```python
import torch

def _softmax(x, axis=-1):
    return torch.softmax(x, dim=axis)
def _gelu(x):
    return torch.nn.functional.gelu(x, approximate="tanh")
def _silu(x):
    return torch.nn.functional.silu(x)
def _sigmoid(x):
    return torch.sigmoid(x)
def _layernorm(x, axis=-1, eps=1e-5):
    m = x.mean(dim=axis, keepdim=True)
    v = x.var(dim=axis, keepdim=True, unbiased=False)
    return (x - m) / torch.sqrt(v + eps)
def _scatter_add(tgt, idx, src, axis=0):
    return tgt.clone().index_add_(axis, idx, src)
def _segment_sum(src, seg, n):
    out = torch.zeros((n,) + src.shape[1:], dtype=src.dtype)
    return out.index_add_(0, seg, src)
def _pad(x, pw):
    flat = tuple(v for pair in reversed(pw) for v in pair)
    return torch.nn.functional.pad(x, flat)

kernel_name = 'gated_mix__ssm_conv_h3__compressed_kv_cla__prompt'

def setup_inputs():

    _w = (lambda a: (lambda t: t.to(torch.bfloat16) if t.is_floating_point() else t)(torch.as_tensor(a)))
    def _A_setup():
        B, S, D = 1, 2048, 1024
        ks = 4
        return {
            "q": _w((lambda *s: torch.randn(*s, dtype=torch.bfloat16) * 0.05)(B, S, D)),
            "k": _w((lambda *s: torch.randn(*s, dtype=torch.bfloat16) * 0.4)(B, S, D)),
            "v": _w((lambda *s: torch.randn(*s, dtype=torch.bfloat16) * 0.4)(B, S, D)),
            "shift_k": _w((lambda *s: torch.randn(*s, dtype=torch.bfloat16) * 0.4)(D, ks) * 0.5),
            "ssm_k": _w((lambda *s: torch.randn(*s, dtype=torch.bfloat16) * 0.8)(D, S) * (1.0 / S ** 0.5)),
            "ssm_D": _w((lambda *s: torch.randn(*s, dtype=torch.bfloat16) * 0.4)(D)),
        }
    _A_in = _A_setup()

    def _B_setup():
        B, H, Sq, Sk, D, M = 1, 32, 2048, 2048, 128, 1024
        Dc = 4 * D
        return {
            "x": _w((lambda *s: torch.randn(*s, dtype=torch.bfloat16) * 0.05)(B, Sq, M)),
            "c_kv": _w((lambda *s: torch.randn(*s, dtype=torch.bfloat16) * 0.4)(B, Sk, Dc)),
            "w_q": _w((lambda *s: torch.randn(*s, dtype=torch.bfloat16) * 6.4)(M, H, D) * (M ** -0.5)),
            "w_uk": _w((lambda *s: torch.randn(*s, dtype=torch.bfloat16) * 6.4)(Dc, H, D) * (Dc ** -0.5)),
            "w_uv": _w((lambda *s: torch.randn(*s, dtype=torch.bfloat16) * 0.4)(Dc, H, D) * (Dc ** -0.5)),
            "w_o": _w((lambda *s: torch.randn(*s, dtype=torch.bfloat16) * 0.4)(H, D, M) * ((H * D) ** -0.5)),
        }
    _B_in = _B_setup()

    return {
        "A_q": _A_in["q"],
        "A_k": _A_in["k"],
        "A_v": _A_in["v"],
        "A_shift_k": _A_in["shift_k"],
        "A_ssm_k": _A_in["ssm_k"],
        "A_ssm_D": _A_in["ssm_D"],
        "B_x": _B_in["x"],
        "B_c_kv": _B_in["c_kv"],
        "B_w_q": _B_in["w_q"],
        "B_w_uk": _B_in["w_uk"],
        "B_w_uv": _B_in["w_uv"],
        "B_w_o": _B_in["w_o"],
        "gate_w": _w((lambda *s: torch.randn(*s, dtype=torch.bfloat16) * 0.05)(1024) * 16.0),
    }

def reference(A_q, A_k, A_v, A_shift_k, A_ssm_k, A_ssm_D, B_x, B_c_kv, B_w_q, B_w_uk, B_w_uv, B_w_o, gate_w):
    def _A_ref(q, k, v, shift_k, ssm_k, ssm_D):
        B, S, D = q.shape
        ks = shift_k.shape[-1]
        k_pad = _pad(k, ((0, 0), (ks - 1, 0), (0, 0)))
        k_shift = torch.zeros_like(k)
        for t in range(ks):
            k_shift = k_shift + k_pad[:, t:t + S, :] * shift_k[:, ks - 1 - t][None, None, :]
        kv = k_shift * v
        L = 2 * S
        kv_pad = _pad(kv, ((0, 0), (0, S), (0, 0)))
        kf_pad = _pad(ssm_k, ((0, 0), (0, S)))
        kv_f = (lambda x, axes=(-2,-1): torch.fft.rfft2(x.float(), dim=axes))(kv_pad[:, None, :, :], axes=(1, 2))
        kf_f = (lambda x, axes=(-2,-1): torch.fft.rfft2(x.float(), dim=axes))(kf_pad[:, None, :], axes=(1, 2))
        kf_f = (lambda x, *d: x.permute(*d))(kf_f, 1, 2, 0)
        y_f = kv_f * kf_f[None, :, :, :]
        y = (lambda x, s, axes=(-2,-1): torch.fft.irfft2(x, s=s, dim=axes).to(torch.bfloat16))(y_f, (1, L), axes=(1, 2))[:, 0, :S, :]
        y = y + kv * ssm_D[None, None, :]
        return q * y

    def _B_ref(x, c_kv, w_q, w_uk, w_uv, w_o):
        B, Sq, M = x.shape[0], x.shape[1], x.shape[2]
        Sk = c_kv.shape[1]
        H, D = w_q.shape[1], w_q.shape[2]
        q = torch.einsum("bqm,mhd->bhqd", x, w_q)
        k = torch.einsum("bkc,chd->bhkd", c_kv, w_uk)
        v = torch.einsum("bkc,chd->bhkd", c_kv, w_uv)
        scores = torch.einsum("bhqd,bhkd->bhqk", q, k) * (D ** -0.5)
        off = Sk - Sq
        qi = torch.arange(Sq)[:, None]
        kj = torch.arange(Sk)[None, :]
        cmask = kj <= (qi + off)
        scores = torch.where(cmask[None, None], scores, -1e9)
        p = _softmax(scores, axis=-1)
        ctx = torch.einsum("bhqk,bhkd->bhqd", p, v)
        return torch.einsum("bhqd,hdm->bqm", ctx, w_o)

    x = A_q
    g = _sigmoid((x * gate_w).sum(-1, keepdims=True))
    a = _A_ref(x, A_k, A_v, A_shift_k, A_ssm_k, A_ssm_D)
    b = _B_ref(x, B_c_kv, B_w_q, B_w_uk, B_w_uv, B_w_o)
    return g * a + (1 - g) * b
```

```asm
; @launch kernel=kz_kernel grid=(256,1,1) block=(256,1,1) lds=0
; @launch kernel=ka_kernel grid=(256,1,1) block=(256,1,1) lds=131072
; @launch kernel=kb_kernel grid=(256,1,1) block=(256,1,1) lds=147456
; @launch kernel=kc_kernel grid=(256,1,1) block=(256,1,1) lds=102400
; @launch kernel=kd_kernel grid=(256,1,1) block=(256,1,1) lds=131072
.amdgcn_target "amdgcn-amd-amdhsa--gfx950"
.text
.globl kz_kernel
.p2align 8
.type kz_kernel,@function
kz_kernel:
  s_cmp_ge_u32 s2, 256
  s_cbranch_scc1 L_kz_kernel_end
  s_load_dwordx8 s[48:55], s[0:1], 0
  s_load_dwordx2 s[56:57], s[0:1], 96
  s_load_dwordx2 s[58:59], s[0:1], 120
  v_lshrrev_b32 v2, 6, v0
  v_and_b32 v1, 63, v0
  v_readfirstlane_b32 s3, v2
  s_waitcnt lgkmcnt(0)
  s_mov_b32 s20, s48
  s_mov_b32 s21, s49
  s_mov_b32 s22, 4194304
  s_mov_b32 s23, 0x20000
  s_mov_b32 s8, s50
  s_mov_b32 s9, s51
  s_mov_b32 s10, 4194304
  s_mov_b32 s11, 0x20000
  s_mov_b32 s12, s52
  s_mov_b32 s13, s53
  s_mov_b32 s14, 4194304
  s_mov_b32 s15, 0x20000
  s_mov_b32 s16, s54
  s_mov_b32 s17, s55
  s_mov_b32 s18, 8192
  s_mov_b32 s19, 0x20000
  s_mov_b32 s24, s56
  s_mov_b32 s25, s57
  s_mov_b32 s26, 2048
  s_mov_b32 s27, 0x20000
  s_add_u32 s28, s58, 50331648
  s_addc_u32 s29, s59, 0
  s_mov_b32 s30, 4194304
  s_mov_b32 s31, 0x20000
  s_add_u32 s32, s58, 58720256
  s_addc_u32 s33, s59, 0
  s_mov_b32 s34, 8192
  s_mov_b32 s35, 0x20000
  s_and_b32 s36, s2, 15
  s_lshl_b32 s36, s36, 2
  s_add_u32 s36, s36, s3
  s_lshr_b32 s37, s2, 4
  v_and_b32 v112, 3, v1
  v_lshrrev_b32 v113, 2, v1
  s_lshl_b32 s38, s36, 2
  v_add_u32 v112, s38, v112
  s_lshl_b32 s38, s37, 4
  v_add_u32 v113, s38, v113
  v_lshlrev_b32 v114, 14, v113
  v_lshl_add_u32 v114, v112, 3, v114
  v_add_u32 v4, -6144, v114
  v_lshlrev_b32 v6, 5, v112
  v_lshlrev_b32 v114, 4, v113
  v_sub_u32 v114, 4080, v114
  v_lshl_add_u32 v5, v112, 14, v114
  v_and_b32 v112, 31, v1
  v_lshlrev_b32 v8, 4, v112
  s_lshl_b32 s38, s2, 2
  s_add_u32 s38, s38, s3
  s_lshl_b32 s38, s38, 1
  v_lshrrev_b32 v113, 5, v1
  v_add_u32 v113, s38, v113
  v_lshl_add_u32 v7, v113, 11, v8
  v_lshlrev_b32 v113, 2, v113
  v_cmp_eq_u32 vcc, 0, v112
  v_mov_b32 v114, 0x40000000
s_nop 0
  v_cndmask_b32 v9, v114, v113, vcc
  buffer_load_dwordx4 v[56:59], v7, s[20:23], 0 offen offset:0
  buffer_load_dwordx4 v[72:75], v8, s[24:27], 0 offen offset:0
  buffer_load_dwordx4 v[60:63], v7, s[20:23], 0 offen offset:512
  buffer_load_dwordx4 v[76:79], v8, s[24:27], 0 offen offset:512
  buffer_load_dwordx4 v[64:67], v7, s[20:23], 0 offen offset:1024
  buffer_load_dwordx4 v[80:83], v8, s[24:27], 0 offen offset:1024
  buffer_load_dwordx4 v[68:71], v7, s[20:23], 0 offen offset:1536
  buffer_load_dwordx4 v[84:87], v8, s[24:27], 0 offen offset:1536
  buffer_load_dwordx4 v[48:51], v6, s[16:19], 0 offen offset:0
  buffer_load_dwordx4 v[52:55], v6, s[16:19], 0 offen offset:16
  v_add_u32 v112, 0, v4
  buffer_load_dwordx2 v[10:11], v112, s[8:11], 0 offen
  v_add_u32 v113, 2048, v4
  buffer_load_dwordx2 v[12:13], v113, s[8:11], 0 offen
  v_add_u32 v114, 4096, v4
  buffer_load_dwordx2 v[14:15], v114, s[8:11], 0 offen
  v_add_u32 v115, 6144, v4
  buffer_load_dwordx2 v[16:17], v115, s[8:11], 0 offen
  buffer_load_dwordx2 v[32:33], v115, s[12:15], 0 offen
  v_add_u32 v112, 8192, v4
  buffer_load_dwordx2 v[18:19], v112, s[8:11], 0 offen
  buffer_load_dwordx2 v[34:35], v112, s[12:15], 0 offen
  v_add_u32 v113, 10240, v4
  buffer_load_dwordx2 v[20:21], v113, s[8:11], 0 offen
  buffer_load_dwordx2 v[36:37], v113, s[12:15], 0 offen
  v_add_u32 v114, 12288, v4
  buffer_load_dwordx2 v[22:23], v114, s[8:11], 0 offen
  buffer_load_dwordx2 v[38:39], v114, s[12:15], 0 offen
  v_add_u32 v115, 14336, v4
  buffer_load_dwordx2 v[24:25], v115, s[8:11], 0 offen
  buffer_load_dwordx2 v[40:41], v115, s[12:15], 0 offen
  v_add_u32 v112, 16384, v4
  buffer_load_dwordx2 v[26:27], v112, s[8:11], 0 offen
  buffer_load_dwordx2 v[42:43], v112, s[12:15], 0 offen
  v_add_u32 v113, 18432, v4
  buffer_load_dwordx2 v[28:29], v113, s[8:11], 0 offen
  buffer_load_dwordx2 v[44:45], v113, s[12:15], 0 offen
  v_add_u32 v114, 20480, v4
  buffer_load_dwordx2 v[30:31], v114, s[8:11], 0 offen
  buffer_load_dwordx2 v[46:47], v114, s[12:15], 0 offen
  v_mov_b32 v112, 0
  v_mov_b32 v113, 0
s_waitcnt vmcnt(27)
  v_dot2_f32_bf16 v112, v56, v72, v112
  v_dot2_f32_bf16 v113, v57, v73, v113
  v_dot2_f32_bf16 v112, v58, v74, v112
  v_dot2_f32_bf16 v113, v59, v75, v113
s_waitcnt vmcnt(25)
  v_dot2_f32_bf16 v112, v60, v76, v112
  v_dot2_f32_bf16 v113, v61, v77, v113
  v_dot2_f32_bf16 v112, v62, v78, v112
  v_dot2_f32_bf16 v113, v63, v79, v113
s_waitcnt vmcnt(23)
  v_dot2_f32_bf16 v112, v64, v80, v112
  v_dot2_f32_bf16 v113, v65, v81, v113
  v_dot2_f32_bf16 v112, v66, v82, v112
  v_dot2_f32_bf16 v113, v67, v83, v113
s_waitcnt vmcnt(21)
  v_dot2_f32_bf16 v112, v68, v84, v112
  v_dot2_f32_bf16 v113, v69, v85, v113
  v_dot2_f32_bf16 v112, v70, v86, v112
  v_dot2_f32_bf16 v113, v71, v87, v113
  s_nop 2
  v_add_f32 v112, v112, v113
  s_nop 1
  v_add_f32_dpp v112, v112, v112 row_ror:8 row_mask:0xf bank_mask:0xf
  s_nop 1
  v_add_f32_dpp v112, v112, v112 row_ror:4 row_mask:0xf bank_mask:0xf
  s_nop 1
  v_add_f32_dpp v112, v112, v112 row_ror:2 row_mask:0xf bank_mask:0xf
  s_nop 1
  v_add_f32_dpp v112, v112, v112 row_ror:1 row_mask:0xf bank_mask:0xf
  v_mov_b32 v113, v112
  s_nop 1
  v_permlane16_swap_b32 v112, v113
  v_add_f32 v112, v112, v113
  v_mul_f32 v112, 0xbfb8aa3b, v112
  v_exp_f32 v112, v112
  s_nop 0
  v_add_f32 v112, 1.0, v112
  v_rcp_f32 v112, v112
  s_nop 0
  buffer_store_dword v112, v9, s[32:35], 0 offen sc1
s_waitcnt vmcnt(21)
  v_lshlrev_b32 v78, 16, v48
  v_and_b32 v79, 0xffff0000, v48
  v_lshlrev_b32 v80, 16, v49
  v_and_b32 v81, 0xffff0000, v49
  v_lshlrev_b32 v82, 16, v50
  v_and_b32 v83, 0xffff0000, v50
  v_lshlrev_b32 v84, 16, v51
  v_and_b32 v85, 0xffff0000, v51
s_waitcnt vmcnt(19)
  v_lshlrev_b32 v56, 16, v10
  v_and_b32 v57, 0xffff0000, v10
s_waitcnt vmcnt(18)
  v_lshlrev_b32 v58, 16, v12
  v_and_b32 v59, 0xffff0000, v12
s_waitcnt vmcnt(17)
  v_lshlrev_b32 v60, 16, v14
  v_and_b32 v61, 0xffff0000, v14
s_waitcnt vmcnt(16)
  v_lshlrev_b32 v62, 16, v16
  v_and_b32 v63, 0xffff0000, v16
s_waitcnt vmcnt(14)
  v_lshlrev_b32 v64, 16, v18
  v_and_b32 v65, 0xffff0000, v18
s_waitcnt vmcnt(12)
  v_lshlrev_b32 v66, 16, v20
  v_and_b32 v67, 0xffff0000, v20
s_waitcnt vmcnt(10)
  v_lshlrev_b32 v68, 16, v22
  v_and_b32 v69, 0xffff0000, v22
s_waitcnt vmcnt(8)
  v_lshlrev_b32 v70, 16, v24
  v_and_b32 v71, 0xffff0000, v24
s_waitcnt vmcnt(6)
  v_lshlrev_b32 v72, 16, v26
  v_and_b32 v73, 0xffff0000, v26
s_waitcnt vmcnt(4)
  v_lshlrev_b32 v74, 16, v28
  v_and_b32 v75, 0xffff0000, v28
s_waitcnt vmcnt(2)
  v_lshlrev_b32 v76, 16, v30
  v_and_b32 v77, 0xffff0000, v30
  v_lshlrev_b32 v114, 16, v32
  v_and_b32 v115, 0xffff0000, v32
  v_mul_f32 v88, v62, v78
  v_mul_f32 v96, v63, v82
  v_fmac_f32 v88, v60, v79
  v_fmac_f32 v96, v61, v83
  v_fmac_f32 v88, v58, v80
  v_fmac_f32 v96, v59, v84
  v_fmac_f32 v88, v56, v81
  v_fmac_f32 v96, v57, v85
  v_mul_f32 v88, v88, v114
  v_mul_f32 v96, v96, v115
  v_lshlrev_b32 v114, 16, v34
  v_and_b32 v115, 0xffff0000, v34
  v_mul_f32 v89, v64, v78
  v_mul_f32 v97, v65, v82
  v_fmac_f32 v89, v62, v79
  v_fmac_f32 v97, v63, v83
  v_fmac_f32 v89, v60, v80
  v_fmac_f32 v97, v61, v84
  v_fmac_f32 v89, v58, v81
  v_fmac_f32 v97, v59, v85
  v_mul_f32 v89, v89, v114
  v_mul_f32 v97, v97, v115
  v_lshlrev_b32 v114, 16, v36
  v_and_b32 v115, 0xffff0000, v36
  v_mul_f32 v90, v66, v78
  v_mul_f32 v98, v67, v82
  v_fmac_f32 v90, v64, v79
  v_fmac_f32 v98, v65, v83
  v_fmac_f32 v90, v62, v80
  v_fmac_f32 v98, v63, v84
  v_fmac_f32 v90, v60, v81
  v_fmac_f32 v98, v61, v85
  v_mul_f32 v90, v90, v114
  v_mul_f32 v98, v98, v115
  v_lshlrev_b32 v114, 16, v38
  v_and_b32 v115, 0xffff0000, v38
  v_mul_f32 v91, v68, v78
  v_mul_f32 v99, v69, v82
  v_fmac_f32 v91, v66, v79
  v_fmac_f32 v99, v67, v83
  v_fmac_f32 v91, v64, v80
  v_fmac_f32 v99, v65, v84
  v_fmac_f32 v91, v62, v81
  v_fmac_f32 v99, v63, v85
  v_mul_f32 v91, v91, v114
  v_mul_f32 v99, v99, v115
  v_lshlrev_b32 v114, 16, v40
  v_and_b32 v115, 0xffff0000, v40
  v_mul_f32 v92, v70, v78
  v_mul_f32 v100, v71, v82
  v_fmac_f32 v92, v68, v79
  v_fmac_f32 v100, v69, v83
  v_fmac_f32 v92, v66, v80
  v_fmac_f32 v100, v67, v84
  v_fmac_f32 v92, v64, v81
  v_fmac_f32 v100, v65, v85
  v_mul_f32 v92, v92, v114
  v_mul_f32 v100, v100, v115
  v_lshlrev_b32 v114, 16, v42
  v_and_b32 v115, 0xffff0000, v42
  v_mul_f32 v93, v72, v78
  v_mul_f32 v101, v73, v82
  v_fmac_f32 v93, v70, v79
  v_fmac_f32 v101, v71, v83
  v_fmac_f32 v93, v68, v80
  v_fmac_f32 v101, v69, v84
  v_fmac_f32 v93, v66, v81
  v_fmac_f32 v101, v67, v85
  v_mul_f32 v93, v93, v114
  v_mul_f32 v101, v101, v115
  v_lshlrev_b32 v114, 16, v44
  v_and_b32 v115, 0xffff0000, v44
  v_mul_f32 v94, v74, v78
  v_mul_f32 v102, v75, v82
  v_fmac_f32 v94, v72, v79
  v_fmac_f32 v102, v73, v83
  v_fmac_f32 v94, v70, v80
  v_fmac_f32 v102, v71, v84
  v_fmac_f32 v94, v68, v81
  v_fmac_f32 v102, v69, v85
  v_mul_f32 v94, v94, v114
  v_mul_f32 v102, v102, v115
s_waitcnt vmcnt(1)
  v_lshlrev_b32 v114, 16, v46
  v_and_b32 v115, 0xffff0000, v46
  v_mul_f32 v95, v76, v78
  v_mul_f32 v103, v77, v82
  v_fmac_f32 v95, v74, v79
  v_fmac_f32 v103, v75, v83
  v_fmac_f32 v95, v72, v80
  v_fmac_f32 v103, v73, v84
  v_fmac_f32 v95, v70, v81
  v_fmac_f32 v103, v71, v85
  v_mul_f32 v95, v95, v114
  v_mul_f32 v103, v103, v115
  v_cvt_pk_bf16_f32 v104, v95, v94
  v_cvt_pk_bf16_f32 v105, v93, v92
  v_cvt_pk_bf16_f32 v106, v91, v90
  v_cvt_pk_bf16_f32 v107, v89, v88
  s_mov_b32 s36, 0
  buffer_store_dwordx4 v[104:107], v5, s[28:31], s36 offen sc1
  v_cvt_pk_bf16_f32 v108, v103, v102
  v_cvt_pk_bf16_f32 v109, v101, v100
  v_cvt_pk_bf16_f32 v110, v99, v98
  v_cvt_pk_bf16_f32 v111, v97, v96
  s_mov_b32 s36, 4096
  buffer_store_dwordx4 v[108:111], v5, s[28:31], s36 offen sc1
  v_lshlrev_b32 v78, 16, v52
  v_and_b32 v79, 0xffff0000, v52
  v_lshlrev_b32 v80, 16, v53
  v_and_b32 v81, 0xffff0000, v53
  v_lshlrev_b32 v82, 16, v54
  v_and_b32 v83, 0xffff0000, v54
  v_lshlrev_b32 v84, 16, v55
  v_and_b32 v85, 0xffff0000, v55
  v_lshlrev_b32 v56, 16, v11
  v_and_b32 v57, 0xffff0000, v11
  v_lshlrev_b32 v58, 16, v13
  v_and_b32 v59, 0xffff0000, v13
  v_lshlrev_b32 v60, 16, v15
  v_and_b32 v61, 0xffff0000, v15
  v_lshlrev_b32 v62, 16, v17
  v_and_b32 v63, 0xffff0000, v17
  v_lshlrev_b32 v64, 16, v19
  v_and_b32 v65, 0xffff0000, v19
  v_lshlrev_b32 v66, 16, v21
  v_and_b32 v67, 0xffff0000, v21
  v_lshlrev_b32 v68, 16, v23
  v_and_b32 v69, 0xffff0000, v23
  v_lshlrev_b32 v70, 16, v25
  v_and_b32 v71, 0xffff0000, v25
  v_lshlrev_b32 v72, 16, v27
  v_and_b32 v73, 0xffff0000, v27
  v_lshlrev_b32 v74, 16, v29
  v_and_b32 v75, 0xffff0000, v29
  v_lshlrev_b32 v76, 16, v31
  v_and_b32 v77, 0xffff0000, v31
  v_lshlrev_b32 v114, 16, v33
  v_and_b32 v115, 0xffff0000, v33
  v_mul_f32 v88, v62, v78
  v_mul_f32 v96, v63, v82
  v_fmac_f32 v88, v60, v79
  v_fmac_f32 v96, v61, v83
  v_fmac_f32 v88, v58, v80
  v_fmac_f32 v96, v59, v84
  v_fmac_f32 v88, v56, v81
  v_fmac_f32 v96, v57, v85
  v_mul_f32 v88, v88, v114
  v_mul_f32 v96, v96, v115
  v_lshlrev_b32 v114, 16, v35
  v_and_b32 v115, 0xffff0000, v35
  v_mul_f32 v89, v64, v78
  v_mul_f32 v97, v65, v82
  v_fmac_f32 v89, v62, v79
  v_fmac_f32 v97, v63, v83
  v_fmac_f32 v89, v60, v80
  v_fmac_f32 v97, v61, v84
  v_fmac_f32 v89, v58, v81
  v_fmac_f32 v97, v59, v85
  v_mul_f32 v89, v89, v114
  v_mul_f32 v97, v97, v115
  v_lshlrev_b32 v114, 16, v37
  v_and_b32 v115, 0xffff0000, v37
  v_mul_f32 v90, v66, v78
  v_mul_f32 v98, v67, v82
  v_fmac_f32 v90, v64, v79
  v_fmac_f32 v98, v65, v83
  v_fmac_f32 v90, v62, v80
  v_fmac_f32 v98, v63, v84
  v_fmac_f32 v90, v60, v81
  v_fmac_f32 v98, v61, v85
  v_mul_f32 v90, v90, v114
  v_mul_f32 v98, v98, v115
  v_lshlrev_b32 v114, 16, v39
  v_and_b32 v115, 0xffff0000, v39
  v_mul_f32 v91, v68, v78
  v_mul_f32 v99, v69, v82
  v_fmac_f32 v91, v66, v79
  v_fmac_f32 v99, v67, v83
  v_fmac_f32 v91, v64, v80
  v_fmac_f32 v99, v65, v84
  v_fmac_f32 v91, v62, v81
  v_fmac_f32 v99, v63, v85
  v_mul_f32 v91, v91, v114
  v_mul_f32 v99, v99, v115
  v_lshlrev_b32 v114, 16, v41
  v_and_b32 v115, 0xffff0000, v41
  v_mul_f32 v92, v70, v78
  v_mul_f32 v100, v71, v82
  v_fmac_f32 v92, v68, v79
  v_fmac_f32 v100, v69, v83
  v_fmac_f32 v92, v66, v80
  v_fmac_f32 v100, v67, v84
  v_fmac_f32 v92, v64, v81
  v_fmac_f32 v100, v65, v85
  v_mul_f32 v92, v92, v114
  v_mul_f32 v100, v100, v115
  v_lshlrev_b32 v114, 16, v43
  v_and_b32 v115, 0xffff0000, v43
  v_mul_f32 v93, v72, v78
  v_mul_f32 v101, v73, v82
  v_fmac_f32 v93, v70, v79
  v_fmac_f32 v101, v71, v83
  v_fmac_f32 v93, v68, v80
  v_fmac_f32 v101, v69, v84
  v_fmac_f32 v93, v66, v81
  v_fmac_f32 v101, v67, v85
  v_mul_f32 v93, v93, v114
  v_mul_f32 v101, v101, v115
  v_lshlrev_b32 v114, 16, v45
  v_and_b32 v115, 0xffff0000, v45
  v_mul_f32 v94, v74, v78
  v_mul_f32 v102, v75, v82
  v_fmac_f32 v94, v72, v79
  v_fmac_f32 v102, v73, v83
  v_fmac_f32 v94, v70, v80
  v_fmac_f32 v102, v71, v84
  v_fmac_f32 v94, v68, v81
  v_fmac_f32 v102, v69, v85
  v_mul_f32 v94, v94, v114
  v_mul_f32 v102, v102, v115
  v_lshlrev_b32 v114, 16, v47
  v_and_b32 v115, 0xffff0000, v47
  v_mul_f32 v95, v76, v78
  v_mul_f32 v103, v77, v82
  v_fmac_f32 v95, v74, v79
  v_fmac_f32 v103, v75, v83
  v_fmac_f32 v95, v72, v80
  v_fmac_f32 v103, v73, v84
  v_fmac_f32 v95, v70, v81
  v_fmac_f32 v103, v71, v85
  v_mul_f32 v95, v95, v114
  v_mul_f32 v103, v103, v115
  v_cvt_pk_bf16_f32 v104, v95, v94
  v_cvt_pk_bf16_f32 v105, v93, v92
  v_cvt_pk_bf16_f32 v106, v91, v90
  v_cvt_pk_bf16_f32 v107, v89, v88
  s_mov_b32 s36, 8192
  buffer_store_dwordx4 v[104:107], v5, s[28:31], s36 offen sc1
  v_cvt_pk_bf16_f32 v108, v103, v102
  v_cvt_pk_bf16_f32 v109, v101, v100
  v_cvt_pk_bf16_f32 v110, v99, v98
  v_cvt_pk_bf16_f32 v111, v97, v96
  s_mov_b32 s36, 12288
  buffer_store_dwordx4 v[108:111], v5, s[28:31], s36 offen sc1
L_kz_kernel_end:
  s_endpgm
.section .rodata,"a"
.p2align 6
.amdhsa_kernel kz_kernel
  .amdhsa_next_free_vgpr 128
  .amdhsa_next_free_sgpr 102
  .amdhsa_accum_offset 128
  .amdhsa_group_segment_fixed_size 0
  .amdhsa_kernarg_size 128
  .amdhsa_user_sgpr_count 2
  .amdhsa_user_sgpr_kernarg_segment_ptr 1
  .amdhsa_system_sgpr_workgroup_id_x 1
  .amdhsa_float_denorm_mode_32 3
.end_amdhsa_kernel
.text
.globl ka_kernel
.p2align 8
.type ka_kernel,@function
ka_kernel:
  s_cmp_ge_u32 s2, 256
  s_cbranch_scc1 L_ka_kernel_end
  s_load_dwordx2 s[32:33], s[0:1], 56
  s_load_dwordx4 s[36:39], s[0:1], 72
  s_load_dwordx2 s[40:41], s[0:1], 120
  v_lshrrev_b32 v29, 6, v0
  v_and_b32 v1, 63, v0
  v_readfirstlane_b32 s3, v29
  s_and_b32 s25, s2, 7
  s_lshr_b32 s26, s2, 3
  s_and_b32 s27, s26, 7
  s_lshr_b32 s26, s26, 3
  s_lshr_b32 s30, s26, 1
  s_and_b32 s26, s26, 1
  s_lshl_b32 s25, s25, 1
  s_add_u32 s25, s25, s26
  s_lshl_b32 s20, s27, 18
  s_lshl_b32 s28, s3, 16
  s_add_u32 s20, s20, s28
  s_lshl_b32 s21, s3, 17
  s_lshl_b32 s28, s25, 9
  s_add_u32 s21, s21, s28
  s_lshl_b32 s22, s3, 13
  s_add_u32 s23, s22, 65536
  s_lshl_b32 s25, s25, 1
  s_lshr_b32 s28, s3, 1
  s_add_u32 s25, s25, s28
  s_lshl_b32 s24, s25, 19
  s_lshl_b32 s27, s27, 16
  s_add_u32 s24, s24, s27
  s_and_b32 s28, s3, 1
  s_lshl_b32 s28, s28, 15
  s_add_u32 s24, s24, s28
  s_mov_b32 s31, 0x3e0293ee
  v_lshrrev_b32 v29, 3, v1
  v_lshlrev_b32 v29, 10, v29
  v_lshrrev_b32 v30, 4, v1
  v_and_b32 v31, 7, v1
  v_xor_b32 v31, v31, v30
  v_lshl_add_u32 v29, v31, 4, v29
  v_xor_b32 v32, 64, v29
  v_add_u32 v2, 0, v29
  v_add_u32 v3, 7168, v32
  v_add_u32 v4, 14336, v29
  v_add_u32 v5, 21504, v32
  v_add_u32 v6, 32768, v29
  v_add_u32 v7, 39936, v32
  v_add_u32 v8, 47104, v29
  v_add_u32 v9, 54272, v32
  v_lshrrev_b32 v29, 5, v1
  v_and_b32 v31, 31, v1
  v_lshlrev_b32 v32, 1, v29
  v_xor_b32 v31, v31, v32
  v_lshlrev_b32 v29, 13, v29
  v_xor_b32 v32, 0, v31
  v_lshl_add_u32 v32, v32, 4, v29
  v_add_u32 v10, 0, v32
  v_xor_b32 v32, 4, v31
  v_lshl_add_u32 v32, v32, 4, v29
  v_add_u32 v11, 15360, v32
  v_xor_b32 v32, 0, v31
  v_lshl_add_u32 v32, v32, 4, v29
  v_add_u32 v12, 30720, v32
  v_xor_b32 v32, 4, v31
  v_lshl_add_u32 v32, v32, 4, v29
  v_add_u32 v13, 46080, v32
  v_xor_b32 v32, 8, v31
  v_lshl_add_u32 v32, v32, 4, v29
  v_add_u32 v14, 65536, v32
  v_xor_b32 v32, 12, v31
  v_lshl_add_u32 v32, v32, 4, v29
  v_add_u32 v15, 80896, v32
  v_xor_b32 v32, 8, v31
  v_lshl_add_u32 v32, v32, 4, v29
  v_add_u32 v16, 96256, v32
  v_xor_b32 v32, 12, v31
  v_lshl_add_u32 v32, v32, 4, v29
  v_add_u32 v17, 111616, v32
  v_and_b32 v29, 15, v1
  v_lshrrev_b32 v31, 1, v29
  v_xor_b32 v31, v31, v30
  v_lshlrev_b32 v31, 4, v31
  v_lshl_add_u32 v31, v29, 7, v31
  s_and_b32 s28, s3, 1
  s_lshl_b32 s28, s28, 14
  v_add_u32 v18, s28, v31
  v_xor_b32 v19, 64, v18
  v_bfe_u32 v29, v1, 2, 2
  v_and_b32 v31, 1, v30
  v_lshl_or_b32 v31, v31, 2, v29
  v_lshl_add_u32 v29, v30, 3, v29
  v_lshlrev_b32 v29, 9, v29
  v_and_b32 v32, 3, v1
  v_lshl_add_u32 v29, v32, 3, v29
  s_lshr_b32 s28, s3, 1
  s_lshl_b32 s28, s28, 8
  s_add_u32 s28, s28, 65536
  v_add_u32 v29, s28, v29
  v_xor_b32 v32, 0, v31
  v_lshl_add_u32 v20, v32, 5, v29
  v_xor_b32 v32, 1, v31
  v_lshl_add_u32 v21, v32, 5, v29
  v_xor_b32 v32, 2, v31
  v_lshl_add_u32 v22, v32, 5, v29
  v_xor_b32 v32, 3, v31
  v_lshl_add_u32 v23, v32, 5, v29
  v_xor_b32 v32, 4, v31
  v_lshl_add_u32 v24, v32, 5, v29
  v_xor_b32 v32, 5, v31
  v_lshl_add_u32 v25, v32, 5, v29
  v_xor_b32 v32, 6, v31
  v_lshl_add_u32 v26, v32, 5, v29
  v_xor_b32 v32, 7, v31
  v_lshl_add_u32 v27, v32, 5, v29
  s_waitcnt lgkmcnt(0)
  s_mov_b32 s8, s32
  s_mov_b32 s9, s33
  s_mov_b32 s10, 2097152
  s_mov_b32 s11, 0x20000
  s_cmp_eq_u32 s30, 0
  s_cselect_b32 s12, s36, s38
  s_cselect_b32 s13, s37, s39
  s_mov_b32 s14, 4194304
  s_mov_b32 s15, 0x20000
  s_lshl_b32 s25, s30, 24
  s_add_u32 s16, s40, s25
  s_addc_u32 s17, s41, 0
  s_mov_b32 s18, 16777216
  s_mov_b32 s19, 0x20000
  s_add_u32 m0, s22, 0
s_nop 0
  buffer_load_dwordx4 v2, s[8:11], s20 offen offset:0 lds
  buffer_load_dwordx4 v3, s[8:11], s20 offen offset:1024 lds
  buffer_load_dwordx4 v4, s[8:11], s20 offen offset:2048 lds
  buffer_load_dwordx4 v5, s[8:11], s20 offen offset:3072 lds
  s_add_u32 m0, s23, 0
s_nop 0
  buffer_load_dwordx4 v10, s[12:15], s21 offen offset:0 lds
  buffer_load_dwordx4 v11, s[12:15], s21 offen offset:1024 lds
  buffer_load_dwordx4 v12, s[12:15], s21 offen offset:2048 lds
  buffer_load_dwordx4 v13, s[12:15], s21 offen offset:3072 lds
  s_add_u32 m0, s22, 4096
s_nop 0
  buffer_load_dwordx4 v6, s[8:11], s20 offen offset:0 lds
  buffer_load_dwordx4 v7, s[8:11], s20 offen offset:1024 lds
  buffer_load_dwordx4 v8, s[8:11], s20 offen offset:2048 lds
  buffer_load_dwordx4 v9, s[8:11], s20 offen offset:3072 lds
  s_add_u32 m0, s23, 4096
s_nop 0
  buffer_load_dwordx4 v14, s[12:15], s21 offen offset:0 lds
  buffer_load_dwordx4 v15, s[12:15], s21 offen offset:1024 lds
  buffer_load_dwordx4 v16, s[12:15], s21 offen offset:2048 lds
  buffer_load_dwordx4 v17, s[12:15], s21 offen offset:3072 lds
  s_add_u32 s20, s20, 128
  s_add_u32 s21, s21, 524288
  s_add_u32 m0, s22, 32768
s_nop 0
  buffer_load_dwordx4 v2, s[8:11], s20 offen offset:0 lds
  buffer_load_dwordx4 v3, s[8:11], s20 offen offset:1024 lds
  buffer_load_dwordx4 v4, s[8:11], s20 offen offset:2048 lds
  buffer_load_dwordx4 v5, s[8:11], s20 offen offset:3072 lds
  s_add_u32 m0, s23, 32768
s_nop 0
  buffer_load_dwordx4 v10, s[12:15], s21 offen offset:0 lds
  buffer_load_dwordx4 v11, s[12:15], s21 offen offset:1024 lds
  buffer_load_dwordx4 v12, s[12:15], s21 offen offset:2048 lds
  buffer_load_dwordx4 v13, s[12:15], s21 offen offset:3072 lds
  s_add_u32 m0, s22, 36864
s_nop 0
  buffer_load_dwordx4 v6, s[8:11], s20 offen offset:0 lds
  buffer_load_dwordx4 v7, s[8:11], s20 offen offset:1024 lds
  buffer_load_dwordx4 v8, s[8:11], s20 offen offset:2048 lds
  buffer_load_dwordx4 v9, s[8:11], s20 offen offset:3072 lds
  s_add_u32 m0, s23, 36864
s_nop 0
  buffer_load_dwordx4 v14, s[12:15], s21 offen offset:0 lds
  buffer_load_dwordx4 v15, s[12:15], s21 offen offset:1024 lds
  buffer_load_dwordx4 v16, s[12:15], s21 offen offset:2048 lds
  buffer_load_dwordx4 v17, s[12:15], s21 offen offset:3072 lds
  s_add_u32 s20, s20, 128
  s_add_u32 s21, s21, 524288
  s_waitcnt vmcnt(16)
  s_barrier
  ds_read_b128 v[36:39], v18 offset:0
  ds_read_b128 v[40:43], v18 offset:2048
  ds_read_b128 v[44:47], v18 offset:4096
  ds_read_b128 v[48:51], v18 offset:6144
  ds_read_b128 v[52:55], v18 offset:8192
  ds_read_b128 v[56:59], v18 offset:10240
  ds_read_b128 v[60:63], v18 offset:12288
  ds_read_b128 v[64:67], v18 offset:14336
  ds_read_b64_tr_b16 v[100:101], v20 offset:0
  ds_read_b64_tr_b16 v[102:103], v20 offset:2048
  ds_read_b64_tr_b16 v[104:105], v21 offset:0
  ds_read_b64_tr_b16 v[106:107], v21 offset:2048
  ds_read_b64_tr_b16 v[108:109], v22 offset:0
  ds_read_b64_tr_b16 v[110:111], v22 offset:2048
  ds_read_b64_tr_b16 v[112:113], v23 offset:0
  ds_read_b64_tr_b16 v[114:115], v23 offset:2048
  ds_read_b64_tr_b16 v[116:117], v24 offset:0
  ds_read_b64_tr_b16 v[118:119], v24 offset:2048
  ds_read_b64_tr_b16 v[120:121], v25 offset:0
  ds_read_b64_tr_b16 v[122:123], v25 offset:2048
  ds_read_b64_tr_b16 v[124:125], v26 offset:0
  ds_read_b64_tr_b16 v[126:127], v26 offset:2048
  ds_read_b64_tr_b16 v[128:129], v27 offset:0
  ds_read_b64_tr_b16 v[130:131], v27 offset:2048
  s_cmp_eq_u32 s30, 0
  s_cbranch_scc0 L_ka_kernel_V
  v_bfe_u32 v29, v1, 4, 1
  v_lshlrev_b32 v29, 10, v29
  v_bfe_u32 v30, v1, 3, 1
  v_lshl_add_u32 v29, v30, 8, v29
  v_and_b32 v30, 7, v1
  v_lshl_add_u32 v29, v30, 4, v29
  v_lshrrev_b32 v30, 5, v1
  v_lshl_add_u32 v28, v30, 9, v29
s_waitcnt lgkmcnt(14)
  v_mfma_f32_16x16x32_bf16 a[0:3], v[100:103], v[36:39], 0
  v_mfma_f32_16x16x32_bf16 a[4:7], v[100:103], v[40:43], 0
  v_mfma_f32_16x16x32_bf16 a[8:11], v[100:103], v[44:47], 0
  ds_read_b128 v[68:71], v19 offset:0
  v_mfma_f32_16x16x32_bf16 a[12:15], v[100:103], v[48:51], 0
  v_mfma_f32_16x16x32_bf16 a[16:19], v[100:103], v[52:55], 0
  v_mfma_f32_16x16x32_bf16 a[20:23], v[100:103], v[56:59], 0
  v_mfma_f32_16x16x32_bf16 a[24:27], v[100:103], v[60:63], 0
  v_mfma_f32_16x16x32_bf16 a[28:31], v[100:103], v[64:67], 0
  ds_read_b64_tr_b16 v[100:101], v20 offset:16384
s_waitcnt lgkmcnt(14)
  v_mfma_f32_16x16x32_bf16 a[32:35], v[104:107], v[36:39], 0
  ds_read_b64_tr_b16 v[102:103], v20 offset:18432
  ds_read_b128 v[72:75], v19 offset:2048
  v_mfma_f32_16x16x32_bf16 a[36:39], v[104:107], v[40:43], 0
  v_mfma_f32_16x16x32_bf16 a[40:43], v[104:107], v[44:47], 0
  v_mfma_f32_16x16x32_bf16 a[44:47], v[104:107], v[48:51], 0
  v_mfma_f32_16x16x32_bf16 a[48:51], v[104:107], v[52:55], 0
  v_mfma_f32_16x16x32_bf16 a[52:55], v[104:107], v[56:59], 0
  v_mfma_f32_16x16x32_bf16 a[56:59], v[104:107], v[60:63], 0
  ds_read_b128 v[76:79], v19 offset:4096
  v_mfma_f32_16x16x32_bf16 a[60:63], v[104:107], v[64:67], 0
  ds_read_b64_tr_b16 v[104:105], v21 offset:16384
s_waitcnt lgkmcnt(15)
  v_mfma_f32_16x16x32_bf16 a[64:67], v[108:111], v[36:39], 0
  ds_read_b64_tr_b16 v[106:107], v21 offset:18432
  v_mfma_f32_16x16x32_bf16 a[68:71], v[108:111], v[40:43], 0
  v_mfma_f32_16x16x32_bf16 a[72:75], v[108:111], v[44:47], 0
  v_mfma_f32_16x16x32_bf16 a[76:79], v[108:111], v[48:51], 0
  v_mfma_f32_16x16x32_bf16 a[80:83], v[108:111], v[52:55], 0
  ds_read_b128 v[80:83], v19 offset:6144
  v_mfma_f32_16x16x32_bf16 a[84:87], v[108:111], v[56:59], 0
  v_mfma_f32_16x16x32_bf16 a[88:91], v[108:111], v[60:63], 0
  v_mfma_f32_16x16x32_bf16 a[92:95], v[108:111], v[64:67], 0
  ds_read_b64_tr_b16 v[108:109], v22 offset:16384
s_waitcnt lgkmcnt(15)
  v_mfma_f32_16x16x32_bf16 a[96:99], v[112:115], v[36:39], 0
  ds_read_b64_tr_b16 v[110:111], v22 offset:18432
  v_mfma_f32_16x16x32_bf16 a[100:103], v[112:115], v[40:43], 0
  v_mfma_f32_16x16x32_bf16 a[104:107], v[112:115], v[44:47], 0
  ds_read_b128 v[84:87], v19 offset:8192
  v_mfma_f32_16x16x32_bf16 a[108:111], v[112:115], v[48:51], 0
  v_mfma_f32_16x16x32_bf16 a[112:115], v[112:115], v[52:55], 0
  v_mfma_f32_16x16x32_bf16 a[116:119], v[112:115], v[56:59], 0
  v_mfma_f32_16x16x32_bf16 a[120:123], v[112:115], v[60:63], 0
  v_mfma_f32_16x16x32_bf16 a[124:127], v[112:115], v[64:67], 0
  ds_read_b64_tr_b16 v[112:113], v23 offset:16384
  v_mfma_f32_16x16x32_bf16 a[128:131], v[116:119], v[36:39], 0
  ds_read_b64_tr_b16 v[114:115], v23 offset:18432
  ds_read_b128 v[88:91], v19 offset:10240
  v_mfma_f32_16x16x32_bf16 a[132:135], v[116:119], v[40:43], 0
  v_mfma_f32_16x16x32_bf16 a[136:139], v[116:119], v[44:47], 0
  v_mfma_f32_16x16x32_bf16 a[140:143], v[116:119], v[48:51], 0
  v_mfma_f32_16x16x32_bf16 a[144:147], v[116:119], v[52:55], 0
  v_mfma_f32_16x16x32_bf16 a[148:151], v[116:119], v[56:59], 0
  v_mfma_f32_16x16x32_bf16 a[152:155], v[116:119], v[60:63], 0
  ds_read_b128 v[92:95], v19 offset:12288
  v_mfma_f32_16x16x32_bf16 a[156:159], v[116:119], v[64:67], 0
  ds_read_b64_tr_b16 v[116:117], v24 offset:16384
s_waitcnt lgkmcnt(15)
  v_mfma_f32_16x16x32_bf16 a[160:163], v[120:123], v[36:39], 0
  ds_read_b64_tr_b16 v[118:119], v24 offset:18432
  v_mfma_f32_16x16x32_bf16 a[164:167], v[120:123], v[40:43], 0
  v_mfma_f32_16x16x32_bf16 a[168:171], v[120:123], v[44:47], 0
  v_mfma_f32_16x16x32_bf16 a[172:175], v[120:123], v[48:51], 0
  v_mfma_f32_16x16x32_bf16 a[176:179], v[120:123], v[52:55], 0
  ds_read_b128 v[96:99], v19 offset:14336
  v_mfma_f32_16x16x32_bf16 a[180:183], v[120:123], v[56:59], 0
  v_mfma_f32_16x16x32_bf16 a[184:187], v[120:123], v[60:63], 0
  v_mfma_f32_16x16x32_bf16 a[188:191], v[120:123], v[64:67], 0
  ds_read_b64_tr_b16 v[120:121], v25 offset:16384
  v_mfma_f32_16x16x32_bf16 a[192:195], v[124:127], v[36:39], 0
  ds_read_b64_tr_b16 v[122:123], v25 offset:18432
  v_mfma_f32_16x16x32_bf16 a[196:199], v[124:127], v[40:43], 0
  v_mfma_f32_16x16x32_bf16 a[200:203], v[124:127], v[44:47], 0
  v_mfma_f32_16x16x32_bf16 a[204:207], v[124:127], v[48:51], 0
  v_mfma_f32_16x16x32_bf16 a[208:211], v[124:127], v[52:55], 0
  v_mfma_f32_16x16x32_bf16 a[212:215], v[124:127], v[56:59], 0
  v_mfma_f32_16x16x32_bf16 a[216:219], v[124:127], v[60:63], 0
  v_mfma_f32_16x16x32_bf16 a[220:223], v[124:127], v[64:67], 0
  ds_read_b64_tr_b16 v[124:125], v26 offset:16384
  v_mfma_f32_16x16x32_bf16 a[224:227], v[128:131], v[36:39], 0
  ds_read_b64_tr_b16 v[126:127], v26 offset:18432
  v_mfma_f32_16x16x32_bf16 a[228:231], v[128:131], v[40:43], 0
  v_mfma_f32_16x16x32_bf16 a[232:235], v[128:131], v[44:47], 0
  v_mfma_f32_16x16x32_bf16 a[236:239], v[128:131], v[48:51], 0
  v_mfma_f32_16x16x32_bf16 a[240:243], v[128:131], v[52:55], 0
  v_mfma_f32_16x16x32_bf16 a[244:247], v[128:131], v[56:59], 0
  v_mfma_f32_16x16x32_bf16 a[248:251], v[128:131], v[60:63], 0
  v_mfma_f32_16x16x32_bf16 a[252:255], v[128:131], v[64:67], 0
  ds_read_b64_tr_b16 v[128:129], v27 offset:16384
  ds_read_b64_tr_b16 v[130:131], v27 offset:18432
  s_waitcnt lgkmcnt(2)
  v_mfma_f32_16x16x32_bf16 a[0:3], v[100:103], v[68:71], a[0:3]
  v_mfma_f32_16x16x32_bf16 a[4:7], v[100:103], v[72:75], a[4:7]
  v_mfma_f32_16x16x32_bf16 a[8:11], v[100:103], v[76:79], a[8:11]
  v_mfma_f32_16x16x32_bf16 a[12:15], v[100:103], v[80:83], a[12:15]
  v_mfma_f32_16x16x32_bf16 a[16:19], v[100:103], v[84:87], a[16:19]
  v_mfma_f32_16x16x32_bf16 a[20:23], v[100:103], v[88:91], a[20:23]
  v_mfma_f32_16x16x32_bf16 a[24:27], v[100:103], v[92:95], a[24:27]
  v_mfma_f32_16x16x32_bf16 a[28:31], v[100:103], v[96:99], a[28:31]
  v_mfma_f32_16x16x32_bf16 a[32:35], v[104:107], v[68:71], a[32:35]
  v_mfma_f32_16x16x32_bf16 a[36:39], v[104:107], v[72:75], a[36:39]
  s_waitcnt vmcnt(0) lgkmcnt(0)
  s_barrier
  v_mfma_f32_16x16x32_bf16 a[40:43], v[104:107], v[76:79], a[40:43]
  ds_read_b64_tr_b16 v[100:101], v20 offset:32768
  v_mfma_f32_16x16x32_bf16 a[44:47], v[104:107], v[80:83], a[44:47]
  s_add_u32 m0, s22, 0
s_nop 0
  buffer_load_dwordx4 v2, s[8:11], s20 offen offset:0 lds
  ds_read_b64_tr_b16 v[102:103], v20 offset:34816
  v_mfma_f32_16x16x32_bf16 a[48:51], v[104:107], v[84:87], a[48:51]
  ds_read_b128 v[36:39], v18 offset:32768
  v_mfma_f32_16x16x32_bf16 a[52:55], v[104:107], v[88:91], a[52:55]
  v_mfma_f32_16x16x32_bf16 a[56:59], v[104:107], v[92:95], a[56:59]
  buffer_load_dwordx4 v3, s[8:11], s20 offen offset:1024 lds
  v_mfma_f32_16x16x32_bf16 a[60:63], v[104:107], v[96:99], a[60:63]
  ds_read_b64_tr_b16 v[104:105], v21 offset:32768
  v_mfma_f32_16x16x32_bf16 a[64:67], v[108:111], v[68:71], a[64:67]
  ds_read_b64_tr_b16 v[106:107], v21 offset:34816
  ds_read_b128 v[40:43], v18 offset:34816
  v_mfma_f32_16x16x32_bf16 a[68:71], v[108:111], v[72:75], a[68:71]
  buffer_load_dwordx4 v4, s[8:11], s20 offen offset:2048 lds
  v_mfma_f32_16x16x32_bf16 a[72:75], v[108:111], v[76:79], a[72:75]
  v_mfma_f32_16x16x32_bf16 a[76:79], v[108:111], v[80:83], a[76:79]
  v_mfma_f32_16x16x32_bf16 a[80:83], v[108:111], v[84:87], a[80:83]
  buffer_load_dwordx4 v5, s[8:11], s20 offen offset:3072 lds
  v_mfma_f32_16x16x32_bf16 a[84:87], v[108:111], v[88:91], a[84:87]
  ds_read_b128 v[44:47], v18 offset:36864
  v_mfma_f32_16x16x32_bf16 a[88:91], v[108:111], v[92:95], a[88:91]
  v_mfma_f32_16x16x32_bf16 a[92:95], v[108:111], v[96:99], a[92:95]
  s_add_u32 m0, s23, 0
s_nop 0
  buffer_load_dwordx4 v10, s[12:15], s21 offen offset:0 lds
  ds_read_b64_tr_b16 v[108:109], v22 offset:32768
  v_mfma_f32_16x16x32_bf16 a[96:99], v[112:115], v[68:71], a[96:99]
  ds_read_b64_tr_b16 v[110:111], v22 offset:34816
  v_mfma_f32_16x16x32_bf16 a[100:103], v[112:115], v[72:75], a[100:103]
  v_mfma_f32_16x16x32_bf16 a[104:107], v[112:115], v[76:79], a[104:107]
  buffer_load_dwordx4 v11, s[12:15], s21 offen offset:1024 lds
  ds_read_b128 v[48:51], v18 offset:38912
  v_mfma_f32_16x16x32_bf16 a[108:111], v[112:115], v[80:83], a[108:111]
  v_mfma_f32_16x16x32_bf16 a[112:115], v[112:115], v[84:87], a[112:115]
  v_mfma_f32_16x16x32_bf16 a[116:119], v[112:115], v[88:91], a[116:119]
  buffer_load_dwordx4 v12, s[12:15], s21 offen offset:2048 lds
  v_mfma_f32_16x16x32_bf16 a[120:123], v[112:115], v[92:95], a[120:123]
  v_mfma_f32_16x16x32_bf16 a[124:127], v[112:115], v[96:99], a[124:127]
  ds_read_b64_tr_b16 v[112:113], v23 offset:32768
  ds_read_b128 v[52:55], v18 offset:40960
  v_mfma_f32_16x16x32_bf16 a[128:131], v[116:119], v[68:71], a[128:131]
  buffer_load_dwordx4 v13, s[12:15], s21 offen offset:3072 lds
  ds_read_b64_tr_b16 v[114:115], v23 offset:34816
  v_mfma_f32_16x16x32_bf16 a[132:135], v[116:119], v[72:75], a[132:135]
  v_mfma_f32_16x16x32_bf16 a[136:139], v[116:119], v[76:79], a[136:139]
  v_mfma_f32_16x16x32_bf16 a[140:143], v[116:119], v[80:83], a[140:143]
  s_add_u32 m0, s22, 4096
s_nop 0
  buffer_load_dwordx4 v6, s[8:11], s20 offen offset:0 lds
  ds_read_b128 v[56:59], v18 offset:43008
  v_mfma_f32_16x16x32_bf16 a[144:147], v[116:119], v[84:87], a[144:147]
  v_mfma_f32_16x16x32_bf16 a[148:151], v[116:119], v[88:91], a[148:151]
  v_mfma_f32_16x16x32_bf16 a[152:155], v[116:119], v[92:95], a[152:155]
  buffer_load_dwordx4 v7, s[8:11], s20 offen offset:1024 lds
  v_mfma_f32_16x16x32_bf16 a[156:159], v[116:119], v[96:99], a[156:159]
  ds_read_b64_tr_b16 v[116:117], v24 offset:32768
  v_mfma_f32_16x16x32_bf16 a[160:163], v[120:123], v[68:71], a[160:163]
  ds_read_b64_tr_b16 v[118:119], v24 offset:34816
  ds_read_b128 v[60:63], v18 offset:45056
  v_mfma_f32_16x16x32_bf16 a[164:167], v[120:123], v[72:75], a[164:167]
  buffer_load_dwordx4 v8, s[8:11], s20 offen offset:2048 lds
  v_mfma_f32_16x16x32_bf16 a[168:171], v[120:123], v[76:79], a[168:171]
  v_mfma_f32_16x16x32_bf16 a[172:175], v[120:123], v[80:83], a[172:175]
  v_mfma_f32_16x16x32_bf16 a[176:179], v[120:123], v[84:87], a[176:179]
  buffer_load_dwordx4 v9, s[8:11], s20 offen offset:3072 lds
  v_mfma_f32_16x16x32_bf16 a[180:183], v[120:123], v[88:91], a[180:183]
  ds_read_b128 v[64:67], v18 offset:47104
  v_mfma_f32_16x16x32_bf16 a[184:187], v[120:123], v[92:95], a[184:187]
  v_mfma_f32_16x16x32_bf16 a[188:191], v[120:123], v[96:99], a[188:191]
  s_add_u32 m0, s23, 4096
s_nop 0
  buffer_load_dwordx4 v14, s[12:15], s21 offen offset:0 lds
  ds_read_b64_tr_b16 v[120:121], v25 offset:32768
  v_mfma_f32_16x16x32_bf16 a[192:195], v[124:127], v[68:71], a[192:195]
  ds_read_b64_tr_b16 v[122:123], v25 offset:34816
  v_mfma_f32_16x16x32_bf16 a[196:199], v[124:127], v[72:75], a[196:199]
  v_mfma_f32_16x16x32_bf16 a[200:203], v[124:127], v[76:79], a[200:203]
  buffer_load_dwordx4 v15, s[12:15], s21 offen offset:1024 lds
  v_mfma_f32_16x16x32_bf16 a[204:207], v[124:127], v[80:83], a[204:207]
  v_mfma_f32_16x16x32_bf16 a[208:211], v[124:127], v[84:87], a[208:211]
  v_mfma_f32_16x16x32_bf16 a[212:215], v[124:127], v[88:91], a[212:215]
  buffer_load_dwordx4 v16, s[12:15], s21 offen offset:2048 lds
  v_mfma_f32_16x16x32_bf16 a[216:219], v[124:127], v[92:95], a[216:219]
  v_mfma_f32_16x16x32_bf16 a[220:223], v[124:127], v[96:99], a[220:223]
  ds_read_b64_tr_b16 v[124:125], v26 offset:32768
  v_mfma_f32_16x16x32_bf16 a[224:227], v[128:131], v[68:71], a[224:227]
  buffer_load_dwordx4 v17, s[12:15], s21 offen offset:3072 lds
  s_add_u32 s20, s20, 128
  s_add_u32 s21, s21, 524288
  ds_read_b64_tr_b16 v[126:127], v26 offset:34816
  v_mfma_f32_16x16x32_bf16 a[228:231], v[128:131], v[72:75], a[228:231]
  v_mfma_f32_16x16x32_bf16 a[232:235], v[128:131], v[76:79], a[232:235]
  v_mfma_f32_16x16x32_bf16 a[236:239], v[128:131], v[80:83], a[236:239]
  v_mfma_f32_16x16x32_bf16 a[240:243], v[128:131], v[84:87], a[240:243]
  v_mfma_f32_16x16x32_bf16 a[244:247], v[128:131], v[88:91], a[244:247]
  v_mfma_f32_16x16x32_bf16 a[248:251], v[128:131], v[92:95], a[248:251]
  v_mfma_f32_16x16x32_bf16 a[252:255], v[128:131], v[96:99], a[252:255]
  ds_read_b64_tr_b16 v[128:129], v27 offset:32768
  ds_read_b64_tr_b16 v[130:131], v27 offset:34816
  s_waitcnt lgkmcnt(2)
  v_mfma_f32_16x16x32_bf16 a[0:3], v[100:103], v[36:39], a[0:3]
  v_mfma_f32_16x16x32_bf16 a[4:7], v[100:103], v[40:43], a[4:7]
  v_mfma_f32_16x16x32_bf16 a[8:11], v[100:103], v[44:47], a[8:11]
  ds_read_b128 v[68:71], v19 offset:32768
  v_mfma_f32_16x16x32_bf16 a[12:15], v[100:103], v[48:51], a[12:15]
  v_mfma_f32_16x16x32_bf16 a[16:19], v[100:103], v[52:55], a[16:19]
  v_mfma_f32_16x16x32_bf16 a[20:23], v[100:103], v[56:59], a[20:23]
  v_mfma_f32_16x16x32_bf16 a[24:27], v[100:103], v[60:63], a[24:27]
  v_mfma_f32_16x16x32_bf16 a[28:31], v[100:103], v[64:67], a[28:31]
  ds_read_b64_tr_b16 v[100:101], v20 offset:49152
  v_mfma_f32_16x16x32_bf16 a[32:35], v[104:107], v[36:39], a[32:35]
  ds_read_b64_tr_b16 v[102:103], v20 offset:51200
  ds_read_b128 v[72:75], v19 offset:34816
  v_mfma_f32_16x16x32_bf16 a[36:39], v[104:107], v[40:43], a[36:39]
  v_mfma_f32_16x16x32_bf16 a[40:43], v[104:107], v[44:47], a[40:43]
  v_mfma_f32_16x16x32_bf16 a[44:47], v[104:107], v[48:51], a[44:47]
  v_mfma_f32_16x16x32_bf16 a[48:51], v[104:107], v[52:55], a[48:51]
  v_mfma_f32_16x16x32_bf16 a[52:55], v[104:107], v[56:59], a[52:55]
  v_mfma_f32_16x16x32_bf16 a[56:59], v[104:107], v[60:63], a[56:59]
  ds_read_b128 v[76:79], v19 offset:36864
  v_mfma_f32_16x16x32_bf16 a[60:63], v[104:107], v[64:67], a[60:63]
  ds_read_b64_tr_b16 v[104:105], v21 offset:49152
  v_mfma_f32_16x16x32_bf16 a[64:67], v[108:111], v[36:39], a[64:67]
  ds_read_b64_tr_b16 v[106:107], v21 offset:51200
  v_mfma_f32_16x16x32_bf16 a[68:71], v[108:111], v[40:43], a[68:71]
  v_mfma_f32_16x16x32_bf16 a[72:75], v[108:111], v[44:47], a[72:75]
  v_mfma_f32_16x16x32_bf16 a[76:79], v[108:111], v[48:51], a[76:79]
  v_mfma_f32_16x16x32_bf16 a[80:83], v[108:111], v[52:55], a[80:83]
  ds_read_b128 v[80:83], v19 offset:38912
  v_mfma_f32_16x16x32_bf16 a[84:87], v[108:111], v[56:59], a[84:87]
  v_mfma_f32_16x16x32_bf16 a[88:91], v[108:111], v[60:63], a[88:91]
  v_mfma_f32_16x16x32_bf16 a[92:95], v[108:111], v[64:67], a[92:95]
  ds_read_b64_tr_b16 v[108:109], v22 offset:49152
  v_mfma_f32_16x16x32_bf16 a[96:99], v[112:115], v[36:39], a[96:99]
  ds_read_b64_tr_b16 v[110:111], v22 offset:51200
  v_mfma_f32_16x16x32_bf16 a[100:103], v[112:115], v[40:43], a[100:103]
  v_mfma_f32_16x16x32_bf16 a[104:107], v[112:115], v[44:47], a[104:107]
  ds_read_b128 v[84:87], v19 offset:40960
  v_mfma_f32_16x16x32_bf16 a[108:111], v[112:115], v[48:51], a[108:111]
  v_mfma_f32_16x16x32_bf16 a[112:115], v[112:115], v[52:55], a[112:115]
  v_mfma_f32_16x16x32_bf16 a[116:119], v[112:115], v[56:59], a[116:119]
  v_mfma_f32_16x16x32_bf16 a[120:123], v[112:115], v[60:63], a[120:123]
  v_mfma_f32_16x16x32_bf16 a[124:127], v[112:115], v[64:67], a[124:127]
  ds_read_b64_tr_b16 v[112:113], v23 offset:49152
  v_mfma_f32_16x16x32_bf16 a[128:131], v[116:119], v[36:39], a[128:131]
  ds_read_b64_tr_b16 v[114:115], v23 offset:51200
  ds_read_b128 v[88:91], v19 offset:43008
  v_mfma_f32_16x16x32_bf16 a[132:135], v[116:119], v[40:43], a[132:135]
  v_mfma_f32_16x16x32_bf16 a[136:139], v[116:119], v[44:47], a[136:139]
  v_mfma_f32_16x16x32_bf16 a[140:143], v[116:119], v[48:51], a[140:143]
  v_mfma_f32_16x16x32_bf16 a[144:147], v[116:119], v[52:55], a[144:147]
  v_mfma_f32_16x16x32_bf16 a[148:151], v[116:119], v[56:59], a[148:151]
  v_mfma_f32_16x16x32_bf16 a[152:155], v[116:119], v[60:63], a[152:155]
  ds_read_b128 v[92:95], v19 offset:45056
  v_mfma_f32_16x16x32_bf16 a[156:159], v[116:119], v[64:67], a[156:159]
  ds_read_b64_tr_b16 v[116:117], v24 offset:49152
  v_mfma_f32_16x16x32_bf16 a[160:163], v[120:123], v[36:39], a[160:163]
  ds_read_b64_tr_b16 v[118:119], v24 offset:51200
  v_mfma_f32_16x16x32_bf16 a[164:167], v[120:123], v[40:43], a[164:167]
  v_mfma_f32_16x16x32_bf16 a[168:171], v[120:123], v[44:47], a[168:171]
  v_mfma_f32_16x16x32_bf16 a[172:175], v[120:123], v[48:51], a[172:175]
  v_mfma_f32_16x16x32_bf16 a[176:179], v[120:123], v[52:55], a[176:179]
  ds_read_b128 v[96:99], v19 offset:47104
  v_mfma_f32_16x16x32_bf16 a[180:183], v[120:123], v[56:59], a[180:183]
  v_mfma_f32_16x16x32_bf16 a[184:187], v[120:123], v[60:63], a[184:187]
  v_mfma_f32_16x16x32_bf16 a[188:191], v[120:123], v[64:67], a[188:191]
  ds_read_b64_tr_b16 v[120:121], v25 offset:49152
  v_mfma_f32_16x16x32_bf16 a[192:195], v[124:127], v[36:39], a[192:195]
  ds_read_b64_tr_b16 v[122:123], v25 offset:51200
  v_mfma_f32_16x16x32_bf16 a[196:199], v[124:127], v[40:43], a[196:199]
  v_mfma_f32_16x16x32_bf16 a[200:203], v[124:127], v[44:47], a[200:203]
  v_mfma_f32_16x16x32_bf16 a[204:207], v[124:127], v[48:51], a[204:207]
  v_mfma_f32_16x16x32_bf16 a[208:211], v[124:127], v[52:55], a[208:211]
  v_mfma_f32_16x16x32_bf16 a[212:215], v[124:127], v[56:59], a[212:215]
  v_mfma_f32_16x16x32_bf16 a[216:219], v[124:127], v[60:63], a[216:219]
  v_mfma_f32_16x16x32_bf16 a[220:223], v[124:127], v[64:67], a[220:223]
  ds_read_b64_tr_b16 v[124:125], v26 offset:49152
s_waitcnt lgkmcnt(15)
  v_mfma_f32_16x16x32_bf16 a[224:227], v[128:131], v[36:39], a[224:227]
  ds_read_b64_tr_b16 v[126:127], v26 offset:51200
  v_mfma_f32_16x16x32_bf16 a[228:231], v[128:131], v[40:43], a[228:231]
  v_mfma_f32_16x16x32_bf16 a[232:235], v[128:131], v[44:47], a[232:235]
  v_mfma_f32_16x16x32_bf16 a[236:239], v[128:131], v[48:51], a[236:239]
  v_mfma_f32_16x16x32_bf16 a[240:243], v[128:131], v[52:55], a[240:243]
  v_mfma_f32_16x16x32_bf16 a[244:247], v[128:131], v[56:59], a[244:247]
  v_mfma_f32_16x16x32_bf16 a[248:251], v[128:131], v[60:63], a[248:251]
  v_mfma_f32_16x16x32_bf16 a[252:255], v[128:131], v[64:67], a[252:255]
  ds_read_b64_tr_b16 v[128:129], v27 offset:49152
  ds_read_b64_tr_b16 v[130:131], v27 offset:51200
  s_waitcnt lgkmcnt(2)
  v_mfma_f32_16x16x32_bf16 a[0:3], v[100:103], v[68:71], a[0:3]
  v_mfma_f32_16x16x32_bf16 a[4:7], v[100:103], v[72:75], a[4:7]
  v_mfma_f32_16x16x32_bf16 a[8:11], v[100:103], v[76:79], a[8:11]
  v_mfma_f32_16x16x32_bf16 a[12:15], v[100:103], v[80:83], a[12:15]
  v_mfma_f32_16x16x32_bf16 a[16:19], v[100:103], v[84:87], a[16:19]
  v_mfma_f32_16x16x32_bf16 a[20:23], v[100:103], v[88:91], a[20:23]
  v_mfma_f32_16x16x32_bf16 a[24:27], v[100:103], v[92:95], a[24:27]
  v_mfma_f32_16x16x32_bf16 a[28:31], v[100:103], v[96:99], a[28:31]
  v_mfma_f32_16x16x32_bf16 a[32:35], v[104:107], v[68:71], a[32:35]
  v_mfma_f32_16x16x32_bf16 a[36:39], v[104:107], v[72:75], a[36:39]
  s_waitcnt vmcnt(0) lgkmcnt(0)
  s_barrier
  v_mfma_f32_16x16x32_bf16 a[40:43], v[104:107], v[76:79], a[40:43]
  ds_read_b64_tr_b16 v[100:101], v20 offset:0
  v_mfma_f32_16x16x32_bf16 a[44:47], v[104:107], v[80:83], a[44:47]
  s_add_u32 m0, s22, 32768
s_nop 0
  buffer_load_dwordx4 v2, s[8:11], s20 offen offset:0 lds
  ds_read_b64_tr_b16 v[102:103], v20 offset:2048
  v_mfma_f32_16x16x32_bf16 a[48:51], v[104:107], v[84:87], a[48:51]
  ds_read_b128 v[36:39], v18 offset:0
  v_mfma_f32_16x16x32_bf16 a[52:55], v[104:107], v[88:91], a[52:55]
  v_mfma_f32_16x16x32_bf16 a[56:59], v[104:107], v[92:95], a[56:59]
  buffer_load_dwordx4 v3, s[8:11], s20 offen offset:1024 lds
  v_mfma_f32_16x16x32_bf16 a[60:63], v[104:107], v[96:99], a[60:63]
  ds_read_b64_tr_b16 v[104:105], v21 offset:0
  v_mfma_f32_16x16x32_bf16 a[64:67], v[108:111], v[68:71], a[64:67]
  ds_read_b64_tr_b16 v[106:107], v21 offset:2048
  ds_read_b128 v[40:43], v18 offset:2048
  v_mfma_f32_16x16x32_bf16 a[68:71], v[108:111], v[72:75], a[68:71]
  buffer_load_dwordx4 v4, s[8:11], s20 offen offset:2048 lds
  v_mfma_f32_16x16x32_bf16 a[72:75], v[108:111], v[76:79], a[72:75]
  v_mfma_f32_16x16x32_bf16 a[76:79], v[108:111], v[80:83], a[76:79]
  v_mfma_f32_16x16x32_bf16 a[80:83], v[108:111], v[84:87], a[80:83]
  buffer_load_dwordx4 v5, s[8:11], s20 offen offset:3072 lds
  v_mfma_f32_16x16x32_bf16 a[84:87], v[108:111], v[88:91], a[84:87]
  ds_read_b128 v[44:47], v18 offset:4096
  v_mfma_f32_16x16x32_bf16 a[88:91], v[108:111], v[92:95], a[88:91]
  v_mfma_f32_16x16x32_bf16 a[92:95], v[108:111], v[96:99], a[92:95]
  s_add_u32 m0, s23, 32768
s_nop 0
  buffer_load_dwordx4 v10, s[12:15], s21 offen offset:0 lds
  ds_read_b64_tr_b16 v[108:109], v22 offset:0
  v_mfma_f32_16x16x32_bf16 a[96:99], v[112:115], v[68:71], a[96:99]
  ds_read_b64_tr_b16 v[110:111], v22 offset:2048
  v_mfma_f32_16x16x32_bf16 a[100:103], v[112:115], v[72:75], a[100:103]
  v_mfma_f32_16x16x32_bf16 a[104:107], v[112:115], v[76:79], a[104:107]
  buffer_load_dwordx4 v11, s[12:15], s21 offen offset:1024 lds
  ds_read_b128 v[48:51], v18 offset:6144
  v_mfma_f32_16x16x32_bf16 a[108:111], v[112:115], v[80:83], a[108:111]
  v_mfma_f32_16x16x32_bf16 a[112:115], v[112:115], v[84:87], a[112:115]
  v_mfma_f32_16x16x32_bf16 a[116:119], v[112:115], v[88:91], a[116:119]
  buffer_load_dwordx4 v12, s[12:15], s21 offen offset:2048 lds
  v_mfma_f32_16x16x32_bf16 a[120:123], v[112:115], v[92:95], a[120:123]
  v_mfma_f32_16x16x32_bf16 a[124:127], v[112:115], v[96:99], a[124:127]
  ds_read_b64_tr_b16 v[112:113], v23 offset:0
  ds_read_b128 v[52:55], v18 offset:8192
  v_mfma_f32_16x16x32_bf16 a[128:131], v[116:119], v[68:71], a[128:131]
  buffer_load_dwordx4 v13, s[12:15], s21 offen offset:3072 lds
  ds_read_b64_tr_b16 v[114:115], v23 offset:2048
  v_mfma_f32_16x16x32_bf16 a[132:135], v[116:119], v[72:75], a[132:135]
  v_mfma_f32_16x16x32_bf16 a[136:139], v[116:119], v[76:79], a[136:139]
  v_mfma_f32_16x16x32_bf16 a[140:143], v[116:119], v[80:83], a[140:143]
  s_add_u32 m0, s22, 36864
s_nop 0
  buffer_load_dwordx4 v6, s[8:11], s20 offen offset:0 lds
  ds_read_b128 v[56:59], v18 offset:10240
  v_mfma_f32_16x16x32_bf16 a[144:147], v[116:119], v[84:87], a[144:147]
  v_mfma_f32_16x16x32_bf16 a[148:151], v[116:119], v[88:91], a[148:151]
  v_mfma_f32_16x16x32_bf16 a[152:155], v[116:119], v[92:95], a[152:155]
  buffer_load_dwordx4 v7, s[8:11], s20 offen offset:1024 lds
  v_mfma_f32_16x16x32_bf16 a[156:159], v[116:119], v[96:99], a[156:159]
  ds_read_b64_tr_b16 v[116:117], v24 offset:0
  v_mfma_f32_16x16x32_bf16 a[160:163], v[120:123], v[68:71], a[160:163]
  ds_read_b64_tr_b16 v[118:119], v24 offset:2048
  ds_read_b128 v[60:63], v18 offset:12288
  v_mfma_f32_16x16x32_bf16 a[164:167], v[120:123], v[72:75], a[164:167]
  buffer_load_dwordx4 v8, s[8:11], s20 offen offset:2048 lds
  v_mfma_f32_16x16x32_bf16 a[168:171], v[120:123], v[76:79], a[168:171]
  v_mfma_f32_16x16x32_bf16 a[172:175], v[120:123], v[80:83], a[172:175]
  v_mfma_f32_16x16x32_bf16 a[176:179], v[120:123], v[84:87], a[176:179]
  buffer_load_dwordx4 v9, s[8:11], s20 offen offset:3072 lds
  v_mfma_f32_16x16x32_bf16 a[180:183], v[120:123], v[88:91], a[180:183]
  ds_read_b128 v[64:67], v18 offset:14336
  v_mfma_f32_16x16x32_bf16 a[184:187], v[120:123], v[92:95], a[184:187]
  v_mfma_f32_16x16x32_bf16 a[188:191], v[120:123], v[96:99], a[188:191]
  s_add_u32 m0, s23, 36864
s_nop 0
  buffer_load_dwordx4 v14, s[12:15], s21 offen offset:0 lds
  ds_read_b64_tr_b16 v[120:121], v25 offset:0
  v_mfma_f32_16x16x32_bf16 a[192:195], v[124:127], v[68:71], a[192:195]
  ds_read_b64_tr_b16 v[122:123], v25 offset:2048
  v_mfma_f32_16x16x32_bf16 a[196:199], v[124:127], v[72:75], a[196:199]
  v_mfma_f32_16x16x32_bf16 a[200:203], v[124:127], v[76:79], a[200:203]
  buffer_load_dwordx4 v15, s[12:15], s21 offen offset:1024 lds
  v_mfma_f32_16x16x32_bf16 a[204:207], v[124:127], v[80:83], a[204:207]
  v_mfma_f32_16x16x32_bf16 a[208:211], v[124:127], v[84:87], a[208:211]
  v_mfma_f32_16x16x32_bf16 a[212:215], v[124:127], v[88:91], a[212:215]
  buffer_load_dwordx4 v16, s[12:15], s21 offen offset:2048 lds
  v_mfma_f32_16x16x32_bf16 a[216:219], v[124:127], v[92:95], a[216:219]
  v_mfma_f32_16x16x32_bf16 a[220:223], v[124:127], v[96:99], a[220:223]
  ds_read_b64_tr_b16 v[124:125], v26 offset:0
  v_mfma_f32_16x16x32_bf16 a[224:227], v[128:131], v[68:71], a[224:227]
  buffer_load_dwordx4 v17, s[12:15], s21 offen offset:3072 lds
  s_add_u32 s20, s20, 128
  s_add_u32 s21, s21, 524288
  ds_read_b64_tr_b16 v[126:127], v26 offset:2048
  v_mfma_f32_16x16x32_bf16 a[228:231], v[128:131], v[72:75], a[228:231]
  v_mfma_f32_16x16x32_bf16 a[232:235], v[128:131], v[76:79], a[232:235]
  v_mfma_f32_16x16x32_bf16 a[236:239], v[128:131], v[80:83], a[236:239]
  v_mfma_f32_16x16x32_bf16 a[240:243], v[128:131], v[84:87], a[240:243]
  v_mfma_f32_16x16x32_bf16 a[244:247], v[128:131], v[88:91], a[244:247]
  v_mfma_f32_16x16x32_bf16 a[248:251], v[128:131], v[92:95], a[248:251]
  v_mfma_f32_16x16x32_bf16 a[252:255], v[128:131], v[96:99], a[252:255]
  ds_read_b64_tr_b16 v[128:129], v27 offset:0
  ds_read_b64_tr_b16 v[130:131], v27 offset:2048
  s_waitcnt lgkmcnt(2)
  v_mfma_f32_16x16x32_bf16 a[0:3], v[100:103], v[36:39], a[0:3]
  v_mfma_f32_16x16x32_bf16 a[4:7], v[100:103], v[40:43], a[4:7]
  v_mfma_f32_16x16x32_bf16 a[8:11], v[100:103], v[44:47], a[8:11]
  ds_read_b128 v[68:71], v19 offset:0
  v_mfma_f32_16x16x32_bf16 a[12:15], v[100:103], v[48:51], a[12:15]
  v_mfma_f32_16x16x32_bf16 a[16:19], v[100:103], v[52:55], a[16:19]
  v_mfma_f32_16x16x32_bf16 a[20:23], v[100:103], v[56:59], a[20:23]
  v_mfma_f32_16x16x32_bf16 a[24:27], v[100:103], v[60:63], a[24:27]
  v_mfma_f32_16x16x32_bf16 a[28:31], v[100:103], v[64:67], a[28:31]
  ds_read_b64_tr_b16 v[100:101], v20 offset:16384
  v_mfma_f32_16x16x32_bf16 a[32:35], v[104:107], v[36:39], a[32:35]
  ds_read_b64_tr_b16 v[102:103], v20 offset:18432
  ds_read_b128 v[72:75], v19 offset:2048
  v_mfma_f32_16x16x32_bf16 a[36:39], v[104:107], v[40:43], a[36:39]
  v_mfma_f32_16x16x32_bf16 a[40:43], v[104:107], v[44:47], a[40:43]
  v_mfma_f32_16x16x32_bf16 a[44:47], v[104:107], v[48:51], a[44:47]
  v_mfma_f32_16x16x32_bf16 a[48:51], v[104:107], v[52:55], a[48:51]
  v_mfma_f32_16x16x32_bf16 a[52:55], v[104:107], v[56:59], a[52:55]
  v_mfma_f32_16x16x32_bf16 a[56:59], v[104:107], v[60:63], a[56:59]
  ds_read_b128 v[76:79], v19 offset:4096
  v_mfma_f32_16x16x32_bf16 a[60:63], v[104:107], v[64:67], a[60:63]
  ds_read_b64_tr_b16 v[104:105], v21 offset:16384
  v_mfma_f32_16x16x32_bf16 a[64:67], v[108:111], v[36:39], a[64:67]
  ds_read_b64_tr_b16 v[106:107], v21 offset:18432
  v_mfma_f32_16x16x32_bf16 a[68:71], v[108:111], v[40:43], a[68:71]
  v_mfma_f32_16x16x32_bf16 a[72:75], v[108:111], v[44:47], a[72:75]
  v_mfma_f32_16x16x32_bf16 a[76:79], v[108:111], v[48:51], a[76:79]
  v_mfma_f32_16x16x32_bf16 a[80:83], v[108:111], v[52:55], a[80:83]
  ds_read_b128 v[80:83], v19 offset:6144
  v_mfma_f32_16x16x32_bf16 a[84:87], v[108:111], v[56:59], a[84:87]
  v_mfma_f32_16x16x32_bf16 a[88:91], v[108:111], v[60:63], a[88:91]
  v_mfma_f32_16x16x32_bf16 a[92:95], v[108:111], v[64:67], a[92:95]
  ds_read_b64_tr_b16 v[108:109], v22 offset:16384
  v_mfma_f32_16x16x32_bf16 a[96:99], v[112:115], v[36:39], a[96:99]
  ds_read_b64_tr_b16 v[110:111], v22 offset:18432
  v_mfma_f32_16x16x32_bf16 a[100:103], v[112:115], v[40:43], a[100:103]
  v_mfma_f32_16x16x32_bf16 a[104:107], v[112:115], v[44:47], a[104:107]
  ds_read_b128 v[84:87], v19 offset:8192
  v_mfma_f32_16x16x32_bf16 a[108:111], v[112:115], v[48:51], a[108:111]
  v_mfma_f32_16x16x32_bf16 a[112:115], v[112:115], v[52:55], a[112:115]
  v_mfma_f32_16x16x32_bf16 a[116:119], v[112:115], v[56:59], a[116:119]
  v_mfma_f32_16x16x32_bf16 a[120:123], v[112:115], v[60:63], a[120:123]
  v_mfma_f32_16x16x32_bf16 a[124:127], v[112:115], v[64:67], a[124:127]
  ds_read_b64_tr_b16 v[112:113], v23 offset:16384
  v_mfma_f32_16x16x32_bf16 a[128:131], v[116:119], v[36:39], a[128:131]
  ds_read_b64_tr_b16 v[114:115], v23 offset:18432
  ds_read_b128 v[88:91], v19 offset:10240
  v_mfma_f32_16x16x32_bf16 a[132:135], v[116:119], v[40:43], a[132:135]
  v_mfma_f32_16x16x32_bf16 a[136:139], v[116:119], v[44:47], a[136:139]
  v_mfma_f32_16x16x32_bf16 a[140:143], v[116:119], v[48:51], a[140:143]
  v_mfma_f32_16x16x32_bf16 a[144:147], v[116:119], v[52:55], a[144:147]
  v_mfma_f32_16x16x32_bf16 a[148:151], v[116:119], v[56:59], a[148:151]
  v_mfma_f32_16x16x32_bf16 a[152:155], v[116:119], v[60:63], a[152:155]
  ds_read_b128 v[92:95], v19 offset:12288
  v_mfma_f32_16x16x32_bf16 a[156:159], v[116:119], v[64:67], a[156:159]
  ds_read_b64_tr_b16 v[116:117], v24 offset:16384
  v_mfma_f32_16x16x32_bf16 a[160:163], v[120:123], v[36:39], a[160:163]
  ds_read_b64_tr_b16 v[118:119], v24 offset:18432
  v_mfma_f32_16x16x32_bf16 a[164:167], v[120:123], v[40:43], a[164:167]
  v_mfma_f32_16x16x32_bf16 a[168:171], v[120:123], v[44:47], a[168:171]
  v_mfma_f32_16x16x32_bf16 a[172:175], v[120:123], v[48:51], a[172:175]
  v_mfma_f32_16x16x32_bf16 a[176:179], v[120:123], v[52:55], a[176:179]
  ds_read_b128 v[96:99], v19 offset:14336
  v_mfma_f32_16x16x32_bf16 a[180:183], v[120:123], v[56:59], a[180:183]
  v_mfma_f32_16x16x32_bf16 a[184:187], v[120:123], v[60:63], a[184:187]
  v_mfma_f32_16x16x32_bf16 a[188:191], v[120:123], v[64:67], a[188:191]
  ds_read_b64_tr_b16 v[120:121], v25 offset:16384
  v_mfma_f32_16x16x32_bf16 a[192:195], v[124:127], v[36:39], a[192:195]
  ds_read_b64_tr_b16 v[122:123], v25 offset:18432
  v_mfma_f32_16x16x32_bf16 a[196:199], v[124:127], v[40:43], a[196:199]
  v_mfma_f32_16x16x32_bf16 a[200:203], v[124:127], v[44:47], a[200:203]
  v_mfma_f32_16x16x32_bf16 a[204:207], v[124:127], v[48:51], a[204:207]
  v_mfma_f32_16x16x32_bf16 a[208:211], v[124:127], v[52:55], a[208:211]
  v_mfma_f32_16x16x32_bf16 a[212:215], v[124:127], v[56:59], a[212:215]
  v_mfma_f32_16x16x32_bf16 a[216:219], v[124:127], v[60:63], a[216:219]
  v_mfma_f32_16x16x32_bf16 a[220:223], v[124:127], v[64:67], a[220:223]
  ds_read_b64_tr_b16 v[124:125], v26 offset:16384
s_waitcnt lgkmcnt(15)
  v_mfma_f32_16x16x32_bf16 a[224:227], v[128:131], v[36:39], a[224:227]
  ds_read_b64_tr_b16 v[126:127], v26 offset:18432
  v_mfma_f32_16x16x32_bf16 a[228:231], v[128:131], v[40:43], a[228:231]
  v_mfma_f32_16x16x32_bf16 a[232:235], v[128:131], v[44:47], a[232:235]
  v_mfma_f32_16x16x32_bf16 a[236:239], v[128:131], v[48:51], a[236:239]
  v_mfma_f32_16x16x32_bf16 a[240:243], v[128:131], v[52:55], a[240:243]
  v_mfma_f32_16x16x32_bf16 a[244:247], v[128:131], v[56:59], a[244:247]
  v_mfma_f32_16x16x32_bf16 a[248:251], v[128:131], v[60:63], a[248:251]
  v_mfma_f32_16x16x32_bf16 a[252:255], v[128:131], v[64:67], a[252:255]
  ds_read_b64_tr_b16 v[128:129], v27 offset:16384
  ds_read_b64_tr_b16 v[130:131], v27 offset:18432
  s_waitcnt lgkmcnt(2)
  v_mfma_f32_16x16x32_bf16 a[0:3], v[100:103], v[68:71], a[0:3]
  v_mfma_f32_16x16x32_bf16 a[4:7], v[100:103], v[72:75], a[4:7]
  v_mfma_f32_16x16x32_bf16 a[8:11], v[100:103], v[76:79], a[8:11]
  v_mfma_f32_16x16x32_bf16 a[12:15], v[100:103], v[80:83], a[12:15]
  v_mfma_f32_16x16x32_bf16 a[16:19], v[100:103], v[84:87], a[16:19]
  v_mfma_f32_16x16x32_bf16 a[20:23], v[100:103], v[88:91], a[20:23]
  v_mfma_f32_16x16x32_bf16 a[24:27], v[100:103], v[92:95], a[24:27]
  v_mfma_f32_16x16x32_bf16 a[28:31], v[100:103], v[96:99], a[28:31]
  v_mfma_f32_16x16x32_bf16 a[32:35], v[104:107], v[68:71], a[32:35]
  v_mfma_f32_16x16x32_bf16 a[36:39], v[104:107], v[72:75], a[36:39]
  s_waitcnt vmcnt(0) lgkmcnt(0)
  s_barrier
  v_mfma_f32_16x16x32_bf16 a[40:43], v[104:107], v[76:79], a[40:43]
  ds_read_b64_tr_b16 v[100:101], v20 offset:32768
  v_mfma_f32_16x16x32_bf16 a[44:47], v[104:107], v[80:83], a[44:47]
  s_add_u32 m0, s22, 0
s_nop 0
  buffer_load_dwordx4 v2, s[8:11], s20 offen offset:0 lds
  ds_read_b64_tr_b16 v[102:103], v20 offset:34816
  v_mfma_f32_16x16x32_bf16 a[48:51], v[104:107], v[84:87], a[48:51]
  ds_read_b128 v[36:39], v18 offset:32768
  v_mfma_f32_16x16x32_bf16 a[52:55], v[104:107], v[88:91], a[52:55]
  v_mfma_f32_16x16x32_bf16 a[56:59], v[104:107], v[92:95], a[56:59]
  buffer_load_dwordx4 v3, s[8:11], s20 offen offset:1024 lds
  v_mfma_f32_16x16x32_bf16 a[60:63], v[104:107], v[96:99], a[60:63]
  ds_read_b64_tr_b16 v[104:105], v21 offset:32768
  v_mfma_f32_16x16x32_bf16 a[64:67], v[108:111], v[68:71], a[64:67]
  ds_read_b64_tr_b16 v[106:107], v21 offset:34816
  ds_read_b128 v[40:43], v18 offset:34816
  v_mfma_f32_16x16x32_bf16 a[68:71], v[108:111], v[72:75], a[68:71]
  buffer_load_dwordx4 v4, s[8:11], s20 offen offset:2048 lds
  v_mfma_f32_16x16x32_bf16 a[72:75], v[108:111], v[76:79], a[72:75]
  v_mfma_f32_16x16x32_bf16 a[76:79], v[108:111], v[80:83], a[76:79]
  v_mfma_f32_16x16x32_bf16 a[80:83], v[108:111], v[84:87], a[80:83]
  buffer_load_dwordx4 v5, s[8:11], s20 offen offset:3072 lds
  v_mfma_f32_16x16x32_bf16 a[84:87], v[108:111], v[88:91], a[84:87]
  ds_read_b128 v[44:47], v18 offset:36864
  v_mfma_f32_16x16x32_bf16 a[88:91], v[108:111], v[92:95], a[88:91]
  v_mfma_f32_16x16x32_bf16 a[92:95], v[108:111], v[96:99], a[92:95]
  s_add_u32 m0, s23, 0
s_nop 0
  buffer_load_dwordx4 v10, s[12:15], s21 offen offset:0 lds
  ds_read_b64_tr_b16 v[108:109], v22 offset:32768
  v_mfma_f32_16x16x32_bf16 a[96:99], v[112:115], v[68:71], a[96:99]
  ds_read_b64_tr_b16 v[110:111], v22 offset:34816
  v_mfma_f32_16x16x32_bf16 a[100:103], v[112:115], v[72:75], a[100:103]
  v_mfma_f32_16x16x32_bf16 a[104:107], v[112:115], v[76:79], a[104:107]
  buffer_load_dwordx4 v11, s[12:15], s21 offen offset:1024 lds
  ds_read_b128 v[48:51], v18 offset:38912
  v_mfma_f32_16x16x32_bf16 a[108:111], v[112:115], v[80:83], a[108:111]
  v_mfma_f32_16x16x32_bf16 a[112:115], v[112:115], v[84:87], a[112:115]
  v_mfma_f32_16x16x32_bf16 a[116:119], v[112:115], v[88:91], a[116:119]
  buffer_load_dwordx4 v12, s[12:15], s21 offen offset:2048 lds
  v_mfma_f32_16x16x32_bf16 a[120:123], v[112:115], v[92:95], a[120:123]
  v_mfma_f32_16x16x32_bf16 a[124:127], v[112:115], v[96:99], a[124:127]
  ds_read_b64_tr_b16 v[112:113], v23 offset:32768
  ds_read_b128 v[52:55], v18 offset:40960
  v_mfma_f32_16x16x32_bf16 a[128:131], v[116:119], v[68:71], a[128:131]
  buffer_load_dwordx4 v13, s[12:15], s21 offen offset:3072 lds
  ds_read_b64_tr_b16 v[114:115], v23 offset:34816
  v_mfma_f32_16x16x32_bf16 a[132:135], v[116:119], v[72:75], a[132:135]
  v_mfma_f32_16x16x32_bf16 a[136:139], v[116:119], v[76:79], a[136:139]
  v_mfma_f32_16x16x32_bf16 a[140:143], v[116:119], v[80:83], a[140:143]
  s_add_u32 m0, s22, 4096
s_nop 0
  buffer_load_dwordx4 v6, s[8:11], s20 offen offset:0 lds
  ds_read_b128 v[56:59], v18 offset:43008
  v_mfma_f32_16x16x32_bf16 a[144:147], v[116:119], v[84:87], a[144:147]
  v_mfma_f32_16x16x32_bf16 a[148:151], v[116:119], v[88:91], a[148:151]
  v_mfma_f32_16x16x32_bf16 a[152:155], v[116:119], v[92:95], a[152:155]
  buffer_load_dwordx4 v7, s[8:11], s20 offen offset:1024 lds
  v_mfma_f32_16x16x32_bf16 a[156:159], v[116:119], v[96:99], a[156:159]
  ds_read_b64_tr_b16 v[116:117], v24 offset:32768
  v_mfma_f32_16x16x32_bf16 a[160:163], v[120:123], v[68:71], a[160:163]
  ds_read_b64_tr_b16 v[118:119], v24 offset:34816
  ds_read_b128 v[60:63], v18 offset:45056
  v_mfma_f32_16x16x32_bf16 a[164:167], v[120:123], v[72:75], a[164:167]
  buffer_load_dwordx4 v8, s[8:11], s20 offen offset:2048 lds
  v_mfma_f32_16x16x32_bf16 a[168:171], v[120:123], v[76:79], a[168:171]
  v_mfma_f32_16x16x32_bf16 a[172:175], v[120:123], v[80:83], a[172:175]
  v_mfma_f32_16x16x32_bf16 a[176:179], v[120:123], v[84:87], a[176:179]
  buffer_load_dwordx4 v9, s[8:11], s20 offen offset:3072 lds
  v_mfma_f32_16x16x32_bf16 a[180:183], v[120:123], v[88:91], a[180:183]
  ds_read_b128 v[64:67], v18 offset:47104
  v_mfma_f32_16x16x32_bf16 a[184:187], v[120:123], v[92:95], a[184:187]
  v_mfma_f32_16x16x32_bf16 a[188:191], v[120:123], v[96:99], a[188:191]
  s_add_u32 m0, s23, 4096
s_nop 0
  buffer_load_dwordx4 v14, s[12:15], s21 offen offset:0 lds
  ds_read_b64_tr_b16 v[120:121], v25 offset:32768
  v_mfma_f32_16x16x32_bf16 a[192:195], v[124:127], v[68:71], a[192:195]
  ds_read_b64_tr_b16 v[122:123], v25 offset:34816
  v_mfma_f32_16x16x32_bf16 a[196:199], v[124:127], v[72:75], a[196:199]
  v_mfma_f32_16x16x32_bf16 a[200:203], v[124:127], v[76:79], a[200:203]
  buffer_load_dwordx4 v15, s[12:15], s21 offen offset:1024 lds
  v_mfma_f32_16x16x32_bf16 a[204:207], v[124:127], v[80:83], a[204:207]
  v_mfma_f32_16x16x32_bf16 a[208:211], v[124:127], v[84:87], a[208:211]
  v_mfma_f32_16x16x32_bf16 a[212:215], v[124:127], v[88:91], a[212:215]
  buffer_load_dwordx4 v16, s[12:15], s21 offen offset:2048 lds
  v_mfma_f32_16x16x32_bf16 a[216:219], v[124:127], v[92:95], a[216:219]
  v_mfma_f32_16x16x32_bf16 a[220:223], v[124:127], v[96:99], a[220:223]
  ds_read_b64_tr_b16 v[124:125], v26 offset:32768
  v_mfma_f32_16x16x32_bf16 a[224:227], v[128:131], v[68:71], a[224:227]
  buffer_load_dwordx4 v17, s[12:15], s21 offen offset:3072 lds
  s_add_u32 s20, s20, 128
  s_add_u32 s21, s21, 524288
  ds_read_b64_tr_b16 v[126:127], v26 offset:34816
  v_mfma_f32_16x16x32_bf16 a[228:231], v[128:131], v[72:75], a[228:231]
  v_mfma_f32_16x16x32_bf16 a[232:235], v[128:131], v[76:79], a[232:235]
  v_mfma_f32_16x16x32_bf16 a[236:239], v[128:131], v[80:83], a[236:239]
  v_mfma_f32_16x16x32_bf16 a[240:243], v[128:131], v[84:87], a[240:243]
  v_mfma_f32_16x16x32_bf16 a[244:247], v[128:131], v[88:91], a[244:247]
  v_mfma_f32_16x16x32_bf16 a[248:251], v[128:131], v[92:95], a[248:251]
  v_mfma_f32_16x16x32_bf16 a[252:255], v[128:131], v[96:99], a[252:255]
  ds_read_b64_tr_b16 v[128:129], v27 offset:32768
  ds_read_b64_tr_b16 v[130:131], v27 offset:34816
  s_waitcnt lgkmcnt(2)
  v_mfma_f32_16x16x32_bf16 a[0:3], v[100:103], v[36:39], a[0:3]
  v_mfma_f32_16x16x32_bf16 a[4:7], v[100:103], v[40:43], a[4:7]
  v_mfma_f32_16x16x32_bf16 a[8:11], v[100:103], v[44:47], a[8:11]
  ds_read_b128 v[68:71], v19 offset:32768
  v_mfma_f32_16x16x32_bf16 a[12:15], v[100:103], v[48:51], a[12:15]
  v_mfma_f32_16x16x32_bf16 a[16:19], v[100:103], v[52:55], a[16:19]
  v_mfma_f32_16x16x32_bf16 a[20:23], v[100:103], v[56:59], a[20:23]
  v_mfma_f32_16x16x32_bf16 a[24:27], v[100:103], v[60:63], a[24:27]
  v_mfma_f32_16x16x32_bf16 a[28:31], v[100:103], v[64:67], a[28:31]
  ds_read_b64_tr_b16 v[100:101], v20 offset:49152
  v_mfma_f32_16x16x32_bf16 a[32:35], v[104:107], v[36:39], a[32:35]
  ds_read_b64_tr_b16 v[102:103], v20 offset:51200
  ds_read_b128 v[72:75], v19 offset:34816
  v_mfma_f32_16x16x32_bf16 a[36:39], v[104:107], v[40:43], a[36:39]
  v_mfma_f32_16x16x32_bf16 a[40:43], v[104:107], v[44:47], a[40:43]
  v_mfma_f32_16x16x32_bf16 a[44:47], v[104:107], v[48:51], a[44:47]
  v_mfma_f32_16x16x32_bf16 a[48:51], v[104:107], v[52:55], a[48:51]
  v_mfma_f32_16x16x32_bf16 a[52:55], v[104:107], v[56:59], a[52:55]
  v_mfma_f32_16x16x32_bf16 a[56:59], v[104:107], v[60:63], a[56:59]
  ds_read_b128 v[76:79], v19 offset:36864
  v_mfma_f32_16x16x32_bf16 a[60:63], v[104:107], v[64:67], a[60:63]
  ds_read_b64_tr_b16 v[104:105], v21 offset:49152
  v_mfma_f32_16x16x32_bf16 a[64:67], v[108:111], v[36:39], a[64:67]
  ds_read_b64_tr_b16 v[106:107], v21 offset:51200
  v_mfma_f32_16x16x32_bf16 a[68:71], v[108:111], v[40:43], a[68:71]
  v_mfma_f32_16x16x32_bf16 a[72:75], v[108:111], v[44:47], a[72:75]
  v_mfma_f32_16x16x32_bf16 a[76:79], v[108:111], v[48:51], a[76:79]
  v_mfma_f32_16x16x32_bf16 a[80:83], v[108:111], v[52:55], a[80:83]
  ds_read_b128 v[80:83], v19 offset:38912
  v_mfma_f32_16x16x32_bf16 a[84:87], v[108:111], v[56:59], a[84:87]
  v_mfma_f32_16x16x32_bf16 a[88:91], v[108:111], v[60:63], a[88:91]
  v_mfma_f32_16x16x32_bf16 a[92:95], v[108:111], v[64:67], a[92:95]
  ds_read_b64_tr_b16 v[108:109], v22 offset:49152
  v_mfma_f32_16x16x32_bf16 a[96:99], v[112:115], v[36:39], a[96:99]
  ds_read_b64_tr_b16 v[110:111], v22 offset:51200
  v_mfma_f32_16x16x32_bf16 a[100:103], v[112:115], v[40:43], a[100:103]
  v_mfma_f32_16x16x32_bf16 a[104:107], v[112:115], v[44:47], a[104:107]
  ds_read_b128 v[84:87], v19 offset:40960
  v_mfma_f32_16x16x32_bf16 a[108:111], v[112:115], v[48:51], a[108:111]
  v_mfma_f32_16x16x32_bf16 a[112:115], v[112:115], v[52:55], a[112:115]
  v_mfma_f32_16x16x32_bf16 a[116:119], v[112:115], v[56:59], a[116:119]
  v_mfma_f32_16x16x32_bf16 a[120:123], v[112:115], v[60:63], a[120:123]
  v_mfma_f32_16x16x32_bf16 a[124:127], v[112:115], v[64:67], a[124:127]
  ds_read_b64_tr_b16 v[112:113], v23 offset:49152
  v_mfma_f32_16x16x32_bf16 a[128:131], v[116:119], v[36:39], a[128:131]
  ds_read_b64_tr_b16 v[114:115], v23 offset:51200
  ds_read_b128 v[88:91], v19 offset:43008
  v_mfma_f32_16x16x32_bf16 a[132:135], v[116:119], v[40:43], a[132:135]
  v_mfma_f32_16x16x32_bf16 a[136:139], v[116:119], v[44:47], a[136:139]
  v_mfma_f32_16x16x32_bf16 a[140:143], v[116:119], v[48:51], a[140:143]
  v_mfma_f32_16x16x32_bf16 a[144:147], v[116:119], v[52:55], a[144:147]
  v_mfma_f32_16x16x32_bf16 a[148:151], v[116:119], v[56:59], a[148:151]
  v_mfma_f32_16x16x32_bf16 a[152:155], v[116:119], v[60:63], a[152:155]
  ds_read_b128 v[92:95], v19 offset:45056
  v_mfma_f32_16x16x32_bf16 a[156:159], v[116:119], v[64:67], a[156:159]
  ds_read_b64_tr_b16 v[116:117], v24 offset:49152
  v_mfma_f32_16x16x32_bf16 a[160:163], v[120:123], v[36:39], a[160:163]
  ds_read_b64_tr_b16 v[118:119], v24 offset:51200
  v_mfma_f32_16x16x32_bf16 a[164:167], v[120:123], v[40:43], a[164:167]
  v_mfma_f32_16x16x32_bf16 a[168:171], v[120:123], v[44:47], a[168:171]
  v_mfma_f32_16x16x32_bf16 a[172:175], v[120:123], v[48:51], a[172:175]
  v_mfma_f32_16x16x32_bf16 a[176:179], v[120:123], v[52:55], a[176:179]
  ds_read_b128 v[96:99], v19 offset:47104
  v_mfma_f32_16x16x32_bf16 a[180:183], v[120:123], v[56:59], a[180:183]
  v_mfma_f32_16x16x32_bf16 a[184:187], v[120:123], v[60:63], a[184:187]
  v_mfma_f32_16x16x32_bf16 a[188:191], v[120:123], v[64:67], a[188:191]
  ds_read_b64_tr_b16 v[120:121], v25 offset:49152
  v_mfma_f32_16x16x32_bf16 a[192:195], v[124:127], v[36:39], a[192:195]
  ds_read_b64_tr_b16 v[122:123], v25 offset:51200
  v_mfma_f32_16x16x32_bf16 a[196:199], v[124:127], v[40:43], a[196:199]
  v_mfma_f32_16x16x32_bf16 a[200:203], v[124:127], v[44:47], a[200:203]
  v_mfma_f32_16x16x32_bf16 a[204:207], v[124:127], v[48:51], a[204:207]
  v_mfma_f32_16x16x32_bf16 a[208:211], v[124:127], v[52:55], a[208:211]
  v_mfma_f32_16x16x32_bf16 a[212:215], v[124:127], v[56:59], a[212:215]
  v_mfma_f32_16x16x32_bf16 a[216:219], v[124:127], v[60:63], a[216:219]
  v_mfma_f32_16x16x32_bf16 a[220:223], v[124:127], v[64:67], a[220:223]
  ds_read_b64_tr_b16 v[124:125], v26 offset:49152
s_waitcnt lgkmcnt(15)
  v_mfma_f32_16x16x32_bf16 a[224:227], v[128:131], v[36:39], a[224:227]
  ds_read_b64_tr_b16 v[126:127], v26 offset:51200
  v_mfma_f32_16x16x32_bf16 a[228:231], v[128:131], v[40:43], a[228:231]
  v_mfma_f32_16x16x32_bf16 a[232:235], v[128:131], v[44:47], a[232:235]
  v_mfma_f32_16x16x32_bf16 a[236:239], v[128:131], v[48:51], a[236:239]
  v_mfma_f32_16x16x32_bf16 a[240:243], v[128:131], v[52:55], a[240:243]
  v_mfma_f32_16x16x32_bf16 a[244:247], v[128:131], v[56:59], a[244:247]
  v_mfma_f32_16x16x32_bf16 a[248:251], v[128:131], v[60:63], a[248:251]
  v_mfma_f32_16x16x32_bf16 a[252:255], v[128:131], v[64:67], a[252:255]
  ds_read_b64_tr_b16 v[128:129], v27 offset:49152
  ds_read_b64_tr_b16 v[130:131], v27 offset:51200
  s_waitcnt lgkmcnt(2)
  v_mfma_f32_16x16x32_bf16 a[0:3], v[100:103], v[68:71], a[0:3]
  v_mfma_f32_16x16x32_bf16 a[4:7], v[100:103], v[72:75], a[4:7]
  v_mfma_f32_16x16x32_bf16 a[8:11], v[100:103], v[76:79], a[8:11]
  v_mfma_f32_16x16x32_bf16 a[12:15], v[100:103], v[80:83], a[12:15]
  v_mfma_f32_16x16x32_bf16 a[16:19], v[100:103], v[84:87], a[16:19]
  v_mfma_f32_16x16x32_bf16 a[20:23], v[100:103], v[88:91], a[20:23]
  v_mfma_f32_16x16x32_bf16 a[24:27], v[100:103], v[92:95], a[24:27]
  v_mfma_f32_16x16x32_bf16 a[28:31], v[100:103], v[96:99], a[28:31]
  v_mfma_f32_16x16x32_bf16 a[32:35], v[104:107], v[68:71], a[32:35]
  v_mfma_f32_16x16x32_bf16 a[36:39], v[104:107], v[72:75], a[36:39]
  s_waitcnt vmcnt(0) lgkmcnt(0)
  s_barrier
  v_mfma_f32_16x16x32_bf16 a[40:43], v[104:107], v[76:79], a[40:43]
  ds_read_b64_tr_b16 v[100:101], v20 offset:0
  v_mfma_f32_16x16x32_bf16 a[44:47], v[104:107], v[80:83], a[44:47]
  s_add_u32 m0, s22, 32768
s_nop 0
  buffer_load_dwordx4 v2, s[8:11], s20 offen offset:0 lds
  ds_read_b64_tr_b16 v[102:103], v20 offset:2048
  v_mfma_f32_16x16x32_bf16 a[48:51], v[104:107], v[84:87], a[48:51]
  ds_read_b128 v[36:39], v18 offset:0
  v_mfma_f32_16x16x32_bf16 a[52:55], v[104:107], v[88:91], a[52:55]
  v_mfma_f32_16x16x32_bf16 a[56:59], v[104:107], v[92:95], a[56:59]
  buffer_load_dwordx4 v3, s[8:11], s20 offen offset:1024 lds
  v_mfma_f32_16x16x32_bf16 a[60:63], v[104:107], v[96:99], a[60:63]
  ds_read_b64_tr_b16 v[104:105], v21 offset:0
  v_mfma_f32_16x16x32_bf16 a[64:67], v[108:111], v[68:71], a[64:67]
  ds_read_b64_tr_b16 v[106:107], v21 offset:2048
  ds_read_b128 v[40:43], v18 offset:2048
  v_mfma_f32_16x16x32_bf16 a[68:71], v[108:111], v[72:75], a[68:71]
  buffer_load_dwordx4 v4, s[8:11], s20 offen offset:2048 lds
  v_mfma_f32_16x16x32_bf16 a[72:75], v[108:111], v[76:79], a[72:75]
  v_mfma_f32_16x16x32_bf16 a[76:79], v[108:111], v[80:83], a[76:79]
  v_mfma_f32_16x16x32_bf16 a[80:83], v[108:111], v[84:87], a[80:83]
  buffer_load_dwordx4 v5, s[8:11], s20 offen offset:3072 lds
  v_mfma_f32_16x16x32_bf16 a[84:87], v[108:111], v[88:91], a[84:87]
  ds_read_b128 v[44:47], v18 offset:4096
  v_mfma_f32_16x16x32_bf16 a[88:91], v[108:111], v[92:95], a[88:91]
  v_mfma_f32_16x16x32_bf16 a[92:95], v[108:111], v[96:99], a[92:95]
  s_add_u32 m0, s23, 32768
s_nop 0
  buffer_load_dwordx4 v10, s[12:15], s21 offen offset:0 lds
  ds_read_b64_tr_b16 v[108:109], v22 offset:0
  v_mfma_f32_16x16x32_bf16 a[96:99], v[112:115], v[68:71], a[96:99]
  ds_read_b64_tr_b16 v[110:111], v22 offset:2048
  v_mfma_f32_16x16x32_bf16 a[100:103], v[112:115], v[72:75], a[100:103]
  v_mfma_f32_16x16x32_bf16 a[104:107], v[112:115], v[76:79], a[104:107]
  buffer_load_dwordx4 v11, s[12:15], s21 offen offset:1024 lds
  ds_read_b128 v[48:51], v18 offset:6144
  v_mfma_f32_16x16x32_bf16 a[108:111], v[112:115], v[80:83], a[108:111]
  v_mfma_f32_16x16x32_bf16 a[112:115], v[112:115], v[84:87], a[112:115]
  v_mfma_f32_16x16x32_bf16 a[116:119], v[112:115], v[88:91], a[116:119]
  buffer_load_dwordx4 v12, s[12:15], s21 offen offset:2048 lds
  v_mfma_f32_16x16x32_bf16 a[120:123], v[112:115], v[92:95], a[120:123]
  v_mfma_f32_16x16x32_bf16 a[124:127], v[112:115], v[96:99], a[124:127]
  ds_read_b64_tr_b16 v[112:113], v23 offset:0
  ds_read_b128 v[52:55], v18 offset:8192
  v_mfma_f32_16x16x32_bf16 a[128:131], v[116:119], v[68:71], a[128:131]
  buffer_load_dwordx4 v13, s[12:15], s21 offen offset:3072 lds
  ds_read_b64_tr_b16 v[114:115], v23 offset:2048
  v_mfma_f32_16x16x32_bf16 a[132:135], v[116:119], v[72:75], a[132:135]
  v_mfma_f32_16x16x32_bf16 a[136:139], v[116:119], v[76:79], a[136:139]
  v_mfma_f32_16x16x32_bf16 a[140:143], v[116:119], v[80:83], a[140:143]
  s_add_u32 m0, s22, 36864
s_nop 0
  buffer_load_dwordx4 v6, s[8:11], s20 offen offset:0 lds
  ds_read_b128 v[56:59], v18 offset:10240
  v_mfma_f32_16x16x32_bf16 a[144:147], v[116:119], v[84:87], a[144:147]
  v_mfma_f32_16x16x32_bf16 a[148:151], v[116:119], v[88:91], a[148:151]
  v_mfma_f32_16x16x32_bf16 a[152:155], v[116:119], v[92:95], a[152:155]
  buffer_load_dwordx4 v7, s[8:11], s20 offen offset:1024 lds
  v_mfma_f32_16x16x32_bf16 a[156:159], v[116:119], v[96:99], a[156:159]
  ds_read_b64_tr_b16 v[116:117], v24 offset:0
  v_mfma_f32_16x16x32_bf16 a[160:163], v[120:123], v[68:71], a[160:163]
  ds_read_b64_tr_b16 v[118:119], v24 offset:2048
  ds_read_b128 v[60:63], v18 offset:12288
  v_mfma_f32_16x16x32_bf16 a[164:167], v[120:123], v[72:75], a[164:167]
  buffer_load_dwordx4 v8, s[8:11], s20 offen offset:2048 lds
  v_mfma_f32_16x16x32_bf16 a[168:171], v[120:123], v[76:79], a[168:171]
  v_mfma_f32_16x16x32_bf16 a[172:175], v[120:123], v[80:83], a[172:175]
  v_mfma_f32_16x16x32_bf16 a[176:179], v[120:123], v[84:87], a[176:179]
  buffer_load_dwordx4 v9, s[8:11], s20 offen offset:3072 lds
  v_mfma_f32_16x16x32_bf16 a[180:183], v[120:123], v[88:91], a[180:183]
  ds_read_b128 v[64:67], v18 offset:14336
  v_mfma_f32_16x16x32_bf16 a[184:187], v[120:123], v[92:95], a[184:187]
  v_mfma_f32_16x16x32_bf16 a[188:191], v[120:123], v[96:99], a[188:191]
  s_add_u32 m0, s23, 36864
s_nop 0
  buffer_load_dwordx4 v14, s[12:15], s21 offen offset:0 lds
  ds_read_b64_tr_b16 v[120:121], v25 offset:0
  v_mfma_f32_16x16x32_bf16 a[192:195], v[124:127], v[68:71], a[192:195]
  ds_read_b64_tr_b16 v[122:123], v25 offset:2048
  v_mfma_f32_16x16x32_bf16 a[196:199], v[124:127], v[72:75], a[196:199]
  v_mfma_f32_16x16x32_bf16 a[200:203], v[124:127], v[76:79], a[200:203]
  buffer_load_dwordx4 v15, s[12:15], s21 offen offset:1024 lds
  v_mfma_f32_16x16x32_bf16 a[204:207], v[124:127], v[80:83], a[204:207]
  v_mfma_f32_16x16x32_bf16 a[208:211], v[124:127], v[84:87], a[208:211]
  v_mfma_f32_16x16x32_bf16 a[212:215], v[124:127], v[88:91], a[212:215]
  buffer_load_dwordx4 v16, s[12:15], s21 offen offset:2048 lds
  v_mfma_f32_16x16x32_bf16 a[216:219], v[124:127], v[92:95], a[216:219]
  v_mfma_f32_16x16x32_bf16 a[220:223], v[124:127], v[96:99], a[220:223]
  ds_read_b64_tr_b16 v[124:125], v26 offset:0
  v_mfma_f32_16x16x32_bf16 a[224:227], v[128:131], v[68:71], a[224:227]
  buffer_load_dwordx4 v17, s[12:15], s21 offen offset:3072 lds
  s_add_u32 s20, s20, 128
  s_add_u32 s21, s21, 524288
  ds_read_b64_tr_b16 v[126:127], v26 offset:2048
  v_mfma_f32_16x16x32_bf16 a[228:231], v[128:131], v[72:75], a[228:231]
  v_mfma_f32_16x16x32_bf16 a[232:235], v[128:131], v[76:79], a[232:235]
  v_mfma_f32_16x16x32_bf16 a[236:239], v[128:131], v[80:83], a[236:239]
  v_mfma_f32_16x16x32_bf16 a[240:243], v[128:131], v[84:87], a[240:243]
  v_mfma_f32_16x16x32_bf16 a[244:247], v[128:131], v[88:91], a[244:247]
  v_mfma_f32_16x16x32_bf16 a[248:251], v[128:131], v[92:95], a[248:251]
  v_mfma_f32_16x16x32_bf16 a[252:255], v[128:131], v[96:99], a[252:255]
  ds_read_b64_tr_b16 v[128:129], v27 offset:0
  ds_read_b64_tr_b16 v[130:131], v27 offset:2048
  s_waitcnt lgkmcnt(2)
  v_mfma_f32_16x16x32_bf16 a[0:3], v[100:103], v[36:39], a[0:3]
  v_mfma_f32_16x16x32_bf16 a[4:7], v[100:103], v[40:43], a[4:7]
  v_mfma_f32_16x16x32_bf16 a[8:11], v[100:103], v[44:47], a[8:11]
  ds_read_b128 v[68:71], v19 offset:0
  v_mfma_f32_16x16x32_bf16 a[12:15], v[100:103], v[48:51], a[12:15]
  v_mfma_f32_16x16x32_bf16 a[16:19], v[100:103], v[52:55], a[16:19]
  v_mfma_f32_16x16x32_bf16 a[20:23], v[100:103], v[56:59], a[20:23]
  v_mfma_f32_16x16x32_bf16 a[24:27], v[100:103], v[60:63], a[24:27]
  v_mfma_f32_16x16x32_bf16 a[28:31], v[100:103], v[64:67], a[28:31]
  ds_read_b64_tr_b16 v[100:101], v20 offset:16384
  v_mfma_f32_16x16x32_bf16 a[32:35], v[104:107], v[36:39], a[32:35]
  ds_read_b64_tr_b16 v[102:103], v20 offset:18432
  ds_read_b128 v[72:75], v19 offset:2048
  v_mfma_f32_16x16x32_bf16 a[36:39], v[104:107], v[40:43], a[36:39]
  v_mfma_f32_16x16x32_bf16 a[40:43], v[104:107], v[44:47], a[40:43]
  v_mfma_f32_16x16x32_bf16 a[44:47], v[104:107], v[48:51], a[44:47]
  v_mfma_f32_16x16x32_bf16 a[48:51], v[104:107], v[52:55], a[48:51]
  v_mfma_f32_16x16x32_bf16 a[52:55], v[104:107], v[56:59], a[52:55]
  v_mfma_f32_16x16x32_bf16 a[56:59], v[104:107], v[60:63], a[56:59]
  ds_read_b128 v[76:79], v19 offset:4096
  v_mfma_f32_16x16x32_bf16 a[60:63], v[104:107], v[64:67], a[60:63]
  ds_read_b64_tr_b16 v[104:105], v21 offset:16384
  v_mfma_f32_16x16x32_bf16 a[64:67], v[108:111], v[36:39], a[64:67]
  ds_read_b64_tr_b16 v[106:107], v21 offset:18432
  v_mfma_f32_16x16x32_bf16 a[68:71], v[108:111], v[40:43], a[68:71]
  v_mfma_f32_16x16x32_bf16 a[72:75], v[108:111], v[44:47], a[72:75]
  v_mfma_f32_16x16x32_bf16 a[76:79], v[108:111], v[48:51], a[76:79]
  v_mfma_f32_16x16x32_bf16 a[80:83], v[108:111], v[52:55], a[80:83]
  ds_read_b128 v[80:83], v19 offset:6144
  v_mfma_f32_16x16x32_bf16 a[84:87], v[108:111], v[56:59], a[84:87]
  v_mfma_f32_16x16x32_bf16 a[88:91], v[108:111], v[60:63], a[88:91]
  v_mfma_f32_16x16x32_bf16 a[92:95], v[108:111], v[64:67], a[92:95]
  ds_read_b64_tr_b16 v[108:109], v22 offset:16384
  v_mfma_f32_16x16x32_bf16 a[96:99], v[112:115], v[36:39], a[96:99]
  ds_read_b64_tr_b16 v[110:111], v22 offset:18432
  v_mfma_f32_16x16x32_bf16 a[100:103], v[112:115], v[40:43], a[100:103]
  v_mfma_f32_16x16x32_bf16 a[104:107], v[112:115], v[44:47], a[104:107]
  ds_read_b128 v[84:87], v19 offset:8192
  v_mfma_f32_16x16x32_bf16 a[108:111], v[112:115], v[48:51], a[108:111]
  v_mfma_f32_16x16x32_bf16 a[112:115], v[112:115], v[52:55], a[112:115]
  v_mfma_f32_16x16x32_bf16 a[116:119], v[112:115], v[56:59], a[116:119]
  v_mfma_f32_16x16x32_bf16 a[120:123], v[112:115], v[60:63], a[120:123]
  v_mfma_f32_16x16x32_bf16 a[124:127], v[112:115], v[64:67], a[124:127]
  ds_read_b64_tr_b16 v[112:113], v23 offset:16384
  v_mfma_f32_16x16x32_bf16 a[128:131], v[116:119], v[36:39], a[128:131]
  ds_read_b64_tr_b16 v[114:115], v23 offset:18432
  ds_read_b128 v[88:91], v19 offset:10240
  v_mfma_f32_16x16x32_bf16 a[132:135], v[116:119], v[40:43], a[132:135]
  v_mfma_f32_16x16x32_bf16 a[136:139], v[116:119], v[44:47], a[136:139]
  v_mfma_f32_16x16x32_bf16 a[140:143], v[116:119], v[48:51], a[140:143]
  v_mfma_f32_16x16x32_bf16 a[144:147], v[116:119], v[52:55], a[144:147]
  v_mfma_f32_16x16x32_bf16 a[148:151], v[116:119], v[56:59], a[148:151]
  v_mfma_f32_16x16x32_bf16 a[152:155], v[116:119], v[60:63], a[152:155]
  ds_read_b128 v[92:95], v19 offset:12288
  v_mfma_f32_16x16x32_bf16 a[156:159], v[116:119], v[64:67], a[156:159]
  ds_read_b64_tr_b16 v[116:117], v24 offset:16384
  v_mfma_f32_16x16x32_bf16 a[160:163], v[120:123], v[36:39], a[160:163]
  ds_read_b64_tr_b16 v[118:119], v24 offset:18432
  v_mfma_f32_16x16x32_bf16 a[164:167], v[120:123], v[40:43], a[164:167]
  v_mfma_f32_16x16x32_bf16 a[168:171], v[120:123], v[44:47], a[168:171]
  v_mfma_f32_16x16x32_bf16 a[172:175], v[120:123], v[48:51], a[172:175]
  v_mfma_f32_16x16x32_bf16 a[176:179], v[120:123], v[52:55], a[176:179]
  ds_read_b128 v[96:99], v19 offset:14336
  v_mfma_f32_16x16x32_bf16 a[180:183], v[120:123], v[56:59], a[180:183]
  v_mfma_f32_16x16x32_bf16 a[184:187], v[120:123], v[60:63], a[184:187]
  v_mfma_f32_16x16x32_bf16 a[188:191], v[120:123], v[64:67], a[188:191]
  ds_read_b64_tr_b16 v[120:121], v25 offset:16384
  v_mfma_f32_16x16x32_bf16 a[192:195], v[124:127], v[36:39], a[192:195]
  ds_read_b64_tr_b16 v[122:123], v25 offset:18432
  v_mfma_f32_16x16x32_bf16 a[196:199], v[124:127], v[40:43], a[196:199]
  v_mfma_f32_16x16x32_bf16 a[200:203], v[124:127], v[44:47], a[200:203]
  v_mfma_f32_16x16x32_bf16 a[204:207], v[124:127], v[48:51], a[204:207]
  v_mfma_f32_16x16x32_bf16 a[208:211], v[124:127], v[52:55], a[208:211]
  v_mfma_f32_16x16x32_bf16 a[212:215], v[124:127], v[56:59], a[212:215]
  v_mfma_f32_16x16x32_bf16 a[216:219], v[124:127], v[60:63], a[216:219]
  v_mfma_f32_16x16x32_bf16 a[220:223], v[124:127], v[64:67], a[220:223]
  ds_read_b64_tr_b16 v[124:125], v26 offset:16384
s_waitcnt lgkmcnt(15)
  v_mfma_f32_16x16x32_bf16 a[224:227], v[128:131], v[36:39], a[224:227]
  ds_read_b64_tr_b16 v[126:127], v26 offset:18432
  v_mfma_f32_16x16x32_bf16 a[228:231], v[128:131], v[40:43], a[228:231]
  v_mfma_f32_16x16x32_bf16 a[232:235], v[128:131], v[44:47], a[232:235]
  v_mfma_f32_16x16x32_bf16 a[236:239], v[128:131], v[48:51], a[236:239]
  v_mfma_f32_16x16x32_bf16 a[240:243], v[128:131], v[52:55], a[240:243]
  v_mfma_f32_16x16x32_bf16 a[244:247], v[128:131], v[56:59], a[244:247]
  v_mfma_f32_16x16x32_bf16 a[248:251], v[128:131], v[60:63], a[248:251]
  v_mfma_f32_16x16x32_bf16 a[252:255], v[128:131], v[64:67], a[252:255]
  ds_read_b64_tr_b16 v[128:129], v27 offset:16384
  ds_read_b64_tr_b16 v[130:131], v27 offset:18432
  s_waitcnt lgkmcnt(2)
  v_mfma_f32_16x16x32_bf16 a[0:3], v[100:103], v[68:71], a[0:3]
  v_mfma_f32_16x16x32_bf16 a[4:7], v[100:103], v[72:75], a[4:7]
  v_mfma_f32_16x16x32_bf16 a[8:11], v[100:103], v[76:79], a[8:11]
  v_mfma_f32_16x16x32_bf16 a[12:15], v[100:103], v[80:83], a[12:15]
  v_mfma_f32_16x16x32_bf16 a[16:19], v[100:103], v[84:87], a[16:19]
  v_mfma_f32_16x16x32_bf16 a[20:23], v[100:103], v[88:91], a[20:23]
  v_mfma_f32_16x16x32_bf16 a[24:27], v[100:103], v[92:95], a[24:27]
  v_mfma_f32_16x16x32_bf16 a[28:31], v[100:103], v[96:99], a[28:31]
  v_mfma_f32_16x16x32_bf16 a[32:35], v[104:107], v[68:71], a[32:35]
  v_mfma_f32_16x16x32_bf16 a[36:39], v[104:107], v[72:75], a[36:39]
  s_waitcnt vmcnt(0) lgkmcnt(0)
  s_barrier
  v_mfma_f32_16x16x32_bf16 a[40:43], v[104:107], v[76:79], a[40:43]
  ds_read_b64_tr_b16 v[100:101], v20 offset:32768
  v_mfma_f32_16x16x32_bf16 a[44:47], v[104:107], v[80:83], a[44:47]
  s_add_u32 m0, s22, 0
s_nop 0
  buffer_load_dwordx4 v2, s[8:11], s20 offen offset:0 lds
  ds_read_b64_tr_b16 v[102:103], v20 offset:34816
  v_mfma_f32_16x16x32_bf16 a[48:51], v[104:107], v[84:87], a[48:51]
  ds_read_b128 v[36:39], v18 offset:32768
  v_mfma_f32_16x16x32_bf16 a[52:55], v[104:107], v[88:91], a[52:55]
  v_mfma_f32_16x16x32_bf16 a[56:59], v[104:107], v[92:95], a[56:59]
  buffer_load_dwordx4 v3, s[8:11], s20 offen offset:1024 lds
  v_mfma_f32_16x16x32_bf16 a[60:63], v[104:107], v[96:99], a[60:63]
  ds_read_b64_tr_b16 v[104:105], v21 offset:32768
  v_mfma_f32_16x16x32_bf16 a[64:67], v[108:111], v[68:71], a[64:67]
  ds_read_b64_tr_b16 v[106:107], v21 offset:34816
  ds_read_b128 v[40:43], v18 offset:34816
  v_mfma_f32_16x16x32_bf16 a[68:71], v[108:111], v[72:75], a[68:71]
  buffer_load_dwordx4 v4, s[8:11], s20 offen offset:2048 lds
  v_mfma_f32_16x16x32_bf16 a[72:75], v[108:111], v[76:79], a[72:75]
  v_mfma_f32_16x16x32_bf16 a[76:79], v[108:111], v[80:83], a[76:79]
  v_mfma_f32_16x16x32_bf16 a[80:83], v[108:111], v[84:87], a[80:83]
  buffer_load_dwordx4 v5, s[8:11], s20 offen offset:3072 lds
  v_mfma_f32_16x16x32_bf16 a[84:87], v[108:111], v[88:91], a[84:87]
  ds_read_b128 v[44:47], v18 offset:36864
  v_mfma_f32_16x16x32_bf16 a[88:91], v[108:111], v[92:95], a[88:91]
  v_mfma_f32_16x16x32_bf16 a[92:95], v[108:111], v[96:99], a[92:95]
  s_add_u32 m0, s23, 0
s_nop 0
  buffer_load_dwordx4 v10, s[12:15], s21 offen offset:0 lds
  ds_read_b64_tr_b16 v[108:109], v22 offset:32768
  v_mfma_f32_16x16x32_bf16 a[96:99], v[112:115], v[68:71], a[96:99]
  ds_read_b64_tr_b16 v[110:111], v22 offset:34816
  v_mfma_f32_16x16x32_bf16 a[100:103], v[112:115], v[72:75], a[100:103]
  v_mfma_f32_16x16x32_bf16 a[104:107], v[112:115], v[76:79], a[104:107]
  buffer_load_dwordx4 v11, s[12:15], s21 offen offset:1024 lds
  ds_read_b128 v[48:51], v18 offset:38912
  v_mfma_f32_16x16x32_bf16 a[108:111], v[112:115], v[80:83], a[108:111]
  v_mfma_f32_16x16x32_bf16 a[112:115], v[112:115], v[84:87], a[112:115]
  v_mfma_f32_16x16x32_bf16 a[116:119], v[112:115], v[88:91], a[116:119]
  buffer_load_dwordx4 v12, s[12:15], s21 offen offset:2048 lds
  v_mfma_f32_16x16x32_bf16 a[120:123], v[112:115], v[92:95], a[120:123]
  v_mfma_f32_16x16x32_bf16 a[124:127], v[112:115], v[96:99], a[124:127]
  ds_read_b64_tr_b16 v[112:113], v23 offset:32768
  ds_read_b128 v[52:55], v18 offset:40960
  v_mfma_f32_16x16x32_bf16 a[128:131], v[116:119], v[68:71], a[128:131]
  buffer_load_dwordx4 v13, s[12:15], s21 offen offset:3072 lds
  ds_read_b64_tr_b16 v[114:115], v23 offset:34816
  v_mfma_f32_16x16x32_bf16 a[132:135], v[116:119], v[72:75], a[132:135]
  v_mfma_f32_16x16x32_bf16 a[136:139], v[116:119], v[76:79], a[136:139]
  v_mfma_f32_16x16x32_bf16 a[140:143], v[116:119], v[80:83], a[140:143]
  s_add_u32 m0, s22, 4096
s_nop 0
  buffer_load_dwordx4 v6, s[8:11], s20 offen offset:0 lds
  ds_read_b128 v[56:59], v18 offset:43008
  v_mfma_f32_16x16x32_bf16 a[144:147], v[116:119], v[84:87], a[144:147]
  v_mfma_f32_16x16x32_bf16 a[148:151], v[116:119], v[88:91], a[148:151]
  v_mfma_f32_16x16x32_bf16 a[152:155], v[116:119], v[92:95], a[152:155]
  buffer_load_dwordx4 v7, s[8:11], s20 offen offset:1024 lds
  v_mfma_f32_16x16x32_bf16 a[156:159], v[116:119], v[96:99], a[156:159]
  ds_read_b64_tr_b16 v[116:117], v24 offset:32768
  v_mfma_f32_16x16x32_bf16 a[160:163], v[120:123], v[68:71], a[160:163]
  ds_read_b64_tr_b16 v[118:119], v24 offset:34816
  ds_read_b128 v[60:63], v18 offset:45056
  v_mfma_f32_16x16x32_bf16 a[164:167], v[120:123], v[72:75], a[164:167]
  buffer_load_dwordx4 v8, s[8:11], s20 offen offset:2048 lds
  v_mfma_f32_16x16x32_bf16 a[168:171], v[120:123], v[76:79], a[168:171]
  v_mfma_f32_16x16x32_bf16 a[172:175], v[120:123], v[80:83], a[172:175]
  v_mfma_f32_16x16x32_bf16 a[176:179], v[120:123], v[84:87], a[176:179]
  buffer_load_dwordx4 v9, s[8:11], s20 offen offset:3072 lds
  v_mfma_f32_16x16x32_bf16 a[180:183], v[120:123], v[88:91], a[180:183]
  ds_read_b128 v[64:67], v18 offset:47104
  v_mfma_f32_16x16x32_bf16 a[184:187], v[120:123], v[92:95], a[184:187]
  v_mfma_f32_16x16x32_bf16 a[188:191], v[120:123], v[96:99], a[188:191]
  s_add_u32 m0, s23, 4096
s_nop 0
  buffer_load_dwordx4 v14, s[12:15], s21 offen offset:0 lds
  ds_read_b64_tr_b16 v[120:121], v25 offset:32768
  v_mfma_f32_16x16x32_bf16 a[192:195], v[124:127], v[68:71], a[192:195]
  ds_read_b64_tr_b16 v[122:123], v25 offset:34816
  v_mfma_f32_16x16x32_bf16 a[196:199], v[124:127], v[72:75], a[196:199]
  v_mfma_f32_16x16x32_bf16 a[200:203], v[124:127], v[76:79], a[200:203]
  buffer_load_dwordx4 v15, s[12:15], s21 offen offset:1024 lds
  v_mfma_f32_16x16x32_bf16 a[204:207], v[124:127], v[80:83], a[204:207]
  v_mfma_f32_16x16x32_bf16 a[208:211], v[124:127], v[84:87], a[208:211]
  v_mfma_f32_16x16x32_bf16 a[212:215], v[124:127], v[88:91], a[212:215]
  buffer_load_dwordx4 v16, s[12:15], s21 offen offset:2048 lds
  v_mfma_f32_16x16x32_bf16 a[216:219], v[124:127], v[92:95], a[216:219]
  v_mfma_f32_16x16x32_bf16 a[220:223], v[124:127], v[96:99], a[220:223]
  ds_read_b64_tr_b16 v[124:125], v26 offset:32768
  v_mfma_f32_16x16x32_bf16 a[224:227], v[128:131], v[68:71], a[224:227]
  buffer_load_dwordx4 v17, s[12:15], s21 offen offset:3072 lds
  s_add_u32 s20, s20, 128
  s_add_u32 s21, s21, 524288
  ds_read_b64_tr_b16 v[126:127], v26 offset:34816
  v_mfma_f32_16x16x32_bf16 a[228:231], v[128:131], v[72:75], a[228:231]
  v_mfma_f32_16x16x32_bf16 a[232:235], v[128:131], v[76:79], a[232:235]
  v_mfma_f32_16x16x32_bf16 a[236:239], v[128:131], v[80:83], a[236:239]
  v_mfma_f32_16x16x32_bf16 a[240:243], v[128:131], v[84:87], a[240:243]
  v_mfma_f32_16x16x32_bf16 a[244:247], v[128:131], v[88:91], a[244:247]
  v_mfma_f32_16x16x32_bf16 a[248:251], v[128:131], v[92:95], a[248:251]
  v_mfma_f32_16x16x32_bf16 a[252:255], v[128:131], v[96:99], a[252:255]
  ds_read_b64_tr_b16 v[128:129], v27 offset:32768
  ds_read_b64_tr_b16 v[130:131], v27 offset:34816
  s_waitcnt lgkmcnt(2)
  v_mfma_f32_16x16x32_bf16 a[0:3], v[100:103], v[36:39], a[0:3]
  v_mfma_f32_16x16x32_bf16 a[4:7], v[100:103], v[40:43], a[4:7]
  v_mfma_f32_16x16x32_bf16 a[8:11], v[100:103], v[44:47], a[8:11]
  ds_read_b128 v[68:71], v19 offset:32768
  v_mfma_f32_16x16x32_bf16 a[12:15], v[100:103], v[48:51], a[12:15]
  v_mfma_f32_16x16x32_bf16 a[16:19], v[100:103], v[52:55], a[16:19]
  v_mfma_f32_16x16x32_bf16 a[20:23], v[100:103], v[56:59], a[20:23]
  v_mfma_f32_16x16x32_bf16 a[24:27], v[100:103], v[60:63], a[24:27]
  v_mfma_f32_16x16x32_bf16 a[28:31], v[100:103], v[64:67], a[28:31]
  ds_read_b64_tr_b16 v[100:101], v20 offset:49152
  v_mfma_f32_16x16x32_bf16 a[32:35], v[104:107], v[36:39], a[32:35]
  ds_read_b64_tr_b16 v[102:103], v20 offset:51200
  ds_read_b128 v[72:75], v19 offset:34816
  v_mfma_f32_16x16x32_bf16 a[36:39], v[104:107], v[40:43], a[36:39]
  v_mfma_f32_16x16x32_bf16 a[40:43], v[104:107], v[44:47], a[40:43]
  v_mfma_f32_16x16x32_bf16 a[44:47], v[104:107], v[48:51], a[44:47]
  v_mfma_f32_16x16x32_bf16 a[48:51], v[104:107], v[52:55], a[48:51]
  v_mfma_f32_16x16x32_bf16 a[52:55], v[104:107], v[56:59], a[52:55]
  v_mfma_f32_16x16x32_bf16 a[56:59], v[104:107], v[60:63], a[56:59]
  ds_read_b128 v[76:79], v19 offset:36864
  v_mfma_f32_16x16x32_bf16 a[60:63], v[104:107], v[64:67], a[60:63]
  ds_read_b64_tr_b16 v[104:105], v21 offset:49152
  v_mfma_f32_16x16x32_bf16 a[64:67], v[108:111], v[36:39], a[64:67]
  ds_read_b64_tr_b16 v[106:107], v21 offset:51200
  v_mfma_f32_16x16x32_bf16 a[68:71], v[108:111], v[40:43], a[68:71]
  v_mfma_f32_16x16x32_bf16 a[72:75], v[108:111], v[44:47], a[72:75]
  v_mfma_f32_16x16x32_bf16 a[76:79], v[108:111], v[48:51], a[76:79]
  v_mfma_f32_16x16x32_bf16 a[80:83], v[108:111], v[52:55], a[80:83]
  ds_read_b128 v[80:83], v19 offset:38912
  v_mfma_f32_16x16x32_bf16 a[84:87], v[108:111], v[56:59], a[84:87]
  v_mfma_f32_16x16x32_bf16 a[88:91], v[108:111], v[60:63], a[88:91]
  v_mfma_f32_16x16x32_bf16 a[92:95], v[108:111], v[64:67], a[92:95]
  ds_read_b64_tr_b16 v[108:109], v22 offset:49152
  v_mfma_f32_16x16x32_bf16 a[96:99], v[112:115], v[36:39], a[96:99]
  ds_read_b64_tr_b16 v[110:111], v22 offset:51200
  v_mfma_f32_16x16x32_bf16 a[100:103], v[112:115], v[40:43], a[100:103]
  v_mfma_f32_16x16x32_bf16 a[104:107], v[112:115], v[44:47], a[104:107]
  ds_read_b128 v[84:87], v19 offset:40960
  v_mfma_f32_16x16x32_bf16 a[108:111], v[112:115], v[48:51], a[108:111]
  v_mfma_f32_16x16x32_bf16 a[112:115], v[112:115], v[52:55], a[112:115]
  v_mfma_f32_16x16x32_bf16 a[116:119], v[112:115], v[56:59], a[116:119]
  v_mfma_f32_16x16x32_bf16 a[120:123], v[112:115], v[60:63], a[120:123]
  v_mfma_f32_16x16x32_bf16 a[124:127], v[112:115], v[64:67], a[124:127]
  ds_read_b64_tr_b16 v[112:113], v23 offset:49152
  v_mfma_f32_16x16x32_bf16 a[128:131], v[116:119], v[36:39], a[128:131]
  ds_read_b64_tr_b16 v[114:115], v23 offset:51200
  ds_read_b128 v[88:91], v19 offset:43008
  v_mfma_f32_16x16x32_bf16 a[132:135], v[116:119], v[40:43], a[132:135]
  v_mfma_f32_16x16x32_bf16 a[136:139], v[116:119], v[44:47], a[136:139]
  v_mfma_f32_16x16x32_bf16 a[140:143], v[116:119], v[48:51], a[140:143]
  v_mfma_f32_16x16x32_bf16 a[144:147], v[116:119], v[52:55], a[144:147]
  v_mfma_f32_16x16x32_bf16 a[148:151], v[116:119], v[56:59], a[148:151]
  v_mfma_f32_16x16x32_bf16 a[152:155], v[116:119], v[60:63], a[152:155]
  ds_read_b128 v[92:95], v19 offset:45056
  v_mfma_f32_16x16x32_bf16 a[156:159], v[116:119], v[64:67], a[156:159]
  ds_read_b64_tr_b16 v[116:117], v24 offset:49152
  v_mfma_f32_16x16x32_bf16 a[160:163], v[120:123], v[36:39], a[160:163]
  ds_read_b64_tr_b16 v[118:119], v24 offset:51200
  v_mfma_f32_16x16x32_bf16 a[164:167], v[120:123], v[40:43], a[164:167]
  v_mfma_f32_16x16x32_bf16 a[168:171], v[120:123], v[44:47], a[168:171]
  v_mfma_f32_16x16x32_bf16 a[172:175], v[120:123], v[48:51], a[172:175]
  v_mfma_f32_16x16x32_bf16 a[176:179], v[120:123], v[52:55], a[176:179]
  ds_read_b128 v[96:99], v19 offset:47104
  v_mfma_f32_16x16x32_bf16 a[180:183], v[120:123], v[56:59], a[180:183]
  v_mfma_f32_16x16x32_bf16 a[184:187], v[120:123], v[60:63], a[184:187]
  v_mfma_f32_16x16x32_bf16 a[188:191], v[120:123], v[64:67], a[188:191]
  ds_read_b64_tr_b16 v[120:121], v25 offset:49152
  v_mfma_f32_16x16x32_bf16 a[192:195], v[124:127], v[36:39], a[192:195]
  ds_read_b64_tr_b16 v[122:123], v25 offset:51200
  v_mfma_f32_16x16x32_bf16 a[196:199], v[124:127], v[40:43], a[196:199]
  v_mfma_f32_16x16x32_bf16 a[200:203], v[124:127], v[44:47], a[200:203]
  v_mfma_f32_16x16x32_bf16 a[204:207], v[124:127], v[48:51], a[204:207]
  v_mfma_f32_16x16x32_bf16 a[208:211], v[124:127], v[52:55], a[208:211]
  v_mfma_f32_16x16x32_bf16 a[212:215], v[124:127], v[56:59], a[212:215]
  v_mfma_f32_16x16x32_bf16 a[216:219], v[124:127], v[60:63], a[216:219]
  v_mfma_f32_16x16x32_bf16 a[220:223], v[124:127], v[64:67], a[220:223]
  ds_read_b64_tr_b16 v[124:125], v26 offset:49152
s_waitcnt lgkmcnt(15)
  v_mfma_f32_16x16x32_bf16 a[224:227], v[128:131], v[36:39], a[224:227]
  ds_read_b64_tr_b16 v[126:127], v26 offset:51200
  v_mfma_f32_16x16x32_bf16 a[228:231], v[128:131], v[40:43], a[228:231]
  v_mfma_f32_16x16x32_bf16 a[232:235], v[128:131], v[44:47], a[232:235]
  v_mfma_f32_16x16x32_bf16 a[236:239], v[128:131], v[48:51], a[236:239]
  v_mfma_f32_16x16x32_bf16 a[240:243], v[128:131], v[52:55], a[240:243]
  v_mfma_f32_16x16x32_bf16 a[244:247], v[128:131], v[56:59], a[244:247]
  v_mfma_f32_16x16x32_bf16 a[248:251], v[128:131], v[60:63], a[248:251]
  v_mfma_f32_16x16x32_bf16 a[252:255], v[128:131], v[64:67], a[252:255]
  ds_read_b64_tr_b16 v[128:129], v27 offset:49152
  ds_read_b64_tr_b16 v[130:131], v27 offset:51200
  s_waitcnt lgkmcnt(2)
  v_mfma_f32_16x16x32_bf16 a[0:3], v[100:103], v[68:71], a[0:3]
  v_mfma_f32_16x16x32_bf16 a[4:7], v[100:103], v[72:75], a[4:7]
  v_mfma_f32_16x16x32_bf16 a[8:11], v[100:103], v[76:79], a[8:11]
  v_mfma_f32_16x16x32_bf16 a[12:15], v[100:103], v[80:83], a[12:15]
  v_mfma_f32_16x16x32_bf16 a[16:19], v[100:103], v[84:87], a[16:19]
  v_mfma_f32_16x16x32_bf16 a[20:23], v[100:103], v[88:91], a[20:23]
  v_mfma_f32_16x16x32_bf16 a[24:27], v[100:103], v[92:95], a[24:27]
  v_mfma_f32_16x16x32_bf16 a[28:31], v[100:103], v[96:99], a[28:31]
  v_mfma_f32_16x16x32_bf16 a[32:35], v[104:107], v[68:71], a[32:35]
  v_mfma_f32_16x16x32_bf16 a[36:39], v[104:107], v[72:75], a[36:39]
  s_waitcnt vmcnt(0) lgkmcnt(0)
  s_barrier
  v_mfma_f32_16x16x32_bf16 a[40:43], v[104:107], v[76:79], a[40:43]
  ds_read_b64_tr_b16 v[100:101], v20 offset:0
  v_mfma_f32_16x16x32_bf16 a[44:47], v[104:107], v[80:83], a[44:47]
  s_add_u32 m0, s22, 32768
s_nop 0
  buffer_load_dwordx4 v2, s[8:11], s20 offen offset:0 lds
  ds_read_b64_tr_b16 v[102:103], v20 offset:2048
  v_mfma_f32_16x16x32_bf16 a[48:51], v[104:107], v[84:87], a[48:51]
  ds_read_b128 v[36:39], v18 offset:0
  v_mfma_f32_16x16x32_bf16 a[52:55], v[104:107], v[88:91], a[52:55]
  v_mfma_f32_16x16x32_bf16 a[56:59], v[104:107], v[92:95], a[56:59]
  buffer_load_dwordx4 v3, s[8:11], s20 offen offset:1024 lds
  v_mfma_f32_16x16x32_bf16 a[60:63], v[104:107], v[96:99], a[60:63]
  ds_read_b64_tr_b16 v[104:105], v21 offset:0
  v_mfma_f32_16x16x32_bf16 a[64:67], v[108:111], v[68:71], a[64:67]
  ds_read_b64_tr_b16 v[106:107], v21 offset:2048
  ds_read_b128 v[40:43], v18 offset:2048
  v_mfma_f32_16x16x32_bf16 a[68:71], v[108:111], v[72:75], a[68:71]
  buffer_load_dwordx4 v4, s[8:11], s20 offen offset:2048 lds
  v_mfma_f32_16x16x32_bf16 a[72:75], v[108:111], v[76:79], a[72:75]
  v_mfma_f32_16x16x32_bf16 a[76:79], v[108:111], v[80:83], a[76:79]
  v_mfma_f32_16x16x32_bf16 a[80:83], v[108:111], v[84:87], a[80:83]
  buffer_load_dwordx4 v5, s[8:11], s20 offen offset:3072 lds
  v_mfma_f32_16x16x32_bf16 a[84:87], v[108:111], v[88:91], a[84:87]
  ds_read_b128 v[44:47], v18 offset:4096
  v_mfma_f32_16x16x32_bf16 a[88:91], v[108:111], v[92:95], a[88:91]
  v_mfma_f32_16x16x32_bf16 a[92:95], v[108:111], v[96:99], a[92:95]
  s_add_u32 m0, s23, 32768
s_nop 0
  buffer_load_dwordx4 v10, s[12:15], s21 offen offset:0 lds
  ds_read_b64_tr_b16 v[108:109], v22 offset:0
  v_mfma_f32_16x16x32_bf16 a[96:99], v[112:115], v[68:71], a[96:99]
  ds_read_b64_tr_b16 v[110:111], v22 offset:2048
  v_mfma_f32_16x16x32_bf16 a[100:103], v[112:115], v[72:75], a[100:103]
  v_mfma_f32_16x16x32_bf16 a[104:107], v[112:115], v[76:79], a[104:107]
  buffer_load_dwordx4 v11, s[12:15], s21 offen offset:1024 lds
  ds_read_b128 v[48:51], v18 offset:6144
  v_mfma_f32_16x16x32_bf16 a[108:111], v[112:115], v[80:83], a[108:111]
  v_mfma_f32_16x16x32_bf16 a[112:115], v[112:115], v[84:87], a[112:115]
  v_mfma_f32_16x16x32_bf16 a[116:119], v[112:115], v[88:91], a[116:119]
  buffer_load_dwordx4 v12, s[12:15], s21 offen offset:2048 lds
  v_mfma_f32_16x16x32_bf16 a[120:123], v[112:115], v[92:95], a[120:123]
  v_mfma_f32_16x16x32_bf16 a[124:127], v[112:115], v[96:99], a[124:127]
  ds_read_b64_tr_b16 v[112:113], v23 offset:0
  ds_read_b128 v[52:55], v18 offset:8192
  v_mfma_f32_16x16x32_bf16 a[128:131], v[116:119], v[68:71], a[128:131]
  buffer_load_dwordx4 v13, s[12:15], s21 offen offset:3072 lds
  ds_read_b64_tr_b16 v[114:115], v23 offset:2048
  v_mfma_f32_16x16x32_bf16 a[132:135], v[116:119], v[72:75], a[132:135]
  v_mfma_f32_16x16x32_bf16 a[136:139], v[116:119], v[76:79], a[136:139]
  v_mfma_f32_16x16x32_bf16 a[140:143], v[116:119], v[80:83], a[140:143]
  s_add_u32 m0, s22, 36864
s_nop 0
  buffer_load_dwordx4 v6, s[8:11], s20 offen offset:0 lds
  ds_read_b128 v[56:59], v18 offset:10240
  v_mfma_f32_16x16x32_bf16 a[144:147], v[116:119], v[84:87], a[144:147]
  v_mfma_f32_16x16x32_bf16 a[148:151], v[116:119], v[88:91], a[148:151]
  v_mfma_f32_16x16x32_bf16 a[152:155], v[116:119], v[92:95], a[152:155]
  buffer_load_dwordx4 v7, s[8:11], s20 offen offset:1024 lds
  v_mfma_f32_16x16x32_bf16 a[156:159], v[116:119], v[96:99], a[156:159]
  ds_read_b64_tr_b16 v[116:117], v24 offset:0
  v_mfma_f32_16x16x32_bf16 a[160:163], v[120:123], v[68:71], a[160:163]
  ds_read_b64_tr_b16 v[118:119], v24 offset:2048
  ds_read_b128 v[60:63], v18 offset:12288
  v_mfma_f32_16x16x32_bf16 a[164:167], v[120:123], v[72:75], a[164:167]
  buffer_load_dwordx4 v8, s[8:11], s20 offen offset:2048 lds
  v_mfma_f32_16x16x32_bf16 a[168:171], v[120:123], v[76:79], a[168:171]
  v_mfma_f32_16x16x32_bf16 a[172:175], v[120:123], v[80:83], a[172:175]
  v_mfma_f32_16x16x32_bf16 a[176:179], v[120:123], v[84:87], a[176:179]
  buffer_load_dwordx4 v9, s[8:11], s20 offen offset:3072 lds
  v_mfma_f32_16x16x32_bf16 a[180:183], v[120:123], v[88:91], a[180:183]
  ds_read_b128 v[64:67], v18 offset:14336
  v_mfma_f32_16x16x32_bf16 a[184:187], v[120:123], v[92:95], a[184:187]
  v_mfma_f32_16x16x32_bf16 a[188:191], v[120:123], v[96:99], a[188:191]
  s_add_u32 m0, s23, 36864
s_nop 0
  buffer_load_dwordx4 v14, s[12:15], s21 offen offset:0 lds
  ds_read_b64_tr_b16 v[120:121], v25 offset:0
  v_mfma_f32_16x16x32_bf16 a[192:195], v[124:127], v[68:71], a[192:195]
  ds_read_b64_tr_b16 v[122:123], v25 offset:2048
  v_mfma_f32_16x16x32_bf16 a[196:199], v[124:127], v[72:75], a[196:199]
  v_mfma_f32_16x16x32_bf16 a[200:203], v[124:127], v[76:79], a[200:203]
  buffer_load_dwordx4 v15, s[12:15], s21 offen offset:1024 lds
  v_mfma_f32_16x16x32_bf16 a[204:207], v[124:127], v[80:83], a[204:207]
  v_mfma_f32_16x16x32_bf16 a[208:211], v[124:127], v[84:87], a[208:211]
  v_mfma_f32_16x16x32_bf16 a[212:215], v[124:127], v[88:91], a[212:215]
  buffer_load_dwordx4 v16, s[12:15], s21 offen offset:2048 lds
  v_mfma_f32_16x16x32_bf16 a[216:219], v[124:127], v[92:95], a[216:219]
  v_mfma_f32_16x16x32_bf16 a[220:223], v[124:127], v[96:99], a[220:223]
  ds_read_b64_tr_b16 v[124:125], v26 offset:0
  v_mfma_f32_16x16x32_bf16 a[224:227], v[128:131], v[68:71], a[224:227]
  buffer_load_dwordx4 v17, s[12:15], s21 offen offset:3072 lds
  s_add_u32 s20, s20, 128
  s_add_u32 s21, s21, 524288
  ds_read_b64_tr_b16 v[126:127], v26 offset:2048
  v_mfma_f32_16x16x32_bf16 a[228:231], v[128:131], v[72:75], a[228:231]
  v_mfma_f32_16x16x32_bf16 a[232:235], v[128:131], v[76:79], a[232:235]
  v_mfma_f32_16x16x32_bf16 a[236:239], v[128:131], v[80:83], a[236:239]
  v_mfma_f32_16x16x32_bf16 a[240:243], v[128:131], v[84:87], a[240:243]
  v_mfma_f32_16x16x32_bf16 a[244:247], v[128:131], v[88:91], a[244:247]
  v_mfma_f32_16x16x32_bf16 a[248:251], v[128:131], v[92:95], a[248:251]
  v_mfma_f32_16x16x32_bf16 a[252:255], v[128:131], v[96:99], a[252:255]
  ds_read_b64_tr_b16 v[128:129], v27 offset:0
  ds_read_b64_tr_b16 v[130:131], v27 offset:2048
  s_waitcnt lgkmcnt(2)
  v_mfma_f32_16x16x32_bf16 a[0:3], v[100:103], v[36:39], a[0:3]
  v_mfma_f32_16x16x32_bf16 a[4:7], v[100:103], v[40:43], a[4:7]
  v_mfma_f32_16x16x32_bf16 a[8:11], v[100:103], v[44:47], a[8:11]
  ds_read_b128 v[68:71], v19 offset:0
  v_mfma_f32_16x16x32_bf16 a[12:15], v[100:103], v[48:51], a[12:15]
  v_mfma_f32_16x16x32_bf16 a[16:19], v[100:103], v[52:55], a[16:19]
  v_mfma_f32_16x16x32_bf16 a[20:23], v[100:103], v[56:59], a[20:23]
  v_mfma_f32_16x16x32_bf16 a[24:27], v[100:103], v[60:63], a[24:27]
  v_mfma_f32_16x16x32_bf16 a[28:31], v[100:103], v[64:67], a[28:31]
  ds_read_b64_tr_b16 v[100:101], v20 offset:16384
  v_mfma_f32_16x16x32_bf16 a[32:35], v[104:107], v[36:39], a[32:35]
  ds_read_b64_tr_b16 v[102:103], v20 offset:18432
  ds_read_b128 v[72:75], v19 offset:2048
  v_mfma_f32_16x16x32_bf16 a[36:39], v[104:107], v[40:43], a[36:39]
  v_mfma_f32_16x16x32_bf16 a[40:43], v[104:107], v[44:47], a[40:43]
  v_mfma_f32_16x16x32_bf16 a[44:47], v[104:107], v[48:51], a[44:47]
  v_mfma_f32_16x16x32_bf16 a[48:51], v[104:107], v[52:55], a[48:51]
  v_mfma_f32_16x16x32_bf16 a[52:55], v[104:107], v[56:59], a[52:55]
  v_mfma_f32_16x16x32_bf16 a[56:59], v[104:107], v[60:63], a[56:59]
  ds_read_b128 v[76:79], v19 offset:4096
  v_mfma_f32_16x16x32_bf16 a[60:63], v[104:107], v[64:67], a[60:63]
  ds_read_b64_tr_b16 v[104:105], v21 offset:16384
  v_mfma_f32_16x16x32_bf16 a[64:67], v[108:111], v[36:39], a[64:67]
  ds_read_b64_tr_b16 v[106:107], v21 offset:18432
  v_mfma_f32_16x16x32_bf16 a[68:71], v[108:111], v[40:43], a[68:71]
  v_mfma_f32_16x16x32_bf16 a[72:75], v[108:111], v[44:47], a[72:75]
  v_mfma_f32_16x16x32_bf16 a[76:79], v[108:111], v[48:51], a[76:79]
  v_mfma_f32_16x16x32_bf16 a[80:83], v[108:111], v[52:55], a[80:83]
  ds_read_b128 v[80:83], v19 offset:6144
  v_mfma_f32_16x16x32_bf16 a[84:87], v[108:111], v[56:59], a[84:87]
  v_mfma_f32_16x16x32_bf16 a[88:91], v[108:111], v[60:63], a[88:91]
  v_mfma_f32_16x16x32_bf16 a[92:95], v[108:111], v[64:67], a[92:95]
  ds_read_b64_tr_b16 v[108:109], v22 offset:16384
  v_mfma_f32_16x16x32_bf16 a[96:99], v[112:115], v[36:39], a[96:99]
  ds_read_b64_tr_b16 v[110:111], v22 offset:18432
  v_mfma_f32_16x16x32_bf16 a[100:103], v[112:115], v[40:43], a[100:103]
  v_mfma_f32_16x16x32_bf16 a[104:107], v[112:115], v[44:47], a[104:107]
  ds_read_b128 v[84:87], v19 offset:8192
  v_mfma_f32_16x16x32_bf16 a[108:111], v[112:115], v[48:51], a[108:111]
  v_mfma_f32_16x16x32_bf16 a[112:115], v[112:115], v[52:55], a[112:115]
  v_mfma_f32_16x16x32_bf16 a[116:119], v[112:115], v[56:59], a[116:119]
  v_mfma_f32_16x16x32_bf16 a[120:123], v[112:115], v[60:63], a[120:123]
  v_mfma_f32_16x16x32_bf16 a[124:127], v[112:115], v[64:67], a[124:127]
  ds_read_b64_tr_b16 v[112:113], v23 offset:16384
  v_mfma_f32_16x16x32_bf16 a[128:131], v[116:119], v[36:39], a[128:131]
  ds_read_b64_tr_b16 v[114:115], v23 offset:18432
  ds_read_b128 v[88:91], v19 offset:10240
  v_mfma_f32_16x16x32_bf16 a[132:135], v[116:119], v[40:43], a[132:135]
  v_mfma_f32_16x16x32_bf16 a[136:139], v[116:119], v[44:47], a[136:139]
  v_mfma_f32_16x16x32_bf16 a[140:143], v[116:119], v[48:51], a[140:143]
  v_mfma_f32_16x16x32_bf16 a[144:147], v[116:119], v[52:55], a[144:147]
  v_mfma_f32_16x16x32_bf16 a[148:151], v[116:119], v[56:59], a[148:151]
  v_mfma_f32_16x16x32_bf16 a[152:155], v[116:119], v[60:63], a[152:155]
  ds_read_b128 v[92:95], v19 offset:12288
  v_mfma_f32_16x16x32_bf16 a[156:159], v[116:119], v[64:67], a[156:159]
  ds_read_b64_tr_b16 v[116:117], v24 offset:16384
  v_mfma_f32_16x16x32_bf16 a[160:163], v[120:123], v[36:39], a[160:163]
  ds_read_b64_tr_b16 v[118:119], v24 offset:18432
  v_mfma_f32_16x16x32_bf16 a[164:167], v[120:123], v[40:43], a[164:167]
  v_mfma_f32_16x16x32_bf16 a[168:171], v[120:123], v[44:47], a[168:171]
  v_mfma_f32_16x16x32_bf16 a[172:175], v[120:123], v[48:51], a[172:175]
  v_mfma_f32_16x16x32_bf16 a[176:179], v[120:123], v[52:55], a[176:179]
  ds_read_b128 v[96:99], v19 offset:14336
  v_mfma_f32_16x16x32_bf16 a[180:183], v[120:123], v[56:59], a[180:183]
  v_mfma_f32_16x16x32_bf16 a[184:187], v[120:123], v[60:63], a[184:187]
  v_mfma_f32_16x16x32_bf16 a[188:191], v[120:123], v[64:67], a[188:191]
  ds_read_b64_tr_b16 v[120:121], v25 offset:16384
  v_mfma_f32_16x16x32_bf16 a[192:195], v[124:127], v[36:39], a[192:195]
  ds_read_b64_tr_b16 v[122:123], v25 offset:18432
  v_mfma_f32_16x16x32_bf16 a[196:199], v[124:127], v[40:43], a[196:199]
  v_mfma_f32_16x16x32_bf16 a[200:203], v[124:127], v[44:47], a[200:203]
  v_mfma_f32_16x16x32_bf16 a[204:207], v[124:127], v[48:51], a[204:207]
  v_mfma_f32_16x16x32_bf16 a[208:211], v[124:127], v[52:55], a[208:211]
  v_mfma_f32_16x16x32_bf16 a[212:215], v[124:127], v[56:59], a[212:215]
  v_mfma_f32_16x16x32_bf16 a[216:219], v[124:127], v[60:63], a[216:219]
  v_mfma_f32_16x16x32_bf16 a[220:223], v[124:127], v[64:67], a[220:223]
  ds_read_b64_tr_b16 v[124:125], v26 offset:16384
s_waitcnt lgkmcnt(15)
  v_mfma_f32_16x16x32_bf16 a[224:227], v[128:131], v[36:39], a[224:227]
  ds_read_b64_tr_b16 v[126:127], v26 offset:18432
  v_mfma_f32_16x16x32_bf16 a[228:231], v[128:131], v[40:43], a[228:231]
  v_mfma_f32_16x16x32_bf16 a[232:235], v[128:131], v[44:47], a[232:235]
  v_mfma_f32_16x16x32_bf16 a[236:239], v[128:131], v[48:51], a[236:239]
  v_mfma_f32_16x16x32_bf16 a[240:243], v[128:131], v[52:55], a[240:243]
  v_mfma_f32_16x16x32_bf16 a[244:247], v[128:131], v[56:59], a[244:247]
  v_mfma_f32_16x16x32_bf16 a[248:251], v[128:131], v[60:63], a[248:251]
  v_mfma_f32_16x16x32_bf16 a[252:255], v[128:131], v[64:67], a[252:255]
  ds_read_b64_tr_b16 v[128:129], v27 offset:16384
  ds_read_b64_tr_b16 v[130:131], v27 offset:18432
  s_waitcnt lgkmcnt(2)
  v_mfma_f32_16x16x32_bf16 a[0:3], v[100:103], v[68:71], a[0:3]
  v_mfma_f32_16x16x32_bf16 a[4:7], v[100:103], v[72:75], a[4:7]
  v_mfma_f32_16x16x32_bf16 a[8:11], v[100:103], v[76:79], a[8:11]
  v_mfma_f32_16x16x32_bf16 a[12:15], v[100:103], v[80:83], a[12:15]
  v_mfma_f32_16x16x32_bf16 a[16:19], v[100:103], v[84:87], a[16:19]
  v_mfma_f32_16x16x32_bf16 a[20:23], v[100:103], v[88:91], a[20:23]
  v_mfma_f32_16x16x32_bf16 a[24:27], v[100:103], v[92:95], a[24:27]
  v_mfma_f32_16x16x32_bf16 a[28:31], v[100:103], v[96:99], a[28:31]
  v_mfma_f32_16x16x32_bf16 a[32:35], v[104:107], v[68:71], a[32:35]
  v_mfma_f32_16x16x32_bf16 a[36:39], v[104:107], v[72:75], a[36:39]
  s_waitcnt vmcnt(0) lgkmcnt(0)
  s_barrier
  v_mfma_f32_16x16x32_bf16 a[40:43], v[104:107], v[76:79], a[40:43]
  ds_read_b64_tr_b16 v[100:101], v20 offset:32768
  v_mfma_f32_16x16x32_bf16 a[44:47], v[104:107], v[80:83], a[44:47]
  ds_read_b64_tr_b16 v[102:103], v20 offset:34816
  v_mfma_f32_16x16x32_bf16 a[48:51], v[104:107], v[84:87], a[48:51]
  ds_read_b128 v[36:39], v18 offset:32768
  v_mfma_f32_16x16x32_bf16 a[52:55], v[104:107], v[88:91], a[52:55]
  v_mfma_f32_16x16x32_bf16 a[56:59], v[104:107], v[92:95], a[56:59]
  v_mfma_f32_16x16x32_bf16 a[60:63], v[104:107], v[96:99], a[60:63]
  ds_read_b64_tr_b16 v[104:105], v21 offset:32768
  v_mfma_f32_16x16x32_bf16 a[64:67], v[108:111], v[68:71], a[64:67]
  ds_read_b64_tr_b16 v[106:107], v21 offset:34816
  ds_read_b128 v[40:43], v18 offset:34816
  v_mfma_f32_16x16x32_bf16 a[68:71], v[108:111], v[72:75], a[68:71]
  v_mfma_f32_16x16x32_bf16 a[72:75], v[108:111], v[76:79], a[72:75]
  v_mfma_f32_16x16x32_bf16 a[76:79], v[108:111], v[80:83], a[76:79]
  v_mfma_f32_16x16x32_bf16 a[80:83], v[108:111], v[84:87], a[80:83]
  v_mfma_f32_16x16x32_bf16 a[84:87], v[108:111], v[88:91], a[84:87]
  ds_read_b128 v[44:47], v18 offset:36864
  v_mfma_f32_16x16x32_bf16 a[88:91], v[108:111], v[92:95], a[88:91]
  v_mfma_f32_16x16x32_bf16 a[92:95], v[108:111], v[96:99], a[92:95]
  ds_read_b64_tr_b16 v[108:109], v22 offset:32768
  v_mfma_f32_16x16x32_bf16 a[96:99], v[112:115], v[68:71], a[96:99]
  ds_read_b64_tr_b16 v[110:111], v22 offset:34816
  v_mfma_f32_16x16x32_bf16 a[100:103], v[112:115], v[72:75], a[100:103]
  v_mfma_f32_16x16x32_bf16 a[104:107], v[112:115], v[76:79], a[104:107]
  ds_read_b128 v[48:51], v18 offset:38912
  v_mfma_f32_16x16x32_bf16 a[108:111], v[112:115], v[80:83], a[108:111]
  v_mfma_f32_16x16x32_bf16 a[112:115], v[112:115], v[84:87], a[112:115]
  v_mfma_f32_16x16x32_bf16 a[116:119], v[112:115], v[88:91], a[116:119]
  v_mfma_f32_16x16x32_bf16 a[120:123], v[112:115], v[92:95], a[120:123]
  v_mfma_f32_16x16x32_bf16 a[124:127], v[112:115], v[96:99], a[124:127]
  ds_read_b64_tr_b16 v[112:113], v23 offset:32768
  ds_read_b128 v[52:55], v18 offset:40960
  v_mfma_f32_16x16x32_bf16 a[128:131], v[116:119], v[68:71], a[128:131]
  ds_read_b64_tr_b16 v[114:115], v23 offset:34816
  v_mfma_f32_16x16x32_bf16 a[132:135], v[116:119], v[72:75], a[132:135]
  v_mfma_f32_16x16x32_bf16 a[136:139], v[116:119], v[76:79], a[136:139]
  v_mfma_f32_16x16x32_bf16 a[140:143], v[116:119], v[80:83], a[140:143]
  ds_read_b128 v[56:59], v18 offset:43008
  v_mfma_f32_16x16x32_bf16 a[144:147], v[116:119], v[84:87], a[144:147]
  v_mfma_f32_16x16x32_bf16 a[148:151], v[116:119], v[88:91], a[148:151]
  v_mfma_f32_16x16x32_bf16 a[152:155], v[116:119], v[92:95], a[152:155]
  v_mfma_f32_16x16x32_bf16 a[156:159], v[116:119], v[96:99], a[156:159]
  ds_read_b64_tr_b16 v[116:117], v24 offset:32768
  v_mfma_f32_16x16x32_bf16 a[160:163], v[120:123], v[68:71], a[160:163]
  ds_read_b64_tr_b16 v[118:119], v24 offset:34816
  ds_read_b128 v[60:63], v18 offset:45056
  v_mfma_f32_16x16x32_bf16 a[164:167], v[120:123], v[72:75], a[164:167]
  v_mfma_f32_16x16x32_bf16 a[168:171], v[120:123], v[76:79], a[168:171]
  v_mfma_f32_16x16x32_bf16 a[172:175], v[120:123], v[80:83], a[172:175]
  v_mfma_f32_16x16x32_bf16 a[176:179], v[120:123], v[84:87], a[176:179]
  v_mfma_f32_16x16x32_bf16 a[180:183], v[120:123], v[88:91], a[180:183]
  ds_read_b128 v[64:67], v18 offset:47104
  v_mfma_f32_16x16x32_bf16 a[184:187], v[120:123], v[92:95], a[184:187]
  v_mfma_f32_16x16x32_bf16 a[188:191], v[120:123], v[96:99], a[188:191]
  ds_read_b64_tr_b16 v[120:121], v25 offset:32768
  v_mfma_f32_16x16x32_bf16 a[192:195], v[124:127], v[68:71], a[192:195]
  ds_read_b64_tr_b16 v[122:123], v25 offset:34816
  v_mfma_f32_16x16x32_bf16 a[196:199], v[124:127], v[72:75], a[196:199]
  v_mfma_f32_16x16x32_bf16 a[200:203], v[124:127], v[76:79], a[200:203]
  v_mfma_f32_16x16x32_bf16 a[204:207], v[124:127], v[80:83], a[204:207]
  v_mfma_f32_16x16x32_bf16 a[208:211], v[124:127], v[84:87], a[208:211]
  v_mfma_f32_16x16x32_bf16 a[212:215], v[124:127], v[88:91], a[212:215]
  v_mfma_f32_16x16x32_bf16 a[216:219], v[124:127], v[92:95], a[216:219]
  v_mfma_f32_16x16x32_bf16 a[220:223], v[124:127], v[96:99], a[220:223]
  ds_read_b64_tr_b16 v[124:125], v26 offset:32768
  v_mfma_f32_16x16x32_bf16 a[224:227], v[128:131], v[68:71], a[224:227]
  ds_read_b64_tr_b16 v[126:127], v26 offset:34816
  v_mfma_f32_16x16x32_bf16 a[228:231], v[128:131], v[72:75], a[228:231]
  v_mfma_f32_16x16x32_bf16 a[232:235], v[128:131], v[76:79], a[232:235]
  v_mfma_f32_16x16x32_bf16 a[236:239], v[128:131], v[80:83], a[236:239]
  v_mfma_f32_16x16x32_bf16 a[240:243], v[128:131], v[84:87], a[240:243]
  v_mfma_f32_16x16x32_bf16 a[244:247], v[128:131], v[88:91], a[244:247]
  v_mfma_f32_16x16x32_bf16 a[248:251], v[128:131], v[92:95], a[248:251]
  v_mfma_f32_16x16x32_bf16 a[252:255], v[128:131], v[96:99], a[252:255]
  ds_read_b64_tr_b16 v[128:129], v27 offset:32768
  ds_read_b64_tr_b16 v[130:131], v27 offset:34816
  s_waitcnt lgkmcnt(2)
  v_mfma_f32_16x16x32_bf16 a[0:3], v[100:103], v[36:39], a[0:3]
  v_mfma_f32_16x16x32_bf16 a[4:7], v[100:103], v[40:43], a[4:7]
  v_mfma_f32_16x16x32_bf16 a[8:11], v[100:103], v[44:47], a[8:11]
  ds_read_b128 v[68:71], v19 offset:32768
  v_mfma_f32_16x16x32_bf16 a[12:15], v[100:103], v[48:51], a[12:15]
  v_mfma_f32_16x16x32_bf16 a[16:19], v[100:103], v[52:55], a[16:19]
  v_mfma_f32_16x16x32_bf16 a[20:23], v[100:103], v[56:59], a[20:23]
  v_mfma_f32_16x16x32_bf16 a[24:27], v[100:103], v[60:63], a[24:27]
  v_mfma_f32_16x16x32_bf16 a[28:31], v[100:103], v[64:67], a[28:31]
  ds_read_b64_tr_b16 v[100:101], v20 offset:49152
  v_mfma_f32_16x16x32_bf16 a[32:35], v[104:107], v[36:39], a[32:35]
  ds_read_b64_tr_b16 v[102:103], v20 offset:51200
  ds_read_b128 v[72:75], v19 offset:34816
  v_mfma_f32_16x16x32_bf16 a[36:39], v[104:107], v[40:43], a[36:39]
  v_mfma_f32_16x16x32_bf16 a[40:43], v[104:107], v[44:47], a[40:43]
  v_mfma_f32_16x16x32_bf16 a[44:47], v[104:107], v[48:51], a[44:47]
  v_mfma_f32_16x16x32_bf16 a[48:51], v[104:107], v[52:55], a[48:51]
  v_mfma_f32_16x16x32_bf16 a[52:55], v[104:107], v[56:59], a[52:55]
  v_mfma_f32_16x16x32_bf16 a[56:59], v[104:107], v[60:63], a[56:59]
  ds_read_b128 v[76:79], v19 offset:36864
  v_mfma_f32_16x16x32_bf16 a[60:63], v[104:107], v[64:67], a[60:63]
  ds_read_b64_tr_b16 v[104:105], v21 offset:49152
  v_mfma_f32_16x16x32_bf16 a[64:67], v[108:111], v[36:39], a[64:67]
  ds_read_b64_tr_b16 v[106:107], v21 offset:51200
  v_mfma_f32_16x16x32_bf16 a[68:71], v[108:111], v[40:43], a[68:71]
  v_mfma_f32_16x16x32_bf16 a[72:75], v[108:111], v[44:47], a[72:75]
  v_mfma_f32_16x16x32_bf16 a[76:79], v[108:111], v[48:51], a[76:79]
  v_mfma_f32_16x16x32_bf16 a[80:83], v[108:111], v[52:55], a[80:83]
  ds_read_b128 v[80:83], v19 offset:38912
  v_mfma_f32_16x16x32_bf16 a[84:87], v[108:111], v[56:59], a[84:87]
  v_mfma_f32_16x16x32_bf16 a[88:91], v[108:111], v[60:63], a[88:91]
  v_mfma_f32_16x16x32_bf16 a[92:95], v[108:111], v[64:67], a[92:95]
  ds_read_b64_tr_b16 v[108:109], v22 offset:49152
  v_mfma_f32_16x16x32_bf16 a[96:99], v[112:115], v[36:39], a[96:99]
  ds_read_b64_tr_b16 v[110:111], v22 offset:51200
  v_mfma_f32_16x16x32_bf16 a[100:103], v[112:115], v[40:43], a[100:103]
  v_mfma_f32_16x16x32_bf16 a[104:107], v[112:115], v[44:47], a[104:107]
  ds_read_b128 v[84:87], v19 offset:40960
  v_mfma_f32_16x16x32_bf16 a[108:111], v[112:115], v[48:51], a[108:111]
  v_mfma_f32_16x16x32_bf16 a[112:115], v[112:115], v[52:55], a[112:115]
  v_mfma_f32_16x16x32_bf16 a[116:119], v[112:115], v[56:59], a[116:119]
  v_mfma_f32_16x16x32_bf16 a[120:123], v[112:115], v[60:63], a[120:123]
  v_mfma_f32_16x16x32_bf16 a[124:127], v[112:115], v[64:67], a[124:127]
  ds_read_b64_tr_b16 v[112:113], v23 offset:49152
  v_mfma_f32_16x16x32_bf16 a[128:131], v[116:119], v[36:39], a[128:131]
  ds_read_b64_tr_b16 v[114:115], v23 offset:51200
  ds_read_b128 v[88:91], v19 offset:43008
  v_mfma_f32_16x16x32_bf16 a[132:135], v[116:119], v[40:43], a[132:135]
  v_mfma_f32_16x16x32_bf16 a[136:139], v[116:119], v[44:47], a[136:139]
  v_mfma_f32_16x16x32_bf16 a[140:143], v[116:119], v[48:51], a[140:143]
  v_mfma_f32_16x16x32_bf16 a[144:147], v[116:119], v[52:55], a[144:147]
  v_mfma_f32_16x16x32_bf16 a[148:151], v[116:119], v[56:59], a[148:151]
  v_mfma_f32_16x16x32_bf16 a[152:155], v[116:119], v[60:63], a[152:155]
  ds_read_b128 v[92:95], v19 offset:45056
  v_mfma_f32_16x16x32_bf16 a[156:159], v[116:119], v[64:67], a[156:159]
  ds_read_b64_tr_b16 v[116:117], v24 offset:49152
  v_mfma_f32_16x16x32_bf16 a[160:163], v[120:123], v[36:39], a[160:163]
  ds_read_b64_tr_b16 v[118:119], v24 offset:51200
  v_mfma_f32_16x16x32_bf16 a[164:167], v[120:123], v[40:43], a[164:167]
  v_mfma_f32_16x16x32_bf16 a[168:171], v[120:123], v[44:47], a[168:171]
  v_mfma_f32_16x16x32_bf16 a[172:175], v[120:123], v[48:51], a[172:175]
  v_mfma_f32_16x16x32_bf16 a[176:179], v[120:123], v[52:55], a[176:179]
  ds_read_b128 v[96:99], v19 offset:47104
  v_mfma_f32_16x16x32_bf16 a[180:183], v[120:123], v[56:59], a[180:183]
  v_mfma_f32_16x16x32_bf16 a[184:187], v[120:123], v[60:63], a[184:187]
  v_mfma_f32_16x16x32_bf16 a[188:191], v[120:123], v[64:67], a[188:191]
  ds_read_b64_tr_b16 v[120:121], v25 offset:49152
  v_mfma_f32_16x16x32_bf16 a[192:195], v[124:127], v[36:39], a[192:195]
  ds_read_b64_tr_b16 v[122:123], v25 offset:51200
  v_mfma_f32_16x16x32_bf16 a[196:199], v[124:127], v[40:43], a[196:199]
  v_mfma_f32_16x16x32_bf16 a[200:203], v[124:127], v[44:47], a[200:203]
  v_mfma_f32_16x16x32_bf16 a[204:207], v[124:127], v[48:51], a[204:207]
  v_mfma_f32_16x16x32_bf16 a[208:211], v[124:127], v[52:55], a[208:211]
  v_mfma_f32_16x16x32_bf16 a[212:215], v[124:127], v[56:59], a[212:215]
  v_mfma_f32_16x16x32_bf16 a[216:219], v[124:127], v[60:63], a[216:219]
  v_mfma_f32_16x16x32_bf16 a[220:223], v[124:127], v[64:67], a[220:223]
  ds_read_b64_tr_b16 v[124:125], v26 offset:49152
s_waitcnt lgkmcnt(15)
  v_mfma_f32_16x16x32_bf16 a[224:227], v[128:131], v[36:39], a[224:227]
  ds_read_b64_tr_b16 v[126:127], v26 offset:51200
  v_mfma_f32_16x16x32_bf16 a[228:231], v[128:131], v[40:43], a[228:231]
  v_mfma_f32_16x16x32_bf16 a[232:235], v[128:131], v[44:47], a[232:235]
  v_mfma_f32_16x16x32_bf16 a[236:239], v[128:131], v[48:51], a[236:239]
  v_mfma_f32_16x16x32_bf16 a[240:243], v[128:131], v[52:55], a[240:243]
  v_mfma_f32_16x16x32_bf16 a[244:247], v[128:131], v[56:59], a[244:247]
  v_mfma_f32_16x16x32_bf16 a[248:251], v[128:131], v[60:63], a[248:251]
  v_mfma_f32_16x16x32_bf16 a[252:255], v[128:131], v[64:67], a[252:255]
  ds_read_b64_tr_b16 v[128:129], v27 offset:49152
  ds_read_b64_tr_b16 v[130:131], v27 offset:51200
  s_waitcnt lgkmcnt(2)
  v_mfma_f32_16x16x32_bf16 a[0:3], v[100:103], v[68:71], a[0:3]
  v_mfma_f32_16x16x32_bf16 a[4:7], v[100:103], v[72:75], a[4:7]
  v_mfma_f32_16x16x32_bf16 a[8:11], v[100:103], v[76:79], a[8:11]
  v_mfma_f32_16x16x32_bf16 a[12:15], v[100:103], v[80:83], a[12:15]
  v_mfma_f32_16x16x32_bf16 a[16:19], v[100:103], v[84:87], a[16:19]
  v_mfma_f32_16x16x32_bf16 a[20:23], v[100:103], v[88:91], a[20:23]
  v_mfma_f32_16x16x32_bf16 a[24:27], v[100:103], v[92:95], a[24:27]
  v_mfma_f32_16x16x32_bf16 a[28:31], v[100:103], v[96:99], a[28:31]
  v_mfma_f32_16x16x32_bf16 a[32:35], v[104:107], v[68:71], a[32:35]
  v_mfma_f32_16x16x32_bf16 a[36:39], v[104:107], v[72:75], a[36:39]
  v_mfma_f32_16x16x32_bf16 a[40:43], v[104:107], v[76:79], a[40:43]
  v_mfma_f32_16x16x32_bf16 a[44:47], v[104:107], v[80:83], a[44:47]
  v_mfma_f32_16x16x32_bf16 a[48:51], v[104:107], v[84:87], a[48:51]
  v_mfma_f32_16x16x32_bf16 a[52:55], v[104:107], v[88:91], a[52:55]
  v_mfma_f32_16x16x32_bf16 a[56:59], v[104:107], v[92:95], a[56:59]
  v_mfma_f32_16x16x32_bf16 a[60:63], v[104:107], v[96:99], a[60:63]
  v_mfma_f32_16x16x32_bf16 a[64:67], v[108:111], v[68:71], a[64:67]
  v_mfma_f32_16x16x32_bf16 a[68:71], v[108:111], v[72:75], a[68:71]
  v_mfma_f32_16x16x32_bf16 a[72:75], v[108:111], v[76:79], a[72:75]
  v_mfma_f32_16x16x32_bf16 a[76:79], v[108:111], v[80:83], a[76:79]
  v_mfma_f32_16x16x32_bf16 a[80:83], v[108:111], v[84:87], a[80:83]
  v_mfma_f32_16x16x32_bf16 a[84:87], v[108:111], v[88:91], a[84:87]
  v_mfma_f32_16x16x32_bf16 a[88:91], v[108:111], v[92:95], a[88:91]
  v_mfma_f32_16x16x32_bf16 a[92:95], v[108:111], v[96:99], a[92:95]
  v_mfma_f32_16x16x32_bf16 a[96:99], v[112:115], v[68:71], a[96:99]
  v_mfma_f32_16x16x32_bf16 a[100:103], v[112:115], v[72:75], a[100:103]
  v_mfma_f32_16x16x32_bf16 a[104:107], v[112:115], v[76:79], a[104:107]
  v_mfma_f32_16x16x32_bf16 a[108:111], v[112:115], v[80:83], a[108:111]
  v_mfma_f32_16x16x32_bf16 a[112:115], v[112:115], v[84:87], a[112:115]
  v_mfma_f32_16x16x32_bf16 a[116:119], v[112:115], v[88:91], a[116:119]
  v_mfma_f32_16x16x32_bf16 a[120:123], v[112:115], v[92:95], a[120:123]
  v_mfma_f32_16x16x32_bf16 a[124:127], v[112:115], v[96:99], a[124:127]
  v_mfma_f32_16x16x32_bf16 a[128:131], v[116:119], v[68:71], a[128:131]
  v_mfma_f32_16x16x32_bf16 a[132:135], v[116:119], v[72:75], a[132:135]
  v_mfma_f32_16x16x32_bf16 a[136:139], v[116:119], v[76:79], a[136:139]
  v_mfma_f32_16x16x32_bf16 a[140:143], v[116:119], v[80:83], a[140:143]
  v_mfma_f32_16x16x32_bf16 a[144:147], v[116:119], v[84:87], a[144:147]
  v_mfma_f32_16x16x32_bf16 a[148:151], v[116:119], v[88:91], a[148:151]
  v_mfma_f32_16x16x32_bf16 a[152:155], v[116:119], v[92:95], a[152:155]
  v_mfma_f32_16x16x32_bf16 a[156:159], v[116:119], v[96:99], a[156:159]
  v_mfma_f32_16x16x32_bf16 a[160:163], v[120:123], v[68:71], a[160:163]
  v_mfma_f32_16x16x32_bf16 a[164:167], v[120:123], v[72:75], a[164:167]
  v_mfma_f32_16x16x32_bf16 a[168:171], v[120:123], v[76:79], a[168:171]
  v_mfma_f32_16x16x32_bf16 a[172:175], v[120:123], v[80:83], a[172:175]
  v_mfma_f32_16x16x32_bf16 a[176:179], v[120:123], v[84:87], a[176:179]
  v_mfma_f32_16x16x32_bf16 a[180:183], v[120:123], v[88:91], a[180:183]
  v_mfma_f32_16x16x32_bf16 a[184:187], v[120:123], v[92:95], a[184:187]
  v_mfma_f32_16x16x32_bf16 a[188:191], v[120:123], v[96:99], a[188:191]
  v_mfma_f32_16x16x32_bf16 a[192:195], v[124:127], v[68:71], a[192:195]
  v_mfma_f32_16x16x32_bf16 a[196:199], v[124:127], v[72:75], a[196:199]
  v_mfma_f32_16x16x32_bf16 a[200:203], v[124:127], v[76:79], a[200:203]
  v_mfma_f32_16x16x32_bf16 a[204:207], v[124:127], v[80:83], a[204:207]
  v_mfma_f32_16x16x32_bf16 a[208:211], v[124:127], v[84:87], a[208:211]
  v_mfma_f32_16x16x32_bf16 a[212:215], v[124:127], v[88:91], a[212:215]
  v_mfma_f32_16x16x32_bf16 a[216:219], v[124:127], v[92:95], a[216:219]
  v_mfma_f32_16x16x32_bf16 a[220:223], v[124:127], v[96:99], a[220:223]
s_waitcnt lgkmcnt(0)
  v_mfma_f32_16x16x32_bf16 a[224:227], v[128:131], v[68:71], a[224:227]
  v_mfma_f32_16x16x32_bf16 a[228:231], v[128:131], v[72:75], a[228:231]
  v_mfma_f32_16x16x32_bf16 a[232:235], v[128:131], v[76:79], a[232:235]
  v_mfma_f32_16x16x32_bf16 a[236:239], v[128:131], v[80:83], a[236:239]
  v_mfma_f32_16x16x32_bf16 a[240:243], v[128:131], v[84:87], a[240:243]
  v_mfma_f32_16x16x32_bf16 a[244:247], v[128:131], v[88:91], a[244:247]
  v_mfma_f32_16x16x32_bf16 a[248:251], v[128:131], v[92:95], a[248:251]
  v_mfma_f32_16x16x32_bf16 a[252:255], v[128:131], v[96:99], a[252:255]
  v_accvgpr_read_b32 v136, a0
  v_accvgpr_read_b32 v137, a1
  v_accvgpr_read_b32 v138, a2
  v_accvgpr_read_b32 v139, a3
  v_accvgpr_read_b32 v140, a32
  v_accvgpr_read_b32 v141, a33
  v_accvgpr_read_b32 v142, a34
  v_accvgpr_read_b32 v143, a35
  v_mul_f32 v136, s31, v136
  v_mul_f32 v137, s31, v137
  v_mul_f32 v138, s31, v138
  v_mul_f32 v139, s31, v139
  v_mul_f32 v140, s31, v140
  v_mul_f32 v141, s31, v141
  v_mul_f32 v142, s31, v142
  v_mul_f32 v143, s31, v143
  v_cvt_pk_bf16_f32 v132, v136, v137
  v_cvt_pk_bf16_f32 v133, v138, v139
  v_cvt_pk_bf16_f32 v134, v140, v141
  v_cvt_pk_bf16_f32 v135, v142, v143
  s_add_u32 s25, s24, 0
  buffer_store_dwordx4 v[132:135], v28, s[16:19], s25 offen offset:0 sc1
  v_accvgpr_read_b32 v148, a64
  v_accvgpr_read_b32 v149, a65
  v_accvgpr_read_b32 v150, a66
  v_accvgpr_read_b32 v151, a67
  v_accvgpr_read_b32 v152, a96
  v_accvgpr_read_b32 v153, a97
  v_accvgpr_read_b32 v154, a98
  v_accvgpr_read_b32 v155, a99
  v_mul_f32 v148, s31, v148
  v_mul_f32 v149, s31, v149
  v_mul_f32 v150, s31, v150
  v_mul_f32 v151, s31, v151
  v_mul_f32 v152, s31, v152
  v_mul_f32 v153, s31, v153
  v_mul_f32 v154, s31, v154
  v_mul_f32 v155, s31, v155
  v_cvt_pk_bf16_f32 v144, v148, v149
  v_cvt_pk_bf16_f32 v145, v150, v151
  v_cvt_pk_bf16_f32 v146, v152, v153
  v_cvt_pk_bf16_f32 v147, v154, v155
  s_add_u32 s25, s24, 0
  buffer_store_dwordx4 v[144:147], v28, s[16:19], s25 offen offset:2048 sc1
  v_accvgpr_read_b32 v136, a128
  v_accvgpr_read_b32 v137, a129
  v_accvgpr_read_b32 v138, a130
  v_accvgpr_read_b32 v139, a131
  v_accvgpr_read_b32 v140, a160
  v_accvgpr_read_b32 v141, a161
  v_accvgpr_read_b32 v142, a162
  v_accvgpr_read_b32 v143, a163
  v_mul_f32 v136, s31, v136
  v_mul_f32 v137, s31, v137
  v_mul_f32 v138, s31, v138
  v_mul_f32 v139, s31, v139
  v_mul_f32 v140, s31, v140
  v_mul_f32 v141, s31, v141
  v_mul_f32 v142, s31, v142
  v_mul_f32 v143, s31, v143
  v_cvt_pk_bf16_f32 v132, v136, v137
  v_cvt_pk_bf16_f32 v133, v138, v139
  v_cvt_pk_bf16_f32 v134, v140, v141
  v_cvt_pk_bf16_f32 v135, v142, v143
  s_add_u32 s25, s24, 4096
  buffer_store_dwordx4 v[132:135], v28, s[16:19], s25 offen offset:0 sc1
  v_accvgpr_read_b32 v148, a192
  v_accvgpr_read_b32 v149, a193
  v_accvgpr_read_b32 v150, a194
  v_accvgpr_read_b32 v151, a195
  v_accvgpr_read_b32 v152, a224
  v_accvgpr_read_b32 v153, a225
  v_accvgpr_read_b32 v154, a226
  v_accvgpr_read_b32 v155, a227
  v_mul_f32 v148, s31, v148
  v_mul_f32 v149, s31, v149
  v_mul_f32 v150, s31, v150
  v_mul_f32 v151, s31, v151
  v_mul_f32 v152, s31, v152
  v_mul_f32 v153, s31, v153
  v_mul_f32 v154, s31, v154
  v_mul_f32 v155, s31, v155
  v_cvt_pk_bf16_f32 v144, v148, v149
  v_cvt_pk_bf16_f32 v145, v150, v151
  v_cvt_pk_bf16_f32 v146, v152, v153
  v_cvt_pk_bf16_f32 v147, v154, v155
  s_add_u32 s25, s24, 4096
  buffer_store_dwordx4 v[144:147], v28, s[16:19], s25 offen offset:2048 sc1
  v_accvgpr_read_b32 v136, a4
  v_accvgpr_read_b32 v137, a5
  v_accvgpr_read_b32 v138, a6
  v_accvgpr_read_b32 v139, a7
  v_accvgpr_read_b32 v140, a36
  v_accvgpr_read_b32 v141, a37
  v_accvgpr_read_b32 v142, a38
  v_accvgpr_read_b32 v143, a39
  v_mul_f32 v136, s31, v136
  v_mul_f32 v137, s31, v137
  v_mul_f32 v138, s31, v138
  v_mul_f32 v139, s31, v139
  v_mul_f32 v140, s31, v140
  v_mul_f32 v141, s31, v141
  v_mul_f32 v142, s31, v142
  v_mul_f32 v143, s31, v143
  v_cvt_pk_bf16_f32 v132, v136, v137
  v_cvt_pk_bf16_f32 v133, v138, v139
  v_cvt_pk_bf16_f32 v134, v140, v141
  v_cvt_pk_bf16_f32 v135, v142, v143
  s_add_u32 s25, s24, 0
  buffer_store_dwordx4 v[132:135], v28, s[16:19], s25 offen offset:128 sc1
  v_accvgpr_read_b32 v148, a68
  v_accvgpr_read_b32 v149, a69
  v_accvgpr_read_b32 v150, a70
  v_accvgpr_read_b32 v151, a71
  v_accvgpr_read_b32 v152, a100
  v_accvgpr_read_b32 v153, a101
  v_accvgpr_read_b32 v154, a102
  v_accvgpr_read_b32 v155, a103
  v_mul_f32 v148, s31, v148
  v_mul_f32 v149, s31, v149
  v_mul_f32 v150, s31, v150
  v_mul_f32 v151, s31, v151
  v_mul_f32 v152, s31, v152
  v_mul_f32 v153, s31, v153
  v_mul_f32 v154, s31, v154
  v_mul_f32 v155, s31, v155
  v_cvt_pk_bf16_f32 v144, v148, v149
  v_cvt_pk_bf16_f32 v145, v150, v151
  v_cvt_pk_bf16_f32 v146, v152, v153
  v_cvt_pk_bf16_f32 v147, v154, v155
  s_add_u32 s25, s24, 0
  buffer_store_dwordx4 v[144:147], v28, s[16:19], s25 offen offset:2176 sc1
  v_accvgpr_read_b32 v136, a132
  v_accvgpr_read_b32 v137, a133
  v_accvgpr_read_b32 v138, a134
  v_accvgpr_read_b32 v139, a135
  v_accvgpr_read_b32 v140, a164
  v_accvgpr_read_b32 v141, a165
  v_accvgpr_read_b32 v142, a166
  v_accvgpr_read_b32 v143, a167
  v_mul_f32 v136, s31, v136
  v_mul_f32 v137, s31, v137
  v_mul_f32 v138, s31, v138
  v_mul_f32 v139, s31, v139
  v_mul_f32 v140, s31, v140
  v_mul_f32 v141, s31, v141
  v_mul_f32 v142, s31, v142
  v_mul_f32 v143, s31, v143
  v_cvt_pk_bf16_f32 v132, v136, v137
  v_cvt_pk_bf16_f32 v133, v138, v139
  v_cvt_pk_bf16_f32 v134, v140, v141
  v_cvt_pk_bf16_f32 v135, v142, v143
  s_add_u32 s25, s24, 4096
  buffer_store_dwordx4 v[132:135], v28, s[16:19], s25 offen offset:128 sc1
  v_accvgpr_read_b32 v148, a196
  v_accvgpr_read_b32 v149, a197
  v_accvgpr_read_b32 v150, a198
  v_accvgpr_read_b32 v151, a199
  v_accvgpr_read_b32 v152, a228
  v_accvgpr_read_b32 v153, a229
  v_accvgpr_read_b32 v154, a230
  v_accvgpr_read_b32 v155, a231
  v_mul_f32 v148, s31, v148
  v_mul_f32 v149, s31, v149
  v_mul_f32 v150, s31, v150
  v_mul_f32 v151, s31, v151
  v_mul_f32 v152, s31, v152
  v_mul_f32 v153, s31, v153
  v_mul_f32 v154, s31, v154
  v_mul_f32 v155, s31, v155
  v_cvt_pk_bf16_f32 v144, v148, v149
  v_cvt_pk_bf16_f32 v145, v150, v151
  v_cvt_pk_bf16_f32 v146, v152, v153
  v_cvt_pk_bf16_f32 v147, v154, v155
  s_add_u32 s25, s24, 4096
  buffer_store_dwordx4 v[144:147], v28, s[16:19], s25 offen offset:2176 sc1
  v_accvgpr_read_b32 v136, a8
  v_accvgpr_read_b32 v137, a9
  v_accvgpr_read_b32 v138, a10
  v_accvgpr_read_b32 v139, a11
  v_accvgpr_read_b32 v140, a40
  v_accvgpr_read_b32 v141, a41
  v_accvgpr_read_b32 v142, a42
  v_accvgpr_read_b32 v143, a43
  v_mul_f32 v136, s31, v136
  v_mul_f32 v137, s31, v137
  v_mul_f32 v138, s31, v138
  v_mul_f32 v139, s31, v139
  v_mul_f32 v140, s31, v140
  v_mul_f32 v141, s31, v141
  v_mul_f32 v142, s31, v142
  v_mul_f32 v143, s31, v143
  v_cvt_pk_bf16_f32 v132, v136, v137
  v_cvt_pk_bf16_f32 v133, v138, v139
  v_cvt_pk_bf16_f32 v134, v140, v141
  v_cvt_pk_bf16_f32 v135, v142, v143
  s_add_u32 s25, s24, 8192
  buffer_store_dwordx4 v[132:135], v28, s[16:19], s25 offen offset:0 sc1
  v_accvgpr_read_b32 v148, a72
  v_accvgpr_read_b32 v149, a73
  v_accvgpr_read_b32 v150, a74
  v_accvgpr_read_b32 v151, a75
  v_accvgpr_read_b32 v152, a104
  v_accvgpr_read_b32 v153, a105
  v_accvgpr_read_b32 v154, a106
  v_accvgpr_read_b32 v155, a107
  v_mul_f32 v148, s31, v148
  v_mul_f32 v149, s31, v149
  v_mul_f32 v150, s31, v150
  v_mul_f32 v151, s31, v151
  v_mul_f32 v152, s31, v152
  v_mul_f32 v153, s31, v153
  v_mul_f32 v154, s31, v154
  v_mul_f32 v155, s31, v155
  v_cvt_pk_bf16_f32 v144, v148, v149
  v_cvt_pk_bf16_f32 v145, v150, v151
  v_cvt_pk_bf16_f32 v146, v152, v153
  v_cvt_pk_bf16_f32 v147, v154, v155
  s_add_u32 s25, s24, 8192
  buffer_store_dwordx4 v[144:147], v28, s[16:19], s25 offen offset:2048 sc1
  v_accvgpr_read_b32 v136, a136
  v_accvgpr_read_b32 v137, a137
  v_accvgpr_read_b32 v138, a138
  v_accvgpr_read_b32 v139, a139
  v_accvgpr_read_b32 v140, a168
  v_accvgpr_read_b32 v141, a169
  v_accvgpr_read_b32 v142, a170
  v_accvgpr_read_b32 v143, a171
  v_mul_f32 v136, s31, v136
  v_mul_f32 v137, s31, v137
  v_mul_f32 v138, s31, v138
  v_mul_f32 v139, s31, v139
  v_mul_f32 v140, s31, v140
  v_mul_f32 v141, s31, v141
  v_mul_f32 v142, s31, v142
  v_mul_f32 v143, s31, v143
  v_cvt_pk_bf16_f32 v132, v136, v137
  v_cvt_pk_bf16_f32 v133, v138, v139
  v_cvt_pk_bf16_f32 v134, v140, v141
  v_cvt_pk_bf16_f32 v135, v142, v143
  s_add_u32 s25, s24, 12288
  buffer_store_dwordx4 v[132:135], v28, s[16:19], s25 offen offset:0 sc1
  v_accvgpr_read_b32 v148, a200
  v_accvgpr_read_b32 v149, a201
  v_accvgpr_read_b32 v150, a202
  v_accvgpr_read_b32 v151, a203
  v_accvgpr_read_b32 v152, a232
  v_accvgpr_read_b32 v153, a233
  v_accvgpr_read_b32 v154, a234
  v_accvgpr_read_b32 v155, a235
  v_mul_f32 v148, s31, v148
  v_mul_f32 v149, s31, v149
  v_mul_f32 v150, s31, v150
  v_mul_f32 v151, s31, v151
  v_mul_f32 v152, s31, v152
  v_mul_f32 v153, s31, v153
  v_mul_f32 v154, s31, v154
  v_mul_f32 v155, s31, v155
  v_cvt_pk_bf16_f32 v144, v148, v149
  v_cvt_pk_bf16_f32 v145, v150, v151
  v_cvt_pk_bf16_f32 v146, v152, v153
  v_cvt_pk_bf16_f32 v147, v154, v155
  s_add_u32 s25, s24, 12288
  buffer_store_dwordx4 v[144:147], v28, s[16:19], s25 offen offset:2048 sc1
  v_accvgpr_read_b32 v136, a12
  v_accvgpr_read_b32 v137, a13
  v_accvgpr_read_b32 v138, a14
  v_accvgpr_read_b32 v139, a15
  v_accvgpr_read_b32 v140, a44
  v_accvgpr_read_b32 v141, a45
  v_accvgpr_read_b32 v142, a46
  v_accvgpr_read_b32 v143, a47
  v_mul_f32 v136, s31, v136
  v_mul_f32 v137, s31, v137
  v_mul_f32 v138, s31, v138
  v_mul_f32 v139, s31, v139
  v_mul_f32 v140, s31, v140
  v_mul_f32 v141, s31, v141
  v_mul_f32 v142, s31, v142
  v_mul_f32 v143, s31, v143
  v_cvt_pk_bf16_f32 v132, v136, v137
  v_cvt_pk_bf16_f32 v133, v138, v139
  v_cvt_pk_bf16_f32 v134, v140, v141
  v_cvt_pk_bf16_f32 v135, v142, v143
  s_add_u32 s25, s24, 8192
  buffer_store_dwordx4 v[132:135], v28, s[16:19], s25 offen offset:128 sc1
  v_accvgpr_read_b32 v148, a76
  v_accvgpr_read_b32 v149, a77
  v_accvgpr_read_b32 v150, a78
  v_accvgpr_read_b32 v151, a79
  v_accvgpr_read_b32 v152, a108
  v_accvgpr_read_b32 v153, a109
  v_accvgpr_read_b32 v154, a110
  v_accvgpr_read_b32 v155, a111
  v_mul_f32 v148, s31, v148
  v_mul_f32 v149, s31, v149
  v_mul_f32 v150, s31, v150
  v_mul_f32 v151, s31, v151
  v_mul_f32 v152, s31, v152
  v_mul_f32 v153, s31, v153
  v_mul_f32 v154, s31, v154
  v_mul_f32 v155, s31, v155
  v_cvt_pk_bf16_f32 v144, v148, v149
  v_cvt_pk_bf16_f32 v145, v150, v151
  v_cvt_pk_bf16_f32 v146, v152, v153
  v_cvt_pk_bf16_f32 v147, v154, v155
  s_add_u32 s25, s24, 8192
  buffer_store_dwordx4 v[144:147], v28, s[16:19], s25 offen offset:2176 sc1
  v_accvgpr_read_b32 v136, a140
  v_accvgpr_read_b32 v137, a141
  v_accvgpr_read_b32 v138, a142
  v_accvgpr_read_b32 v139, a143
  v_accvgpr_read_b32 v140, a172
  v_accvgpr_read_b32 v141, a173
  v_accvgpr_read_b32 v142, a174
  v_accvgpr_read_b32 v143, a175
  v_mul_f32 v136, s31, v136
  v_mul_f32 v137, s31, v137
  v_mul_f32 v138, s31, v138
  v_mul_f32 v139, s31, v139
  v_mul_f32 v140, s31, v140
  v_mul_f32 v141, s31, v141
  v_mul_f32 v142, s31, v142
  v_mul_f32 v143, s31, v143
  v_cvt_pk_bf16_f32 v132, v136, v137
  v_cvt_pk_bf16_f32 v133, v138, v139
  v_cvt_pk_bf16_f32 v134, v140, v141
  v_cvt_pk_bf16_f32 v135, v142, v143
  s_add_u32 s25, s24, 12288
  buffer_store_dwordx4 v[132:135], v28, s[16:19], s25 offen offset:128 sc1
  v_accvgpr_read_b32 v148, a204
  v_accvgpr_read_b32 v149, a205
  v_accvgpr_read_b32 v150, a206
  v_accvgpr_read_b32 v151, a207
  v_accvgpr_read_b32 v152, a236
  v_accvgpr_read_b32 v153, a237
  v_accvgpr_read_b32 v154, a238
  v_accvgpr_read_b32 v155, a239
  v_mul_f32 v148, s31, v148
  v_mul_f32 v149, s31, v149
  v_mul_f32 v150, s31, v150
  v_mul_f32 v151, s31, v151
  v_mul_f32 v152, s31, v152
  v_mul_f32 v153, s31, v153
  v_mul_f32 v154, s31, v154
  v_mul_f32 v155, s31, v155
  v_cvt_pk_bf16_f32 v144, v148, v149
  v_cvt_pk_bf16_f32 v145, v150, v151
  v_cvt_pk_bf16_f32 v146, v152, v153
  v_cvt_pk_bf16_f32 v147, v154, v155
  s_add_u32 s25, s24, 12288
  buffer_store_dwordx4 v[144:147], v28, s[16:19], s25 offen offset:2176 sc1
  v_accvgpr_read_b32 v136, a16
  v_accvgpr_read_b32 v137, a17
  v_accvgpr_read_b32 v138, a18
  v_accvgpr_read_b32 v139, a19
  v_accvgpr_read_b32 v140, a48
  v_accvgpr_read_b32 v141, a49
  v_accvgpr_read_b32 v142, a50
  v_accvgpr_read_b32 v143, a51
  v_mul_f32 v136, s31, v136
  v_mul_f32 v137, s31, v137
  v_mul_f32 v138, s31, v138
  v_mul_f32 v139, s31, v139
  v_mul_f32 v140, s31, v140
  v_mul_f32 v141, s31, v141
  v_mul_f32 v142, s31, v142
  v_mul_f32 v143, s31, v143
  v_cvt_pk_bf16_f32 v132, v136, v137
  v_cvt_pk_bf16_f32 v133, v138, v139
  v_cvt_pk_bf16_f32 v134, v140, v141
  v_cvt_pk_bf16_f32 v135, v142, v143
  s_add_u32 s25, s24, 16384
  buffer_store_dwordx4 v[132:135], v28, s[16:19], s25 offen offset:0 sc1
  v_accvgpr_read_b32 v148, a80
  v_accvgpr_read_b32 v149, a81
  v_accvgpr_read_b32 v150, a82
  v_accvgpr_read_b32 v151, a83
  v_accvgpr_read_b32 v152, a112
  v_accvgpr_read_b32 v153, a113
  v_accvgpr_read_b32 v154, a114
  v_accvgpr_read_b32 v155, a115
  v_mul_f32 v148, s31, v148
  v_mul_f32 v149, s31, v149
  v_mul_f32 v150, s31, v150
  v_mul_f32 v151, s31, v151
  v_mul_f32 v152, s31, v152
  v_mul_f32 v153, s31, v153
  v_mul_f32 v154, s31, v154
  v_mul_f32 v155, s31, v155
  v_cvt_pk_bf16_f32 v144, v148, v149
  v_cvt_pk_bf16_f32 v145, v150, v151
  v_cvt_pk_bf16_f32 v146, v152, v153
  v_cvt_pk_bf16_f32 v147, v154, v155
  s_add_u32 s25, s24, 16384
  buffer_store_dwordx4 v[144:147], v28, s[16:19], s25 offen offset:2048 sc1
  v_accvgpr_read_b32 v136, a144
  v_accvgpr_read_b32 v137, a145
  v_accvgpr_read_b32 v138, a146
  v_accvgpr_read_b32 v139, a147
  v_accvgpr_read_b32 v140, a176
  v_accvgpr_read_b32 v141, a177
  v_accvgpr_read_b32 v142, a178
  v_accvgpr_read_b32 v143, a179
  v_mul_f32 v136, s31, v136
  v_mul_f32 v137, s31, v137
  v_mul_f32 v138, s31, v138
  v_mul_f32 v139, s31, v139
  v_mul_f32 v140, s31, v140
  v_mul_f32 v141, s31, v141
  v_mul_f32 v142, s31, v142
  v_mul_f32 v143, s31, v143
  v_cvt_pk_bf16_f32 v132, v136, v137
  v_cvt_pk_bf16_f32 v133, v138, v139
  v_cvt_pk_bf16_f32 v134, v140, v141
  v_cvt_pk_bf16_f32 v135, v142, v143
  s_add_u32 s25, s24, 20480
  buffer_store_dwordx4 v[132:135], v28, s[16:19], s25 offen offset:0 sc1
  v_accvgpr_read_b32 v148, a208
  v_accvgpr_read_b32 v149, a209
  v_accvgpr_read_b32 v150, a210
  v_accvgpr_read_b32 v151, a211
  v_accvgpr_read_b32 v152, a240
  v_accvgpr_read_b32 v153, a241
  v_accvgpr_read_b32 v154, a242
  v_accvgpr_read_b32 v155, a243
  v_mul_f32 v148, s31, v148
  v_mul_f32 v149, s31, v149
  v_mul_f32 v150, s31, v150
  v_mul_f32 v151, s31, v151
  v_mul_f32 v152, s31, v152
  v_mul_f32 v153, s31, v153
  v_mul_f32 v154, s31, v154
  v_mul_f32 v155, s31, v155
  v_cvt_pk_bf16_f32 v144, v148, v149
  v_cvt_pk_bf16_f32 v145, v150, v151
  v_cvt_pk_bf16_f32 v146, v152, v153
  v_cvt_pk_bf16_f32 v147, v154, v155
  s_add_u32 s25, s24, 20480
  buffer_store_dwordx4 v[144:147], v28, s[16:19], s25 offen offset:2048 sc1
  v_accvgpr_read_b32 v136, a20
  v_accvgpr_read_b32 v137, a21
  v_accvgpr_read_b32 v138, a22
  v_accvgpr_read_b32 v139, a23
  v_accvgpr_read_b32 v140, a52
  v_accvgpr_read_b32 v141, a53
  v_accvgpr_read_b32 v142, a54
  v_accvgpr_read_b32 v143, a55
  v_mul_f32 v136, s31, v136
  v_mul_f32 v137, s31, v137
  v_mul_f32 v138, s31, v138
  v_mul_f32 v139, s31, v139
  v_mul_f32 v140, s31, v140
  v_mul_f32 v141, s31, v141
  v_mul_f32 v142, s31, v142
  v_mul_f32 v143, s31, v143
  v_cvt_pk_bf16_f32 v132, v136, v137
  v_cvt_pk_bf16_f32 v133, v138, v139
  v_cvt_pk_bf16_f32 v134, v140, v141
  v_cvt_pk_bf16_f32 v135, v142, v143
  s_add_u32 s25, s24, 16384
  buffer_store_dwordx4 v[132:135], v28, s[16:19], s25 offen offset:128 sc1
  v_accvgpr_read_b32 v148, a84
  v_accvgpr_read_b32 v149, a85
  v_accvgpr_read_b32 v150, a86
  v_accvgpr_read_b32 v151, a87
  v_accvgpr_read_b32 v152, a116
  v_accvgpr_read_b32 v153, a117
  v_accvgpr_read_b32 v154, a118
  v_accvgpr_read_b32 v155, a119
  v_mul_f32 v148, s31, v148
  v_mul_f32 v149, s31, v149
  v_mul_f32 v150, s31, v150
  v_mul_f32 v151, s31, v151
  v_mul_f32 v152, s31, v152
  v_mul_f32 v153, s31, v153
  v_mul_f32 v154, s31, v154
  v_mul_f32 v155, s31, v155
  v_cvt_pk_bf16_f32 v144, v148, v149
  v_cvt_pk_bf16_f32 v145, v150, v151
  v_cvt_pk_bf16_f32 v146, v152, v153
  v_cvt_pk_bf16_f32 v147, v154, v155
  s_add_u32 s25, s24, 16384
  buffer_store_dwordx4 v[144:147], v28, s[16:19], s25 offen offset:2176 sc1
  v_accvgpr_read_b32 v136, a148
  v_accvgpr_read_b32 v137, a149
  v_accvgpr_read_b32 v138, a150
  v_accvgpr_read_b32 v139, a151
  v_accvgpr_read_b32 v140, a180
  v_accvgpr_read_b32 v141, a181
  v_accvgpr_read_b32 v142, a182
  v_accvgpr_read_b32 v143, a183
  v_mul_f32 v136, s31, v136
  v_mul_f32 v137, s31, v137
  v_mul_f32 v138, s31, v138
  v_mul_f32 v139, s31, v139
  v_mul_f32 v140, s31, v140
  v_mul_f32 v141, s31, v141
  v_mul_f32 v142, s31, v142
  v_mul_f32 v143, s31, v143
  v_cvt_pk_bf16_f32 v132, v136, v137
  v_cvt_pk_bf16_f32 v133, v138, v139
  v_cvt_pk_bf16_f32 v134, v140, v141
  v_cvt_pk_bf16_f32 v135, v142, v143
  s_add_u32 s25, s24, 20480
  buffer_store_dwordx4 v[132:135], v28, s[16:19], s25 offen offset:128 sc1
  v_accvgpr_read_b32 v148, a212
  v_accvgpr_read_b32 v149, a213
  v_accvgpr_read_b32 v150, a214
  v_accvgpr_read_b32 v151, a215
  v_accvgpr_read_b32 v152, a244
  v_accvgpr_read_b32 v153, a245
  v_accvgpr_read_b32 v154, a246
  v_accvgpr_read_b32 v155, a247
  v_mul_f32 v148, s31, v148
  v_mul_f32 v149, s31, v149
  v_mul_f32 v150, s31, v150
  v_mul_f32 v151, s31, v151
  v_mul_f32 v152, s31, v152
  v_mul_f32 v153, s31, v153
  v_mul_f32 v154, s31, v154
  v_mul_f32 v155, s31, v155
  v_cvt_pk_bf16_f32 v144, v148, v149
  v_cvt_pk_bf16_f32 v145, v150, v151
  v_cvt_pk_bf16_f32 v146, v152, v153
  v_cvt_pk_bf16_f32 v147, v154, v155
  s_add_u32 s25, s24, 20480
  buffer_store_dwordx4 v[144:147], v28, s[16:19], s25 offen offset:2176 sc1
  v_accvgpr_read_b32 v136, a24
  v_accvgpr_read_b32 v137, a25
  v_accvgpr_read_b32 v138, a26
  v_accvgpr_read_b32 v139, a27
  v_accvgpr_read_b32 v140, a56
  v_accvgpr_read_b32 v141, a57
  v_accvgpr_read_b32 v142, a58
  v_accvgpr_read_b32 v143, a59
  v_mul_f32 v136, s31, v136
  v_mul_f32 v137, s31, v137
  v_mul_f32 v138, s31, v138
  v_mul_f32 v139, s31, v139
  v_mul_f32 v140, s31, v140
  v_mul_f32 v141, s31, v141
  v_mul_f32 v142, s31, v142
  v_mul_f32 v143, s31, v143
  v_cvt_pk_bf16_f32 v132, v136, v137
  v_cvt_pk_bf16_f32 v133, v138, v139
  v_cvt_pk_bf16_f32 v134, v140, v141
  v_cvt_pk_bf16_f32 v135, v142, v143
  s_add_u32 s25, s24, 24576
  buffer_store_dwordx4 v[132:135], v28, s[16:19], s25 offen offset:0 sc1
  v_accvgpr_read_b32 v148, a88
  v_accvgpr_read_b32 v149, a89
  v_accvgpr_read_b32 v150, a90
  v_accvgpr_read_b32 v151, a91
  v_accvgpr_read_b32 v152, a120
  v_accvgpr_read_b32 v153, a121
  v_accvgpr_read_b32 v154, a122
  v_accvgpr_read_b32 v155, a123
  v_mul_f32 v148, s31, v148
  v_mul_f32 v149, s31, v149
  v_mul_f32 v150, s31, v150
  v_mul_f32 v151, s31, v151
  v_mul_f32 v152, s31, v152
  v_mul_f32 v153, s31, v153
  v_mul_f32 v154, s31, v154
  v_mul_f32 v155, s31, v155
  v_cvt_pk_bf16_f32 v144, v148, v149
  v_cvt_pk_bf16_f32 v145, v150, v151
  v_cvt_pk_bf16_f32 v146, v152, v153
  v_cvt_pk_bf16_f32 v147, v154, v155
  s_add_u32 s25, s24, 24576
  buffer_store_dwordx4 v[144:147], v28, s[16:19], s25 offen offset:2048 sc1
  v_accvgpr_read_b32 v136, a152
  v_accvgpr_read_b32 v137, a153
  v_accvgpr_read_b32 v138, a154
  v_accvgpr_read_b32 v139, a155
  v_accvgpr_read_b32 v140, a184
  v_accvgpr_read_b32 v141, a185
  v_accvgpr_read_b32 v142, a186
  v_accvgpr_read_b32 v143, a187
  v_mul_f32 v136, s31, v136
  v_mul_f32 v137, s31, v137
  v_mul_f32 v138, s31, v138
  v_mul_f32 v139, s31, v139
  v_mul_f32 v140, s31, v140
  v_mul_f32 v141, s31, v141
  v_mul_f32 v142, s31, v142
  v_mul_f32 v143, s31, v143
  v_cvt_pk_bf16_f32 v132, v136, v137
  v_cvt_pk_bf16_f32 v133, v138, v139
  v_cvt_pk_bf16_f32 v134, v140, v141
  v_cvt_pk_bf16_f32 v135, v142, v143
  s_add_u32 s25, s24, 28672
  buffer_store_dwordx4 v[132:135], v28, s[16:19], s25 offen offset:0 sc1
  v_accvgpr_read_b32 v148, a216
  v_accvgpr_read_b32 v149, a217
  v_accvgpr_read_b32 v150, a218
  v_accvgpr_read_b32 v151, a219
  v_accvgpr_read_b32 v152, a248
  v_accvgpr_read_b32 v153, a249
  v_accvgpr_read_b32 v154, a250
  v_accvgpr_read_b32 v155, a251
  v_mul_f32 v148, s31, v148
  v_mul_f32 v149, s31, v149
  v_mul_f32 v150, s31, v150
  v_mul_f32 v151, s31, v151
  v_mul_f32 v152, s31, v152
  v_mul_f32 v153, s31, v153
  v_mul_f32 v154, s31, v154
  v_mul_f32 v155, s31, v155
  v_cvt_pk_bf16_f32 v144, v148, v149
  v_cvt_pk_bf16_f32 v145, v150, v151
  v_cvt_pk_bf16_f32 v146, v152, v153
  v_cvt_pk_bf16_f32 v147, v154, v155
  s_add_u32 s25, s24, 28672
  buffer_store_dwordx4 v[144:147], v28, s[16:19], s25 offen offset:2048 sc1
  v_accvgpr_read_b32 v136, a28
  v_accvgpr_read_b32 v137, a29
  v_accvgpr_read_b32 v138, a30
  v_accvgpr_read_b32 v139, a31
  v_accvgpr_read_b32 v140, a60
  v_accvgpr_read_b32 v141, a61
  v_accvgpr_read_b32 v142, a62
  v_accvgpr_read_b32 v143, a63
  v_mul_f32 v136, s31, v136
  v_mul_f32 v137, s31, v137
  v_mul_f32 v138, s31, v138
  v_mul_f32 v139, s31, v139
  v_mul_f32 v140, s31, v140
  v_mul_f32 v141, s31, v141
  v_mul_f32 v142, s31, v142
  v_mul_f32 v143, s31, v143
  v_cvt_pk_bf16_f32 v132, v136, v137
  v_cvt_pk_bf16_f32 v133, v138, v139
  v_cvt_pk_bf16_f32 v134, v140, v141
  v_cvt_pk_bf16_f32 v135, v142, v143
  s_add_u32 s25, s24, 24576
  buffer_store_dwordx4 v[132:135], v28, s[16:19], s25 offen offset:128 sc1
  v_accvgpr_read_b32 v148, a92
  v_accvgpr_read_b32 v149, a93
  v_accvgpr_read_b32 v150, a94
  v_accvgpr_read_b32 v151, a95
  v_accvgpr_read_b32 v152, a124
  v_accvgpr_read_b32 v153, a125
  v_accvgpr_read_b32 v154, a126
  v_accvgpr_read_b32 v155, a127
  v_mul_f32 v148, s31, v148
  v_mul_f32 v149, s31, v149
  v_mul_f32 v150, s31, v150
  v_mul_f32 v151, s31, v151
  v_mul_f32 v152, s31, v152
  v_mul_f32 v153, s31, v153
  v_mul_f32 v154, s31, v154
  v_mul_f32 v155, s31, v155
  v_cvt_pk_bf16_f32 v144, v148, v149
  v_cvt_pk_bf16_f32 v145, v150, v151
  v_cvt_pk_bf16_f32 v146, v152, v153
  v_cvt_pk_bf16_f32 v147, v154, v155
  s_add_u32 s25, s24, 24576
  buffer_store_dwordx4 v[144:147], v28, s[16:19], s25 offen offset:2176 sc1
  v_accvgpr_read_b32 v136, a156
  v_accvgpr_read_b32 v137, a157
  v_accvgpr_read_b32 v138, a158
  v_accvgpr_read_b32 v139, a159
  v_accvgpr_read_b32 v140, a188
  v_accvgpr_read_b32 v141, a189
  v_accvgpr_read_b32 v142, a190
  v_accvgpr_read_b32 v143, a191
  v_mul_f32 v136, s31, v136
  v_mul_f32 v137, s31, v137
  v_mul_f32 v138, s31, v138
  v_mul_f32 v139, s31, v139
  v_mul_f32 v140, s31, v140
  v_mul_f32 v141, s31, v141
  v_mul_f32 v142, s31, v142
  v_mul_f32 v143, s31, v143
  v_cvt_pk_bf16_f32 v132, v136, v137
  v_cvt_pk_bf16_f32 v133, v138, v139
  v_cvt_pk_bf16_f32 v134, v140, v141
  v_cvt_pk_bf16_f32 v135, v142, v143
  s_add_u32 s25, s24, 28672
  buffer_store_dwordx4 v[132:135], v28, s[16:19], s25 offen offset:128 sc1
  v_accvgpr_read_b32 v148, a220
  v_accvgpr_read_b32 v149, a221
  v_accvgpr_read_b32 v150, a222
  v_accvgpr_read_b32 v151, a223
  v_accvgpr_read_b32 v152, a252
  v_accvgpr_read_b32 v153, a253
  v_accvgpr_read_b32 v154, a254
  v_accvgpr_read_b32 v155, a255
  v_mul_f32 v148, s31, v148
  v_mul_f32 v149, s31, v149
  v_mul_f32 v150, s31, v150
  v_mul_f32 v151, s31, v151
  v_mul_f32 v152, s31, v152
  v_mul_f32 v153, s31, v153
  v_mul_f32 v154, s31, v154
  v_mul_f32 v155, s31, v155
  v_cvt_pk_bf16_f32 v144, v148, v149
  v_cvt_pk_bf16_f32 v145, v150, v151
  v_cvt_pk_bf16_f32 v146, v152, v153
  v_cvt_pk_bf16_f32 v147, v154, v155
  s_add_u32 s25, s24, 28672
  buffer_store_dwordx4 v[144:147], v28, s[16:19], s25 offen offset:2176 sc1
  s_endpgm
L_ka_kernel_V:
  v_lshrrev_b32 v29, 5, v1
  v_lshlrev_b32 v29, 12, v29
  v_and_b32 v30, 15, v1
  v_lshl_add_u32 v29, v30, 4, v29
  v_bfe_u32 v30, v1, 4, 1
  v_lshl_add_u32 v28, v30, 9, v29
s_waitcnt lgkmcnt(14)
  v_mfma_f32_16x16x32_bf16 a[0:3], v[36:39], v[100:103], 0
  v_mfma_f32_16x16x32_bf16 a[4:7], v[40:43], v[100:103], 0
  v_mfma_f32_16x16x32_bf16 a[8:11], v[44:47], v[100:103], 0
  ds_read_b128 v[68:71], v19 offset:0
  v_mfma_f32_16x16x32_bf16 a[12:15], v[48:51], v[100:103], 0
  v_mfma_f32_16x16x32_bf16 a[16:19], v[52:55], v[100:103], 0
  v_mfma_f32_16x16x32_bf16 a[20:23], v[56:59], v[100:103], 0
  v_mfma_f32_16x16x32_bf16 a[24:27], v[60:63], v[100:103], 0
  v_mfma_f32_16x16x32_bf16 a[28:31], v[64:67], v[100:103], 0
  ds_read_b64_tr_b16 v[100:101], v20 offset:16384
s_waitcnt lgkmcnt(14)
  v_mfma_f32_16x16x32_bf16 a[32:35], v[36:39], v[104:107], 0
  ds_read_b64_tr_b16 v[102:103], v20 offset:18432
  ds_read_b128 v[72:75], v19 offset:2048
  v_mfma_f32_16x16x32_bf16 a[36:39], v[40:43], v[104:107], 0
  v_mfma_f32_16x16x32_bf16 a[40:43], v[44:47], v[104:107], 0
  v_mfma_f32_16x16x32_bf16 a[44:47], v[48:51], v[104:107], 0
  v_mfma_f32_16x16x32_bf16 a[48:51], v[52:55], v[104:107], 0
  v_mfma_f32_16x16x32_bf16 a[52:55], v[56:59], v[104:107], 0
  v_mfma_f32_16x16x32_bf16 a[56:59], v[60:63], v[104:107], 0
  ds_read_b128 v[76:79], v19 offset:4096
  v_mfma_f32_16x16x32_bf16 a[60:63], v[64:67], v[104:107], 0
  ds_read_b64_tr_b16 v[104:105], v21 offset:16384
s_waitcnt lgkmcnt(15)
  v_mfma_f32_16x16x32_bf16 a[64:67], v[36:39], v[108:111], 0
  ds_read_b64_tr_b16 v[106:107], v21 offset:18432
  v_mfma_f32_16x16x32_bf16 a[68:71], v[40:43], v[108:111], 0
  v_mfma_f32_16x16x32_bf16 a[72:75], v[44:47], v[108:111], 0
  v_mfma_f32_16x16x32_bf16 a[76:79], v[48:51], v[108:111], 0
  v_mfma_f32_16x16x32_bf16 a[80:83], v[52:55], v[108:111], 0
  ds_read_b128 v[80:83], v19 offset:6144
  v_mfma_f32_16x16x32_bf16 a[84:87], v[56:59], v[108:111], 0
  v_mfma_f32_16x16x32_bf16 a[88:91], v[60:63], v[108:111], 0
  v_mfma_f32_16x16x32_bf16 a[92:95], v[64:67], v[108:111], 0
  ds_read_b64_tr_b16 v[108:109], v22 offset:16384
s_waitcnt lgkmcnt(15)
  v_mfma_f32_16x16x32_bf16 a[96:99], v[36:39], v[112:115], 0
  ds_read_b64_tr_b16 v[110:111], v22 offset:18432
  v_mfma_f32_16x16x32_bf16 a[100:103], v[40:43], v[112:115], 0
  v_mfma_f32_16x16x32_bf16 a[104:107], v[44:47], v[112:115], 0
  ds_read_b128 v[84:87], v19 offset:8192
  v_mfma_f32_16x16x32_bf16 a[108:111], v[48:51], v[112:115], 0
  v_mfma_f32_16x16x32_bf16 a[112:115], v[52:55], v[112:115], 0
  v_mfma_f32_16x16x32_bf16 a[116:119], v[56:59], v[112:115], 0
  v_mfma_f32_16x16x32_bf16 a[120:123], v[60:63], v[112:115], 0
  v_mfma_f32_16x16x32_bf16 a[124:127], v[64:67], v[112:115], 0
  ds_read_b64_tr_b16 v[112:113], v23 offset:16384
  v_mfma_f32_16x16x32_bf16 a[128:131], v[36:39], v[116:119], 0
  ds_read_b64_tr_b16 v[114:115], v23 offset:18432
  ds_read_b128 v[88:91], v19 offset:10240
  v_mfma_f32_16x16x32_bf16 a[132:135], v[40:43], v[116:119], 0
  v_mfma_f32_16x16x32_bf16 a[136:139], v[44:47], v[116:119], 0
  v_mfma_f32_16x16x32_bf16 a[140:143], v[48:51], v[116:119], 0
  v_mfma_f32_16x16x32_bf16 a[144:147], v[52:55], v[116:119], 0
  v_mfma_f32_16x16x32_bf16 a[148:151], v[56:59], v[116:119], 0
  v_mfma_f32_16x16x32_bf16 a[152:155], v[60:63], v[116:119], 0
  ds_read_b128 v[92:95], v19 offset:12288
  v_mfma_f32_16x16x32_bf16 a[156:159], v[64:67], v[116:119], 0
  ds_read_b64_tr_b16 v[116:117], v24 offset:16384
s_waitcnt lgkmcnt(15)
  v_mfma_f32_16x16x32_bf16 a[160:163], v[36:39], v[120:123], 0
  ds_read_b64_tr_b16 v[118:119], v24 offset:18432
  v_mfma_f32_16x16x32_bf16 a[164:167], v[40:43], v[120:123], 0
  v_mfma_f32_16x16x32_bf16 a[168:171], v[44:47], v[120:123], 0
  v_mfma_f32_16x16x32_bf16 a[172:175], v[48:51], v[120:123], 0
  v_mfma_f32_16x16x32_bf16 a[176:179], v[52:55], v[120:123], 0
  ds_read_b128 v[96:99], v19 offset:14336
  v_mfma_f32_16x16x32_bf16 a[180:183], v[56:59], v[120:123], 0
  v_mfma_f32_16x16x32_bf16 a[184:187], v[60:63], v[120:123], 0
  v_mfma_f32_16x16x32_bf16 a[188:191], v[64:67], v[120:123], 0
  ds_read_b64_tr_b16 v[120:121], v25 offset:16384
  v_mfma_f32_16x16x32_bf16 a[192:195], v[36:39], v[124:127], 0
  ds_read_b64_tr_b16 v[122:123], v25 offset:18432
  v_mfma_f32_16x16x32_bf16 a[196:199], v[40:43], v[124:127], 0
  v_mfma_f32_16x16x32_bf16 a[200:203], v[44:47], v[124:127], 0
  v_mfma_f32_16x16x32_bf16 a[204:207], v[48:51], v[124:127], 0
  v_mfma_f32_16x16x32_bf16 a[208:211], v[52:55], v[124:127], 0
  v_mfma_f32_16x16x32_bf16 a[212:215], v[56:59], v[124:127], 0
  v_mfma_f32_16x16x32_bf16 a[216:219], v[60:63], v[124:127], 0
  v_mfma_f32_16x16x32_bf16 a[220:223], v[64:67], v[124:127], 0
  ds_read_b64_tr_b16 v[124:125], v26 offset:16384
  v_mfma_f32_16x16x32_bf16 a[224:227], v[36:39], v[128:131], 0
  ds_read_b64_tr_b16 v[126:127], v26 offset:18432
  v_mfma_f32_16x16x32_bf16 a[228:231], v[40:43], v[128:131], 0
  v_mfma_f32_16x16x32_bf16 a[232:235], v[44:47], v[128:131], 0
  v_mfma_f32_16x16x32_bf16 a[236:239], v[48:51], v[128:131], 0
  v_mfma_f32_16x16x32_bf16 a[240:243], v[52:55], v[128:131], 0
  v_mfma_f32_16x16x32_bf16 a[244:247], v[56:59], v[128:131], 0
  v_mfma_f32_16x16x32_bf16 a[248:251], v[60:63], v[128:131], 0
  v_mfma_f32_16x16x32_bf16 a[252:255], v[64:67], v[128:131], 0
  ds_read_b64_tr_b16 v[128:129], v27 offset:16384
  ds_read_b64_tr_b16 v[130:131], v27 offset:18432
  s_waitcnt lgkmcnt(2)
  v_mfma_f32_16x16x32_bf16 a[0:3], v[68:71], v[100:103], a[0:3]
  v_mfma_f32_16x16x32_bf16 a[4:7], v[72:75], v[100:103], a[4:7]
  v_mfma_f32_16x16x32_bf16 a[8:11], v[76:79], v[100:103], a[8:11]
  v_mfma_f32_16x16x32_bf16 a[12:15], v[80:83], v[100:103], a[12:15]
  v_mfma_f32_16x16x32_bf16 a[16:19], v[84:87], v[100:103], a[16:19]
  v_mfma_f32_16x16x32_bf16 a[20:23], v[88:91], v[100:103], a[20:23]
  v_mfma_f32_16x16x32_bf16 a[24:27], v[92:95], v[100:103], a[24:27]
  v_mfma_f32_16x16x32_bf16 a[28:31], v[96:99], v[100:103], a[28:31]
  v_mfma_f32_16x16x32_bf16 a[32:35], v[68:71], v[104:107], a[32:35]
  v_mfma_f32_16x16x32_bf16 a[36:39], v[72:75], v[104:107], a[36:39]
  s_waitcnt vmcnt(0) lgkmcnt(0)
  s_barrier
  v_mfma_f32_16x16x32_bf16 a[40:43], v[76:79], v[104:107], a[40:43]
  ds_read_b64_tr_b16 v[100:101], v20 offset:32768
  v_mfma_f32_16x16x32_bf16 a[44:47], v[80:83], v[104:107], a[44:47]
  s_add_u32 m0, s22, 0
s_nop 0
  buffer_load_dwordx4 v2, s[8:11], s20 offen offset:0 lds
  ds_read_b64_tr_b16 v[102:103], v20 offset:34816
  v_mfma_f32_16x16x32_bf16 a[48:51], v[84:87], v[104:107], a[48:51]
  ds_read_b128 v[36:39], v18 offset:32768
  v_mfma_f32_16x16x32_bf16 a[52:55], v[88:91], v[104:107], a[52:55]
  v_mfma_f32_16x16x32_bf16 a[56:59], v[92:95], v[104:107], a[56:59]
  buffer_load_dwordx4 v3, s[8:11], s20 offen offset:1024 lds
  v_mfma_f32_16x16x32_bf16 a[60:63], v[96:99], v[104:107], a[60:63]
  ds_read_b64_tr_b16 v[104:105], v21 offset:32768
  v_mfma_f32_16x16x32_bf16 a[64:67], v[68:71], v[108:111], a[64:67]
  ds_read_b64_tr_b16 v[106:107], v21 offset:34816
  ds_read_b128 v[40:43], v18 offset:34816
  v_mfma_f32_16x16x32_bf16 a[68:71], v[72:75], v[108:111], a[68:71]
  buffer_load_dwordx4 v4, s[8:11], s20 offen offset:2048 lds
  v_mfma_f32_16x16x32_bf16 a[72:75], v[76:79], v[108:111], a[72:75]
  v_mfma_f32_16x16x32_bf16 a[76:79], v[80:83], v[108:111], a[76:79]
  v_mfma_f32_16x16x32_bf16 a[80:83], v[84:87], v[108:111], a[80:83]
  buffer_load_dwordx4 v5, s[8:11], s20 offen offset:3072 lds
  v_mfma_f32_16x16x32_bf16 a[84:87], v[88:91], v[108:111], a[84:87]
  ds_read_b128 v[44:47], v18 offset:36864
  v_mfma_f32_16x16x32_bf16 a[88:91], v[92:95], v[108:111], a[88:91]
  v_mfma_f32_16x16x32_bf16 a[92:95], v[96:99], v[108:111], a[92:95]
  s_add_u32 m0, s23, 0
s_nop 0
  buffer_load_dwordx4 v10, s[12:15], s21 offen offset:0 lds
  ds_read_b64_tr_b16 v[108:109], v22 offset:32768
  v_mfma_f32_16x16x32_bf16 a[96:99], v[68:71], v[112:115], a[96:99]
  ds_read_b64_tr_b16 v[110:111], v22 offset:34816
  v_mfma_f32_16x16x32_bf16 a[100:103], v[72:75], v[112:115], a[100:103]
  v_mfma_f32_16x16x32_bf16 a[104:107], v[76:79], v[112:115], a[104:107]
  buffer_load_dwordx4 v11, s[12:15], s21 offen offset:1024 lds
  ds_read_b128 v[48:51], v18 offset:38912
  v_mfma_f32_16x16x32_bf16 a[108:111], v[80:83], v[112:115], a[108:111]
  v_mfma_f32_16x16x32_bf16 a[112:115], v[84:87], v[112:115], a[112:115]
  v_mfma_f32_16x16x32_bf16 a[116:119], v[88:91], v[112:115], a[116:119]
  buffer_load_dwordx4 v12, s[12:15], s21 offen offset:2048 lds
  v_mfma_f32_16x16x32_bf16 a[120:123], v[92:95], v[112:115], a[120:123]
  v_mfma_f32_16x16x32_bf16 a[124:127], v[96:99], v[112:115], a[124:127]
  ds_read_b64_tr_b16 v[112:113], v23 offset:32768
  ds_read_b128 v[52:55], v18 offset:40960
  v_mfma_f32_16x16x32_bf16 a[128:131], v[68:71], v[116:119], a[128:131]
  buffer_load_dwordx4 v13, s[12:15], s21 offen offset:3072 lds
  ds_read_b64_tr_b16 v[114:115], v23 offset:34816
  v_mfma_f32_16x16x32_bf16 a[132:135], v[72:75], v[116:119], a[132:135]
  v_mfma_f32_16x16x32_bf16 a[136:139], v[76:79], v[116:119], a[136:139]
  v_mfma_f32_16x16x32_bf16 a[140:143], v[80:83], v[116:119], a[140:143]
  s_add_u32 m0, s22, 4096
s_nop 0
  buffer_load_dwordx4 v6, s[8:11], s20 offen offset:0 lds
  ds_read_b128 v[56:59], v18 offset:43008
  v_mfma_f32_16x16x32_bf16 a[144:147], v[84:87], v[116:119], a[144:147]
  v_mfma_f32_16x16x32_bf16 a[148:151], v[88:91], v[116:119], a[148:151]
  v_mfma_f32_16x16x32_bf16 a[152:155], v[92:95], v[116:119], a[152:155]
  buffer_load_dwordx4 v7, s[8:11], s20 offen offset:1024 lds
  v_mfma_f32_16x16x32_bf16 a[156:159], v[96:99], v[116:119], a[156:159]
  ds_read_b64_tr_b16 v[116:117], v24 offset:32768
  v_mfma_f32_16x16x32_bf16 a[160:163], v[68:71], v[120:123], a[160:163]
  ds_read_b64_tr_b16 v[118:119], v24 offset:34816
  ds_read_b128 v[60:63], v18 offset:45056
  v_mfma_f32_16x16x32_bf16 a[164:167], v[72:75], v[120:123], a[164:167]
  buffer_load_dwordx4 v8, s[8:11], s20 offen offset:2048 lds
  v_mfma_f32_16x16x32_bf16 a[168:171], v[76:79], v[120:123], a[168:171]
  v_mfma_f32_16x16x32_bf16 a[172:175], v[80:83], v[120:123], a[172:175]
  v_mfma_f32_16x16x32_bf16 a[176:179], v[84:87], v[120:123], a[176:179]
  buffer_load_dwordx4 v9, s[8:11], s20 offen offset:3072 lds
  v_mfma_f32_16x16x32_bf16 a[180:183], v[88:91], v[120:123], a[180:183]
  ds_read_b128 v[64:67], v18 offset:47104
  v_mfma_f32_16x16x32_bf16 a[184:187], v[92:95], v[120:123], a[184:187]
  v_mfma_f32_16x16x32_bf16 a[188:191], v[96:99], v[120:123], a[188:191]
  s_add_u32 m0, s23, 4096
s_nop 0
  buffer_load_dwordx4 v14, s[12:15], s21 offen offset:0 lds
  ds_read_b64_tr_b16 v[120:121], v25 offset:32768
  v_mfma_f32_16x16x32_bf16 a[192:195], v[68:71], v[124:127], a[192:195]
  ds_read_b64_tr_b16 v[122:123], v25 offset:34816
  v_mfma_f32_16x16x32_bf16 a[196:199], v[72:75], v[124:127], a[196:199]
  v_mfma_f32_16x16x32_bf16 a[200:203], v[76:79], v[124:127], a[200:203]
  buffer_load_dwordx4 v15, s[12:15], s21 offen offset:1024 lds
  v_mfma_f32_16x16x32_bf16 a[204:207], v[80:83], v[124:127], a[204:207]
  v_mfma_f32_16x16x32_bf16 a[208:211], v[84:87], v[124:127], a[208:211]
  v_mfma_f32_16x16x32_bf16 a[212:215], v[88:91], v[124:127], a[212:215]
  buffer_load_dwordx4 v16, s[12:15], s21 offen offset:2048 lds
  v_mfma_f32_16x16x32_bf16 a[216:219], v[92:95], v[124:127], a[216:219]
  v_mfma_f32_16x16x32_bf16 a[220:223], v[96:99], v[124:127], a[220:223]
  ds_read_b64_tr_b16 v[124:125], v26 offset:32768
  v_mfma_f32_16x16x32_bf16 a[224:227], v[68:71], v[128:131], a[224:227]
  buffer_load_dwordx4 v17, s[12:15], s21 offen offset:3072 lds
  s_add_u32 s20, s20, 128
  s_add_u32 s21, s21, 524288
  ds_read_b64_tr_b16 v[126:127], v26 offset:34816
  v_mfma_f32_16x16x32_bf16 a[228:231], v[72:75], v[128:131], a[228:231]
  v_mfma_f32_16x16x32_bf16 a[232:235], v[76:79], v[128:131], a[232:235]
  v_mfma_f32_16x16x32_bf16 a[236:239], v[80:83], v[128:131], a[236:239]
  v_mfma_f32_16x16x32_bf16 a[240:243], v[84:87], v[128:131], a[240:243]
  v_mfma_f32_16x16x32_bf16 a[244:247], v[88:91], v[128:131], a[244:247]
  v_mfma_f32_16x16x32_bf16 a[248:251], v[92:95], v[128:131], a[248:251]
  v_mfma_f32_16x16x32_bf16 a[252:255], v[96:99], v[128:131], a[252:255]
  ds_read_b64_tr_b16 v[128:129], v27 offset:32768
  ds_read_b64_tr_b16 v[130:131], v27 offset:34816
  s_waitcnt lgkmcnt(2)
  v_mfma_f32_16x16x32_bf16 a[0:3], v[36:39], v[100:103], a[0:3]
  v_mfma_f32_16x16x32_bf16 a[4:7], v[40:43], v[100:103], a[4:7]
  v_mfma_f32_16x16x32_bf16 a[8:11], v[44:47], v[100:103], a[8:11]
  ds_read_b128 v[68:71], v19 offset:32768
  v_mfma_f32_16x16x32_bf16 a[12:15], v[48:51], v[100:103], a[12:15]
  v_mfma_f32_16x16x32_bf16 a[16:19], v[52:55], v[100:103], a[16:19]
  v_mfma_f32_16x16x32_bf16 a[20:23], v[56:59], v[100:103], a[20:23]
  v_mfma_f32_16x16x32_bf16 a[24:27], v[60:63], v[100:103], a[24:27]
  v_mfma_f32_16x16x32_bf16 a[28:31], v[64:67], v[100:103], a[28:31]
  ds_read_b64_tr_b16 v[100:101], v20 offset:49152
  v_mfma_f32_16x16x32_bf16 a[32:35], v[36:39], v[104:107], a[32:35]
  ds_read_b64_tr_b16 v[102:103], v20 offset:51200
  ds_read_b128 v[72:75], v19 offset:34816
  v_mfma_f32_16x16x32_bf16 a[36:39], v[40:43], v[104:107], a[36:39]
  v_mfma_f32_16x16x32_bf16 a[40:43], v[44:47], v[104:107], a[40:43]
  v_mfma_f32_16x16x32_bf16 a[44:47], v[48:51], v[104:107], a[44:47]
  v_mfma_f32_16x16x32_bf16 a[48:51], v[52:55], v[104:107], a[48:51]
  v_mfma_f32_16x16x32_bf16 a[52:55], v[56:59], v[104:107], a[52:55]
  v_mfma_f32_16x16x32_bf16 a[56:59], v[60:63], v[104:107], a[56:59]
  ds_read_b128 v[76:79], v19 offset:36864
  v_mfma_f32_16x16x32_bf16 a[60:63], v[64:67], v[104:107], a[60:63]
  ds_read_b64_tr_b16 v[104:105], v21 offset:49152
  v_mfma_f32_16x16x32_bf16 a[64:67], v[36:39], v[108:111], a[64:67]
  ds_read_b64_tr_b16 v[106:107], v21 offset:51200
  v_mfma_f32_16x16x32_bf16 a[68:71], v[40:43], v[108:111], a[68:71]
  v_mfma_f32_16x16x32_bf16 a[72:75], v[44:47], v[108:111], a[72:75]
  v_mfma_f32_16x16x32_bf16 a[76:79], v[48:51], v[108:111], a[76:79]
  v_mfma_f32_16x16x32_bf16 a[80:83], v[52:55], v[108:111], a[80:83]
  ds_read_b128 v[80:83], v19 offset:38912
  v_mfma_f32_16x16x32_bf16 a[84:87], v[56:59], v[108:111], a[84:87]
  v_mfma_f32_16x16x32_bf16 a[88:91], v[60:63], v[108:111], a[88:91]
  v_mfma_f32_16x16x32_bf16 a[92:95], v[64:67], v[108:111], a[92:95]
  ds_read_b64_tr_b16 v[108:109], v22 offset:49152
  v_mfma_f32_16x16x32_bf16 a[96:99], v[36:39], v[112:115], a[96:99]
  ds_read_b64_tr_b16 v[110:111], v22 offset:51200
  v_mfma_f32_16x16x32_bf16 a[100:103], v[40:43], v[112:115], a[100:103]
  v_mfma_f32_16x16x32_bf16 a[104:107], v[44:47], v[112:115], a[104:107]
  ds_read_b128 v[84:87], v19 offset:40960
  v_mfma_f32_16x16x32_bf16 a[108:111], v[48:51], v[112:115], a[108:111]
  v_mfma_f32_16x16x32_bf16 a[112:115], v[52:55], v[112:115], a[112:115]
  v_mfma_f32_16x16x32_bf16 a[116:119], v[56:59], v[112:115], a[116:119]
  v_mfma_f32_16x16x32_bf16 a[120:123], v[60:63], v[112:115], a[120:123]
  v_mfma_f32_16x16x32_bf16 a[124:127], v[64:67], v[112:115], a[124:127]
  ds_read_b64_tr_b16 v[112:113], v23 offset:49152
  v_mfma_f32_16x16x32_bf16 a[128:131], v[36:39], v[116:119], a[128:131]
  ds_read_b64_tr_b16 v[114:115], v23 offset:51200
  ds_read_b128 v[88:91], v19 offset:43008
  v_mfma_f32_16x16x32_bf16 a[132:135], v[40:43], v[116:119], a[132:135]
  v_mfma_f32_16x16x32_bf16 a[136:139], v[44:47], v[116:119], a[136:139]
  v_mfma_f32_16x16x32_bf16 a[140:143], v[48:51], v[116:119], a[140:143]
  v_mfma_f32_16x16x32_bf16 a[144:147], v[52:55], v[116:119], a[144:147]
  v_mfma_f32_16x16x32_bf16 a[148:151], v[56:59], v[116:119], a[148:151]
  v_mfma_f32_16x16x32_bf16 a[152:155], v[60:63], v[116:119], a[152:155]
  ds_read_b128 v[92:95], v19 offset:45056
  v_mfma_f32_16x16x32_bf16 a[156:159], v[64:67], v[116:119], a[156:159]
  ds_read_b64_tr_b16 v[116:117], v24 offset:49152
  v_mfma_f32_16x16x32_bf16 a[160:163], v[36:39], v[120:123], a[160:163]
  ds_read_b64_tr_b16 v[118:119], v24 offset:51200
  v_mfma_f32_16x16x32_bf16 a[164:167], v[40:43], v[120:123], a[164:167]
  v_mfma_f32_16x16x32_bf16 a[168:171], v[44:47], v[120:123], a[168:171]
  v_mfma_f32_16x16x32_bf16 a[172:175], v[48:51], v[120:123], a[172:175]
  v_mfma_f32_16x16x32_bf16 a[176:179], v[52:55], v[120:123], a[176:179]
  ds_read_b128 v[96:99], v19 offset:47104
  v_mfma_f32_16x16x32_bf16 a[180:183], v[56:59], v[120:123], a[180:183]
  v_mfma_f32_16x16x32_bf16 a[184:187], v[60:63], v[120:123], a[184:187]
  v_mfma_f32_16x16x32_bf16 a[188:191], v[64:67], v[120:123], a[188:191]
  ds_read_b64_tr_b16 v[120:121], v25 offset:49152
  v_mfma_f32_16x16x32_bf16 a[192:195], v[36:39], v[124:127], a[192:195]
  ds_read_b64_tr_b16 v[122:123], v25 offset:51200
  v_mfma_f32_16x16x32_bf16 a[196:199], v[40:43], v[124:127], a[196:199]
  v_mfma_f32_16x16x32_bf16 a[200:203], v[44:47], v[124:127], a[200:203]
  v_mfma_f32_16x16x32_bf16 a[204:207], v[48:51], v[124:127], a[204:207]
  v_mfma_f32_16x16x32_bf16 a[208:211], v[52:55], v[124:127], a[208:211]
  v_mfma_f32_16x16x32_bf16 a[212:215], v[56:59], v[124:127], a[212:215]
  v_mfma_f32_16x16x32_bf16 a[216:219], v[60:63], v[124:127], a[216:219]
  v_mfma_f32_16x16x32_bf16 a[220:223], v[64:67], v[124:127], a[220:223]
  ds_read_b64_tr_b16 v[124:125], v26 offset:49152
s_waitcnt lgkmcnt(15)
  v_mfma_f32_16x16x32_bf16 a[224:227], v[36:39], v[128:131], a[224:227]
  ds_read_b64_tr_b16 v[126:127], v26 offset:51200
  v_mfma_f32_16x16x32_bf16 a[228:231], v[40:43], v[128:131], a[228:231]
  v_mfma_f32_16x16x32_bf16 a[232:235], v[44:47], v[128:131], a[232:235]
  v_mfma_f32_16x16x32_bf16 a[236:239], v[48:51], v[128:131], a[236:239]
  v_mfma_f32_16x16x32_bf16 a[240:243], v[52:55], v[128:131], a[240:243]
  v_mfma_f32_16x16x32_bf16 a[244:247], v[56:59], v[128:131], a[244:247]
  v_mfma_f32_16x16x32_bf16 a[248:251], v[60:63], v[128:131], a[248:251]
  v_mfma_f32_16x16x32_bf16 a[252:255], v[64:67], v[128:131], a[252:255]
  ds_read_b64_tr_b16 v[128:129], v27 offset:49152
  ds_read_b64_tr_b16 v[130:131], v27 offset:51200
  s_waitcnt lgkmcnt(2)
  v_mfma_f32_16x16x32_bf16 a[0:3], v[68:71], v[100:103], a[0:3]
  v_mfma_f32_16x16x32_bf16 a[4:7], v[72:75], v[100:103], a[4:7]
  v_mfma_f32_16x16x32_bf16 a[8:11], v[76:79], v[100:103], a[8:11]
  v_mfma_f32_16x16x32_bf16 a[12:15], v[80:83], v[100:103], a[12:15]
  v_mfma_f32_16x16x32_bf16 a[16:19], v[84:87], v[100:103], a[16:19]
  v_mfma_f32_16x16x32_bf16 a[20:23], v[88:91], v[100:103], a[20:23]
  v_mfma_f32_16x16x32_bf16 a[24:27], v[92:95], v[100:103], a[24:27]
  v_mfma_f32_16x16x32_bf16 a[28:31], v[96:99], v[100:103], a[28:31]
  v_mfma_f32_16x16x32_bf16 a[32:35], v[68:71], v[104:107], a[32:35]
  v_mfma_f32_16x16x32_bf16 a[36:39], v[72:75], v[104:107], a[36:39]
  s_waitcnt vmcnt(0) lgkmcnt(0)
  s_barrier
  v_mfma_f32_16x16x32_bf16 a[40:43], v[76:79], v[104:107], a[40:43]
  ds_read_b64_tr_b16 v[100:101], v20 offset:0
  v_mfma_f32_16x16x32_bf16 a[44:47], v[80:83], v[104:107], a[44:47]
  s_add_u32 m0, s22, 32768
s_nop 0
  buffer_load_dwordx4 v2, s[8:11], s20 offen offset:0 lds
  ds_read_b64_tr_b16 v[102:103], v20 offset:2048
  v_mfma_f32_16x16x32_bf16 a[48:51], v[84:87], v[104:107], a[48:51]
  ds_read_b128 v[36:39], v18 offset:0
  v_mfma_f32_16x16x32_bf16 a[52:55], v[88:91], v[104:107], a[52:55]
  v_mfma_f32_16x16x32_bf16 a[56:59], v[92:95], v[104:107], a[56:59]
  buffer_load_dwordx4 v3, s[8:11], s20 offen offset:1024 lds
  v_mfma_f32_16x16x32_bf16 a[60:63], v[96:99], v[104:107], a[60:63]
  ds_read_b64_tr_b16 v[104:105], v21 offset:0
  v_mfma_f32_16x16x32_bf16 a[64:67], v[68:71], v[108:111], a[64:67]
  ds_read_b64_tr_b16 v[106:107], v21 offset:2048
  ds_read_b128 v[40:43], v18 offset:2048
  v_mfma_f32_16x16x32_bf16 a[68:71], v[72:75], v[108:111], a[68:71]
  buffer_load_dwordx4 v4, s[8:11], s20 offen offset:2048 lds
  v_mfma_f32_16x16x32_bf16 a[72:75], v[76:79], v[108:111], a[72:75]
  v_mfma_f32_16x16x32_bf16 a[76:79], v[80:83], v[108:111], a[76:79]
  v_mfma_f32_16x16x32_bf16 a[80:83], v[84:87], v[108:111], a[80:83]
  buffer_load_dwordx4 v5, s[8:11], s20 offen offset:3072 lds
  v_mfma_f32_16x16x32_bf16 a[84:87], v[88:91], v[108:111], a[84:87]
  ds_read_b128 v[44:47], v18 offset:4096
  v_mfma_f32_16x16x32_bf16 a[88:91], v[92:95], v[108:111], a[88:91]
  v_mfma_f32_16x16x32_bf16 a[92:95], v[96:99], v[108:111], a[92:95]
  s_add_u32 m0, s23, 32768
s_nop 0
  buffer_load_dwordx4 v10, s[12:15], s21 offen offset:0 lds
  ds_read_b64_tr_b16 v[108:109], v22 offset:0
  v_mfma_f32_16x16x32_bf16 a[96:99], v[68:71], v[112:115], a[96:99]
  ds_read_b64_tr_b16 v[110:111], v22 offset:2048
  v_mfma_f32_16x16x32_bf16 a[100:103], v[72:75], v[112:115], a[100:103]
  v_mfma_f32_16x16x32_bf16 a[104:107], v[76:79], v[112:115], a[104:107]
  buffer_load_dwordx4 v11, s[12:15], s21 offen offset:1024 lds
  ds_read_b128 v[48:51], v18 offset:6144
  v_mfma_f32_16x16x32_bf16 a[108:111], v[80:83], v[112:115], a[108:111]
  v_mfma_f32_16x16x32_bf16 a[112:115], v[84:87], v[112:115], a[112:115]
  v_mfma_f32_16x16x32_bf16 a[116:119], v[88:91], v[112:115], a[116:119]
  buffer_load_dwordx4 v12, s[12:15], s21 offen offset:2048 lds
  v_mfma_f32_16x16x32_bf16 a[120:123], v[92:95], v[112:115], a[120:123]
  v_mfma_f32_16x16x32_bf16 a[124:127], v[96:99], v[112:115], a[124:127]
  ds_read_b64_tr_b16 v[112:113], v23 offset:0
  ds_read_b128 v[52:55], v18 offset:8192
  v_mfma_f32_16x16x32_bf16 a[128:131], v[68:71], v[116:119], a[128:131]
  buffer_load_dwordx4 v13, s[12:15], s21 offen offset:3072 lds
  ds_read_b64_tr_b16 v[114:115], v23 offset:2048
  v_mfma_f32_16x16x32_bf16 a[132:135], v[72:75], v[116:119], a[132:135]
  v_mfma_f32_16x16x32_bf16 a[136:139], v[76:79], v[116:119], a[136:139]
  v_mfma_f32_16x16x32_bf16 a[140:143], v[80:83], v[116:119], a[140:143]
  s_add_u32 m0, s22, 36864
s_nop 0
  buffer_load_dwordx4 v6, s[8:11], s20 offen offset:0 lds
  ds_read_b128 v[56:59], v18 offset:10240
  v_mfma_f32_16x16x32_bf16 a[144:147], v[84:87], v[116:119], a[144:147]
  v_mfma_f32_16x16x32_bf16 a[148:151], v[88:91], v[116:119], a[148:151]
  v_mfma_f32_16x16x32_bf16 a[152:155], v[92:95], v[116:119], a[152:155]
  buffer_load_dwordx4 v7, s[8:11], s20 offen offset:1024 lds
  v_mfma_f32_16x16x32_bf16 a[156:159], v[96:99], v[116:119], a[156:159]
  ds_read_b64_tr_b16 v[116:117], v24 offset:0
  v_mfma_f32_16x16x32_bf16 a[160:163], v[68:71], v[120:123], a[160:163]
  ds_read_b64_tr_b16 v[118:119], v24 offset:2048
  ds_read_b128 v[60:63], v18 offset:12288
  v_mfma_f32_16x16x32_bf16 a[164:167], v[72:75], v[120:123], a[164:167]
  buffer_load_dwordx4 v8, s[8:11], s20 offen offset:2048 lds
  v_mfma_f32_16x16x32_bf16 a[168:171], v[76:79], v[120:123], a[168:171]
  v_mfma_f32_16x16x32_bf16 a[172:175], v[80:83], v[120:123], a[172:175]
  v_mfma_f32_16x16x32_bf16 a[176:179], v[84:87], v[120:123], a[176:179]
  buffer_load_dwordx4 v9, s[8:11], s20 offen offset:3072 lds
  v_mfma_f32_16x16x32_bf16 a[180:183], v[88:91], v[120:123], a[180:183]
  ds_read_b128 v[64:67], v18 offset:14336
  v_mfma_f32_16x16x32_bf16 a[184:187], v[92:95], v[120:123], a[184:187]
  v_mfma_f32_16x16x32_bf16 a[188:191], v[96:99], v[120:123], a[188:191]
  s_add_u32 m0, s23, 36864
s_nop 0
  buffer_load_dwordx4 v14, s[12:15], s21 offen offset:0 lds
  ds_read_b64_tr_b16 v[120:121], v25 offset:0
  v_mfma_f32_16x16x32_bf16 a[192:195], v[68:71], v[124:127], a[192:195]
  ds_read_b64_tr_b16 v[122:123], v25 offset:2048
  v_mfma_f32_16x16x32_bf16 a[196:199], v[72:75], v[124:127], a[196:199]
  v_mfma_f32_16x16x32_bf16 a[200:203], v[76:79], v[124:127], a[200:203]
  buffer_load_dwordx4 v15, s[12:15], s21 offen offset:1024 lds
  v_mfma_f32_16x16x32_bf16 a[204:207], v[80:83], v[124:127], a[204:207]
  v_mfma_f32_16x16x32_bf16 a[208:211], v[84:87], v[124:127], a[208:211]
  v_mfma_f32_16x16x32_bf16 a[212:215], v[88:91], v[124:127], a[212:215]
  buffer_load_dwordx4 v16, s[12:15], s21 offen offset:2048 lds
  v_mfma_f32_16x16x32_bf16 a[216:219], v[92:95], v[124:127], a[216:219]
  v_mfma_f32_16x16x32_bf16 a[220:223], v[96:99], v[124:127], a[220:223]
  ds_read_b64_tr_b16 v[124:125], v26 offset:0
  v_mfma_f32_16x16x32_bf16 a[224:227], v[68:71], v[128:131], a[224:227]
  buffer_load_dwordx4 v17, s[12:15], s21 offen offset:3072 lds
  s_add_u32 s20, s20, 128
  s_add_u32 s21, s21, 524288
  ds_read_b64_tr_b16 v[126:127], v26 offset:2048
  v_mfma_f32_16x16x32_bf16 a[228:231], v[72:75], v[128:131], a[228:231]
  v_mfma_f32_16x16x32_bf16 a[232:235], v[76:79], v[128:131], a[232:235]
  v_mfma_f32_16x16x32_bf16 a[236:239], v[80:83], v[128:131], a[236:239]
  v_mfma_f32_16x16x32_bf16 a[240:243], v[84:87], v[128:131], a[240:243]
  v_mfma_f32_16x16x32_bf16 a[244:247], v[88:91], v[128:131], a[244:247]
  v_mfma_f32_16x16x32_bf16 a[248:251], v[92:95], v[128:131], a[248:251]
  v_mfma_f32_16x16x32_bf16 a[252:255], v[96:99], v[128:131], a[252:255]
  ds_read_b64_tr_b16 v[128:129], v27 offset:0
  ds_read_b64_tr_b16 v[130:131], v27 offset:2048
  s_waitcnt lgkmcnt(2)
  v_mfma_f32_16x16x32_bf16 a[0:3], v[36:39], v[100:103], a[0:3]
  v_mfma_f32_16x16x32_bf16 a[4:7], v[40:43], v[100:103], a[4:7]
  v_mfma_f32_16x16x32_bf16 a[8:11], v[44:47], v[100:103], a[8:11]
  ds_read_b128 v[68:71], v19 offset:0
  v_mfma_f32_16x16x32_bf16 a[12:15], v[48:51], v[100:103], a[12:15]
  v_mfma_f32_16x16x32_bf16 a[16:19], v[52:55], v[100:103], a[16:19]
  v_mfma_f32_16x16x32_bf16 a[20:23], v[56:59], v[100:103], a[20:23]
  v_mfma_f32_16x16x32_bf16 a[24:27], v[60:63], v[100:103], a[24:27]
  v_mfma_f32_16x16x32_bf16 a[28:31], v[64:67], v[100:103], a[28:31]
  ds_read_b64_tr_b16 v[100:101], v20 offset:16384
  v_mfma_f32_16x16x32_bf16 a[32:35], v[36:39], v[104:107], a[32:35]
  ds_read_b64_tr_b16 v[102:103], v20 offset:18432
  ds_read_b128 v[72:75], v19 offset:2048
  v_mfma_f32_16x16x32_bf16 a[36:39], v[40:43], v[104:107], a[36:39]
  v_mfma_f32_16x16x32_bf16 a[40:43], v[44:47], v[104:107], a[40:43]
  v_mfma_f32_16x16x32_bf16 a[44:47], v[48:51], v[104:107], a[44:47]
  v_mfma_f32_16x16x32_bf16 a[48:51], v[52:55], v[104:107], a[48:51]
  v_mfma_f32_16x16x32_bf16 a[52:55], v[56:59], v[104:107], a[52:55]
  v_mfma_f32_16x16x32_bf16 a[56:59], v[60:63], v[104:107], a[56:59]
  ds_read_b128 v[76:79], v19 offset:4096
  v_mfma_f32_16x16x32_bf16 a[60:63], v[64:67], v[104:107], a[60:63]
  ds_read_b64_tr_b16 v[104:105], v21 offset:16384
  v_mfma_f32_16x16x32_bf16 a[64:67], v[36:39], v[108:111], a[64:67]
  ds_read_b64_tr_b16 v[106:107], v21 offset:18432
  v_mfma_f32_16x16x32_bf16 a[68:71], v[40:43], v[108:111], a[68:71]
  v_mfma_f32_16x16x32_bf16 a[72:75], v[44:47], v[108:111], a[72:75]
  v_mfma_f32_16x16x32_bf16 a[76:79], v[48:51], v[108:111], a[76:79]
  v_mfma_f32_16x16x32_bf16 a[80:83], v[52:55], v[108:111], a[80:83]
  ds_read_b128 v[80:83], v19 offset:6144
  v_mfma_f32_16x16x32_bf16 a[84:87], v[56:59], v[108:111], a[84:87]
  v_mfma_f32_16x16x32_bf16 a[88:91], v[60:63], v[108:111], a[88:91]
  v_mfma_f32_16x16x32_bf16 a[92:95], v[64:67], v[108:111], a[92:95]
  ds_read_b64_tr_b16 v[108:109], v22 offset:16384
  v_mfma_f32_16x16x32_bf16 a[96:99], v[36:39], v[112:115], a[96:99]
  ds_read_b64_tr_b16 v[110:111], v22 offset:18432
  v_mfma_f32_16x16x32_bf16 a[100:103], v[40:43], v[112:115], a[100:103]
  v_mfma_f32_16x16x32_bf16 a[104:107], v[44:47], v[112:115], a[104:107]
  ds_read_b128 v[84:87], v19 offset:8192
  v_mfma_f32_16x16x32_bf16 a[108:111], v[48:51], v[112:115], a[108:111]
  v_mfma_f32_16x16x32_bf16 a[112:115], v[52:55], v[112:115], a[112:115]
  v_mfma_f32_16x16x32_bf16 a[116:119], v[56:59], v[112:115], a[116:119]
  v_mfma_f32_16x16x32_bf16 a[120:123], v[60:63], v[112:115], a[120:123]
  v_mfma_f32_16x16x32_bf16 a[124:127], v[64:67], v[112:115], a[124:127]
  ds_read_b64_tr_b16 v[112:113], v23 offset:16384
  v_mfma_f32_16x16x32_bf16 a[128:131], v[36:39], v[116:119], a[128:131]
  ds_read_b64_tr_b16 v[114:115], v23 offset:18432
  ds_read_b128 v[88:91], v19 offset:10240
  v_mfma_f32_16x16x32_bf16 a[132:135], v[40:43], v[116:119], a[132:135]
  v_mfma_f32_16x16x32_bf16 a[136:139], v[44:47], v[116:119], a[136:139]
  v_mfma_f32_16x16x32_bf16 a[140:143], v[48:51], v[116:119], a[140:143]
  v_mfma_f32_16x16x32_bf16 a[144:147], v[52:55], v[116:119], a[144:147]
  v_mfma_f32_16x16x32_bf16 a[148:151], v[56:59], v[116:119], a[148:151]
  v_mfma_f32_16x16x32_bf16 a[152:155], v[60:63], v[116:119], a[152:155]
  ds_read_b128 v[92:95], v19 offset:12288
  v_mfma_f32_16x16x32_bf16 a[156:159], v[64:67], v[116:119], a[156:159]
  ds_read_b64_tr_b16 v[116:117], v24 offset:16384
  v_mfma_f32_16x16x32_bf16 a[160:163], v[36:39], v[120:123], a[160:163]
  ds_read_b64_tr_b16 v[118:119], v24 offset:18432
  v_mfma_f32_16x16x32_bf16 a[164:167], v[40:43], v[120:123], a[164:167]
  v_mfma_f32_16x16x32_bf16 a[168:171], v[44:47], v[120:123], a[168:171]
  v_mfma_f32_16x16x32_bf16 a[172:175], v[48:51], v[120:123], a[172:175]
  v_mfma_f32_16x16x32_bf16 a[176:179], v[52:55], v[120:123], a[176:179]
  ds_read_b128 v[96:99], v19 offset:14336
  v_mfma_f32_16x16x32_bf16 a[180:183], v[56:59], v[120:123], a[180:183]
  v_mfma_f32_16x16x32_bf16 a[184:187], v[60:63], v[120:123], a[184:187]
  v_mfma_f32_16x16x32_bf16 a[188:191], v[64:67], v[120:123], a[188:191]
  ds_read_b64_tr_b16 v[120:121], v25 offset:16384
  v_mfma_f32_16x16x32_bf16 a[192:195], v[36:39], v[124:127], a[192:195]
  ds_read_b64_tr_b16 v[122:123], v25 offset:18432
  v_mfma_f32_16x16x32_bf16 a[196:199], v[40:43], v[124:127], a[196:199]
  v_mfma_f32_16x16x32_bf16 a[200:203], v[44:47], v[124:127], a[200:203]
  v_mfma_f32_16x16x32_bf16 a[204:207], v[48:51], v[124:127], a[204:207]
  v_mfma_f32_16x16x32_bf16 a[208:211], v[52:55], v[124:127], a[208:211]
  v_mfma_f32_16x16x32_bf16 a[212:215], v[56:59], v[124:127], a[212:215]
  v_mfma_f32_16x16x32_bf16 a[216:219], v[60:63], v[124:127], a[216:219]
  v_mfma_f32_16x16x32_bf16 a[220:223], v[64:67], v[124:127], a[220:223]
  ds_read_b64_tr_b16 v[124:125], v26 offset:16384
s_waitcnt lgkmcnt(15)
  v_mfma_f32_16x16x32_bf16 a[224:227], v[36:39], v[128:131], a[224:227]
  ds_read_b64_tr_b16 v[126:127], v26 offset:18432
  v_mfma_f32_16x16x32_bf16 a[228:231], v[40:43], v[128:131], a[228:231]
  v_mfma_f32_16x16x32_bf16 a[232:235], v[44:47], v[128:131], a[232:235]
  v_mfma_f32_16x16x32_bf16 a[236:239], v[48:51], v[128:131], a[236:239]
  v_mfma_f32_16x16x32_bf16 a[240:243], v[52:55], v[128:131], a[240:243]
  v_mfma_f32_16x16x32_bf16 a[244:247], v[56:59], v[128:131], a[244:247]
  v_mfma_f32_16x16x32_bf16 a[248:251], v[60:63], v[128:131], a[248:251]
  v_mfma_f32_16x16x32_bf16 a[252:255], v[64:67], v[128:131], a[252:255]
  ds_read_b64_tr_b16 v[128:129], v27 offset:16384
  ds_read_b64_tr_b16 v[130:131], v27 offset:18432
  s_waitcnt lgkmcnt(2)
  v_mfma_f32_16x16x32_bf16 a[0:3], v[68:71], v[100:103], a[0:3]
  v_mfma_f32_16x16x32_bf16 a[4:7], v[72:75], v[100:103], a[4:7]
  v_mfma_f32_16x16x32_bf16 a[8:11], v[76:79], v[100:103], a[8:11]
  v_mfma_f32_16x16x32_bf16 a[12:15], v[80:83], v[100:103], a[12:15]
  v_mfma_f32_16x16x32_bf16 a[16:19], v[84:87], v[100:103], a[16:19]
  v_mfma_f32_16x16x32_bf16 a[20:23], v[88:91], v[100:103], a[20:23]
  v_mfma_f32_16x16x32_bf16 a[24:27], v[92:95], v[100:103], a[24:27]
  v_mfma_f32_16x16x32_bf16 a[28:31], v[96:99], v[100:103], a[28:31]
  v_mfma_f32_16x16x32_bf16 a[32:35], v[68:71], v[104:107], a[32:35]
  v_mfma_f32_16x16x32_bf16 a[36:39], v[72:75], v[104:107], a[36:39]
  s_waitcnt vmcnt(0) lgkmcnt(0)
  s_barrier
  v_mfma_f32_16x16x32_bf16 a[40:43], v[76:79], v[104:107], a[40:43]
  ds_read_b64_tr_b16 v[100:101], v20 offset:32768
  v_mfma_f32_16x16x32_bf16 a[44:47], v[80:83], v[104:107], a[44:47]
  s_add_u32 m0, s22, 0
s_nop 0
  buffer_load_dwordx4 v2, s[8:11], s20 offen offset:0 lds
  ds_read_b64_tr_b16 v[102:103], v20 offset:34816
  v_mfma_f32_16x16x32_bf16 a[48:51], v[84:87], v[104:107], a[48:51]
  ds_read_b128 v[36:39], v18 offset:32768
  v_mfma_f32_16x16x32_bf16 a[52:55], v[88:91], v[104:107], a[52:55]
  v_mfma_f32_16x16x32_bf16 a[56:59], v[92:95], v[104:107], a[56:59]
  buffer_load_dwordx4 v3, s[8:11], s20 offen offset:1024 lds
  v_mfma_f32_16x16x32_bf16 a[60:63], v[96:99], v[104:107], a[60:63]
  ds_read_b64_tr_b16 v[104:105], v21 offset:32768
  v_mfma_f32_16x16x32_bf16 a[64:67], v[68:71], v[108:111], a[64:67]
  ds_read_b64_tr_b16 v[106:107], v21 offset:34816
  ds_read_b128 v[40:43], v18 offset:34816
  v_mfma_f32_16x16x32_bf16 a[68:71], v[72:75], v[108:111], a[68:71]
  buffer_load_dwordx4 v4, s[8:11], s20 offen offset:2048 lds
  v_mfma_f32_16x16x32_bf16 a[72:75], v[76:79], v[108:111], a[72:75]
  v_mfma_f32_16x16x32_bf16 a[76:79], v[80:83], v[108:111], a[76:79]
  v_mfma_f32_16x16x32_bf16 a[80:83], v[84:87], v[108:111], a[80:83]
  buffer_load_dwordx4 v5, s[8:11], s20 offen offset:3072 lds
  v_mfma_f32_16x16x32_bf16 a[84:87], v[88:91], v[108:111], a[84:87]
  ds_read_b128 v[44:47], v18 offset:36864
  v_mfma_f32_16x16x32_bf16 a[88:91], v[92:95], v[108:111], a[88:91]
  v_mfma_f32_16x16x32_bf16 a[92:95], v[96:99], v[108:111], a[92:95]
  s_add_u32 m0, s23, 0
s_nop 0
  buffer_load_dwordx4 v10, s[12:15], s21 offen offset:0 lds
  ds_read_b64_tr_b16 v[108:109], v22 offset:32768
  v_mfma_f32_16x16x32_bf16 a[96:99], v[68:71], v[112:115], a[96:99]
  ds_read_b64_tr_b16 v[110:111], v22 offset:34816
  v_mfma_f32_16x16x32_bf16 a[100:103], v[72:75], v[112:115], a[100:103]
  v_mfma_f32_16x16x32_bf16 a[104:107], v[76:79], v[112:115], a[104:107]
  buffer_load_dwordx4 v11, s[12:15], s21 offen offset:1024 lds
  ds_read_b128 v[48:51], v18 offset:38912
  v_mfma_f32_16x16x32_bf16 a[108:111], v[80:83], v[112:115], a[108:111]
  v_mfma_f32_16x16x32_bf16 a[112:115], v[84:87], v[112:115], a[112:115]
  v_mfma_f32_16x16x32_bf16 a[116:119], v[88:91], v[112:115], a[116:119]
  buffer_load_dwordx4 v12, s[12:15], s21 offen offset:2048 lds
  v_mfma_f32_16x16x32_bf16 a[120:123], v[92:95], v[112:115], a[120:123]
  v_mfma_f32_16x16x32_bf16 a[124:127], v[96:99], v[112:115], a[124:127]
  ds_read_b64_tr_b16 v[112:113], v23 offset:32768
  ds_read_b128 v[52:55], v18 offset:40960
  v_mfma_f32_16x16x32_bf16 a[128:131], v[68:71], v[116:119], a[128:131]
  buffer_load_dwordx4 v13, s[12:15], s21 offen offset:3072 lds
  ds_read_b64_tr_b16 v[114:115], v23 offset:34816
  v_mfma_f32_16x16x32_bf16 a[132:135], v[72:75], v[116:119], a[132:135]
  v_mfma_f32_16x16x32_bf16 a[136:139], v[76:79], v[116:119], a[136:139]
  v_mfma_f32_16x16x32_bf16 a[140:143], v[80:83], v[116:119], a[140:143]
  s_add_u32 m0, s22, 4096
s_nop 0
  buffer_load_dwordx4 v6, s[8:11], s20 offen offset:0 lds
  ds_read_b128 v[56:59], v18 offset:43008
  v_mfma_f32_16x16x32_bf16 a[144:147], v[84:87], v[116:119], a[144:147]
  v_mfma_f32_16x16x32_bf16 a[148:151], v[88:91], v[116:119], a[148:151]
  v_mfma_f32_16x16x32_bf16 a[152:155], v[92:95], v[116:119], a[152:155]
  buffer_load_dwordx4 v7, s[8:11], s20 offen offset:1024 lds
  v_mfma_f32_16x16x32_bf16 a[156:159], v[96:99], v[116:119], a[156:159]
  ds_read_b64_tr_b16 v[116:117], v24 offset:32768
  v_mfma_f32_16x16x32_bf16 a[160:163], v[68:71], v[120:123], a[160:163]
  ds_read_b64_tr_b16 v[118:119], v24 offset:34816
  ds_read_b128 v[60:63], v18 offset:45056
  v_mfma_f32_16x16x32_bf16 a[164:167], v[72:75], v[120:123], a[164:167]
  buffer_load_dwordx4 v8, s[8:11], s20 offen offset:2048 lds
  v_mfma_f32_16x16x32_bf16 a[168:171], v[76:79], v[120:123], a[168:171]
  v_mfma_f32_16x16x32_bf16 a[172:175], v[80:83], v[120:123], a[172:175]
  v_mfma_f32_16x16x32_bf16 a[176:179], v[84:87], v[120:123], a[176:179]
  buffer_load_dwordx4 v9, s[8:11], s20 offen offset:3072 lds
  v_mfma_f32_16x16x32_bf16 a[180:183], v[88:91], v[120:123], a[180:183]
  ds_read_b128 v[64:67], v18 offset:47104
  v_mfma_f32_16x16x32_bf16 a[184:187], v[92:95], v[120:123], a[184:187]
  v_mfma_f32_16x16x32_bf16 a[188:191], v[96:99], v[120:123], a[188:191]
  s_add_u32 m0, s23, 4096
s_nop 0
  buffer_load_dwordx4 v14, s[12:15], s21 offen offset:0 lds
  ds_read_b64_tr_b16 v[120:121], v25 offset:32768
  v_mfma_f32_16x16x32_bf16 a[192:195], v[68:71], v[124:127], a[192:195]
  ds_read_b64_tr_b16 v[122:123], v25 offset:34816
  v_mfma_f32_16x16x32_bf16 a[196:199], v[72:75], v[124:127], a[196:199]
  v_mfma_f32_16x16x32_bf16 a[200:203], v[76:79], v[124:127], a[200:203]
  buffer_load_dwordx4 v15, s[12:15], s21 offen offset:1024 lds
  v_mfma_f32_16x16x32_bf16 a[204:207], v[80:83], v[124:127], a[204:207]
  v_mfma_f32_16x16x32_bf16 a[208:211], v[84:87], v[124:127], a[208:211]
  v_mfma_f32_16x16x32_bf16 a[212:215], v[88:91], v[124:127], a[212:215]
  buffer_load_dwordx4 v16, s[12:15], s21 offen offset:2048 lds
  v_mfma_f32_16x16x32_bf16 a[216:219], v[92:95], v[124:127], a[216:219]
  v_mfma_f32_16x16x32_bf16 a[220:223], v[96:99], v[124:127], a[220:223]
  ds_read_b64_tr_b16 v[124:125], v26 offset:32768
  v_mfma_f32_16x16x32_bf16 a[224:227], v[68:71], v[128:131], a[224:227]
  buffer_load_dwordx4 v17, s[12:15], s21 offen offset:3072 lds
  s_add_u32 s20, s20, 128
  s_add_u32 s21, s21, 524288
  ds_read_b64_tr_b16 v[126:127], v26 offset:34816
  v_mfma_f32_16x16x32_bf16 a[228:231], v[72:75], v[128:131], a[228:231]
  v_mfma_f32_16x16x32_bf16 a[232:235], v[76:79], v[128:131], a[232:235]
  v_mfma_f32_16x16x32_bf16 a[236:239], v[80:83], v[128:131], a[236:239]
  v_mfma_f32_16x16x32_bf16 a[240:243], v[84:87], v[128:131], a[240:243]
  v_mfma_f32_16x16x32_bf16 a[244:247], v[88:91], v[128:131], a[244:247]
  v_mfma_f32_16x16x32_bf16 a[248:251], v[92:95], v[128:131], a[248:251]
  v_mfma_f32_16x16x32_bf16 a[252:255], v[96:99], v[128:131], a[252:255]
  ds_read_b64_tr_b16 v[128:129], v27 offset:32768
  ds_read_b64_tr_b16 v[130:131], v27 offset:34816
  s_waitcnt lgkmcnt(2)
  v_mfma_f32_16x16x32_bf16 a[0:3], v[36:39], v[100:103], a[0:3]
  v_mfma_f32_16x16x32_bf16 a[4:7], v[40:43], v[100:103], a[4:7]
  v_mfma_f32_16x16x32_bf16 a[8:11], v[44:47], v[100:103], a[8:11]
  ds_read_b128 v[68:71], v19 offset:32768
  v_mfma_f32_16x16x32_bf16 a[12:15], v[48:51], v[100:103], a[12:15]
  v_mfma_f32_16x16x32_bf16 a[16:19], v[52:55], v[100:103], a[16:19]
  v_mfma_f32_16x16x32_bf16 a[20:23], v[56:59], v[100:103], a[20:23]
  v_mfma_f32_16x16x32_bf16 a[24:27], v[60:63], v[100:103], a[24:27]
  v_mfma_f32_16x16x32_bf16 a[28:31], v[64:67], v[100:103], a[28:31]
  ds_read_b64_tr_b16 v[100:101], v20 offset:49152
  v_mfma_f32_16x16x32_bf16 a[32:35], v[36:39], v[104:107], a[32:35]
  ds_read_b64_tr_b16 v[102:103], v20 offset:51200
  ds_read_b128 v[72:75], v19 offset:34816
  v_mfma_f32_16x16x32_bf16 a[36:39], v[40:43], v[104:107], a[36:39]
  v_mfma_f32_16x16x32_bf16 a[40:43], v[44:47], v[104:107], a[40:43]
  v_mfma_f32_16x16x32_bf16 a[44:47], v[48:51], v[104:107], a[44:47]
  v_mfma_f32_16x16x32_bf16 a[48:51], v[52:55], v[104:107], a[48:51]
  v_mfma_f32_16x16x32_bf16 a[52:55], v[56:59], v[104:107], a[52:55]
  v_mfma_f32_16x16x32_bf16 a[56:59], v[60:63], v[104:107], a[56:59]
  ds_read_b128 v[76:79], v19 offset:36864
  v_mfma_f32_16x16x32_bf16 a[60:63], v[64:67], v[104:107], a[60:63]
  ds_read_b64_tr_b16 v[104:105], v21 offset:49152
  v_mfma_f32_16x16x32_bf16 a[64:67], v[36:39], v[108:111], a[64:67]
  ds_read_b64_tr_b16 v[106:107], v21 offset:51200
  v_mfma_f32_16x16x32_bf16 a[68:71], v[40:43], v[108:111], a[68:71]
  v_mfma_f32_16x16x32_bf16 a[72:75], v[44:47], v[108:111], a[72:75]
  v_mfma_f32_16x16x32_bf16 a[76:79], v[48:51], v[108:111], a[76:79]
  v_mfma_f32_16x16x32_bf16 a[80:83], v[52:55], v[108:111], a[80:83]
  ds_read_b128 v[80:83], v19 offset:38912
  v_mfma_f32_16x16x32_bf16 a[84:87], v[56:59], v[108:111], a[84:87]
  v_mfma_f32_16x16x32_bf16 a[88:91], v[60:63], v[108:111], a[88:91]
  v_mfma_f32_16x16x32_bf16 a[92:95], v[64:67], v[108:111], a[92:95]
  ds_read_b64_tr_b16 v[108:109], v22 offset:49152
  v_mfma_f32_16x16x32_bf16 a[96:99], v[36:39], v[112:115], a[96:99]
  ds_read_b64_tr_b16 v[110:111], v22 offset:51200
  v_mfma_f32_16x16x32_bf16 a[100:103], v[40:43], v[112:115], a[100:103]
  v_mfma_f32_16x16x32_bf16 a[104:107], v[44:47], v[112:115], a[104:107]
  ds_read_b128 v[84:87], v19 offset:40960
  v_mfma_f32_16x16x32_bf16 a[108:111], v[48:51], v[112:115], a[108:111]
  v_mfma_f32_16x16x32_bf16 a[112:115], v[52:55], v[112:115], a[112:115]
  v_mfma_f32_16x16x32_bf16 a[116:119], v[56:59], v[112:115], a[116:119]
  v_mfma_f32_16x16x32_bf16 a[120:123], v[60:63], v[112:115], a[120:123]
  v_mfma_f32_16x16x32_bf16 a[124:127], v[64:67], v[112:115], a[124:127]
  ds_read_b64_tr_b16 v[112:113], v23 offset:49152
  v_mfma_f32_16x16x32_bf16 a[128:131], v[36:39], v[116:119], a[128:131]
  ds_read_b64_tr_b16 v[114:115], v23 offset:51200
  ds_read_b128 v[88:91], v19 offset:43008
  v_mfma_f32_16x16x32_bf16 a[132:135], v[40:43], v[116:119], a[132:135]
  v_mfma_f32_16x16x32_bf16 a[136:139], v[44:47], v[116:119], a[136:139]
  v_mfma_f32_16x16x32_bf16 a[140:143], v[48:51], v[116:119], a[140:143]
  v_mfma_f32_16x16x32_bf16 a[144:147], v[52:55], v[116:119], a[144:147]
  v_mfma_f32_16x16x32_bf16 a[148:151], v[56:59], v[116:119], a[148:151]
  v_mfma_f32_16x16x32_bf16 a[152:155], v[60:63], v[116:119], a[152:155]
  ds_read_b128 v[92:95], v19 offset:45056
  v_mfma_f32_16x16x32_bf16 a[156:159], v[64:67], v[116:119], a[156:159]
  ds_read_b64_tr_b16 v[116:117], v24 offset:49152
  v_mfma_f32_16x16x32_bf16 a[160:163], v[36:39], v[120:123], a[160:163]
  ds_read_b64_tr_b16 v[118:119], v24 offset:51200
  v_mfma_f32_16x16x32_bf16 a[164:167], v[40:43], v[120:123], a[164:167]
  v_mfma_f32_16x16x32_bf16 a[168:171], v[44:47], v[120:123], a[168:171]
  v_mfma_f32_16x16x32_bf16 a[172:175], v[48:51], v[120:123], a[172:175]
  v_mfma_f32_16x16x32_bf16 a[176:179], v[52:55], v[120:123], a[176:179]
  ds_read_b128 v[96:99], v19 offset:47104
  v_mfma_f32_16x16x32_bf16 a[180:183], v[56:59], v[120:123], a[180:183]
  v_mfma_f32_16x16x32_bf16 a[184:187], v[60:63], v[120:123], a[184:187]
  v_mfma_f32_16x16x32_bf16 a[188:191], v[64:67], v[120:123], a[188:191]
  ds_read_b64_tr_b16 v[120:121], v25 offset:49152
  v_mfma_f32_16x16x32_bf16 a[192:195], v[36:39], v[124:127], a[192:195]
  ds_read_b64_tr_b16 v[122:123], v25 offset:51200
  v_mfma_f32_16x16x32_bf16 a[196:199], v[40:43], v[124:127], a[196:199]
  v_mfma_f32_16x16x32_bf16 a[200:203], v[44:47], v[124:127], a[200:203]
  v_mfma_f32_16x16x32_bf16 a[204:207], v[48:51], v[124:127], a[204:207]
  v_mfma_f32_16x16x32_bf16 a[208:211], v[52:55], v[124:127], a[208:211]
  v_mfma_f32_16x16x32_bf16 a[212:215], v[56:59], v[124:127], a[212:215]
  v_mfma_f32_16x16x32_bf16 a[216:219], v[60:63], v[124:127], a[216:219]
  v_mfma_f32_16x16x32_bf16 a[220:223], v[64:67], v[124:127], a[220:223]
  ds_read_b64_tr_b16 v[124:125], v26 offset:49152
s_waitcnt lgkmcnt(15)
  v_mfma_f32_16x16x32_bf16 a[224:227], v[36:39], v[128:131], a[224:227]
  ds_read_b64_tr_b16 v[126:127], v26 offset:51200
  v_mfma_f32_16x16x32_bf16 a[228:231], v[40:43], v[128:131], a[228:231]
  v_mfma_f32_16x16x32_bf16 a[232:235], v[44:47], v[128:131], a[232:235]
  v_mfma_f32_16x16x32_bf16 a[236:239], v[48:51], v[128:131], a[236:239]
  v_mfma_f32_16x16x32_bf16 a[240:243], v[52:55], v[128:131], a[240:243]
  v_mfma_f32_16x16x32_bf16 a[244:247], v[56:59], v[128:131], a[244:247]
  v_mfma_f32_16x16x32_bf16 a[248:251], v[60:63], v[128:131], a[248:251]
  v_mfma_f32_16x16x32_bf16 a[252:255], v[64:67], v[128:131], a[252:255]
  ds_read_b64_tr_b16 v[128:129], v27 offset:49152
  ds_read_b64_tr_b16 v[130:131], v27 offset:51200
  s_waitcnt lgkmcnt(2)
  v_mfma_f32_16x16x32_bf16 a[0:3], v[68:71], v[100:103], a[0:3]
  v_mfma_f32_16x16x32_bf16 a[4:7], v[72:75], v[100:103], a[4:7]
  v_mfma_f32_16x16x32_bf16 a[8:11], v[76:79], v[100:103], a[8:11]
  v_mfma_f32_16x16x32_bf16 a[12:15], v[80:83], v[100:103], a[12:15]
  v_mfma_f32_16x16x32_bf16 a[16:19], v[84:87], v[100:103], a[16:19]
  v_mfma_f32_16x16x32_bf16 a[20:23], v[88:91], v[100:103], a[20:23]
  v_mfma_f32_16x16x32_bf16 a[24:27], v[92:95], v[100:103], a[24:27]
  v_mfma_f32_16x16x32_bf16 a[28:31], v[96:99], v[100:103], a[28:31]
  v_mfma_f32_16x16x32_bf16 a[32:35], v[68:71], v[104:107], a[32:35]
  v_mfma_f32_16x16x32_bf16 a[36:39], v[72:75], v[104:107], a[36:39]
  s_waitcnt vmcnt(0) lgkmcnt(0)
  s_barrier
  v_mfma_f32_16x16x32_bf16 a[40:43], v[76:79], v[104:107], a[40:43]
  ds_read_b64_tr_b16 v[100:101], v20 offset:0
  v_mfma_f32_16x16x32_bf16 a[44:47], v[80:83], v[104:107], a[44:47]
  s_add_u32 m0, s22, 32768
s_nop 0
  buffer_load_dwordx4 v2, s[8:11], s20 offen offset:0 lds
  ds_read_b64_tr_b16 v[102:103], v20 offset:2048
  v_mfma_f32_16x16x32_bf16 a[48:51], v[84:87], v[104:107], a[48:51]
  ds_read_b128 v[36:39], v18 offset:0
  v_mfma_f32_16x16x32_bf16 a[52:55], v[88:91], v[104:107], a[52:55]
  v_mfma_f32_16x16x32_bf16 a[56:59], v[92:95], v[104:107], a[56:59]
  buffer_load_dwordx4 v3, s[8:11], s20 offen offset:1024 lds
  v_mfma_f32_16x16x32_bf16 a[60:63], v[96:99], v[104:107], a[60:63]
  ds_read_b64_tr_b16 v[104:105], v21 offset:0
  v_mfma_f32_16x16x32_bf16 a[64:67], v[68:71], v[108:111], a[64:67]
  ds_read_b64_tr_b16 v[106:107], v21 offset:2048
  ds_read_b128 v[40:43], v18 offset:2048
  v_mfma_f32_16x16x32_bf16 a[68:71], v[72:75], v[108:111], a[68:71]
  buffer_load_dwordx4 v4, s[8:11], s20 offen offset:2048 lds
  v_mfma_f32_16x16x32_bf16 a[72:75], v[76:79], v[108:111], a[72:75]
  v_mfma_f32_16x16x32_bf16 a[76:79], v[80:83], v[108:111], a[76:79]
  v_mfma_f32_16x16x32_bf16 a[80:83], v[84:87], v[108:111], a[80:83]
  buffer_load_dwordx4 v5, s[8:11], s20 offen offset:3072 lds
  v_mfma_f32_16x16x32_bf16 a[84:87], v[88:91], v[108:111], a[84:87]
  ds_read_b128 v[44:47], v18 offset:4096
  v_mfma_f32_16x16x32_bf16 a[88:91], v[92:95], v[108:111], a[88:91]
  v_mfma_f32_16x16x32_bf16 a[92:95], v[96:99], v[108:111], a[92:95]
  s_add_u32 m0, s23, 32768
s_nop 0
  buffer_load_dwordx4 v10, s[12:15], s21 offen offset:0 lds
  ds_read_b64_tr_b16 v[108:109], v22 offset:0
  v_mfma_f32_16x16x32_bf16 a[96:99], v[68:71], v[112:115], a[96:99]
  ds_read_b64_tr_b16 v[110:111], v22 offset:2048
  v_mfma_f32_16x16x32_bf16 a[100:103], v[72:75], v[112:115], a[100:103]
  v_mfma_f32_16x16x32_bf16 a[104:107], v[76:79], v[112:115], a[104:107]
  buffer_load_dwordx4 v11, s[12:15], s21 offen offset:1024 lds
  ds_read_b128 v[48:51], v18 offset:6144
  v_mfma_f32_16x16x32_bf16 a[108:111], v[80:83], v[112:115], a[108:111]
  v_mfma_f32_16x16x32_bf16 a[112:115], v[84:87], v[112:115], a[112:115]
  v_mfma_f32_16x16x32_bf16 a[116:119], v[88:91], v[112:115], a[116:119]
  buffer_load_dwordx4 v12, s[12:15], s21 offen offset:2048 lds
  v_mfma_f32_16x16x32_bf16 a[120:123], v[92:95], v[112:115], a[120:123]
  v_mfma_f32_16x16x32_bf16 a[124:127], v[96:99], v[112:115], a[124:127]
  ds_read_b64_tr_b16 v[112:113], v23 offset:0
  ds_read_b128 v[52:55], v18 offset:8192
  v_mfma_f32_16x16x32_bf16 a[128:131], v[68:71], v[116:119], a[128:131]
  buffer_load_dwordx4 v13, s[12:15], s21 offen offset:3072 lds
  ds_read_b64_tr_b16 v[114:115], v23 offset:2048
  v_mfma_f32_16x16x32_bf16 a[132:135], v[72:75], v[116:119], a[132:135]
  v_mfma_f32_16x16x32_bf16 a[136:139], v[76:79], v[116:119], a[136:139]
  v_mfma_f32_16x16x32_bf16 a[140:143], v[80:83], v[116:119], a[140:143]
  s_add_u32 m0, s22, 36864
s_nop 0
  buffer_load_dwordx4 v6, s[8:11], s20 offen offset:0 lds
  ds_read_b128 v[56:59], v18 offset:10240
  v_mfma_f32_16x16x32_bf16 a[144:147], v[84:87], v[116:119], a[144:147]
  v_mfma_f32_16x16x32_bf16 a[148:151], v[88:91], v[116:119], a[148:151]
  v_mfma_f32_16x16x32_bf16 a[152:155], v[92:95], v[116:119], a[152:155]
  buffer_load_dwordx4 v7, s[8:11], s20 offen offset:1024 lds
  v_mfma_f32_16x16x32_bf16 a[156:159], v[96:99], v[116:119], a[156:159]
  ds_read_b64_tr_b16 v[116:117], v24 offset:0
  v_mfma_f32_16x16x32_bf16 a[160:163], v[68:71], v[120:123], a[160:163]
  ds_read_b64_tr_b16 v[118:119], v24 offset:2048
  ds_read_b128 v[60:63], v18 offset:12288
  v_mfma_f32_16x16x32_bf16 a[164:167], v[72:75], v[120:123], a[164:167]
  buffer_load_dwordx4 v8, s[8:11], s20 offen offset:2048 lds
  v_mfma_f32_16x16x32_bf16 a[168:171], v[76:79], v[120:123], a[168:171]
  v_mfma_f32_16x16x32_bf16 a[172:175], v[80:83], v[120:123], a[172:175]
  v_mfma_f32_16x16x32_bf16 a[176:179], v[84:87], v[120:123], a[176:179]
  buffer_load_dwordx4 v9, s[8:11], s20 offen offset:3072 lds
  v_mfma_f32_16x16x32_bf16 a[180:183], v[88:91], v[120:123], a[180:183]
  ds_read_b128 v[64:67], v18 offset:14336
  v_mfma_f32_16x16x32_bf16 a[184:187], v[92:95], v[120:123], a[184:187]
  v_mfma_f32_16x16x32_bf16 a[188:191], v[96:99], v[120:123], a[188:191]
  s_add_u32 m0, s23, 36864
s_nop 0
  buffer_load_dwordx4 v14, s[12:15], s21 offen offset:0 lds
  ds_read_b64_tr_b16 v[120:121], v25 offset:0
  v_mfma_f32_16x16x32_bf16 a[192:195], v[68:71], v[124:127], a[192:195]
  ds_read_b64_tr_b16 v[122:123], v25 offset:2048
  v_mfma_f32_16x16x32_bf16 a[196:199], v[72:75], v[124:127], a[196:199]
  v_mfma_f32_16x16x32_bf16 a[200:203], v[76:79], v[124:127], a[200:203]
  buffer_load_dwordx4 v15, s[12:15], s21 offen offset:1024 lds
  v_mfma_f32_16x16x32_bf16 a[204:207], v[80:83], v[124:127], a[204:207]
  v_mfma_f32_16x16x32_bf16 a[208:211], v[84:87], v[124:127], a[208:211]
  v_mfma_f32_16x16x32_bf16 a[212:215], v[88:91], v[124:127], a[212:215]
  buffer_load_dwordx4 v16, s[12:15], s21 offen offset:2048 lds
  v_mfma_f32_16x16x32_bf16 a[216:219], v[92:95], v[124:127], a[216:219]
  v_mfma_f32_16x16x32_bf16 a[220:223], v[96:99], v[124:127], a[220:223]
  ds_read_b64_tr_b16 v[124:125], v26 offset:0
  v_mfma_f32_16x16x32_bf16 a[224:227], v[68:71], v[128:131], a[224:227]
  buffer_load_dwordx4 v17, s[12:15], s21 offen offset:3072 lds
  s_add_u32 s20, s20, 128
  s_add_u32 s21, s21, 524288
  ds_read_b64_tr_b16 v[126:127], v26 offset:2048
  v_mfma_f32_16x16x32_bf16 a[228:231], v[72:75], v[128:131], a[228:231]
  v_mfma_f32_16x16x32_bf16 a[232:235], v[76:79], v[128:131], a[232:235]
  v_mfma_f32_16x16x32_bf16 a[236:239], v[80:83], v[128:131], a[236:239]
  v_mfma_f32_16x16x32_bf16 a[240:243], v[84:87], v[128:131], a[240:243]
  v_mfma_f32_16x16x32_bf16 a[244:247], v[88:91], v[128:131], a[244:247]
  v_mfma_f32_16x16x32_bf16 a[248:251], v[92:95], v[128:131], a[248:251]
  v_mfma_f32_16x16x32_bf16 a[252:255], v[96:99], v[128:131], a[252:255]
  ds_read_b64_tr_b16 v[128:129], v27 offset:0
  ds_read_b64_tr_b16 v[130:131], v27 offset:2048
  s_waitcnt lgkmcnt(2)
  v_mfma_f32_16x16x32_bf16 a[0:3], v[36:39], v[100:103], a[0:3]
  v_mfma_f32_16x16x32_bf16 a[4:7], v[40:43], v[100:103], a[4:7]
  v_mfma_f32_16x16x32_bf16 a[8:11], v[44:47], v[100:103], a[8:11]
  ds_read_b128 v[68:71], v19 offset:0
  v_mfma_f32_16x16x32_bf16 a[12:15], v[48:51], v[100:103], a[12:15]
  v_mfma_f32_16x16x32_bf16 a[16:19], v[52:55], v[100:103], a[16:19]
  v_mfma_f32_16x16x32_bf16 a[20:23], v[56:59], v[100:103], a[20:23]
  v_mfma_f32_16x16x32_bf16 a[24:27], v[60:63], v[100:103], a[24:27]
  v_mfma_f32_16x16x32_bf16 a[28:31], v[64:67], v[100:103], a[28:31]
  ds_read_b64_tr_b16 v[100:101], v20 offset:16384
  v_mfma_f32_16x16x32_bf16 a[32:35], v[36:39], v[104:107], a[32:35]
  ds_read_b64_tr_b16 v[102:103], v20 offset:18432
  ds_read_b128 v[72:75], v19 offset:2048
  v_mfma_f32_16x16x32_bf16 a[36:39], v[40:43], v[104:107], a[36:39]
  v_mfma_f32_16x16x32_bf16 a[40:43], v[44:47], v[104:107], a[40:43]
  v_mfma_f32_16x16x32_bf16 a[44:47], v[48:51], v[104:107], a[44:47]
  v_mfma_f32_16x16x32_bf16 a[48:51], v[52:55], v[104:107], a[48:51]
  v_mfma_f32_16x16x32_bf16 a[52:55], v[56:59], v[104:107], a[52:55]
  v_mfma_f32_16x16x32_bf16 a[56:59], v[60:63], v[104:107], a[56:59]
  ds_read_b128 v[76:79], v19 offset:4096
  v_mfma_f32_16x16x32_bf16 a[60:63], v[64:67], v[104:107], a[60:63]
  ds_read_b64_tr_b16 v[104:105], v21 offset:16384
  v_mfma_f32_16x16x32_bf16 a[64:67], v[36:39], v[108:111], a[64:67]
  ds_read_b64_tr_b16 v[106:107], v21 offset:18432
  v_mfma_f32_16x16x32_bf16 a[68:71], v[40:43], v[108:111], a[68:71]
  v_mfma_f32_16x16x32_bf16 a[72:75], v[44:47], v[108:111], a[72:75]
  v_mfma_f32_16x16x32_bf16 a[76:79], v[48:51], v[108:111], a[76:79]
  v_mfma_f32_16x16x32_bf16 a[80:83], v[52:55], v[108:111], a[80:83]
  ds_read_b128 v[80:83], v19 offset:6144
  v_mfma_f32_16x16x32_bf16 a[84:87], v[56:59], v[108:111], a[84:87]
  v_mfma_f32_16x16x32_bf16 a[88:91], v[60:63], v[108:111], a[88:91]
  v_mfma_f32_16x16x32_bf16 a[92:95], v[64:67], v[108:111], a[92:95]
  ds_read_b64_tr_b16 v[108:109], v22 offset:16384
  v_mfma_f32_16x16x32_bf16 a[96:99], v[36:39], v[112:115], a[96:99]
  ds_read_b64_tr_b16 v[110:111], v22 offset:18432
  v_mfma_f32_16x16x32_bf16 a[100:103], v[40:43], v[112:115], a[100:103]
  v_mfma_f32_16x16x32_bf16 a[104:107], v[44:47], v[112:115], a[104:107]
  ds_read_b128 v[84:87], v19 offset:8192
  v_mfma_f32_16x16x32_bf16 a[108:111], v[48:51], v[112:115], a[108:111]
  v_mfma_f32_16x16x32_bf16 a[112:115], v[52:55], v[112:115], a[112:115]
  v_mfma_f32_16x16x32_bf16 a[116:119], v[56:59], v[112:115], a[116:119]
  v_mfma_f32_16x16x32_bf16 a[120:123], v[60:63], v[112:115], a[120:123]
  v_mfma_f32_16x16x32_bf16 a[124:127], v[64:67], v[112:115], a[124:127]
  ds_read_b64_tr_b16 v[112:113], v23 offset:16384
  v_mfma_f32_16x16x32_bf16 a[128:131], v[36:39], v[116:119], a[128:131]
  ds_read_b64_tr_b16 v[114:115], v23 offset:18432
  ds_read_b128 v[88:91], v19 offset:10240
  v_mfma_f32_16x16x32_bf16 a[132:135], v[40:43], v[116:119], a[132:135]
  v_mfma_f32_16x16x32_bf16 a[136:139], v[44:47], v[116:119], a[136:139]
  v_mfma_f32_16x16x32_bf16 a[140:143], v[48:51], v[116:119], a[140:143]
  v_mfma_f32_16x16x32_bf16 a[144:147], v[52:55], v[116:119], a[144:147]
  v_mfma_f32_16x16x32_bf16 a[148:151], v[56:59], v[116:119], a[148:151]
  v_mfma_f32_16x16x32_bf16 a[152:155], v[60:63], v[116:119], a[152:155]
  ds_read_b128 v[92:95], v19 offset:12288
  v_mfma_f32_16x16x32_bf16 a[156:159], v[64:67], v[116:119], a[156:159]
  ds_read_b64_tr_b16 v[116:117], v24 offset:16384
  v_mfma_f32_16x16x32_bf16 a[160:163], v[36:39], v[120:123], a[160:163]
  ds_read_b64_tr_b16 v[118:119], v24 offset:18432
  v_mfma_f32_16x16x32_bf16 a[164:167], v[40:43], v[120:123], a[164:167]
  v_mfma_f32_16x16x32_bf16 a[168:171], v[44:47], v[120:123], a[168:171]
  v_mfma_f32_16x16x32_bf16 a[172:175], v[48:51], v[120:123], a[172:175]
  v_mfma_f32_16x16x32_bf16 a[176:179], v[52:55], v[120:123], a[176:179]
  ds_read_b128 v[96:99], v19 offset:14336
  v_mfma_f32_16x16x32_bf16 a[180:183], v[56:59], v[120:123], a[180:183]
  v_mfma_f32_16x16x32_bf16 a[184:187], v[60:63], v[120:123], a[184:187]
  v_mfma_f32_16x16x32_bf16 a[188:191], v[64:67], v[120:123], a[188:191]
  ds_read_b64_tr_b16 v[120:121], v25 offset:16384
  v_mfma_f32_16x16x32_bf16 a[192:195], v[36:39], v[124:127], a[192:195]
  ds_read_b64_tr_b16 v[122:123], v25 offset:18432
  v_mfma_f32_16x16x32_bf16 a[196:199], v[40:43], v[124:127], a[196:199]
  v_mfma_f32_16x16x32_bf16 a[200:203], v[44:47], v[124:127], a[200:203]
  v_mfma_f32_16x16x32_bf16 a[204:207], v[48:51], v[124:127], a[204:207]
  v_mfma_f32_16x16x32_bf16 a[208:211], v[52:55], v[124:127], a[208:211]
  v_mfma_f32_16x16x32_bf16 a[212:215], v[56:59], v[124:127], a[212:215]
  v_mfma_f32_16x16x32_bf16 a[216:219], v[60:63], v[124:127], a[216:219]
  v_mfma_f32_16x16x32_bf16 a[220:223], v[64:67], v[124:127], a[220:223]
  ds_read_b64_tr_b16 v[124:125], v26 offset:16384
s_waitcnt lgkmcnt(15)
  v_mfma_f32_16x16x32_bf16 a[224:227], v[36:39], v[128:131], a[224:227]
  ds_read_b64_tr_b16 v[126:127], v26 offset:18432
  v_mfma_f32_16x16x32_bf16 a[228:231], v[40:43], v[128:131], a[228:231]
  v_mfma_f32_16x16x32_bf16 a[232:235], v[44:47], v[128:131], a[232:235]
  v_mfma_f32_16x16x32_bf16 a[236:239], v[48:51], v[128:131], a[236:239]
  v_mfma_f32_16x16x32_bf16 a[240:243], v[52:55], v[128:131], a[240:243]
  v_mfma_f32_16x16x32_bf16 a[244:247], v[56:59], v[128:131], a[244:247]
  v_mfma_f32_16x16x32_bf16 a[248:251], v[60:63], v[128:131], a[248:251]
  v_mfma_f32_16x16x32_bf16 a[252:255], v[64:67], v[128:131], a[252:255]
  ds_read_b64_tr_b16 v[128:129], v27 offset:16384
  ds_read_b64_tr_b16 v[130:131], v27 offset:18432
  s_waitcnt lgkmcnt(2)
  v_mfma_f32_16x16x32_bf16 a[0:3], v[68:71], v[100:103], a[0:3]
  v_mfma_f32_16x16x32_bf16 a[4:7], v[72:75], v[100:103], a[4:7]
  v_mfma_f32_16x16x32_bf16 a[8:11], v[76:79], v[100:103], a[8:11]
  v_mfma_f32_16x16x32_bf16 a[12:15], v[80:83], v[100:103], a[12:15]
  v_mfma_f32_16x16x32_bf16 a[16:19], v[84:87], v[100:103], a[16:19]
  v_mfma_f32_16x16x32_bf16 a[20:23], v[88:91], v[100:103], a[20:23]
  v_mfma_f32_16x16x32_bf16 a[24:27], v[92:95], v[100:103], a[24:27]
  v_mfma_f32_16x16x32_bf16 a[28:31], v[96:99], v[100:103], a[28:31]
  v_mfma_f32_16x16x32_bf16 a[32:35], v[68:71], v[104:107], a[32:35]
  v_mfma_f32_16x16x32_bf16 a[36:39], v[72:75], v[104:107], a[36:39]
  s_waitcnt vmcnt(0) lgkmcnt(0)
  s_barrier
  v_mfma_f32_16x16x32_bf16 a[40:43], v[76:79], v[104:107], a[40:43]
  ds_read_b64_tr_b16 v[100:101], v20 offset:32768
  v_mfma_f32_16x16x32_bf16 a[44:47], v[80:83], v[104:107], a[44:47]
  s_add_u32 m0, s22, 0
s_nop 0
  buffer_load_dwordx4 v2, s[8:11], s20 offen offset:0 lds
  ds_read_b64_tr_b16 v[102:103], v20 offset:34816
  v_mfma_f32_16x16x32_bf16 a[48:51], v[84:87], v[104:107], a[48:51]
  ds_read_b128 v[36:39], v18 offset:32768
  v_mfma_f32_16x16x32_bf16 a[52:55], v[88:91], v[104:107], a[52:55]
  v_mfma_f32_16x16x32_bf16 a[56:59], v[92:95], v[104:107], a[56:59]
  buffer_load_dwordx4 v3, s[8:11], s20 offen offset:1024 lds
  v_mfma_f32_16x16x32_bf16 a[60:63], v[96:99], v[104:107], a[60:63]
  ds_read_b64_tr_b16 v[104:105], v21 offset:32768
  v_mfma_f32_16x16x32_bf16 a[64:67], v[68:71], v[108:111], a[64:67]
  ds_read_b64_tr_b16 v[106:107], v21 offset:34816
  ds_read_b128 v[40:43], v18 offset:34816
  v_mfma_f32_16x16x32_bf16 a[68:71], v[72:75], v[108:111], a[68:71]
  buffer_load_dwordx4 v4, s[8:11], s20 offen offset:2048 lds
  v_mfma_f32_16x16x32_bf16 a[72:75], v[76:79], v[108:111], a[72:75]
  v_mfma_f32_16x16x32_bf16 a[76:79], v[80:83], v[108:111], a[76:79]
  v_mfma_f32_16x16x32_bf16 a[80:83], v[84:87], v[108:111], a[80:83]
  buffer_load_dwordx4 v5, s[8:11], s20 offen offset:3072 lds
  v_mfma_f32_16x16x32_bf16 a[84:87], v[88:91], v[108:111], a[84:87]
  ds_read_b128 v[44:47], v18 offset:36864
  v_mfma_f32_16x16x32_bf16 a[88:91], v[92:95], v[108:111], a[88:91]
  v_mfma_f32_16x16x32_bf16 a[92:95], v[96:99], v[108:111], a[92:95]
  s_add_u32 m0, s23, 0
s_nop 0
  buffer_load_dwordx4 v10, s[12:15], s21 offen offset:0 lds
  ds_read_b64_tr_b16 v[108:109], v22 offset:32768
  v_mfma_f32_16x16x32_bf16 a[96:99], v[68:71], v[112:115], a[96:99]
  ds_read_b64_tr_b16 v[110:111], v22 offset:34816
  v_mfma_f32_16x16x32_bf16 a[100:103], v[72:75], v[112:115], a[100:103]
  v_mfma_f32_16x16x32_bf16 a[104:107], v[76:79], v[112:115], a[104:107]
  buffer_load_dwordx4 v11, s[12:15], s21 offen offset:1024 lds
  ds_read_b128 v[48:51], v18 offset:38912
  v_mfma_f32_16x16x32_bf16 a[108:111], v[80:83], v[112:115], a[108:111]
  v_mfma_f32_16x16x32_bf16 a[112:115], v[84:87], v[112:115], a[112:115]
  v_mfma_f32_16x16x32_bf16 a[116:119], v[88:91], v[112:115], a[116:119]
  buffer_load_dwordx4 v12, s[12:15], s21 offen offset:2048 lds
  v_mfma_f32_16x16x32_bf16 a[120:123], v[92:95], v[112:115], a[120:123]
  v_mfma_f32_16x16x32_bf16 a[124:127], v[96:99], v[112:115], a[124:127]
  ds_read_b64_tr_b16 v[112:113], v23 offset:32768
  ds_read_b128 v[52:55], v18 offset:40960
  v_mfma_f32_16x16x32_bf16 a[128:131], v[68:71], v[116:119], a[128:131]
  buffer_load_dwordx4 v13, s[12:15], s21 offen offset:3072 lds
  ds_read_b64_tr_b16 v[114:115], v23 offset:34816
  v_mfma_f32_16x16x32_bf16 a[132:135], v[72:75], v[116:119], a[132:135]
  v_mfma_f32_16x16x32_bf16 a[136:139], v[76:79], v[116:119], a[136:139]
  v_mfma_f32_16x16x32_bf16 a[140:143], v[80:83], v[116:119], a[140:143]
  s_add_u32 m0, s22, 4096
s_nop 0
  buffer_load_dwordx4 v6, s[8:11], s20 offen offset:0 lds
  ds_read_b128 v[56:59], v18 offset:43008
  v_mfma_f32_16x16x32_bf16 a[144:147], v[84:87], v[116:119], a[144:147]
  v_mfma_f32_16x16x32_bf16 a[148:151], v[88:91], v[116:119], a[148:151]
  v_mfma_f32_16x16x32_bf16 a[152:155], v[92:95], v[116:119], a[152:155]
  buffer_load_dwordx4 v7, s[8:11], s20 offen offset:1024 lds
  v_mfma_f32_16x16x32_bf16 a[156:159], v[96:99], v[116:119], a[156:159]
  ds_read_b64_tr_b16 v[116:117], v24 offset:32768
  v_mfma_f32_16x16x32_bf16 a[160:163], v[68:71], v[120:123], a[160:163]
  ds_read_b64_tr_b16 v[118:119], v24 offset:34816
  ds_read_b128 v[60:63], v18 offset:45056
  v_mfma_f32_16x16x32_bf16 a[164:167], v[72:75], v[120:123], a[164:167]
  buffer_load_dwordx4 v8, s[8:11], s20 offen offset:2048 lds
  v_mfma_f32_16x16x32_bf16 a[168:171], v[76:79], v[120:123], a[168:171]
  v_mfma_f32_16x16x32_bf16 a[172:175], v[80:83], v[120:123], a[172:175]
  v_mfma_f32_16x16x32_bf16 a[176:179], v[84:87], v[120:123], a[176:179]
  buffer_load_dwordx4 v9, s[8:11], s20 offen offset:3072 lds
  v_mfma_f32_16x16x32_bf16 a[180:183], v[88:91], v[120:123], a[180:183]
  ds_read_b128 v[64:67], v18 offset:47104
  v_mfma_f32_16x16x32_bf16 a[184:187], v[92:95], v[120:123], a[184:187]
  v_mfma_f32_16x16x32_bf16 a[188:191], v[96:99], v[120:123], a[188:191]
  s_add_u32 m0, s23, 4096
s_nop 0
  buffer_load_dwordx4 v14, s[12:15], s21 offen offset:0 lds
  ds_read_b64_tr_b16 v[120:121], v25 offset:32768
  v_mfma_f32_16x16x32_bf16 a[192:195], v[68:71], v[124:127], a[192:195]
  ds_read_b64_tr_b16 v[122:123], v25 offset:34816
  v_mfma_f32_16x16x32_bf16 a[196:199], v[72:75], v[124:127], a[196:199]
  v_mfma_f32_16x16x32_bf16 a[200:203], v[76:79], v[124:127], a[200:203]
  buffer_load_dwordx4 v15, s[12:15], s21 offen offset:1024 lds
  v_mfma_f32_16x16x32_bf16 a[204:207], v[80:83], v[124:127], a[204:207]
  v_mfma_f32_16x16x32_bf16 a[208:211], v[84:87], v[124:127], a[208:211]
  v_mfma_f32_16x16x32_bf16 a[212:215], v[88:91], v[124:127], a[212:215]
  buffer_load_dwordx4 v16, s[12:15], s21 offen offset:2048 lds
  v_mfma_f32_16x16x32_bf16 a[216:219], v[92:95], v[124:127], a[216:219]
  v_mfma_f32_16x16x32_bf16 a[220:223], v[96:99], v[124:127], a[220:223]
  ds_read_b64_tr_b16 v[124:125], v26 offset:32768
  v_mfma_f32_16x16x32_bf16 a[224:227], v[68:71], v[128:131], a[224:227]
  buffer_load_dwordx4 v17, s[12:15], s21 offen offset:3072 lds
  s_add_u32 s20, s20, 128
  s_add_u32 s21, s21, 524288
  ds_read_b64_tr_b16 v[126:127], v26 offset:34816
  v_mfma_f32_16x16x32_bf16 a[228:231], v[72:75], v[128:131], a[228:231]
  v_mfma_f32_16x16x32_bf16 a[232:235], v[76:79], v[128:131], a[232:235]
  v_mfma_f32_16x16x32_bf16 a[236:239], v[80:83], v[128:131], a[236:239]
  v_mfma_f32_16x16x32_bf16 a[240:243], v[84:87], v[128:131], a[240:243]
  v_mfma_f32_16x16x32_bf16 a[244:247], v[88:91], v[128:131], a[244:247]
  v_mfma_f32_16x16x32_bf16 a[248:251], v[92:95], v[128:131], a[248:251]
  v_mfma_f32_16x16x32_bf16 a[252:255], v[96:99], v[128:131], a[252:255]
  ds_read_b64_tr_b16 v[128:129], v27 offset:32768
  ds_read_b64_tr_b16 v[130:131], v27 offset:34816
  s_waitcnt lgkmcnt(2)
  v_mfma_f32_16x16x32_bf16 a[0:3], v[36:39], v[100:103], a[0:3]
  v_mfma_f32_16x16x32_bf16 a[4:7], v[40:43], v[100:103], a[4:7]
  v_mfma_f32_16x16x32_bf16 a[8:11], v[44:47], v[100:103], a[8:11]
  ds_read_b128 v[68:71], v19 offset:32768
  v_mfma_f32_16x16x32_bf16 a[12:15], v[48:51], v[100:103], a[12:15]
  v_mfma_f32_16x16x32_bf16 a[16:19], v[52:55], v[100:103], a[16:19]
  v_mfma_f32_16x16x32_bf16 a[20:23], v[56:59], v[100:103], a[20:23]
  v_mfma_f32_16x16x32_bf16 a[24:27], v[60:63], v[100:103], a[24:27]
  v_mfma_f32_16x16x32_bf16 a[28:31], v[64:67], v[100:103], a[28:31]
  ds_read_b64_tr_b16 v[100:101], v20 offset:49152
  v_mfma_f32_16x16x32_bf16 a[32:35], v[36:39], v[104:107], a[32:35]
  ds_read_b64_tr_b16 v[102:103], v20 offset:51200
  ds_read_b128 v[72:75], v19 offset:34816
  v_mfma_f32_16x16x32_bf16 a[36:39], v[40:43], v[104:107], a[36:39]
  v_mfma_f32_16x16x32_bf16 a[40:43], v[44:47], v[104:107], a[40:43]
  v_mfma_f32_16x16x32_bf16 a[44:47], v[48:51], v[104:107], a[44:47]
  v_mfma_f32_16x16x32_bf16 a[48:51], v[52:55], v[104:107], a[48:51]
  v_mfma_f32_16x16x32_bf16 a[52:55], v[56:59], v[104:107], a[52:55]
  v_mfma_f32_16x16x32_bf16 a[56:59], v[60:63], v[104:107], a[56:59]
  ds_read_b128 v[76:79], v19 offset:36864
  v_mfma_f32_16x16x32_bf16 a[60:63], v[64:67], v[104:107], a[60:63]
  ds_read_b64_tr_b16 v[104:105], v21 offset:49152
  v_mfma_f32_16x16x32_bf16 a[64:67], v[36:39], v[108:111], a[64:67]
  ds_read_b64_tr_b16 v[106:107], v21 offset:51200
  v_mfma_f32_16x16x32_bf16 a[68:71], v[40:43], v[108:111], a[68:71]
  v_mfma_f32_16x16x32_bf16 a[72:75], v[44:47], v[108:111], a[72:75]
  v_mfma_f32_16x16x32_bf16 a[76:79], v[48:51], v[108:111], a[76:79]
  v_mfma_f32_16x16x32_bf16 a[80:83], v[52:55], v[108:111], a[80:83]
  ds_read_b128 v[80:83], v19 offset:38912
  v_mfma_f32_16x16x32_bf16 a[84:87], v[56:59], v[108:111], a[84:87]
  v_mfma_f32_16x16x32_bf16 a[88:91], v[60:63], v[108:111], a[88:91]
  v_mfma_f32_16x16x32_bf16 a[92:95], v[64:67], v[108:111], a[92:95]
  ds_read_b64_tr_b16 v[108:109], v22 offset:49152
  v_mfma_f32_16x16x32_bf16 a[96:99], v[36:39], v[112:115], a[96:99]
  ds_read_b64_tr_b16 v[110:111], v22 offset:51200
  v_mfma_f32_16x16x32_bf16 a[100:103], v[40:43], v[112:115], a[100:103]
  v_mfma_f32_16x16x32_bf16 a[104:107], v[44:47], v[112:115], a[104:107]
  ds_read_b128 v[84:87], v19 offset:40960
  v_mfma_f32_16x16x32_bf16 a[108:111], v[48:51], v[112:115], a[108:111]
  v_mfma_f32_16x16x32_bf16 a[112:115], v[52:55], v[112:115], a[112:115]
  v_mfma_f32_16x16x32_bf16 a[116:119], v[56:59], v[112:115], a[116:119]
  v_mfma_f32_16x16x32_bf16 a[120:123], v[60:63], v[112:115], a[120:123]
  v_mfma_f32_16x16x32_bf16 a[124:127], v[64:67], v[112:115], a[124:127]
  ds_read_b64_tr_b16 v[112:113], v23 offset:49152
  v_mfma_f32_16x16x32_bf16 a[128:131], v[36:39], v[116:119], a[128:131]
  ds_read_b64_tr_b16 v[114:115], v23 offset:51200
  ds_read_b128 v[88:91], v19 offset:43008
  v_mfma_f32_16x16x32_bf16 a[132:135], v[40:43], v[116:119], a[132:135]
  v_mfma_f32_16x16x32_bf16 a[136:139], v[44:47], v[116:119], a[136:139]
  v_mfma_f32_16x16x32_bf16 a[140:143], v[48:51], v[116:119], a[140:143]
  v_mfma_f32_16x16x32_bf16 a[144:147], v[52:55], v[116:119], a[144:147]
  v_mfma_f32_16x16x32_bf16 a[148:151], v[56:59], v[116:119], a[148:151]
  v_mfma_f32_16x16x32_bf16 a[152:155], v[60:63], v[116:119], a[152:155]
  ds_read_b128 v[92:95], v19 offset:45056
  v_mfma_f32_16x16x32_bf16 a[156:159], v[64:67], v[116:119], a[156:159]
  ds_read_b64_tr_b16 v[116:117], v24 offset:49152
  v_mfma_f32_16x16x32_bf16 a[160:163], v[36:39], v[120:123], a[160:163]
  ds_read_b64_tr_b16 v[118:119], v24 offset:51200
  v_mfma_f32_16x16x32_bf16 a[164:167], v[40:43], v[120:123], a[164:167]
  v_mfma_f32_16x16x32_bf16 a[168:171], v[44:47], v[120:123], a[168:171]
  v_mfma_f32_16x16x32_bf16 a[172:175], v[48:51], v[120:123], a[172:175]
  v_mfma_f32_16x16x32_bf16 a[176:179], v[52:55], v[120:123], a[176:179]
  ds_read_b128 v[96:99], v19 offset:47104
  v_mfma_f32_16x16x32_bf16 a[180:183], v[56:59], v[120:123], a[180:183]
  v_mfma_f32_16x16x32_bf16 a[184:187], v[60:63], v[120:123], a[184:187]
  v_mfma_f32_16x16x32_bf16 a[188:191], v[64:67], v[120:123], a[188:191]
  ds_read_b64_tr_b16 v[120:121], v25 offset:49152
  v_mfma_f32_16x16x32_bf16 a[192:195], v[36:39], v[124:127], a[192:195]
  ds_read_b64_tr_b16 v[122:123], v25 offset:51200
  v_mfma_f32_16x16x32_bf16 a[196:199], v[40:43], v[124:127], a[196:199]
  v_mfma_f32_16x16x32_bf16 a[200:203], v[44:47], v[124:127], a[200:203]
  v_mfma_f32_16x16x32_bf16 a[204:207], v[48:51], v[124:127], a[204:207]
  v_mfma_f32_16x16x32_bf16 a[208:211], v[52:55], v[124:127], a[208:211]
  v_mfma_f32_16x16x32_bf16 a[212:215], v[56:59], v[124:127], a[212:215]
  v_mfma_f32_16x16x32_bf16 a[216:219], v[60:63], v[124:127], a[216:219]
  v_mfma_f32_16x16x32_bf16 a[220:223], v[64:67], v[124:127], a[220:223]
  ds_read_b64_tr_b16 v[124:125], v26 offset:49152
s_waitcnt lgkmcnt(15)
  v_mfma_f32_16x16x32_bf16 a[224:227], v[36:39], v[128:131], a[224:227]
  ds_read_b64_tr_b16 v[126:127], v26 offset:51200
  v_mfma_f32_16x16x32_bf16 a[228:231], v[40:43], v[128:131], a[228:231]
  v_mfma_f32_16x16x32_bf16 a[232:235], v[44:47], v[128:131], a[232:235]
  v_mfma_f32_16x16x32_bf16 a[236:239], v[48:51], v[128:131], a[236:239]
  v_mfma_f32_16x16x32_bf16 a[240:243], v[52:55], v[128:131], a[240:243]
  v_mfma_f32_16x16x32_bf16 a[244:247], v[56:59], v[128:131], a[244:247]
  v_mfma_f32_16x16x32_bf16 a[248:251], v[60:63], v[128:131], a[248:251]
  v_mfma_f32_16x16x32_bf16 a[252:255], v[64:67], v[128:131], a[252:255]
  ds_read_b64_tr_b16 v[128:129], v27 offset:49152
  ds_read_b64_tr_b16 v[130:131], v27 offset:51200
  s_waitcnt lgkmcnt(2)
  v_mfma_f32_16x16x32_bf16 a[0:3], v[68:71], v[100:103], a[0:3]
  v_mfma_f32_16x16x32_bf16 a[4:7], v[72:75], v[100:103], a[4:7]
  v_mfma_f32_16x16x32_bf16 a[8:11], v[76:79], v[100:103], a[8:11]
  v_mfma_f32_16x16x32_bf16 a[12:15], v[80:83], v[100:103], a[12:15]
  v_mfma_f32_16x16x32_bf16 a[16:19], v[84:87], v[100:103], a[16:19]
  v_mfma_f32_16x16x32_bf16 a[20:23], v[88:91], v[100:103], a[20:23]
  v_mfma_f32_16x16x32_bf16 a[24:27], v[92:95], v[100:103], a[24:27]
  v_mfma_f32_16x16x32_bf16 a[28:31], v[96:99], v[100:103], a[28:31]
  v_mfma_f32_16x16x32_bf16 a[32:35], v[68:71], v[104:107], a[32:35]
  v_mfma_f32_16x16x32_bf16 a[36:39], v[72:75], v[104:107], a[36:39]
  s_waitcnt vmcnt(0) lgkmcnt(0)
  s_barrier
  v_mfma_f32_16x16x32_bf16 a[40:43], v[76:79], v[104:107], a[40:43]
  ds_read_b64_tr_b16 v[100:101], v20 offset:0
  v_mfma_f32_16x16x32_bf16 a[44:47], v[80:83], v[104:107], a[44:47]
  s_add_u32 m0, s22, 32768
s_nop 0
  buffer_load_dwordx4 v2, s[8:11], s20 offen offset:0 lds
  ds_read_b64_tr_b16 v[102:103], v20 offset:2048
  v_mfma_f32_16x16x32_bf16 a[48:51], v[84:87], v[104:107], a[48:51]
  ds_read_b128 v[36:39], v18 offset:0
  v_mfma_f32_16x16x32_bf16 a[52:55], v[88:91], v[104:107], a[52:55]
  v_mfma_f32_16x16x32_bf16 a[56:59], v[92:95], v[104:107], a[56:59]
  buffer_load_dwordx4 v3, s[8:11], s20 offen offset:1024 lds
  v_mfma_f32_16x16x32_bf16 a[60:63], v[96:99], v[104:107], a[60:63]
  ds_read_b64_tr_b16 v[104:105], v21 offset:0
  v_mfma_f32_16x16x32_bf16 a[64:67], v[68:71], v[108:111], a[64:67]
  ds_read_b64_tr_b16 v[106:107], v21 offset:2048
  ds_read_b128 v[40:43], v18 offset:2048
  v_mfma_f32_16x16x32_bf16 a[68:71], v[72:75], v[108:111], a[68:71]
  buffer_load_dwordx4 v4, s[8:11], s20 offen offset:2048 lds
  v_mfma_f32_16x16x32_bf16 a[72:75], v[76:79], v[108:111], a[72:75]
  v_mfma_f32_16x16x32_bf16 a[76:79], v[80:83], v[108:111], a[76:79]
  v_mfma_f32_16x16x32_bf16 a[80:83], v[84:87], v[108:111], a[80:83]
  buffer_load_dwordx4 v5, s[8:11], s20 offen offset:3072 lds
  v_mfma_f32_16x16x32_bf16 a[84:87], v[88:91], v[108:111], a[84:87]
  ds_read_b128 v[44:47], v18 offset:4096
  v_mfma_f32_16x16x32_bf16 a[88:91], v[92:95], v[108:111], a[88:91]
  v_mfma_f32_16x16x32_bf16 a[92:95], v[96:99], v[108:111], a[92:95]
  s_add_u32 m0, s23, 32768
s_nop 0
  buffer_load_dwordx4 v10, s[12:15], s21 offen offset:0 lds
  ds_read_b64_tr_b16 v[108:109], v22 offset:0
  v_mfma_f32_16x16x32_bf16 a[96:99], v[68:71], v[112:115], a[96:99]
  ds_read_b64_tr_b16 v[110:111], v22 offset:2048
  v_mfma_f32_16x16x32_bf16 a[100:103], v[72:75], v[112:115], a[100:103]
  v_mfma_f32_16x16x32_bf16 a[104:107], v[76:79], v[112:115], a[104:107]
  buffer_load_dwordx4 v11, s[12:15], s21 offen offset:1024 lds
  ds_read_b128 v[48:51], v18 offset:6144
  v_mfma_f32_16x16x32_bf16 a[108:111], v[80:83], v[112:115], a[108:111]
  v_mfma_f32_16x16x32_bf16 a[112:115], v[84:87], v[112:115], a[112:115]
  v_mfma_f32_16x16x32_bf16 a[116:119], v[88:91], v[112:115], a[116:119]
  buffer_load_dwordx4 v12, s[12:15], s21 offen offset:2048 lds
  v_mfma_f32_16x16x32_bf16 a[120:123], v[92:95], v[112:115], a[120:123]
  v_mfma_f32_16x16x32_bf16 a[124:127], v[96:99], v[112:115], a[124:127]
  ds_read_b64_tr_b16 v[112:113], v23 offset:0
  ds_read_b128 v[52:55], v18 offset:8192
  v_mfma_f32_16x16x32_bf16 a[128:131], v[68:71], v[116:119], a[128:131]
  buffer_load_dwordx4 v13, s[12:15], s21 offen offset:3072 lds
  ds_read_b64_tr_b16 v[114:115], v23 offset:2048
  v_mfma_f32_16x16x32_bf16 a[132:135], v[72:75], v[116:119], a[132:135]
  v_mfma_f32_16x16x32_bf16 a[136:139], v[76:79], v[116:119], a[136:139]
  v_mfma_f32_16x16x32_bf16 a[140:143], v[80:83], v[116:119], a[140:143]
  s_add_u32 m0, s22, 36864
s_nop 0
  buffer_load_dwordx4 v6, s[8:11], s20 offen offset:0 lds
  ds_read_b128 v[56:59], v18 offset:10240
  v_mfma_f32_16x16x32_bf16 a[144:147], v[84:87], v[116:119], a[144:147]
  v_mfma_f32_16x16x32_bf16 a[148:151], v[88:91], v[116:119], a[148:151]
  v_mfma_f32_16x16x32_bf16 a[152:155], v[92:95], v[116:119], a[152:155]
  buffer_load_dwordx4 v7, s[8:11], s20 offen offset:1024 lds
  v_mfma_f32_16x16x32_bf16 a[156:159], v[96:99], v[116:119], a[156:159]
  ds_read_b64_tr_b16 v[116:117], v24 offset:0
  v_mfma_f32_16x16x32_bf16 a[160:163], v[68:71], v[120:123], a[160:163]
  ds_read_b64_tr_b16 v[118:119], v24 offset:2048
  ds_read_b128 v[60:63], v18 offset:12288
  v_mfma_f32_16x16x32_bf16 a[164:167], v[72:75], v[120:123], a[164:167]
  buffer_load_dwordx4 v8, s[8:11], s20 offen offset:2048 lds
  v_mfma_f32_16x16x32_bf16 a[168:171], v[76:79], v[120:123], a[168:171]
  v_mfma_f32_16x16x32_bf16 a[172:175], v[80:83], v[120:123], a[172:175]
  v_mfma_f32_16x16x32_bf16 a[176:179], v[84:87], v[120:123], a[176:179]
  buffer_load_dwordx4 v9, s[8:11], s20 offen offset:3072 lds
  v_mfma_f32_16x16x32_bf16 a[180:183], v[88:91], v[120:123], a[180:183]
  ds_read_b128 v[64:67], v18 offset:14336
  v_mfma_f32_16x16x32_bf16 a[184:187], v[92:95], v[120:123], a[184:187]
  v_mfma_f32_16x16x32_bf16 a[188:191], v[96:99], v[120:123], a[188:191]
  s_add_u32 m0, s23, 36864
s_nop 0
  buffer_load_dwordx4 v14, s[12:15], s21 offen offset:0 lds
  ds_read_b64_tr_b16 v[120:121], v25 offset:0
  v_mfma_f32_16x16x32_bf16 a[192:195], v[68:71], v[124:127], a[192:195]
  ds_read_b64_tr_b16 v[122:123], v25 offset:2048
  v_mfma_f32_16x16x32_bf16 a[196:199], v[72:75], v[124:127], a[196:199]
  v_mfma_f32_16x16x32_bf16 a[200:203], v[76:79], v[124:127], a[200:203]
  buffer_load_dwordx4 v15, s[12:15], s21 offen offset:1024 lds
  v_mfma_f32_16x16x32_bf16 a[204:207], v[80:83], v[124:127], a[204:207]
  v_mfma_f32_16x16x32_bf16 a[208:211], v[84:87], v[124:127], a[208:211]
  v_mfma_f32_16x16x32_bf16 a[212:215], v[88:91], v[124:127], a[212:215]
  buffer_load_dwordx4 v16, s[12:15], s21 offen offset:2048 lds
  v_mfma_f32_16x16x32_bf16 a[216:219], v[92:95], v[124:127], a[216:219]
  v_mfma_f32_16x16x32_bf16 a[220:223], v[96:99], v[124:127], a[220:223]
  ds_read_b64_tr_b16 v[124:125], v26 offset:0
  v_mfma_f32_16x16x32_bf16 a[224:227], v[68:71], v[128:131], a[224:227]
  buffer_load_dwordx4 v17, s[12:15], s21 offen offset:3072 lds
  s_add_u32 s20, s20, 128
  s_add_u32 s21, s21, 524288
  ds_read_b64_tr_b16 v[126:127], v26 offset:2048
  v_mfma_f32_16x16x32_bf16 a[228:231], v[72:75], v[128:131], a[228:231]
  v_mfma_f32_16x16x32_bf16 a[232:235], v[76:79], v[128:131], a[232:235]
  v_mfma_f32_16x16x32_bf16 a[236:239], v[80:83], v[128:131], a[236:239]
  v_mfma_f32_16x16x32_bf16 a[240:243], v[84:87], v[128:131], a[240:243]
  v_mfma_f32_16x16x32_bf16 a[244:247], v[88:91], v[128:131], a[244:247]
  v_mfma_f32_16x16x32_bf16 a[248:251], v[92:95], v[128:131], a[248:251]
  v_mfma_f32_16x16x32_bf16 a[252:255], v[96:99], v[128:131], a[252:255]
  ds_read_b64_tr_b16 v[128:129], v27 offset:0
  ds_read_b64_tr_b16 v[130:131], v27 offset:2048
  s_waitcnt lgkmcnt(2)
  v_mfma_f32_16x16x32_bf16 a[0:3], v[36:39], v[100:103], a[0:3]
  v_mfma_f32_16x16x32_bf16 a[4:7], v[40:43], v[100:103], a[4:7]
  v_mfma_f32_16x16x32_bf16 a[8:11], v[44:47], v[100:103], a[8:11]
  ds_read_b128 v[68:71], v19 offset:0
  v_mfma_f32_16x16x32_bf16 a[12:15], v[48:51], v[100:103], a[12:15]
  v_mfma_f32_16x16x32_bf16 a[16:19], v[52:55], v[100:103], a[16:19]
  v_mfma_f32_16x16x32_bf16 a[20:23], v[56:59], v[100:103], a[20:23]
  v_mfma_f32_16x16x32_bf16 a[24:27], v[60:63], v[100:103], a[24:27]
  v_mfma_f32_16x16x32_bf16 a[28:31], v[64:67], v[100:103], a[28:31]
  ds_read_b64_tr_b16 v[100:101], v20 offset:16384
  v_mfma_f32_16x16x32_bf16 a[32:35], v[36:39], v[104:107], a[32:35]
  ds_read_b64_tr_b16 v[102:103], v20 offset:18432
  ds_read_b128 v[72:75], v19 offset:2048
  v_mfma_f32_16x16x32_bf16 a[36:39], v[40:43], v[104:107], a[36:39]
  v_mfma_f32_16x16x32_bf16 a[40:43], v[44:47], v[104:107], a[40:43]
  v_mfma_f32_16x16x32_bf16 a[44:47], v[48:51], v[104:107], a[44:47]
  v_mfma_f32_16x16x32_bf16 a[48:51], v[52:55], v[104:107], a[48:51]
  v_mfma_f32_16x16x32_bf16 a[52:55], v[56:59], v[104:107], a[52:55]
  v_mfma_f32_16x16x32_bf16 a[56:59], v[60:63], v[104:107], a[56:59]
  ds_read_b128 v[76:79], v19 offset:4096
  v_mfma_f32_16x16x32_bf16 a[60:63], v[64:67], v[104:107], a[60:63]
  ds_read_b64_tr_b16 v[104:105], v21 offset:16384
  v_mfma_f32_16x16x32_bf16 a[64:67], v[36:39], v[108:111], a[64:67]
  ds_read_b64_tr_b16 v[106:107], v21 offset:18432
  v_mfma_f32_16x16x32_bf16 a[68:71], v[40:43], v[108:111], a[68:71]
  v_mfma_f32_16x16x32_bf16 a[72:75], v[44:47], v[108:111], a[72:75]
  v_mfma_f32_16x16x32_bf16 a[76:79], v[48:51], v[108:111], a[76:79]
  v_mfma_f32_16x16x32_bf16 a[80:83], v[52:55], v[108:111], a[80:83]
  ds_read_b128 v[80:83], v19 offset:6144
  v_mfma_f32_16x16x32_bf16 a[84:87], v[56:59], v[108:111], a[84:87]
  v_mfma_f32_16x16x32_bf16 a[88:91], v[60:63], v[108:111], a[88:91]
  v_mfma_f32_16x16x32_bf16 a[92:95], v[64:67], v[108:111], a[92:95]
  ds_read_b64_tr_b16 v[108:109], v22 offset:16384
  v_mfma_f32_16x16x32_bf16 a[96:99], v[36:39], v[112:115], a[96:99]
  ds_read_b64_tr_b16 v[110:111], v22 offset:18432
  v_mfma_f32_16x16x32_bf16 a[100:103], v[40:43], v[112:115], a[100:103]
  v_mfma_f32_16x16x32_bf16 a[104:107], v[44:47], v[112:115], a[104:107]
  ds_read_b128 v[84:87], v19 offset:8192
  v_mfma_f32_16x16x32_bf16 a[108:111], v[48:51], v[112:115], a[108:111]
  v_mfma_f32_16x16x32_bf16 a[112:115], v[52:55], v[112:115], a[112:115]
  v_mfma_f32_16x16x32_bf16 a[116:119], v[56:59], v[112:115], a[116:119]
  v_mfma_f32_16x16x32_bf16 a[120:123], v[60:63], v[112:115], a[120:123]
  v_mfma_f32_16x16x32_bf16 a[124:127], v[64:67], v[112:115], a[124:127]
  ds_read_b64_tr_b16 v[112:113], v23 offset:16384
  v_mfma_f32_16x16x32_bf16 a[128:131], v[36:39], v[116:119], a[128:131]
  ds_read_b64_tr_b16 v[114:115], v23 offset:18432
  ds_read_b128 v[88:91], v19 offset:10240
  v_mfma_f32_16x16x32_bf16 a[132:135], v[40:43], v[116:119], a[132:135]
  v_mfma_f32_16x16x32_bf16 a[136:139], v[44:47], v[116:119], a[136:139]
  v_mfma_f32_16x16x32_bf16 a[140:143], v[48:51], v[116:119], a[140:143]
  v_mfma_f32_16x16x32_bf16 a[144:147], v[52:55], v[116:119], a[144:147]
  v_mfma_f32_16x16x32_bf16 a[148:151], v[56:59], v[116:119], a[148:151]
  v_mfma_f32_16x16x32_bf16 a[152:155], v[60:63], v[116:119], a[152:155]
  ds_read_b128 v[92:95], v19 offset:12288
  v_mfma_f32_16x16x32_bf16 a[156:159], v[64:67], v[116:119], a[156:159]
  ds_read_b64_tr_b16 v[116:117], v24 offset:16384
  v_mfma_f32_16x16x32_bf16 a[160:163], v[36:39], v[120:123], a[160:163]
  ds_read_b64_tr_b16 v[118:119], v24 offset:18432
  v_mfma_f32_16x16x32_bf16 a[164:167], v[40:43], v[120:123], a[164:167]
  v_mfma_f32_16x16x32_bf16 a[168:171], v[44:47], v[120:123], a[168:171]
  v_mfma_f32_16x16x32_bf16 a[172:175], v[48:51], v[120:123], a[172:175]
  v_mfma_f32_16x16x32_bf16 a[176:179], v[52:55], v[120:123], a[176:179]
  ds_read_b128 v[96:99], v19 offset:14336
  v_mfma_f32_16x16x32_bf16 a[180:183], v[56:59], v[120:123], a[180:183]
  v_mfma_f32_16x16x32_bf16 a[184:187], v[60:63], v[120:123], a[184:187]
  v_mfma_f32_16x16x32_bf16 a[188:191], v[64:67], v[120:123], a[188:191]
  ds_read_b64_tr_b16 v[120:121], v25 offset:16384
  v_mfma_f32_16x16x32_bf16 a[192:195], v[36:39], v[124:127], a[192:195]
  ds_read_b64_tr_b16 v[122:123], v25 offset:18432
  v_mfma_f32_16x16x32_bf16 a[196:199], v[40:43], v[124:127], a[196:199]
  v_mfma_f32_16x16x32_bf16 a[200:203], v[44:47], v[124:127], a[200:203]
  v_mfma_f32_16x16x32_bf16 a[204:207], v[48:51], v[124:127], a[204:207]
  v_mfma_f32_16x16x32_bf16 a[208:211], v[52:55], v[124:127], a[208:211]
  v_mfma_f32_16x16x32_bf16 a[212:215], v[56:59], v[124:127], a[212:215]
  v_mfma_f32_16x16x32_bf16 a[216:219], v[60:63], v[124:127], a[216:219]
  v_mfma_f32_16x16x32_bf16 a[220:223], v[64:67], v[124:127], a[220:223]
  ds_read_b64_tr_b16 v[124:125], v26 offset:16384
s_waitcnt lgkmcnt(15)
  v_mfma_f32_16x16x32_bf16 a[224:227], v[36:39], v[128:131], a[224:227]
  ds_read_b64_tr_b16 v[126:127], v26 offset:18432
  v_mfma_f32_16x16x32_bf16 a[228:231], v[40:43], v[128:131], a[228:231]
  v_mfma_f32_16x16x32_bf16 a[232:235], v[44:47], v[128:131], a[232:235]
  v_mfma_f32_16x16x32_bf16 a[236:239], v[48:51], v[128:131], a[236:239]
  v_mfma_f32_16x16x32_bf16 a[240:243], v[52:55], v[128:131], a[240:243]
  v_mfma_f32_16x16x32_bf16 a[244:247], v[56:59], v[128:131], a[244:247]
  v_mfma_f32_16x16x32_bf16 a[248:251], v[60:63], v[128:131], a[248:251]
  v_mfma_f32_16x16x32_bf16 a[252:255], v[64:67], v[128:131], a[252:255]
  ds_read_b64_tr_b16 v[128:129], v27 offset:16384
  ds_read_b64_tr_b16 v[130:131], v27 offset:18432
  s_waitcnt lgkmcnt(2)
  v_mfma_f32_16x16x32_bf16 a[0:3], v[68:71], v[100:103], a[0:3]
  v_mfma_f32_16x16x32_bf16 a[4:7], v[72:75], v[100:103], a[4:7]
  v_mfma_f32_16x16x32_bf16 a[8:11], v[76:79], v[100:103], a[8:11]
  v_mfma_f32_16x16x32_bf16 a[12:15], v[80:83], v[100:103], a[12:15]
  v_mfma_f32_16x16x32_bf16 a[16:19], v[84:87], v[100:103], a[16:19]
  v_mfma_f32_16x16x32_bf16 a[20:23], v[88:91], v[100:103], a[20:23]
  v_mfma_f32_16x16x32_bf16 a[24:27], v[92:95], v[100:103], a[24:27]
  v_mfma_f32_16x16x32_bf16 a[28:31], v[96:99], v[100:103], a[28:31]
  v_mfma_f32_16x16x32_bf16 a[32:35], v[68:71], v[104:107], a[32:35]
  v_mfma_f32_16x16x32_bf16 a[36:39], v[72:75], v[104:107], a[36:39]
  s_waitcnt vmcnt(0) lgkmcnt(0)
  s_barrier
  v_mfma_f32_16x16x32_bf16 a[40:43], v[76:79], v[104:107], a[40:43]
  ds_read_b64_tr_b16 v[100:101], v20 offset:32768
  v_mfma_f32_16x16x32_bf16 a[44:47], v[80:83], v[104:107], a[44:47]
  ds_read_b64_tr_b16 v[102:103], v20 offset:34816
  v_mfma_f32_16x16x32_bf16 a[48:51], v[84:87], v[104:107], a[48:51]
  ds_read_b128 v[36:39], v18 offset:32768
  v_mfma_f32_16x16x32_bf16 a[52:55], v[88:91], v[104:107], a[52:55]
  v_mfma_f32_16x16x32_bf16 a[56:59], v[92:95], v[104:107], a[56:59]
  v_mfma_f32_16x16x32_bf16 a[60:63], v[96:99], v[104:107], a[60:63]
  ds_read_b64_tr_b16 v[104:105], v21 offset:32768
  v_mfma_f32_16x16x32_bf16 a[64:67], v[68:71], v[108:111], a[64:67]
  ds_read_b64_tr_b16 v[106:107], v21 offset:34816
  ds_read_b128 v[40:43], v18 offset:34816
  v_mfma_f32_16x16x32_bf16 a[68:71], v[72:75], v[108:111], a[68:71]
  v_mfma_f32_16x16x32_bf16 a[72:75], v[76:79], v[108:111], a[72:75]
  v_mfma_f32_16x16x32_bf16 a[76:79], v[80:83], v[108:111], a[76:79]
  v_mfma_f32_16x16x32_bf16 a[80:83], v[84:87], v[108:111], a[80:83]
  v_mfma_f32_16x16x32_bf16 a[84:87], v[88:91], v[108:111], a[84:87]
  ds_read_b128 v[44:47], v18 offset:36864
  v_mfma_f32_16x16x32_bf16 a[88:91], v[92:95], v[108:111], a[88:91]
  v_mfma_f32_16x16x32_bf16 a[92:95], v[96:99], v[108:111], a[92:95]
  ds_read_b64_tr_b16 v[108:109], v22 offset:32768
  v_mfma_f32_16x16x32_bf16 a[96:99], v[68:71], v[112:115], a[96:99]
  ds_read_b64_tr_b16 v[110:111], v22 offset:34816
  v_mfma_f32_16x16x32_bf16 a[100:103], v[72:75], v[112:115], a[100:103]
  v_mfma_f32_16x16x32_bf16 a[104:107], v[76:79], v[112:115], a[104:107]
  ds_read_b128 v[48:51], v18 offset:38912
  v_mfma_f32_16x16x32_bf16 a[108:111], v[80:83], v[112:115], a[108:111]
  v_mfma_f32_16x16x32_bf16 a[112:115], v[84:87], v[112:115], a[112:115]
  v_mfma_f32_16x16x32_bf16 a[116:119], v[88:91], v[112:115], a[116:119]
  v_mfma_f32_16x16x32_bf16 a[120:123], v[92:95], v[112:115], a[120:123]
  v_mfma_f32_16x16x32_bf16 a[124:127], v[96:99], v[112:115], a[124:127]
  ds_read_b64_tr_b16 v[112:113], v23 offset:32768
  ds_read_b128 v[52:55], v18 offset:40960
  v_mfma_f32_16x16x32_bf16 a[128:131], v[68:71], v[116:119], a[128:131]
  ds_read_b64_tr_b16 v[114:115], v23 offset:34816
  v_mfma_f32_16x16x32_bf16 a[132:135], v[72:75], v[116:119], a[132:135]
  v_mfma_f32_16x16x32_bf16 a[136:139], v[76:79], v[116:119], a[136:139]
  v_mfma_f32_16x16x32_bf16 a[140:143], v[80:83], v[116:119], a[140:143]
  ds_read_b128 v[56:59], v18 offset:43008
  v_mfma_f32_16x16x32_bf16 a[144:147], v[84:87], v[116:119], a[144:147]
  v_mfma_f32_16x16x32_bf16 a[148:151], v[88:91], v[116:119], a[148:151]
  v_mfma_f32_16x16x32_bf16 a[152:155], v[92:95], v[116:119], a[152:155]
  v_mfma_f32_16x16x32_bf16 a[156:159], v[96:99], v[116:119], a[156:159]
  ds_read_b64_tr_b16 v[116:117], v24 offset:32768
  v_mfma_f32_16x16x32_bf16 a[160:163], v[68:71], v[120:123], a[160:163]
  ds_read_b64_tr_b16 v[118:119], v24 offset:34816
  ds_read_b128 v[60:63], v18 offset:45056
  v_mfma_f32_16x16x32_bf16 a[164:167], v[72:75], v[120:123], a[164:167]
  v_mfma_f32_16x16x32_bf16 a[168:171], v[76:79], v[120:123], a[168:171]
  v_mfma_f32_16x16x32_bf16 a[172:175], v[80:83], v[120:123], a[172:175]
  v_mfma_f32_16x16x32_bf16 a[176:179], v[84:87], v[120:123], a[176:179]
  v_mfma_f32_16x16x32_bf16 a[180:183], v[88:91], v[120:123], a[180:183]
  ds_read_b128 v[64:67], v18 offset:47104
  v_mfma_f32_16x16x32_bf16 a[184:187], v[92:95], v[120:123], a[184:187]
  v_mfma_f32_16x16x32_bf16 a[188:191], v[96:99], v[120:123], a[188:191]
  ds_read_b64_tr_b16 v[120:121], v25 offset:32768
  v_mfma_f32_16x16x32_bf16 a[192:195], v[68:71], v[124:127], a[192:195]
  ds_read_b64_tr_b16 v[122:123], v25 offset:34816
  v_mfma_f32_16x16x32_bf16 a[196:199], v[72:75], v[124:127], a[196:199]
  v_mfma_f32_16x16x32_bf16 a[200:203], v[76:79], v[124:127], a[200:203]
  v_mfma_f32_16x16x32_bf16 a[204:207], v[80:83], v[124:127], a[204:207]
  v_mfma_f32_16x16x32_bf16 a[208:211], v[84:87], v[124:127], a[208:211]
  v_mfma_f32_16x16x32_bf16 a[212:215], v[88:91], v[124:127], a[212:215]
  v_mfma_f32_16x16x32_bf16 a[216:219], v[92:95], v[124:127], a[216:219]
  v_mfma_f32_16x16x32_bf16 a[220:223], v[96:99], v[124:127], a[220:223]
  ds_read_b64_tr_b16 v[124:125], v26 offset:32768
  v_mfma_f32_16x16x32_bf16 a[224:227], v[68:71], v[128:131], a[224:227]
  ds_read_b64_tr_b16 v[126:127], v26 offset:34816
  v_mfma_f32_16x16x32_bf16 a[228:231], v[72:75], v[128:131], a[228:231]
  v_mfma_f32_16x16x32_bf16 a[232:235], v[76:79], v[128:131], a[232:235]
  v_mfma_f32_16x16x32_bf16 a[236:239], v[80:83], v[128:131], a[236:239]
  v_mfma_f32_16x16x32_bf16 a[240:243], v[84:87], v[128:131], a[240:243]
  v_mfma_f32_16x16x32_bf16 a[244:247], v[88:91], v[128:131], a[244:247]
  v_mfma_f32_16x16x32_bf16 a[248:251], v[92:95], v[128:131], a[248:251]
  v_mfma_f32_16x16x32_bf16 a[252:255], v[96:99], v[128:131], a[252:255]
  ds_read_b64_tr_b16 v[128:129], v27 offset:32768
  ds_read_b64_tr_b16 v[130:131], v27 offset:34816
  s_waitcnt lgkmcnt(2)
  v_mfma_f32_16x16x32_bf16 a[0:3], v[36:39], v[100:103], a[0:3]
  v_mfma_f32_16x16x32_bf16 a[4:7], v[40:43], v[100:103], a[4:7]
  v_mfma_f32_16x16x32_bf16 a[8:11], v[44:47], v[100:103], a[8:11]
  ds_read_b128 v[68:71], v19 offset:32768
  v_mfma_f32_16x16x32_bf16 a[12:15], v[48:51], v[100:103], a[12:15]
  v_mfma_f32_16x16x32_bf16 a[16:19], v[52:55], v[100:103], a[16:19]
  v_mfma_f32_16x16x32_bf16 a[20:23], v[56:59], v[100:103], a[20:23]
  v_mfma_f32_16x16x32_bf16 a[24:27], v[60:63], v[100:103], a[24:27]
  v_mfma_f32_16x16x32_bf16 a[28:31], v[64:67], v[100:103], a[28:31]
  ds_read_b64_tr_b16 v[100:101], v20 offset:49152
  v_mfma_f32_16x16x32_bf16 a[32:35], v[36:39], v[104:107], a[32:35]
  ds_read_b64_tr_b16 v[102:103], v20 offset:51200
  ds_read_b128 v[72:75], v19 offset:34816
  v_mfma_f32_16x16x32_bf16 a[36:39], v[40:43], v[104:107], a[36:39]
  v_mfma_f32_16x16x32_bf16 a[40:43], v[44:47], v[104:107], a[40:43]
  v_mfma_f32_16x16x32_bf16 a[44:47], v[48:51], v[104:107], a[44:47]
  v_mfma_f32_16x16x32_bf16 a[48:51], v[52:55], v[104:107], a[48:51]
  v_mfma_f32_16x16x32_bf16 a[52:55], v[56:59], v[104:107], a[52:55]
  v_mfma_f32_16x16x32_bf16 a[56:59], v[60:63], v[104:107], a[56:59]
  ds_read_b128 v[76:79], v19 offset:36864
  v_mfma_f32_16x16x32_bf16 a[60:63], v[64:67], v[104:107], a[60:63]
  ds_read_b64_tr_b16 v[104:105], v21 offset:49152
  v_mfma_f32_16x16x32_bf16 a[64:67], v[36:39], v[108:111], a[64:67]
  ds_read_b64_tr_b16 v[106:107], v21 offset:51200
  v_mfma_f32_16x16x32_bf16 a[68:71], v[40:43], v[108:111], a[68:71]
  v_mfma_f32_16x16x32_bf16 a[72:75], v[44:47], v[108:111], a[72:75]
  v_mfma_f32_16x16x32_bf16 a[76:79], v[48:51], v[108:111], a[76:79]
  v_mfma_f32_16x16x32_bf16 a[80:83], v[52:55], v[108:111], a[80:83]
  ds_read_b128 v[80:83], v19 offset:38912
  v_mfma_f32_16x16x32_bf16 a[84:87], v[56:59], v[108:111], a[84:87]
  v_mfma_f32_16x16x32_bf16 a[88:91], v[60:63], v[108:111], a[88:91]
  v_mfma_f32_16x16x32_bf16 a[92:95], v[64:67], v[108:111], a[92:95]
  ds_read_b64_tr_b16 v[108:109], v22 offset:49152
  v_mfma_f32_16x16x32_bf16 a[96:99], v[36:39], v[112:115], a[96:99]
  ds_read_b64_tr_b16 v[110:111], v22 offset:51200
  v_mfma_f32_16x16x32_bf16 a[100:103], v[40:43], v[112:115], a[100:103]
  v_mfma_f32_16x16x32_bf16 a[104:107], v[44:47], v[112:115], a[104:107]
  ds_read_b128 v[84:87], v19 offset:40960
  v_mfma_f32_16x16x32_bf16 a[108:111], v[48:51], v[112:115], a[108:111]
  v_mfma_f32_16x16x32_bf16 a[112:115], v[52:55], v[112:115], a[112:115]
  v_mfma_f32_16x16x32_bf16 a[116:119], v[56:59], v[112:115], a[116:119]
  v_mfma_f32_16x16x32_bf16 a[120:123], v[60:63], v[112:115], a[120:123]
  v_mfma_f32_16x16x32_bf16 a[124:127], v[64:67], v[112:115], a[124:127]
  ds_read_b64_tr_b16 v[112:113], v23 offset:49152
  v_mfma_f32_16x16x32_bf16 a[128:131], v[36:39], v[116:119], a[128:131]
  ds_read_b64_tr_b16 v[114:115], v23 offset:51200
  ds_read_b128 v[88:91], v19 offset:43008
  v_mfma_f32_16x16x32_bf16 a[132:135], v[40:43], v[116:119], a[132:135]
  v_mfma_f32_16x16x32_bf16 a[136:139], v[44:47], v[116:119], a[136:139]
  v_mfma_f32_16x16x32_bf16 a[140:143], v[48:51], v[116:119], a[140:143]
  v_mfma_f32_16x16x32_bf16 a[144:147], v[52:55], v[116:119], a[144:147]
  v_mfma_f32_16x16x32_bf16 a[148:151], v[56:59], v[116:119], a[148:151]
  v_mfma_f32_16x16x32_bf16 a[152:155], v[60:63], v[116:119], a[152:155]
  ds_read_b128 v[92:95], v19 offset:45056
  v_mfma_f32_16x16x32_bf16 a[156:159], v[64:67], v[116:119], a[156:159]
  ds_read_b64_tr_b16 v[116:117], v24 offset:49152
  v_mfma_f32_16x16x32_bf16 a[160:163], v[36:39], v[120:123], a[160:163]
  ds_read_b64_tr_b16 v[118:119], v24 offset:51200
  v_mfma_f32_16x16x32_bf16 a[164:167], v[40:43], v[120:123], a[164:167]
  v_mfma_f32_16x16x32_bf16 a[168:171], v[44:47], v[120:123], a[168:171]
  v_mfma_f32_16x16x32_bf16 a[172:175], v[48:51], v[120:123], a[172:175]
  v_mfma_f32_16x16x32_bf16 a[176:179], v[52:55], v[120:123], a[176:179]
  ds_read_b128 v[96:99], v19 offset:47104
  v_mfma_f32_16x16x32_bf16 a[180:183], v[56:59], v[120:123], a[180:183]
  v_mfma_f32_16x16x32_bf16 a[184:187], v[60:63], v[120:123], a[184:187]
  v_mfma_f32_16x16x32_bf16 a[188:191], v[64:67], v[120:123], a[188:191]
  ds_read_b64_tr_b16 v[120:121], v25 offset:49152
  v_mfma_f32_16x16x32_bf16 a[192:195], v[36:39], v[124:127], a[192:195]
  ds_read_b64_tr_b16 v[122:123], v25 offset:51200
  v_mfma_f32_16x16x32_bf16 a[196:199], v[40:43], v[124:127], a[196:199]
  v_mfma_f32_16x16x32_bf16 a[200:203], v[44:47], v[124:127], a[200:203]
  v_mfma_f32_16x16x32_bf16 a[204:207], v[48:51], v[124:127], a[204:207]
  v_mfma_f32_16x16x32_bf16 a[208:211], v[52:55], v[124:127], a[208:211]
  v_mfma_f32_16x16x32_bf16 a[212:215], v[56:59], v[124:127], a[212:215]
  v_mfma_f32_16x16x32_bf16 a[216:219], v[60:63], v[124:127], a[216:219]
  v_mfma_f32_16x16x32_bf16 a[220:223], v[64:67], v[124:127], a[220:223]
  ds_read_b64_tr_b16 v[124:125], v26 offset:49152
s_waitcnt lgkmcnt(15)
  v_mfma_f32_16x16x32_bf16 a[224:227], v[36:39], v[128:131], a[224:227]
  ds_read_b64_tr_b16 v[126:127], v26 offset:51200
  v_mfma_f32_16x16x32_bf16 a[228:231], v[40:43], v[128:131], a[228:231]
  v_mfma_f32_16x16x32_bf16 a[232:235], v[44:47], v[128:131], a[232:235]
  v_mfma_f32_16x16x32_bf16 a[236:239], v[48:51], v[128:131], a[236:239]
  v_mfma_f32_16x16x32_bf16 a[240:243], v[52:55], v[128:131], a[240:243]
  v_mfma_f32_16x16x32_bf16 a[244:247], v[56:59], v[128:131], a[244:247]
  v_mfma_f32_16x16x32_bf16 a[248:251], v[60:63], v[128:131], a[248:251]
  v_mfma_f32_16x16x32_bf16 a[252:255], v[64:67], v[128:131], a[252:255]
  ds_read_b64_tr_b16 v[128:129], v27 offset:49152
  ds_read_b64_tr_b16 v[130:131], v27 offset:51200
  s_waitcnt lgkmcnt(2)
  v_mfma_f32_16x16x32_bf16 a[0:3], v[68:71], v[100:103], a[0:3]
  v_mfma_f32_16x16x32_bf16 a[4:7], v[72:75], v[100:103], a[4:7]
  v_mfma_f32_16x16x32_bf16 a[8:11], v[76:79], v[100:103], a[8:11]
  v_mfma_f32_16x16x32_bf16 a[12:15], v[80:83], v[100:103], a[12:15]
  v_mfma_f32_16x16x32_bf16 a[16:19], v[84:87], v[100:103], a[16:19]
  v_mfma_f32_16x16x32_bf16 a[20:23], v[88:91], v[100:103], a[20:23]
  v_mfma_f32_16x16x32_bf16 a[24:27], v[92:95], v[100:103], a[24:27]
  v_mfma_f32_16x16x32_bf16 a[28:31], v[96:99], v[100:103], a[28:31]
  v_mfma_f32_16x16x32_bf16 a[32:35], v[68:71], v[104:107], a[32:35]
  v_mfma_f32_16x16x32_bf16 a[36:39], v[72:75], v[104:107], a[36:39]
  v_mfma_f32_16x16x32_bf16 a[40:43], v[76:79], v[104:107], a[40:43]
  v_mfma_f32_16x16x32_bf16 a[44:47], v[80:83], v[104:107], a[44:47]
  v_mfma_f32_16x16x32_bf16 a[48:51], v[84:87], v[104:107], a[48:51]
  v_mfma_f32_16x16x32_bf16 a[52:55], v[88:91], v[104:107], a[52:55]
  v_mfma_f32_16x16x32_bf16 a[56:59], v[92:95], v[104:107], a[56:59]
  v_mfma_f32_16x16x32_bf16 a[60:63], v[96:99], v[104:107], a[60:63]
  v_mfma_f32_16x16x32_bf16 a[64:67], v[68:71], v[108:111], a[64:67]
  v_mfma_f32_16x16x32_bf16 a[68:71], v[72:75], v[108:111], a[68:71]
  v_mfma_f32_16x16x32_bf16 a[72:75], v[76:79], v[108:111], a[72:75]
  v_mfma_f32_16x16x32_bf16 a[76:79], v[80:83], v[108:111], a[76:79]
  v_mfma_f32_16x16x32_bf16 a[80:83], v[84:87], v[108:111], a[80:83]
  v_mfma_f32_16x16x32_bf16 a[84:87], v[88:91], v[108:111], a[84:87]
  v_mfma_f32_16x16x32_bf16 a[88:91], v[92:95], v[108:111], a[88:91]
  v_mfma_f32_16x16x32_bf16 a[92:95], v[96:99], v[108:111], a[92:95]
  v_mfma_f32_16x16x32_bf16 a[96:99], v[68:71], v[112:115], a[96:99]
  v_mfma_f32_16x16x32_bf16 a[100:103], v[72:75], v[112:115], a[100:103]
  v_mfma_f32_16x16x32_bf16 a[104:107], v[76:79], v[112:115], a[104:107]
  v_mfma_f32_16x16x32_bf16 a[108:111], v[80:83], v[112:115], a[108:111]
  v_mfma_f32_16x16x32_bf16 a[112:115], v[84:87], v[112:115], a[112:115]
  v_mfma_f32_16x16x32_bf16 a[116:119], v[88:91], v[112:115], a[116:119]
  v_mfma_f32_16x16x32_bf16 a[120:123], v[92:95], v[112:115], a[120:123]
  v_mfma_f32_16x16x32_bf16 a[124:127], v[96:99], v[112:115], a[124:127]
  v_mfma_f32_16x16x32_bf16 a[128:131], v[68:71], v[116:119], a[128:131]
  v_mfma_f32_16x16x32_bf16 a[132:135], v[72:75], v[116:119], a[132:135]
  v_mfma_f32_16x16x32_bf16 a[136:139], v[76:79], v[116:119], a[136:139]
  v_mfma_f32_16x16x32_bf16 a[140:143], v[80:83], v[116:119], a[140:143]
  v_mfma_f32_16x16x32_bf16 a[144:147], v[84:87], v[116:119], a[144:147]
  v_mfma_f32_16x16x32_bf16 a[148:151], v[88:91], v[116:119], a[148:151]
  v_mfma_f32_16x16x32_bf16 a[152:155], v[92:95], v[116:119], a[152:155]
  v_mfma_f32_16x16x32_bf16 a[156:159], v[96:99], v[116:119], a[156:159]
  v_mfma_f32_16x16x32_bf16 a[160:163], v[68:71], v[120:123], a[160:163]
  v_mfma_f32_16x16x32_bf16 a[164:167], v[72:75], v[120:123], a[164:167]
  v_mfma_f32_16x16x32_bf16 a[168:171], v[76:79], v[120:123], a[168:171]
  v_mfma_f32_16x16x32_bf16 a[172:175], v[80:83], v[120:123], a[172:175]
  v_mfma_f32_16x16x32_bf16 a[176:179], v[84:87], v[120:123], a[176:179]
  v_mfma_f32_16x16x32_bf16 a[180:183], v[88:91], v[120:123], a[180:183]
  v_mfma_f32_16x16x32_bf16 a[184:187], v[92:95], v[120:123], a[184:187]
  v_mfma_f32_16x16x32_bf16 a[188:191], v[96:99], v[120:123], a[188:191]
  v_mfma_f32_16x16x32_bf16 a[192:195], v[68:71], v[124:127], a[192:195]
  v_mfma_f32_16x16x32_bf16 a[196:199], v[72:75], v[124:127], a[196:199]
  v_mfma_f32_16x16x32_bf16 a[200:203], v[76:79], v[124:127], a[200:203]
  v_mfma_f32_16x16x32_bf16 a[204:207], v[80:83], v[124:127], a[204:207]
  v_mfma_f32_16x16x32_bf16 a[208:211], v[84:87], v[124:127], a[208:211]
  v_mfma_f32_16x16x32_bf16 a[212:215], v[88:91], v[124:127], a[212:215]
  v_mfma_f32_16x16x32_bf16 a[216:219], v[92:95], v[124:127], a[216:219]
  v_mfma_f32_16x16x32_bf16 a[220:223], v[96:99], v[124:127], a[220:223]
s_waitcnt lgkmcnt(0)
  v_mfma_f32_16x16x32_bf16 a[224:227], v[68:71], v[128:131], a[224:227]
  v_mfma_f32_16x16x32_bf16 a[228:231], v[72:75], v[128:131], a[228:231]
  v_mfma_f32_16x16x32_bf16 a[232:235], v[76:79], v[128:131], a[232:235]
  v_mfma_f32_16x16x32_bf16 a[236:239], v[80:83], v[128:131], a[236:239]
  v_mfma_f32_16x16x32_bf16 a[240:243], v[84:87], v[128:131], a[240:243]
  v_mfma_f32_16x16x32_bf16 a[244:247], v[88:91], v[128:131], a[244:247]
  v_mfma_f32_16x16x32_bf16 a[248:251], v[92:95], v[128:131], a[248:251]
  v_mfma_f32_16x16x32_bf16 a[252:255], v[96:99], v[128:131], a[252:255]
  v_accvgpr_read_b32 v136, a0
  v_accvgpr_read_b32 v137, a1
  v_accvgpr_read_b32 v138, a2
  v_accvgpr_read_b32 v139, a3
  v_accvgpr_read_b32 v140, a4
  v_accvgpr_read_b32 v141, a5
  v_accvgpr_read_b32 v142, a6
  v_accvgpr_read_b32 v143, a7
  v_cvt_pk_bf16_f32 v132, v136, v137
  v_cvt_pk_bf16_f32 v133, v138, v139
  v_cvt_pk_bf16_f32 v134, v140, v141
  v_cvt_pk_bf16_f32 v135, v142, v143
  s_add_u32 s25, s24, 0
  buffer_store_dwordx4 v[132:135], v28, s[16:19], s25 offen offset:0 sc1
  v_accvgpr_read_b32 v148, a32
  v_accvgpr_read_b32 v149, a33
  v_accvgpr_read_b32 v150, a34
  v_accvgpr_read_b32 v151, a35
  v_accvgpr_read_b32 v152, a36
  v_accvgpr_read_b32 v153, a37
  v_accvgpr_read_b32 v154, a38
  v_accvgpr_read_b32 v155, a39
  v_cvt_pk_bf16_f32 v144, v148, v149
  v_cvt_pk_bf16_f32 v145, v150, v151
  v_cvt_pk_bf16_f32 v146, v152, v153
  v_cvt_pk_bf16_f32 v147, v154, v155
  s_add_u32 s25, s24, 0
  buffer_store_dwordx4 v[144:147], v28, s[16:19], s25 offen offset:256 sc1
  v_accvgpr_read_b32 v136, a64
  v_accvgpr_read_b32 v137, a65
  v_accvgpr_read_b32 v138, a66
  v_accvgpr_read_b32 v139, a67
  v_accvgpr_read_b32 v140, a68
  v_accvgpr_read_b32 v141, a69
  v_accvgpr_read_b32 v142, a70
  v_accvgpr_read_b32 v143, a71
  v_cvt_pk_bf16_f32 v132, v136, v137
  v_cvt_pk_bf16_f32 v133, v138, v139
  v_cvt_pk_bf16_f32 v134, v140, v141
  v_cvt_pk_bf16_f32 v135, v142, v143
  s_add_u32 s25, s24, 0
  buffer_store_dwordx4 v[132:135], v28, s[16:19], s25 offen offset:1024 sc1
  v_accvgpr_read_b32 v148, a96
  v_accvgpr_read_b32 v149, a97
  v_accvgpr_read_b32 v150, a98
  v_accvgpr_read_b32 v151, a99
  v_accvgpr_read_b32 v152, a100
  v_accvgpr_read_b32 v153, a101
  v_accvgpr_read_b32 v154, a102
  v_accvgpr_read_b32 v155, a103
  v_cvt_pk_bf16_f32 v144, v148, v149
  v_cvt_pk_bf16_f32 v145, v150, v151
  v_cvt_pk_bf16_f32 v146, v152, v153
  v_cvt_pk_bf16_f32 v147, v154, v155
  s_add_u32 s25, s24, 0
  buffer_store_dwordx4 v[144:147], v28, s[16:19], s25 offen offset:1280 sc1
  v_accvgpr_read_b32 v136, a128
  v_accvgpr_read_b32 v137, a129
  v_accvgpr_read_b32 v138, a130
  v_accvgpr_read_b32 v139, a131
  v_accvgpr_read_b32 v140, a132
  v_accvgpr_read_b32 v141, a133
  v_accvgpr_read_b32 v142, a134
  v_accvgpr_read_b32 v143, a135
  v_cvt_pk_bf16_f32 v132, v136, v137
  v_cvt_pk_bf16_f32 v133, v138, v139
  v_cvt_pk_bf16_f32 v134, v140, v141
  v_cvt_pk_bf16_f32 v135, v142, v143
  s_add_u32 s25, s24, 0
  buffer_store_dwordx4 v[132:135], v28, s[16:19], s25 offen offset:2048 sc1
  v_accvgpr_read_b32 v148, a160
  v_accvgpr_read_b32 v149, a161
  v_accvgpr_read_b32 v150, a162
  v_accvgpr_read_b32 v151, a163
  v_accvgpr_read_b32 v152, a164
  v_accvgpr_read_b32 v153, a165
  v_accvgpr_read_b32 v154, a166
  v_accvgpr_read_b32 v155, a167
  v_cvt_pk_bf16_f32 v144, v148, v149
  v_cvt_pk_bf16_f32 v145, v150, v151
  v_cvt_pk_bf16_f32 v146, v152, v153
  v_cvt_pk_bf16_f32 v147, v154, v155
  s_add_u32 s25, s24, 0
  buffer_store_dwordx4 v[144:147], v28, s[16:19], s25 offen offset:2304 sc1
  v_accvgpr_read_b32 v136, a192
  v_accvgpr_read_b32 v137, a193
  v_accvgpr_read_b32 v138, a194
  v_accvgpr_read_b32 v139, a195
  v_accvgpr_read_b32 v140, a196
  v_accvgpr_read_b32 v141, a197
  v_accvgpr_read_b32 v142, a198
  v_accvgpr_read_b32 v143, a199
  v_cvt_pk_bf16_f32 v132, v136, v137
  v_cvt_pk_bf16_f32 v133, v138, v139
  v_cvt_pk_bf16_f32 v134, v140, v141
  v_cvt_pk_bf16_f32 v135, v142, v143
  s_add_u32 s25, s24, 0
  buffer_store_dwordx4 v[132:135], v28, s[16:19], s25 offen offset:3072 sc1
  v_accvgpr_read_b32 v148, a224
  v_accvgpr_read_b32 v149, a225
  v_accvgpr_read_b32 v150, a226
  v_accvgpr_read_b32 v151, a227
  v_accvgpr_read_b32 v152, a228
  v_accvgpr_read_b32 v153, a229
  v_accvgpr_read_b32 v154, a230
  v_accvgpr_read_b32 v155, a231
  v_cvt_pk_bf16_f32 v144, v148, v149
  v_cvt_pk_bf16_f32 v145, v150, v151
  v_cvt_pk_bf16_f32 v146, v152, v153
  v_cvt_pk_bf16_f32 v147, v154, v155
  s_add_u32 s25, s24, 0
  buffer_store_dwordx4 v[144:147], v28, s[16:19], s25 offen offset:3328 sc1
  v_accvgpr_read_b32 v136, a8
  v_accvgpr_read_b32 v137, a9
  v_accvgpr_read_b32 v138, a10
  v_accvgpr_read_b32 v139, a11
  v_accvgpr_read_b32 v140, a12
  v_accvgpr_read_b32 v141, a13
  v_accvgpr_read_b32 v142, a14
  v_accvgpr_read_b32 v143, a15
  v_cvt_pk_bf16_f32 v132, v136, v137
  v_cvt_pk_bf16_f32 v133, v138, v139
  v_cvt_pk_bf16_f32 v134, v140, v141
  v_cvt_pk_bf16_f32 v135, v142, v143
  s_add_u32 s25, s24, 8192
  buffer_store_dwordx4 v[132:135], v28, s[16:19], s25 offen offset:0 sc1
  v_accvgpr_read_b32 v148, a40
  v_accvgpr_read_b32 v149, a41
  v_accvgpr_read_b32 v150, a42
  v_accvgpr_read_b32 v151, a43
  v_accvgpr_read_b32 v152, a44
  v_accvgpr_read_b32 v153, a45
  v_accvgpr_read_b32 v154, a46
  v_accvgpr_read_b32 v155, a47
  v_cvt_pk_bf16_f32 v144, v148, v149
  v_cvt_pk_bf16_f32 v145, v150, v151
  v_cvt_pk_bf16_f32 v146, v152, v153
  v_cvt_pk_bf16_f32 v147, v154, v155
  s_add_u32 s25, s24, 8192
  buffer_store_dwordx4 v[144:147], v28, s[16:19], s25 offen offset:256 sc1
  v_accvgpr_read_b32 v136, a72
  v_accvgpr_read_b32 v137, a73
  v_accvgpr_read_b32 v138, a74
  v_accvgpr_read_b32 v139, a75
  v_accvgpr_read_b32 v140, a76
  v_accvgpr_read_b32 v141, a77
  v_accvgpr_read_b32 v142, a78
  v_accvgpr_read_b32 v143, a79
  v_cvt_pk_bf16_f32 v132, v136, v137
  v_cvt_pk_bf16_f32 v133, v138, v139
  v_cvt_pk_bf16_f32 v134, v140, v141
  v_cvt_pk_bf16_f32 v135, v142, v143
  s_add_u32 s25, s24, 8192
  buffer_store_dwordx4 v[132:135], v28, s[16:19], s25 offen offset:1024 sc1
  v_accvgpr_read_b32 v148, a104
  v_accvgpr_read_b32 v149, a105
  v_accvgpr_read_b32 v150, a106
  v_accvgpr_read_b32 v151, a107
  v_accvgpr_read_b32 v152, a108
  v_accvgpr_read_b32 v153, a109
  v_accvgpr_read_b32 v154, a110
  v_accvgpr_read_b32 v155, a111
  v_cvt_pk_bf16_f32 v144, v148, v149
  v_cvt_pk_bf16_f32 v145, v150, v151
  v_cvt_pk_bf16_f32 v146, v152, v153
  v_cvt_pk_bf16_f32 v147, v154, v155
  s_add_u32 s25, s24, 8192
  buffer_store_dwordx4 v[144:147], v28, s[16:19], s25 offen offset:1280 sc1
  v_accvgpr_read_b32 v136, a136
  v_accvgpr_read_b32 v137, a137
  v_accvgpr_read_b32 v138, a138
  v_accvgpr_read_b32 v139, a139
  v_accvgpr_read_b32 v140, a140
  v_accvgpr_read_b32 v141, a141
  v_accvgpr_read_b32 v142, a142
  v_accvgpr_read_b32 v143, a143
  v_cvt_pk_bf16_f32 v132, v136, v137
  v_cvt_pk_bf16_f32 v133, v138, v139
  v_cvt_pk_bf16_f32 v134, v140, v141
  v_cvt_pk_bf16_f32 v135, v142, v143
  s_add_u32 s25, s24, 8192
  buffer_store_dwordx4 v[132:135], v28, s[16:19], s25 offen offset:2048 sc1
  v_accvgpr_read_b32 v148, a168
  v_accvgpr_read_b32 v149, a169
  v_accvgpr_read_b32 v150, a170
  v_accvgpr_read_b32 v151, a171
  v_accvgpr_read_b32 v152, a172
  v_accvgpr_read_b32 v153, a173
  v_accvgpr_read_b32 v154, a174
  v_accvgpr_read_b32 v155, a175
  v_cvt_pk_bf16_f32 v144, v148, v149
  v_cvt_pk_bf16_f32 v145, v150, v151
  v_cvt_pk_bf16_f32 v146, v152, v153
  v_cvt_pk_bf16_f32 v147, v154, v155
  s_add_u32 s25, s24, 8192
  buffer_store_dwordx4 v[144:147], v28, s[16:19], s25 offen offset:2304 sc1
  v_accvgpr_read_b32 v136, a200
  v_accvgpr_read_b32 v137, a201
  v_accvgpr_read_b32 v138, a202
  v_accvgpr_read_b32 v139, a203
  v_accvgpr_read_b32 v140, a204
  v_accvgpr_read_b32 v141, a205
  v_accvgpr_read_b32 v142, a206
  v_accvgpr_read_b32 v143, a207
  v_cvt_pk_bf16_f32 v132, v136, v137
  v_cvt_pk_bf16_f32 v133, v138, v139
  v_cvt_pk_bf16_f32 v134, v140, v141
  v_cvt_pk_bf16_f32 v135, v142, v143
  s_add_u32 s25, s24, 8192
  buffer_store_dwordx4 v[132:135], v28, s[16:19], s25 offen offset:3072 sc1
  v_accvgpr_read_b32 v148, a232
  v_accvgpr_read_b32 v149, a233
  v_accvgpr_read_b32 v150, a234
  v_accvgpr_read_b32 v151, a235
  v_accvgpr_read_b32 v152, a236
  v_accvgpr_read_b32 v153, a237
  v_accvgpr_read_b32 v154, a238
  v_accvgpr_read_b32 v155, a239
  v_cvt_pk_bf16_f32 v144, v148, v149
  v_cvt_pk_bf16_f32 v145, v150, v151
  v_cvt_pk_bf16_f32 v146, v152, v153
  v_cvt_pk_bf16_f32 v147, v154, v155
  s_add_u32 s25, s24, 8192
  buffer_store_dwordx4 v[144:147], v28, s[16:19], s25 offen offset:3328 sc1
  v_accvgpr_read_b32 v136, a16
  v_accvgpr_read_b32 v137, a17
  v_accvgpr_read_b32 v138, a18
  v_accvgpr_read_b32 v139, a19
  v_accvgpr_read_b32 v140, a20
  v_accvgpr_read_b32 v141, a21
  v_accvgpr_read_b32 v142, a22
  v_accvgpr_read_b32 v143, a23
  v_cvt_pk_bf16_f32 v132, v136, v137
  v_cvt_pk_bf16_f32 v133, v138, v139
  v_cvt_pk_bf16_f32 v134, v140, v141
  v_cvt_pk_bf16_f32 v135, v142, v143
  s_add_u32 s25, s24, 16384
  buffer_store_dwordx4 v[132:135], v28, s[16:19], s25 offen offset:0 sc1
  v_accvgpr_read_b32 v148, a48
  v_accvgpr_read_b32 v149, a49
  v_accvgpr_read_b32 v150, a50
  v_accvgpr_read_b32 v151, a51
  v_accvgpr_read_b32 v152, a52
  v_accvgpr_read_b32 v153, a53
  v_accvgpr_read_b32 v154, a54
  v_accvgpr_read_b32 v155, a55
  v_cvt_pk_bf16_f32 v144, v148, v149
  v_cvt_pk_bf16_f32 v145, v150, v151
  v_cvt_pk_bf16_f32 v146, v152, v153
  v_cvt_pk_bf16_f32 v147, v154, v155
  s_add_u32 s25, s24, 16384
  buffer_store_dwordx4 v[144:147], v28, s[16:19], s25 offen offset:256 sc1
  v_accvgpr_read_b32 v136, a80
  v_accvgpr_read_b32 v137, a81
  v_accvgpr_read_b32 v138, a82
  v_accvgpr_read_b32 v139, a83
  v_accvgpr_read_b32 v140, a84
  v_accvgpr_read_b32 v141, a85
  v_accvgpr_read_b32 v142, a86
  v_accvgpr_read_b32 v143, a87
  v_cvt_pk_bf16_f32 v132, v136, v137
  v_cvt_pk_bf16_f32 v133, v138, v139
  v_cvt_pk_bf16_f32 v134, v140, v141
  v_cvt_pk_bf16_f32 v135, v142, v143
  s_add_u32 s25, s24, 16384
  buffer_store_dwordx4 v[132:135], v28, s[16:19], s25 offen offset:1024 sc1
  v_accvgpr_read_b32 v148, a112
  v_accvgpr_read_b32 v149, a113
  v_accvgpr_read_b32 v150, a114
  v_accvgpr_read_b32 v151, a115
  v_accvgpr_read_b32 v152, a116
  v_accvgpr_read_b32 v153, a117
  v_accvgpr_read_b32 v154, a118
  v_accvgpr_read_b32 v155, a119
  v_cvt_pk_bf16_f32 v144, v148, v149
  v_cvt_pk_bf16_f32 v145, v150, v151
  v_cvt_pk_bf16_f32 v146, v152, v153
  v_cvt_pk_bf16_f32 v147, v154, v155
  s_add_u32 s25, s24, 16384
  buffer_store_dwordx4 v[144:147], v28, s[16:19], s25 offen offset:1280 sc1
  v_accvgpr_read_b32 v136, a144
  v_accvgpr_read_b32 v137, a145
  v_accvgpr_read_b32 v138, a146
  v_accvgpr_read_b32 v139, a147
  v_accvgpr_read_b32 v140, a148
  v_accvgpr_read_b32 v141, a149
  v_accvgpr_read_b32 v142, a150
  v_accvgpr_read_b32 v143, a151
  v_cvt_pk_bf16_f32 v132, v136, v137
  v_cvt_pk_bf16_f32 v133, v138, v139
  v_cvt_pk_bf16_f32 v134, v140, v141
  v_cvt_pk_bf16_f32 v135, v142, v143
  s_add_u32 s25, s24, 16384
  buffer_store_dwordx4 v[132:135], v28, s[16:19], s25 offen offset:2048 sc1
  v_accvgpr_read_b32 v148, a176
  v_accvgpr_read_b32 v149, a177
  v_accvgpr_read_b32 v150, a178
  v_accvgpr_read_b32 v151, a179
  v_accvgpr_read_b32 v152, a180
  v_accvgpr_read_b32 v153, a181
  v_accvgpr_read_b32 v154, a182
  v_accvgpr_read_b32 v155, a183
  v_cvt_pk_bf16_f32 v144, v148, v149
  v_cvt_pk_bf16_f32 v145, v150, v151
  v_cvt_pk_bf16_f32 v146, v152, v153
  v_cvt_pk_bf16_f32 v147, v154, v155
  s_add_u32 s25, s24, 16384
  buffer_store_dwordx4 v[144:147], v28, s[16:19], s25 offen offset:2304 sc1
  v_accvgpr_read_b32 v136, a208
  v_accvgpr_read_b32 v137, a209
  v_accvgpr_read_b32 v138, a210
  v_accvgpr_read_b32 v139, a211
  v_accvgpr_read_b32 v140, a212
  v_accvgpr_read_b32 v141, a213
  v_accvgpr_read_b32 v142, a214
  v_accvgpr_read_b32 v143, a215
  v_cvt_pk_bf16_f32 v132, v136, v137
  v_cvt_pk_bf16_f32 v133, v138, v139
  v_cvt_pk_bf16_f32 v134, v140, v141
  v_cvt_pk_bf16_f32 v135, v142, v143
  s_add_u32 s25, s24, 16384
  buffer_store_dwordx4 v[132:135], v28, s[16:19], s25 offen offset:3072 sc1
  v_accvgpr_read_b32 v148, a240
  v_accvgpr_read_b32 v149, a241
  v_accvgpr_read_b32 v150, a242
  v_accvgpr_read_b32 v151, a243
  v_accvgpr_read_b32 v152, a244
  v_accvgpr_read_b32 v153, a245
  v_accvgpr_read_b32 v154, a246
  v_accvgpr_read_b32 v155, a247
  v_cvt_pk_bf16_f32 v144, v148, v149
  v_cvt_pk_bf16_f32 v145, v150, v151
  v_cvt_pk_bf16_f32 v146, v152, v153
  v_cvt_pk_bf16_f32 v147, v154, v155
  s_add_u32 s25, s24, 16384
  buffer_store_dwordx4 v[144:147], v28, s[16:19], s25 offen offset:3328 sc1
  v_accvgpr_read_b32 v136, a24
  v_accvgpr_read_b32 v137, a25
  v_accvgpr_read_b32 v138, a26
  v_accvgpr_read_b32 v139, a27
  v_accvgpr_read_b32 v140, a28
  v_accvgpr_read_b32 v141, a29
  v_accvgpr_read_b32 v142, a30
  v_accvgpr_read_b32 v143, a31
  v_cvt_pk_bf16_f32 v132, v136, v137
  v_cvt_pk_bf16_f32 v133, v138, v139
  v_cvt_pk_bf16_f32 v134, v140, v141
  v_cvt_pk_bf16_f32 v135, v142, v143
  s_add_u32 s25, s24, 24576
  buffer_store_dwordx4 v[132:135], v28, s[16:19], s25 offen offset:0 sc1
  v_accvgpr_read_b32 v148, a56
  v_accvgpr_read_b32 v149, a57
  v_accvgpr_read_b32 v150, a58
  v_accvgpr_read_b32 v151, a59
  v_accvgpr_read_b32 v152, a60
  v_accvgpr_read_b32 v153, a61
  v_accvgpr_read_b32 v154, a62
  v_accvgpr_read_b32 v155, a63
  v_cvt_pk_bf16_f32 v144, v148, v149
  v_cvt_pk_bf16_f32 v145, v150, v151
  v_cvt_pk_bf16_f32 v146, v152, v153
  v_cvt_pk_bf16_f32 v147, v154, v155
  s_add_u32 s25, s24, 24576
  buffer_store_dwordx4 v[144:147], v28, s[16:19], s25 offen offset:256 sc1
  v_accvgpr_read_b32 v136, a88
  v_accvgpr_read_b32 v137, a89
  v_accvgpr_read_b32 v138, a90
  v_accvgpr_read_b32 v139, a91
  v_accvgpr_read_b32 v140, a92
  v_accvgpr_read_b32 v141, a93
  v_accvgpr_read_b32 v142, a94
  v_accvgpr_read_b32 v143, a95
  v_cvt_pk_bf16_f32 v132, v136, v137
  v_cvt_pk_bf16_f32 v133, v138, v139
  v_cvt_pk_bf16_f32 v134, v140, v141
  v_cvt_pk_bf16_f32 v135, v142, v143
  s_add_u32 s25, s24, 24576
  buffer_store_dwordx4 v[132:135], v28, s[16:19], s25 offen offset:1024 sc1
  v_accvgpr_read_b32 v148, a120
  v_accvgpr_read_b32 v149, a121
  v_accvgpr_read_b32 v150, a122
  v_accvgpr_read_b32 v151, a123
  v_accvgpr_read_b32 v152, a124
  v_accvgpr_read_b32 v153, a125
  v_accvgpr_read_b32 v154, a126
  v_accvgpr_read_b32 v155, a127
  v_cvt_pk_bf16_f32 v144, v148, v149
  v_cvt_pk_bf16_f32 v145, v150, v151
  v_cvt_pk_bf16_f32 v146, v152, v153
  v_cvt_pk_bf16_f32 v147, v154, v155
  s_add_u32 s25, s24, 24576
  buffer_store_dwordx4 v[144:147], v28, s[16:19], s25 offen offset:1280 sc1
  v_accvgpr_read_b32 v136, a152
  v_accvgpr_read_b32 v137, a153
  v_accvgpr_read_b32 v138, a154
  v_accvgpr_read_b32 v139, a155
  v_accvgpr_read_b32 v140, a156
  v_accvgpr_read_b32 v141, a157
  v_accvgpr_read_b32 v142, a158
  v_accvgpr_read_b32 v143, a159
  v_cvt_pk_bf16_f32 v132, v136, v137
  v_cvt_pk_bf16_f32 v133, v138, v139
  v_cvt_pk_bf16_f32 v134, v140, v141
  v_cvt_pk_bf16_f32 v135, v142, v143
  s_add_u32 s25, s24, 24576
  buffer_store_dwordx4 v[132:135], v28, s[16:19], s25 offen offset:2048 sc1
  v_accvgpr_read_b32 v148, a184
  v_accvgpr_read_b32 v149, a185
  v_accvgpr_read_b32 v150, a186
  v_accvgpr_read_b32 v151, a187
  v_accvgpr_read_b32 v152, a188
  v_accvgpr_read_b32 v153, a189
  v_accvgpr_read_b32 v154, a190
  v_accvgpr_read_b32 v155, a191
  v_cvt_pk_bf16_f32 v144, v148, v149
  v_cvt_pk_bf16_f32 v145, v150, v151
  v_cvt_pk_bf16_f32 v146, v152, v153
  v_cvt_pk_bf16_f32 v147, v154, v155
  s_add_u32 s25, s24, 24576
  buffer_store_dwordx4 v[144:147], v28, s[16:19], s25 offen offset:2304 sc1
  v_accvgpr_read_b32 v136, a216
  v_accvgpr_read_b32 v137, a217
  v_accvgpr_read_b32 v138, a218
  v_accvgpr_read_b32 v139, a219
  v_accvgpr_read_b32 v140, a220
  v_accvgpr_read_b32 v141, a221
  v_accvgpr_read_b32 v142, a222
  v_accvgpr_read_b32 v143, a223
  v_cvt_pk_bf16_f32 v132, v136, v137
  v_cvt_pk_bf16_f32 v133, v138, v139
  v_cvt_pk_bf16_f32 v134, v140, v141
  v_cvt_pk_bf16_f32 v135, v142, v143
  s_add_u32 s25, s24, 24576
  buffer_store_dwordx4 v[132:135], v28, s[16:19], s25 offen offset:3072 sc1
  v_accvgpr_read_b32 v148, a248
  v_accvgpr_read_b32 v149, a249
  v_accvgpr_read_b32 v150, a250
  v_accvgpr_read_b32 v151, a251
  v_accvgpr_read_b32 v152, a252
  v_accvgpr_read_b32 v153, a253
  v_accvgpr_read_b32 v154, a254
  v_accvgpr_read_b32 v155, a255
  v_cvt_pk_bf16_f32 v144, v148, v149
  v_cvt_pk_bf16_f32 v145, v150, v151
  v_cvt_pk_bf16_f32 v146, v152, v153
  v_cvt_pk_bf16_f32 v147, v154, v155
  s_add_u32 s25, s24, 24576
  buffer_store_dwordx4 v[144:147], v28, s[16:19], s25 offen offset:3328 sc1
  s_endpgm
L_ka_kernel_end:
  s_endpgm
.section .rodata,"a"
.p2align 6
.amdhsa_kernel ka_kernel
  .amdhsa_next_free_vgpr 512
  .amdhsa_next_free_sgpr 102
  .amdhsa_accum_offset 256
  .amdhsa_group_segment_fixed_size 0
  .amdhsa_kernarg_size 128
  .amdhsa_user_sgpr_count 2
  .amdhsa_user_sgpr_kernarg_segment_ptr 1
  .amdhsa_system_sgpr_workgroup_id_x 1
  .amdhsa_float_denorm_mode_32 3
.end_amdhsa_kernel
.text
.globl kb_kernel
.p2align 8
.type kb_kernel,@function
kb_kernel:
  s_cmp_ge_u32 s2, 256
  s_cbranch_scc1 L_kb_kernel_end
  s_load_dwordx2 s[32:33], s[0:1], 0
  s_load_dwordx2 s[34:35], s[0:1], 64
  s_load_dwordx2 s[40:41], s[0:1], 120
  v_lshrrev_b32 v240, 6, v0
  v_and_b32 v1, 63, v0
  v_readfirstlane_b32 s3, v240
  s_and_b32 s80, s2, 7
  s_lshr_b32 s81, s2, 3
  s_and_b32 s69, s81, 3
  s_lshl_b32 s80, s80, 2
  s_add_u32 s69, s69, s80
  s_lshr_b32 s70, s81, 2
  s_lshl_b32 s80, s3, 16
  s_lshl_b32 s65, s70, 18
  s_sub_u32 s64, 3932160, s65
  s_add_u32 s65, s65, s80
  s_add_u32 s64, s64, s80
  s_lshl_b32 s81, s69, 12
  s_lshl_b32 s100, s64, 2
  s_add_u32 s100, s100, s81
  s_lshl_b32 s101, s65, 2
  s_add_u32 s101, s101, s81
  s_lshl_b32 s66, s3, 17
  s_lshl_b32 s81, s69, 8
  s_add_u32 s66, s66, s81
  s_mul_i32 s67, s3, 24576
  s_add_u32 s67, s67, 49152
  s_lshl_b32 s68, s3, 12
  s_lshl_b32 s76, s70, 1
  s_sub_u32 s77, 32, s76
  s_add_u32 s76, s76, 2
  s_mov_b32 s79, 0x41000000
  s_mov_b32 s78, 0
  v_lshrrev_b32 v240, 3, v1
  v_lshlrev_b32 v240, 11, v240
  v_lshrrev_b32 v241, 4, v1
  v_and_b32 v242, 7, v1
  v_xor_b32 v242, v242, v241
  v_lshl_add_u32 v240, v242, 4, v240
  v_xor_b32 v243, 64, v240
  v_add_u32 v208, 0, v240
  v_add_u32 v209, 15360, v243
  v_add_u32 v210, 30720, v240
  v_add_u32 v211, 46080, v243
  v_and_b32 v242, 15, v1
  v_lshlrev_b32 v243, 1, v241
  v_xor_b32 v242, v242, v243
  v_lshlrev_b32 v240, 13, v241
  v_xor_b32 v243, 0, v242
  v_lshl_add_u32 v243, v243, 4, v240
  v_add_u32 v212, 0, v243
  v_xor_b32 v243, 0, v242
  v_lshl_add_u32 v243, v243, 4, v240
  v_add_u32 v213, 31744, v243
  v_xor_b32 v243, 8, v242
  v_lshl_add_u32 v243, v243, 4, v240
  v_add_u32 v214, 63488, v243
  v_xor_b32 v243, 8, v242
  v_lshl_add_u32 v243, v243, 4, v240
  v_add_u32 v215, 95232, v243
  v_and_b32 v240, 15, v1
  v_lshrrev_b32 v242, 1, v240
  v_xor_b32 v242, v242, v241
  v_lshlrev_b32 v242, 4, v242
  v_lshl_add_u32 v242, v240, 7, v242
  v_add_u32 v224, s67, v242
  v_xor_b32 v225, 64, v224
  v_bfe_u32 v240, v1, 2, 2
  v_and_b32 v242, 1, v241
  v_lshl_or_b32 v242, v242, 2, v240
  v_lshl_add_u32 v240, v241, 3, v240
  v_lshlrev_b32 v240, 8, v240
  v_and_b32 v243, 3, v1
  v_lshl_add_u32 v240, v243, 3, v240
  v_xor_b32 v243, 0, v242
  v_lshl_add_u32 v216, v243, 5, v240
  v_xor_b32 v243, 1, v242
  v_lshl_add_u32 v217, v243, 5, v240
  v_xor_b32 v243, 2, v242
  v_lshl_add_u32 v218, v243, 5, v240
  v_xor_b32 v243, 3, v242
  v_lshl_add_u32 v219, v243, 5, v240
  v_xor_b32 v243, 4, v242
  v_lshl_add_u32 v220, v243, 5, v240
  v_xor_b32 v243, 5, v242
  v_lshl_add_u32 v221, v243, 5, v240
  v_xor_b32 v243, 6, v242
  v_lshl_add_u32 v222, v243, 5, v240
  v_xor_b32 v243, 7, v242
  v_lshl_add_u32 v223, v243, 5, v240
  v_lshlrev_b32 v240, 4, v1
  s_lshl_b32 s80, s3, 12
  v_add_u32 v12, s80, v240
  v_add_u32 v10, 0x8000, v240
  v_add_u32 v11, 0x10000, v240
  s_add_u32 s72, s80, 0x8000
  s_add_u32 s73, s80, 0x10000
  v_and_b32 v240, 31, v1
  v_lshrrev_b32 v242, 5, v1
  v_lshlrev_b32 v243, 2, v242
  v_sub_u32 v13, v240, v243
  v_mov_b32 v14, 0xff800000
  v_and_b32 v240, 15, v1
  v_lshl_add_u32 v240, v242, 4, v240
  v_lshlrev_b32 v240, 4, v240
  v_bfe_u32 v243, v1, 4, 1
  v_lshl_add_u32 v15, v243, 17, v240
  s_waitcnt lgkmcnt(0)
  s_mov_b32 s44, s32
  s_mov_b32 s45, s33
  s_mov_b32 s46, 4194304
  s_mov_b32 s47, 0x20000
  s_mov_b32 s48, s34
  s_mov_b32 s49, s35
  s_mov_b32 s50, 8388608
  s_mov_b32 s51, 0x20000
  s_add_u32 s60, s40, 33554432
  s_addc_u32 s61, s41, 0
  s_mov_b32 s62, 16777216
  s_mov_b32 s63, 0x20000
  s_lshl_b32 s80, s69, 19
  s_add_u32 s52, s40, s80
  s_addc_u32 s53, s41, 0
  s_lshl_b32 s54, s77, 14
  s_mov_b32 s55, 0x20000
  s_add_u32 s80, s80, 16760832
  s_add_u32 s56, s40, s80
  s_addc_u32 s57, s41, 0
  s_add_u32 s58, s54, 16384
  s_mov_b32 s59, 0x20000
  s_add_u32 m0, s67, 0
s_nop 0
  buffer_load_dwordx4 v208, s[44:47], s64 offen offset:0 lds
  buffer_load_dwordx4 v209, s[44:47], s64 offen offset:1024 lds
  buffer_load_dwordx4 v210, s[44:47], s64 offen offset:2048 lds
  buffer_load_dwordx4 v211, s[44:47], s64 offen offset:3072 lds
  s_add_u32 m0, s67, 4096
s_nop 0
  buffer_load_dwordx4 v208, s[44:47], s65 offen offset:0 lds
  buffer_load_dwordx4 v209, s[44:47], s65 offen offset:1024 lds
  buffer_load_dwordx4 v210, s[44:47], s65 offen offset:2048 lds
  buffer_load_dwordx4 v211, s[44:47], s65 offen offset:3072 lds
  s_add_u32 m0, s68, 0
s_nop 0
  buffer_load_dwordx4 v212, s[48:51], s66 offen offset:0 lds
  buffer_load_dwordx4 v213, s[48:51], s66 offen offset:1024 lds
  buffer_load_dwordx4 v214, s[48:51], s66 offen offset:2048 lds
  buffer_load_dwordx4 v215, s[48:51], s66 offen offset:3072 lds
  s_add_u32 s64, s64, 128
  s_add_u32 s65, s65, 128
  s_add_u32 s66, s66, 524288
  s_add_u32 m0, s67, 8192
s_nop 0
  buffer_load_dwordx4 v208, s[44:47], s64 offen offset:0 lds
  buffer_load_dwordx4 v209, s[44:47], s64 offen offset:1024 lds
  buffer_load_dwordx4 v210, s[44:47], s64 offen offset:2048 lds
  buffer_load_dwordx4 v211, s[44:47], s64 offen offset:3072 lds
  s_add_u32 m0, s67, 12288
s_nop 0
  buffer_load_dwordx4 v208, s[44:47], s65 offen offset:0 lds
  buffer_load_dwordx4 v209, s[44:47], s65 offen offset:1024 lds
  buffer_load_dwordx4 v210, s[44:47], s65 offen offset:2048 lds
  buffer_load_dwordx4 v211, s[44:47], s65 offen offset:3072 lds
  s_add_u32 m0, s68, 16384
s_nop 0
  buffer_load_dwordx4 v212, s[48:51], s66 offen offset:0 lds
  buffer_load_dwordx4 v213, s[48:51], s66 offen offset:1024 lds
  buffer_load_dwordx4 v214, s[48:51], s66 offen offset:2048 lds
  buffer_load_dwordx4 v215, s[48:51], s66 offen offset:3072 lds
  s_add_u32 s64, s64, 128
  s_add_u32 s65, s65, 128
  s_add_u32 s66, s66, 524288
  s_add_u32 m0, s67, 16384
s_nop 0
  buffer_load_dwordx4 v208, s[44:47], s64 offen offset:0 lds
  buffer_load_dwordx4 v209, s[44:47], s64 offen offset:1024 lds
  buffer_load_dwordx4 v210, s[44:47], s64 offen offset:2048 lds
  buffer_load_dwordx4 v211, s[44:47], s64 offen offset:3072 lds
  s_add_u32 m0, s67, 20480
s_nop 0
  buffer_load_dwordx4 v208, s[44:47], s65 offen offset:0 lds
  buffer_load_dwordx4 v209, s[44:47], s65 offen offset:1024 lds
  buffer_load_dwordx4 v210, s[44:47], s65 offen offset:2048 lds
  buffer_load_dwordx4 v211, s[44:47], s65 offen offset:3072 lds
  s_add_u32 m0, s68, 32768
s_nop 0
  buffer_load_dwordx4 v212, s[48:51], s66 offen offset:0 lds
  buffer_load_dwordx4 v213, s[48:51], s66 offen offset:1024 lds
  buffer_load_dwordx4 v214, s[48:51], s66 offen offset:2048 lds
  buffer_load_dwordx4 v215, s[48:51], s66 offen offset:3072 lds
  s_add_u32 s64, s64, 128
  s_add_u32 s65, s65, 128
  s_add_u32 s66, s66, 524288
  s_waitcnt vmcnt(24)
  s_barrier
  ds_read_b128 v[48:51], v224 offset:0
  ds_read_b128 v[52:55], v224 offset:2048
  ds_read_b128 v[56:59], v224 offset:4096
  ds_read_b128 v[60:63], v224 offset:6144
  ds_read_b64_tr_b16 v[16:17], v216 offset:0
  ds_read_b64_tr_b16 v[18:19], v216 offset:1024
  ds_read_b64_tr_b16 v[20:21], v217 offset:0
  ds_read_b64_tr_b16 v[22:23], v217 offset:1024
  ds_read_b64_tr_b16 v[24:25], v218 offset:0
  ds_read_b64_tr_b16 v[26:27], v218 offset:1024
  ds_read_b64_tr_b16 v[28:29], v219 offset:0
  ds_read_b64_tr_b16 v[30:31], v219 offset:1024
  ds_read_b64_tr_b16 v[32:33], v220 offset:0
  ds_read_b64_tr_b16 v[34:35], v220 offset:1024
  ds_read_b64_tr_b16 v[36:37], v221 offset:0
  ds_read_b64_tr_b16 v[38:39], v221 offset:1024
  ds_read_b64_tr_b16 v[40:41], v222 offset:0
  ds_read_b64_tr_b16 v[42:43], v222 offset:1024
  ds_read_b64_tr_b16 v[44:45], v223 offset:0
  ds_read_b64_tr_b16 v[46:47], v223 offset:1024
s_waitcnt lgkmcnt(14)
  v_mfma_f32_16x16x32_bf16 v[80:83], v[16:19], v[48:51], 0
  v_mfma_f32_16x16x32_bf16 v[84:87], v[16:19], v[52:55], 0
  ds_read_b128 v[64:67], v225 offset:0
  v_mfma_f32_16x16x32_bf16 v[88:91], v[16:19], v[56:59], 0
  v_mfma_f32_16x16x32_bf16 v[92:95], v[16:19], v[60:63], 0
  ds_read_b64_tr_b16 v[16:17], v216 offset:8192
s_waitcnt lgkmcnt(14)
  v_mfma_f32_16x16x32_bf16 v[96:99], v[20:23], v[48:51], 0
  ds_read_b64_tr_b16 v[18:19], v216 offset:9216
  v_mfma_f32_16x16x32_bf16 v[100:103], v[20:23], v[52:55], 0
  v_mfma_f32_16x16x32_bf16 v[104:107], v[20:23], v[56:59], 0
  ds_read_b128 v[68:71], v225 offset:2048
  v_mfma_f32_16x16x32_bf16 v[108:111], v[20:23], v[60:63], 0
  ds_read_b64_tr_b16 v[20:21], v217 offset:8192
s_waitcnt lgkmcnt(15)
  v_mfma_f32_16x16x32_bf16 v[112:115], v[24:27], v[48:51], 0
  ds_read_b64_tr_b16 v[22:23], v217 offset:9216
  v_mfma_f32_16x16x32_bf16 v[116:119], v[24:27], v[52:55], 0
  v_mfma_f32_16x16x32_bf16 v[120:123], v[24:27], v[56:59], 0
  v_mfma_f32_16x16x32_bf16 v[124:127], v[24:27], v[60:63], 0
  ds_read_b64_tr_b16 v[24:25], v218 offset:8192
s_waitcnt lgkmcnt(15)
  v_mfma_f32_16x16x32_bf16 v[128:131], v[28:31], v[48:51], 0
  ds_read_b64_tr_b16 v[26:27], v218 offset:9216
  ds_read_b128 v[72:75], v225 offset:4096
  v_mfma_f32_16x16x32_bf16 v[132:135], v[28:31], v[52:55], 0
  v_mfma_f32_16x16x32_bf16 v[136:139], v[28:31], v[56:59], 0
  v_mfma_f32_16x16x32_bf16 v[140:143], v[28:31], v[60:63], 0
  ds_read_b64_tr_b16 v[28:29], v219 offset:8192
s_waitcnt lgkmcnt(15)
  v_mfma_f32_16x16x32_bf16 v[144:147], v[32:35], v[48:51], 0
  ds_read_b64_tr_b16 v[30:31], v219 offset:9216
  v_mfma_f32_16x16x32_bf16 v[148:151], v[32:35], v[52:55], 0
  v_mfma_f32_16x16x32_bf16 v[152:155], v[32:35], v[56:59], 0
  ds_read_b128 v[76:79], v225 offset:6144
  v_mfma_f32_16x16x32_bf16 v[156:159], v[32:35], v[60:63], 0
  ds_read_b64_tr_b16 v[32:33], v220 offset:8192
s_waitcnt lgkmcnt(15)
  v_mfma_f32_16x16x32_bf16 v[160:163], v[36:39], v[48:51], 0
  ds_read_b64_tr_b16 v[34:35], v220 offset:9216
  v_mfma_f32_16x16x32_bf16 v[164:167], v[36:39], v[52:55], 0
  v_mfma_f32_16x16x32_bf16 v[168:171], v[36:39], v[56:59], 0
  v_mfma_f32_16x16x32_bf16 v[172:175], v[36:39], v[60:63], 0
  ds_read_b64_tr_b16 v[36:37], v221 offset:8192
  v_mfma_f32_16x16x32_bf16 v[176:179], v[40:43], v[48:51], 0
  ds_read_b64_tr_b16 v[38:39], v221 offset:9216
  v_mfma_f32_16x16x32_bf16 v[180:183], v[40:43], v[52:55], 0
  v_mfma_f32_16x16x32_bf16 v[184:187], v[40:43], v[56:59], 0
  v_mfma_f32_16x16x32_bf16 v[188:191], v[40:43], v[60:63], 0
  ds_read_b64_tr_b16 v[40:41], v222 offset:8192
s_waitcnt lgkmcnt(15)
  v_mfma_f32_16x16x32_bf16 v[192:195], v[44:47], v[48:51], 0
  ds_read_b64_tr_b16 v[42:43], v222 offset:9216
  v_mfma_f32_16x16x32_bf16 v[196:199], v[44:47], v[52:55], 0
  v_mfma_f32_16x16x32_bf16 v[200:203], v[44:47], v[56:59], 0
  v_mfma_f32_16x16x32_bf16 v[204:207], v[44:47], v[60:63], 0
  ds_read_b64_tr_b16 v[44:45], v223 offset:8192
  ds_read_b64_tr_b16 v[46:47], v223 offset:9216
  s_waitcnt lgkmcnt(4)
  v_mfma_f32_16x16x32_bf16 v[80:83], v[16:19], v[64:67], v[80:83]
  v_mfma_f32_16x16x32_bf16 v[84:87], v[16:19], v[68:71], v[84:87]
  v_mfma_f32_16x16x32_bf16 v[88:91], v[16:19], v[72:75], v[88:91]
  v_mfma_f32_16x16x32_bf16 v[92:95], v[16:19], v[76:79], v[92:95]
  v_mfma_f32_16x16x32_bf16 v[96:99], v[20:23], v[64:67], v[96:99]
  v_mfma_f32_16x16x32_bf16 v[100:103], v[20:23], v[68:71], v[100:103]
  v_mfma_f32_16x16x32_bf16 v[104:107], v[20:23], v[72:75], v[104:107]
  v_mfma_f32_16x16x32_bf16 v[108:111], v[20:23], v[76:79], v[108:111]
  s_waitcnt vmcnt(12) lgkmcnt(0)
  s_barrier
  v_mfma_f32_16x16x32_bf16 v[112:115], v[24:27], v[64:67], v[112:115]
  ds_read_b64_tr_b16 v[16:17], v216 offset:16384
  v_mfma_f32_16x16x32_bf16 v[116:119], v[24:27], v[68:71], v[116:119]
  s_add_u32 m0, s67, 0
s_nop 0
  buffer_load_dwordx4 v208, s[44:47], s64 offen offset:0 lds
  ds_read_b64_tr_b16 v[18:19], v216 offset:17408
  ds_read_b128 v[48:51], v224 offset:8192
  v_mfma_f32_16x16x32_bf16 v[120:123], v[24:27], v[72:75], v[120:123]
  buffer_load_dwordx4 v209, s[44:47], s64 offen offset:1024 lds
  ds_read_b64_tr_b16 v[20:21], v217 offset:16384
  v_mfma_f32_16x16x32_bf16 v[124:127], v[24:27], v[76:79], v[124:127]
  ds_read_b64_tr_b16 v[22:23], v217 offset:17408
  v_mfma_f32_16x16x32_bf16 v[128:131], v[28:31], v[64:67], v[128:131]
  buffer_load_dwordx4 v210, s[44:47], s64 offen offset:2048 lds
  ds_read_b64_tr_b16 v[24:25], v218 offset:16384
  ds_read_b128 v[52:55], v224 offset:10240
  v_mfma_f32_16x16x32_bf16 v[132:135], v[28:31], v[68:71], v[132:135]
  ds_read_b64_tr_b16 v[26:27], v218 offset:17408
  v_mfma_f32_16x16x32_bf16 v[136:139], v[28:31], v[72:75], v[136:139]
  buffer_load_dwordx4 v211, s[44:47], s64 offen offset:3072 lds
  v_mfma_f32_16x16x32_bf16 v[140:143], v[28:31], v[76:79], v[140:143]
  ds_read_b64_tr_b16 v[28:29], v219 offset:16384
  v_mfma_f32_16x16x32_bf16 v[144:147], v[32:35], v[64:67], v[144:147]
  s_add_u32 m0, s67, 4096
s_nop 0
  buffer_load_dwordx4 v208, s[44:47], s65 offen offset:0 lds
  ds_read_b64_tr_b16 v[30:31], v219 offset:17408
  ds_read_b128 v[56:59], v224 offset:12288
  v_mfma_f32_16x16x32_bf16 v[148:151], v[32:35], v[68:71], v[148:151]
  v_mfma_f32_16x16x32_bf16 v[152:155], v[32:35], v[72:75], v[152:155]
  buffer_load_dwordx4 v209, s[44:47], s65 offen offset:1024 lds
  v_mfma_f32_16x16x32_bf16 v[156:159], v[32:35], v[76:79], v[156:159]
  ds_read_b64_tr_b16 v[32:33], v220 offset:16384
  v_mfma_f32_16x16x32_bf16 v[160:163], v[36:39], v[64:67], v[160:163]
  buffer_load_dwordx4 v210, s[44:47], s65 offen offset:2048 lds
  ds_read_b64_tr_b16 v[34:35], v220 offset:17408
  ds_read_b128 v[60:63], v224 offset:14336
  v_mfma_f32_16x16x32_bf16 v[164:167], v[36:39], v[68:71], v[164:167]
  buffer_load_dwordx4 v211, s[44:47], s65 offen offset:3072 lds
  v_mfma_f32_16x16x32_bf16 v[168:171], v[36:39], v[72:75], v[168:171]
  v_mfma_f32_16x16x32_bf16 v[172:175], v[36:39], v[76:79], v[172:175]
  s_add_u32 m0, s68, 0
s_nop 0
  buffer_load_dwordx4 v212, s[48:51], s66 offen offset:0 lds
  ds_read_b64_tr_b16 v[36:37], v221 offset:16384
  v_mfma_f32_16x16x32_bf16 v[176:179], v[40:43], v[64:67], v[176:179]
  ds_read_b64_tr_b16 v[38:39], v221 offset:17408
  v_mfma_f32_16x16x32_bf16 v[180:183], v[40:43], v[68:71], v[180:183]
  buffer_load_dwordx4 v213, s[48:51], s66 offen offset:1024 lds
  v_mfma_f32_16x16x32_bf16 v[184:187], v[40:43], v[72:75], v[184:187]
  v_mfma_f32_16x16x32_bf16 v[188:191], v[40:43], v[76:79], v[188:191]
  buffer_load_dwordx4 v214, s[48:51], s66 offen offset:2048 lds
  ds_read_b64_tr_b16 v[40:41], v222 offset:16384
  v_mfma_f32_16x16x32_bf16 v[192:195], v[44:47], v[64:67], v[192:195]
  ds_read_b64_tr_b16 v[42:43], v222 offset:17408
  v_mfma_f32_16x16x32_bf16 v[196:199], v[44:47], v[68:71], v[196:199]
  buffer_load_dwordx4 v215, s[48:51], s66 offen offset:3072 lds
  s_add_u32 s64, s64, 128
  s_add_u32 s65, s65, 128
  s_add_u32 s66, s66, 524288
  v_mfma_f32_16x16x32_bf16 v[200:203], v[44:47], v[72:75], v[200:203]
  v_mfma_f32_16x16x32_bf16 v[204:207], v[44:47], v[76:79], v[204:207]
  ds_read_b64_tr_b16 v[44:45], v223 offset:16384
  ds_read_b64_tr_b16 v[46:47], v223 offset:17408
  s_waitcnt lgkmcnt(4)
  v_mfma_f32_16x16x32_bf16 v[80:83], v[16:19], v[48:51], v[80:83]
  v_mfma_f32_16x16x32_bf16 v[84:87], v[16:19], v[52:55], v[84:87]
  ds_read_b128 v[64:67], v225 offset:8192
  v_mfma_f32_16x16x32_bf16 v[88:91], v[16:19], v[56:59], v[88:91]
  v_accvgpr_write_b32 a0, 0
  v_mfma_f32_16x16x32_bf16 v[92:95], v[16:19], v[60:63], v[92:95]
  ds_read_b64_tr_b16 v[16:17], v216 offset:24576
  v_mfma_f32_16x16x32_bf16 v[96:99], v[20:23], v[48:51], v[96:99]
  ds_read_b64_tr_b16 v[18:19], v216 offset:25600
  v_mfma_f32_16x16x32_bf16 v[100:103], v[20:23], v[52:55], v[100:103]
  v_accvgpr_write_b32 a1, 0
  v_mfma_f32_16x16x32_bf16 v[104:107], v[20:23], v[56:59], v[104:107]
  ds_read_b128 v[68:71], v225 offset:10240
  v_mfma_f32_16x16x32_bf16 v[108:111], v[20:23], v[60:63], v[108:111]
  ds_read_b64_tr_b16 v[20:21], v217 offset:24576
  v_mfma_f32_16x16x32_bf16 v[112:115], v[24:27], v[48:51], v[112:115]
  ds_read_b64_tr_b16 v[22:23], v217 offset:25600
  v_mfma_f32_16x16x32_bf16 v[116:119], v[24:27], v[52:55], v[116:119]
  v_accvgpr_write_b32 a2, 0
  v_mfma_f32_16x16x32_bf16 v[120:123], v[24:27], v[56:59], v[120:123]
  v_mfma_f32_16x16x32_bf16 v[124:127], v[24:27], v[60:63], v[124:127]
  ds_read_b64_tr_b16 v[24:25], v218 offset:24576
  v_mfma_f32_16x16x32_bf16 v[128:131], v[28:31], v[48:51], v[128:131]
  ds_read_b64_tr_b16 v[26:27], v218 offset:25600
  ds_read_b128 v[72:75], v225 offset:12288
  v_accvgpr_write_b32 a3, 0
  v_mfma_f32_16x16x32_bf16 v[132:135], v[28:31], v[52:55], v[132:135]
  v_mfma_f32_16x16x32_bf16 v[136:139], v[28:31], v[56:59], v[136:139]
  v_mfma_f32_16x16x32_bf16 v[140:143], v[28:31], v[60:63], v[140:143]
  ds_read_b64_tr_b16 v[28:29], v219 offset:24576
  v_mfma_f32_16x16x32_bf16 v[144:147], v[32:35], v[48:51], v[144:147]
  ds_read_b64_tr_b16 v[30:31], v219 offset:25600
  v_accvgpr_write_b32 a4, 0
  v_mfma_f32_16x16x32_bf16 v[148:151], v[32:35], v[52:55], v[148:151]
  v_mfma_f32_16x16x32_bf16 v[152:155], v[32:35], v[56:59], v[152:155]
  ds_read_b128 v[76:79], v225 offset:14336
  v_mfma_f32_16x16x32_bf16 v[156:159], v[32:35], v[60:63], v[156:159]
  ds_read_b64_tr_b16 v[32:33], v220 offset:24576
  v_accvgpr_write_b32 a5, 0
  v_mfma_f32_16x16x32_bf16 v[160:163], v[36:39], v[48:51], v[160:163]
  ds_read_b64_tr_b16 v[34:35], v220 offset:25600
  v_mfma_f32_16x16x32_bf16 v[164:167], v[36:39], v[52:55], v[164:167]
  v_mfma_f32_16x16x32_bf16 v[168:171], v[36:39], v[56:59], v[168:171]
  v_mfma_f32_16x16x32_bf16 v[172:175], v[36:39], v[60:63], v[172:175]
  ds_read_b64_tr_b16 v[36:37], v221 offset:24576
  v_accvgpr_write_b32 a6, 0
s_waitcnt lgkmcnt(15)
  v_mfma_f32_16x16x32_bf16 v[176:179], v[40:43], v[48:51], v[176:179]
  ds_read_b64_tr_b16 v[38:39], v221 offset:25600
  v_mfma_f32_16x16x32_bf16 v[180:183], v[40:43], v[52:55], v[180:183]
  v_mfma_f32_16x16x32_bf16 v[184:187], v[40:43], v[56:59], v[184:187]
  v_accvgpr_write_b32 a7, 0
  v_mfma_f32_16x16x32_bf16 v[188:191], v[40:43], v[60:63], v[188:191]
  ds_read_b64_tr_b16 v[40:41], v222 offset:24576
  v_mfma_f32_16x16x32_bf16 v[192:195], v[44:47], v[48:51], v[192:195]
  ds_read_b64_tr_b16 v[42:43], v222 offset:25600
  v_mfma_f32_16x16x32_bf16 v[196:199], v[44:47], v[52:55], v[196:199]
  v_mfma_f32_16x16x32_bf16 v[200:203], v[44:47], v[56:59], v[200:203]
  v_mfma_f32_16x16x32_bf16 v[204:207], v[44:47], v[60:63], v[204:207]
  ds_read_b64_tr_b16 v[44:45], v223 offset:24576
  ds_read_b64_tr_b16 v[46:47], v223 offset:25600
  s_waitcnt lgkmcnt(4)
  v_mfma_f32_16x16x32_bf16 v[80:83], v[16:19], v[64:67], v[80:83]
  v_mfma_f32_16x16x32_bf16 v[84:87], v[16:19], v[68:71], v[84:87]
  v_mfma_f32_16x16x32_bf16 v[88:91], v[16:19], v[72:75], v[88:91]
  v_accvgpr_write_b32 a8, 0
  v_mfma_f32_16x16x32_bf16 v[92:95], v[16:19], v[76:79], v[92:95]
  v_mfma_f32_16x16x32_bf16 v[96:99], v[20:23], v[64:67], v[96:99]
  v_mfma_f32_16x16x32_bf16 v[100:103], v[20:23], v[68:71], v[100:103]
  v_accvgpr_write_b32 a9, 0
  v_mfma_f32_16x16x32_bf16 v[104:107], v[20:23], v[72:75], v[104:107]
  v_mfma_f32_16x16x32_bf16 v[108:111], v[20:23], v[76:79], v[108:111]
  s_waitcnt vmcnt(12) lgkmcnt(0)
  s_barrier
  v_mfma_f32_16x16x32_bf16 v[112:115], v[24:27], v[64:67], v[112:115]
  ds_read_b64_tr_b16 v[16:17], v216 offset:32768
  v_mfma_f32_16x16x32_bf16 v[116:119], v[24:27], v[68:71], v[116:119]
  s_add_u32 m0, s67, 8192
s_nop 0
  buffer_load_dwordx4 v208, s[44:47], s64 offen offset:0 lds
  ds_read_b64_tr_b16 v[18:19], v216 offset:33792
  ds_read_b128 v[48:51], v224 offset:16384
  v_accvgpr_write_b32 a10, 0
  v_mfma_f32_16x16x32_bf16 v[120:123], v[24:27], v[72:75], v[120:123]
  buffer_load_dwordx4 v209, s[44:47], s64 offen offset:1024 lds
  ds_read_b64_tr_b16 v[20:21], v217 offset:32768
  v_mfma_f32_16x16x32_bf16 v[124:127], v[24:27], v[76:79], v[124:127]
  ds_read_b64_tr_b16 v[22:23], v217 offset:33792
  v_mfma_f32_16x16x32_bf16 v[128:131], v[28:31], v[64:67], v[128:131]
  buffer_load_dwordx4 v210, s[44:47], s64 offen offset:2048 lds
  ds_read_b64_tr_b16 v[24:25], v218 offset:32768
  ds_read_b128 v[52:55], v224 offset:18432
  v_accvgpr_write_b32 a11, 0
  v_mfma_f32_16x16x32_bf16 v[132:135], v[28:31], v[68:71], v[132:135]
  ds_read_b64_tr_b16 v[26:27], v218 offset:33792
  v_mfma_f32_16x16x32_bf16 v[136:139], v[28:31], v[72:75], v[136:139]
  buffer_load_dwordx4 v211, s[44:47], s64 offen offset:3072 lds
  v_mfma_f32_16x16x32_bf16 v[140:143], v[28:31], v[76:79], v[140:143]
  ds_read_b64_tr_b16 v[28:29], v219 offset:32768
  v_mfma_f32_16x16x32_bf16 v[144:147], v[32:35], v[64:67], v[144:147]
  s_add_u32 m0, s67, 12288
s_nop 0
  buffer_load_dwordx4 v208, s[44:47], s65 offen offset:0 lds
  ds_read_b64_tr_b16 v[30:31], v219 offset:33792
  ds_read_b128 v[56:59], v224 offset:20480
  v_accvgpr_write_b32 a12, 0
  v_mfma_f32_16x16x32_bf16 v[148:151], v[32:35], v[68:71], v[148:151]
  v_mfma_f32_16x16x32_bf16 v[152:155], v[32:35], v[72:75], v[152:155]
  buffer_load_dwordx4 v209, s[44:47], s65 offen offset:1024 lds
  v_mfma_f32_16x16x32_bf16 v[156:159], v[32:35], v[76:79], v[156:159]
  ds_read_b64_tr_b16 v[32:33], v220 offset:32768
  v_accvgpr_write_b32 a13, 0
  v_mfma_f32_16x16x32_bf16 v[160:163], v[36:39], v[64:67], v[160:163]
  buffer_load_dwordx4 v210, s[44:47], s65 offen offset:2048 lds
  ds_read_b64_tr_b16 v[34:35], v220 offset:33792
  ds_read_b128 v[60:63], v224 offset:22528
  v_mfma_f32_16x16x32_bf16 v[164:167], v[36:39], v[68:71], v[164:167]
  buffer_load_dwordx4 v211, s[44:47], s65 offen offset:3072 lds
  v_mfma_f32_16x16x32_bf16 v[168:171], v[36:39], v[72:75], v[168:171]
  v_mfma_f32_16x16x32_bf16 v[172:175], v[36:39], v[76:79], v[172:175]
  s_add_u32 m0, s68, 16384
s_nop 0
  buffer_load_dwordx4 v212, s[48:51], s66 offen offset:0 lds
  ds_read_b64_tr_b16 v[36:37], v221 offset:32768
  v_accvgpr_write_b32 a14, 0
  v_mfma_f32_16x16x32_bf16 v[176:179], v[40:43], v[64:67], v[176:179]
  ds_read_b64_tr_b16 v[38:39], v221 offset:33792
  v_mfma_f32_16x16x32_bf16 v[180:183], v[40:43], v[68:71], v[180:183]
  buffer_load_dwordx4 v213, s[48:51], s66 offen offset:1024 lds
  v_mfma_f32_16x16x32_bf16 v[184:187], v[40:43], v[72:75], v[184:187]
  v_accvgpr_write_b32 a15, 0
  v_mfma_f32_16x16x32_bf16 v[188:191], v[40:43], v[76:79], v[188:191]
  buffer_load_dwordx4 v214, s[48:51], s66 offen offset:2048 lds
  ds_read_b64_tr_b16 v[40:41], v222 offset:32768
  v_mfma_f32_16x16x32_bf16 v[192:195], v[44:47], v[64:67], v[192:195]
  ds_read_b64_tr_b16 v[42:43], v222 offset:33792
  v_mfma_f32_16x16x32_bf16 v[196:199], v[44:47], v[68:71], v[196:199]
  buffer_load_dwordx4 v215, s[48:51], s66 offen offset:3072 lds
  s_add_u32 s64, s64, 128
  s_add_u32 s65, s65, 128
  s_add_u32 s66, s66, 524288
  v_mfma_f32_16x16x32_bf16 v[200:203], v[44:47], v[72:75], v[200:203]
  v_mfma_f32_16x16x32_bf16 v[204:207], v[44:47], v[76:79], v[204:207]
  ds_read_b64_tr_b16 v[44:45], v223 offset:32768
  ds_read_b64_tr_b16 v[46:47], v223 offset:33792
  s_waitcnt lgkmcnt(4)
  v_mfma_f32_16x16x32_bf16 v[80:83], v[16:19], v[48:51], v[80:83]
  v_mfma_f32_16x16x32_bf16 v[84:87], v[16:19], v[52:55], v[84:87]
  ds_read_b128 v[64:67], v225 offset:16384
  v_mfma_f32_16x16x32_bf16 v[88:91], v[16:19], v[56:59], v[88:91]
  v_accvgpr_write_b32 a16, 0
  v_mfma_f32_16x16x32_bf16 v[92:95], v[16:19], v[60:63], v[92:95]
  ds_read_b64_tr_b16 v[16:17], v216 offset:40960
  v_mfma_f32_16x16x32_bf16 v[96:99], v[20:23], v[48:51], v[96:99]
  ds_read_b64_tr_b16 v[18:19], v216 offset:41984
  v_mfma_f32_16x16x32_bf16 v[100:103], v[20:23], v[52:55], v[100:103]
  v_accvgpr_write_b32 a17, 0
  v_mfma_f32_16x16x32_bf16 v[104:107], v[20:23], v[56:59], v[104:107]
  ds_read_b128 v[68:71], v225 offset:18432
  v_mfma_f32_16x16x32_bf16 v[108:111], v[20:23], v[60:63], v[108:111]
  ds_read_b64_tr_b16 v[20:21], v217 offset:40960
  v_mfma_f32_16x16x32_bf16 v[112:115], v[24:27], v[48:51], v[112:115]
  ds_read_b64_tr_b16 v[22:23], v217 offset:41984
  v_mfma_f32_16x16x32_bf16 v[116:119], v[24:27], v[52:55], v[116:119]
  v_accvgpr_write_b32 a18, 0
  v_mfma_f32_16x16x32_bf16 v[120:123], v[24:27], v[56:59], v[120:123]
  v_mfma_f32_16x16x32_bf16 v[124:127], v[24:27], v[60:63], v[124:127]
  ds_read_b64_tr_b16 v[24:25], v218 offset:40960
  v_mfma_f32_16x16x32_bf16 v[128:131], v[28:31], v[48:51], v[128:131]
  ds_read_b64_tr_b16 v[26:27], v218 offset:41984
  ds_read_b128 v[72:75], v225 offset:20480
  v_accvgpr_write_b32 a19, 0
  v_mfma_f32_16x16x32_bf16 v[132:135], v[28:31], v[52:55], v[132:135]
  v_mfma_f32_16x16x32_bf16 v[136:139], v[28:31], v[56:59], v[136:139]
  v_mfma_f32_16x16x32_bf16 v[140:143], v[28:31], v[60:63], v[140:143]
  ds_read_b64_tr_b16 v[28:29], v219 offset:40960
  v_mfma_f32_16x16x32_bf16 v[144:147], v[32:35], v[48:51], v[144:147]
  ds_read_b64_tr_b16 v[30:31], v219 offset:41984
  v_accvgpr_write_b32 a20, 0
  v_mfma_f32_16x16x32_bf16 v[148:151], v[32:35], v[52:55], v[148:151]
  v_mfma_f32_16x16x32_bf16 v[152:155], v[32:35], v[56:59], v[152:155]
  ds_read_b128 v[76:79], v225 offset:22528
  v_mfma_f32_16x16x32_bf16 v[156:159], v[32:35], v[60:63], v[156:159]
  ds_read_b64_tr_b16 v[32:33], v220 offset:40960
  v_accvgpr_write_b32 a21, 0
  v_mfma_f32_16x16x32_bf16 v[160:163], v[36:39], v[48:51], v[160:163]
  ds_read_b64_tr_b16 v[34:35], v220 offset:41984
  v_mfma_f32_16x16x32_bf16 v[164:167], v[36:39], v[52:55], v[164:167]
  v_mfma_f32_16x16x32_bf16 v[168:171], v[36:39], v[56:59], v[168:171]
  v_mfma_f32_16x16x32_bf16 v[172:175], v[36:39], v[60:63], v[172:175]
  ds_read_b64_tr_b16 v[36:37], v221 offset:40960
  v_accvgpr_write_b32 a22, 0
s_waitcnt lgkmcnt(15)
  v_mfma_f32_16x16x32_bf16 v[176:179], v[40:43], v[48:51], v[176:179]
  ds_read_b64_tr_b16 v[38:39], v221 offset:41984
  v_mfma_f32_16x16x32_bf16 v[180:183], v[40:43], v[52:55], v[180:183]
  v_mfma_f32_16x16x32_bf16 v[184:187], v[40:43], v[56:59], v[184:187]
  v_accvgpr_write_b32 a23, 0
  v_mfma_f32_16x16x32_bf16 v[188:191], v[40:43], v[60:63], v[188:191]
  ds_read_b64_tr_b16 v[40:41], v222 offset:40960
  v_mfma_f32_16x16x32_bf16 v[192:195], v[44:47], v[48:51], v[192:195]
  ds_read_b64_tr_b16 v[42:43], v222 offset:41984
  v_mfma_f32_16x16x32_bf16 v[196:199], v[44:47], v[52:55], v[196:199]
  v_mfma_f32_16x16x32_bf16 v[200:203], v[44:47], v[56:59], v[200:203]
  v_mfma_f32_16x16x32_bf16 v[204:207], v[44:47], v[60:63], v[204:207]
  ds_read_b64_tr_b16 v[44:45], v223 offset:40960
  ds_read_b64_tr_b16 v[46:47], v223 offset:41984
  s_waitcnt lgkmcnt(4)
  v_mfma_f32_16x16x32_bf16 v[80:83], v[16:19], v[64:67], v[80:83]
  v_mfma_f32_16x16x32_bf16 v[84:87], v[16:19], v[68:71], v[84:87]
  v_mfma_f32_16x16x32_bf16 v[88:91], v[16:19], v[72:75], v[88:91]
  v_accvgpr_write_b32 a24, 0
  v_mfma_f32_16x16x32_bf16 v[92:95], v[16:19], v[76:79], v[92:95]
  v_mfma_f32_16x16x32_bf16 v[96:99], v[20:23], v[64:67], v[96:99]
  v_mfma_f32_16x16x32_bf16 v[100:103], v[20:23], v[68:71], v[100:103]
  v_accvgpr_write_b32 a25, 0
  v_mfma_f32_16x16x32_bf16 v[104:107], v[20:23], v[72:75], v[104:107]
  v_mfma_f32_16x16x32_bf16 v[108:111], v[20:23], v[76:79], v[108:111]
  s_waitcnt vmcnt(12) lgkmcnt(0)
  s_barrier
  v_mfma_f32_16x16x32_bf16 v[112:115], v[24:27], v[64:67], v[112:115]
  ds_read_b64_tr_b16 v[16:17], v216 offset:0
  v_mfma_f32_16x16x32_bf16 v[116:119], v[24:27], v[68:71], v[116:119]
  s_add_u32 m0, s67, 16384
s_nop 0
  buffer_load_dwordx4 v208, s[44:47], s64 offen offset:0 lds
  ds_read_b64_tr_b16 v[18:19], v216 offset:1024
  ds_read_b128 v[48:51], v224 offset:0
  v_accvgpr_write_b32 a26, 0
  v_mfma_f32_16x16x32_bf16 v[120:123], v[24:27], v[72:75], v[120:123]
  buffer_load_dwordx4 v209, s[44:47], s64 offen offset:1024 lds
  ds_read_b64_tr_b16 v[20:21], v217 offset:0
  v_mfma_f32_16x16x32_bf16 v[124:127], v[24:27], v[76:79], v[124:127]
  ds_read_b64_tr_b16 v[22:23], v217 offset:1024
  v_mfma_f32_16x16x32_bf16 v[128:131], v[28:31], v[64:67], v[128:131]
  buffer_load_dwordx4 v210, s[44:47], s64 offen offset:2048 lds
  ds_read_b64_tr_b16 v[24:25], v218 offset:0
  ds_read_b128 v[52:55], v224 offset:2048
  v_accvgpr_write_b32 a27, 0
  v_mfma_f32_16x16x32_bf16 v[132:135], v[28:31], v[68:71], v[132:135]
  ds_read_b64_tr_b16 v[26:27], v218 offset:1024
  v_mfma_f32_16x16x32_bf16 v[136:139], v[28:31], v[72:75], v[136:139]
  buffer_load_dwordx4 v211, s[44:47], s64 offen offset:3072 lds
  v_mfma_f32_16x16x32_bf16 v[140:143], v[28:31], v[76:79], v[140:143]
  ds_read_b64_tr_b16 v[28:29], v219 offset:0
  v_mfma_f32_16x16x32_bf16 v[144:147], v[32:35], v[64:67], v[144:147]
  s_add_u32 m0, s67, 20480
s_nop 0
  buffer_load_dwordx4 v208, s[44:47], s65 offen offset:0 lds
  ds_read_b64_tr_b16 v[30:31], v219 offset:1024
  ds_read_b128 v[56:59], v224 offset:4096
  v_accvgpr_write_b32 a28, 0
  v_mfma_f32_16x16x32_bf16 v[148:151], v[32:35], v[68:71], v[148:151]
  v_mfma_f32_16x16x32_bf16 v[152:155], v[32:35], v[72:75], v[152:155]
  buffer_load_dwordx4 v209, s[44:47], s65 offen offset:1024 lds
  v_mfma_f32_16x16x32_bf16 v[156:159], v[32:35], v[76:79], v[156:159]
  ds_read_b64_tr_b16 v[32:33], v220 offset:0
  v_accvgpr_write_b32 a29, 0
  v_mfma_f32_16x16x32_bf16 v[160:163], v[36:39], v[64:67], v[160:163]
  buffer_load_dwordx4 v210, s[44:47], s65 offen offset:2048 lds
  ds_read_b64_tr_b16 v[34:35], v220 offset:1024
  ds_read_b128 v[60:63], v224 offset:6144
  v_mfma_f32_16x16x32_bf16 v[164:167], v[36:39], v[68:71], v[164:167]
  buffer_load_dwordx4 v211, s[44:47], s65 offen offset:3072 lds
  v_mfma_f32_16x16x32_bf16 v[168:171], v[36:39], v[72:75], v[168:171]
  v_mfma_f32_16x16x32_bf16 v[172:175], v[36:39], v[76:79], v[172:175]
  s_add_u32 m0, s68, 32768
s_nop 0
  buffer_load_dwordx4 v212, s[48:51], s66 offen offset:0 lds
  ds_read_b64_tr_b16 v[36:37], v221 offset:0
  v_accvgpr_write_b32 a30, 0
  v_mfma_f32_16x16x32_bf16 v[176:179], v[40:43], v[64:67], v[176:179]
  ds_read_b64_tr_b16 v[38:39], v221 offset:1024
  v_mfma_f32_16x16x32_bf16 v[180:183], v[40:43], v[68:71], v[180:183]
  buffer_load_dwordx4 v213, s[48:51], s66 offen offset:1024 lds
  v_mfma_f32_16x16x32_bf16 v[184:187], v[40:43], v[72:75], v[184:187]
  v_accvgpr_write_b32 a31, 0
  v_mfma_f32_16x16x32_bf16 v[188:191], v[40:43], v[76:79], v[188:191]
  buffer_load_dwordx4 v214, s[48:51], s66 offen offset:2048 lds
  ds_read_b64_tr_b16 v[40:41], v222 offset:0
  v_mfma_f32_16x16x32_bf16 v[192:195], v[44:47], v[64:67], v[192:195]
  ds_read_b64_tr_b16 v[42:43], v222 offset:1024
  v_mfma_f32_16x16x32_bf16 v[196:199], v[44:47], v[68:71], v[196:199]
  buffer_load_dwordx4 v215, s[48:51], s66 offen offset:3072 lds
  s_add_u32 s64, s64, 128
  s_add_u32 s65, s65, 128
  s_add_u32 s66, s66, 524288
  v_mfma_f32_16x16x32_bf16 v[200:203], v[44:47], v[72:75], v[200:203]
  v_mfma_f32_16x16x32_bf16 v[204:207], v[44:47], v[76:79], v[204:207]
  ds_read_b64_tr_b16 v[44:45], v223 offset:0
  ds_read_b64_tr_b16 v[46:47], v223 offset:1024
  s_waitcnt lgkmcnt(4)
  v_mfma_f32_16x16x32_bf16 v[80:83], v[16:19], v[48:51], v[80:83]
  v_mfma_f32_16x16x32_bf16 v[84:87], v[16:19], v[52:55], v[84:87]
  ds_read_b128 v[64:67], v225 offset:0
  v_mfma_f32_16x16x32_bf16 v[88:91], v[16:19], v[56:59], v[88:91]
  v_accvgpr_write_b32 a32, 0
  v_mfma_f32_16x16x32_bf16 v[92:95], v[16:19], v[60:63], v[92:95]
  ds_read_b64_tr_b16 v[16:17], v216 offset:8192
  v_mfma_f32_16x16x32_bf16 v[96:99], v[20:23], v[48:51], v[96:99]
  ds_read_b64_tr_b16 v[18:19], v216 offset:9216
  v_mfma_f32_16x16x32_bf16 v[100:103], v[20:23], v[52:55], v[100:103]
  v_accvgpr_write_b32 a33, 0
  v_mfma_f32_16x16x32_bf16 v[104:107], v[20:23], v[56:59], v[104:107]
  ds_read_b128 v[68:71], v225 offset:2048
  v_mfma_f32_16x16x32_bf16 v[108:111], v[20:23], v[60:63], v[108:111]
  ds_read_b64_tr_b16 v[20:21], v217 offset:8192
  v_mfma_f32_16x16x32_bf16 v[112:115], v[24:27], v[48:51], v[112:115]
  ds_read_b64_tr_b16 v[22:23], v217 offset:9216
  v_mfma_f32_16x16x32_bf16 v[116:119], v[24:27], v[52:55], v[116:119]
  v_accvgpr_write_b32 a34, 0
  v_mfma_f32_16x16x32_bf16 v[120:123], v[24:27], v[56:59], v[120:123]
  v_mfma_f32_16x16x32_bf16 v[124:127], v[24:27], v[60:63], v[124:127]
  ds_read_b64_tr_b16 v[24:25], v218 offset:8192
  v_mfma_f32_16x16x32_bf16 v[128:131], v[28:31], v[48:51], v[128:131]
  ds_read_b64_tr_b16 v[26:27], v218 offset:9216
  ds_read_b128 v[72:75], v225 offset:4096
  v_accvgpr_write_b32 a35, 0
  v_mfma_f32_16x16x32_bf16 v[132:135], v[28:31], v[52:55], v[132:135]
  v_mfma_f32_16x16x32_bf16 v[136:139], v[28:31], v[56:59], v[136:139]
  v_mfma_f32_16x16x32_bf16 v[140:143], v[28:31], v[60:63], v[140:143]
  ds_read_b64_tr_b16 v[28:29], v219 offset:8192
  v_mfma_f32_16x16x32_bf16 v[144:147], v[32:35], v[48:51], v[144:147]
  ds_read_b64_tr_b16 v[30:31], v219 offset:9216
  v_accvgpr_write_b32 a36, 0
  v_mfma_f32_16x16x32_bf16 v[148:151], v[32:35], v[52:55], v[148:151]
  v_mfma_f32_16x16x32_bf16 v[152:155], v[32:35], v[56:59], v[152:155]
  ds_read_b128 v[76:79], v225 offset:6144
  v_mfma_f32_16x16x32_bf16 v[156:159], v[32:35], v[60:63], v[156:159]
  ds_read_b64_tr_b16 v[32:33], v220 offset:8192
  v_accvgpr_write_b32 a37, 0
  v_mfma_f32_16x16x32_bf16 v[160:163], v[36:39], v[48:51], v[160:163]
  ds_read_b64_tr_b16 v[34:35], v220 offset:9216
  v_mfma_f32_16x16x32_bf16 v[164:167], v[36:39], v[52:55], v[164:167]
  v_mfma_f32_16x16x32_bf16 v[168:171], v[36:39], v[56:59], v[168:171]
  v_mfma_f32_16x16x32_bf16 v[172:175], v[36:39], v[60:63], v[172:175]
  ds_read_b64_tr_b16 v[36:37], v221 offset:8192
  v_accvgpr_write_b32 a38, 0
s_waitcnt lgkmcnt(15)
  v_mfma_f32_16x16x32_bf16 v[176:179], v[40:43], v[48:51], v[176:179]
  ds_read_b64_tr_b16 v[38:39], v221 offset:9216
  v_mfma_f32_16x16x32_bf16 v[180:183], v[40:43], v[52:55], v[180:183]
  v_mfma_f32_16x16x32_bf16 v[184:187], v[40:43], v[56:59], v[184:187]
  v_accvgpr_write_b32 a39, 0
  v_mfma_f32_16x16x32_bf16 v[188:191], v[40:43], v[60:63], v[188:191]
  ds_read_b64_tr_b16 v[40:41], v222 offset:8192
  v_mfma_f32_16x16x32_bf16 v[192:195], v[44:47], v[48:51], v[192:195]
  ds_read_b64_tr_b16 v[42:43], v222 offset:9216
  v_mfma_f32_16x16x32_bf16 v[196:199], v[44:47], v[52:55], v[196:199]
  v_mfma_f32_16x16x32_bf16 v[200:203], v[44:47], v[56:59], v[200:203]
  v_mfma_f32_16x16x32_bf16 v[204:207], v[44:47], v[60:63], v[204:207]
  ds_read_b64_tr_b16 v[44:45], v223 offset:8192
  ds_read_b64_tr_b16 v[46:47], v223 offset:9216
  s_waitcnt lgkmcnt(4)
  v_mfma_f32_16x16x32_bf16 v[80:83], v[16:19], v[64:67], v[80:83]
  v_mfma_f32_16x16x32_bf16 v[84:87], v[16:19], v[68:71], v[84:87]
  v_mfma_f32_16x16x32_bf16 v[88:91], v[16:19], v[72:75], v[88:91]
  v_accvgpr_write_b32 a40, 0
  v_mfma_f32_16x16x32_bf16 v[92:95], v[16:19], v[76:79], v[92:95]
  v_mfma_f32_16x16x32_bf16 v[96:99], v[20:23], v[64:67], v[96:99]
  v_mfma_f32_16x16x32_bf16 v[100:103], v[20:23], v[68:71], v[100:103]
  v_accvgpr_write_b32 a41, 0
  v_mfma_f32_16x16x32_bf16 v[104:107], v[20:23], v[72:75], v[104:107]
  v_mfma_f32_16x16x32_bf16 v[108:111], v[20:23], v[76:79], v[108:111]
  s_waitcnt vmcnt(12) lgkmcnt(0)
  s_barrier
  v_mfma_f32_16x16x32_bf16 v[112:115], v[24:27], v[64:67], v[112:115]
  ds_read_b64_tr_b16 v[16:17], v216 offset:16384
  v_mfma_f32_16x16x32_bf16 v[116:119], v[24:27], v[68:71], v[116:119]
  s_add_u32 m0, s67, 0
s_nop 0
  buffer_load_dwordx4 v208, s[44:47], s64 offen offset:0 lds
  ds_read_b64_tr_b16 v[18:19], v216 offset:17408
  ds_read_b128 v[48:51], v224 offset:8192
  v_accvgpr_write_b32 a42, 0
  v_mfma_f32_16x16x32_bf16 v[120:123], v[24:27], v[72:75], v[120:123]
  buffer_load_dwordx4 v209, s[44:47], s64 offen offset:1024 lds
  ds_read_b64_tr_b16 v[20:21], v217 offset:16384
  v_mfma_f32_16x16x32_bf16 v[124:127], v[24:27], v[76:79], v[124:127]
  ds_read_b64_tr_b16 v[22:23], v217 offset:17408
  v_mfma_f32_16x16x32_bf16 v[128:131], v[28:31], v[64:67], v[128:131]
  buffer_load_dwordx4 v210, s[44:47], s64 offen offset:2048 lds
  ds_read_b64_tr_b16 v[24:25], v218 offset:16384
  ds_read_b128 v[52:55], v224 offset:10240
  v_accvgpr_write_b32 a43, 0
  v_mfma_f32_16x16x32_bf16 v[132:135], v[28:31], v[68:71], v[132:135]
  ds_read_b64_tr_b16 v[26:27], v218 offset:17408
  v_mfma_f32_16x16x32_bf16 v[136:139], v[28:31], v[72:75], v[136:139]
  buffer_load_dwordx4 v211, s[44:47], s64 offen offset:3072 lds
  v_mfma_f32_16x16x32_bf16 v[140:143], v[28:31], v[76:79], v[140:143]
  ds_read_b64_tr_b16 v[28:29], v219 offset:16384
  v_mfma_f32_16x16x32_bf16 v[144:147], v[32:35], v[64:67], v[144:147]
  s_add_u32 m0, s67, 4096
s_nop 0
  buffer_load_dwordx4 v208, s[44:47], s65 offen offset:0 lds
  ds_read_b64_tr_b16 v[30:31], v219 offset:17408
  ds_read_b128 v[56:59], v224 offset:12288
  v_accvgpr_write_b32 a44, 0
  v_mfma_f32_16x16x32_bf16 v[148:151], v[32:35], v[68:71], v[148:151]
  v_mfma_f32_16x16x32_bf16 v[152:155], v[32:35], v[72:75], v[152:155]
  buffer_load_dwordx4 v209, s[44:47], s65 offen offset:1024 lds
  v_mfma_f32_16x16x32_bf16 v[156:159], v[32:35], v[76:79], v[156:159]
  ds_read_b64_tr_b16 v[32:33], v220 offset:16384
  v_accvgpr_write_b32 a45, 0
  v_mfma_f32_16x16x32_bf16 v[160:163], v[36:39], v[64:67], v[160:163]
  buffer_load_dwordx4 v210, s[44:47], s65 offen offset:2048 lds
  ds_read_b64_tr_b16 v[34:35], v220 offset:17408
  ds_read_b128 v[60:63], v224 offset:14336
  v_mfma_f32_16x16x32_bf16 v[164:167], v[36:39], v[68:71], v[164:167]
  buffer_load_dwordx4 v211, s[44:47], s65 offen offset:3072 lds
  v_mfma_f32_16x16x32_bf16 v[168:171], v[36:39], v[72:75], v[168:171]
  v_mfma_f32_16x16x32_bf16 v[172:175], v[36:39], v[76:79], v[172:175]
  s_add_u32 m0, s68, 0
s_nop 0
  buffer_load_dwordx4 v212, s[48:51], s66 offen offset:0 lds
  ds_read_b64_tr_b16 v[36:37], v221 offset:16384
  v_accvgpr_write_b32 a46, 0
  v_mfma_f32_16x16x32_bf16 v[176:179], v[40:43], v[64:67], v[176:179]
  ds_read_b64_tr_b16 v[38:39], v221 offset:17408
  v_mfma_f32_16x16x32_bf16 v[180:183], v[40:43], v[68:71], v[180:183]
  buffer_load_dwordx4 v213, s[48:51], s66 offen offset:1024 lds
  v_mfma_f32_16x16x32_bf16 v[184:187], v[40:43], v[72:75], v[184:187]
  v_accvgpr_write_b32 a47, 0
  v_mfma_f32_16x16x32_bf16 v[188:191], v[40:43], v[76:79], v[188:191]
  buffer_load_dwordx4 v214, s[48:51], s66 offen offset:2048 lds
  ds_read_b64_tr_b16 v[40:41], v222 offset:16384
  v_mfma_f32_16x16x32_bf16 v[192:195], v[44:47], v[64:67], v[192:195]
  ds_read_b64_tr_b16 v[42:43], v222 offset:17408
  v_mfma_f32_16x16x32_bf16 v[196:199], v[44:47], v[68:71], v[196:199]
  buffer_load_dwordx4 v215, s[48:51], s66 offen offset:3072 lds
  s_add_u32 s64, s64, 128
  s_add_u32 s65, s65, 128
  s_add_u32 s66, s66, 524288
  v_mfma_f32_16x16x32_bf16 v[200:203], v[44:47], v[72:75], v[200:203]
  v_mfma_f32_16x16x32_bf16 v[204:207], v[44:47], v[76:79], v[204:207]
  ds_read_b64_tr_b16 v[44:45], v223 offset:16384
  ds_read_b64_tr_b16 v[46:47], v223 offset:17408
  s_waitcnt lgkmcnt(4)
  v_mfma_f32_16x16x32_bf16 v[80:83], v[16:19], v[48:51], v[80:83]
  v_mfma_f32_16x16x32_bf16 v[84:87], v[16:19], v[52:55], v[84:87]
  ds_read_b128 v[64:67], v225 offset:8192
  v_mfma_f32_16x16x32_bf16 v[88:91], v[16:19], v[56:59], v[88:91]
  v_accvgpr_write_b32 a48, 0
  v_mfma_f32_16x16x32_bf16 v[92:95], v[16:19], v[60:63], v[92:95]
  ds_read_b64_tr_b16 v[16:17], v216 offset:24576
  v_mfma_f32_16x16x32_bf16 v[96:99], v[20:23], v[48:51], v[96:99]
  ds_read_b64_tr_b16 v[18:19], v216 offset:25600
  v_mfma_f32_16x16x32_bf16 v[100:103], v[20:23], v[52:55], v[100:103]
  v_accvgpr_write_b32 a49, 0
  v_mfma_f32_16x16x32_bf16 v[104:107], v[20:23], v[56:59], v[104:107]
  ds_read_b128 v[68:71], v225 offset:10240
  v_mfma_f32_16x16x32_bf16 v[108:111], v[20:23], v[60:63], v[108:111]
  ds_read_b64_tr_b16 v[20:21], v217 offset:24576
  v_mfma_f32_16x16x32_bf16 v[112:115], v[24:27], v[48:51], v[112:115]
  ds_read_b64_tr_b16 v[22:23], v217 offset:25600
  v_mfma_f32_16x16x32_bf16 v[116:119], v[24:27], v[52:55], v[116:119]
  v_accvgpr_write_b32 a50, 0
  v_mfma_f32_16x16x32_bf16 v[120:123], v[24:27], v[56:59], v[120:123]
  v_mfma_f32_16x16x32_bf16 v[124:127], v[24:27], v[60:63], v[124:127]
  ds_read_b64_tr_b16 v[24:25], v218 offset:24576
  v_mfma_f32_16x16x32_bf16 v[128:131], v[28:31], v[48:51], v[128:131]
  ds_read_b64_tr_b16 v[26:27], v218 offset:25600
  ds_read_b128 v[72:75], v225 offset:12288
  v_accvgpr_write_b32 a51, 0
  v_mfma_f32_16x16x32_bf16 v[132:135], v[28:31], v[52:55], v[132:135]
  v_mfma_f32_16x16x32_bf16 v[136:139], v[28:31], v[56:59], v[136:139]
  v_mfma_f32_16x16x32_bf16 v[140:143], v[28:31], v[60:63], v[140:143]
  ds_read_b64_tr_b16 v[28:29], v219 offset:24576
  v_mfma_f32_16x16x32_bf16 v[144:147], v[32:35], v[48:51], v[144:147]
  ds_read_b64_tr_b16 v[30:31], v219 offset:25600
  v_accvgpr_write_b32 a52, 0
  v_mfma_f32_16x16x32_bf16 v[148:151], v[32:35], v[52:55], v[148:151]
  v_mfma_f32_16x16x32_bf16 v[152:155], v[32:35], v[56:59], v[152:155]
  ds_read_b128 v[76:79], v225 offset:14336
  v_mfma_f32_16x16x32_bf16 v[156:159], v[32:35], v[60:63], v[156:159]
  ds_read_b64_tr_b16 v[32:33], v220 offset:24576
  v_accvgpr_write_b32 a53, 0
  v_mfma_f32_16x16x32_bf16 v[160:163], v[36:39], v[48:51], v[160:163]
  ds_read_b64_tr_b16 v[34:35], v220 offset:25600
  v_mfma_f32_16x16x32_bf16 v[164:167], v[36:39], v[52:55], v[164:167]
  v_mfma_f32_16x16x32_bf16 v[168:171], v[36:39], v[56:59], v[168:171]
  v_mfma_f32_16x16x32_bf16 v[172:175], v[36:39], v[60:63], v[172:175]
  ds_read_b64_tr_b16 v[36:37], v221 offset:24576
  v_accvgpr_write_b32 a54, 0
s_waitcnt lgkmcnt(15)
  v_mfma_f32_16x16x32_bf16 v[176:179], v[40:43], v[48:51], v[176:179]
  ds_read_b64_tr_b16 v[38:39], v221 offset:25600
  v_mfma_f32_16x16x32_bf16 v[180:183], v[40:43], v[52:55], v[180:183]
  v_mfma_f32_16x16x32_bf16 v[184:187], v[40:43], v[56:59], v[184:187]
  v_accvgpr_write_b32 a55, 0
  v_mfma_f32_16x16x32_bf16 v[188:191], v[40:43], v[60:63], v[188:191]
  ds_read_b64_tr_b16 v[40:41], v222 offset:24576
  v_mfma_f32_16x16x32_bf16 v[192:195], v[44:47], v[48:51], v[192:195]
  ds_read_b64_tr_b16 v[42:43], v222 offset:25600
  v_mfma_f32_16x16x32_bf16 v[196:199], v[44:47], v[52:55], v[196:199]
  v_mfma_f32_16x16x32_bf16 v[200:203], v[44:47], v[56:59], v[200:203]
  v_mfma_f32_16x16x32_bf16 v[204:207], v[44:47], v[60:63], v[204:207]
  ds_read_b64_tr_b16 v[44:45], v223 offset:24576
  ds_read_b64_tr_b16 v[46:47], v223 offset:25600
  s_waitcnt lgkmcnt(4)
  v_mfma_f32_16x16x32_bf16 v[80:83], v[16:19], v[64:67], v[80:83]
  v_mfma_f32_16x16x32_bf16 v[84:87], v[16:19], v[68:71], v[84:87]
  v_mfma_f32_16x16x32_bf16 v[88:91], v[16:19], v[72:75], v[88:91]
  v_accvgpr_write_b32 a56, 0
  v_mfma_f32_16x16x32_bf16 v[92:95], v[16:19], v[76:79], v[92:95]
  v_mfma_f32_16x16x32_bf16 v[96:99], v[20:23], v[64:67], v[96:99]
  v_mfma_f32_16x16x32_bf16 v[100:103], v[20:23], v[68:71], v[100:103]
  v_accvgpr_write_b32 a57, 0
  v_mfma_f32_16x16x32_bf16 v[104:107], v[20:23], v[72:75], v[104:107]
  v_mfma_f32_16x16x32_bf16 v[108:111], v[20:23], v[76:79], v[108:111]
  s_waitcnt vmcnt(12) lgkmcnt(0)
  s_barrier
  v_mfma_f32_16x16x32_bf16 v[112:115], v[24:27], v[64:67], v[112:115]
  ds_read_b64_tr_b16 v[16:17], v216 offset:32768
  v_mfma_f32_16x16x32_bf16 v[116:119], v[24:27], v[68:71], v[116:119]
  s_add_u32 m0, s67, 8192
s_nop 0
  buffer_load_dwordx4 v208, s[44:47], s64 offen offset:0 lds
  ds_read_b64_tr_b16 v[18:19], v216 offset:33792
  ds_read_b128 v[48:51], v224 offset:16384
  v_accvgpr_write_b32 a58, 0
  v_mfma_f32_16x16x32_bf16 v[120:123], v[24:27], v[72:75], v[120:123]
  buffer_load_dwordx4 v209, s[44:47], s64 offen offset:1024 lds
  ds_read_b64_tr_b16 v[20:21], v217 offset:32768
  v_mfma_f32_16x16x32_bf16 v[124:127], v[24:27], v[76:79], v[124:127]
  ds_read_b64_tr_b16 v[22:23], v217 offset:33792
  v_mfma_f32_16x16x32_bf16 v[128:131], v[28:31], v[64:67], v[128:131]
  buffer_load_dwordx4 v210, s[44:47], s64 offen offset:2048 lds
  ds_read_b64_tr_b16 v[24:25], v218 offset:32768
  ds_read_b128 v[52:55], v224 offset:18432
  v_accvgpr_write_b32 a59, 0
  v_mfma_f32_16x16x32_bf16 v[132:135], v[28:31], v[68:71], v[132:135]
  ds_read_b64_tr_b16 v[26:27], v218 offset:33792
  v_mfma_f32_16x16x32_bf16 v[136:139], v[28:31], v[72:75], v[136:139]
  buffer_load_dwordx4 v211, s[44:47], s64 offen offset:3072 lds
  v_mfma_f32_16x16x32_bf16 v[140:143], v[28:31], v[76:79], v[140:143]
  ds_read_b64_tr_b16 v[28:29], v219 offset:32768
  v_mfma_f32_16x16x32_bf16 v[144:147], v[32:35], v[64:67], v[144:147]
  s_add_u32 m0, s67, 12288
s_nop 0
  buffer_load_dwordx4 v208, s[44:47], s65 offen offset:0 lds
  ds_read_b64_tr_b16 v[30:31], v219 offset:33792
  ds_read_b128 v[56:59], v224 offset:20480
  v_accvgpr_write_b32 a60, 0
  v_mfma_f32_16x16x32_bf16 v[148:151], v[32:35], v[68:71], v[148:151]
  v_mfma_f32_16x16x32_bf16 v[152:155], v[32:35], v[72:75], v[152:155]
  buffer_load_dwordx4 v209, s[44:47], s65 offen offset:1024 lds
  v_mfma_f32_16x16x32_bf16 v[156:159], v[32:35], v[76:79], v[156:159]
  ds_read_b64_tr_b16 v[32:33], v220 offset:32768
  v_accvgpr_write_b32 a61, 0
  v_mfma_f32_16x16x32_bf16 v[160:163], v[36:39], v[64:67], v[160:163]
  buffer_load_dwordx4 v210, s[44:47], s65 offen offset:2048 lds
  ds_read_b64_tr_b16 v[34:35], v220 offset:33792
  ds_read_b128 v[60:63], v224 offset:22528
  v_mfma_f32_16x16x32_bf16 v[164:167], v[36:39], v[68:71], v[164:167]
  buffer_load_dwordx4 v211, s[44:47], s65 offen offset:3072 lds
  v_mfma_f32_16x16x32_bf16 v[168:171], v[36:39], v[72:75], v[168:171]
  v_mfma_f32_16x16x32_bf16 v[172:175], v[36:39], v[76:79], v[172:175]
  s_add_u32 m0, s68, 16384
s_nop 0
  buffer_load_dwordx4 v212, s[48:51], s66 offen offset:0 lds
  ds_read_b64_tr_b16 v[36:37], v221 offset:32768
  v_accvgpr_write_b32 a62, 0
  v_mfma_f32_16x16x32_bf16 v[176:179], v[40:43], v[64:67], v[176:179]
  ds_read_b64_tr_b16 v[38:39], v221 offset:33792
  v_mfma_f32_16x16x32_bf16 v[180:183], v[40:43], v[68:71], v[180:183]
  buffer_load_dwordx4 v213, s[48:51], s66 offen offset:1024 lds
  v_mfma_f32_16x16x32_bf16 v[184:187], v[40:43], v[72:75], v[184:187]
  v_accvgpr_write_b32 a63, 0
  v_mfma_f32_16x16x32_bf16 v[188:191], v[40:43], v[76:79], v[188:191]
  buffer_load_dwordx4 v214, s[48:51], s66 offen offset:2048 lds
  ds_read_b64_tr_b16 v[40:41], v222 offset:32768
  v_mfma_f32_16x16x32_bf16 v[192:195], v[44:47], v[64:67], v[192:195]
  ds_read_b64_tr_b16 v[42:43], v222 offset:33792
  v_mfma_f32_16x16x32_bf16 v[196:199], v[44:47], v[68:71], v[196:199]
  buffer_load_dwordx4 v215, s[48:51], s66 offen offset:3072 lds
  s_add_u32 s64, s64, 128
  s_add_u32 s65, s65, 128
  s_add_u32 s66, s66, 524288
  v_mfma_f32_16x16x32_bf16 v[200:203], v[44:47], v[72:75], v[200:203]
  v_mfma_f32_16x16x32_bf16 v[204:207], v[44:47], v[76:79], v[204:207]
  ds_read_b64_tr_b16 v[44:45], v223 offset:32768
  ds_read_b64_tr_b16 v[46:47], v223 offset:33792
  s_waitcnt lgkmcnt(4)
  v_mfma_f32_16x16x32_bf16 v[80:83], v[16:19], v[48:51], v[80:83]
  v_mfma_f32_16x16x32_bf16 v[84:87], v[16:19], v[52:55], v[84:87]
  ds_read_b128 v[64:67], v225 offset:16384
  v_mfma_f32_16x16x32_bf16 v[88:91], v[16:19], v[56:59], v[88:91]
  v_accvgpr_write_b32 a64, 0
  v_mfma_f32_16x16x32_bf16 v[92:95], v[16:19], v[60:63], v[92:95]
  ds_read_b64_tr_b16 v[16:17], v216 offset:40960
  v_mfma_f32_16x16x32_bf16 v[96:99], v[20:23], v[48:51], v[96:99]
  ds_read_b64_tr_b16 v[18:19], v216 offset:41984
  v_mfma_f32_16x16x32_bf16 v[100:103], v[20:23], v[52:55], v[100:103]
  v_accvgpr_write_b32 a65, 0
  v_mfma_f32_16x16x32_bf16 v[104:107], v[20:23], v[56:59], v[104:107]
  ds_read_b128 v[68:71], v225 offset:18432
  v_mfma_f32_16x16x32_bf16 v[108:111], v[20:23], v[60:63], v[108:111]
  ds_read_b64_tr_b16 v[20:21], v217 offset:40960
  v_mfma_f32_16x16x32_bf16 v[112:115], v[24:27], v[48:51], v[112:115]
  ds_read_b64_tr_b16 v[22:23], v217 offset:41984
  v_mfma_f32_16x16x32_bf16 v[116:119], v[24:27], v[52:55], v[116:119]
  v_accvgpr_write_b32 a66, 0
  v_mfma_f32_16x16x32_bf16 v[120:123], v[24:27], v[56:59], v[120:123]
  v_mfma_f32_16x16x32_bf16 v[124:127], v[24:27], v[60:63], v[124:127]
  ds_read_b64_tr_b16 v[24:25], v218 offset:40960
  v_mfma_f32_16x16x32_bf16 v[128:131], v[28:31], v[48:51], v[128:131]
  ds_read_b64_tr_b16 v[26:27], v218 offset:41984
  ds_read_b128 v[72:75], v225 offset:20480
  v_accvgpr_write_b32 a67, 0
  v_mfma_f32_16x16x32_bf16 v[132:135], v[28:31], v[52:55], v[132:135]
  v_mfma_f32_16x16x32_bf16 v[136:139], v[28:31], v[56:59], v[136:139]
  v_mfma_f32_16x16x32_bf16 v[140:143], v[28:31], v[60:63], v[140:143]
  ds_read_b64_tr_b16 v[28:29], v219 offset:40960
  v_mfma_f32_16x16x32_bf16 v[144:147], v[32:35], v[48:51], v[144:147]
  ds_read_b64_tr_b16 v[30:31], v219 offset:41984
  v_accvgpr_write_b32 a68, 0
  v_mfma_f32_16x16x32_bf16 v[148:151], v[32:35], v[52:55], v[148:151]
  v_mfma_f32_16x16x32_bf16 v[152:155], v[32:35], v[56:59], v[152:155]
  ds_read_b128 v[76:79], v225 offset:22528
  v_mfma_f32_16x16x32_bf16 v[156:159], v[32:35], v[60:63], v[156:159]
  ds_read_b64_tr_b16 v[32:33], v220 offset:40960
  v_accvgpr_write_b32 a69, 0
  v_mfma_f32_16x16x32_bf16 v[160:163], v[36:39], v[48:51], v[160:163]
  ds_read_b64_tr_b16 v[34:35], v220 offset:41984
  v_mfma_f32_16x16x32_bf16 v[164:167], v[36:39], v[52:55], v[164:167]
  v_mfma_f32_16x16x32_bf16 v[168:171], v[36:39], v[56:59], v[168:171]
  v_mfma_f32_16x16x32_bf16 v[172:175], v[36:39], v[60:63], v[172:175]
  ds_read_b64_tr_b16 v[36:37], v221 offset:40960
  v_accvgpr_write_b32 a70, 0
s_waitcnt lgkmcnt(15)
  v_mfma_f32_16x16x32_bf16 v[176:179], v[40:43], v[48:51], v[176:179]
  ds_read_b64_tr_b16 v[38:39], v221 offset:41984
  v_mfma_f32_16x16x32_bf16 v[180:183], v[40:43], v[52:55], v[180:183]
  v_mfma_f32_16x16x32_bf16 v[184:187], v[40:43], v[56:59], v[184:187]
  v_accvgpr_write_b32 a71, 0
  v_mfma_f32_16x16x32_bf16 v[188:191], v[40:43], v[60:63], v[188:191]
  ds_read_b64_tr_b16 v[40:41], v222 offset:40960
  v_mfma_f32_16x16x32_bf16 v[192:195], v[44:47], v[48:51], v[192:195]
  ds_read_b64_tr_b16 v[42:43], v222 offset:41984
  v_mfma_f32_16x16x32_bf16 v[196:199], v[44:47], v[52:55], v[196:199]
  v_mfma_f32_16x16x32_bf16 v[200:203], v[44:47], v[56:59], v[200:203]
  v_mfma_f32_16x16x32_bf16 v[204:207], v[44:47], v[60:63], v[204:207]
  ds_read_b64_tr_b16 v[44:45], v223 offset:40960
  ds_read_b64_tr_b16 v[46:47], v223 offset:41984
  s_waitcnt lgkmcnt(4)
  v_mfma_f32_16x16x32_bf16 v[80:83], v[16:19], v[64:67], v[80:83]
  v_mfma_f32_16x16x32_bf16 v[84:87], v[16:19], v[68:71], v[84:87]
  v_mfma_f32_16x16x32_bf16 v[88:91], v[16:19], v[72:75], v[88:91]
  v_accvgpr_write_b32 a72, 0
  v_mfma_f32_16x16x32_bf16 v[92:95], v[16:19], v[76:79], v[92:95]
  v_mfma_f32_16x16x32_bf16 v[96:99], v[20:23], v[64:67], v[96:99]
  v_mfma_f32_16x16x32_bf16 v[100:103], v[20:23], v[68:71], v[100:103]
  v_accvgpr_write_b32 a73, 0
  v_mfma_f32_16x16x32_bf16 v[104:107], v[20:23], v[72:75], v[104:107]
  v_mfma_f32_16x16x32_bf16 v[108:111], v[20:23], v[76:79], v[108:111]
  s_waitcnt vmcnt(12) lgkmcnt(0)
  s_barrier
  v_mfma_f32_16x16x32_bf16 v[112:115], v[24:27], v[64:67], v[112:115]
  ds_read_b64_tr_b16 v[16:17], v216 offset:0
  v_mfma_f32_16x16x32_bf16 v[116:119], v[24:27], v[68:71], v[116:119]
  s_add_u32 m0, s67, 16384
s_nop 0
  buffer_load_dwordx4 v208, s[44:47], s64 offen offset:0 lds
  ds_read_b64_tr_b16 v[18:19], v216 offset:1024
  ds_read_b128 v[48:51], v224 offset:0
  v_accvgpr_write_b32 a74, 0
  v_mfma_f32_16x16x32_bf16 v[120:123], v[24:27], v[72:75], v[120:123]
  buffer_load_dwordx4 v209, s[44:47], s64 offen offset:1024 lds
  ds_read_b64_tr_b16 v[20:21], v217 offset:0
  v_mfma_f32_16x16x32_bf16 v[124:127], v[24:27], v[76:79], v[124:127]
  ds_read_b64_tr_b16 v[22:23], v217 offset:1024
  v_mfma_f32_16x16x32_bf16 v[128:131], v[28:31], v[64:67], v[128:131]
  buffer_load_dwordx4 v210, s[44:47], s64 offen offset:2048 lds
  ds_read_b64_tr_b16 v[24:25], v218 offset:0
  ds_read_b128 v[52:55], v224 offset:2048
  v_accvgpr_write_b32 a75, 0
  v_mfma_f32_16x16x32_bf16 v[132:135], v[28:31], v[68:71], v[132:135]
  ds_read_b64_tr_b16 v[26:27], v218 offset:1024
  v_mfma_f32_16x16x32_bf16 v[136:139], v[28:31], v[72:75], v[136:139]
  buffer_load_dwordx4 v211, s[44:47], s64 offen offset:3072 lds
  v_mfma_f32_16x16x32_bf16 v[140:143], v[28:31], v[76:79], v[140:143]
  ds_read_b64_tr_b16 v[28:29], v219 offset:0
  v_mfma_f32_16x16x32_bf16 v[144:147], v[32:35], v[64:67], v[144:147]
  s_add_u32 m0, s67, 20480
s_nop 0
  buffer_load_dwordx4 v208, s[44:47], s65 offen offset:0 lds
  ds_read_b64_tr_b16 v[30:31], v219 offset:1024
  ds_read_b128 v[56:59], v224 offset:4096
  v_accvgpr_write_b32 a76, 0
  v_mfma_f32_16x16x32_bf16 v[148:151], v[32:35], v[68:71], v[148:151]
  v_mfma_f32_16x16x32_bf16 v[152:155], v[32:35], v[72:75], v[152:155]
  buffer_load_dwordx4 v209, s[44:47], s65 offen offset:1024 lds
  v_mfma_f32_16x16x32_bf16 v[156:159], v[32:35], v[76:79], v[156:159]
  ds_read_b64_tr_b16 v[32:33], v220 offset:0
  v_accvgpr_write_b32 a77, 0
  v_mfma_f32_16x16x32_bf16 v[160:163], v[36:39], v[64:67], v[160:163]
  buffer_load_dwordx4 v210, s[44:47], s65 offen offset:2048 lds
  ds_read_b64_tr_b16 v[34:35], v220 offset:1024
  ds_read_b128 v[60:63], v224 offset:6144
  v_mfma_f32_16x16x32_bf16 v[164:167], v[36:39], v[68:71], v[164:167]
  buffer_load_dwordx4 v211, s[44:47], s65 offen offset:3072 lds
  v_mfma_f32_16x16x32_bf16 v[168:171], v[36:39], v[72:75], v[168:171]
  v_mfma_f32_16x16x32_bf16 v[172:175], v[36:39], v[76:79], v[172:175]
  s_add_u32 m0, s68, 32768
s_nop 0
  buffer_load_dwordx4 v212, s[48:51], s66 offen offset:0 lds
  ds_read_b64_tr_b16 v[36:37], v221 offset:0
  v_accvgpr_write_b32 a78, 0
  v_mfma_f32_16x16x32_bf16 v[176:179], v[40:43], v[64:67], v[176:179]
  ds_read_b64_tr_b16 v[38:39], v221 offset:1024
  v_mfma_f32_16x16x32_bf16 v[180:183], v[40:43], v[68:71], v[180:183]
  buffer_load_dwordx4 v213, s[48:51], s66 offen offset:1024 lds
  v_mfma_f32_16x16x32_bf16 v[184:187], v[40:43], v[72:75], v[184:187]
  v_accvgpr_write_b32 a79, 0
  v_mfma_f32_16x16x32_bf16 v[188:191], v[40:43], v[76:79], v[188:191]
  buffer_load_dwordx4 v214, s[48:51], s66 offen offset:2048 lds
  ds_read_b64_tr_b16 v[40:41], v222 offset:0
  v_mfma_f32_16x16x32_bf16 v[192:195], v[44:47], v[64:67], v[192:195]
  ds_read_b64_tr_b16 v[42:43], v222 offset:1024
  v_mfma_f32_16x16x32_bf16 v[196:199], v[44:47], v[68:71], v[196:199]
  buffer_load_dwordx4 v215, s[48:51], s66 offen offset:3072 lds
  s_add_u32 s64, s64, 128
  s_add_u32 s65, s65, 128
  s_add_u32 s66, s66, 524288
  v_mfma_f32_16x16x32_bf16 v[200:203], v[44:47], v[72:75], v[200:203]
  v_mfma_f32_16x16x32_bf16 v[204:207], v[44:47], v[76:79], v[204:207]
  ds_read_b64_tr_b16 v[44:45], v223 offset:0
  ds_read_b64_tr_b16 v[46:47], v223 offset:1024
  s_waitcnt lgkmcnt(4)
  v_mfma_f32_16x16x32_bf16 v[80:83], v[16:19], v[48:51], v[80:83]
  v_mfma_f32_16x16x32_bf16 v[84:87], v[16:19], v[52:55], v[84:87]
  ds_read_b128 v[64:67], v225 offset:0
  v_mfma_f32_16x16x32_bf16 v[88:91], v[16:19], v[56:59], v[88:91]
  v_accvgpr_write_b32 a80, 0
  v_mfma_f32_16x16x32_bf16 v[92:95], v[16:19], v[60:63], v[92:95]
  ds_read_b64_tr_b16 v[16:17], v216 offset:8192
  v_mfma_f32_16x16x32_bf16 v[96:99], v[20:23], v[48:51], v[96:99]
  ds_read_b64_tr_b16 v[18:19], v216 offset:9216
  v_mfma_f32_16x16x32_bf16 v[100:103], v[20:23], v[52:55], v[100:103]
  v_accvgpr_write_b32 a81, 0
  v_mfma_f32_16x16x32_bf16 v[104:107], v[20:23], v[56:59], v[104:107]
  ds_read_b128 v[68:71], v225 offset:2048
  v_mfma_f32_16x16x32_bf16 v[108:111], v[20:23], v[60:63], v[108:111]
  ds_read_b64_tr_b16 v[20:21], v217 offset:8192
  v_mfma_f32_16x16x32_bf16 v[112:115], v[24:27], v[48:51], v[112:115]
  ds_read_b64_tr_b16 v[22:23], v217 offset:9216
  v_mfma_f32_16x16x32_bf16 v[116:119], v[24:27], v[52:55], v[116:119]
  v_accvgpr_write_b32 a82, 0
  v_mfma_f32_16x16x32_bf16 v[120:123], v[24:27], v[56:59], v[120:123]
  v_mfma_f32_16x16x32_bf16 v[124:127], v[24:27], v[60:63], v[124:127]
  ds_read_b64_tr_b16 v[24:25], v218 offset:8192
  v_mfma_f32_16x16x32_bf16 v[128:131], v[28:31], v[48:51], v[128:131]
  ds_read_b64_tr_b16 v[26:27], v218 offset:9216
  ds_read_b128 v[72:75], v225 offset:4096
  v_accvgpr_write_b32 a83, 0
  v_mfma_f32_16x16x32_bf16 v[132:135], v[28:31], v[52:55], v[132:135]
  v_mfma_f32_16x16x32_bf16 v[136:139], v[28:31], v[56:59], v[136:139]
  v_mfma_f32_16x16x32_bf16 v[140:143], v[28:31], v[60:63], v[140:143]
  ds_read_b64_tr_b16 v[28:29], v219 offset:8192
  v_mfma_f32_16x16x32_bf16 v[144:147], v[32:35], v[48:51], v[144:147]
  ds_read_b64_tr_b16 v[30:31], v219 offset:9216
  v_accvgpr_write_b32 a84, 0
  v_mfma_f32_16x16x32_bf16 v[148:151], v[32:35], v[52:55], v[148:151]
  v_mfma_f32_16x16x32_bf16 v[152:155], v[32:35], v[56:59], v[152:155]
  ds_read_b128 v[76:79], v225 offset:6144
  v_mfma_f32_16x16x32_bf16 v[156:159], v[32:35], v[60:63], v[156:159]
  ds_read_b64_tr_b16 v[32:33], v220 offset:8192
  v_accvgpr_write_b32 a85, 0
  v_mfma_f32_16x16x32_bf16 v[160:163], v[36:39], v[48:51], v[160:163]
  ds_read_b64_tr_b16 v[34:35], v220 offset:9216
  v_mfma_f32_16x16x32_bf16 v[164:167], v[36:39], v[52:55], v[164:167]
  v_mfma_f32_16x16x32_bf16 v[168:171], v[36:39], v[56:59], v[168:171]
  v_mfma_f32_16x16x32_bf16 v[172:175], v[36:39], v[60:63], v[172:175]
  ds_read_b64_tr_b16 v[36:37], v221 offset:8192
  v_accvgpr_write_b32 a86, 0
s_waitcnt lgkmcnt(15)
  v_mfma_f32_16x16x32_bf16 v[176:179], v[40:43], v[48:51], v[176:179]
  ds_read_b64_tr_b16 v[38:39], v221 offset:9216
  v_mfma_f32_16x16x32_bf16 v[180:183], v[40:43], v[52:55], v[180:183]
  v_mfma_f32_16x16x32_bf16 v[184:187], v[40:43], v[56:59], v[184:187]
  v_accvgpr_write_b32 a87, 0
  v_mfma_f32_16x16x32_bf16 v[188:191], v[40:43], v[60:63], v[188:191]
  ds_read_b64_tr_b16 v[40:41], v222 offset:8192
  v_mfma_f32_16x16x32_bf16 v[192:195], v[44:47], v[48:51], v[192:195]
  ds_read_b64_tr_b16 v[42:43], v222 offset:9216
  v_mfma_f32_16x16x32_bf16 v[196:199], v[44:47], v[52:55], v[196:199]
  v_mfma_f32_16x16x32_bf16 v[200:203], v[44:47], v[56:59], v[200:203]
  v_mfma_f32_16x16x32_bf16 v[204:207], v[44:47], v[60:63], v[204:207]
  ds_read_b64_tr_b16 v[44:45], v223 offset:8192
  ds_read_b64_tr_b16 v[46:47], v223 offset:9216
  s_waitcnt lgkmcnt(4)
  v_mfma_f32_16x16x32_bf16 v[80:83], v[16:19], v[64:67], v[80:83]
  v_mfma_f32_16x16x32_bf16 v[84:87], v[16:19], v[68:71], v[84:87]
  v_mfma_f32_16x16x32_bf16 v[88:91], v[16:19], v[72:75], v[88:91]
  v_accvgpr_write_b32 a88, 0
  v_mfma_f32_16x16x32_bf16 v[92:95], v[16:19], v[76:79], v[92:95]
  v_mfma_f32_16x16x32_bf16 v[96:99], v[20:23], v[64:67], v[96:99]
  v_mfma_f32_16x16x32_bf16 v[100:103], v[20:23], v[68:71], v[100:103]
  v_accvgpr_write_b32 a89, 0
  v_mfma_f32_16x16x32_bf16 v[104:107], v[20:23], v[72:75], v[104:107]
  v_mfma_f32_16x16x32_bf16 v[108:111], v[20:23], v[76:79], v[108:111]
  s_waitcnt vmcnt(12) lgkmcnt(0)
  s_barrier
  v_mfma_f32_16x16x32_bf16 v[112:115], v[24:27], v[64:67], v[112:115]
  ds_read_b64_tr_b16 v[16:17], v216 offset:16384
  v_mfma_f32_16x16x32_bf16 v[116:119], v[24:27], v[68:71], v[116:119]
  s_add_u32 m0, s67, 0
s_nop 0
  buffer_load_dwordx4 v208, s[44:47], s64 offen offset:0 lds
  ds_read_b64_tr_b16 v[18:19], v216 offset:17408
  ds_read_b128 v[48:51], v224 offset:8192
  v_accvgpr_write_b32 a90, 0
  v_mfma_f32_16x16x32_bf16 v[120:123], v[24:27], v[72:75], v[120:123]
  buffer_load_dwordx4 v209, s[44:47], s64 offen offset:1024 lds
  ds_read_b64_tr_b16 v[20:21], v217 offset:16384
  v_mfma_f32_16x16x32_bf16 v[124:127], v[24:27], v[76:79], v[124:127]
  ds_read_b64_tr_b16 v[22:23], v217 offset:17408
  v_mfma_f32_16x16x32_bf16 v[128:131], v[28:31], v[64:67], v[128:131]
  buffer_load_dwordx4 v210, s[44:47], s64 offen offset:2048 lds
  ds_read_b64_tr_b16 v[24:25], v218 offset:16384
  ds_read_b128 v[52:55], v224 offset:10240
  v_accvgpr_write_b32 a91, 0
  v_mfma_f32_16x16x32_bf16 v[132:135], v[28:31], v[68:71], v[132:135]
  ds_read_b64_tr_b16 v[26:27], v218 offset:17408
  v_mfma_f32_16x16x32_bf16 v[136:139], v[28:31], v[72:75], v[136:139]
  buffer_load_dwordx4 v211, s[44:47], s64 offen offset:3072 lds
  v_mfma_f32_16x16x32_bf16 v[140:143], v[28:31], v[76:79], v[140:143]
  ds_read_b64_tr_b16 v[28:29], v219 offset:16384
  v_mfma_f32_16x16x32_bf16 v[144:147], v[32:35], v[64:67], v[144:147]
  s_add_u32 m0, s67, 4096
s_nop 0
  buffer_load_dwordx4 v208, s[44:47], s65 offen offset:0 lds
  ds_read_b64_tr_b16 v[30:31], v219 offset:17408
  ds_read_b128 v[56:59], v224 offset:12288
  v_accvgpr_write_b32 a92, 0
  v_mfma_f32_16x16x32_bf16 v[148:151], v[32:35], v[68:71], v[148:151]
  v_mfma_f32_16x16x32_bf16 v[152:155], v[32:35], v[72:75], v[152:155]
  buffer_load_dwordx4 v209, s[44:47], s65 offen offset:1024 lds
  v_mfma_f32_16x16x32_bf16 v[156:159], v[32:35], v[76:79], v[156:159]
  ds_read_b64_tr_b16 v[32:33], v220 offset:16384
  v_accvgpr_write_b32 a93, 0
  v_mfma_f32_16x16x32_bf16 v[160:163], v[36:39], v[64:67], v[160:163]
  buffer_load_dwordx4 v210, s[44:47], s65 offen offset:2048 lds
  ds_read_b64_tr_b16 v[34:35], v220 offset:17408
  ds_read_b128 v[60:63], v224 offset:14336
  v_mfma_f32_16x16x32_bf16 v[164:167], v[36:39], v[68:71], v[164:167]
  buffer_load_dwordx4 v211, s[44:47], s65 offen offset:3072 lds
  v_mfma_f32_16x16x32_bf16 v[168:171], v[36:39], v[72:75], v[168:171]
  v_mfma_f32_16x16x32_bf16 v[172:175], v[36:39], v[76:79], v[172:175]
  s_add_u32 m0, s68, 0
s_nop 0
  buffer_load_dwordx4 v212, s[48:51], s66 offen offset:0 lds
  ds_read_b64_tr_b16 v[36:37], v221 offset:16384
  v_accvgpr_write_b32 a94, 0
  v_mfma_f32_16x16x32_bf16 v[176:179], v[40:43], v[64:67], v[176:179]
  ds_read_b64_tr_b16 v[38:39], v221 offset:17408
  v_mfma_f32_16x16x32_bf16 v[180:183], v[40:43], v[68:71], v[180:183]
  buffer_load_dwordx4 v213, s[48:51], s66 offen offset:1024 lds
  v_mfma_f32_16x16x32_bf16 v[184:187], v[40:43], v[72:75], v[184:187]
  v_accvgpr_write_b32 a95, 0
  v_mfma_f32_16x16x32_bf16 v[188:191], v[40:43], v[76:79], v[188:191]
  buffer_load_dwordx4 v214, s[48:51], s66 offen offset:2048 lds
  ds_read_b64_tr_b16 v[40:41], v222 offset:16384
  v_mfma_f32_16x16x32_bf16 v[192:195], v[44:47], v[64:67], v[192:195]
  ds_read_b64_tr_b16 v[42:43], v222 offset:17408
  v_mfma_f32_16x16x32_bf16 v[196:199], v[44:47], v[68:71], v[196:199]
  buffer_load_dwordx4 v215, s[48:51], s66 offen offset:3072 lds
  s_add_u32 s64, s64, 128
  s_add_u32 s65, s65, 128
  s_add_u32 s66, s66, 524288
  v_mfma_f32_16x16x32_bf16 v[200:203], v[44:47], v[72:75], v[200:203]
  v_mfma_f32_16x16x32_bf16 v[204:207], v[44:47], v[76:79], v[204:207]
  ds_read_b64_tr_b16 v[44:45], v223 offset:16384
  ds_read_b64_tr_b16 v[46:47], v223 offset:17408
  s_waitcnt lgkmcnt(4)
  v_mfma_f32_16x16x32_bf16 v[80:83], v[16:19], v[48:51], v[80:83]
  v_mfma_f32_16x16x32_bf16 v[84:87], v[16:19], v[52:55], v[84:87]
  ds_read_b128 v[64:67], v225 offset:8192
  v_mfma_f32_16x16x32_bf16 v[88:91], v[16:19], v[56:59], v[88:91]
  v_accvgpr_write_b32 a96, 0
  v_mfma_f32_16x16x32_bf16 v[92:95], v[16:19], v[60:63], v[92:95]
  ds_read_b64_tr_b16 v[16:17], v216 offset:24576
  v_mfma_f32_16x16x32_bf16 v[96:99], v[20:23], v[48:51], v[96:99]
  ds_read_b64_tr_b16 v[18:19], v216 offset:25600
  v_mfma_f32_16x16x32_bf16 v[100:103], v[20:23], v[52:55], v[100:103]
  v_accvgpr_write_b32 a97, 0
  v_mfma_f32_16x16x32_bf16 v[104:107], v[20:23], v[56:59], v[104:107]
  ds_read_b128 v[68:71], v225 offset:10240
  v_mfma_f32_16x16x32_bf16 v[108:111], v[20:23], v[60:63], v[108:111]
  ds_read_b64_tr_b16 v[20:21], v217 offset:24576
  v_mfma_f32_16x16x32_bf16 v[112:115], v[24:27], v[48:51], v[112:115]
  ds_read_b64_tr_b16 v[22:23], v217 offset:25600
  v_mfma_f32_16x16x32_bf16 v[116:119], v[24:27], v[52:55], v[116:119]
  v_accvgpr_write_b32 a98, 0
  v_mfma_f32_16x16x32_bf16 v[120:123], v[24:27], v[56:59], v[120:123]
  v_mfma_f32_16x16x32_bf16 v[124:127], v[24:27], v[60:63], v[124:127]
  ds_read_b64_tr_b16 v[24:25], v218 offset:24576
  v_mfma_f32_16x16x32_bf16 v[128:131], v[28:31], v[48:51], v[128:131]
  ds_read_b64_tr_b16 v[26:27], v218 offset:25600
  ds_read_b128 v[72:75], v225 offset:12288
  v_accvgpr_write_b32 a99, 0
  v_mfma_f32_16x16x32_bf16 v[132:135], v[28:31], v[52:55], v[132:135]
  v_mfma_f32_16x16x32_bf16 v[136:139], v[28:31], v[56:59], v[136:139]
  v_mfma_f32_16x16x32_bf16 v[140:143], v[28:31], v[60:63], v[140:143]
  ds_read_b64_tr_b16 v[28:29], v219 offset:24576
  v_mfma_f32_16x16x32_bf16 v[144:147], v[32:35], v[48:51], v[144:147]
  ds_read_b64_tr_b16 v[30:31], v219 offset:25600
  v_accvgpr_write_b32 a100, 0
  v_mfma_f32_16x16x32_bf16 v[148:151], v[32:35], v[52:55], v[148:151]
  v_mfma_f32_16x16x32_bf16 v[152:155], v[32:35], v[56:59], v[152:155]
  ds_read_b128 v[76:79], v225 offset:14336
  v_mfma_f32_16x16x32_bf16 v[156:159], v[32:35], v[60:63], v[156:159]
  ds_read_b64_tr_b16 v[32:33], v220 offset:24576
  v_accvgpr_write_b32 a101, 0
  v_mfma_f32_16x16x32_bf16 v[160:163], v[36:39], v[48:51], v[160:163]
  ds_read_b64_tr_b16 v[34:35], v220 offset:25600
  v_mfma_f32_16x16x32_bf16 v[164:167], v[36:39], v[52:55], v[164:167]
  v_mfma_f32_16x16x32_bf16 v[168:171], v[36:39], v[56:59], v[168:171]
  v_mfma_f32_16x16x32_bf16 v[172:175], v[36:39], v[60:63], v[172:175]
  ds_read_b64_tr_b16 v[36:37], v221 offset:24576
  v_accvgpr_write_b32 a102, 0
s_waitcnt lgkmcnt(15)
  v_mfma_f32_16x16x32_bf16 v[176:179], v[40:43], v[48:51], v[176:179]
  ds_read_b64_tr_b16 v[38:39], v221 offset:25600
  v_mfma_f32_16x16x32_bf16 v[180:183], v[40:43], v[52:55], v[180:183]
  v_mfma_f32_16x16x32_bf16 v[184:187], v[40:43], v[56:59], v[184:187]
  v_accvgpr_write_b32 a103, 0
  v_mfma_f32_16x16x32_bf16 v[188:191], v[40:43], v[60:63], v[188:191]
  ds_read_b64_tr_b16 v[40:41], v222 offset:24576
  v_mfma_f32_16x16x32_bf16 v[192:195], v[44:47], v[48:51], v[192:195]
  ds_read_b64_tr_b16 v[42:43], v222 offset:25600
  v_mfma_f32_16x16x32_bf16 v[196:199], v[44:47], v[52:55], v[196:199]
  v_mfma_f32_16x16x32_bf16 v[200:203], v[44:47], v[56:59], v[200:203]
  v_mfma_f32_16x16x32_bf16 v[204:207], v[44:47], v[60:63], v[204:207]
  ds_read_b64_tr_b16 v[44:45], v223 offset:24576
  ds_read_b64_tr_b16 v[46:47], v223 offset:25600
  s_waitcnt lgkmcnt(4)
  v_mfma_f32_16x16x32_bf16 v[80:83], v[16:19], v[64:67], v[80:83]
  v_mfma_f32_16x16x32_bf16 v[84:87], v[16:19], v[68:71], v[84:87]
  v_mfma_f32_16x16x32_bf16 v[88:91], v[16:19], v[72:75], v[88:91]
  v_accvgpr_write_b32 a104, 0
  v_mfma_f32_16x16x32_bf16 v[92:95], v[16:19], v[76:79], v[92:95]
  v_mfma_f32_16x16x32_bf16 v[96:99], v[20:23], v[64:67], v[96:99]
  v_mfma_f32_16x16x32_bf16 v[100:103], v[20:23], v[68:71], v[100:103]
  v_accvgpr_write_b32 a105, 0
  v_mfma_f32_16x16x32_bf16 v[104:107], v[20:23], v[72:75], v[104:107]
  v_mfma_f32_16x16x32_bf16 v[108:111], v[20:23], v[76:79], v[108:111]
  s_waitcnt vmcnt(12) lgkmcnt(0)
  s_barrier
  v_mfma_f32_16x16x32_bf16 v[112:115], v[24:27], v[64:67], v[112:115]
  ds_read_b64_tr_b16 v[16:17], v216 offset:32768
  v_mfma_f32_16x16x32_bf16 v[116:119], v[24:27], v[68:71], v[116:119]
  s_add_u32 m0, s67, 8192
s_nop 0
  buffer_load_dwordx4 v208, s[44:47], s64 offen offset:0 lds
  ds_read_b64_tr_b16 v[18:19], v216 offset:33792
  ds_read_b128 v[48:51], v224 offset:16384
  v_accvgpr_write_b32 a106, 0
  v_mfma_f32_16x16x32_bf16 v[120:123], v[24:27], v[72:75], v[120:123]
  buffer_load_dwordx4 v209, s[44:47], s64 offen offset:1024 lds
  ds_read_b64_tr_b16 v[20:21], v217 offset:32768
  v_mfma_f32_16x16x32_bf16 v[124:127], v[24:27], v[76:79], v[124:127]
  ds_read_b64_tr_b16 v[22:23], v217 offset:33792
  v_mfma_f32_16x16x32_bf16 v[128:131], v[28:31], v[64:67], v[128:131]
  buffer_load_dwordx4 v210, s[44:47], s64 offen offset:2048 lds
  ds_read_b64_tr_b16 v[24:25], v218 offset:32768
  ds_read_b128 v[52:55], v224 offset:18432
  v_accvgpr_write_b32 a107, 0
  v_mfma_f32_16x16x32_bf16 v[132:135], v[28:31], v[68:71], v[132:135]
  ds_read_b64_tr_b16 v[26:27], v218 offset:33792
  v_mfma_f32_16x16x32_bf16 v[136:139], v[28:31], v[72:75], v[136:139]
  buffer_load_dwordx4 v211, s[44:47], s64 offen offset:3072 lds
  v_mfma_f32_16x16x32_bf16 v[140:143], v[28:31], v[76:79], v[140:143]
  ds_read_b64_tr_b16 v[28:29], v219 offset:32768
  v_mfma_f32_16x16x32_bf16 v[144:147], v[32:35], v[64:67], v[144:147]
  s_add_u32 m0, s67, 12288
s_nop 0
  buffer_load_dwordx4 v208, s[44:47], s65 offen offset:0 lds
  ds_read_b64_tr_b16 v[30:31], v219 offset:33792
  ds_read_b128 v[56:59], v224 offset:20480
  v_accvgpr_write_b32 a108, 0
  v_mfma_f32_16x16x32_bf16 v[148:151], v[32:35], v[68:71], v[148:151]
  v_mfma_f32_16x16x32_bf16 v[152:155], v[32:35], v[72:75], v[152:155]
  buffer_load_dwordx4 v209, s[44:47], s65 offen offset:1024 lds
  v_mfma_f32_16x16x32_bf16 v[156:159], v[32:35], v[76:79], v[156:159]
  ds_read_b64_tr_b16 v[32:33], v220 offset:32768
  v_accvgpr_write_b32 a109, 0
  v_mfma_f32_16x16x32_bf16 v[160:163], v[36:39], v[64:67], v[160:163]
  buffer_load_dwordx4 v210, s[44:47], s65 offen offset:2048 lds
  ds_read_b64_tr_b16 v[34:35], v220 offset:33792
  ds_read_b128 v[60:63], v224 offset:22528
  v_mfma_f32_16x16x32_bf16 v[164:167], v[36:39], v[68:71], v[164:167]
  buffer_load_dwordx4 v211, s[44:47], s65 offen offset:3072 lds
  v_mfma_f32_16x16x32_bf16 v[168:171], v[36:39], v[72:75], v[168:171]
  v_mfma_f32_16x16x32_bf16 v[172:175], v[36:39], v[76:79], v[172:175]
  s_add_u32 m0, s68, 16384
s_nop 0
  buffer_load_dwordx4 v212, s[48:51], s66 offen offset:0 lds
  ds_read_b64_tr_b16 v[36:37], v221 offset:32768
  v_accvgpr_write_b32 a110, 0
  v_mfma_f32_16x16x32_bf16 v[176:179], v[40:43], v[64:67], v[176:179]
  ds_read_b64_tr_b16 v[38:39], v221 offset:33792
  v_mfma_f32_16x16x32_bf16 v[180:183], v[40:43], v[68:71], v[180:183]
  buffer_load_dwordx4 v213, s[48:51], s66 offen offset:1024 lds
  v_mfma_f32_16x16x32_bf16 v[184:187], v[40:43], v[72:75], v[184:187]
  v_accvgpr_write_b32 a111, 0
  v_mfma_f32_16x16x32_bf16 v[188:191], v[40:43], v[76:79], v[188:191]
  buffer_load_dwordx4 v214, s[48:51], s66 offen offset:2048 lds
  ds_read_b64_tr_b16 v[40:41], v222 offset:32768
  v_mfma_f32_16x16x32_bf16 v[192:195], v[44:47], v[64:67], v[192:195]
  ds_read_b64_tr_b16 v[42:43], v222 offset:33792
  v_mfma_f32_16x16x32_bf16 v[196:199], v[44:47], v[68:71], v[196:199]
  buffer_load_dwordx4 v215, s[48:51], s66 offen offset:3072 lds
  s_add_u32 s64, s64, 128
  s_add_u32 s65, s65, 128
  s_add_u32 s66, s66, 524288
  v_mfma_f32_16x16x32_bf16 v[200:203], v[44:47], v[72:75], v[200:203]
  v_mfma_f32_16x16x32_bf16 v[204:207], v[44:47], v[76:79], v[204:207]
  ds_read_b64_tr_b16 v[44:45], v223 offset:32768
  ds_read_b64_tr_b16 v[46:47], v223 offset:33792
  s_waitcnt lgkmcnt(4)
  v_mfma_f32_16x16x32_bf16 v[80:83], v[16:19], v[48:51], v[80:83]
  v_mfma_f32_16x16x32_bf16 v[84:87], v[16:19], v[52:55], v[84:87]
  ds_read_b128 v[64:67], v225 offset:16384
  v_mfma_f32_16x16x32_bf16 v[88:91], v[16:19], v[56:59], v[88:91]
  v_accvgpr_write_b32 a112, 0
  v_mfma_f32_16x16x32_bf16 v[92:95], v[16:19], v[60:63], v[92:95]
  ds_read_b64_tr_b16 v[16:17], v216 offset:40960
  v_mfma_f32_16x16x32_bf16 v[96:99], v[20:23], v[48:51], v[96:99]
  ds_read_b64_tr_b16 v[18:19], v216 offset:41984
  v_mfma_f32_16x16x32_bf16 v[100:103], v[20:23], v[52:55], v[100:103]
  v_accvgpr_write_b32 a113, 0
  v_mfma_f32_16x16x32_bf16 v[104:107], v[20:23], v[56:59], v[104:107]
  ds_read_b128 v[68:71], v225 offset:18432
  v_mfma_f32_16x16x32_bf16 v[108:111], v[20:23], v[60:63], v[108:111]
  ds_read_b64_tr_b16 v[20:21], v217 offset:40960
  v_mfma_f32_16x16x32_bf16 v[112:115], v[24:27], v[48:51], v[112:115]
  ds_read_b64_tr_b16 v[22:23], v217 offset:41984
  v_mfma_f32_16x16x32_bf16 v[116:119], v[24:27], v[52:55], v[116:119]
  v_accvgpr_write_b32 a114, 0
  v_mfma_f32_16x16x32_bf16 v[120:123], v[24:27], v[56:59], v[120:123]
  v_mfma_f32_16x16x32_bf16 v[124:127], v[24:27], v[60:63], v[124:127]
  ds_read_b64_tr_b16 v[24:25], v218 offset:40960
  v_mfma_f32_16x16x32_bf16 v[128:131], v[28:31], v[48:51], v[128:131]
  ds_read_b64_tr_b16 v[26:27], v218 offset:41984
  ds_read_b128 v[72:75], v225 offset:20480
  v_accvgpr_write_b32 a115, 0
  v_mfma_f32_16x16x32_bf16 v[132:135], v[28:31], v[52:55], v[132:135]
  v_mfma_f32_16x16x32_bf16 v[136:139], v[28:31], v[56:59], v[136:139]
  v_mfma_f32_16x16x32_bf16 v[140:143], v[28:31], v[60:63], v[140:143]
  ds_read_b64_tr_b16 v[28:29], v219 offset:40960
  v_mfma_f32_16x16x32_bf16 v[144:147], v[32:35], v[48:51], v[144:147]
  ds_read_b64_tr_b16 v[30:31], v219 offset:41984
  v_accvgpr_write_b32 a116, 0
  v_mfma_f32_16x16x32_bf16 v[148:151], v[32:35], v[52:55], v[148:151]
  v_mfma_f32_16x16x32_bf16 v[152:155], v[32:35], v[56:59], v[152:155]
  ds_read_b128 v[76:79], v225 offset:22528
  v_mfma_f32_16x16x32_bf16 v[156:159], v[32:35], v[60:63], v[156:159]
  ds_read_b64_tr_b16 v[32:33], v220 offset:40960
  v_accvgpr_write_b32 a117, 0
  v_mfma_f32_16x16x32_bf16 v[160:163], v[36:39], v[48:51], v[160:163]
  ds_read_b64_tr_b16 v[34:35], v220 offset:41984
  v_mfma_f32_16x16x32_bf16 v[164:167], v[36:39], v[52:55], v[164:167]
  v_mfma_f32_16x16x32_bf16 v[168:171], v[36:39], v[56:59], v[168:171]
  v_mfma_f32_16x16x32_bf16 v[172:175], v[36:39], v[60:63], v[172:175]
  ds_read_b64_tr_b16 v[36:37], v221 offset:40960
  v_accvgpr_write_b32 a118, 0
s_waitcnt lgkmcnt(15)
  v_mfma_f32_16x16x32_bf16 v[176:179], v[40:43], v[48:51], v[176:179]
  ds_read_b64_tr_b16 v[38:39], v221 offset:41984
  v_mfma_f32_16x16x32_bf16 v[180:183], v[40:43], v[52:55], v[180:183]
  v_mfma_f32_16x16x32_bf16 v[184:187], v[40:43], v[56:59], v[184:187]
  v_accvgpr_write_b32 a119, 0
  v_mfma_f32_16x16x32_bf16 v[188:191], v[40:43], v[60:63], v[188:191]
  ds_read_b64_tr_b16 v[40:41], v222 offset:40960
  v_mfma_f32_16x16x32_bf16 v[192:195], v[44:47], v[48:51], v[192:195]
  ds_read_b64_tr_b16 v[42:43], v222 offset:41984
  v_mfma_f32_16x16x32_bf16 v[196:199], v[44:47], v[52:55], v[196:199]
  v_mfma_f32_16x16x32_bf16 v[200:203], v[44:47], v[56:59], v[200:203]
  v_mfma_f32_16x16x32_bf16 v[204:207], v[44:47], v[60:63], v[204:207]
  ds_read_b64_tr_b16 v[44:45], v223 offset:40960
  ds_read_b64_tr_b16 v[46:47], v223 offset:41984
  s_waitcnt lgkmcnt(4)
  v_mfma_f32_16x16x32_bf16 v[80:83], v[16:19], v[64:67], v[80:83]
  v_mfma_f32_16x16x32_bf16 v[84:87], v[16:19], v[68:71], v[84:87]
  v_mfma_f32_16x16x32_bf16 v[88:91], v[16:19], v[72:75], v[88:91]
  v_accvgpr_write_b32 a120, 0
  v_mfma_f32_16x16x32_bf16 v[92:95], v[16:19], v[76:79], v[92:95]
  v_mfma_f32_16x16x32_bf16 v[96:99], v[20:23], v[64:67], v[96:99]
  v_mfma_f32_16x16x32_bf16 v[100:103], v[20:23], v[68:71], v[100:103]
  v_accvgpr_write_b32 a121, 0
  v_mfma_f32_16x16x32_bf16 v[104:107], v[20:23], v[72:75], v[104:107]
  v_mfma_f32_16x16x32_bf16 v[108:111], v[20:23], v[76:79], v[108:111]
  s_waitcnt vmcnt(12) lgkmcnt(0)
  s_barrier
  v_mfma_f32_16x16x32_bf16 v[112:115], v[24:27], v[64:67], v[112:115]
  ds_read_b64_tr_b16 v[16:17], v216 offset:0
  v_mfma_f32_16x16x32_bf16 v[116:119], v[24:27], v[68:71], v[116:119]
  s_add_u32 m0, s67, 16384
s_nop 0
  buffer_load_dwordx4 v208, s[44:47], s64 offen offset:0 lds
  ds_read_b64_tr_b16 v[18:19], v216 offset:1024
  ds_read_b128 v[48:51], v224 offset:0
  v_accvgpr_write_b32 a122, 0
  v_mfma_f32_16x16x32_bf16 v[120:123], v[24:27], v[72:75], v[120:123]
  buffer_load_dwordx4 v209, s[44:47], s64 offen offset:1024 lds
  ds_read_b64_tr_b16 v[20:21], v217 offset:0
  v_mfma_f32_16x16x32_bf16 v[124:127], v[24:27], v[76:79], v[124:127]
  ds_read_b64_tr_b16 v[22:23], v217 offset:1024
  v_mfma_f32_16x16x32_bf16 v[128:131], v[28:31], v[64:67], v[128:131]
  buffer_load_dwordx4 v210, s[44:47], s64 offen offset:2048 lds
  ds_read_b64_tr_b16 v[24:25], v218 offset:0
  ds_read_b128 v[52:55], v224 offset:2048
  v_accvgpr_write_b32 a123, 0
  v_mfma_f32_16x16x32_bf16 v[132:135], v[28:31], v[68:71], v[132:135]
  ds_read_b64_tr_b16 v[26:27], v218 offset:1024
  v_mfma_f32_16x16x32_bf16 v[136:139], v[28:31], v[72:75], v[136:139]
  buffer_load_dwordx4 v211, s[44:47], s64 offen offset:3072 lds
  v_mfma_f32_16x16x32_bf16 v[140:143], v[28:31], v[76:79], v[140:143]
  ds_read_b64_tr_b16 v[28:29], v219 offset:0
  v_mfma_f32_16x16x32_bf16 v[144:147], v[32:35], v[64:67], v[144:147]
  s_add_u32 m0, s67, 20480
s_nop 0
  buffer_load_dwordx4 v208, s[44:47], s65 offen offset:0 lds
  ds_read_b64_tr_b16 v[30:31], v219 offset:1024
  ds_read_b128 v[56:59], v224 offset:4096
  v_accvgpr_write_b32 a124, 0
  v_mfma_f32_16x16x32_bf16 v[148:151], v[32:35], v[68:71], v[148:151]
  v_mfma_f32_16x16x32_bf16 v[152:155], v[32:35], v[72:75], v[152:155]
  buffer_load_dwordx4 v209, s[44:47], s65 offen offset:1024 lds
  v_mfma_f32_16x16x32_bf16 v[156:159], v[32:35], v[76:79], v[156:159]
  ds_read_b64_tr_b16 v[32:33], v220 offset:0
  v_accvgpr_write_b32 a125, 0
  v_mfma_f32_16x16x32_bf16 v[160:163], v[36:39], v[64:67], v[160:163]
  buffer_load_dwordx4 v210, s[44:47], s65 offen offset:2048 lds
  ds_read_b64_tr_b16 v[34:35], v220 offset:1024
  ds_read_b128 v[60:63], v224 offset:6144
  v_mfma_f32_16x16x32_bf16 v[164:167], v[36:39], v[68:71], v[164:167]
  buffer_load_dwordx4 v211, s[44:47], s65 offen offset:3072 lds
  v_mfma_f32_16x16x32_bf16 v[168:171], v[36:39], v[72:75], v[168:171]
  v_mfma_f32_16x16x32_bf16 v[172:175], v[36:39], v[76:79], v[172:175]
  s_add_u32 m0, s68, 32768
s_nop 0
  buffer_load_dwordx4 v212, s[48:51], s66 offen offset:0 lds
  ds_read_b64_tr_b16 v[36:37], v221 offset:0
  v_accvgpr_write_b32 a126, 0
  v_mfma_f32_16x16x32_bf16 v[176:179], v[40:43], v[64:67], v[176:179]
  ds_read_b64_tr_b16 v[38:39], v221 offset:1024
  v_mfma_f32_16x16x32_bf16 v[180:183], v[40:43], v[68:71], v[180:183]
  buffer_load_dwordx4 v213, s[48:51], s66 offen offset:1024 lds
  v_mfma_f32_16x16x32_bf16 v[184:187], v[40:43], v[72:75], v[184:187]
  v_accvgpr_write_b32 a127, 0
  v_mfma_f32_16x16x32_bf16 v[188:191], v[40:43], v[76:79], v[188:191]
  buffer_load_dwordx4 v214, s[48:51], s66 offen offset:2048 lds
  ds_read_b64_tr_b16 v[40:41], v222 offset:0
  v_mfma_f32_16x16x32_bf16 v[192:195], v[44:47], v[64:67], v[192:195]
  ds_read_b64_tr_b16 v[42:43], v222 offset:1024
  v_mfma_f32_16x16x32_bf16 v[196:199], v[44:47], v[68:71], v[196:199]
  buffer_load_dwordx4 v215, s[48:51], s66 offen offset:3072 lds
  s_add_u32 s64, s64, 128
  s_add_u32 s65, s65, 128
  s_add_u32 s66, s66, 524288
  v_mfma_f32_16x16x32_bf16 v[200:203], v[44:47], v[72:75], v[200:203]
  v_mfma_f32_16x16x32_bf16 v[204:207], v[44:47], v[76:79], v[204:207]
  ds_read_b64_tr_b16 v[44:45], v223 offset:0
  ds_read_b64_tr_b16 v[46:47], v223 offset:1024
  s_waitcnt lgkmcnt(4)
  v_mfma_f32_16x16x32_bf16 v[80:83], v[16:19], v[48:51], v[80:83]
  v_mfma_f32_16x16x32_bf16 v[84:87], v[16:19], v[52:55], v[84:87]
  ds_read_b128 v[64:67], v225 offset:0
  v_mfma_f32_16x16x32_bf16 v[88:91], v[16:19], v[56:59], v[88:91]
  v_mfma_f32_16x16x32_bf16 v[92:95], v[16:19], v[60:63], v[92:95]
  ds_read_b64_tr_b16 v[16:17], v216 offset:8192
  v_mfma_f32_16x16x32_bf16 v[96:99], v[20:23], v[48:51], v[96:99]
  ds_read_b64_tr_b16 v[18:19], v216 offset:9216
  v_mfma_f32_16x16x32_bf16 v[100:103], v[20:23], v[52:55], v[100:103]
  v_mfma_f32_16x16x32_bf16 v[104:107], v[20:23], v[56:59], v[104:107]
  ds_read_b128 v[68:71], v225 offset:2048
  v_mfma_f32_16x16x32_bf16 v[108:111], v[20:23], v[60:63], v[108:111]
  ds_read_b64_tr_b16 v[20:21], v217 offset:8192
  v_mfma_f32_16x16x32_bf16 v[112:115], v[24:27], v[48:51], v[112:115]
  ds_read_b64_tr_b16 v[22:23], v217 offset:9216
  v_mfma_f32_16x16x32_bf16 v[116:119], v[24:27], v[52:55], v[116:119]
  v_mfma_f32_16x16x32_bf16 v[120:123], v[24:27], v[56:59], v[120:123]
  v_mfma_f32_16x16x32_bf16 v[124:127], v[24:27], v[60:63], v[124:127]
  ds_read_b64_tr_b16 v[24:25], v218 offset:8192
  v_mfma_f32_16x16x32_bf16 v[128:131], v[28:31], v[48:51], v[128:131]
  ds_read_b64_tr_b16 v[26:27], v218 offset:9216
  ds_read_b128 v[72:75], v225 offset:4096
  v_mfma_f32_16x16x32_bf16 v[132:135], v[28:31], v[52:55], v[132:135]
  v_mfma_f32_16x16x32_bf16 v[136:139], v[28:31], v[56:59], v[136:139]
  v_mfma_f32_16x16x32_bf16 v[140:143], v[28:31], v[60:63], v[140:143]
  ds_read_b64_tr_b16 v[28:29], v219 offset:8192
  v_mfma_f32_16x16x32_bf16 v[144:147], v[32:35], v[48:51], v[144:147]
  ds_read_b64_tr_b16 v[30:31], v219 offset:9216
  v_mfma_f32_16x16x32_bf16 v[148:151], v[32:35], v[52:55], v[148:151]
  v_mfma_f32_16x16x32_bf16 v[152:155], v[32:35], v[56:59], v[152:155]
  ds_read_b128 v[76:79], v225 offset:6144
  v_mfma_f32_16x16x32_bf16 v[156:159], v[32:35], v[60:63], v[156:159]
  ds_read_b64_tr_b16 v[32:33], v220 offset:8192
  v_mfma_f32_16x16x32_bf16 v[160:163], v[36:39], v[48:51], v[160:163]
  ds_read_b64_tr_b16 v[34:35], v220 offset:9216
  v_mfma_f32_16x16x32_bf16 v[164:167], v[36:39], v[52:55], v[164:167]
  v_mfma_f32_16x16x32_bf16 v[168:171], v[36:39], v[56:59], v[168:171]
  v_mfma_f32_16x16x32_bf16 v[172:175], v[36:39], v[60:63], v[172:175]
  ds_read_b64_tr_b16 v[36:37], v221 offset:8192
s_waitcnt lgkmcnt(15)
  v_mfma_f32_16x16x32_bf16 v[176:179], v[40:43], v[48:51], v[176:179]
  ds_read_b64_tr_b16 v[38:39], v221 offset:9216
  v_mfma_f32_16x16x32_bf16 v[180:183], v[40:43], v[52:55], v[180:183]
  v_mfma_f32_16x16x32_bf16 v[184:187], v[40:43], v[56:59], v[184:187]
  v_mfma_f32_16x16x32_bf16 v[188:191], v[40:43], v[60:63], v[188:191]
  ds_read_b64_tr_b16 v[40:41], v222 offset:8192
  v_mfma_f32_16x16x32_bf16 v[192:195], v[44:47], v[48:51], v[192:195]
  ds_read_b64_tr_b16 v[42:43], v222 offset:9216
  v_mfma_f32_16x16x32_bf16 v[196:199], v[44:47], v[52:55], v[196:199]
  v_mfma_f32_16x16x32_bf16 v[200:203], v[44:47], v[56:59], v[200:203]
  v_mfma_f32_16x16x32_bf16 v[204:207], v[44:47], v[60:63], v[204:207]
  ds_read_b64_tr_b16 v[44:45], v223 offset:8192
  ds_read_b64_tr_b16 v[46:47], v223 offset:9216
  s_waitcnt lgkmcnt(4)
  v_mfma_f32_16x16x32_bf16 v[80:83], v[16:19], v[64:67], v[80:83]
  v_mfma_f32_16x16x32_bf16 v[84:87], v[16:19], v[68:71], v[84:87]
  v_mfma_f32_16x16x32_bf16 v[88:91], v[16:19], v[72:75], v[88:91]
  v_mfma_f32_16x16x32_bf16 v[92:95], v[16:19], v[76:79], v[92:95]
  v_mfma_f32_16x16x32_bf16 v[96:99], v[20:23], v[64:67], v[96:99]
  v_mfma_f32_16x16x32_bf16 v[100:103], v[20:23], v[68:71], v[100:103]
  v_mfma_f32_16x16x32_bf16 v[104:107], v[20:23], v[72:75], v[104:107]
  v_mfma_f32_16x16x32_bf16 v[108:111], v[20:23], v[76:79], v[108:111]
  s_waitcnt vmcnt(12) lgkmcnt(0)
  s_barrier
  v_mfma_f32_16x16x32_bf16 v[112:115], v[24:27], v[64:67], v[112:115]
  ds_read_b64_tr_b16 v[16:17], v216 offset:16384
  v_mfma_f32_16x16x32_bf16 v[116:119], v[24:27], v[68:71], v[116:119]
  s_add_u32 m0, s67, 0
s_nop 0
  buffer_load_dwordx4 v208, s[44:47], s64 offen offset:0 lds
  ds_read_b64_tr_b16 v[18:19], v216 offset:17408
  ds_read_b128 v[48:51], v224 offset:8192
  v_mfma_f32_16x16x32_bf16 v[120:123], v[24:27], v[72:75], v[120:123]
  buffer_load_dwordx4 v209, s[44:47], s64 offen offset:1024 lds
  ds_read_b64_tr_b16 v[20:21], v217 offset:16384
  v_mfma_f32_16x16x32_bf16 v[124:127], v[24:27], v[76:79], v[124:127]
  ds_read_b64_tr_b16 v[22:23], v217 offset:17408
  v_mfma_f32_16x16x32_bf16 v[128:131], v[28:31], v[64:67], v[128:131]
  buffer_load_dwordx4 v210, s[44:47], s64 offen offset:2048 lds
  ds_read_b64_tr_b16 v[24:25], v218 offset:16384
  ds_read_b128 v[52:55], v224 offset:10240
  v_mfma_f32_16x16x32_bf16 v[132:135], v[28:31], v[68:71], v[132:135]
  ds_read_b64_tr_b16 v[26:27], v218 offset:17408
  v_mfma_f32_16x16x32_bf16 v[136:139], v[28:31], v[72:75], v[136:139]
  buffer_load_dwordx4 v211, s[44:47], s64 offen offset:3072 lds
  v_mfma_f32_16x16x32_bf16 v[140:143], v[28:31], v[76:79], v[140:143]
  ds_read_b64_tr_b16 v[28:29], v219 offset:16384
  v_mfma_f32_16x16x32_bf16 v[144:147], v[32:35], v[64:67], v[144:147]
  s_add_u32 m0, s67, 4096
s_nop 0
  buffer_load_dwordx4 v208, s[44:47], s65 offen offset:0 lds
  ds_read_b64_tr_b16 v[30:31], v219 offset:17408
  ds_read_b128 v[56:59], v224 offset:12288
  v_mfma_f32_16x16x32_bf16 v[148:151], v[32:35], v[68:71], v[148:151]
  v_mfma_f32_16x16x32_bf16 v[152:155], v[32:35], v[72:75], v[152:155]
  buffer_load_dwordx4 v209, s[44:47], s65 offen offset:1024 lds
  v_mfma_f32_16x16x32_bf16 v[156:159], v[32:35], v[76:79], v[156:159]
  ds_read_b64_tr_b16 v[32:33], v220 offset:16384
  v_mfma_f32_16x16x32_bf16 v[160:163], v[36:39], v[64:67], v[160:163]
  buffer_load_dwordx4 v210, s[44:47], s65 offen offset:2048 lds
  ds_read_b64_tr_b16 v[34:35], v220 offset:17408
  ds_read_b128 v[60:63], v224 offset:14336
  v_mfma_f32_16x16x32_bf16 v[164:167], v[36:39], v[68:71], v[164:167]
  buffer_load_dwordx4 v211, s[44:47], s65 offen offset:3072 lds
  v_mfma_f32_16x16x32_bf16 v[168:171], v[36:39], v[72:75], v[168:171]
  v_mfma_f32_16x16x32_bf16 v[172:175], v[36:39], v[76:79], v[172:175]
  s_add_u32 m0, s68, 0
s_nop 0
  buffer_load_dwordx4 v212, s[48:51], s66 offen offset:0 lds
  ds_read_b64_tr_b16 v[36:37], v221 offset:16384
  v_mfma_f32_16x16x32_bf16 v[176:179], v[40:43], v[64:67], v[176:179]
  ds_read_b64_tr_b16 v[38:39], v221 offset:17408
  v_mfma_f32_16x16x32_bf16 v[180:183], v[40:43], v[68:71], v[180:183]
  buffer_load_dwordx4 v213, s[48:51], s66 offen offset:1024 lds
  v_mfma_f32_16x16x32_bf16 v[184:187], v[40:43], v[72:75], v[184:187]
  v_mfma_f32_16x16x32_bf16 v[188:191], v[40:43], v[76:79], v[188:191]
  buffer_load_dwordx4 v214, s[48:51], s66 offen offset:2048 lds
  ds_read_b64_tr_b16 v[40:41], v222 offset:16384
  v_mfma_f32_16x16x32_bf16 v[192:195], v[44:47], v[64:67], v[192:195]
  ds_read_b64_tr_b16 v[42:43], v222 offset:17408
  v_mfma_f32_16x16x32_bf16 v[196:199], v[44:47], v[68:71], v[196:199]
  buffer_load_dwordx4 v215, s[48:51], s66 offen offset:3072 lds
  s_add_u32 s64, s64, 128
  s_add_u32 s65, s65, 128
  s_add_u32 s66, s66, 524288
  v_mfma_f32_16x16x32_bf16 v[200:203], v[44:47], v[72:75], v[200:203]
  v_mfma_f32_16x16x32_bf16 v[204:207], v[44:47], v[76:79], v[204:207]
  ds_read_b64_tr_b16 v[44:45], v223 offset:16384
  ds_read_b64_tr_b16 v[46:47], v223 offset:17408
  s_waitcnt lgkmcnt(4)
  v_mfma_f32_16x16x32_bf16 v[80:83], v[16:19], v[48:51], v[80:83]
  v_mfma_f32_16x16x32_bf16 v[84:87], v[16:19], v[52:55], v[84:87]
  ds_read_b128 v[64:67], v225 offset:8192
  v_mfma_f32_16x16x32_bf16 v[88:91], v[16:19], v[56:59], v[88:91]
  v_mfma_f32_16x16x32_bf16 v[92:95], v[16:19], v[60:63], v[92:95]
  ds_read_b64_tr_b16 v[16:17], v216 offset:24576
  v_mfma_f32_16x16x32_bf16 v[96:99], v[20:23], v[48:51], v[96:99]
  ds_read_b64_tr_b16 v[18:19], v216 offset:25600
  v_mfma_f32_16x16x32_bf16 v[100:103], v[20:23], v[52:55], v[100:103]
  v_mfma_f32_16x16x32_bf16 v[104:107], v[20:23], v[56:59], v[104:107]
  ds_read_b128 v[68:71], v225 offset:10240
  v_mfma_f32_16x16x32_bf16 v[108:111], v[20:23], v[60:63], v[108:111]
  ds_read_b64_tr_b16 v[20:21], v217 offset:24576
  v_mfma_f32_16x16x32_bf16 v[112:115], v[24:27], v[48:51], v[112:115]
  ds_read_b64_tr_b16 v[22:23], v217 offset:25600
  v_mfma_f32_16x16x32_bf16 v[116:119], v[24:27], v[52:55], v[116:119]
  v_mfma_f32_16x16x32_bf16 v[120:123], v[24:27], v[56:59], v[120:123]
  v_mfma_f32_16x16x32_bf16 v[124:127], v[24:27], v[60:63], v[124:127]
  ds_read_b64_tr_b16 v[24:25], v218 offset:24576
  v_mfma_f32_16x16x32_bf16 v[128:131], v[28:31], v[48:51], v[128:131]
  ds_read_b64_tr_b16 v[26:27], v218 offset:25600
  ds_read_b128 v[72:75], v225 offset:12288
  v_mfma_f32_16x16x32_bf16 v[132:135], v[28:31], v[52:55], v[132:135]
  v_mfma_f32_16x16x32_bf16 v[136:139], v[28:31], v[56:59], v[136:139]
  v_mfma_f32_16x16x32_bf16 v[140:143], v[28:31], v[60:63], v[140:143]
  ds_read_b64_tr_b16 v[28:29], v219 offset:24576
  v_mfma_f32_16x16x32_bf16 v[144:147], v[32:35], v[48:51], v[144:147]
  ds_read_b64_tr_b16 v[30:31], v219 offset:25600
  v_mfma_f32_16x16x32_bf16 v[148:151], v[32:35], v[52:55], v[148:151]
  v_mfma_f32_16x16x32_bf16 v[152:155], v[32:35], v[56:59], v[152:155]
  ds_read_b128 v[76:79], v225 offset:14336
  v_mfma_f32_16x16x32_bf16 v[156:159], v[32:35], v[60:63], v[156:159]
  ds_read_b64_tr_b16 v[32:33], v220 offset:24576
  v_mfma_f32_16x16x32_bf16 v[160:163], v[36:39], v[48:51], v[160:163]
  ds_read_b64_tr_b16 v[34:35], v220 offset:25600
  v_mfma_f32_16x16x32_bf16 v[164:167], v[36:39], v[52:55], v[164:167]
  v_mfma_f32_16x16x32_bf16 v[168:171], v[36:39], v[56:59], v[168:171]
  v_mfma_f32_16x16x32_bf16 v[172:175], v[36:39], v[60:63], v[172:175]
  ds_read_b64_tr_b16 v[36:37], v221 offset:24576
s_waitcnt lgkmcnt(15)
  v_mfma_f32_16x16x32_bf16 v[176:179], v[40:43], v[48:51], v[176:179]
  ds_read_b64_tr_b16 v[38:39], v221 offset:25600
  v_mfma_f32_16x16x32_bf16 v[180:183], v[40:43], v[52:55], v[180:183]
  v_mfma_f32_16x16x32_bf16 v[184:187], v[40:43], v[56:59], v[184:187]
  v_mfma_f32_16x16x32_bf16 v[188:191], v[40:43], v[60:63], v[188:191]
  ds_read_b64_tr_b16 v[40:41], v222 offset:24576
  v_mfma_f32_16x16x32_bf16 v[192:195], v[44:47], v[48:51], v[192:195]
  ds_read_b64_tr_b16 v[42:43], v222 offset:25600
  v_mfma_f32_16x16x32_bf16 v[196:199], v[44:47], v[52:55], v[196:199]
  v_mfma_f32_16x16x32_bf16 v[200:203], v[44:47], v[56:59], v[200:203]
  v_mfma_f32_16x16x32_bf16 v[204:207], v[44:47], v[60:63], v[204:207]
  ds_read_b64_tr_b16 v[44:45], v223 offset:24576
  ds_read_b64_tr_b16 v[46:47], v223 offset:25600
  s_waitcnt lgkmcnt(4)
  v_mfma_f32_16x16x32_bf16 v[80:83], v[16:19], v[64:67], v[80:83]
  v_mfma_f32_16x16x32_bf16 v[84:87], v[16:19], v[68:71], v[84:87]
  v_mfma_f32_16x16x32_bf16 v[88:91], v[16:19], v[72:75], v[88:91]
  v_mfma_f32_16x16x32_bf16 v[92:95], v[16:19], v[76:79], v[92:95]
  v_mfma_f32_16x16x32_bf16 v[96:99], v[20:23], v[64:67], v[96:99]
  v_mfma_f32_16x16x32_bf16 v[100:103], v[20:23], v[68:71], v[100:103]
  v_mfma_f32_16x16x32_bf16 v[104:107], v[20:23], v[72:75], v[104:107]
  v_mfma_f32_16x16x32_bf16 v[108:111], v[20:23], v[76:79], v[108:111]
  s_waitcnt vmcnt(12) lgkmcnt(0)
  s_barrier
  v_mfma_f32_16x16x32_bf16 v[112:115], v[24:27], v[64:67], v[112:115]
  ds_read_b64_tr_b16 v[16:17], v216 offset:32768
  v_mfma_f32_16x16x32_bf16 v[116:119], v[24:27], v[68:71], v[116:119]
  s_add_u32 m0, s67, 8192
s_nop 0
  buffer_load_dwordx4 v208, s[44:47], s64 offen offset:0 lds
  ds_read_b64_tr_b16 v[18:19], v216 offset:33792
  ds_read_b128 v[48:51], v224 offset:16384
  v_mfma_f32_16x16x32_bf16 v[120:123], v[24:27], v[72:75], v[120:123]
  buffer_load_dwordx4 v209, s[44:47], s64 offen offset:1024 lds
  ds_read_b64_tr_b16 v[20:21], v217 offset:32768
  v_mfma_f32_16x16x32_bf16 v[124:127], v[24:27], v[76:79], v[124:127]
  ds_read_b64_tr_b16 v[22:23], v217 offset:33792
  v_mfma_f32_16x16x32_bf16 v[128:131], v[28:31], v[64:67], v[128:131]
  buffer_load_dwordx4 v210, s[44:47], s64 offen offset:2048 lds
  ds_read_b64_tr_b16 v[24:25], v218 offset:32768
  ds_read_b128 v[52:55], v224 offset:18432
  v_mfma_f32_16x16x32_bf16 v[132:135], v[28:31], v[68:71], v[132:135]
  ds_read_b64_tr_b16 v[26:27], v218 offset:33792
  v_mfma_f32_16x16x32_bf16 v[136:139], v[28:31], v[72:75], v[136:139]
  buffer_load_dwordx4 v211, s[44:47], s64 offen offset:3072 lds
  v_mfma_f32_16x16x32_bf16 v[140:143], v[28:31], v[76:79], v[140:143]
  ds_read_b64_tr_b16 v[28:29], v219 offset:32768
  v_mfma_f32_16x16x32_bf16 v[144:147], v[32:35], v[64:67], v[144:147]
  s_add_u32 m0, s67, 12288
s_nop 0
  buffer_load_dwordx4 v208, s[44:47], s65 offen offset:0 lds
  ds_read_b64_tr_b16 v[30:31], v219 offset:33792
  ds_read_b128 v[56:59], v224 offset:20480
  v_mfma_f32_16x16x32_bf16 v[148:151], v[32:35], v[68:71], v[148:151]
  v_mfma_f32_16x16x32_bf16 v[152:155], v[32:35], v[72:75], v[152:155]
  buffer_load_dwordx4 v209, s[44:47], s65 offen offset:1024 lds
  v_mfma_f32_16x16x32_bf16 v[156:159], v[32:35], v[76:79], v[156:159]
  ds_read_b64_tr_b16 v[32:33], v220 offset:32768
  v_mfma_f32_16x16x32_bf16 v[160:163], v[36:39], v[64:67], v[160:163]
  buffer_load_dwordx4 v210, s[44:47], s65 offen offset:2048 lds
  ds_read_b64_tr_b16 v[34:35], v220 offset:33792
  ds_read_b128 v[60:63], v224 offset:22528
  v_mfma_f32_16x16x32_bf16 v[164:167], v[36:39], v[68:71], v[164:167]
  buffer_load_dwordx4 v211, s[44:47], s65 offen offset:3072 lds
  v_mfma_f32_16x16x32_bf16 v[168:171], v[36:39], v[72:75], v[168:171]
  v_mfma_f32_16x16x32_bf16 v[172:175], v[36:39], v[76:79], v[172:175]
  s_add_u32 m0, s68, 16384
s_nop 0
  buffer_load_dwordx4 v212, s[48:51], s66 offen offset:0 lds
  ds_read_b64_tr_b16 v[36:37], v221 offset:32768
  v_mfma_f32_16x16x32_bf16 v[176:179], v[40:43], v[64:67], v[176:179]
  ds_read_b64_tr_b16 v[38:39], v221 offset:33792
  v_mfma_f32_16x16x32_bf16 v[180:183], v[40:43], v[68:71], v[180:183]
  buffer_load_dwordx4 v213, s[48:51], s66 offen offset:1024 lds
  v_mfma_f32_16x16x32_bf16 v[184:187], v[40:43], v[72:75], v[184:187]
  v_mfma_f32_16x16x32_bf16 v[188:191], v[40:43], v[76:79], v[188:191]
  buffer_load_dwordx4 v214, s[48:51], s66 offen offset:2048 lds
  ds_read_b64_tr_b16 v[40:41], v222 offset:32768
  v_mfma_f32_16x16x32_bf16 v[192:195], v[44:47], v[64:67], v[192:195]
  ds_read_b64_tr_b16 v[42:43], v222 offset:33792
  v_mfma_f32_16x16x32_bf16 v[196:199], v[44:47], v[68:71], v[196:199]
  buffer_load_dwordx4 v215, s[48:51], s66 offen offset:3072 lds
  s_add_u32 s64, s64, 128
  s_add_u32 s65, s65, 128
  s_add_u32 s66, s66, 524288
  v_mfma_f32_16x16x32_bf16 v[200:203], v[44:47], v[72:75], v[200:203]
  v_mfma_f32_16x16x32_bf16 v[204:207], v[44:47], v[76:79], v[204:207]
  ds_read_b64_tr_b16 v[44:45], v223 offset:32768
  ds_read_b64_tr_b16 v[46:47], v223 offset:33792
  s_waitcnt lgkmcnt(4)
  v_mfma_f32_16x16x32_bf16 v[80:83], v[16:19], v[48:51], v[80:83]
  v_mfma_f32_16x16x32_bf16 v[84:87], v[16:19], v[52:55], v[84:87]
  ds_read_b128 v[64:67], v225 offset:16384
  v_mfma_f32_16x16x32_bf16 v[88:91], v[16:19], v[56:59], v[88:91]
  v_mfma_f32_16x16x32_bf16 v[92:95], v[16:19], v[60:63], v[92:95]
  ds_read_b64_tr_b16 v[16:17], v216 offset:40960
  v_mfma_f32_16x16x32_bf16 v[96:99], v[20:23], v[48:51], v[96:99]
  ds_read_b64_tr_b16 v[18:19], v216 offset:41984
  v_mfma_f32_16x16x32_bf16 v[100:103], v[20:23], v[52:55], v[100:103]
  v_mfma_f32_16x16x32_bf16 v[104:107], v[20:23], v[56:59], v[104:107]
  ds_read_b128 v[68:71], v225 offset:18432
  v_mfma_f32_16x16x32_bf16 v[108:111], v[20:23], v[60:63], v[108:111]
  ds_read_b64_tr_b16 v[20:21], v217 offset:40960
  v_mfma_f32_16x16x32_bf16 v[112:115], v[24:27], v[48:51], v[112:115]
  ds_read_b64_tr_b16 v[22:23], v217 offset:41984
  v_mfma_f32_16x16x32_bf16 v[116:119], v[24:27], v[52:55], v[116:119]
  v_mfma_f32_16x16x32_bf16 v[120:123], v[24:27], v[56:59], v[120:123]
  v_mfma_f32_16x16x32_bf16 v[124:127], v[24:27], v[60:63], v[124:127]
  ds_read_b64_tr_b16 v[24:25], v218 offset:40960
  v_mfma_f32_16x16x32_bf16 v[128:131], v[28:31], v[48:51], v[128:131]
  ds_read_b64_tr_b16 v[26:27], v218 offset:41984
  ds_read_b128 v[72:75], v225 offset:20480
  v_mfma_f32_16x16x32_bf16 v[132:135], v[28:31], v[52:55], v[132:135]
  v_mfma_f32_16x16x32_bf16 v[136:139], v[28:31], v[56:59], v[136:139]
  v_mfma_f32_16x16x32_bf16 v[140:143], v[28:31], v[60:63], v[140:143]
  ds_read_b64_tr_b16 v[28:29], v219 offset:40960
  v_mfma_f32_16x16x32_bf16 v[144:147], v[32:35], v[48:51], v[144:147]
  ds_read_b64_tr_b16 v[30:31], v219 offset:41984
  v_mfma_f32_16x16x32_bf16 v[148:151], v[32:35], v[52:55], v[148:151]
  v_mfma_f32_16x16x32_bf16 v[152:155], v[32:35], v[56:59], v[152:155]
  ds_read_b128 v[76:79], v225 offset:22528
  v_mfma_f32_16x16x32_bf16 v[156:159], v[32:35], v[60:63], v[156:159]
  ds_read_b64_tr_b16 v[32:33], v220 offset:40960
  v_mfma_f32_16x16x32_bf16 v[160:163], v[36:39], v[48:51], v[160:163]
  ds_read_b64_tr_b16 v[34:35], v220 offset:41984
  v_mfma_f32_16x16x32_bf16 v[164:167], v[36:39], v[52:55], v[164:167]
  v_mfma_f32_16x16x32_bf16 v[168:171], v[36:39], v[56:59], v[168:171]
  v_mfma_f32_16x16x32_bf16 v[172:175], v[36:39], v[60:63], v[172:175]
  ds_read_b64_tr_b16 v[36:37], v221 offset:40960
s_waitcnt lgkmcnt(15)
  v_mfma_f32_16x16x32_bf16 v[176:179], v[40:43], v[48:51], v[176:179]
  ds_read_b64_tr_b16 v[38:39], v221 offset:41984
  v_mfma_f32_16x16x32_bf16 v[180:183], v[40:43], v[52:55], v[180:183]
  v_mfma_f32_16x16x32_bf16 v[184:187], v[40:43], v[56:59], v[184:187]
  v_mfma_f32_16x16x32_bf16 v[188:191], v[40:43], v[60:63], v[188:191]
  ds_read_b64_tr_b16 v[40:41], v222 offset:40960
  v_mfma_f32_16x16x32_bf16 v[192:195], v[44:47], v[48:51], v[192:195]
  ds_read_b64_tr_b16 v[42:43], v222 offset:41984
  v_mfma_f32_16x16x32_bf16 v[196:199], v[44:47], v[52:55], v[196:199]
  v_mfma_f32_16x16x32_bf16 v[200:203], v[44:47], v[56:59], v[200:203]
  v_mfma_f32_16x16x32_bf16 v[204:207], v[44:47], v[60:63], v[204:207]
  ds_read_b64_tr_b16 v[44:45], v223 offset:40960
  ds_read_b64_tr_b16 v[46:47], v223 offset:41984
  s_waitcnt lgkmcnt(4)
  v_mfma_f32_16x16x32_bf16 v[80:83], v[16:19], v[64:67], v[80:83]
  v_mfma_f32_16x16x32_bf16 v[84:87], v[16:19], v[68:71], v[84:87]
  v_mfma_f32_16x16x32_bf16 v[88:91], v[16:19], v[72:75], v[88:91]
  v_mfma_f32_16x16x32_bf16 v[92:95], v[16:19], v[76:79], v[92:95]
  v_mfma_f32_16x16x32_bf16 v[96:99], v[20:23], v[64:67], v[96:99]
  v_mfma_f32_16x16x32_bf16 v[100:103], v[20:23], v[68:71], v[100:103]
  v_mfma_f32_16x16x32_bf16 v[104:107], v[20:23], v[72:75], v[104:107]
  v_mfma_f32_16x16x32_bf16 v[108:111], v[20:23], v[76:79], v[108:111]
  s_waitcnt vmcnt(12) lgkmcnt(0)
  s_barrier
  v_mfma_f32_16x16x32_bf16 v[112:115], v[24:27], v[64:67], v[112:115]
  ds_read_b64_tr_b16 v[16:17], v216 offset:0
  v_mfma_f32_16x16x32_bf16 v[116:119], v[24:27], v[68:71], v[116:119]
  s_add_u32 m0, s67, 16384
s_nop 0
  buffer_load_dwordx4 v208, s[44:47], s64 offen offset:0 lds
  ds_read_b64_tr_b16 v[18:19], v216 offset:1024
  ds_read_b128 v[48:51], v224 offset:0
  v_mfma_f32_16x16x32_bf16 v[120:123], v[24:27], v[72:75], v[120:123]
  buffer_load_dwordx4 v209, s[44:47], s64 offen offset:1024 lds
  ds_read_b64_tr_b16 v[20:21], v217 offset:0
  v_mfma_f32_16x16x32_bf16 v[124:127], v[24:27], v[76:79], v[124:127]
  ds_read_b64_tr_b16 v[22:23], v217 offset:1024
  v_mfma_f32_16x16x32_bf16 v[128:131], v[28:31], v[64:67], v[128:131]
  buffer_load_dwordx4 v210, s[44:47], s64 offen offset:2048 lds
  ds_read_b64_tr_b16 v[24:25], v218 offset:0
  ds_read_b128 v[52:55], v224 offset:2048
  v_mfma_f32_16x16x32_bf16 v[132:135], v[28:31], v[68:71], v[132:135]
  ds_read_b64_tr_b16 v[26:27], v218 offset:1024
  v_mfma_f32_16x16x32_bf16 v[136:139], v[28:31], v[72:75], v[136:139]
  buffer_load_dwordx4 v211, s[44:47], s64 offen offset:3072 lds
  v_mfma_f32_16x16x32_bf16 v[140:143], v[28:31], v[76:79], v[140:143]
  ds_read_b64_tr_b16 v[28:29], v219 offset:0
  v_mfma_f32_16x16x32_bf16 v[144:147], v[32:35], v[64:67], v[144:147]
  s_add_u32 m0, s67, 20480
s_nop 0
  buffer_load_dwordx4 v208, s[44:47], s65 offen offset:0 lds
  ds_read_b64_tr_b16 v[30:31], v219 offset:1024
  ds_read_b128 v[56:59], v224 offset:4096
  v_mfma_f32_16x16x32_bf16 v[148:151], v[32:35], v[68:71], v[148:151]
  v_mfma_f32_16x16x32_bf16 v[152:155], v[32:35], v[72:75], v[152:155]
  buffer_load_dwordx4 v209, s[44:47], s65 offen offset:1024 lds
  v_mfma_f32_16x16x32_bf16 v[156:159], v[32:35], v[76:79], v[156:159]
  ds_read_b64_tr_b16 v[32:33], v220 offset:0
  v_mfma_f32_16x16x32_bf16 v[160:163], v[36:39], v[64:67], v[160:163]
  buffer_load_dwordx4 v210, s[44:47], s65 offen offset:2048 lds
  ds_read_b64_tr_b16 v[34:35], v220 offset:1024
  ds_read_b128 v[60:63], v224 offset:6144
  v_mfma_f32_16x16x32_bf16 v[164:167], v[36:39], v[68:71], v[164:167]
  buffer_load_dwordx4 v211, s[44:47], s65 offen offset:3072 lds
  v_mfma_f32_16x16x32_bf16 v[168:171], v[36:39], v[72:75], v[168:171]
  v_mfma_f32_16x16x32_bf16 v[172:175], v[36:39], v[76:79], v[172:175]
  s_add_u32 m0, s68, 32768
s_nop 0
  buffer_load_dwordx4 v212, s[48:51], s66 offen offset:0 lds
  ds_read_b64_tr_b16 v[36:37], v221 offset:0
  v_mfma_f32_16x16x32_bf16 v[176:179], v[40:43], v[64:67], v[176:179]
  ds_read_b64_tr_b16 v[38:39], v221 offset:1024
  v_mfma_f32_16x16x32_bf16 v[180:183], v[40:43], v[68:71], v[180:183]
  buffer_load_dwordx4 v213, s[48:51], s66 offen offset:1024 lds
  v_mfma_f32_16x16x32_bf16 v[184:187], v[40:43], v[72:75], v[184:187]
  v_mfma_f32_16x16x32_bf16 v[188:191], v[40:43], v[76:79], v[188:191]
  buffer_load_dwordx4 v214, s[48:51], s66 offen offset:2048 lds
  ds_read_b64_tr_b16 v[40:41], v222 offset:0
  v_mfma_f32_16x16x32_bf16 v[192:195], v[44:47], v[64:67], v[192:195]
  ds_read_b64_tr_b16 v[42:43], v222 offset:1024
  v_mfma_f32_16x16x32_bf16 v[196:199], v[44:47], v[68:71], v[196:199]
  buffer_load_dwordx4 v215, s[48:51], s66 offen offset:3072 lds
  s_add_u32 s64, s64, 128
  s_add_u32 s65, s65, 128
  s_add_u32 s66, s66, 524288
  v_mfma_f32_16x16x32_bf16 v[200:203], v[44:47], v[72:75], v[200:203]
  v_mfma_f32_16x16x32_bf16 v[204:207], v[44:47], v[76:79], v[204:207]
  ds_read_b64_tr_b16 v[44:45], v223 offset:0
  ds_read_b64_tr_b16 v[46:47], v223 offset:1024
  s_waitcnt lgkmcnt(4)
  v_mfma_f32_16x16x32_bf16 v[80:83], v[16:19], v[48:51], v[80:83]
  v_mfma_f32_16x16x32_bf16 v[84:87], v[16:19], v[52:55], v[84:87]
  ds_read_b128 v[64:67], v225 offset:0
  v_mfma_f32_16x16x32_bf16 v[88:91], v[16:19], v[56:59], v[88:91]
  v_mfma_f32_16x16x32_bf16 v[92:95], v[16:19], v[60:63], v[92:95]
  ds_read_b64_tr_b16 v[16:17], v216 offset:8192
  v_mfma_f32_16x16x32_bf16 v[96:99], v[20:23], v[48:51], v[96:99]
  ds_read_b64_tr_b16 v[18:19], v216 offset:9216
  v_mfma_f32_16x16x32_bf16 v[100:103], v[20:23], v[52:55], v[100:103]
  v_mfma_f32_16x16x32_bf16 v[104:107], v[20:23], v[56:59], v[104:107]
  ds_read_b128 v[68:71], v225 offset:2048
  v_mfma_f32_16x16x32_bf16 v[108:111], v[20:23], v[60:63], v[108:111]
  ds_read_b64_tr_b16 v[20:21], v217 offset:8192
  v_mfma_f32_16x16x32_bf16 v[112:115], v[24:27], v[48:51], v[112:115]
  ds_read_b64_tr_b16 v[22:23], v217 offset:9216
  v_mfma_f32_16x16x32_bf16 v[116:119], v[24:27], v[52:55], v[116:119]
  v_mfma_f32_16x16x32_bf16 v[120:123], v[24:27], v[56:59], v[120:123]
  v_mfma_f32_16x16x32_bf16 v[124:127], v[24:27], v[60:63], v[124:127]
  ds_read_b64_tr_b16 v[24:25], v218 offset:8192
  v_mfma_f32_16x16x32_bf16 v[128:131], v[28:31], v[48:51], v[128:131]
  ds_read_b64_tr_b16 v[26:27], v218 offset:9216
  ds_read_b128 v[72:75], v225 offset:4096
  v_mfma_f32_16x16x32_bf16 v[132:135], v[28:31], v[52:55], v[132:135]
  v_mfma_f32_16x16x32_bf16 v[136:139], v[28:31], v[56:59], v[136:139]
  v_mfma_f32_16x16x32_bf16 v[140:143], v[28:31], v[60:63], v[140:143]
  ds_read_b64_tr_b16 v[28:29], v219 offset:8192
  v_mfma_f32_16x16x32_bf16 v[144:147], v[32:35], v[48:51], v[144:147]
  ds_read_b64_tr_b16 v[30:31], v219 offset:9216
  v_mfma_f32_16x16x32_bf16 v[148:151], v[32:35], v[52:55], v[148:151]
  v_mfma_f32_16x16x32_bf16 v[152:155], v[32:35], v[56:59], v[152:155]
  ds_read_b128 v[76:79], v225 offset:6144
  v_mfma_f32_16x16x32_bf16 v[156:159], v[32:35], v[60:63], v[156:159]
  ds_read_b64_tr_b16 v[32:33], v220 offset:8192
  v_mfma_f32_16x16x32_bf16 v[160:163], v[36:39], v[48:51], v[160:163]
  ds_read_b64_tr_b16 v[34:35], v220 offset:9216
  v_mfma_f32_16x16x32_bf16 v[164:167], v[36:39], v[52:55], v[164:167]
  v_mfma_f32_16x16x32_bf16 v[168:171], v[36:39], v[56:59], v[168:171]
  v_mfma_f32_16x16x32_bf16 v[172:175], v[36:39], v[60:63], v[172:175]
  ds_read_b64_tr_b16 v[36:37], v221 offset:8192
s_waitcnt lgkmcnt(15)
  v_mfma_f32_16x16x32_bf16 v[176:179], v[40:43], v[48:51], v[176:179]
  ds_read_b64_tr_b16 v[38:39], v221 offset:9216
  v_mfma_f32_16x16x32_bf16 v[180:183], v[40:43], v[52:55], v[180:183]
  v_mfma_f32_16x16x32_bf16 v[184:187], v[40:43], v[56:59], v[184:187]
  v_mfma_f32_16x16x32_bf16 v[188:191], v[40:43], v[60:63], v[188:191]
  ds_read_b64_tr_b16 v[40:41], v222 offset:8192
  v_mfma_f32_16x16x32_bf16 v[192:195], v[44:47], v[48:51], v[192:195]
  ds_read_b64_tr_b16 v[42:43], v222 offset:9216
  v_mfma_f32_16x16x32_bf16 v[196:199], v[44:47], v[52:55], v[196:199]
  v_mfma_f32_16x16x32_bf16 v[200:203], v[44:47], v[56:59], v[200:203]
  v_mfma_f32_16x16x32_bf16 v[204:207], v[44:47], v[60:63], v[204:207]
  ds_read_b64_tr_b16 v[44:45], v223 offset:8192
  ds_read_b64_tr_b16 v[46:47], v223 offset:9216
  s_waitcnt lgkmcnt(4)
  v_mfma_f32_16x16x32_bf16 v[80:83], v[16:19], v[64:67], v[80:83]
  v_mfma_f32_16x16x32_bf16 v[84:87], v[16:19], v[68:71], v[84:87]
  v_mfma_f32_16x16x32_bf16 v[88:91], v[16:19], v[72:75], v[88:91]
  v_mfma_f32_16x16x32_bf16 v[92:95], v[16:19], v[76:79], v[92:95]
  v_mfma_f32_16x16x32_bf16 v[96:99], v[20:23], v[64:67], v[96:99]
  v_mfma_f32_16x16x32_bf16 v[100:103], v[20:23], v[68:71], v[100:103]
  v_mfma_f32_16x16x32_bf16 v[104:107], v[20:23], v[72:75], v[104:107]
  v_mfma_f32_16x16x32_bf16 v[108:111], v[20:23], v[76:79], v[108:111]
  s_waitcnt vmcnt(12) lgkmcnt(0)
  s_barrier
  v_mfma_f32_16x16x32_bf16 v[112:115], v[24:27], v[64:67], v[112:115]
  ds_read_b64_tr_b16 v[16:17], v216 offset:16384
  v_mfma_f32_16x16x32_bf16 v[116:119], v[24:27], v[68:71], v[116:119]
  s_add_u32 m0, s67, 0
s_nop 0
  buffer_load_dwordx4 v208, s[44:47], s64 offen offset:0 lds
  ds_read_b64_tr_b16 v[18:19], v216 offset:17408
  ds_read_b128 v[48:51], v224 offset:8192
  v_mfma_f32_16x16x32_bf16 v[120:123], v[24:27], v[72:75], v[120:123]
  buffer_load_dwordx4 v209, s[44:47], s64 offen offset:1024 lds
  ds_read_b64_tr_b16 v[20:21], v217 offset:16384
  v_mfma_f32_16x16x32_bf16 v[124:127], v[24:27], v[76:79], v[124:127]
  ds_read_b64_tr_b16 v[22:23], v217 offset:17408
  v_mfma_f32_16x16x32_bf16 v[128:131], v[28:31], v[64:67], v[128:131]
  buffer_load_dwordx4 v210, s[44:47], s64 offen offset:2048 lds
  ds_read_b64_tr_b16 v[24:25], v218 offset:16384
  ds_read_b128 v[52:55], v224 offset:10240
  v_mfma_f32_16x16x32_bf16 v[132:135], v[28:31], v[68:71], v[132:135]
  ds_read_b64_tr_b16 v[26:27], v218 offset:17408
  v_mfma_f32_16x16x32_bf16 v[136:139], v[28:31], v[72:75], v[136:139]
  buffer_load_dwordx4 v211, s[44:47], s64 offen offset:3072 lds
  v_mfma_f32_16x16x32_bf16 v[140:143], v[28:31], v[76:79], v[140:143]
  ds_read_b64_tr_b16 v[28:29], v219 offset:16384
  v_mfma_f32_16x16x32_bf16 v[144:147], v[32:35], v[64:67], v[144:147]
  s_add_u32 m0, s67, 4096
s_nop 0
  buffer_load_dwordx4 v208, s[44:47], s65 offen offset:0 lds
  ds_read_b64_tr_b16 v[30:31], v219 offset:17408
  ds_read_b128 v[56:59], v224 offset:12288
  v_mfma_f32_16x16x32_bf16 v[148:151], v[32:35], v[68:71], v[148:151]
  v_mfma_f32_16x16x32_bf16 v[152:155], v[32:35], v[72:75], v[152:155]
  buffer_load_dwordx4 v209, s[44:47], s65 offen offset:1024 lds
  v_mfma_f32_16x16x32_bf16 v[156:159], v[32:35], v[76:79], v[156:159]
  ds_read_b64_tr_b16 v[32:33], v220 offset:16384
  v_mfma_f32_16x16x32_bf16 v[160:163], v[36:39], v[64:67], v[160:163]
  buffer_load_dwordx4 v210, s[44:47], s65 offen offset:2048 lds
  ds_read_b64_tr_b16 v[34:35], v220 offset:17408
  ds_read_b128 v[60:63], v224 offset:14336
  v_mfma_f32_16x16x32_bf16 v[164:167], v[36:39], v[68:71], v[164:167]
  buffer_load_dwordx4 v211, s[44:47], s65 offen offset:3072 lds
  v_mfma_f32_16x16x32_bf16 v[168:171], v[36:39], v[72:75], v[168:171]
  v_mfma_f32_16x16x32_bf16 v[172:175], v[36:39], v[76:79], v[172:175]
  s_add_u32 m0, s68, 0
s_nop 0
  buffer_load_dwordx4 v212, s[48:51], s66 offen offset:0 lds
  ds_read_b64_tr_b16 v[36:37], v221 offset:16384
  v_mfma_f32_16x16x32_bf16 v[176:179], v[40:43], v[64:67], v[176:179]
  ds_read_b64_tr_b16 v[38:39], v221 offset:17408
  v_mfma_f32_16x16x32_bf16 v[180:183], v[40:43], v[68:71], v[180:183]
  buffer_load_dwordx4 v213, s[48:51], s66 offen offset:1024 lds
  v_mfma_f32_16x16x32_bf16 v[184:187], v[40:43], v[72:75], v[184:187]
  v_mfma_f32_16x16x32_bf16 v[188:191], v[40:43], v[76:79], v[188:191]
  buffer_load_dwordx4 v214, s[48:51], s66 offen offset:2048 lds
  ds_read_b64_tr_b16 v[40:41], v222 offset:16384
  v_mfma_f32_16x16x32_bf16 v[192:195], v[44:47], v[64:67], v[192:195]
  ds_read_b64_tr_b16 v[42:43], v222 offset:17408
  v_mfma_f32_16x16x32_bf16 v[196:199], v[44:47], v[68:71], v[196:199]
  buffer_load_dwordx4 v215, s[48:51], s66 offen offset:3072 lds
  s_add_u32 s64, s64, 128
  s_add_u32 s65, s65, 128
  s_add_u32 s66, s66, 524288
  v_mfma_f32_16x16x32_bf16 v[200:203], v[44:47], v[72:75], v[200:203]
  v_mfma_f32_16x16x32_bf16 v[204:207], v[44:47], v[76:79], v[204:207]
  ds_read_b64_tr_b16 v[44:45], v223 offset:16384
  ds_read_b64_tr_b16 v[46:47], v223 offset:17408
  s_waitcnt lgkmcnt(4)
  v_mfma_f32_16x16x32_bf16 v[80:83], v[16:19], v[48:51], v[80:83]
  v_mfma_f32_16x16x32_bf16 v[84:87], v[16:19], v[52:55], v[84:87]
  ds_read_b128 v[64:67], v225 offset:8192
  v_mfma_f32_16x16x32_bf16 v[88:91], v[16:19], v[56:59], v[88:91]
  v_mfma_f32_16x16x32_bf16 v[92:95], v[16:19], v[60:63], v[92:95]
  ds_read_b64_tr_b16 v[16:17], v216 offset:24576
  v_mfma_f32_16x16x32_bf16 v[96:99], v[20:23], v[48:51], v[96:99]
  ds_read_b64_tr_b16 v[18:19], v216 offset:25600
  v_mfma_f32_16x16x32_bf16 v[100:103], v[20:23], v[52:55], v[100:103]
  v_mfma_f32_16x16x32_bf16 v[104:107], v[20:23], v[56:59], v[104:107]
  ds_read_b128 v[68:71], v225 offset:10240
  v_mfma_f32_16x16x32_bf16 v[108:111], v[20:23], v[60:63], v[108:111]
  ds_read_b64_tr_b16 v[20:21], v217 offset:24576
  v_mfma_f32_16x16x32_bf16 v[112:115], v[24:27], v[48:51], v[112:115]
  ds_read_b64_tr_b16 v[22:23], v217 offset:25600
  v_mfma_f32_16x16x32_bf16 v[116:119], v[24:27], v[52:55], v[116:119]
  v_mfma_f32_16x16x32_bf16 v[120:123], v[24:27], v[56:59], v[120:123]
  v_mfma_f32_16x16x32_bf16 v[124:127], v[24:27], v[60:63], v[124:127]
  ds_read_b64_tr_b16 v[24:25], v218 offset:24576
  v_mfma_f32_16x16x32_bf16 v[128:131], v[28:31], v[48:51], v[128:131]
  ds_read_b64_tr_b16 v[26:27], v218 offset:25600
  ds_read_b128 v[72:75], v225 offset:12288
  v_mfma_f32_16x16x32_bf16 v[132:135], v[28:31], v[52:55], v[132:135]
  v_mfma_f32_16x16x32_bf16 v[136:139], v[28:31], v[56:59], v[136:139]
  v_mfma_f32_16x16x32_bf16 v[140:143], v[28:31], v[60:63], v[140:143]
  ds_read_b64_tr_b16 v[28:29], v219 offset:24576
  v_mfma_f32_16x16x32_bf16 v[144:147], v[32:35], v[48:51], v[144:147]
  ds_read_b64_tr_b16 v[30:31], v219 offset:25600
  v_mfma_f32_16x16x32_bf16 v[148:151], v[32:35], v[52:55], v[148:151]
  v_mfma_f32_16x16x32_bf16 v[152:155], v[32:35], v[56:59], v[152:155]
  ds_read_b128 v[76:79], v225 offset:14336
  v_mfma_f32_16x16x32_bf16 v[156:159], v[32:35], v[60:63], v[156:159]
  ds_read_b64_tr_b16 v[32:33], v220 offset:24576
  v_mfma_f32_16x16x32_bf16 v[160:163], v[36:39], v[48:51], v[160:163]
  ds_read_b64_tr_b16 v[34:35], v220 offset:25600
  v_mfma_f32_16x16x32_bf16 v[164:167], v[36:39], v[52:55], v[164:167]
  v_mfma_f32_16x16x32_bf16 v[168:171], v[36:39], v[56:59], v[168:171]
  v_mfma_f32_16x16x32_bf16 v[172:175], v[36:39], v[60:63], v[172:175]
  ds_read_b64_tr_b16 v[36:37], v221 offset:24576
s_waitcnt lgkmcnt(15)
  v_mfma_f32_16x16x32_bf16 v[176:179], v[40:43], v[48:51], v[176:179]
  ds_read_b64_tr_b16 v[38:39], v221 offset:25600
  v_mfma_f32_16x16x32_bf16 v[180:183], v[40:43], v[52:55], v[180:183]
  v_mfma_f32_16x16x32_bf16 v[184:187], v[40:43], v[56:59], v[184:187]
  v_mfma_f32_16x16x32_bf16 v[188:191], v[40:43], v[60:63], v[188:191]
  ds_read_b64_tr_b16 v[40:41], v222 offset:24576
  v_mfma_f32_16x16x32_bf16 v[192:195], v[44:47], v[48:51], v[192:195]
  ds_read_b64_tr_b16 v[42:43], v222 offset:25600
  v_mfma_f32_16x16x32_bf16 v[196:199], v[44:47], v[52:55], v[196:199]
  v_mfma_f32_16x16x32_bf16 v[200:203], v[44:47], v[56:59], v[200:203]
  v_mfma_f32_16x16x32_bf16 v[204:207], v[44:47], v[60:63], v[204:207]
  ds_read_b64_tr_b16 v[44:45], v223 offset:24576
  ds_read_b64_tr_b16 v[46:47], v223 offset:25600
  s_waitcnt lgkmcnt(4)
  v_mfma_f32_16x16x32_bf16 v[80:83], v[16:19], v[64:67], v[80:83]
  v_mfma_f32_16x16x32_bf16 v[84:87], v[16:19], v[68:71], v[84:87]
  v_mfma_f32_16x16x32_bf16 v[88:91], v[16:19], v[72:75], v[88:91]
  v_mfma_f32_16x16x32_bf16 v[92:95], v[16:19], v[76:79], v[92:95]
  v_mfma_f32_16x16x32_bf16 v[96:99], v[20:23], v[64:67], v[96:99]
  v_mfma_f32_16x16x32_bf16 v[100:103], v[20:23], v[68:71], v[100:103]
  v_mfma_f32_16x16x32_bf16 v[104:107], v[20:23], v[72:75], v[104:107]
  v_mfma_f32_16x16x32_bf16 v[108:111], v[20:23], v[76:79], v[108:111]
  s_waitcnt vmcnt(12) lgkmcnt(0)
  s_barrier
  v_mfma_f32_16x16x32_bf16 v[112:115], v[24:27], v[64:67], v[112:115]
  ds_read_b64_tr_b16 v[16:17], v216 offset:32768
  v_mfma_f32_16x16x32_bf16 v[116:119], v[24:27], v[68:71], v[116:119]
  s_add_u32 m0, s68, 16384
  s_mov_b32 s80, 0
  buffer_load_dwordx4 v12, s[52:55], s80 offen lds
  ds_read_b64_tr_b16 v[18:19], v216 offset:33792
  ds_read_b128 v[48:51], v224 offset:16384
  v_mfma_f32_16x16x32_bf16 v[120:123], v[24:27], v[72:75], v[120:123]
  ds_read_b64_tr_b16 v[20:21], v217 offset:32768
  v_mfma_f32_16x16x32_bf16 v[124:127], v[24:27], v[76:79], v[124:127]
  ds_read_b64_tr_b16 v[22:23], v217 offset:33792
  v_mfma_f32_16x16x32_bf16 v[128:131], v[28:31], v[64:67], v[128:131]
  ds_read_b64_tr_b16 v[24:25], v218 offset:32768
  ds_read_b128 v[52:55], v224 offset:18432
  v_mfma_f32_16x16x32_bf16 v[132:135], v[28:31], v[68:71], v[132:135]
  ds_read_b64_tr_b16 v[26:27], v218 offset:33792
  v_mfma_f32_16x16x32_bf16 v[136:139], v[28:31], v[72:75], v[136:139]
  buffer_load_dwordx4 v12, s[52:55], s80 offen offset:1024 lds
  v_mfma_f32_16x16x32_bf16 v[140:143], v[28:31], v[76:79], v[140:143]
  ds_read_b64_tr_b16 v[28:29], v219 offset:32768
  v_mfma_f32_16x16x32_bf16 v[144:147], v[32:35], v[64:67], v[144:147]
  ds_read_b64_tr_b16 v[30:31], v219 offset:33792
  ds_read_b128 v[56:59], v224 offset:20480
  v_mfma_f32_16x16x32_bf16 v[148:151], v[32:35], v[68:71], v[148:151]
  v_mfma_f32_16x16x32_bf16 v[152:155], v[32:35], v[72:75], v[152:155]
  v_mfma_f32_16x16x32_bf16 v[156:159], v[32:35], v[76:79], v[156:159]
  ds_read_b64_tr_b16 v[32:33], v220 offset:32768
  v_mfma_f32_16x16x32_bf16 v[160:163], v[36:39], v[64:67], v[160:163]
  buffer_load_dwordx4 v12, s[52:55], s80 offen offset:2048 lds
  ds_read_b64_tr_b16 v[34:35], v220 offset:33792
  ds_read_b128 v[60:63], v224 offset:22528
  v_mfma_f32_16x16x32_bf16 v[164:167], v[36:39], v[68:71], v[164:167]
  v_mfma_f32_16x16x32_bf16 v[168:171], v[36:39], v[72:75], v[168:171]
  v_mfma_f32_16x16x32_bf16 v[172:175], v[36:39], v[76:79], v[172:175]
  ds_read_b64_tr_b16 v[36:37], v221 offset:32768
  v_mfma_f32_16x16x32_bf16 v[176:179], v[40:43], v[64:67], v[176:179]
  ds_read_b64_tr_b16 v[38:39], v221 offset:33792
  v_mfma_f32_16x16x32_bf16 v[180:183], v[40:43], v[68:71], v[180:183]
  buffer_load_dwordx4 v12, s[52:55], s80 offen offset:3072 lds
  v_mfma_f32_16x16x32_bf16 v[184:187], v[40:43], v[72:75], v[184:187]
  v_mfma_f32_16x16x32_bf16 v[188:191], v[40:43], v[76:79], v[188:191]
  ds_read_b64_tr_b16 v[40:41], v222 offset:32768
  v_mfma_f32_16x16x32_bf16 v[192:195], v[44:47], v[64:67], v[192:195]
  ds_read_b64_tr_b16 v[42:43], v222 offset:33792
  v_mfma_f32_16x16x32_bf16 v[196:199], v[44:47], v[68:71], v[196:199]
  v_mfma_f32_16x16x32_bf16 v[200:203], v[44:47], v[72:75], v[200:203]
  v_mfma_f32_16x16x32_bf16 v[204:207], v[44:47], v[76:79], v[204:207]
  ds_read_b64_tr_b16 v[44:45], v223 offset:32768
  ds_read_b64_tr_b16 v[46:47], v223 offset:33792
  s_waitcnt lgkmcnt(4)
  v_mfma_f32_16x16x32_bf16 v[80:83], v[16:19], v[48:51], v[80:83]
  v_mfma_f32_16x16x32_bf16 v[84:87], v[16:19], v[52:55], v[84:87]
  ds_read_b128 v[64:67], v225 offset:16384
  v_mfma_f32_16x16x32_bf16 v[88:91], v[16:19], v[56:59], v[88:91]
  v_mfma_f32_16x16x32_bf16 v[92:95], v[16:19], v[60:63], v[92:95]
  ds_read_b64_tr_b16 v[16:17], v216 offset:40960
  v_mfma_f32_16x16x32_bf16 v[96:99], v[20:23], v[48:51], v[96:99]
  ds_read_b64_tr_b16 v[18:19], v216 offset:41984
  v_mfma_f32_16x16x32_bf16 v[100:103], v[20:23], v[52:55], v[100:103]
  v_mfma_f32_16x16x32_bf16 v[104:107], v[20:23], v[56:59], v[104:107]
  ds_read_b128 v[68:71], v225 offset:18432
  v_mfma_f32_16x16x32_bf16 v[108:111], v[20:23], v[60:63], v[108:111]
  ds_read_b64_tr_b16 v[20:21], v217 offset:40960
  v_mfma_f32_16x16x32_bf16 v[112:115], v[24:27], v[48:51], v[112:115]
  ds_read_b64_tr_b16 v[22:23], v217 offset:41984
  v_mfma_f32_16x16x32_bf16 v[116:119], v[24:27], v[52:55], v[116:119]
  v_mfma_f32_16x16x32_bf16 v[120:123], v[24:27], v[56:59], v[120:123]
  v_mfma_f32_16x16x32_bf16 v[124:127], v[24:27], v[60:63], v[124:127]
  ds_read_b64_tr_b16 v[24:25], v218 offset:40960
  v_mfma_f32_16x16x32_bf16 v[128:131], v[28:31], v[48:51], v[128:131]
  ds_read_b64_tr_b16 v[26:27], v218 offset:41984
  ds_read_b128 v[72:75], v225 offset:20480
  v_mfma_f32_16x16x32_bf16 v[132:135], v[28:31], v[52:55], v[132:135]
  v_mfma_f32_16x16x32_bf16 v[136:139], v[28:31], v[56:59], v[136:139]
  v_mfma_f32_16x16x32_bf16 v[140:143], v[28:31], v[60:63], v[140:143]
  ds_read_b64_tr_b16 v[28:29], v219 offset:40960
  v_mfma_f32_16x16x32_bf16 v[144:147], v[32:35], v[48:51], v[144:147]
  ds_read_b64_tr_b16 v[30:31], v219 offset:41984
  v_mfma_f32_16x16x32_bf16 v[148:151], v[32:35], v[52:55], v[148:151]
  v_mfma_f32_16x16x32_bf16 v[152:155], v[32:35], v[56:59], v[152:155]
  ds_read_b128 v[76:79], v225 offset:22528
  v_mfma_f32_16x16x32_bf16 v[156:159], v[32:35], v[60:63], v[156:159]
  ds_read_b64_tr_b16 v[32:33], v220 offset:40960
  v_mfma_f32_16x16x32_bf16 v[160:163], v[36:39], v[48:51], v[160:163]
  ds_read_b64_tr_b16 v[34:35], v220 offset:41984
  v_mfma_f32_16x16x32_bf16 v[164:167], v[36:39], v[52:55], v[164:167]
  v_mfma_f32_16x16x32_bf16 v[168:171], v[36:39], v[56:59], v[168:171]
  v_mfma_f32_16x16x32_bf16 v[172:175], v[36:39], v[60:63], v[172:175]
  ds_read_b64_tr_b16 v[36:37], v221 offset:40960
s_waitcnt lgkmcnt(15)
  v_mfma_f32_16x16x32_bf16 v[176:179], v[40:43], v[48:51], v[176:179]
  ds_read_b64_tr_b16 v[38:39], v221 offset:41984
  v_mfma_f32_16x16x32_bf16 v[180:183], v[40:43], v[52:55], v[180:183]
  v_mfma_f32_16x16x32_bf16 v[184:187], v[40:43], v[56:59], v[184:187]
  v_mfma_f32_16x16x32_bf16 v[188:191], v[40:43], v[60:63], v[188:191]
  ds_read_b64_tr_b16 v[40:41], v222 offset:40960
  v_mfma_f32_16x16x32_bf16 v[192:195], v[44:47], v[48:51], v[192:195]
  ds_read_b64_tr_b16 v[42:43], v222 offset:41984
  v_mfma_f32_16x16x32_bf16 v[196:199], v[44:47], v[52:55], v[196:199]
  v_mfma_f32_16x16x32_bf16 v[200:203], v[44:47], v[56:59], v[200:203]
  v_mfma_f32_16x16x32_bf16 v[204:207], v[44:47], v[60:63], v[204:207]
  ds_read_b64_tr_b16 v[44:45], v223 offset:40960
  ds_read_b64_tr_b16 v[46:47], v223 offset:41984
  s_waitcnt lgkmcnt(4)
  v_mfma_f32_16x16x32_bf16 v[80:83], v[16:19], v[64:67], v[80:83]
  v_mfma_f32_16x16x32_bf16 v[84:87], v[16:19], v[68:71], v[84:87]
  v_mfma_f32_16x16x32_bf16 v[88:91], v[16:19], v[72:75], v[88:91]
  v_mfma_f32_16x16x32_bf16 v[92:95], v[16:19], v[76:79], v[92:95]
  v_mfma_f32_16x16x32_bf16 v[96:99], v[20:23], v[64:67], v[96:99]
  v_mfma_f32_16x16x32_bf16 v[100:103], v[20:23], v[68:71], v[100:103]
  v_mfma_f32_16x16x32_bf16 v[104:107], v[20:23], v[72:75], v[104:107]
  v_mfma_f32_16x16x32_bf16 v[108:111], v[20:23], v[76:79], v[108:111]
  s_waitcnt vmcnt(4) lgkmcnt(0)
  s_barrier
  v_mfma_f32_16x16x32_bf16 v[112:115], v[24:27], v[64:67], v[112:115]
  ds_read_b64_tr_b16 v[16:17], v216 offset:0
  v_mfma_f32_16x16x32_bf16 v[116:119], v[24:27], v[68:71], v[116:119]
  s_add_u32 m0, s68, 32768
  s_mov_b32 s80, 16384
  buffer_load_dwordx4 v12, s[52:55], s80 offen lds
  ds_read_b64_tr_b16 v[18:19], v216 offset:1024
  ds_read_b128 v[48:51], v224 offset:0
  v_mfma_f32_16x16x32_bf16 v[120:123], v[24:27], v[72:75], v[120:123]
  ds_read_b64_tr_b16 v[20:21], v217 offset:0
  v_mfma_f32_16x16x32_bf16 v[124:127], v[24:27], v[76:79], v[124:127]
  buffer_load_dwordx4 v12, s[52:55], s80 offen offset:1024 lds
  ds_read_b64_tr_b16 v[22:23], v217 offset:1024
  v_mfma_f32_16x16x32_bf16 v[128:131], v[28:31], v[64:67], v[128:131]
  ds_read_b64_tr_b16 v[24:25], v218 offset:0
  ds_read_b128 v[52:55], v224 offset:2048
  v_mfma_f32_16x16x32_bf16 v[132:135], v[28:31], v[68:71], v[132:135]
  ds_read_b64_tr_b16 v[26:27], v218 offset:1024
  v_mfma_f32_16x16x32_bf16 v[136:139], v[28:31], v[72:75], v[136:139]
  buffer_load_dwordx4 v12, s[52:55], s80 offen offset:2048 lds
  v_mfma_f32_16x16x32_bf16 v[140:143], v[28:31], v[76:79], v[140:143]
  ds_read_b64_tr_b16 v[28:29], v219 offset:0
  v_mfma_f32_16x16x32_bf16 v[144:147], v[32:35], v[64:67], v[144:147]
  ds_read_b64_tr_b16 v[30:31], v219 offset:1024
  ds_read_b128 v[56:59], v224 offset:4096
  v_mfma_f32_16x16x32_bf16 v[148:151], v[32:35], v[68:71], v[148:151]
  buffer_load_dwordx4 v12, s[52:55], s80 offen offset:3072 lds
  v_mfma_f32_16x16x32_bf16 v[152:155], v[32:35], v[72:75], v[152:155]
  v_mfma_f32_16x16x32_bf16 v[156:159], v[32:35], v[76:79], v[156:159]
  ds_read_b64_tr_b16 v[32:33], v220 offset:0
  v_mfma_f32_16x16x32_bf16 v[160:163], v[36:39], v[64:67], v[160:163]
  s_add_u32 m0, s68, 81920
  s_mov_b32 s80, 16384
  buffer_load_dwordx4 v12, s[56:59], s80 offen lds
  ds_read_b64_tr_b16 v[34:35], v220 offset:1024
  ds_read_b128 v[60:63], v224 offset:6144
  v_mfma_f32_16x16x32_bf16 v[164:167], v[36:39], v[68:71], v[164:167]
  v_mfma_f32_16x16x32_bf16 v[168:171], v[36:39], v[72:75], v[168:171]
  buffer_load_dwordx4 v12, s[56:59], s80 offen offset:1024 lds
  v_mfma_f32_16x16x32_bf16 v[172:175], v[36:39], v[76:79], v[172:175]
  ds_read_b64_tr_b16 v[36:37], v221 offset:0
  v_mfma_f32_16x16x32_bf16 v[176:179], v[40:43], v[64:67], v[176:179]
  ds_read_b64_tr_b16 v[38:39], v221 offset:1024
  v_mfma_f32_16x16x32_bf16 v[180:183], v[40:43], v[68:71], v[180:183]
  buffer_load_dwordx4 v12, s[56:59], s80 offen offset:2048 lds
  v_mfma_f32_16x16x32_bf16 v[184:187], v[40:43], v[72:75], v[184:187]
  v_mfma_f32_16x16x32_bf16 v[188:191], v[40:43], v[76:79], v[188:191]
  ds_read_b64_tr_b16 v[40:41], v222 offset:0
  v_mfma_f32_16x16x32_bf16 v[192:195], v[44:47], v[64:67], v[192:195]
  buffer_load_dwordx4 v12, s[56:59], s80 offen offset:3072 lds
  ds_read_b64_tr_b16 v[42:43], v222 offset:1024
  v_mfma_f32_16x16x32_bf16 v[196:199], v[44:47], v[68:71], v[196:199]
  v_mfma_f32_16x16x32_bf16 v[200:203], v[44:47], v[72:75], v[200:203]
  v_mfma_f32_16x16x32_bf16 v[204:207], v[44:47], v[76:79], v[204:207]
  ds_read_b64_tr_b16 v[44:45], v223 offset:0
  ds_read_b64_tr_b16 v[46:47], v223 offset:1024
  s_waitcnt lgkmcnt(4)
  v_mfma_f32_16x16x32_bf16 v[80:83], v[16:19], v[48:51], v[80:83]
  v_mfma_f32_16x16x32_bf16 v[84:87], v[16:19], v[52:55], v[84:87]
  ds_read_b128 v[64:67], v225 offset:0
  v_mfma_f32_16x16x32_bf16 v[88:91], v[16:19], v[56:59], v[88:91]
  v_mfma_f32_16x16x32_bf16 v[92:95], v[16:19], v[60:63], v[92:95]
  ds_read_b64_tr_b16 v[16:17], v216 offset:8192
  v_mfma_f32_16x16x32_bf16 v[96:99], v[20:23], v[48:51], v[96:99]
  ds_read_b64_tr_b16 v[18:19], v216 offset:9216
  v_mfma_f32_16x16x32_bf16 v[100:103], v[20:23], v[52:55], v[100:103]
  v_mfma_f32_16x16x32_bf16 v[104:107], v[20:23], v[56:59], v[104:107]
  ds_read_b128 v[68:71], v225 offset:2048
  v_mfma_f32_16x16x32_bf16 v[108:111], v[20:23], v[60:63], v[108:111]
  ds_read_b64_tr_b16 v[20:21], v217 offset:8192
  v_mfma_f32_16x16x32_bf16 v[112:115], v[24:27], v[48:51], v[112:115]
  ds_read_b64_tr_b16 v[22:23], v217 offset:9216
  v_mfma_f32_16x16x32_bf16 v[116:119], v[24:27], v[52:55], v[116:119]
  v_mfma_f32_16x16x32_bf16 v[120:123], v[24:27], v[56:59], v[120:123]
  v_mfma_f32_16x16x32_bf16 v[124:127], v[24:27], v[60:63], v[124:127]
  ds_read_b64_tr_b16 v[24:25], v218 offset:8192
  v_mfma_f32_16x16x32_bf16 v[128:131], v[28:31], v[48:51], v[128:131]
  ds_read_b64_tr_b16 v[26:27], v218 offset:9216
  ds_read_b128 v[72:75], v225 offset:4096
  v_mfma_f32_16x16x32_bf16 v[132:135], v[28:31], v[52:55], v[132:135]
  v_mfma_f32_16x16x32_bf16 v[136:139], v[28:31], v[56:59], v[136:139]
  v_mfma_f32_16x16x32_bf16 v[140:143], v[28:31], v[60:63], v[140:143]
  ds_read_b64_tr_b16 v[28:29], v219 offset:8192
  v_mfma_f32_16x16x32_bf16 v[144:147], v[32:35], v[48:51], v[144:147]
  ds_read_b64_tr_b16 v[30:31], v219 offset:9216
  v_mfma_f32_16x16x32_bf16 v[148:151], v[32:35], v[52:55], v[148:151]
  v_mfma_f32_16x16x32_bf16 v[152:155], v[32:35], v[56:59], v[152:155]
  ds_read_b128 v[76:79], v225 offset:6144
  v_mfma_f32_16x16x32_bf16 v[156:159], v[32:35], v[60:63], v[156:159]
  ds_read_b64_tr_b16 v[32:33], v220 offset:8192
  v_mfma_f32_16x16x32_bf16 v[160:163], v[36:39], v[48:51], v[160:163]
  ds_read_b64_tr_b16 v[34:35], v220 offset:9216
  v_mfma_f32_16x16x32_bf16 v[164:167], v[36:39], v[52:55], v[164:167]
  v_mfma_f32_16x16x32_bf16 v[168:171], v[36:39], v[56:59], v[168:171]
  v_mfma_f32_16x16x32_bf16 v[172:175], v[36:39], v[60:63], v[172:175]
  ds_read_b64_tr_b16 v[36:37], v221 offset:8192
s_waitcnt lgkmcnt(15)
  v_mfma_f32_16x16x32_bf16 v[176:179], v[40:43], v[48:51], v[176:179]
  ds_read_b64_tr_b16 v[38:39], v221 offset:9216
  v_mfma_f32_16x16x32_bf16 v[180:183], v[40:43], v[52:55], v[180:183]
  v_mfma_f32_16x16x32_bf16 v[184:187], v[40:43], v[56:59], v[184:187]
  v_mfma_f32_16x16x32_bf16 v[188:191], v[40:43], v[60:63], v[188:191]
  ds_read_b64_tr_b16 v[40:41], v222 offset:8192
  v_mfma_f32_16x16x32_bf16 v[192:195], v[44:47], v[48:51], v[192:195]
  ds_read_b64_tr_b16 v[42:43], v222 offset:9216
  v_mfma_f32_16x16x32_bf16 v[196:199], v[44:47], v[52:55], v[196:199]
  v_mfma_f32_16x16x32_bf16 v[200:203], v[44:47], v[56:59], v[200:203]
  v_mfma_f32_16x16x32_bf16 v[204:207], v[44:47], v[60:63], v[204:207]
  ds_read_b64_tr_b16 v[44:45], v223 offset:8192
  ds_read_b64_tr_b16 v[46:47], v223 offset:9216
  s_waitcnt lgkmcnt(4)
  v_mfma_f32_16x16x32_bf16 v[80:83], v[16:19], v[64:67], v[80:83]
  v_mfma_f32_16x16x32_bf16 v[84:87], v[16:19], v[68:71], v[84:87]
  v_mfma_f32_16x16x32_bf16 v[88:91], v[16:19], v[72:75], v[88:91]
  v_mfma_f32_16x16x32_bf16 v[92:95], v[16:19], v[76:79], v[92:95]
  v_mfma_f32_16x16x32_bf16 v[96:99], v[20:23], v[64:67], v[96:99]
  v_mfma_f32_16x16x32_bf16 v[100:103], v[20:23], v[68:71], v[100:103]
  v_mfma_f32_16x16x32_bf16 v[104:107], v[20:23], v[72:75], v[104:107]
  v_mfma_f32_16x16x32_bf16 v[108:111], v[20:23], v[76:79], v[108:111]
  v_mfma_f32_16x16x32_bf16 v[112:115], v[24:27], v[64:67], v[112:115]
  v_mfma_f32_16x16x32_bf16 v[116:119], v[24:27], v[68:71], v[116:119]
  v_mfma_f32_16x16x32_bf16 v[120:123], v[24:27], v[72:75], v[120:123]
  v_mfma_f32_16x16x32_bf16 v[124:127], v[24:27], v[76:79], v[124:127]
  v_mfma_f32_16x16x32_bf16 v[128:131], v[28:31], v[64:67], v[128:131]
  v_mfma_f32_16x16x32_bf16 v[132:135], v[28:31], v[68:71], v[132:135]
  v_mfma_f32_16x16x32_bf16 v[136:139], v[28:31], v[72:75], v[136:139]
  v_mfma_f32_16x16x32_bf16 v[140:143], v[28:31], v[76:79], v[140:143]
  v_mfma_f32_16x16x32_bf16 v[144:147], v[32:35], v[64:67], v[144:147]
  v_mfma_f32_16x16x32_bf16 v[148:151], v[32:35], v[68:71], v[148:151]
  v_mfma_f32_16x16x32_bf16 v[152:155], v[32:35], v[72:75], v[152:155]
  v_mfma_f32_16x16x32_bf16 v[156:159], v[32:35], v[76:79], v[156:159]
  v_mfma_f32_16x16x32_bf16 v[160:163], v[36:39], v[64:67], v[160:163]
  v_mfma_f32_16x16x32_bf16 v[164:167], v[36:39], v[68:71], v[164:167]
  v_mfma_f32_16x16x32_bf16 v[168:171], v[36:39], v[72:75], v[168:171]
  v_mfma_f32_16x16x32_bf16 v[172:175], v[36:39], v[76:79], v[172:175]
s_waitcnt lgkmcnt(2)
  v_mfma_f32_16x16x32_bf16 v[176:179], v[40:43], v[64:67], v[176:179]
  v_mfma_f32_16x16x32_bf16 v[180:183], v[40:43], v[68:71], v[180:183]
  v_mfma_f32_16x16x32_bf16 v[184:187], v[40:43], v[72:75], v[184:187]
  v_mfma_f32_16x16x32_bf16 v[188:191], v[40:43], v[76:79], v[188:191]
s_waitcnt lgkmcnt(0)
  v_mfma_f32_16x16x32_bf16 v[192:195], v[44:47], v[64:67], v[192:195]
  v_mfma_f32_16x16x32_bf16 v[196:199], v[44:47], v[68:71], v[196:199]
  v_mfma_f32_16x16x32_bf16 v[200:203], v[44:47], v[72:75], v[200:203]
  v_mfma_f32_16x16x32_bf16 v[204:207], v[44:47], v[76:79], v[204:207]
  s_waitcnt vmcnt(8) lgkmcnt(0)
  s_barrier
  s_add_u32 m0, s68, 49152
  s_mov_b32 s80, 32768
  buffer_load_dwordx4 v12, s[52:55], s80 offen lds
  buffer_load_dwordx4 v12, s[52:55], s80 offen offset:1024 lds
  buffer_load_dwordx4 v12, s[52:55], s80 offen offset:2048 lds
  buffer_load_dwordx4 v12, s[52:55], s80 offen offset:3072 lds
  s_add_u32 m0, s68, 98304
  s_mov_b32 s80, 32768
  buffer_load_dwordx4 v12, s[56:59], s80 offen lds
  buffer_load_dwordx4 v12, s[56:59], s80 offen offset:1024 lds
  buffer_load_dwordx4 v12, s[56:59], s80 offen offset:2048 lds
  buffer_load_dwordx4 v12, s[56:59], s80 offen offset:3072 lds
  s_add_u32 m0, s68, 0
  s_mov_b32 s80, 49152
  buffer_load_dwordx4 v12, s[52:55], s80 offen lds
  buffer_load_dwordx4 v12, s[52:55], s80 offen offset:1024 lds
  buffer_load_dwordx4 v12, s[52:55], s80 offen offset:2048 lds
  buffer_load_dwordx4 v12, s[52:55], s80 offen offset:3072 lds
  s_add_u32 m0, s68, 114688
  s_mov_b32 s80, 49152
  buffer_load_dwordx4 v12, s[56:59], s80 offen lds
  buffer_load_dwordx4 v12, s[56:59], s80 offen offset:1024 lds
  buffer_load_dwordx4 v12, s[56:59], s80 offen offset:2048 lds
  buffer_load_dwordx4 v12, s[56:59], s80 offen offset:3072 lds
  v_xor_b32 v244, 0x8000, v10
  ds_read_b128 a[128:131], v244 offset:16384
  ds_read_b128 a[132:135], v244 offset:17408
  ds_read_b128 a[136:139], v244 offset:18432
  ds_read_b128 a[140:143], v244 offset:19456
  ds_read_b128 a[144:147], v244 offset:20480
  ds_read_b128 a[148:151], v244 offset:21504
  ds_read_b128 a[152:155], v244 offset:22528
  ds_read_b128 a[156:159], v244 offset:23552
  ds_read_b128 a[160:163], v244 offset:24576
  ds_read_b128 a[164:167], v244 offset:25600
  ds_read_b128 a[168:171], v244 offset:26624
  ds_read_b128 a[172:175], v244 offset:27648
  ds_read_b128 a[176:179], v244 offset:28672
  ds_read_b128 a[180:183], v244 offset:29696
  ds_read_b128 a[184:187], v244 offset:30720
  ds_read_b128 a[188:191], v244 offset:31744
  v_cvt_pk_bf16_f32 v16, v80, v81
  v_cvt_pk_bf16_f32 v17, v82, v83
  v_cvt_pk_bf16_f32 v18, v96, v97
  v_cvt_pk_bf16_f32 v19, v98, v99
  v_cvt_pk_bf16_f32 v20, v84, v85
  v_cvt_pk_bf16_f32 v21, v86, v87
  v_cvt_pk_bf16_f32 v22, v100, v101
  v_cvt_pk_bf16_f32 v23, v102, v103
  v_cvt_pk_bf16_f32 v24, v112, v113
  v_cvt_pk_bf16_f32 v25, v114, v115
  v_cvt_pk_bf16_f32 v26, v128, v129
  v_cvt_pk_bf16_f32 v27, v130, v131
  v_cvt_pk_bf16_f32 v28, v116, v117
  v_cvt_pk_bf16_f32 v29, v118, v119
  v_cvt_pk_bf16_f32 v30, v132, v133
  v_cvt_pk_bf16_f32 v31, v134, v135
  v_cvt_pk_bf16_f32 v32, v144, v145
  v_cvt_pk_bf16_f32 v33, v146, v147
  v_cvt_pk_bf16_f32 v34, v160, v161
  v_cvt_pk_bf16_f32 v35, v162, v163
  v_cvt_pk_bf16_f32 v36, v148, v149
  v_cvt_pk_bf16_f32 v37, v150, v151
  v_cvt_pk_bf16_f32 v38, v164, v165
  v_cvt_pk_bf16_f32 v39, v166, v167
  v_cvt_pk_bf16_f32 v40, v176, v177
  v_cvt_pk_bf16_f32 v41, v178, v179
  v_cvt_pk_bf16_f32 v42, v192, v193
  v_cvt_pk_bf16_f32 v43, v194, v195
  v_cvt_pk_bf16_f32 v44, v180, v181
  v_cvt_pk_bf16_f32 v45, v182, v183
  v_cvt_pk_bf16_f32 v46, v196, v197
  v_cvt_pk_bf16_f32 v47, v198, v199
  v_cvt_pk_bf16_f32 v48, v88, v89
  v_cvt_pk_bf16_f32 v49, v90, v91
  v_cvt_pk_bf16_f32 v50, v104, v105
  v_cvt_pk_bf16_f32 v51, v106, v107
  v_cvt_pk_bf16_f32 v52, v92, v93
  v_cvt_pk_bf16_f32 v53, v94, v95
  v_cvt_pk_bf16_f32 v54, v108, v109
  v_cvt_pk_bf16_f32 v55, v110, v111
  v_cvt_pk_bf16_f32 v56, v120, v121
  v_cvt_pk_bf16_f32 v57, v122, v123
  v_cvt_pk_bf16_f32 v58, v136, v137
  v_cvt_pk_bf16_f32 v59, v138, v139
  v_cvt_pk_bf16_f32 v60, v124, v125
  v_cvt_pk_bf16_f32 v61, v126, v127
  v_cvt_pk_bf16_f32 v62, v140, v141
  v_cvt_pk_bf16_f32 v63, v142, v143
  v_cvt_pk_bf16_f32 v64, v152, v153
  v_cvt_pk_bf16_f32 v65, v154, v155
  v_cvt_pk_bf16_f32 v66, v168, v169
  v_cvt_pk_bf16_f32 v67, v170, v171
  v_cvt_pk_bf16_f32 v68, v156, v157
  v_cvt_pk_bf16_f32 v69, v158, v159
  v_cvt_pk_bf16_f32 v70, v172, v173
  v_cvt_pk_bf16_f32 v71, v174, v175
  v_cvt_pk_bf16_f32 v72, v184, v185
  v_cvt_pk_bf16_f32 v73, v186, v187
  v_cvt_pk_bf16_f32 v74, v200, v201
  v_cvt_pk_bf16_f32 v75, v202, v203
  v_cvt_pk_bf16_f32 v76, v188, v189
  v_cvt_pk_bf16_f32 v77, v190, v191
  v_cvt_pk_bf16_f32 v78, v204, v205
  v_cvt_pk_bf16_f32 v79, v206, v207
  v_permlane16_swap_b32 v16, v20
  v_permlane16_swap_b32 v17, v21
  v_permlane16_swap_b32 v18, v22
  v_permlane16_swap_b32 v19, v23
  v_permlane16_swap_b32 v24, v28
  v_permlane16_swap_b32 v25, v29
  v_permlane16_swap_b32 v26, v30
  v_permlane16_swap_b32 v27, v31
  v_permlane16_swap_b32 v32, v36
  v_permlane16_swap_b32 v33, v37
  v_permlane16_swap_b32 v34, v38
  v_permlane16_swap_b32 v35, v39
  v_permlane16_swap_b32 v40, v44
  v_permlane16_swap_b32 v41, v45
  v_permlane16_swap_b32 v42, v46
  v_permlane16_swap_b32 v43, v47
  v_permlane16_swap_b32 v48, v52
  v_permlane16_swap_b32 v49, v53
  v_permlane16_swap_b32 v50, v54
  v_permlane16_swap_b32 v51, v55
  v_permlane16_swap_b32 v56, v60
  v_permlane16_swap_b32 v57, v61
  v_permlane16_swap_b32 v58, v62
  v_permlane16_swap_b32 v59, v63
  v_permlane16_swap_b32 v64, v68
  v_permlane16_swap_b32 v65, v69
  v_permlane16_swap_b32 v66, v70
  v_permlane16_swap_b32 v67, v71
  v_permlane16_swap_b32 v72, v76
  v_permlane16_swap_b32 v73, v77
  v_permlane16_swap_b32 v74, v78
  v_permlane16_swap_b32 v75, v79
  v_mov_b32 v2, 0
  v_mov_b32 v3, 0
  v_mov_b32 v4, 0
  v_mov_b32 v5, 0
s_waitcnt lgkmcnt(15)
  v_mfma_f32_32x32x16_bf16 v[80:95], a[128:131], v[16:19], 0
  v_mfma_f32_32x32x16_bf16 v[96:111], a[128:131], v[48:51], 0
s_waitcnt lgkmcnt(14)
  v_mfma_f32_32x32x16_bf16 v[80:95], a[132:135], v[20:23], v[80:95]
  v_mfma_f32_32x32x16_bf16 v[96:111], a[132:135], v[52:55], v[96:111]
s_waitcnt lgkmcnt(13)
  v_mfma_f32_32x32x16_bf16 v[80:95], a[136:139], v[24:27], v[80:95]
  v_mfma_f32_32x32x16_bf16 v[96:111], a[136:139], v[56:59], v[96:111]
s_waitcnt lgkmcnt(12)
  v_mfma_f32_32x32x16_bf16 v[80:95], a[140:143], v[28:31], v[80:95]
  v_mfma_f32_32x32x16_bf16 v[96:111], a[140:143], v[60:63], v[96:111]
s_waitcnt lgkmcnt(11)
  v_mfma_f32_32x32x16_bf16 v[80:95], a[144:147], v[32:35], v[80:95]
  v_mfma_f32_32x32x16_bf16 v[96:111], a[144:147], v[64:67], v[96:111]
s_waitcnt lgkmcnt(10)
  v_mfma_f32_32x32x16_bf16 v[80:95], a[148:151], v[36:39], v[80:95]
  v_mfma_f32_32x32x16_bf16 v[96:111], a[148:151], v[68:71], v[96:111]
s_waitcnt lgkmcnt(9)
  v_mfma_f32_32x32x16_bf16 v[80:95], a[152:155], v[40:43], v[80:95]
  v_mfma_f32_32x32x16_bf16 v[96:111], a[152:155], v[72:75], v[96:111]
s_waitcnt lgkmcnt(8)
  v_mfma_f32_32x32x16_bf16 v[80:95], a[156:159], v[44:47], v[80:95]
  v_mfma_f32_32x32x16_bf16 v[96:111], a[156:159], v[76:79], v[96:111]
s_waitcnt lgkmcnt(7)
  v_mfma_f32_32x32x16_bf16 v[112:127], a[160:163], v[16:19], 0
  v_mfma_f32_32x32x16_bf16 v[128:143], a[160:163], v[48:51], 0
s_waitcnt lgkmcnt(6)
  v_mfma_f32_32x32x16_bf16 v[112:127], a[164:167], v[20:23], v[112:127]
  v_mfma_f32_32x32x16_bf16 v[128:143], a[164:167], v[52:55], v[128:143]
s_waitcnt lgkmcnt(5)
  v_mfma_f32_32x32x16_bf16 v[112:127], a[168:171], v[24:27], v[112:127]
  v_mfma_f32_32x32x16_bf16 v[128:143], a[168:171], v[56:59], v[128:143]
s_waitcnt lgkmcnt(4)
  v_mfma_f32_32x32x16_bf16 v[112:127], a[172:175], v[28:31], v[112:127]
  v_mfma_f32_32x32x16_bf16 v[128:143], a[172:175], v[60:63], v[128:143]
s_waitcnt lgkmcnt(3)
  v_mfma_f32_32x32x16_bf16 v[112:127], a[176:179], v[32:35], v[112:127]
  v_mfma_f32_32x32x16_bf16 v[128:143], a[176:179], v[64:67], v[128:143]
s_waitcnt lgkmcnt(2)
  v_mfma_f32_32x32x16_bf16 v[112:127], a[180:183], v[36:39], v[112:127]
  v_mfma_f32_32x32x16_bf16 v[128:143], a[180:183], v[68:71], v[128:143]
s_waitcnt lgkmcnt(1)
  v_mfma_f32_32x32x16_bf16 v[112:127], a[184:187], v[40:43], v[112:127]
  v_mfma_f32_32x32x16_bf16 v[128:143], a[184:187], v[72:75], v[128:143]
s_waitcnt lgkmcnt(0)
  v_mfma_f32_32x32x16_bf16 v[112:127], a[188:191], v[44:47], v[112:127]
  v_mfma_f32_32x32x16_bf16 v[128:143], a[188:191], v[76:79], v[128:143]
  s_waitcnt vmcnt(8)
  s_barrier
  s_add_u32 m0, s68, 16384
  s_mov_b32 s80, 65536
  buffer_load_dwordx4 v12, s[52:55], s80 offen lds
  buffer_load_dwordx4 v12, s[52:55], s80 offen offset:1024 lds
  buffer_load_dwordx4 v12, s[52:55], s80 offen offset:2048 lds
  buffer_load_dwordx4 v12, s[52:55], s80 offen offset:3072 lds
  s_add_u32 m0, s68, 65536
  s_mov_b32 s80, 65536
  buffer_load_dwordx4 v12, s[56:59], s80 offen lds
  buffer_load_dwordx4 v12, s[56:59], s80 offen offset:1024 lds
  buffer_load_dwordx4 v12, s[56:59], s80 offen offset:2048 lds
  buffer_load_dwordx4 v12, s[56:59], s80 offen offset:3072 lds
  ds_read_b128 a[128:131], v10 offset:0
  ds_read_b128 a[132:135], v10 offset:1024
  ds_read_b128 a[136:139], v10 offset:2048
  ds_read_b128 a[140:143], v10 offset:3072
  ds_read_b128 a[144:147], v10 offset:4096
  ds_read_b128 a[148:151], v10 offset:5120
  ds_read_b128 a[152:155], v10 offset:6144
  ds_read_b128 a[156:159], v10 offset:7168
  ds_read_b128 a[160:163], v10 offset:8192
  ds_read_b128 a[164:167], v10 offset:9216
  ds_read_b128 a[168:171], v10 offset:10240
  ds_read_b128 a[172:175], v10 offset:11264
  ds_read_b128 a[176:179], v10 offset:12288
  ds_read_b128 a[180:183], v10 offset:13312
  ds_read_b128 a[184:187], v10 offset:14336
  ds_read_b128 a[188:191], v10 offset:15360
  s_mov_b32 s71, 81920
  s_mov_b32 s75, 1
  s_mov_b32 s80, 0
  s_cmp_eq_u32 s76, 2
  s_cbranch_scc1 L_kb_kernel_pmask
L_kb_kernel_pmask_ret:
  v_max3_f32 v6, v80, v81, v82
  v_max3_f32 v7, v96, v97, v98
  v_max3_f32 v6, v6, v83, v84
  v_max3_f32 v7, v7, v99, v100
  v_max3_f32 v6, v6, v85, v86
  v_max3_f32 v7, v7, v101, v102
  v_max3_f32 v6, v6, v87, v88
  v_max3_f32 v7, v7, v103, v104
  v_max3_f32 v6, v6, v89, v90
  v_max3_f32 v7, v7, v105, v106
  v_max3_f32 v6, v6, v91, v92
  v_max3_f32 v7, v7, v107, v108
  v_max3_f32 v6, v6, v93, v94
  v_max3_f32 v7, v7, v109, v110
  v_max3_f32 v6, v6, v95, v112
  v_max3_f32 v7, v7, v111, v128
  v_max3_f32 v6, v6, v113, v114
  v_max3_f32 v7, v7, v129, v130
  v_max3_f32 v6, v6, v115, v116
  v_max3_f32 v7, v7, v131, v132
  v_max3_f32 v6, v6, v117, v118
  v_max3_f32 v7, v7, v133, v134
  v_max3_f32 v6, v6, v119, v120
  v_max3_f32 v7, v7, v135, v136
  v_max3_f32 v6, v6, v121, v122
  v_max3_f32 v7, v7, v137, v138
  v_max3_f32 v6, v6, v123, v124
  v_max3_f32 v7, v7, v139, v140
  v_max3_f32 v6, v6, v125, v126
  v_max3_f32 v7, v7, v141, v142
  v_max_f32 v6, v6, v127
  v_max_f32 v7, v7, v143
  v_mov_b32 v240, v6
  v_mov_b32 v241, v6
s_nop 1
  v_permlane32_swap_b32 v240, v241
  v_max_f32 v242, v240, v241
  v_sub_f32 v208, 0, v242
  v_sub_f32 v209, 0, v242
  v_sub_f32 v210, 0, v242
  v_sub_f32 v211, 0, v242
  v_sub_f32 v212, 0, v242
  v_sub_f32 v213, 0, v242
  v_sub_f32 v214, 0, v242
  v_sub_f32 v215, 0, v242
  v_sub_f32 v216, 0, v242
  v_sub_f32 v217, 0, v242
  v_sub_f32 v218, 0, v242
  v_sub_f32 v219, 0, v242
  v_sub_f32 v220, 0, v242
  v_sub_f32 v221, 0, v242
  v_sub_f32 v222, 0, v242
  v_sub_f32 v223, 0, v242
  v_sub_f32 v80, v80, v242
  v_sub_f32 v81, v81, v242
  v_sub_f32 v82, v82, v242
  v_sub_f32 v83, v83, v242
  v_sub_f32 v84, v84, v242
  v_sub_f32 v85, v85, v242
  v_sub_f32 v86, v86, v242
  v_sub_f32 v87, v87, v242
  v_sub_f32 v88, v88, v242
  v_sub_f32 v89, v89, v242
  v_sub_f32 v90, v90, v242
  v_sub_f32 v91, v91, v242
  v_sub_f32 v92, v92, v242
  v_sub_f32 v93, v93, v242
  v_sub_f32 v94, v94, v242
  v_sub_f32 v95, v95, v242
  v_sub_f32 v112, v112, v242
  v_sub_f32 v113, v113, v242
  v_sub_f32 v114, v114, v242
  v_sub_f32 v115, v115, v242
  v_sub_f32 v116, v116, v242
  v_sub_f32 v117, v117, v242
  v_sub_f32 v118, v118, v242
  v_sub_f32 v119, v119, v242
  v_sub_f32 v120, v120, v242
  v_sub_f32 v121, v121, v242
  v_sub_f32 v122, v122, v242
  v_sub_f32 v123, v123, v242
  v_sub_f32 v124, v124, v242
  v_sub_f32 v125, v125, v242
  v_sub_f32 v126, v126, v242
  v_sub_f32 v127, v127, v242
  v_mov_b32 v240, v7
  v_mov_b32 v241, v7
s_nop 1
  v_permlane32_swap_b32 v240, v241
  v_max_f32 v242, v240, v241
  v_sub_f32 v224, 0, v242
  v_sub_f32 v225, 0, v242
  v_sub_f32 v226, 0, v242
  v_sub_f32 v227, 0, v242
  v_sub_f32 v228, 0, v242
  v_sub_f32 v229, 0, v242
  v_sub_f32 v230, 0, v242
  v_sub_f32 v231, 0, v242
  v_sub_f32 v232, 0, v242
  v_sub_f32 v233, 0, v242
  v_sub_f32 v234, 0, v242
  v_sub_f32 v235, 0, v242
  v_sub_f32 v236, 0, v242
  v_sub_f32 v237, 0, v242
  v_sub_f32 v238, 0, v242
  v_sub_f32 v239, 0, v242
  v_sub_f32 v96, v96, v242
  v_sub_f32 v97, v97, v242
  v_sub_f32 v98, v98, v242
  v_sub_f32 v99, v99, v242
  v_sub_f32 v100, v100, v242
  v_sub_f32 v101, v101, v242
  v_sub_f32 v102, v102, v242
  v_sub_f32 v103, v103, v242
  v_sub_f32 v104, v104, v242
  v_sub_f32 v105, v105, v242
  v_sub_f32 v106, v106, v242
  v_sub_f32 v107, v107, v242
  v_sub_f32 v108, v108, v242
  v_sub_f32 v109, v109, v242
  v_sub_f32 v110, v110, v242
  v_sub_f32 v111, v111, v242
  v_sub_f32 v128, v128, v242
  v_sub_f32 v129, v129, v242
  v_sub_f32 v130, v130, v242
  v_sub_f32 v131, v131, v242
  v_sub_f32 v132, v132, v242
  v_sub_f32 v133, v133, v242
  v_sub_f32 v134, v134, v242
  v_sub_f32 v135, v135, v242
  v_sub_f32 v136, v136, v242
  v_sub_f32 v137, v137, v242
  v_sub_f32 v138, v138, v242
  v_sub_f32 v139, v139, v242
  v_sub_f32 v140, v140, v242
  v_sub_f32 v141, v141, v242
  v_sub_f32 v142, v142, v242
  v_sub_f32 v143, v143, v242
  v_exp_f32 v80, v80
  v_exp_f32 v81, v81
  v_exp_f32 v82, v82
  v_add_f32 v2, v2, v80
  v_exp_f32 v83, v83
  v_add_f32 v3, v3, v81
  v_cvt_pk_bf16_f32 v80, v80, v81
  v_exp_f32 v84, v84
  v_add_f32 v2, v2, v82
  v_exp_f32 v85, v85
  v_add_f32 v3, v3, v83
  v_cvt_pk_bf16_f32 v81, v82, v83
  v_exp_f32 v86, v86
  v_add_f32 v2, v2, v84
  v_exp_f32 v87, v87
  v_add_f32 v3, v3, v85
  v_cvt_pk_bf16_f32 v82, v84, v85
  v_exp_f32 v88, v88
  v_add_f32 v2, v2, v86
  v_exp_f32 v89, v89
  v_add_f32 v3, v3, v87
  v_cvt_pk_bf16_f32 v83, v86, v87
  v_exp_f32 v90, v90
  v_add_f32 v2, v2, v88
  v_exp_f32 v91, v91
  v_add_f32 v3, v3, v89
  v_cvt_pk_bf16_f32 v88, v88, v89
  v_exp_f32 v92, v92
  v_add_f32 v2, v2, v90
  v_exp_f32 v93, v93
  v_add_f32 v3, v3, v91
  v_cvt_pk_bf16_f32 v89, v90, v91
  v_exp_f32 v94, v94
  v_add_f32 v2, v2, v92
  v_exp_f32 v95, v95
  v_add_f32 v3, v3, v93
  v_cvt_pk_bf16_f32 v90, v92, v93
  v_exp_f32 v96, v96
  v_add_f32 v2, v2, v94
  v_exp_f32 v97, v97
  v_add_f32 v3, v3, v95
  v_cvt_pk_bf16_f32 v91, v94, v95
  v_exp_f32 v98, v98
  v_add_f32 v4, v4, v96
  v_exp_f32 v99, v99
  v_add_f32 v5, v5, v97
  v_cvt_pk_bf16_f32 v96, v96, v97
  v_exp_f32 v100, v100
  v_add_f32 v4, v4, v98
  v_exp_f32 v101, v101
  v_add_f32 v5, v5, v99
  v_cvt_pk_bf16_f32 v97, v98, v99
  v_exp_f32 v102, v102
  v_add_f32 v4, v4, v100
  v_exp_f32 v103, v103
  v_add_f32 v5, v5, v101
  v_cvt_pk_bf16_f32 v98, v100, v101
  v_add_f32 v4, v4, v102
  v_add_f32 v5, v5, v103
  v_cvt_pk_bf16_f32 v99, v102, v103
  s_sub_u32 s74, s76, 1
.p2align 5
L_kb_kernel_dual:
  s_waitcnt lgkmcnt(0)
  v_mfma_f32_32x32x16_bf16 v[144:159], a[128:131], v[16:19], v[208:223]
  ds_read_b128 a[192:195], v11 offset:16384
  v_exp_f32 v104, v104
  v_exp_f32 v105, v105
  v_exp_f32 v106, v106
  v_add_f32 v4, v4, v104
  v_mfma_f32_32x32x16_bf16 v[160:175], a[128:131], v[48:51], v[224:239]
  ds_read_b128 a[196:199], v11 offset:17408
  v_exp_f32 v107, v107
  v_add_f32 v5, v5, v105
  v_cvt_pk_bf16_f32 v104, v104, v105
  v_mfma_f32_32x32x16_bf16 v[144:159], a[132:135], v[20:23], v[144:159]
  v_exp_f32 v108, v108
  v_add_f32 v4, v4, v106
  v_exp_f32 v109, v109
  v_mfma_f32_32x32x16_bf16 v[160:175], a[132:135], v[52:55], v[160:175]
  ds_read_b128 a[200:203], v11 offset:18432
  v_add_f32 v5, v5, v107
  v_cvt_pk_bf16_f32 v105, v106, v107
  v_exp_f32 v110, v110
  v_mfma_f32_32x32x16_bf16 v[144:159], a[136:139], v[24:27], v[144:159]
  ds_read_b128 a[204:207], v11 offset:19456
  v_add_f32 v4, v4, v108
  v_exp_f32 v111, v111
  v_add_f32 v5, v5, v109
  v_mfma_f32_32x32x16_bf16 v[160:175], a[136:139], v[56:59], v[160:175]
  v_cvt_pk_bf16_f32 v106, v108, v109
  v_exp_f32 v112, v112
  v_add_f32 v4, v4, v110
  v_mfma_f32_32x32x16_bf16 v[144:159], a[140:143], v[28:31], v[144:159]
  ds_read_b128 a[208:211], v11 offset:20480
  v_exp_f32 v113, v113
  v_add_f32 v5, v5, v111
  v_cvt_pk_bf16_f32 v107, v110, v111
  v_mfma_f32_32x32x16_bf16 v[160:175], a[140:143], v[60:63], v[160:175]
  ds_read_b128 a[212:215], v11 offset:21504
  v_exp_f32 v114, v114
  v_add_f32 v2, v2, v112
  v_exp_f32 v115, v115
  v_mfma_f32_32x32x16_bf16 v[144:159], a[144:147], v[32:35], v[144:159]
  v_add_f32 v3, v3, v113
  v_cvt_pk_bf16_f32 v112, v112, v113
  v_exp_f32 v116, v116
  v_add_f32 v2, v2, v114
  v_mfma_f32_32x32x16_bf16 v[160:175], a[144:147], v[64:67], v[160:175]
  ds_read_b128 a[216:219], v11 offset:22528
  v_exp_f32 v117, v117
  v_add_f32 v3, v3, v115
  v_cvt_pk_bf16_f32 v113, v114, v115
  v_mfma_f32_32x32x16_bf16 v[144:159], a[148:151], v[36:39], v[144:159]
  ds_read_b128 a[220:223], v11 offset:23552
  v_exp_f32 v118, v118
  v_add_f32 v2, v2, v116
  v_exp_f32 v119, v119
  v_mfma_f32_32x32x16_bf16 v[160:175], a[148:151], v[68:71], v[160:175]
  v_add_f32 v3, v3, v117
  v_cvt_pk_bf16_f32 v114, v116, v117
  v_exp_f32 v120, v120
  v_mfma_f32_32x32x16_bf16 v[144:159], a[152:155], v[40:43], v[144:159]
  ds_read_b128 a[224:227], v11 offset:24576
  v_add_f32 v2, v2, v118
  v_exp_f32 v121, v121
  v_add_f32 v3, v3, v119
  v_mfma_f32_32x32x16_bf16 v[160:175], a[152:155], v[72:75], v[160:175]
  ds_read_b128 a[228:231], v11 offset:25600
  v_cvt_pk_bf16_f32 v115, v118, v119
  v_exp_f32 v122, v122
  v_add_f32 v2, v2, v120
  v_mfma_f32_32x32x16_bf16 v[144:159], a[156:159], v[44:47], v[144:159]
  v_exp_f32 v123, v123
  v_add_f32 v3, v3, v121
  v_cvt_pk_bf16_f32 v120, v120, v121
  v_mfma_f32_32x32x16_bf16 v[160:175], a[156:159], v[76:79], v[160:175]
  ds_read_b128 a[232:235], v11 offset:26624
  v_exp_f32 v124, v124
  v_add_f32 v2, v2, v122
  v_exp_f32 v125, v125
  v_mfma_f32_32x32x16_bf16 v[176:191], a[160:163], v[16:19], v[208:223]
  ds_read_b128 a[236:239], v11 offset:27648
  v_add_f32 v3, v3, v123
  v_cvt_pk_bf16_f32 v121, v122, v123
  v_exp_f32 v126, v126
  v_add_f32 v2, v2, v124
  v_mfma_f32_32x32x16_bf16 v[192:207], a[160:163], v[48:51], v[224:239]
  v_exp_f32 v127, v127
  v_add_f32 v3, v3, v125
  v_cvt_pk_bf16_f32 v122, v124, v125
  v_mfma_f32_32x32x16_bf16 v[176:191], a[164:167], v[20:23], v[176:191]
  ds_read_b128 a[240:243], v11 offset:28672
  v_exp_f32 v128, v128
  v_add_f32 v2, v2, v126
  v_exp_f32 v129, v129
  v_mfma_f32_32x32x16_bf16 v[192:207], a[164:167], v[52:55], v[192:207]
  ds_read_b128 a[244:247], v11 offset:29696
  v_add_f32 v3, v3, v127
  v_cvt_pk_bf16_f32 v123, v126, v127
  v_exp_f32 v130, v130
  v_mfma_f32_32x32x16_bf16 v[176:191], a[168:171], v[24:27], v[176:191]
  v_add_f32 v4, v4, v128
  v_exp_f32 v131, v131
  v_add_f32 v5, v5, v129
  v_mfma_f32_32x32x16_bf16 v[192:207], a[168:171], v[56:59], v[192:207]
  ds_read_b128 a[248:251], v11 offset:30720
  v_cvt_pk_bf16_f32 v128, v128, v129
  v_exp_f32 v132, v132
  v_add_f32 v4, v4, v130
  v_mfma_f32_32x32x16_bf16 v[176:191], a[172:175], v[28:31], v[176:191]
  ds_read_b128 a[252:255], v11 offset:31744
  v_exp_f32 v133, v133
  v_add_f32 v5, v5, v131
  v_cvt_pk_bf16_f32 v129, v130, v131
  v_mfma_f32_32x32x16_bf16 v[192:207], a[172:175], v[60:63], v[192:207]
  v_exp_f32 v134, v134
  v_add_f32 v4, v4, v132
  v_exp_f32 v135, v135
  v_mfma_f32_32x32x16_bf16 v[176:191], a[176:179], v[32:35], v[176:191]
  v_add_f32 v5, v5, v133
  v_cvt_pk_bf16_f32 v130, v132, v133
  v_exp_f32 v136, v136
  v_add_f32 v4, v4, v134
  v_mfma_f32_32x32x16_bf16 v[192:207], a[176:179], v[64:67], v[192:207]
  v_exp_f32 v137, v137
  v_add_f32 v5, v5, v135
  v_cvt_pk_bf16_f32 v131, v134, v135
  v_mfma_f32_32x32x16_bf16 v[176:191], a[180:183], v[36:39], v[176:191]
  v_exp_f32 v138, v138
  v_add_f32 v4, v4, v136
  v_exp_f32 v139, v139
  v_mfma_f32_32x32x16_bf16 v[192:207], a[180:183], v[68:71], v[192:207]
  v_add_f32 v5, v5, v137
  v_cvt_pk_bf16_f32 v136, v136, v137
  v_exp_f32 v140, v140
  v_mfma_f32_32x32x16_bf16 v[176:191], a[184:187], v[40:43], v[176:191]
  v_add_f32 v4, v4, v138
  v_exp_f32 v141, v141
  v_add_f32 v5, v5, v139
  v_mfma_f32_32x32x16_bf16 v[192:207], a[184:187], v[72:75], v[192:207]
  v_cvt_pk_bf16_f32 v137, v138, v139
  v_exp_f32 v142, v142
  v_add_f32 v4, v4, v140
  v_mfma_f32_32x32x16_bf16 v[176:191], a[188:191], v[44:47], v[176:191]
  v_exp_f32 v143, v143
  v_add_f32 v5, v5, v141
  v_cvt_pk_bf16_f32 v138, v140, v141
  v_mfma_f32_32x32x16_bf16 v[192:207], a[188:191], v[76:79], v[192:207]
  v_add_f32 v4, v4, v142
  v_add_f32 v5, v5, v143
  v_cvt_pk_bf16_f32 v139, v142, v143
  s_waitcnt vmcnt(16) lgkmcnt(0)
  s_barrier
  v_mfma_f32_32x32x16_bf16 a[0:15], a[192:195], v[80:83], a[0:15]
  s_sub_u32 s80, s75, s76
  s_add_u32 s80, s80, 2
  v_mfma_f32_32x32x16_bf16 a[64:79], a[192:195], v[96:99], a[64:79]
  s_cmp_lt_u32 s80, 2
  s_cbranch_scc1 L_kb_kernel_d0_mask
L_kb_kernel_d0_mask_ret:
  ds_read_b128 a[128:131], v10 offset:16384
  v_mfma_f32_32x32x16_bf16 a[16:31], a[196:199], v[80:83], a[16:31]
  v_max3_f32 v6, v144, v145, v146
  v_max3_f32 v7, v160, v161, v162
  v_max3_f32 v6, v6, v147, v148
  v_max3_f32 v7, v7, v163, v164
  v_max3_f32 v6, v6, v149, v150
  v_max3_f32 v7, v7, v165, v166
  ds_read_b128 a[132:135], v10 offset:17408
  v_mfma_f32_32x32x16_bf16 a[80:95], a[196:199], v[96:99], a[80:95]
  v_max3_f32 v6, v6, v151, v152
  v_max3_f32 v7, v7, v167, v168
  v_max3_f32 v6, v6, v153, v154
  v_max3_f32 v7, v7, v169, v170
  v_max3_f32 v6, v6, v155, v156
  v_mfma_f32_32x32x16_bf16 a[32:47], a[200:203], v[80:83], a[32:47]
  v_max3_f32 v7, v7, v171, v172
  v_max3_f32 v6, v6, v157, v158
  v_max3_f32 v7, v7, v173, v174
  v_max3_f32 v6, v6, v159, v176
  v_max3_f32 v7, v7, v175, v192
  ds_read_b128 a[136:139], v10 offset:18432
  v_mfma_f32_32x32x16_bf16 a[96:111], a[200:203], v[96:99], a[96:111]
  v_max3_f32 v6, v6, v177, v178
  v_max3_f32 v7, v7, v193, v194
  v_max3_f32 v6, v6, v179, v180
  v_max3_f32 v7, v7, v195, v196
  v_max3_f32 v6, v6, v181, v182
  v_max3_f32 v7, v7, v197, v198
  v_mfma_f32_32x32x16_bf16 a[48:63], a[204:207], v[80:83], a[48:63]
  v_max3_f32 v6, v6, v183, v184
  v_max3_f32 v7, v7, v199, v200
  v_max3_f32 v6, v6, v185, v186
  v_max3_f32 v7, v7, v201, v202
  v_max3_f32 v6, v6, v187, v188
  ds_read_b128 a[140:143], v10 offset:19456
  v_mfma_f32_32x32x16_bf16 a[112:127], a[204:207], v[96:99], a[112:127]
  v_max3_f32 v7, v7, v203, v204
  v_max3_f32 v6, v6, v189, v190
  v_max3_f32 v7, v7, v205, v206
  v_max_f32 v6, v6, v191
  v_max_f32 v7, v7, v207
  v_max_f32 v240, v6, v7
  v_cmp_lt_f32 vcc, s79, v240
  v_mfma_f32_32x32x16_bf16 a[0:15], a[208:211], v[88:91], a[0:15]
  s_cbranch_vccnz L_kb_kernel_d0_rare
L_kb_kernel_d0_rare_ret:
  s_add_u32 s75, s75, 1
  ds_read_b128 a[144:147], v10 offset:20480
  s_add_u32 m0, s72, 0
  v_mfma_f32_32x32x16_bf16 a[64:79], a[208:211], v[104:107], a[64:79]
  v_exp_f32 v144, v144
  v_exp_f32 v145, v145
  v_exp_f32 v146, v146
  v_mfma_f32_32x32x16_bf16 a[16:31], a[212:215], v[88:91], a[16:31]
  ds_read_b128 a[148:151], v10 offset:21504
  buffer_load_dwordx4 v12, s[52:55], s71 offen offset:0 lds
  v_add_f32 v2, v2, v144
  v_exp_f32 v147, v147
  v_add_f32 v3, v3, v145
  v_mfma_f32_32x32x16_bf16 a[80:95], a[212:215], v[104:107], a[80:95]
  ds_read_b128 a[152:155], v10 offset:22528
  v_cvt_pk_bf16_f32 v144, v144, v145
  v_exp_f32 v148, v148
  v_mfma_f32_32x32x16_bf16 a[32:47], a[216:219], v[88:91], a[32:47]
  buffer_load_dwordx4 v12, s[52:55], s71 offen offset:1024 lds
  v_add_f32 v2, v2, v146
  v_exp_f32 v149, v149
  v_add_f32 v3, v3, v147
  v_mfma_f32_32x32x16_bf16 a[96:111], a[216:219], v[104:107], a[96:111]
  ds_read_b128 a[156:159], v10 offset:23552
  v_cvt_pk_bf16_f32 v145, v146, v147
  v_exp_f32 v150, v150
  v_add_f32 v2, v2, v148
  v_mfma_f32_32x32x16_bf16 a[48:63], a[220:223], v[88:91], a[48:63]
  buffer_load_dwordx4 v12, s[52:55], s71 offen offset:2048 lds
  v_exp_f32 v151, v151
  v_add_f32 v3, v3, v149
  v_mfma_f32_32x32x16_bf16 a[112:127], a[220:223], v[104:107], a[112:127]
  ds_read_b128 a[160:163], v10 offset:24576
  v_cvt_pk_bf16_f32 v146, v148, v149
  v_exp_f32 v152, v152
  v_add_f32 v2, v2, v150
  v_mfma_f32_32x32x16_bf16 a[0:15], a[224:227], v[112:115], a[0:15]
  buffer_load_dwordx4 v12, s[52:55], s71 offen offset:3072 lds
  v_exp_f32 v153, v153
  v_add_f32 v3, v3, v151
  v_mfma_f32_32x32x16_bf16 a[64:79], a[224:227], v[128:131], a[64:79]
  ds_read_b128 a[164:167], v10 offset:25600
  v_cvt_pk_bf16_f32 v147, v150, v151
  v_exp_f32 v154, v154
  v_add_f32 v2, v2, v152
  v_mfma_f32_32x32x16_bf16 a[16:31], a[228:231], v[112:115], a[16:31]
  s_add_u32 m0, s73, 16384
  v_exp_f32 v155, v155
  v_add_f32 v3, v3, v153
  v_cvt_pk_bf16_f32 v152, v152, v153
  v_mfma_f32_32x32x16_bf16 a[80:95], a[228:231], v[128:131], a[80:95]
  ds_read_b128 a[168:171], v10 offset:26624
  v_exp_f32 v156, v156
  v_add_f32 v2, v2, v154
  v_mfma_f32_32x32x16_bf16 a[32:47], a[232:235], v[112:115], a[32:47]
  ds_read_b128 a[172:175], v10 offset:27648
  v_exp_f32 v157, v157
  v_add_f32 v3, v3, v155
  v_cvt_pk_bf16_f32 v153, v154, v155
  v_mfma_f32_32x32x16_bf16 a[96:111], a[232:235], v[128:131], a[96:111]
  buffer_load_dwordx4 v12, s[56:59], s71 offen offset:0 lds
  v_exp_f32 v158, v158
  v_add_f32 v2, v2, v156
  v_mfma_f32_32x32x16_bf16 a[48:63], a[236:239], v[112:115], a[48:63]
  ds_read_b128 a[176:179], v10 offset:28672
  v_exp_f32 v159, v159
  v_add_f32 v3, v3, v157
  v_cvt_pk_bf16_f32 v154, v156, v157
  v_mfma_f32_32x32x16_bf16 a[112:127], a[236:239], v[128:131], a[112:127]
  buffer_load_dwordx4 v12, s[56:59], s71 offen offset:1024 lds
  v_exp_f32 v160, v160
  v_add_f32 v2, v2, v158
  v_exp_f32 v161, v161
  v_mfma_f32_32x32x16_bf16 a[0:15], a[240:243], v[120:123], a[0:15]
  ds_read_b128 a[180:183], v10 offset:29696
  v_add_f32 v3, v3, v159
  v_cvt_pk_bf16_f32 v155, v158, v159
  v_mfma_f32_32x32x16_bf16 a[64:79], a[240:243], v[136:139], a[64:79]
  buffer_load_dwordx4 v12, s[56:59], s71 offen offset:2048 lds
  v_exp_f32 v162, v162
  v_add_f32 v4, v4, v160
  v_exp_f32 v163, v163
  v_mfma_f32_32x32x16_bf16 a[16:31], a[244:247], v[120:123], a[16:31]
  ds_read_b128 a[184:187], v10 offset:30720
  v_add_f32 v5, v5, v161
  v_cvt_pk_bf16_f32 v160, v160, v161
  v_mfma_f32_32x32x16_bf16 a[80:95], a[244:247], v[136:139], a[80:95]
  buffer_load_dwordx4 v12, s[56:59], s71 offen offset:3072 lds
  v_exp_f32 v164, v164
  v_add_f32 v4, v4, v162
  v_exp_f32 v165, v165
  v_mfma_f32_32x32x16_bf16 a[32:47], a[248:251], v[120:123], a[32:47]
  ds_read_b128 a[188:191], v10 offset:31744
  v_add_f32 v5, v5, v163
  v_cvt_pk_bf16_f32 v161, v162, v163
  v_exp_f32 v166, v166
  v_mfma_f32_32x32x16_bf16 a[96:111], a[248:251], v[136:139], a[96:111]
  s_add_u32 s71, s71, 16384
  v_add_f32 v4, v4, v164
  v_exp_f32 v167, v167
  v_mfma_f32_32x32x16_bf16 a[48:63], a[252:255], v[120:123], a[48:63]
  v_add_f32 v5, v5, v165
  v_cvt_pk_bf16_f32 v162, v164, v165
  v_add_f32 v4, v4, v166
  v_mfma_f32_32x32x16_bf16 a[112:127], a[252:255], v[136:139], a[112:127]
  v_add_f32 v5, v5, v167
  v_cvt_pk_bf16_f32 v163, v166, v167
  s_cmp_lg_u32 s78, 0
  s_cbranch_scc1 L_kb_kernel_d0_resc
L_kb_kernel_d0_resc_ret:
  s_sub_u32 s74, s74, 1
  s_cmp_eq_u32 s74, 0
  s_cbranch_scc1 L_kb_kernel_mixed
  v_xor_b32 v11, 0x8000, v11
  s_waitcnt lgkmcnt(0)
  v_mfma_f32_32x32x16_bf16 v[80:95], a[128:131], v[16:19], v[208:223]
  ds_read_b128 a[192:195], v11 offset:0
  v_exp_f32 v168, v168
  v_exp_f32 v169, v169
  v_exp_f32 v170, v170
  v_add_f32 v4, v4, v168
  v_mfma_f32_32x32x16_bf16 v[96:111], a[128:131], v[48:51], v[224:239]
  ds_read_b128 a[196:199], v11 offset:1024
  v_exp_f32 v171, v171
  v_add_f32 v5, v5, v169
  v_cvt_pk_bf16_f32 v168, v168, v169
  v_mfma_f32_32x32x16_bf16 v[80:95], a[132:135], v[20:23], v[80:95]
  v_exp_f32 v172, v172
  v_add_f32 v4, v4, v170
  v_exp_f32 v173, v173
  v_mfma_f32_32x32x16_bf16 v[96:111], a[132:135], v[52:55], v[96:111]
  ds_read_b128 a[200:203], v11 offset:2048
  v_add_f32 v5, v5, v171
  v_cvt_pk_bf16_f32 v169, v170, v171
  v_exp_f32 v174, v174
  v_mfma_f32_32x32x16_bf16 v[80:95], a[136:139], v[24:27], v[80:95]
  ds_read_b128 a[204:207], v11 offset:3072
  v_add_f32 v4, v4, v172
  v_exp_f32 v175, v175
  v_add_f32 v5, v5, v173
  v_mfma_f32_32x32x16_bf16 v[96:111], a[136:139], v[56:59], v[96:111]
  v_cvt_pk_bf16_f32 v170, v172, v173
  v_exp_f32 v176, v176
  v_add_f32 v4, v4, v174
  v_mfma_f32_32x32x16_bf16 v[80:95], a[140:143], v[28:31], v[80:95]
  ds_read_b128 a[208:211], v11 offset:4096
  v_exp_f32 v177, v177
  v_add_f32 v5, v5, v175
  v_cvt_pk_bf16_f32 v171, v174, v175
  v_mfma_f32_32x32x16_bf16 v[96:111], a[140:143], v[60:63], v[96:111]
  ds_read_b128 a[212:215], v11 offset:5120
  v_exp_f32 v178, v178
  v_add_f32 v2, v2, v176
  v_exp_f32 v179, v179
  v_mfma_f32_32x32x16_bf16 v[80:95], a[144:147], v[32:35], v[80:95]
  v_add_f32 v3, v3, v177
  v_cvt_pk_bf16_f32 v176, v176, v177
  v_exp_f32 v180, v180
  v_add_f32 v2, v2, v178
  v_mfma_f32_32x32x16_bf16 v[96:111], a[144:147], v[64:67], v[96:111]
  ds_read_b128 a[216:219], v11 offset:6144
  v_exp_f32 v181, v181
  v_add_f32 v3, v3, v179
  v_cvt_pk_bf16_f32 v177, v178, v179
  v_mfma_f32_32x32x16_bf16 v[80:95], a[148:151], v[36:39], v[80:95]
  ds_read_b128 a[220:223], v11 offset:7168
  v_exp_f32 v182, v182
  v_add_f32 v2, v2, v180
  v_exp_f32 v183, v183
  v_mfma_f32_32x32x16_bf16 v[96:111], a[148:151], v[68:71], v[96:111]
  v_add_f32 v3, v3, v181
  v_cvt_pk_bf16_f32 v178, v180, v181
  v_exp_f32 v184, v184
  v_mfma_f32_32x32x16_bf16 v[80:95], a[152:155], v[40:43], v[80:95]
  ds_read_b128 a[224:227], v11 offset:8192
  v_add_f32 v2, v2, v182
  v_exp_f32 v185, v185
  v_add_f32 v3, v3, v183
  v_mfma_f32_32x32x16_bf16 v[96:111], a[152:155], v[72:75], v[96:111]
  ds_read_b128 a[228:231], v11 offset:9216
  v_cvt_pk_bf16_f32 v179, v182, v183
  v_exp_f32 v186, v186
  v_add_f32 v2, v2, v184
  v_mfma_f32_32x32x16_bf16 v[80:95], a[156:159], v[44:47], v[80:95]
  v_exp_f32 v187, v187
  v_add_f32 v3, v3, v185
  v_cvt_pk_bf16_f32 v184, v184, v185
  v_mfma_f32_32x32x16_bf16 v[96:111], a[156:159], v[76:79], v[96:111]
  ds_read_b128 a[232:235], v11 offset:10240
  v_exp_f32 v188, v188
  v_add_f32 v2, v2, v186
  v_exp_f32 v189, v189
  v_mfma_f32_32x32x16_bf16 v[112:127], a[160:163], v[16:19], v[208:223]
  ds_read_b128 a[236:239], v11 offset:11264
  v_add_f32 v3, v3, v187
  v_cvt_pk_bf16_f32 v185, v186, v187
  v_exp_f32 v190, v190
  v_add_f32 v2, v2, v188
  v_mfma_f32_32x32x16_bf16 v[128:143], a[160:163], v[48:51], v[224:239]
  v_exp_f32 v191, v191
  v_add_f32 v3, v3, v189
  v_cvt_pk_bf16_f32 v186, v188, v189
  v_mfma_f32_32x32x16_bf16 v[112:127], a[164:167], v[20:23], v[112:127]
  ds_read_b128 a[240:243], v11 offset:12288
  v_exp_f32 v192, v192
  v_add_f32 v2, v2, v190
  v_exp_f32 v193, v193
  v_mfma_f32_32x32x16_bf16 v[128:143], a[164:167], v[52:55], v[128:143]
  ds_read_b128 a[244:247], v11 offset:13312
  v_add_f32 v3, v3, v191
  v_cvt_pk_bf16_f32 v187, v190, v191
  v_exp_f32 v194, v194
  v_mfma_f32_32x32x16_bf16 v[112:127], a[168:171], v[24:27], v[112:127]
  v_add_f32 v4, v4, v192
  v_exp_f32 v195, v195
  v_add_f32 v5, v5, v193
  v_mfma_f32_32x32x16_bf16 v[128:143], a[168:171], v[56:59], v[128:143]
  ds_read_b128 a[248:251], v11 offset:14336
  v_cvt_pk_bf16_f32 v192, v192, v193
  v_exp_f32 v196, v196
  v_add_f32 v4, v4, v194
  v_mfma_f32_32x32x16_bf16 v[112:127], a[172:175], v[28:31], v[112:127]
  ds_read_b128 a[252:255], v11 offset:15360
  v_exp_f32 v197, v197
  v_add_f32 v5, v5, v195
  v_cvt_pk_bf16_f32 v193, v194, v195
  v_mfma_f32_32x32x16_bf16 v[128:143], a[172:175], v[60:63], v[128:143]
  v_exp_f32 v198, v198
  v_add_f32 v4, v4, v196
  v_exp_f32 v199, v199
  v_mfma_f32_32x32x16_bf16 v[112:127], a[176:179], v[32:35], v[112:127]
  v_add_f32 v5, v5, v197
  v_cvt_pk_bf16_f32 v194, v196, v197
  v_exp_f32 v200, v200
  v_add_f32 v4, v4, v198
  v_mfma_f32_32x32x16_bf16 v[128:143], a[176:179], v[64:67], v[128:143]
  v_exp_f32 v201, v201
  v_add_f32 v5, v5, v199
  v_cvt_pk_bf16_f32 v195, v198, v199
  v_mfma_f32_32x32x16_bf16 v[112:127], a[180:183], v[36:39], v[112:127]
  v_exp_f32 v202, v202
  v_add_f32 v4, v4, v200
  v_exp_f32 v203, v203
  v_mfma_f32_32x32x16_bf16 v[128:143], a[180:183], v[68:71], v[128:143]
  v_add_f32 v5, v5, v201
  v_cvt_pk_bf16_f32 v200, v200, v201
  v_exp_f32 v204, v204
  v_mfma_f32_32x32x16_bf16 v[112:127], a[184:187], v[40:43], v[112:127]
  v_add_f32 v4, v4, v202
  v_exp_f32 v205, v205
  v_add_f32 v5, v5, v203
  v_mfma_f32_32x32x16_bf16 v[128:143], a[184:187], v[72:75], v[128:143]
  v_cvt_pk_bf16_f32 v201, v202, v203
  v_exp_f32 v206, v206
  v_add_f32 v4, v4, v204
  v_mfma_f32_32x32x16_bf16 v[112:127], a[188:191], v[44:47], v[112:127]
  v_exp_f32 v207, v207
  v_add_f32 v5, v5, v205
  v_cvt_pk_bf16_f32 v202, v204, v205
  v_mfma_f32_32x32x16_bf16 v[128:143], a[188:191], v[76:79], v[128:143]
  v_add_f32 v4, v4, v206
  v_add_f32 v5, v5, v207
  v_cvt_pk_bf16_f32 v203, v206, v207
  s_waitcnt vmcnt(16) lgkmcnt(0)
  s_barrier
  v_mfma_f32_32x32x16_bf16 a[0:15], a[192:195], v[144:147], a[0:15]
  v_xor_b32 v10, 0x8000, v10
  s_xor_b32 s73, s73, 0x8000
  s_sub_u32 s80, s75, s76
  s_add_u32 s80, s80, 2
  v_mfma_f32_32x32x16_bf16 a[64:79], a[192:195], v[160:163], a[64:79]
  s_cmp_lt_u32 s80, 2
  s_cbranch_scc1 L_kb_kernel_d1_mask
L_kb_kernel_d1_mask_ret:
  ds_read_b128 a[128:131], v10 offset:0
  v_mfma_f32_32x32x16_bf16 a[16:31], a[196:199], v[144:147], a[16:31]
  v_max3_f32 v6, v80, v81, v82
  v_max3_f32 v7, v96, v97, v98
  v_max3_f32 v6, v6, v83, v84
  v_max3_f32 v7, v7, v99, v100
  v_max3_f32 v6, v6, v85, v86
  v_max3_f32 v7, v7, v101, v102
  ds_read_b128 a[132:135], v10 offset:1024
  v_mfma_f32_32x32x16_bf16 a[80:95], a[196:199], v[160:163], a[80:95]
  v_max3_f32 v6, v6, v87, v88
  v_max3_f32 v7, v7, v103, v104
  v_max3_f32 v6, v6, v89, v90
  v_max3_f32 v7, v7, v105, v106
  v_max3_f32 v6, v6, v91, v92
  v_mfma_f32_32x32x16_bf16 a[32:47], a[200:203], v[144:147], a[32:47]
  v_max3_f32 v7, v7, v107, v108
  v_max3_f32 v6, v6, v93, v94
  v_max3_f32 v7, v7, v109, v110
  v_max3_f32 v6, v6, v95, v112
  v_max3_f32 v7, v7, v111, v128
  ds_read_b128 a[136:139], v10 offset:2048
  v_mfma_f32_32x32x16_bf16 a[96:111], a[200:203], v[160:163], a[96:111]
  v_max3_f32 v6, v6, v113, v114
  v_max3_f32 v7, v7, v129, v130
  v_max3_f32 v6, v6, v115, v116
  v_max3_f32 v7, v7, v131, v132
  v_max3_f32 v6, v6, v117, v118
  v_max3_f32 v7, v7, v133, v134
  v_mfma_f32_32x32x16_bf16 a[48:63], a[204:207], v[144:147], a[48:63]
  v_max3_f32 v6, v6, v119, v120
  v_max3_f32 v7, v7, v135, v136
  v_max3_f32 v6, v6, v121, v122
  v_max3_f32 v7, v7, v137, v138
  v_max3_f32 v6, v6, v123, v124
  ds_read_b128 a[140:143], v10 offset:3072
  v_mfma_f32_32x32x16_bf16 a[112:127], a[204:207], v[160:163], a[112:127]
  v_max3_f32 v7, v7, v139, v140
  v_max3_f32 v6, v6, v125, v126
  v_max3_f32 v7, v7, v141, v142
  v_max_f32 v6, v6, v127
  v_max_f32 v7, v7, v143
  v_max_f32 v240, v6, v7
  v_cmp_lt_f32 vcc, s79, v240
  v_mfma_f32_32x32x16_bf16 a[0:15], a[208:211], v[152:155], a[0:15]
  s_cbranch_vccnz L_kb_kernel_d1_rare
L_kb_kernel_d1_rare_ret:
  s_add_u32 s75, s75, 1
  ds_read_b128 a[144:147], v10 offset:4096
  s_add_u32 m0, s72, 16384
  v_mfma_f32_32x32x16_bf16 a[64:79], a[208:211], v[168:171], a[64:79]
  v_exp_f32 v80, v80
  v_exp_f32 v81, v81
  v_exp_f32 v82, v82
  v_mfma_f32_32x32x16_bf16 a[16:31], a[212:215], v[152:155], a[16:31]
  ds_read_b128 a[148:151], v10 offset:5120
  buffer_load_dwordx4 v12, s[52:55], s71 offen offset:0 lds
  v_add_f32 v2, v2, v80
  v_exp_f32 v83, v83
  v_add_f32 v3, v3, v81
  v_mfma_f32_32x32x16_bf16 a[80:95], a[212:215], v[168:171], a[80:95]
  ds_read_b128 a[152:155], v10 offset:6144
  v_cvt_pk_bf16_f32 v80, v80, v81
  v_exp_f32 v84, v84
  v_mfma_f32_32x32x16_bf16 a[32:47], a[216:219], v[152:155], a[32:47]
  buffer_load_dwordx4 v12, s[52:55], s71 offen offset:1024 lds
  v_add_f32 v2, v2, v82
  v_exp_f32 v85, v85
  v_add_f32 v3, v3, v83
  v_mfma_f32_32x32x16_bf16 a[96:111], a[216:219], v[168:171], a[96:111]
  ds_read_b128 a[156:159], v10 offset:7168
  v_cvt_pk_bf16_f32 v81, v82, v83
  v_exp_f32 v86, v86
  v_add_f32 v2, v2, v84
  v_mfma_f32_32x32x16_bf16 a[48:63], a[220:223], v[152:155], a[48:63]
  buffer_load_dwordx4 v12, s[52:55], s71 offen offset:2048 lds
  v_exp_f32 v87, v87
  v_add_f32 v3, v3, v85
  v_mfma_f32_32x32x16_bf16 a[112:127], a[220:223], v[168:171], a[112:127]
  ds_read_b128 a[160:163], v10 offset:8192
  v_cvt_pk_bf16_f32 v82, v84, v85
  v_exp_f32 v88, v88
  v_add_f32 v2, v2, v86
  v_mfma_f32_32x32x16_bf16 a[0:15], a[224:227], v[176:179], a[0:15]
  buffer_load_dwordx4 v12, s[52:55], s71 offen offset:3072 lds
  v_exp_f32 v89, v89
  v_add_f32 v3, v3, v87
  v_mfma_f32_32x32x16_bf16 a[64:79], a[224:227], v[192:195], a[64:79]
  ds_read_b128 a[164:167], v10 offset:9216
  v_cvt_pk_bf16_f32 v83, v86, v87
  v_exp_f32 v90, v90
  v_add_f32 v2, v2, v88
  v_mfma_f32_32x32x16_bf16 a[16:31], a[228:231], v[176:179], a[16:31]
  s_add_u32 m0, s73, 0
  v_exp_f32 v91, v91
  v_add_f32 v3, v3, v89
  v_cvt_pk_bf16_f32 v88, v88, v89
  v_mfma_f32_32x32x16_bf16 a[80:95], a[228:231], v[192:195], a[80:95]
  ds_read_b128 a[168:171], v10 offset:10240
  v_exp_f32 v92, v92
  v_add_f32 v2, v2, v90
  v_mfma_f32_32x32x16_bf16 a[32:47], a[232:235], v[176:179], a[32:47]
  ds_read_b128 a[172:175], v10 offset:11264
  v_exp_f32 v93, v93
  v_add_f32 v3, v3, v91
  v_cvt_pk_bf16_f32 v89, v90, v91
  v_mfma_f32_32x32x16_bf16 a[96:111], a[232:235], v[192:195], a[96:111]
  buffer_load_dwordx4 v12, s[56:59], s71 offen offset:0 lds
  v_exp_f32 v94, v94
  v_add_f32 v2, v2, v92
  v_mfma_f32_32x32x16_bf16 a[48:63], a[236:239], v[176:179], a[48:63]
  ds_read_b128 a[176:179], v10 offset:12288
  v_exp_f32 v95, v95
  v_add_f32 v3, v3, v93
  v_cvt_pk_bf16_f32 v90, v92, v93
  v_mfma_f32_32x32x16_bf16 a[112:127], a[236:239], v[192:195], a[112:127]
  buffer_load_dwordx4 v12, s[56:59], s71 offen offset:1024 lds
  v_exp_f32 v96, v96
  v_add_f32 v2, v2, v94
  v_exp_f32 v97, v97
  v_mfma_f32_32x32x16_bf16 a[0:15], a[240:243], v[184:187], a[0:15]
  ds_read_b128 a[180:183], v10 offset:13312
  v_add_f32 v3, v3, v95
  v_cvt_pk_bf16_f32 v91, v94, v95
  v_mfma_f32_32x32x16_bf16 a[64:79], a[240:243], v[200:203], a[64:79]
  buffer_load_dwordx4 v12, s[56:59], s71 offen offset:2048 lds
  v_exp_f32 v98, v98
  v_add_f32 v4, v4, v96
  v_exp_f32 v99, v99
  v_mfma_f32_32x32x16_bf16 a[16:31], a[244:247], v[184:187], a[16:31]
  ds_read_b128 a[184:187], v10 offset:14336
  v_add_f32 v5, v5, v97
  v_cvt_pk_bf16_f32 v96, v96, v97
  v_mfma_f32_32x32x16_bf16 a[80:95], a[244:247], v[200:203], a[80:95]
  buffer_load_dwordx4 v12, s[56:59], s71 offen offset:3072 lds
  v_exp_f32 v100, v100
  v_add_f32 v4, v4, v98
  v_exp_f32 v101, v101
  v_mfma_f32_32x32x16_bf16 a[32:47], a[248:251], v[184:187], a[32:47]
  ds_read_b128 a[188:191], v10 offset:15360
  v_add_f32 v5, v5, v99
  v_cvt_pk_bf16_f32 v97, v98, v99
  v_exp_f32 v102, v102
  v_mfma_f32_32x32x16_bf16 a[96:111], a[248:251], v[200:203], a[96:111]
  s_add_u32 s71, s71, 16384
  s_xor_b32 s72, s72, 0x8000
  v_add_f32 v4, v4, v100
  v_exp_f32 v103, v103
  v_mfma_f32_32x32x16_bf16 a[48:63], a[252:255], v[184:187], a[48:63]
  v_add_f32 v5, v5, v101
  v_cvt_pk_bf16_f32 v98, v100, v101
  v_add_f32 v4, v4, v102
  v_mfma_f32_32x32x16_bf16 a[112:127], a[252:255], v[200:203], a[112:127]
  v_add_f32 v5, v5, v103
  v_cvt_pk_bf16_f32 v99, v102, v103
  s_cmp_lg_u32 s78, 0
  s_cbranch_scc1 L_kb_kernel_d1_resc
L_kb_kernel_d1_resc_ret:
  s_sub_u32 s74, s74, 1
  s_branch L_kb_kernel_dual
L_kb_kernel_mixed:
  v_xor_b32 v11, 0x8000, v11
  s_waitcnt lgkmcnt(0)
  v_mfma_f32_32x32x16_bf16 v[80:95], a[128:131], v[16:19], v[208:223]
  ds_read_b128 a[192:195], v11 offset:0
  ds_read_b128 a[196:199], v11 offset:1024
  v_exp_f32 v168, v168
  v_exp_f32 v169, v169
  v_exp_f32 v170, v170
  v_add_f32 v4, v4, v168
  v_exp_f32 v171, v171
  v_add_f32 v5, v5, v169
  v_cvt_pk_bf16_f32 v168, v168, v169
  v_mfma_f32_32x32x16_bf16 v[80:95], a[132:135], v[20:23], v[80:95]
  ds_read_b128 a[200:203], v11 offset:2048
  v_exp_f32 v172, v172
  v_add_f32 v4, v4, v170
  v_exp_f32 v173, v173
  v_add_f32 v5, v5, v171
  v_cvt_pk_bf16_f32 v169, v170, v171
  v_exp_f32 v174, v174
  v_mfma_f32_32x32x16_bf16 v[80:95], a[136:139], v[24:27], v[80:95]
  ds_read_b128 a[204:207], v11 offset:3072
  v_add_f32 v4, v4, v172
  v_exp_f32 v175, v175
  v_add_f32 v5, v5, v173
  v_cvt_pk_bf16_f32 v170, v172, v173
  v_exp_f32 v176, v176
  v_add_f32 v4, v4, v174
  v_mfma_f32_32x32x16_bf16 v[80:95], a[140:143], v[28:31], v[80:95]
  ds_read_b128 a[208:211], v11 offset:4096
  ds_read_b128 a[212:215], v11 offset:5120
  v_exp_f32 v177, v177
  v_add_f32 v5, v5, v175
  v_cvt_pk_bf16_f32 v171, v174, v175
  v_exp_f32 v178, v178
  v_add_f32 v2, v2, v176
  v_exp_f32 v179, v179
  v_mfma_f32_32x32x16_bf16 v[80:95], a[144:147], v[32:35], v[80:95]
  ds_read_b128 a[216:219], v11 offset:6144
  v_add_f32 v3, v3, v177
  v_cvt_pk_bf16_f32 v176, v176, v177
  v_exp_f32 v180, v180
  v_add_f32 v2, v2, v178
  v_exp_f32 v181, v181
  v_add_f32 v3, v3, v179
  v_cvt_pk_bf16_f32 v177, v178, v179
  v_mfma_f32_32x32x16_bf16 v[80:95], a[148:151], v[36:39], v[80:95]
  ds_read_b128 a[220:223], v11 offset:7168
  v_exp_f32 v182, v182
  v_add_f32 v2, v2, v180
  v_exp_f32 v183, v183
  v_add_f32 v3, v3, v181
  v_cvt_pk_bf16_f32 v178, v180, v181
  v_exp_f32 v184, v184
  v_mfma_f32_32x32x16_bf16 v[80:95], a[152:155], v[40:43], v[80:95]
  ds_read_b128 a[224:227], v11 offset:8192
  ds_read_b128 a[228:231], v11 offset:9216
  v_add_f32 v2, v2, v182
  v_exp_f32 v185, v185
  v_add_f32 v3, v3, v183
  v_cvt_pk_bf16_f32 v179, v182, v183
  v_exp_f32 v186, v186
  v_add_f32 v2, v2, v184
  v_mfma_f32_32x32x16_bf16 v[80:95], a[156:159], v[44:47], v[80:95]
  ds_read_b128 a[232:235], v11 offset:10240
  v_exp_f32 v187, v187
  v_add_f32 v3, v3, v185
  v_cvt_pk_bf16_f32 v184, v184, v185
  v_exp_f32 v188, v188
  v_add_f32 v2, v2, v186
  v_exp_f32 v189, v189
  v_mfma_f32_32x32x16_bf16 v[112:127], a[160:163], v[16:19], v[208:223]
  ds_read_b128 a[236:239], v11 offset:11264
  v_add_f32 v3, v3, v187
  v_cvt_pk_bf16_f32 v185, v186, v187
  v_exp_f32 v190, v190
  v_add_f32 v2, v2, v188
  v_exp_f32 v191, v191
  v_add_f32 v3, v3, v189
  v_cvt_pk_bf16_f32 v186, v188, v189
  v_mfma_f32_32x32x16_bf16 v[112:127], a[164:167], v[20:23], v[112:127]
  ds_read_b128 a[240:243], v11 offset:12288
  ds_read_b128 a[244:247], v11 offset:13312
  v_exp_f32 v192, v192
  v_add_f32 v2, v2, v190
  v_exp_f32 v193, v193
  v_add_f32 v3, v3, v191
  v_cvt_pk_bf16_f32 v187, v190, v191
  v_exp_f32 v194, v194
  v_mfma_f32_32x32x16_bf16 v[112:127], a[168:171], v[24:27], v[112:127]
  ds_read_b128 a[248:251], v11 offset:14336
  v_add_f32 v4, v4, v192
  v_exp_f32 v195, v195
  v_add_f32 v5, v5, v193
  v_cvt_pk_bf16_f32 v192, v192, v193
  v_exp_f32 v196, v196
  v_add_f32 v4, v4, v194
  v_mfma_f32_32x32x16_bf16 v[112:127], a[172:175], v[28:31], v[112:127]
  ds_read_b128 a[252:255], v11 offset:15360
  v_exp_f32 v197, v197
  v_add_f32 v5, v5, v195
  v_cvt_pk_bf16_f32 v193, v194, v195
  v_exp_f32 v198, v198
  v_add_f32 v4, v4, v196
  v_exp_f32 v199, v199
  v_mfma_f32_32x32x16_bf16 v[112:127], a[176:179], v[32:35], v[112:127]
  v_add_f32 v5, v5, v197
  v_cvt_pk_bf16_f32 v194, v196, v197
  v_exp_f32 v200, v200
  v_add_f32 v4, v4, v198
  v_exp_f32 v201, v201
  v_add_f32 v5, v5, v199
  v_cvt_pk_bf16_f32 v195, v198, v199
  v_mfma_f32_32x32x16_bf16 v[112:127], a[180:183], v[36:39], v[112:127]
  v_exp_f32 v202, v202
  v_add_f32 v4, v4, v200
  v_exp_f32 v203, v203
  v_add_f32 v5, v5, v201
  v_cvt_pk_bf16_f32 v200, v200, v201
  v_exp_f32 v204, v204
  v_mfma_f32_32x32x16_bf16 v[112:127], a[184:187], v[40:43], v[112:127]
  v_add_f32 v4, v4, v202
  v_exp_f32 v205, v205
  v_add_f32 v5, v5, v203
  v_cvt_pk_bf16_f32 v201, v202, v203
  v_exp_f32 v206, v206
  v_add_f32 v4, v4, v204
  v_mfma_f32_32x32x16_bf16 v[112:127], a[188:191], v[44:47], v[112:127]
  v_exp_f32 v207, v207
  v_add_f32 v5, v5, v205
  v_cvt_pk_bf16_f32 v202, v204, v205
  v_add_f32 v4, v4, v206
  v_add_f32 v5, v5, v207
  v_cvt_pk_bf16_f32 v203, v206, v207
  s_waitcnt vmcnt(16) lgkmcnt(0)
  s_barrier
  v_mfma_f32_32x32x16_bf16 a[0:15], a[192:195], v[144:147], a[0:15]
  v_xor_b32 v10, 0x8000, v10
  s_xor_b32 s73, s73, 0x8000
  s_sub_u32 s80, s75, s77
  s_add_u32 s80, s80, 2
  v_mfma_f32_32x32x16_bf16 a[64:79], a[192:195], v[160:163], a[64:79]
  s_cmp_lt_u32 s80, 2
  s_cbranch_scc1 L_kb_kernel_mx_mask
L_kb_kernel_mx_mask_ret:
  ds_read_b128 a[128:131], v10 offset:0
  v_mfma_f32_32x32x16_bf16 a[16:31], a[196:199], v[144:147], a[16:31]
  v_max3_f32 v6, v80, v81, v82
  v_max3_f32 v6, v6, v83, v84
  v_max3_f32 v6, v6, v85, v86
  v_max3_f32 v6, v6, v87, v88
  ds_read_b128 a[132:135], v10 offset:1024
  v_mfma_f32_32x32x16_bf16 a[80:95], a[196:199], v[160:163], a[80:95]
  v_max3_f32 v6, v6, v89, v90
  v_max3_f32 v6, v6, v91, v92
  v_max3_f32 v6, v6, v93, v94
  v_max3_f32 v6, v6, v95, v112
  v_mfma_f32_32x32x16_bf16 a[32:47], a[200:203], v[144:147], a[32:47]
  v_max3_f32 v6, v6, v113, v114
  v_max3_f32 v6, v6, v115, v116
  v_max3_f32 v6, v6, v117, v118
  v_max3_f32 v6, v6, v119, v120
  ds_read_b128 a[136:139], v10 offset:2048
  v_mfma_f32_32x32x16_bf16 a[96:111], a[200:203], v[160:163], a[96:111]
  v_max3_f32 v6, v6, v121, v122
  v_max3_f32 v6, v6, v123, v124
  v_max3_f32 v6, v6, v125, v126
  v_max_f32 v6, v6, v127
  v_cmp_lt_f32 vcc, s79, v6
  v_mfma_f32_32x32x16_bf16 a[48:63], a[204:207], v[144:147], a[48:63]
  s_cbranch_vccnz L_kb_kernel_mx_rare
L_kb_kernel_mx_rare_ret:
  s_add_u32 s75, s75, 1
  ds_read_b128 a[140:143], v10 offset:3072
  s_add_u32 m0, s72, 16384
  v_mfma_f32_32x32x16_bf16 a[112:127], a[204:207], v[160:163], a[112:127]
  v_exp_f32 v80, v80
  v_exp_f32 v81, v81
  v_mfma_f32_32x32x16_bf16 a[0:15], a[208:211], v[152:155], a[0:15]
  ds_read_b128 a[144:147], v10 offset:4096
  buffer_load_dwordx4 v12, s[52:55], s71 offen offset:0 lds
  v_exp_f32 v82, v82
  v_mfma_f32_32x32x16_bf16 a[64:79], a[208:211], v[168:171], a[64:79]
  v_add_f32 v2, v2, v80
  v_mfma_f32_32x32x16_bf16 a[16:31], a[212:215], v[152:155], a[16:31]
  ds_read_b128 a[148:151], v10 offset:5120
  buffer_load_dwordx4 v12, s[52:55], s71 offen offset:1024 lds
  v_exp_f32 v83, v83
  v_mfma_f32_32x32x16_bf16 a[80:95], a[212:215], v[168:171], a[80:95]
  ds_read_b128 a[152:155], v10 offset:6144
  v_add_f32 v3, v3, v81
  v_mfma_f32_32x32x16_bf16 a[32:47], a[216:219], v[152:155], a[32:47]
  v_cvt_pk_bf16_f32 v80, v80, v81
  v_exp_f32 v84, v84
  v_mfma_f32_32x32x16_bf16 a[96:111], a[216:219], v[168:171], a[96:111]
  ds_read_b128 a[156:159], v10 offset:7168
  buffer_load_dwordx4 v12, s[52:55], s71 offen offset:2048 lds
  v_add_f32 v2, v2, v82
  v_mfma_f32_32x32x16_bf16 a[48:63], a[220:223], v[152:155], a[48:63]
  v_exp_f32 v85, v85
  v_mfma_f32_32x32x16_bf16 a[112:127], a[220:223], v[168:171], a[112:127]
  ds_read_b128 a[160:163], v10 offset:8192
  buffer_load_dwordx4 v12, s[52:55], s71 offen offset:3072 lds
  v_add_f32 v3, v3, v83
  v_mfma_f32_32x32x16_bf16 a[0:15], a[224:227], v[176:179], a[0:15]
  v_cvt_pk_bf16_f32 v81, v82, v83
  v_mfma_f32_32x32x16_bf16 a[64:79], a[224:227], v[192:195], a[64:79]
  ds_read_b128 a[164:167], v10 offset:9216
  s_add_u32 m0, s73, 0
  v_exp_f32 v86, v86
  v_add_f32 v2, v2, v84
  v_mfma_f32_32x32x16_bf16 a[16:31], a[228:231], v[176:179], a[16:31]
  v_exp_f32 v87, v87
  v_mfma_f32_32x32x16_bf16 a[80:95], a[228:231], v[192:195], a[80:95]
  ds_read_b128 a[168:171], v10 offset:10240
  v_add_f32 v3, v3, v85
  v_mfma_f32_32x32x16_bf16 a[32:47], a[232:235], v[176:179], a[32:47]
  ds_read_b128 a[172:175], v10 offset:11264
  buffer_load_dwordx4 v12, s[56:59], s71 offen offset:0 lds
  v_cvt_pk_bf16_f32 v82, v84, v85
  v_mfma_f32_32x32x16_bf16 a[96:111], a[232:235], v[192:195], a[96:111]
  v_exp_f32 v88, v88
  v_mfma_f32_32x32x16_bf16 a[48:63], a[236:239], v[176:179], a[48:63]
  ds_read_b128 a[176:179], v10 offset:12288
  buffer_load_dwordx4 v12, s[56:59], s71 offen offset:1024 lds
  v_add_f32 v2, v2, v86
  v_exp_f32 v89, v89
  v_mfma_f32_32x32x16_bf16 a[112:127], a[236:239], v[192:195], a[112:127]
  v_add_f32 v3, v3, v87
  v_mfma_f32_32x32x16_bf16 a[0:15], a[240:243], v[184:187], a[0:15]
  ds_read_b128 a[180:183], v10 offset:13312
  buffer_load_dwordx4 v12, s[56:59], s71 offen offset:2048 lds
  v_cvt_pk_bf16_f32 v83, v86, v87
  v_mfma_f32_32x32x16_bf16 a[64:79], a[240:243], v[200:203], a[64:79]
  v_exp_f32 v90, v90
  v_mfma_f32_32x32x16_bf16 a[16:31], a[244:247], v[184:187], a[16:31]
  ds_read_b128 a[184:187], v10 offset:14336
  v_add_f32 v2, v2, v88
  v_mfma_f32_32x32x16_bf16 a[80:95], a[244:247], v[200:203], a[80:95]
  buffer_load_dwordx4 v12, s[56:59], s71 offen offset:3072 lds
  v_exp_f32 v91, v91
  v_add_f32 v3, v3, v89
  v_mfma_f32_32x32x16_bf16 a[32:47], a[248:251], v[184:187], a[32:47]
  ds_read_b128 a[188:191], v10 offset:15360
  v_cvt_pk_bf16_f32 v88, v88, v89
  v_mfma_f32_32x32x16_bf16 a[96:111], a[248:251], v[200:203], a[96:111]
  s_add_u32 s71, s71, 16384
  s_xor_b32 s72, s72, 0x8000
  v_add_f32 v2, v2, v90
  v_mfma_f32_32x32x16_bf16 a[48:63], a[252:255], v[184:187], a[48:63]
  v_add_f32 v3, v3, v91
  v_mfma_f32_32x32x16_bf16 a[112:127], a[252:255], v[200:203], a[112:127]
  v_cvt_pk_bf16_f32 v89, v90, v91
  s_cmp_lg_u32 s78, 0
  s_cbranch_scc1 L_kb_kernel_mx_resc
L_kb_kernel_mx_resc_ret:
  v_add_f32 v4, v4, v5
  v_mov_b32 v5, v4
s_nop 1
  v_permlane32_swap_b32 v4, v5
  v_add_f32 v4, v4, v5
  v_rcp_f32 v4, v4
  s_nop 7
  v_accvgpr_read_b32 v240, a64
  v_accvgpr_read_b32 v241, a65
  v_accvgpr_read_b32 v242, a66
  v_accvgpr_read_b32 v243, a67
  v_accvgpr_read_b32 v244, a68
  v_accvgpr_read_b32 v245, a69
  v_accvgpr_read_b32 v246, a70
  v_accvgpr_read_b32 v247, a71
  v_mul_f32 v240, v240, v4
  v_mul_f32 v241, v241, v4
  v_mul_f32 v242, v242, v4
  v_mul_f32 v243, v243, v4
  v_mul_f32 v244, v244, v4
  v_mul_f32 v245, v245, v4
  v_mul_f32 v246, v246, v4
  v_mul_f32 v247, v247, v4
  v_cvt_pk_bf16_f32 v248, v240, v241
  v_cvt_pk_bf16_f32 v249, v242, v243
  v_cvt_pk_bf16_f32 v250, v244, v245
  v_cvt_pk_bf16_f32 v251, v246, v247
  buffer_store_dwordx4 v[248:251], v15, s[60:63], s101 offen offset:0 sc1
  v_accvgpr_read_b32 v240, a72
  v_accvgpr_read_b32 v241, a73
  v_accvgpr_read_b32 v242, a74
  v_accvgpr_read_b32 v243, a75
  v_accvgpr_read_b32 v244, a76
  v_accvgpr_read_b32 v245, a77
  v_accvgpr_read_b32 v246, a78
  v_accvgpr_read_b32 v247, a79
  v_mul_f32 v240, v240, v4
  v_mul_f32 v241, v241, v4
  v_mul_f32 v242, v242, v4
  v_mul_f32 v243, v243, v4
  v_mul_f32 v244, v244, v4
  v_mul_f32 v245, v245, v4
  v_mul_f32 v246, v246, v4
  v_mul_f32 v247, v247, v4
  v_cvt_pk_bf16_f32 v252, v240, v241
  v_cvt_pk_bf16_f32 v253, v242, v243
  v_cvt_pk_bf16_f32 v254, v244, v245
  v_cvt_pk_bf16_f32 v255, v246, v247
  buffer_store_dwordx4 v[252:255], v15, s[60:63], s101 offen offset:512 sc1
  v_accvgpr_read_b32 v240, a80
  v_accvgpr_read_b32 v241, a81
  v_accvgpr_read_b32 v242, a82
  v_accvgpr_read_b32 v243, a83
  v_accvgpr_read_b32 v244, a84
  v_accvgpr_read_b32 v245, a85
  v_accvgpr_read_b32 v246, a86
  v_accvgpr_read_b32 v247, a87
  v_mul_f32 v240, v240, v4
  v_mul_f32 v241, v241, v4
  v_mul_f32 v242, v242, v4
  v_mul_f32 v243, v243, v4
  v_mul_f32 v244, v244, v4
  v_mul_f32 v245, v245, v4
  v_mul_f32 v246, v246, v4
  v_mul_f32 v247, v247, v4
  v_cvt_pk_bf16_f32 v248, v240, v241
  v_cvt_pk_bf16_f32 v249, v242, v243
  v_cvt_pk_bf16_f32 v250, v244, v245
  v_cvt_pk_bf16_f32 v251, v246, v247
  buffer_store_dwordx4 v[248:251], v15, s[60:63], s101 offen offset:1024 sc1
  v_accvgpr_read_b32 v240, a88
  v_accvgpr_read_b32 v241, a89
  v_accvgpr_read_b32 v242, a90
  v_accvgpr_read_b32 v243, a91
  v_accvgpr_read_b32 v244, a92
  v_accvgpr_read_b32 v245, a93
  v_accvgpr_read_b32 v246, a94
  v_accvgpr_read_b32 v247, a95
  v_mul_f32 v240, v240, v4
  v_mul_f32 v241, v241, v4
  v_mul_f32 v242, v242, v4
  v_mul_f32 v243, v243, v4
  v_mul_f32 v244, v244, v4
  v_mul_f32 v245, v245, v4
  v_mul_f32 v246, v246, v4
  v_mul_f32 v247, v247, v4
  v_cvt_pk_bf16_f32 v252, v240, v241
  v_cvt_pk_bf16_f32 v253, v242, v243
  v_cvt_pk_bf16_f32 v254, v244, v245
  v_cvt_pk_bf16_f32 v255, v246, v247
  buffer_store_dwordx4 v[252:255], v15, s[60:63], s101 offen offset:1536 sc1
  v_accvgpr_read_b32 v240, a96
  v_accvgpr_read_b32 v241, a97
  v_accvgpr_read_b32 v242, a98
  v_accvgpr_read_b32 v243, a99
  v_accvgpr_read_b32 v244, a100
  v_accvgpr_read_b32 v245, a101
  v_accvgpr_read_b32 v246, a102
  v_accvgpr_read_b32 v247, a103
  v_mul_f32 v240, v240, v4
  v_mul_f32 v241, v241, v4
  v_mul_f32 v242, v242, v4
  v_mul_f32 v243, v243, v4
  v_mul_f32 v244, v244, v4
  v_mul_f32 v245, v245, v4
  v_mul_f32 v246, v246, v4
  v_mul_f32 v247, v247, v4
  v_cvt_pk_bf16_f32 v248, v240, v241
  v_cvt_pk_bf16_f32 v249, v242, v243
  v_cvt_pk_bf16_f32 v250, v244, v245
  v_cvt_pk_bf16_f32 v251, v246, v247
  buffer_store_dwordx4 v[248:251], v15, s[60:63], s101 offen offset:2048 sc1
  v_accvgpr_read_b32 v240, a104
  v_accvgpr_read_b32 v241, a105
  v_accvgpr_read_b32 v242, a106
  v_accvgpr_read_b32 v243, a107
  v_accvgpr_read_b32 v244, a108
  v_accvgpr_read_b32 v245, a109
  v_accvgpr_read_b32 v246, a110
  v_accvgpr_read_b32 v247, a111
  v_mul_f32 v240, v240, v4
  v_mul_f32 v241, v241, v4
  v_mul_f32 v242, v242, v4
  v_mul_f32 v243, v243, v4
  v_mul_f32 v244, v244, v4
  v_mul_f32 v245, v245, v4
  v_mul_f32 v246, v246, v4
  v_mul_f32 v247, v247, v4
  v_cvt_pk_bf16_f32 v252, v240, v241
  v_cvt_pk_bf16_f32 v253, v242, v243
  v_cvt_pk_bf16_f32 v254, v244, v245
  v_cvt_pk_bf16_f32 v255, v246, v247
  buffer_store_dwordx4 v[252:255], v15, s[60:63], s101 offen offset:2560 sc1
  v_accvgpr_read_b32 v240, a112
  v_accvgpr_read_b32 v241, a113
  v_accvgpr_read_b32 v242, a114
  v_accvgpr_read_b32 v243, a115
  v_accvgpr_read_b32 v244, a116
  v_accvgpr_read_b32 v245, a117
  v_accvgpr_read_b32 v246, a118
  v_accvgpr_read_b32 v247, a119
  v_mul_f32 v240, v240, v4
  v_mul_f32 v241, v241, v4
  v_mul_f32 v242, v242, v4
  v_mul_f32 v243, v243, v4
  v_mul_f32 v244, v244, v4
  v_mul_f32 v245, v245, v4
  v_mul_f32 v246, v246, v4
  v_mul_f32 v247, v247, v4
  v_cvt_pk_bf16_f32 v248, v240, v241
  v_cvt_pk_bf16_f32 v249, v242, v243
  v_cvt_pk_bf16_f32 v250, v244, v245
  v_cvt_pk_bf16_f32 v251, v246, v247
  buffer_store_dwordx4 v[248:251], v15, s[60:63], s101 offen offset:3072 sc1
  v_accvgpr_read_b32 v240, a120
  v_accvgpr_read_b32 v241, a121
  v_accvgpr_read_b32 v242, a122
  v_accvgpr_read_b32 v243, a123
  v_accvgpr_read_b32 v244, a124
  v_accvgpr_read_b32 v245, a125
  v_accvgpr_read_b32 v246, a126
  v_accvgpr_read_b32 v247, a127
  v_mul_f32 v240, v240, v4
  v_mul_f32 v241, v241, v4
  v_mul_f32 v242, v242, v4
  v_mul_f32 v243, v243, v4
  v_mul_f32 v244, v244, v4
  v_mul_f32 v245, v245, v4
  v_mul_f32 v246, v246, v4
  v_mul_f32 v247, v247, v4
  v_cvt_pk_bf16_f32 v252, v240, v241
  v_cvt_pk_bf16_f32 v253, v242, v243
  v_cvt_pk_bf16_f32 v254, v244, v245
  v_cvt_pk_bf16_f32 v255, v246, v247
  buffer_store_dwordx4 v[252:255], v15, s[60:63], s101 offen offset:3584 sc1
  s_sub_u32 s74, s77, s76
  s_sub_u32 s74, s74, 1
.p2align 5
L_kb_kernel_single:
  s_waitcnt lgkmcnt(0)
  v_mfma_f32_32x32x16_bf16 v[144:159], a[128:131], v[16:19], v[208:223]
  ds_read_b128 a[192:195], v11 offset:16384
  ds_read_b128 a[196:199], v11 offset:17408
  v_exp_f32 v92, v92
  v_exp_f32 v93, v93
  v_exp_f32 v94, v94
  v_add_f32 v2, v2, v92
  v_mfma_f32_32x32x16_bf16 v[144:159], a[132:135], v[20:23], v[144:159]
  ds_read_b128 a[200:203], v11 offset:18432
  v_exp_f32 v95, v95
  v_add_f32 v3, v3, v93
  v_cvt_pk_bf16_f32 v90, v92, v93
  v_mfma_f32_32x32x16_bf16 v[144:159], a[136:139], v[24:27], v[144:159]
  ds_read_b128 a[204:207], v11 offset:19456
  v_exp_f32 v112, v112
  v_add_f32 v2, v2, v94
  v_exp_f32 v113, v113
  v_mfma_f32_32x32x16_bf16 v[144:159], a[140:143], v[28:31], v[144:159]
  ds_read_b128 a[208:211], v11 offset:20480
  ds_read_b128 a[212:215], v11 offset:21504
  v_add_f32 v3, v3, v95
  v_cvt_pk_bf16_f32 v91, v94, v95
  v_exp_f32 v114, v114
  v_mfma_f32_32x32x16_bf16 v[144:159], a[144:147], v[32:35], v[144:159]
  ds_read_b128 a[216:219], v11 offset:22528
  v_add_f32 v2, v2, v112
  v_exp_f32 v115, v115
  v_add_f32 v3, v3, v113
  v_mfma_f32_32x32x16_bf16 v[144:159], a[148:151], v[36:39], v[144:159]
  ds_read_b128 a[220:223], v11 offset:23552
  v_cvt_pk_bf16_f32 v112, v112, v113
  v_exp_f32 v116, v116
  v_add_f32 v2, v2, v114
  v_mfma_f32_32x32x16_bf16 v[144:159], a[152:155], v[40:43], v[144:159]
  ds_read_b128 a[224:227], v11 offset:24576
  ds_read_b128 a[228:231], v11 offset:25600
  v_exp_f32 v117, v117
  v_add_f32 v3, v3, v115
  v_cvt_pk_bf16_f32 v113, v114, v115
  v_mfma_f32_32x32x16_bf16 v[144:159], a[156:159], v[44:47], v[144:159]
  ds_read_b128 a[232:235], v11 offset:26624
  v_exp_f32 v118, v118
  v_add_f32 v2, v2, v116
  v_exp_f32 v119, v119
  v_mfma_f32_32x32x16_bf16 v[176:191], a[160:163], v[16:19], v[208:223]
  ds_read_b128 a[236:239], v11 offset:27648
  v_add_f32 v3, v3, v117
  v_cvt_pk_bf16_f32 v114, v116, v117
  v_exp_f32 v120, v120
  v_add_f32 v2, v2, v118
  v_mfma_f32_32x32x16_bf16 v[176:191], a[164:167], v[20:23], v[176:191]
  ds_read_b128 a[240:243], v11 offset:28672
  ds_read_b128 a[244:247], v11 offset:29696
  v_exp_f32 v121, v121
  v_add_f32 v3, v3, v119
  v_cvt_pk_bf16_f32 v115, v118, v119
  v_mfma_f32_32x32x16_bf16 v[176:191], a[168:171], v[24:27], v[176:191]
  ds_read_b128 a[248:251], v11 offset:30720
  v_exp_f32 v122, v122
  v_add_f32 v2, v2, v120
  v_exp_f32 v123, v123
  v_mfma_f32_32x32x16_bf16 v[176:191], a[172:175], v[28:31], v[176:191]
  ds_read_b128 a[252:255], v11 offset:31744
  v_add_f32 v3, v3, v121
  v_cvt_pk_bf16_f32 v120, v120, v121
  v_exp_f32 v124, v124
  v_mfma_f32_32x32x16_bf16 v[176:191], a[176:179], v[32:35], v[176:191]
  v_add_f32 v2, v2, v122
  v_exp_f32 v125, v125
  v_add_f32 v3, v3, v123
  v_mfma_f32_32x32x16_bf16 v[176:191], a[180:183], v[36:39], v[176:191]
  v_cvt_pk_bf16_f32 v121, v122, v123
  v_exp_f32 v126, v126
  v_add_f32 v2, v2, v124
  v_mfma_f32_32x32x16_bf16 v[176:191], a[184:187], v[40:43], v[176:191]
  v_exp_f32 v127, v127
  v_add_f32 v3, v3, v125
  v_cvt_pk_bf16_f32 v122, v124, v125
  v_mfma_f32_32x32x16_bf16 v[176:191], a[188:191], v[44:47], v[176:191]
  v_add_f32 v2, v2, v126
  v_add_f32 v3, v3, v127
  v_cvt_pk_bf16_f32 v123, v126, v127
  s_waitcnt vmcnt(16) lgkmcnt(0)
  s_barrier
  v_mfma_f32_32x32x16_bf16 a[0:15], a[192:195], v[80:83], a[0:15]
  s_sub_u32 s80, s75, s77
  s_add_u32 s80, s80, 2
  v_mfma_f32_32x32x16_bf16 a[16:31], a[196:199], v[80:83], a[16:31]
  s_cmp_lt_u32 s80, 2
  s_cbranch_scc1 L_kb_kernel_s0_mask
L_kb_kernel_s0_mask_ret:
  ds_read_b128 a[128:131], v10 offset:16384
  ds_read_b128 a[132:135], v10 offset:17408
  v_mfma_f32_32x32x16_bf16 a[32:47], a[200:203], v[80:83], a[32:47]
  v_max3_f32 v6, v144, v145, v146
  v_max3_f32 v6, v6, v147, v148
  v_max3_f32 v6, v6, v149, v150
  v_max3_f32 v6, v6, v151, v152
  v_max3_f32 v6, v6, v153, v154
  v_max3_f32 v6, v6, v155, v156
  ds_read_b128 a[136:139], v10 offset:18432
  v_mfma_f32_32x32x16_bf16 a[48:63], a[204:207], v[80:83], a[48:63]
  v_max3_f32 v6, v6, v157, v158
  v_max3_f32 v6, v6, v159, v176
  v_max3_f32 v6, v6, v177, v178
  v_max3_f32 v6, v6, v179, v180
  v_max3_f32 v6, v6, v181, v182
  ds_read_b128 a[140:143], v10 offset:19456
  v_mfma_f32_32x32x16_bf16 a[0:15], a[208:211], v[88:91], a[0:15]
  v_max3_f32 v6, v6, v183, v184
  v_max3_f32 v6, v6, v185, v186
  v_max3_f32 v6, v6, v187, v188
  v_max3_f32 v6, v6, v189, v190
  v_max_f32 v6, v6, v191
  v_cmp_lt_f32 vcc, s79, v6
  ds_read_b128 a[144:147], v10 offset:20480
  v_mfma_f32_32x32x16_bf16 a[16:31], a[212:215], v[88:91], a[16:31]
  s_cbranch_vccnz L_kb_kernel_s0_rare
L_kb_kernel_s0_rare_ret:
  s_add_u32 s75, s75, 1
  ds_read_b128 a[148:151], v10 offset:21504
  ds_read_b128 a[152:155], v10 offset:22528
  s_add_u32 m0, s72, 0
  v_exp_f32 v144, v144
  v_exp_f32 v145, v145
  v_exp_f32 v146, v146
  v_mfma_f32_32x32x16_bf16 a[32:47], a[216:219], v[88:91], a[32:47]
  ds_read_b128 a[156:159], v10 offset:23552
  buffer_load_dwordx4 v12, s[52:55], s71 offen offset:0 lds
  v_add_f32 v2, v2, v144
  v_exp_f32 v147, v147
  v_add_f32 v3, v3, v145
  v_mfma_f32_32x32x16_bf16 a[48:63], a[220:223], v[88:91], a[48:63]
  ds_read_b128 a[160:163], v10 offset:24576
  buffer_load_dwordx4 v12, s[52:55], s71 offen offset:1024 lds
  v_cvt_pk_bf16_f32 v144, v144, v145
  v_exp_f32 v148, v148
  v_add_f32 v2, v2, v146
  v_mfma_f32_32x32x16_bf16 a[0:15], a[224:227], v[112:115], a[0:15]
  ds_read_b128 a[164:167], v10 offset:25600
  buffer_load_dwordx4 v12, s[52:55], s71 offen offset:2048 lds
  v_exp_f32 v149, v149
  v_add_f32 v3, v3, v147
  v_mfma_f32_32x32x16_bf16 a[16:31], a[228:231], v[112:115], a[16:31]
  ds_read_b128 a[168:171], v10 offset:26624
  ds_read_b128 a[172:175], v10 offset:27648
  buffer_load_dwordx4 v12, s[52:55], s71 offen offset:3072 lds
  v_cvt_pk_bf16_f32 v145, v146, v147
  v_exp_f32 v150, v150
  v_add_f32 v2, v2, v148
  v_mfma_f32_32x32x16_bf16 a[32:47], a[232:235], v[112:115], a[32:47]
  ds_read_b128 a[176:179], v10 offset:28672
  s_add_u32 m0, s73, 16384
  v_exp_f32 v151, v151
  v_add_f32 v3, v3, v149
  v_cvt_pk_bf16_f32 v146, v148, v149
  v_mfma_f32_32x32x16_bf16 a[48:63], a[236:239], v[112:115], a[48:63]
  ds_read_b128 a[180:183], v10 offset:29696
  buffer_load_dwordx4 v12, s[56:59], s71 offen offset:0 lds
  v_exp_f32 v152, v152
  v_add_f32 v2, v2, v150
  v_exp_f32 v153, v153
  v_mfma_f32_32x32x16_bf16 a[0:15], a[240:243], v[120:123], a[0:15]
  ds_read_b128 a[184:187], v10 offset:30720
  buffer_load_dwordx4 v12, s[56:59], s71 offen offset:1024 lds
  v_add_f32 v3, v3, v151
  v_cvt_pk_bf16_f32 v147, v150, v151
  v_mfma_f32_32x32x16_bf16 a[16:31], a[244:247], v[120:123], a[16:31]
  ds_read_b128 a[188:191], v10 offset:31744
  buffer_load_dwordx4 v12, s[56:59], s71 offen offset:2048 lds
  v_exp_f32 v154, v154
  v_add_f32 v2, v2, v152
  v_exp_f32 v155, v155
  v_mfma_f32_32x32x16_bf16 a[32:47], a[248:251], v[120:123], a[32:47]
  buffer_load_dwordx4 v12, s[56:59], s71 offen offset:3072 lds
  v_add_f32 v3, v3, v153
  v_cvt_pk_bf16_f32 v152, v152, v153
  v_add_f32 v2, v2, v154
  v_mfma_f32_32x32x16_bf16 a[48:63], a[252:255], v[120:123], a[48:63]
  s_add_u32 s71, s71, 16384
  v_add_f32 v3, v3, v155
  v_cvt_pk_bf16_f32 v153, v154, v155
  s_cmp_lg_u32 s78, 0
  s_cbranch_scc1 L_kb_kernel_s0_resc
L_kb_kernel_s0_resc_ret:
  s_sub_u32 s74, s74, 1
  s_cmp_eq_u32 s74, 0
  s_cbranch_scc1 L_kb_kernel_last
  v_xor_b32 v11, 0x8000, v11
  s_waitcnt lgkmcnt(0)
  v_mfma_f32_32x32x16_bf16 v[80:95], a[128:131], v[16:19], v[208:223]
  ds_read_b128 a[192:195], v11 offset:0
  ds_read_b128 a[196:199], v11 offset:1024
  v_exp_f32 v156, v156
  v_exp_f32 v157, v157
  v_exp_f32 v158, v158
  v_add_f32 v2, v2, v156
  v_mfma_f32_32x32x16_bf16 v[80:95], a[132:135], v[20:23], v[80:95]
  ds_read_b128 a[200:203], v11 offset:2048
  v_exp_f32 v159, v159
  v_add_f32 v3, v3, v157
  v_cvt_pk_bf16_f32 v154, v156, v157
  v_mfma_f32_32x32x16_bf16 v[80:95], a[136:139], v[24:27], v[80:95]
  ds_read_b128 a[204:207], v11 offset:3072
  v_exp_f32 v176, v176
  v_add_f32 v2, v2, v158
  v_exp_f32 v177, v177
  v_mfma_f32_32x32x16_bf16 v[80:95], a[140:143], v[28:31], v[80:95]
  ds_read_b128 a[208:211], v11 offset:4096
  ds_read_b128 a[212:215], v11 offset:5120
  v_add_f32 v3, v3, v159
  v_cvt_pk_bf16_f32 v155, v158, v159
  v_exp_f32 v178, v178
  v_mfma_f32_32x32x16_bf16 v[80:95], a[144:147], v[32:35], v[80:95]
  ds_read_b128 a[216:219], v11 offset:6144
  v_add_f32 v2, v2, v176
  v_exp_f32 v179, v179
  v_add_f32 v3, v3, v177
  v_mfma_f32_32x32x16_bf16 v[80:95], a[148:151], v[36:39], v[80:95]
  ds_read_b128 a[220:223], v11 offset:7168
  v_cvt_pk_bf16_f32 v176, v176, v177
  v_exp_f32 v180, v180
  v_add_f32 v2, v2, v178
  v_mfma_f32_32x32x16_bf16 v[80:95], a[152:155], v[40:43], v[80:95]
  ds_read_b128 a[224:227], v11 offset:8192
  ds_read_b128 a[228:231], v11 offset:9216
  v_exp_f32 v181, v181
  v_add_f32 v3, v3, v179
  v_cvt_pk_bf16_f32 v177, v178, v179
  v_mfma_f32_32x32x16_bf16 v[80:95], a[156:159], v[44:47], v[80:95]
  ds_read_b128 a[232:235], v11 offset:10240
  v_exp_f32 v182, v182
  v_add_f32 v2, v2, v180
  v_exp_f32 v183, v183
  v_mfma_f32_32x32x16_bf16 v[112:127], a[160:163], v[16:19], v[208:223]
  ds_read_b128 a[236:239], v11 offset:11264
  v_add_f32 v3, v3, v181
  v_cvt_pk_bf16_f32 v178, v180, v181
  v_exp_f32 v184, v184
  v_add_f32 v2, v2, v182
  v_mfma_f32_32x32x16_bf16 v[112:127], a[164:167], v[20:23], v[112:127]
  ds_read_b128 a[240:243], v11 offset:12288
  ds_read_b128 a[244:247], v11 offset:13312
  v_exp_f32 v185, v185
  v_add_f32 v3, v3, v183
  v_cvt_pk_bf16_f32 v179, v182, v183
  v_mfma_f32_32x32x16_bf16 v[112:127], a[168:171], v[24:27], v[112:127]
  ds_read_b128 a[248:251], v11 offset:14336
  v_exp_f32 v186, v186
  v_add_f32 v2, v2, v184
  v_exp_f32 v187, v187
  v_mfma_f32_32x32x16_bf16 v[112:127], a[172:175], v[28:31], v[112:127]
  ds_read_b128 a[252:255], v11 offset:15360
  v_add_f32 v3, v3, v185
  v_cvt_pk_bf16_f32 v184, v184, v185
  v_exp_f32 v188, v188
  v_mfma_f32_32x32x16_bf16 v[112:127], a[176:179], v[32:35], v[112:127]
  v_add_f32 v2, v2, v186
  v_exp_f32 v189, v189
  v_add_f32 v3, v3, v187
  v_mfma_f32_32x32x16_bf16 v[112:127], a[180:183], v[36:39], v[112:127]
  v_cvt_pk_bf16_f32 v185, v186, v187
  v_exp_f32 v190, v190
  v_add_f32 v2, v2, v188
  v_mfma_f32_32x32x16_bf16 v[112:127], a[184:187], v[40:43], v[112:127]
  v_exp_f32 v191, v191
  v_add_f32 v3, v3, v189
  v_cvt_pk_bf16_f32 v186, v188, v189
  v_mfma_f32_32x32x16_bf16 v[112:127], a[188:191], v[44:47], v[112:127]
  v_add_f32 v2, v2, v190
  v_add_f32 v3, v3, v191
  v_cvt_pk_bf16_f32 v187, v190, v191
  s_waitcnt vmcnt(16) lgkmcnt(0)
  s_barrier
  v_mfma_f32_32x32x16_bf16 a[0:15], a[192:195], v[144:147], a[0:15]
  v_xor_b32 v10, 0x8000, v10
  s_xor_b32 s73, s73, 0x8000
  s_sub_u32 s80, s75, s77
  s_add_u32 s80, s80, 2
  v_mfma_f32_32x32x16_bf16 a[16:31], a[196:199], v[144:147], a[16:31]
  s_cmp_lt_u32 s80, 2
  s_cbranch_scc1 L_kb_kernel_s1_mask
L_kb_kernel_s1_mask_ret:
  ds_read_b128 a[128:131], v10 offset:0
  ds_read_b128 a[132:135], v10 offset:1024
  v_mfma_f32_32x32x16_bf16 a[32:47], a[200:203], v[144:147], a[32:47]
  v_max3_f32 v6, v80, v81, v82
  v_max3_f32 v6, v6, v83, v84
  v_max3_f32 v6, v6, v85, v86
  v_max3_f32 v6, v6, v87, v88
  v_max3_f32 v6, v6, v89, v90
  v_max3_f32 v6, v6, v91, v92
  ds_read_b128 a[136:139], v10 offset:2048
  v_mfma_f32_32x32x16_bf16 a[48:63], a[204:207], v[144:147], a[48:63]
  v_max3_f32 v6, v6, v93, v94
  v_max3_f32 v6, v6, v95, v112
  v_max3_f32 v6, v6, v113, v114
  v_max3_f32 v6, v6, v115, v116
  v_max3_f32 v6, v6, v117, v118
  ds_read_b128 a[140:143], v10 offset:3072
  v_mfma_f32_32x32x16_bf16 a[0:15], a[208:211], v[152:155], a[0:15]
  v_max3_f32 v6, v6, v119, v120
  v_max3_f32 v6, v6, v121, v122
  v_max3_f32 v6, v6, v123, v124
  v_max3_f32 v6, v6, v125, v126
  v_max_f32 v6, v6, v127
  v_cmp_lt_f32 vcc, s79, v6
  ds_read_b128 a[144:147], v10 offset:4096
  v_mfma_f32_32x32x16_bf16 a[16:31], a[212:215], v[152:155], a[16:31]
  s_cbranch_vccnz L_kb_kernel_s1_rare
L_kb_kernel_s1_rare_ret:
  s_add_u32 s75, s75, 1
  ds_read_b128 a[148:151], v10 offset:5120
  ds_read_b128 a[152:155], v10 offset:6144
  s_add_u32 m0, s72, 16384
  v_exp_f32 v80, v80
  v_exp_f32 v81, v81
  v_exp_f32 v82, v82
  v_mfma_f32_32x32x16_bf16 a[32:47], a[216:219], v[152:155], a[32:47]
  ds_read_b128 a[156:159], v10 offset:7168
  buffer_load_dwordx4 v12, s[52:55], s71 offen offset:0 lds
  v_add_f32 v2, v2, v80
  v_exp_f32 v83, v83
  v_add_f32 v3, v3, v81
  v_mfma_f32_32x32x16_bf16 a[48:63], a[220:223], v[152:155], a[48:63]
  ds_read_b128 a[160:163], v10 offset:8192
  buffer_load_dwordx4 v12, s[52:55], s71 offen offset:1024 lds
  v_cvt_pk_bf16_f32 v80, v80, v81
  v_exp_f32 v84, v84
  v_add_f32 v2, v2, v82
  v_mfma_f32_32x32x16_bf16 a[0:15], a[224:227], v[176:179], a[0:15]
  ds_read_b128 a[164:167], v10 offset:9216
  buffer_load_dwordx4 v12, s[52:55], s71 offen offset:2048 lds
  v_exp_f32 v85, v85
  v_add_f32 v3, v3, v83
  v_mfma_f32_32x32x16_bf16 a[16:31], a[228:231], v[176:179], a[16:31]
  ds_read_b128 a[168:171], v10 offset:10240
  ds_read_b128 a[172:175], v10 offset:11264
  buffer_load_dwordx4 v12, s[52:55], s71 offen offset:3072 lds
  v_cvt_pk_bf16_f32 v81, v82, v83
  v_exp_f32 v86, v86
  v_add_f32 v2, v2, v84
  v_mfma_f32_32x32x16_bf16 a[32:47], a[232:235], v[176:179], a[32:47]
  ds_read_b128 a[176:179], v10 offset:12288
  s_add_u32 m0, s73, 0
  v_exp_f32 v87, v87
  v_add_f32 v3, v3, v85
  v_cvt_pk_bf16_f32 v82, v84, v85
  v_mfma_f32_32x32x16_bf16 a[48:63], a[236:239], v[176:179], a[48:63]
  ds_read_b128 a[180:183], v10 offset:13312
  buffer_load_dwordx4 v12, s[56:59], s71 offen offset:0 lds
  v_exp_f32 v88, v88
  v_add_f32 v2, v2, v86
  v_exp_f32 v89, v89
  v_mfma_f32_32x32x16_bf16 a[0:15], a[240:243], v[184:187], a[0:15]
  ds_read_b128 a[184:187], v10 offset:14336
  buffer_load_dwordx4 v12, s[56:59], s71 offen offset:1024 lds
  v_add_f32 v3, v3, v87
  v_cvt_pk_bf16_f32 v83, v86, v87
  v_mfma_f32_32x32x16_bf16 a[16:31], a[244:247], v[184:187], a[16:31]
  ds_read_b128 a[188:191], v10 offset:15360
  buffer_load_dwordx4 v12, s[56:59], s71 offen offset:2048 lds
  v_exp_f32 v90, v90
  v_add_f32 v2, v2, v88
  v_exp_f32 v91, v91
  v_mfma_f32_32x32x16_bf16 a[32:47], a[248:251], v[184:187], a[32:47]
  buffer_load_dwordx4 v12, s[56:59], s71 offen offset:3072 lds
  v_add_f32 v3, v3, v89
  v_cvt_pk_bf16_f32 v88, v88, v89
  v_add_f32 v2, v2, v90
  v_mfma_f32_32x32x16_bf16 a[48:63], a[252:255], v[184:187], a[48:63]
  s_add_u32 s71, s71, 16384
  s_xor_b32 s72, s72, 0x8000
  v_add_f32 v3, v3, v91
  v_cvt_pk_bf16_f32 v89, v90, v91
  s_cmp_lg_u32 s78, 0
  s_cbranch_scc1 L_kb_kernel_s1_resc
L_kb_kernel_s1_resc_ret:
  s_sub_u32 s74, s74, 1
  s_branch L_kb_kernel_single
L_kb_kernel_last:
  v_xor_b32 v11, 0x8000, v11
  ds_read_b128 a[192:195], v11 offset:0
  ds_read_b128 a[196:199], v11 offset:1024
  ds_read_b128 a[200:203], v11 offset:2048
  ds_read_b128 a[204:207], v11 offset:3072
  ds_read_b128 a[208:211], v11 offset:4096
  ds_read_b128 a[212:215], v11 offset:5120
  ds_read_b128 a[216:219], v11 offset:6144
  ds_read_b128 a[220:223], v11 offset:7168
  ds_read_b128 a[224:227], v11 offset:8192
  ds_read_b128 a[228:231], v11 offset:9216
  ds_read_b128 a[232:235], v11 offset:10240
  ds_read_b128 a[236:239], v11 offset:11264
  ds_read_b128 a[240:243], v11 offset:12288
  ds_read_b128 a[244:247], v11 offset:13312
  ds_read_b128 a[248:251], v11 offset:14336
  ds_read_b128 a[252:255], v11 offset:15360
  v_exp_f32 v156, v156
  v_exp_f32 v157, v157
  v_exp_f32 v158, v158
  v_add_f32 v2, v2, v156
  v_exp_f32 v159, v159
  v_add_f32 v3, v3, v157
  v_cvt_pk_bf16_f32 v154, v156, v157
  v_exp_f32 v176, v176
  v_add_f32 v2, v2, v158
  v_exp_f32 v177, v177
  v_add_f32 v3, v3, v159
  v_cvt_pk_bf16_f32 v155, v158, v159
  v_exp_f32 v178, v178
  v_add_f32 v2, v2, v176
  v_exp_f32 v179, v179
  v_add_f32 v3, v3, v177
  v_cvt_pk_bf16_f32 v176, v176, v177
  v_exp_f32 v180, v180
  v_add_f32 v2, v2, v178
  v_exp_f32 v181, v181
  v_add_f32 v3, v3, v179
  v_cvt_pk_bf16_f32 v177, v178, v179
  v_exp_f32 v182, v182
  v_add_f32 v2, v2, v180
  v_exp_f32 v183, v183
  v_add_f32 v3, v3, v181
  v_cvt_pk_bf16_f32 v178, v180, v181
  v_exp_f32 v184, v184
  v_add_f32 v2, v2, v182
  v_exp_f32 v185, v185
  v_add_f32 v3, v3, v183
  v_cvt_pk_bf16_f32 v179, v182, v183
  v_exp_f32 v186, v186
  v_add_f32 v2, v2, v184
  v_exp_f32 v187, v187
  v_add_f32 v3, v3, v185
  v_cvt_pk_bf16_f32 v184, v184, v185
  v_exp_f32 v188, v188
  v_add_f32 v2, v2, v186
  v_exp_f32 v189, v189
  v_add_f32 v3, v3, v187
  v_cvt_pk_bf16_f32 v185, v186, v187
  v_exp_f32 v190, v190
  v_add_f32 v2, v2, v188
  v_exp_f32 v191, v191
  v_add_f32 v3, v3, v189
  v_cvt_pk_bf16_f32 v186, v188, v189
  v_add_f32 v2, v2, v190
  v_add_f32 v3, v3, v191
  v_cvt_pk_bf16_f32 v187, v190, v191
  s_waitcnt lgkmcnt(0)
  v_mfma_f32_32x32x16_bf16 a[0:15], a[192:195], v[144:147], a[0:15]
  v_mfma_f32_32x32x16_bf16 a[16:31], a[196:199], v[144:147], a[16:31]
  v_mfma_f32_32x32x16_bf16 a[32:47], a[200:203], v[144:147], a[32:47]
  v_mfma_f32_32x32x16_bf16 a[48:63], a[204:207], v[144:147], a[48:63]
  v_mfma_f32_32x32x16_bf16 a[0:15], a[208:211], v[152:155], a[0:15]
  v_mfma_f32_32x32x16_bf16 a[16:31], a[212:215], v[152:155], a[16:31]
  v_mfma_f32_32x32x16_bf16 a[32:47], a[216:219], v[152:155], a[32:47]
  v_mfma_f32_32x32x16_bf16 a[48:63], a[220:223], v[152:155], a[48:63]
  v_mfma_f32_32x32x16_bf16 a[0:15], a[224:227], v[176:179], a[0:15]
  v_mfma_f32_32x32x16_bf16 a[16:31], a[228:231], v[176:179], a[16:31]
  v_mfma_f32_32x32x16_bf16 a[32:47], a[232:235], v[176:179], a[32:47]
  v_mfma_f32_32x32x16_bf16 a[48:63], a[236:239], v[176:179], a[48:63]
  v_mfma_f32_32x32x16_bf16 a[0:15], a[240:243], v[184:187], a[0:15]
  v_mfma_f32_32x32x16_bf16 a[16:31], a[244:247], v[184:187], a[16:31]
  v_mfma_f32_32x32x16_bf16 a[32:47], a[248:251], v[184:187], a[32:47]
  v_mfma_f32_32x32x16_bf16 a[48:63], a[252:255], v[184:187], a[48:63]
  v_add_f32 v2, v2, v3
  v_mov_b32 v3, v2
s_nop 1
  v_permlane32_swap_b32 v2, v3
  v_add_f32 v2, v2, v3
  v_rcp_f32 v2, v2
  s_nop 7
  v_accvgpr_read_b32 v240, a0
  v_accvgpr_read_b32 v241, a1
  v_accvgpr_read_b32 v242, a2
  v_accvgpr_read_b32 v243, a3
  v_accvgpr_read_b32 v244, a4
  v_accvgpr_read_b32 v245, a5
  v_accvgpr_read_b32 v246, a6
  v_accvgpr_read_b32 v247, a7
  v_mul_f32 v240, v240, v2
  v_mul_f32 v241, v241, v2
  v_mul_f32 v242, v242, v2
  v_mul_f32 v243, v243, v2
  v_mul_f32 v244, v244, v2
  v_mul_f32 v245, v245, v2
  v_mul_f32 v246, v246, v2
  v_mul_f32 v247, v247, v2
  v_cvt_pk_bf16_f32 v248, v240, v241
  v_cvt_pk_bf16_f32 v249, v242, v243
  v_cvt_pk_bf16_f32 v250, v244, v245
  v_cvt_pk_bf16_f32 v251, v246, v247
  buffer_store_dwordx4 v[248:251], v15, s[60:63], s100 offen offset:0 sc1
  v_accvgpr_read_b32 v240, a8
  v_accvgpr_read_b32 v241, a9
  v_accvgpr_read_b32 v242, a10
  v_accvgpr_read_b32 v243, a11
  v_accvgpr_read_b32 v244, a12
  v_accvgpr_read_b32 v245, a13
  v_accvgpr_read_b32 v246, a14
  v_accvgpr_read_b32 v247, a15
  v_mul_f32 v240, v240, v2
  v_mul_f32 v241, v241, v2
  v_mul_f32 v242, v242, v2
  v_mul_f32 v243, v243, v2
  v_mul_f32 v244, v244, v2
  v_mul_f32 v245, v245, v2
  v_mul_f32 v246, v246, v2
  v_mul_f32 v247, v247, v2
  v_cvt_pk_bf16_f32 v252, v240, v241
  v_cvt_pk_bf16_f32 v253, v242, v243
  v_cvt_pk_bf16_f32 v254, v244, v245
  v_cvt_pk_bf16_f32 v255, v246, v247
  buffer_store_dwordx4 v[252:255], v15, s[60:63], s100 offen offset:512 sc1
  v_accvgpr_read_b32 v240, a16
  v_accvgpr_read_b32 v241, a17
  v_accvgpr_read_b32 v242, a18
  v_accvgpr_read_b32 v243, a19
  v_accvgpr_read_b32 v244, a20
  v_accvgpr_read_b32 v245, a21
  v_accvgpr_read_b32 v246, a22
  v_accvgpr_read_b32 v247, a23
  v_mul_f32 v240, v240, v2
  v_mul_f32 v241, v241, v2
  v_mul_f32 v242, v242, v2
  v_mul_f32 v243, v243, v2
  v_mul_f32 v244, v244, v2
  v_mul_f32 v245, v245, v2
  v_mul_f32 v246, v246, v2
  v_mul_f32 v247, v247, v2
  v_cvt_pk_bf16_f32 v248, v240, v241
  v_cvt_pk_bf16_f32 v249, v242, v243
  v_cvt_pk_bf16_f32 v250, v244, v245
  v_cvt_pk_bf16_f32 v251, v246, v247
  buffer_store_dwordx4 v[248:251], v15, s[60:63], s100 offen offset:1024 sc1
  v_accvgpr_read_b32 v240, a24
  v_accvgpr_read_b32 v241, a25
  v_accvgpr_read_b32 v242, a26
  v_accvgpr_read_b32 v243, a27
  v_accvgpr_read_b32 v244, a28
  v_accvgpr_read_b32 v245, a29
  v_accvgpr_read_b32 v246, a30
  v_accvgpr_read_b32 v247, a31
  v_mul_f32 v240, v240, v2
  v_mul_f32 v241, v241, v2
  v_mul_f32 v242, v242, v2
  v_mul_f32 v243, v243, v2
  v_mul_f32 v244, v244, v2
  v_mul_f32 v245, v245, v2
  v_mul_f32 v246, v246, v2
  v_mul_f32 v247, v247, v2
  v_cvt_pk_bf16_f32 v252, v240, v241
  v_cvt_pk_bf16_f32 v253, v242, v243
  v_cvt_pk_bf16_f32 v254, v244, v245
  v_cvt_pk_bf16_f32 v255, v246, v247
  buffer_store_dwordx4 v[252:255], v15, s[60:63], s100 offen offset:1536 sc1
  v_accvgpr_read_b32 v240, a32
  v_accvgpr_read_b32 v241, a33
  v_accvgpr_read_b32 v242, a34
  v_accvgpr_read_b32 v243, a35
  v_accvgpr_read_b32 v244, a36
  v_accvgpr_read_b32 v245, a37
  v_accvgpr_read_b32 v246, a38
  v_accvgpr_read_b32 v247, a39
  v_mul_f32 v240, v240, v2
  v_mul_f32 v241, v241, v2
  v_mul_f32 v242, v242, v2
  v_mul_f32 v243, v243, v2
  v_mul_f32 v244, v244, v2
  v_mul_f32 v245, v245, v2
  v_mul_f32 v246, v246, v2
  v_mul_f32 v247, v247, v2
  v_cvt_pk_bf16_f32 v248, v240, v241
  v_cvt_pk_bf16_f32 v249, v242, v243
  v_cvt_pk_bf16_f32 v250, v244, v245
  v_cvt_pk_bf16_f32 v251, v246, v247
  buffer_store_dwordx4 v[248:251], v15, s[60:63], s100 offen offset:2048 sc1
  v_accvgpr_read_b32 v240, a40
  v_accvgpr_read_b32 v241, a41
  v_accvgpr_read_b32 v242, a42
  v_accvgpr_read_b32 v243, a43
  v_accvgpr_read_b32 v244, a44
  v_accvgpr_read_b32 v245, a45
  v_accvgpr_read_b32 v246, a46
  v_accvgpr_read_b32 v247, a47
  v_mul_f32 v240, v240, v2
  v_mul_f32 v241, v241, v2
  v_mul_f32 v242, v242, v2
  v_mul_f32 v243, v243, v2
  v_mul_f32 v244, v244, v2
  v_mul_f32 v245, v245, v2
  v_mul_f32 v246, v246, v2
  v_mul_f32 v247, v247, v2
  v_cvt_pk_bf16_f32 v252, v240, v241
  v_cvt_pk_bf16_f32 v253, v242, v243
  v_cvt_pk_bf16_f32 v254, v244, v245
  v_cvt_pk_bf16_f32 v255, v246, v247
  buffer_store_dwordx4 v[252:255], v15, s[60:63], s100 offen offset:2560 sc1
  v_accvgpr_read_b32 v240, a48
  v_accvgpr_read_b32 v241, a49
  v_accvgpr_read_b32 v242, a50
  v_accvgpr_read_b32 v243, a51
  v_accvgpr_read_b32 v244, a52
  v_accvgpr_read_b32 v245, a53
  v_accvgpr_read_b32 v246, a54
  v_accvgpr_read_b32 v247, a55
  v_mul_f32 v240, v240, v2
  v_mul_f32 v241, v241, v2
  v_mul_f32 v242, v242, v2
  v_mul_f32 v243, v243, v2
  v_mul_f32 v244, v244, v2
  v_mul_f32 v245, v245, v2
  v_mul_f32 v246, v246, v2
  v_mul_f32 v247, v247, v2
  v_cvt_pk_bf16_f32 v248, v240, v241
  v_cvt_pk_bf16_f32 v249, v242, v243
  v_cvt_pk_bf16_f32 v250, v244, v245
  v_cvt_pk_bf16_f32 v251, v246, v247
  buffer_store_dwordx4 v[248:251], v15, s[60:63], s100 offen offset:3072 sc1
  v_accvgpr_read_b32 v240, a56
  v_accvgpr_read_b32 v241, a57
  v_accvgpr_read_b32 v242, a58
  v_accvgpr_read_b32 v243, a59
  v_accvgpr_read_b32 v244, a60
  v_accvgpr_read_b32 v245, a61
  v_accvgpr_read_b32 v246, a62
  v_accvgpr_read_b32 v247, a63
  v_mul_f32 v240, v240, v2
  v_mul_f32 v241, v241, v2
  v_mul_f32 v242, v242, v2
  v_mul_f32 v243, v243, v2
  v_mul_f32 v244, v244, v2
  v_mul_f32 v245, v245, v2
  v_mul_f32 v246, v246, v2
  v_mul_f32 v247, v247, v2
  v_cvt_pk_bf16_f32 v252, v240, v241
  v_cvt_pk_bf16_f32 v253, v242, v243
  v_cvt_pk_bf16_f32 v254, v244, v245
  v_cvt_pk_bf16_f32 v255, v246, v247
  buffer_store_dwordx4 v[252:255], v15, s[60:63], s100 offen offset:3584 sc1
L_kb_kernel_end:
  s_endpgm
L_kb_kernel_pmask:
  s_nop 7
  s_lshl_b32 s81, s80, 1
  s_sub_u32 s81, s3, s81
  s_lshl_b32 s81, s81, 5
  v_add_u32 v240, s81, v13
  v_add_u32 v241, -32, v240
  v_cmp_gt_i32_e64 s[84:85], 0, v240
  v_cmp_gt_i32_e64 s[86:87], 1, v240
  v_cmp_gt_i32_e64 s[88:89], 2, v240
  v_cmp_gt_i32_e64 s[90:91], 3, v240
  v_cmp_gt_i32_e64 s[92:93], 16, v240
  v_cmp_gt_i32_e64 s[94:95], 17, v240
  v_cmp_gt_i32_e64 s[96:97], 18, v240
  v_cmp_gt_i32_e64 s[98:99], 19, v240
  v_cndmask_b32_e64 v96, v96, v14, s[84:85]
  v_cndmask_b32_e64 v97, v97, v14, s[86:87]
  v_cndmask_b32_e64 v98, v98, v14, s[88:89]
  v_cndmask_b32_e64 v99, v99, v14, s[90:91]
  v_cndmask_b32_e64 v100, v100, v14, s[92:93]
  v_cndmask_b32_e64 v101, v101, v14, s[94:95]
  v_cndmask_b32_e64 v102, v102, v14, s[96:97]
  v_cndmask_b32_e64 v103, v103, v14, s[98:99]
  v_cmp_gt_i32_e64 s[84:85], 8, v240
  v_cmp_gt_i32_e64 s[86:87], 9, v240
  v_cmp_gt_i32_e64 s[88:89], 10, v240
  v_cmp_gt_i32_e64 s[90:91], 11, v240
  v_cmp_gt_i32_e64 s[92:93], 24, v240
  v_cmp_gt_i32_e64 s[94:95], 25, v240
  v_cmp_gt_i32_e64 s[96:97], 26, v240
  v_cmp_gt_i32_e64 s[98:99], 27, v240
  v_cndmask_b32_e64 v104, v104, v14, s[84:85]
  v_cndmask_b32_e64 v105, v105, v14, s[86:87]
  v_cndmask_b32_e64 v106, v106, v14, s[88:89]
  v_cndmask_b32_e64 v107, v107, v14, s[90:91]
  v_cndmask_b32_e64 v108, v108, v14, s[92:93]
  v_cndmask_b32_e64 v109, v109, v14, s[94:95]
  v_cndmask_b32_e64 v110, v110, v14, s[96:97]
  v_cndmask_b32_e64 v111, v111, v14, s[98:99]
  v_cmp_gt_i32_e64 s[84:85], 0, v241
  v_cmp_gt_i32_e64 s[86:87], 1, v241
  v_cmp_gt_i32_e64 s[88:89], 2, v241
  v_cmp_gt_i32_e64 s[90:91], 3, v241
  v_cmp_gt_i32_e64 s[92:93], 16, v241
  v_cmp_gt_i32_e64 s[94:95], 17, v241
  v_cmp_gt_i32_e64 s[96:97], 18, v241
  v_cmp_gt_i32_e64 s[98:99], 19, v241
  v_cndmask_b32_e64 v128, v128, v14, s[84:85]
  v_cndmask_b32_e64 v129, v129, v14, s[86:87]
  v_cndmask_b32_e64 v130, v130, v14, s[88:89]
  v_cndmask_b32_e64 v131, v131, v14, s[90:91]
  v_cndmask_b32_e64 v132, v132, v14, s[92:93]
  v_cndmask_b32_e64 v133, v133, v14, s[94:95]
  v_cndmask_b32_e64 v134, v134, v14, s[96:97]
  v_cndmask_b32_e64 v135, v135, v14, s[98:99]
  v_cmp_gt_i32_e64 s[84:85], 8, v241
  v_cmp_gt_i32_e64 s[86:87], 9, v241
  v_cmp_gt_i32_e64 s[88:89], 10, v241
  v_cmp_gt_i32_e64 s[90:91], 11, v241
  v_cmp_gt_i32_e64 s[92:93], 24, v241
  v_cmp_gt_i32_e64 s[94:95], 25, v241
  v_cmp_gt_i32_e64 s[96:97], 26, v241
  v_cmp_gt_i32_e64 s[98:99], 27, v241
  v_cndmask_b32_e64 v136, v136, v14, s[84:85]
  v_cndmask_b32_e64 v137, v137, v14, s[86:87]
  v_cndmask_b32_e64 v138, v138, v14, s[88:89]
  v_cndmask_b32_e64 v139, v139, v14, s[90:91]
  v_cndmask_b32_e64 v140, v140, v14, s[92:93]
  v_cndmask_b32_e64 v141, v141, v14, s[94:95]
  v_cndmask_b32_e64 v142, v142, v14, s[96:97]
  v_cndmask_b32_e64 v143, v143, v14, s[98:99]
  s_branch L_kb_kernel_pmask_ret
L_kb_kernel_d0_mask:
  s_nop 7
  s_lshl_b32 s81, s80, 1
  s_sub_u32 s81, s3, s81
  s_lshl_b32 s81, s81, 5
  v_add_u32 v240, s81, v13
  v_add_u32 v241, -32, v240
  v_cmp_gt_i32_e64 s[84:85], 0, v240
  v_cmp_gt_i32_e64 s[86:87], 1, v240
  v_cmp_gt_i32_e64 s[88:89], 2, v240
  v_cmp_gt_i32_e64 s[90:91], 3, v240
  v_cmp_gt_i32_e64 s[92:93], 16, v240
  v_cmp_gt_i32_e64 s[94:95], 17, v240
  v_cmp_gt_i32_e64 s[96:97], 18, v240
  v_cmp_gt_i32_e64 s[98:99], 19, v240
  v_cndmask_b32_e64 v160, v160, v14, s[84:85]
  v_cndmask_b32_e64 v161, v161, v14, s[86:87]
  v_cndmask_b32_e64 v162, v162, v14, s[88:89]
  v_cndmask_b32_e64 v163, v163, v14, s[90:91]
  v_cndmask_b32_e64 v164, v164, v14, s[92:93]
  v_cndmask_b32_e64 v165, v165, v14, s[94:95]
  v_cndmask_b32_e64 v166, v166, v14, s[96:97]
  v_cndmask_b32_e64 v167, v167, v14, s[98:99]
  v_cmp_gt_i32_e64 s[84:85], 8, v240
  v_cmp_gt_i32_e64 s[86:87], 9, v240
  v_cmp_gt_i32_e64 s[88:89], 10, v240
  v_cmp_gt_i32_e64 s[90:91], 11, v240
  v_cmp_gt_i32_e64 s[92:93], 24, v240
  v_cmp_gt_i32_e64 s[94:95], 25, v240
  v_cmp_gt_i32_e64 s[96:97], 26, v240
  v_cmp_gt_i32_e64 s[98:99], 27, v240
  v_cndmask_b32_e64 v168, v168, v14, s[84:85]
  v_cndmask_b32_e64 v169, v169, v14, s[86:87]
  v_cndmask_b32_e64 v170, v170, v14, s[88:89]
  v_cndmask_b32_e64 v171, v171, v14, s[90:91]
  v_cndmask_b32_e64 v172, v172, v14, s[92:93]
  v_cndmask_b32_e64 v173, v173, v14, s[94:95]
  v_cndmask_b32_e64 v174, v174, v14, s[96:97]
  v_cndmask_b32_e64 v175, v175, v14, s[98:99]
  v_cmp_gt_i32_e64 s[84:85], 0, v241
  v_cmp_gt_i32_e64 s[86:87], 1, v241
  v_cmp_gt_i32_e64 s[88:89], 2, v241
  v_cmp_gt_i32_e64 s[90:91], 3, v241
  v_cmp_gt_i32_e64 s[92:93], 16, v241
  v_cmp_gt_i32_e64 s[94:95], 17, v241
  v_cmp_gt_i32_e64 s[96:97], 18, v241
  v_cmp_gt_i32_e64 s[98:99], 19, v241
  v_cndmask_b32_e64 v192, v192, v14, s[84:85]
  v_cndmask_b32_e64 v193, v193, v14, s[86:87]
  v_cndmask_b32_e64 v194, v194, v14, s[88:89]
  v_cndmask_b32_e64 v195, v195, v14, s[90:91]
  v_cndmask_b32_e64 v196, v196, v14, s[92:93]
  v_cndmask_b32_e64 v197, v197, v14, s[94:95]
  v_cndmask_b32_e64 v198, v198, v14, s[96:97]
  v_cndmask_b32_e64 v199, v199, v14, s[98:99]
  v_cmp_gt_i32_e64 s[84:85], 8, v241
  v_cmp_gt_i32_e64 s[86:87], 9, v241
  v_cmp_gt_i32_e64 s[88:89], 10, v241
  v_cmp_gt_i32_e64 s[90:91], 11, v241
  v_cmp_gt_i32_e64 s[92:93], 24, v241
  v_cmp_gt_i32_e64 s[94:95], 25, v241
  v_cmp_gt_i32_e64 s[96:97], 26, v241
  v_cmp_gt_i32_e64 s[98:99], 27, v241
  v_cndmask_b32_e64 v200, v200, v14, s[84:85]
  v_cndmask_b32_e64 v201, v201, v14, s[86:87]
  v_cndmask_b32_e64 v202, v202, v14, s[88:89]
  v_cndmask_b32_e64 v203, v203, v14, s[90:91]
  v_cndmask_b32_e64 v204, v204, v14, s[92:93]
  v_cndmask_b32_e64 v205, v205, v14, s[94:95]
  v_cndmask_b32_e64 v206, v206, v14, s[96:97]
  v_cndmask_b32_e64 v207, v207, v14, s[98:99]
  s_branch L_kb_kernel_d0_mask_ret
L_kb_kernel_d0_rare:
  v_mov_b32 v240, v6
  v_mov_b32 v241, v6
s_nop 1
  v_permlane32_swap_b32 v240, v241
  v_max_f32 v242, v240, v241
  v_max_f32 v242, 0, v242
  v_exp_f32 v8, -v242
  v_sub_f32 v208, v208, v242
  v_sub_f32 v209, v209, v242
  v_sub_f32 v210, v210, v242
  v_sub_f32 v211, v211, v242
  v_sub_f32 v212, v212, v242
  v_sub_f32 v213, v213, v242
  v_sub_f32 v214, v214, v242
  v_sub_f32 v215, v215, v242
  v_sub_f32 v216, v216, v242
  v_sub_f32 v217, v217, v242
  v_sub_f32 v218, v218, v242
  v_sub_f32 v219, v219, v242
  v_sub_f32 v220, v220, v242
  v_sub_f32 v221, v221, v242
  v_sub_f32 v222, v222, v242
  v_sub_f32 v223, v223, v242
  v_mul_f32 v2, v2, v8
  v_mul_f32 v3, v3, v8
  v_sub_f32 v144, v144, v242
  v_sub_f32 v145, v145, v242
  v_sub_f32 v146, v146, v242
  v_sub_f32 v147, v147, v242
  v_sub_f32 v148, v148, v242
  v_sub_f32 v149, v149, v242
  v_sub_f32 v150, v150, v242
  v_sub_f32 v151, v151, v242
  v_sub_f32 v152, v152, v242
  v_sub_f32 v153, v153, v242
  v_sub_f32 v154, v154, v242
  v_sub_f32 v155, v155, v242
  v_sub_f32 v156, v156, v242
  v_sub_f32 v157, v157, v242
  v_sub_f32 v158, v158, v242
  v_sub_f32 v159, v159, v242
  v_sub_f32 v176, v176, v242
  v_sub_f32 v177, v177, v242
  v_sub_f32 v178, v178, v242
  v_sub_f32 v179, v179, v242
  v_sub_f32 v180, v180, v242
  v_sub_f32 v181, v181, v242
  v_sub_f32 v182, v182, v242
  v_sub_f32 v183, v183, v242
  v_sub_f32 v184, v184, v242
  v_sub_f32 v185, v185, v242
  v_sub_f32 v186, v186, v242
  v_sub_f32 v187, v187, v242
  v_sub_f32 v188, v188, v242
  v_sub_f32 v189, v189, v242
  v_sub_f32 v190, v190, v242
  v_sub_f32 v191, v191, v242
  v_mov_b32 v240, v7
  v_mov_b32 v241, v7
s_nop 1
  v_permlane32_swap_b32 v240, v241
  v_max_f32 v242, v240, v241
  v_max_f32 v242, 0, v242
  v_exp_f32 v9, -v242
  v_sub_f32 v224, v224, v242
  v_sub_f32 v225, v225, v242
  v_sub_f32 v226, v226, v242
  v_sub_f32 v227, v227, v242
  v_sub_f32 v228, v228, v242
  v_sub_f32 v229, v229, v242
  v_sub_f32 v230, v230, v242
  v_sub_f32 v231, v231, v242
  v_sub_f32 v232, v232, v242
  v_sub_f32 v233, v233, v242
  v_sub_f32 v234, v234, v242
  v_sub_f32 v235, v235, v242
  v_sub_f32 v236, v236, v242
  v_sub_f32 v237, v237, v242
  v_sub_f32 v238, v238, v242
  v_sub_f32 v239, v239, v242
  v_mul_f32 v4, v4, v9
  v_mul_f32 v5, v5, v9
  v_sub_f32 v160, v160, v242
  v_sub_f32 v161, v161, v242
  v_sub_f32 v162, v162, v242
  v_sub_f32 v163, v163, v242
  v_sub_f32 v164, v164, v242
  v_sub_f32 v165, v165, v242
  v_sub_f32 v166, v166, v242
  v_sub_f32 v167, v167, v242
  v_sub_f32 v168, v168, v242
  v_sub_f32 v169, v169, v242
  v_sub_f32 v170, v170, v242
  v_sub_f32 v171, v171, v242
  v_sub_f32 v172, v172, v242
  v_sub_f32 v173, v173, v242
  v_sub_f32 v174, v174, v242
  v_sub_f32 v175, v175, v242
  v_sub_f32 v192, v192, v242
  v_sub_f32 v193, v193, v242
  v_sub_f32 v194, v194, v242
  v_sub_f32 v195, v195, v242
  v_sub_f32 v196, v196, v242
  v_sub_f32 v197, v197, v242
  v_sub_f32 v198, v198, v242
  v_sub_f32 v199, v199, v242
  v_sub_f32 v200, v200, v242
  v_sub_f32 v201, v201, v242
  v_sub_f32 v202, v202, v242
  v_sub_f32 v203, v203, v242
  v_sub_f32 v204, v204, v242
  v_sub_f32 v205, v205, v242
  v_sub_f32 v206, v206, v242
  v_sub_f32 v207, v207, v242
  s_mov_b32 s78, 1
  s_branch L_kb_kernel_d0_rare_ret
L_kb_kernel_d0_resc:
  s_nop 15
  v_accvgpr_read_b32 v240, a0
  v_accvgpr_read_b32 v241, a1
  v_accvgpr_read_b32 v242, a2
  v_accvgpr_read_b32 v243, a3
  v_accvgpr_read_b32 v244, a4
  v_accvgpr_read_b32 v245, a5
  v_accvgpr_read_b32 v246, a6
  v_accvgpr_read_b32 v247, a7
  v_mul_f32 v240, v240, v8
  v_mul_f32 v241, v241, v8
  v_mul_f32 v242, v242, v8
  v_mul_f32 v243, v243, v8
  v_mul_f32 v244, v244, v8
  v_mul_f32 v245, v245, v8
  v_mul_f32 v246, v246, v8
  v_mul_f32 v247, v247, v8
  v_accvgpr_write_b32 a0, v240
  v_accvgpr_write_b32 a1, v241
  v_accvgpr_write_b32 a2, v242
  v_accvgpr_write_b32 a3, v243
  v_accvgpr_write_b32 a4, v244
  v_accvgpr_write_b32 a5, v245
  v_accvgpr_write_b32 a6, v246
  v_accvgpr_write_b32 a7, v247
  v_accvgpr_read_b32 v240, a8
  v_accvgpr_read_b32 v241, a9
  v_accvgpr_read_b32 v242, a10
  v_accvgpr_read_b32 v243, a11
  v_accvgpr_read_b32 v244, a12
  v_accvgpr_read_b32 v245, a13
  v_accvgpr_read_b32 v246, a14
  v_accvgpr_read_b32 v247, a15
  v_mul_f32 v240, v240, v8
  v_mul_f32 v241, v241, v8
  v_mul_f32 v242, v242, v8
  v_mul_f32 v243, v243, v8
  v_mul_f32 v244, v244, v8
  v_mul_f32 v245, v245, v8
  v_mul_f32 v246, v246, v8
  v_mul_f32 v247, v247, v8
  v_accvgpr_write_b32 a8, v240
  v_accvgpr_write_b32 a9, v241
  v_accvgpr_write_b32 a10, v242
  v_accvgpr_write_b32 a11, v243
  v_accvgpr_write_b32 a12, v244
  v_accvgpr_write_b32 a13, v245
  v_accvgpr_write_b32 a14, v246
  v_accvgpr_write_b32 a15, v247
  v_accvgpr_read_b32 v240, a16
  v_accvgpr_read_b32 v241, a17
  v_accvgpr_read_b32 v242, a18
  v_accvgpr_read_b32 v243, a19
  v_accvgpr_read_b32 v244, a20
  v_accvgpr_read_b32 v245, a21
  v_accvgpr_read_b32 v246, a22
  v_accvgpr_read_b32 v247, a23
  v_mul_f32 v240, v240, v8
  v_mul_f32 v241, v241, v8
  v_mul_f32 v242, v242, v8
  v_mul_f32 v243, v243, v8
  v_mul_f32 v244, v244, v8
  v_mul_f32 v245, v245, v8
  v_mul_f32 v246, v246, v8
  v_mul_f32 v247, v247, v8
  v_accvgpr_write_b32 a16, v240
  v_accvgpr_write_b32 a17, v241
  v_accvgpr_write_b32 a18, v242
  v_accvgpr_write_b32 a19, v243
  v_accvgpr_write_b32 a20, v244
  v_accvgpr_write_b32 a21, v245
  v_accvgpr_write_b32 a22, v246
  v_accvgpr_write_b32 a23, v247
  v_accvgpr_read_b32 v240, a24
  v_accvgpr_read_b32 v241, a25
  v_accvgpr_read_b32 v242, a26
  v_accvgpr_read_b32 v243, a27
  v_accvgpr_read_b32 v244, a28
  v_accvgpr_read_b32 v245, a29
  v_accvgpr_read_b32 v246, a30
  v_accvgpr_read_b32 v247, a31
  v_mul_f32 v240, v240, v8
  v_mul_f32 v241, v241, v8
  v_mul_f32 v242, v242, v8
  v_mul_f32 v243, v243, v8
  v_mul_f32 v244, v244, v8
  v_mul_f32 v245, v245, v8
  v_mul_f32 v246, v246, v8
  v_mul_f32 v247, v247, v8
  v_accvgpr_write_b32 a24, v240
  v_accvgpr_write_b32 a25, v241
  v_accvgpr_write_b32 a26, v242
  v_accvgpr_write_b32 a27, v243
  v_accvgpr_write_b32 a28, v244
  v_accvgpr_write_b32 a29, v245
  v_accvgpr_write_b32 a30, v246
  v_accvgpr_write_b32 a31, v247
  v_accvgpr_read_b32 v240, a32
  v_accvgpr_read_b32 v241, a33
  v_accvgpr_read_b32 v242, a34
  v_accvgpr_read_b32 v243, a35
  v_accvgpr_read_b32 v244, a36
  v_accvgpr_read_b32 v245, a37
  v_accvgpr_read_b32 v246, a38
  v_accvgpr_read_b32 v247, a39
  v_mul_f32 v240, v240, v8
  v_mul_f32 v241, v241, v8
  v_mul_f32 v242, v242, v8
  v_mul_f32 v243, v243, v8
  v_mul_f32 v244, v244, v8
  v_mul_f32 v245, v245, v8
  v_mul_f32 v246, v246, v8
  v_mul_f32 v247, v247, v8
  v_accvgpr_write_b32 a32, v240
  v_accvgpr_write_b32 a33, v241
  v_accvgpr_write_b32 a34, v242
  v_accvgpr_write_b32 a35, v243
  v_accvgpr_write_b32 a36, v244
  v_accvgpr_write_b32 a37, v245
  v_accvgpr_write_b32 a38, v246
  v_accvgpr_write_b32 a39, v247
  v_accvgpr_read_b32 v240, a40
  v_accvgpr_read_b32 v241, a41
  v_accvgpr_read_b32 v242, a42
  v_accvgpr_read_b32 v243, a43
  v_accvgpr_read_b32 v244, a44
  v_accvgpr_read_b32 v245, a45
  v_accvgpr_read_b32 v246, a46
  v_accvgpr_read_b32 v247, a47
  v_mul_f32 v240, v240, v8
  v_mul_f32 v241, v241, v8
  v_mul_f32 v242, v242, v8
  v_mul_f32 v243, v243, v8
  v_mul_f32 v244, v244, v8
  v_mul_f32 v245, v245, v8
  v_mul_f32 v246, v246, v8
  v_mul_f32 v247, v247, v8
  v_accvgpr_write_b32 a40, v240
  v_accvgpr_write_b32 a41, v241
  v_accvgpr_write_b32 a42, v242
  v_accvgpr_write_b32 a43, v243
  v_accvgpr_write_b32 a44, v244
  v_accvgpr_write_b32 a45, v245
  v_accvgpr_write_b32 a46, v246
  v_accvgpr_write_b32 a47, v247
  v_accvgpr_read_b32 v240, a48
  v_accvgpr_read_b32 v241, a49
  v_accvgpr_read_b32 v242, a50
  v_accvgpr_read_b32 v243, a51
  v_accvgpr_read_b32 v244, a52
  v_accvgpr_read_b32 v245, a53
  v_accvgpr_read_b32 v246, a54
  v_accvgpr_read_b32 v247, a55
  v_mul_f32 v240, v240, v8
  v_mul_f32 v241, v241, v8
  v_mul_f32 v242, v242, v8
  v_mul_f32 v243, v243, v8
  v_mul_f32 v244, v244, v8
  v_mul_f32 v245, v245, v8
  v_mul_f32 v246, v246, v8
  v_mul_f32 v247, v247, v8
  v_accvgpr_write_b32 a48, v240
  v_accvgpr_write_b32 a49, v241
  v_accvgpr_write_b32 a50, v242
  v_accvgpr_write_b32 a51, v243
  v_accvgpr_write_b32 a52, v244
  v_accvgpr_write_b32 a53, v245
  v_accvgpr_write_b32 a54, v246
  v_accvgpr_write_b32 a55, v247
  v_accvgpr_read_b32 v240, a56
  v_accvgpr_read_b32 v241, a57
  v_accvgpr_read_b32 v242, a58
  v_accvgpr_read_b32 v243, a59
  v_accvgpr_read_b32 v244, a60
  v_accvgpr_read_b32 v245, a61
  v_accvgpr_read_b32 v246, a62
  v_accvgpr_read_b32 v247, a63
  v_mul_f32 v240, v240, v8
  v_mul_f32 v241, v241, v8
  v_mul_f32 v242, v242, v8
  v_mul_f32 v243, v243, v8
  v_mul_f32 v244, v244, v8
  v_mul_f32 v245, v245, v8
  v_mul_f32 v246, v246, v8
  v_mul_f32 v247, v247, v8
  v_accvgpr_write_b32 a56, v240
  v_accvgpr_write_b32 a57, v241
  v_accvgpr_write_b32 a58, v242
  v_accvgpr_write_b32 a59, v243
  v_accvgpr_write_b32 a60, v244
  v_accvgpr_write_b32 a61, v245
  v_accvgpr_write_b32 a62, v246
  v_accvgpr_write_b32 a63, v247
  v_accvgpr_read_b32 v240, a64
  v_accvgpr_read_b32 v241, a65
  v_accvgpr_read_b32 v242, a66
  v_accvgpr_read_b32 v243, a67
  v_accvgpr_read_b32 v244, a68
  v_accvgpr_read_b32 v245, a69
  v_accvgpr_read_b32 v246, a70
  v_accvgpr_read_b32 v247, a71
  v_mul_f32 v240, v240, v9
  v_mul_f32 v241, v241, v9
  v_mul_f32 v242, v242, v9
  v_mul_f32 v243, v243, v9
  v_mul_f32 v244, v244, v9
  v_mul_f32 v245, v245, v9
  v_mul_f32 v246, v246, v9
  v_mul_f32 v247, v247, v9
  v_accvgpr_write_b32 a64, v240
  v_accvgpr_write_b32 a65, v241
  v_accvgpr_write_b32 a66, v242
  v_accvgpr_write_b32 a67, v243
  v_accvgpr_write_b32 a68, v244
  v_accvgpr_write_b32 a69, v245
  v_accvgpr_write_b32 a70, v246
  v_accvgpr_write_b32 a71, v247
  v_accvgpr_read_b32 v240, a72
  v_accvgpr_read_b32 v241, a73
  v_accvgpr_read_b32 v242, a74
  v_accvgpr_read_b32 v243, a75
  v_accvgpr_read_b32 v244, a76
  v_accvgpr_read_b32 v245, a77
  v_accvgpr_read_b32 v246, a78
  v_accvgpr_read_b32 v247, a79
  v_mul_f32 v240, v240, v9
  v_mul_f32 v241, v241, v9
  v_mul_f32 v242, v242, v9
  v_mul_f32 v243, v243, v9
  v_mul_f32 v244, v244, v9
  v_mul_f32 v245, v245, v9
  v_mul_f32 v246, v246, v9
  v_mul_f32 v247, v247, v9
  v_accvgpr_write_b32 a72, v240
  v_accvgpr_write_b32 a73, v241
  v_accvgpr_write_b32 a74, v242
  v_accvgpr_write_b32 a75, v243
  v_accvgpr_write_b32 a76, v244
  v_accvgpr_write_b32 a77, v245
  v_accvgpr_write_b32 a78, v246
  v_accvgpr_write_b32 a79, v247
  v_accvgpr_read_b32 v240, a80
  v_accvgpr_read_b32 v241, a81
  v_accvgpr_read_b32 v242, a82
  v_accvgpr_read_b32 v243, a83
  v_accvgpr_read_b32 v244, a84
  v_accvgpr_read_b32 v245, a85
  v_accvgpr_read_b32 v246, a86
  v_accvgpr_read_b32 v247, a87
  v_mul_f32 v240, v240, v9
  v_mul_f32 v241, v241, v9
  v_mul_f32 v242, v242, v9
  v_mul_f32 v243, v243, v9
  v_mul_f32 v244, v244, v9
  v_mul_f32 v245, v245, v9
  v_mul_f32 v246, v246, v9
  v_mul_f32 v247, v247, v9
  v_accvgpr_write_b32 a80, v240
  v_accvgpr_write_b32 a81, v241
  v_accvgpr_write_b32 a82, v242
  v_accvgpr_write_b32 a83, v243
  v_accvgpr_write_b32 a84, v244
  v_accvgpr_write_b32 a85, v245
  v_accvgpr_write_b32 a86, v246
  v_accvgpr_write_b32 a87, v247
  v_accvgpr_read_b32 v240, a88
  v_accvgpr_read_b32 v241, a89
  v_accvgpr_read_b32 v242, a90
  v_accvgpr_read_b32 v243, a91
  v_accvgpr_read_b32 v244, a92
  v_accvgpr_read_b32 v245, a93
  v_accvgpr_read_b32 v246, a94
  v_accvgpr_read_b32 v247, a95
  v_mul_f32 v240, v240, v9
  v_mul_f32 v241, v241, v9
  v_mul_f32 v242, v242, v9
  v_mul_f32 v243, v243, v9
  v_mul_f32 v244, v244, v9
  v_mul_f32 v245, v245, v9
  v_mul_f32 v246, v246, v9
  v_mul_f32 v247, v247, v9
  v_accvgpr_write_b32 a88, v240
  v_accvgpr_write_b32 a89, v241
  v_accvgpr_write_b32 a90, v242
  v_accvgpr_write_b32 a91, v243
  v_accvgpr_write_b32 a92, v244
  v_accvgpr_write_b32 a93, v245
  v_accvgpr_write_b32 a94, v246
  v_accvgpr_write_b32 a95, v247
  v_accvgpr_read_b32 v240, a96
  v_accvgpr_read_b32 v241, a97
  v_accvgpr_read_b32 v242, a98
  v_accvgpr_read_b32 v243, a99
  v_accvgpr_read_b32 v244, a100
  v_accvgpr_read_b32 v245, a101
  v_accvgpr_read_b32 v246, a102
  v_accvgpr_read_b32 v247, a103
  v_mul_f32 v240, v240, v9
  v_mul_f32 v241, v241, v9
  v_mul_f32 v242, v242, v9
  v_mul_f32 v243, v243, v9
  v_mul_f32 v244, v244, v9
  v_mul_f32 v245, v245, v9
  v_mul_f32 v246, v246, v9
  v_mul_f32 v247, v247, v9
  v_accvgpr_write_b32 a96, v240
  v_accvgpr_write_b32 a97, v241
  v_accvgpr_write_b32 a98, v242
  v_accvgpr_write_b32 a99, v243
  v_accvgpr_write_b32 a100, v244
  v_accvgpr_write_b32 a101, v245
  v_accvgpr_write_b32 a102, v246
  v_accvgpr_write_b32 a103, v247
  v_accvgpr_read_b32 v240, a104
  v_accvgpr_read_b32 v241, a105
  v_accvgpr_read_b32 v242, a106
  v_accvgpr_read_b32 v243, a107
  v_accvgpr_read_b32 v244, a108
  v_accvgpr_read_b32 v245, a109
  v_accvgpr_read_b32 v246, a110
  v_accvgpr_read_b32 v247, a111
  v_mul_f32 v240, v240, v9
  v_mul_f32 v241, v241, v9
  v_mul_f32 v242, v242, v9
  v_mul_f32 v243, v243, v9
  v_mul_f32 v244, v244, v9
  v_mul_f32 v245, v245, v9
  v_mul_f32 v246, v246, v9
  v_mul_f32 v247, v247, v9
  v_accvgpr_write_b32 a104, v240
  v_accvgpr_write_b32 a105, v241
  v_accvgpr_write_b32 a106, v242
  v_accvgpr_write_b32 a107, v243
  v_accvgpr_write_b32 a108, v244
  v_accvgpr_write_b32 a109, v245
  v_accvgpr_write_b32 a110, v246
  v_accvgpr_write_b32 a111, v247
  v_accvgpr_read_b32 v240, a112
  v_accvgpr_read_b32 v241, a113
  v_accvgpr_read_b32 v242, a114
  v_accvgpr_read_b32 v243, a115
  v_accvgpr_read_b32 v244, a116
  v_accvgpr_read_b32 v245, a117
  v_accvgpr_read_b32 v246, a118
  v_accvgpr_read_b32 v247, a119
  v_mul_f32 v240, v240, v9
  v_mul_f32 v241, v241, v9
  v_mul_f32 v242, v242, v9
  v_mul_f32 v243, v243, v9
  v_mul_f32 v244, v244, v9
  v_mul_f32 v245, v245, v9
  v_mul_f32 v246, v246, v9
  v_mul_f32 v247, v247, v9
  v_accvgpr_write_b32 a112, v240
  v_accvgpr_write_b32 a113, v241
  v_accvgpr_write_b32 a114, v242
  v_accvgpr_write_b32 a115, v243
  v_accvgpr_write_b32 a116, v244
  v_accvgpr_write_b32 a117, v245
  v_accvgpr_write_b32 a118, v246
  v_accvgpr_write_b32 a119, v247
  v_accvgpr_read_b32 v240, a120
  v_accvgpr_read_b32 v241, a121
  v_accvgpr_read_b32 v242, a122
  v_accvgpr_read_b32 v243, a123
  v_accvgpr_read_b32 v244, a124
  v_accvgpr_read_b32 v245, a125
  v_accvgpr_read_b32 v246, a126
  v_accvgpr_read_b32 v247, a127
  v_mul_f32 v240, v240, v9
  v_mul_f32 v241, v241, v9
  v_mul_f32 v242, v242, v9
  v_mul_f32 v243, v243, v9
  v_mul_f32 v244, v244, v9
  v_mul_f32 v245, v245, v9
  v_mul_f32 v246, v246, v9
  v_mul_f32 v247, v247, v9
  v_accvgpr_write_b32 a120, v240
  v_accvgpr_write_b32 a121, v241
  v_accvgpr_write_b32 a122, v242
  v_accvgpr_write_b32 a123, v243
  v_accvgpr_write_b32 a124, v244
  v_accvgpr_write_b32 a125, v245
  v_accvgpr_write_b32 a126, v246
  v_accvgpr_write_b32 a127, v247
  s_mov_b32 s78, 0
  s_nop 1
  s_branch L_kb_kernel_d0_resc_ret
L_kb_kernel_d1_mask:
  s_nop 7
  s_lshl_b32 s81, s80, 1
  s_sub_u32 s81, s3, s81
  s_lshl_b32 s81, s81, 5
  v_add_u32 v240, s81, v13
  v_add_u32 v241, -32, v240
  v_cmp_gt_i32_e64 s[84:85], 0, v240
  v_cmp_gt_i32_e64 s[86:87], 1, v240
  v_cmp_gt_i32_e64 s[88:89], 2, v240
  v_cmp_gt_i32_e64 s[90:91], 3, v240
  v_cmp_gt_i32_e64 s[92:93], 16, v240
  v_cmp_gt_i32_e64 s[94:95], 17, v240
  v_cmp_gt_i32_e64 s[96:97], 18, v240
  v_cmp_gt_i32_e64 s[98:99], 19, v240
  v_cndmask_b32_e64 v96, v96, v14, s[84:85]
  v_cndmask_b32_e64 v97, v97, v14, s[86:87]
  v_cndmask_b32_e64 v98, v98, v14, s[88:89]
  v_cndmask_b32_e64 v99, v99, v14, s[90:91]
  v_cndmask_b32_e64 v100, v100, v14, s[92:93]
  v_cndmask_b32_e64 v101, v101, v14, s[94:95]
  v_cndmask_b32_e64 v102, v102, v14, s[96:97]
  v_cndmask_b32_e64 v103, v103, v14, s[98:99]
  v_cmp_gt_i32_e64 s[84:85], 8, v240
  v_cmp_gt_i32_e64 s[86:87], 9, v240
  v_cmp_gt_i32_e64 s[88:89], 10, v240
  v_cmp_gt_i32_e64 s[90:91], 11, v240
  v_cmp_gt_i32_e64 s[92:93], 24, v240
  v_cmp_gt_i32_e64 s[94:95], 25, v240
  v_cmp_gt_i32_e64 s[96:97], 26, v240
  v_cmp_gt_i32_e64 s[98:99], 27, v240
  v_cndmask_b32_e64 v104, v104, v14, s[84:85]
  v_cndmask_b32_e64 v105, v105, v14, s[86:87]
  v_cndmask_b32_e64 v106, v106, v14, s[88:89]
  v_cndmask_b32_e64 v107, v107, v14, s[90:91]
  v_cndmask_b32_e64 v108, v108, v14, s[92:93]
  v_cndmask_b32_e64 v109, v109, v14, s[94:95]
  v_cndmask_b32_e64 v110, v110, v14, s[96:97]
  v_cndmask_b32_e64 v111, v111, v14, s[98:99]
  v_cmp_gt_i32_e64 s[84:85], 0, v241
  v_cmp_gt_i32_e64 s[86:87], 1, v241
  v_cmp_gt_i32_e64 s[88:89], 2, v241
  v_cmp_gt_i32_e64 s[90:91], 3, v241
  v_cmp_gt_i32_e64 s[92:93], 16, v241
  v_cmp_gt_i32_e64 s[94:95], 17, v241
  v_cmp_gt_i32_e64 s[96:97], 18, v241
  v_cmp_gt_i32_e64 s[98:99], 19, v241
  v_cndmask_b32_e64 v128, v128, v14, s[84:85]
  v_cndmask_b32_e64 v129, v129, v14, s[86:87]
  v_cndmask_b32_e64 v130, v130, v14, s[88:89]
  v_cndmask_b32_e64 v131, v131, v14, s[90:91]
  v_cndmask_b32_e64 v132, v132, v14, s[92:93]
  v_cndmask_b32_e64 v133, v133, v14, s[94:95]
  v_cndmask_b32_e64 v134, v134, v14, s[96:97]
  v_cndmask_b32_e64 v135, v135, v14, s[98:99]
  v_cmp_gt_i32_e64 s[84:85], 8, v241
  v_cmp_gt_i32_e64 s[86:87], 9, v241
  v_cmp_gt_i32_e64 s[88:89], 10, v241
  v_cmp_gt_i32_e64 s[90:91], 11, v241
  v_cmp_gt_i32_e64 s[92:93], 24, v241
  v_cmp_gt_i32_e64 s[94:95], 25, v241
  v_cmp_gt_i32_e64 s[96:97], 26, v241
  v_cmp_gt_i32_e64 s[98:99], 27, v241
  v_cndmask_b32_e64 v136, v136, v14, s[84:85]
  v_cndmask_b32_e64 v137, v137, v14, s[86:87]
  v_cndmask_b32_e64 v138, v138, v14, s[88:89]
  v_cndmask_b32_e64 v139, v139, v14, s[90:91]
  v_cndmask_b32_e64 v140, v140, v14, s[92:93]
  v_cndmask_b32_e64 v141, v141, v14, s[94:95]
  v_cndmask_b32_e64 v142, v142, v14, s[96:97]
  v_cndmask_b32_e64 v143, v143, v14, s[98:99]
  s_branch L_kb_kernel_d1_mask_ret
L_kb_kernel_d1_rare:
  v_mov_b32 v240, v6
  v_mov_b32 v241, v6
s_nop 1
  v_permlane32_swap_b32 v240, v241
  v_max_f32 v242, v240, v241
  v_max_f32 v242, 0, v242
  v_exp_f32 v8, -v242
  v_sub_f32 v208, v208, v242
  v_sub_f32 v209, v209, v242
  v_sub_f32 v210, v210, v242
  v_sub_f32 v211, v211, v242
  v_sub_f32 v212, v212, v242
  v_sub_f32 v213, v213, v242
  v_sub_f32 v214, v214, v242
  v_sub_f32 v215, v215, v242
  v_sub_f32 v216, v216, v242
  v_sub_f32 v217, v217, v242
  v_sub_f32 v218, v218, v242
  v_sub_f32 v219, v219, v242
  v_sub_f32 v220, v220, v242
  v_sub_f32 v221, v221, v242
  v_sub_f32 v222, v222, v242
  v_sub_f32 v223, v223, v242
  v_mul_f32 v2, v2, v8
  v_mul_f32 v3, v3, v8
  v_sub_f32 v80, v80, v242
  v_sub_f32 v81, v81, v242
  v_sub_f32 v82, v82, v242
  v_sub_f32 v83, v83, v242
  v_sub_f32 v84, v84, v242
  v_sub_f32 v85, v85, v242
  v_sub_f32 v86, v86, v242
  v_sub_f32 v87, v87, v242
  v_sub_f32 v88, v88, v242
  v_sub_f32 v89, v89, v242
  v_sub_f32 v90, v90, v242
  v_sub_f32 v91, v91, v242
  v_sub_f32 v92, v92, v242
  v_sub_f32 v93, v93, v242
  v_sub_f32 v94, v94, v242
  v_sub_f32 v95, v95, v242
  v_sub_f32 v112, v112, v242
  v_sub_f32 v113, v113, v242
  v_sub_f32 v114, v114, v242
  v_sub_f32 v115, v115, v242
  v_sub_f32 v116, v116, v242
  v_sub_f32 v117, v117, v242
  v_sub_f32 v118, v118, v242
  v_sub_f32 v119, v119, v242
  v_sub_f32 v120, v120, v242
  v_sub_f32 v121, v121, v242
  v_sub_f32 v122, v122, v242
  v_sub_f32 v123, v123, v242
  v_sub_f32 v124, v124, v242
  v_sub_f32 v125, v125, v242
  v_sub_f32 v126, v126, v242
  v_sub_f32 v127, v127, v242
  v_mov_b32 v240, v7
  v_mov_b32 v241, v7
s_nop 1
  v_permlane32_swap_b32 v240, v241
  v_max_f32 v242, v240, v241
  v_max_f32 v242, 0, v242
  v_exp_f32 v9, -v242
  v_sub_f32 v224, v224, v242
  v_sub_f32 v225, v225, v242
  v_sub_f32 v226, v226, v242
  v_sub_f32 v227, v227, v242
  v_sub_f32 v228, v228, v242
  v_sub_f32 v229, v229, v242
  v_sub_f32 v230, v230, v242
  v_sub_f32 v231, v231, v242
  v_sub_f32 v232, v232, v242
  v_sub_f32 v233, v233, v242
  v_sub_f32 v234, v234, v242
  v_sub_f32 v235, v235, v242
  v_sub_f32 v236, v236, v242
  v_sub_f32 v237, v237, v242
  v_sub_f32 v238, v238, v242
  v_sub_f32 v239, v239, v242
  v_mul_f32 v4, v4, v9
  v_mul_f32 v5, v5, v9
  v_sub_f32 v96, v96, v242
  v_sub_f32 v97, v97, v242
  v_sub_f32 v98, v98, v242
  v_sub_f32 v99, v99, v242
  v_sub_f32 v100, v100, v242
  v_sub_f32 v101, v101, v242
  v_sub_f32 v102, v102, v242
  v_sub_f32 v103, v103, v242
  v_sub_f32 v104, v104, v242
  v_sub_f32 v105, v105, v242
  v_sub_f32 v106, v106, v242
  v_sub_f32 v107, v107, v242
  v_sub_f32 v108, v108, v242
  v_sub_f32 v109, v109, v242
  v_sub_f32 v110, v110, v242
  v_sub_f32 v111, v111, v242
  v_sub_f32 v128, v128, v242
  v_sub_f32 v129, v129, v242
  v_sub_f32 v130, v130, v242
  v_sub_f32 v131, v131, v242
  v_sub_f32 v132, v132, v242
  v_sub_f32 v133, v133, v242
  v_sub_f32 v134, v134, v242
  v_sub_f32 v135, v135, v242
  v_sub_f32 v136, v136, v242
  v_sub_f32 v137, v137, v242
  v_sub_f32 v138, v138, v242
  v_sub_f32 v139, v139, v242
  v_sub_f32 v140, v140, v242
  v_sub_f32 v141, v141, v242
  v_sub_f32 v142, v142, v242
  v_sub_f32 v143, v143, v242
  s_mov_b32 s78, 1
  s_branch L_kb_kernel_d1_rare_ret
L_kb_kernel_d1_resc:
  s_nop 15
  v_accvgpr_read_b32 v240, a0
  v_accvgpr_read_b32 v241, a1
  v_accvgpr_read_b32 v242, a2
  v_accvgpr_read_b32 v243, a3
  v_accvgpr_read_b32 v244, a4
  v_accvgpr_read_b32 v245, a5
  v_accvgpr_read_b32 v246, a6
  v_accvgpr_read_b32 v247, a7
  v_mul_f32 v240, v240, v8
  v_mul_f32 v241, v241, v8
  v_mul_f32 v242, v242, v8
  v_mul_f32 v243, v243, v8
  v_mul_f32 v244, v244, v8
  v_mul_f32 v245, v245, v8
  v_mul_f32 v246, v246, v8
  v_mul_f32 v247, v247, v8
  v_accvgpr_write_b32 a0, v240
  v_accvgpr_write_b32 a1, v241
  v_accvgpr_write_b32 a2, v242
  v_accvgpr_write_b32 a3, v243
  v_accvgpr_write_b32 a4, v244
  v_accvgpr_write_b32 a5, v245
  v_accvgpr_write_b32 a6, v246
  v_accvgpr_write_b32 a7, v247
  v_accvgpr_read_b32 v240, a8
  v_accvgpr_read_b32 v241, a9
  v_accvgpr_read_b32 v242, a10
  v_accvgpr_read_b32 v243, a11
  v_accvgpr_read_b32 v244, a12
  v_accvgpr_read_b32 v245, a13
  v_accvgpr_read_b32 v246, a14
  v_accvgpr_read_b32 v247, a15
  v_mul_f32 v240, v240, v8
  v_mul_f32 v241, v241, v8
  v_mul_f32 v242, v242, v8
  v_mul_f32 v243, v243, v8
  v_mul_f32 v244, v244, v8
  v_mul_f32 v245, v245, v8
  v_mul_f32 v246, v246, v8
  v_mul_f32 v247, v247, v8
  v_accvgpr_write_b32 a8, v240
  v_accvgpr_write_b32 a9, v241
  v_accvgpr_write_b32 a10, v242
  v_accvgpr_write_b32 a11, v243
  v_accvgpr_write_b32 a12, v244
  v_accvgpr_write_b32 a13, v245
  v_accvgpr_write_b32 a14, v246
  v_accvgpr_write_b32 a15, v247
  v_accvgpr_read_b32 v240, a16
  v_accvgpr_read_b32 v241, a17
  v_accvgpr_read_b32 v242, a18
  v_accvgpr_read_b32 v243, a19
  v_accvgpr_read_b32 v244, a20
  v_accvgpr_read_b32 v245, a21
  v_accvgpr_read_b32 v246, a22
  v_accvgpr_read_b32 v247, a23
  v_mul_f32 v240, v240, v8
  v_mul_f32 v241, v241, v8
  v_mul_f32 v242, v242, v8
  v_mul_f32 v243, v243, v8
  v_mul_f32 v244, v244, v8
  v_mul_f32 v245, v245, v8
  v_mul_f32 v246, v246, v8
  v_mul_f32 v247, v247, v8
  v_accvgpr_write_b32 a16, v240
  v_accvgpr_write_b32 a17, v241
  v_accvgpr_write_b32 a18, v242
  v_accvgpr_write_b32 a19, v243
  v_accvgpr_write_b32 a20, v244
  v_accvgpr_write_b32 a21, v245
  v_accvgpr_write_b32 a22, v246
  v_accvgpr_write_b32 a23, v247
  v_accvgpr_read_b32 v240, a24
  v_accvgpr_read_b32 v241, a25
  v_accvgpr_read_b32 v242, a26
  v_accvgpr_read_b32 v243, a27
  v_accvgpr_read_b32 v244, a28
  v_accvgpr_read_b32 v245, a29
  v_accvgpr_read_b32 v246, a30
  v_accvgpr_read_b32 v247, a31
  v_mul_f32 v240, v240, v8
  v_mul_f32 v241, v241, v8
  v_mul_f32 v242, v242, v8
  v_mul_f32 v243, v243, v8
  v_mul_f32 v244, v244, v8
  v_mul_f32 v245, v245, v8
  v_mul_f32 v246, v246, v8
  v_mul_f32 v247, v247, v8
  v_accvgpr_write_b32 a24, v240
  v_accvgpr_write_b32 a25, v241
  v_accvgpr_write_b32 a26, v242
  v_accvgpr_write_b32 a27, v243
  v_accvgpr_write_b32 a28, v244
  v_accvgpr_write_b32 a29, v245
  v_accvgpr_write_b32 a30, v246
  v_accvgpr_write_b32 a31, v247
  v_accvgpr_read_b32 v240, a32
  v_accvgpr_read_b32 v241, a33
  v_accvgpr_read_b32 v242, a34
  v_accvgpr_read_b32 v243, a35
  v_accvgpr_read_b32 v244, a36
  v_accvgpr_read_b32 v245, a37
  v_accvgpr_read_b32 v246, a38
  v_accvgpr_read_b32 v247, a39
  v_mul_f32 v240, v240, v8
  v_mul_f32 v241, v241, v8
  v_mul_f32 v242, v242, v8
  v_mul_f32 v243, v243, v8
  v_mul_f32 v244, v244, v8
  v_mul_f32 v245, v245, v8
  v_mul_f32 v246, v246, v8
  v_mul_f32 v247, v247, v8
  v_accvgpr_write_b32 a32, v240
  v_accvgpr_write_b32 a33, v241
  v_accvgpr_write_b32 a34, v242
  v_accvgpr_write_b32 a35, v243
  v_accvgpr_write_b32 a36, v244
  v_accvgpr_write_b32 a37, v245
  v_accvgpr_write_b32 a38, v246
  v_accvgpr_write_b32 a39, v247
  v_accvgpr_read_b32 v240, a40
  v_accvgpr_read_b32 v241, a41
  v_accvgpr_read_b32 v242, a42
  v_accvgpr_read_b32 v243, a43
  v_accvgpr_read_b32 v244, a44
  v_accvgpr_read_b32 v245, a45
  v_accvgpr_read_b32 v246, a46
  v_accvgpr_read_b32 v247, a47
  v_mul_f32 v240, v240, v8
  v_mul_f32 v241, v241, v8
  v_mul_f32 v242, v242, v8
  v_mul_f32 v243, v243, v8
  v_mul_f32 v244, v244, v8
  v_mul_f32 v245, v245, v8
  v_mul_f32 v246, v246, v8
  v_mul_f32 v247, v247, v8
  v_accvgpr_write_b32 a40, v240
  v_accvgpr_write_b32 a41, v241
  v_accvgpr_write_b32 a42, v242
  v_accvgpr_write_b32 a43, v243
  v_accvgpr_write_b32 a44, v244
  v_accvgpr_write_b32 a45, v245
  v_accvgpr_write_b32 a46, v246
  v_accvgpr_write_b32 a47, v247
  v_accvgpr_read_b32 v240, a48
  v_accvgpr_read_b32 v241, a49
  v_accvgpr_read_b32 v242, a50
  v_accvgpr_read_b32 v243, a51
  v_accvgpr_read_b32 v244, a52
  v_accvgpr_read_b32 v245, a53
  v_accvgpr_read_b32 v246, a54
  v_accvgpr_read_b32 v247, a55
  v_mul_f32 v240, v240, v8
  v_mul_f32 v241, v241, v8
  v_mul_f32 v242, v242, v8
  v_mul_f32 v243, v243, v8
  v_mul_f32 v244, v244, v8
  v_mul_f32 v245, v245, v8
  v_mul_f32 v246, v246, v8
  v_mul_f32 v247, v247, v8
  v_accvgpr_write_b32 a48, v240
  v_accvgpr_write_b32 a49, v241
  v_accvgpr_write_b32 a50, v242
  v_accvgpr_write_b32 a51, v243
  v_accvgpr_write_b32 a52, v244
  v_accvgpr_write_b32 a53, v245
  v_accvgpr_write_b32 a54, v246
  v_accvgpr_write_b32 a55, v247
  v_accvgpr_read_b32 v240, a56
  v_accvgpr_read_b32 v241, a57
  v_accvgpr_read_b32 v242, a58
  v_accvgpr_read_b32 v243, a59
  v_accvgpr_read_b32 v244, a60
  v_accvgpr_read_b32 v245, a61
  v_accvgpr_read_b32 v246, a62
  v_accvgpr_read_b32 v247, a63
  v_mul_f32 v240, v240, v8
  v_mul_f32 v241, v241, v8
  v_mul_f32 v242, v242, v8
  v_mul_f32 v243, v243, v8
  v_mul_f32 v244, v244, v8
  v_mul_f32 v245, v245, v8
  v_mul_f32 v246, v246, v8
  v_mul_f32 v247, v247, v8
  v_accvgpr_write_b32 a56, v240
  v_accvgpr_write_b32 a57, v241
  v_accvgpr_write_b32 a58, v242
  v_accvgpr_write_b32 a59, v243
  v_accvgpr_write_b32 a60, v244
  v_accvgpr_write_b32 a61, v245
  v_accvgpr_write_b32 a62, v246
  v_accvgpr_write_b32 a63, v247
  v_accvgpr_read_b32 v240, a64
  v_accvgpr_read_b32 v241, a65
  v_accvgpr_read_b32 v242, a66
  v_accvgpr_read_b32 v243, a67
  v_accvgpr_read_b32 v244, a68
  v_accvgpr_read_b32 v245, a69
  v_accvgpr_read_b32 v246, a70
  v_accvgpr_read_b32 v247, a71
  v_mul_f32 v240, v240, v9
  v_mul_f32 v241, v241, v9
  v_mul_f32 v242, v242, v9
  v_mul_f32 v243, v243, v9
  v_mul_f32 v244, v244, v9
  v_mul_f32 v245, v245, v9
  v_mul_f32 v246, v246, v9
  v_mul_f32 v247, v247, v9
  v_accvgpr_write_b32 a64, v240
  v_accvgpr_write_b32 a65, v241
  v_accvgpr_write_b32 a66, v242
  v_accvgpr_write_b32 a67, v243
  v_accvgpr_write_b32 a68, v244
  v_accvgpr_write_b32 a69, v245
  v_accvgpr_write_b32 a70, v246
  v_accvgpr_write_b32 a71, v247
  v_accvgpr_read_b32 v240, a72
  v_accvgpr_read_b32 v241, a73
  v_accvgpr_read_b32 v242, a74
  v_accvgpr_read_b32 v243, a75
  v_accvgpr_read_b32 v244, a76
  v_accvgpr_read_b32 v245, a77
  v_accvgpr_read_b32 v246, a78
  v_accvgpr_read_b32 v247, a79
  v_mul_f32 v240, v240, v9
  v_mul_f32 v241, v241, v9
  v_mul_f32 v242, v242, v9
  v_mul_f32 v243, v243, v9
  v_mul_f32 v244, v244, v9
  v_mul_f32 v245, v245, v9
  v_mul_f32 v246, v246, v9
  v_mul_f32 v247, v247, v9
  v_accvgpr_write_b32 a72, v240
  v_accvgpr_write_b32 a73, v241
  v_accvgpr_write_b32 a74, v242
  v_accvgpr_write_b32 a75, v243
  v_accvgpr_write_b32 a76, v244
  v_accvgpr_write_b32 a77, v245
  v_accvgpr_write_b32 a78, v246
  v_accvgpr_write_b32 a79, v247
  v_accvgpr_read_b32 v240, a80
  v_accvgpr_read_b32 v241, a81
  v_accvgpr_read_b32 v242, a82
  v_accvgpr_read_b32 v243, a83
  v_accvgpr_read_b32 v244, a84
  v_accvgpr_read_b32 v245, a85
  v_accvgpr_read_b32 v246, a86
  v_accvgpr_read_b32 v247, a87
  v_mul_f32 v240, v240, v9
  v_mul_f32 v241, v241, v9
  v_mul_f32 v242, v242, v9
  v_mul_f32 v243, v243, v9
  v_mul_f32 v244, v244, v9
  v_mul_f32 v245, v245, v9
  v_mul_f32 v246, v246, v9
  v_mul_f32 v247, v247, v9
  v_accvgpr_write_b32 a80, v240
  v_accvgpr_write_b32 a81, v241
  v_accvgpr_write_b32 a82, v242
  v_accvgpr_write_b32 a83, v243
  v_accvgpr_write_b32 a84, v244
  v_accvgpr_write_b32 a85, v245
  v_accvgpr_write_b32 a86, v246
  v_accvgpr_write_b32 a87, v247
  v_accvgpr_read_b32 v240, a88
  v_accvgpr_read_b32 v241, a89
  v_accvgpr_read_b32 v242, a90
  v_accvgpr_read_b32 v243, a91
  v_accvgpr_read_b32 v244, a92
  v_accvgpr_read_b32 v245, a93
  v_accvgpr_read_b32 v246, a94
  v_accvgpr_read_b32 v247, a95
  v_mul_f32 v240, v240, v9
  v_mul_f32 v241, v241, v9
  v_mul_f32 v242, v242, v9
  v_mul_f32 v243, v243, v9
  v_mul_f32 v244, v244, v9
  v_mul_f32 v245, v245, v9
  v_mul_f32 v246, v246, v9
  v_mul_f32 v247, v247, v9
  v_accvgpr_write_b32 a88, v240
  v_accvgpr_write_b32 a89, v241
  v_accvgpr_write_b32 a90, v242
  v_accvgpr_write_b32 a91, v243
  v_accvgpr_write_b32 a92, v244
  v_accvgpr_write_b32 a93, v245
  v_accvgpr_write_b32 a94, v246
  v_accvgpr_write_b32 a95, v247
  v_accvgpr_read_b32 v240, a96
  v_accvgpr_read_b32 v241, a97
  v_accvgpr_read_b32 v242, a98
  v_accvgpr_read_b32 v243, a99
  v_accvgpr_read_b32 v244, a100
  v_accvgpr_read_b32 v245, a101
  v_accvgpr_read_b32 v246, a102
  v_accvgpr_read_b32 v247, a103
  v_mul_f32 v240, v240, v9
  v_mul_f32 v241, v241, v9
  v_mul_f32 v242, v242, v9
  v_mul_f32 v243, v243, v9
  v_mul_f32 v244, v244, v9
  v_mul_f32 v245, v245, v9
  v_mul_f32 v246, v246, v9
  v_mul_f32 v247, v247, v9
  v_accvgpr_write_b32 a96, v240
  v_accvgpr_write_b32 a97, v241
  v_accvgpr_write_b32 a98, v242
  v_accvgpr_write_b32 a99, v243
  v_accvgpr_write_b32 a100, v244
  v_accvgpr_write_b32 a101, v245
  v_accvgpr_write_b32 a102, v246
  v_accvgpr_write_b32 a103, v247
  v_accvgpr_read_b32 v240, a104
  v_accvgpr_read_b32 v241, a105
  v_accvgpr_read_b32 v242, a106
  v_accvgpr_read_b32 v243, a107
  v_accvgpr_read_b32 v244, a108
  v_accvgpr_read_b32 v245, a109
  v_accvgpr_read_b32 v246, a110
  v_accvgpr_read_b32 v247, a111
  v_mul_f32 v240, v240, v9
  v_mul_f32 v241, v241, v9
  v_mul_f32 v242, v242, v9
  v_mul_f32 v243, v243, v9
  v_mul_f32 v244, v244, v9
  v_mul_f32 v245, v245, v9
  v_mul_f32 v246, v246, v9
  v_mul_f32 v247, v247, v9
  v_accvgpr_write_b32 a104, v240
  v_accvgpr_write_b32 a105, v241
  v_accvgpr_write_b32 a106, v242
  v_accvgpr_write_b32 a107, v243
  v_accvgpr_write_b32 a108, v244
  v_accvgpr_write_b32 a109, v245
  v_accvgpr_write_b32 a110, v246
  v_accvgpr_write_b32 a111, v247
  v_accvgpr_read_b32 v240, a112
  v_accvgpr_read_b32 v241, a113
  v_accvgpr_read_b32 v242, a114
  v_accvgpr_read_b32 v243, a115
  v_accvgpr_read_b32 v244, a116
  v_accvgpr_read_b32 v245, a117
  v_accvgpr_read_b32 v246, a118
  v_accvgpr_read_b32 v247, a119
  v_mul_f32 v240, v240, v9
  v_mul_f32 v241, v241, v9
  v_mul_f32 v242, v242, v9
  v_mul_f32 v243, v243, v9
  v_mul_f32 v244, v244, v9
  v_mul_f32 v245, v245, v9
  v_mul_f32 v246, v246, v9
  v_mul_f32 v247, v247, v9
  v_accvgpr_write_b32 a112, v240
  v_accvgpr_write_b32 a113, v241
  v_accvgpr_write_b32 a114, v242
  v_accvgpr_write_b32 a115, v243
  v_accvgpr_write_b32 a116, v244
  v_accvgpr_write_b32 a117, v245
  v_accvgpr_write_b32 a118, v246
  v_accvgpr_write_b32 a119, v247
  v_accvgpr_read_b32 v240, a120
  v_accvgpr_read_b32 v241, a121
  v_accvgpr_read_b32 v242, a122
  v_accvgpr_read_b32 v243, a123
  v_accvgpr_read_b32 v244, a124
  v_accvgpr_read_b32 v245, a125
  v_accvgpr_read_b32 v246, a126
  v_accvgpr_read_b32 v247, a127
  v_mul_f32 v240, v240, v9
  v_mul_f32 v241, v241, v9
  v_mul_f32 v242, v242, v9
  v_mul_f32 v243, v243, v9
  v_mul_f32 v244, v244, v9
  v_mul_f32 v245, v245, v9
  v_mul_f32 v246, v246, v9
  v_mul_f32 v247, v247, v9
  v_accvgpr_write_b32 a120, v240
  v_accvgpr_write_b32 a121, v241
  v_accvgpr_write_b32 a122, v242
  v_accvgpr_write_b32 a123, v243
  v_accvgpr_write_b32 a124, v244
  v_accvgpr_write_b32 a125, v245
  v_accvgpr_write_b32 a126, v246
  v_accvgpr_write_b32 a127, v247
  s_mov_b32 s78, 0
  s_nop 1
  s_branch L_kb_kernel_d1_resc_ret
L_kb_kernel_mx_mask:
  s_nop 7
  s_lshl_b32 s81, s80, 1
  s_sub_u32 s81, s3, s81
  s_lshl_b32 s81, s81, 5
  v_add_u32 v240, s81, v13
  v_add_u32 v241, -32, v240
  v_cmp_gt_i32_e64 s[84:85], 0, v240
  v_cmp_gt_i32_e64 s[86:87], 1, v240
  v_cmp_gt_i32_e64 s[88:89], 2, v240
  v_cmp_gt_i32_e64 s[90:91], 3, v240
  v_cmp_gt_i32_e64 s[92:93], 16, v240
  v_cmp_gt_i32_e64 s[94:95], 17, v240
  v_cmp_gt_i32_e64 s[96:97], 18, v240
  v_cmp_gt_i32_e64 s[98:99], 19, v240
  v_cndmask_b32_e64 v80, v80, v14, s[84:85]
  v_cndmask_b32_e64 v81, v81, v14, s[86:87]
  v_cndmask_b32_e64 v82, v82, v14, s[88:89]
  v_cndmask_b32_e64 v83, v83, v14, s[90:91]
  v_cndmask_b32_e64 v84, v84, v14, s[92:93]
  v_cndmask_b32_e64 v85, v85, v14, s[94:95]
  v_cndmask_b32_e64 v86, v86, v14, s[96:97]
  v_cndmask_b32_e64 v87, v87, v14, s[98:99]
  v_cmp_gt_i32_e64 s[84:85], 8, v240
  v_cmp_gt_i32_e64 s[86:87], 9, v240
  v_cmp_gt_i32_e64 s[88:89], 10, v240
  v_cmp_gt_i32_e64 s[90:91], 11, v240
  v_cmp_gt_i32_e64 s[92:93], 24, v240
  v_cmp_gt_i32_e64 s[94:95], 25, v240
  v_cmp_gt_i32_e64 s[96:97], 26, v240
  v_cmp_gt_i32_e64 s[98:99], 27, v240
  v_cndmask_b32_e64 v88, v88, v14, s[84:85]
  v_cndmask_b32_e64 v89, v89, v14, s[86:87]
  v_cndmask_b32_e64 v90, v90, v14, s[88:89]
  v_cndmask_b32_e64 v91, v91, v14, s[90:91]
  v_cndmask_b32_e64 v92, v92, v14, s[92:93]
  v_cndmask_b32_e64 v93, v93, v14, s[94:95]
  v_cndmask_b32_e64 v94, v94, v14, s[96:97]
  v_cndmask_b32_e64 v95, v95, v14, s[98:99]
  v_cmp_gt_i32_e64 s[84:85], 0, v241
  v_cmp_gt_i32_e64 s[86:87], 1, v241
  v_cmp_gt_i32_e64 s[88:89], 2, v241
  v_cmp_gt_i32_e64 s[90:91], 3, v241
  v_cmp_gt_i32_e64 s[92:93], 16, v241
  v_cmp_gt_i32_e64 s[94:95], 17, v241
  v_cmp_gt_i32_e64 s[96:97], 18, v241
  v_cmp_gt_i32_e64 s[98:99], 19, v241
  v_cndmask_b32_e64 v112, v112, v14, s[84:85]
  v_cndmask_b32_e64 v113, v113, v14, s[86:87]
  v_cndmask_b32_e64 v114, v114, v14, s[88:89]
  v_cndmask_b32_e64 v115, v115, v14, s[90:91]
  v_cndmask_b32_e64 v116, v116, v14, s[92:93]
  v_cndmask_b32_e64 v117, v117, v14, s[94:95]
  v_cndmask_b32_e64 v118, v118, v14, s[96:97]
  v_cndmask_b32_e64 v119, v119, v14, s[98:99]
  v_cmp_gt_i32_e64 s[84:85], 8, v241
  v_cmp_gt_i32_e64 s[86:87], 9, v241
  v_cmp_gt_i32_e64 s[88:89], 10, v241
  v_cmp_gt_i32_e64 s[90:91], 11, v241
  v_cmp_gt_i32_e64 s[92:93], 24, v241
  v_cmp_gt_i32_e64 s[94:95], 25, v241
  v_cmp_gt_i32_e64 s[96:97], 26, v241
  v_cmp_gt_i32_e64 s[98:99], 27, v241
  v_cndmask_b32_e64 v120, v120, v14, s[84:85]
  v_cndmask_b32_e64 v121, v121, v14, s[86:87]
  v_cndmask_b32_e64 v122, v122, v14, s[88:89]
  v_cndmask_b32_e64 v123, v123, v14, s[90:91]
  v_cndmask_b32_e64 v124, v124, v14, s[92:93]
  v_cndmask_b32_e64 v125, v125, v14, s[94:95]
  v_cndmask_b32_e64 v126, v126, v14, s[96:97]
  v_cndmask_b32_e64 v127, v127, v14, s[98:99]
  s_branch L_kb_kernel_mx_mask_ret
L_kb_kernel_mx_rare:
  v_mov_b32 v240, v6
  v_mov_b32 v241, v6
s_nop 1
  v_permlane32_swap_b32 v240, v241
  v_max_f32 v242, v240, v241
  v_max_f32 v242, 0, v242
  v_exp_f32 v8, -v242
  v_sub_f32 v208, v208, v242
  v_sub_f32 v209, v209, v242
  v_sub_f32 v210, v210, v242
  v_sub_f32 v211, v211, v242
  v_sub_f32 v212, v212, v242
  v_sub_f32 v213, v213, v242
  v_sub_f32 v214, v214, v242
  v_sub_f32 v215, v215, v242
  v_sub_f32 v216, v216, v242
  v_sub_f32 v217, v217, v242
  v_sub_f32 v218, v218, v242
  v_sub_f32 v219, v219, v242
  v_sub_f32 v220, v220, v242
  v_sub_f32 v221, v221, v242
  v_sub_f32 v222, v222, v242
  v_sub_f32 v223, v223, v242
  v_mul_f32 v2, v2, v8
  v_mul_f32 v3, v3, v8
  v_sub_f32 v80, v80, v242
  v_sub_f32 v81, v81, v242
  v_sub_f32 v82, v82, v242
  v_sub_f32 v83, v83, v242
  v_sub_f32 v84, v84, v242
  v_sub_f32 v85, v85, v242
  v_sub_f32 v86, v86, v242
  v_sub_f32 v87, v87, v242
  v_sub_f32 v88, v88, v242
  v_sub_f32 v89, v89, v242
  v_sub_f32 v90, v90, v242
  v_sub_f32 v91, v91, v242
  v_sub_f32 v92, v92, v242
  v_sub_f32 v93, v93, v242
  v_sub_f32 v94, v94, v242
  v_sub_f32 v95, v95, v242
  v_sub_f32 v112, v112, v242
  v_sub_f32 v113, v113, v242
  v_sub_f32 v114, v114, v242
  v_sub_f32 v115, v115, v242
  v_sub_f32 v116, v116, v242
  v_sub_f32 v117, v117, v242
  v_sub_f32 v118, v118, v242
  v_sub_f32 v119, v119, v242
  v_sub_f32 v120, v120, v242
  v_sub_f32 v121, v121, v242
  v_sub_f32 v122, v122, v242
  v_sub_f32 v123, v123, v242
  v_sub_f32 v124, v124, v242
  v_sub_f32 v125, v125, v242
  v_sub_f32 v126, v126, v242
  v_sub_f32 v127, v127, v242
  s_mov_b32 s78, 1
  s_branch L_kb_kernel_mx_rare_ret
L_kb_kernel_mx_resc:
  s_nop 15
  v_accvgpr_read_b32 v240, a0
  v_accvgpr_read_b32 v241, a1
  v_accvgpr_read_b32 v242, a2
  v_accvgpr_read_b32 v243, a3
  v_accvgpr_read_b32 v244, a4
  v_accvgpr_read_b32 v245, a5
  v_accvgpr_read_b32 v246, a6
  v_accvgpr_read_b32 v247, a7
  v_mul_f32 v240, v240, v8
  v_mul_f32 v241, v241, v8
  v_mul_f32 v242, v242, v8
  v_mul_f32 v243, v243, v8
  v_mul_f32 v244, v244, v8
  v_mul_f32 v245, v245, v8
  v_mul_f32 v246, v246, v8
  v_mul_f32 v247, v247, v8
  v_accvgpr_write_b32 a0, v240
  v_accvgpr_write_b32 a1, v241
  v_accvgpr_write_b32 a2, v242
  v_accvgpr_write_b32 a3, v243
  v_accvgpr_write_b32 a4, v244
  v_accvgpr_write_b32 a5, v245
  v_accvgpr_write_b32 a6, v246
  v_accvgpr_write_b32 a7, v247
  v_accvgpr_read_b32 v240, a8
  v_accvgpr_read_b32 v241, a9
  v_accvgpr_read_b32 v242, a10
  v_accvgpr_read_b32 v243, a11
  v_accvgpr_read_b32 v244, a12
  v_accvgpr_read_b32 v245, a13
  v_accvgpr_read_b32 v246, a14
  v_accvgpr_read_b32 v247, a15
  v_mul_f32 v240, v240, v8
  v_mul_f32 v241, v241, v8
  v_mul_f32 v242, v242, v8
  v_mul_f32 v243, v243, v8
  v_mul_f32 v244, v244, v8
  v_mul_f32 v245, v245, v8
  v_mul_f32 v246, v246, v8
  v_mul_f32 v247, v247, v8
  v_accvgpr_write_b32 a8, v240
  v_accvgpr_write_b32 a9, v241
  v_accvgpr_write_b32 a10, v242
  v_accvgpr_write_b32 a11, v243
  v_accvgpr_write_b32 a12, v244
  v_accvgpr_write_b32 a13, v245
  v_accvgpr_write_b32 a14, v246
  v_accvgpr_write_b32 a15, v247
  v_accvgpr_read_b32 v240, a16
  v_accvgpr_read_b32 v241, a17
  v_accvgpr_read_b32 v242, a18
  v_accvgpr_read_b32 v243, a19
  v_accvgpr_read_b32 v244, a20
  v_accvgpr_read_b32 v245, a21
  v_accvgpr_read_b32 v246, a22
  v_accvgpr_read_b32 v247, a23
  v_mul_f32 v240, v240, v8
  v_mul_f32 v241, v241, v8
  v_mul_f32 v242, v242, v8
  v_mul_f32 v243, v243, v8
  v_mul_f32 v244, v244, v8
  v_mul_f32 v245, v245, v8
  v_mul_f32 v246, v246, v8
  v_mul_f32 v247, v247, v8
  v_accvgpr_write_b32 a16, v240
  v_accvgpr_write_b32 a17, v241
  v_accvgpr_write_b32 a18, v242
  v_accvgpr_write_b32 a19, v243
  v_accvgpr_write_b32 a20, v244
  v_accvgpr_write_b32 a21, v245
  v_accvgpr_write_b32 a22, v246
  v_accvgpr_write_b32 a23, v247
  v_accvgpr_read_b32 v240, a24
  v_accvgpr_read_b32 v241, a25
  v_accvgpr_read_b32 v242, a26
  v_accvgpr_read_b32 v243, a27
  v_accvgpr_read_b32 v244, a28
  v_accvgpr_read_b32 v245, a29
  v_accvgpr_read_b32 v246, a30
  v_accvgpr_read_b32 v247, a31
  v_mul_f32 v240, v240, v8
  v_mul_f32 v241, v241, v8
  v_mul_f32 v242, v242, v8
  v_mul_f32 v243, v243, v8
  v_mul_f32 v244, v244, v8
  v_mul_f32 v245, v245, v8
  v_mul_f32 v246, v246, v8
  v_mul_f32 v247, v247, v8
  v_accvgpr_write_b32 a24, v240
  v_accvgpr_write_b32 a25, v241
  v_accvgpr_write_b32 a26, v242
  v_accvgpr_write_b32 a27, v243
  v_accvgpr_write_b32 a28, v244
  v_accvgpr_write_b32 a29, v245
  v_accvgpr_write_b32 a30, v246
  v_accvgpr_write_b32 a31, v247
  v_accvgpr_read_b32 v240, a32
  v_accvgpr_read_b32 v241, a33
  v_accvgpr_read_b32 v242, a34
  v_accvgpr_read_b32 v243, a35
  v_accvgpr_read_b32 v244, a36
  v_accvgpr_read_b32 v245, a37
  v_accvgpr_read_b32 v246, a38
  v_accvgpr_read_b32 v247, a39
  v_mul_f32 v240, v240, v8
  v_mul_f32 v241, v241, v8
  v_mul_f32 v242, v242, v8
  v_mul_f32 v243, v243, v8
  v_mul_f32 v244, v244, v8
  v_mul_f32 v245, v245, v8
  v_mul_f32 v246, v246, v8
  v_mul_f32 v247, v247, v8
  v_accvgpr_write_b32 a32, v240
  v_accvgpr_write_b32 a33, v241
  v_accvgpr_write_b32 a34, v242
  v_accvgpr_write_b32 a35, v243
  v_accvgpr_write_b32 a36, v244
  v_accvgpr_write_b32 a37, v245
  v_accvgpr_write_b32 a38, v246
  v_accvgpr_write_b32 a39, v247
  v_accvgpr_read_b32 v240, a40
  v_accvgpr_read_b32 v241, a41
  v_accvgpr_read_b32 v242, a42
  v_accvgpr_read_b32 v243, a43
  v_accvgpr_read_b32 v244, a44
  v_accvgpr_read_b32 v245, a45
  v_accvgpr_read_b32 v246, a46
  v_accvgpr_read_b32 v247, a47
  v_mul_f32 v240, v240, v8
  v_mul_f32 v241, v241, v8
  v_mul_f32 v242, v242, v8
  v_mul_f32 v243, v243, v8
  v_mul_f32 v244, v244, v8
  v_mul_f32 v245, v245, v8
  v_mul_f32 v246, v246, v8
  v_mul_f32 v247, v247, v8
  v_accvgpr_write_b32 a40, v240
  v_accvgpr_write_b32 a41, v241
  v_accvgpr_write_b32 a42, v242
  v_accvgpr_write_b32 a43, v243
  v_accvgpr_write_b32 a44, v244
  v_accvgpr_write_b32 a45, v245
  v_accvgpr_write_b32 a46, v246
  v_accvgpr_write_b32 a47, v247
  v_accvgpr_read_b32 v240, a48
  v_accvgpr_read_b32 v241, a49
  v_accvgpr_read_b32 v242, a50
  v_accvgpr_read_b32 v243, a51
  v_accvgpr_read_b32 v244, a52
  v_accvgpr_read_b32 v245, a53
  v_accvgpr_read_b32 v246, a54
  v_accvgpr_read_b32 v247, a55
  v_mul_f32 v240, v240, v8
  v_mul_f32 v241, v241, v8
  v_mul_f32 v242, v242, v8
  v_mul_f32 v243, v243, v8
  v_mul_f32 v244, v244, v8
  v_mul_f32 v245, v245, v8
  v_mul_f32 v246, v246, v8
  v_mul_f32 v247, v247, v8
  v_accvgpr_write_b32 a48, v240
  v_accvgpr_write_b32 a49, v241
  v_accvgpr_write_b32 a50, v242
  v_accvgpr_write_b32 a51, v243
  v_accvgpr_write_b32 a52, v244
  v_accvgpr_write_b32 a53, v245
  v_accvgpr_write_b32 a54, v246
  v_accvgpr_write_b32 a55, v247
  v_accvgpr_read_b32 v240, a56
  v_accvgpr_read_b32 v241, a57
  v_accvgpr_read_b32 v242, a58
  v_accvgpr_read_b32 v243, a59
  v_accvgpr_read_b32 v244, a60
  v_accvgpr_read_b32 v245, a61
  v_accvgpr_read_b32 v246, a62
  v_accvgpr_read_b32 v247, a63
  v_mul_f32 v240, v240, v8
  v_mul_f32 v241, v241, v8
  v_mul_f32 v242, v242, v8
  v_mul_f32 v243, v243, v8
  v_mul_f32 v244, v244, v8
  v_mul_f32 v245, v245, v8
  v_mul_f32 v246, v246, v8
  v_mul_f32 v247, v247, v8
  v_accvgpr_write_b32 a56, v240
  v_accvgpr_write_b32 a57, v241
  v_accvgpr_write_b32 a58, v242
  v_accvgpr_write_b32 a59, v243
  v_accvgpr_write_b32 a60, v244
  v_accvgpr_write_b32 a61, v245
  v_accvgpr_write_b32 a62, v246
  v_accvgpr_write_b32 a63, v247
  s_mov_b32 s78, 0
  s_nop 1
  s_branch L_kb_kernel_mx_resc_ret
L_kb_kernel_s0_mask:
  s_nop 7
  s_lshl_b32 s81, s80, 1
  s_sub_u32 s81, s3, s81
  s_lshl_b32 s81, s81, 5
  v_add_u32 v240, s81, v13
  v_add_u32 v241, -32, v240
  v_cmp_gt_i32_e64 s[84:85], 0, v240
  v_cmp_gt_i32_e64 s[86:87], 1, v240
  v_cmp_gt_i32_e64 s[88:89], 2, v240
  v_cmp_gt_i32_e64 s[90:91], 3, v240
  v_cmp_gt_i32_e64 s[92:93], 16, v240
  v_cmp_gt_i32_e64 s[94:95], 17, v240
  v_cmp_gt_i32_e64 s[96:97], 18, v240
  v_cmp_gt_i32_e64 s[98:99], 19, v240
  v_cndmask_b32_e64 v144, v144, v14, s[84:85]
  v_cndmask_b32_e64 v145, v145, v14, s[86:87]
  v_cndmask_b32_e64 v146, v146, v14, s[88:89]
  v_cndmask_b32_e64 v147, v147, v14, s[90:91]
  v_cndmask_b32_e64 v148, v148, v14, s[92:93]
  v_cndmask_b32_e64 v149, v149, v14, s[94:95]
  v_cndmask_b32_e64 v150, v150, v14, s[96:97]
  v_cndmask_b32_e64 v151, v151, v14, s[98:99]
  v_cmp_gt_i32_e64 s[84:85], 8, v240
  v_cmp_gt_i32_e64 s[86:87], 9, v240
  v_cmp_gt_i32_e64 s[88:89], 10, v240
  v_cmp_gt_i32_e64 s[90:91], 11, v240
  v_cmp_gt_i32_e64 s[92:93], 24, v240
  v_cmp_gt_i32_e64 s[94:95], 25, v240
  v_cmp_gt_i32_e64 s[96:97], 26, v240
  v_cmp_gt_i32_e64 s[98:99], 27, v240
  v_cndmask_b32_e64 v152, v152, v14, s[84:85]
  v_cndmask_b32_e64 v153, v153, v14, s[86:87]
  v_cndmask_b32_e64 v154, v154, v14, s[88:89]
  v_cndmask_b32_e64 v155, v155, v14, s[90:91]
  v_cndmask_b32_e64 v156, v156, v14, s[92:93]
  v_cndmask_b32_e64 v157, v157, v14, s[94:95]
  v_cndmask_b32_e64 v158, v158, v14, s[96:97]
  v_cndmask_b32_e64 v159, v159, v14, s[98:99]
  v_cmp_gt_i32_e64 s[84:85], 0, v241
  v_cmp_gt_i32_e64 s[86:87], 1, v241
  v_cmp_gt_i32_e64 s[88:89], 2, v241
  v_cmp_gt_i32_e64 s[90:91], 3, v241
  v_cmp_gt_i32_e64 s[92:93], 16, v241
  v_cmp_gt_i32_e64 s[94:95], 17, v241
  v_cmp_gt_i32_e64 s[96:97], 18, v241
  v_cmp_gt_i32_e64 s[98:99], 19, v241
  v_cndmask_b32_e64 v176, v176, v14, s[84:85]
  v_cndmask_b32_e64 v177, v177, v14, s[86:87]
  v_cndmask_b32_e64 v178, v178, v14, s[88:89]
  v_cndmask_b32_e64 v179, v179, v14, s[90:91]
  v_cndmask_b32_e64 v180, v180, v14, s[92:93]
  v_cndmask_b32_e64 v181, v181, v14, s[94:95]
  v_cndmask_b32_e64 v182, v182, v14, s[96:97]
  v_cndmask_b32_e64 v183, v183, v14, s[98:99]
  v_cmp_gt_i32_e64 s[84:85], 8, v241
  v_cmp_gt_i32_e64 s[86:87], 9, v241
  v_cmp_gt_i32_e64 s[88:89], 10, v241
  v_cmp_gt_i32_e64 s[90:91], 11, v241
  v_cmp_gt_i32_e64 s[92:93], 24, v241
  v_cmp_gt_i32_e64 s[94:95], 25, v241
  v_cmp_gt_i32_e64 s[96:97], 26, v241
  v_cmp_gt_i32_e64 s[98:99], 27, v241
  v_cndmask_b32_e64 v184, v184, v14, s[84:85]
  v_cndmask_b32_e64 v185, v185, v14, s[86:87]
  v_cndmask_b32_e64 v186, v186, v14, s[88:89]
  v_cndmask_b32_e64 v187, v187, v14, s[90:91]
  v_cndmask_b32_e64 v188, v188, v14, s[92:93]
  v_cndmask_b32_e64 v189, v189, v14, s[94:95]
  v_cndmask_b32_e64 v190, v190, v14, s[96:97]
  v_cndmask_b32_e64 v191, v191, v14, s[98:99]
  s_branch L_kb_kernel_s0_mask_ret
L_kb_kernel_s0_rare:
  v_mov_b32 v240, v6
  v_mov_b32 v241, v6
s_nop 1
  v_permlane32_swap_b32 v240, v241
  v_max_f32 v242, v240, v241
  v_max_f32 v242, 0, v242
  v_exp_f32 v8, -v242
  v_sub_f32 v208, v208, v242
  v_sub_f32 v209, v209, v242
  v_sub_f32 v210, v210, v242
  v_sub_f32 v211, v211, v242
  v_sub_f32 v212, v212, v242
  v_sub_f32 v213, v213, v242
  v_sub_f32 v214, v214, v242
  v_sub_f32 v215, v215, v242
  v_sub_f32 v216, v216, v242
  v_sub_f32 v217, v217, v242
  v_sub_f32 v218, v218, v242
  v_sub_f32 v219, v219, v242
  v_sub_f32 v220, v220, v242
  v_sub_f32 v221, v221, v242
  v_sub_f32 v222, v222, v242
  v_sub_f32 v223, v223, v242
  v_mul_f32 v2, v2, v8
  v_mul_f32 v3, v3, v8
  v_sub_f32 v144, v144, v242
  v_sub_f32 v145, v145, v242
  v_sub_f32 v146, v146, v242
  v_sub_f32 v147, v147, v242
  v_sub_f32 v148, v148, v242
  v_sub_f32 v149, v149, v242
  v_sub_f32 v150, v150, v242
  v_sub_f32 v151, v151, v242
  v_sub_f32 v152, v152, v242
  v_sub_f32 v153, v153, v242
  v_sub_f32 v154, v154, v242
  v_sub_f32 v155, v155, v242
  v_sub_f32 v156, v156, v242
  v_sub_f32 v157, v157, v242
  v_sub_f32 v158, v158, v242
  v_sub_f32 v159, v159, v242
  v_sub_f32 v176, v176, v242
  v_sub_f32 v177, v177, v242
  v_sub_f32 v178, v178, v242
  v_sub_f32 v179, v179, v242
  v_sub_f32 v180, v180, v242
  v_sub_f32 v181, v181, v242
  v_sub_f32 v182, v182, v242
  v_sub_f32 v183, v183, v242
  v_sub_f32 v184, v184, v242
  v_sub_f32 v185, v185, v242
  v_sub_f32 v186, v186, v242
  v_sub_f32 v187, v187, v242
  v_sub_f32 v188, v188, v242
  v_sub_f32 v189, v189, v242
  v_sub_f32 v190, v190, v242
  v_sub_f32 v191, v191, v242
  s_mov_b32 s78, 1
  s_branch L_kb_kernel_s0_rare_ret
L_kb_kernel_s0_resc:
  s_nop 15
  v_accvgpr_read_b32 v240, a0
  v_accvgpr_read_b32 v241, a1
  v_accvgpr_read_b32 v242, a2
  v_accvgpr_read_b32 v243, a3
  v_accvgpr_read_b32 v244, a4
  v_accvgpr_read_b32 v245, a5
  v_accvgpr_read_b32 v246, a6
  v_accvgpr_read_b32 v247, a7
  v_mul_f32 v240, v240, v8
  v_mul_f32 v241, v241, v8
  v_mul_f32 v242, v242, v8
  v_mul_f32 v243, v243, v8
  v_mul_f32 v244, v244, v8
  v_mul_f32 v245, v245, v8
  v_mul_f32 v246, v246, v8
  v_mul_f32 v247, v247, v8
  v_accvgpr_write_b32 a0, v240
  v_accvgpr_write_b32 a1, v241
  v_accvgpr_write_b32 a2, v242
  v_accvgpr_write_b32 a3, v243
  v_accvgpr_write_b32 a4, v244
  v_accvgpr_write_b32 a5, v245
  v_accvgpr_write_b32 a6, v246
  v_accvgpr_write_b32 a7, v247
  v_accvgpr_read_b32 v240, a8
  v_accvgpr_read_b32 v241, a9
  v_accvgpr_read_b32 v242, a10
  v_accvgpr_read_b32 v243, a11
  v_accvgpr_read_b32 v244, a12
  v_accvgpr_read_b32 v245, a13
  v_accvgpr_read_b32 v246, a14
  v_accvgpr_read_b32 v247, a15
  v_mul_f32 v240, v240, v8
  v_mul_f32 v241, v241, v8
  v_mul_f32 v242, v242, v8
  v_mul_f32 v243, v243, v8
  v_mul_f32 v244, v244, v8
  v_mul_f32 v245, v245, v8
  v_mul_f32 v246, v246, v8
  v_mul_f32 v247, v247, v8
  v_accvgpr_write_b32 a8, v240
  v_accvgpr_write_b32 a9, v241
  v_accvgpr_write_b32 a10, v242
  v_accvgpr_write_b32 a11, v243
  v_accvgpr_write_b32 a12, v244
  v_accvgpr_write_b32 a13, v245
  v_accvgpr_write_b32 a14, v246
  v_accvgpr_write_b32 a15, v247
  v_accvgpr_read_b32 v240, a16
  v_accvgpr_read_b32 v241, a17
  v_accvgpr_read_b32 v242, a18
  v_accvgpr_read_b32 v243, a19
  v_accvgpr_read_b32 v244, a20
  v_accvgpr_read_b32 v245, a21
  v_accvgpr_read_b32 v246, a22
  v_accvgpr_read_b32 v247, a23
  v_mul_f32 v240, v240, v8
  v_mul_f32 v241, v241, v8
  v_mul_f32 v242, v242, v8
  v_mul_f32 v243, v243, v8
  v_mul_f32 v244, v244, v8
  v_mul_f32 v245, v245, v8
  v_mul_f32 v246, v246, v8
  v_mul_f32 v247, v247, v8
  v_accvgpr_write_b32 a16, v240
  v_accvgpr_write_b32 a17, v241
  v_accvgpr_write_b32 a18, v242
  v_accvgpr_write_b32 a19, v243
  v_accvgpr_write_b32 a20, v244
  v_accvgpr_write_b32 a21, v245
  v_accvgpr_write_b32 a22, v246
  v_accvgpr_write_b32 a23, v247
  v_accvgpr_read_b32 v240, a24
  v_accvgpr_read_b32 v241, a25
  v_accvgpr_read_b32 v242, a26
  v_accvgpr_read_b32 v243, a27
  v_accvgpr_read_b32 v244, a28
  v_accvgpr_read_b32 v245, a29
  v_accvgpr_read_b32 v246, a30
  v_accvgpr_read_b32 v247, a31
  v_mul_f32 v240, v240, v8
  v_mul_f32 v241, v241, v8
  v_mul_f32 v242, v242, v8
  v_mul_f32 v243, v243, v8
  v_mul_f32 v244, v244, v8
  v_mul_f32 v245, v245, v8
  v_mul_f32 v246, v246, v8
  v_mul_f32 v247, v247, v8
  v_accvgpr_write_b32 a24, v240
  v_accvgpr_write_b32 a25, v241
  v_accvgpr_write_b32 a26, v242
  v_accvgpr_write_b32 a27, v243
  v_accvgpr_write_b32 a28, v244
  v_accvgpr_write_b32 a29, v245
  v_accvgpr_write_b32 a30, v246
  v_accvgpr_write_b32 a31, v247
  v_accvgpr_read_b32 v240, a32
  v_accvgpr_read_b32 v241, a33
  v_accvgpr_read_b32 v242, a34
  v_accvgpr_read_b32 v243, a35
  v_accvgpr_read_b32 v244, a36
  v_accvgpr_read_b32 v245, a37
  v_accvgpr_read_b32 v246, a38
  v_accvgpr_read_b32 v247, a39
  v_mul_f32 v240, v240, v8
  v_mul_f32 v241, v241, v8
  v_mul_f32 v242, v242, v8
  v_mul_f32 v243, v243, v8
  v_mul_f32 v244, v244, v8
  v_mul_f32 v245, v245, v8
  v_mul_f32 v246, v246, v8
  v_mul_f32 v247, v247, v8
  v_accvgpr_write_b32 a32, v240
  v_accvgpr_write_b32 a33, v241
  v_accvgpr_write_b32 a34, v242
  v_accvgpr_write_b32 a35, v243
  v_accvgpr_write_b32 a36, v244
  v_accvgpr_write_b32 a37, v245
  v_accvgpr_write_b32 a38, v246
  v_accvgpr_write_b32 a39, v247
  v_accvgpr_read_b32 v240, a40
  v_accvgpr_read_b32 v241, a41
  v_accvgpr_read_b32 v242, a42
  v_accvgpr_read_b32 v243, a43
  v_accvgpr_read_b32 v244, a44
  v_accvgpr_read_b32 v245, a45
  v_accvgpr_read_b32 v246, a46
  v_accvgpr_read_b32 v247, a47
  v_mul_f32 v240, v240, v8
  v_mul_f32 v241, v241, v8
  v_mul_f32 v242, v242, v8
  v_mul_f32 v243, v243, v8
  v_mul_f32 v244, v244, v8
  v_mul_f32 v245, v245, v8
  v_mul_f32 v246, v246, v8
  v_mul_f32 v247, v247, v8
  v_accvgpr_write_b32 a40, v240
  v_accvgpr_write_b32 a41, v241
  v_accvgpr_write_b32 a42, v242
  v_accvgpr_write_b32 a43, v243
  v_accvgpr_write_b32 a44, v244
  v_accvgpr_write_b32 a45, v245
  v_accvgpr_write_b32 a46, v246
  v_accvgpr_write_b32 a47, v247
  v_accvgpr_read_b32 v240, a48
  v_accvgpr_read_b32 v241, a49
  v_accvgpr_read_b32 v242, a50
  v_accvgpr_read_b32 v243, a51
  v_accvgpr_read_b32 v244, a52
  v_accvgpr_read_b32 v245, a53
  v_accvgpr_read_b32 v246, a54
  v_accvgpr_read_b32 v247, a55
  v_mul_f32 v240, v240, v8
  v_mul_f32 v241, v241, v8
  v_mul_f32 v242, v242, v8
  v_mul_f32 v243, v243, v8
  v_mul_f32 v244, v244, v8
  v_mul_f32 v245, v245, v8
  v_mul_f32 v246, v246, v8
  v_mul_f32 v247, v247, v8
  v_accvgpr_write_b32 a48, v240
  v_accvgpr_write_b32 a49, v241
  v_accvgpr_write_b32 a50, v242
  v_accvgpr_write_b32 a51, v243
  v_accvgpr_write_b32 a52, v244
  v_accvgpr_write_b32 a53, v245
  v_accvgpr_write_b32 a54, v246
  v_accvgpr_write_b32 a55, v247
  v_accvgpr_read_b32 v240, a56
  v_accvgpr_read_b32 v241, a57
  v_accvgpr_read_b32 v242, a58
  v_accvgpr_read_b32 v243, a59
  v_accvgpr_read_b32 v244, a60
  v_accvgpr_read_b32 v245, a61
  v_accvgpr_read_b32 v246, a62
  v_accvgpr_read_b32 v247, a63
  v_mul_f32 v240, v240, v8
  v_mul_f32 v241, v241, v8
  v_mul_f32 v242, v242, v8
  v_mul_f32 v243, v243, v8
  v_mul_f32 v244, v244, v8
  v_mul_f32 v245, v245, v8
  v_mul_f32 v246, v246, v8
  v_mul_f32 v247, v247, v8
  v_accvgpr_write_b32 a56, v240
  v_accvgpr_write_b32 a57, v241
  v_accvgpr_write_b32 a58, v242
  v_accvgpr_write_b32 a59, v243
  v_accvgpr_write_b32 a60, v244
  v_accvgpr_write_b32 a61, v245
  v_accvgpr_write_b32 a62, v246
  v_accvgpr_write_b32 a63, v247
  s_mov_b32 s78, 0
  s_nop 1
  s_branch L_kb_kernel_s0_resc_ret
L_kb_kernel_s1_mask:
  s_nop 7
  s_lshl_b32 s81, s80, 1
  s_sub_u32 s81, s3, s81
  s_lshl_b32 s81, s81, 5
  v_add_u32 v240, s81, v13
  v_add_u32 v241, -32, v240
  v_cmp_gt_i32_e64 s[84:85], 0, v240
  v_cmp_gt_i32_e64 s[86:87], 1, v240
  v_cmp_gt_i32_e64 s[88:89], 2, v240
  v_cmp_gt_i32_e64 s[90:91], 3, v240
  v_cmp_gt_i32_e64 s[92:93], 16, v240
  v_cmp_gt_i32_e64 s[94:95], 17, v240
  v_cmp_gt_i32_e64 s[96:97], 18, v240
  v_cmp_gt_i32_e64 s[98:99], 19, v240
  v_cndmask_b32_e64 v80, v80, v14, s[84:85]
  v_cndmask_b32_e64 v81, v81, v14, s[86:87]
  v_cndmask_b32_e64 v82, v82, v14, s[88:89]
  v_cndmask_b32_e64 v83, v83, v14, s[90:91]
  v_cndmask_b32_e64 v84, v84, v14, s[92:93]
  v_cndmask_b32_e64 v85, v85, v14, s[94:95]
  v_cndmask_b32_e64 v86, v86, v14, s[96:97]
  v_cndmask_b32_e64 v87, v87, v14, s[98:99]
  v_cmp_gt_i32_e64 s[84:85], 8, v240
  v_cmp_gt_i32_e64 s[86:87], 9, v240
  v_cmp_gt_i32_e64 s[88:89], 10, v240
  v_cmp_gt_i32_e64 s[90:91], 11, v240
  v_cmp_gt_i32_e64 s[92:93], 24, v240
  v_cmp_gt_i32_e64 s[94:95], 25, v240
  v_cmp_gt_i32_e64 s[96:97], 26, v240
  v_cmp_gt_i32_e64 s[98:99], 27, v240
  v_cndmask_b32_e64 v88, v88, v14, s[84:85]
  v_cndmask_b32_e64 v89, v89, v14, s[86:87]
  v_cndmask_b32_e64 v90, v90, v14, s[88:89]
  v_cndmask_b32_e64 v91, v91, v14, s[90:91]
  v_cndmask_b32_e64 v92, v92, v14, s[92:93]
  v_cndmask_b32_e64 v93, v93, v14, s[94:95]
  v_cndmask_b32_e64 v94, v94, v14, s[96:97]
  v_cndmask_b32_e64 v95, v95, v14, s[98:99]
  v_cmp_gt_i32_e64 s[84:85], 0, v241
  v_cmp_gt_i32_e64 s[86:87], 1, v241
  v_cmp_gt_i32_e64 s[88:89], 2, v241
  v_cmp_gt_i32_e64 s[90:91], 3, v241
  v_cmp_gt_i32_e64 s[92:93], 16, v241
  v_cmp_gt_i32_e64 s[94:95], 17, v241
  v_cmp_gt_i32_e64 s[96:97], 18, v241
  v_cmp_gt_i32_e64 s[98:99], 19, v241
  v_cndmask_b32_e64 v112, v112, v14, s[84:85]
  v_cndmask_b32_e64 v113, v113, v14, s[86:87]
  v_cndmask_b32_e64 v114, v114, v14, s[88:89]
  v_cndmask_b32_e64 v115, v115, v14, s[90:91]
  v_cndmask_b32_e64 v116, v116, v14, s[92:93]
  v_cndmask_b32_e64 v117, v117, v14, s[94:95]
  v_cndmask_b32_e64 v118, v118, v14, s[96:97]
  v_cndmask_b32_e64 v119, v119, v14, s[98:99]
  v_cmp_gt_i32_e64 s[84:85], 8, v241
  v_cmp_gt_i32_e64 s[86:87], 9, v241
  v_cmp_gt_i32_e64 s[88:89], 10, v241
  v_cmp_gt_i32_e64 s[90:91], 11, v241
  v_cmp_gt_i32_e64 s[92:93], 24, v241
  v_cmp_gt_i32_e64 s[94:95], 25, v241
  v_cmp_gt_i32_e64 s[96:97], 26, v241
  v_cmp_gt_i32_e64 s[98:99], 27, v241
  v_cndmask_b32_e64 v120, v120, v14, s[84:85]
  v_cndmask_b32_e64 v121, v121, v14, s[86:87]
  v_cndmask_b32_e64 v122, v122, v14, s[88:89]
  v_cndmask_b32_e64 v123, v123, v14, s[90:91]
  v_cndmask_b32_e64 v124, v124, v14, s[92:93]
  v_cndmask_b32_e64 v125, v125, v14, s[94:95]
  v_cndmask_b32_e64 v126, v126, v14, s[96:97]
  v_cndmask_b32_e64 v127, v127, v14, s[98:99]
  s_branch L_kb_kernel_s1_mask_ret
L_kb_kernel_s1_rare:
  v_mov_b32 v240, v6
  v_mov_b32 v241, v6
s_nop 1
  v_permlane32_swap_b32 v240, v241
  v_max_f32 v242, v240, v241
  v_max_f32 v242, 0, v242
  v_exp_f32 v8, -v242
  v_sub_f32 v208, v208, v242
  v_sub_f32 v209, v209, v242
  v_sub_f32 v210, v210, v242
  v_sub_f32 v211, v211, v242
  v_sub_f32 v212, v212, v242
  v_sub_f32 v213, v213, v242
  v_sub_f32 v214, v214, v242
  v_sub_f32 v215, v215, v242
  v_sub_f32 v216, v216, v242
  v_sub_f32 v217, v217, v242
  v_sub_f32 v218, v218, v242
  v_sub_f32 v219, v219, v242
  v_sub_f32 v220, v220, v242
  v_sub_f32 v221, v221, v242
  v_sub_f32 v222, v222, v242
  v_sub_f32 v223, v223, v242
  v_mul_f32 v2, v2, v8
  v_mul_f32 v3, v3, v8
  v_sub_f32 v80, v80, v242
  v_sub_f32 v81, v81, v242
  v_sub_f32 v82, v82, v242
  v_sub_f32 v83, v83, v242
  v_sub_f32 v84, v84, v242
  v_sub_f32 v85, v85, v242
  v_sub_f32 v86, v86, v242
  v_sub_f32 v87, v87, v242
  v_sub_f32 v88, v88, v242
  v_sub_f32 v89, v89, v242
  v_sub_f32 v90, v90, v242
  v_sub_f32 v91, v91, v242
  v_sub_f32 v92, v92, v242
  v_sub_f32 v93, v93, v242
  v_sub_f32 v94, v94, v242
  v_sub_f32 v95, v95, v242
  v_sub_f32 v112, v112, v242
  v_sub_f32 v113, v113, v242
  v_sub_f32 v114, v114, v242
  v_sub_f32 v115, v115, v242
  v_sub_f32 v116, v116, v242
  v_sub_f32 v117, v117, v242
  v_sub_f32 v118, v118, v242
  v_sub_f32 v119, v119, v242
  v_sub_f32 v120, v120, v242
  v_sub_f32 v121, v121, v242
  v_sub_f32 v122, v122, v242
  v_sub_f32 v123, v123, v242
  v_sub_f32 v124, v124, v242
  v_sub_f32 v125, v125, v242
  v_sub_f32 v126, v126, v242
  v_sub_f32 v127, v127, v242
  s_mov_b32 s78, 1
  s_branch L_kb_kernel_s1_rare_ret
L_kb_kernel_s1_resc:
  s_nop 15
  v_accvgpr_read_b32 v240, a0
  v_accvgpr_read_b32 v241, a1
  v_accvgpr_read_b32 v242, a2
  v_accvgpr_read_b32 v243, a3
  v_accvgpr_read_b32 v244, a4
  v_accvgpr_read_b32 v245, a5
  v_accvgpr_read_b32 v246, a6
  v_accvgpr_read_b32 v247, a7
  v_mul_f32 v240, v240, v8
  v_mul_f32 v241, v241, v8
  v_mul_f32 v242, v242, v8
  v_mul_f32 v243, v243, v8
  v_mul_f32 v244, v244, v8
  v_mul_f32 v245, v245, v8
  v_mul_f32 v246, v246, v8
  v_mul_f32 v247, v247, v8
  v_accvgpr_write_b32 a0, v240
  v_accvgpr_write_b32 a1, v241
  v_accvgpr_write_b32 a2, v242
  v_accvgpr_write_b32 a3, v243
  v_accvgpr_write_b32 a4, v244
  v_accvgpr_write_b32 a5, v245
  v_accvgpr_write_b32 a6, v246
  v_accvgpr_write_b32 a7, v247
  v_accvgpr_read_b32 v240, a8
  v_accvgpr_read_b32 v241, a9
  v_accvgpr_read_b32 v242, a10
  v_accvgpr_read_b32 v243, a11
  v_accvgpr_read_b32 v244, a12
  v_accvgpr_read_b32 v245, a13
  v_accvgpr_read_b32 v246, a14
  v_accvgpr_read_b32 v247, a15
  v_mul_f32 v240, v240, v8
  v_mul_f32 v241, v241, v8
  v_mul_f32 v242, v242, v8
  v_mul_f32 v243, v243, v8
  v_mul_f32 v244, v244, v8
  v_mul_f32 v245, v245, v8
  v_mul_f32 v246, v246, v8
  v_mul_f32 v247, v247, v8
  v_accvgpr_write_b32 a8, v240
  v_accvgpr_write_b32 a9, v241
  v_accvgpr_write_b32 a10, v242
  v_accvgpr_write_b32 a11, v243
  v_accvgpr_write_b32 a12, v244
  v_accvgpr_write_b32 a13, v245
  v_accvgpr_write_b32 a14, v246
  v_accvgpr_write_b32 a15, v247
  v_accvgpr_read_b32 v240, a16
  v_accvgpr_read_b32 v241, a17
  v_accvgpr_read_b32 v242, a18
  v_accvgpr_read_b32 v243, a19
  v_accvgpr_read_b32 v244, a20
  v_accvgpr_read_b32 v245, a21
  v_accvgpr_read_b32 v246, a22
  v_accvgpr_read_b32 v247, a23
  v_mul_f32 v240, v240, v8
  v_mul_f32 v241, v241, v8
  v_mul_f32 v242, v242, v8
  v_mul_f32 v243, v243, v8
  v_mul_f32 v244, v244, v8
  v_mul_f32 v245, v245, v8
  v_mul_f32 v246, v246, v8
  v_mul_f32 v247, v247, v8
  v_accvgpr_write_b32 a16, v240
  v_accvgpr_write_b32 a17, v241
  v_accvgpr_write_b32 a18, v242
  v_accvgpr_write_b32 a19, v243
  v_accvgpr_write_b32 a20, v244
  v_accvgpr_write_b32 a21, v245
  v_accvgpr_write_b32 a22, v246
  v_accvgpr_write_b32 a23, v247
  v_accvgpr_read_b32 v240, a24
  v_accvgpr_read_b32 v241, a25
  v_accvgpr_read_b32 v242, a26
  v_accvgpr_read_b32 v243, a27
  v_accvgpr_read_b32 v244, a28
  v_accvgpr_read_b32 v245, a29
  v_accvgpr_read_b32 v246, a30
  v_accvgpr_read_b32 v247, a31
  v_mul_f32 v240, v240, v8
  v_mul_f32 v241, v241, v8
  v_mul_f32 v242, v242, v8
  v_mul_f32 v243, v243, v8
  v_mul_f32 v244, v244, v8
  v_mul_f32 v245, v245, v8
  v_mul_f32 v246, v246, v8
  v_mul_f32 v247, v247, v8
  v_accvgpr_write_b32 a24, v240
  v_accvgpr_write_b32 a25, v241
  v_accvgpr_write_b32 a26, v242
  v_accvgpr_write_b32 a27, v243
  v_accvgpr_write_b32 a28, v244
  v_accvgpr_write_b32 a29, v245
  v_accvgpr_write_b32 a30, v246
  v_accvgpr_write_b32 a31, v247
  v_accvgpr_read_b32 v240, a32
  v_accvgpr_read_b32 v241, a33
  v_accvgpr_read_b32 v242, a34
  v_accvgpr_read_b32 v243, a35
  v_accvgpr_read_b32 v244, a36
  v_accvgpr_read_b32 v245, a37
  v_accvgpr_read_b32 v246, a38
  v_accvgpr_read_b32 v247, a39
  v_mul_f32 v240, v240, v8
  v_mul_f32 v241, v241, v8
  v_mul_f32 v242, v242, v8
  v_mul_f32 v243, v243, v8
  v_mul_f32 v244, v244, v8
  v_mul_f32 v245, v245, v8
  v_mul_f32 v246, v246, v8
  v_mul_f32 v247, v247, v8
  v_accvgpr_write_b32 a32, v240
  v_accvgpr_write_b32 a33, v241
  v_accvgpr_write_b32 a34, v242
  v_accvgpr_write_b32 a35, v243
  v_accvgpr_write_b32 a36, v244
  v_accvgpr_write_b32 a37, v245
  v_accvgpr_write_b32 a38, v246
  v_accvgpr_write_b32 a39, v247
  v_accvgpr_read_b32 v240, a40
  v_accvgpr_read_b32 v241, a41
  v_accvgpr_read_b32 v242, a42
  v_accvgpr_read_b32 v243, a43
  v_accvgpr_read_b32 v244, a44
  v_accvgpr_read_b32 v245, a45
  v_accvgpr_read_b32 v246, a46
  v_accvgpr_read_b32 v247, a47
  v_mul_f32 v240, v240, v8
  v_mul_f32 v241, v241, v8
  v_mul_f32 v242, v242, v8
  v_mul_f32 v243, v243, v8
  v_mul_f32 v244, v244, v8
  v_mul_f32 v245, v245, v8
  v_mul_f32 v246, v246, v8
  v_mul_f32 v247, v247, v8
  v_accvgpr_write_b32 a40, v240
  v_accvgpr_write_b32 a41, v241
  v_accvgpr_write_b32 a42, v242
  v_accvgpr_write_b32 a43, v243
  v_accvgpr_write_b32 a44, v244
  v_accvgpr_write_b32 a45, v245
  v_accvgpr_write_b32 a46, v246
  v_accvgpr_write_b32 a47, v247
  v_accvgpr_read_b32 v240, a48
  v_accvgpr_read_b32 v241, a49
  v_accvgpr_read_b32 v242, a50
  v_accvgpr_read_b32 v243, a51
  v_accvgpr_read_b32 v244, a52
  v_accvgpr_read_b32 v245, a53
  v_accvgpr_read_b32 v246, a54
  v_accvgpr_read_b32 v247, a55
  v_mul_f32 v240, v240, v8
  v_mul_f32 v241, v241, v8
  v_mul_f32 v242, v242, v8
  v_mul_f32 v243, v243, v8
  v_mul_f32 v244, v244, v8
  v_mul_f32 v245, v245, v8
  v_mul_f32 v246, v246, v8
  v_mul_f32 v247, v247, v8
  v_accvgpr_write_b32 a48, v240
  v_accvgpr_write_b32 a49, v241
  v_accvgpr_write_b32 a50, v242
  v_accvgpr_write_b32 a51, v243
  v_accvgpr_write_b32 a52, v244
  v_accvgpr_write_b32 a53, v245
  v_accvgpr_write_b32 a54, v246
  v_accvgpr_write_b32 a55, v247
  v_accvgpr_read_b32 v240, a56
  v_accvgpr_read_b32 v241, a57
  v_accvgpr_read_b32 v242, a58
  v_accvgpr_read_b32 v243, a59
  v_accvgpr_read_b32 v244, a60
  v_accvgpr_read_b32 v245, a61
  v_accvgpr_read_b32 v246, a62
  v_accvgpr_read_b32 v247, a63
  v_mul_f32 v240, v240, v8
  v_mul_f32 v241, v241, v8
  v_mul_f32 v242, v242, v8
  v_mul_f32 v243, v243, v8
  v_mul_f32 v244, v244, v8
  v_mul_f32 v245, v245, v8
  v_mul_f32 v246, v246, v8
  v_mul_f32 v247, v247, v8
  v_accvgpr_write_b32 a56, v240
  v_accvgpr_write_b32 a57, v241
  v_accvgpr_write_b32 a58, v242
  v_accvgpr_write_b32 a59, v243
  v_accvgpr_write_b32 a60, v244
  v_accvgpr_write_b32 a61, v245
  v_accvgpr_write_b32 a62, v246
  v_accvgpr_write_b32 a63, v247
  s_mov_b32 s78, 0
  s_nop 1
  s_branch L_kb_kernel_s1_resc_ret
.section .rodata,"a"
.p2align 6
.amdhsa_kernel kb_kernel
  .amdhsa_next_free_vgpr 512
  .amdhsa_next_free_sgpr 102
  .amdhsa_accum_offset 256
  .amdhsa_group_segment_fixed_size 0
  .amdhsa_kernarg_size 128
  .amdhsa_user_sgpr_count 2
  .amdhsa_user_sgpr_kernarg_segment_ptr 1
  .amdhsa_system_sgpr_workgroup_id_x 1
  .amdhsa_float_denorm_mode_32 3
.end_amdhsa_kernel
.text
.globl kc_kernel
.p2align 8
.type kc_kernel,@function
kc_kernel:
  s_cmp_ge_u32 s2, 256
  s_cbranch_scc1 L_kc_kernel_end
  s_load_dwordx4 s[32:35], s[0:1], 32
  s_load_dwordx2 s[40:41], s[0:1], 120
  v_lshrrev_b32 v2, 6, v0
  v_and_b32 v1, 63, v0
  v_readfirstlane_b32 s3, v2
  s_waitcnt lgkmcnt(0)
  s_lshl_b32 s24, s2, 2
  s_add_u32 s24, s24, s3
  s_lshl_b32 s25, s24, 12
  s_add_u32 s8, s32, s25
  s_addc_u32 s9, s33, 0
  s_mov_b32 s10, 4096
  s_mov_b32 s11, 0x20000
  s_add_u32 s25, s25, 50331648
  s_add_u32 s12, s40, s25
  s_addc_u32 s13, s41, 0
  s_mov_b32 s14, 4096
  s_mov_b32 s15, 0x20000
  s_lshl_b32 s25, s2, 14
  s_add_u32 s25, s25, 54525952
  s_add_u32 s16, s40, s25
  s_addc_u32 s17, s41, 0
  s_mov_b32 s18, 16384
  s_mov_b32 s19, 0x20000
  s_mov_b32 s20, s34
  s_mov_b32 s21, s35
  s_mov_b32 s22, 2048
  s_mov_b32 s23, 0x20000
  s_lshl_b32 s26, s24, 1
  s_mul_i32 s30, s3, 21248
  v_lshlrev_b32 v2, 4, v1
  v_add_u32 v3, -8, v2
  v_mov_b32 v12, 0
  buffer_load_ushort v10, v12, s[20:23], s26 offen
  v_and_b32 v12, 15, v1
  v_lshrrev_b32 v13, 4, v1
  v_add_u32 v14, 13, v12
  v_and_b32 v15, 3, v14
  v_lshrrev_b32 v14, 2, v14
  v_cmp_eq_u32 vcc, 0, v15
  v_mul_u32_u24 v15, 4160, v15
s_nop 0
  v_cndmask_b32 v15, v15, 8, vcc
  v_lshl_add_u32 v15, v14, 3, v15
  v_lshl_add_u32 v15, v13, 4, v15
  v_add_u32 v4, s30, v15
  v_lshlrev_b32 v14, 5, v12
  v_lshlrev_b32 v15, 4, v13
  v_sub_u32 v15, v15, v14
  s_add_u32 s27, s30, 17120
  v_add_u32 v5, s27, v15
  v_add_u32 v6, s30, v2
  v_mul_u32_u24 v14, 136, v12
  v_lshl_add_u32 v14, v13, 5, v14
  s_lshl_b32 s27, s3, 1
  s_add_u32 s27, s27, 84992
  v_add_u32 v7, s27, v14
  v_lshrrev_b32 v14, 3, v1
  v_mul_u32_u24 v14, 136, v14
  v_and_b32 v15, 7, v1
  v_lshl_add_u32 v14, v15, 4, v14
  s_mul_i32 s27, s3, 4352
  s_add_u32 s27, s27, 84992
  v_add_u32 v8, s27, v14
  s_lshl_b32 s27, s3, 12
  v_add_u32 v9, s27, v2
  v_lshl_add_u32 v14, v13, 3, v12
  v_sub_u32 v11, 15, v14
  s_add_u32 m0, s30, 16640
s_nop 0
  buffer_load_dwordx4 v2, s[12:15], 0 offen offset:0 lds
  buffer_load_dwordx4 v2, s[12:15], 0 offen offset:1024 lds
  buffer_load_dwordx4 v2, s[12:15], 0 offen offset:2048 lds
  buffer_load_dwordx4 v2, s[12:15], 0 offen offset:3072 lds
  buffer_load_dwordx2 v[20:21], v3, s[8:11], 0 offen
  buffer_load_dwordx4 v[22:25], v2, s[8:11], 0 offen offset:0
  buffer_load_dwordx2 v[26:27], v2, s[8:11], 0 offen offset:1016
  buffer_load_dwordx4 v[28:31], v2, s[8:11], 0 offen offset:1024
  buffer_load_dwordx2 v[32:33], v2, s[8:11], 0 offen offset:2040
  buffer_load_dwordx4 v[34:37], v2, s[8:11], 0 offen offset:2048
  buffer_load_dwordx2 v[38:39], v2, s[8:11], 0 offen offset:3064
  buffer_load_dwordx4 v[40:43], v2, s[8:11], 0 offen offset:3072
  v_mov_b32 v16, 0
  v_mov_b32 v17, 0
  v_mov_b32 v18, 0
  v_mov_b32 v19, 0
  v_and_b32 v12, 3, v1
  v_mul_u32_u24 v12, 4160, v12
  v_lshrrev_b32 v13, 2, v1
  v_min_u32 v13, 3, v13
  v_lshl_add_u32 v12, v13, 4, v12
  v_add_u32 v12, s30, v12
  ds_write_b128 v12, v[16:19]
  v_and_b32 v13, 31, v1
  v_lshlrev_b32 v13, 4, v13
  v_add_u32 v13, s30, v13
  ds_write_b128 v13, v[16:19] offset:20736
s_waitcnt vmcnt(7)
  v_alignbit_b32 v44, v21, v20, 16
s_waitcnt vmcnt(6)
  v_alignbit_b32 v45, v22, v21, 16
  v_alignbit_b32 v46, v23, v22, 16
  v_alignbit_b32 v47, v24, v23, 16
  v_alignbit_b32 v48, v25, v24, 16
  ds_write_b128 v6, v[22:25] offset:64
  ds_write_b128 v6, v[44:47] offset:4208
  v_mov_b32 v12, v21
  v_mov_b32 v13, v22
  v_mov_b32 v14, v23
  v_mov_b32 v15, v24
  ds_write_b128 v6, v[12:15] offset:8368
  v_mov_b32 v12, v45
  v_mov_b32 v13, v46
  v_mov_b32 v14, v47
  v_mov_b32 v15, v48
  ds_write_b128 v6, v[12:15] offset:12528
s_waitcnt vmcnt(5)
  v_alignbit_b32 v50, v27, v26, 16
s_waitcnt vmcnt(4)
  v_alignbit_b32 v51, v28, v27, 16
  v_alignbit_b32 v52, v29, v28, 16
  v_alignbit_b32 v53, v30, v29, 16
  v_alignbit_b32 v54, v31, v30, 16
  ds_write_b128 v6, v[28:31] offset:1088
  ds_write_b128 v6, v[50:53] offset:5232
  v_mov_b32 v12, v27
  v_mov_b32 v13, v28
  v_mov_b32 v14, v29
  v_mov_b32 v15, v30
  ds_write_b128 v6, v[12:15] offset:9392
  v_mov_b32 v12, v51
  v_mov_b32 v13, v52
  v_mov_b32 v14, v53
  v_mov_b32 v15, v54
  ds_write_b128 v6, v[12:15] offset:13552
s_waitcnt vmcnt(3)
  v_alignbit_b32 v44, v33, v32, 16
s_waitcnt vmcnt(2)
  v_alignbit_b32 v45, v34, v33, 16
  v_alignbit_b32 v46, v35, v34, 16
  v_alignbit_b32 v47, v36, v35, 16
  v_alignbit_b32 v48, v37, v36, 16
  ds_write_b128 v6, v[34:37] offset:2112
  ds_write_b128 v6, v[44:47] offset:6256
  v_mov_b32 v12, v33
  v_mov_b32 v13, v34
  v_mov_b32 v14, v35
  v_mov_b32 v15, v36
  ds_write_b128 v6, v[12:15] offset:10416
  v_mov_b32 v12, v45
  v_mov_b32 v13, v46
  v_mov_b32 v14, v47
  v_mov_b32 v15, v48
  ds_write_b128 v6, v[12:15] offset:14576
s_waitcnt vmcnt(1)
  v_alignbit_b32 v50, v39, v38, 16
s_waitcnt vmcnt(0)
  v_alignbit_b32 v51, v40, v39, 16
  v_alignbit_b32 v52, v41, v40, 16
  v_alignbit_b32 v53, v42, v41, 16
  v_alignbit_b32 v54, v43, v42, 16
  ds_write_b128 v6, v[40:43] offset:3136
  ds_write_b128 v6, v[50:53] offset:7280
  v_mov_b32 v12, v39
  v_mov_b32 v13, v40
  v_mov_b32 v14, v41
  v_mov_b32 v15, v42
  ds_write_b128 v6, v[12:15] offset:11440
  v_mov_b32 v12, v51
  v_mov_b32 v13, v52
  v_mov_b32 v14, v53
  v_mov_b32 v15, v54
  ds_write_b128 v6, v[12:15] offset:15600
  v_lshlrev_b32 v12, 16, v10
  v_cmp_eq_u32 vcc, 0, v11
s_nop 1
  v_cndmask_b32 v216, 0, v10, vcc
  v_cmp_eq_u32 vcc, 1, v11
s_nop 1
  v_cndmask_b32 v216, v216, v12, vcc
  v_cmp_eq_u32 vcc, 2, v11
s_nop 1
  v_cndmask_b32 v217, 0, v10, vcc
  v_cmp_eq_u32 vcc, 3, v11
s_nop 1
  v_cndmask_b32 v217, v217, v12, vcc
  v_cmp_eq_u32 vcc, 4, v11
s_nop 1
  v_cndmask_b32 v218, 0, v10, vcc
  v_cmp_eq_u32 vcc, 5, v11
s_nop 1
  v_cndmask_b32 v218, v218, v12, vcc
  v_cmp_eq_u32 vcc, 6, v11
s_nop 1
  v_cndmask_b32 v219, 0, v10, vcc
  v_cmp_eq_u32 vcc, 7, v11
s_nop 1
  v_cndmask_b32 v219, v219, v12, vcc
  s_waitcnt vmcnt(0) lgkmcnt(0)
  ds_read_b128 v[120:123], v5 offset:3584
  ds_read_b64 v[88:89], v4 offset:0
  ds_read_b64 v[90:91], v4 offset:8
  ds_read_b128 v[124:127], v5 offset:3072
  ds_read_b64 v[92:93], v4 offset:512
  ds_read_b64 v[94:95], v4 offset:520
  ds_read_b128 v[128:131], v5 offset:2560
  ds_read_b64 v[96:97], v4 offset:1024
  ds_read_b64 v[98:99], v4 offset:1032
  ds_read_b128 v[132:135], v5 offset:2048
  ds_read_b64 v[100:101], v4 offset:1536
  ds_read_b64 v[102:103], v4 offset:1544
  ds_read_b128 v[136:139], v5 offset:1536
  ds_read_b64 v[104:105], v4 offset:2048
  ds_read_b64 v[106:107], v4 offset:2056
  ds_read_b128 v[140:143], v5 offset:1024
  ds_read_b64 v[108:109], v4 offset:2560
  ds_read_b64 v[110:111], v4 offset:2568
  ds_read_b128 v[144:147], v5 offset:512
  ds_read_b64 v[112:113], v4 offset:3072
  ds_read_b64 v[114:115], v4 offset:3080
  ds_read_b128 v[148:151], v5 offset:0
  ds_read_b64 v[116:117], v4 offset:3584
  ds_read_b64 v[118:119], v4 offset:3592
s_waitcnt lgkmcnt(15)
  v_mfma_f32_16x16x32_bf16 v[56:59], v[88:91], v[120:123], 0
  ds_read_b128 v[184:187], v5 offset:3648
  v_mfma_f32_16x16x32_bf16 v[60:63], v[88:91], v[124:127], 0
  ds_read_b64 v[152:153], v4 offset:64
  v_mfma_f32_16x16x32_bf16 v[64:67], v[88:91], v[128:131], 0
  ds_read_b64 v[154:155], v4 offset:72
s_waitcnt lgkmcnt(15)
  v_mfma_f32_16x16x32_bf16 v[68:71], v[88:91], v[132:135], 0
  ds_read_b128 v[188:191], v5 offset:3136
s_waitcnt lgkmcnt(15)
  v_mfma_f32_16x16x32_bf16 v[72:75], v[88:91], v[136:139], 0
s_waitcnt lgkmcnt(12)
  v_mfma_f32_16x16x32_bf16 v[76:79], v[88:91], v[140:143], 0
  ds_read_b64 v[156:157], v4 offset:576
s_waitcnt lgkmcnt(10)
  v_mfma_f32_16x16x32_bf16 v[80:83], v[88:91], v[144:147], 0
  ds_read_b64 v[158:159], v4 offset:584
s_waitcnt lgkmcnt(8)
  v_mfma_f32_16x16x32_bf16 v[84:87], v[88:91], v[148:151], 0
  ds_read_b128 v[192:195], v5 offset:2624
  v_mfma_f32_16x16x32_bf16 v[56:59], v[216:219], v[120:123], v[56:59]
  ds_read_b64 v[160:161], v4 offset:1088
  v_mfma_f32_16x16x32_bf16 v[60:63], v[216:219], v[124:127], v[60:63]
  v_mfma_f32_16x16x32_bf16 v[64:67], v[216:219], v[128:131], v[64:67]
  ds_read_b64 v[162:163], v4 offset:1096
  v_mfma_f32_16x16x32_bf16 v[68:71], v[216:219], v[132:135], v[68:71]
  ds_read_b128 v[196:199], v5 offset:2112
  v_mfma_f32_16x16x32_bf16 v[72:75], v[216:219], v[136:139], v[72:75]
  ds_read_b64 v[164:165], v4 offset:1600
  v_mfma_f32_16x16x32_bf16 v[76:79], v[216:219], v[140:143], v[76:79]
  ds_read_b64 v[166:167], v4 offset:1608
  v_mfma_f32_16x16x32_bf16 v[80:83], v[216:219], v[144:147], v[80:83]
  v_mfma_f32_16x16x32_bf16 v[84:87], v[216:219], v[148:151], v[84:87]
  ds_read_b128 v[200:203], v5 offset:1600
  v_mfma_f32_16x16x32_bf16 v[60:63], v[92:95], v[120:123], v[60:63]
  ds_read_b64 v[168:169], v4 offset:2112
  v_mfma_f32_16x16x32_bf16 v[64:67], v[92:95], v[124:127], v[64:67]
  ds_read_b64 v[170:171], v4 offset:2120
  v_mfma_f32_16x16x32_bf16 v[68:71], v[92:95], v[128:131], v[68:71]
  ds_read_b128 v[204:207], v5 offset:1088
  v_mfma_f32_16x16x32_bf16 v[72:75], v[92:95], v[132:135], v[72:75]
  v_mfma_f32_16x16x32_bf16 v[76:79], v[92:95], v[136:139], v[76:79]
  ds_read_b64 v[172:173], v4 offset:2624
  v_mfma_f32_16x16x32_bf16 v[80:83], v[92:95], v[140:143], v[80:83]
  ds_read_b64 v[174:175], v4 offset:2632
  v_mfma_f32_16x16x32_bf16 v[84:87], v[92:95], v[144:147], v[84:87]
  ds_read_b128 v[208:211], v5 offset:576
  v_mfma_f32_16x16x32_bf16 v[64:67], v[96:99], v[120:123], v[64:67]
  ds_read_b64 v[176:177], v4 offset:3136
  v_mfma_f32_16x16x32_bf16 v[68:71], v[96:99], v[124:127], v[68:71]
  v_mfma_f32_16x16x32_bf16 v[72:75], v[96:99], v[128:131], v[72:75]
  ds_read_b64 v[178:179], v4 offset:3144
  v_mfma_f32_16x16x32_bf16 v[76:79], v[96:99], v[132:135], v[76:79]
  ds_read_b128 v[212:215], v5 offset:64
  v_mfma_f32_16x16x32_bf16 v[80:83], v[96:99], v[136:139], v[80:83]
  ds_read_b64 v[180:181], v4 offset:3648
  v_mfma_f32_16x16x32_bf16 v[84:87], v[96:99], v[140:143], v[84:87]
  ds_read_b64 v[182:183], v4 offset:3656
  v_mfma_f32_16x16x32_bf16 v[68:71], v[100:103], v[120:123], v[68:71]
  v_mfma_f32_16x16x32_bf16 v[72:75], v[100:103], v[124:127], v[72:75]
  v_mfma_f32_16x16x32_bf16 v[76:79], v[100:103], v[128:131], v[76:79]
  v_mfma_f32_16x16x32_bf16 v[80:83], v[100:103], v[132:135], v[80:83]
  v_mfma_f32_16x16x32_bf16 v[84:87], v[100:103], v[136:139], v[84:87]
  v_mfma_f32_16x16x32_bf16 v[72:75], v[104:107], v[120:123], v[72:75]
  v_mfma_f32_16x16x32_bf16 v[76:79], v[104:107], v[124:127], v[76:79]
  v_mfma_f32_16x16x32_bf16 v[80:83], v[104:107], v[128:131], v[80:83]
  v_mfma_f32_16x16x32_bf16 v[84:87], v[104:107], v[132:135], v[84:87]
  v_mfma_f32_16x16x32_bf16 v[76:79], v[108:111], v[120:123], v[76:79]
  v_mfma_f32_16x16x32_bf16 v[80:83], v[108:111], v[124:127], v[80:83]
  v_mfma_f32_16x16x32_bf16 v[84:87], v[108:111], v[128:131], v[84:87]
  v_mfma_f32_16x16x32_bf16 v[80:83], v[112:115], v[120:123], v[80:83]
  v_mfma_f32_16x16x32_bf16 v[84:87], v[112:115], v[124:127], v[84:87]
s_waitcnt lgkmcnt(15)
  v_mfma_f32_16x16x32_bf16 v[84:87], v[116:119], v[120:123], v[84:87]
  v_mfma_f32_16x16x32_bf16 v[56:59], v[152:155], v[184:187], v[56:59]
  ds_read_b128 v[120:123], v5 offset:3712
  v_mfma_f32_16x16x32_bf16 v[60:63], v[152:155], v[188:191], v[60:63]
  ds_read_b64 v[88:89], v4 offset:128
  v_mfma_f32_16x16x32_bf16 v[64:67], v[152:155], v[192:195], v[64:67]
  ds_read_b64 v[90:91], v4 offset:136
s_waitcnt lgkmcnt(15)
  v_mfma_f32_16x16x32_bf16 v[68:71], v[152:155], v[196:199], v[68:71]
  ds_read_b128 v[124:127], v5 offset:3200
s_waitcnt lgkmcnt(15)
  v_mfma_f32_16x16x32_bf16 v[72:75], v[152:155], v[200:203], v[72:75]
s_waitcnt lgkmcnt(12)
  v_mfma_f32_16x16x32_bf16 v[76:79], v[152:155], v[204:207], v[76:79]
  ds_read_b64 v[92:93], v4 offset:640
s_waitcnt lgkmcnt(10)
  v_mfma_f32_16x16x32_bf16 v[80:83], v[152:155], v[208:211], v[80:83]
  ds_read_b64 v[94:95], v4 offset:648
s_waitcnt lgkmcnt(8)
  v_mfma_f32_16x16x32_bf16 v[84:87], v[152:155], v[212:215], v[84:87]
  ds_read_b128 v[128:131], v5 offset:2688
  v_mfma_f32_16x16x32_bf16 v[60:63], v[156:159], v[184:187], v[60:63]
  ds_read_b64 v[96:97], v4 offset:1152
  v_mfma_f32_16x16x32_bf16 v[64:67], v[156:159], v[188:191], v[64:67]
  v_mfma_f32_16x16x32_bf16 v[68:71], v[156:159], v[192:195], v[68:71]
  ds_read_b64 v[98:99], v4 offset:1160
  v_mfma_f32_16x16x32_bf16 v[72:75], v[156:159], v[196:199], v[72:75]
  ds_read_b128 v[132:135], v5 offset:2176
  v_mfma_f32_16x16x32_bf16 v[76:79], v[156:159], v[200:203], v[76:79]
  ds_read_b64 v[100:101], v4 offset:1664
  v_mfma_f32_16x16x32_bf16 v[80:83], v[156:159], v[204:207], v[80:83]
  ds_read_b64 v[102:103], v4 offset:1672
  v_mfma_f32_16x16x32_bf16 v[84:87], v[156:159], v[208:211], v[84:87]
  v_mfma_f32_16x16x32_bf16 v[64:67], v[160:163], v[184:187], v[64:67]
  ds_read_b128 v[136:139], v5 offset:1664
  v_mfma_f32_16x16x32_bf16 v[68:71], v[160:163], v[188:191], v[68:71]
  ds_read_b64 v[104:105], v4 offset:2176
  v_mfma_f32_16x16x32_bf16 v[72:75], v[160:163], v[192:195], v[72:75]
  ds_read_b64 v[106:107], v4 offset:2184
  v_mfma_f32_16x16x32_bf16 v[76:79], v[160:163], v[196:199], v[76:79]
  ds_read_b128 v[140:143], v5 offset:1152
  v_mfma_f32_16x16x32_bf16 v[80:83], v[160:163], v[200:203], v[80:83]
  v_mfma_f32_16x16x32_bf16 v[84:87], v[160:163], v[204:207], v[84:87]
  ds_read_b64 v[108:109], v4 offset:2688
  v_mfma_f32_16x16x32_bf16 v[68:71], v[164:167], v[184:187], v[68:71]
  ds_read_b64 v[110:111], v4 offset:2696
  v_mfma_f32_16x16x32_bf16 v[72:75], v[164:167], v[188:191], v[72:75]
  ds_read_b128 v[144:147], v5 offset:640
  v_mfma_f32_16x16x32_bf16 v[76:79], v[164:167], v[192:195], v[76:79]
  ds_read_b64 v[112:113], v4 offset:3200
  v_mfma_f32_16x16x32_bf16 v[80:83], v[164:167], v[196:199], v[80:83]
  v_mfma_f32_16x16x32_bf16 v[84:87], v[164:167], v[200:203], v[84:87]
  ds_read_b64 v[114:115], v4 offset:3208
  v_mfma_f32_16x16x32_bf16 v[72:75], v[168:171], v[184:187], v[72:75]
  ds_read_b128 v[148:151], v5 offset:128
  v_mfma_f32_16x16x32_bf16 v[76:79], v[168:171], v[188:191], v[76:79]
  ds_read_b64 v[116:117], v4 offset:3712
  v_mfma_f32_16x16x32_bf16 v[80:83], v[168:171], v[192:195], v[80:83]
  ds_read_b64 v[118:119], v4 offset:3720
  v_mfma_f32_16x16x32_bf16 v[84:87], v[168:171], v[196:199], v[84:87]
  v_mfma_f32_16x16x32_bf16 v[76:79], v[172:175], v[184:187], v[76:79]
  v_mfma_f32_16x16x32_bf16 v[80:83], v[172:175], v[188:191], v[80:83]
  v_mfma_f32_16x16x32_bf16 v[84:87], v[172:175], v[192:195], v[84:87]
  v_mfma_f32_16x16x32_bf16 v[80:83], v[176:179], v[184:187], v[80:83]
  v_mfma_f32_16x16x32_bf16 v[84:87], v[176:179], v[188:191], v[84:87]
s_waitcnt lgkmcnt(15)
  v_mfma_f32_16x16x32_bf16 v[84:87], v[180:183], v[184:187], v[84:87]
  v_mfma_f32_16x16x32_bf16 v[56:59], v[88:91], v[120:123], v[56:59]
  ds_read_b128 v[184:187], v5 offset:3776
  v_mfma_f32_16x16x32_bf16 v[60:63], v[88:91], v[124:127], v[60:63]
  ds_read_b64 v[152:153], v4 offset:192
  v_mfma_f32_16x16x32_bf16 v[64:67], v[88:91], v[128:131], v[64:67]
  ds_read_b64 v[154:155], v4 offset:200
s_waitcnt lgkmcnt(15)
  v_mfma_f32_16x16x32_bf16 v[68:71], v[88:91], v[132:135], v[68:71]
  ds_read_b128 v[188:191], v5 offset:3264
s_waitcnt lgkmcnt(15)
  v_mfma_f32_16x16x32_bf16 v[72:75], v[88:91], v[136:139], v[72:75]
s_waitcnt lgkmcnt(12)
  v_mfma_f32_16x16x32_bf16 v[76:79], v[88:91], v[140:143], v[76:79]
  ds_read_b64 v[156:157], v4 offset:704
s_waitcnt lgkmcnt(10)
  v_mfma_f32_16x16x32_bf16 v[80:83], v[88:91], v[144:147], v[80:83]
  ds_read_b64 v[158:159], v4 offset:712
s_waitcnt lgkmcnt(8)
  v_mfma_f32_16x16x32_bf16 v[84:87], v[88:91], v[148:151], v[84:87]
  ds_read_b128 v[192:195], v5 offset:2752
  v_mfma_f32_16x16x32_bf16 v[60:63], v[92:95], v[120:123], v[60:63]
  ds_read_b64 v[160:161], v4 offset:1216
  v_mfma_f32_16x16x32_bf16 v[64:67], v[92:95], v[124:127], v[64:67]
  v_mfma_f32_16x16x32_bf16 v[68:71], v[92:95], v[128:131], v[68:71]
  ds_read_b64 v[162:163], v4 offset:1224
  v_mfma_f32_16x16x32_bf16 v[72:75], v[92:95], v[132:135], v[72:75]
  ds_read_b128 v[196:199], v5 offset:2240
  v_mfma_f32_16x16x32_bf16 v[76:79], v[92:95], v[136:139], v[76:79]
  ds_read_b64 v[164:165], v4 offset:1728
  v_mfma_f32_16x16x32_bf16 v[80:83], v[92:95], v[140:143], v[80:83]
  ds_read_b64 v[166:167], v4 offset:1736
  v_mfma_f32_16x16x32_bf16 v[84:87], v[92:95], v[144:147], v[84:87]
  v_mfma_f32_16x16x32_bf16 v[64:67], v[96:99], v[120:123], v[64:67]
  ds_read_b128 v[200:203], v5 offset:1728
  v_mfma_f32_16x16x32_bf16 v[68:71], v[96:99], v[124:127], v[68:71]
  ds_read_b64 v[168:169], v4 offset:2240
  v_mfma_f32_16x16x32_bf16 v[72:75], v[96:99], v[128:131], v[72:75]
  ds_read_b64 v[170:171], v4 offset:2248
  v_mfma_f32_16x16x32_bf16 v[76:79], v[96:99], v[132:135], v[76:79]
  ds_read_b128 v[204:207], v5 offset:1216
  v_mfma_f32_16x16x32_bf16 v[80:83], v[96:99], v[136:139], v[80:83]
  v_mfma_f32_16x16x32_bf16 v[84:87], v[96:99], v[140:143], v[84:87]
  ds_read_b64 v[172:173], v4 offset:2752
  v_mfma_f32_16x16x32_bf16 v[68:71], v[100:103], v[120:123], v[68:71]
  ds_read_b64 v[174:175], v4 offset:2760
  v_mfma_f32_16x16x32_bf16 v[72:75], v[100:103], v[124:127], v[72:75]
  ds_read_b128 v[208:211], v5 offset:704
  v_mfma_f32_16x16x32_bf16 v[76:79], v[100:103], v[128:131], v[76:79]
  ds_read_b64 v[176:177], v4 offset:3264
  v_mfma_f32_16x16x32_bf16 v[80:83], v[100:103], v[132:135], v[80:83]
  v_mfma_f32_16x16x32_bf16 v[84:87], v[100:103], v[136:139], v[84:87]
  ds_read_b64 v[178:179], v4 offset:3272
  v_mfma_f32_16x16x32_bf16 v[72:75], v[104:107], v[120:123], v[72:75]
  ds_read_b128 v[212:215], v5 offset:192
  v_mfma_f32_16x16x32_bf16 v[76:79], v[104:107], v[124:127], v[76:79]
  ds_read_b64 v[180:181], v4 offset:3776
  v_mfma_f32_16x16x32_bf16 v[80:83], v[104:107], v[128:131], v[80:83]
  ds_read_b64 v[182:183], v4 offset:3784
  v_mfma_f32_16x16x32_bf16 v[84:87], v[104:107], v[132:135], v[84:87]
  v_mfma_f32_16x16x32_bf16 v[76:79], v[108:111], v[120:123], v[76:79]
  v_mfma_f32_16x16x32_bf16 v[80:83], v[108:111], v[124:127], v[80:83]
  v_mfma_f32_16x16x32_bf16 v[84:87], v[108:111], v[128:131], v[84:87]
  v_mfma_f32_16x16x32_bf16 v[80:83], v[112:115], v[120:123], v[80:83]
  v_mfma_f32_16x16x32_bf16 v[84:87], v[112:115], v[124:127], v[84:87]
s_waitcnt lgkmcnt(15)
  v_mfma_f32_16x16x32_bf16 v[84:87], v[116:119], v[120:123], v[84:87]
  v_mfma_f32_16x16x32_bf16 v[56:59], v[152:155], v[184:187], v[56:59]
  ds_read_b128 v[120:123], v5 offset:3840
  v_mfma_f32_16x16x32_bf16 v[60:63], v[152:155], v[188:191], v[60:63]
  ds_read_b64 v[88:89], v4 offset:256
  v_mfma_f32_16x16x32_bf16 v[64:67], v[152:155], v[192:195], v[64:67]
  ds_read_b64 v[90:91], v4 offset:264
s_waitcnt lgkmcnt(15)
  v_mfma_f32_16x16x32_bf16 v[68:71], v[152:155], v[196:199], v[68:71]
  ds_read_b128 v[124:127], v5 offset:3328
s_waitcnt lgkmcnt(15)
  v_mfma_f32_16x16x32_bf16 v[72:75], v[152:155], v[200:203], v[72:75]
s_waitcnt lgkmcnt(12)
  v_mfma_f32_16x16x32_bf16 v[76:79], v[152:155], v[204:207], v[76:79]
  ds_read_b64 v[92:93], v4 offset:768
s_waitcnt lgkmcnt(10)
  v_mfma_f32_16x16x32_bf16 v[80:83], v[152:155], v[208:211], v[80:83]
  ds_read_b64 v[94:95], v4 offset:776
s_waitcnt lgkmcnt(8)
  v_mfma_f32_16x16x32_bf16 v[84:87], v[152:155], v[212:215], v[84:87]
  ds_read_b128 v[128:131], v5 offset:2816
  v_mfma_f32_16x16x32_bf16 v[60:63], v[156:159], v[184:187], v[60:63]
  ds_read_b64 v[96:97], v4 offset:1280
  v_mfma_f32_16x16x32_bf16 v[64:67], v[156:159], v[188:191], v[64:67]
  v_mfma_f32_16x16x32_bf16 v[68:71], v[156:159], v[192:195], v[68:71]
  ds_read_b64 v[98:99], v4 offset:1288
  v_mfma_f32_16x16x32_bf16 v[72:75], v[156:159], v[196:199], v[72:75]
  ds_read_b128 v[132:135], v5 offset:2304
  v_mfma_f32_16x16x32_bf16 v[76:79], v[156:159], v[200:203], v[76:79]
  ds_read_b64 v[100:101], v4 offset:1792
  v_mfma_f32_16x16x32_bf16 v[80:83], v[156:159], v[204:207], v[80:83]
  ds_read_b64 v[102:103], v4 offset:1800
  v_mfma_f32_16x16x32_bf16 v[84:87], v[156:159], v[208:211], v[84:87]
  v_mfma_f32_16x16x32_bf16 v[64:67], v[160:163], v[184:187], v[64:67]
  ds_read_b128 v[136:139], v5 offset:1792
  v_mfma_f32_16x16x32_bf16 v[68:71], v[160:163], v[188:191], v[68:71]
  ds_read_b64 v[104:105], v4 offset:2304
  v_mfma_f32_16x16x32_bf16 v[72:75], v[160:163], v[192:195], v[72:75]
  ds_read_b64 v[106:107], v4 offset:2312
  v_mfma_f32_16x16x32_bf16 v[76:79], v[160:163], v[196:199], v[76:79]
  ds_read_b128 v[140:143], v5 offset:1280
  v_mfma_f32_16x16x32_bf16 v[80:83], v[160:163], v[200:203], v[80:83]
  v_mfma_f32_16x16x32_bf16 v[84:87], v[160:163], v[204:207], v[84:87]
  ds_read_b64 v[108:109], v4 offset:2816
  v_mfma_f32_16x16x32_bf16 v[68:71], v[164:167], v[184:187], v[68:71]
  ds_read_b64 v[110:111], v4 offset:2824
  v_mfma_f32_16x16x32_bf16 v[72:75], v[164:167], v[188:191], v[72:75]
  ds_read_b128 v[144:147], v5 offset:768
  v_mfma_f32_16x16x32_bf16 v[76:79], v[164:167], v[192:195], v[76:79]
  ds_read_b64 v[112:113], v4 offset:3328
  v_mfma_f32_16x16x32_bf16 v[80:83], v[164:167], v[196:199], v[80:83]
  v_mfma_f32_16x16x32_bf16 v[84:87], v[164:167], v[200:203], v[84:87]
  ds_read_b64 v[114:115], v4 offset:3336
  v_mfma_f32_16x16x32_bf16 v[72:75], v[168:171], v[184:187], v[72:75]
  ds_read_b128 v[148:151], v5 offset:256
  v_mfma_f32_16x16x32_bf16 v[76:79], v[168:171], v[188:191], v[76:79]
  ds_read_b64 v[116:117], v4 offset:3840
  v_mfma_f32_16x16x32_bf16 v[80:83], v[168:171], v[192:195], v[80:83]
  ds_read_b64 v[118:119], v4 offset:3848
  v_mfma_f32_16x16x32_bf16 v[84:87], v[168:171], v[196:199], v[84:87]
  v_mfma_f32_16x16x32_bf16 v[76:79], v[172:175], v[184:187], v[76:79]
  v_mfma_f32_16x16x32_bf16 v[80:83], v[172:175], v[188:191], v[80:83]
  v_mfma_f32_16x16x32_bf16 v[84:87], v[172:175], v[192:195], v[84:87]
  v_mfma_f32_16x16x32_bf16 v[80:83], v[176:179], v[184:187], v[80:83]
  v_mfma_f32_16x16x32_bf16 v[84:87], v[176:179], v[188:191], v[84:87]
s_waitcnt lgkmcnt(15)
  v_mfma_f32_16x16x32_bf16 v[84:87], v[180:183], v[184:187], v[84:87]
  v_mfma_f32_16x16x32_bf16 v[56:59], v[88:91], v[120:123], v[56:59]
  ds_read_b128 v[184:187], v5 offset:3904
  v_mfma_f32_16x16x32_bf16 v[60:63], v[88:91], v[124:127], v[60:63]
  ds_read_b64 v[152:153], v4 offset:320
  v_mfma_f32_16x16x32_bf16 v[64:67], v[88:91], v[128:131], v[64:67]
  ds_read_b64 v[154:155], v4 offset:328
s_waitcnt lgkmcnt(15)
  v_mfma_f32_16x16x32_bf16 v[68:71], v[88:91], v[132:135], v[68:71]
  ds_read_b128 v[188:191], v5 offset:3392
s_waitcnt lgkmcnt(15)
  v_mfma_f32_16x16x32_bf16 v[72:75], v[88:91], v[136:139], v[72:75]
s_waitcnt lgkmcnt(12)
  v_mfma_f32_16x16x32_bf16 v[76:79], v[88:91], v[140:143], v[76:79]
  ds_read_b64 v[156:157], v4 offset:832
s_waitcnt lgkmcnt(10)
  v_mfma_f32_16x16x32_bf16 v[80:83], v[88:91], v[144:147], v[80:83]
  ds_read_b64 v[158:159], v4 offset:840
s_waitcnt lgkmcnt(8)
  v_mfma_f32_16x16x32_bf16 v[84:87], v[88:91], v[148:151], v[84:87]
  ds_read_b128 v[192:195], v5 offset:2880
  v_mfma_f32_16x16x32_bf16 v[60:63], v[92:95], v[120:123], v[60:63]
  ds_read_b64 v[160:161], v4 offset:1344
  v_mfma_f32_16x16x32_bf16 v[64:67], v[92:95], v[124:127], v[64:67]
  v_mfma_f32_16x16x32_bf16 v[68:71], v[92:95], v[128:131], v[68:71]
  ds_read_b64 v[162:163], v4 offset:1352
  v_mfma_f32_16x16x32_bf16 v[72:75], v[92:95], v[132:135], v[72:75]
  ds_read_b128 v[196:199], v5 offset:2368
  v_mfma_f32_16x16x32_bf16 v[76:79], v[92:95], v[136:139], v[76:79]
  ds_read_b64 v[164:165], v4 offset:1856
  v_mfma_f32_16x16x32_bf16 v[80:83], v[92:95], v[140:143], v[80:83]
  ds_read_b64 v[166:167], v4 offset:1864
  v_mfma_f32_16x16x32_bf16 v[84:87], v[92:95], v[144:147], v[84:87]
  v_mfma_f32_16x16x32_bf16 v[64:67], v[96:99], v[120:123], v[64:67]
  ds_read_b128 v[200:203], v5 offset:1856
  v_mfma_f32_16x16x32_bf16 v[68:71], v[96:99], v[124:127], v[68:71]
  ds_read_b64 v[168:169], v4 offset:2368
  v_mfma_f32_16x16x32_bf16 v[72:75], v[96:99], v[128:131], v[72:75]
  ds_read_b64 v[170:171], v4 offset:2376
  v_mfma_f32_16x16x32_bf16 v[76:79], v[96:99], v[132:135], v[76:79]
  ds_read_b128 v[204:207], v5 offset:1344
  v_mfma_f32_16x16x32_bf16 v[80:83], v[96:99], v[136:139], v[80:83]
  v_mfma_f32_16x16x32_bf16 v[84:87], v[96:99], v[140:143], v[84:87]
  ds_read_b64 v[172:173], v4 offset:2880
  v_mfma_f32_16x16x32_bf16 v[68:71], v[100:103], v[120:123], v[68:71]
  ds_read_b64 v[174:175], v4 offset:2888
  v_mfma_f32_16x16x32_bf16 v[72:75], v[100:103], v[124:127], v[72:75]
  ds_read_b128 v[208:211], v5 offset:832
  v_mfma_f32_16x16x32_bf16 v[76:79], v[100:103], v[128:131], v[76:79]
  ds_read_b64 v[176:177], v4 offset:3392
  v_mfma_f32_16x16x32_bf16 v[80:83], v[100:103], v[132:135], v[80:83]
  v_mfma_f32_16x16x32_bf16 v[84:87], v[100:103], v[136:139], v[84:87]
  ds_read_b64 v[178:179], v4 offset:3400
  v_mfma_f32_16x16x32_bf16 v[72:75], v[104:107], v[120:123], v[72:75]
  ds_read_b128 v[212:215], v5 offset:320
  v_mfma_f32_16x16x32_bf16 v[76:79], v[104:107], v[124:127], v[76:79]
  ds_read_b64 v[180:181], v4 offset:3904
  v_mfma_f32_16x16x32_bf16 v[80:83], v[104:107], v[128:131], v[80:83]
  ds_read_b64 v[182:183], v4 offset:3912
  v_mfma_f32_16x16x32_bf16 v[84:87], v[104:107], v[132:135], v[84:87]
  v_mfma_f32_16x16x32_bf16 v[76:79], v[108:111], v[120:123], v[76:79]
  v_mfma_f32_16x16x32_bf16 v[80:83], v[108:111], v[124:127], v[80:83]
  v_mfma_f32_16x16x32_bf16 v[84:87], v[108:111], v[128:131], v[84:87]
  v_mfma_f32_16x16x32_bf16 v[80:83], v[112:115], v[120:123], v[80:83]
  v_mfma_f32_16x16x32_bf16 v[84:87], v[112:115], v[124:127], v[84:87]
s_waitcnt lgkmcnt(15)
  v_mfma_f32_16x16x32_bf16 v[84:87], v[116:119], v[120:123], v[84:87]
  v_mfma_f32_16x16x32_bf16 v[56:59], v[152:155], v[184:187], v[56:59]
  ds_read_b128 v[120:123], v5 offset:3968
  v_mfma_f32_16x16x32_bf16 v[60:63], v[152:155], v[188:191], v[60:63]
  ds_read_b64 v[88:89], v4 offset:384
  v_mfma_f32_16x16x32_bf16 v[64:67], v[152:155], v[192:195], v[64:67]
  ds_read_b64 v[90:91], v4 offset:392
s_waitcnt lgkmcnt(15)
  v_mfma_f32_16x16x32_bf16 v[68:71], v[152:155], v[196:199], v[68:71]
  ds_read_b128 v[124:127], v5 offset:3456
s_waitcnt lgkmcnt(15)
  v_mfma_f32_16x16x32_bf16 v[72:75], v[152:155], v[200:203], v[72:75]
s_waitcnt lgkmcnt(12)
  v_mfma_f32_16x16x32_bf16 v[76:79], v[152:155], v[204:207], v[76:79]
  ds_read_b64 v[92:93], v4 offset:896
s_waitcnt lgkmcnt(10)
  v_mfma_f32_16x16x32_bf16 v[80:83], v[152:155], v[208:211], v[80:83]
  ds_read_b64 v[94:95], v4 offset:904
s_waitcnt lgkmcnt(8)
  v_mfma_f32_16x16x32_bf16 v[84:87], v[152:155], v[212:215], v[84:87]
  ds_read_b128 v[128:131], v5 offset:2944
  v_mfma_f32_16x16x32_bf16 v[60:63], v[156:159], v[184:187], v[60:63]
  ds_read_b64 v[96:97], v4 offset:1408
  v_mfma_f32_16x16x32_bf16 v[64:67], v[156:159], v[188:191], v[64:67]
  v_mfma_f32_16x16x32_bf16 v[68:71], v[156:159], v[192:195], v[68:71]
  ds_read_b64 v[98:99], v4 offset:1416
  v_mfma_f32_16x16x32_bf16 v[72:75], v[156:159], v[196:199], v[72:75]
  ds_read_b128 v[132:135], v5 offset:2432
  v_mfma_f32_16x16x32_bf16 v[76:79], v[156:159], v[200:203], v[76:79]
  ds_read_b64 v[100:101], v4 offset:1920
  v_mfma_f32_16x16x32_bf16 v[80:83], v[156:159], v[204:207], v[80:83]
  ds_read_b64 v[102:103], v4 offset:1928
  v_mfma_f32_16x16x32_bf16 v[84:87], v[156:159], v[208:211], v[84:87]
  v_mfma_f32_16x16x32_bf16 v[64:67], v[160:163], v[184:187], v[64:67]
  ds_read_b128 v[136:139], v5 offset:1920
  v_mfma_f32_16x16x32_bf16 v[68:71], v[160:163], v[188:191], v[68:71]
  ds_read_b64 v[104:105], v4 offset:2432
  v_mfma_f32_16x16x32_bf16 v[72:75], v[160:163], v[192:195], v[72:75]
  ds_read_b64 v[106:107], v4 offset:2440
  v_mfma_f32_16x16x32_bf16 v[76:79], v[160:163], v[196:199], v[76:79]
  ds_read_b128 v[140:143], v5 offset:1408
  v_mfma_f32_16x16x32_bf16 v[80:83], v[160:163], v[200:203], v[80:83]
  v_mfma_f32_16x16x32_bf16 v[84:87], v[160:163], v[204:207], v[84:87]
  ds_read_b64 v[108:109], v4 offset:2944
  v_mfma_f32_16x16x32_bf16 v[68:71], v[164:167], v[184:187], v[68:71]
  ds_read_b64 v[110:111], v4 offset:2952
  v_mfma_f32_16x16x32_bf16 v[72:75], v[164:167], v[188:191], v[72:75]
  ds_read_b128 v[144:147], v5 offset:896
  v_mfma_f32_16x16x32_bf16 v[76:79], v[164:167], v[192:195], v[76:79]
  ds_read_b64 v[112:113], v4 offset:3456
  v_mfma_f32_16x16x32_bf16 v[80:83], v[164:167], v[196:199], v[80:83]
  v_mfma_f32_16x16x32_bf16 v[84:87], v[164:167], v[200:203], v[84:87]
  ds_read_b64 v[114:115], v4 offset:3464
  v_mfma_f32_16x16x32_bf16 v[72:75], v[168:171], v[184:187], v[72:75]
  ds_read_b128 v[148:151], v5 offset:384
  v_mfma_f32_16x16x32_bf16 v[76:79], v[168:171], v[188:191], v[76:79]
  ds_read_b64 v[116:117], v4 offset:3968
  v_mfma_f32_16x16x32_bf16 v[80:83], v[168:171], v[192:195], v[80:83]
  ds_read_b64 v[118:119], v4 offset:3976
  v_mfma_f32_16x16x32_bf16 v[84:87], v[168:171], v[196:199], v[84:87]
  v_mfma_f32_16x16x32_bf16 v[76:79], v[172:175], v[184:187], v[76:79]
  v_mfma_f32_16x16x32_bf16 v[80:83], v[172:175], v[188:191], v[80:83]
  v_mfma_f32_16x16x32_bf16 v[84:87], v[172:175], v[192:195], v[84:87]
  v_mfma_f32_16x16x32_bf16 v[80:83], v[176:179], v[184:187], v[80:83]
  v_mfma_f32_16x16x32_bf16 v[84:87], v[176:179], v[188:191], v[84:87]
s_waitcnt lgkmcnt(15)
  v_mfma_f32_16x16x32_bf16 v[84:87], v[180:183], v[184:187], v[84:87]
  v_mfma_f32_16x16x32_bf16 v[56:59], v[88:91], v[120:123], v[56:59]
  ds_read_b128 v[184:187], v5 offset:4032
  v_mfma_f32_16x16x32_bf16 v[60:63], v[88:91], v[124:127], v[60:63]
  ds_read_b64 v[152:153], v4 offset:448
  v_mfma_f32_16x16x32_bf16 v[64:67], v[88:91], v[128:131], v[64:67]
  ds_read_b64 v[154:155], v4 offset:456
s_waitcnt lgkmcnt(15)
  v_mfma_f32_16x16x32_bf16 v[68:71], v[88:91], v[132:135], v[68:71]
  ds_read_b128 v[188:191], v5 offset:3520
s_waitcnt lgkmcnt(15)
  v_mfma_f32_16x16x32_bf16 v[72:75], v[88:91], v[136:139], v[72:75]
s_waitcnt lgkmcnt(12)
  v_mfma_f32_16x16x32_bf16 v[76:79], v[88:91], v[140:143], v[76:79]
  ds_read_b64 v[156:157], v4 offset:960
s_waitcnt lgkmcnt(10)
  v_mfma_f32_16x16x32_bf16 v[80:83], v[88:91], v[144:147], v[80:83]
  ds_read_b64 v[158:159], v4 offset:968
s_waitcnt lgkmcnt(8)
  v_mfma_f32_16x16x32_bf16 v[84:87], v[88:91], v[148:151], v[84:87]
  ds_read_b128 v[192:195], v5 offset:3008
  v_mfma_f32_16x16x32_bf16 v[60:63], v[92:95], v[120:123], v[60:63]
  ds_read_b64 v[160:161], v4 offset:1472
  v_mfma_f32_16x16x32_bf16 v[64:67], v[92:95], v[124:127], v[64:67]
  v_mfma_f32_16x16x32_bf16 v[68:71], v[92:95], v[128:131], v[68:71]
  ds_read_b64 v[162:163], v4 offset:1480
  v_mfma_f32_16x16x32_bf16 v[72:75], v[92:95], v[132:135], v[72:75]
  ds_read_b128 v[196:199], v5 offset:2496
  v_mfma_f32_16x16x32_bf16 v[76:79], v[92:95], v[136:139], v[76:79]
  ds_read_b64 v[164:165], v4 offset:1984
  v_mfma_f32_16x16x32_bf16 v[80:83], v[92:95], v[140:143], v[80:83]
  ds_read_b64 v[166:167], v4 offset:1992
  v_mfma_f32_16x16x32_bf16 v[84:87], v[92:95], v[144:147], v[84:87]
  v_mfma_f32_16x16x32_bf16 v[64:67], v[96:99], v[120:123], v[64:67]
  ds_read_b128 v[200:203], v5 offset:1984
  v_mfma_f32_16x16x32_bf16 v[68:71], v[96:99], v[124:127], v[68:71]
  ds_read_b64 v[168:169], v4 offset:2496
  v_mfma_f32_16x16x32_bf16 v[72:75], v[96:99], v[128:131], v[72:75]
  ds_read_b64 v[170:171], v4 offset:2504
  v_mfma_f32_16x16x32_bf16 v[76:79], v[96:99], v[132:135], v[76:79]
  ds_read_b128 v[204:207], v5 offset:1472
  v_mfma_f32_16x16x32_bf16 v[80:83], v[96:99], v[136:139], v[80:83]
  v_mfma_f32_16x16x32_bf16 v[84:87], v[96:99], v[140:143], v[84:87]
  ds_read_b64 v[172:173], v4 offset:3008
  v_mfma_f32_16x16x32_bf16 v[68:71], v[100:103], v[120:123], v[68:71]
  ds_read_b64 v[174:175], v4 offset:3016
  v_mfma_f32_16x16x32_bf16 v[72:75], v[100:103], v[124:127], v[72:75]
  ds_read_b128 v[208:211], v5 offset:960
  v_mfma_f32_16x16x32_bf16 v[76:79], v[100:103], v[128:131], v[76:79]
  ds_read_b64 v[176:177], v4 offset:3520
  v_mfma_f32_16x16x32_bf16 v[80:83], v[100:103], v[132:135], v[80:83]
  v_mfma_f32_16x16x32_bf16 v[84:87], v[100:103], v[136:139], v[84:87]
  ds_read_b64 v[178:179], v4 offset:3528
  v_mfma_f32_16x16x32_bf16 v[72:75], v[104:107], v[120:123], v[72:75]
  ds_read_b128 v[212:215], v5 offset:448
  v_mfma_f32_16x16x32_bf16 v[76:79], v[104:107], v[124:127], v[76:79]
  ds_read_b64 v[180:181], v4 offset:4032
  v_mfma_f32_16x16x32_bf16 v[80:83], v[104:107], v[128:131], v[80:83]
  ds_read_b64 v[182:183], v4 offset:4040
  v_mfma_f32_16x16x32_bf16 v[84:87], v[104:107], v[132:135], v[84:87]
  v_mfma_f32_16x16x32_bf16 v[76:79], v[108:111], v[120:123], v[76:79]
  v_mfma_f32_16x16x32_bf16 v[80:83], v[108:111], v[124:127], v[80:83]
  v_mfma_f32_16x16x32_bf16 v[84:87], v[108:111], v[128:131], v[84:87]
  v_mfma_f32_16x16x32_bf16 v[80:83], v[112:115], v[120:123], v[80:83]
  v_mfma_f32_16x16x32_bf16 v[84:87], v[112:115], v[124:127], v[84:87]
s_waitcnt lgkmcnt(15)
  v_mfma_f32_16x16x32_bf16 v[84:87], v[116:119], v[120:123], v[84:87]
  v_mfma_f32_16x16x32_bf16 v[56:59], v[152:155], v[184:187], v[56:59]
  v_mfma_f32_16x16x32_bf16 v[60:63], v[152:155], v[188:191], v[60:63]
  v_mfma_f32_16x16x32_bf16 v[64:67], v[152:155], v[192:195], v[64:67]
s_waitcnt lgkmcnt(14)
  v_mfma_f32_16x16x32_bf16 v[68:71], v[152:155], v[196:199], v[68:71]
s_waitcnt lgkmcnt(11)
  v_mfma_f32_16x16x32_bf16 v[72:75], v[152:155], v[200:203], v[72:75]
s_waitcnt lgkmcnt(8)
  v_mfma_f32_16x16x32_bf16 v[76:79], v[152:155], v[204:207], v[76:79]
s_waitcnt lgkmcnt(5)
  v_mfma_f32_16x16x32_bf16 v[80:83], v[152:155], v[208:211], v[80:83]
s_waitcnt lgkmcnt(2)
  v_mfma_f32_16x16x32_bf16 v[84:87], v[152:155], v[212:215], v[84:87]
  v_mfma_f32_16x16x32_bf16 v[60:63], v[156:159], v[184:187], v[60:63]
  v_mfma_f32_16x16x32_bf16 v[64:67], v[156:159], v[188:191], v[64:67]
  v_mfma_f32_16x16x32_bf16 v[68:71], v[156:159], v[192:195], v[68:71]
  v_mfma_f32_16x16x32_bf16 v[72:75], v[156:159], v[196:199], v[72:75]
  v_mfma_f32_16x16x32_bf16 v[76:79], v[156:159], v[200:203], v[76:79]
  v_mfma_f32_16x16x32_bf16 v[80:83], v[156:159], v[204:207], v[80:83]
  v_mfma_f32_16x16x32_bf16 v[84:87], v[156:159], v[208:211], v[84:87]
  v_mfma_f32_16x16x32_bf16 v[64:67], v[160:163], v[184:187], v[64:67]
  v_mfma_f32_16x16x32_bf16 v[68:71], v[160:163], v[188:191], v[68:71]
  v_mfma_f32_16x16x32_bf16 v[72:75], v[160:163], v[192:195], v[72:75]
  v_mfma_f32_16x16x32_bf16 v[76:79], v[160:163], v[196:199], v[76:79]
  v_mfma_f32_16x16x32_bf16 v[80:83], v[160:163], v[200:203], v[80:83]
  v_mfma_f32_16x16x32_bf16 v[84:87], v[160:163], v[204:207], v[84:87]
  v_mfma_f32_16x16x32_bf16 v[68:71], v[164:167], v[184:187], v[68:71]
  v_mfma_f32_16x16x32_bf16 v[72:75], v[164:167], v[188:191], v[72:75]
  v_mfma_f32_16x16x32_bf16 v[76:79], v[164:167], v[192:195], v[76:79]
  v_mfma_f32_16x16x32_bf16 v[80:83], v[164:167], v[196:199], v[80:83]
  v_mfma_f32_16x16x32_bf16 v[84:87], v[164:167], v[200:203], v[84:87]
  v_mfma_f32_16x16x32_bf16 v[72:75], v[168:171], v[184:187], v[72:75]
  v_mfma_f32_16x16x32_bf16 v[76:79], v[168:171], v[188:191], v[76:79]
  v_mfma_f32_16x16x32_bf16 v[80:83], v[168:171], v[192:195], v[80:83]
  v_mfma_f32_16x16x32_bf16 v[84:87], v[168:171], v[196:199], v[84:87]
  v_mfma_f32_16x16x32_bf16 v[76:79], v[172:175], v[184:187], v[76:79]
  v_mfma_f32_16x16x32_bf16 v[80:83], v[172:175], v[188:191], v[80:83]
  v_mfma_f32_16x16x32_bf16 v[84:87], v[172:175], v[192:195], v[84:87]
  v_mfma_f32_16x16x32_bf16 v[80:83], v[176:179], v[184:187], v[80:83]
  v_mfma_f32_16x16x32_bf16 v[84:87], v[176:179], v[188:191], v[84:87]
s_waitcnt lgkmcnt(0)
  v_mfma_f32_16x16x32_bf16 v[84:87], v[180:183], v[184:187], v[84:87]
  v_cvt_pk_bf16_f32 v12, v56, v57
  v_cvt_pk_bf16_f32 v13, v58, v59
  ds_write_b16 v7, v12 offset:0
  ds_write_b16_d16_hi v7, v12 offset:8
  ds_write_b16 v7, v13 offset:16
  ds_write_b16_d16_hi v7, v13 offset:24
  v_cvt_pk_bf16_f32 v14, v60, v61
  v_cvt_pk_bf16_f32 v15, v62, v63
  ds_write_b16 v7, v14 offset:2176
  ds_write_b16_d16_hi v7, v14 offset:2184
  ds_write_b16 v7, v15 offset:2192
  ds_write_b16_d16_hi v7, v15 offset:2200
  v_cvt_pk_bf16_f32 v12, v64, v65
  v_cvt_pk_bf16_f32 v13, v66, v67
  ds_write_b16 v7, v12 offset:4352
  ds_write_b16_d16_hi v7, v12 offset:4360
  ds_write_b16 v7, v13 offset:4368
  ds_write_b16_d16_hi v7, v13 offset:4376
  v_cvt_pk_bf16_f32 v14, v68, v69
  v_cvt_pk_bf16_f32 v15, v70, v71
  ds_write_b16 v7, v14 offset:6528
  ds_write_b16_d16_hi v7, v14 offset:6536
  ds_write_b16 v7, v15 offset:6544
  ds_write_b16_d16_hi v7, v15 offset:6552
  v_cvt_pk_bf16_f32 v12, v72, v73
  v_cvt_pk_bf16_f32 v13, v74, v75
  ds_write_b16 v7, v12 offset:8704
  ds_write_b16_d16_hi v7, v12 offset:8712
  ds_write_b16 v7, v13 offset:8720
  ds_write_b16_d16_hi v7, v13 offset:8728
  v_cvt_pk_bf16_f32 v14, v76, v77
  v_cvt_pk_bf16_f32 v15, v78, v79
  ds_write_b16 v7, v14 offset:10880
  ds_write_b16_d16_hi v7, v14 offset:10888
  ds_write_b16 v7, v15 offset:10896
  ds_write_b16_d16_hi v7, v15 offset:10904
  v_cvt_pk_bf16_f32 v12, v80, v81
  v_cvt_pk_bf16_f32 v13, v82, v83
  ds_write_b16 v7, v12 offset:13056
  ds_write_b16_d16_hi v7, v12 offset:13064
  ds_write_b16 v7, v13 offset:13072
  ds_write_b16_d16_hi v7, v13 offset:13080
  v_cvt_pk_bf16_f32 v14, v84, v85
  v_cvt_pk_bf16_f32 v15, v86, v87
  ds_write_b16 v7, v14 offset:15232
  ds_write_b16_d16_hi v7, v14 offset:15240
  ds_write_b16 v7, v15 offset:15248
  ds_write_b16_d16_hi v7, v15 offset:15256
  s_waitcnt lgkmcnt(0)
  s_barrier
  ds_read_b64 v[88:89], v8 offset:0
  ds_read_b64 v[90:91], v8 offset:8
  ds_read_b64 v[92:93], v8 offset:1088
  ds_read_b64 v[94:95], v8 offset:1096
  ds_read_b64 v[96:97], v8 offset:2176
  ds_read_b64 v[98:99], v8 offset:2184
  ds_read_b64 v[100:101], v8 offset:3264
  ds_read_b64 v[102:103], v8 offset:3272
s_waitcnt lgkmcnt(6)
  buffer_store_dwordx4 v[88:91], v9, s[16:19], 0 offen offset:0 sc1
s_waitcnt lgkmcnt(4)
  buffer_store_dwordx4 v[92:95], v9, s[16:19], 0 offen offset:1024 sc1
s_waitcnt lgkmcnt(2)
  buffer_store_dwordx4 v[96:99], v9, s[16:19], 0 offen offset:2048 sc1
s_waitcnt lgkmcnt(0)
  buffer_store_dwordx4 v[100:103], v9, s[16:19], 0 offen offset:3072 sc1
L_kc_kernel_end:
  s_endpgm
.section .rodata,"a"
.p2align 6
.amdhsa_kernel kc_kernel
  .amdhsa_next_free_vgpr 512
  .amdhsa_next_free_sgpr 102
  .amdhsa_accum_offset 256
  .amdhsa_group_segment_fixed_size 0
  .amdhsa_kernarg_size 128
  .amdhsa_user_sgpr_count 2
  .amdhsa_user_sgpr_kernarg_segment_ptr 1
  .amdhsa_system_sgpr_workgroup_id_x 1
  .amdhsa_float_denorm_mode_32 3
.end_amdhsa_kernel
.text
.globl kd_kernel
.p2align 8
.type kd_kernel,@function
kd_kernel:
  s_cmp_ge_u32 s2, 256
  s_cbranch_scc1 L_kd_kernel_end
  s_load_dwordx2 s[32:33], s[0:1], 0
  s_load_dwordx2 s[34:35], s[0:1], 88
  s_load_dwordx2 s[36:37], s[0:1], 104
  s_load_dwordx2 s[40:41], s[0:1], 120
  v_lshrrev_b32 v152, 6, v0
  v_and_b32 v1, 63, v0
  v_readfirstlane_b32 s3, v152
  s_and_b32 s68, s2, 3
  s_lshl_b32 s68, s68, 2
  s_bfe_u32 s69, s2, 0x20003
  s_add_u32 s68, s68, s69
  s_bfe_u32 s69, s2, 0x10002
  s_lshl_b32 s69, s69, 3
  s_lshr_b32 s70, s2, 5
  s_add_u32 s69, s69, s70
  s_lshl_b32 s70, s68, 2
  s_add_u32 s70, s70, s3
  s_lshl_b32 s64, s70, 18
  s_lshl_b32 s65, s3, 16
  s_lshl_b32 s71, s69, 7
  s_add_u32 s65, s65, s71
  s_lshl_b32 s66, s3, 12
  s_lshl_b32 s74, s70, 16
  s_add_u32 s74, s74, s71
  s_lshl_b32 s75, s69, 18
  s_lshl_b32 s71, s70, 8
  s_add_u32 s75, s75, s71
  s_lshl_b32 s76, s70, 7
  v_lshlrev_b32 v2, 4, v1
  v_add_u32 v3, 0x20000, v2
  v_lshrrev_b32 v152, 3, v1
  v_lshlrev_b32 v152, 11, v152
  v_lshrrev_b32 v153, 4, v1
  v_lshlrev_b32 v154, 1, v153
  v_and_b32 v155, 7, v1
  v_xor_b32 v154, v154, v155
  v_lshl_add_u32 v152, v154, 4, v152
  v_add_u32 v4, 0, v152
  v_add_u32 v5, 15360, v152
  v_add_u32 v6, 30720, v152
  v_add_u32 v7, 46080, v152
  v_bfe_u32 v152, v1, 2, 2
  v_and_b32 v154, 1, v153
  v_lshrrev_b32 v155, 1, v152
  v_lshl_add_u32 v155, v154, 1, v155
  v_lshl_add_u32 v152, v154, 2, v152
  v_lshrrev_b32 v156, 5, v1
  v_lshl_add_u32 v152, v156, 4, v152
  v_lshlrev_b32 v152, 7, v152
  v_and_b32 v157, 3, v1
  v_lshl_add_u32 v152, v157, 3, v152
  v_xor_b32 v157, 0, v155
  v_lshl_add_u32 v8, v157, 5, v152
  v_add_u32 v12, 0x10000, v8
  v_xor_b32 v157, 1, v155
  v_lshl_add_u32 v9, v157, 5, v152
  v_add_u32 v13, 0x10000, v9
  v_xor_b32 v157, 2, v155
  v_lshl_add_u32 v10, v157, 5, v152
  v_add_u32 v14, 0x10000, v10
  v_xor_b32 v157, 3, v155
  v_lshl_add_u32 v11, v157, 5, v152
  v_add_u32 v15, 0x10000, v11
  v_and_b32 v152, 15, v1
  v_lshlrev_b32 v157, 5, v154
  v_lshl_add_u32 v157, v156, 4, v157
  v_lshl_add_u32 v16, v152, 11, v157
  v_lshlrev_b32 v157, 11, v157
  v_lshl_add_u32 v17, v152, 3, v157
  v_lshlrev_b32 v158, 2, v152
  s_waitcnt lgkmcnt(0)
  s_add_u32 s8, s40, 33554432
  s_addc_u32 s9, s41, 0
  s_mov_b32 s10, 16777216
  s_mov_b32 s11, 0x20000
  s_mov_b32 s12, s34
  s_mov_b32 s13, s35
  s_mov_b32 s14, 8388608
  s_mov_b32 s15, 0x20000
  s_mov_b32 s16, s32
  s_mov_b32 s17, s33
  s_mov_b32 s18, 4194304
  s_mov_b32 s19, 0x20000
  s_add_u32 s20, s40, 54525952
  s_addc_u32 s21, s41, 0
  s_mov_b32 s22, 4194304
  s_mov_b32 s23, 0x20000
  s_mov_b32 s24, s36
  s_mov_b32 s25, s37
  s_mov_b32 s26, 4194304
  s_mov_b32 s27, 0x20000
  s_add_u32 s28, s40, 58720256
  s_addc_u32 s29, s41, 0
  s_mov_b32 s30, 8192
  s_mov_b32 s31, 0x20000
  s_add_u32 s68, s74, 0
  buffer_load_dwordx4 v[84:87], v16, s[16:19], s68 offen offset:0
  buffer_load_dwordx4 v[88:91], v16, s[16:19], s68 offen offset:64
  buffer_load_dword v116, v158, s[28:31], s76 offen offset:0
  s_add_u32 s68, s75, 0
  buffer_load_dwordx2 v[100:101], v17, s[20:23], s68 offen offset:0
  s_add_u32 s68, s75, 16384
  buffer_load_dwordx2 v[102:103], v17, s[20:23], s68 offen offset:0
  s_add_u32 s68, s75, 131072
  buffer_load_dwordx2 v[104:105], v17, s[20:23], s68 offen offset:0
  s_add_u32 s68, s75, 147456
  buffer_load_dwordx2 v[106:107], v17, s[20:23], s68 offen offset:0
  s_add_u32 s68, s74, 32768
  buffer_load_dwordx4 v[92:95], v16, s[16:19], s68 offen offset:0
  buffer_load_dwordx4 v[96:99], v16, s[16:19], s68 offen offset:64
  buffer_load_dword v117, v158, s[28:31], s76 offen offset:64
  s_add_u32 s68, s75, 0
  buffer_load_dwordx2 v[108:109], v17, s[20:23], s68 offen offset:128
  s_add_u32 s68, s75, 16384
  buffer_load_dwordx2 v[110:111], v17, s[20:23], s68 offen offset:128
  s_add_u32 s68, s75, 131072
  buffer_load_dwordx2 v[112:113], v17, s[20:23], s68 offen offset:128
  s_add_u32 s68, s75, 147456
  buffer_load_dwordx2 v[114:115], v17, s[20:23], s68 offen offset:128
  s_add_u32 m0, s66, 0
s_nop 0
  buffer_load_dwordx4 v4, s[12:15], s65 offen offset:0 lds
  buffer_load_dwordx4 a[0:3], v2, s[8:11], s64 offen offset:0
  buffer_load_dwordx4 a[4:7], v3, s[8:11], s64 offen offset:0
  buffer_load_dwordx4 v5, s[12:15], s65 offen offset:1024 lds
  buffer_load_dwordx4 a[8:11], v2, s[8:11], s64 offen offset:1024
  buffer_load_dwordx4 a[12:15], v3, s[8:11], s64 offen offset:1024
  buffer_load_dwordx4 v6, s[12:15], s65 offen offset:2048 lds
  buffer_load_dwordx4 a[16:19], v2, s[8:11], s64 offen offset:2048
  buffer_load_dwordx4 a[20:23], v3, s[8:11], s64 offen offset:2048
  buffer_load_dwordx4 v7, s[12:15], s65 offen offset:3072 lds
  buffer_load_dwordx4 a[24:27], v2, s[8:11], s64 offen offset:3072
  buffer_load_dwordx4 a[28:31], v3, s[8:11], s64 offen offset:3072
  s_add_u32 s64, s64, 4096
  s_add_u32 s65, s65, 262144
  s_add_u32 m0, s66, 16384
s_nop 0
  buffer_load_dwordx4 v4, s[12:15], s65 offen offset:0 lds
  buffer_load_dwordx4 a[32:35], v2, s[8:11], s64 offen offset:0
  buffer_load_dwordx4 a[36:39], v3, s[8:11], s64 offen offset:0
  buffer_load_dwordx4 v5, s[12:15], s65 offen offset:1024 lds
  buffer_load_dwordx4 a[40:43], v2, s[8:11], s64 offen offset:1024
  buffer_load_dwordx4 a[44:47], v3, s[8:11], s64 offen offset:1024
  buffer_load_dwordx4 v6, s[12:15], s65 offen offset:2048 lds
  buffer_load_dwordx4 a[48:51], v2, s[8:11], s64 offen offset:2048
  buffer_load_dwordx4 a[52:55], v3, s[8:11], s64 offen offset:2048
  buffer_load_dwordx4 v7, s[12:15], s65 offen offset:3072 lds
  buffer_load_dwordx4 a[56:59], v2, s[8:11], s64 offen offset:3072
  buffer_load_dwordx4 a[60:63], v3, s[8:11], s64 offen offset:3072
  s_add_u32 s64, s64, 4096
  s_add_u32 s65, s65, 262144
  s_add_u32 m0, s66, 32768
s_nop 0
  buffer_load_dwordx4 v4, s[12:15], s65 offen offset:0 lds
  buffer_load_dwordx4 a[64:67], v2, s[8:11], s64 offen offset:0
  buffer_load_dwordx4 a[68:71], v3, s[8:11], s64 offen offset:0
  buffer_load_dwordx4 v5, s[12:15], s65 offen offset:1024 lds
  buffer_load_dwordx4 a[72:75], v2, s[8:11], s64 offen offset:1024
  buffer_load_dwordx4 a[76:79], v3, s[8:11], s64 offen offset:1024
  buffer_load_dwordx4 v6, s[12:15], s65 offen offset:2048 lds
  buffer_load_dwordx4 a[80:83], v2, s[8:11], s64 offen offset:2048
  buffer_load_dwordx4 a[84:87], v3, s[8:11], s64 offen offset:2048
  buffer_load_dwordx4 v7, s[12:15], s65 offen offset:3072 lds
  buffer_load_dwordx4 a[88:91], v2, s[8:11], s64 offen offset:3072
  buffer_load_dwordx4 a[92:95], v3, s[8:11], s64 offen offset:3072
  s_add_u32 s64, s64, 4096
  s_add_u32 s65, s65, 262144
  s_add_u32 m0, s66, 49152
s_nop 0
  buffer_load_dwordx4 v4, s[12:15], s65 offen offset:0 lds
  buffer_load_dwordx4 a[96:99], v2, s[8:11], s64 offen offset:0
  buffer_load_dwordx4 a[100:103], v3, s[8:11], s64 offen offset:0
  buffer_load_dwordx4 v5, s[12:15], s65 offen offset:1024 lds
  buffer_load_dwordx4 a[104:107], v2, s[8:11], s64 offen offset:1024
  buffer_load_dwordx4 a[108:111], v3, s[8:11], s64 offen offset:1024
  buffer_load_dwordx4 v6, s[12:15], s65 offen offset:2048 lds
  buffer_load_dwordx4 a[112:115], v2, s[8:11], s64 offen offset:2048
  buffer_load_dwordx4 a[116:119], v3, s[8:11], s64 offen offset:2048
  buffer_load_dwordx4 v7, s[12:15], s65 offen offset:3072 lds
  buffer_load_dwordx4 a[120:123], v2, s[8:11], s64 offen offset:3072
  buffer_load_dwordx4 a[124:127], v3, s[8:11], s64 offen offset:3072
  s_add_u32 s64, s64, 4096
  s_add_u32 s65, s65, 262144
  s_waitcnt vmcnt(38)
  s_barrier
  ds_read_b64_tr_b16 v[52:53], v8 offset:0
  ds_read_b64_tr_b16 v[54:55], v8 offset:1024
  ds_read_b64_tr_b16 v[56:57], v9 offset:0
  ds_read_b64_tr_b16 v[58:59], v9 offset:1024
  ds_read_b64_tr_b16 v[60:61], v10 offset:0
  ds_read_b64_tr_b16 v[62:63], v10 offset:1024
  ds_read_b64_tr_b16 v[64:65], v11 offset:0
  ds_read_b64_tr_b16 v[66:67], v11 offset:1024
s_waitcnt lgkmcnt(6)
  v_mfma_f32_16x16x32_bf16 v[20:23], v[52:55], a[0:3], 0
  ds_read_b64_tr_b16 v[68:69], v8 offset:4096
  ds_read_b64_tr_b16 v[70:71], v8 offset:5120
  v_mfma_f32_16x16x32_bf16 v[24:27], v[52:55], a[4:7], 0
  ds_read_b64_tr_b16 v[72:73], v9 offset:4096
s_waitcnt lgkmcnt(7)
  v_mfma_f32_16x16x32_bf16 v[28:31], v[56:59], a[0:3], 0
  ds_read_b64_tr_b16 v[74:75], v9 offset:5120
  s_add_u32 m0, s66, 65536
  v_mfma_f32_16x16x32_bf16 v[32:35], v[56:59], a[4:7], 0
  ds_read_b64_tr_b16 v[76:77], v10 offset:4096
  ds_read_b64_tr_b16 v[78:79], v10 offset:5120
s_waitcnt lgkmcnt(8)
  v_mfma_f32_16x16x32_bf16 v[36:39], v[60:63], a[0:3], 0
  ds_read_b64_tr_b16 v[80:81], v11 offset:4096
  buffer_load_dwordx4 v4, s[12:15], s65 offen offset:0 lds
  v_mfma_f32_16x16x32_bf16 v[40:43], v[60:63], a[4:7], 0
  ds_read_b64_tr_b16 v[82:83], v11 offset:5120
s_waitcnt lgkmcnt(8)
  v_mfma_f32_16x16x32_bf16 v[44:47], v[64:67], a[0:3], 0
  buffer_load_dwordx4 a[0:3], v2, s[8:11], s64 offen offset:0
  v_mfma_f32_16x16x32_bf16 v[48:51], v[64:67], a[4:7], 0
  buffer_load_dwordx4 a[4:7], v3, s[8:11], s64 offen offset:0
s_waitcnt lgkmcnt(6)
  v_mfma_f32_16x16x32_bf16 v[20:23], v[68:71], a[8:11], v[20:23]
  ds_read_b64_tr_b16 v[52:53], v8 offset:8192
  ds_read_b64_tr_b16 v[54:55], v8 offset:9216
  v_mfma_f32_16x16x32_bf16 v[24:27], v[68:71], a[12:15], v[24:27]
  ds_read_b64_tr_b16 v[56:57], v9 offset:8192
s_waitcnt lgkmcnt(7)
  v_mfma_f32_16x16x32_bf16 v[28:31], v[72:75], a[8:11], v[28:31]
  ds_read_b64_tr_b16 v[58:59], v9 offset:9216
  v_mfma_f32_16x16x32_bf16 v[32:35], v[72:75], a[12:15], v[32:35]
  ds_read_b64_tr_b16 v[60:61], v10 offset:8192
  ds_read_b64_tr_b16 v[62:63], v10 offset:9216
s_waitcnt lgkmcnt(8)
  v_mfma_f32_16x16x32_bf16 v[36:39], v[76:79], a[8:11], v[36:39]
  ds_read_b64_tr_b16 v[64:65], v11 offset:8192
  buffer_load_dwordx4 v5, s[12:15], s65 offen offset:1024 lds
  v_mfma_f32_16x16x32_bf16 v[40:43], v[76:79], a[12:15], v[40:43]
  ds_read_b64_tr_b16 v[66:67], v11 offset:9216
s_waitcnt lgkmcnt(8)
  v_mfma_f32_16x16x32_bf16 v[44:47], v[80:83], a[8:11], v[44:47]
  buffer_load_dwordx4 a[8:11], v2, s[8:11], s64 offen offset:1024
  v_mfma_f32_16x16x32_bf16 v[48:51], v[80:83], a[12:15], v[48:51]
  buffer_load_dwordx4 a[12:15], v3, s[8:11], s64 offen offset:1024
s_waitcnt lgkmcnt(6)
  v_mfma_f32_16x16x32_bf16 v[20:23], v[52:55], a[16:19], v[20:23]
  ds_read_b64_tr_b16 v[68:69], v8 offset:12288
  ds_read_b64_tr_b16 v[70:71], v8 offset:13312
  v_mfma_f32_16x16x32_bf16 v[24:27], v[52:55], a[20:23], v[24:27]
  ds_read_b64_tr_b16 v[72:73], v9 offset:12288
s_waitcnt lgkmcnt(7)
  v_mfma_f32_16x16x32_bf16 v[28:31], v[56:59], a[16:19], v[28:31]
  ds_read_b64_tr_b16 v[74:75], v9 offset:13312
  v_mfma_f32_16x16x32_bf16 v[32:35], v[56:59], a[20:23], v[32:35]
  ds_read_b64_tr_b16 v[76:77], v10 offset:12288
  ds_read_b64_tr_b16 v[78:79], v10 offset:13312
s_waitcnt lgkmcnt(8)
  v_mfma_f32_16x16x32_bf16 v[36:39], v[60:63], a[16:19], v[36:39]
  ds_read_b64_tr_b16 v[80:81], v11 offset:12288
  buffer_load_dwordx4 v6, s[12:15], s65 offen offset:2048 lds
  v_mfma_f32_16x16x32_bf16 v[40:43], v[60:63], a[20:23], v[40:43]
  ds_read_b64_tr_b16 v[82:83], v11 offset:13312
s_waitcnt lgkmcnt(8)
  v_mfma_f32_16x16x32_bf16 v[44:47], v[64:67], a[16:19], v[44:47]
  buffer_load_dwordx4 a[16:19], v2, s[8:11], s64 offen offset:2048
  v_mfma_f32_16x16x32_bf16 v[48:51], v[64:67], a[20:23], v[48:51]
  buffer_load_dwordx4 a[20:23], v3, s[8:11], s64 offen offset:2048
  s_waitcnt vmcnt(35)
  s_barrier
s_waitcnt lgkmcnt(6)
  v_mfma_f32_16x16x32_bf16 v[20:23], v[68:71], a[24:27], v[20:23]
  ds_read_b64_tr_b16 v[52:53], v8 offset:16384
  ds_read_b64_tr_b16 v[54:55], v8 offset:17408
  v_mfma_f32_16x16x32_bf16 v[24:27], v[68:71], a[28:31], v[24:27]
  ds_read_b64_tr_b16 v[56:57], v9 offset:16384
s_waitcnt lgkmcnt(7)
  v_mfma_f32_16x16x32_bf16 v[28:31], v[72:75], a[24:27], v[28:31]
  ds_read_b64_tr_b16 v[58:59], v9 offset:17408
  v_mfma_f32_16x16x32_bf16 v[32:35], v[72:75], a[28:31], v[32:35]
  ds_read_b64_tr_b16 v[60:61], v10 offset:16384
  ds_read_b64_tr_b16 v[62:63], v10 offset:17408
s_waitcnt lgkmcnt(8)
  v_mfma_f32_16x16x32_bf16 v[36:39], v[76:79], a[24:27], v[36:39]
  ds_read_b64_tr_b16 v[64:65], v11 offset:16384
  buffer_load_dwordx4 v7, s[12:15], s65 offen offset:3072 lds
  v_mfma_f32_16x16x32_bf16 v[40:43], v[76:79], a[28:31], v[40:43]
  ds_read_b64_tr_b16 v[66:67], v11 offset:17408
s_waitcnt lgkmcnt(8)
  v_mfma_f32_16x16x32_bf16 v[44:47], v[80:83], a[24:27], v[44:47]
  buffer_load_dwordx4 a[24:27], v2, s[8:11], s64 offen offset:3072
  v_mfma_f32_16x16x32_bf16 v[48:51], v[80:83], a[28:31], v[48:51]
  buffer_load_dwordx4 a[28:31], v3, s[8:11], s64 offen offset:3072
  s_add_u32 s64, s64, 4096
  s_add_u32 s65, s65, 262144
s_waitcnt lgkmcnt(6)
  v_mfma_f32_16x16x32_bf16 v[20:23], v[52:55], a[32:35], v[20:23]
  ds_read_b64_tr_b16 v[68:69], v8 offset:20480
  ds_read_b64_tr_b16 v[70:71], v8 offset:21504
  v_mfma_f32_16x16x32_bf16 v[24:27], v[52:55], a[36:39], v[24:27]
  ds_read_b64_tr_b16 v[72:73], v9 offset:20480
s_waitcnt lgkmcnt(7)
  v_mfma_f32_16x16x32_bf16 v[28:31], v[56:59], a[32:35], v[28:31]
  ds_read_b64_tr_b16 v[74:75], v9 offset:21504
  s_add_u32 m0, s66, 81920
  v_mfma_f32_16x16x32_bf16 v[32:35], v[56:59], a[36:39], v[32:35]
  ds_read_b64_tr_b16 v[76:77], v10 offset:20480
  ds_read_b64_tr_b16 v[78:79], v10 offset:21504
s_waitcnt lgkmcnt(8)
  v_mfma_f32_16x16x32_bf16 v[36:39], v[60:63], a[32:35], v[36:39]
  ds_read_b64_tr_b16 v[80:81], v11 offset:20480
  buffer_load_dwordx4 v4, s[12:15], s65 offen offset:0 lds
  v_mfma_f32_16x16x32_bf16 v[40:43], v[60:63], a[36:39], v[40:43]
  ds_read_b64_tr_b16 v[82:83], v11 offset:21504
s_waitcnt lgkmcnt(8)
  v_mfma_f32_16x16x32_bf16 v[44:47], v[64:67], a[32:35], v[44:47]
  buffer_load_dwordx4 a[32:35], v2, s[8:11], s64 offen offset:0
  v_mfma_f32_16x16x32_bf16 v[48:51], v[64:67], a[36:39], v[48:51]
  buffer_load_dwordx4 a[36:39], v3, s[8:11], s64 offen offset:0
s_waitcnt lgkmcnt(6)
  v_mfma_f32_16x16x32_bf16 v[20:23], v[68:71], a[40:43], v[20:23]
  ds_read_b64_tr_b16 v[52:53], v8 offset:24576
  ds_read_b64_tr_b16 v[54:55], v8 offset:25600
  v_mfma_f32_16x16x32_bf16 v[24:27], v[68:71], a[44:47], v[24:27]
  ds_read_b64_tr_b16 v[56:57], v9 offset:24576
s_waitcnt lgkmcnt(7)
  v_mfma_f32_16x16x32_bf16 v[28:31], v[72:75], a[40:43], v[28:31]
  ds_read_b64_tr_b16 v[58:59], v9 offset:25600
  v_mfma_f32_16x16x32_bf16 v[32:35], v[72:75], a[44:47], v[32:35]
  ds_read_b64_tr_b16 v[60:61], v10 offset:24576
  ds_read_b64_tr_b16 v[62:63], v10 offset:25600
s_waitcnt lgkmcnt(8)
  v_mfma_f32_16x16x32_bf16 v[36:39], v[76:79], a[40:43], v[36:39]
  ds_read_b64_tr_b16 v[64:65], v11 offset:24576
  buffer_load_dwordx4 v5, s[12:15], s65 offen offset:1024 lds
  v_mfma_f32_16x16x32_bf16 v[40:43], v[76:79], a[44:47], v[40:43]
  ds_read_b64_tr_b16 v[66:67], v11 offset:25600
s_waitcnt lgkmcnt(8)
  v_mfma_f32_16x16x32_bf16 v[44:47], v[80:83], a[40:43], v[44:47]
  buffer_load_dwordx4 a[40:43], v2, s[8:11], s64 offen offset:1024
  v_mfma_f32_16x16x32_bf16 v[48:51], v[80:83], a[44:47], v[48:51]
  buffer_load_dwordx4 a[44:47], v3, s[8:11], s64 offen offset:1024
s_waitcnt lgkmcnt(6)
  v_mfma_f32_16x16x32_bf16 v[20:23], v[52:55], a[48:51], v[20:23]
  ds_read_b64_tr_b16 v[68:69], v8 offset:28672
  ds_read_b64_tr_b16 v[70:71], v8 offset:29696
  v_mfma_f32_16x16x32_bf16 v[24:27], v[52:55], a[52:55], v[24:27]
  ds_read_b64_tr_b16 v[72:73], v9 offset:28672
s_waitcnt lgkmcnt(7)
  v_mfma_f32_16x16x32_bf16 v[28:31], v[56:59], a[48:51], v[28:31]
  ds_read_b64_tr_b16 v[74:75], v9 offset:29696
  v_mfma_f32_16x16x32_bf16 v[32:35], v[56:59], a[52:55], v[32:35]
  ds_read_b64_tr_b16 v[76:77], v10 offset:28672
  ds_read_b64_tr_b16 v[78:79], v10 offset:29696
s_waitcnt lgkmcnt(8)
  v_mfma_f32_16x16x32_bf16 v[36:39], v[60:63], a[48:51], v[36:39]
  ds_read_b64_tr_b16 v[80:81], v11 offset:28672
  buffer_load_dwordx4 v6, s[12:15], s65 offen offset:2048 lds
  v_mfma_f32_16x16x32_bf16 v[40:43], v[60:63], a[52:55], v[40:43]
  ds_read_b64_tr_b16 v[82:83], v11 offset:29696
s_waitcnt lgkmcnt(8)
  v_mfma_f32_16x16x32_bf16 v[44:47], v[64:67], a[48:51], v[44:47]
  buffer_load_dwordx4 a[48:51], v2, s[8:11], s64 offen offset:2048
  v_mfma_f32_16x16x32_bf16 v[48:51], v[64:67], a[52:55], v[48:51]
  buffer_load_dwordx4 a[52:55], v3, s[8:11], s64 offen offset:2048
  s_waitcnt vmcnt(35)
  s_barrier
s_waitcnt lgkmcnt(6)
  v_mfma_f32_16x16x32_bf16 v[20:23], v[68:71], a[56:59], v[20:23]
  ds_read_b64_tr_b16 v[52:53], v8 offset:32768
  ds_read_b64_tr_b16 v[54:55], v8 offset:33792
  v_mfma_f32_16x16x32_bf16 v[24:27], v[68:71], a[60:63], v[24:27]
  ds_read_b64_tr_b16 v[56:57], v9 offset:32768
s_waitcnt lgkmcnt(7)
  v_mfma_f32_16x16x32_bf16 v[28:31], v[72:75], a[56:59], v[28:31]
  ds_read_b64_tr_b16 v[58:59], v9 offset:33792
  v_mfma_f32_16x16x32_bf16 v[32:35], v[72:75], a[60:63], v[32:35]
  ds_read_b64_tr_b16 v[60:61], v10 offset:32768
  ds_read_b64_tr_b16 v[62:63], v10 offset:33792
s_waitcnt lgkmcnt(8)
  v_mfma_f32_16x16x32_bf16 v[36:39], v[76:79], a[56:59], v[36:39]
  ds_read_b64_tr_b16 v[64:65], v11 offset:32768
  buffer_load_dwordx4 v7, s[12:15], s65 offen offset:3072 lds
  v_mfma_f32_16x16x32_bf16 v[40:43], v[76:79], a[60:63], v[40:43]
  ds_read_b64_tr_b16 v[66:67], v11 offset:33792
s_waitcnt lgkmcnt(8)
  v_mfma_f32_16x16x32_bf16 v[44:47], v[80:83], a[56:59], v[44:47]
  buffer_load_dwordx4 a[56:59], v2, s[8:11], s64 offen offset:3072
  v_mfma_f32_16x16x32_bf16 v[48:51], v[80:83], a[60:63], v[48:51]
  buffer_load_dwordx4 a[60:63], v3, s[8:11], s64 offen offset:3072
  s_add_u32 s64, s64, 4096
  s_add_u32 s65, s65, 262144
s_waitcnt lgkmcnt(6)
  v_mfma_f32_16x16x32_bf16 v[20:23], v[52:55], a[64:67], v[20:23]
  ds_read_b64_tr_b16 v[68:69], v8 offset:36864
  ds_read_b64_tr_b16 v[70:71], v8 offset:37888
  v_mfma_f32_16x16x32_bf16 v[24:27], v[52:55], a[68:71], v[24:27]
  ds_read_b64_tr_b16 v[72:73], v9 offset:36864
s_waitcnt lgkmcnt(7)
  v_mfma_f32_16x16x32_bf16 v[28:31], v[56:59], a[64:67], v[28:31]
  ds_read_b64_tr_b16 v[74:75], v9 offset:37888
  s_add_u32 m0, s66, 98304
  v_mfma_f32_16x16x32_bf16 v[32:35], v[56:59], a[68:71], v[32:35]
  ds_read_b64_tr_b16 v[76:77], v10 offset:36864
  ds_read_b64_tr_b16 v[78:79], v10 offset:37888
s_waitcnt lgkmcnt(8)
  v_mfma_f32_16x16x32_bf16 v[36:39], v[60:63], a[64:67], v[36:39]
  ds_read_b64_tr_b16 v[80:81], v11 offset:36864
  buffer_load_dwordx4 v4, s[12:15], s65 offen offset:0 lds
  v_mfma_f32_16x16x32_bf16 v[40:43], v[60:63], a[68:71], v[40:43]
  ds_read_b64_tr_b16 v[82:83], v11 offset:37888
s_waitcnt lgkmcnt(8)
  v_mfma_f32_16x16x32_bf16 v[44:47], v[64:67], a[64:67], v[44:47]
  buffer_load_dwordx4 a[64:67], v2, s[8:11], s64 offen offset:0
  v_mfma_f32_16x16x32_bf16 v[48:51], v[64:67], a[68:71], v[48:51]
  buffer_load_dwordx4 a[68:71], v3, s[8:11], s64 offen offset:0
s_waitcnt lgkmcnt(6)
  v_mfma_f32_16x16x32_bf16 v[20:23], v[68:71], a[72:75], v[20:23]
  ds_read_b64_tr_b16 v[52:53], v8 offset:40960
  ds_read_b64_tr_b16 v[54:55], v8 offset:41984
  v_mfma_f32_16x16x32_bf16 v[24:27], v[68:71], a[76:79], v[24:27]
  ds_read_b64_tr_b16 v[56:57], v9 offset:40960
s_waitcnt lgkmcnt(7)
  v_mfma_f32_16x16x32_bf16 v[28:31], v[72:75], a[72:75], v[28:31]
  ds_read_b64_tr_b16 v[58:59], v9 offset:41984
  v_mfma_f32_16x16x32_bf16 v[32:35], v[72:75], a[76:79], v[32:35]
  ds_read_b64_tr_b16 v[60:61], v10 offset:40960
  ds_read_b64_tr_b16 v[62:63], v10 offset:41984
s_waitcnt lgkmcnt(8)
  v_mfma_f32_16x16x32_bf16 v[36:39], v[76:79], a[72:75], v[36:39]
  ds_read_b64_tr_b16 v[64:65], v11 offset:40960
  buffer_load_dwordx4 v5, s[12:15], s65 offen offset:1024 lds
  v_mfma_f32_16x16x32_bf16 v[40:43], v[76:79], a[76:79], v[40:43]
  ds_read_b64_tr_b16 v[66:67], v11 offset:41984
s_waitcnt lgkmcnt(8)
  v_mfma_f32_16x16x32_bf16 v[44:47], v[80:83], a[72:75], v[44:47]
  buffer_load_dwordx4 a[72:75], v2, s[8:11], s64 offen offset:1024
  v_mfma_f32_16x16x32_bf16 v[48:51], v[80:83], a[76:79], v[48:51]
  buffer_load_dwordx4 a[76:79], v3, s[8:11], s64 offen offset:1024
s_waitcnt lgkmcnt(6)
  v_mfma_f32_16x16x32_bf16 v[20:23], v[52:55], a[80:83], v[20:23]
  ds_read_b64_tr_b16 v[68:69], v8 offset:45056
  ds_read_b64_tr_b16 v[70:71], v8 offset:46080
  v_mfma_f32_16x16x32_bf16 v[24:27], v[52:55], a[84:87], v[24:27]
  ds_read_b64_tr_b16 v[72:73], v9 offset:45056
s_waitcnt lgkmcnt(7)
  v_mfma_f32_16x16x32_bf16 v[28:31], v[56:59], a[80:83], v[28:31]
  ds_read_b64_tr_b16 v[74:75], v9 offset:46080
  v_mfma_f32_16x16x32_bf16 v[32:35], v[56:59], a[84:87], v[32:35]
  ds_read_b64_tr_b16 v[76:77], v10 offset:45056
  ds_read_b64_tr_b16 v[78:79], v10 offset:46080
s_waitcnt lgkmcnt(8)
  v_mfma_f32_16x16x32_bf16 v[36:39], v[60:63], a[80:83], v[36:39]
  ds_read_b64_tr_b16 v[80:81], v11 offset:45056
  buffer_load_dwordx4 v6, s[12:15], s65 offen offset:2048 lds
  v_mfma_f32_16x16x32_bf16 v[40:43], v[60:63], a[84:87], v[40:43]
  ds_read_b64_tr_b16 v[82:83], v11 offset:46080
s_waitcnt lgkmcnt(8)
  v_mfma_f32_16x16x32_bf16 v[44:47], v[64:67], a[80:83], v[44:47]
  buffer_load_dwordx4 a[80:83], v2, s[8:11], s64 offen offset:2048
  v_mfma_f32_16x16x32_bf16 v[48:51], v[64:67], a[84:87], v[48:51]
  buffer_load_dwordx4 a[84:87], v3, s[8:11], s64 offen offset:2048
  s_waitcnt vmcnt(35)
  s_barrier
s_waitcnt lgkmcnt(6)
  v_mfma_f32_16x16x32_bf16 v[20:23], v[68:71], a[88:91], v[20:23]
  ds_read_b64_tr_b16 v[52:53], v8 offset:49152
  ds_read_b64_tr_b16 v[54:55], v8 offset:50176
  v_mfma_f32_16x16x32_bf16 v[24:27], v[68:71], a[92:95], v[24:27]
  ds_read_b64_tr_b16 v[56:57], v9 offset:49152
s_waitcnt lgkmcnt(7)
  v_mfma_f32_16x16x32_bf16 v[28:31], v[72:75], a[88:91], v[28:31]
  ds_read_b64_tr_b16 v[58:59], v9 offset:50176
  v_mfma_f32_16x16x32_bf16 v[32:35], v[72:75], a[92:95], v[32:35]
  ds_read_b64_tr_b16 v[60:61], v10 offset:49152
  ds_read_b64_tr_b16 v[62:63], v10 offset:50176
s_waitcnt lgkmcnt(8)
  v_mfma_f32_16x16x32_bf16 v[36:39], v[76:79], a[88:91], v[36:39]
  ds_read_b64_tr_b16 v[64:65], v11 offset:49152
  buffer_load_dwordx4 v7, s[12:15], s65 offen offset:3072 lds
  v_mfma_f32_16x16x32_bf16 v[40:43], v[76:79], a[92:95], v[40:43]
  ds_read_b64_tr_b16 v[66:67], v11 offset:50176
s_waitcnt lgkmcnt(8)
  v_mfma_f32_16x16x32_bf16 v[44:47], v[80:83], a[88:91], v[44:47]
  buffer_load_dwordx4 a[88:91], v2, s[8:11], s64 offen offset:3072
  v_mfma_f32_16x16x32_bf16 v[48:51], v[80:83], a[92:95], v[48:51]
  buffer_load_dwordx4 a[92:95], v3, s[8:11], s64 offen offset:3072
  s_add_u32 s64, s64, 4096
  s_add_u32 s65, s65, 262144
s_waitcnt lgkmcnt(6)
  v_mfma_f32_16x16x32_bf16 v[20:23], v[52:55], a[96:99], v[20:23]
  ds_read_b64_tr_b16 v[68:69], v8 offset:53248
  ds_read_b64_tr_b16 v[70:71], v8 offset:54272
  v_mfma_f32_16x16x32_bf16 v[24:27], v[52:55], a[100:103], v[24:27]
  ds_read_b64_tr_b16 v[72:73], v9 offset:53248
s_waitcnt lgkmcnt(7)
  v_mfma_f32_16x16x32_bf16 v[28:31], v[56:59], a[96:99], v[28:31]
  ds_read_b64_tr_b16 v[74:75], v9 offset:54272
  s_add_u32 m0, s66, 114688
  v_mfma_f32_16x16x32_bf16 v[32:35], v[56:59], a[100:103], v[32:35]
  ds_read_b64_tr_b16 v[76:77], v10 offset:53248
  ds_read_b64_tr_b16 v[78:79], v10 offset:54272
s_waitcnt lgkmcnt(8)
  v_mfma_f32_16x16x32_bf16 v[36:39], v[60:63], a[96:99], v[36:39]
  ds_read_b64_tr_b16 v[80:81], v11 offset:53248
  buffer_load_dwordx4 v4, s[12:15], s65 offen offset:0 lds
  v_mfma_f32_16x16x32_bf16 v[40:43], v[60:63], a[100:103], v[40:43]
  ds_read_b64_tr_b16 v[82:83], v11 offset:54272
s_waitcnt lgkmcnt(8)
  v_mfma_f32_16x16x32_bf16 v[44:47], v[64:67], a[96:99], v[44:47]
  buffer_load_dwordx4 a[96:99], v2, s[8:11], s64 offen offset:0
  v_mfma_f32_16x16x32_bf16 v[48:51], v[64:67], a[100:103], v[48:51]
  buffer_load_dwordx4 a[100:103], v3, s[8:11], s64 offen offset:0
s_waitcnt lgkmcnt(6)
  v_mfma_f32_16x16x32_bf16 v[20:23], v[68:71], a[104:107], v[20:23]
  ds_read_b64_tr_b16 v[52:53], v8 offset:57344
  ds_read_b64_tr_b16 v[54:55], v8 offset:58368
  v_mfma_f32_16x16x32_bf16 v[24:27], v[68:71], a[108:111], v[24:27]
  ds_read_b64_tr_b16 v[56:57], v9 offset:57344
s_waitcnt lgkmcnt(7)
  v_mfma_f32_16x16x32_bf16 v[28:31], v[72:75], a[104:107], v[28:31]
  ds_read_b64_tr_b16 v[58:59], v9 offset:58368
  v_mfma_f32_16x16x32_bf16 v[32:35], v[72:75], a[108:111], v[32:35]
  ds_read_b64_tr_b16 v[60:61], v10 offset:57344
  ds_read_b64_tr_b16 v[62:63], v10 offset:58368
s_waitcnt lgkmcnt(8)
  v_mfma_f32_16x16x32_bf16 v[36:39], v[76:79], a[104:107], v[36:39]
  ds_read_b64_tr_b16 v[64:65], v11 offset:57344
  buffer_load_dwordx4 v5, s[12:15], s65 offen offset:1024 lds
  v_mfma_f32_16x16x32_bf16 v[40:43], v[76:79], a[108:111], v[40:43]
  ds_read_b64_tr_b16 v[66:67], v11 offset:58368
s_waitcnt lgkmcnt(8)
  v_mfma_f32_16x16x32_bf16 v[44:47], v[80:83], a[104:107], v[44:47]
  buffer_load_dwordx4 a[104:107], v2, s[8:11], s64 offen offset:1024
  v_mfma_f32_16x16x32_bf16 v[48:51], v[80:83], a[108:111], v[48:51]
  buffer_load_dwordx4 a[108:111], v3, s[8:11], s64 offen offset:1024
s_waitcnt lgkmcnt(6)
  v_mfma_f32_16x16x32_bf16 v[20:23], v[52:55], a[112:115], v[20:23]
  ds_read_b64_tr_b16 v[68:69], v8 offset:61440
  ds_read_b64_tr_b16 v[70:71], v8 offset:62464
  v_mfma_f32_16x16x32_bf16 v[24:27], v[52:55], a[116:119], v[24:27]
  ds_read_b64_tr_b16 v[72:73], v9 offset:61440
s_waitcnt lgkmcnt(7)
  v_mfma_f32_16x16x32_bf16 v[28:31], v[56:59], a[112:115], v[28:31]
  ds_read_b64_tr_b16 v[74:75], v9 offset:62464
  v_mfma_f32_16x16x32_bf16 v[32:35], v[56:59], a[116:119], v[32:35]
  ds_read_b64_tr_b16 v[76:77], v10 offset:61440
  ds_read_b64_tr_b16 v[78:79], v10 offset:62464
s_waitcnt lgkmcnt(8)
  v_mfma_f32_16x16x32_bf16 v[36:39], v[60:63], a[112:115], v[36:39]
  ds_read_b64_tr_b16 v[80:81], v11 offset:61440
  buffer_load_dwordx4 v6, s[12:15], s65 offen offset:2048 lds
  v_mfma_f32_16x16x32_bf16 v[40:43], v[60:63], a[116:119], v[40:43]
  ds_read_b64_tr_b16 v[82:83], v11 offset:62464
s_waitcnt lgkmcnt(8)
  v_mfma_f32_16x16x32_bf16 v[44:47], v[64:67], a[112:115], v[44:47]
  buffer_load_dwordx4 a[112:115], v2, s[8:11], s64 offen offset:2048
  v_mfma_f32_16x16x32_bf16 v[48:51], v[64:67], a[116:119], v[48:51]
  buffer_load_dwordx4 a[116:119], v3, s[8:11], s64 offen offset:2048
  s_waitcnt vmcnt(35)
  s_barrier
s_waitcnt lgkmcnt(6)
  v_mfma_f32_16x16x32_bf16 v[20:23], v[68:71], a[120:123], v[20:23]
  ds_read_b64_tr_b16 v[52:53], v12 offset:0
  ds_read_b64_tr_b16 v[54:55], v12 offset:1024
  v_mfma_f32_16x16x32_bf16 v[24:27], v[68:71], a[124:127], v[24:27]
  ds_read_b64_tr_b16 v[56:57], v13 offset:0
s_waitcnt lgkmcnt(7)
  v_mfma_f32_16x16x32_bf16 v[28:31], v[72:75], a[120:123], v[28:31]
  ds_read_b64_tr_b16 v[58:59], v13 offset:1024
  v_mfma_f32_16x16x32_bf16 v[32:35], v[72:75], a[124:127], v[32:35]
  ds_read_b64_tr_b16 v[60:61], v14 offset:0
  ds_read_b64_tr_b16 v[62:63], v14 offset:1024
s_waitcnt lgkmcnt(8)
  v_mfma_f32_16x16x32_bf16 v[36:39], v[76:79], a[120:123], v[36:39]
  ds_read_b64_tr_b16 v[64:65], v15 offset:0
  buffer_load_dwordx4 v7, s[12:15], s65 offen offset:3072 lds
  v_mfma_f32_16x16x32_bf16 v[40:43], v[76:79], a[124:127], v[40:43]
  ds_read_b64_tr_b16 v[66:67], v15 offset:1024
s_waitcnt lgkmcnt(8)
  v_mfma_f32_16x16x32_bf16 v[44:47], v[80:83], a[120:123], v[44:47]
  buffer_load_dwordx4 a[120:123], v2, s[8:11], s64 offen offset:3072
  v_mfma_f32_16x16x32_bf16 v[48:51], v[80:83], a[124:127], v[48:51]
  buffer_load_dwordx4 a[124:127], v3, s[8:11], s64 offen offset:3072
  s_add_u32 s64, s64, 4096
  s_add_u32 s65, s65, 262144
s_waitcnt lgkmcnt(6)
  v_mfma_f32_16x16x32_bf16 v[20:23], v[52:55], a[0:3], v[20:23]
  ds_read_b64_tr_b16 v[68:69], v12 offset:4096
  ds_read_b64_tr_b16 v[70:71], v12 offset:5120
  v_mfma_f32_16x16x32_bf16 v[24:27], v[52:55], a[4:7], v[24:27]
  ds_read_b64_tr_b16 v[72:73], v13 offset:4096
s_waitcnt lgkmcnt(7)
  v_mfma_f32_16x16x32_bf16 v[28:31], v[56:59], a[0:3], v[28:31]
  ds_read_b64_tr_b16 v[74:75], v13 offset:5120
  s_add_u32 m0, s66, 0
  v_mfma_f32_16x16x32_bf16 v[32:35], v[56:59], a[4:7], v[32:35]
  ds_read_b64_tr_b16 v[76:77], v14 offset:4096
  ds_read_b64_tr_b16 v[78:79], v14 offset:5120
s_waitcnt lgkmcnt(8)
  v_mfma_f32_16x16x32_bf16 v[36:39], v[60:63], a[0:3], v[36:39]
  ds_read_b64_tr_b16 v[80:81], v15 offset:4096
  buffer_load_dwordx4 v4, s[12:15], s65 offen offset:0 lds
  v_mfma_f32_16x16x32_bf16 v[40:43], v[60:63], a[4:7], v[40:43]
  ds_read_b64_tr_b16 v[82:83], v15 offset:5120
s_waitcnt lgkmcnt(8)
  v_mfma_f32_16x16x32_bf16 v[44:47], v[64:67], a[0:3], v[44:47]
  buffer_load_dwordx4 a[0:3], v2, s[8:11], s64 offen offset:0
  v_mfma_f32_16x16x32_bf16 v[48:51], v[64:67], a[4:7], v[48:51]
  buffer_load_dwordx4 a[4:7], v3, s[8:11], s64 offen offset:0
s_waitcnt lgkmcnt(6)
  v_mfma_f32_16x16x32_bf16 v[20:23], v[68:71], a[8:11], v[20:23]
  ds_read_b64_tr_b16 v[52:53], v12 offset:8192
  ds_read_b64_tr_b16 v[54:55], v12 offset:9216
  v_mfma_f32_16x16x32_bf16 v[24:27], v[68:71], a[12:15], v[24:27]
  ds_read_b64_tr_b16 v[56:57], v13 offset:8192
s_waitcnt lgkmcnt(7)
  v_mfma_f32_16x16x32_bf16 v[28:31], v[72:75], a[8:11], v[28:31]
  ds_read_b64_tr_b16 v[58:59], v13 offset:9216
  v_mfma_f32_16x16x32_bf16 v[32:35], v[72:75], a[12:15], v[32:35]
  ds_read_b64_tr_b16 v[60:61], v14 offset:8192
  ds_read_b64_tr_b16 v[62:63], v14 offset:9216
s_waitcnt lgkmcnt(8)
  v_mfma_f32_16x16x32_bf16 v[36:39], v[76:79], a[8:11], v[36:39]
  ds_read_b64_tr_b16 v[64:65], v15 offset:8192
  buffer_load_dwordx4 v5, s[12:15], s65 offen offset:1024 lds
  v_mfma_f32_16x16x32_bf16 v[40:43], v[76:79], a[12:15], v[40:43]
  ds_read_b64_tr_b16 v[66:67], v15 offset:9216
s_waitcnt lgkmcnt(8)
  v_mfma_f32_16x16x32_bf16 v[44:47], v[80:83], a[8:11], v[44:47]
  buffer_load_dwordx4 a[8:11], v2, s[8:11], s64 offen offset:1024
  v_mfma_f32_16x16x32_bf16 v[48:51], v[80:83], a[12:15], v[48:51]
  buffer_load_dwordx4 a[12:15], v3, s[8:11], s64 offen offset:1024
s_waitcnt lgkmcnt(6)
  v_mfma_f32_16x16x32_bf16 v[20:23], v[52:55], a[16:19], v[20:23]
  ds_read_b64_tr_b16 v[68:69], v12 offset:12288
  ds_read_b64_tr_b16 v[70:71], v12 offset:13312
  v_mfma_f32_16x16x32_bf16 v[24:27], v[52:55], a[20:23], v[24:27]
  ds_read_b64_tr_b16 v[72:73], v13 offset:12288
s_waitcnt lgkmcnt(7)
  v_mfma_f32_16x16x32_bf16 v[28:31], v[56:59], a[16:19], v[28:31]
  ds_read_b64_tr_b16 v[74:75], v13 offset:13312
  v_mfma_f32_16x16x32_bf16 v[32:35], v[56:59], a[20:23], v[32:35]
  ds_read_b64_tr_b16 v[76:77], v14 offset:12288
  ds_read_b64_tr_b16 v[78:79], v14 offset:13312
s_waitcnt lgkmcnt(8)
  v_mfma_f32_16x16x32_bf16 v[36:39], v[60:63], a[16:19], v[36:39]
  ds_read_b64_tr_b16 v[80:81], v15 offset:12288
  buffer_load_dwordx4 v6, s[12:15], s65 offen offset:2048 lds
  v_mfma_f32_16x16x32_bf16 v[40:43], v[60:63], a[20:23], v[40:43]
  ds_read_b64_tr_b16 v[82:83], v15 offset:13312
s_waitcnt lgkmcnt(8)
  v_mfma_f32_16x16x32_bf16 v[44:47], v[64:67], a[16:19], v[44:47]
  buffer_load_dwordx4 a[16:19], v2, s[8:11], s64 offen offset:2048
  v_mfma_f32_16x16x32_bf16 v[48:51], v[64:67], a[20:23], v[48:51]
  buffer_load_dwordx4 a[20:23], v3, s[8:11], s64 offen offset:2048
  s_waitcnt vmcnt(35)
  s_barrier
s_waitcnt lgkmcnt(6)
  v_mfma_f32_16x16x32_bf16 v[20:23], v[68:71], a[24:27], v[20:23]
  ds_read_b64_tr_b16 v[52:53], v12 offset:16384
  ds_read_b64_tr_b16 v[54:55], v12 offset:17408
  v_mfma_f32_16x16x32_bf16 v[24:27], v[68:71], a[28:31], v[24:27]
  ds_read_b64_tr_b16 v[56:57], v13 offset:16384
s_waitcnt lgkmcnt(7)
  v_mfma_f32_16x16x32_bf16 v[28:31], v[72:75], a[24:27], v[28:31]
  ds_read_b64_tr_b16 v[58:59], v13 offset:17408
  v_mfma_f32_16x16x32_bf16 v[32:35], v[72:75], a[28:31], v[32:35]
  ds_read_b64_tr_b16 v[60:61], v14 offset:16384
  ds_read_b64_tr_b16 v[62:63], v14 offset:17408
s_waitcnt lgkmcnt(8)
  v_mfma_f32_16x16x32_bf16 v[36:39], v[76:79], a[24:27], v[36:39]
  ds_read_b64_tr_b16 v[64:65], v15 offset:16384
  buffer_load_dwordx4 v7, s[12:15], s65 offen offset:3072 lds
  v_mfma_f32_16x16x32_bf16 v[40:43], v[76:79], a[28:31], v[40:43]
  ds_read_b64_tr_b16 v[66:67], v15 offset:17408
s_waitcnt lgkmcnt(8)
  v_mfma_f32_16x16x32_bf16 v[44:47], v[80:83], a[24:27], v[44:47]
  buffer_load_dwordx4 a[24:27], v2, s[8:11], s64 offen offset:3072
  v_mfma_f32_16x16x32_bf16 v[48:51], v[80:83], a[28:31], v[48:51]
  buffer_load_dwordx4 a[28:31], v3, s[8:11], s64 offen offset:3072
  s_add_u32 s64, s64, 4096
  s_add_u32 s65, s65, 262144
s_waitcnt lgkmcnt(6)
  v_mfma_f32_16x16x32_bf16 v[20:23], v[52:55], a[32:35], v[20:23]
  ds_read_b64_tr_b16 v[68:69], v12 offset:20480
  ds_read_b64_tr_b16 v[70:71], v12 offset:21504
  v_mfma_f32_16x16x32_bf16 v[24:27], v[52:55], a[36:39], v[24:27]
  ds_read_b64_tr_b16 v[72:73], v13 offset:20480
s_waitcnt lgkmcnt(7)
  v_mfma_f32_16x16x32_bf16 v[28:31], v[56:59], a[32:35], v[28:31]
  ds_read_b64_tr_b16 v[74:75], v13 offset:21504
  s_add_u32 m0, s66, 16384
  v_mfma_f32_16x16x32_bf16 v[32:35], v[56:59], a[36:39], v[32:35]
  ds_read_b64_tr_b16 v[76:77], v14 offset:20480
  ds_read_b64_tr_b16 v[78:79], v14 offset:21504
s_waitcnt lgkmcnt(8)
  v_mfma_f32_16x16x32_bf16 v[36:39], v[60:63], a[32:35], v[36:39]
  ds_read_b64_tr_b16 v[80:81], v15 offset:20480
  buffer_load_dwordx4 v4, s[12:15], s65 offen offset:0 lds
  v_mfma_f32_16x16x32_bf16 v[40:43], v[60:63], a[36:39], v[40:43]
  ds_read_b64_tr_b16 v[82:83], v15 offset:21504
s_waitcnt lgkmcnt(8)
  v_mfma_f32_16x16x32_bf16 v[44:47], v[64:67], a[32:35], v[44:47]
  buffer_load_dwordx4 a[32:35], v2, s[8:11], s64 offen offset:0
  v_mfma_f32_16x16x32_bf16 v[48:51], v[64:67], a[36:39], v[48:51]
  buffer_load_dwordx4 a[36:39], v3, s[8:11], s64 offen offset:0
s_waitcnt lgkmcnt(6)
  v_mfma_f32_16x16x32_bf16 v[20:23], v[68:71], a[40:43], v[20:23]
  ds_read_b64_tr_b16 v[52:53], v12 offset:24576
  ds_read_b64_tr_b16 v[54:55], v12 offset:25600
  v_mfma_f32_16x16x32_bf16 v[24:27], v[68:71], a[44:47], v[24:27]
  ds_read_b64_tr_b16 v[56:57], v13 offset:24576
s_waitcnt lgkmcnt(7)
  v_mfma_f32_16x16x32_bf16 v[28:31], v[72:75], a[40:43], v[28:31]
  ds_read_b64_tr_b16 v[58:59], v13 offset:25600
  v_mfma_f32_16x16x32_bf16 v[32:35], v[72:75], a[44:47], v[32:35]
  ds_read_b64_tr_b16 v[60:61], v14 offset:24576
  ds_read_b64_tr_b16 v[62:63], v14 offset:25600
s_waitcnt lgkmcnt(8)
  v_mfma_f32_16x16x32_bf16 v[36:39], v[76:79], a[40:43], v[36:39]
  ds_read_b64_tr_b16 v[64:65], v15 offset:24576
  buffer_load_dwordx4 v5, s[12:15], s65 offen offset:1024 lds
  v_mfma_f32_16x16x32_bf16 v[40:43], v[76:79], a[44:47], v[40:43]
  ds_read_b64_tr_b16 v[66:67], v15 offset:25600
s_waitcnt lgkmcnt(8)
  v_mfma_f32_16x16x32_bf16 v[44:47], v[80:83], a[40:43], v[44:47]
  buffer_load_dwordx4 a[40:43], v2, s[8:11], s64 offen offset:1024
  v_mfma_f32_16x16x32_bf16 v[48:51], v[80:83], a[44:47], v[48:51]
  buffer_load_dwordx4 a[44:47], v3, s[8:11], s64 offen offset:1024
s_waitcnt lgkmcnt(6)
  v_mfma_f32_16x16x32_bf16 v[20:23], v[52:55], a[48:51], v[20:23]
  ds_read_b64_tr_b16 v[68:69], v12 offset:28672
  ds_read_b64_tr_b16 v[70:71], v12 offset:29696
  v_mfma_f32_16x16x32_bf16 v[24:27], v[52:55], a[52:55], v[24:27]
  ds_read_b64_tr_b16 v[72:73], v13 offset:28672
s_waitcnt lgkmcnt(7)
  v_mfma_f32_16x16x32_bf16 v[28:31], v[56:59], a[48:51], v[28:31]
  ds_read_b64_tr_b16 v[74:75], v13 offset:29696
  v_mfma_f32_16x16x32_bf16 v[32:35], v[56:59], a[52:55], v[32:35]
  ds_read_b64_tr_b16 v[76:77], v14 offset:28672
  ds_read_b64_tr_b16 v[78:79], v14 offset:29696
s_waitcnt lgkmcnt(8)
  v_mfma_f32_16x16x32_bf16 v[36:39], v[60:63], a[48:51], v[36:39]
  ds_read_b64_tr_b16 v[80:81], v15 offset:28672
  buffer_load_dwordx4 v6, s[12:15], s65 offen offset:2048 lds
  v_mfma_f32_16x16x32_bf16 v[40:43], v[60:63], a[52:55], v[40:43]
  ds_read_b64_tr_b16 v[82:83], v15 offset:29696
s_waitcnt lgkmcnt(8)
  v_mfma_f32_16x16x32_bf16 v[44:47], v[64:67], a[48:51], v[44:47]
  buffer_load_dwordx4 a[48:51], v2, s[8:11], s64 offen offset:2048
  v_mfma_f32_16x16x32_bf16 v[48:51], v[64:67], a[52:55], v[48:51]
  buffer_load_dwordx4 a[52:55], v3, s[8:11], s64 offen offset:2048
  s_waitcnt vmcnt(35)
  s_barrier
s_waitcnt lgkmcnt(6)
  v_mfma_f32_16x16x32_bf16 v[20:23], v[68:71], a[56:59], v[20:23]
  ds_read_b64_tr_b16 v[52:53], v12 offset:32768
  ds_read_b64_tr_b16 v[54:55], v12 offset:33792
  v_mfma_f32_16x16x32_bf16 v[24:27], v[68:71], a[60:63], v[24:27]
  ds_read_b64_tr_b16 v[56:57], v13 offset:32768
s_waitcnt lgkmcnt(7)
  v_mfma_f32_16x16x32_bf16 v[28:31], v[72:75], a[56:59], v[28:31]
  ds_read_b64_tr_b16 v[58:59], v13 offset:33792
  v_mfma_f32_16x16x32_bf16 v[32:35], v[72:75], a[60:63], v[32:35]
  ds_read_b64_tr_b16 v[60:61], v14 offset:32768
  ds_read_b64_tr_b16 v[62:63], v14 offset:33792
s_waitcnt lgkmcnt(8)
  v_mfma_f32_16x16x32_bf16 v[36:39], v[76:79], a[56:59], v[36:39]
  ds_read_b64_tr_b16 v[64:65], v15 offset:32768
  buffer_load_dwordx4 v7, s[12:15], s65 offen offset:3072 lds
  v_mfma_f32_16x16x32_bf16 v[40:43], v[76:79], a[60:63], v[40:43]
  ds_read_b64_tr_b16 v[66:67], v15 offset:33792
s_waitcnt lgkmcnt(8)
  v_mfma_f32_16x16x32_bf16 v[44:47], v[80:83], a[56:59], v[44:47]
  buffer_load_dwordx4 a[56:59], v2, s[8:11], s64 offen offset:3072
  v_mfma_f32_16x16x32_bf16 v[48:51], v[80:83], a[60:63], v[48:51]
  buffer_load_dwordx4 a[60:63], v3, s[8:11], s64 offen offset:3072
  s_add_u32 s64, s64, 4096
  s_add_u32 s65, s65, 262144
s_waitcnt lgkmcnt(6)
  v_mfma_f32_16x16x32_bf16 v[20:23], v[52:55], a[64:67], v[20:23]
  ds_read_b64_tr_b16 v[68:69], v12 offset:36864
  ds_read_b64_tr_b16 v[70:71], v12 offset:37888
  v_mfma_f32_16x16x32_bf16 v[24:27], v[52:55], a[68:71], v[24:27]
  ds_read_b64_tr_b16 v[72:73], v13 offset:36864
s_waitcnt lgkmcnt(7)
  v_mfma_f32_16x16x32_bf16 v[28:31], v[56:59], a[64:67], v[28:31]
  ds_read_b64_tr_b16 v[74:75], v13 offset:37888
  s_add_u32 m0, s66, 32768
  v_mfma_f32_16x16x32_bf16 v[32:35], v[56:59], a[68:71], v[32:35]
  ds_read_b64_tr_b16 v[76:77], v14 offset:36864
  ds_read_b64_tr_b16 v[78:79], v14 offset:37888
s_waitcnt lgkmcnt(8)
  v_mfma_f32_16x16x32_bf16 v[36:39], v[60:63], a[64:67], v[36:39]
  ds_read_b64_tr_b16 v[80:81], v15 offset:36864
  buffer_load_dwordx4 v4, s[12:15], s65 offen offset:0 lds
  v_mfma_f32_16x16x32_bf16 v[40:43], v[60:63], a[68:71], v[40:43]
  ds_read_b64_tr_b16 v[82:83], v15 offset:37888
s_waitcnt lgkmcnt(8)
  v_mfma_f32_16x16x32_bf16 v[44:47], v[64:67], a[64:67], v[44:47]
  buffer_load_dwordx4 a[64:67], v2, s[8:11], s64 offen offset:0
  v_mfma_f32_16x16x32_bf16 v[48:51], v[64:67], a[68:71], v[48:51]
  buffer_load_dwordx4 a[68:71], v3, s[8:11], s64 offen offset:0
s_waitcnt lgkmcnt(6)
  v_mfma_f32_16x16x32_bf16 v[20:23], v[68:71], a[72:75], v[20:23]
  ds_read_b64_tr_b16 v[52:53], v12 offset:40960
  ds_read_b64_tr_b16 v[54:55], v12 offset:41984
  v_mfma_f32_16x16x32_bf16 v[24:27], v[68:71], a[76:79], v[24:27]
  ds_read_b64_tr_b16 v[56:57], v13 offset:40960
s_waitcnt lgkmcnt(7)
  v_mfma_f32_16x16x32_bf16 v[28:31], v[72:75], a[72:75], v[28:31]
  ds_read_b64_tr_b16 v[58:59], v13 offset:41984
  v_mfma_f32_16x16x32_bf16 v[32:35], v[72:75], a[76:79], v[32:35]
  ds_read_b64_tr_b16 v[60:61], v14 offset:40960
  ds_read_b64_tr_b16 v[62:63], v14 offset:41984
s_waitcnt lgkmcnt(8)
  v_mfma_f32_16x16x32_bf16 v[36:39], v[76:79], a[72:75], v[36:39]
  ds_read_b64_tr_b16 v[64:65], v15 offset:40960
  buffer_load_dwordx4 v5, s[12:15], s65 offen offset:1024 lds
  v_mfma_f32_16x16x32_bf16 v[40:43], v[76:79], a[76:79], v[40:43]
  ds_read_b64_tr_b16 v[66:67], v15 offset:41984
s_waitcnt lgkmcnt(8)
  v_mfma_f32_16x16x32_bf16 v[44:47], v[80:83], a[72:75], v[44:47]
  buffer_load_dwordx4 a[72:75], v2, s[8:11], s64 offen offset:1024
  v_mfma_f32_16x16x32_bf16 v[48:51], v[80:83], a[76:79], v[48:51]
  buffer_load_dwordx4 a[76:79], v3, s[8:11], s64 offen offset:1024
s_waitcnt lgkmcnt(6)
  v_mfma_f32_16x16x32_bf16 v[20:23], v[52:55], a[80:83], v[20:23]
  ds_read_b64_tr_b16 v[68:69], v12 offset:45056
  ds_read_b64_tr_b16 v[70:71], v12 offset:46080
  v_mfma_f32_16x16x32_bf16 v[24:27], v[52:55], a[84:87], v[24:27]
  ds_read_b64_tr_b16 v[72:73], v13 offset:45056
s_waitcnt lgkmcnt(7)
  v_mfma_f32_16x16x32_bf16 v[28:31], v[56:59], a[80:83], v[28:31]
  ds_read_b64_tr_b16 v[74:75], v13 offset:46080
  v_mfma_f32_16x16x32_bf16 v[32:35], v[56:59], a[84:87], v[32:35]
  ds_read_b64_tr_b16 v[76:77], v14 offset:45056
  ds_read_b64_tr_b16 v[78:79], v14 offset:46080
s_waitcnt lgkmcnt(8)
  v_mfma_f32_16x16x32_bf16 v[36:39], v[60:63], a[80:83], v[36:39]
  ds_read_b64_tr_b16 v[80:81], v15 offset:45056
  buffer_load_dwordx4 v6, s[12:15], s65 offen offset:2048 lds
  v_mfma_f32_16x16x32_bf16 v[40:43], v[60:63], a[84:87], v[40:43]
  ds_read_b64_tr_b16 v[82:83], v15 offset:46080
s_waitcnt lgkmcnt(8)
  v_mfma_f32_16x16x32_bf16 v[44:47], v[64:67], a[80:83], v[44:47]
  buffer_load_dwordx4 a[80:83], v2, s[8:11], s64 offen offset:2048
  v_mfma_f32_16x16x32_bf16 v[48:51], v[64:67], a[84:87], v[48:51]
  buffer_load_dwordx4 a[84:87], v3, s[8:11], s64 offen offset:2048
  s_waitcnt vmcnt(35)
  s_barrier
s_waitcnt lgkmcnt(6)
  v_mfma_f32_16x16x32_bf16 v[20:23], v[68:71], a[88:91], v[20:23]
  ds_read_b64_tr_b16 v[52:53], v12 offset:49152
  ds_read_b64_tr_b16 v[54:55], v12 offset:50176
  v_mfma_f32_16x16x32_bf16 v[24:27], v[68:71], a[92:95], v[24:27]
  ds_read_b64_tr_b16 v[56:57], v13 offset:49152
s_waitcnt lgkmcnt(7)
  v_mfma_f32_16x16x32_bf16 v[28:31], v[72:75], a[88:91], v[28:31]
  ds_read_b64_tr_b16 v[58:59], v13 offset:50176
  v_mfma_f32_16x16x32_bf16 v[32:35], v[72:75], a[92:95], v[32:35]
  ds_read_b64_tr_b16 v[60:61], v14 offset:49152
  ds_read_b64_tr_b16 v[62:63], v14 offset:50176
s_waitcnt lgkmcnt(8)
  v_mfma_f32_16x16x32_bf16 v[36:39], v[76:79], a[88:91], v[36:39]
  ds_read_b64_tr_b16 v[64:65], v15 offset:49152
  buffer_load_dwordx4 v7, s[12:15], s65 offen offset:3072 lds
  v_mfma_f32_16x16x32_bf16 v[40:43], v[76:79], a[92:95], v[40:43]
  ds_read_b64_tr_b16 v[66:67], v15 offset:50176
s_waitcnt lgkmcnt(8)
  v_mfma_f32_16x16x32_bf16 v[44:47], v[80:83], a[88:91], v[44:47]
  buffer_load_dwordx4 a[88:91], v2, s[8:11], s64 offen offset:3072
  v_mfma_f32_16x16x32_bf16 v[48:51], v[80:83], a[92:95], v[48:51]
  buffer_load_dwordx4 a[92:95], v3, s[8:11], s64 offen offset:3072
  s_add_u32 s64, s64, 4096
  s_add_u32 s65, s65, 262144
s_waitcnt lgkmcnt(6)
  v_mfma_f32_16x16x32_bf16 v[20:23], v[52:55], a[96:99], v[20:23]
  ds_read_b64_tr_b16 v[68:69], v12 offset:53248
  ds_read_b64_tr_b16 v[70:71], v12 offset:54272
  v_mfma_f32_16x16x32_bf16 v[24:27], v[52:55], a[100:103], v[24:27]
  ds_read_b64_tr_b16 v[72:73], v13 offset:53248
s_waitcnt lgkmcnt(7)
  v_mfma_f32_16x16x32_bf16 v[28:31], v[56:59], a[96:99], v[28:31]
  ds_read_b64_tr_b16 v[74:75], v13 offset:54272
  s_add_u32 m0, s66, 49152
  v_mfma_f32_16x16x32_bf16 v[32:35], v[56:59], a[100:103], v[32:35]
  ds_read_b64_tr_b16 v[76:77], v14 offset:53248
  ds_read_b64_tr_b16 v[78:79], v14 offset:54272
s_waitcnt lgkmcnt(8)
  v_mfma_f32_16x16x32_bf16 v[36:39], v[60:63], a[96:99], v[36:39]
  ds_read_b64_tr_b16 v[80:81], v15 offset:53248
  buffer_load_dwordx4 v4, s[12:15], s65 offen offset:0 lds
  v_mfma_f32_16x16x32_bf16 v[40:43], v[60:63], a[100:103], v[40:43]
  ds_read_b64_tr_b16 v[82:83], v15 offset:54272
s_waitcnt lgkmcnt(8)
  v_mfma_f32_16x16x32_bf16 v[44:47], v[64:67], a[96:99], v[44:47]
  buffer_load_dwordx4 a[96:99], v2, s[8:11], s64 offen offset:0
  v_mfma_f32_16x16x32_bf16 v[48:51], v[64:67], a[100:103], v[48:51]
  buffer_load_dwordx4 a[100:103], v3, s[8:11], s64 offen offset:0
s_waitcnt lgkmcnt(6)
  v_mfma_f32_16x16x32_bf16 v[20:23], v[68:71], a[104:107], v[20:23]
  ds_read_b64_tr_b16 v[52:53], v12 offset:57344
  ds_read_b64_tr_b16 v[54:55], v12 offset:58368
  v_mfma_f32_16x16x32_bf16 v[24:27], v[68:71], a[108:111], v[24:27]
  ds_read_b64_tr_b16 v[56:57], v13 offset:57344
s_waitcnt lgkmcnt(7)
  v_mfma_f32_16x16x32_bf16 v[28:31], v[72:75], a[104:107], v[28:31]
  ds_read_b64_tr_b16 v[58:59], v13 offset:58368
  v_mfma_f32_16x16x32_bf16 v[32:35], v[72:75], a[108:111], v[32:35]
  ds_read_b64_tr_b16 v[60:61], v14 offset:57344
  ds_read_b64_tr_b16 v[62:63], v14 offset:58368
s_waitcnt lgkmcnt(8)
  v_mfma_f32_16x16x32_bf16 v[36:39], v[76:79], a[104:107], v[36:39]
  ds_read_b64_tr_b16 v[64:65], v15 offset:57344
  buffer_load_dwordx4 v5, s[12:15], s65 offen offset:1024 lds
  v_mfma_f32_16x16x32_bf16 v[40:43], v[76:79], a[108:111], v[40:43]
  ds_read_b64_tr_b16 v[66:67], v15 offset:58368
s_waitcnt lgkmcnt(8)
  v_mfma_f32_16x16x32_bf16 v[44:47], v[80:83], a[104:107], v[44:47]
  buffer_load_dwordx4 a[104:107], v2, s[8:11], s64 offen offset:1024
  v_mfma_f32_16x16x32_bf16 v[48:51], v[80:83], a[108:111], v[48:51]
  buffer_load_dwordx4 a[108:111], v3, s[8:11], s64 offen offset:1024
s_waitcnt lgkmcnt(6)
  v_mfma_f32_16x16x32_bf16 v[20:23], v[52:55], a[112:115], v[20:23]
  ds_read_b64_tr_b16 v[68:69], v12 offset:61440
  ds_read_b64_tr_b16 v[70:71], v12 offset:62464
  v_mfma_f32_16x16x32_bf16 v[24:27], v[52:55], a[116:119], v[24:27]
  ds_read_b64_tr_b16 v[72:73], v13 offset:61440
s_waitcnt lgkmcnt(7)
  v_mfma_f32_16x16x32_bf16 v[28:31], v[56:59], a[112:115], v[28:31]
  ds_read_b64_tr_b16 v[74:75], v13 offset:62464
  v_mfma_f32_16x16x32_bf16 v[32:35], v[56:59], a[116:119], v[32:35]
  ds_read_b64_tr_b16 v[76:77], v14 offset:61440
  ds_read_b64_tr_b16 v[78:79], v14 offset:62464
s_waitcnt lgkmcnt(8)
  v_mfma_f32_16x16x32_bf16 v[36:39], v[60:63], a[112:115], v[36:39]
  ds_read_b64_tr_b16 v[80:81], v15 offset:61440
  buffer_load_dwordx4 v6, s[12:15], s65 offen offset:2048 lds
  v_mfma_f32_16x16x32_bf16 v[40:43], v[60:63], a[116:119], v[40:43]
  ds_read_b64_tr_b16 v[82:83], v15 offset:62464
s_waitcnt lgkmcnt(8)
  v_mfma_f32_16x16x32_bf16 v[44:47], v[64:67], a[112:115], v[44:47]
  buffer_load_dwordx4 a[112:115], v2, s[8:11], s64 offen offset:2048
  v_mfma_f32_16x16x32_bf16 v[48:51], v[64:67], a[116:119], v[48:51]
  buffer_load_dwordx4 a[116:119], v3, s[8:11], s64 offen offset:2048
  s_waitcnt vmcnt(35)
  s_barrier
s_waitcnt lgkmcnt(6)
  v_mfma_f32_16x16x32_bf16 v[20:23], v[68:71], a[120:123], v[20:23]
  ds_read_b64_tr_b16 v[52:53], v8 offset:0
  ds_read_b64_tr_b16 v[54:55], v8 offset:1024
  v_mfma_f32_16x16x32_bf16 v[24:27], v[68:71], a[124:127], v[24:27]
  ds_read_b64_tr_b16 v[56:57], v9 offset:0
s_waitcnt lgkmcnt(7)
  v_mfma_f32_16x16x32_bf16 v[28:31], v[72:75], a[120:123], v[28:31]
  ds_read_b64_tr_b16 v[58:59], v9 offset:1024
  v_mfma_f32_16x16x32_bf16 v[32:35], v[72:75], a[124:127], v[32:35]
  ds_read_b64_tr_b16 v[60:61], v10 offset:0
  ds_read_b64_tr_b16 v[62:63], v10 offset:1024
s_waitcnt lgkmcnt(8)
  v_mfma_f32_16x16x32_bf16 v[36:39], v[76:79], a[120:123], v[36:39]
  ds_read_b64_tr_b16 v[64:65], v11 offset:0
  buffer_load_dwordx4 v7, s[12:15], s65 offen offset:3072 lds
  v_mfma_f32_16x16x32_bf16 v[40:43], v[76:79], a[124:127], v[40:43]
  ds_read_b64_tr_b16 v[66:67], v11 offset:1024
s_waitcnt lgkmcnt(8)
  v_mfma_f32_16x16x32_bf16 v[44:47], v[80:83], a[120:123], v[44:47]
  buffer_load_dwordx4 a[120:123], v2, s[8:11], s64 offen offset:3072
  v_mfma_f32_16x16x32_bf16 v[48:51], v[80:83], a[124:127], v[48:51]
  buffer_load_dwordx4 a[124:127], v3, s[8:11], s64 offen offset:3072
  s_add_u32 s64, s64, 4096
  s_add_u32 s65, s65, 262144
  s_mov_b32 s67, 2
.p2align 5
L_kd_kernel_loop:
s_waitcnt lgkmcnt(6)
  v_mfma_f32_16x16x32_bf16 v[20:23], v[52:55], a[0:3], v[20:23]
  ds_read_b64_tr_b16 v[68:69], v8 offset:4096
  ds_read_b64_tr_b16 v[70:71], v8 offset:5120
  v_mfma_f32_16x16x32_bf16 v[24:27], v[52:55], a[4:7], v[24:27]
  ds_read_b64_tr_b16 v[72:73], v9 offset:4096
s_waitcnt lgkmcnt(7)
  v_mfma_f32_16x16x32_bf16 v[28:31], v[56:59], a[0:3], v[28:31]
  ds_read_b64_tr_b16 v[74:75], v9 offset:5120
  s_add_u32 m0, s66, 65536
  v_mfma_f32_16x16x32_bf16 v[32:35], v[56:59], a[4:7], v[32:35]
  ds_read_b64_tr_b16 v[76:77], v10 offset:4096
  ds_read_b64_tr_b16 v[78:79], v10 offset:5120
s_waitcnt lgkmcnt(8)
  v_mfma_f32_16x16x32_bf16 v[36:39], v[60:63], a[0:3], v[36:39]
  ds_read_b64_tr_b16 v[80:81], v11 offset:4096
  buffer_load_dwordx4 v4, s[12:15], s65 offen offset:0 lds
  v_mfma_f32_16x16x32_bf16 v[40:43], v[60:63], a[4:7], v[40:43]
  ds_read_b64_tr_b16 v[82:83], v11 offset:5120
s_waitcnt lgkmcnt(8)
  v_mfma_f32_16x16x32_bf16 v[44:47], v[64:67], a[0:3], v[44:47]
  buffer_load_dwordx4 a[0:3], v2, s[8:11], s64 offen offset:0
  v_mfma_f32_16x16x32_bf16 v[48:51], v[64:67], a[4:7], v[48:51]
  buffer_load_dwordx4 a[4:7], v3, s[8:11], s64 offen offset:0
s_waitcnt lgkmcnt(6)
  v_mfma_f32_16x16x32_bf16 v[20:23], v[68:71], a[8:11], v[20:23]
  ds_read_b64_tr_b16 v[52:53], v8 offset:8192
  ds_read_b64_tr_b16 v[54:55], v8 offset:9216
  v_mfma_f32_16x16x32_bf16 v[24:27], v[68:71], a[12:15], v[24:27]
  ds_read_b64_tr_b16 v[56:57], v9 offset:8192
s_waitcnt lgkmcnt(7)
  v_mfma_f32_16x16x32_bf16 v[28:31], v[72:75], a[8:11], v[28:31]
  ds_read_b64_tr_b16 v[58:59], v9 offset:9216
  v_mfma_f32_16x16x32_bf16 v[32:35], v[72:75], a[12:15], v[32:35]
  ds_read_b64_tr_b16 v[60:61], v10 offset:8192
  ds_read_b64_tr_b16 v[62:63], v10 offset:9216
s_waitcnt lgkmcnt(8)
  v_mfma_f32_16x16x32_bf16 v[36:39], v[76:79], a[8:11], v[36:39]
  ds_read_b64_tr_b16 v[64:65], v11 offset:8192
  buffer_load_dwordx4 v5, s[12:15], s65 offen offset:1024 lds
  v_mfma_f32_16x16x32_bf16 v[40:43], v[76:79], a[12:15], v[40:43]
  ds_read_b64_tr_b16 v[66:67], v11 offset:9216
s_waitcnt lgkmcnt(8)
  v_mfma_f32_16x16x32_bf16 v[44:47], v[80:83], a[8:11], v[44:47]
  buffer_load_dwordx4 a[8:11], v2, s[8:11], s64 offen offset:1024
  v_mfma_f32_16x16x32_bf16 v[48:51], v[80:83], a[12:15], v[48:51]
  buffer_load_dwordx4 a[12:15], v3, s[8:11], s64 offen offset:1024
s_waitcnt lgkmcnt(6)
  v_mfma_f32_16x16x32_bf16 v[20:23], v[52:55], a[16:19], v[20:23]
  ds_read_b64_tr_b16 v[68:69], v8 offset:12288
  ds_read_b64_tr_b16 v[70:71], v8 offset:13312
  v_mfma_f32_16x16x32_bf16 v[24:27], v[52:55], a[20:23], v[24:27]
  ds_read_b64_tr_b16 v[72:73], v9 offset:12288
s_waitcnt lgkmcnt(7)
  v_mfma_f32_16x16x32_bf16 v[28:31], v[56:59], a[16:19], v[28:31]
  ds_read_b64_tr_b16 v[74:75], v9 offset:13312
  v_mfma_f32_16x16x32_bf16 v[32:35], v[56:59], a[20:23], v[32:35]
  ds_read_b64_tr_b16 v[76:77], v10 offset:12288
  ds_read_b64_tr_b16 v[78:79], v10 offset:13312
s_waitcnt lgkmcnt(8)
  v_mfma_f32_16x16x32_bf16 v[36:39], v[60:63], a[16:19], v[36:39]
  ds_read_b64_tr_b16 v[80:81], v11 offset:12288
  buffer_load_dwordx4 v6, s[12:15], s65 offen offset:2048 lds
  v_mfma_f32_16x16x32_bf16 v[40:43], v[60:63], a[20:23], v[40:43]
  ds_read_b64_tr_b16 v[82:83], v11 offset:13312
s_waitcnt lgkmcnt(8)
  v_mfma_f32_16x16x32_bf16 v[44:47], v[64:67], a[16:19], v[44:47]
  buffer_load_dwordx4 a[16:19], v2, s[8:11], s64 offen offset:2048
  v_mfma_f32_16x16x32_bf16 v[48:51], v[64:67], a[20:23], v[48:51]
  buffer_load_dwordx4 a[20:23], v3, s[8:11], s64 offen offset:2048
  s_waitcnt vmcnt(35)
  s_barrier
s_waitcnt lgkmcnt(6)
  v_mfma_f32_16x16x32_bf16 v[20:23], v[68:71], a[24:27], v[20:23]
  ds_read_b64_tr_b16 v[52:53], v8 offset:16384
  ds_read_b64_tr_b16 v[54:55], v8 offset:17408
  v_mfma_f32_16x16x32_bf16 v[24:27], v[68:71], a[28:31], v[24:27]
  ds_read_b64_tr_b16 v[56:57], v9 offset:16384
s_waitcnt lgkmcnt(7)
  v_mfma_f32_16x16x32_bf16 v[28:31], v[72:75], a[24:27], v[28:31]
  ds_read_b64_tr_b16 v[58:59], v9 offset:17408
  v_mfma_f32_16x16x32_bf16 v[32:35], v[72:75], a[28:31], v[32:35]
  ds_read_b64_tr_b16 v[60:61], v10 offset:16384
  ds_read_b64_tr_b16 v[62:63], v10 offset:17408
s_waitcnt lgkmcnt(8)
  v_mfma_f32_16x16x32_bf16 v[36:39], v[76:79], a[24:27], v[36:39]
  ds_read_b64_tr_b16 v[64:65], v11 offset:16384
  buffer_load_dwordx4 v7, s[12:15], s65 offen offset:3072 lds
  v_mfma_f32_16x16x32_bf16 v[40:43], v[76:79], a[28:31], v[40:43]
  ds_read_b64_tr_b16 v[66:67], v11 offset:17408
s_waitcnt lgkmcnt(8)
  v_mfma_f32_16x16x32_bf16 v[44:47], v[80:83], a[24:27], v[44:47]
  buffer_load_dwordx4 a[24:27], v2, s[8:11], s64 offen offset:3072
  v_mfma_f32_16x16x32_bf16 v[48:51], v[80:83], a[28:31], v[48:51]
  buffer_load_dwordx4 a[28:31], v3, s[8:11], s64 offen offset:3072
  s_add_u32 s64, s64, 4096
  s_add_u32 s65, s65, 262144
s_waitcnt lgkmcnt(6)
  v_mfma_f32_16x16x32_bf16 v[20:23], v[52:55], a[32:35], v[20:23]
  ds_read_b64_tr_b16 v[68:69], v8 offset:20480
  ds_read_b64_tr_b16 v[70:71], v8 offset:21504
  v_mfma_f32_16x16x32_bf16 v[24:27], v[52:55], a[36:39], v[24:27]
  ds_read_b64_tr_b16 v[72:73], v9 offset:20480
s_waitcnt lgkmcnt(7)
  v_mfma_f32_16x16x32_bf16 v[28:31], v[56:59], a[32:35], v[28:31]
  ds_read_b64_tr_b16 v[74:75], v9 offset:21504
  s_add_u32 m0, s66, 81920
  v_mfma_f32_16x16x32_bf16 v[32:35], v[56:59], a[36:39], v[32:35]
  ds_read_b64_tr_b16 v[76:77], v10 offset:20480
  ds_read_b64_tr_b16 v[78:79], v10 offset:21504
s_waitcnt lgkmcnt(8)
  v_mfma_f32_16x16x32_bf16 v[36:39], v[60:63], a[32:35], v[36:39]
  ds_read_b64_tr_b16 v[80:81], v11 offset:20480
  buffer_load_dwordx4 v4, s[12:15], s65 offen offset:0 lds
  v_mfma_f32_16x16x32_bf16 v[40:43], v[60:63], a[36:39], v[40:43]
  ds_read_b64_tr_b16 v[82:83], v11 offset:21504
s_waitcnt lgkmcnt(8)
  v_mfma_f32_16x16x32_bf16 v[44:47], v[64:67], a[32:35], v[44:47]
  buffer_load_dwordx4 a[32:35], v2, s[8:11], s64 offen offset:0
  v_mfma_f32_16x16x32_bf16 v[48:51], v[64:67], a[36:39], v[48:51]
  buffer_load_dwordx4 a[36:39], v3, s[8:11], s64 offen offset:0
s_waitcnt lgkmcnt(6)
  v_mfma_f32_16x16x32_bf16 v[20:23], v[68:71], a[40:43], v[20:23]
  ds_read_b64_tr_b16 v[52:53], v8 offset:24576
  ds_read_b64_tr_b16 v[54:55], v8 offset:25600
  v_mfma_f32_16x16x32_bf16 v[24:27], v[68:71], a[44:47], v[24:27]
  ds_read_b64_tr_b16 v[56:57], v9 offset:24576
s_waitcnt lgkmcnt(7)
  v_mfma_f32_16x16x32_bf16 v[28:31], v[72:75], a[40:43], v[28:31]
  ds_read_b64_tr_b16 v[58:59], v9 offset:25600
  v_mfma_f32_16x16x32_bf16 v[32:35], v[72:75], a[44:47], v[32:35]
  ds_read_b64_tr_b16 v[60:61], v10 offset:24576
  ds_read_b64_tr_b16 v[62:63], v10 offset:25600
s_waitcnt lgkmcnt(8)
  v_mfma_f32_16x16x32_bf16 v[36:39], v[76:79], a[40:43], v[36:39]
  ds_read_b64_tr_b16 v[64:65], v11 offset:24576
  buffer_load_dwordx4 v5, s[12:15], s65 offen offset:1024 lds
  v_mfma_f32_16x16x32_bf16 v[40:43], v[76:79], a[44:47], v[40:43]
  ds_read_b64_tr_b16 v[66:67], v11 offset:25600
s_waitcnt lgkmcnt(8)
  v_mfma_f32_16x16x32_bf16 v[44:47], v[80:83], a[40:43], v[44:47]
  buffer_load_dwordx4 a[40:43], v2, s[8:11], s64 offen offset:1024
  v_mfma_f32_16x16x32_bf16 v[48:51], v[80:83], a[44:47], v[48:51]
  buffer_load_dwordx4 a[44:47], v3, s[8:11], s64 offen offset:1024
s_waitcnt lgkmcnt(6)
  v_mfma_f32_16x16x32_bf16 v[20:23], v[52:55], a[48:51], v[20:23]
  ds_read_b64_tr_b16 v[68:69], v8 offset:28672
  ds_read_b64_tr_b16 v[70:71], v8 offset:29696
  v_mfma_f32_16x16x32_bf16 v[24:27], v[52:55], a[52:55], v[24:27]
  ds_read_b64_tr_b16 v[72:73], v9 offset:28672
s_waitcnt lgkmcnt(7)
  v_mfma_f32_16x16x32_bf16 v[28:31], v[56:59], a[48:51], v[28:31]
  ds_read_b64_tr_b16 v[74:75], v9 offset:29696
  v_mfma_f32_16x16x32_bf16 v[32:35], v[56:59], a[52:55], v[32:35]
  ds_read_b64_tr_b16 v[76:77], v10 offset:28672
  ds_read_b64_tr_b16 v[78:79], v10 offset:29696
s_waitcnt lgkmcnt(8)
  v_mfma_f32_16x16x32_bf16 v[36:39], v[60:63], a[48:51], v[36:39]
  ds_read_b64_tr_b16 v[80:81], v11 offset:28672
  buffer_load_dwordx4 v6, s[12:15], s65 offen offset:2048 lds
  v_mfma_f32_16x16x32_bf16 v[40:43], v[60:63], a[52:55], v[40:43]
  ds_read_b64_tr_b16 v[82:83], v11 offset:29696
s_waitcnt lgkmcnt(8)
  v_mfma_f32_16x16x32_bf16 v[44:47], v[64:67], a[48:51], v[44:47]
  buffer_load_dwordx4 a[48:51], v2, s[8:11], s64 offen offset:2048
  v_mfma_f32_16x16x32_bf16 v[48:51], v[64:67], a[52:55], v[48:51]
  buffer_load_dwordx4 a[52:55], v3, s[8:11], s64 offen offset:2048
  s_waitcnt vmcnt(35)
  s_barrier
s_waitcnt lgkmcnt(6)
  v_mfma_f32_16x16x32_bf16 v[20:23], v[68:71], a[56:59], v[20:23]
  ds_read_b64_tr_b16 v[52:53], v8 offset:32768
  ds_read_b64_tr_b16 v[54:55], v8 offset:33792
  v_mfma_f32_16x16x32_bf16 v[24:27], v[68:71], a[60:63], v[24:27]
  ds_read_b64_tr_b16 v[56:57], v9 offset:32768
s_waitcnt lgkmcnt(7)
  v_mfma_f32_16x16x32_bf16 v[28:31], v[72:75], a[56:59], v[28:31]
  ds_read_b64_tr_b16 v[58:59], v9 offset:33792
  v_mfma_f32_16x16x32_bf16 v[32:35], v[72:75], a[60:63], v[32:35]
  ds_read_b64_tr_b16 v[60:61], v10 offset:32768
  ds_read_b64_tr_b16 v[62:63], v10 offset:33792
s_waitcnt lgkmcnt(8)
  v_mfma_f32_16x16x32_bf16 v[36:39], v[76:79], a[56:59], v[36:39]
  ds_read_b64_tr_b16 v[64:65], v11 offset:32768
  buffer_load_dwordx4 v7, s[12:15], s65 offen offset:3072 lds
  v_mfma_f32_16x16x32_bf16 v[40:43], v[76:79], a[60:63], v[40:43]
  ds_read_b64_tr_b16 v[66:67], v11 offset:33792
s_waitcnt lgkmcnt(8)
  v_mfma_f32_16x16x32_bf16 v[44:47], v[80:83], a[56:59], v[44:47]
  buffer_load_dwordx4 a[56:59], v2, s[8:11], s64 offen offset:3072
  v_mfma_f32_16x16x32_bf16 v[48:51], v[80:83], a[60:63], v[48:51]
  buffer_load_dwordx4 a[60:63], v3, s[8:11], s64 offen offset:3072
  s_add_u32 s64, s64, 4096
  s_add_u32 s65, s65, 262144
s_waitcnt lgkmcnt(6)
  v_mfma_f32_16x16x32_bf16 v[20:23], v[52:55], a[64:67], v[20:23]
  ds_read_b64_tr_b16 v[68:69], v8 offset:36864
  ds_read_b64_tr_b16 v[70:71], v8 offset:37888
  v_mfma_f32_16x16x32_bf16 v[24:27], v[52:55], a[68:71], v[24:27]
  ds_read_b64_tr_b16 v[72:73], v9 offset:36864
s_waitcnt lgkmcnt(7)
  v_mfma_f32_16x16x32_bf16 v[28:31], v[56:59], a[64:67], v[28:31]
  ds_read_b64_tr_b16 v[74:75], v9 offset:37888
  s_add_u32 m0, s66, 98304
  v_mfma_f32_16x16x32_bf16 v[32:35], v[56:59], a[68:71], v[32:35]
  ds_read_b64_tr_b16 v[76:77], v10 offset:36864
  ds_read_b64_tr_b16 v[78:79], v10 offset:37888
s_waitcnt lgkmcnt(8)
  v_mfma_f32_16x16x32_bf16 v[36:39], v[60:63], a[64:67], v[36:39]
  ds_read_b64_tr_b16 v[80:81], v11 offset:36864
  buffer_load_dwordx4 v4, s[12:15], s65 offen offset:0 lds
  v_mfma_f32_16x16x32_bf16 v[40:43], v[60:63], a[68:71], v[40:43]
  ds_read_b64_tr_b16 v[82:83], v11 offset:37888
s_waitcnt lgkmcnt(8)
  v_mfma_f32_16x16x32_bf16 v[44:47], v[64:67], a[64:67], v[44:47]
  buffer_load_dwordx4 a[64:67], v2, s[8:11], s64 offen offset:0
  v_mfma_f32_16x16x32_bf16 v[48:51], v[64:67], a[68:71], v[48:51]
  buffer_load_dwordx4 a[68:71], v3, s[8:11], s64 offen offset:0
s_waitcnt lgkmcnt(6)
  v_mfma_f32_16x16x32_bf16 v[20:23], v[68:71], a[72:75], v[20:23]
  ds_read_b64_tr_b16 v[52:53], v8 offset:40960
  ds_read_b64_tr_b16 v[54:55], v8 offset:41984
  v_mfma_f32_16x16x32_bf16 v[24:27], v[68:71], a[76:79], v[24:27]
  ds_read_b64_tr_b16 v[56:57], v9 offset:40960
s_waitcnt lgkmcnt(7)
  v_mfma_f32_16x16x32_bf16 v[28:31], v[72:75], a[72:75], v[28:31]
  ds_read_b64_tr_b16 v[58:59], v9 offset:41984
  v_mfma_f32_16x16x32_bf16 v[32:35], v[72:75], a[76:79], v[32:35]
  ds_read_b64_tr_b16 v[60:61], v10 offset:40960
  ds_read_b64_tr_b16 v[62:63], v10 offset:41984
s_waitcnt lgkmcnt(8)
  v_mfma_f32_16x16x32_bf16 v[36:39], v[76:79], a[72:75], v[36:39]
  ds_read_b64_tr_b16 v[64:65], v11 offset:40960
  buffer_load_dwordx4 v5, s[12:15], s65 offen offset:1024 lds
  v_mfma_f32_16x16x32_bf16 v[40:43], v[76:79], a[76:79], v[40:43]
  ds_read_b64_tr_b16 v[66:67], v11 offset:41984
s_waitcnt lgkmcnt(8)
  v_mfma_f32_16x16x32_bf16 v[44:47], v[80:83], a[72:75], v[44:47]
  buffer_load_dwordx4 a[72:75], v2, s[8:11], s64 offen offset:1024
  v_mfma_f32_16x16x32_bf16 v[48:51], v[80:83], a[76:79], v[48:51]
  buffer_load_dwordx4 a[76:79], v3, s[8:11], s64 offen offset:1024
s_waitcnt lgkmcnt(6)
  v_mfma_f32_16x16x32_bf16 v[20:23], v[52:55], a[80:83], v[20:23]
  ds_read_b64_tr_b16 v[68:69], v8 offset:45056
  ds_read_b64_tr_b16 v[70:71], v8 offset:46080
  v_mfma_f32_16x16x32_bf16 v[24:27], v[52:55], a[84:87], v[24:27]
  ds_read_b64_tr_b16 v[72:73], v9 offset:45056
s_waitcnt lgkmcnt(7)
  v_mfma_f32_16x16x32_bf16 v[28:31], v[56:59], a[80:83], v[28:31]
  ds_read_b64_tr_b16 v[74:75], v9 offset:46080
  v_mfma_f32_16x16x32_bf16 v[32:35], v[56:59], a[84:87], v[32:35]
  ds_read_b64_tr_b16 v[76:77], v10 offset:45056
  ds_read_b64_tr_b16 v[78:79], v10 offset:46080
s_waitcnt lgkmcnt(8)
  v_mfma_f32_16x16x32_bf16 v[36:39], v[60:63], a[80:83], v[36:39]
  ds_read_b64_tr_b16 v[80:81], v11 offset:45056
  buffer_load_dwordx4 v6, s[12:15], s65 offen offset:2048 lds
  v_mfma_f32_16x16x32_bf16 v[40:43], v[60:63], a[84:87], v[40:43]
  ds_read_b64_tr_b16 v[82:83], v11 offset:46080
s_waitcnt lgkmcnt(8)
  v_mfma_f32_16x16x32_bf16 v[44:47], v[64:67], a[80:83], v[44:47]
  buffer_load_dwordx4 a[80:83], v2, s[8:11], s64 offen offset:2048
  v_mfma_f32_16x16x32_bf16 v[48:51], v[64:67], a[84:87], v[48:51]
  buffer_load_dwordx4 a[84:87], v3, s[8:11], s64 offen offset:2048
  s_waitcnt vmcnt(35)
  s_barrier
s_waitcnt lgkmcnt(6)
  v_mfma_f32_16x16x32_bf16 v[20:23], v[68:71], a[88:91], v[20:23]
  ds_read_b64_tr_b16 v[52:53], v8 offset:49152
  ds_read_b64_tr_b16 v[54:55], v8 offset:50176
  v_mfma_f32_16x16x32_bf16 v[24:27], v[68:71], a[92:95], v[24:27]
  ds_read_b64_tr_b16 v[56:57], v9 offset:49152
s_waitcnt lgkmcnt(7)
  v_mfma_f32_16x16x32_bf16 v[28:31], v[72:75], a[88:91], v[28:31]
  ds_read_b64_tr_b16 v[58:59], v9 offset:50176
  v_mfma_f32_16x16x32_bf16 v[32:35], v[72:75], a[92:95], v[32:35]
  ds_read_b64_tr_b16 v[60:61], v10 offset:49152
  ds_read_b64_tr_b16 v[62:63], v10 offset:50176
s_waitcnt lgkmcnt(8)
  v_mfma_f32_16x16x32_bf16 v[36:39], v[76:79], a[88:91], v[36:39]
  ds_read_b64_tr_b16 v[64:65], v11 offset:49152
  buffer_load_dwordx4 v7, s[12:15], s65 offen offset:3072 lds
  v_mfma_f32_16x16x32_bf16 v[40:43], v[76:79], a[92:95], v[40:43]
  ds_read_b64_tr_b16 v[66:67], v11 offset:50176
s_waitcnt lgkmcnt(8)
  v_mfma_f32_16x16x32_bf16 v[44:47], v[80:83], a[88:91], v[44:47]
  buffer_load_dwordx4 a[88:91], v2, s[8:11], s64 offen offset:3072
  v_mfma_f32_16x16x32_bf16 v[48:51], v[80:83], a[92:95], v[48:51]
  buffer_load_dwordx4 a[92:95], v3, s[8:11], s64 offen offset:3072
  s_add_u32 s64, s64, 4096
  s_add_u32 s65, s65, 262144
s_waitcnt lgkmcnt(6)
  v_mfma_f32_16x16x32_bf16 v[20:23], v[52:55], a[96:99], v[20:23]
  ds_read_b64_tr_b16 v[68:69], v8 offset:53248
  ds_read_b64_tr_b16 v[70:71], v8 offset:54272
  v_mfma_f32_16x16x32_bf16 v[24:27], v[52:55], a[100:103], v[24:27]
  ds_read_b64_tr_b16 v[72:73], v9 offset:53248
s_waitcnt lgkmcnt(7)
  v_mfma_f32_16x16x32_bf16 v[28:31], v[56:59], a[96:99], v[28:31]
  ds_read_b64_tr_b16 v[74:75], v9 offset:54272
  s_add_u32 m0, s66, 114688
  v_mfma_f32_16x16x32_bf16 v[32:35], v[56:59], a[100:103], v[32:35]
  ds_read_b64_tr_b16 v[76:77], v10 offset:53248
  ds_read_b64_tr_b16 v[78:79], v10 offset:54272
s_waitcnt lgkmcnt(8)
  v_mfma_f32_16x16x32_bf16 v[36:39], v[60:63], a[96:99], v[36:39]
  ds_read_b64_tr_b16 v[80:81], v11 offset:53248
  buffer_load_dwordx4 v4, s[12:15], s65 offen offset:0 lds
  v_mfma_f32_16x16x32_bf16 v[40:43], v[60:63], a[100:103], v[40:43]
  ds_read_b64_tr_b16 v[82:83], v11 offset:54272
s_waitcnt lgkmcnt(8)
  v_mfma_f32_16x16x32_bf16 v[44:47], v[64:67], a[96:99], v[44:47]
  buffer_load_dwordx4 a[96:99], v2, s[8:11], s64 offen offset:0
  v_mfma_f32_16x16x32_bf16 v[48:51], v[64:67], a[100:103], v[48:51]
  buffer_load_dwordx4 a[100:103], v3, s[8:11], s64 offen offset:0
s_waitcnt lgkmcnt(6)
  v_mfma_f32_16x16x32_bf16 v[20:23], v[68:71], a[104:107], v[20:23]
  ds_read_b64_tr_b16 v[52:53], v8 offset:57344
  ds_read_b64_tr_b16 v[54:55], v8 offset:58368
  v_mfma_f32_16x16x32_bf16 v[24:27], v[68:71], a[108:111], v[24:27]
  ds_read_b64_tr_b16 v[56:57], v9 offset:57344
s_waitcnt lgkmcnt(7)
  v_mfma_f32_16x16x32_bf16 v[28:31], v[72:75], a[104:107], v[28:31]
  ds_read_b64_tr_b16 v[58:59], v9 offset:58368
  v_mfma_f32_16x16x32_bf16 v[32:35], v[72:75], a[108:111], v[32:35]
  ds_read_b64_tr_b16 v[60:61], v10 offset:57344
  ds_read_b64_tr_b16 v[62:63], v10 offset:58368
s_waitcnt lgkmcnt(8)
  v_mfma_f32_16x16x32_bf16 v[36:39], v[76:79], a[104:107], v[36:39]
  ds_read_b64_tr_b16 v[64:65], v11 offset:57344
  buffer_load_dwordx4 v5, s[12:15], s65 offen offset:1024 lds
  v_mfma_f32_16x16x32_bf16 v[40:43], v[76:79], a[108:111], v[40:43]
  ds_read_b64_tr_b16 v[66:67], v11 offset:58368
s_waitcnt lgkmcnt(8)
  v_mfma_f32_16x16x32_bf16 v[44:47], v[80:83], a[104:107], v[44:47]
  buffer_load_dwordx4 a[104:107], v2, s[8:11], s64 offen offset:1024
  v_mfma_f32_16x16x32_bf16 v[48:51], v[80:83], a[108:111], v[48:51]
  buffer_load_dwordx4 a[108:111], v3, s[8:11], s64 offen offset:1024
s_waitcnt lgkmcnt(6)
  v_mfma_f32_16x16x32_bf16 v[20:23], v[52:55], a[112:115], v[20:23]
  ds_read_b64_tr_b16 v[68:69], v8 offset:61440
  ds_read_b64_tr_b16 v[70:71], v8 offset:62464
  v_mfma_f32_16x16x32_bf16 v[24:27], v[52:55], a[116:119], v[24:27]
  ds_read_b64_tr_b16 v[72:73], v9 offset:61440
s_waitcnt lgkmcnt(7)
  v_mfma_f32_16x16x32_bf16 v[28:31], v[56:59], a[112:115], v[28:31]
  ds_read_b64_tr_b16 v[74:75], v9 offset:62464
  v_mfma_f32_16x16x32_bf16 v[32:35], v[56:59], a[116:119], v[32:35]
  ds_read_b64_tr_b16 v[76:77], v10 offset:61440
  ds_read_b64_tr_b16 v[78:79], v10 offset:62464
s_waitcnt lgkmcnt(8)
  v_mfma_f32_16x16x32_bf16 v[36:39], v[60:63], a[112:115], v[36:39]
  ds_read_b64_tr_b16 v[80:81], v11 offset:61440
  buffer_load_dwordx4 v6, s[12:15], s65 offen offset:2048 lds
  v_mfma_f32_16x16x32_bf16 v[40:43], v[60:63], a[116:119], v[40:43]
  ds_read_b64_tr_b16 v[82:83], v11 offset:62464
s_waitcnt lgkmcnt(8)
  v_mfma_f32_16x16x32_bf16 v[44:47], v[64:67], a[112:115], v[44:47]
  buffer_load_dwordx4 a[112:115], v2, s[8:11], s64 offen offset:2048
  v_mfma_f32_16x16x32_bf16 v[48:51], v[64:67], a[116:119], v[48:51]
  buffer_load_dwordx4 a[116:119], v3, s[8:11], s64 offen offset:2048
  s_waitcnt vmcnt(35)
  s_barrier
s_waitcnt lgkmcnt(6)
  v_mfma_f32_16x16x32_bf16 v[20:23], v[68:71], a[120:123], v[20:23]
  ds_read_b64_tr_b16 v[52:53], v12 offset:0
  ds_read_b64_tr_b16 v[54:55], v12 offset:1024
  v_mfma_f32_16x16x32_bf16 v[24:27], v[68:71], a[124:127], v[24:27]
  ds_read_b64_tr_b16 v[56:57], v13 offset:0
s_waitcnt lgkmcnt(7)
  v_mfma_f32_16x16x32_bf16 v[28:31], v[72:75], a[120:123], v[28:31]
  ds_read_b64_tr_b16 v[58:59], v13 offset:1024
  v_mfma_f32_16x16x32_bf16 v[32:35], v[72:75], a[124:127], v[32:35]
  ds_read_b64_tr_b16 v[60:61], v14 offset:0
  ds_read_b64_tr_b16 v[62:63], v14 offset:1024
s_waitcnt lgkmcnt(8)
  v_mfma_f32_16x16x32_bf16 v[36:39], v[76:79], a[120:123], v[36:39]
  ds_read_b64_tr_b16 v[64:65], v15 offset:0
  buffer_load_dwordx4 v7, s[12:15], s65 offen offset:3072 lds
  v_mfma_f32_16x16x32_bf16 v[40:43], v[76:79], a[124:127], v[40:43]
  ds_read_b64_tr_b16 v[66:67], v15 offset:1024
s_waitcnt lgkmcnt(8)
  v_mfma_f32_16x16x32_bf16 v[44:47], v[80:83], a[120:123], v[44:47]
  buffer_load_dwordx4 a[120:123], v2, s[8:11], s64 offen offset:3072
  v_mfma_f32_16x16x32_bf16 v[48:51], v[80:83], a[124:127], v[48:51]
  buffer_load_dwordx4 a[124:127], v3, s[8:11], s64 offen offset:3072
  s_add_u32 s64, s64, 4096
  s_add_u32 s65, s65, 262144
s_waitcnt lgkmcnt(6)
  v_mfma_f32_16x16x32_bf16 v[20:23], v[52:55], a[0:3], v[20:23]
  ds_read_b64_tr_b16 v[68:69], v12 offset:4096
  ds_read_b64_tr_b16 v[70:71], v12 offset:5120
  v_mfma_f32_16x16x32_bf16 v[24:27], v[52:55], a[4:7], v[24:27]
  ds_read_b64_tr_b16 v[72:73], v13 offset:4096
s_waitcnt lgkmcnt(7)
  v_mfma_f32_16x16x32_bf16 v[28:31], v[56:59], a[0:3], v[28:31]
  ds_read_b64_tr_b16 v[74:75], v13 offset:5120
  s_add_u32 m0, s66, 0
  v_mfma_f32_16x16x32_bf16 v[32:35], v[56:59], a[4:7], v[32:35]
  ds_read_b64_tr_b16 v[76:77], v14 offset:4096
  ds_read_b64_tr_b16 v[78:79], v14 offset:5120
s_waitcnt lgkmcnt(8)
  v_mfma_f32_16x16x32_bf16 v[36:39], v[60:63], a[0:3], v[36:39]
  ds_read_b64_tr_b16 v[80:81], v15 offset:4096
  buffer_load_dwordx4 v4, s[12:15], s65 offen offset:0 lds
  v_mfma_f32_16x16x32_bf16 v[40:43], v[60:63], a[4:7], v[40:43]
  ds_read_b64_tr_b16 v[82:83], v15 offset:5120
s_waitcnt lgkmcnt(8)
  v_mfma_f32_16x16x32_bf16 v[44:47], v[64:67], a[0:3], v[44:47]
  buffer_load_dwordx4 a[0:3], v2, s[8:11], s64 offen offset:0
  v_mfma_f32_16x16x32_bf16 v[48:51], v[64:67], a[4:7], v[48:51]
  buffer_load_dwordx4 a[4:7], v3, s[8:11], s64 offen offset:0
s_waitcnt lgkmcnt(6)
  v_mfma_f32_16x16x32_bf16 v[20:23], v[68:71], a[8:11], v[20:23]
  ds_read_b64_tr_b16 v[52:53], v12 offset:8192
  ds_read_b64_tr_b16 v[54:55], v12 offset:9216
  v_mfma_f32_16x16x32_bf16 v[24:27], v[68:71], a[12:15], v[24:27]
  ds_read_b64_tr_b16 v[56:57], v13 offset:8192
s_waitcnt lgkmcnt(7)
  v_mfma_f32_16x16x32_bf16 v[28:31], v[72:75], a[8:11], v[28:31]
  ds_read_b64_tr_b16 v[58:59], v13 offset:9216
  v_mfma_f32_16x16x32_bf16 v[32:35], v[72:75], a[12:15], v[32:35]
  ds_read_b64_tr_b16 v[60:61], v14 offset:8192
  ds_read_b64_tr_b16 v[62:63], v14 offset:9216
s_waitcnt lgkmcnt(8)
  v_mfma_f32_16x16x32_bf16 v[36:39], v[76:79], a[8:11], v[36:39]
  ds_read_b64_tr_b16 v[64:65], v15 offset:8192
  buffer_load_dwordx4 v5, s[12:15], s65 offen offset:1024 lds
  v_mfma_f32_16x16x32_bf16 v[40:43], v[76:79], a[12:15], v[40:43]
  ds_read_b64_tr_b16 v[66:67], v15 offset:9216
s_waitcnt lgkmcnt(8)
  v_mfma_f32_16x16x32_bf16 v[44:47], v[80:83], a[8:11], v[44:47]
  buffer_load_dwordx4 a[8:11], v2, s[8:11], s64 offen offset:1024
  v_mfma_f32_16x16x32_bf16 v[48:51], v[80:83], a[12:15], v[48:51]
  buffer_load_dwordx4 a[12:15], v3, s[8:11], s64 offen offset:1024
s_waitcnt lgkmcnt(6)
  v_mfma_f32_16x16x32_bf16 v[20:23], v[52:55], a[16:19], v[20:23]
  ds_read_b64_tr_b16 v[68:69], v12 offset:12288
  ds_read_b64_tr_b16 v[70:71], v12 offset:13312
  v_mfma_f32_16x16x32_bf16 v[24:27], v[52:55], a[20:23], v[24:27]
  ds_read_b64_tr_b16 v[72:73], v13 offset:12288
s_waitcnt lgkmcnt(7)
  v_mfma_f32_16x16x32_bf16 v[28:31], v[56:59], a[16:19], v[28:31]
  ds_read_b64_tr_b16 v[74:75], v13 offset:13312
  v_mfma_f32_16x16x32_bf16 v[32:35], v[56:59], a[20:23], v[32:35]
  ds_read_b64_tr_b16 v[76:77], v14 offset:12288
  ds_read_b64_tr_b16 v[78:79], v14 offset:13312
s_waitcnt lgkmcnt(8)
  v_mfma_f32_16x16x32_bf16 v[36:39], v[60:63], a[16:19], v[36:39]
  ds_read_b64_tr_b16 v[80:81], v15 offset:12288
  buffer_load_dwordx4 v6, s[12:15], s65 offen offset:2048 lds
  v_mfma_f32_16x16x32_bf16 v[40:43], v[60:63], a[20:23], v[40:43]
  ds_read_b64_tr_b16 v[82:83], v15 offset:13312
s_waitcnt lgkmcnt(8)
  v_mfma_f32_16x16x32_bf16 v[44:47], v[64:67], a[16:19], v[44:47]
  buffer_load_dwordx4 a[16:19], v2, s[8:11], s64 offen offset:2048
  v_mfma_f32_16x16x32_bf16 v[48:51], v[64:67], a[20:23], v[48:51]
  buffer_load_dwordx4 a[20:23], v3, s[8:11], s64 offen offset:2048
  s_waitcnt vmcnt(35)
  s_barrier
s_waitcnt lgkmcnt(6)
  v_mfma_f32_16x16x32_bf16 v[20:23], v[68:71], a[24:27], v[20:23]
  ds_read_b64_tr_b16 v[52:53], v12 offset:16384
  ds_read_b64_tr_b16 v[54:55], v12 offset:17408
  v_mfma_f32_16x16x32_bf16 v[24:27], v[68:71], a[28:31], v[24:27]
  ds_read_b64_tr_b16 v[56:57], v13 offset:16384
s_waitcnt lgkmcnt(7)
  v_mfma_f32_16x16x32_bf16 v[28:31], v[72:75], a[24:27], v[28:31]
  ds_read_b64_tr_b16 v[58:59], v13 offset:17408
  v_mfma_f32_16x16x32_bf16 v[32:35], v[72:75], a[28:31], v[32:35]
  ds_read_b64_tr_b16 v[60:61], v14 offset:16384
  ds_read_b64_tr_b16 v[62:63], v14 offset:17408
s_waitcnt lgkmcnt(8)
  v_mfma_f32_16x16x32_bf16 v[36:39], v[76:79], a[24:27], v[36:39]
  ds_read_b64_tr_b16 v[64:65], v15 offset:16384
  buffer_load_dwordx4 v7, s[12:15], s65 offen offset:3072 lds
  v_mfma_f32_16x16x32_bf16 v[40:43], v[76:79], a[28:31], v[40:43]
  ds_read_b64_tr_b16 v[66:67], v15 offset:17408
s_waitcnt lgkmcnt(8)
  v_mfma_f32_16x16x32_bf16 v[44:47], v[80:83], a[24:27], v[44:47]
  buffer_load_dwordx4 a[24:27], v2, s[8:11], s64 offen offset:3072
  v_mfma_f32_16x16x32_bf16 v[48:51], v[80:83], a[28:31], v[48:51]
  buffer_load_dwordx4 a[28:31], v3, s[8:11], s64 offen offset:3072
  s_add_u32 s64, s64, 4096
  s_add_u32 s65, s65, 262144
s_waitcnt lgkmcnt(6)
  v_mfma_f32_16x16x32_bf16 v[20:23], v[52:55], a[32:35], v[20:23]
  ds_read_b64_tr_b16 v[68:69], v12 offset:20480
  ds_read_b64_tr_b16 v[70:71], v12 offset:21504
  v_mfma_f32_16x16x32_bf16 v[24:27], v[52:55], a[36:39], v[24:27]
  ds_read_b64_tr_b16 v[72:73], v13 offset:20480
s_waitcnt lgkmcnt(7)
  v_mfma_f32_16x16x32_bf16 v[28:31], v[56:59], a[32:35], v[28:31]
  ds_read_b64_tr_b16 v[74:75], v13 offset:21504
  s_add_u32 m0, s66, 16384
  v_mfma_f32_16x16x32_bf16 v[32:35], v[56:59], a[36:39], v[32:35]
  ds_read_b64_tr_b16 v[76:77], v14 offset:20480
  ds_read_b64_tr_b16 v[78:79], v14 offset:21504
s_waitcnt lgkmcnt(8)
  v_mfma_f32_16x16x32_bf16 v[36:39], v[60:63], a[32:35], v[36:39]
  ds_read_b64_tr_b16 v[80:81], v15 offset:20480
  buffer_load_dwordx4 v4, s[12:15], s65 offen offset:0 lds
  v_mfma_f32_16x16x32_bf16 v[40:43], v[60:63], a[36:39], v[40:43]
  ds_read_b64_tr_b16 v[82:83], v15 offset:21504
s_waitcnt lgkmcnt(8)
  v_mfma_f32_16x16x32_bf16 v[44:47], v[64:67], a[32:35], v[44:47]
  buffer_load_dwordx4 a[32:35], v2, s[8:11], s64 offen offset:0
  v_mfma_f32_16x16x32_bf16 v[48:51], v[64:67], a[36:39], v[48:51]
  buffer_load_dwordx4 a[36:39], v3, s[8:11], s64 offen offset:0
s_waitcnt lgkmcnt(6)
  v_mfma_f32_16x16x32_bf16 v[20:23], v[68:71], a[40:43], v[20:23]
  ds_read_b64_tr_b16 v[52:53], v12 offset:24576
  ds_read_b64_tr_b16 v[54:55], v12 offset:25600
  v_mfma_f32_16x16x32_bf16 v[24:27], v[68:71], a[44:47], v[24:27]
  ds_read_b64_tr_b16 v[56:57], v13 offset:24576
s_waitcnt lgkmcnt(7)
  v_mfma_f32_16x16x32_bf16 v[28:31], v[72:75], a[40:43], v[28:31]
  ds_read_b64_tr_b16 v[58:59], v13 offset:25600
  v_mfma_f32_16x16x32_bf16 v[32:35], v[72:75], a[44:47], v[32:35]
  ds_read_b64_tr_b16 v[60:61], v14 offset:24576
  ds_read_b64_tr_b16 v[62:63], v14 offset:25600
s_waitcnt lgkmcnt(8)
  v_mfma_f32_16x16x32_bf16 v[36:39], v[76:79], a[40:43], v[36:39]
  ds_read_b64_tr_b16 v[64:65], v15 offset:24576
  buffer_load_dwordx4 v5, s[12:15], s65 offen offset:1024 lds
  v_mfma_f32_16x16x32_bf16 v[40:43], v[76:79], a[44:47], v[40:43]
  ds_read_b64_tr_b16 v[66:67], v15 offset:25600
s_waitcnt lgkmcnt(8)
  v_mfma_f32_16x16x32_bf16 v[44:47], v[80:83], a[40:43], v[44:47]
  buffer_load_dwordx4 a[40:43], v2, s[8:11], s64 offen offset:1024
  v_mfma_f32_16x16x32_bf16 v[48:51], v[80:83], a[44:47], v[48:51]
  buffer_load_dwordx4 a[44:47], v3, s[8:11], s64 offen offset:1024
s_waitcnt lgkmcnt(6)
  v_mfma_f32_16x16x32_bf16 v[20:23], v[52:55], a[48:51], v[20:23]
  ds_read_b64_tr_b16 v[68:69], v12 offset:28672
  ds_read_b64_tr_b16 v[70:71], v12 offset:29696
  v_mfma_f32_16x16x32_bf16 v[24:27], v[52:55], a[52:55], v[24:27]
  ds_read_b64_tr_b16 v[72:73], v13 offset:28672
s_waitcnt lgkmcnt(7)
  v_mfma_f32_16x16x32_bf16 v[28:31], v[56:59], a[48:51], v[28:31]
  ds_read_b64_tr_b16 v[74:75], v13 offset:29696
  v_mfma_f32_16x16x32_bf16 v[32:35], v[56:59], a[52:55], v[32:35]
  ds_read_b64_tr_b16 v[76:77], v14 offset:28672
  ds_read_b64_tr_b16 v[78:79], v14 offset:29696
s_waitcnt lgkmcnt(8)
  v_mfma_f32_16x16x32_bf16 v[36:39], v[60:63], a[48:51], v[36:39]
  ds_read_b64_tr_b16 v[80:81], v15 offset:28672
  buffer_load_dwordx4 v6, s[12:15], s65 offen offset:2048 lds
  v_mfma_f32_16x16x32_bf16 v[40:43], v[60:63], a[52:55], v[40:43]
  ds_read_b64_tr_b16 v[82:83], v15 offset:29696
s_waitcnt lgkmcnt(8)
  v_mfma_f32_16x16x32_bf16 v[44:47], v[64:67], a[48:51], v[44:47]
  buffer_load_dwordx4 a[48:51], v2, s[8:11], s64 offen offset:2048
  v_mfma_f32_16x16x32_bf16 v[48:51], v[64:67], a[52:55], v[48:51]
  buffer_load_dwordx4 a[52:55], v3, s[8:11], s64 offen offset:2048
  s_waitcnt vmcnt(35)
  s_barrier
s_waitcnt lgkmcnt(6)
  v_mfma_f32_16x16x32_bf16 v[20:23], v[68:71], a[56:59], v[20:23]
  ds_read_b64_tr_b16 v[52:53], v12 offset:32768
  ds_read_b64_tr_b16 v[54:55], v12 offset:33792
  v_mfma_f32_16x16x32_bf16 v[24:27], v[68:71], a[60:63], v[24:27]
  ds_read_b64_tr_b16 v[56:57], v13 offset:32768
s_waitcnt lgkmcnt(7)
  v_mfma_f32_16x16x32_bf16 v[28:31], v[72:75], a[56:59], v[28:31]
  ds_read_b64_tr_b16 v[58:59], v13 offset:33792
  v_mfma_f32_16x16x32_bf16 v[32:35], v[72:75], a[60:63], v[32:35]
  ds_read_b64_tr_b16 v[60:61], v14 offset:32768
  ds_read_b64_tr_b16 v[62:63], v14 offset:33792
s_waitcnt lgkmcnt(8)
  v_mfma_f32_16x16x32_bf16 v[36:39], v[76:79], a[56:59], v[36:39]
  ds_read_b64_tr_b16 v[64:65], v15 offset:32768
  buffer_load_dwordx4 v7, s[12:15], s65 offen offset:3072 lds
  v_mfma_f32_16x16x32_bf16 v[40:43], v[76:79], a[60:63], v[40:43]
  ds_read_b64_tr_b16 v[66:67], v15 offset:33792
s_waitcnt lgkmcnt(8)
  v_mfma_f32_16x16x32_bf16 v[44:47], v[80:83], a[56:59], v[44:47]
  buffer_load_dwordx4 a[56:59], v2, s[8:11], s64 offen offset:3072
  v_mfma_f32_16x16x32_bf16 v[48:51], v[80:83], a[60:63], v[48:51]
  buffer_load_dwordx4 a[60:63], v3, s[8:11], s64 offen offset:3072
  s_add_u32 s64, s64, 4096
  s_add_u32 s65, s65, 262144
s_waitcnt lgkmcnt(6)
  v_mfma_f32_16x16x32_bf16 v[20:23], v[52:55], a[64:67], v[20:23]
  ds_read_b64_tr_b16 v[68:69], v12 offset:36864
  ds_read_b64_tr_b16 v[70:71], v12 offset:37888
  v_mfma_f32_16x16x32_bf16 v[24:27], v[52:55], a[68:71], v[24:27]
  ds_read_b64_tr_b16 v[72:73], v13 offset:36864
s_waitcnt lgkmcnt(7)
  v_mfma_f32_16x16x32_bf16 v[28:31], v[56:59], a[64:67], v[28:31]
  ds_read_b64_tr_b16 v[74:75], v13 offset:37888
  s_add_u32 m0, s66, 32768
  v_mfma_f32_16x16x32_bf16 v[32:35], v[56:59], a[68:71], v[32:35]
  ds_read_b64_tr_b16 v[76:77], v14 offset:36864
  ds_read_b64_tr_b16 v[78:79], v14 offset:37888
s_waitcnt lgkmcnt(8)
  v_mfma_f32_16x16x32_bf16 v[36:39], v[60:63], a[64:67], v[36:39]
  ds_read_b64_tr_b16 v[80:81], v15 offset:36864
  buffer_load_dwordx4 v4, s[12:15], s65 offen offset:0 lds
  v_mfma_f32_16x16x32_bf16 v[40:43], v[60:63], a[68:71], v[40:43]
  ds_read_b64_tr_b16 v[82:83], v15 offset:37888
s_waitcnt lgkmcnt(8)
  v_mfma_f32_16x16x32_bf16 v[44:47], v[64:67], a[64:67], v[44:47]
  buffer_load_dwordx4 a[64:67], v2, s[8:11], s64 offen offset:0
  v_mfma_f32_16x16x32_bf16 v[48:51], v[64:67], a[68:71], v[48:51]
  buffer_load_dwordx4 a[68:71], v3, s[8:11], s64 offen offset:0
s_waitcnt lgkmcnt(6)
  v_mfma_f32_16x16x32_bf16 v[20:23], v[68:71], a[72:75], v[20:23]
  ds_read_b64_tr_b16 v[52:53], v12 offset:40960
  ds_read_b64_tr_b16 v[54:55], v12 offset:41984
  v_mfma_f32_16x16x32_bf16 v[24:27], v[68:71], a[76:79], v[24:27]
  ds_read_b64_tr_b16 v[56:57], v13 offset:40960
s_waitcnt lgkmcnt(7)
  v_mfma_f32_16x16x32_bf16 v[28:31], v[72:75], a[72:75], v[28:31]
  ds_read_b64_tr_b16 v[58:59], v13 offset:41984
  v_mfma_f32_16x16x32_bf16 v[32:35], v[72:75], a[76:79], v[32:35]
  ds_read_b64_tr_b16 v[60:61], v14 offset:40960
  ds_read_b64_tr_b16 v[62:63], v14 offset:41984
s_waitcnt lgkmcnt(8)
  v_mfma_f32_16x16x32_bf16 v[36:39], v[76:79], a[72:75], v[36:39]
  ds_read_b64_tr_b16 v[64:65], v15 offset:40960
  buffer_load_dwordx4 v5, s[12:15], s65 offen offset:1024 lds
  v_mfma_f32_16x16x32_bf16 v[40:43], v[76:79], a[76:79], v[40:43]
  ds_read_b64_tr_b16 v[66:67], v15 offset:41984
s_waitcnt lgkmcnt(8)
  v_mfma_f32_16x16x32_bf16 v[44:47], v[80:83], a[72:75], v[44:47]
  buffer_load_dwordx4 a[72:75], v2, s[8:11], s64 offen offset:1024
  v_mfma_f32_16x16x32_bf16 v[48:51], v[80:83], a[76:79], v[48:51]
  buffer_load_dwordx4 a[76:79], v3, s[8:11], s64 offen offset:1024
s_waitcnt lgkmcnt(6)
  v_mfma_f32_16x16x32_bf16 v[20:23], v[52:55], a[80:83], v[20:23]
  ds_read_b64_tr_b16 v[68:69], v12 offset:45056
  ds_read_b64_tr_b16 v[70:71], v12 offset:46080
  v_mfma_f32_16x16x32_bf16 v[24:27], v[52:55], a[84:87], v[24:27]
  ds_read_b64_tr_b16 v[72:73], v13 offset:45056
s_waitcnt lgkmcnt(7)
  v_mfma_f32_16x16x32_bf16 v[28:31], v[56:59], a[80:83], v[28:31]
  ds_read_b64_tr_b16 v[74:75], v13 offset:46080
  v_mfma_f32_16x16x32_bf16 v[32:35], v[56:59], a[84:87], v[32:35]
  ds_read_b64_tr_b16 v[76:77], v14 offset:45056
  ds_read_b64_tr_b16 v[78:79], v14 offset:46080
s_waitcnt lgkmcnt(8)
  v_mfma_f32_16x16x32_bf16 v[36:39], v[60:63], a[80:83], v[36:39]
  ds_read_b64_tr_b16 v[80:81], v15 offset:45056
  buffer_load_dwordx4 v6, s[12:15], s65 offen offset:2048 lds
  v_mfma_f32_16x16x32_bf16 v[40:43], v[60:63], a[84:87], v[40:43]
  ds_read_b64_tr_b16 v[82:83], v15 offset:46080
s_waitcnt lgkmcnt(8)
  v_mfma_f32_16x16x32_bf16 v[44:47], v[64:67], a[80:83], v[44:47]
  buffer_load_dwordx4 a[80:83], v2, s[8:11], s64 offen offset:2048
  v_mfma_f32_16x16x32_bf16 v[48:51], v[64:67], a[84:87], v[48:51]
  buffer_load_dwordx4 a[84:87], v3, s[8:11], s64 offen offset:2048
  s_waitcnt vmcnt(35)
  s_barrier
s_waitcnt lgkmcnt(6)
  v_mfma_f32_16x16x32_bf16 v[20:23], v[68:71], a[88:91], v[20:23]
  ds_read_b64_tr_b16 v[52:53], v12 offset:49152
  ds_read_b64_tr_b16 v[54:55], v12 offset:50176
  v_mfma_f32_16x16x32_bf16 v[24:27], v[68:71], a[92:95], v[24:27]
  ds_read_b64_tr_b16 v[56:57], v13 offset:49152
s_waitcnt lgkmcnt(7)
  v_mfma_f32_16x16x32_bf16 v[28:31], v[72:75], a[88:91], v[28:31]
  ds_read_b64_tr_b16 v[58:59], v13 offset:50176
  v_mfma_f32_16x16x32_bf16 v[32:35], v[72:75], a[92:95], v[32:35]
  ds_read_b64_tr_b16 v[60:61], v14 offset:49152
  ds_read_b64_tr_b16 v[62:63], v14 offset:50176
s_waitcnt lgkmcnt(8)
  v_mfma_f32_16x16x32_bf16 v[36:39], v[76:79], a[88:91], v[36:39]
  ds_read_b64_tr_b16 v[64:65], v15 offset:49152
  buffer_load_dwordx4 v7, s[12:15], s65 offen offset:3072 lds
  v_mfma_f32_16x16x32_bf16 v[40:43], v[76:79], a[92:95], v[40:43]
  ds_read_b64_tr_b16 v[66:67], v15 offset:50176
s_waitcnt lgkmcnt(8)
  v_mfma_f32_16x16x32_bf16 v[44:47], v[80:83], a[88:91], v[44:47]
  buffer_load_dwordx4 a[88:91], v2, s[8:11], s64 offen offset:3072
  v_mfma_f32_16x16x32_bf16 v[48:51], v[80:83], a[92:95], v[48:51]
  buffer_load_dwordx4 a[92:95], v3, s[8:11], s64 offen offset:3072
  s_add_u32 s64, s64, 4096
  s_add_u32 s65, s65, 262144
s_waitcnt lgkmcnt(6)
  v_mfma_f32_16x16x32_bf16 v[20:23], v[52:55], a[96:99], v[20:23]
  ds_read_b64_tr_b16 v[68:69], v12 offset:53248
  ds_read_b64_tr_b16 v[70:71], v12 offset:54272
  v_mfma_f32_16x16x32_bf16 v[24:27], v[52:55], a[100:103], v[24:27]
  ds_read_b64_tr_b16 v[72:73], v13 offset:53248
s_waitcnt lgkmcnt(7)
  v_mfma_f32_16x16x32_bf16 v[28:31], v[56:59], a[96:99], v[28:31]
  ds_read_b64_tr_b16 v[74:75], v13 offset:54272
  s_add_u32 m0, s66, 49152
  v_mfma_f32_16x16x32_bf16 v[32:35], v[56:59], a[100:103], v[32:35]
  ds_read_b64_tr_b16 v[76:77], v14 offset:53248
  ds_read_b64_tr_b16 v[78:79], v14 offset:54272
s_waitcnt lgkmcnt(8)
  v_mfma_f32_16x16x32_bf16 v[36:39], v[60:63], a[96:99], v[36:39]
  ds_read_b64_tr_b16 v[80:81], v15 offset:53248
  buffer_load_dwordx4 v4, s[12:15], s65 offen offset:0 lds
  v_mfma_f32_16x16x32_bf16 v[40:43], v[60:63], a[100:103], v[40:43]
  ds_read_b64_tr_b16 v[82:83], v15 offset:54272
s_waitcnt lgkmcnt(8)
  v_mfma_f32_16x16x32_bf16 v[44:47], v[64:67], a[96:99], v[44:47]
  buffer_load_dwordx4 a[96:99], v2, s[8:11], s64 offen offset:0
  v_mfma_f32_16x16x32_bf16 v[48:51], v[64:67], a[100:103], v[48:51]
  buffer_load_dwordx4 a[100:103], v3, s[8:11], s64 offen offset:0
s_waitcnt lgkmcnt(6)
  v_mfma_f32_16x16x32_bf16 v[20:23], v[68:71], a[104:107], v[20:23]
  ds_read_b64_tr_b16 v[52:53], v12 offset:57344
  ds_read_b64_tr_b16 v[54:55], v12 offset:58368
  v_mfma_f32_16x16x32_bf16 v[24:27], v[68:71], a[108:111], v[24:27]
  ds_read_b64_tr_b16 v[56:57], v13 offset:57344
s_waitcnt lgkmcnt(7)
  v_mfma_f32_16x16x32_bf16 v[28:31], v[72:75], a[104:107], v[28:31]
  ds_read_b64_tr_b16 v[58:59], v13 offset:58368
  v_mfma_f32_16x16x32_bf16 v[32:35], v[72:75], a[108:111], v[32:35]
  ds_read_b64_tr_b16 v[60:61], v14 offset:57344
  ds_read_b64_tr_b16 v[62:63], v14 offset:58368
s_waitcnt lgkmcnt(8)
  v_mfma_f32_16x16x32_bf16 v[36:39], v[76:79], a[104:107], v[36:39]
  ds_read_b64_tr_b16 v[64:65], v15 offset:57344
  buffer_load_dwordx4 v5, s[12:15], s65 offen offset:1024 lds
  v_mfma_f32_16x16x32_bf16 v[40:43], v[76:79], a[108:111], v[40:43]
  ds_read_b64_tr_b16 v[66:67], v15 offset:58368
s_waitcnt lgkmcnt(8)
  v_mfma_f32_16x16x32_bf16 v[44:47], v[80:83], a[104:107], v[44:47]
  buffer_load_dwordx4 a[104:107], v2, s[8:11], s64 offen offset:1024
  v_mfma_f32_16x16x32_bf16 v[48:51], v[80:83], a[108:111], v[48:51]
  buffer_load_dwordx4 a[108:111], v3, s[8:11], s64 offen offset:1024
s_waitcnt lgkmcnt(6)
  v_mfma_f32_16x16x32_bf16 v[20:23], v[52:55], a[112:115], v[20:23]
  ds_read_b64_tr_b16 v[68:69], v12 offset:61440
  ds_read_b64_tr_b16 v[70:71], v12 offset:62464
  v_mfma_f32_16x16x32_bf16 v[24:27], v[52:55], a[116:119], v[24:27]
  ds_read_b64_tr_b16 v[72:73], v13 offset:61440
s_waitcnt lgkmcnt(7)
  v_mfma_f32_16x16x32_bf16 v[28:31], v[56:59], a[112:115], v[28:31]
  ds_read_b64_tr_b16 v[74:75], v13 offset:62464
  v_mfma_f32_16x16x32_bf16 v[32:35], v[56:59], a[116:119], v[32:35]
  ds_read_b64_tr_b16 v[76:77], v14 offset:61440
  ds_read_b64_tr_b16 v[78:79], v14 offset:62464
s_waitcnt lgkmcnt(8)
  v_mfma_f32_16x16x32_bf16 v[36:39], v[60:63], a[112:115], v[36:39]
  ds_read_b64_tr_b16 v[80:81], v15 offset:61440
  buffer_load_dwordx4 v6, s[12:15], s65 offen offset:2048 lds
  v_mfma_f32_16x16x32_bf16 v[40:43], v[60:63], a[116:119], v[40:43]
  ds_read_b64_tr_b16 v[82:83], v15 offset:62464
s_waitcnt lgkmcnt(8)
  v_mfma_f32_16x16x32_bf16 v[44:47], v[64:67], a[112:115], v[44:47]
  buffer_load_dwordx4 a[112:115], v2, s[8:11], s64 offen offset:2048
  v_mfma_f32_16x16x32_bf16 v[48:51], v[64:67], a[116:119], v[48:51]
  buffer_load_dwordx4 a[116:119], v3, s[8:11], s64 offen offset:2048
  s_waitcnt vmcnt(35)
  s_barrier
s_waitcnt lgkmcnt(6)
  v_mfma_f32_16x16x32_bf16 v[20:23], v[68:71], a[120:123], v[20:23]
  ds_read_b64_tr_b16 v[52:53], v8 offset:0
  ds_read_b64_tr_b16 v[54:55], v8 offset:1024
  v_mfma_f32_16x16x32_bf16 v[24:27], v[68:71], a[124:127], v[24:27]
  ds_read_b64_tr_b16 v[56:57], v9 offset:0
s_waitcnt lgkmcnt(7)
  v_mfma_f32_16x16x32_bf16 v[28:31], v[72:75], a[120:123], v[28:31]
  ds_read_b64_tr_b16 v[58:59], v9 offset:1024
  v_mfma_f32_16x16x32_bf16 v[32:35], v[72:75], a[124:127], v[32:35]
  ds_read_b64_tr_b16 v[60:61], v10 offset:0
  ds_read_b64_tr_b16 v[62:63], v10 offset:1024
s_waitcnt lgkmcnt(8)
  v_mfma_f32_16x16x32_bf16 v[36:39], v[76:79], a[120:123], v[36:39]
  ds_read_b64_tr_b16 v[64:65], v11 offset:0
  buffer_load_dwordx4 v7, s[12:15], s65 offen offset:3072 lds
  v_mfma_f32_16x16x32_bf16 v[40:43], v[76:79], a[124:127], v[40:43]
  ds_read_b64_tr_b16 v[66:67], v11 offset:1024
s_waitcnt lgkmcnt(8)
  v_mfma_f32_16x16x32_bf16 v[44:47], v[80:83], a[120:123], v[44:47]
  buffer_load_dwordx4 a[120:123], v2, s[8:11], s64 offen offset:3072
  v_mfma_f32_16x16x32_bf16 v[48:51], v[80:83], a[124:127], v[48:51]
  buffer_load_dwordx4 a[124:127], v3, s[8:11], s64 offen offset:3072
  s_add_u32 s64, s64, 4096
  s_add_u32 s65, s65, 262144
  s_sub_u32 s67, s67, 1
  s_cmp_lg_u32 s67, 0
  s_cbranch_scc1 L_kd_kernel_loop
s_waitcnt lgkmcnt(6)
  v_mfma_f32_16x16x32_bf16 v[20:23], v[52:55], a[0:3], v[20:23]
  ds_read_b64_tr_b16 v[68:69], v8 offset:4096
  ds_read_b64_tr_b16 v[70:71], v8 offset:5120
  v_sub_f32 v118, 1.0, v116
  v_mfma_f32_16x16x32_bf16 v[24:27], v[52:55], a[4:7], v[24:27]
  ds_read_b64_tr_b16 v[72:73], v9 offset:4096
  v_lshlrev_b32 v120, 16, v84
s_waitcnt lgkmcnt(7)
  v_mfma_f32_16x16x32_bf16 v[28:31], v[56:59], a[0:3], v[28:31]
  ds_read_b64_tr_b16 v[74:75], v9 offset:5120
  s_add_u32 m0, s66, 65536
  v_lshlrev_b32 v152, 16, v100
  v_mfma_f32_16x16x32_bf16 v[32:35], v[56:59], a[4:7], v[32:35]
  ds_read_b64_tr_b16 v[76:77], v10 offset:4096
  ds_read_b64_tr_b16 v[78:79], v10 offset:5120
  v_and_b32 v121, 0xffff0000, v84
s_waitcnt lgkmcnt(8)
  v_mfma_f32_16x16x32_bf16 v[36:39], v[60:63], a[0:3], v[36:39]
  ds_read_b64_tr_b16 v[80:81], v11 offset:4096
  buffer_load_dwordx4 v4, s[12:15], s65 offen offset:0 lds
  v_and_b32 v153, 0xffff0000, v100
  v_mfma_f32_16x16x32_bf16 v[40:43], v[60:63], a[4:7], v[40:43]
  ds_read_b64_tr_b16 v[82:83], v11 offset:5120
  v_mul_f32 v120, v120, v152
s_waitcnt lgkmcnt(8)
  v_mfma_f32_16x16x32_bf16 v[44:47], v[64:67], a[0:3], v[44:47]
  buffer_load_dwordx4 a[0:3], v2, s[8:11], s64 offen offset:0
  v_mul_f32 v121, v121, v153
  v_mfma_f32_16x16x32_bf16 v[48:51], v[64:67], a[4:7], v[48:51]
  buffer_load_dwordx4 a[4:7], v3, s[8:11], s64 offen offset:0
  v_mul_f32 v120, v120, v116
s_waitcnt lgkmcnt(6)
  v_mfma_f32_16x16x32_bf16 v[20:23], v[68:71], a[8:11], v[20:23]
  ds_read_b64_tr_b16 v[52:53], v8 offset:8192
  ds_read_b64_tr_b16 v[54:55], v8 offset:9216
  v_mul_f32 v121, v121, v116
  v_mfma_f32_16x16x32_bf16 v[24:27], v[68:71], a[12:15], v[24:27]
  ds_read_b64_tr_b16 v[56:57], v9 offset:8192
  v_lshlrev_b32 v122, 16, v85
s_waitcnt lgkmcnt(7)
  v_mfma_f32_16x16x32_bf16 v[28:31], v[72:75], a[8:11], v[28:31]
  ds_read_b64_tr_b16 v[58:59], v9 offset:9216
  v_lshlrev_b32 v152, 16, v101
  v_mfma_f32_16x16x32_bf16 v[32:35], v[72:75], a[12:15], v[32:35]
  ds_read_b64_tr_b16 v[60:61], v10 offset:8192
  ds_read_b64_tr_b16 v[62:63], v10 offset:9216
  v_and_b32 v123, 0xffff0000, v85
s_waitcnt lgkmcnt(8)
  v_mfma_f32_16x16x32_bf16 v[36:39], v[76:79], a[8:11], v[36:39]
  ds_read_b64_tr_b16 v[64:65], v11 offset:8192
  buffer_load_dwordx4 v5, s[12:15], s65 offen offset:1024 lds
  v_and_b32 v153, 0xffff0000, v101
  v_mfma_f32_16x16x32_bf16 v[40:43], v[76:79], a[12:15], v[40:43]
  ds_read_b64_tr_b16 v[66:67], v11 offset:9216
  v_mul_f32 v122, v122, v152
s_waitcnt lgkmcnt(8)
  v_mfma_f32_16x16x32_bf16 v[44:47], v[80:83], a[8:11], v[44:47]
  buffer_load_dwordx4 a[8:11], v2, s[8:11], s64 offen offset:1024
  v_mul_f32 v123, v123, v153
  v_mfma_f32_16x16x32_bf16 v[48:51], v[80:83], a[12:15], v[48:51]
  buffer_load_dwordx4 a[12:15], v3, s[8:11], s64 offen offset:1024
  v_mul_f32 v122, v122, v116
s_waitcnt lgkmcnt(6)
  v_mfma_f32_16x16x32_bf16 v[20:23], v[52:55], a[16:19], v[20:23]
  ds_read_b64_tr_b16 v[68:69], v8 offset:12288
  ds_read_b64_tr_b16 v[70:71], v8 offset:13312
  v_mul_f32 v123, v123, v116
  v_mfma_f32_16x16x32_bf16 v[24:27], v[52:55], a[20:23], v[24:27]
  ds_read_b64_tr_b16 v[72:73], v9 offset:12288
  v_lshlrev_b32 v124, 16, v86
s_waitcnt lgkmcnt(7)
  v_mfma_f32_16x16x32_bf16 v[28:31], v[56:59], a[16:19], v[28:31]
  ds_read_b64_tr_b16 v[74:75], v9 offset:13312
  v_lshlrev_b32 v152, 16, v102
  v_mfma_f32_16x16x32_bf16 v[32:35], v[56:59], a[20:23], v[32:35]
  ds_read_b64_tr_b16 v[76:77], v10 offset:12288
  ds_read_b64_tr_b16 v[78:79], v10 offset:13312
  v_and_b32 v125, 0xffff0000, v86
s_waitcnt lgkmcnt(8)
  v_mfma_f32_16x16x32_bf16 v[36:39], v[60:63], a[16:19], v[36:39]
  ds_read_b64_tr_b16 v[80:81], v11 offset:12288
  buffer_load_dwordx4 v6, s[12:15], s65 offen offset:2048 lds
  v_and_b32 v153, 0xffff0000, v102
  v_mfma_f32_16x16x32_bf16 v[40:43], v[60:63], a[20:23], v[40:43]
  ds_read_b64_tr_b16 v[82:83], v11 offset:13312
  v_mul_f32 v124, v124, v152
s_waitcnt lgkmcnt(8)
  v_mfma_f32_16x16x32_bf16 v[44:47], v[64:67], a[16:19], v[44:47]
  buffer_load_dwordx4 a[16:19], v2, s[8:11], s64 offen offset:2048
  v_mul_f32 v125, v125, v153
  v_mfma_f32_16x16x32_bf16 v[48:51], v[64:67], a[20:23], v[48:51]
  buffer_load_dwordx4 a[20:23], v3, s[8:11], s64 offen offset:2048
  v_mul_f32 v124, v124, v116
  s_waitcnt vmcnt(35)
  s_barrier
s_waitcnt lgkmcnt(6)
  v_mfma_f32_16x16x32_bf16 v[20:23], v[68:71], a[24:27], v[20:23]
  ds_read_b64_tr_b16 v[52:53], v8 offset:16384
  ds_read_b64_tr_b16 v[54:55], v8 offset:17408
  v_mul_f32 v125, v125, v116
  v_mfma_f32_16x16x32_bf16 v[24:27], v[68:71], a[28:31], v[24:27]
  ds_read_b64_tr_b16 v[56:57], v9 offset:16384
  v_lshlrev_b32 v126, 16, v87
s_waitcnt lgkmcnt(7)
  v_mfma_f32_16x16x32_bf16 v[28:31], v[72:75], a[24:27], v[28:31]
  ds_read_b64_tr_b16 v[58:59], v9 offset:17408
  v_lshlrev_b32 v152, 16, v103
  v_mfma_f32_16x16x32_bf16 v[32:35], v[72:75], a[28:31], v[32:35]
  ds_read_b64_tr_b16 v[60:61], v10 offset:16384
  ds_read_b64_tr_b16 v[62:63], v10 offset:17408
  v_and_b32 v127, 0xffff0000, v87
s_waitcnt lgkmcnt(8)
  v_mfma_f32_16x16x32_bf16 v[36:39], v[76:79], a[24:27], v[36:39]
  ds_read_b64_tr_b16 v[64:65], v11 offset:16384
  buffer_load_dwordx4 v7, s[12:15], s65 offen offset:3072 lds
  v_and_b32 v153, 0xffff0000, v103
  v_mfma_f32_16x16x32_bf16 v[40:43], v[76:79], a[28:31], v[40:43]
  ds_read_b64_tr_b16 v[66:67], v11 offset:17408
  v_mul_f32 v126, v126, v152
s_waitcnt lgkmcnt(8)
  v_mfma_f32_16x16x32_bf16 v[44:47], v[80:83], a[24:27], v[44:47]
  buffer_load_dwordx4 a[24:27], v2, s[8:11], s64 offen offset:3072
  v_mul_f32 v127, v127, v153
  v_mfma_f32_16x16x32_bf16 v[48:51], v[80:83], a[28:31], v[48:51]
  buffer_load_dwordx4 a[28:31], v3, s[8:11], s64 offen offset:3072
  s_add_u32 s64, s64, 4096
  s_add_u32 s65, s65, 262144
  v_mul_f32 v126, v126, v116
s_waitcnt lgkmcnt(6)
  v_mfma_f32_16x16x32_bf16 v[20:23], v[52:55], a[32:35], v[20:23]
  ds_read_b64_tr_b16 v[68:69], v8 offset:20480
  ds_read_b64_tr_b16 v[70:71], v8 offset:21504
  v_mul_f32 v127, v127, v116
  v_mfma_f32_16x16x32_bf16 v[24:27], v[52:55], a[36:39], v[24:27]
  ds_read_b64_tr_b16 v[72:73], v9 offset:20480
  v_lshlrev_b32 v128, 16, v88
s_waitcnt lgkmcnt(7)
  v_mfma_f32_16x16x32_bf16 v[28:31], v[56:59], a[32:35], v[28:31]
  ds_read_b64_tr_b16 v[74:75], v9 offset:21504
  s_add_u32 m0, s66, 81920
  v_lshlrev_b32 v152, 16, v104
  v_mfma_f32_16x16x32_bf16 v[32:35], v[56:59], a[36:39], v[32:35]
  ds_read_b64_tr_b16 v[76:77], v10 offset:20480
  ds_read_b64_tr_b16 v[78:79], v10 offset:21504
  v_and_b32 v129, 0xffff0000, v88
s_waitcnt lgkmcnt(8)
  v_mfma_f32_16x16x32_bf16 v[36:39], v[60:63], a[32:35], v[36:39]
  ds_read_b64_tr_b16 v[80:81], v11 offset:20480
  buffer_load_dwordx4 v4, s[12:15], s65 offen offset:0 lds
  v_and_b32 v153, 0xffff0000, v104
  v_mfma_f32_16x16x32_bf16 v[40:43], v[60:63], a[36:39], v[40:43]
  ds_read_b64_tr_b16 v[82:83], v11 offset:21504
  v_mul_f32 v128, v128, v152
s_waitcnt lgkmcnt(8)
  v_mfma_f32_16x16x32_bf16 v[44:47], v[64:67], a[32:35], v[44:47]
  buffer_load_dwordx4 a[32:35], v2, s[8:11], s64 offen offset:0
  v_mul_f32 v129, v129, v153
  v_mfma_f32_16x16x32_bf16 v[48:51], v[64:67], a[36:39], v[48:51]
  buffer_load_dwordx4 a[36:39], v3, s[8:11], s64 offen offset:0
  v_mul_f32 v128, v128, v116
s_waitcnt lgkmcnt(6)
  v_mfma_f32_16x16x32_bf16 v[20:23], v[68:71], a[40:43], v[20:23]
  ds_read_b64_tr_b16 v[52:53], v8 offset:24576
  ds_read_b64_tr_b16 v[54:55], v8 offset:25600
  v_mul_f32 v129, v129, v116
  v_mfma_f32_16x16x32_bf16 v[24:27], v[68:71], a[44:47], v[24:27]
  ds_read_b64_tr_b16 v[56:57], v9 offset:24576
  v_lshlrev_b32 v130, 16, v89
s_waitcnt lgkmcnt(7)
  v_mfma_f32_16x16x32_bf16 v[28:31], v[72:75], a[40:43], v[28:31]
  ds_read_b64_tr_b16 v[58:59], v9 offset:25600
  v_lshlrev_b32 v152, 16, v105
  v_mfma_f32_16x16x32_bf16 v[32:35], v[72:75], a[44:47], v[32:35]
  ds_read_b64_tr_b16 v[60:61], v10 offset:24576
  ds_read_b64_tr_b16 v[62:63], v10 offset:25600
  v_and_b32 v131, 0xffff0000, v89
s_waitcnt lgkmcnt(8)
  v_mfma_f32_16x16x32_bf16 v[36:39], v[76:79], a[40:43], v[36:39]
  ds_read_b64_tr_b16 v[64:65], v11 offset:24576
  buffer_load_dwordx4 v5, s[12:15], s65 offen offset:1024 lds
  v_and_b32 v153, 0xffff0000, v105
  v_mfma_f32_16x16x32_bf16 v[40:43], v[76:79], a[44:47], v[40:43]
  ds_read_b64_tr_b16 v[66:67], v11 offset:25600
  v_mul_f32 v130, v130, v152
s_waitcnt lgkmcnt(8)
  v_mfma_f32_16x16x32_bf16 v[44:47], v[80:83], a[40:43], v[44:47]
  buffer_load_dwordx4 a[40:43], v2, s[8:11], s64 offen offset:1024
  v_mul_f32 v131, v131, v153
  v_mfma_f32_16x16x32_bf16 v[48:51], v[80:83], a[44:47], v[48:51]
  buffer_load_dwordx4 a[44:47], v3, s[8:11], s64 offen offset:1024
  v_mul_f32 v130, v130, v116
s_waitcnt lgkmcnt(6)
  v_mfma_f32_16x16x32_bf16 v[20:23], v[52:55], a[48:51], v[20:23]
  ds_read_b64_tr_b16 v[68:69], v8 offset:28672
  ds_read_b64_tr_b16 v[70:71], v8 offset:29696
  v_mul_f32 v131, v131, v116
  v_mfma_f32_16x16x32_bf16 v[24:27], v[52:55], a[52:55], v[24:27]
  ds_read_b64_tr_b16 v[72:73], v9 offset:28672
  v_lshlrev_b32 v132, 16, v90
s_waitcnt lgkmcnt(7)
  v_mfma_f32_16x16x32_bf16 v[28:31], v[56:59], a[48:51], v[28:31]
  ds_read_b64_tr_b16 v[74:75], v9 offset:29696
  v_lshlrev_b32 v152, 16, v106
  v_mfma_f32_16x16x32_bf16 v[32:35], v[56:59], a[52:55], v[32:35]
  ds_read_b64_tr_b16 v[76:77], v10 offset:28672
  ds_read_b64_tr_b16 v[78:79], v10 offset:29696
  v_and_b32 v133, 0xffff0000, v90
s_waitcnt lgkmcnt(8)
  v_mfma_f32_16x16x32_bf16 v[36:39], v[60:63], a[48:51], v[36:39]
  ds_read_b64_tr_b16 v[80:81], v11 offset:28672
  buffer_load_dwordx4 v6, s[12:15], s65 offen offset:2048 lds
  v_and_b32 v153, 0xffff0000, v106
  v_mfma_f32_16x16x32_bf16 v[40:43], v[60:63], a[52:55], v[40:43]
  ds_read_b64_tr_b16 v[82:83], v11 offset:29696
  v_mul_f32 v132, v132, v152
s_waitcnt lgkmcnt(8)
  v_mfma_f32_16x16x32_bf16 v[44:47], v[64:67], a[48:51], v[44:47]
  buffer_load_dwordx4 a[48:51], v2, s[8:11], s64 offen offset:2048
  v_mul_f32 v133, v133, v153
  v_mfma_f32_16x16x32_bf16 v[48:51], v[64:67], a[52:55], v[48:51]
  buffer_load_dwordx4 a[52:55], v3, s[8:11], s64 offen offset:2048
  v_mul_f32 v132, v132, v116
  s_waitcnt vmcnt(35)
  s_barrier
s_waitcnt lgkmcnt(6)
  v_mfma_f32_16x16x32_bf16 v[20:23], v[68:71], a[56:59], v[20:23]
  ds_read_b64_tr_b16 v[52:53], v8 offset:32768
  ds_read_b64_tr_b16 v[54:55], v8 offset:33792
  v_mul_f32 v133, v133, v116
  v_lshlrev_b32 v134, 16, v91
  v_mfma_f32_16x16x32_bf16 v[24:27], v[68:71], a[60:63], v[24:27]
  ds_read_b64_tr_b16 v[56:57], v9 offset:32768
  v_lshlrev_b32 v152, 16, v107
s_waitcnt lgkmcnt(7)
  v_mfma_f32_16x16x32_bf16 v[28:31], v[72:75], a[56:59], v[28:31]
  ds_read_b64_tr_b16 v[58:59], v9 offset:33792
  v_and_b32 v135, 0xffff0000, v91
  v_mfma_f32_16x16x32_bf16 v[32:35], v[72:75], a[60:63], v[32:35]
  ds_read_b64_tr_b16 v[60:61], v10 offset:32768
  ds_read_b64_tr_b16 v[62:63], v10 offset:33792
  v_and_b32 v153, 0xffff0000, v107
s_waitcnt lgkmcnt(8)
  v_mfma_f32_16x16x32_bf16 v[36:39], v[76:79], a[56:59], v[36:39]
  ds_read_b64_tr_b16 v[64:65], v11 offset:32768
  buffer_load_dwordx4 v7, s[12:15], s65 offen offset:3072 lds
  v_mul_f32 v134, v134, v152
  v_mfma_f32_16x16x32_bf16 v[40:43], v[76:79], a[60:63], v[40:43]
  ds_read_b64_tr_b16 v[66:67], v11 offset:33792
  v_mul_f32 v135, v135, v153
s_waitcnt lgkmcnt(8)
  v_mfma_f32_16x16x32_bf16 v[44:47], v[80:83], a[56:59], v[44:47]
  buffer_load_dwordx4 a[56:59], v2, s[8:11], s64 offen offset:3072
  v_mul_f32 v134, v134, v116
  v_mfma_f32_16x16x32_bf16 v[48:51], v[80:83], a[60:63], v[48:51]
  buffer_load_dwordx4 a[60:63], v3, s[8:11], s64 offen offset:3072
  s_add_u32 s64, s64, 4096
  s_add_u32 s65, s65, 262144
  v_mul_f32 v135, v135, v116
s_waitcnt lgkmcnt(6)
  v_mfma_f32_16x16x32_bf16 v[20:23], v[52:55], a[64:67], v[20:23]
  ds_read_b64_tr_b16 v[68:69], v8 offset:36864
  ds_read_b64_tr_b16 v[70:71], v8 offset:37888
  v_sub_f32 v119, 1.0, v117
  v_mfma_f32_16x16x32_bf16 v[24:27], v[52:55], a[68:71], v[24:27]
  ds_read_b64_tr_b16 v[72:73], v9 offset:36864
  v_lshlrev_b32 v136, 16, v92
s_waitcnt lgkmcnt(7)
  v_mfma_f32_16x16x32_bf16 v[28:31], v[56:59], a[64:67], v[28:31]
  ds_read_b64_tr_b16 v[74:75], v9 offset:37888
  s_add_u32 m0, s66, 98304
  v_lshlrev_b32 v152, 16, v108
  v_mfma_f32_16x16x32_bf16 v[32:35], v[56:59], a[68:71], v[32:35]
  ds_read_b64_tr_b16 v[76:77], v10 offset:36864
  ds_read_b64_tr_b16 v[78:79], v10 offset:37888
  v_and_b32 v137, 0xffff0000, v92
s_waitcnt lgkmcnt(8)
  v_mfma_f32_16x16x32_bf16 v[36:39], v[60:63], a[64:67], v[36:39]
  ds_read_b64_tr_b16 v[80:81], v11 offset:36864
  buffer_load_dwordx4 v4, s[12:15], s65 offen offset:0 lds
  v_and_b32 v153, 0xffff0000, v108
  v_mfma_f32_16x16x32_bf16 v[40:43], v[60:63], a[68:71], v[40:43]
  ds_read_b64_tr_b16 v[82:83], v11 offset:37888
  v_mul_f32 v136, v136, v152
s_waitcnt lgkmcnt(8)
  v_mfma_f32_16x16x32_bf16 v[44:47], v[64:67], a[64:67], v[44:47]
  buffer_load_dwordx4 a[64:67], v2, s[8:11], s64 offen offset:0
  v_mul_f32 v137, v137, v153
  v_mfma_f32_16x16x32_bf16 v[48:51], v[64:67], a[68:71], v[48:51]
  buffer_load_dwordx4 a[68:71], v3, s[8:11], s64 offen offset:0
  v_mul_f32 v136, v136, v117
s_waitcnt lgkmcnt(6)
  v_mfma_f32_16x16x32_bf16 v[20:23], v[68:71], a[72:75], v[20:23]
  ds_read_b64_tr_b16 v[52:53], v8 offset:40960
  ds_read_b64_tr_b16 v[54:55], v8 offset:41984
  v_mul_f32 v137, v137, v117
  v_mfma_f32_16x16x32_bf16 v[24:27], v[68:71], a[76:79], v[24:27]
  ds_read_b64_tr_b16 v[56:57], v9 offset:40960
  v_lshlrev_b32 v138, 16, v93
s_waitcnt lgkmcnt(7)
  v_mfma_f32_16x16x32_bf16 v[28:31], v[72:75], a[72:75], v[28:31]
  ds_read_b64_tr_b16 v[58:59], v9 offset:41984
  v_lshlrev_b32 v152, 16, v109
  v_mfma_f32_16x16x32_bf16 v[32:35], v[72:75], a[76:79], v[32:35]
  ds_read_b64_tr_b16 v[60:61], v10 offset:40960
  ds_read_b64_tr_b16 v[62:63], v10 offset:41984
  v_and_b32 v139, 0xffff0000, v93
s_waitcnt lgkmcnt(8)
  v_mfma_f32_16x16x32_bf16 v[36:39], v[76:79], a[72:75], v[36:39]
  ds_read_b64_tr_b16 v[64:65], v11 offset:40960
  buffer_load_dwordx4 v5, s[12:15], s65 offen offset:1024 lds
  v_and_b32 v153, 0xffff0000, v109
  v_mfma_f32_16x16x32_bf16 v[40:43], v[76:79], a[76:79], v[40:43]
  ds_read_b64_tr_b16 v[66:67], v11 offset:41984
  v_mul_f32 v138, v138, v152
s_waitcnt lgkmcnt(8)
  v_mfma_f32_16x16x32_bf16 v[44:47], v[80:83], a[72:75], v[44:47]
  buffer_load_dwordx4 a[72:75], v2, s[8:11], s64 offen offset:1024
  v_mul_f32 v139, v139, v153
  v_mfma_f32_16x16x32_bf16 v[48:51], v[80:83], a[76:79], v[48:51]
  buffer_load_dwordx4 a[76:79], v3, s[8:11], s64 offen offset:1024
  v_mul_f32 v138, v138, v117
s_waitcnt lgkmcnt(6)
  v_mfma_f32_16x16x32_bf16 v[20:23], v[52:55], a[80:83], v[20:23]
  ds_read_b64_tr_b16 v[68:69], v8 offset:45056
  ds_read_b64_tr_b16 v[70:71], v8 offset:46080
  v_mul_f32 v139, v139, v117
  v_mfma_f32_16x16x32_bf16 v[24:27], v[52:55], a[84:87], v[24:27]
  ds_read_b64_tr_b16 v[72:73], v9 offset:45056
  v_lshlrev_b32 v140, 16, v94
s_waitcnt lgkmcnt(7)
  v_mfma_f32_16x16x32_bf16 v[28:31], v[56:59], a[80:83], v[28:31]
  ds_read_b64_tr_b16 v[74:75], v9 offset:46080
  v_lshlrev_b32 v152, 16, v110
  v_mfma_f32_16x16x32_bf16 v[32:35], v[56:59], a[84:87], v[32:35]
  ds_read_b64_tr_b16 v[76:77], v10 offset:45056
  ds_read_b64_tr_b16 v[78:79], v10 offset:46080
  v_and_b32 v141, 0xffff0000, v94
s_waitcnt lgkmcnt(8)
  v_mfma_f32_16x16x32_bf16 v[36:39], v[60:63], a[80:83], v[36:39]
  ds_read_b64_tr_b16 v[80:81], v11 offset:45056
  buffer_load_dwordx4 v6, s[12:15], s65 offen offset:2048 lds
  v_and_b32 v153, 0xffff0000, v110
  v_mfma_f32_16x16x32_bf16 v[40:43], v[60:63], a[84:87], v[40:43]
  ds_read_b64_tr_b16 v[82:83], v11 offset:46080
  v_mul_f32 v140, v140, v152
s_waitcnt lgkmcnt(8)
  v_mfma_f32_16x16x32_bf16 v[44:47], v[64:67], a[80:83], v[44:47]
  buffer_load_dwordx4 a[80:83], v2, s[8:11], s64 offen offset:2048
  v_mul_f32 v141, v141, v153
  v_mfma_f32_16x16x32_bf16 v[48:51], v[64:67], a[84:87], v[48:51]
  buffer_load_dwordx4 a[84:87], v3, s[8:11], s64 offen offset:2048
  v_mul_f32 v140, v140, v117
  s_waitcnt vmcnt(35)
  s_barrier
s_waitcnt lgkmcnt(6)
  v_mfma_f32_16x16x32_bf16 v[20:23], v[68:71], a[88:91], v[20:23]
  ds_read_b64_tr_b16 v[52:53], v8 offset:49152
  ds_read_b64_tr_b16 v[54:55], v8 offset:50176
  v_mul_f32 v141, v141, v117
  v_mfma_f32_16x16x32_bf16 v[24:27], v[68:71], a[92:95], v[24:27]
  ds_read_b64_tr_b16 v[56:57], v9 offset:49152
  v_lshlrev_b32 v142, 16, v95
s_waitcnt lgkmcnt(7)
  v_mfma_f32_16x16x32_bf16 v[28:31], v[72:75], a[88:91], v[28:31]
  ds_read_b64_tr_b16 v[58:59], v9 offset:50176
  v_lshlrev_b32 v152, 16, v111
  v_mfma_f32_16x16x32_bf16 v[32:35], v[72:75], a[92:95], v[32:35]
  ds_read_b64_tr_b16 v[60:61], v10 offset:49152
  ds_read_b64_tr_b16 v[62:63], v10 offset:50176
  v_and_b32 v143, 0xffff0000, v95
s_waitcnt lgkmcnt(8)
  v_mfma_f32_16x16x32_bf16 v[36:39], v[76:79], a[88:91], v[36:39]
  ds_read_b64_tr_b16 v[64:65], v11 offset:49152
  buffer_load_dwordx4 v7, s[12:15], s65 offen offset:3072 lds
  v_and_b32 v153, 0xffff0000, v111
  v_mfma_f32_16x16x32_bf16 v[40:43], v[76:79], a[92:95], v[40:43]
  ds_read_b64_tr_b16 v[66:67], v11 offset:50176
  v_mul_f32 v142, v142, v152
s_waitcnt lgkmcnt(8)
  v_mfma_f32_16x16x32_bf16 v[44:47], v[80:83], a[88:91], v[44:47]
  buffer_load_dwordx4 a[88:91], v2, s[8:11], s64 offen offset:3072
  v_mul_f32 v143, v143, v153
  v_mfma_f32_16x16x32_bf16 v[48:51], v[80:83], a[92:95], v[48:51]
  buffer_load_dwordx4 a[92:95], v3, s[8:11], s64 offen offset:3072
  s_add_u32 s64, s64, 4096
  s_add_u32 s65, s65, 262144
  v_mul_f32 v142, v142, v117
s_waitcnt lgkmcnt(6)
  v_mfma_f32_16x16x32_bf16 v[20:23], v[52:55], a[96:99], v[20:23]
  ds_read_b64_tr_b16 v[68:69], v8 offset:53248
  ds_read_b64_tr_b16 v[70:71], v8 offset:54272
  v_mul_f32 v143, v143, v117
  v_mfma_f32_16x16x32_bf16 v[24:27], v[52:55], a[100:103], v[24:27]
  ds_read_b64_tr_b16 v[72:73], v9 offset:53248
  v_lshlrev_b32 v144, 16, v96
s_waitcnt lgkmcnt(7)
  v_mfma_f32_16x16x32_bf16 v[28:31], v[56:59], a[96:99], v[28:31]
  ds_read_b64_tr_b16 v[74:75], v9 offset:54272
  s_add_u32 m0, s66, 114688
  v_lshlrev_b32 v152, 16, v112
  v_mfma_f32_16x16x32_bf16 v[32:35], v[56:59], a[100:103], v[32:35]
  ds_read_b64_tr_b16 v[76:77], v10 offset:53248
  ds_read_b64_tr_b16 v[78:79], v10 offset:54272
  v_and_b32 v145, 0xffff0000, v96
s_waitcnt lgkmcnt(8)
  v_mfma_f32_16x16x32_bf16 v[36:39], v[60:63], a[96:99], v[36:39]
  ds_read_b64_tr_b16 v[80:81], v11 offset:53248
  buffer_load_dwordx4 v4, s[12:15], s65 offen offset:0 lds
  v_and_b32 v153, 0xffff0000, v112
  v_mfma_f32_16x16x32_bf16 v[40:43], v[60:63], a[100:103], v[40:43]
  ds_read_b64_tr_b16 v[82:83], v11 offset:54272
  v_mul_f32 v144, v144, v152
s_waitcnt lgkmcnt(8)
  v_mfma_f32_16x16x32_bf16 v[44:47], v[64:67], a[96:99], v[44:47]
  buffer_load_dwordx4 a[96:99], v2, s[8:11], s64 offen offset:0
  v_mul_f32 v145, v145, v153
  v_mfma_f32_16x16x32_bf16 v[48:51], v[64:67], a[100:103], v[48:51]
  buffer_load_dwordx4 a[100:103], v3, s[8:11], s64 offen offset:0
  v_mul_f32 v144, v144, v117
s_waitcnt lgkmcnt(6)
  v_mfma_f32_16x16x32_bf16 v[20:23], v[68:71], a[104:107], v[20:23]
  ds_read_b64_tr_b16 v[52:53], v8 offset:57344
  ds_read_b64_tr_b16 v[54:55], v8 offset:58368
  v_mul_f32 v145, v145, v117
  v_mfma_f32_16x16x32_bf16 v[24:27], v[68:71], a[108:111], v[24:27]
  ds_read_b64_tr_b16 v[56:57], v9 offset:57344
  v_lshlrev_b32 v146, 16, v97
s_waitcnt lgkmcnt(7)
  v_mfma_f32_16x16x32_bf16 v[28:31], v[72:75], a[104:107], v[28:31]
  ds_read_b64_tr_b16 v[58:59], v9 offset:58368
  v_lshlrev_b32 v152, 16, v113
  v_mfma_f32_16x16x32_bf16 v[32:35], v[72:75], a[108:111], v[32:35]
  ds_read_b64_tr_b16 v[60:61], v10 offset:57344
  ds_read_b64_tr_b16 v[62:63], v10 offset:58368
  v_and_b32 v147, 0xffff0000, v97
s_waitcnt lgkmcnt(8)
  v_mfma_f32_16x16x32_bf16 v[36:39], v[76:79], a[104:107], v[36:39]
  ds_read_b64_tr_b16 v[64:65], v11 offset:57344
  buffer_load_dwordx4 v5, s[12:15], s65 offen offset:1024 lds
  v_and_b32 v153, 0xffff0000, v113
  v_mfma_f32_16x16x32_bf16 v[40:43], v[76:79], a[108:111], v[40:43]
  ds_read_b64_tr_b16 v[66:67], v11 offset:58368
  v_mul_f32 v146, v146, v152
s_waitcnt lgkmcnt(8)
  v_mfma_f32_16x16x32_bf16 v[44:47], v[80:83], a[104:107], v[44:47]
  buffer_load_dwordx4 a[104:107], v2, s[8:11], s64 offen offset:1024
  v_mul_f32 v147, v147, v153
  v_mfma_f32_16x16x32_bf16 v[48:51], v[80:83], a[108:111], v[48:51]
  buffer_load_dwordx4 a[108:111], v3, s[8:11], s64 offen offset:1024
  v_mul_f32 v146, v146, v117
s_waitcnt lgkmcnt(6)
  v_mfma_f32_16x16x32_bf16 v[20:23], v[52:55], a[112:115], v[20:23]
  ds_read_b64_tr_b16 v[68:69], v8 offset:61440
  ds_read_b64_tr_b16 v[70:71], v8 offset:62464
  v_mul_f32 v147, v147, v117
  v_mfma_f32_16x16x32_bf16 v[24:27], v[52:55], a[116:119], v[24:27]
  ds_read_b64_tr_b16 v[72:73], v9 offset:61440
  v_lshlrev_b32 v148, 16, v98
s_waitcnt lgkmcnt(7)
  v_mfma_f32_16x16x32_bf16 v[28:31], v[56:59], a[112:115], v[28:31]
  ds_read_b64_tr_b16 v[74:75], v9 offset:62464
  v_lshlrev_b32 v152, 16, v114
  v_mfma_f32_16x16x32_bf16 v[32:35], v[56:59], a[116:119], v[32:35]
  ds_read_b64_tr_b16 v[76:77], v10 offset:61440
  ds_read_b64_tr_b16 v[78:79], v10 offset:62464
  v_and_b32 v149, 0xffff0000, v98
s_waitcnt lgkmcnt(8)
  v_mfma_f32_16x16x32_bf16 v[36:39], v[60:63], a[112:115], v[36:39]
  ds_read_b64_tr_b16 v[80:81], v11 offset:61440
  buffer_load_dwordx4 v6, s[12:15], s65 offen offset:2048 lds
  v_and_b32 v153, 0xffff0000, v114
  v_mfma_f32_16x16x32_bf16 v[40:43], v[60:63], a[116:119], v[40:43]
  ds_read_b64_tr_b16 v[82:83], v11 offset:62464
  v_mul_f32 v148, v148, v152
s_waitcnt lgkmcnt(8)
  v_mfma_f32_16x16x32_bf16 v[44:47], v[64:67], a[112:115], v[44:47]
  buffer_load_dwordx4 a[112:115], v2, s[8:11], s64 offen offset:2048
  v_mul_f32 v149, v149, v153
  v_mfma_f32_16x16x32_bf16 v[48:51], v[64:67], a[116:119], v[48:51]
  buffer_load_dwordx4 a[116:119], v3, s[8:11], s64 offen offset:2048
  v_mul_f32 v148, v148, v117
  s_waitcnt vmcnt(35)
  s_barrier
s_waitcnt lgkmcnt(6)
  v_mfma_f32_16x16x32_bf16 v[20:23], v[68:71], a[120:123], v[20:23]
  ds_read_b64_tr_b16 v[52:53], v12 offset:0
  ds_read_b64_tr_b16 v[54:55], v12 offset:1024
  v_mul_f32 v149, v149, v117
  v_lshlrev_b32 v150, 16, v99
  v_mfma_f32_16x16x32_bf16 v[24:27], v[68:71], a[124:127], v[24:27]
  ds_read_b64_tr_b16 v[56:57], v13 offset:0
  v_lshlrev_b32 v152, 16, v115
s_waitcnt lgkmcnt(7)
  v_mfma_f32_16x16x32_bf16 v[28:31], v[72:75], a[120:123], v[28:31]
  ds_read_b64_tr_b16 v[58:59], v13 offset:1024
  v_and_b32 v151, 0xffff0000, v99
  v_mfma_f32_16x16x32_bf16 v[32:35], v[72:75], a[124:127], v[32:35]
  ds_read_b64_tr_b16 v[60:61], v14 offset:0
  ds_read_b64_tr_b16 v[62:63], v14 offset:1024
  v_and_b32 v153, 0xffff0000, v115
s_waitcnt lgkmcnt(8)
  v_mfma_f32_16x16x32_bf16 v[36:39], v[76:79], a[120:123], v[36:39]
  ds_read_b64_tr_b16 v[64:65], v15 offset:0
  buffer_load_dwordx4 v7, s[12:15], s65 offen offset:3072 lds
  v_mul_f32 v150, v150, v152
  v_mfma_f32_16x16x32_bf16 v[40:43], v[76:79], a[124:127], v[40:43]
  ds_read_b64_tr_b16 v[66:67], v15 offset:1024
  v_mul_f32 v151, v151, v153
s_waitcnt lgkmcnt(8)
  v_mfma_f32_16x16x32_bf16 v[44:47], v[80:83], a[120:123], v[44:47]
  buffer_load_dwordx4 a[120:123], v2, s[8:11], s64 offen offset:3072
  v_mul_f32 v150, v150, v117
  v_mfma_f32_16x16x32_bf16 v[48:51], v[80:83], a[124:127], v[48:51]
  buffer_load_dwordx4 a[124:127], v3, s[8:11], s64 offen offset:3072
  s_add_u32 s64, s64, 4096
  s_add_u32 s65, s65, 262144
  v_mul_f32 v151, v151, v117
s_waitcnt lgkmcnt(6)
  v_mfma_f32_16x16x32_bf16 v[20:23], v[52:55], a[0:3], v[20:23]
  ds_read_b64_tr_b16 v[68:69], v12 offset:4096
  ds_read_b64_tr_b16 v[70:71], v12 offset:5120
  v_mfma_f32_16x16x32_bf16 v[24:27], v[52:55], a[4:7], v[24:27]
  ds_read_b64_tr_b16 v[72:73], v13 offset:4096
s_waitcnt lgkmcnt(7)
  v_mfma_f32_16x16x32_bf16 v[28:31], v[56:59], a[0:3], v[28:31]
  ds_read_b64_tr_b16 v[74:75], v13 offset:5120
  v_mfma_f32_16x16x32_bf16 v[32:35], v[56:59], a[4:7], v[32:35]
  ds_read_b64_tr_b16 v[76:77], v14 offset:4096
  ds_read_b64_tr_b16 v[78:79], v14 offset:5120
s_waitcnt lgkmcnt(8)
  v_mfma_f32_16x16x32_bf16 v[36:39], v[60:63], a[0:3], v[36:39]
  ds_read_b64_tr_b16 v[80:81], v15 offset:4096
  v_mfma_f32_16x16x32_bf16 v[40:43], v[60:63], a[4:7], v[40:43]
  ds_read_b64_tr_b16 v[82:83], v15 offset:5120
s_waitcnt lgkmcnt(8)
  v_mfma_f32_16x16x32_bf16 v[44:47], v[64:67], a[0:3], v[44:47]
  v_mfma_f32_16x16x32_bf16 v[48:51], v[64:67], a[4:7], v[48:51]
s_waitcnt lgkmcnt(6)
  v_mfma_f32_16x16x32_bf16 v[20:23], v[68:71], a[8:11], v[20:23]
  ds_read_b64_tr_b16 v[52:53], v12 offset:8192
  ds_read_b64_tr_b16 v[54:55], v12 offset:9216
  v_mfma_f32_16x16x32_bf16 v[24:27], v[68:71], a[12:15], v[24:27]
  ds_read_b64_tr_b16 v[56:57], v13 offset:8192
s_waitcnt lgkmcnt(7)
  v_mfma_f32_16x16x32_bf16 v[28:31], v[72:75], a[8:11], v[28:31]
  ds_read_b64_tr_b16 v[58:59], v13 offset:9216
  v_mfma_f32_16x16x32_bf16 v[32:35], v[72:75], a[12:15], v[32:35]
  ds_read_b64_tr_b16 v[60:61], v14 offset:8192
  ds_read_b64_tr_b16 v[62:63], v14 offset:9216
s_waitcnt lgkmcnt(8)
  v_mfma_f32_16x16x32_bf16 v[36:39], v[76:79], a[8:11], v[36:39]
  ds_read_b64_tr_b16 v[64:65], v15 offset:8192
  v_mfma_f32_16x16x32_bf16 v[40:43], v[76:79], a[12:15], v[40:43]
  ds_read_b64_tr_b16 v[66:67], v15 offset:9216
s_waitcnt lgkmcnt(8)
  v_mfma_f32_16x16x32_bf16 v[44:47], v[80:83], a[8:11], v[44:47]
  v_mfma_f32_16x16x32_bf16 v[48:51], v[80:83], a[12:15], v[48:51]
s_waitcnt lgkmcnt(6)
  v_mfma_f32_16x16x32_bf16 v[20:23], v[52:55], a[16:19], v[20:23]
  ds_read_b64_tr_b16 v[68:69], v12 offset:12288
  ds_read_b64_tr_b16 v[70:71], v12 offset:13312
  v_mfma_f32_16x16x32_bf16 v[24:27], v[52:55], a[20:23], v[24:27]
  ds_read_b64_tr_b16 v[72:73], v13 offset:12288
s_waitcnt lgkmcnt(7)
  v_mfma_f32_16x16x32_bf16 v[28:31], v[56:59], a[16:19], v[28:31]
  ds_read_b64_tr_b16 v[74:75], v13 offset:13312
  v_mfma_f32_16x16x32_bf16 v[32:35], v[56:59], a[20:23], v[32:35]
  ds_read_b64_tr_b16 v[76:77], v14 offset:12288
  ds_read_b64_tr_b16 v[78:79], v14 offset:13312
s_waitcnt lgkmcnt(8)
  v_mfma_f32_16x16x32_bf16 v[36:39], v[60:63], a[16:19], v[36:39]
  ds_read_b64_tr_b16 v[80:81], v15 offset:12288
  v_mfma_f32_16x16x32_bf16 v[40:43], v[60:63], a[20:23], v[40:43]
  ds_read_b64_tr_b16 v[82:83], v15 offset:13312
s_waitcnt lgkmcnt(8)
  v_mfma_f32_16x16x32_bf16 v[44:47], v[64:67], a[16:19], v[44:47]
  v_mfma_f32_16x16x32_bf16 v[48:51], v[64:67], a[20:23], v[48:51]
  s_waitcnt vmcnt(26)
  s_barrier
s_waitcnt lgkmcnt(6)
  v_mfma_f32_16x16x32_bf16 v[20:23], v[68:71], a[24:27], v[20:23]
  ds_read_b64_tr_b16 v[52:53], v12 offset:16384
  ds_read_b64_tr_b16 v[54:55], v12 offset:17408
  v_mfma_f32_16x16x32_bf16 v[24:27], v[68:71], a[28:31], v[24:27]
  ds_read_b64_tr_b16 v[56:57], v13 offset:16384
s_waitcnt lgkmcnt(7)
  v_mfma_f32_16x16x32_bf16 v[28:31], v[72:75], a[24:27], v[28:31]
  ds_read_b64_tr_b16 v[58:59], v13 offset:17408
  v_mfma_f32_16x16x32_bf16 v[32:35], v[72:75], a[28:31], v[32:35]
  ds_read_b64_tr_b16 v[60:61], v14 offset:16384
  ds_read_b64_tr_b16 v[62:63], v14 offset:17408
s_waitcnt lgkmcnt(8)
  v_mfma_f32_16x16x32_bf16 v[36:39], v[76:79], a[24:27], v[36:39]
  ds_read_b64_tr_b16 v[64:65], v15 offset:16384
  v_mfma_f32_16x16x32_bf16 v[40:43], v[76:79], a[28:31], v[40:43]
  ds_read_b64_tr_b16 v[66:67], v15 offset:17408
s_waitcnt lgkmcnt(8)
  v_mfma_f32_16x16x32_bf16 v[44:47], v[80:83], a[24:27], v[44:47]
  v_mfma_f32_16x16x32_bf16 v[48:51], v[80:83], a[28:31], v[48:51]
s_waitcnt lgkmcnt(6)
  v_mfma_f32_16x16x32_bf16 v[20:23], v[52:55], a[32:35], v[20:23]
  ds_read_b64_tr_b16 v[68:69], v12 offset:20480
  ds_read_b64_tr_b16 v[70:71], v12 offset:21504
  v_mfma_f32_16x16x32_bf16 v[24:27], v[52:55], a[36:39], v[24:27]
  ds_read_b64_tr_b16 v[72:73], v13 offset:20480
s_waitcnt lgkmcnt(7)
  v_mfma_f32_16x16x32_bf16 v[28:31], v[56:59], a[32:35], v[28:31]
  ds_read_b64_tr_b16 v[74:75], v13 offset:21504
  v_mfma_f32_16x16x32_bf16 v[32:35], v[56:59], a[36:39], v[32:35]
  ds_read_b64_tr_b16 v[76:77], v14 offset:20480
  ds_read_b64_tr_b16 v[78:79], v14 offset:21504
s_waitcnt lgkmcnt(8)
  v_mfma_f32_16x16x32_bf16 v[36:39], v[60:63], a[32:35], v[36:39]
  ds_read_b64_tr_b16 v[80:81], v15 offset:20480
  v_mfma_f32_16x16x32_bf16 v[40:43], v[60:63], a[36:39], v[40:43]
  ds_read_b64_tr_b16 v[82:83], v15 offset:21504
s_waitcnt lgkmcnt(8)
  v_mfma_f32_16x16x32_bf16 v[44:47], v[64:67], a[32:35], v[44:47]
  v_mfma_f32_16x16x32_bf16 v[48:51], v[64:67], a[36:39], v[48:51]
s_waitcnt lgkmcnt(6)
  v_mfma_f32_16x16x32_bf16 v[20:23], v[68:71], a[40:43], v[20:23]
  ds_read_b64_tr_b16 v[52:53], v12 offset:24576
  ds_read_b64_tr_b16 v[54:55], v12 offset:25600
  v_mfma_f32_16x16x32_bf16 v[24:27], v[68:71], a[44:47], v[24:27]
  ds_read_b64_tr_b16 v[56:57], v13 offset:24576
s_waitcnt lgkmcnt(7)
  v_mfma_f32_16x16x32_bf16 v[28:31], v[72:75], a[40:43], v[28:31]
  ds_read_b64_tr_b16 v[58:59], v13 offset:25600
  v_mfma_f32_16x16x32_bf16 v[32:35], v[72:75], a[44:47], v[32:35]
  ds_read_b64_tr_b16 v[60:61], v14 offset:24576
  ds_read_b64_tr_b16 v[62:63], v14 offset:25600
s_waitcnt lgkmcnt(8)
  v_mfma_f32_16x16x32_bf16 v[36:39], v[76:79], a[40:43], v[36:39]
  ds_read_b64_tr_b16 v[64:65], v15 offset:24576
  v_mfma_f32_16x16x32_bf16 v[40:43], v[76:79], a[44:47], v[40:43]
  ds_read_b64_tr_b16 v[66:67], v15 offset:25600
s_waitcnt lgkmcnt(8)
  v_mfma_f32_16x16x32_bf16 v[44:47], v[80:83], a[40:43], v[44:47]
  v_mfma_f32_16x16x32_bf16 v[48:51], v[80:83], a[44:47], v[48:51]
s_waitcnt lgkmcnt(6)
  v_mfma_f32_16x16x32_bf16 v[20:23], v[52:55], a[48:51], v[20:23]
  ds_read_b64_tr_b16 v[68:69], v12 offset:28672
  ds_read_b64_tr_b16 v[70:71], v12 offset:29696
  v_mfma_f32_16x16x32_bf16 v[24:27], v[52:55], a[52:55], v[24:27]
  ds_read_b64_tr_b16 v[72:73], v13 offset:28672
s_waitcnt lgkmcnt(7)
  v_mfma_f32_16x16x32_bf16 v[28:31], v[56:59], a[48:51], v[28:31]
  ds_read_b64_tr_b16 v[74:75], v13 offset:29696
  v_mfma_f32_16x16x32_bf16 v[32:35], v[56:59], a[52:55], v[32:35]
  ds_read_b64_tr_b16 v[76:77], v14 offset:28672
  ds_read_b64_tr_b16 v[78:79], v14 offset:29696
s_waitcnt lgkmcnt(8)
  v_mfma_f32_16x16x32_bf16 v[36:39], v[60:63], a[48:51], v[36:39]
  ds_read_b64_tr_b16 v[80:81], v15 offset:28672
  v_mfma_f32_16x16x32_bf16 v[40:43], v[60:63], a[52:55], v[40:43]
  ds_read_b64_tr_b16 v[82:83], v15 offset:29696
s_waitcnt lgkmcnt(8)
  v_mfma_f32_16x16x32_bf16 v[44:47], v[64:67], a[48:51], v[44:47]
  v_mfma_f32_16x16x32_bf16 v[48:51], v[64:67], a[52:55], v[48:51]
  s_waitcnt vmcnt(14)
  s_barrier
s_waitcnt lgkmcnt(6)
  v_mfma_f32_16x16x32_bf16 v[20:23], v[68:71], a[56:59], v[20:23]
  ds_read_b64_tr_b16 v[52:53], v12 offset:32768
  ds_read_b64_tr_b16 v[54:55], v12 offset:33792
  v_mfma_f32_16x16x32_bf16 v[24:27], v[68:71], a[60:63], v[24:27]
  ds_read_b64_tr_b16 v[56:57], v13 offset:32768
s_waitcnt lgkmcnt(7)
  v_mfma_f32_16x16x32_bf16 v[28:31], v[72:75], a[56:59], v[28:31]
  ds_read_b64_tr_b16 v[58:59], v13 offset:33792
  v_mfma_f32_16x16x32_bf16 v[32:35], v[72:75], a[60:63], v[32:35]
  ds_read_b64_tr_b16 v[60:61], v14 offset:32768
  ds_read_b64_tr_b16 v[62:63], v14 offset:33792
s_waitcnt lgkmcnt(8)
  v_mfma_f32_16x16x32_bf16 v[36:39], v[76:79], a[56:59], v[36:39]
  ds_read_b64_tr_b16 v[64:65], v15 offset:32768
  v_mfma_f32_16x16x32_bf16 v[40:43], v[76:79], a[60:63], v[40:43]
  ds_read_b64_tr_b16 v[66:67], v15 offset:33792
s_waitcnt lgkmcnt(8)
  v_mfma_f32_16x16x32_bf16 v[44:47], v[80:83], a[56:59], v[44:47]
  v_mfma_f32_16x16x32_bf16 v[48:51], v[80:83], a[60:63], v[48:51]
s_waitcnt lgkmcnt(6)
  v_mfma_f32_16x16x32_bf16 v[20:23], v[52:55], a[64:67], v[20:23]
  ds_read_b64_tr_b16 v[68:69], v12 offset:36864
  ds_read_b64_tr_b16 v[70:71], v12 offset:37888
  v_mfma_f32_16x16x32_bf16 v[24:27], v[52:55], a[68:71], v[24:27]
  ds_read_b64_tr_b16 v[72:73], v13 offset:36864
s_waitcnt lgkmcnt(7)
  v_mfma_f32_16x16x32_bf16 v[28:31], v[56:59], a[64:67], v[28:31]
  ds_read_b64_tr_b16 v[74:75], v13 offset:37888
  v_mfma_f32_16x16x32_bf16 v[32:35], v[56:59], a[68:71], v[32:35]
  ds_read_b64_tr_b16 v[76:77], v14 offset:36864
  ds_read_b64_tr_b16 v[78:79], v14 offset:37888
s_waitcnt lgkmcnt(8)
  v_mfma_f32_16x16x32_bf16 v[36:39], v[60:63], a[64:67], v[36:39]
  ds_read_b64_tr_b16 v[80:81], v15 offset:36864
  v_mfma_f32_16x16x32_bf16 v[40:43], v[60:63], a[68:71], v[40:43]
  ds_read_b64_tr_b16 v[82:83], v15 offset:37888
s_waitcnt lgkmcnt(8)
  v_mfma_f32_16x16x32_bf16 v[44:47], v[64:67], a[64:67], v[44:47]
  v_mfma_f32_16x16x32_bf16 v[48:51], v[64:67], a[68:71], v[48:51]
s_waitcnt lgkmcnt(6)
  v_mfma_f32_16x16x32_bf16 v[20:23], v[68:71], a[72:75], v[20:23]
  ds_read_b64_tr_b16 v[52:53], v12 offset:40960
  ds_read_b64_tr_b16 v[54:55], v12 offset:41984
  v_mfma_f32_16x16x32_bf16 v[24:27], v[68:71], a[76:79], v[24:27]
  ds_read_b64_tr_b16 v[56:57], v13 offset:40960
s_waitcnt lgkmcnt(7)
  v_mfma_f32_16x16x32_bf16 v[28:31], v[72:75], a[72:75], v[28:31]
  ds_read_b64_tr_b16 v[58:59], v13 offset:41984
  v_mfma_f32_16x16x32_bf16 v[32:35], v[72:75], a[76:79], v[32:35]
  ds_read_b64_tr_b16 v[60:61], v14 offset:40960
  ds_read_b64_tr_b16 v[62:63], v14 offset:41984
s_waitcnt lgkmcnt(8)
  v_mfma_f32_16x16x32_bf16 v[36:39], v[76:79], a[72:75], v[36:39]
  ds_read_b64_tr_b16 v[64:65], v15 offset:40960
  v_mfma_f32_16x16x32_bf16 v[40:43], v[76:79], a[76:79], v[40:43]
  ds_read_b64_tr_b16 v[66:67], v15 offset:41984
s_waitcnt lgkmcnt(8)
  v_mfma_f32_16x16x32_bf16 v[44:47], v[80:83], a[72:75], v[44:47]
  v_mfma_f32_16x16x32_bf16 v[48:51], v[80:83], a[76:79], v[48:51]
s_waitcnt lgkmcnt(6)
  v_mfma_f32_16x16x32_bf16 v[20:23], v[52:55], a[80:83], v[20:23]
  ds_read_b64_tr_b16 v[68:69], v12 offset:45056
  ds_read_b64_tr_b16 v[70:71], v12 offset:46080
  v_mfma_f32_16x16x32_bf16 v[24:27], v[52:55], a[84:87], v[24:27]
  ds_read_b64_tr_b16 v[72:73], v13 offset:45056
s_waitcnt lgkmcnt(7)
  v_mfma_f32_16x16x32_bf16 v[28:31], v[56:59], a[80:83], v[28:31]
  ds_read_b64_tr_b16 v[74:75], v13 offset:46080
  v_mfma_f32_16x16x32_bf16 v[32:35], v[56:59], a[84:87], v[32:35]
  ds_read_b64_tr_b16 v[76:77], v14 offset:45056
  ds_read_b64_tr_b16 v[78:79], v14 offset:46080
s_waitcnt lgkmcnt(8)
  v_mfma_f32_16x16x32_bf16 v[36:39], v[60:63], a[80:83], v[36:39]
  ds_read_b64_tr_b16 v[80:81], v15 offset:45056
  v_mfma_f32_16x16x32_bf16 v[40:43], v[60:63], a[84:87], v[40:43]
  ds_read_b64_tr_b16 v[82:83], v15 offset:46080
s_waitcnt lgkmcnt(8)
  v_mfma_f32_16x16x32_bf16 v[44:47], v[64:67], a[80:83], v[44:47]
  v_mfma_f32_16x16x32_bf16 v[48:51], v[64:67], a[84:87], v[48:51]
  s_waitcnt vmcnt(2)
  s_barrier
s_waitcnt lgkmcnt(6)
  v_mfma_f32_16x16x32_bf16 v[20:23], v[68:71], a[88:91], v[20:23]
  ds_read_b64_tr_b16 v[52:53], v12 offset:49152
  ds_read_b64_tr_b16 v[54:55], v12 offset:50176
  v_mfma_f32_16x16x32_bf16 v[24:27], v[68:71], a[92:95], v[24:27]
  ds_read_b64_tr_b16 v[56:57], v13 offset:49152
s_waitcnt lgkmcnt(7)
  v_mfma_f32_16x16x32_bf16 v[28:31], v[72:75], a[88:91], v[28:31]
  ds_read_b64_tr_b16 v[58:59], v13 offset:50176
  v_mfma_f32_16x16x32_bf16 v[32:35], v[72:75], a[92:95], v[32:35]
  ds_read_b64_tr_b16 v[60:61], v14 offset:49152
  ds_read_b64_tr_b16 v[62:63], v14 offset:50176
s_waitcnt lgkmcnt(8)
  v_mfma_f32_16x16x32_bf16 v[36:39], v[76:79], a[88:91], v[36:39]
  ds_read_b64_tr_b16 v[64:65], v15 offset:49152
  v_mfma_f32_16x16x32_bf16 v[40:43], v[76:79], a[92:95], v[40:43]
  ds_read_b64_tr_b16 v[66:67], v15 offset:50176
s_waitcnt lgkmcnt(8)
  v_mfma_f32_16x16x32_bf16 v[44:47], v[80:83], a[88:91], v[44:47]
  v_mfma_f32_16x16x32_bf16 v[48:51], v[80:83], a[92:95], v[48:51]
s_waitcnt lgkmcnt(6)
  v_mfma_f32_16x16x32_bf16 v[20:23], v[52:55], a[96:99], v[20:23]
  ds_read_b64_tr_b16 v[68:69], v12 offset:53248
  ds_read_b64_tr_b16 v[70:71], v12 offset:54272
  v_mfma_f32_16x16x32_bf16 v[24:27], v[52:55], a[100:103], v[24:27]
  ds_read_b64_tr_b16 v[72:73], v13 offset:53248
s_waitcnt lgkmcnt(7)
  v_mfma_f32_16x16x32_bf16 v[28:31], v[56:59], a[96:99], v[28:31]
  ds_read_b64_tr_b16 v[74:75], v13 offset:54272
  v_mfma_f32_16x16x32_bf16 v[32:35], v[56:59], a[100:103], v[32:35]
  ds_read_b64_tr_b16 v[76:77], v14 offset:53248
  ds_read_b64_tr_b16 v[78:79], v14 offset:54272
s_waitcnt lgkmcnt(8)
  v_mfma_f32_16x16x32_bf16 v[36:39], v[60:63], a[96:99], v[36:39]
  ds_read_b64_tr_b16 v[80:81], v15 offset:53248
  v_mfma_f32_16x16x32_bf16 v[40:43], v[60:63], a[100:103], v[40:43]
  ds_read_b64_tr_b16 v[82:83], v15 offset:54272
s_waitcnt lgkmcnt(8)
  v_mfma_f32_16x16x32_bf16 v[44:47], v[64:67], a[96:99], v[44:47]
  v_mfma_f32_16x16x32_bf16 v[48:51], v[64:67], a[100:103], v[48:51]
s_waitcnt lgkmcnt(6)
  v_mfma_f32_16x16x32_bf16 v[20:23], v[68:71], a[104:107], v[20:23]
  ds_read_b64_tr_b16 v[52:53], v12 offset:57344
  ds_read_b64_tr_b16 v[54:55], v12 offset:58368
  v_mfma_f32_16x16x32_bf16 v[24:27], v[68:71], a[108:111], v[24:27]
  ds_read_b64_tr_b16 v[56:57], v13 offset:57344
s_waitcnt lgkmcnt(7)
  v_mfma_f32_16x16x32_bf16 v[28:31], v[72:75], a[104:107], v[28:31]
  ds_read_b64_tr_b16 v[58:59], v13 offset:58368
  v_mfma_f32_16x16x32_bf16 v[32:35], v[72:75], a[108:111], v[32:35]
  ds_read_b64_tr_b16 v[60:61], v14 offset:57344
  ds_read_b64_tr_b16 v[62:63], v14 offset:58368
s_waitcnt lgkmcnt(8)
  v_mfma_f32_16x16x32_bf16 v[36:39], v[76:79], a[104:107], v[36:39]
  ds_read_b64_tr_b16 v[64:65], v15 offset:57344
  v_mfma_f32_16x16x32_bf16 v[40:43], v[76:79], a[108:111], v[40:43]
  ds_read_b64_tr_b16 v[66:67], v15 offset:58368
s_waitcnt lgkmcnt(8)
  v_mfma_f32_16x16x32_bf16 v[44:47], v[80:83], a[104:107], v[44:47]
  v_mfma_f32_16x16x32_bf16 v[48:51], v[80:83], a[108:111], v[48:51]
s_waitcnt lgkmcnt(6)
  v_mfma_f32_16x16x32_bf16 v[20:23], v[52:55], a[112:115], v[20:23]
  ds_read_b64_tr_b16 v[68:69], v12 offset:61440
  ds_read_b64_tr_b16 v[70:71], v12 offset:62464
  v_mfma_f32_16x16x32_bf16 v[24:27], v[52:55], a[116:119], v[24:27]
  ds_read_b64_tr_b16 v[72:73], v13 offset:61440
s_waitcnt lgkmcnt(7)
  v_mfma_f32_16x16x32_bf16 v[28:31], v[56:59], a[112:115], v[28:31]
  ds_read_b64_tr_b16 v[74:75], v13 offset:62464
  v_mfma_f32_16x16x32_bf16 v[32:35], v[56:59], a[116:119], v[32:35]
  ds_read_b64_tr_b16 v[76:77], v14 offset:61440
  ds_read_b64_tr_b16 v[78:79], v14 offset:62464
s_waitcnt lgkmcnt(8)
  v_mfma_f32_16x16x32_bf16 v[36:39], v[60:63], a[112:115], v[36:39]
  ds_read_b64_tr_b16 v[80:81], v15 offset:61440
  v_mfma_f32_16x16x32_bf16 v[40:43], v[60:63], a[116:119], v[40:43]
  ds_read_b64_tr_b16 v[82:83], v15 offset:62464
s_waitcnt lgkmcnt(8)
  v_mfma_f32_16x16x32_bf16 v[44:47], v[64:67], a[112:115], v[44:47]
  v_mfma_f32_16x16x32_bf16 v[48:51], v[64:67], a[116:119], v[48:51]
s_waitcnt vmcnt(1) lgkmcnt(6)
  v_mfma_f32_16x16x32_bf16 v[20:23], v[68:71], a[120:123], v[20:23]
s_waitcnt vmcnt(0)
  v_mfma_f32_16x16x32_bf16 v[24:27], v[68:71], a[124:127], v[24:27]
s_waitcnt lgkmcnt(4)
  v_mfma_f32_16x16x32_bf16 v[28:31], v[72:75], a[120:123], v[28:31]
  v_mfma_f32_16x16x32_bf16 v[32:35], v[72:75], a[124:127], v[32:35]
s_waitcnt lgkmcnt(2)
  v_mfma_f32_16x16x32_bf16 v[36:39], v[76:79], a[120:123], v[36:39]
  v_mfma_f32_16x16x32_bf16 v[40:43], v[76:79], a[124:127], v[40:43]
s_waitcnt lgkmcnt(0)
  v_mfma_f32_16x16x32_bf16 v[44:47], v[80:83], a[120:123], v[44:47]
  v_mfma_f32_16x16x32_bf16 v[48:51], v[80:83], a[124:127], v[48:51]
s_nop 0
  v_permlane16_swap_b32 v20, v28
  v_permlane16_swap_b32 v21, v29
  v_permlane16_swap_b32 v22, v30
  v_permlane16_swap_b32 v23, v31
s_nop 1
  v_permlane16_swap_b32 v36, v44
  v_permlane16_swap_b32 v37, v45
  v_permlane16_swap_b32 v38, v46
  v_permlane16_swap_b32 v39, v47
  v_permlane16_swap_b32 v24, v32
  v_permlane16_swap_b32 v25, v33
  v_permlane16_swap_b32 v26, v34
  v_permlane16_swap_b32 v27, v35
  v_permlane16_swap_b32 v40, v48
  v_permlane16_swap_b32 v41, v49
  v_permlane16_swap_b32 v42, v50
  v_permlane16_swap_b32 v43, v51
  s_add_u32 s68, s74, 0
  v_fma_f32 v120, v20, v118, v120
  v_fma_f32 v121, v21, v118, v121
  v_fma_f32 v122, v22, v118, v122
  v_fma_f32 v123, v23, v118, v123
  v_fma_f32 v124, v28, v118, v124
  v_fma_f32 v125, v29, v118, v125
  v_fma_f32 v126, v30, v118, v126
  v_fma_f32 v127, v31, v118, v127
  v_cvt_pk_bf16_f32 v84, v120, v121
  v_cvt_pk_bf16_f32 v85, v122, v123
  v_cvt_pk_bf16_f32 v86, v124, v125
  v_cvt_pk_bf16_f32 v87, v126, v127
  buffer_store_dwordx4 v[84:87], v16, s[24:27], s68 offen offset:0
  v_fma_f32 v128, v36, v118, v128
  v_fma_f32 v129, v37, v118, v129
  v_fma_f32 v130, v38, v118, v130
  v_fma_f32 v131, v39, v118, v131
  v_fma_f32 v132, v44, v118, v132
  v_fma_f32 v133, v45, v118, v133
  v_fma_f32 v134, v46, v118, v134
  v_fma_f32 v135, v47, v118, v135
  v_cvt_pk_bf16_f32 v88, v128, v129
  v_cvt_pk_bf16_f32 v89, v130, v131
  v_cvt_pk_bf16_f32 v90, v132, v133
  v_cvt_pk_bf16_f32 v91, v134, v135
  buffer_store_dwordx4 v[88:91], v16, s[24:27], s68 offen offset:64
  s_add_u32 s68, s74, 32768
  v_fma_f32 v136, v24, v119, v136
  v_fma_f32 v137, v25, v119, v137
  v_fma_f32 v138, v26, v119, v138
  v_fma_f32 v139, v27, v119, v139
  v_fma_f32 v140, v32, v119, v140
  v_fma_f32 v141, v33, v119, v141
  v_fma_f32 v142, v34, v119, v142
  v_fma_f32 v143, v35, v119, v143
  v_cvt_pk_bf16_f32 v92, v136, v137
  v_cvt_pk_bf16_f32 v93, v138, v139
  v_cvt_pk_bf16_f32 v94, v140, v141
  v_cvt_pk_bf16_f32 v95, v142, v143
  buffer_store_dwordx4 v[92:95], v16, s[24:27], s68 offen offset:0
  v_fma_f32 v144, v40, v119, v144
  v_fma_f32 v145, v41, v119, v145
  v_fma_f32 v146, v42, v119, v146
  v_fma_f32 v147, v43, v119, v147
  v_fma_f32 v148, v48, v119, v148
  v_fma_f32 v149, v49, v119, v149
  v_fma_f32 v150, v50, v119, v150
  v_fma_f32 v151, v51, v119, v151
  v_cvt_pk_bf16_f32 v96, v144, v145
  v_cvt_pk_bf16_f32 v97, v146, v147
  v_cvt_pk_bf16_f32 v98, v148, v149
  v_cvt_pk_bf16_f32 v99, v150, v151
  buffer_store_dwordx4 v[96:99], v16, s[24:27], s68 offen offset:64
L_kd_kernel_end:
  s_endpgm
.section .rodata,"a"
.p2align 6
.amdhsa_kernel kd_kernel
  .amdhsa_next_free_vgpr 512
  .amdhsa_next_free_sgpr 102
  .amdhsa_accum_offset 256
  .amdhsa_group_segment_fixed_size 0
  .amdhsa_kernarg_size 128
  .amdhsa_user_sgpr_count 2
  .amdhsa_user_sgpr_kernarg_segment_ptr 1
  .amdhsa_system_sgpr_workgroup_id_x 1
  .amdhsa_float_denorm_mode_32 3
.end_amdhsa_kernel
.text
```

```asm
; @launch grid=(256,1,1) block=(256,1,1) lds=163840
.amdgcn_target "amdgcn-amd-amdhsa--gfx950"
.text
.macro MA d,x,a,y,b
v_mfma_f32_16x16x32_bf16 a[\d:\d+3], \x[\a:\a+3], \y[\b:\b+3], a[\d:\d+3]
.endm
.macro MV d,x,a,y,b
v_mfma_f32_16x16x32_bf16 v[\d:\d+3], \x[\a:\a+3], \y[\b:\b+3], v[\d:\d+3]
.endm
.macro TR d,a,o
ds_read_b64_tr_b16 v[\d:\d+1], v\a offset:\o
.endm
.globl gated_mix__ssm_conv_h3__compressed_kv_cla__prompt_kernel
.p2align 8
.type gated_mix__ssm_conv_h3__compressed_kv_cla__prompt_kernel,@function
gated_mix__ssm_conv_h3__compressed_kv_cla__prompt_kernel:
s_cmp_ge_u32 s2, 256
s_cbranch_scc1 L_end
s_load_dwordx2 s[88:89], s[0:1], 56
s_load_dwordx4 s[92:95], s[0:1], 72
s_load_dwordx2 s[40:41], s[0:1], 120
s_load_dwordx8 s[76:83], s[0:1], 0
s_load_dwordx2 s[84:85], s[0:1], 96
s_load_dwordx2 s[90:91], s[0:1], 64
s_load_dwordx2 s[96:97], s[0:1], 112
v_lshrrev_b32 v2, 6, v0
v_and_b32 v1, 63, v0
v_lshlrev_b32 v3, 4, v0
v_readfirstlane_b32 s3, v2
s_and_b32 s36, s2, 7
s_lshr_b32 s37, s2, 3
s_and_b32 s38, s37, 7
s_lshr_b32 s37, s37, 3
s_lshr_b32 s42, s37, 1
s_and_b32 s37, s37, 1
s_lshl_b32 s36, s36, 1
s_add_u32 s36, s36, s37
s_lshl_b32 s20, s38, 18
s_lshl_b32 s39, s3, 16
s_add_u32 s20, s20, s39
s_lshl_b32 s21, s3, 17
s_lshl_b32 s39, s36, 9
s_add_u32 s21, s21, s39
s_lshl_b32 s22, s3, 13
s_add_u32 s23, s22, 98304
v_lshrrev_b32 v204, 3, v1
v_lshlrev_b32 v204, 10, v204
v_lshrrev_b32 v205, 4, v1
v_and_b32 v206, 7, v1
v_xor_b32 v206, v206, v205
v_lshl_add_u32 v204, v206, 4, v204
v_xor_b32 v207, 64, v204
v_add_u32 v176, 0, v204
v_add_u32 v177, 7168, v207
v_add_u32 v178, 14336, v204
v_add_u32 v179, 21504, v207
v_add_u32 v180, 32768, v204
v_add_u32 v181, 39936, v207
v_add_u32 v182, 47104, v204
v_add_u32 v183, 54272, v207
v_lshrrev_b32 v204, 5, v1
v_and_b32 v206, 31, v1
v_lshlrev_b32 v207, 1, v204
v_xor_b32 v206, v206, v207
v_lshlrev_b32 v204, 13, v204
v_xor_b32 v207, 0, v206
v_lshl_add_u32 v207, v207, 4, v204
v_add_u32 v184, 0, v207
v_xor_b32 v207, 4, v206
v_lshl_add_u32 v207, v207, 4, v204
v_add_u32 v185, 15360, v207
v_xor_b32 v207, 0, v206
v_lshl_add_u32 v207, v207, 4, v204
v_add_u32 v186, 30720, v207
v_xor_b32 v207, 4, v206
v_lshl_add_u32 v207, v207, 4, v204
v_add_u32 v187, 46080, v207
v_xor_b32 v207, 8, v206
v_lshl_add_u32 v207, v207, 4, v204
v_add_u32 v188, 65536, v207
v_xor_b32 v207, 12, v206
v_lshl_add_u32 v207, v207, 4, v204
v_add_u32 v189, 80896, v207
v_xor_b32 v207, 8, v206
v_lshl_add_u32 v207, v207, 4, v204
v_add_u32 v190, 96256, v207
v_xor_b32 v207, 12, v206
v_lshl_add_u32 v207, v207, 4, v204
v_add_u32 v191, 111616, v207
s_waitcnt lgkmcnt(0)
s_mov_b32 s8, s88
s_mov_b32 s9, s89
s_mov_b32 s10, 2097152
s_mov_b32 s11, 0x20000
s_cmp_eq_u32 s42, 0
s_cselect_b32 s12, s92, s94
s_cselect_b32 s13, s93, s95
s_mov_b32 s14, 4194304
s_mov_b32 s15, 0x20000
s_add_u32 s4, s40, 59768832
s_addc_u32 s5, s41, 0
s_mov_b32 s6, 4096
s_mov_b32 s7, 0x20000
s_lshl_b32 s43, s2, 20
v_add_u32 v3, s43, v3
v_mov_b32 v4, 0
v_mov_b32 v5, 0
v_mov_b32 v6, 0
v_mov_b32 v7, 0
buffer_store_dwordx4 v[4:7], v3, s[4:7], 0 offen sc1
s_add_u32 m0, s23, 0
s_nop 0
buffer_load_dwordx4 v184, s[12:15], s21 offen offset:0 lds
buffer_load_dwordx4 v185, s[12:15], s21 offen offset:1024 lds
buffer_load_dwordx4 v186, s[12:15], s21 offen offset:2048 lds
buffer_load_dwordx4 v187, s[12:15], s21 offen offset:3072 lds
s_add_u32 m0, s23, 4096
s_nop 0
buffer_load_dwordx4 v188, s[12:15], s21 offen offset:0 lds
buffer_load_dwordx4 v189, s[12:15], s21 offen offset:1024 lds
buffer_load_dwordx4 v190, s[12:15], s21 offen offset:2048 lds
buffer_load_dwordx4 v191, s[12:15], s21 offen offset:3072 lds
s_add_u32 s21, s21, 524288
s_add_u32 m0, s22, 0
s_nop 0
buffer_load_dwordx4 v176, s[8:11], s20 offen offset:0 lds
buffer_load_dwordx4 v177, s[8:11], s20 offen offset:1024 lds
buffer_load_dwordx4 v178, s[8:11], s20 offen offset:2048 lds
buffer_load_dwordx4 v179, s[8:11], s20 offen offset:3072 lds
s_add_u32 m0, s22, 4096
s_nop 0
buffer_load_dwordx4 v180, s[8:11], s20 offen offset:0 lds
buffer_load_dwordx4 v181, s[8:11], s20 offen offset:1024 lds
buffer_load_dwordx4 v182, s[8:11], s20 offen offset:2048 lds
buffer_load_dwordx4 v183, s[8:11], s20 offen offset:3072 lds
s_add_u32 s20, s20, 128
s_add_u32 m0, s23, 32768
s_nop 0
buffer_load_dwordx4 v184, s[12:15], s21 offen offset:0 lds
buffer_load_dwordx4 v185, s[12:15], s21 offen offset:1024 lds
buffer_load_dwordx4 v186, s[12:15], s21 offen offset:2048 lds
buffer_load_dwordx4 v187, s[12:15], s21 offen offset:3072 lds
s_add_u32 m0, s23, 36864
s_nop 0
buffer_load_dwordx4 v188, s[12:15], s21 offen offset:0 lds
buffer_load_dwordx4 v189, s[12:15], s21 offen offset:1024 lds
buffer_load_dwordx4 v190, s[12:15], s21 offen offset:2048 lds
buffer_load_dwordx4 v191, s[12:15], s21 offen offset:3072 lds
s_add_u32 s21, s21, 524288
s_add_u32 m0, s22, 32768
s_nop 0
buffer_load_dwordx4 v176, s[8:11], s20 offen offset:0 lds
buffer_load_dwordx4 v177, s[8:11], s20 offen offset:1024 lds
buffer_load_dwordx4 v178, s[8:11], s20 offen offset:2048 lds
buffer_load_dwordx4 v179, s[8:11], s20 offen offset:3072 lds
s_add_u32 m0, s22, 36864
s_nop 0
buffer_load_dwordx4 v180, s[8:11], s20 offen offset:0 lds
buffer_load_dwordx4 v181, s[8:11], s20 offen offset:1024 lds
buffer_load_dwordx4 v182, s[8:11], s20 offen offset:2048 lds
buffer_load_dwordx4 v183, s[8:11], s20 offen offset:3072 lds
s_add_u32 s20, s20, 128
s_lshl_b32 s43, s2, 2
s_add_u32 s43, s43, s3
v_lshlrev_b32 v8, 7, v1
s_bitcmp1_b32 s43, 0
s_cselect_b32 s4, s94, s92
s_cselect_b32 s5, s95, s93
s_mov_b32 s6, 4194304
s_lshr_b32 s98, s43, 1
s_lshl_b32 s98, s98, 13
buffer_load_dword v15, v8, s[4:7], s98 offen
v_lshrrev_b32 v9, 4, v1
v_lshl_add_u32 v9, v9, 24, v8
s_lshl_b32 s98, s43, 11
buffer_load_dword v15, v9, s[8:11], s98 offen
s_getpc_b64 s[4:5]
L_pc:
s_lshr_b32 s98, s2, 3
s_lshl_b32 s98, s98, 2
s_add_u32 s98, s98, s3
s_lshl_b32 s98, s98, 10
v_and_b32 v9, 0x380, v8
v_add_u32 v9, s98, v9
v_min_u32 v9, L_code_end - L_pc - 4, v9
v_mov_b32 v11, s5
v_add_co_u32 v10, vcc, s4, v9
s_nop 1
v_addc_co_u32 v11, vcc, 0, v11, vcc
global_load_dword v15, v[10:11], off
v_and_b32 v204, 15, v1
v_lshrrev_b32 v206, 1, v204
v_xor_b32 v206, v206, v205
v_lshlrev_b32 v206, 4, v206
v_lshl_add_u32 v206, v204, 7, v206
s_and_b32 s39, s3, 1
s_lshl_b32 s39, s39, 14
v_add_u32 v192, s39, v206
v_xor_b32 v193, 64, v192
v_add_u32 v194, 0x10000, v192
v_add_u32 v195, 0x10000, v193
v_bfe_u32 v204, v1, 2, 2
v_and_b32 v206, 1, v205
v_lshl_or_b32 v206, v206, 2, v204
v_lshl_add_u32 v204, v205, 3, v204
v_lshlrev_b32 v204, 9, v204
v_and_b32 v207, 3, v1
v_lshl_add_u32 v204, v207, 3, v204
s_lshr_b32 s39, s3, 1
s_lshl_b32 s39, s39, 8
s_add_u32 s39, s39, 98304
v_add_u32 v204, s39, v204
v_xor_b32 v207, 0, v206
v_lshl_add_u32 v196, v207, 5, v204
v_xor_b32 v207, 1, v206
v_lshl_add_u32 v197, v207, 5, v204
v_xor_b32 v207, 2, v206
v_lshl_add_u32 v198, v207, 5, v204
v_xor_b32 v207, 3, v206
v_lshl_add_u32 v199, v207, 5, v204
v_xor_b32 v207, 4, v206
v_lshl_add_u32 v200, v207, 5, v204
v_xor_b32 v207, 5, v206
v_lshl_add_u32 v201, v207, 5, v204
v_xor_b32 v207, 6, v206
v_lshl_add_u32 v202, v207, 5, v204
v_xor_b32 v207, 7, v206
v_lshl_add_u32 v203, v207, 5, v204
s_lshl_b32 s36, s36, 1
s_lshr_b32 s39, s3, 1
s_add_u32 s36, s36, s39
s_lshl_b32 s24, s36, 19
s_lshl_b32 s38, s38, 16
s_add_u32 s24, s24, s38
s_and_b32 s39, s3, 1
s_lshl_b32 s39, s39, 15
s_add_u32 s24, s24, s39
s_lshl_b32 s36, s42, 24
s_add_u32 s16, s40, s36
s_addc_u32 s17, s41, 0
s_mov_b32 s18, 16777216
s_mov_b32 s19, 0x20000
s_mov_b32 s98, 256
s_mov_b32 s99, 0x20000
v_lshlrev_b32 v3, 16, v3
v_mov_b32 v4, 1
s_cmp_lg_u32 s2, 0
s_cselect_b32 s43, 0x10000000, 0
v_or_b32 v3, s43, v3
s_waitcnt vmcnt(19)
s_barrier
buffer_store_dword v4, v3, s[96:99], 0 offen sc1
ds_read_b128 v[80:83], v192 offset:0
ds_read_b128 v[84:87], v192 offset:2048
ds_read_b128 v[88:91], v192 offset:4096
ds_read_b128 v[92:95], v192 offset:6144
ds_read_b128 v[96:99], v192 offset:8192
ds_read_b128 v[100:103], v192 offset:10240
ds_read_b128 v[104:107], v192 offset:12288
ds_read_b128 v[108:111], v192 offset:14336
TR 144,196,0
TR 146,196,2048
TR 148,197,0
TR 150,197,2048
TR 152,198,0
TR 154,198,2048
TR 156,199,0
TR 158,199,2048
TR 160,200,0
TR 162,200,2048
TR 164,201,0
TR 166,201,2048
TR 168,202,0
TR 170,202,2048
TR 172,203,0
TR 174,203,2048
s_cmp_eq_u32 s42, 0
s_cbranch_scc0 L_p1_V
s_waitcnt lgkmcnt(14)
v_mfma_f32_16x16x32_bf16 a[0:3], v[144:147], v[80:83], 0
s_add_u32 m0, s22, 65536
s_mov_b32 s56, s76
v_mfma_f32_16x16x32_bf16 a[8:11], v[144:147], v[84:87], 0
ds_read_b128 v[112:115], v193 offset:0
s_mov_b32 s57, s77
v_mfma_f32_16x16x32_bf16 a[64:67], v[144:147], v[88:91], 0
s_mov_b32 s58, 4194304
v_mfma_f32_16x16x32_bf16 a[72:75], v[144:147], v[92:95], 0
s_mov_b32 s59, 0x20000
v_mfma_f32_16x16x32_bf16 a[128:131], v[144:147], v[96:99], 0
s_mov_b32 s44, s78
v_mfma_f32_16x16x32_bf16 a[136:139], v[144:147], v[100:103], 0
buffer_load_dwordx4 v176, s[8:11], s20 offen offset:0 lds
s_mov_b32 s45, s79
v_mfma_f32_16x16x32_bf16 a[192:195], v[144:147], v[104:107], 0
s_mov_b32 s46, 4194304
v_mfma_f32_16x16x32_bf16 a[200:203], v[144:147], v[108:111], 0
TR 144,196,16384
TR 146,196,18432
s_waitcnt lgkmcnt(15)
v_mfma_f32_16x16x32_bf16 a[4:7], v[148:151], v[80:83], 0
ds_read_b128 v[116:119], v193 offset:2048
s_mov_b32 s47, 0x20000
v_mfma_f32_16x16x32_bf16 a[12:15], v[148:151], v[84:87], 0
s_mov_b32 s48, s80
s_mov_b32 s49, s81
v_mfma_f32_16x16x32_bf16 a[68:71], v[148:151], v[88:91], 0
s_mov_b32 s50, 4194304
v_mfma_f32_16x16x32_bf16 a[76:79], v[148:151], v[92:95], 0
buffer_load_dwordx4 v177, s[8:11], s20 offen offset:1024 lds
s_mov_b32 s51, 0x20000
v_mfma_f32_16x16x32_bf16 a[132:135], v[148:151], v[96:99], 0
s_mov_b32 s52, s82
v_mfma_f32_16x16x32_bf16 a[140:143], v[148:151], v[100:103], 0
ds_read_b128 v[120:123], v193 offset:4096
s_mov_b32 s53, s83
v_mfma_f32_16x16x32_bf16 a[196:199], v[148:151], v[104:107], 0
s_mov_b32 s54, 8192
v_mfma_f32_16x16x32_bf16 a[204:207], v[148:151], v[108:111], 0
TR 148,197,16384
TR 150,197,18432
s_waitcnt lgkmcnt(15)
v_mfma_f32_16x16x32_bf16 a[16:19], v[152:155], v[80:83], 0
buffer_load_dwordx4 v178, s[8:11], s20 offen offset:2048 lds
s_mov_b32 s55, 0x20000
v_mfma_f32_16x16x32_bf16 a[24:27], v[152:155], v[84:87], 0
s_mov_b32 s60, s84
s_mov_b32 s61, s85
v_mfma_f32_16x16x32_bf16 a[80:83], v[152:155], v[88:91], 0
s_mov_b32 s62, 2048
v_mfma_f32_16x16x32_bf16 a[88:91], v[152:155], v[92:95], 0
s_mov_b32 s63, 0x20000
v_mfma_f32_16x16x32_bf16 a[144:147], v[152:155], v[96:99], 0
ds_read_b128 v[124:127], v193 offset:6144
v_mfma_f32_16x16x32_bf16 a[152:155], v[152:155], v[100:103], 0
s_add_u32 s64, s40, 50331648
s_addc_u32 s65, s41, 0
v_mfma_f32_16x16x32_bf16 a[208:211], v[152:155], v[104:107], 0
buffer_load_dwordx4 v179, s[8:11], s20 offen offset:3072 lds
s_mov_b32 s66, 4194304
v_mfma_f32_16x16x32_bf16 a[216:219], v[152:155], v[108:111], 0
TR 152,198,16384
TR 154,198,18432
v_mfma_f32_16x16x32_bf16 a[20:23], v[156:159], v[80:83], 0
s_mov_b32 s67, 0x20000
v_mfma_f32_16x16x32_bf16 a[28:31], v[156:159], v[84:87], 0
s_add_u32 s68, s40, 58720256
s_addc_u32 s69, s41, 0
v_mfma_f32_16x16x32_bf16 a[84:87], v[156:159], v[88:91], 0
ds_read_b128 v[128:131], v193 offset:8192
s_mov_b32 s70, 8192
v_mfma_f32_16x16x32_bf16 a[92:95], v[156:159], v[92:95], 0
s_mov_b32 s71, 0x20000
v_mfma_f32_16x16x32_bf16 a[148:151], v[156:159], v[96:99], 0
s_add_u32 m0, s22, 69632
s_and_b32 s72, s2, 15
v_mfma_f32_16x16x32_bf16 a[156:159], v[156:159], v[100:103], 0
s_lshl_b32 s72, s72, 2
v_mfma_f32_16x16x32_bf16 a[212:215], v[156:159], v[104:107], 0
s_add_u32 s72, s72, s3
v_mfma_f32_16x16x32_bf16 a[220:223], v[156:159], v[108:111], 0
TR 156,199,16384
TR 158,199,18432
s_waitcnt lgkmcnt(15)
v_mfma_f32_16x16x32_bf16 a[32:35], v[160:163], v[80:83], 0
ds_read_b128 v[132:135], v193 offset:10240
s_lshr_b32 s73, s2, 4
v_mfma_f32_16x16x32_bf16 a[40:43], v[160:163], v[84:87], 0
buffer_load_dwordx4 v180, s[8:11], s20 offen offset:0 lds
v_and_b32 v248, 3, v1
v_mfma_f32_16x16x32_bf16 a[96:99], v[160:163], v[88:91], 0
v_lshrrev_b32 v249, 2, v1
s_lshl_b32 s74, s72, 2
v_mfma_f32_16x16x32_bf16 a[104:107], v[160:163], v[92:95], 0
v_add_u32 v248, s74, v248
v_mfma_f32_16x16x32_bf16 a[160:163], v[160:163], v[96:99], 0
s_lshl_b32 s74, s73, 4
v_mfma_f32_16x16x32_bf16 a[168:171], v[160:163], v[100:103], 0
v_add_u32 v249, s74, v249
v_mfma_f32_16x16x32_bf16 a[224:227], v[160:163], v[104:107], 0
v_lshlrev_b32 v250, 14, v249
v_mfma_f32_16x16x32_bf16 a[232:235], v[160:163], v[108:111], 0
TR 160,200,16384
TR 162,200,18432
v_mfma_f32_16x16x32_bf16 a[36:39], v[164:167], v[80:83], 0
ds_read_b128 v[136:139], v193 offset:12288
buffer_load_dwordx4 v181, s[8:11], s20 offen offset:1024 lds
v_mfma_f32_16x16x32_bf16 a[44:47], v[164:167], v[84:87], 0
v_lshl_add_u32 v250, v248, 3, v250
v_add_u32 v252, -6144, v250
v_mfma_f32_16x16x32_bf16 a[100:103], v[164:167], v[88:91], 0
v_lshlrev_b32 v254, 5, v248
v_lshlrev_b32 v250, 4, v249
v_mfma_f32_16x16x32_bf16 a[108:111], v[164:167], v[92:95], 0
v_sub_u32 v250, 4080, v250
v_mfma_f32_16x16x32_bf16 a[164:167], v[164:167], v[96:99], 0
v_lshl_add_u32 v253, v248, 14, v250
v_mfma_f32_16x16x32_bf16 a[172:175], v[164:167], v[100:103], 0
ds_read_b128 v[140:143], v193 offset:14336
buffer_load_dwordx4 v182, s[8:11], s20 offen offset:2048 lds
v_mfma_f32_16x16x32_bf16 a[228:231], v[164:167], v[104:107], 0
v_and_b32 v248, 31, v1
v_lshlrev_b32 v78, 4, v248
v_mfma_f32_16x16x32_bf16 a[236:239], v[164:167], v[108:111], 0
TR 164,201,16384
TR 166,201,18432
v_mfma_f32_16x16x32_bf16 a[48:51], v[168:171], v[80:83], 0
s_lshl_b32 s74, s2, 2
s_add_u32 s74, s74, s3
v_mfma_f32_16x16x32_bf16 a[56:59], v[168:171], v[84:87], 0
s_lshl_b32 s74, s74, 1
v_mfma_f32_16x16x32_bf16 a[112:115], v[168:171], v[88:91], 0
buffer_load_dwordx4 v183, s[8:11], s20 offen offset:3072 lds
v_lshrrev_b32 v249, 5, v1
v_mfma_f32_16x16x32_bf16 a[120:123], v[168:171], v[92:95], 0
v_add_u32 v249, s74, v249
v_mfma_f32_16x16x32_bf16 a[176:179], v[168:171], v[96:99], 0
v_lshl_add_u32 v255, v249, 11, v78
v_mfma_f32_16x16x32_bf16 a[184:187], v[168:171], v[100:103], 0
v_lshlrev_b32 v249, 2, v249
v_mfma_f32_16x16x32_bf16 a[240:243], v[168:171], v[104:107], 0
v_lshl_add_u32 v79, v248, 20, v249
v_mfma_f32_16x16x32_bf16 a[248:251], v[168:171], v[108:111], 0
TR 168,202,16384
TR 170,202,18432
s_waitcnt lgkmcnt(15)
v_mfma_f32_16x16x32_bf16 a[52:55], v[172:175], v[80:83], 0
s_add_u32 s20, s20, 128
s_add_u32 s25, s24, 128
v_mfma_f32_16x16x32_bf16 a[60:63], v[172:175], v[84:87], 0
s_add_u32 s26, s24, 2048
s_add_u32 s27, s24, 2176
v_mfma_f32_16x16x32_bf16 a[116:119], v[172:175], v[88:91], 0
s_add_u32 s28, s24, 4096
v_mfma_f32_16x16x32_bf16 a[124:127], v[172:175], v[92:95], 0
s_add_u32 s29, s24, 4224
v_mfma_f32_16x16x32_bf16 a[180:183], v[172:175], v[96:99], 0
s_add_u32 s30, s24, 6144
v_mfma_f32_16x16x32_bf16 a[188:191], v[172:175], v[100:103], 0
s_add_u32 s31, s24, 6272
v_mfma_f32_16x16x32_bf16 a[244:247], v[172:175], v[104:107], 0
v_mfma_f32_16x16x32_bf16 a[252:255], v[172:175], v[108:111], 0
TR 172,203,16384
TR 174,203,18432
s_waitcnt lgkmcnt(2)
MA 0,v,144,v,112
MA 8,v,144,v,116
MA 64,v,144,v,120
MA 72,v,144,v,124
MA 128,v,144,v,128
MA 136,v,144,v,132
MA 192,v,144,v,136
MA 200,v,144,v,140
MA 4,v,148,v,112
MA 12,v,148,v,116
s_waitcnt vmcnt(12) lgkmcnt(0)
s_barrier
MA 68,v,148,v,120
TR 144,196,32768
TR 146,196,34816
MA 76,v,148,v,124
ds_read_b128 v[80:83], v192 offset:32768
s_add_u32 m0, s23, 0
MA 132,v,148,v,128
buffer_load_dwordx4 v[208:211], v255, s[56:59], 0 offen offset:0
MA 140,v,148,v,132
MA 196,v,148,v,136
buffer_load_dwordx4 v184, s[12:15], s21 offen offset:0 lds
buffer_load_dwordx4 v[224:227], v78, s[60:63], 0 offen offset:0
MA 204,v,148,v,140
TR 148,197,32768
TR 150,197,34816
MA 16,v,152,v,112
ds_read_b128 v[84:87], v192 offset:34816
MA 24,v,152,v,116
MA 80,v,152,v,120
buffer_load_dwordx4 v[212:215], v255, s[56:59], 0 offen offset:512
MA 88,v,152,v,124
buffer_load_dwordx4 v185, s[12:15], s21 offen offset:1024 lds
MA 144,v,152,v,128
MA 152,v,152,v,132
ds_read_b128 v[88:91], v192 offset:36864
MA 208,v,152,v,136
buffer_load_dwordx4 v[228:231], v78, s[60:63], 0 offen offset:512
MA 216,v,152,v,140
TR 152,198,32768
TR 154,198,34816
MA 20,v,156,v,112
buffer_load_dwordx4 v186, s[12:15], s21 offen offset:2048 lds
MA 28,v,156,v,116
MA 84,v,156,v,120
ds_read_b128 v[92:95], v192 offset:38912
buffer_load_dwordx4 v[216:219], v255, s[56:59], 0 offen offset:1024
MA 92,v,156,v,124
MA 148,v,156,v,128
buffer_load_dwordx4 v187, s[12:15], s21 offen offset:3072 lds
MA 156,v,156,v,132
MA 212,v,156,v,136
buffer_load_dwordx4 v[232:235], v78, s[60:63], 0 offen offset:1024
MA 220,v,156,v,140
TR 156,199,32768
TR 158,199,34816
MA 32,v,160,v,112
ds_read_b128 v[96:99], v192 offset:40960
MA 40,v,160,v,116
s_add_u32 m0, s23, 4096
MA 96,v,160,v,120
buffer_load_dwordx4 v[220:223], v255, s[56:59], 0 offen offset:1536
MA 104,v,160,v,124
MA 160,v,160,v,128
ds_read_b128 v[100:103], v192 offset:43008
MA 168,v,160,v,132
MA 224,v,160,v,136
buffer_load_dwordx4 v188, s[12:15], s21 offen offset:0 lds
buffer_load_dwordx4 v[236:239], v78, s[60:63], 0 offen offset:1536
MA 232,v,160,v,140
TR 160,200,32768
TR 162,200,34816
MA 36,v,164,v,112
MA 44,v,164,v,116
ds_read_b128 v[104:107], v192 offset:45056
MA 100,v,164,v,120
buffer_load_dwordx4 v[54:57], v254, s[52:55], 0 offen offset:0
MA 108,v,164,v,124
buffer_load_dwordx4 v189, s[12:15], s21 offen offset:1024 lds
MA 164,v,164,v,128
MA 172,v,164,v,132
MA 228,v,164,v,136
ds_read_b128 v[108:111], v192 offset:47104
buffer_load_dwordx4 v[58:61], v254, s[52:55], 0 offen offset:16
MA 236,v,164,v,140
TR 164,201,32768
TR 166,201,34816
MA 48,v,168,v,112
buffer_load_dwordx4 v190, s[12:15], s21 offen offset:2048 lds
MA 56,v,168,v,116
MA 112,v,168,v,120
v_add_u32 v248, 0, v252
MA 120,v,168,v,124
MA 176,v,168,v,128
buffer_load_dwordx4 v191, s[12:15], s21 offen offset:3072 lds
MA 184,v,168,v,132
MA 240,v,168,v,136
buffer_load_dwordx2 v[16:17], v248, s[44:47], 0 offen
MA 248,v,168,v,140
TR 168,202,32768
TR 170,202,34816
MA 52,v,172,v,112
MA 60,v,172,v,116
s_add_u32 s21, s21, 524288
MA 116,v,172,v,120
v_add_u32 v249, 2048, v252
MA 124,v,172,v,124
MA 180,v,172,v,128
MA 188,v,172,v,132
MA 244,v,172,v,136
MA 252,v,172,v,140
TR 172,203,32768
TR 174,203,34816
s_waitcnt lgkmcnt(2)
MA 0,v,144,v,80
s_add_u32 m0, s22, 0
buffer_load_dwordx2 v[18:19], v249, s[44:47], 0 offen
MA 8,v,144,v,84
ds_read_b128 v[112:115], v193 offset:32768
MA 64,v,144,v,88
MA 72,v,144,v,92
MA 128,v,144,v,96
v_add_u32 v250, 4096, v252
MA 136,v,144,v,100
buffer_load_dwordx4 v176, s[8:11], s20 offen offset:0 lds
MA 192,v,144,v,104
MA 200,v,144,v,108
TR 144,196,49152
TR 146,196,51200
MA 4,v,148,v,80
ds_read_b128 v[116:119], v193 offset:34816
MA 12,v,148,v,84
buffer_load_dwordx2 v[20:21], v250, s[44:47], 0 offen
MA 68,v,148,v,88
MA 76,v,148,v,92
buffer_load_dwordx4 v177, s[8:11], s20 offen offset:1024 lds
MA 132,v,148,v,96
MA 140,v,148,v,100
ds_read_b128 v[120:123], v193 offset:36864
MA 196,v,148,v,104
v_add_u32 v251, 6144, v252
MA 204,v,148,v,108
TR 148,197,49152
TR 150,197,51200
MA 16,v,152,v,80
buffer_load_dwordx4 v178, s[8:11], s20 offen offset:2048 lds
MA 24,v,152,v,84
MA 80,v,152,v,88
MA 88,v,152,v,92
buffer_load_dwordx2 v[22:23], v251, s[44:47], 0 offen
MA 144,v,152,v,96
ds_read_b128 v[124:127], v193 offset:38912
MA 152,v,152,v,100
MA 208,v,152,v,104
buffer_load_dwordx4 v179, s[8:11], s20 offen offset:3072 lds
MA 216,v,152,v,108
TR 152,198,49152
TR 154,198,51200
MA 20,v,156,v,80
buffer_load_dwordx2 v[38:39], v251, s[48:51], 0 offen
MA 28,v,156,v,84
MA 84,v,156,v,88
ds_read_b128 v[128:131], v193 offset:40960
MA 92,v,156,v,92
MA 148,v,156,v,96
s_add_u32 m0, s22, 4096
v_add_u32 v248, 8192, v252
MA 156,v,156,v,100
MA 212,v,156,v,104
MA 220,v,156,v,108
TR 156,199,49152
TR 158,199,51200
MA 32,v,160,v,80
ds_read_b128 v[132:135], v193 offset:43008
MA 40,v,160,v,84
buffer_load_dwordx4 v180, s[8:11], s20 offen offset:0 lds
buffer_load_dwordx2 v[24:25], v248, s[44:47], 0 offen
MA 96,v,160,v,88
MA 104,v,160,v,92
MA 160,v,160,v,96
MA 168,v,160,v,100
MA 224,v,160,v,104
buffer_load_dwordx2 v[40:41], v248, s[48:51], 0 offen
MA 232,v,160,v,108
TR 160,200,49152
TR 162,200,51200
MA 36,v,164,v,80
ds_read_b128 v[136:139], v193 offset:45056
buffer_load_dwordx4 v181, s[8:11], s20 offen offset:1024 lds
MA 44,v,164,v,84
MA 100,v,164,v,88
v_add_u32 v249, 10240, v252
MA 108,v,164,v,92
MA 164,v,164,v,96
MA 172,v,164,v,100
ds_read_b128 v[140:143], v193 offset:47104
buffer_load_dwordx4 v182, s[8:11], s20 offen offset:2048 lds
MA 228,v,164,v,104
MA 236,v,164,v,108
TR 164,201,49152
TR 166,201,51200
MA 48,v,168,v,80
buffer_load_dwordx2 v[26:27], v249, s[44:47], 0 offen
MA 56,v,168,v,84
MA 112,v,168,v,88
buffer_load_dwordx4 v183, s[8:11], s20 offen offset:3072 lds
MA 120,v,168,v,92
MA 176,v,168,v,96
buffer_load_dwordx2 v[42:43], v249, s[48:51], 0 offen
MA 184,v,168,v,100
MA 240,v,168,v,104
MA 248,v,168,v,108
TR 168,202,49152
TR 170,202,51200
s_waitcnt lgkmcnt(15)
MA 52,v,172,v,80
s_add_u32 s20, s20, 128
MA 60,v,172,v,84
v_add_u32 v250, 12288, v252
MA 116,v,172,v,88
MA 124,v,172,v,92
MA 180,v,172,v,96
MA 188,v,172,v,100
MA 244,v,172,v,104
MA 252,v,172,v,108
TR 172,203,49152
TR 174,203,51200
s_waitcnt lgkmcnt(2)
MA 0,v,144,v,112
MA 8,v,144,v,116
MA 64,v,144,v,120
MA 72,v,144,v,124
MA 128,v,144,v,128
MA 136,v,144,v,132
MA 192,v,144,v,136
MA 200,v,144,v,140
MA 4,v,148,v,112
MA 12,v,148,v,116
s_waitcnt vmcnt(17) lgkmcnt(0)
s_barrier
MA 68,v,148,v,120
TR 144,196,0
TR 146,196,2048
MA 76,v,148,v,124
ds_read_b128 v[80:83], v194 offset:0
s_add_u32 m0, s23, 32768
MA 132,v,148,v,128
buffer_load_dwordx2 v[28:29], v250, s[44:47], 0 offen
MA 140,v,148,v,132
buffer_load_dwordx2 v[44:45], v250, s[48:51], 0 offen
MA 196,v,148,v,136
buffer_load_dwordx4 v184, s[12:15], s21 offen offset:0 lds
MA 204,v,148,v,140
TR 148,197,0
TR 150,197,2048
MA 16,v,152,v,112
ds_read_b128 v[84:87], v194 offset:2048
MA 24,v,152,v,116
v_add_u32 v251, 14336, v252
MA 80,v,152,v,120
MA 88,v,152,v,124
buffer_load_dwordx4 v185, s[12:15], s21 offen offset:1024 lds
MA 144,v,152,v,128
MA 152,v,152,v,132
ds_read_b128 v[88:91], v194 offset:4096
buffer_load_dwordx2 v[30:31], v251, s[44:47], 0 offen
MA 208,v,152,v,136
MA 216,v,152,v,140
TR 152,198,0
TR 154,198,2048
MA 20,v,156,v,112
buffer_load_dwordx4 v186, s[12:15], s21 offen offset:2048 lds
buffer_load_dwordx2 v[46:47], v251, s[48:51], 0 offen
MA 28,v,156,v,116
MA 84,v,156,v,120
ds_read_b128 v[92:95], v194 offset:6144
MA 92,v,156,v,124
MA 148,v,156,v,128
buffer_load_dwordx4 v187, s[12:15], s21 offen offset:3072 lds
v_add_u32 v248, 16384, v252
MA 156,v,156,v,132
MA 212,v,156,v,136
MA 220,v,156,v,140
TR 156,199,0
TR 158,199,2048
MA 32,v,160,v,112
ds_read_b128 v[96:99], v194 offset:8192
buffer_load_dwordx2 v[32:33], v248, s[44:47], 0 offen
MA 40,v,160,v,116
s_add_u32 m0, s23, 36864
MA 96,v,160,v,120
MA 104,v,160,v,124
MA 160,v,160,v,128
ds_read_b128 v[100:103], v194 offset:10240
buffer_load_dwordx2 v[48:49], v248, s[48:51], 0 offen
MA 168,v,160,v,132
MA 224,v,160,v,136
buffer_load_dwordx4 v188, s[12:15], s21 offen offset:0 lds
MA 232,v,160,v,140
TR 160,200,0
TR 162,200,2048
MA 36,v,164,v,112
v_add_u32 v249, 18432, v252
MA 44,v,164,v,116
ds_read_b128 v[104:107], v194 offset:12288
MA 100,v,164,v,120
MA 108,v,164,v,124
buffer_load_dwordx4 v189, s[12:15], s21 offen offset:1024 lds
buffer_load_dwordx2 v[34:35], v249, s[44:47], 0 offen
MA 164,v,164,v,128
MA 172,v,164,v,132
MA 228,v,164,v,136
ds_read_b128 v[108:111], v194 offset:14336
MA 236,v,164,v,140
TR 164,201,0
TR 166,201,2048
MA 48,v,168,v,112
buffer_load_dwordx4 v190, s[12:15], s21 offen offset:2048 lds
buffer_load_dwordx2 v[50:51], v249, s[48:51], 0 offen
MA 56,v,168,v,116
MA 112,v,168,v,120
v_add_u32 v250, 20480, v252
MA 120,v,168,v,124
MA 176,v,168,v,128
buffer_load_dwordx4 v191, s[12:15], s21 offen offset:3072 lds
MA 184,v,168,v,132
MA 240,v,168,v,136
buffer_load_dwordx2 v[36:37], v250, s[44:47], 0 offen
MA 248,v,168,v,140
TR 168,202,0
TR 170,202,2048
MA 52,v,172,v,112
MA 60,v,172,v,116
s_add_u32 s21, s21, 524288
MA 116,v,172,v,120
buffer_load_dwordx2 v[52:53], v250, s[48:51], 0 offen
MA 124,v,172,v,124
MA 180,v,172,v,128
MA 188,v,172,v,132
MA 244,v,172,v,136
MA 252,v,172,v,140
TR 172,203,0
TR 174,203,2048
s_waitcnt lgkmcnt(2)
MA 0,v,144,v,80
s_add_u32 m0, s22, 32768
MA 8,v,144,v,84
ds_read_b128 v[112:115], v195 offset:0
MA 64,v,144,v,88
s_mov_b32 s4, s90
s_mov_b32 s5, s91
s_mov_b32 s6, 8388608
s_mov_b32 s7, 0x20000
MA 72,v,144,v,92
MA 128,v,144,v,96
MA 136,v,144,v,100
buffer_load_dwordx4 v176, s[8:11], s20 offen offset:0 lds
MA 192,v,144,v,104
MA 200,v,144,v,108
TR 144,196,16384
TR 146,196,18432
MA 4,v,148,v,80
ds_read_b128 v[116:119], v195 offset:2048
MA 12,v,148,v,84
MA 68,v,148,v,88
MA 76,v,148,v,92
buffer_load_dwordx4 v177, s[8:11], s20 offen offset:1024 lds
MA 132,v,148,v,96
MA 140,v,148,v,100
ds_read_b128 v[120:123], v195 offset:4096
MA 196,v,148,v,104
MA 204,v,148,v,108
TR 148,197,16384
TR 150,197,18432
MA 16,v,152,v,80
buffer_load_dwordx4 v178, s[8:11], s20 offen offset:2048 lds
MA 24,v,152,v,84
MA 80,v,152,v,88
MA 88,v,152,v,92
MA 144,v,152,v,96
ds_read_b128 v[124:127], v195 offset:6144
MA 152,v,152,v,100
MA 208,v,152,v,104
buffer_load_dwordx4 v179, s[8:11], s20 offen offset:3072 lds
MA 216,v,152,v,108
TR 152,198,16384
TR 154,198,18432
MA 20,v,156,v,80
MA 28,v,156,v,84
MA 84,v,156,v,88
ds_read_b128 v[128:131], v195 offset:8192
MA 92,v,156,v,92
v_lshlrev_b32 v14, 7, v1
MA 148,v,156,v,96
s_add_u32 m0, s22, 36864
MA 156,v,156,v,100
MA 212,v,156,v,104
MA 220,v,156,v,108
TR 156,199,16384
TR 158,199,18432
MA 32,v,160,v,80
ds_read_b128 v[132:135], v195 offset:10240
MA 40,v,160,v,84
buffer_load_dwordx4 v180, s[8:11], s20 offen offset:0 lds
MA 96,v,160,v,88
s_lshl_b32 s43, s2, 2
s_add_u32 s43, s43, s3
s_lshl_b32 s43, s43, 13
buffer_load_dword v15, v14, s[4:7], s43 offen
MA 104,v,160,v,92
MA 160,v,160,v,96
MA 168,v,160,v,100
MA 224,v,160,v,104
MA 232,v,160,v,108
TR 160,200,16384
TR 162,200,18432
MA 36,v,164,v,80
ds_read_b128 v[136:139], v195 offset:12288
buffer_load_dwordx4 v181, s[8:11], s20 offen offset:1024 lds
MA 44,v,164,v,84
MA 100,v,164,v,88
MA 108,v,164,v,92
MA 164,v,164,v,96
MA 172,v,164,v,100
ds_read_b128 v[140:143], v195 offset:14336
buffer_load_dwordx4 v182, s[8:11], s20 offen offset:2048 lds
MA 228,v,164,v,104
MA 236,v,164,v,108
TR 164,201,16384
TR 166,201,18432
MA 48,v,168,v,80
MA 56,v,168,v,84
MA 112,v,168,v,88
buffer_load_dwordx4 v183, s[8:11], s20 offen offset:3072 lds
MA 120,v,168,v,92
MA 176,v,168,v,96
MA 184,v,168,v,100
MA 240,v,168,v,104
MA 248,v,168,v,108
TR 168,202,16384
TR 170,202,18432
s_waitcnt lgkmcnt(15)
MA 52,v,172,v,80
s_add_u32 s20, s20, 128
MA 60,v,172,v,84
MA 116,v,172,v,88
MA 124,v,172,v,92
MA 180,v,172,v,96
MA 188,v,172,v,100
MA 244,v,172,v,104
MA 252,v,172,v,108
TR 172,203,16384
TR 174,203,18432
s_waitcnt lgkmcnt(2)
MA 0,v,144,v,112
MA 8,v,144,v,116
MA 64,v,144,v,120
MA 72,v,144,v,124
MA 128,v,144,v,128
MA 136,v,144,v,132
MA 192,v,144,v,136
MA 200,v,144,v,140
MA 4,v,148,v,112
MA 12,v,148,v,116
s_waitcnt vmcnt(11) lgkmcnt(0)
s_barrier
MA 68,v,148,v,120
TR 144,196,32768
TR 146,196,34816
MA 76,v,148,v,124
ds_read_b128 v[80:83], v192 offset:0
s_add_u32 m0, s23, 0
MA 132,v,148,v,128
MA 140,v,148,v,132
MA 196,v,148,v,136
buffer_load_dwordx4 v184, s[12:15], s21 offen offset:0 lds
MA 204,v,148,v,140
TR 148,197,32768
TR 150,197,34816
MA 16,v,152,v,112
ds_read_b128 v[84:87], v192 offset:2048
MA 24,v,152,v,116
MA 80,v,152,v,120
MA 88,v,152,v,124
buffer_load_dwordx4 v185, s[12:15], s21 offen offset:1024 lds
MA 144,v,152,v,128
MA 152,v,152,v,132
ds_read_b128 v[88:91], v192 offset:4096
MA 208,v,152,v,136
MA 216,v,152,v,140
TR 152,198,32768
TR 154,198,34816
MA 20,v,156,v,112
buffer_load_dwordx4 v186, s[12:15], s21 offen offset:2048 lds
MA 28,v,156,v,116
MA 84,v,156,v,120
ds_read_b128 v[92:95], v192 offset:6144
MA 92,v,156,v,124
MA 148,v,156,v,128
buffer_load_dwordx4 v187, s[12:15], s21 offen offset:3072 lds
MA 156,v,156,v,132
MA 212,v,156,v,136
MA 220,v,156,v,140
TR 156,199,32768
TR 158,199,34816
MA 32,v,160,v,112
ds_read_b128 v[96:99], v192 offset:8192
MA 40,v,160,v,116
s_add_u32 m0, s23, 4096
MA 96,v,160,v,120
MA 104,v,160,v,124
MA 160,v,160,v,128
ds_read_b128 v[100:103], v192 offset:10240
MA 168,v,160,v,132
MA 224,v,160,v,136
buffer_load_dwordx4 v188, s[12:15], s21 offen offset:0 lds
MA 232,v,160,v,140
TR 160,200,32768
TR 162,200,34816
MA 36,v,164,v,112
MA 44,v,164,v,116
ds_read_b128 v[104:107], v192 offset:12288
MA 100,v,164,v,120
MA 108,v,164,v,124
buffer_load_dwordx4 v189, s[12:15], s21 offen offset:1024 lds
MA 164,v,164,v,128
MA 172,v,164,v,132
MA 228,v,164,v,136
ds_read_b128 v[108:111], v192 offset:14336
MA 236,v,164,v,140
TR 164,201,32768
TR 166,201,34816
MA 48,v,168,v,112
buffer_load_dwordx4 v190, s[12:15], s21 offen offset:2048 lds
MA 56,v,168,v,116
MA 112,v,168,v,120
MA 120,v,168,v,124
MA 176,v,168,v,128
buffer_load_dwordx4 v191, s[12:15], s21 offen offset:3072 lds
MA 184,v,168,v,132
MA 240,v,168,v,136
MA 248,v,168,v,140
TR 168,202,32768
TR 170,202,34816
MA 52,v,172,v,112
MA 60,v,172,v,116
s_add_u32 s21, s21, 524288
MA 116,v,172,v,120
MA 124,v,172,v,124
MA 180,v,172,v,128
MA 188,v,172,v,132
MA 244,v,172,v,136
MA 252,v,172,v,140
TR 172,203,32768
TR 174,203,34816
s_waitcnt lgkmcnt(2)
MA 0,v,144,v,80
s_add_u32 m0, s22, 65536
v_mov_b32 v248, 0
MA 8,v,144,v,84
ds_read_b128 v[112:115], v193 offset:0
v_mov_b32 v249, 0
MA 64,v,144,v,88
v_dot2_f32_bf16 v248, v208, v224, v248
v_dot2_f32_bf16 v249, v209, v225, v249
MA 72,v,144,v,92
v_dot2_f32_bf16 v248, v210, v226, v248
v_dot2_f32_bf16 v249, v211, v227, v249
MA 128,v,144,v,96
v_dot2_f32_bf16 v248, v212, v228, v248
MA 136,v,144,v,100
buffer_load_dwordx4 v176, s[8:11], s20 offen offset:0 lds
v_dot2_f32_bf16 v249, v213, v229, v249
MA 192,v,144,v,104
v_dot2_f32_bf16 v248, v214, v230, v248
v_dot2_f32_bf16 v249, v215, v231, v249
MA 200,v,144,v,108
TR 144,196,49152
TR 146,196,51200
MA 4,v,148,v,80
ds_read_b128 v[116:119], v193 offset:2048
v_dot2_f32_bf16 v248, v216, v232, v248
MA 12,v,148,v,84
v_dot2_f32_bf16 v249, v217, v233, v249
v_dot2_f32_bf16 v248, v218, v234, v248
MA 68,v,148,v,88
v_dot2_f32_bf16 v249, v219, v235, v249
v_dot2_f32_bf16 v248, v220, v236, v248
MA 76,v,148,v,92
buffer_load_dwordx4 v177, s[8:11], s20 offen offset:1024 lds
v_dot2_f32_bf16 v249, v221, v237, v249
MA 132,v,148,v,96
v_dot2_f32_bf16 v248, v222, v238, v248
v_dot2_f32_bf16 v249, v223, v239, v249
MA 140,v,148,v,100
ds_read_b128 v[120:123], v193 offset:4096
MA 196,v,148,v,104
s_nop 2
v_add_f32 v248, v248, v249
MA 204,v,148,v,108
TR 148,197,49152
TR 150,197,51200
MA 16,v,152,v,80
buffer_load_dwordx4 v178, s[8:11], s20 offen offset:2048 lds
v_add_f32_dpp v248, v248, v248 row_ror:8 row_mask:0xf bank_mask:0xf
MA 24,v,152,v,84
s_nop 0
v_add_f32_dpp v248, v248, v248 row_ror:4 row_mask:0xf bank_mask:0xf
MA 80,v,152,v,88
s_nop 0
v_add_f32_dpp v248, v248, v248 row_ror:2 row_mask:0xf bank_mask:0xf
s_nop 1
v_add_f32_dpp v248, v248, v248 row_ror:1 row_mask:0xf bank_mask:0xf
MA 88,v,152,v,92
v_mov_b32 v249, v248
MA 144,v,152,v,96
ds_read_b128 v[124:127], v193 offset:6144
v_permlane16_swap_b32 v248, v249
MA 152,v,152,v,100
v_add_f32 v248, v248, v249
v_mul_f32 v248, 0xbfb8aa3b, v248
MA 208,v,152,v,104
buffer_load_dwordx4 v179, s[8:11], s20 offen offset:3072 lds
MA 216,v,152,v,108
TR 152,198,49152
TR 154,198,51200
MA 20,v,156,v,80
v_exp_f32 v248, v248
MA 28,v,156,v,84
v_add_f32 v248, 1.0, v248
MA 84,v,156,v,88
ds_read_b128 v[128:131], v193 offset:8192
MA 92,v,156,v,92
v_rcp_f32 v248, v248
MA 148,v,156,v,96
s_add_u32 m0, s22, 69632
MA 156,v,156,v,100
s_nop 0
buffer_store_dword v248, v79, s[68:71], 0 offen sc1
MA 212,v,156,v,104
v_lshlrev_b32 v230, 16, v54
v_and_b32 v231, 0xffff0000, v54
MA 220,v,156,v,108
TR 156,199,49152
TR 158,199,51200
MA 32,v,160,v,80
ds_read_b128 v[132:135], v193 offset:10240
v_lshlrev_b32 v232, 16, v55
MA 40,v,160,v,84
buffer_load_dwordx4 v180, s[8:11], s20 offen offset:0 lds
v_and_b32 v233, 0xffff0000, v55
MA 96,v,160,v,88
v_lshlrev_b32 v234, 16, v56
v_and_b32 v235, 0xffff0000, v56
MA 104,v,160,v,92
v_lshlrev_b32 v236, 16, v57
v_and_b32 v237, 0xffff0000, v57
MA 160,v,160,v,96
v_lshlrev_b32 v208, 16, v16
v_and_b32 v209, 0xffff0000, v16
MA 168,v,160,v,100
v_lshlrev_b32 v210, 16, v18
v_and_b32 v211, 0xffff0000, v18
MA 224,v,160,v,104
v_lshlrev_b32 v212, 16, v20
v_and_b32 v213, 0xffff0000, v20
MA 232,v,160,v,108
TR 160,200,49152
TR 162,200,51200
MA 36,v,164,v,80
ds_read_b128 v[136:139], v193 offset:12288
buffer_load_dwordx4 v181, s[8:11], s20 offen offset:1024 lds
MA 44,v,164,v,84
v_lshlrev_b32 v214, 16, v22
v_and_b32 v215, 0xffff0000, v22
MA 100,v,164,v,88
v_lshlrev_b32 v216, 16, v24
v_and_b32 v217, 0xffff0000, v24
MA 108,v,164,v,92
v_lshlrev_b32 v218, 16, v26
v_and_b32 v219, 0xffff0000, v26
MA 164,v,164,v,96
v_lshlrev_b32 v220, 16, v28
v_and_b32 v221, 0xffff0000, v28
MA 172,v,164,v,100
ds_read_b128 v[140:143], v193 offset:14336
buffer_load_dwordx4 v182, s[8:11], s20 offen offset:2048 lds
MA 228,v,164,v,104
v_lshlrev_b32 v222, 16, v30
v_and_b32 v223, 0xffff0000, v30
MA 236,v,164,v,108
TR 164,201,49152
TR 166,201,51200
MA 48,v,168,v,80
v_lshlrev_b32 v224, 16, v32
v_and_b32 v225, 0xffff0000, v32
MA 56,v,168,v,84
v_lshlrev_b32 v226, 16, v34
v_and_b32 v227, 0xffff0000, v34
MA 112,v,168,v,88
buffer_load_dwordx4 v183, s[8:11], s20 offen offset:3072 lds
s_waitcnt vmcnt(27)
v_lshlrev_b32 v228, 16, v36
MA 120,v,168,v,92
v_and_b32 v229, 0xffff0000, v36
v_lshlrev_b32 v250, 16, v38
MA 176,v,168,v,96
v_and_b32 v251, 0xffff0000, v38
v_mul_f32 v62, v214, v230
MA 184,v,168,v,100
v_mul_f32 v70, v215, v234
v_fmac_f32 v62, v212, v231
MA 240,v,168,v,104
v_fmac_f32 v70, v213, v235
MA 248,v,168,v,108
TR 168,202,49152
TR 170,202,51200
s_waitcnt lgkmcnt(15)
MA 52,v,172,v,80
s_add_u32 s20, s20, 128
v_fmac_f32 v62, v210, v232
MA 60,v,172,v,84
v_fmac_f32 v70, v211, v236
v_fmac_f32 v62, v208, v233
MA 116,v,172,v,88
v_fmac_f32 v70, v209, v237
v_mul_f32 v62, v62, v250
MA 124,v,172,v,92
v_mul_f32 v70, v70, v251
v_lshlrev_b32 v250, 16, v40
MA 180,v,172,v,96
v_and_b32 v251, 0xffff0000, v40
MA 188,v,172,v,100
v_mul_f32 v63, v216, v230
MA 244,v,172,v,104
MA 252,v,172,v,108
TR 172,203,49152
TR 174,203,51200
s_waitcnt lgkmcnt(2)
MA 0,v,144,v,112
MA 8,v,144,v,116
MA 64,v,144,v,120
MA 72,v,144,v,124
MA 128,v,144,v,128
MA 136,v,144,v,132
MA 192,v,144,v,136
MA 200,v,144,v,140
MA 4,v,148,v,112
MA 12,v,148,v,116
s_waitcnt vmcnt(9) lgkmcnt(0)
s_barrier
MA 68,v,148,v,120
TR 144,196,0
TR 146,196,2048
MA 76,v,148,v,124
ds_read_b128 v[80:83], v192 offset:32768
s_add_u32 m0, s23, 32768
MA 132,v,148,v,128
v_mul_f32 v71, v217, v234
v_fmac_f32 v63, v214, v231
MA 140,v,148,v,132
v_fmac_f32 v71, v215, v235
v_fmac_f32 v63, v212, v232
MA 196,v,148,v,136
buffer_load_dwordx4 v184, s[12:15], s21 offen offset:0 lds
v_fmac_f32 v71, v213, v236
MA 204,v,148,v,140
TR 148,197,0
TR 150,197,2048
MA 16,v,152,v,112
ds_read_b128 v[84:87], v192 offset:34816
v_fmac_f32 v63, v210, v233
MA 24,v,152,v,116
v_fmac_f32 v71, v211, v237
v_mul_f32 v63, v63, v250
MA 80,v,152,v,120
v_mul_f32 v71, v71, v251
v_lshlrev_b32 v250, 16, v42
MA 88,v,152,v,124
buffer_load_dwordx4 v185, s[12:15], s21 offen offset:1024 lds
v_and_b32 v251, 0xffff0000, v42
MA 144,v,152,v,128
v_mul_f32 v64, v218, v230
v_mul_f32 v72, v219, v234
MA 152,v,152,v,132
ds_read_b128 v[88:91], v192 offset:36864
v_fmac_f32 v64, v216, v231
MA 208,v,152,v,136
v_fmac_f32 v72, v217, v235
v_fmac_f32 v64, v214, v232
MA 216,v,152,v,140
TR 152,198,0
TR 154,198,2048
MA 20,v,156,v,112
buffer_load_dwordx4 v186, s[12:15], s21 offen offset:2048 lds
v_fmac_f32 v72, v215, v236
MA 28,v,156,v,116
v_fmac_f32 v64, v212, v233
v_fmac_f32 v72, v213, v237
MA 84,v,156,v,120
ds_read_b128 v[92:95], v192 offset:38912
v_mul_f32 v64, v64, v250
MA 92,v,156,v,124
v_mul_f32 v72, v72, v251
v_lshlrev_b32 v250, 16, v44
MA 148,v,156,v,128
buffer_load_dwordx4 v187, s[12:15], s21 offen offset:3072 lds
v_and_b32 v251, 0xffff0000, v44
MA 156,v,156,v,132
v_mul_f32 v65, v220, v230
v_mul_f32 v73, v221, v234
MA 212,v,156,v,136
v_fmac_f32 v65, v218, v231
v_fmac_f32 v73, v219, v235
MA 220,v,156,v,140
TR 156,199,0
TR 158,199,2048
MA 32,v,160,v,112
ds_read_b128 v[96:99], v192 offset:40960
v_fmac_f32 v65, v216, v232
MA 40,v,160,v,116
s_add_u32 m0, s23, 36864
v_fmac_f32 v73, v217, v236
MA 96,v,160,v,120
v_fmac_f32 v65, v214, v233
v_fmac_f32 v73, v215, v237
MA 104,v,160,v,124
v_mul_f32 v65, v65, v250
v_mul_f32 v73, v73, v251
MA 160,v,160,v,128
ds_read_b128 v[100:103], v192 offset:43008
v_lshlrev_b32 v250, 16, v46
MA 168,v,160,v,132
v_and_b32 v251, 0xffff0000, v46
v_mul_f32 v66, v222, v230
MA 224,v,160,v,136
buffer_load_dwordx4 v188, s[12:15], s21 offen offset:0 lds
v_mul_f32 v74, v223, v234
MA 232,v,160,v,140
TR 160,200,0
TR 162,200,2048
MA 36,v,164,v,112
v_fmac_f32 v66, v220, v231
v_fmac_f32 v74, v221, v235
MA 44,v,164,v,116
ds_read_b128 v[104:107], v192 offset:45056
v_fmac_f32 v66, v218, v232
MA 100,v,164,v,120
v_fmac_f32 v74, v219, v236
v_fmac_f32 v66, v216, v233
MA 108,v,164,v,124
buffer_load_dwordx4 v189, s[12:15], s21 offen offset:1024 lds
v_fmac_f32 v74, v217, v237
MA 164,v,164,v,128
v_mul_f32 v66, v66, v250
v_mul_f32 v74, v74, v251
MA 172,v,164,v,132
v_lshlrev_b32 v250, 16, v48
v_and_b32 v251, 0xffff0000, v48
MA 228,v,164,v,136
ds_read_b128 v[108:111], v192 offset:47104
v_mul_f32 v67, v224, v230
MA 236,v,164,v,140
TR 164,201,0
TR 166,201,2048
MA 48,v,168,v,112
buffer_load_dwordx4 v190, s[12:15], s21 offen offset:2048 lds
v_mul_f32 v75, v225, v234
MA 56,v,168,v,116
v_fmac_f32 v67, v222, v231
v_fmac_f32 v75, v223, v235
MA 112,v,168,v,120
v_fmac_f32 v67, v220, v232
v_fmac_f32 v75, v221, v236
MA 120,v,168,v,124
v_fmac_f32 v67, v218, v233
v_fmac_f32 v75, v219, v237
MA 176,v,168,v,128
buffer_load_dwordx4 v191, s[12:15], s21 offen offset:3072 lds
v_mul_f32 v67, v67, v250
MA 184,v,168,v,132
v_mul_f32 v75, v75, v251
v_lshlrev_b32 v250, 16, v50
MA 240,v,168,v,136
v_and_b32 v251, 0xffff0000, v50
v_mul_f32 v68, v226, v230
MA 248,v,168,v,140
TR 168,202,0
TR 170,202,2048
MA 52,v,172,v,112
v_mul_f32 v76, v227, v234
v_fmac_f32 v68, v224, v231
MA 60,v,172,v,116
s_add_u32 s21, s21, 524288
v_fmac_f32 v76, v225, v235
MA 116,v,172,v,120
v_fmac_f32 v68, v222, v232
v_fmac_f32 v76, v223, v236
MA 124,v,172,v,124
v_fmac_f32 v68, v220, v233
v_fmac_f32 v76, v221, v237
MA 180,v,172,v,128
v_mul_f32 v68, v68, v250
v_mul_f32 v76, v76, v251
MA 188,v,172,v,132
v_lshlrev_b32 v250, 16, v52
v_and_b32 v251, 0xffff0000, v52
MA 244,v,172,v,136
v_mul_f32 v69, v228, v230
v_mul_f32 v77, v229, v234
MA 252,v,172,v,140
TR 172,203,0
TR 174,203,2048
v_fmac_f32 v69, v226, v231
v_fmac_f32 v77, v227, v235
v_fmac_f32 v69, v224, v232
v_fmac_f32 v77, v225, v236
s_waitcnt lgkmcnt(2)
MA 0,v,144,v,80
s_add_u32 m0, s22, 0
v_fmac_f32 v69, v222, v233
MA 8,v,144,v,84
ds_read_b128 v[112:115], v193 offset:32768
v_fmac_f32 v77, v223, v237
MA 64,v,144,v,88
v_mul_f32 v69, v69, v250
v_mul_f32 v77, v77, v251
MA 72,v,144,v,92
v_cvt_pk_bf16_f32 v240, v69, v68
MA 128,v,144,v,96
v_cvt_pk_bf16_f32 v241, v67, v66
v_cvt_pk_bf16_f32 v242, v65, v64
MA 136,v,144,v,100
buffer_load_dwordx4 v176, s[8:11], s20 offen offset:0 lds
v_cvt_pk_bf16_f32 v243, v63, v62
MA 192,v,144,v,104
s_mov_b32 s72, 0
MA 200,v,144,v,108
TR 144,196,16384
TR 146,196,18432
MA 4,v,148,v,80
ds_read_b128 v[116:119], v193 offset:34816
buffer_store_dwordx4 v[240:243], v253, s[64:67], s72 offen sc1
MA 12,v,148,v,84
v_cvt_pk_bf16_f32 v244, v77, v76
v_cvt_pk_bf16_f32 v245, v75, v74
MA 68,v,148,v,88
v_cvt_pk_bf16_f32 v246, v73, v72
v_cvt_pk_bf16_f32 v247, v71, v70
MA 76,v,148,v,92
buffer_load_dwordx4 v177, s[8:11], s20 offen offset:1024 lds
s_mov_b32 s72, 4096
MA 132,v,148,v,96
buffer_store_dwordx4 v[244:247], v253, s[64:67], s72 offen sc1
v_lshlrev_b32 v230, 16, v58
MA 140,v,148,v,100
ds_read_b128 v[120:123], v193 offset:36864
v_and_b32 v231, 0xffff0000, v58
MA 196,v,148,v,104
v_lshlrev_b32 v232, 16, v59
MA 204,v,148,v,108
TR 148,197,16384
TR 150,197,18432
MA 16,v,152,v,80
buffer_load_dwordx4 v178, s[8:11], s20 offen offset:2048 lds
v_and_b32 v233, 0xffff0000, v59
MA 24,v,152,v,84
v_lshlrev_b32 v234, 16, v60
v_and_b32 v235, 0xffff0000, v60
MA 80,v,152,v,88
v_lshlrev_b32 v236, 16, v61
v_and_b32 v237, 0xffff0000, v61
MA 88,v,152,v,92
v_lshlrev_b32 v208, 16, v17
MA 144,v,152,v,96
ds_read_b128 v[124:127], v193 offset:38912
v_and_b32 v209, 0xffff0000, v17
MA 152,v,152,v,100
v_lshlrev_b32 v210, 16, v19
v_and_b32 v211, 0xffff0000, v19
MA 208,v,152,v,104
buffer_load_dwordx4 v179, s[8:11], s20 offen offset:3072 lds
v_lshlrev_b32 v212, 16, v21
MA 216,v,152,v,108
TR 152,198,16384
TR 154,198,18432
MA 20,v,156,v,80
v_and_b32 v213, 0xffff0000, v21
v_lshlrev_b32 v214, 16, v23
MA 28,v,156,v,84
v_and_b32 v215, 0xffff0000, v23
v_lshlrev_b32 v216, 16, v25
MA 84,v,156,v,88
ds_read_b128 v[128:131], v193 offset:40960
v_and_b32 v217, 0xffff0000, v25
MA 92,v,156,v,92
v_lshlrev_b32 v218, 16, v27
MA 148,v,156,v,96
s_add_u32 m0, s22, 4096
v_and_b32 v219, 0xffff0000, v27
MA 156,v,156,v,100
v_lshlrev_b32 v220, 16, v29
v_and_b32 v221, 0xffff0000, v29
MA 212,v,156,v,104
v_lshlrev_b32 v222, 16, v31
MA 220,v,156,v,108
TR 156,199,16384
TR 158,199,18432
MA 32,v,160,v,80
ds_read_b128 v[132:135], v193 offset:43008
v_and_b32 v223, 0xffff0000, v31
MA 40,v,160,v,84
buffer_load_dwordx4 v180, s[8:11], s20 offen offset:0 lds
v_lshlrev_b32 v224, 16, v33
MA 96,v,160,v,88
v_and_b32 v225, 0xffff0000, v33
v_lshlrev_b32 v226, 16, v35
MA 104,v,160,v,92
v_and_b32 v227, 0xffff0000, v35
v_lshlrev_b32 v228, 16, v37
MA 160,v,160,v,96
v_and_b32 v229, 0xffff0000, v37
MA 168,v,160,v,100
v_lshlrev_b32 v250, 16, v39
v_and_b32 v251, 0xffff0000, v39
MA 224,v,160,v,104
v_mul_f32 v62, v214, v230
MA 232,v,160,v,108
TR 160,200,16384
TR 162,200,18432
MA 36,v,164,v,80
ds_read_b128 v[136:139], v193 offset:45056
buffer_load_dwordx4 v181, s[8:11], s20 offen offset:1024 lds
MA 44,v,164,v,84
v_mul_f32 v70, v215, v234
v_fmac_f32 v62, v212, v231
MA 100,v,164,v,88
v_fmac_f32 v70, v213, v235
v_fmac_f32 v62, v210, v232
MA 108,v,164,v,92
v_fmac_f32 v70, v211, v236
v_fmac_f32 v62, v208, v233
MA 164,v,164,v,96
v_fmac_f32 v70, v209, v237
MA 172,v,164,v,100
ds_read_b128 v[140:143], v193 offset:47104
buffer_load_dwordx4 v182, s[8:11], s20 offen offset:2048 lds
MA 228,v,164,v,104
v_mul_f32 v62, v62, v250
v_mul_f32 v70, v70, v251
MA 236,v,164,v,108
TR 164,201,16384
TR 166,201,18432
MA 48,v,168,v,80
v_lshlrev_b32 v250, 16, v41
v_and_b32 v251, 0xffff0000, v41
MA 56,v,168,v,84
v_mul_f32 v63, v216, v230
v_mul_f32 v71, v217, v234
MA 112,v,168,v,88
buffer_load_dwordx4 v183, s[8:11], s20 offen offset:3072 lds
v_fmac_f32 v63, v214, v231
MA 120,v,168,v,92
v_fmac_f32 v71, v215, v235
v_fmac_f32 v63, v212, v232
MA 176,v,168,v,96
v_fmac_f32 v71, v213, v236
MA 184,v,168,v,100
v_fmac_f32 v63, v210, v233
v_fmac_f32 v71, v211, v237
MA 240,v,168,v,104
v_mul_f32 v63, v63, v250
MA 248,v,168,v,108
TR 168,202,16384
TR 170,202,18432
s_waitcnt lgkmcnt(15)
MA 52,v,172,v,80
s_add_u32 s20, s20, 128
v_mul_f32 v71, v71, v251
MA 60,v,172,v,84
v_lshlrev_b32 v250, 16, v43
v_and_b32 v251, 0xffff0000, v43
MA 116,v,172,v,88
v_mul_f32 v64, v218, v230
v_mul_f32 v72, v219, v234
MA 124,v,172,v,92
v_fmac_f32 v64, v216, v231
MA 180,v,172,v,96
v_fmac_f32 v72, v217, v235
MA 188,v,172,v,100
v_fmac_f32 v64, v214, v232
MA 244,v,172,v,104
MA 252,v,172,v,108
TR 172,203,16384
TR 174,203,18432
s_waitcnt lgkmcnt(2)
MA 0,v,144,v,112
MA 8,v,144,v,116
MA 64,v,144,v,120
MA 72,v,144,v,124
MA 128,v,144,v,128
MA 136,v,144,v,132
MA 192,v,144,v,136
MA 200,v,144,v,140
MA 4,v,148,v,112
MA 12,v,148,v,116
s_waitcnt vmcnt(10) lgkmcnt(0)
s_barrier
MA 68,v,148,v,120
TR 144,196,32768
TR 146,196,34816
MA 76,v,148,v,124
ds_read_b128 v[80:83], v194 offset:0
s_add_u32 m0, s23, 0
MA 132,v,148,v,128
s_load_dwordx2 s[32:33], s[0:1], 0
s_load_dwordx2 s[34:35], s[0:1], 64
MA 140,v,148,v,132
s_load_dwordx2 s[38:39], s[0:1], 112
v_fmac_f32 v72, v215, v236
MA 196,v,148,v,136
buffer_load_dwordx4 v184, s[12:15], s21 offen offset:0 lds
v_fmac_f32 v64, v212, v233
MA 204,v,148,v,140
TR 148,197,32768
TR 150,197,34816
MA 16,v,152,v,112
ds_read_b128 v[84:87], v194 offset:2048
v_fmac_f32 v72, v213, v237
MA 24,v,152,v,116
v_mul_f32 v64, v64, v250
v_mul_f32 v72, v72, v251
MA 80,v,152,v,120
v_lshlrev_b32 v250, 16, v45
v_and_b32 v251, 0xffff0000, v45
MA 88,v,152,v,124
buffer_load_dwordx4 v185, s[12:15], s21 offen offset:1024 lds
v_mul_f32 v65, v220, v230
MA 144,v,152,v,128
v_mul_f32 v73, v221, v234
v_fmac_f32 v65, v218, v231
MA 152,v,152,v,132
ds_read_b128 v[88:91], v194 offset:4096
v_fmac_f32 v73, v219, v235
MA 208,v,152,v,136
v_fmac_f32 v65, v216, v232
v_fmac_f32 v73, v217, v236
MA 216,v,152,v,140
TR 152,198,32768
TR 154,198,34816
MA 20,v,156,v,112
buffer_load_dwordx4 v186, s[12:15], s21 offen offset:2048 lds
v_fmac_f32 v65, v214, v233
MA 28,v,156,v,116
v_fmac_f32 v73, v215, v237
v_mul_f32 v65, v65, v250
MA 84,v,156,v,120
ds_read_b128 v[92:95], v194 offset:6144
v_mul_f32 v73, v73, v251
MA 92,v,156,v,124
v_lshlrev_b32 v250, 16, v47
v_and_b32 v251, 0xffff0000, v47
MA 148,v,156,v,128
buffer_load_dwordx4 v187, s[12:15], s21 offen offset:3072 lds
v_mul_f32 v66, v222, v230
MA 156,v,156,v,132
v_mul_f32 v74, v223, v234
v_fmac_f32 v66, v220, v231
MA 212,v,156,v,136
v_fmac_f32 v74, v221, v235
v_fmac_f32 v66, v218, v232
MA 220,v,156,v,140
TR 156,199,32768
TR 158,199,34816
MA 32,v,160,v,112
ds_read_b128 v[96:99], v194 offset:8192
v_fmac_f32 v74, v219, v236
MA 40,v,160,v,116
s_add_u32 m0, s23, 4096
v_fmac_f32 v66, v216, v233
MA 96,v,160,v,120
v_fmac_f32 v74, v217, v237
v_mul_f32 v66, v66, v250
MA 104,v,160,v,124
v_mul_f32 v74, v74, v251
v_lshlrev_b32 v250, 16, v49
MA 160,v,160,v,128
ds_read_b128 v[100:103], v194 offset:10240
v_and_b32 v251, 0xffff0000, v49
MA 168,v,160,v,132
v_mul_f32 v67, v224, v230
v_mul_f32 v75, v225, v234
MA 224,v,160,v,136
buffer_load_dwordx4 v188, s[12:15], s21 offen offset:0 lds
v_fmac_f32 v67, v222, v231
MA 232,v,160,v,140
TR 160,200,32768
TR 162,200,34816
MA 36,v,164,v,112
v_fmac_f32 v75, v223, v235
v_fmac_f32 v67, v220, v232
MA 44,v,164,v,116
ds_read_b128 v[104:107], v194 offset:12288
v_fmac_f32 v75, v221, v236
MA 100,v,164,v,120
v_fmac_f32 v67, v218, v233
v_fmac_f32 v75, v219, v237
MA 108,v,164,v,124
buffer_load_dwordx4 v189, s[12:15], s21 offen offset:1024 lds
v_mul_f32 v67, v67, v250
MA 164,v,164,v,128
v_mul_f32 v75, v75, v251
v_lshlrev_b32 v250, 16, v51
MA 172,v,164,v,132
v_and_b32 v251, 0xffff0000, v51
v_mul_f32 v68, v226, v230
MA 228,v,164,v,136
ds_read_b128 v[108:111], v194 offset:14336
v_mul_f32 v76, v227, v234
MA 236,v,164,v,140
TR 164,201,32768
TR 166,201,34816
MA 48,v,168,v,112
buffer_load_dwordx4 v190, s[12:15], s21 offen offset:2048 lds
v_fmac_f32 v68, v224, v231
MA 56,v,168,v,116
v_fmac_f32 v76, v225, v235
v_fmac_f32 v68, v222, v232
MA 112,v,168,v,120
v_fmac_f32 v76, v223, v236
v_fmac_f32 v68, v220, v233
MA 120,v,168,v,124
v_fmac_f32 v76, v221, v237
v_mul_f32 v68, v68, v250
MA 176,v,168,v,128
buffer_load_dwordx4 v191, s[12:15], s21 offen offset:3072 lds
v_mul_f32 v76, v76, v251
MA 184,v,168,v,132
v_lshlrev_b32 v250, 16, v53
v_and_b32 v251, 0xffff0000, v53
MA 240,v,168,v,136
v_mul_f32 v69, v228, v230
v_mul_f32 v77, v229, v234
MA 248,v,168,v,140
TR 168,202,32768
TR 170,202,34816
MA 52,v,172,v,112
v_fmac_f32 v69, v226, v231
v_fmac_f32 v77, v227, v235
MA 60,v,172,v,116
s_add_u32 s21, s21, 524288
v_fmac_f32 v69, v224, v232
MA 116,v,172,v,120
v_fmac_f32 v77, v225, v236
v_fmac_f32 v69, v222, v233
MA 124,v,172,v,124
v_fmac_f32 v77, v223, v237
v_mul_f32 v69, v69, v250
MA 180,v,172,v,128
v_mul_f32 v77, v77, v251
v_cvt_pk_bf16_f32 v240, v69, v68
MA 188,v,172,v,132
v_cvt_pk_bf16_f32 v241, v67, v66
v_cvt_pk_bf16_f32 v242, v65, v64
MA 244,v,172,v,136
v_cvt_pk_bf16_f32 v243, v63, v62
s_mov_b32 s72, 8192
MA 252,v,172,v,140
TR 172,203,32768
TR 174,203,34816
buffer_store_dwordx4 v[240:243], v253, s[64:67], s72 offen sc1
v_cvt_pk_bf16_f32 v244, v77, v76
v_cvt_pk_bf16_f32 v245, v75, v74
v_cvt_pk_bf16_f32 v246, v73, v72
v_cvt_pk_bf16_f32 v247, v71, v70
s_mov_b32 s72, 12288
buffer_store_dwordx4 v[244:247], v253, s[64:67], s72 offen sc1
s_waitcnt lgkmcnt(2)
MA 0,v,144,v,80
s_add_u32 m0, s22, 32768
s_and_b32 s80, s2, 7
MA 8,v,144,v,84
ds_read_b128 v[112:115], v195 offset:0
s_lshr_b32 s81, s2, 3
MA 64,v,144,v,88
s_and_b32 s69, s81, 3
s_lshl_b32 s80, s80, 2
MA 72,v,144,v,92
s_add_u32 s69, s69, s80
MA 128,v,144,v,96
s_lshr_b32 s70, s81, 2
MA 136,v,144,v,100
buffer_load_dwordx4 v176, s[8:11], s20 offen offset:0 lds
s_lshl_b32 s80, s3, 16
MA 192,v,144,v,104
s_lshl_b32 s65, s70, 18
s_sub_u32 s64, 3932160, s65
MA 200,v,144,v,108
TR 144,196,49152
TR 146,196,51200
MA 4,v,148,v,80
ds_read_b128 v[116:119], v195 offset:2048
s_add_u32 s65, s65, s80
MA 12,v,148,v,84
s_add_u32 s64, s64, s80
s_lshl_b32 s81, s69, 12
MA 68,v,148,v,88
s_lshl_b32 s100, s64, 2
MA 76,v,148,v,92
buffer_load_dwordx4 v177, s[8:11], s20 offen offset:1024 lds
s_add_u32 s100, s100, s81
MA 132,v,148,v,96
s_lshl_b32 s101, s65, 2
s_add_u32 s101, s101, s81
MA 140,v,148,v,100
ds_read_b128 v[120:123], v195 offset:4096
s_lshl_b32 s66, s3, 17
MA 196,v,148,v,104
s_lshl_b32 s81, s69, 8
MA 204,v,148,v,108
TR 148,197,49152
TR 150,197,51200
MA 16,v,152,v,80
buffer_load_dwordx4 v178, s[8:11], s20 offen offset:2048 lds
s_add_u32 s66, s66, s81
MA 24,v,152,v,84
s_lshl_b32 s67, s3, 13
s_lshl_b32 s68, s3, 12
MA 80,v,152,v,88
s_lshl_b32 s76, s70, 1
s_sub_u32 s77, 32, s76
MA 88,v,152,v,92
s_add_u32 s76, s76, 2
MA 144,v,152,v,96
ds_read_b128 v[124:127], v195 offset:6144
s_mov_b32 s79, 0x41000000
MA 152,v,152,v,100
s_mov_b32 s78, 0
MA 208,v,152,v,104
buffer_load_dwordx4 v179, s[8:11], s20 offen offset:3072 lds
v_lshrrev_b32 v240, 3, v1
MA 216,v,152,v,108
TR 152,198,49152
TR 154,198,51200
MA 20,v,156,v,80
v_lshlrev_b32 v240, 11, v240
v_lshrrev_b32 v241, 4, v1
MA 28,v,156,v,84
v_and_b32 v242, 7, v1
v_xor_b32 v242, v242, v241
MA 84,v,156,v,88
ds_read_b128 v[128:131], v195 offset:8192
v_lshl_add_u32 v240, v242, 4, v240
MA 92,v,156,v,92
v_xor_b32 v243, 64, v240
MA 148,v,156,v,96
s_add_u32 m0, s22, 36864
v_add_u32 v208, 0, v240
MA 156,v,156,v,100
v_add_u32 v209, 15360, v243
v_add_u32 v210, 30720, v240
MA 212,v,156,v,104
v_add_u32 v211, 46080, v243
MA 220,v,156,v,108
TR 156,199,49152
TR 158,199,51200
MA 32,v,160,v,80
ds_read_b128 v[132:135], v195 offset:10240
v_and_b32 v242, 15, v1
MA 40,v,160,v,84
buffer_load_dwordx4 v180, s[8:11], s20 offen offset:0 lds
v_lshlrev_b32 v243, 1, v241
MA 96,v,160,v,88
v_xor_b32 v242, v242, v243
v_lshlrev_b32 v240, 13, v241
MA 104,v,160,v,92
v_xor_b32 v243, 0, v242
v_lshl_add_u32 v243, v243, 4, v240
MA 160,v,160,v,96
v_add_u32 v212, 0, v243
MA 168,v,160,v,100
v_xor_b32 v243, 0, v242
MA 224,v,160,v,104
v_lshl_add_u32 v243, v243, 4, v240
MA 232,v,160,v,108
TR 160,200,49152
TR 162,200,51200
MA 36,v,164,v,80
ds_read_b128 v[136:139], v195 offset:12288
buffer_load_dwordx4 v181, s[8:11], s20 offen offset:1024 lds
MA 44,v,164,v,84
v_add_u32 v213, 31744, v243
v_xor_b32 v243, 8, v242
MA 100,v,164,v,88
v_lshl_add_u32 v243, v243, 4, v240
v_add_u32 v214, 63488, v243
MA 108,v,164,v,92
v_xor_b32 v243, 8, v242
v_lshl_add_u32 v243, v243, 4, v240
MA 164,v,164,v,96
v_add_u32 v215, 95232, v243
MA 172,v,164,v,100
ds_read_b128 v[140:143], v195 offset:14336
buffer_load_dwordx4 v182, s[8:11], s20 offen offset:2048 lds
MA 228,v,164,v,104
v_and_b32 v240, 15, v1
v_lshrrev_b32 v242, 1, v240
MA 236,v,164,v,108
TR 164,201,49152
TR 166,201,51200
MA 48,v,168,v,80
v_xor_b32 v242, v242, v241
v_lshlrev_b32 v242, 4, v242
MA 56,v,168,v,84
v_lshl_add_u32 v242, v240, 7, v242
v_add_u32 v224, s67, v242
MA 112,v,168,v,88
buffer_load_dwordx4 v183, s[8:11], s20 offen offset:3072 lds
v_xor_b32 v225, 64, v224
MA 120,v,168,v,92
v_add_u32 v226, 0x10000, v224
v_add_u32 v227, 0x10000, v225
MA 176,v,168,v,96
v_bfe_u32 v240, v1, 2, 2
MA 184,v,168,v,100
v_and_b32 v242, 1, v241
MA 240,v,168,v,104
v_lshl_or_b32 v242, v242, 2, v240
MA 248,v,168,v,108
TR 168,202,49152
TR 170,202,51200
s_waitcnt lgkmcnt(15)
MA 52,v,172,v,80
s_add_u32 s20, s20, 128
v_lshl_add_u32 v240, v241, 3, v240
MA 60,v,172,v,84
v_lshlrev_b32 v240, 8, v240
v_and_b32 v243, 3, v1
MA 116,v,172,v,88
v_lshl_add_u32 v240, v243, 3, v240
v_add_u32 v240, 98304, v240
MA 124,v,172,v,92
v_xor_b32 v243, 0, v242
MA 180,v,172,v,96
v_lshl_add_u32 v216, v243, 5, v240
MA 188,v,172,v,100
v_xor_b32 v243, 1, v242
MA 244,v,172,v,104
MA 252,v,172,v,108
TR 172,203,49152
TR 174,203,51200
s_waitcnt lgkmcnt(2)
MA 0,v,144,v,112
MA 8,v,144,v,116
MA 64,v,144,v,120
MA 72,v,144,v,124
MA 128,v,144,v,128
MA 136,v,144,v,132
MA 192,v,144,v,136
MA 200,v,144,v,140
MA 4,v,148,v,112
MA 12,v,148,v,116
s_waitcnt vmcnt(10) lgkmcnt(0)
s_barrier
MA 68,v,148,v,120
TR 144,196,0
TR 146,196,2048
MA 76,v,148,v,124
ds_read_b128 v[80:83], v192 offset:0
s_add_u32 m0, s23, 32768
MA 132,v,148,v,128
v_lshl_add_u32 v217, v243, 5, v240
v_xor_b32 v243, 2, v242
MA 140,v,148,v,132
v_lshl_add_u32 v218, v243, 5, v240
v_xor_b32 v243, 3, v242
MA 196,v,148,v,136
buffer_load_dwordx4 v184, s[12:15], s21 offen offset:0 lds
v_lshl_add_u32 v219, v243, 5, v240
MA 204,v,148,v,140
TR 148,197,0
TR 150,197,2048
MA 16,v,152,v,112
ds_read_b128 v[84:87], v192 offset:2048
v_xor_b32 v243, 4, v242
MA 24,v,152,v,116
v_lshl_add_u32 v220, v243, 5, v240
v_xor_b32 v243, 5, v242
MA 80,v,152,v,120
v_lshl_add_u32 v221, v243, 5, v240
v_xor_b32 v243, 6, v242
MA 88,v,152,v,124
buffer_load_dwordx4 v185, s[12:15], s21 offen offset:1024 lds
v_lshl_add_u32 v222, v243, 5, v240
MA 144,v,152,v,128
v_xor_b32 v243, 7, v242
v_lshl_add_u32 v223, v243, 5, v240
MA 152,v,152,v,132
ds_read_b128 v[88:91], v192 offset:4096
v_lshlrev_b32 v240, 4, v1
MA 208,v,152,v,136
s_lshl_b32 s80, s3, 12
MA 216,v,152,v,140
TR 152,198,0
TR 154,198,2048
MA 20,v,156,v,112
buffer_load_dwordx4 v186, s[12:15], s21 offen offset:2048 lds
v_add_u32 v12, s80, v240
MA 28,v,156,v,116
v_add_u32 v10, 0x8000, v240
v_add_u32 v11, 0x10000, v240
MA 84,v,156,v,120
ds_read_b128 v[92:95], v192 offset:6144
s_add_u32 s72, s80, 0x8000
MA 92,v,156,v,124
s_add_u32 s73, s80, 0x10000
v_and_b32 v240, 31, v1
MA 148,v,156,v,128
buffer_load_dwordx4 v187, s[12:15], s21 offen offset:3072 lds
v_lshrrev_b32 v242, 5, v1
MA 156,v,156,v,132
v_lshlrev_b32 v243, 2, v242
v_sub_u32 v13, v240, v243
MA 212,v,156,v,136
v_mov_b32 v14, 0xff800000
MA 220,v,156,v,140
TR 156,199,0
TR 158,199,2048
MA 32,v,160,v,112
ds_read_b128 v[96:99], v192 offset:8192
v_and_b32 v240, 15, v1
MA 40,v,160,v,116
s_add_u32 m0, s23, 36864
v_lshl_add_u32 v240, v242, 4, v240
MA 96,v,160,v,120
v_lshlrev_b32 v240, 4, v240
v_bfe_u32 v243, v1, 4, 1
MA 104,v,160,v,124
v_lshl_add_u32 v15, v243, 17, v240
MA 160,v,160,v,128
ds_read_b128 v[100:103], v192 offset:10240
s_mov_b32 s44, s32
MA 168,v,160,v,132
s_mov_b32 s45, s33
s_mov_b32 s46, 4194304
MA 224,v,160,v,136
buffer_load_dwordx4 v188, s[12:15], s21 offen offset:0 lds
s_mov_b32 s47, 0x20000
MA 232,v,160,v,140
TR 160,200,0
TR 162,200,2048
MA 36,v,164,v,112
s_mov_b32 s48, s34
s_mov_b32 s49, s35
MA 44,v,164,v,116
ds_read_b128 v[104:107], v192 offset:12288
s_mov_b32 s50, 8388608
MA 100,v,164,v,120
s_mov_b32 s51, 0x20000
MA 108,v,164,v,124
buffer_load_dwordx4 v189, s[12:15], s21 offen offset:1024 lds
MA 164,v,164,v,128
s_add_u32 s60, s40, 33554432
s_addc_u32 s61, s41, 0
MA 172,v,164,v,132
s_mov_b32 s62, 16777216
s_mov_b32 s63, 0x20000
MA 228,v,164,v,136
ds_read_b128 v[108:111], v192 offset:14336
s_lshl_b32 s80, s69, 19
MA 236,v,164,v,140
TR 164,201,0
TR 166,201,2048
MA 48,v,168,v,112
buffer_load_dwordx4 v190, s[12:15], s21 offen offset:2048 lds
MA 56,v,168,v,116
s_add_u32 s52, s40, s80
s_addc_u32 s53, s41, 0
MA 112,v,168,v,120
s_lshl_b32 s54, s77, 14
s_mov_b32 s55, 0x20000
MA 120,v,168,v,124
s_add_u32 s80, s80, 16760832
MA 176,v,168,v,128
buffer_load_dwordx4 v191, s[12:15], s21 offen offset:3072 lds
MA 184,v,168,v,132
s_add_u32 s56, s40, s80
s_addc_u32 s57, s41, 0
MA 240,v,168,v,136
s_add_u32 s58, s54, 16384
s_mov_b32 s59, 0x20000
MA 248,v,168,v,140
TR 168,202,0
TR 170,202,2048
MA 52,v,172,v,112
v_bfe_u32 v230, v1, 4, 1
v_lshlrev_b32 v230, 10, v230
MA 60,v,172,v,116
s_add_u32 s21, s21, 524288
v_bfe_u32 v231, v1, 3, 1
MA 116,v,172,v,120
v_lshl_add_u32 v230, v231, 8, v230
v_and_b32 v231, 7, v1
MA 124,v,172,v,124
v_lshl_add_u32 v230, v231, 4, v230
MA 180,v,172,v,128
v_lshrrev_b32 v231, 5, v1
MA 188,v,172,v,132
v_lshl_add_u32 v228, v231, 9, v230
MA 244,v,172,v,136
MA 252,v,172,v,140
TR 172,203,0
TR 174,203,2048
s_waitcnt lgkmcnt(2)
MA 0,v,144,v,80
s_add_u32 m0, s67, 65536
MA 8,v,144,v,84
ds_read_b128 v[112:115], v193 offset:0
MA 64,v,144,v,88
MA 72,v,144,v,92
MA 128,v,144,v,96
MA 136,v,144,v,100
buffer_load_dwordx4 v208, s[44:47], s64 offen offset:0 lds
MA 192,v,144,v,104
MA 200,v,144,v,108
TR 144,196,16384
TR 146,196,18432
MA 4,v,148,v,80
ds_read_b128 v[116:119], v193 offset:2048
MA 12,v,148,v,84
MA 68,v,148,v,88
buffer_load_dwordx4 v209, s[44:47], s64 offen offset:1024 lds
MA 76,v,148,v,92
MA 132,v,148,v,96
MA 140,v,148,v,100
ds_read_b128 v[120:123], v193 offset:4096
MA 196,v,148,v,104
MA 204,v,148,v,108
TR 148,197,16384
TR 150,197,18432
MA 16,v,152,v,80
buffer_load_dwordx4 v210, s[44:47], s64 offen offset:2048 lds
MA 24,v,152,v,84
MA 80,v,152,v,88
MA 88,v,152,v,92
MA 144,v,152,v,96
ds_read_b128 v[124:127], v193 offset:6144
buffer_load_dwordx4 v211, s[44:47], s64 offen offset:3072 lds
MA 152,v,152,v,100
MA 208,v,152,v,104
MA 216,v,152,v,108
TR 152,198,16384
TR 154,198,18432
MA 20,v,156,v,80
MA 28,v,156,v,84
s_add_u32 s64, s64, 128
MA 84,v,156,v,88
ds_read_b128 v[128:131], v193 offset:8192
MA 92,v,156,v,92
MA 148,v,156,v,96
MA 156,v,156,v,100
MA 212,v,156,v,104
MA 220,v,156,v,108
TR 156,199,16384
TR 158,199,18432
MA 32,v,160,v,80
ds_read_b128 v[132:135], v193 offset:10240
s_add_u32 m0, s67, 69632
MA 40,v,160,v,84
MA 96,v,160,v,88
MA 104,v,160,v,92
MA 160,v,160,v,96
buffer_load_dwordx4 v208, s[44:47], s65 offen offset:0 lds
MA 168,v,160,v,100
MA 224,v,160,v,104
MA 232,v,160,v,108
TR 160,200,16384
TR 162,200,18432
MA 36,v,164,v,80
ds_read_b128 v[136:139], v193 offset:12288
MA 44,v,164,v,84
buffer_load_dwordx4 v209, s[44:47], s65 offen offset:1024 lds
MA 100,v,164,v,88
MA 108,v,164,v,92
MA 164,v,164,v,96
MA 172,v,164,v,100
ds_read_b128 v[140:143], v193 offset:14336
MA 228,v,164,v,104
buffer_load_dwordx4 v210, s[44:47], s65 offen offset:2048 lds
MA 236,v,164,v,108
TR 164,201,16384
TR 166,201,18432
MA 48,v,168,v,80
MA 56,v,168,v,84
MA 112,v,168,v,88
MA 120,v,168,v,92
buffer_load_dwordx4 v211, s[44:47], s65 offen offset:3072 lds
MA 176,v,168,v,96
MA 184,v,168,v,100
MA 240,v,168,v,104
MA 248,v,168,v,108
TR 168,202,16384
TR 170,202,18432
s_waitcnt lgkmcnt(15)
MA 52,v,172,v,80
s_add_u32 s65, s65, 128
MA 60,v,172,v,84
MA 116,v,172,v,88
MA 124,v,172,v,92
MA 180,v,172,v,96
MA 188,v,172,v,100
MA 244,v,172,v,104
MA 252,v,172,v,108
TR 172,203,16384
TR 174,203,18432
s_waitcnt lgkmcnt(2)
MA 0,v,144,v,112
MA 8,v,144,v,116
MA 64,v,144,v,120
MA 72,v,144,v,124
MA 128,v,144,v,128
MA 136,v,144,v,132
MA 192,v,144,v,136
MA 200,v,144,v,140
MA 4,v,148,v,112
MA 12,v,148,v,116
s_waitcnt vmcnt(8) lgkmcnt(0)
s_barrier
MA 68,v,148,v,120
TR 144,196,32768
TR 146,196,34816
MA 76,v,148,v,124
ds_read_b128 v[80:83], v192 offset:32768
s_add_u32 m0, s68, 98304
MA 132,v,148,v,128
MA 140,v,148,v,132
MA 196,v,148,v,136
buffer_load_dwordx4 v212, s[48:51], s66 offen offset:0 lds
MA 204,v,148,v,140
TR 148,197,32768
TR 150,197,34816
MA 16,v,152,v,112
ds_read_b128 v[84:87], v192 offset:34816
MA 24,v,152,v,116
MA 80,v,152,v,120
buffer_load_dwordx4 v213, s[48:51], s66 offen offset:1024 lds
MA 88,v,152,v,124
MA 144,v,152,v,128
MA 152,v,152,v,132
ds_read_b128 v[88:91], v192 offset:36864
MA 208,v,152,v,136
MA 216,v,152,v,140
TR 152,198,32768
TR 154,198,34816
MA 20,v,156,v,112
buffer_load_dwordx4 v214, s[48:51], s66 offen offset:2048 lds
MA 28,v,156,v,116
MA 84,v,156,v,120
ds_read_b128 v[92:95], v192 offset:38912
MA 92,v,156,v,124
buffer_load_dwordx4 v215, s[48:51], s66 offen offset:3072 lds
MA 148,v,156,v,128
MA 156,v,156,v,132
MA 212,v,156,v,136
MA 220,v,156,v,140
TR 156,199,32768
TR 158,199,34816
MA 32,v,160,v,112
ds_read_b128 v[96:99], v192 offset:40960
s_add_u32 s66, s66, 524288
MA 40,v,160,v,116
MA 96,v,160,v,120
MA 104,v,160,v,124
MA 160,v,160,v,128
ds_read_b128 v[100:103], v192 offset:43008
s_add_u32 m0, s68, 114688
MA 168,v,160,v,132
MA 224,v,160,v,136
MA 232,v,160,v,140
TR 160,200,32768
TR 162,200,34816
MA 36,v,164,v,112
buffer_load_dwordx4 v212, s[48:51], s66 offen offset:0 lds
MA 44,v,164,v,116
ds_read_b128 v[104:107], v192 offset:45056
MA 100,v,164,v,120
MA 108,v,164,v,124
MA 164,v,164,v,128
buffer_load_dwordx4 v213, s[48:51], s66 offen offset:1024 lds
MA 172,v,164,v,132
MA 228,v,164,v,136
ds_read_b128 v[108:111], v192 offset:47104
MA 236,v,164,v,140
TR 164,201,32768
TR 166,201,34816
MA 48,v,168,v,112
MA 56,v,168,v,116
buffer_load_dwordx4 v214, s[48:51], s66 offen offset:2048 lds
MA 112,v,168,v,120
MA 120,v,168,v,124
MA 176,v,168,v,128
MA 184,v,168,v,132
buffer_load_dwordx4 v215, s[48:51], s66 offen offset:3072 lds
MA 240,v,168,v,136
MA 248,v,168,v,140
TR 168,202,32768
TR 170,202,34816
MA 52,v,172,v,112
MA 60,v,172,v,116
s_add_u32 s66, s66, 524288
MA 116,v,172,v,120
MA 124,v,172,v,124
MA 180,v,172,v,128
MA 188,v,172,v,132
MA 244,v,172,v,136
MA 252,v,172,v,140
TR 172,203,32768
TR 174,203,34816
s_waitcnt lgkmcnt(2)
MA 0,v,144,v,80
s_add_u32 m0, s67, 0
MA 8,v,144,v,84
ds_read_b128 v[112:115], v193 offset:32768
MA 64,v,144,v,88
MA 72,v,144,v,92
MA 128,v,144,v,96
MA 136,v,144,v,100
buffer_load_dwordx4 v208, s[44:47], s64 offen offset:0 lds
MA 192,v,144,v,104
MA 200,v,144,v,108
TR 144,196,49152
TR 146,196,51200
MA 4,v,148,v,80
ds_read_b128 v[116:119], v193 offset:34816
MA 12,v,148,v,84
MA 68,v,148,v,88
buffer_load_dwordx4 v209, s[44:47], s64 offen offset:1024 lds
MA 76,v,148,v,92
MA 132,v,148,v,96
MA 140,v,148,v,100
ds_read_b128 v[120:123], v193 offset:36864
MA 196,v,148,v,104
MA 204,v,148,v,108
TR 148,197,49152
TR 150,197,51200
MA 16,v,152,v,80
buffer_load_dwordx4 v210, s[44:47], s64 offen offset:2048 lds
MA 24,v,152,v,84
MA 80,v,152,v,88
MA 88,v,152,v,92
MA 144,v,152,v,96
ds_read_b128 v[124:127], v193 offset:38912
buffer_load_dwordx4 v211, s[44:47], s64 offen offset:3072 lds
MA 152,v,152,v,100
MA 208,v,152,v,104
MA 216,v,152,v,108
TR 152,198,49152
TR 154,198,51200
MA 20,v,156,v,80
MA 28,v,156,v,84
s_add_u32 s64, s64, 128
MA 84,v,156,v,88
ds_read_b128 v[128:131], v193 offset:40960
MA 92,v,156,v,92
MA 148,v,156,v,96
MA 156,v,156,v,100
MA 212,v,156,v,104
MA 220,v,156,v,108
TR 156,199,49152
TR 158,199,51200
MA 32,v,160,v,80
ds_read_b128 v[132:135], v193 offset:43008
s_add_u32 m0, s67, 4096
MA 40,v,160,v,84
MA 96,v,160,v,88
MA 104,v,160,v,92
MA 160,v,160,v,96
buffer_load_dwordx4 v208, s[44:47], s65 offen offset:0 lds
MA 168,v,160,v,100
MA 224,v,160,v,104
MA 232,v,160,v,108
TR 160,200,49152
TR 162,200,51200
MA 36,v,164,v,80
ds_read_b128 v[136:139], v193 offset:45056
MA 44,v,164,v,84
buffer_load_dwordx4 v209, s[44:47], s65 offen offset:1024 lds
MA 100,v,164,v,88
MA 108,v,164,v,92
MA 164,v,164,v,96
MA 172,v,164,v,100
ds_read_b128 v[140:143], v193 offset:47104
MA 228,v,164,v,104
buffer_load_dwordx4 v210, s[44:47], s65 offen offset:2048 lds
MA 236,v,164,v,108
TR 164,201,49152
TR 166,201,51200
MA 48,v,168,v,80
MA 56,v,168,v,84
MA 112,v,168,v,88
MA 120,v,168,v,92
buffer_load_dwordx4 v211, s[44:47], s65 offen offset:3072 lds
MA 176,v,168,v,96
MA 184,v,168,v,100
MA 240,v,168,v,104
MA 248,v,168,v,108
TR 168,202,49152
TR 170,202,51200
s_waitcnt lgkmcnt(15)
MA 52,v,172,v,80
s_add_u32 s65, s65, 128
MA 60,v,172,v,84
MA 116,v,172,v,88
MA 124,v,172,v,92
MA 180,v,172,v,96
MA 188,v,172,v,100
MA 244,v,172,v,104
MA 252,v,172,v,108
TR 172,203,49152
TR 174,203,51200
s_waitcnt lgkmcnt(2)
MA 0,v,144,v,112
MA 8,v,144,v,116
MA 64,v,144,v,120
MA 72,v,144,v,124
MA 128,v,144,v,128
MA 136,v,144,v,132
MA 192,v,144,v,136
MA 200,v,144,v,140
MA 4,v,148,v,112
MA 12,v,148,v,116
s_waitcnt vmcnt(12) lgkmcnt(0)
s_barrier
MA 68,v,148,v,120
ds_read_b128 v[48:51], v226 offset:0
s_add_u32 m0, s68, 131072
MA 76,v,148,v,124
MA 132,v,148,v,128
ds_read_b128 v[52:55], v226 offset:2048
buffer_load_dwordx4 v212, s[48:51], s66 offen offset:0 lds
MA 140,v,148,v,132
MA 196,v,148,v,136
ds_read_b128 v[56:59], v226 offset:4096
MA 204,v,148,v,140
buffer_load_dwordx4 v213, s[48:51], s66 offen offset:1024 lds
MA 16,v,152,v,112
ds_read_b128 v[60:63], v226 offset:6144
MA 24,v,152,v,116
MA 80,v,152,v,120
TR 16,216,0
buffer_load_dwordx4 v214, s[48:51], s66 offen offset:2048 lds
MA 88,v,152,v,124
MA 144,v,152,v,128
TR 18,216,1024
MA 152,v,152,v,132
buffer_load_dwordx4 v215, s[48:51], s66 offen offset:3072 lds
MA 208,v,152,v,136
TR 20,217,0
MA 216,v,152,v,140
MA 20,v,156,v,112
TR 22,217,1024
s_add_u32 s66, s66, 524288
MA 28,v,156,v,116
MA 84,v,156,v,120
TR 24,218,0
MA 92,v,156,v,124
s_add_u32 m0, s67, 32768
MA 148,v,156,v,128
TR 26,218,1024
MA 156,v,156,v,132
MA 212,v,156,v,136
TR 28,219,0
buffer_load_dwordx4 v208, s[44:47], s64 offen offset:0 lds
MA 220,v,156,v,140
MA 32,v,160,v,112
TR 30,219,1024
MA 40,v,160,v,116
buffer_load_dwordx4 v209, s[44:47], s64 offen offset:1024 lds
MA 96,v,160,v,120
TR 32,220,0
MA 104,v,160,v,124
MA 160,v,160,v,128
TR 34,220,1024
buffer_load_dwordx4 v210, s[44:47], s64 offen offset:2048 lds
MA 168,v,160,v,132
MA 224,v,160,v,136
TR 36,221,0
buffer_load_dwordx4 v211, s[44:47], s64 offen offset:3072 lds
MA 232,v,160,v,140
MA 36,v,164,v,112
TR 38,221,1024
MA 44,v,164,v,116
s_add_u32 s64, s64, 128
MA 100,v,164,v,120
TR 40,222,0
MA 108,v,164,v,124
MA 164,v,164,v,128
TR 42,222,1024
s_add_u32 m0, s67, 36864
MA 172,v,164,v,132
MA 228,v,164,v,136
TR 44,223,0
MA 236,v,164,v,140
buffer_load_dwordx4 v208, s[44:47], s65 offen offset:0 lds
MA 48,v,168,v,112
TR 46,223,1024
MA 56,v,168,v,116
MA 112,v,168,v,120
buffer_load_dwordx4 v209, s[44:47], s65 offen offset:1024 lds
MA 120,v,168,v,124
MA 176,v,168,v,128
MA 184,v,168,v,132
buffer_load_dwordx4 v210, s[44:47], s65 offen offset:2048 lds
MA 240,v,168,v,136
MA 248,v,168,v,140
MA 52,v,172,v,112
buffer_load_dwordx4 v211, s[44:47], s65 offen offset:3072 lds
MA 60,v,172,v,116
MA 116,v,172,v,120
MA 124,v,172,v,124
s_add_u32 s65, s65, 128
MA 180,v,172,v,128
MA 188,v,172,v,132
MA 244,v,172,v,136
MA 252,v,172,v,140
s_branch L_p2
L_p1_V:
s_waitcnt lgkmcnt(14)
v_mfma_f32_16x16x32_bf16 a[0:3], v[80:83], v[144:147], 0
s_add_u32 m0, s22, 65536
s_mov_b32 s56, s76
v_mfma_f32_16x16x32_bf16 a[4:7], v[84:87], v[144:147], 0
ds_read_b128 v[112:115], v193 offset:0
s_mov_b32 s57, s77
v_mfma_f32_16x16x32_bf16 a[64:67], v[88:91], v[144:147], 0
s_mov_b32 s58, 4194304
v_mfma_f32_16x16x32_bf16 a[68:71], v[92:95], v[144:147], 0
s_mov_b32 s59, 0x20000
v_mfma_f32_16x16x32_bf16 a[128:131], v[96:99], v[144:147], 0
s_mov_b32 s44, s78
v_mfma_f32_16x16x32_bf16 a[132:135], v[100:103], v[144:147], 0
buffer_load_dwordx4 v176, s[8:11], s20 offen offset:0 lds
s_mov_b32 s45, s79
v_mfma_f32_16x16x32_bf16 a[192:195], v[104:107], v[144:147], 0
s_mov_b32 s46, 4194304
v_mfma_f32_16x16x32_bf16 a[196:199], v[108:111], v[144:147], 0
TR 144,196,16384
TR 146,196,18432
s_waitcnt lgkmcnt(15)
v_mfma_f32_16x16x32_bf16 a[8:11], v[80:83], v[148:151], 0
ds_read_b128 v[116:119], v193 offset:2048
s_mov_b32 s47, 0x20000
v_mfma_f32_16x16x32_bf16 a[12:15], v[84:87], v[148:151], 0
s_mov_b32 s48, s80
s_mov_b32 s49, s81
v_mfma_f32_16x16x32_bf16 a[72:75], v[88:91], v[148:151], 0
s_mov_b32 s50, 4194304
v_mfma_f32_16x16x32_bf16 a[76:79], v[92:95], v[148:151], 0
buffer_load_dwordx4 v177, s[8:11], s20 offen offset:1024 lds
s_mov_b32 s51, 0x20000
v_mfma_f32_16x16x32_bf16 a[136:139], v[96:99], v[148:151], 0
s_mov_b32 s52, s82
v_mfma_f32_16x16x32_bf16 a[140:143], v[100:103], v[148:151], 0
ds_read_b128 v[120:123], v193 offset:4096
s_mov_b32 s53, s83
v_mfma_f32_16x16x32_bf16 a[200:203], v[104:107], v[148:151], 0
s_mov_b32 s54, 8192
v_mfma_f32_16x16x32_bf16 a[204:207], v[108:111], v[148:151], 0
TR 148,197,16384
TR 150,197,18432
s_waitcnt lgkmcnt(15)
v_mfma_f32_16x16x32_bf16 a[16:19], v[80:83], v[152:155], 0
buffer_load_dwordx4 v178, s[8:11], s20 offen offset:2048 lds
s_mov_b32 s55, 0x20000
v_mfma_f32_16x16x32_bf16 a[20:23], v[84:87], v[152:155], 0
s_mov_b32 s60, s84
s_mov_b32 s61, s85
v_mfma_f32_16x16x32_bf16 a[80:83], v[88:91], v[152:155], 0
s_mov_b32 s62, 2048
v_mfma_f32_16x16x32_bf16 a[84:87], v[92:95], v[152:155], 0
s_mov_b32 s63, 0x20000
v_mfma_f32_16x16x32_bf16 a[144:147], v[96:99], v[152:155], 0
ds_read_b128 v[124:127], v193 offset:6144
v_mfma_f32_16x16x32_bf16 a[148:151], v[100:103], v[152:155], 0
s_add_u32 s64, s40, 50331648
s_addc_u32 s65, s41, 0
v_mfma_f32_16x16x32_bf16 a[208:211], v[104:107], v[152:155], 0
buffer_load_dwordx4 v179, s[8:11], s20 offen offset:3072 lds
s_mov_b32 s66, 4194304
v_mfma_f32_16x16x32_bf16 a[212:215], v[108:111], v[152:155], 0
TR 152,198,16384
TR 154,198,18432
v_mfma_f32_16x16x32_bf16 a[24:27], v[80:83], v[156:159], 0
s_mov_b32 s67, 0x20000
v_mfma_f32_16x16x32_bf16 a[28:31], v[84:87], v[156:159], 0
s_add_u32 s68, s40, 58720256
s_addc_u32 s69, s41, 0
v_mfma_f32_16x16x32_bf16 a[88:91], v[88:91], v[156:159], 0
ds_read_b128 v[128:131], v193 offset:8192
s_mov_b32 s70, 8192
v_mfma_f32_16x16x32_bf16 a[92:95], v[92:95], v[156:159], 0
s_mov_b32 s71, 0x20000
v_mfma_f32_16x16x32_bf16 a[152:155], v[96:99], v[156:159], 0
s_add_u32 m0, s22, 69632
s_and_b32 s72, s2, 15
v_mfma_f32_16x16x32_bf16 a[156:159], v[100:103], v[156:159], 0
s_lshl_b32 s72, s72, 2
v_mfma_f32_16x16x32_bf16 a[216:219], v[104:107], v[156:159], 0
s_add_u32 s72, s72, s3
v_mfma_f32_16x16x32_bf16 a[220:223], v[108:111], v[156:159], 0
TR 156,199,16384
TR 158,199,18432
s_waitcnt lgkmcnt(15)
v_mfma_f32_16x16x32_bf16 a[32:35], v[80:83], v[160:163], 0
ds_read_b128 v[132:135], v193 offset:10240
s_lshr_b32 s73, s2, 4
v_mfma_f32_16x16x32_bf16 a[36:39], v[84:87], v[160:163], 0
buffer_load_dwordx4 v180, s[8:11], s20 offen offset:0 lds
v_and_b32 v248, 3, v1
v_mfma_f32_16x16x32_bf16 a[96:99], v[88:91], v[160:163], 0
v_lshrrev_b32 v249, 2, v1
s_lshl_b32 s74, s72, 2
v_mfma_f32_16x16x32_bf16 a[100:103], v[92:95], v[160:163], 0
v_add_u32 v248, s74, v248
v_mfma_f32_16x16x32_bf16 a[160:163], v[96:99], v[160:163], 0
s_lshl_b32 s74, s73, 4
v_mfma_f32_16x16x32_bf16 a[164:167], v[100:103], v[160:163], 0
v_add_u32 v249, s74, v249
v_mfma_f32_16x16x32_bf16 a[224:227], v[104:107], v[160:163], 0
v_lshlrev_b32 v250, 14, v249
v_mfma_f32_16x16x32_bf16 a[228:231], v[108:111], v[160:163], 0
TR 160,200,16384
TR 162,200,18432
v_mfma_f32_16x16x32_bf16 a[40:43], v[80:83], v[164:167], 0
ds_read_b128 v[136:139], v193 offset:12288
buffer_load_dwordx4 v181, s[8:11], s20 offen offset:1024 lds
v_mfma_f32_16x16x32_bf16 a[44:47], v[84:87], v[164:167], 0
v_lshl_add_u32 v250, v248, 3, v250
v_add_u32 v252, -6144, v250
v_mfma_f32_16x16x32_bf16 a[104:107], v[88:91], v[164:167], 0
v_lshlrev_b32 v254, 5, v248
v_lshlrev_b32 v250, 4, v249
v_mfma_f32_16x16x32_bf16 a[108:111], v[92:95], v[164:167], 0
v_sub_u32 v250, 4080, v250
v_mfma_f32_16x16x32_bf16 a[168:171], v[96:99], v[164:167], 0
v_lshl_add_u32 v253, v248, 14, v250
v_mfma_f32_16x16x32_bf16 a[172:175], v[100:103], v[164:167], 0
ds_read_b128 v[140:143], v193 offset:14336
buffer_load_dwordx4 v182, s[8:11], s20 offen offset:2048 lds
v_mfma_f32_16x16x32_bf16 a[232:235], v[104:107], v[164:167], 0
v_and_b32 v248, 31, v1
v_lshlrev_b32 v78, 4, v248
v_mfma_f32_16x16x32_bf16 a[236:239], v[108:111], v[164:167], 0
TR 164,201,16384
TR 166,201,18432
v_mfma_f32_16x16x32_bf16 a[48:51], v[80:83], v[168:171], 0
s_lshl_b32 s74, s2, 2
s_add_u32 s74, s74, s3
v_mfma_f32_16x16x32_bf16 a[52:55], v[84:87], v[168:171], 0
s_lshl_b32 s74, s74, 1
v_mfma_f32_16x16x32_bf16 a[112:115], v[88:91], v[168:171], 0
buffer_load_dwordx4 v183, s[8:11], s20 offen offset:3072 lds
v_lshrrev_b32 v249, 5, v1
v_mfma_f32_16x16x32_bf16 a[116:119], v[92:95], v[168:171], 0
v_add_u32 v249, s74, v249
v_mfma_f32_16x16x32_bf16 a[176:179], v[96:99], v[168:171], 0
v_lshl_add_u32 v255, v249, 11, v78
v_mfma_f32_16x16x32_bf16 a[180:183], v[100:103], v[168:171], 0
v_lshlrev_b32 v249, 2, v249
v_mfma_f32_16x16x32_bf16 a[240:243], v[104:107], v[168:171], 0
v_lshl_add_u32 v79, v248, 20, v249
v_mfma_f32_16x16x32_bf16 a[244:247], v[108:111], v[168:171], 0
TR 168,202,16384
TR 170,202,18432
s_waitcnt lgkmcnt(15)
v_mfma_f32_16x16x32_bf16 a[56:59], v[80:83], v[172:175], 0
s_add_u32 s20, s20, 128
s_add_u32 s25, s24, 256
v_mfma_f32_16x16x32_bf16 a[60:63], v[84:87], v[172:175], 0
s_add_u32 s26, s24, 1024
s_add_u32 s27, s24, 1280
v_mfma_f32_16x16x32_bf16 a[120:123], v[88:91], v[172:175], 0
s_add_u32 s28, s24, 2048
v_mfma_f32_16x16x32_bf16 a[124:127], v[92:95], v[172:175], 0
s_add_u32 s29, s24, 2304
v_mfma_f32_16x16x32_bf16 a[184:187], v[96:99], v[172:175], 0
s_add_u32 s30, s24, 3072
v_mfma_f32_16x16x32_bf16 a[188:191], v[100:103], v[172:175], 0
s_add_u32 s31, s24, 3328
v_mfma_f32_16x16x32_bf16 a[248:251], v[104:107], v[172:175], 0
v_mfma_f32_16x16x32_bf16 a[252:255], v[108:111], v[172:175], 0
TR 172,203,16384
TR 174,203,18432
s_waitcnt lgkmcnt(2)
MA 0,v,112,v,144
MA 4,v,116,v,144
MA 64,v,120,v,144
MA 68,v,124,v,144
MA 128,v,128,v,144
MA 132,v,132,v,144
MA 192,v,136,v,144
MA 196,v,140,v,144
MA 8,v,112,v,148
MA 12,v,116,v,148
s_waitcnt vmcnt(12) lgkmcnt(0)
s_barrier
MA 72,v,120,v,148
TR 144,196,32768
TR 146,196,34816
MA 76,v,124,v,148
ds_read_b128 v[80:83], v192 offset:32768
s_add_u32 m0, s23, 0
MA 136,v,128,v,148
buffer_load_dwordx4 v[208:211], v255, s[56:59], 0 offen offset:0
MA 140,v,132,v,148
MA 200,v,136,v,148
buffer_load_dwordx4 v184, s[12:15], s21 offen offset:0 lds
buffer_load_dwordx4 v[224:227], v78, s[60:63], 0 offen offset:0
MA 204,v,140,v,148
TR 148,197,32768
TR 150,197,34816
MA 16,v,112,v,152
ds_read_b128 v[84:87], v192 offset:34816
MA 20,v,116,v,152
MA 80,v,120,v,152
buffer_load_dwordx4 v[212:215], v255, s[56:59], 0 offen offset:512
MA 84,v,124,v,152
buffer_load_dwordx4 v185, s[12:15], s21 offen offset:1024 lds
MA 144,v,128,v,152
MA 148,v,132,v,152
ds_read_b128 v[88:91], v192 offset:36864
MA 208,v,136,v,152
buffer_load_dwordx4 v[228:231], v78, s[60:63], 0 offen offset:512
MA 212,v,140,v,152
TR 152,198,32768
TR 154,198,34816
MA 24,v,112,v,156
buffer_load_dwordx4 v186, s[12:15], s21 offen offset:2048 lds
MA 28,v,116,v,156
MA 88,v,120,v,156
ds_read_b128 v[92:95], v192 offset:38912
buffer_load_dwordx4 v[216:219], v255, s[56:59], 0 offen offset:1024
MA 92,v,124,v,156
MA 152,v,128,v,156
buffer_load_dwordx4 v187, s[12:15], s21 offen offset:3072 lds
MA 156,v,132,v,156
MA 216,v,136,v,156
buffer_load_dwordx4 v[232:235], v78, s[60:63], 0 offen offset:1024
MA 220,v,140,v,156
TR 156,199,32768
TR 158,199,34816
MA 32,v,112,v,160
ds_read_b128 v[96:99], v192 offset:40960
MA 36,v,116,v,160
s_add_u32 m0, s23, 4096
MA 96,v,120,v,160
buffer_load_dwordx4 v[220:223], v255, s[56:59], 0 offen offset:1536
MA 100,v,124,v,160
MA 160,v,128,v,160
ds_read_b128 v[100:103], v192 offset:43008
MA 164,v,132,v,160
MA 224,v,136,v,160
buffer_load_dwordx4 v188, s[12:15], s21 offen offset:0 lds
buffer_load_dwordx4 v[236:239], v78, s[60:63], 0 offen offset:1536
MA 228,v,140,v,160
TR 160,200,32768
TR 162,200,34816
MA 40,v,112,v,164
MA 44,v,116,v,164
ds_read_b128 v[104:107], v192 offset:45056
MA 104,v,120,v,164
buffer_load_dwordx4 v[54:57], v254, s[52:55], 0 offen offset:0
MA 108,v,124,v,164
buffer_load_dwordx4 v189, s[12:15], s21 offen offset:1024 lds
MA 168,v,128,v,164
MA 172,v,132,v,164
MA 232,v,136,v,164
ds_read_b128 v[108:111], v192 offset:47104
buffer_load_dwordx4 v[58:61], v254, s[52:55], 0 offen offset:16
MA 236,v,140,v,164
TR 164,201,32768
TR 166,201,34816
MA 48,v,112,v,168
buffer_load_dwordx4 v190, s[12:15], s21 offen offset:2048 lds
MA 52,v,116,v,168
MA 112,v,120,v,168
v_add_u32 v248, 0, v252
MA 116,v,124,v,168
MA 176,v,128,v,168
buffer_load_dwordx4 v191, s[12:15], s21 offen offset:3072 lds
MA 180,v,132,v,168
MA 240,v,136,v,168
buffer_load_dwordx2 v[16:17], v248, s[44:47], 0 offen
MA 244,v,140,v,168
TR 168,202,32768
TR 170,202,34816
MA 56,v,112,v,172
MA 60,v,116,v,172
s_add_u32 s21, s21, 524288
MA 120,v,120,v,172
v_add_u32 v249, 2048, v252
MA 124,v,124,v,172
MA 184,v,128,v,172
MA 188,v,132,v,172
MA 248,v,136,v,172
MA 252,v,140,v,172
TR 172,203,32768
TR 174,203,34816
s_waitcnt lgkmcnt(2)
MA 0,v,80,v,144
s_add_u32 m0, s22, 0
buffer_load_dwordx2 v[18:19], v249, s[44:47], 0 offen
MA 4,v,84,v,144
ds_read_b128 v[112:115], v193 offset:32768
MA 64,v,88,v,144
MA 68,v,92,v,144
MA 128,v,96,v,144
v_add_u32 v250, 4096, v252
MA 132,v,100,v,144
buffer_load_dwordx4 v176, s[8:11], s20 offen offset:0 lds
MA 192,v,104,v,144
MA 196,v,108,v,144
TR 144,196,49152
TR 146,196,51200
MA 8,v,80,v,148
ds_read_b128 v[116:119], v193 offset:34816
MA 12,v,84,v,148
buffer_load_dwordx2 v[20:21], v250, s[44:47], 0 offen
MA 72,v,88,v,148
MA 76,v,92,v,148
buffer_load_dwordx4 v177, s[8:11], s20 offen offset:1024 lds
MA 136,v,96,v,148
MA 140,v,100,v,148
ds_read_b128 v[120:123], v193 offset:36864
MA 200,v,104,v,148
v_add_u32 v251, 6144, v252
MA 204,v,108,v,148
TR 148,197,49152
TR 150,197,51200
MA 16,v,80,v,152
buffer_load_dwordx4 v178, s[8:11], s20 offen offset:2048 lds
MA 20,v,84,v,152
MA 80,v,88,v,152
MA 84,v,92,v,152
buffer_load_dwordx2 v[22:23], v251, s[44:47], 0 offen
MA 144,v,96,v,152
ds_read_b128 v[124:127], v193 offset:38912
MA 148,v,100,v,152
MA 208,v,104,v,152
buffer_load_dwordx4 v179, s[8:11], s20 offen offset:3072 lds
MA 212,v,108,v,152
TR 152,198,49152
TR 154,198,51200
MA 24,v,80,v,156
buffer_load_dwordx2 v[38:39], v251, s[48:51], 0 offen
MA 28,v,84,v,156
MA 88,v,88,v,156
ds_read_b128 v[128:131], v193 offset:40960
MA 92,v,92,v,156
MA 152,v,96,v,156
s_add_u32 m0, s22, 4096
v_add_u32 v248, 8192, v252
MA 156,v,100,v,156
MA 216,v,104,v,156
MA 220,v,108,v,156
TR 156,199,49152
TR 158,199,51200
MA 32,v,80,v,160
ds_read_b128 v[132:135], v193 offset:43008
MA 36,v,84,v,160
buffer_load_dwordx4 v180, s[8:11], s20 offen offset:0 lds
buffer_load_dwordx2 v[24:25], v248, s[44:47], 0 offen
MA 96,v,88,v,160
MA 100,v,92,v,160
MA 160,v,96,v,160
MA 164,v,100,v,160
MA 224,v,104,v,160
buffer_load_dwordx2 v[40:41], v248, s[48:51], 0 offen
MA 228,v,108,v,160
TR 160,200,49152
TR 162,200,51200
MA 40,v,80,v,164
ds_read_b128 v[136:139], v193 offset:45056
buffer_load_dwordx4 v181, s[8:11], s20 offen offset:1024 lds
MA 44,v,84,v,164
MA 104,v,88,v,164
v_add_u32 v249, 10240, v252
MA 108,v,92,v,164
MA 168,v,96,v,164
MA 172,v,100,v,164
ds_read_b128 v[140:143], v193 offset:47104
buffer_load_dwordx4 v182, s[8:11], s20 offen offset:2048 lds
MA 232,v,104,v,164
MA 236,v,108,v,164
TR 164,201,49152
TR 166,201,51200
MA 48,v,80,v,168
buffer_load_dwordx2 v[26:27], v249, s[44:47], 0 offen
MA 52,v,84,v,168
MA 112,v,88,v,168
buffer_load_dwordx4 v183, s[8:11], s20 offen offset:3072 lds
MA 116,v,92,v,168
MA 176,v,96,v,168
buffer_load_dwordx2 v[42:43], v249, s[48:51], 0 offen
MA 180,v,100,v,168
MA 240,v,104,v,168
MA 244,v,108,v,168
TR 168,202,49152
TR 170,202,51200
s_waitcnt lgkmcnt(15)
MA 56,v,80,v,172
s_add_u32 s20, s20, 128
MA 60,v,84,v,172
v_add_u32 v250, 12288, v252
MA 120,v,88,v,172
MA 124,v,92,v,172
MA 184,v,96,v,172
MA 188,v,100,v,172
MA 248,v,104,v,172
MA 252,v,108,v,172
TR 172,203,49152
TR 174,203,51200
s_waitcnt lgkmcnt(2)
MA 0,v,112,v,144
MA 4,v,116,v,144
MA 64,v,120,v,144
MA 68,v,124,v,144
MA 128,v,128,v,144
MA 132,v,132,v,144
MA 192,v,136,v,144
MA 196,v,140,v,144
MA 8,v,112,v,148
MA 12,v,116,v,148
s_waitcnt vmcnt(17) lgkmcnt(0)
s_barrier
MA 72,v,120,v,148
TR 144,196,0
TR 146,196,2048
MA 76,v,124,v,148
ds_read_b128 v[80:83], v194 offset:0
s_add_u32 m0, s23, 32768
MA 136,v,128,v,148
buffer_load_dwordx2 v[28:29], v250, s[44:47], 0 offen
MA 140,v,132,v,148
buffer_load_dwordx2 v[44:45], v250, s[48:51], 0 offen
MA 200,v,136,v,148
buffer_load_dwordx4 v184, s[12:15], s21 offen offset:0 lds
MA 204,v,140,v,148
TR 148,197,0
TR 150,197,2048
MA 16,v,112,v,152
ds_read_b128 v[84:87], v194 offset:2048
MA 20,v,116,v,152
v_add_u32 v251, 14336, v252
MA 80,v,120,v,152
MA 84,v,124,v,152
buffer_load_dwordx4 v185, s[12:15], s21 offen offset:1024 lds
MA 144,v,128,v,152
MA 148,v,132,v,152
ds_read_b128 v[88:91], v194 offset:4096
buffer_load_dwordx2 v[30:31], v251, s[44:47], 0 offen
MA 208,v,136,v,152
MA 212,v,140,v,152
TR 152,198,0
TR 154,198,2048
MA 24,v,112,v,156
buffer_load_dwordx4 v186, s[12:15], s21 offen offset:2048 lds
buffer_load_dwordx2 v[46:47], v251, s[48:51], 0 offen
MA 28,v,116,v,156
MA 88,v,120,v,156
ds_read_b128 v[92:95], v194 offset:6144
MA 92,v,124,v,156
MA 152,v,128,v,156
buffer_load_dwordx4 v187, s[12:15], s21 offen offset:3072 lds
v_add_u32 v248, 16384, v252
MA 156,v,132,v,156
MA 216,v,136,v,156
MA 220,v,140,v,156
TR 156,199,0
TR 158,199,2048
MA 32,v,112,v,160
ds_read_b128 v[96:99], v194 offset:8192
buffer_load_dwordx2 v[32:33], v248, s[44:47], 0 offen
MA 36,v,116,v,160
s_add_u32 m0, s23, 36864
MA 96,v,120,v,160
MA 100,v,124,v,160
MA 160,v,128,v,160
ds_read_b128 v[100:103], v194 offset:10240
buffer_load_dwordx2 v[48:49], v248, s[48:51], 0 offen
MA 164,v,132,v,160
MA 224,v,136,v,160
buffer_load_dwordx4 v188, s[12:15], s21 offen offset:0 lds
MA 228,v,140,v,160
TR 160,200,0
TR 162,200,2048
MA 40,v,112,v,164
v_add_u32 v249, 18432, v252
MA 44,v,116,v,164
ds_read_b128 v[104:107], v194 offset:12288
MA 104,v,120,v,164
MA 108,v,124,v,164
buffer_load_dwordx4 v189, s[12:15], s21 offen offset:1024 lds
buffer_load_dwordx2 v[34:35], v249, s[44:47], 0 offen
MA 168,v,128,v,164
MA 172,v,132,v,164
MA 232,v,136,v,164
ds_read_b128 v[108:111], v194 offset:14336
MA 236,v,140,v,164
TR 164,201,0
TR 166,201,2048
MA 48,v,112,v,168
buffer_load_dwordx4 v190, s[12:15], s21 offen offset:2048 lds
buffer_load_dwordx2 v[50:51], v249, s[48:51], 0 offen
MA 52,v,116,v,168
MA 112,v,120,v,168
v_add_u32 v250, 20480, v252
MA 116,v,124,v,168
MA 176,v,128,v,168
buffer_load_dwordx4 v191, s[12:15], s21 offen offset:3072 lds
MA 180,v,132,v,168
MA 240,v,136,v,168
buffer_load_dwordx2 v[36:37], v250, s[44:47], 0 offen
MA 244,v,140,v,168
TR 168,202,0
TR 170,202,2048
MA 56,v,112,v,172
MA 60,v,116,v,172
s_add_u32 s21, s21, 524288
MA 120,v,120,v,172
buffer_load_dwordx2 v[52:53], v250, s[48:51], 0 offen
MA 124,v,124,v,172
MA 184,v,128,v,172
MA 188,v,132,v,172
MA 248,v,136,v,172
MA 252,v,140,v,172
TR 172,203,0
TR 174,203,2048
s_waitcnt lgkmcnt(2)
MA 0,v,80,v,144
s_add_u32 m0, s22, 32768
MA 4,v,84,v,144
ds_read_b128 v[112:115], v195 offset:0
MA 64,v,88,v,144
s_mov_b32 s4, s90
s_mov_b32 s5, s91
s_mov_b32 s6, 8388608
s_mov_b32 s7, 0x20000
MA 68,v,92,v,144
MA 128,v,96,v,144
MA 132,v,100,v,144
buffer_load_dwordx4 v176, s[8:11], s20 offen offset:0 lds
MA 192,v,104,v,144
MA 196,v,108,v,144
TR 144,196,16384
TR 146,196,18432
MA 8,v,80,v,148
ds_read_b128 v[116:119], v195 offset:2048
MA 12,v,84,v,148
MA 72,v,88,v,148
MA 76,v,92,v,148
buffer_load_dwordx4 v177, s[8:11], s20 offen offset:1024 lds
MA 136,v,96,v,148
MA 140,v,100,v,148
ds_read_b128 v[120:123], v195 offset:4096
MA 200,v,104,v,148
MA 204,v,108,v,148
TR 148,197,16384
TR 150,197,18432
MA 16,v,80,v,152
buffer_load_dwordx4 v178, s[8:11], s20 offen offset:2048 lds
MA 20,v,84,v,152
MA 80,v,88,v,152
MA 84,v,92,v,152
MA 144,v,96,v,152
ds_read_b128 v[124:127], v195 offset:6144
MA 148,v,100,v,152
MA 208,v,104,v,152
buffer_load_dwordx4 v179, s[8:11], s20 offen offset:3072 lds
MA 212,v,108,v,152
TR 152,198,16384
TR 154,198,18432
MA 24,v,80,v,156
MA 28,v,84,v,156
MA 88,v,88,v,156
ds_read_b128 v[128:131], v195 offset:8192
MA 92,v,92,v,156
v_lshlrev_b32 v14, 7, v1
MA 152,v,96,v,156
s_add_u32 m0, s22, 36864
MA 156,v,100,v,156
MA 216,v,104,v,156
MA 220,v,108,v,156
TR 156,199,16384
TR 158,199,18432
MA 32,v,80,v,160
ds_read_b128 v[132:135], v195 offset:10240
MA 36,v,84,v,160
buffer_load_dwordx4 v180, s[8:11], s20 offen offset:0 lds
MA 96,v,88,v,160
s_lshl_b32 s43, s2, 2
s_add_u32 s43, s43, s3
s_lshl_b32 s43, s43, 13
buffer_load_dword v15, v14, s[4:7], s43 offen
MA 100,v,92,v,160
MA 160,v,96,v,160
MA 164,v,100,v,160
MA 224,v,104,v,160
MA 228,v,108,v,160
TR 160,200,16384
TR 162,200,18432
MA 40,v,80,v,164
ds_read_b128 v[136:139], v195 offset:12288
buffer_load_dwordx4 v181, s[8:11], s20 offen offset:1024 lds
MA 44,v,84,v,164
MA 104,v,88,v,164
MA 108,v,92,v,164
MA 168,v,96,v,164
MA 172,v,100,v,164
ds_read_b128 v[140:143], v195 offset:14336
buffer_load_dwordx4 v182, s[8:11], s20 offen offset:2048 lds
MA 232,v,104,v,164
MA 236,v,108,v,164
TR 164,201,16384
TR 166,201,18432
MA 48,v,80,v,168
MA 52,v,84,v,168
MA 112,v,88,v,168
buffer_load_dwordx4 v183, s[8:11], s20 offen offset:3072 lds
MA 116,v,92,v,168
MA 176,v,96,v,168
MA 180,v,100,v,168
MA 240,v,104,v,168
MA 244,v,108,v,168
TR 168,202,16384
TR 170,202,18432
s_waitcnt lgkmcnt(15)
MA 56,v,80,v,172
s_add_u32 s20, s20, 128
MA 60,v,84,v,172
MA 120,v,88,v,172
MA 124,v,92,v,172
MA 184,v,96,v,172
MA 188,v,100,v,172
MA 248,v,104,v,172
MA 252,v,108,v,172
TR 172,203,16384
TR 174,203,18432
s_waitcnt lgkmcnt(2)
MA 0,v,112,v,144
MA 4,v,116,v,144
MA 64,v,120,v,144
MA 68,v,124,v,144
MA 128,v,128,v,144
MA 132,v,132,v,144
MA 192,v,136,v,144
MA 196,v,140,v,144
MA 8,v,112,v,148
MA 12,v,116,v,148
s_waitcnt vmcnt(11) lgkmcnt(0)
s_barrier
MA 72,v,120,v,148
TR 144,196,32768
TR 146,196,34816
MA 76,v,124,v,148
ds_read_b128 v[80:83], v192 offset:0
s_add_u32 m0, s23, 0
MA 136,v,128,v,148
MA 140,v,132,v,148
MA 200,v,136,v,148
buffer_load_dwordx4 v184, s[12:15], s21 offen offset:0 lds
MA 204,v,140,v,148
TR 148,197,32768
TR 150,197,34816
MA 16,v,112,v,152
ds_read_b128 v[84:87], v192 offset:2048
MA 20,v,116,v,152
MA 80,v,120,v,152
MA 84,v,124,v,152
buffer_load_dwordx4 v185, s[12:15], s21 offen offset:1024 lds
MA 144,v,128,v,152
MA 148,v,132,v,152
ds_read_b128 v[88:91], v192 offset:4096
MA 208,v,136,v,152
MA 212,v,140,v,152
TR 152,198,32768
TR 154,198,34816
MA 24,v,112,v,156
buffer_load_dwordx4 v186, s[12:15], s21 offen offset:2048 lds
MA 28,v,116,v,156
MA 88,v,120,v,156
ds_read_b128 v[92:95], v192 offset:6144
MA 92,v,124,v,156
MA 152,v,128,v,156
buffer_load_dwordx4 v187, s[12:15], s21 offen offset:3072 lds
MA 156,v,132,v,156
MA 216,v,136,v,156
MA 220,v,140,v,156
TR 156,199,32768
TR 158,199,34816
MA 32,v,112,v,160
ds_read_b128 v[96:99], v192 offset:8192
MA 36,v,116,v,160
s_add_u32 m0, s23, 4096
MA 96,v,120,v,160
MA 100,v,124,v,160
MA 160,v,128,v,160
ds_read_b128 v[100:103], v192 offset:10240
MA 164,v,132,v,160
MA 224,v,136,v,160
buffer_load_dwordx4 v188, s[12:15], s21 offen offset:0 lds
MA 228,v,140,v,160
TR 160,200,32768
TR 162,200,34816
MA 40,v,112,v,164
MA 44,v,116,v,164
ds_read_b128 v[104:107], v192 offset:12288
MA 104,v,120,v,164
MA 108,v,124,v,164
buffer_load_dwordx4 v189, s[12:15], s21 offen offset:1024 lds
MA 168,v,128,v,164
MA 172,v,132,v,164
MA 232,v,136,v,164
ds_read_b128 v[108:111], v192 offset:14336
MA 236,v,140,v,164
TR 164,201,32768
TR 166,201,34816
MA 48,v,112,v,168
buffer_load_dwordx4 v190, s[12:15], s21 offen offset:2048 lds
MA 52,v,116,v,168
MA 112,v,120,v,168
MA 116,v,124,v,168
MA 176,v,128,v,168
buffer_load_dwordx4 v191, s[12:15], s21 offen offset:3072 lds
MA 180,v,132,v,168
MA 240,v,136,v,168
MA 244,v,140,v,168
TR 168,202,32768
TR 170,202,34816
MA 56,v,112,v,172
MA 60,v,116,v,172
s_add_u32 s21, s21, 524288
MA 120,v,120,v,172
MA 124,v,124,v,172
MA 184,v,128,v,172
MA 188,v,132,v,172
MA 248,v,136,v,172
MA 252,v,140,v,172
TR 172,203,32768
TR 174,203,34816
s_waitcnt lgkmcnt(2)
MA 0,v,80,v,144
s_add_u32 m0, s22, 65536
v_mov_b32 v248, 0
MA 4,v,84,v,144
ds_read_b128 v[112:115], v193 offset:0
v_mov_b32 v249, 0
MA 64,v,88,v,144
v_dot2_f32_bf16 v248, v208, v224, v248
v_dot2_f32_bf16 v249, v209, v225, v249
MA 68,v,92,v,144
v_dot2_f32_bf16 v248, v210, v226, v248
v_dot2_f32_bf16 v249, v211, v227, v249
MA 128,v,96,v,144
v_dot2_f32_bf16 v248, v212, v228, v248
MA 132,v,100,v,144
buffer_load_dwordx4 v176, s[8:11], s20 offen offset:0 lds
v_dot2_f32_bf16 v249, v213, v229, v249
MA 192,v,104,v,144
v_dot2_f32_bf16 v248, v214, v230, v248
v_dot2_f32_bf16 v249, v215, v231, v249
MA 196,v,108,v,144
TR 144,196,49152
TR 146,196,51200
MA 8,v,80,v,148
ds_read_b128 v[116:119], v193 offset:2048
v_dot2_f32_bf16 v248, v216, v232, v248
MA 12,v,84,v,148
v_dot2_f32_bf16 v249, v217, v233, v249
v_dot2_f32_bf16 v248, v218, v234, v248
MA 72,v,88,v,148
v_dot2_f32_bf16 v249, v219, v235, v249
v_dot2_f32_bf16 v248, v220, v236, v248
MA 76,v,92,v,148
buffer_load_dwordx4 v177, s[8:11], s20 offen offset:1024 lds
v_dot2_f32_bf16 v249, v221, v237, v249
MA 136,v,96,v,148
v_dot2_f32_bf16 v248, v222, v238, v248
v_dot2_f32_bf16 v249, v223, v239, v249
MA 140,v,100,v,148
ds_read_b128 v[120:123], v193 offset:4096
MA 200,v,104,v,148
s_nop 2
v_add_f32 v248, v248, v249
MA 204,v,108,v,148
TR 148,197,49152
TR 150,197,51200
MA 16,v,80,v,152
buffer_load_dwordx4 v178, s[8:11], s20 offen offset:2048 lds
v_add_f32_dpp v248, v248, v248 row_ror:8 row_mask:0xf bank_mask:0xf
MA 20,v,84,v,152
s_nop 0
v_add_f32_dpp v248, v248, v248 row_ror:4 row_mask:0xf bank_mask:0xf
MA 80,v,88,v,152
s_nop 0
v_add_f32_dpp v248, v248, v248 row_ror:2 row_mask:0xf bank_mask:0xf
s_nop 1
v_add_f32_dpp v248, v248, v248 row_ror:1 row_mask:0xf bank_mask:0xf
MA 84,v,92,v,152
v_mov_b32 v249, v248
MA 144,v,96,v,152
ds_read_b128 v[124:127], v193 offset:6144
v_permlane16_swap_b32 v248, v249
MA 148,v,100,v,152
v_add_f32 v248, v248, v249
v_mul_f32 v248, 0xbfb8aa3b, v248
MA 208,v,104,v,152
buffer_load_dwordx4 v179, s[8:11], s20 offen offset:3072 lds
MA 212,v,108,v,152
TR 152,198,49152
TR 154,198,51200
MA 24,v,80,v,156
v_exp_f32 v248, v248
MA 28,v,84,v,156
v_add_f32 v248, 1.0, v248
MA 88,v,88,v,156
ds_read_b128 v[128:131], v193 offset:8192
MA 92,v,92,v,156
v_rcp_f32 v248, v248
MA 152,v,96,v,156
s_add_u32 m0, s22, 69632
MA 156,v,100,v,156
s_nop 0
buffer_store_dword v248, v79, s[68:71], 0 offen sc1
MA 216,v,104,v,156
v_lshlrev_b32 v230, 16, v54
v_and_b32 v231, 0xffff0000, v54
MA 220,v,108,v,156
TR 156,199,49152
TR 158,199,51200
MA 32,v,80,v,160
ds_read_b128 v[132:135], v193 offset:10240
v_lshlrev_b32 v232, 16, v55
MA 36,v,84,v,160
buffer_load_dwordx4 v180, s[8:11], s20 offen offset:0 lds
v_and_b32 v233, 0xffff0000, v55
MA 96,v,88,v,160
v_lshlrev_b32 v234, 16, v56
v_and_b32 v235, 0xffff0000, v56
MA 100,v,92,v,160
v_lshlrev_b32 v236, 16, v57
v_and_b32 v237, 0xffff0000, v57
MA 160,v,96,v,160
v_lshlrev_b32 v208, 16, v16
v_and_b32 v209, 0xffff0000, v16
MA 164,v,100,v,160
v_lshlrev_b32 v210, 16, v18
v_and_b32 v211, 0xffff0000, v18
MA 224,v,104,v,160
v_lshlrev_b32 v212, 16, v20
v_and_b32 v213, 0xffff0000, v20
MA 228,v,108,v,160
TR 160,200,49152
TR 162,200,51200
MA 40,v,80,v,164
ds_read_b128 v[136:139], v193 offset:12288
buffer_load_dwordx4 v181, s[8:11], s20 offen offset:1024 lds
MA 44,v,84,v,164
v_lshlrev_b32 v214, 16, v22
v_and_b32 v215, 0xffff0000, v22
MA 104,v,88,v,164
v_lshlrev_b32 v216, 16, v24
v_and_b32 v217, 0xffff0000, v24
MA 108,v,92,v,164
v_lshlrev_b32 v218, 16, v26
v_and_b32 v219, 0xffff0000, v26
MA 168,v,96,v,164
v_lshlrev_b32 v220, 16, v28
v_and_b32 v221, 0xffff0000, v28
MA 172,v,100,v,164
ds_read_b128 v[140:143], v193 offset:14336
buffer_load_dwordx4 v182, s[8:11], s20 offen offset:2048 lds
MA 232,v,104,v,164
v_lshlrev_b32 v222, 16, v30
v_and_b32 v223, 0xffff0000, v30
MA 236,v,108,v,164
TR 164,201,49152
TR 166,201,51200
MA 48,v,80,v,168
v_lshlrev_b32 v224, 16, v32
v_and_b32 v225, 0xffff0000, v32
MA 52,v,84,v,168
v_lshlrev_b32 v226, 16, v34
v_and_b32 v227, 0xffff0000, v34
MA 112,v,88,v,168
buffer_load_dwordx4 v183, s[8:11], s20 offen offset:3072 lds
s_waitcnt vmcnt(27)
v_lshlrev_b32 v228, 16, v36
MA 116,v,92,v,168
v_and_b32 v229, 0xffff0000, v36
v_lshlrev_b32 v250, 16, v38
MA 176,v,96,v,168
v_and_b32 v251, 0xffff0000, v38
v_mul_f32 v62, v214, v230
MA 180,v,100,v,168
v_mul_f32 v70, v215, v234
v_fmac_f32 v62, v212, v231
MA 240,v,104,v,168
v_fmac_f32 v70, v213, v235
MA 244,v,108,v,168
TR 168,202,49152
TR 170,202,51200
s_waitcnt lgkmcnt(15)
MA 56,v,80,v,172
s_add_u32 s20, s20, 128
v_fmac_f32 v62, v210, v232
MA 60,v,84,v,172
v_fmac_f32 v70, v211, v236
v_fmac_f32 v62, v208, v233
MA 120,v,88,v,172
v_fmac_f32 v70, v209, v237
v_mul_f32 v62, v62, v250
MA 124,v,92,v,172
v_mul_f32 v70, v70, v251
v_lshlrev_b32 v250, 16, v40
MA 184,v,96,v,172
v_and_b32 v251, 0xffff0000, v40
MA 188,v,100,v,172
v_mul_f32 v63, v216, v230
MA 248,v,104,v,172
MA 252,v,108,v,172
TR 172,203,49152
TR 174,203,51200
s_waitcnt lgkmcnt(2)
MA 0,v,112,v,144
MA 4,v,116,v,144
MA 64,v,120,v,144
MA 68,v,124,v,144
MA 128,v,128,v,144
MA 132,v,132,v,144
MA 192,v,136,v,144
MA 196,v,140,v,144
MA 8,v,112,v,148
MA 12,v,116,v,148
s_waitcnt vmcnt(9) lgkmcnt(0)
s_barrier
MA 72,v,120,v,148
TR 144,196,0
TR 146,196,2048
MA 76,v,124,v,148
ds_read_b128 v[80:83], v192 offset:32768
s_add_u32 m0, s23, 32768
MA 136,v,128,v,148
v_mul_f32 v71, v217, v234
v_fmac_f32 v63, v214, v231
MA 140,v,132,v,148
v_fmac_f32 v71, v215, v235
v_fmac_f32 v63, v212, v232
MA 200,v,136,v,148
buffer_load_dwordx4 v184, s[12:15], s21 offen offset:0 lds
v_fmac_f32 v71, v213, v236
MA 204,v,140,v,148
TR 148,197,0
TR 150,197,2048
MA 16,v,112,v,152
ds_read_b128 v[84:87], v192 offset:34816
v_fmac_f32 v63, v210, v233
MA 20,v,116,v,152
v_fmac_f32 v71, v211, v237
v_mul_f32 v63, v63, v250
MA 80,v,120,v,152
v_mul_f32 v71, v71, v251
v_lshlrev_b32 v250, 16, v42
MA 84,v,124,v,152
buffer_load_dwordx4 v185, s[12:15], s21 offen offset:1024 lds
v_and_b32 v251, 0xffff0000, v42
MA 144,v,128,v,152
v_mul_f32 v64, v218, v230
v_mul_f32 v72, v219, v234
MA 148,v,132,v,152
ds_read_b128 v[88:91], v192 offset:36864
v_fmac_f32 v64, v216, v231
MA 208,v,136,v,152
v_fmac_f32 v72, v217, v235
v_fmac_f32 v64, v214, v232
MA 212,v,140,v,152
TR 152,198,0
TR 154,198,2048
MA 24,v,112,v,156
buffer_load_dwordx4 v186, s[12:15], s21 offen offset:2048 lds
v_fmac_f32 v72, v215, v236
MA 28,v,116,v,156
v_fmac_f32 v64, v212, v233
v_fmac_f32 v72, v213, v237
MA 88,v,120,v,156
ds_read_b128 v[92:95], v192 offset:38912
v_mul_f32 v64, v64, v250
MA 92,v,124,v,156
v_mul_f32 v72, v72, v251
v_lshlrev_b32 v250, 16, v44
MA 152,v,128,v,156
buffer_load_dwordx4 v187, s[12:15], s21 offen offset:3072 lds
v_and_b32 v251, 0xffff0000, v44
MA 156,v,132,v,156
v_mul_f32 v65, v220, v230
v_mul_f32 v73, v221, v234
MA 216,v,136,v,156
v_fmac_f32 v65, v218, v231
v_fmac_f32 v73, v219, v235
MA 220,v,140,v,156
TR 156,199,0
TR 158,199,2048
MA 32,v,112,v,160
ds_read_b128 v[96:99], v192 offset:40960
v_fmac_f32 v65, v216, v232
MA 36,v,116,v,160
s_add_u32 m0, s23, 36864
v_fmac_f32 v73, v217, v236
MA 96,v,120,v,160
v_fmac_f32 v65, v214, v233
v_fmac_f32 v73, v215, v237
MA 100,v,124,v,160
v_mul_f32 v65, v65, v250
v_mul_f32 v73, v73, v251
MA 160,v,128,v,160
ds_read_b128 v[100:103], v192 offset:43008
v_lshlrev_b32 v250, 16, v46
MA 164,v,132,v,160
v_and_b32 v251, 0xffff0000, v46
v_mul_f32 v66, v222, v230
MA 224,v,136,v,160
buffer_load_dwordx4 v188, s[12:15], s21 offen offset:0 lds
v_mul_f32 v74, v223, v234
MA 228,v,140,v,160
TR 160,200,0
TR 162,200,2048
MA 40,v,112,v,164
v_fmac_f32 v66, v220, v231
v_fmac_f32 v74, v221, v235
MA 44,v,116,v,164
ds_read_b128 v[104:107], v192 offset:45056
v_fmac_f32 v66, v218, v232
MA 104,v,120,v,164
v_fmac_f32 v74, v219, v236
v_fmac_f32 v66, v216, v233
MA 108,v,124,v,164
buffer_load_dwordx4 v189, s[12:15], s21 offen offset:1024 lds
v_fmac_f32 v74, v217, v237
MA 168,v,128,v,164
v_mul_f32 v66, v66, v250
v_mul_f32 v74, v74, v251
MA 172,v,132,v,164
v_lshlrev_b32 v250, 16, v48
v_and_b32 v251, 0xffff0000, v48
MA 232,v,136,v,164
ds_read_b128 v[108:111], v192 offset:47104
v_mul_f32 v67, v224, v230
MA 236,v,140,v,164
TR 164,201,0
TR 166,201,2048
MA 48,v,112,v,168
buffer_load_dwordx4 v190, s[12:15], s21 offen offset:2048 lds
v_mul_f32 v75, v225, v234
MA 52,v,116,v,168
v_fmac_f32 v67, v222, v231
v_fmac_f32 v75, v223, v235
MA 112,v,120,v,168
v_fmac_f32 v67, v220, v232
v_fmac_f32 v75, v221, v236
MA 116,v,124,v,168
v_fmac_f32 v67, v218, v233
v_fmac_f32 v75, v219, v237
MA 176,v,128,v,168
buffer_load_dwordx4 v191, s[12:15], s21 offen offset:3072 lds
v_mul_f32 v67, v67, v250
MA 180,v,132,v,168
v_mul_f32 v75, v75, v251
v_lshlrev_b32 v250, 16, v50
MA 240,v,136,v,168
v_and_b32 v251, 0xffff0000, v50
v_mul_f32 v68, v226, v230
MA 244,v,140,v,168
TR 168,202,0
TR 170,202,2048
MA 56,v,112,v,172
v_mul_f32 v76, v227, v234
v_fmac_f32 v68, v224, v231
MA 60,v,116,v,172
s_add_u32 s21, s21, 524288
v_fmac_f32 v76, v225, v235
MA 120,v,120,v,172
v_fmac_f32 v68, v222, v232
v_fmac_f32 v76, v223, v236
MA 124,v,124,v,172
v_fmac_f32 v68, v220, v233
v_fmac_f32 v76, v221, v237
MA 184,v,128,v,172
v_mul_f32 v68, v68, v250
v_mul_f32 v76, v76, v251
MA 188,v,132,v,172
v_lshlrev_b32 v250, 16, v52
v_and_b32 v251, 0xffff0000, v52
MA 248,v,136,v,172
v_mul_f32 v69, v228, v230
v_mul_f32 v77, v229, v234
MA 252,v,140,v,172
TR 172,203,0
TR 174,203,2048
v_fmac_f32 v69, v226, v231
v_fmac_f32 v77, v227, v235
v_fmac_f32 v69, v224, v232
v_fmac_f32 v77, v225, v236
s_waitcnt lgkmcnt(2)
MA 0,v,80,v,144
s_add_u32 m0, s22, 0
v_fmac_f32 v69, v222, v233
MA 4,v,84,v,144
ds_read_b128 v[112:115], v193 offset:32768
v_fmac_f32 v77, v223, v237
MA 64,v,88,v,144
v_mul_f32 v69, v69, v250
v_mul_f32 v77, v77, v251
MA 68,v,92,v,144
v_cvt_pk_bf16_f32 v240, v69, v68
MA 128,v,96,v,144
v_cvt_pk_bf16_f32 v241, v67, v66
v_cvt_pk_bf16_f32 v242, v65, v64
MA 132,v,100,v,144
buffer_load_dwordx4 v176, s[8:11], s20 offen offset:0 lds
v_cvt_pk_bf16_f32 v243, v63, v62
MA 192,v,104,v,144
s_mov_b32 s72, 0
MA 196,v,108,v,144
TR 144,196,16384
TR 146,196,18432
MA 8,v,80,v,148
ds_read_b128 v[116:119], v193 offset:34816
buffer_store_dwordx4 v[240:243], v253, s[64:67], s72 offen sc1
MA 12,v,84,v,148
v_cvt_pk_bf16_f32 v244, v77, v76
v_cvt_pk_bf16_f32 v245, v75, v74
MA 72,v,88,v,148
v_cvt_pk_bf16_f32 v246, v73, v72
v_cvt_pk_bf16_f32 v247, v71, v70
MA 76,v,92,v,148
buffer_load_dwordx4 v177, s[8:11], s20 offen offset:1024 lds
s_mov_b32 s72, 4096
MA 136,v,96,v,148
buffer_store_dwordx4 v[244:247], v253, s[64:67], s72 offen sc1
v_lshlrev_b32 v230, 16, v58
MA 140,v,100,v,148
ds_read_b128 v[120:123], v193 offset:36864
v_and_b32 v231, 0xffff0000, v58
MA 200,v,104,v,148
v_lshlrev_b32 v232, 16, v59
MA 204,v,108,v,148
TR 148,197,16384
TR 150,197,18432
MA 16,v,80,v,152
buffer_load_dwordx4 v178, s[8:11], s20 offen offset:2048 lds
v_and_b32 v233, 0xffff0000, v59
MA 20,v,84,v,152
v_lshlrev_b32 v234, 16, v60
v_and_b32 v235, 0xffff0000, v60
MA 80,v,88,v,152
v_lshlrev_b32 v236, 16, v61
v_and_b32 v237, 0xffff0000, v61
MA 84,v,92,v,152
v_lshlrev_b32 v208, 16, v17
MA 144,v,96,v,152
ds_read_b128 v[124:127], v193 offset:38912
v_and_b32 v209, 0xffff0000, v17
MA 148,v,100,v,152
v_lshlrev_b32 v210, 16, v19
v_and_b32 v211, 0xffff0000, v19
MA 208,v,104,v,152
buffer_load_dwordx4 v179, s[8:11], s20 offen offset:3072 lds
v_lshlrev_b32 v212, 16, v21
MA 212,v,108,v,152
TR 152,198,16384
TR 154,198,18432
MA 24,v,80,v,156
v_and_b32 v213, 0xffff0000, v21
v_lshlrev_b32 v214, 16, v23
MA 28,v,84,v,156
v_and_b32 v215, 0xffff0000, v23
v_lshlrev_b32 v216, 16, v25
MA 88,v,88,v,156
ds_read_b128 v[128:131], v193 offset:40960
v_and_b32 v217, 0xffff0000, v25
MA 92,v,92,v,156
v_lshlrev_b32 v218, 16, v27
MA 152,v,96,v,156
s_add_u32 m0, s22, 4096
v_and_b32 v219, 0xffff0000, v27
MA 156,v,100,v,156
v_lshlrev_b32 v220, 16, v29
v_and_b32 v221, 0xffff0000, v29
MA 216,v,104,v,156
v_lshlrev_b32 v222, 16, v31
MA 220,v,108,v,156
TR 156,199,16384
TR 158,199,18432
MA 32,v,80,v,160
ds_read_b128 v[132:135], v193 offset:43008
v_and_b32 v223, 0xffff0000, v31
MA 36,v,84,v,160
buffer_load_dwordx4 v180, s[8:11], s20 offen offset:0 lds
v_lshlrev_b32 v224, 16, v33
MA 96,v,88,v,160
v_and_b32 v225, 0xffff0000, v33
v_lshlrev_b32 v226, 16, v35
MA 100,v,92,v,160
v_and_b32 v227, 0xffff0000, v35
v_lshlrev_b32 v228, 16, v37
MA 160,v,96,v,160
v_and_b32 v229, 0xffff0000, v37
MA 164,v,100,v,160
v_lshlrev_b32 v250, 16, v39
v_and_b32 v251, 0xffff0000, v39
MA 224,v,104,v,160
v_mul_f32 v62, v214, v230
MA 228,v,108,v,160
TR 160,200,16384
TR 162,200,18432
MA 40,v,80,v,164
ds_read_b128 v[136:139], v193 offset:45056
buffer_load_dwordx4 v181, s[8:11], s20 offen offset:1024 lds
MA 44,v,84,v,164
v_mul_f32 v70, v215, v234
v_fmac_f32 v62, v212, v231
MA 104,v,88,v,164
v_fmac_f32 v70, v213, v235
v_fmac_f32 v62, v210, v232
MA 108,v,92,v,164
v_fmac_f32 v70, v211, v236
v_fmac_f32 v62, v208, v233
MA 168,v,96,v,164
v_fmac_f32 v70, v209, v237
MA 172,v,100,v,164
ds_read_b128 v[140:143], v193 offset:47104
buffer_load_dwordx4 v182, s[8:11], s20 offen offset:2048 lds
MA 232,v,104,v,164
v_mul_f32 v62, v62, v250
v_mul_f32 v70, v70, v251
MA 236,v,108,v,164
TR 164,201,16384
TR 166,201,18432
MA 48,v,80,v,168
v_lshlrev_b32 v250, 16, v41
v_and_b32 v251, 0xffff0000, v41
MA 52,v,84,v,168
v_mul_f32 v63, v216, v230
v_mul_f32 v71, v217, v234
MA 112,v,88,v,168
buffer_load_dwordx4 v183, s[8:11], s20 offen offset:3072 lds
v_fmac_f32 v63, v214, v231
MA 116,v,92,v,168
v_fmac_f32 v71, v215, v235
v_fmac_f32 v63, v212, v232
MA 176,v,96,v,168
v_fmac_f32 v71, v213, v236
MA 180,v,100,v,168
v_fmac_f32 v63, v210, v233
v_fmac_f32 v71, v211, v237
MA 240,v,104,v,168
v_mul_f32 v63, v63, v250
MA 244,v,108,v,168
TR 168,202,16384
TR 170,202,18432
s_waitcnt lgkmcnt(15)
MA 56,v,80,v,172
s_add_u32 s20, s20, 128
v_mul_f32 v71, v71, v251
MA 60,v,84,v,172
v_lshlrev_b32 v250, 16, v43
v_and_b32 v251, 0xffff0000, v43
MA 120,v,88,v,172
v_mul_f32 v64, v218, v230
v_mul_f32 v72, v219, v234
MA 124,v,92,v,172
v_fmac_f32 v64, v216, v231
MA 184,v,96,v,172
v_fmac_f32 v72, v217, v235
MA 188,v,100,v,172
v_fmac_f32 v64, v214, v232
MA 248,v,104,v,172
MA 252,v,108,v,172
TR 172,203,16384
TR 174,203,18432
s_waitcnt lgkmcnt(2)
MA 0,v,112,v,144
MA 4,v,116,v,144
MA 64,v,120,v,144
MA 68,v,124,v,144
MA 128,v,128,v,144
MA 132,v,132,v,144
MA 192,v,136,v,144
MA 196,v,140,v,144
MA 8,v,112,v,148
MA 12,v,116,v,148
s_waitcnt vmcnt(10) lgkmcnt(0)
s_barrier
MA 72,v,120,v,148
TR 144,196,32768
TR 146,196,34816
MA 76,v,124,v,148
ds_read_b128 v[80:83], v194 offset:0
s_add_u32 m0, s23, 0
MA 136,v,128,v,148
s_load_dwordx2 s[32:33], s[0:1], 0
s_load_dwordx2 s[34:35], s[0:1], 64
MA 140,v,132,v,148
s_load_dwordx2 s[38:39], s[0:1], 112
v_fmac_f32 v72, v215, v236
MA 200,v,136,v,148
buffer_load_dwordx4 v184, s[12:15], s21 offen offset:0 lds
v_fmac_f32 v64, v212, v233
MA 204,v,140,v,148
TR 148,197,32768
TR 150,197,34816
MA 16,v,112,v,152
ds_read_b128 v[84:87], v194 offset:2048
v_fmac_f32 v72, v213, v237
MA 20,v,116,v,152
v_mul_f32 v64, v64, v250
v_mul_f32 v72, v72, v251
MA 80,v,120,v,152
v_lshlrev_b32 v250, 16, v45
v_and_b32 v251, 0xffff0000, v45
MA 84,v,124,v,152
buffer_load_dwordx4 v185, s[12:15], s21 offen offset:1024 lds
v_mul_f32 v65, v220, v230
MA 144,v,128,v,152
v_mul_f32 v73, v221, v234
v_fmac_f32 v65, v218, v231
MA 148,v,132,v,152
ds_read_b128 v[88:91], v194 offset:4096
v_fmac_f32 v73, v219, v235
MA 208,v,136,v,152
v_fmac_f32 v65, v216, v232
v_fmac_f32 v73, v217, v236
MA 212,v,140,v,152
TR 152,198,32768
TR 154,198,34816
MA 24,v,112,v,156
buffer_load_dwordx4 v186, s[12:15], s21 offen offset:2048 lds
v_fmac_f32 v65, v214, v233
MA 28,v,116,v,156
v_fmac_f32 v73, v215, v237
v_mul_f32 v65, v65, v250
MA 88,v,120,v,156
ds_read_b128 v[92:95], v194 offset:6144
v_mul_f32 v73, v73, v251
MA 92,v,124,v,156
v_lshlrev_b32 v250, 16, v47
v_and_b32 v251, 0xffff0000, v47
MA 152,v,128,v,156
buffer_load_dwordx4 v187, s[12:15], s21 offen offset:3072 lds
v_mul_f32 v66, v222, v230
MA 156,v,132,v,156
v_mul_f32 v74, v223, v234
v_fmac_f32 v66, v220, v231
MA 216,v,136,v,156
v_fmac_f32 v74, v221, v235
v_fmac_f32 v66, v218, v232
MA 220,v,140,v,156
TR 156,199,32768
TR 158,199,34816
MA 32,v,112,v,160
ds_read_b128 v[96:99], v194 offset:8192
v_fmac_f32 v74, v219, v236
MA 36,v,116,v,160
s_add_u32 m0, s23, 4096
v_fmac_f32 v66, v216, v233
MA 96,v,120,v,160
v_fmac_f32 v74, v217, v237
v_mul_f32 v66, v66, v250
MA 100,v,124,v,160
v_mul_f32 v74, v74, v251
v_lshlrev_b32 v250, 16, v49
MA 160,v,128,v,160
ds_read_b128 v[100:103], v194 offset:10240
v_and_b32 v251, 0xffff0000, v49
MA 164,v,132,v,160
v_mul_f32 v67, v224, v230
v_mul_f32 v75, v225, v234
MA 224,v,136,v,160
buffer_load_dwordx4 v188, s[12:15], s21 offen offset:0 lds
v_fmac_f32 v67, v222, v231
MA 228,v,140,v,160
TR 160,200,32768
TR 162,200,34816
MA 40,v,112,v,164
v_fmac_f32 v75, v223, v235
v_fmac_f32 v67, v220, v232
MA 44,v,116,v,164
ds_read_b128 v[104:107], v194 offset:12288
v_fmac_f32 v75, v221, v236
MA 104,v,120,v,164
v_fmac_f32 v67, v218, v233
v_fmac_f32 v75, v219, v237
MA 108,v,124,v,164
buffer_load_dwordx4 v189, s[12:15], s21 offen offset:1024 lds
v_mul_f32 v67, v67, v250
MA 168,v,128,v,164
v_mul_f32 v75, v75, v251
v_lshlrev_b32 v250, 16, v51
MA 172,v,132,v,164
v_and_b32 v251, 0xffff0000, v51
v_mul_f32 v68, v226, v230
MA 232,v,136,v,164
ds_read_b128 v[108:111], v194 offset:14336
v_mul_f32 v76, v227, v234
MA 236,v,140,v,164
TR 164,201,32768
TR 166,201,34816
MA 48,v,112,v,168
buffer_load_dwordx4 v190, s[12:15], s21 offen offset:2048 lds
v_fmac_f32 v68, v224, v231
MA 52,v,116,v,168
v_fmac_f32 v76, v225, v235
v_fmac_f32 v68, v222, v232
MA 112,v,120,v,168
v_fmac_f32 v76, v223, v236
v_fmac_f32 v68, v220, v233
MA 116,v,124,v,168
v_fmac_f32 v76, v221, v237
v_mul_f32 v68, v68, v250
MA 176,v,128,v,168
buffer_load_dwordx4 v191, s[12:15], s21 offen offset:3072 lds
v_mul_f32 v76, v76, v251
MA 180,v,132,v,168
v_lshlrev_b32 v250, 16, v53
v_and_b32 v251, 0xffff0000, v53
MA 240,v,136,v,168
v_mul_f32 v69, v228, v230
v_mul_f32 v77, v229, v234
MA 244,v,140,v,168
TR 168,202,32768
TR 170,202,34816
MA 56,v,112,v,172
v_fmac_f32 v69, v226, v231
v_fmac_f32 v77, v227, v235
MA 60,v,116,v,172
s_add_u32 s21, s21, 524288
v_fmac_f32 v69, v224, v232
MA 120,v,120,v,172
v_fmac_f32 v77, v225, v236
v_fmac_f32 v69, v222, v233
MA 124,v,124,v,172
v_fmac_f32 v77, v223, v237
v_mul_f32 v69, v69, v250
MA 184,v,128,v,172
v_mul_f32 v77, v77, v251
v_cvt_pk_bf16_f32 v240, v69, v68
MA 188,v,132,v,172
v_cvt_pk_bf16_f32 v241, v67, v66
v_cvt_pk_bf16_f32 v242, v65, v64
MA 248,v,136,v,172
v_cvt_pk_bf16_f32 v243, v63, v62
s_mov_b32 s72, 8192
MA 252,v,140,v,172
TR 172,203,32768
TR 174,203,34816
buffer_store_dwordx4 v[240:243], v253, s[64:67], s72 offen sc1
v_cvt_pk_bf16_f32 v244, v77, v76
v_cvt_pk_bf16_f32 v245, v75, v74
v_cvt_pk_bf16_f32 v246, v73, v72
v_cvt_pk_bf16_f32 v247, v71, v70
s_mov_b32 s72, 12288
buffer_store_dwordx4 v[244:247], v253, s[64:67], s72 offen sc1
s_waitcnt lgkmcnt(2)
MA 0,v,80,v,144
s_add_u32 m0, s22, 32768
s_and_b32 s80, s2, 7
MA 4,v,84,v,144
ds_read_b128 v[112:115], v195 offset:0
s_lshr_b32 s81, s2, 3
MA 64,v,88,v,144
s_and_b32 s69, s81, 3
s_lshl_b32 s80, s80, 2
MA 68,v,92,v,144
s_add_u32 s69, s69, s80
MA 128,v,96,v,144
s_lshr_b32 s70, s81, 2
MA 132,v,100,v,144
buffer_load_dwordx4 v176, s[8:11], s20 offen offset:0 lds
s_lshl_b32 s80, s3, 16
MA 192,v,104,v,144
s_lshl_b32 s65, s70, 18
s_sub_u32 s64, 3932160, s65
MA 196,v,108,v,144
TR 144,196,49152
TR 146,196,51200
MA 8,v,80,v,148
ds_read_b128 v[116:119], v195 offset:2048
s_add_u32 s65, s65, s80
MA 12,v,84,v,148
s_add_u32 s64, s64, s80
s_lshl_b32 s81, s69, 12
MA 72,v,88,v,148
s_lshl_b32 s100, s64, 2
MA 76,v,92,v,148
buffer_load_dwordx4 v177, s[8:11], s20 offen offset:1024 lds
s_add_u32 s100, s100, s81
MA 136,v,96,v,148
s_lshl_b32 s101, s65, 2
s_add_u32 s101, s101, s81
MA 140,v,100,v,148
ds_read_b128 v[120:123], v195 offset:4096
s_lshl_b32 s66, s3, 17
MA 200,v,104,v,148
s_lshl_b32 s81, s69, 8
MA 204,v,108,v,148
TR 148,197,49152
TR 150,197,51200
MA 16,v,80,v,152
buffer_load_dwordx4 v178, s[8:11], s20 offen offset:2048 lds
s_add_u32 s66, s66, s81
MA 20,v,84,v,152
s_lshl_b32 s67, s3, 13
s_lshl_b32 s68, s3, 12
MA 80,v,88,v,152
s_lshl_b32 s76, s70, 1
s_sub_u32 s77, 32, s76
MA 84,v,92,v,152
s_add_u32 s76, s76, 2
MA 144,v,96,v,152
ds_read_b128 v[124:127], v195 offset:6144
s_mov_b32 s79, 0x41000000
MA 148,v,100,v,152
s_mov_b32 s78, 0
MA 208,v,104,v,152
buffer_load_dwordx4 v179, s[8:11], s20 offen offset:3072 lds
v_lshrrev_b32 v240, 3, v1
MA 212,v,108,v,152
TR 152,198,49152
TR 154,198,51200
MA 24,v,80,v,156
v_lshlrev_b32 v240, 11, v240
v_lshrrev_b32 v241, 4, v1
MA 28,v,84,v,156
v_and_b32 v242, 7, v1
v_xor_b32 v242, v242, v241
MA 88,v,88,v,156
ds_read_b128 v[128:131], v195 offset:8192
v_lshl_add_u32 v240, v242, 4, v240
MA 92,v,92,v,156
v_xor_b32 v243, 64, v240
MA 152,v,96,v,156
s_add_u32 m0, s22, 36864
v_add_u32 v208, 0, v240
MA 156,v,100,v,156
v_add_u32 v209, 15360, v243
v_add_u32 v210, 30720, v240
MA 216,v,104,v,156
v_add_u32 v211, 46080, v243
MA 220,v,108,v,156
TR 156,199,49152
TR 158,199,51200
MA 32,v,80,v,160
ds_read_b128 v[132:135], v195 offset:10240
v_and_b32 v242, 15, v1
MA 36,v,84,v,160
buffer_load_dwordx4 v180, s[8:11], s20 offen offset:0 lds
v_lshlrev_b32 v243, 1, v241
MA 96,v,88,v,160
v_xor_b32 v242, v242, v243
v_lshlrev_b32 v240, 13, v241
MA 100,v,92,v,160
v_xor_b32 v243, 0, v242
v_lshl_add_u32 v243, v243, 4, v240
MA 160,v,96,v,160
v_add_u32 v212, 0, v243
MA 164,v,100,v,160
v_xor_b32 v243, 0, v242
MA 224,v,104,v,160
v_lshl_add_u32 v243, v243, 4, v240
MA 228,v,108,v,160
TR 160,200,49152
TR 162,200,51200
MA 40,v,80,v,164
ds_read_b128 v[136:139], v195 offset:12288
buffer_load_dwordx4 v181, s[8:11], s20 offen offset:1024 lds
MA 44,v,84,v,164
v_add_u32 v213, 31744, v243
v_xor_b32 v243, 8, v242
MA 104,v,88,v,164
v_lshl_add_u32 v243, v243, 4, v240
v_add_u32 v214, 63488, v243
MA 108,v,92,v,164
v_xor_b32 v243, 8, v242
v_lshl_add_u32 v243, v243, 4, v240
MA 168,v,96,v,164
v_add_u32 v215, 95232, v243
MA 172,v,100,v,164
ds_read_b128 v[140:143], v195 offset:14336
buffer_load_dwordx4 v182, s[8:11], s20 offen offset:2048 lds
MA 232,v,104,v,164
v_and_b32 v240, 15, v1
v_lshrrev_b32 v242, 1, v240
MA 236,v,108,v,164
TR 164,201,49152
TR 166,201,51200
MA 48,v,80,v,168
v_xor_b32 v242, v242, v241
v_lshlrev_b32 v242, 4, v242
MA 52,v,84,v,168
v_lshl_add_u32 v242, v240, 7, v242
v_add_u32 v224, s67, v242
MA 112,v,88,v,168
buffer_load_dwordx4 v183, s[8:11], s20 offen offset:3072 lds
v_xor_b32 v225, 64, v224
MA 116,v,92,v,168
v_add_u32 v226, 0x10000, v224
v_add_u32 v227, 0x10000, v225
MA 176,v,96,v,168
v_bfe_u32 v240, v1, 2, 2
MA 180,v,100,v,168
v_and_b32 v242, 1, v241
MA 240,v,104,v,168
v_lshl_or_b32 v242, v242, 2, v240
MA 244,v,108,v,168
TR 168,202,49152
TR 170,202,51200
s_waitcnt lgkmcnt(15)
MA 56,v,80,v,172
s_add_u32 s20, s20, 128
v_lshl_add_u32 v240, v241, 3, v240
MA 60,v,84,v,172
v_lshlrev_b32 v240, 8, v240
v_and_b32 v243, 3, v1
MA 120,v,88,v,172
v_lshl_add_u32 v240, v243, 3, v240
v_add_u32 v240, 98304, v240
MA 124,v,92,v,172
v_xor_b32 v243, 0, v242
MA 184,v,96,v,172
v_lshl_add_u32 v216, v243, 5, v240
MA 188,v,100,v,172
v_xor_b32 v243, 1, v242
MA 248,v,104,v,172
MA 252,v,108,v,172
TR 172,203,49152
TR 174,203,51200
s_waitcnt lgkmcnt(2)
MA 0,v,112,v,144
MA 4,v,116,v,144
MA 64,v,120,v,144
MA 68,v,124,v,144
MA 128,v,128,v,144
MA 132,v,132,v,144
MA 192,v,136,v,144
MA 196,v,140,v,144
MA 8,v,112,v,148
MA 12,v,116,v,148
s_waitcnt vmcnt(10) lgkmcnt(0)
s_barrier
MA 72,v,120,v,148
TR 144,196,0
TR 146,196,2048
MA 76,v,124,v,148
ds_read_b128 v[80:83], v192 offset:0
s_add_u32 m0, s23, 32768
MA 136,v,128,v,148
v_lshl_add_u32 v217, v243, 5, v240
v_xor_b32 v243, 2, v242
MA 140,v,132,v,148
v_lshl_add_u32 v218, v243, 5, v240
v_xor_b32 v243, 3, v242
MA 200,v,136,v,148
buffer_load_dwordx4 v184, s[12:15], s21 offen offset:0 lds
v_lshl_add_u32 v219, v243, 5, v240
MA 204,v,140,v,148
TR 148,197,0
TR 150,197,2048
MA 16,v,112,v,152
ds_read_b128 v[84:87], v192 offset:2048
v_xor_b32 v243, 4, v242
MA 20,v,116,v,152
v_lshl_add_u32 v220, v243, 5, v240
v_xor_b32 v243, 5, v242
MA 80,v,120,v,152
v_lshl_add_u32 v221, v243, 5, v240
v_xor_b32 v243, 6, v242
MA 84,v,124,v,152
buffer_load_dwordx4 v185, s[12:15], s21 offen offset:1024 lds
v_lshl_add_u32 v222, v243, 5, v240
MA 144,v,128,v,152
v_xor_b32 v243, 7, v242
v_lshl_add_u32 v223, v243, 5, v240
MA 148,v,132,v,152
ds_read_b128 v[88:91], v192 offset:4096
v_lshlrev_b32 v240, 4, v1
MA 208,v,136,v,152
s_lshl_b32 s80, s3, 12
MA 212,v,140,v,152
TR 152,198,0
TR 154,198,2048
MA 24,v,112,v,156
buffer_load_dwordx4 v186, s[12:15], s21 offen offset:2048 lds
v_add_u32 v12, s80, v240
MA 28,v,116,v,156
v_add_u32 v10, 0x8000, v240
v_add_u32 v11, 0x10000, v240
MA 88,v,120,v,156
ds_read_b128 v[92:95], v192 offset:6144
s_add_u32 s72, s80, 0x8000
MA 92,v,124,v,156
s_add_u32 s73, s80, 0x10000
v_and_b32 v240, 31, v1
MA 152,v,128,v,156
buffer_load_dwordx4 v187, s[12:15], s21 offen offset:3072 lds
v_lshrrev_b32 v242, 5, v1
MA 156,v,132,v,156
v_lshlrev_b32 v243, 2, v242
MA 216,v,136,v,156
v_sub_u32 v13, v240, v243
MA 220,v,140,v,156
TR 156,199,0
TR 158,199,2048
MA 32,v,112,v,160
ds_read_b128 v[96:99], v192 offset:8192
v_mov_b32 v14, 0xff800000
MA 36,v,116,v,160
s_add_u32 m0, s23, 36864
v_and_b32 v240, 15, v1
MA 96,v,120,v,160
v_lshl_add_u32 v240, v242, 4, v240
v_lshlrev_b32 v240, 4, v240
MA 100,v,124,v,160
v_bfe_u32 v243, v1, 4, 1
MA 160,v,128,v,160
ds_read_b128 v[100:103], v192 offset:10240
v_lshl_add_u32 v15, v243, 17, v240
MA 164,v,132,v,160
s_mov_b32 s44, s32
s_mov_b32 s45, s33
MA 224,v,136,v,160
buffer_load_dwordx4 v188, s[12:15], s21 offen offset:0 lds
s_mov_b32 s46, 4194304
MA 228,v,140,v,160
TR 160,200,0
TR 162,200,2048
MA 40,v,112,v,164
s_mov_b32 s47, 0x20000
s_mov_b32 s48, s34
MA 44,v,116,v,164
ds_read_b128 v[104:107], v192 offset:12288
s_mov_b32 s49, s35
MA 104,v,120,v,164
s_mov_b32 s50, 8388608
MA 108,v,124,v,164
buffer_load_dwordx4 v189, s[12:15], s21 offen offset:1024 lds
s_mov_b32 s51, 0x20000
MA 168,v,128,v,164
s_add_u32 s60, s40, 33554432
s_addc_u32 s61, s41, 0
MA 172,v,132,v,164
s_mov_b32 s62, 16777216
MA 232,v,136,v,164
ds_read_b128 v[108:111], v192 offset:14336
s_mov_b32 s63, 0x20000
MA 236,v,140,v,164
TR 164,201,0
TR 166,201,2048
MA 48,v,112,v,168
buffer_load_dwordx4 v190, s[12:15], s21 offen offset:2048 lds
s_lshl_b32 s80, s69, 19
MA 52,v,116,v,168
s_add_u32 s52, s40, s80
s_addc_u32 s53, s41, 0
MA 112,v,120,v,168
s_lshl_b32 s54, s77, 14
MA 116,v,124,v,168
s_mov_b32 s55, 0x20000
MA 176,v,128,v,168
buffer_load_dwordx4 v191, s[12:15], s21 offen offset:3072 lds
s_add_u32 s80, s80, 16760832
MA 180,v,132,v,168
s_add_u32 s56, s40, s80
s_addc_u32 s57, s41, 0
MA 240,v,136,v,168
s_add_u32 s58, s54, 16384
MA 244,v,140,v,168
TR 168,202,0
TR 170,202,2048
MA 56,v,112,v,172
s_mov_b32 s59, 0x20000
v_lshrrev_b32 v230, 5, v1
MA 60,v,116,v,172
s_add_u32 s21, s21, 524288
v_lshlrev_b32 v230, 12, v230
MA 120,v,120,v,172
v_and_b32 v231, 15, v1
MA 124,v,124,v,172
v_lshl_add_u32 v230, v231, 4, v230
MA 184,v,128,v,172
v_bfe_u32 v231, v1, 4, 1
MA 188,v,132,v,172
v_lshl_add_u32 v228, v231, 9, v230
MA 248,v,136,v,172
MA 252,v,140,v,172
TR 172,203,0
TR 174,203,2048
s_waitcnt lgkmcnt(2)
MA 0,v,80,v,144
s_add_u32 m0, s67, 65536
MA 4,v,84,v,144
ds_read_b128 v[112:115], v193 offset:0
MA 64,v,88,v,144
MA 68,v,92,v,144
MA 128,v,96,v,144
MA 132,v,100,v,144
buffer_load_dwordx4 v208, s[44:47], s64 offen offset:0 lds
MA 192,v,104,v,144
MA 196,v,108,v,144
TR 144,196,16384
TR 146,196,18432
MA 8,v,80,v,148
ds_read_b128 v[116:119], v193 offset:2048
MA 12,v,84,v,148
MA 72,v,88,v,148
buffer_load_dwordx4 v209, s[44:47], s64 offen offset:1024 lds
MA 76,v,92,v,148
MA 136,v,96,v,148
MA 140,v,100,v,148
ds_read_b128 v[120:123], v193 offset:4096
MA 200,v,104,v,148
MA 204,v,108,v,148
TR 148,197,16384
TR 150,197,18432
MA 16,v,80,v,152
buffer_load_dwordx4 v210, s[44:47], s64 offen offset:2048 lds
MA 20,v,84,v,152
MA 80,v,88,v,152
MA 84,v,92,v,152
MA 144,v,96,v,152
ds_read_b128 v[124:127], v193 offset:6144
buffer_load_dwordx4 v211, s[44:47], s64 offen offset:3072 lds
MA 148,v,100,v,152
MA 208,v,104,v,152
MA 212,v,108,v,152
TR 152,198,16384
TR 154,198,18432
MA 24,v,80,v,156
MA 28,v,84,v,156
s_add_u32 s64, s64, 128
MA 88,v,88,v,156
ds_read_b128 v[128:131], v193 offset:8192
MA 92,v,92,v,156
MA 152,v,96,v,156
MA 156,v,100,v,156
MA 216,v,104,v,156
MA 220,v,108,v,156
TR 156,199,16384
TR 158,199,18432
MA 32,v,80,v,160
ds_read_b128 v[132:135], v193 offset:10240
s_add_u32 m0, s67, 69632
MA 36,v,84,v,160
MA 96,v,88,v,160
MA 100,v,92,v,160
MA 160,v,96,v,160
buffer_load_dwordx4 v208, s[44:47], s65 offen offset:0 lds
MA 164,v,100,v,160
MA 224,v,104,v,160
MA 228,v,108,v,160
TR 160,200,16384
TR 162,200,18432
MA 40,v,80,v,164
ds_read_b128 v[136:139], v193 offset:12288
MA 44,v,84,v,164
buffer_load_dwordx4 v209, s[44:47], s65 offen offset:1024 lds
MA 104,v,88,v,164
MA 108,v,92,v,164
MA 168,v,96,v,164
MA 172,v,100,v,164
ds_read_b128 v[140:143], v193 offset:14336
MA 232,v,104,v,164
buffer_load_dwordx4 v210, s[44:47], s65 offen offset:2048 lds
MA 236,v,108,v,164
TR 164,201,16384
TR 166,201,18432
MA 48,v,80,v,168
MA 52,v,84,v,168
MA 112,v,88,v,168
MA 116,v,92,v,168
buffer_load_dwordx4 v211, s[44:47], s65 offen offset:3072 lds
MA 176,v,96,v,168
MA 180,v,100,v,168
MA 240,v,104,v,168
MA 244,v,108,v,168
TR 168,202,16384
TR 170,202,18432
s_waitcnt lgkmcnt(15)
MA 56,v,80,v,172
s_add_u32 s65, s65, 128
MA 60,v,84,v,172
MA 120,v,88,v,172
MA 124,v,92,v,172
MA 184,v,96,v,172
MA 188,v,100,v,172
MA 248,v,104,v,172
MA 252,v,108,v,172
TR 172,203,16384
TR 174,203,18432
s_waitcnt lgkmcnt(2)
MA 0,v,112,v,144
MA 4,v,116,v,144
MA 64,v,120,v,144
MA 68,v,124,v,144
MA 128,v,128,v,144
MA 132,v,132,v,144
MA 192,v,136,v,144
MA 196,v,140,v,144
MA 8,v,112,v,148
MA 12,v,116,v,148
s_waitcnt vmcnt(8) lgkmcnt(0)
s_barrier
MA 72,v,120,v,148
TR 144,196,32768
TR 146,196,34816
MA 76,v,124,v,148
ds_read_b128 v[80:83], v192 offset:32768
s_add_u32 m0, s68, 98304
MA 136,v,128,v,148
MA 140,v,132,v,148
MA 200,v,136,v,148
buffer_load_dwordx4 v212, s[48:51], s66 offen offset:0 lds
MA 204,v,140,v,148
TR 148,197,32768
TR 150,197,34816
MA 16,v,112,v,152
ds_read_b128 v[84:87], v192 offset:34816
MA 20,v,116,v,152
MA 80,v,120,v,152
buffer_load_dwordx4 v213, s[48:51], s66 offen offset:1024 lds
MA 84,v,124,v,152
MA 144,v,128,v,152
MA 148,v,132,v,152
ds_read_b128 v[88:91], v192 offset:36864
MA 208,v,136,v,152
MA 212,v,140,v,152
TR 152,198,32768
TR 154,198,34816
MA 24,v,112,v,156
buffer_load_dwordx4 v214, s[48:51], s66 offen offset:2048 lds
MA 28,v,116,v,156
MA 88,v,120,v,156
ds_read_b128 v[92:95], v192 offset:38912
MA 92,v,124,v,156
buffer_load_dwordx4 v215, s[48:51], s66 offen offset:3072 lds
MA 152,v,128,v,156
MA 156,v,132,v,156
MA 216,v,136,v,156
MA 220,v,140,v,156
TR 156,199,32768
TR 158,199,34816
MA 32,v,112,v,160
ds_read_b128 v[96:99], v192 offset:40960
s_add_u32 s66, s66, 524288
MA 36,v,116,v,160
MA 96,v,120,v,160
MA 100,v,124,v,160
MA 160,v,128,v,160
ds_read_b128 v[100:103], v192 offset:43008
s_add_u32 m0, s68, 114688
MA 164,v,132,v,160
MA 224,v,136,v,160
MA 228,v,140,v,160
TR 160,200,32768
TR 162,200,34816
MA 40,v,112,v,164
buffer_load_dwordx4 v212, s[48:51], s66 offen offset:0 lds
MA 44,v,116,v,164
ds_read_b128 v[104:107], v192 offset:45056
MA 104,v,120,v,164
MA 108,v,124,v,164
MA 168,v,128,v,164
buffer_load_dwordx4 v213, s[48:51], s66 offen offset:1024 lds
MA 172,v,132,v,164
MA 232,v,136,v,164
ds_read_b128 v[108:111], v192 offset:47104
MA 236,v,140,v,164
TR 164,201,32768
TR 166,201,34816
MA 48,v,112,v,168
MA 52,v,116,v,168
buffer_load_dwordx4 v214, s[48:51], s66 offen offset:2048 lds
MA 112,v,120,v,168
MA 116,v,124,v,168
MA 176,v,128,v,168
MA 180,v,132,v,168
buffer_load_dwordx4 v215, s[48:51], s66 offen offset:3072 lds
MA 240,v,136,v,168
MA 244,v,140,v,168
TR 168,202,32768
TR 170,202,34816
MA 56,v,112,v,172
MA 60,v,116,v,172
s_add_u32 s66, s66, 524288
MA 120,v,120,v,172
MA 124,v,124,v,172
MA 184,v,128,v,172
MA 188,v,132,v,172
MA 248,v,136,v,172
MA 252,v,140,v,172
TR 172,203,32768
TR 174,203,34816
s_waitcnt lgkmcnt(2)
MA 0,v,80,v,144
s_add_u32 m0, s67, 0
MA 4,v,84,v,144
ds_read_b128 v[112:115], v193 offset:32768
MA 64,v,88,v,144
MA 68,v,92,v,144
MA 128,v,96,v,144
MA 132,v,100,v,144
buffer_load_dwordx4 v208, s[44:47], s64 offen offset:0 lds
MA 192,v,104,v,144
MA 196,v,108,v,144
TR 144,196,49152
TR 146,196,51200
MA 8,v,80,v,148
ds_read_b128 v[116:119], v193 offset:34816
MA 12,v,84,v,148
MA 72,v,88,v,148
buffer_load_dwordx4 v209, s[44:47], s64 offen offset:1024 lds
MA 76,v,92,v,148
MA 136,v,96,v,148
MA 140,v,100,v,148
ds_read_b128 v[120:123], v193 offset:36864
MA 200,v,104,v,148
MA 204,v,108,v,148
TR 148,197,49152
TR 150,197,51200
MA 16,v,80,v,152
buffer_load_dwordx4 v210, s[44:47], s64 offen offset:2048 lds
MA 20,v,84,v,152
MA 80,v,88,v,152
MA 84,v,92,v,152
MA 144,v,96,v,152
ds_read_b128 v[124:127], v193 offset:38912
buffer_load_dwordx4 v211, s[44:47], s64 offen offset:3072 lds
MA 148,v,100,v,152
MA 208,v,104,v,152
MA 212,v,108,v,152
TR 152,198,49152
TR 154,198,51200
MA 24,v,80,v,156
MA 28,v,84,v,156
s_add_u32 s64, s64, 128
MA 88,v,88,v,156
ds_read_b128 v[128:131], v193 offset:40960
MA 92,v,92,v,156
MA 152,v,96,v,156
MA 156,v,100,v,156
MA 216,v,104,v,156
MA 220,v,108,v,156
TR 156,199,49152
TR 158,199,51200
MA 32,v,80,v,160
ds_read_b128 v[132:135], v193 offset:43008
s_add_u32 m0, s67, 4096
MA 36,v,84,v,160
MA 96,v,88,v,160
MA 100,v,92,v,160
MA 160,v,96,v,160
buffer_load_dwordx4 v208, s[44:47], s65 offen offset:0 lds
MA 164,v,100,v,160
MA 224,v,104,v,160
MA 228,v,108,v,160
TR 160,200,49152
TR 162,200,51200
MA 40,v,80,v,164
ds_read_b128 v[136:139], v193 offset:45056
MA 44,v,84,v,164
buffer_load_dwordx4 v209, s[44:47], s65 offen offset:1024 lds
MA 104,v,88,v,164
MA 108,v,92,v,164
MA 168,v,96,v,164
MA 172,v,100,v,164
ds_read_b128 v[140:143], v193 offset:47104
MA 232,v,104,v,164
buffer_load_dwordx4 v210, s[44:47], s65 offen offset:2048 lds
MA 236,v,108,v,164
TR 164,201,49152
TR 166,201,51200
MA 48,v,80,v,168
MA 52,v,84,v,168
MA 112,v,88,v,168
MA 116,v,92,v,168
buffer_load_dwordx4 v211, s[44:47], s65 offen offset:3072 lds
MA 176,v,96,v,168
MA 180,v,100,v,168
MA 240,v,104,v,168
MA 244,v,108,v,168
TR 168,202,49152
TR 170,202,51200
s_waitcnt lgkmcnt(15)
MA 56,v,80,v,172
s_add_u32 s65, s65, 128
MA 60,v,84,v,172
MA 120,v,88,v,172
MA 124,v,92,v,172
MA 184,v,96,v,172
MA 188,v,100,v,172
MA 248,v,104,v,172
MA 252,v,108,v,172
TR 172,203,49152
TR 174,203,51200
s_waitcnt lgkmcnt(2)
MA 0,v,112,v,144
MA 4,v,116,v,144
MA 64,v,120,v,144
MA 68,v,124,v,144
MA 128,v,128,v,144
MA 132,v,132,v,144
MA 192,v,136,v,144
MA 196,v,140,v,144
MA 8,v,112,v,148
MA 12,v,116,v,148
s_waitcnt vmcnt(12) lgkmcnt(0)
s_barrier
MA 72,v,120,v,148
ds_read_b128 v[48:51], v226 offset:0
s_add_u32 m0, s68, 131072
MA 76,v,124,v,148
MA 136,v,128,v,148
ds_read_b128 v[52:55], v226 offset:2048
buffer_load_dwordx4 v212, s[48:51], s66 offen offset:0 lds
MA 140,v,132,v,148
MA 200,v,136,v,148
ds_read_b128 v[56:59], v226 offset:4096
MA 204,v,140,v,148
buffer_load_dwordx4 v213, s[48:51], s66 offen offset:1024 lds
MA 16,v,112,v,152
ds_read_b128 v[60:63], v226 offset:6144
MA 20,v,116,v,152
MA 80,v,120,v,152
TR 16,216,0
buffer_load_dwordx4 v214, s[48:51], s66 offen offset:2048 lds
MA 84,v,124,v,152
MA 144,v,128,v,152
TR 18,216,1024
MA 148,v,132,v,152
buffer_load_dwordx4 v215, s[48:51], s66 offen offset:3072 lds
MA 208,v,136,v,152
TR 20,217,0
MA 212,v,140,v,152
MA 24,v,112,v,156
TR 22,217,1024
s_add_u32 s66, s66, 524288
MA 28,v,116,v,156
MA 88,v,120,v,156
TR 24,218,0
MA 92,v,124,v,156
s_add_u32 m0, s67, 32768
MA 152,v,128,v,156
TR 26,218,1024
MA 156,v,132,v,156
MA 216,v,136,v,156
TR 28,219,0
buffer_load_dwordx4 v208, s[44:47], s64 offen offset:0 lds
MA 220,v,140,v,156
MA 32,v,112,v,160
TR 30,219,1024
MA 36,v,116,v,160
buffer_load_dwordx4 v209, s[44:47], s64 offen offset:1024 lds
MA 96,v,120,v,160
TR 32,220,0
MA 100,v,124,v,160
MA 160,v,128,v,160
TR 34,220,1024
buffer_load_dwordx4 v210, s[44:47], s64 offen offset:2048 lds
MA 164,v,132,v,160
MA 224,v,136,v,160
TR 36,221,0
buffer_load_dwordx4 v211, s[44:47], s64 offen offset:3072 lds
MA 228,v,140,v,160
MA 40,v,112,v,164
TR 38,221,1024
MA 44,v,116,v,164
s_add_u32 s64, s64, 128
MA 104,v,120,v,164
TR 40,222,0
MA 108,v,124,v,164
MA 168,v,128,v,164
TR 42,222,1024
s_add_u32 m0, s67, 36864
MA 172,v,132,v,164
MA 232,v,136,v,164
TR 44,223,0
MA 236,v,140,v,164
buffer_load_dwordx4 v208, s[44:47], s65 offen offset:0 lds
MA 48,v,112,v,168
TR 46,223,1024
MA 52,v,116,v,168
MA 112,v,120,v,168
buffer_load_dwordx4 v209, s[44:47], s65 offen offset:1024 lds
MA 116,v,124,v,168
MA 176,v,128,v,168
MA 180,v,132,v,168
buffer_load_dwordx4 v210, s[44:47], s65 offen offset:2048 lds
MA 240,v,136,v,168
MA 244,v,140,v,168
MA 56,v,112,v,172
buffer_load_dwordx4 v211, s[44:47], s65 offen offset:3072 lds
MA 60,v,116,v,172
MA 120,v,120,v,172
MA 124,v,124,v,172
s_add_u32 s65, s65, 128
MA 184,v,128,v,172
MA 188,v,132,v,172
MA 248,v,136,v,172
MA 252,v,140,v,172
L_p2:
s_waitcnt lgkmcnt(4)
v_mfma_f32_16x16x32_bf16 v[80:83], v[16:19], v[48:51], 0
s_add_u32 s8, s40, 59768832
s_addc_u32 s9, s41, 0
v_mfma_f32_16x16x32_bf16 v[84:87], v[16:19], v[52:55], 0
ds_read_b128 v[64:67], v227 offset:0
v_mfma_f32_16x16x32_bf16 v[88:91], v[16:19], v[56:59], 0
s_mov_b32 s10, 4096
v_mfma_f32_16x16x32_bf16 v[92:95], v[16:19], v[60:63], 0
TR 16,216,8192
TR 18,216,9216
v_mfma_f32_16x16x32_bf16 v[96:99], v[20:23], v[48:51], 0
s_mov_b32 s11, 0x20000
s_mov_b32 s12, s38
v_mfma_f32_16x16x32_bf16 v[100:103], v[20:23], v[52:55], 0
s_mov_b32 s13, s39
v_mfma_f32_16x16x32_bf16 v[104:107], v[20:23], v[56:59], 0
ds_read_b128 v[68:71], v227 offset:2048
s_mov_b32 s14, 256
v_mfma_f32_16x16x32_bf16 v[108:111], v[20:23], v[60:63], 0
TR 20,217,8192
TR 22,217,9216
v_mfma_f32_16x16x32_bf16 v[112:115], v[24:27], v[48:51], 0
s_mov_b32 s15, 0x20000
v_accvgpr_read_b32 v234, a0
v_mfma_f32_16x16x32_bf16 v[116:119], v[24:27], v[52:55], 0
v_accvgpr_read_b32 v235, a1
v_mfma_f32_16x16x32_bf16 v[120:123], v[24:27], v[56:59], 0
v_accvgpr_read_b32 v236, a2
v_mfma_f32_16x16x32_bf16 v[124:127], v[24:27], v[60:63], 0
TR 24,218,8192
TR 26,218,9216
v_mfma_f32_16x16x32_bf16 v[128:131], v[28:31], v[48:51], 0
ds_read_b128 v[72:75], v227 offset:4096
v_accvgpr_read_b32 v237, a3
v_mfma_f32_16x16x32_bf16 v[132:135], v[28:31], v[52:55], 0
v_accvgpr_read_b32 v238, a4
v_accvgpr_read_b32 v239, a5
v_mfma_f32_16x16x32_bf16 v[136:139], v[28:31], v[56:59], 0
v_accvgpr_read_b32 v240, a6
v_mfma_f32_16x16x32_bf16 v[140:143], v[28:31], v[60:63], 0
TR 28,219,8192
TR 30,219,9216
v_mfma_f32_16x16x32_bf16 v[144:147], v[32:35], v[48:51], 0
v_accvgpr_read_b32 v241, a7
v_cvt_pk_bf16_f32 v230, v234, v235
v_mfma_f32_16x16x32_bf16 v[148:151], v[32:35], v[52:55], 0
v_cvt_pk_bf16_f32 v231, v236, v237
v_mfma_f32_16x16x32_bf16 v[152:155], v[32:35], v[56:59], 0
ds_read_b128 v[76:79], v227 offset:6144
v_cvt_pk_bf16_f32 v232, v238, v239
v_mfma_f32_16x16x32_bf16 v[156:159], v[32:35], v[60:63], 0
TR 32,220,8192
TR 34,220,9216
v_mfma_f32_16x16x32_bf16 v[160:163], v[36:39], v[48:51], 0
v_cvt_pk_bf16_f32 v233, v240, v241
buffer_store_dwordx4 v[230:233], v228, s[16:19], s24 offen sc1
v_mfma_f32_16x16x32_bf16 v[164:167], v[36:39], v[52:55], 0
v_accvgpr_read_b32 v246, a8
v_mfma_f32_16x16x32_bf16 v[168:171], v[36:39], v[56:59], 0
v_accvgpr_read_b32 v247, a9
v_mfma_f32_16x16x32_bf16 v[172:175], v[36:39], v[60:63], 0
TR 36,221,8192
TR 38,221,9216
s_waitcnt lgkmcnt(15)
v_mfma_f32_16x16x32_bf16 v[176:179], v[40:43], v[48:51], 0
v_accvgpr_read_b32 v248, a10
v_accvgpr_read_b32 v249, a11
v_mfma_f32_16x16x32_bf16 v[180:183], v[40:43], v[52:55], 0
v_accvgpr_read_b32 v250, a12
v_mfma_f32_16x16x32_bf16 v[184:187], v[40:43], v[56:59], 0
v_accvgpr_read_b32 v251, a13
v_mfma_f32_16x16x32_bf16 v[188:191], v[40:43], v[60:63], 0
TR 40,222,8192
TR 42,222,9216
v_mfma_f32_16x16x32_bf16 v[192:195], v[44:47], v[48:51], 0
v_accvgpr_read_b32 v252, a14
v_accvgpr_read_b32 v253, a15
v_mfma_f32_16x16x32_bf16 v[196:199], v[44:47], v[52:55], 0
v_cvt_pk_bf16_f32 v242, v246, v247
v_mfma_f32_16x16x32_bf16 v[200:203], v[44:47], v[56:59], 0
v_mfma_f32_16x16x32_bf16 v[204:207], v[44:47], v[60:63], 0
TR 44,223,8192
TR 46,223,9216
s_waitcnt lgkmcnt(4)
MV 80,v,16,v,64
v_cvt_pk_bf16_f32 v243, v248, v249
MV 84,v,16,v,68
v_cvt_pk_bf16_f32 v244, v250, v251
MV 88,v,16,v,72
v_cvt_pk_bf16_f32 v245, v252, v253
MV 92,v,16,v,76
MV 96,v,20,v,64
buffer_store_dwordx4 v[242:245], v228, s[16:19], s25 offen sc1
MV 100,v,20,v,68
v_accvgpr_read_b32 v234, a16
MV 104,v,20,v,72
v_accvgpr_read_b32 v235, a17
MV 108,v,20,v,76
s_waitcnt vmcnt(14) lgkmcnt(0)
s_barrier
MV 112,v,24,v,64
TR 16,216,16384
TR 18,216,17408
MV 116,v,24,v,68
ds_read_b128 v[48:51], v224 offset:0
s_add_u32 m0, s68, 98304
MV 120,v,24,v,72
TR 20,217,16384
TR 22,217,17408
MV 124,v,24,v,76
buffer_load_dwordx4 v212, s[48:51], s66 offen offset:0 lds
v_accvgpr_read_b32 v236, a18
MV 128,v,28,v,64
TR 24,218,16384
TR 26,218,17408
MV 132,v,28,v,68
ds_read_b128 v[52:55], v224 offset:2048
buffer_load_dwordx4 v213, s[48:51], s66 offen offset:1024 lds
MV 136,v,28,v,72
v_accvgpr_read_b32 v237, a19
v_accvgpr_read_b32 v238, a20
MV 140,v,28,v,76
TR 28,219,16384
TR 30,219,17408
MV 144,v,32,v,64
ds_read_b128 v[56:59], v224 offset:4096
buffer_load_dwordx4 v214, s[48:51], s66 offen offset:2048 lds
MV 148,v,32,v,68
v_accvgpr_read_b32 v239, a21
v_accvgpr_read_b32 v240, a22
MV 152,v,32,v,72
v_accvgpr_read_b32 v241, a23
v_cvt_pk_bf16_f32 v230, v234, v235
MV 156,v,32,v,76
TR 32,220,16384
TR 34,220,17408
MV 160,v,36,v,64
ds_read_b128 v[60:63], v224 offset:6144
buffer_load_dwordx4 v215, s[48:51], s66 offen offset:3072 lds
MV 164,v,36,v,68
v_cvt_pk_bf16_f32 v231, v236, v237
v_cvt_pk_bf16_f32 v232, v238, v239
MV 168,v,36,v,72
s_add_u32 s66, s66, 524288
v_cvt_pk_bf16_f32 v233, v240, v241
MV 172,v,36,v,76
TR 36,221,16384
TR 38,221,17408
MV 176,v,40,v,64
buffer_store_dwordx4 v[230:233], v228, s[16:19], s26 offen sc1
v_accvgpr_read_b32 v246, a24
MV 180,v,40,v,68
s_add_u32 m0, s67, 65536
v_accvgpr_read_b32 v247, a25
MV 184,v,40,v,72
v_accvgpr_read_b32 v248, a26
MV 188,v,40,v,76
TR 40,222,16384
TR 42,222,17408
MV 192,v,44,v,64
buffer_load_dwordx4 v208, s[44:47], s64 offen offset:0 lds
v_accvgpr_read_b32 v249, a27
MV 196,v,44,v,68
v_accvgpr_read_b32 v250, a28
MV 200,v,44,v,72
MV 204,v,44,v,76
TR 44,223,16384
TR 46,223,17408
s_waitcnt lgkmcnt(4)
MV 80,v,16,v,48
buffer_load_dwordx4 v209, s[44:47], s64 offen offset:1024 lds
v_accvgpr_read_b32 v251, a29
MV 84,v,16,v,52
ds_read_b128 v[64:67], v225 offset:0
v_accvgpr_read_b32 v252, a30
MV 88,v,16,v,56
v_accvgpr_read_b32 v253, a31
MV 92,v,16,v,60
TR 16,216,24576
TR 18,216,25600
MV 96,v,20,v,48
buffer_load_dwordx4 v210, s[44:47], s64 offen offset:2048 lds
v_cvt_pk_bf16_f32 v242, v246, v247
MV 100,v,20,v,52
v_cvt_pk_bf16_f32 v243, v248, v249
MV 104,v,20,v,56
ds_read_b128 v[68:71], v225 offset:2048
buffer_load_dwordx4 v211, s[44:47], s64 offen offset:3072 lds
MV 108,v,20,v,60
TR 20,217,24576
TR 22,217,25600
MV 112,v,24,v,48
v_cvt_pk_bf16_f32 v244, v250, v251
v_cvt_pk_bf16_f32 v245, v252, v253
MV 116,v,24,v,52
s_add_u32 s64, s64, 128
buffer_store_dwordx4 v[242:245], v228, s[16:19], s27 offen sc1
MV 120,v,24,v,56
v_accvgpr_read_b32 v234, a32
MV 124,v,24,v,60
TR 24,218,24576
TR 26,218,25600
MV 128,v,28,v,48
ds_read_b128 v[72:75], v225 offset:4096
s_add_u32 m0, s67, 69632
MV 132,v,28,v,52
v_accvgpr_read_b32 v235, a33
v_accvgpr_read_b32 v236, a34
MV 136,v,28,v,56
MV 140,v,28,v,60
TR 28,219,24576
TR 30,219,25600
MV 144,v,32,v,48
buffer_load_dwordx4 v208, s[44:47], s65 offen offset:0 lds
v_accvgpr_read_b32 v237, a35
MV 148,v,32,v,52
v_accvgpr_read_b32 v238, a36
v_accvgpr_read_b32 v239, a37
MV 152,v,32,v,56
ds_read_b128 v[76:79], v225 offset:6144
buffer_load_dwordx4 v209, s[44:47], s65 offen offset:1024 lds
MV 156,v,32,v,60
TR 32,220,24576
TR 34,220,25600
MV 160,v,36,v,48
v_accvgpr_read_b32 v240, a38
v_accvgpr_read_b32 v241, a39
MV 164,v,36,v,52
buffer_load_dwordx4 v210, s[44:47], s65 offen offset:2048 lds
v_cvt_pk_bf16_f32 v230, v234, v235
MV 168,v,36,v,56
MV 172,v,36,v,60
TR 36,221,24576
TR 38,221,25600
s_waitcnt lgkmcnt(15)
MV 176,v,40,v,48
buffer_load_dwordx4 v211, s[44:47], s65 offen offset:3072 lds
v_cvt_pk_bf16_f32 v231, v236, v237
MV 180,v,40,v,52
v_cvt_pk_bf16_f32 v232, v238, v239
v_cvt_pk_bf16_f32 v233, v240, v241
MV 184,v,40,v,56
MV 188,v,40,v,60
TR 40,222,24576
TR 42,222,25600
MV 192,v,44,v,48
s_add_u32 s65, s65, 128
buffer_store_dwordx4 v[230:233], v228, s[16:19], s28 offen sc1
MV 196,v,44,v,52
v_accvgpr_read_b32 v246, a40
MV 200,v,44,v,56
MV 204,v,44,v,60
TR 44,223,24576
TR 46,223,25600
s_waitcnt lgkmcnt(4)
MV 80,v,16,v,64
v_accvgpr_read_b32 v247, a41
MV 84,v,16,v,68
v_accvgpr_read_b32 v248, a42
MV 88,v,16,v,72
v_accvgpr_read_b32 v249, a43
MV 92,v,16,v,76
MV 96,v,20,v,64
v_accvgpr_read_b32 v250, a44
MV 100,v,20,v,68
v_accvgpr_read_b32 v251, a45
MV 104,v,20,v,72
v_accvgpr_read_b32 v252, a46
MV 108,v,20,v,76
s_waitcnt vmcnt(17) lgkmcnt(0)
s_barrier
MV 112,v,24,v,64
TR 16,216,32768
TR 18,216,33792
MV 116,v,24,v,68
ds_read_b128 v[48:51], v224 offset:32768
s_add_u32 m0, s68, 114688
MV 120,v,24,v,72
TR 20,217,32768
TR 22,217,33792
MV 124,v,24,v,76
buffer_load_dwordx4 v212, s[48:51], s66 offen offset:0 lds
v_accvgpr_read_b32 v253, a47
MV 128,v,28,v,64
TR 24,218,32768
TR 26,218,33792
MV 132,v,28,v,68
ds_read_b128 v[52:55], v224 offset:34816
buffer_load_dwordx4 v213, s[48:51], s66 offen offset:1024 lds
MV 136,v,28,v,72
v_cvt_pk_bf16_f32 v242, v246, v247
v_cvt_pk_bf16_f32 v243, v248, v249
MV 140,v,28,v,76
TR 28,219,32768
TR 30,219,33792
MV 144,v,32,v,64
ds_read_b128 v[56:59], v224 offset:36864
buffer_load_dwordx4 v214, s[48:51], s66 offen offset:2048 lds
MV 148,v,32,v,68
v_cvt_pk_bf16_f32 v244, v250, v251
v_cvt_pk_bf16_f32 v245, v252, v253
MV 152,v,32,v,72
buffer_store_dwordx4 v[242:245], v228, s[16:19], s29 offen sc1
v_accvgpr_read_b32 v234, a48
MV 156,v,32,v,76
TR 32,220,32768
TR 34,220,33792
MV 160,v,36,v,64
ds_read_b128 v[60:63], v224 offset:38912
buffer_load_dwordx4 v215, s[48:51], s66 offen offset:3072 lds
MV 164,v,36,v,68
v_accvgpr_read_b32 v235, a49
v_accvgpr_read_b32 v236, a50
MV 168,v,36,v,72
s_add_u32 s66, s66, 524288
v_accvgpr_read_b32 v237, a51
MV 172,v,36,v,76
TR 36,221,32768
TR 38,221,33792
MV 176,v,40,v,64
v_accvgpr_read_b32 v238, a52
v_accvgpr_read_b32 v239, a53
MV 180,v,40,v,68
s_add_u32 m0, s67, 0
v_accvgpr_read_b32 v240, a54
MV 184,v,40,v,72
v_accvgpr_read_b32 v241, a55
MV 188,v,40,v,76
TR 40,222,32768
TR 42,222,33792
MV 192,v,44,v,64
buffer_load_dwordx4 v208, s[44:47], s64 offen offset:0 lds
v_cvt_pk_bf16_f32 v230, v234, v235
MV 196,v,44,v,68
v_cvt_pk_bf16_f32 v231, v236, v237
MV 200,v,44,v,72
MV 204,v,44,v,76
TR 44,223,32768
TR 46,223,33792
s_waitcnt lgkmcnt(4)
MV 80,v,16,v,48
buffer_load_dwordx4 v209, s[44:47], s64 offen offset:1024 lds
v_cvt_pk_bf16_f32 v232, v238, v239
MV 84,v,16,v,52
ds_read_b128 v[64:67], v225 offset:32768
v_cvt_pk_bf16_f32 v233, v240, v241
MV 88,v,16,v,56
buffer_store_dwordx4 v[230:233], v228, s[16:19], s30 offen sc1
MV 92,v,16,v,60
TR 16,216,40960
TR 18,216,41984
MV 96,v,20,v,48
buffer_load_dwordx4 v210, s[44:47], s64 offen offset:2048 lds
v_accvgpr_read_b32 v246, a56
MV 100,v,20,v,52
v_accvgpr_read_b32 v247, a57
MV 104,v,20,v,56
ds_read_b128 v[68:71], v225 offset:34816
buffer_load_dwordx4 v211, s[44:47], s64 offen offset:3072 lds
MV 108,v,20,v,60
TR 20,217,40960
TR 22,217,41984
MV 112,v,24,v,48
v_accvgpr_read_b32 v248, a58
v_accvgpr_read_b32 v249, a59
MV 116,v,24,v,52
s_add_u32 s64, s64, 128
v_accvgpr_read_b32 v250, a60
MV 120,v,24,v,56
v_accvgpr_read_b32 v251, a61
MV 124,v,24,v,60
TR 24,218,40960
TR 26,218,41984
MV 128,v,28,v,48
ds_read_b128 v[72:75], v225 offset:36864
s_add_u32 m0, s67, 4096
MV 132,v,28,v,52
v_accvgpr_read_b32 v252, a62
v_accvgpr_read_b32 v253, a63
MV 136,v,28,v,56
MV 140,v,28,v,60
TR 28,219,40960
TR 30,219,41984
MV 144,v,32,v,48
buffer_load_dwordx4 v208, s[44:47], s65 offen offset:0 lds
v_cvt_pk_bf16_f32 v242, v246, v247
MV 148,v,32,v,52
v_cvt_pk_bf16_f32 v243, v248, v249
v_cvt_pk_bf16_f32 v244, v250, v251
MV 152,v,32,v,56
ds_read_b128 v[76:79], v225 offset:38912
buffer_load_dwordx4 v209, s[44:47], s65 offen offset:1024 lds
MV 156,v,32,v,60
TR 32,220,40960
TR 34,220,41984
MV 160,v,36,v,48
v_cvt_pk_bf16_f32 v245, v252, v253
buffer_store_dwordx4 v[242:245], v228, s[16:19], s31 offen sc1
MV 164,v,36,v,52
buffer_load_dwordx4 v210, s[44:47], s65 offen offset:2048 lds
v_accvgpr_read_b32 v234, a64
MV 168,v,36,v,56
MV 172,v,36,v,60
TR 36,221,40960
TR 38,221,41984
s_waitcnt lgkmcnt(15)
MV 176,v,40,v,48
buffer_load_dwordx4 v211, s[44:47], s65 offen offset:3072 lds
v_accvgpr_read_b32 v235, a65
MV 180,v,40,v,52
v_accvgpr_read_b32 v236, a66
v_accvgpr_read_b32 v237, a67
MV 184,v,40,v,56
MV 188,v,40,v,60
TR 40,222,40960
TR 42,222,41984
MV 192,v,44,v,48
s_add_u32 s65, s65, 128
v_accvgpr_read_b32 v238, a68
MV 196,v,44,v,52
v_accvgpr_read_b32 v239, a69
MV 200,v,44,v,56
MV 204,v,44,v,60
TR 44,223,40960
TR 46,223,41984
s_waitcnt lgkmcnt(4)
MV 80,v,16,v,64
v_accvgpr_read_b32 v240, a70
MV 84,v,16,v,68
v_accvgpr_read_b32 v241, a71
MV 88,v,16,v,72
v_cvt_pk_bf16_f32 v230, v234, v235
MV 92,v,16,v,76
MV 96,v,20,v,64
v_cvt_pk_bf16_f32 v231, v236, v237
MV 100,v,20,v,68
v_cvt_pk_bf16_f32 v232, v238, v239
MV 104,v,20,v,72
v_cvt_pk_bf16_f32 v233, v240, v241
MV 108,v,20,v,76
s_waitcnt vmcnt(16) lgkmcnt(0)
s_barrier
MV 112,v,24,v,64
TR 16,216,0
TR 18,216,1024
MV 116,v,24,v,68
ds_read_b128 v[48:51], v226 offset:0
s_add_u32 m0, s68, 131072
MV 120,v,24,v,72
TR 20,217,0
TR 22,217,1024
MV 124,v,24,v,76
buffer_load_dwordx4 v212, s[48:51], s66 offen offset:0 lds
s_add_u32 s36, s24, 8192
MV 128,v,28,v,64
TR 24,218,0
TR 26,218,1024
MV 132,v,28,v,68
ds_read_b128 v[52:55], v226 offset:2048
buffer_load_dwordx4 v213, s[48:51], s66 offen offset:1024 lds
MV 136,v,28,v,72
buffer_store_dwordx4 v[230:233], v228, s[16:19], s36 offen sc1
v_accvgpr_read_b32 v246, a72
MV 140,v,28,v,76
TR 28,219,0
TR 30,219,1024
MV 144,v,32,v,64
ds_read_b128 v[56:59], v226 offset:4096
buffer_load_dwordx4 v214, s[48:51], s66 offen offset:2048 lds
MV 148,v,32,v,68
v_accvgpr_read_b32 v247, a73
v_accvgpr_read_b32 v248, a74
MV 152,v,32,v,72
v_accvgpr_read_b32 v249, a75
v_accvgpr_read_b32 v250, a76
MV 156,v,32,v,76
TR 32,220,0
TR 34,220,1024
MV 160,v,36,v,64
ds_read_b128 v[60:63], v226 offset:6144
buffer_load_dwordx4 v215, s[48:51], s66 offen offset:3072 lds
MV 164,v,36,v,68
v_accvgpr_read_b32 v251, a77
v_accvgpr_read_b32 v252, a78
MV 168,v,36,v,72
s_add_u32 s66, s66, 524288
v_accvgpr_read_b32 v253, a79
MV 172,v,36,v,76
TR 36,221,0
TR 38,221,1024
MV 176,v,40,v,64
v_cvt_pk_bf16_f32 v242, v246, v247
v_cvt_pk_bf16_f32 v243, v248, v249
MV 180,v,40,v,68
s_add_u32 m0, s67, 32768
v_cvt_pk_bf16_f32 v244, v250, v251
MV 184,v,40,v,72
v_cvt_pk_bf16_f32 v245, v252, v253
MV 188,v,40,v,76
TR 40,222,0
TR 42,222,1024
MV 192,v,44,v,64
buffer_load_dwordx4 v208, s[44:47], s64 offen offset:0 lds
s_add_u32 s36, s25, 8192
MV 196,v,44,v,68
buffer_store_dwordx4 v[242:245], v228, s[16:19], s36 offen sc1
MV 200,v,44,v,72
MV 204,v,44,v,76
TR 44,223,0
TR 46,223,1024
s_waitcnt lgkmcnt(4)
MV 80,v,16,v,48
buffer_load_dwordx4 v209, s[44:47], s64 offen offset:1024 lds
v_accvgpr_read_b32 v234, a80
MV 84,v,16,v,52
ds_read_b128 v[64:67], v227 offset:0
v_accvgpr_read_b32 v235, a81
MV 88,v,16,v,56
v_accvgpr_read_b32 v236, a82
MV 92,v,16,v,60
TR 16,216,8192
TR 18,216,9216
MV 96,v,20,v,48
buffer_load_dwordx4 v210, s[44:47], s64 offen offset:2048 lds
v_accvgpr_read_b32 v237, a83
MV 100,v,20,v,52
v_accvgpr_read_b32 v238, a84
MV 104,v,20,v,56
ds_read_b128 v[68:71], v227 offset:2048
buffer_load_dwordx4 v211, s[44:47], s64 offen offset:3072 lds
MV 108,v,20,v,60
TR 20,217,8192
TR 22,217,9216
MV 112,v,24,v,48
v_accvgpr_read_b32 v239, a85
v_accvgpr_read_b32 v240, a86
MV 116,v,24,v,52
s_add_u32 s64, s64, 128
v_accvgpr_read_b32 v241, a87
MV 120,v,24,v,56
v_cvt_pk_bf16_f32 v230, v234, v235
MV 124,v,24,v,60
TR 24,218,8192
TR 26,218,9216
MV 128,v,28,v,48
ds_read_b128 v[72:75], v227 offset:4096
s_add_u32 m0, s67, 36864
MV 132,v,28,v,52
v_cvt_pk_bf16_f32 v231, v236, v237
v_cvt_pk_bf16_f32 v232, v238, v239
MV 136,v,28,v,56
MV 140,v,28,v,60
TR 28,219,8192
TR 30,219,9216
MV 144,v,32,v,48
buffer_load_dwordx4 v208, s[44:47], s65 offen offset:0 lds
v_cvt_pk_bf16_f32 v233, v240, v241
MV 148,v,32,v,52
s_add_u32 s36, s26, 8192
buffer_store_dwordx4 v[230:233], v228, s[16:19], s36 offen sc1
MV 152,v,32,v,56
ds_read_b128 v[76:79], v227 offset:6144
buffer_load_dwordx4 v209, s[44:47], s65 offen offset:1024 lds
MV 156,v,32,v,60
TR 32,220,8192
TR 34,220,9216
MV 160,v,36,v,48
v_accvgpr_read_b32 v246, a88
v_accvgpr_read_b32 v247, a89
MV 164,v,36,v,52
buffer_load_dwordx4 v210, s[44:47], s65 offen offset:2048 lds
v_accvgpr_read_b32 v248, a90
MV 168,v,36,v,56
MV 172,v,36,v,60
TR 36,221,8192
TR 38,221,9216
s_waitcnt lgkmcnt(15)
MV 176,v,40,v,48
buffer_load_dwordx4 v211, s[44:47], s65 offen offset:3072 lds
v_accvgpr_read_b32 v249, a91
MV 180,v,40,v,52
v_accvgpr_read_b32 v250, a92
v_accvgpr_read_b32 v251, a93
MV 184,v,40,v,56
MV 188,v,40,v,60
TR 40,222,8192
TR 42,222,9216
MV 192,v,44,v,48
s_add_u32 s65, s65, 128
v_accvgpr_read_b32 v252, a94
MV 196,v,44,v,52
v_accvgpr_read_b32 v253, a95
MV 200,v,44,v,56
MV 204,v,44,v,60
TR 44,223,8192
TR 46,223,9216
s_waitcnt lgkmcnt(4)
MV 80,v,16,v,64
v_cvt_pk_bf16_f32 v242, v246, v247
MV 84,v,16,v,68
v_cvt_pk_bf16_f32 v243, v248, v249
MV 88,v,16,v,72
v_cvt_pk_bf16_f32 v244, v250, v251
MV 92,v,16,v,76
MV 96,v,20,v,64
v_cvt_pk_bf16_f32 v245, v252, v253
MV 100,v,20,v,68
s_add_u32 s36, s27, 8192
MV 104,v,20,v,72
buffer_store_dwordx4 v[242:245], v228, s[16:19], s36 offen sc1
MV 108,v,20,v,76
s_waitcnt vmcnt(16) lgkmcnt(0)
s_barrier
MV 112,v,24,v,64
TR 16,216,16384
TR 18,216,17408
MV 116,v,24,v,68
ds_read_b128 v[48:51], v224 offset:0
s_add_u32 m0, s68, 98304
MV 120,v,24,v,72
TR 20,217,16384
TR 22,217,17408
MV 124,v,24,v,76
buffer_load_dwordx4 v212, s[48:51], s66 offen offset:0 lds
v_accvgpr_read_b32 v234, a96
MV 128,v,28,v,64
TR 24,218,16384
TR 26,218,17408
MV 132,v,28,v,68
ds_read_b128 v[52:55], v224 offset:2048
buffer_load_dwordx4 v213, s[48:51], s66 offen offset:1024 lds
MV 136,v,28,v,72
v_accvgpr_read_b32 v235, a97
v_accvgpr_read_b32 v236, a98
MV 140,v,28,v,76
TR 28,219,16384
TR 30,219,17408
MV 144,v,32,v,64
ds_read_b128 v[56:59], v224 offset:4096
buffer_load_dwordx4 v214, s[48:51], s66 offen offset:2048 lds
MV 148,v,32,v,68
v_accvgpr_read_b32 v237, a99
v_accvgpr_read_b32 v238, a100
MV 152,v,32,v,72
v_accvgpr_read_b32 v239, a101
v_accvgpr_read_b32 v240, a102
MV 156,v,32,v,76
TR 32,220,16384
TR 34,220,17408
MV 160,v,36,v,64
ds_read_b128 v[60:63], v224 offset:6144
buffer_load_dwordx4 v215, s[48:51], s66 offen offset:3072 lds
MV 164,v,36,v,68
v_accvgpr_read_b32 v241, a103
v_cvt_pk_bf16_f32 v230, v234, v235
MV 168,v,36,v,72
s_add_u32 s66, s66, 524288
v_cvt_pk_bf16_f32 v231, v236, v237
MV 172,v,36,v,76
TR 36,221,16384
TR 38,221,17408
MV 176,v,40,v,64
v_cvt_pk_bf16_f32 v232, v238, v239
v_cvt_pk_bf16_f32 v233, v240, v241
MV 180,v,40,v,68
s_add_u32 m0, s67, 65536
s_add_u32 s36, s28, 8192
MV 184,v,40,v,72
buffer_store_dwordx4 v[230:233], v228, s[16:19], s36 offen sc1
MV 188,v,40,v,76
TR 40,222,16384
TR 42,222,17408
MV 192,v,44,v,64
buffer_load_dwordx4 v208, s[44:47], s64 offen offset:0 lds
v_accvgpr_read_b32 v246, a104
MV 196,v,44,v,68
v_accvgpr_read_b32 v247, a105
MV 200,v,44,v,72
MV 204,v,44,v,76
TR 44,223,16384
TR 46,223,17408
s_waitcnt lgkmcnt(4)
MV 80,v,16,v,48
buffer_load_dwordx4 v209, s[44:47], s64 offen offset:1024 lds
v_accvgpr_read_b32 v248, a106
MV 84,v,16,v,52
ds_read_b128 v[64:67], v225 offset:0
v_accvgpr_read_b32 v249, a107
MV 88,v,16,v,56
v_accvgpr_read_b32 v250, a108
MV 92,v,16,v,60
TR 16,216,24576
TR 18,216,25600
MV 96,v,20,v,48
buffer_load_dwordx4 v210, s[44:47], s64 offen offset:2048 lds
v_accvgpr_read_b32 v251, a109
MV 100,v,20,v,52
v_accvgpr_read_b32 v252, a110
MV 104,v,20,v,56
ds_read_b128 v[68:71], v225 offset:2048
buffer_load_dwordx4 v211, s[44:47], s64 offen offset:3072 lds
MV 108,v,20,v,60
TR 20,217,24576
TR 22,217,25600
MV 112,v,24,v,48
v_accvgpr_read_b32 v253, a111
v_cvt_pk_bf16_f32 v242, v246, v247
MV 116,v,24,v,52
s_add_u32 s64, s64, 128
v_cvt_pk_bf16_f32 v243, v248, v249
MV 120,v,24,v,56
v_cvt_pk_bf16_f32 v244, v250, v251
MV 124,v,24,v,60
TR 24,218,24576
TR 26,218,25600
MV 128,v,28,v,48
ds_read_b128 v[72:75], v225 offset:4096
s_add_u32 m0, s67, 69632
MV 132,v,28,v,52
v_cvt_pk_bf16_f32 v245, v252, v253
s_add_u32 s36, s29, 8192
MV 136,v,28,v,56
MV 140,v,28,v,60
TR 28,219,24576
TR 30,219,25600
MV 144,v,32,v,48
buffer_load_dwordx4 v208, s[44:47], s65 offen offset:0 lds
buffer_store_dwordx4 v[242:245], v228, s[16:19], s36 offen sc1
MV 148,v,32,v,52
v_accvgpr_read_b32 v234, a112
v_accvgpr_read_b32 v235, a113
MV 152,v,32,v,56
ds_read_b128 v[76:79], v225 offset:6144
buffer_load_dwordx4 v209, s[44:47], s65 offen offset:1024 lds
MV 156,v,32,v,60
TR 32,220,24576
TR 34,220,25600
MV 160,v,36,v,48
v_accvgpr_read_b32 v236, a114
v_accvgpr_read_b32 v237, a115
MV 164,v,36,v,52
buffer_load_dwordx4 v210, s[44:47], s65 offen offset:2048 lds
v_accvgpr_read_b32 v238, a116
MV 168,v,36,v,56
MV 172,v,36,v,60
TR 36,221,24576
TR 38,221,25600
s_waitcnt lgkmcnt(15)
MV 176,v,40,v,48
buffer_load_dwordx4 v211, s[44:47], s65 offen offset:3072 lds
v_accvgpr_read_b32 v239, a117
MV 180,v,40,v,52
v_accvgpr_read_b32 v240, a118
v_accvgpr_read_b32 v241, a119
MV 184,v,40,v,56
MV 188,v,40,v,60
TR 40,222,24576
TR 42,222,25600
MV 192,v,44,v,48
s_add_u32 s65, s65, 128
v_cvt_pk_bf16_f32 v230, v234, v235
MV 196,v,44,v,52
v_cvt_pk_bf16_f32 v231, v236, v237
MV 200,v,44,v,56
MV 204,v,44,v,60
TR 44,223,24576
TR 46,223,25600
s_waitcnt lgkmcnt(4)
MV 80,v,16,v,64
v_cvt_pk_bf16_f32 v232, v238, v239
MV 84,v,16,v,68
v_cvt_pk_bf16_f32 v233, v240, v241
MV 88,v,16,v,72
s_add_u32 s36, s30, 8192
MV 92,v,16,v,76
MV 96,v,20,v,64
buffer_store_dwordx4 v[230:233], v228, s[16:19], s36 offen sc1
MV 100,v,20,v,68
v_accvgpr_read_b32 v246, a120
MV 104,v,20,v,72
v_accvgpr_read_b32 v247, a121
MV 108,v,20,v,76
s_waitcnt vmcnt(16) lgkmcnt(0)
s_barrier
MV 112,v,24,v,64
TR 16,216,32768
TR 18,216,33792
MV 116,v,24,v,68
ds_read_b128 v[48:51], v224 offset:32768
s_add_u32 m0, s68, 114688
MV 120,v,24,v,72
TR 20,217,32768
TR 22,217,33792
MV 124,v,24,v,76
buffer_load_dwordx4 v212, s[48:51], s66 offen offset:0 lds
v_accvgpr_read_b32 v248, a122
MV 128,v,28,v,64
TR 24,218,32768
TR 26,218,33792
MV 132,v,28,v,68
ds_read_b128 v[52:55], v224 offset:34816
buffer_load_dwordx4 v213, s[48:51], s66 offen offset:1024 lds
MV 136,v,28,v,72
v_accvgpr_read_b32 v249, a123
v_accvgpr_read_b32 v250, a124
MV 140,v,28,v,76
TR 28,219,32768
TR 30,219,33792
MV 144,v,32,v,64
ds_read_b128 v[56:59], v224 offset:36864
buffer_load_dwordx4 v214, s[48:51], s66 offen offset:2048 lds
MV 148,v,32,v,68
v_accvgpr_read_b32 v251, a125
v_accvgpr_read_b32 v252, a126
MV 152,v,32,v,72
v_accvgpr_read_b32 v253, a127
v_cvt_pk_bf16_f32 v242, v246, v247
MV 156,v,32,v,76
TR 32,220,32768
TR 34,220,33792
MV 160,v,36,v,64
ds_read_b128 v[60:63], v224 offset:38912
buffer_load_dwordx4 v215, s[48:51], s66 offen offset:3072 lds
MV 164,v,36,v,68
v_cvt_pk_bf16_f32 v243, v248, v249
v_cvt_pk_bf16_f32 v244, v250, v251
MV 168,v,36,v,72
s_add_u32 s66, s66, 524288
v_cvt_pk_bf16_f32 v245, v252, v253
MV 172,v,36,v,76
TR 36,221,32768
TR 38,221,33792
MV 176,v,40,v,64
s_add_u32 s36, s31, 8192
buffer_store_dwordx4 v[242:245], v228, s[16:19], s36 offen sc1
MV 180,v,40,v,68
s_add_u32 m0, s67, 0
v_accvgpr_read_b32 v234, a128
MV 184,v,40,v,72
v_accvgpr_read_b32 v235, a129
MV 188,v,40,v,76
TR 40,222,32768
TR 42,222,33792
MV 192,v,44,v,64
buffer_load_dwordx4 v208, s[44:47], s64 offen offset:0 lds
v_accvgpr_read_b32 v236, a130
MV 196,v,44,v,68
v_accvgpr_read_b32 v237, a131
MV 200,v,44,v,72
MV 204,v,44,v,76
TR 44,223,32768
TR 46,223,33792
s_waitcnt lgkmcnt(4)
MV 80,v,16,v,48
buffer_load_dwordx4 v209, s[44:47], s64 offen offset:1024 lds
v_accvgpr_read_b32 v238, a132
MV 84,v,16,v,52
ds_read_b128 v[64:67], v225 offset:32768
v_accvgpr_read_b32 v239, a133
MV 88,v,16,v,56
v_accvgpr_read_b32 v240, a134
MV 92,v,16,v,60
TR 16,216,40960
TR 18,216,41984
MV 96,v,20,v,48
buffer_load_dwordx4 v210, s[44:47], s64 offen offset:2048 lds
v_accvgpr_read_b32 v241, a135
MV 100,v,20,v,52
v_cvt_pk_bf16_f32 v230, v234, v235
MV 104,v,20,v,56
ds_read_b128 v[68:71], v225 offset:34816
buffer_load_dwordx4 v211, s[44:47], s64 offen offset:3072 lds
MV 108,v,20,v,60
TR 20,217,40960
TR 22,217,41984
MV 112,v,24,v,48
v_cvt_pk_bf16_f32 v231, v236, v237
v_cvt_pk_bf16_f32 v232, v238, v239
MV 116,v,24,v,52
s_add_u32 s64, s64, 128
v_cvt_pk_bf16_f32 v233, v240, v241
MV 120,v,24,v,56
s_add_u32 s36, s24, 16384
MV 124,v,24,v,60
TR 24,218,40960
TR 26,218,41984
MV 128,v,28,v,48
ds_read_b128 v[72:75], v225 offset:36864
s_add_u32 m0, s67, 4096
MV 132,v,28,v,52
buffer_store_dwordx4 v[230:233], v228, s[16:19], s36 offen sc1
v_accvgpr_read_b32 v246, a136
MV 136,v,28,v,56
MV 140,v,28,v,60
TR 28,219,40960
TR 30,219,41984
MV 144,v,32,v,48
buffer_load_dwordx4 v208, s[44:47], s65 offen offset:0 lds
v_accvgpr_read_b32 v247, a137
MV 148,v,32,v,52
v_accvgpr_read_b32 v248, a138
v_accvgpr_read_b32 v249, a139
MV 152,v,32,v,56
ds_read_b128 v[76:79], v225 offset:38912
buffer_load_dwordx4 v209, s[44:47], s65 offen offset:1024 lds
MV 156,v,32,v,60
TR 32,220,40960
TR 34,220,41984
MV 160,v,36,v,48
v_accvgpr_read_b32 v250, a140
v_accvgpr_read_b32 v251, a141
MV 164,v,36,v,52
buffer_load_dwordx4 v210, s[44:47], s65 offen offset:2048 lds
v_accvgpr_read_b32 v252, a142
MV 168,v,36,v,56
MV 172,v,36,v,60
TR 36,221,40960
TR 38,221,41984
s_waitcnt lgkmcnt(15)
MV 176,v,40,v,48
buffer_load_dwordx4 v211, s[44:47], s65 offen offset:3072 lds
v_accvgpr_read_b32 v253, a143
MV 180,v,40,v,52
v_cvt_pk_bf16_f32 v242, v246, v247
v_cvt_pk_bf16_f32 v243, v248, v249
MV 184,v,40,v,56
MV 188,v,40,v,60
TR 40,222,40960
TR 42,222,41984
MV 192,v,44,v,48
s_add_u32 s65, s65, 128
v_cvt_pk_bf16_f32 v244, v250, v251
MV 196,v,44,v,52
v_cvt_pk_bf16_f32 v245, v252, v253
MV 200,v,44,v,56
MV 204,v,44,v,60
TR 44,223,40960
TR 46,223,41984
s_waitcnt lgkmcnt(4)
MV 80,v,16,v,64
s_add_u32 s36, s25, 16384
MV 84,v,16,v,68
buffer_store_dwordx4 v[242:245], v228, s[16:19], s36 offen sc1
MV 88,v,16,v,72
v_accvgpr_read_b32 v234, a144
MV 92,v,16,v,76
MV 96,v,20,v,64
v_accvgpr_read_b32 v235, a145
MV 100,v,20,v,68
v_accvgpr_read_b32 v236, a146
MV 104,v,20,v,72
v_accvgpr_read_b32 v237, a147
MV 108,v,20,v,76
s_waitcnt vmcnt(16) lgkmcnt(0)
s_barrier
MV 112,v,24,v,64
TR 16,216,0
TR 18,216,1024
MV 116,v,24,v,68
ds_read_b128 v[48:51], v226 offset:0
s_add_u32 m0, s68, 131072
MV 120,v,24,v,72
TR 20,217,0
TR 22,217,1024
MV 124,v,24,v,76
buffer_load_dwordx4 v212, s[48:51], s66 offen offset:0 lds
v_accvgpr_read_b32 v238, a148
MV 128,v,28,v,64
TR 24,218,0
TR 26,218,1024
MV 132,v,28,v,68
ds_read_b128 v[52:55], v226 offset:2048
buffer_load_dwordx4 v213, s[48:51], s66 offen offset:1024 lds
MV 136,v,28,v,72
v_accvgpr_read_b32 v239, a149
v_accvgpr_read_b32 v240, a150
MV 140,v,28,v,76
TR 28,219,0
TR 30,219,1024
MV 144,v,32,v,64
ds_read_b128 v[56:59], v226 offset:4096
buffer_load_dwordx4 v214, s[48:51], s66 offen offset:2048 lds
MV 148,v,32,v,68
v_accvgpr_read_b32 v241, a151
v_cvt_pk_bf16_f32 v230, v234, v235
MV 152,v,32,v,72
v_cvt_pk_bf16_f32 v231, v236, v237
v_cvt_pk_bf16_f32 v232, v238, v239
MV 156,v,32,v,76
TR 32,220,0
TR 34,220,1024
MV 160,v,36,v,64
ds_read_b128 v[60:63], v226 offset:6144
buffer_load_dwordx4 v215, s[48:51], s66 offen offset:3072 lds
MV 164,v,36,v,68
v_cvt_pk_bf16_f32 v233, v240, v241
s_add_u32 s36, s26, 16384
MV 168,v,36,v,72
s_add_u32 s66, s66, 524288
buffer_store_dwordx4 v[230:233], v228, s[16:19], s36 offen sc1
MV 172,v,36,v,76
TR 36,221,0
TR 38,221,1024
MV 176,v,40,v,64
v_accvgpr_read_b32 v246, a152
v_accvgpr_read_b32 v247, a153
MV 180,v,40,v,68
s_add_u32 m0, s67, 32768
v_accvgpr_read_b32 v248, a154
MV 184,v,40,v,72
v_accvgpr_read_b32 v249, a155
MV 188,v,40,v,76
TR 40,222,0
TR 42,222,1024
MV 192,v,44,v,64
buffer_load_dwordx4 v208, s[44:47], s64 offen offset:0 lds
v_accvgpr_read_b32 v250, a156
MV 196,v,44,v,68
v_accvgpr_read_b32 v251, a157
MV 200,v,44,v,72
MV 204,v,44,v,76
TR 44,223,0
TR 46,223,1024
s_waitcnt lgkmcnt(4)
MV 80,v,16,v,48
buffer_load_dwordx4 v209, s[44:47], s64 offen offset:1024 lds
v_accvgpr_read_b32 v252, a158
MV 84,v,16,v,52
ds_read_b128 v[64:67], v227 offset:0
v_accvgpr_read_b32 v253, a159
MV 88,v,16,v,56
v_cvt_pk_bf16_f32 v242, v246, v247
MV 92,v,16,v,60
TR 16,216,8192
TR 18,216,9216
MV 96,v,20,v,48
buffer_load_dwordx4 v210, s[44:47], s64 offen offset:2048 lds
v_cvt_pk_bf16_f32 v243, v248, v249
MV 100,v,20,v,52
v_cvt_pk_bf16_f32 v244, v250, v251
MV 104,v,20,v,56
ds_read_b128 v[68:71], v227 offset:2048
buffer_load_dwordx4 v211, s[44:47], s64 offen offset:3072 lds
MV 108,v,20,v,60
TR 20,217,8192
TR 22,217,9216
MV 112,v,24,v,48
v_cvt_pk_bf16_f32 v245, v252, v253
s_add_u32 s36, s27, 16384
MV 116,v,24,v,52
s_add_u32 s64, s64, 128
buffer_store_dwordx4 v[242:245], v228, s[16:19], s36 offen sc1
MV 120,v,24,v,56
v_accvgpr_read_b32 v234, a160
MV 124,v,24,v,60
TR 24,218,8192
TR 26,218,9216
MV 128,v,28,v,48
ds_read_b128 v[72:75], v227 offset:4096
s_add_u32 m0, s67, 36864
MV 132,v,28,v,52
v_accvgpr_read_b32 v235, a161
v_accvgpr_read_b32 v236, a162
MV 136,v,28,v,56
MV 140,v,28,v,60
TR 28,219,8192
TR 30,219,9216
MV 144,v,32,v,48
buffer_load_dwordx4 v208, s[44:47], s65 offen offset:0 lds
v_accvgpr_read_b32 v237, a163
MV 148,v,32,v,52
v_accvgpr_read_b32 v238, a164
v_accvgpr_read_b32 v239, a165
MV 152,v,32,v,56
ds_read_b128 v[76:79], v227 offset:6144
buffer_load_dwordx4 v209, s[44:47], s65 offen offset:1024 lds
MV 156,v,32,v,60
TR 32,220,8192
TR 34,220,9216
MV 160,v,36,v,48
v_accvgpr_read_b32 v240, a166
v_accvgpr_read_b32 v241, a167
MV 164,v,36,v,52
buffer_load_dwordx4 v210, s[44:47], s65 offen offset:2048 lds
v_cvt_pk_bf16_f32 v230, v234, v235
MV 168,v,36,v,56
MV 172,v,36,v,60
TR 36,221,8192
TR 38,221,9216
s_waitcnt lgkmcnt(15)
MV 176,v,40,v,48
buffer_load_dwordx4 v211, s[44:47], s65 offen offset:3072 lds
v_cvt_pk_bf16_f32 v231, v236, v237
MV 180,v,40,v,52
v_cvt_pk_bf16_f32 v232, v238, v239
v_cvt_pk_bf16_f32 v233, v240, v241
MV 184,v,40,v,56
MV 188,v,40,v,60
TR 40,222,8192
TR 42,222,9216
MV 192,v,44,v,48
s_add_u32 s65, s65, 128
s_add_u32 s36, s28, 16384
MV 196,v,44,v,52
buffer_store_dwordx4 v[230:233], v228, s[16:19], s36 offen sc1
MV 200,v,44,v,56
MV 204,v,44,v,60
TR 44,223,8192
TR 46,223,9216
s_waitcnt lgkmcnt(4)
MV 80,v,16,v,64
v_accvgpr_read_b32 v246, a168
MV 84,v,16,v,68
v_accvgpr_read_b32 v247, a169
MV 88,v,16,v,72
v_accvgpr_read_b32 v248, a170
MV 92,v,16,v,76
MV 96,v,20,v,64
v_accvgpr_read_b32 v249, a171
MV 100,v,20,v,68
v_accvgpr_read_b32 v250, a172
MV 104,v,20,v,72
v_accvgpr_read_b32 v251, a173
MV 108,v,20,v,76
s_waitcnt vmcnt(16) lgkmcnt(0)
s_barrier
MV 112,v,24,v,64
TR 16,216,16384
TR 18,216,17408
MV 116,v,24,v,68
ds_read_b128 v[48:51], v224 offset:0
s_add_u32 m0, s68, 98304
MV 120,v,24,v,72
TR 20,217,16384
TR 22,217,17408
MV 124,v,24,v,76
buffer_load_dwordx4 v212, s[48:51], s66 offen offset:0 lds
v_accvgpr_read_b32 v252, a174
MV 128,v,28,v,64
TR 24,218,16384
TR 26,218,17408
MV 132,v,28,v,68
ds_read_b128 v[52:55], v224 offset:2048
buffer_load_dwordx4 v213, s[48:51], s66 offen offset:1024 lds
MV 136,v,28,v,72
v_accvgpr_read_b32 v253, a175
v_cvt_pk_bf16_f32 v242, v246, v247
MV 140,v,28,v,76
TR 28,219,16384
TR 30,219,17408
MV 144,v,32,v,64
ds_read_b128 v[56:59], v224 offset:4096
buffer_load_dwordx4 v214, s[48:51], s66 offen offset:2048 lds
MV 148,v,32,v,68
v_cvt_pk_bf16_f32 v243, v248, v249
v_cvt_pk_bf16_f32 v244, v250, v251
MV 152,v,32,v,72
v_cvt_pk_bf16_f32 v245, v252, v253
s_add_u32 s36, s29, 16384
MV 156,v,32,v,76
TR 32,220,16384
TR 34,220,17408
MV 160,v,36,v,64
ds_read_b128 v[60:63], v224 offset:6144
buffer_load_dwordx4 v215, s[48:51], s66 offen offset:3072 lds
MV 164,v,36,v,68
buffer_store_dwordx4 v[242:245], v228, s[16:19], s36 offen sc1
v_accvgpr_read_b32 v234, a176
MV 168,v,36,v,72
s_add_u32 s66, s66, 524288
v_accvgpr_read_b32 v235, a177
MV 172,v,36,v,76
TR 36,221,16384
TR 38,221,17408
MV 176,v,40,v,64
v_accvgpr_read_b32 v236, a178
v_accvgpr_read_b32 v237, a179
MV 180,v,40,v,68
s_add_u32 m0, s67, 65536
v_accvgpr_read_b32 v238, a180
MV 184,v,40,v,72
v_accvgpr_read_b32 v239, a181
MV 188,v,40,v,76
TR 40,222,16384
TR 42,222,17408
MV 192,v,44,v,64
buffer_load_dwordx4 v208, s[44:47], s64 offen offset:0 lds
v_accvgpr_read_b32 v240, a182
MV 196,v,44,v,68
v_accvgpr_read_b32 v241, a183
MV 200,v,44,v,72
MV 204,v,44,v,76
TR 44,223,16384
TR 46,223,17408
s_waitcnt lgkmcnt(4)
MV 80,v,16,v,48
buffer_load_dwordx4 v209, s[44:47], s64 offen offset:1024 lds
v_cvt_pk_bf16_f32 v230, v234, v235
MV 84,v,16,v,52
ds_read_b128 v[64:67], v225 offset:0
v_cvt_pk_bf16_f32 v231, v236, v237
MV 88,v,16,v,56
v_cvt_pk_bf16_f32 v232, v238, v239
MV 92,v,16,v,60
TR 16,216,24576
TR 18,216,25600
MV 96,v,20,v,48
buffer_load_dwordx4 v210, s[44:47], s64 offen offset:2048 lds
v_cvt_pk_bf16_f32 v233, v240, v241
MV 100,v,20,v,52
s_add_u32 s36, s30, 16384
MV 104,v,20,v,56
ds_read_b128 v[68:71], v225 offset:2048
buffer_load_dwordx4 v211, s[44:47], s64 offen offset:3072 lds
MV 108,v,20,v,60
TR 20,217,24576
TR 22,217,25600
MV 112,v,24,v,48
buffer_store_dwordx4 v[230:233], v228, s[16:19], s36 offen sc1
v_accvgpr_read_b32 v246, a184
MV 116,v,24,v,52
s_add_u32 s64, s64, 128
v_accvgpr_read_b32 v247, a185
MV 120,v,24,v,56
v_accvgpr_read_b32 v248, a186
MV 124,v,24,v,60
TR 24,218,24576
TR 26,218,25600
MV 128,v,28,v,48
ds_read_b128 v[72:75], v225 offset:4096
s_add_u32 m0, s67, 69632
MV 132,v,28,v,52
v_accvgpr_read_b32 v249, a187
v_accvgpr_read_b32 v250, a188
MV 136,v,28,v,56
v_accvgpr_read_b32 v251, a189
MV 140,v,28,v,60
TR 28,219,24576
TR 30,219,25600
MV 144,v,32,v,48
buffer_load_dwordx4 v208, s[44:47], s65 offen offset:0 lds
v_accvgpr_read_b32 v252, a190
MV 148,v,32,v,52
v_accvgpr_read_b32 v253, a191
MV 152,v,32,v,56
ds_read_b128 v[76:79], v225 offset:6144
buffer_load_dwordx4 v209, s[44:47], s65 offen offset:1024 lds
MV 156,v,32,v,60
TR 32,220,24576
TR 34,220,25600
MV 160,v,36,v,48
v_cvt_pk_bf16_f32 v242, v246, v247
v_cvt_pk_bf16_f32 v243, v248, v249
MV 164,v,36,v,52
buffer_load_dwordx4 v210, s[44:47], s65 offen offset:2048 lds
v_cvt_pk_bf16_f32 v244, v250, v251
MV 168,v,36,v,56
v_cvt_pk_bf16_f32 v245, v252, v253
MV 172,v,36,v,60
TR 36,221,24576
TR 38,221,25600
s_waitcnt lgkmcnt(15)
MV 176,v,40,v,48
buffer_load_dwordx4 v211, s[44:47], s65 offen offset:3072 lds
s_add_u32 s36, s31, 16384
MV 180,v,40,v,52
buffer_store_dwordx4 v[242:245], v228, s[16:19], s36 offen sc1
MV 184,v,40,v,56
v_accvgpr_read_b32 v234, a192
MV 188,v,40,v,60
TR 40,222,24576
TR 42,222,25600
MV 192,v,44,v,48
s_add_u32 s65, s65, 128
v_accvgpr_read_b32 v235, a193
MV 196,v,44,v,52
buffer_load_dword v254, off, s[12:15], 0 sc1
MV 200,v,44,v,56
MV 204,v,44,v,60
TR 44,223,24576
TR 46,223,25600
s_waitcnt lgkmcnt(4)
MV 80,v,16,v,64
v_accvgpr_read_b32 v236, a194
MV 84,v,16,v,68
v_accvgpr_read_b32 v237, a195
MV 88,v,16,v,72
v_accvgpr_read_b32 v238, a196
MV 92,v,16,v,76
MV 96,v,20,v,64
v_accvgpr_read_b32 v239, a197
MV 100,v,20,v,68
v_accvgpr_read_b32 v240, a198
MV 104,v,20,v,72
v_accvgpr_read_b32 v241, a199
MV 108,v,20,v,76
s_waitcnt vmcnt(17) lgkmcnt(0)
s_barrier
MV 112,v,24,v,64
TR 16,216,32768
TR 18,216,33792
MV 116,v,24,v,68
ds_read_b128 v[48:51], v224 offset:32768
s_add_u32 m0, s68, 114688
MV 120,v,24,v,72
TR 20,217,32768
TR 22,217,33792
MV 124,v,24,v,76
buffer_load_dwordx4 v212, s[48:51], s66 offen offset:0 lds
v_cvt_pk_bf16_f32 v230, v234, v235
MV 128,v,28,v,64
TR 24,218,32768
TR 26,218,33792
MV 132,v,28,v,68
ds_read_b128 v[52:55], v224 offset:34816
buffer_load_dwordx4 v213, s[48:51], s66 offen offset:1024 lds
MV 136,v,28,v,72
v_cvt_pk_bf16_f32 v231, v236, v237
v_cvt_pk_bf16_f32 v232, v238, v239
MV 140,v,28,v,76
TR 28,219,32768
TR 30,219,33792
MV 144,v,32,v,64
ds_read_b128 v[56:59], v224 offset:36864
buffer_load_dwordx4 v214, s[48:51], s66 offen offset:2048 lds
MV 148,v,32,v,68
v_cvt_pk_bf16_f32 v233, v240, v241
s_add_u32 s36, s24, 24576
MV 152,v,32,v,72
buffer_store_dwordx4 v[230:233], v228, s[16:19], s36 offen sc1
v_accvgpr_read_b32 v246, a200
MV 156,v,32,v,76
TR 32,220,32768
TR 34,220,33792
MV 160,v,36,v,64
ds_read_b128 v[60:63], v224 offset:38912
buffer_load_dwordx4 v215, s[48:51], s66 offen offset:3072 lds
MV 164,v,36,v,68
v_accvgpr_read_b32 v247, a201
v_accvgpr_read_b32 v248, a202
MV 168,v,36,v,72
s_add_u32 s66, s66, 524288
v_accvgpr_read_b32 v249, a203
MV 172,v,36,v,76
TR 36,221,32768
TR 38,221,33792
MV 176,v,40,v,64
v_accvgpr_read_b32 v250, a204
v_accvgpr_read_b32 v251, a205
MV 180,v,40,v,68
s_add_u32 m0, s67, 0
v_accvgpr_read_b32 v252, a206
MV 184,v,40,v,72
v_accvgpr_read_b32 v253, a207
MV 188,v,40,v,76
TR 40,222,32768
TR 42,222,33792
MV 192,v,44,v,64
buffer_load_dwordx4 v208, s[44:47], s64 offen offset:0 lds
v_cvt_pk_bf16_f32 v242, v246, v247
MV 196,v,44,v,68
v_cvt_pk_bf16_f32 v243, v248, v249
MV 200,v,44,v,72
MV 204,v,44,v,76
TR 44,223,32768
TR 46,223,33792
s_waitcnt lgkmcnt(4)
MV 80,v,16,v,48
buffer_load_dwordx4 v209, s[44:47], s64 offen offset:1024 lds
v_cvt_pk_bf16_f32 v244, v250, v251
MV 84,v,16,v,52
ds_read_b128 v[64:67], v225 offset:32768
v_cvt_pk_bf16_f32 v245, v252, v253
MV 88,v,16,v,56
s_add_u32 s36, s25, 24576
MV 92,v,16,v,60
TR 16,216,40960
TR 18,216,41984
MV 96,v,20,v,48
buffer_load_dwordx4 v210, s[44:47], s64 offen offset:2048 lds
buffer_store_dwordx4 v[242:245], v228, s[16:19], s36 offen sc1
MV 100,v,20,v,52
v_accvgpr_read_b32 v234, a208
MV 104,v,20,v,56
ds_read_b128 v[68:71], v225 offset:34816
buffer_load_dwordx4 v211, s[44:47], s64 offen offset:3072 lds
MV 108,v,20,v,60
TR 20,217,40960
TR 22,217,41984
MV 112,v,24,v,48
v_accvgpr_read_b32 v235, a209
v_accvgpr_read_b32 v236, a210
MV 116,v,24,v,52
s_add_u32 s64, s64, 128
v_accvgpr_read_b32 v237, a211
MV 120,v,24,v,56
v_accvgpr_read_b32 v238, a212
MV 124,v,24,v,60
TR 24,218,40960
TR 26,218,41984
MV 128,v,28,v,48
ds_read_b128 v[72:75], v225 offset:36864
s_add_u32 m0, s67, 4096
MV 132,v,28,v,52
v_accvgpr_read_b32 v239, a213
v_accvgpr_read_b32 v240, a214
MV 136,v,28,v,56
MV 140,v,28,v,60
TR 28,219,40960
TR 30,219,41984
MV 144,v,32,v,48
buffer_load_dwordx4 v208, s[44:47], s65 offen offset:0 lds
v_accvgpr_read_b32 v241, a215
MV 148,v,32,v,52
v_cvt_pk_bf16_f32 v230, v234, v235
v_cvt_pk_bf16_f32 v231, v236, v237
MV 152,v,32,v,56
ds_read_b128 v[76:79], v225 offset:38912
buffer_load_dwordx4 v209, s[44:47], s65 offen offset:1024 lds
MV 156,v,32,v,60
TR 32,220,40960
TR 34,220,41984
MV 160,v,36,v,48
v_cvt_pk_bf16_f32 v232, v238, v239
v_cvt_pk_bf16_f32 v233, v240, v241
MV 164,v,36,v,52
buffer_load_dwordx4 v210, s[44:47], s65 offen offset:2048 lds
s_add_u32 s36, s26, 24576
MV 168,v,36,v,56
MV 172,v,36,v,60
TR 36,221,40960
TR 38,221,41984
s_waitcnt lgkmcnt(15)
MV 176,v,40,v,48
buffer_load_dwordx4 v211, s[44:47], s65 offen offset:3072 lds
buffer_store_dwordx4 v[230:233], v228, s[16:19], s36 offen sc1
MV 180,v,40,v,52
v_accvgpr_read_b32 v246, a216
v_accvgpr_read_b32 v247, a217
MV 184,v,40,v,56
MV 188,v,40,v,60
TR 40,222,40960
TR 42,222,41984
MV 192,v,44,v,48
s_add_u32 s65, s65, 128
v_accvgpr_read_b32 v248, a218
MV 196,v,44,v,52
v_accvgpr_read_b32 v249, a219
MV 200,v,44,v,56
MV 204,v,44,v,60
TR 44,223,40960
TR 46,223,41984
s_waitcnt lgkmcnt(4)
MV 80,v,16,v,64
v_accvgpr_read_b32 v250, a220
MV 84,v,16,v,68
v_accvgpr_read_b32 v251, a221
MV 88,v,16,v,72
v_accvgpr_read_b32 v252, a222
MV 92,v,16,v,76
MV 96,v,20,v,64
v_accvgpr_read_b32 v253, a223
MV 100,v,20,v,68
v_cvt_pk_bf16_f32 v242, v246, v247
MV 104,v,20,v,72
v_cvt_pk_bf16_f32 v243, v248, v249
MV 108,v,20,v,76
s_waitcnt vmcnt(17) lgkmcnt(0)
s_barrier
MV 112,v,24,v,64
TR 16,216,0
TR 18,216,1024
MV 116,v,24,v,68
ds_read_b128 v[48:51], v226 offset:0
s_add_u32 m0, s68, 131072
MV 120,v,24,v,72
TR 20,217,0
TR 22,217,1024
MV 124,v,24,v,76
buffer_load_dwordx4 v212, s[48:51], s66 offen offset:0 lds
v_cvt_pk_bf16_f32 v244, v250, v251
MV 128,v,28,v,64
TR 24,218,0
TR 26,218,1024
MV 132,v,28,v,68
ds_read_b128 v[52:55], v226 offset:2048
buffer_load_dwordx4 v213, s[48:51], s66 offen offset:1024 lds
MV 136,v,28,v,72
v_cvt_pk_bf16_f32 v245, v252, v253
s_add_u32 s36, s27, 24576
MV 140,v,28,v,76
TR 28,219,0
TR 30,219,1024
MV 144,v,32,v,64
ds_read_b128 v[56:59], v226 offset:4096
buffer_load_dwordx4 v214, s[48:51], s66 offen offset:2048 lds
MV 148,v,32,v,68
buffer_store_dwordx4 v[242:245], v228, s[16:19], s36 offen sc1
v_accvgpr_read_b32 v234, a224
MV 152,v,32,v,72
v_accvgpr_read_b32 v235, a225
v_accvgpr_read_b32 v236, a226
MV 156,v,32,v,76
TR 32,220,0
TR 34,220,1024
MV 160,v,36,v,64
ds_read_b128 v[60:63], v226 offset:6144
buffer_load_dwordx4 v215, s[48:51], s66 offen offset:3072 lds
MV 164,v,36,v,68
v_accvgpr_read_b32 v237, a227
v_accvgpr_read_b32 v238, a228
MV 168,v,36,v,72
s_add_u32 s66, s66, 524288
v_accvgpr_read_b32 v239, a229
MV 172,v,36,v,76
TR 36,221,0
TR 38,221,1024
MV 176,v,40,v,64
v_accvgpr_read_b32 v240, a230
v_accvgpr_read_b32 v241, a231
MV 180,v,40,v,68
s_add_u32 m0, s67, 32768
v_cvt_pk_bf16_f32 v230, v234, v235
MV 184,v,40,v,72
v_cvt_pk_bf16_f32 v231, v236, v237
MV 188,v,40,v,76
TR 40,222,0
TR 42,222,1024
MV 192,v,44,v,64
buffer_load_dwordx4 v208, s[44:47], s64 offen offset:0 lds
v_cvt_pk_bf16_f32 v232, v238, v239
MV 196,v,44,v,68
v_cvt_pk_bf16_f32 v233, v240, v241
MV 200,v,44,v,72
MV 204,v,44,v,76
TR 44,223,0
TR 46,223,1024
s_waitcnt lgkmcnt(4)
MV 80,v,16,v,48
buffer_load_dwordx4 v209, s[44:47], s64 offen offset:1024 lds
s_add_u32 s36, s28, 24576
MV 84,v,16,v,52
ds_read_b128 v[64:67], v227 offset:0
buffer_store_dwordx4 v[230:233], v228, s[16:19], s36 offen sc1
MV 88,v,16,v,56
v_accvgpr_read_b32 v246, a232
MV 92,v,16,v,60
TR 16,216,8192
TR 18,216,9216
MV 96,v,20,v,48
buffer_load_dwordx4 v210, s[44:47], s64 offen offset:2048 lds
v_accvgpr_read_b32 v247, a233
MV 100,v,20,v,52
v_accvgpr_read_b32 v248, a234
MV 104,v,20,v,56
ds_read_b128 v[68:71], v227 offset:2048
buffer_load_dwordx4 v211, s[44:47], s64 offen offset:3072 lds
MV 108,v,20,v,60
TR 20,217,8192
TR 22,217,9216
MV 112,v,24,v,48
v_accvgpr_read_b32 v249, a235
v_accvgpr_read_b32 v250, a236
MV 116,v,24,v,52
s_add_u32 s64, s64, 128
v_accvgpr_read_b32 v251, a237
MV 120,v,24,v,56
v_accvgpr_read_b32 v252, a238
MV 124,v,24,v,60
TR 24,218,8192
TR 26,218,9216
MV 128,v,28,v,48
ds_read_b128 v[72:75], v227 offset:4096
s_add_u32 m0, s67, 36864
MV 132,v,28,v,52
v_accvgpr_read_b32 v253, a239
v_cvt_pk_bf16_f32 v242, v246, v247
MV 136,v,28,v,56
MV 140,v,28,v,60
TR 28,219,8192
TR 30,219,9216
MV 144,v,32,v,48
buffer_load_dwordx4 v208, s[44:47], s65 offen offset:0 lds
v_cvt_pk_bf16_f32 v243, v248, v249
MV 148,v,32,v,52
v_cvt_pk_bf16_f32 v244, v250, v251
v_cvt_pk_bf16_f32 v245, v252, v253
MV 152,v,32,v,56
ds_read_b128 v[76:79], v227 offset:6144
buffer_load_dwordx4 v209, s[44:47], s65 offen offset:1024 lds
MV 156,v,32,v,60
TR 32,220,8192
TR 34,220,9216
MV 160,v,36,v,48
s_add_u32 s36, s29, 24576
buffer_store_dwordx4 v[242:245], v228, s[16:19], s36 offen sc1
MV 164,v,36,v,52
buffer_load_dwordx4 v210, s[44:47], s65 offen offset:2048 lds
v_accvgpr_read_b32 v234, a240
MV 168,v,36,v,56
MV 172,v,36,v,60
TR 36,221,8192
TR 38,221,9216
s_waitcnt lgkmcnt(15)
MV 176,v,40,v,48
buffer_load_dwordx4 v211, s[44:47], s65 offen offset:3072 lds
v_accvgpr_read_b32 v235, a241
MV 180,v,40,v,52
v_accvgpr_read_b32 v236, a242
v_accvgpr_read_b32 v237, a243
MV 184,v,40,v,56
MV 188,v,40,v,60
TR 40,222,8192
TR 42,222,9216
MV 192,v,44,v,48
s_add_u32 s65, s65, 128
v_accvgpr_read_b32 v238, a244
MV 196,v,44,v,52
v_accvgpr_read_b32 v239, a245
MV 200,v,44,v,56
MV 204,v,44,v,60
TR 44,223,8192
TR 46,223,9216
s_waitcnt lgkmcnt(4)
MV 80,v,16,v,64
v_accvgpr_read_b32 v240, a246
MV 84,v,16,v,68
v_accvgpr_read_b32 v241, a247
MV 88,v,16,v,72
v_cvt_pk_bf16_f32 v230, v234, v235
MV 92,v,16,v,76
MV 96,v,20,v,64
v_cvt_pk_bf16_f32 v231, v236, v237
MV 100,v,20,v,68
v_cvt_pk_bf16_f32 v232, v238, v239
MV 104,v,20,v,72
v_cvt_pk_bf16_f32 v233, v240, v241
MV 108,v,20,v,76
s_waitcnt vmcnt(16) lgkmcnt(0)
s_barrier
MV 112,v,24,v,64
TR 16,216,16384
TR 18,216,17408
MV 116,v,24,v,68
ds_read_b128 v[48:51], v224 offset:0
s_add_u32 m0, s68, 98304
MV 120,v,24,v,72
TR 20,217,16384
TR 22,217,17408
MV 124,v,24,v,76
buffer_load_dwordx4 v212, s[48:51], s66 offen offset:0 lds
s_add_u32 s36, s30, 24576
MV 128,v,28,v,64
TR 24,218,16384
TR 26,218,17408
MV 132,v,28,v,68
ds_read_b128 v[52:55], v224 offset:2048
buffer_load_dwordx4 v213, s[48:51], s66 offen offset:1024 lds
MV 136,v,28,v,72
buffer_store_dwordx4 v[230:233], v228, s[16:19], s36 offen sc1
v_accvgpr_read_b32 v246, a248
MV 140,v,28,v,76
TR 28,219,16384
TR 30,219,17408
MV 144,v,32,v,64
ds_read_b128 v[56:59], v224 offset:4096
buffer_load_dwordx4 v214, s[48:51], s66 offen offset:2048 lds
MV 148,v,32,v,68
v_accvgpr_read_b32 v247, a249
v_accvgpr_read_b32 v248, a250
MV 152,v,32,v,72
v_accvgpr_read_b32 v249, a251
v_accvgpr_read_b32 v250, a252
MV 156,v,32,v,76
TR 32,220,16384
TR 34,220,17408
MV 160,v,36,v,64
ds_read_b128 v[60:63], v224 offset:6144
buffer_load_dwordx4 v215, s[48:51], s66 offen offset:3072 lds
MV 164,v,36,v,68
v_accvgpr_read_b32 v251, a253
v_accvgpr_read_b32 v252, a254
MV 168,v,36,v,72
s_add_u32 s66, s66, 524288
v_accvgpr_read_b32 v253, a255
MV 172,v,36,v,76
TR 36,221,16384
TR 38,221,17408
MV 176,v,40,v,64
v_cvt_pk_bf16_f32 v242, v246, v247
v_cvt_pk_bf16_f32 v243, v248, v249
MV 180,v,40,v,68
s_add_u32 m0, s67, 65536
v_cvt_pk_bf16_f32 v244, v250, v251
MV 184,v,40,v,72
v_cvt_pk_bf16_f32 v245, v252, v253
MV 188,v,40,v,76
TR 40,222,16384
TR 42,222,17408
MV 192,v,44,v,64
buffer_load_dwordx4 v208, s[44:47], s64 offen offset:0 lds
s_add_u32 s36, s31, 24576
MV 196,v,44,v,68
buffer_store_dwordx4 v[242:245], v228, s[16:19], s36 offen sc1
MV 200,v,44,v,72
MV 204,v,44,v,76
TR 44,223,16384
TR 46,223,17408
s_waitcnt lgkmcnt(4)
MV 80,v,16,v,48
buffer_load_dwordx4 v209, s[44:47], s64 offen offset:1024 lds
v_lshlrev_b32 v255, 20, v1
MV 84,v,16,v,52
ds_read_b128 v[64:67], v225 offset:0
MV 88,v,16,v,56
MV 92,v,16,v,60
TR 16,216,24576
TR 18,216,25600
MV 96,v,20,v,48
buffer_load_dwordx4 v210, s[44:47], s64 offen offset:2048 lds
MV 100,v,20,v,52
MV 104,v,20,v,56
ds_read_b128 v[68:71], v225 offset:2048
buffer_load_dwordx4 v211, s[44:47], s64 offen offset:3072 lds
MV 108,v,20,v,60
TR 20,217,24576
TR 22,217,25600
MV 112,v,24,v,48
MV 116,v,24,v,52
s_add_u32 s64, s64, 128
MV 120,v,24,v,56
s_lshl_b32 s36, s3, 26
MV 124,v,24,v,60
TR 24,218,24576
TR 26,218,25600
MV 128,v,28,v,48
ds_read_b128 v[72:75], v225 offset:4096
s_add_u32 m0, s67, 69632
MV 132,v,28,v,52
MV 136,v,28,v,56
MV 140,v,28,v,60
TR 28,219,24576
TR 30,219,25600
MV 144,v,32,v,48
buffer_load_dwordx4 v208, s[44:47], s65 offen offset:0 lds
MV 148,v,32,v,52
MV 152,v,32,v,56
ds_read_b128 v[76:79], v225 offset:6144
buffer_load_dwordx4 v209, s[44:47], s65 offen offset:1024 lds
MV 156,v,32,v,60
TR 32,220,24576
TR 34,220,25600
MV 160,v,36,v,48
v_add_u32 v255, s36, v255
MV 164,v,36,v,52
buffer_load_dwordx4 v210, s[44:47], s65 offen offset:2048 lds
MV 168,v,36,v,56
MV 172,v,36,v,60
TR 36,221,24576
TR 38,221,25600
s_waitcnt lgkmcnt(15)
MV 176,v,40,v,48
buffer_load_dwordx4 v211, s[44:47], s65 offen offset:3072 lds
MV 180,v,40,v,52
MV 184,v,40,v,56
MV 188,v,40,v,60
TR 40,222,24576
TR 42,222,25600
MV 192,v,44,v,48
s_add_u32 s65, s65, 128
MV 196,v,44,v,52
MV 200,v,44,v,56
MV 204,v,44,v,60
TR 44,223,24576
TR 46,223,25600
s_waitcnt lgkmcnt(4)
MV 80,v,16,v,64
MV 84,v,16,v,68
MV 88,v,16,v,72
MV 92,v,16,v,76
MV 96,v,20,v,64
MV 100,v,20,v,68
MV 104,v,20,v,72
MV 108,v,20,v,76
s_waitcnt vmcnt(14) lgkmcnt(0)
s_barrier
MV 112,v,24,v,64
TR 16,216,32768
TR 18,216,33792
MV 116,v,24,v,68
ds_read_b128 v[48:51], v224 offset:32768
s_add_u32 m0, s68, 114688
MV 120,v,24,v,72
TR 20,217,32768
TR 22,217,33792
MV 124,v,24,v,76
buffer_load_dwordx4 v212, s[48:51], s66 offen offset:0 lds
MV 128,v,28,v,64
TR 24,218,32768
TR 26,218,33792
MV 132,v,28,v,68
ds_read_b128 v[52:55], v224 offset:34816
buffer_load_dwordx4 v213, s[48:51], s66 offen offset:1024 lds
MV 136,v,28,v,72
MV 140,v,28,v,76
TR 28,219,32768
TR 30,219,33792
MV 144,v,32,v,64
ds_read_b128 v[56:59], v224 offset:36864
buffer_load_dwordx4 v214, s[48:51], s66 offen offset:2048 lds
MV 148,v,32,v,68
MV 152,v,32,v,72
MV 156,v,32,v,76
TR 32,220,32768
TR 34,220,33792
MV 160,v,36,v,64
ds_read_b128 v[60:63], v224 offset:38912
buffer_load_dwordx4 v215, s[48:51], s66 offen offset:3072 lds
MV 164,v,36,v,68
MV 168,v,36,v,72
s_add_u32 s66, s66, 524288
MV 172,v,36,v,76
TR 36,221,32768
TR 38,221,33792
MV 176,v,40,v,64
MV 180,v,40,v,68
s_add_u32 m0, s67, 0
MV 184,v,40,v,72
MV 188,v,40,v,76
TR 40,222,32768
TR 42,222,33792
MV 192,v,44,v,64
buffer_load_dwordx4 v208, s[44:47], s64 offen offset:0 lds
MV 196,v,44,v,68
MV 200,v,44,v,72
MV 204,v,44,v,76
TR 44,223,32768
TR 46,223,33792
s_waitcnt lgkmcnt(4)
MV 80,v,16,v,48
buffer_load_dwordx4 v209, s[44:47], s64 offen offset:1024 lds
v_accvgpr_write_b32 a0, 0
MV 84,v,16,v,52
ds_read_b128 v[64:67], v225 offset:32768
v_accvgpr_write_b32 a1, 0
MV 88,v,16,v,56
MV 92,v,16,v,60
TR 16,216,40960
TR 18,216,41984
MV 96,v,20,v,48
buffer_load_dwordx4 v210, s[44:47], s64 offen offset:2048 lds
v_accvgpr_write_b32 a2, 0
MV 100,v,20,v,52
v_accvgpr_write_b32 a3, 0
MV 104,v,20,v,56
ds_read_b128 v[68:71], v225 offset:34816
buffer_load_dwordx4 v211, s[44:47], s64 offen offset:3072 lds
MV 108,v,20,v,60
TR 20,217,40960
TR 22,217,41984
MV 112,v,24,v,48
v_accvgpr_write_b32 a4, 0
MV 116,v,24,v,52
s_add_u32 s64, s64, 128
v_accvgpr_write_b32 a5, 0
MV 120,v,24,v,56
MV 124,v,24,v,60
TR 24,218,40960
TR 26,218,41984
MV 128,v,28,v,48
ds_read_b128 v[72:75], v225 offset:36864
s_add_u32 m0, s67, 4096
MV 132,v,28,v,52
v_accvgpr_write_b32 a6, 0
v_accvgpr_write_b32 a7, 0
MV 136,v,28,v,56
MV 140,v,28,v,60
TR 28,219,40960
TR 30,219,41984
MV 144,v,32,v,48
buffer_load_dwordx4 v208, s[44:47], s65 offen offset:0 lds
v_accvgpr_write_b32 a8, 0
MV 148,v,32,v,52
v_accvgpr_write_b32 a9, 0
MV 152,v,32,v,56
ds_read_b128 v[76:79], v225 offset:38912
buffer_load_dwordx4 v209, s[44:47], s65 offen offset:1024 lds
MV 156,v,32,v,60
TR 32,220,40960
TR 34,220,41984
MV 160,v,36,v,48
v_accvgpr_write_b32 a10, 0
v_accvgpr_write_b32 a11, 0
MV 164,v,36,v,52
buffer_load_dwordx4 v210, s[44:47], s65 offen offset:2048 lds
MV 168,v,36,v,56
v_accvgpr_write_b32 a12, 0
MV 172,v,36,v,60
TR 36,221,40960
TR 38,221,41984
s_waitcnt lgkmcnt(15)
MV 176,v,40,v,48
buffer_load_dwordx4 v211, s[44:47], s65 offen offset:3072 lds
v_accvgpr_write_b32 a13, 0
MV 180,v,40,v,52
MV 184,v,40,v,56
v_accvgpr_write_b32 a14, 0
MV 188,v,40,v,60
TR 40,222,40960
TR 42,222,41984
MV 192,v,44,v,48
s_add_u32 s65, s65, 128
v_accvgpr_write_b32 a15, 0
MV 196,v,44,v,52
MV 200,v,44,v,56
MV 204,v,44,v,60
TR 44,223,40960
TR 46,223,41984
s_waitcnt lgkmcnt(4)
MV 80,v,16,v,64
v_accvgpr_write_b32 a16, 0
MV 84,v,16,v,68
v_accvgpr_write_b32 a17, 0
MV 88,v,16,v,72
MV 92,v,16,v,76
v_accvgpr_write_b32 a18, 0
MV 96,v,20,v,64
MV 100,v,20,v,68
v_accvgpr_write_b32 a19, 0
MV 104,v,20,v,72
MV 108,v,20,v,76
s_waitcnt vmcnt(12) lgkmcnt(0)
s_barrier
MV 112,v,24,v,64
v_cmp_ne_u32 vcc, 1, v254
s_nop 4
s_cbranch_vccnz L_spin_go
L_spin_go_ret:
v_mov_b32 v254, 1
s_lshl_b32 s36, s2, 2
buffer_store_dword v254, v255, s[8:11], s36 offen offset:0 sc1
s_load_dwordx4 s[32:35], s[0:1], 32
s_load_dwordx2 s[4:5], s[0:1], 88
MV 116,v,24,v,68
TR 16,216,0
TR 18,216,1024
MV 120,v,24,v,72
TR 20,217,0
TR 22,217,1024
MV 124,v,24,v,76
ds_read_b128 v[48:51], v226 offset:0
s_add_u32 m0, s68, 131072
MV 128,v,28,v,64
TR 24,218,0
TR 26,218,1024
MV 132,v,28,v,68
ds_read_b128 v[52:55], v226 offset:2048
buffer_load_dwordx4 v212, s[48:51], s66 offen offset:0 lds
MV 136,v,28,v,72
buffer_load_dwordx4 v213, s[48:51], s66 offen offset:1024 lds
v_accvgpr_write_b32 a20, 0
MV 140,v,28,v,76
TR 28,219,0
TR 30,219,1024
MV 144,v,32,v,64
ds_read_b128 v[56:59], v226 offset:4096
buffer_load_dwordx4 v214, s[48:51], s66 offen offset:2048 lds
MV 148,v,32,v,68
v_accvgpr_write_b32 a21, 0
v_accvgpr_write_b32 a22, 0
MV 152,v,32,v,72
v_accvgpr_write_b32 a23, 0
v_accvgpr_write_b32 a24, 0
MV 156,v,32,v,76
TR 32,220,0
TR 34,220,1024
MV 160,v,36,v,64
ds_read_b128 v[60:63], v226 offset:6144
buffer_load_dwordx4 v215, s[48:51], s66 offen offset:3072 lds
MV 164,v,36,v,68
v_accvgpr_write_b32 a25, 0
v_accvgpr_write_b32 a26, 0
MV 168,v,36,v,72
s_add_u32 s66, s66, 524288
v_accvgpr_write_b32 a27, 0
MV 172,v,36,v,76
TR 36,221,0
TR 38,221,1024
MV 176,v,40,v,64
v_accvgpr_write_b32 a28, 0
v_accvgpr_write_b32 a29, 0
MV 180,v,40,v,68
s_add_u32 m0, s67, 32768
MV 184,v,40,v,72
v_accvgpr_write_b32 a30, 0
MV 188,v,40,v,76
TR 40,222,0
TR 42,222,1024
MV 192,v,44,v,64
buffer_load_dwordx4 v208, s[44:47], s64 offen offset:0 lds
v_accvgpr_write_b32 a31, 0
MV 196,v,44,v,68
MV 200,v,44,v,72
MV 204,v,44,v,76
TR 44,223,0
TR 46,223,1024
s_waitcnt lgkmcnt(4)
MV 80,v,16,v,48
buffer_load_dwordx4 v209, s[44:47], s64 offen offset:1024 lds
v_accvgpr_write_b32 a32, 0
MV 84,v,16,v,52
ds_read_b128 v[64:67], v227 offset:0
v_accvgpr_write_b32 a33, 0
MV 88,v,16,v,56
v_accvgpr_write_b32 a34, 0
v_accvgpr_write_b32 a35, 0
MV 92,v,16,v,60
TR 16,216,8192
TR 18,216,9216
MV 96,v,20,v,48
buffer_load_dwordx4 v210, s[44:47], s64 offen offset:2048 lds
v_accvgpr_write_b32 a36, 0
MV 100,v,20,v,52
v_accvgpr_write_b32 a37, 0
v_accvgpr_write_b32 a38, 0
MV 104,v,20,v,56
ds_read_b128 v[68:71], v227 offset:2048
buffer_load_dwordx4 v211, s[44:47], s64 offen offset:3072 lds
MV 108,v,20,v,60
TR 20,217,8192
TR 22,217,9216
MV 112,v,24,v,48
v_accvgpr_write_b32 a39, 0
v_accvgpr_write_b32 a40, 0
MV 116,v,24,v,52
s_add_u32 s64, s64, 128
v_accvgpr_write_b32 a41, 0
MV 120,v,24,v,56
v_accvgpr_write_b32 a42, 0
v_accvgpr_write_b32 a43, 0
MV 124,v,24,v,60
TR 24,218,8192
TR 26,218,9216
MV 128,v,28,v,48
ds_read_b128 v[72:75], v227 offset:4096
s_add_u32 m0, s67, 36864
MV 132,v,28,v,52
v_accvgpr_write_b32 a44, 0
v_accvgpr_write_b32 a45, 0
MV 136,v,28,v,56
v_accvgpr_write_b32 a46, 0
v_accvgpr_write_b32 a47, 0
MV 140,v,28,v,60
TR 28,219,8192
TR 30,219,9216
MV 144,v,32,v,48
buffer_load_dwordx4 v208, s[44:47], s65 offen offset:0 lds
s_and_b32 s36, s2, 3
MV 148,v,32,v,52
s_lshl_b32 s36, s36, 1
s_sub_u32 s43, 14, s36
MV 152,v,32,v,56
ds_read_b128 v[76:79], v227 offset:6144
buffer_load_dwordx4 v209, s[44:47], s65 offen offset:1024 lds
MV 156,v,32,v,60
TR 32,220,8192
TR 34,220,9216
MV 160,v,36,v,48
s_bitcmp1_b32 s2, 4
s_cselect_b32 s36, s43, s36
MV 164,v,36,v,52
buffer_load_dwordx4 v210, s[44:47], s65 offen offset:2048 lds
s_bfe_u32 s43, s2, 0x10003
MV 168,v,36,v,56
s_add_u32 s36, s36, s43
s_bfe_u32 s37, s2, 0x10002
MV 172,v,36,v,60
TR 36,221,8192
TR 38,221,9216
s_waitcnt lgkmcnt(15)
MV 176,v,40,v,48
buffer_load_dwordx4 v211, s[44:47], s65 offen offset:3072 lds
s_lshl_b32 s37, s37, 3
MV 180,v,40,v,52
s_lshr_b32 s43, s2, 5
s_add_u32 s37, s37, s43
MV 184,v,40,v,56
v_and_b32 v230, 15, v1
s_lshl_b32 s36, s36, 4
MV 188,v,40,v,60
TR 40,222,8192
TR 42,222,9216
MV 192,v,44,v,48
s_add_u32 s65, s65, 128
v_add_u32 v231, s36, v230
MV 196,v,44,v,52
s_lshr_b32 s36, s2, 4
v_lshl_add_u32 v232, v230, 4, s36
MV 200,v,44,v,56
v_and_b32 v233, 7, v1
v_bfe_u32 v234, v1, 3, 1
MV 204,v,44,v,60
TR 44,223,8192
TR 46,223,9216
v_lshlrev_b32 v233, 3, v233
v_lshl_add_u32 v233, v234, 7, v233
s_bfe_u32 s36, s2, 0x10004
s_lshl_b32 s36, s36, 6
s_and_b32 s37, s2, 7
s_add_u32 s36, s36, s37
v_add_u32 v233, s36, v233
v_lshrrev_b32 v234, 4, v1
v_cmp_eq_u32 vcc, 1, v234
s_nop 1
v_cndmask_b32 v233, v233, v232, vcc
v_cmp_eq_u32 vcc, 2, v234
s_nop 1
v_cndmask_b32 v233, v233, v231, vcc
v_lshlrev_b32 v233, 2, v233
s_waitcnt lgkmcnt(4)
MV 80,v,16,v,64
v_accvgpr_write_b32 a48, 0
MV 84,v,16,v,68
v_accvgpr_write_b32 a49, 0
MV 88,v,16,v,72
MV 92,v,16,v,76
v_accvgpr_write_b32 a50, 0
MV 96,v,20,v,64
MV 100,v,20,v,68
v_accvgpr_write_b32 a51, 0
MV 104,v,20,v,72
MV 108,v,20,v,76
s_waitcnt vmcnt(13) lgkmcnt(0)
s_barrier
MV 112,v,24,v,64
TR 16,216,16384
TR 18,216,17408
MV 116,v,24,v,68
ds_read_b128 v[48:51], v224 offset:0
s_add_u32 m0, s68, 98304
MV 120,v,24,v,72
TR 20,217,16384
TR 22,217,17408
MV 124,v,24,v,76
buffer_load_dwordx4 v212, s[48:51], s66 offen offset:0 lds
v_accvgpr_write_b32 a52, 0
MV 128,v,28,v,64
TR 24,218,16384
TR 26,218,17408
MV 132,v,28,v,68
ds_read_b128 v[52:55], v224 offset:2048
buffer_load_dwordx4 v213, s[48:51], s66 offen offset:1024 lds
MV 136,v,28,v,72
v_accvgpr_write_b32 a53, 0
v_accvgpr_write_b32 a54, 0
MV 140,v,28,v,76
TR 28,219,16384
TR 30,219,17408
MV 144,v,32,v,64
ds_read_b128 v[56:59], v224 offset:4096
buffer_load_dwordx4 v214, s[48:51], s66 offen offset:2048 lds
MV 148,v,32,v,68
v_accvgpr_write_b32 a55, 0
v_accvgpr_write_b32 a56, 0
MV 152,v,32,v,72
v_accvgpr_write_b32 a57, 0
v_accvgpr_write_b32 a58, 0
MV 156,v,32,v,76
TR 32,220,16384
TR 34,220,17408
MV 160,v,36,v,64
ds_read_b128 v[60:63], v224 offset:6144
buffer_load_dwordx4 v215, s[48:51], s66 offen offset:3072 lds
MV 164,v,36,v,68
v_accvgpr_write_b32 a59, 0
MV 168,v,36,v,72
s_add_u32 s66, s66, 524288
v_accvgpr_write_b32 a60, 0
MV 172,v,36,v,76
TR 36,221,16384
TR 38,221,17408
MV 176,v,40,v,64
v_accvgpr_write_b32 a61, 0
MV 180,v,40,v,68
s_add_u32 m0, s67, 65536
MV 184,v,40,v,72
v_accvgpr_write_b32 a62, 0
MV 188,v,40,v,76
TR 40,222,16384
TR 42,222,17408
MV 192,v,44,v,64
buffer_load_dwordx4 v208, s[44:47], s64 offen offset:0 lds
v_accvgpr_write_b32 a63, 0
MV 196,v,44,v,68
MV 200,v,44,v,72
MV 204,v,44,v,76
TR 44,223,16384
TR 46,223,17408
s_waitcnt lgkmcnt(4)
MV 80,v,16,v,48
buffer_load_dwordx4 v209, s[44:47], s64 offen offset:1024 lds
v_accvgpr_write_b32 a64, 0
MV 84,v,16,v,52
ds_read_b128 v[64:67], v225 offset:0
v_accvgpr_write_b32 a65, 0
MV 88,v,16,v,56
v_accvgpr_write_b32 a66, 0
v_accvgpr_write_b32 a67, 0
MV 92,v,16,v,60
TR 16,216,24576
TR 18,216,25600
MV 96,v,20,v,48
buffer_load_dwordx4 v210, s[44:47], s64 offen offset:2048 lds
v_accvgpr_write_b32 a68, 0
MV 100,v,20,v,52
v_accvgpr_write_b32 a69, 0
v_accvgpr_write_b32 a70, 0
MV 104,v,20,v,56
ds_read_b128 v[68:71], v225 offset:2048
buffer_load_dwordx4 v211, s[44:47], s64 offen offset:3072 lds
MV 108,v,20,v,60
TR 20,217,24576
TR 22,217,25600
MV 112,v,24,v,48
v_accvgpr_write_b32 a71, 0
v_accvgpr_write_b32 a72, 0
MV 116,v,24,v,52
s_add_u32 s64, s64, 128
v_accvgpr_write_b32 a73, 0
MV 120,v,24,v,56
v_accvgpr_write_b32 a74, 0
v_accvgpr_write_b32 a75, 0
MV 124,v,24,v,60
TR 24,218,24576
TR 26,218,25600
MV 128,v,28,v,48
ds_read_b128 v[72:75], v225 offset:4096
s_add_u32 m0, s67, 69632
MV 132,v,28,v,52
v_accvgpr_write_b32 a76, 0
v_accvgpr_write_b32 a77, 0
MV 136,v,28,v,56
v_accvgpr_write_b32 a78, 0
v_accvgpr_write_b32 a79, 0
MV 140,v,28,v,60
TR 28,219,24576
TR 30,219,25600
MV 144,v,32,v,48
buffer_load_dwordx4 v208, s[44:47], s65 offen offset:0 lds
s_lshl_b32 s36, s2, 2
MV 148,v,32,v,52
s_add_u32 s36, s36, s3
s_lshl_b32 s42, s36, 1
MV 152,v,32,v,56
ds_read_b128 v[76:79], v225 offset:6144
buffer_load_dwordx4 v209, s[44:47], s65 offen offset:1024 lds
MV 156,v,32,v,60
TR 32,220,24576
TR 34,220,25600
MV 160,v,36,v,48
s_lshl_b32 s37, s36, 12
MV 164,v,36,v,52
buffer_load_dwordx4 v210, s[44:47], s65 offen offset:2048 lds
MV 168,v,36,v,56
s_add_u32 s16, s32, s37
s_addc_u32 s17, s33, 0
MV 172,v,36,v,60
TR 36,221,24576
TR 38,221,25600
s_waitcnt lgkmcnt(15)
MV 176,v,40,v,48
buffer_load_dwordx4 v211, s[44:47], s65 offen offset:3072 lds
s_mov_b32 s18, 4096
MV 180,v,40,v,52
s_mov_b32 s19, 0x20000
s_add_u32 s37, s37, 50331648
MV 184,v,40,v,56
s_add_u32 s20, s40, s37
s_addc_u32 s21, s41, 0
MV 188,v,40,v,60
TR 40,222,24576
TR 42,222,25600
MV 192,v,44,v,48
s_add_u32 s65, s65, 128
s_mov_b32 s22, 4096
MV 196,v,44,v,52
s_mov_b32 s23, 0x20000
s_lshl_b32 s37, s2, 14
MV 200,v,44,v,56
s_add_u32 s37, s37, 54525952
MV 204,v,44,v,60
TR 44,223,24576
TR 46,223,25600
s_add_u32 s24, s40, s37
s_addc_u32 s25, s41, 0
s_mov_b32 s26, 16384
s_mov_b32 s27, 0x20000
s_mov_b32 s28, s34
s_mov_b32 s29, s35
s_mov_b32 s30, 2048
s_mov_b32 s31, 0x20000
s_mul_i32 s43, s3, 4608
s_add_u32 s43, s43, 131072
s_waitcnt lgkmcnt(4)
MV 80,v,16,v,64
v_accvgpr_write_b32 a80, 0
MV 84,v,16,v,68
v_accvgpr_write_b32 a81, 0
MV 88,v,16,v,72
v_accvgpr_write_b32 a82, 0
MV 92,v,16,v,76
v_accvgpr_write_b32 a83, 0
MV 96,v,20,v,64
MV 100,v,20,v,68
v_accvgpr_write_b32 a84, 0
MV 104,v,20,v,72
v_accvgpr_write_b32 a85, 0
MV 108,v,20,v,76
s_waitcnt vmcnt(12) lgkmcnt(0)
s_barrier
MV 112,v,24,v,64
TR 16,216,32768
TR 18,216,33792
MV 116,v,24,v,68
ds_read_b128 v[48:51], v224 offset:32768
v_accvgpr_write_b32 a86, 0
MV 120,v,24,v,72
TR 20,217,32768
TR 22,217,33792
MV 124,v,24,v,76
v_accvgpr_write_b32 a87, 0
v_accvgpr_write_b32 a88, 0
MV 128,v,28,v,64
TR 24,218,32768
TR 26,218,33792
MV 132,v,28,v,68
ds_read_b128 v[52:55], v224 offset:34816
v_accvgpr_write_b32 a89, 0
MV 136,v,28,v,72
v_accvgpr_write_b32 a90, 0
v_accvgpr_write_b32 a91, 0
MV 140,v,28,v,76
TR 28,219,32768
TR 30,219,33792
MV 144,v,32,v,64
ds_read_b128 v[56:59], v224 offset:36864
v_accvgpr_write_b32 a92, 0
MV 148,v,32,v,68
v_accvgpr_write_b32 a93, 0
MV 152,v,32,v,72
v_accvgpr_write_b32 a94, 0
MV 156,v,32,v,76
TR 32,220,32768
TR 34,220,33792
MV 160,v,36,v,64
ds_read_b128 v[60:63], v224 offset:38912
v_accvgpr_write_b32 a95, 0
MV 164,v,36,v,68
s_mov_b32 s6, 0x800000
s_mov_b32 s7, 0x20000
MV 168,v,36,v,72
MV 172,v,36,v,76
TR 36,221,32768
TR 38,221,33792
MV 176,v,40,v,64
v_lshlrev_b32 v235, 7, v1
MV 180,v,40,v,68
s_lshl_b32 s36, s2, 2
s_add_u32 s36, s36, s3
s_lshl_b32 s36, s36, 13
buffer_load_dword v236, v235, s[4:7], s36 offen
MV 184,v,40,v,72
MV 188,v,40,v,76
TR 40,222,32768
TR 42,222,33792
MV 192,v,44,v,64
MV 196,v,44,v,68
MV 200,v,44,v,72
MV 204,v,44,v,76
TR 44,223,32768
TR 46,223,33792
s_waitcnt lgkmcnt(4)
MV 80,v,16,v,48
v_accvgpr_write_b32 a96, 0
MV 84,v,16,v,52
ds_read_b128 v[64:67], v225 offset:32768
v_accvgpr_write_b32 a97, 0
MV 88,v,16,v,56
MV 92,v,16,v,60
TR 16,216,40960
TR 18,216,41984
MV 96,v,20,v,48
v_accvgpr_write_b32 a98, 0
MV 100,v,20,v,52
v_accvgpr_write_b32 a99, 0
MV 104,v,20,v,56
ds_read_b128 v[68:71], v225 offset:34816
MV 108,v,20,v,60
TR 20,217,40960
TR 22,217,41984
MV 112,v,24,v,48
v_accvgpr_write_b32 a100, 0
MV 116,v,24,v,52
v_accvgpr_write_b32 a101, 0
MV 120,v,24,v,56
MV 124,v,24,v,60
TR 24,218,40960
TR 26,218,41984
MV 128,v,28,v,48
ds_read_b128 v[72:75], v225 offset:36864
v_accvgpr_write_b32 a102, 0
MV 132,v,28,v,52
v_accvgpr_write_b32 a103, 0
MV 136,v,28,v,56
MV 140,v,28,v,60
TR 28,219,40960
TR 30,219,41984
MV 144,v,32,v,48
v_accvgpr_write_b32 a104, 0
v_accvgpr_write_b32 a105, 0
MV 148,v,32,v,52
MV 152,v,32,v,56
ds_read_b128 v[76:79], v225 offset:38912
v_accvgpr_write_b32 a106, 0
MV 156,v,32,v,60
TR 32,220,40960
TR 34,220,41984
MV 160,v,36,v,48
v_accvgpr_write_b32 a107, 0
MV 164,v,36,v,52
MV 168,v,36,v,56
v_accvgpr_write_b32 a108, 0
MV 172,v,36,v,60
TR 36,221,40960
TR 38,221,41984
s_waitcnt lgkmcnt(15)
MV 176,v,40,v,48
v_accvgpr_write_b32 a109, 0
MV 180,v,40,v,52
MV 184,v,40,v,56
v_accvgpr_write_b32 a110, 0
MV 188,v,40,v,60
TR 40,222,40960
TR 42,222,41984
MV 192,v,44,v,48
v_accvgpr_write_b32 a111, 0
MV 196,v,44,v,52
MV 200,v,44,v,56
MV 204,v,44,v,60
TR 44,223,40960
TR 46,223,41984
s_waitcnt lgkmcnt(4)
MV 80,v,16,v,64
v_accvgpr_write_b32 a112, 0
MV 84,v,16,v,68
v_accvgpr_write_b32 a113, 0
MV 88,v,16,v,72
MV 92,v,16,v,76
v_accvgpr_write_b32 a114, 0
MV 96,v,20,v,64
MV 100,v,20,v,68
v_accvgpr_write_b32 a115, 0
MV 104,v,20,v,72
MV 108,v,20,v,76
s_waitcnt vmcnt(1) lgkmcnt(0)
s_barrier
MV 112,v,24,v,64
TR 16,216,0
TR 18,216,1024
MV 116,v,24,v,68
ds_read_b128 v[48:51], v226 offset:0
v_accvgpr_write_b32 a116, 0
MV 120,v,24,v,72
TR 20,217,0
TR 22,217,1024
MV 124,v,24,v,76
v_accvgpr_write_b32 a117, 0
v_accvgpr_write_b32 a118, 0
MV 128,v,28,v,64
TR 24,218,0
TR 26,218,1024
MV 132,v,28,v,68
ds_read_b128 v[52:55], v226 offset:2048
v_accvgpr_write_b32 a119, 0
MV 136,v,28,v,72
MV 140,v,28,v,76
TR 28,219,0
TR 30,219,1024
MV 144,v,32,v,64
ds_read_b128 v[56:59], v226 offset:4096
v_accvgpr_write_b32 a120, 0
MV 148,v,32,v,68
v_accvgpr_write_b32 a121, 0
MV 152,v,32,v,72
v_accvgpr_write_b32 a122, 0
MV 156,v,32,v,76
TR 32,220,0
TR 34,220,1024
MV 160,v,36,v,64
ds_read_b128 v[60:63], v226 offset:6144
v_accvgpr_write_b32 a123, 0
MV 164,v,36,v,68
MV 168,v,36,v,72
v_accvgpr_write_b32 a124, 0
MV 172,v,36,v,76
TR 36,221,0
TR 38,221,1024
MV 176,v,40,v,64
v_accvgpr_write_b32 a125, 0
MV 180,v,40,v,68
MV 184,v,40,v,72
v_accvgpr_write_b32 a126, 0
MV 188,v,40,v,76
TR 40,222,0
TR 42,222,1024
MV 192,v,44,v,64
v_accvgpr_write_b32 a127, 0
MV 196,v,44,v,68
MV 200,v,44,v,72
MV 204,v,44,v,76
TR 44,223,0
TR 46,223,1024
s_waitcnt lgkmcnt(4)
MV 80,v,16,v,48
buffer_load_dword v237, v233, s[8:11], 0 offen offset:0 sc1
MV 84,v,16,v,52
ds_read_b128 v[64:67], v227 offset:0
MV 88,v,16,v,56
MV 92,v,16,v,60
TR 16,216,8192
TR 18,216,9216
MV 96,v,20,v,48
MV 100,v,20,v,52
MV 104,v,20,v,56
ds_read_b128 v[68:71], v227 offset:2048
MV 108,v,20,v,60
TR 20,217,8192
TR 22,217,9216
MV 112,v,24,v,48
MV 116,v,24,v,52
MV 120,v,24,v,56
MV 124,v,24,v,60
TR 24,218,8192
TR 26,218,9216
MV 128,v,28,v,48
ds_read_b128 v[72:75], v227 offset:4096
MV 132,v,28,v,52
MV 136,v,28,v,56
MV 140,v,28,v,60
TR 28,219,8192
TR 30,219,9216
MV 144,v,32,v,48
MV 148,v,32,v,52
MV 152,v,32,v,56
ds_read_b128 v[76:79], v227 offset:6144
MV 156,v,32,v,60
TR 32,220,8192
TR 34,220,9216
MV 160,v,36,v,48
MV 164,v,36,v,52
MV 168,v,36,v,56
MV 172,v,36,v,60
TR 36,221,8192
TR 38,221,9216
s_waitcnt lgkmcnt(15)
MV 176,v,40,v,48
MV 180,v,40,v,52
MV 184,v,40,v,56
MV 188,v,40,v,60
TR 40,222,8192
TR 42,222,9216
MV 192,v,44,v,48
MV 196,v,44,v,52
MV 200,v,44,v,56
MV 204,v,44,v,60
TR 44,223,8192
TR 46,223,9216
s_waitcnt lgkmcnt(4)
MV 80,v,16,v,64
MV 84,v,16,v,68
MV 88,v,16,v,72
MV 92,v,16,v,76
MV 96,v,20,v,64
MV 100,v,20,v,68
MV 104,v,20,v,72
MV 108,v,20,v,76
MV 112,v,24,v,64
MV 116,v,24,v,68
MV 120,v,24,v,72
MV 124,v,24,v,76
MV 128,v,28,v,64
MV 132,v,28,v,68
MV 136,v,28,v,72
MV 140,v,28,v,76
MV 144,v,32,v,64
MV 148,v,32,v,68
MV 152,v,32,v,72
MV 156,v,32,v,76
MV 160,v,36,v,64
MV 164,v,36,v,68
MV 168,v,36,v,72
MV 172,v,36,v,76
s_waitcnt lgkmcnt(2)
MV 176,v,40,v,64
MV 180,v,40,v,68
MV 184,v,40,v,72
MV 188,v,40,v,76
s_waitcnt lgkmcnt(0)
MV 192,v,44,v,64
MV 196,v,44,v,68
MV 200,v,44,v,72
MV 204,v,44,v,76
s_waitcnt vmcnt(0)
v_cmp_ne_u32 vcc, 1, v237
s_nop 4
s_cbranch_vccnz L_spin_f1
L_spin_f1_ret:
s_waitcnt lgkmcnt(0)
s_barrier
s_add_u32 m0, s68, 16384
s_mov_b32 s80, 0
buffer_load_dwordx4 v12, s[52:55], s80 offen offset:0 sc1 lds
buffer_load_dwordx4 v12, s[52:55], s80 offen offset:1024 sc1 lds
buffer_load_dwordx4 v12, s[52:55], s80 offen offset:2048 sc1 lds
buffer_load_dwordx4 v12, s[52:55], s80 offen offset:3072 sc1 lds
s_add_u32 m0, s68, 32768
s_mov_b32 s80, 16384
buffer_load_dwordx4 v12, s[52:55], s80 offen offset:0 sc1 lds
buffer_load_dwordx4 v12, s[52:55], s80 offen offset:1024 sc1 lds
buffer_load_dwordx4 v12, s[52:55], s80 offen offset:2048 sc1 lds
buffer_load_dwordx4 v12, s[52:55], s80 offen offset:3072 sc1 lds
s_add_u32 m0, s68, 81920
s_mov_b32 s80, 16384
buffer_load_dwordx4 v12, s[56:59], s80 offen offset:0 sc1 lds
buffer_load_dwordx4 v12, s[56:59], s80 offen offset:1024 sc1 lds
buffer_load_dwordx4 v12, s[56:59], s80 offen offset:2048 sc1 lds
buffer_load_dwordx4 v12, s[56:59], s80 offen offset:3072 sc1 lds
v_lshlrev_b32 v245, 4, v1
s_mov_b32 m0, s43
s_nop 0
buffer_load_dwordx4 v245, s[20:23], 0 offen offset:0 sc1 lds
buffer_load_dwordx4 v245, s[20:23], 0 offen offset:1024 sc1 lds
buffer_load_dwordx4 v245, s[20:23], 0 offen offset:2048 sc1 lds
buffer_load_dwordx4 v245, s[20:23], 0 offen offset:3072 sc1 lds
s_add_u32 m0, s68, 49152
s_mov_b32 s80, 32768
buffer_load_dwordx4 v12, s[52:55], s80 offen offset:0 sc1 lds
buffer_load_dwordx4 v12, s[52:55], s80 offen offset:1024 sc1 lds
buffer_load_dwordx4 v12, s[52:55], s80 offen offset:2048 sc1 lds
buffer_load_dwordx4 v12, s[52:55], s80 offen offset:3072 sc1 lds
s_add_u32 m0, s68, 98304
s_mov_b32 s80, 32768
buffer_load_dwordx4 v12, s[56:59], s80 offen offset:0 sc1 lds
buffer_load_dwordx4 v12, s[56:59], s80 offen offset:1024 sc1 lds
buffer_load_dwordx4 v12, s[56:59], s80 offen offset:2048 sc1 lds
buffer_load_dwordx4 v12, s[56:59], s80 offen offset:3072 sc1 lds
s_add_u32 m0, s68, 0
s_mov_b32 s80, 49152
buffer_load_dwordx4 v12, s[52:55], s80 offen offset:0 sc1 lds
buffer_load_dwordx4 v12, s[52:55], s80 offen offset:1024 sc1 lds
buffer_load_dwordx4 v12, s[52:55], s80 offen offset:2048 sc1 lds
buffer_load_dwordx4 v12, s[52:55], s80 offen offset:3072 sc1 lds
s_add_u32 m0, s68, 114688
s_mov_b32 s80, 49152
buffer_load_dwordx4 v12, s[56:59], s80 offen offset:0 sc1 lds
buffer_load_dwordx4 v12, s[56:59], s80 offen offset:1024 sc1 lds
buffer_load_dwordx4 v12, s[56:59], s80 offen offset:2048 sc1 lds
buffer_load_dwordx4 v12, s[56:59], s80 offen offset:3072 sc1 lds
s_mov_b32 s82, 0x3e0293ee
s_mov_b32 s83, 0x3e0293ee
v_pk_mul_f32 v[80:81], v[80:81], s[82:83]
v_pk_mul_f32 v[82:83], v[82:83], s[82:83]
v_pk_mul_f32 v[84:85], v[84:85], s[82:83]
v_pk_mul_f32 v[86:87], v[86:87], s[82:83]
v_pk_mul_f32 v[88:89], v[88:89], s[82:83]
v_pk_mul_f32 v[90:91], v[90:91], s[82:83]
v_pk_mul_f32 v[92:93], v[92:93], s[82:83]
v_pk_mul_f32 v[94:95], v[94:95], s[82:83]
v_pk_mul_f32 v[96:97], v[96:97], s[82:83]
v_pk_mul_f32 v[98:99], v[98:99], s[82:83]
v_pk_mul_f32 v[100:101], v[100:101], s[82:83]
v_pk_mul_f32 v[102:103], v[102:103], s[82:83]
v_pk_mul_f32 v[104:105], v[104:105], s[82:83]
v_pk_mul_f32 v[106:107], v[106:107], s[82:83]
v_pk_mul_f32 v[108:109], v[108:109], s[82:83]
v_pk_mul_f32 v[110:111], v[110:111], s[82:83]
v_pk_mul_f32 v[112:113], v[112:113], s[82:83]
v_pk_mul_f32 v[114:115], v[114:115], s[82:83]
v_pk_mul_f32 v[116:117], v[116:117], s[82:83]
v_pk_mul_f32 v[118:119], v[118:119], s[82:83]
v_pk_mul_f32 v[120:121], v[120:121], s[82:83]
v_pk_mul_f32 v[122:123], v[122:123], s[82:83]
v_pk_mul_f32 v[124:125], v[124:125], s[82:83]
v_pk_mul_f32 v[126:127], v[126:127], s[82:83]
v_pk_mul_f32 v[128:129], v[128:129], s[82:83]
v_pk_mul_f32 v[130:131], v[130:131], s[82:83]
v_pk_mul_f32 v[132:133], v[132:133], s[82:83]
v_pk_mul_f32 v[134:135], v[134:135], s[82:83]
v_pk_mul_f32 v[136:137], v[136:137], s[82:83]
v_pk_mul_f32 v[138:139], v[138:139], s[82:83]
v_pk_mul_f32 v[140:141], v[140:141], s[82:83]
v_pk_mul_f32 v[142:143], v[142:143], s[82:83]
v_pk_mul_f32 v[144:145], v[144:145], s[82:83]
v_pk_mul_f32 v[146:147], v[146:147], s[82:83]
v_pk_mul_f32 v[148:149], v[148:149], s[82:83]
v_pk_mul_f32 v[150:151], v[150:151], s[82:83]
v_pk_mul_f32 v[152:153], v[152:153], s[82:83]
v_pk_mul_f32 v[154:155], v[154:155], s[82:83]
v_pk_mul_f32 v[156:157], v[156:157], s[82:83]
v_pk_mul_f32 v[158:159], v[158:159], s[82:83]
v_pk_mul_f32 v[160:161], v[160:161], s[82:83]
v_pk_mul_f32 v[162:163], v[162:163], s[82:83]
v_pk_mul_f32 v[164:165], v[164:165], s[82:83]
v_pk_mul_f32 v[166:167], v[166:167], s[82:83]
v_pk_mul_f32 v[168:169], v[168:169], s[82:83]
v_pk_mul_f32 v[170:171], v[170:171], s[82:83]
v_pk_mul_f32 v[172:173], v[172:173], s[82:83]
v_pk_mul_f32 v[174:175], v[174:175], s[82:83]
v_pk_mul_f32 v[176:177], v[176:177], s[82:83]
v_pk_mul_f32 v[178:179], v[178:179], s[82:83]
v_pk_mul_f32 v[180:181], v[180:181], s[82:83]
v_pk_mul_f32 v[182:183], v[182:183], s[82:83]
v_pk_mul_f32 v[184:185], v[184:185], s[82:83]
v_pk_mul_f32 v[186:187], v[186:187], s[82:83]
v_pk_mul_f32 v[188:189], v[188:189], s[82:83]
v_pk_mul_f32 v[190:191], v[190:191], s[82:83]
v_pk_mul_f32 v[192:193], v[192:193], s[82:83]
v_pk_mul_f32 v[194:195], v[194:195], s[82:83]
v_pk_mul_f32 v[196:197], v[196:197], s[82:83]
v_pk_mul_f32 v[198:199], v[198:199], s[82:83]
v_pk_mul_f32 v[200:201], v[200:201], s[82:83]
v_pk_mul_f32 v[202:203], v[202:203], s[82:83]
v_pk_mul_f32 v[204:205], v[204:205], s[82:83]
v_pk_mul_f32 v[206:207], v[206:207], s[82:83]
v_cvt_pk_bf16_f32 v16, v80, v81
v_cvt_pk_bf16_f32 v17, v82, v83
v_cvt_pk_bf16_f32 v18, v96, v97
v_cvt_pk_bf16_f32 v19, v98, v99
v_cvt_pk_bf16_f32 v20, v84, v85
v_cvt_pk_bf16_f32 v21, v86, v87
v_cvt_pk_bf16_f32 v22, v100, v101
v_cvt_pk_bf16_f32 v23, v102, v103
v_cvt_pk_bf16_f32 v24, v112, v113
v_cvt_pk_bf16_f32 v25, v114, v115
v_cvt_pk_bf16_f32 v26, v128, v129
v_cvt_pk_bf16_f32 v27, v130, v131
v_cvt_pk_bf16_f32 v28, v116, v117
v_cvt_pk_bf16_f32 v29, v118, v119
v_cvt_pk_bf16_f32 v30, v132, v133
v_cvt_pk_bf16_f32 v31, v134, v135
v_cvt_pk_bf16_f32 v32, v144, v145
v_cvt_pk_bf16_f32 v33, v146, v147
v_cvt_pk_bf16_f32 v34, v160, v161
v_cvt_pk_bf16_f32 v35, v162, v163
v_cvt_pk_bf16_f32 v36, v148, v149
v_cvt_pk_bf16_f32 v37, v150, v151
v_cvt_pk_bf16_f32 v38, v164, v165
v_cvt_pk_bf16_f32 v39, v166, v167
v_cvt_pk_bf16_f32 v40, v176, v177
v_cvt_pk_bf16_f32 v41, v178, v179
v_cvt_pk_bf16_f32 v42, v192, v193
v_cvt_pk_bf16_f32 v43, v194, v195
v_cvt_pk_bf16_f32 v44, v180, v181
v_cvt_pk_bf16_f32 v45, v182, v183
v_cvt_pk_bf16_f32 v46, v196, v197
v_cvt_pk_bf16_f32 v47, v198, v199
v_cvt_pk_bf16_f32 v48, v88, v89
v_cvt_pk_bf16_f32 v49, v90, v91
v_cvt_pk_bf16_f32 v50, v104, v105
v_cvt_pk_bf16_f32 v51, v106, v107
v_cvt_pk_bf16_f32 v52, v92, v93
v_cvt_pk_bf16_f32 v53, v94, v95
v_cvt_pk_bf16_f32 v54, v108, v109
v_cvt_pk_bf16_f32 v55, v110, v111
v_cvt_pk_bf16_f32 v56, v120, v121
v_cvt_pk_bf16_f32 v57, v122, v123
v_cvt_pk_bf16_f32 v58, v136, v137
v_cvt_pk_bf16_f32 v59, v138, v139
v_cvt_pk_bf16_f32 v60, v124, v125
v_cvt_pk_bf16_f32 v61, v126, v127
v_cvt_pk_bf16_f32 v62, v140, v141
v_cvt_pk_bf16_f32 v63, v142, v143
v_cvt_pk_bf16_f32 v64, v152, v153
v_cvt_pk_bf16_f32 v65, v154, v155
v_cvt_pk_bf16_f32 v66, v168, v169
v_cvt_pk_bf16_f32 v67, v170, v171
v_cvt_pk_bf16_f32 v68, v156, v157
v_cvt_pk_bf16_f32 v69, v158, v159
v_cvt_pk_bf16_f32 v70, v172, v173
v_cvt_pk_bf16_f32 v71, v174, v175
v_cvt_pk_bf16_f32 v72, v184, v185
v_cvt_pk_bf16_f32 v73, v186, v187
v_cvt_pk_bf16_f32 v74, v200, v201
v_cvt_pk_bf16_f32 v75, v202, v203
v_cvt_pk_bf16_f32 v76, v188, v189
v_cvt_pk_bf16_f32 v77, v190, v191
v_cvt_pk_bf16_f32 v78, v204, v205
v_cvt_pk_bf16_f32 v79, v206, v207
v_permlane16_swap_b32 v16, v20
v_permlane16_swap_b32 v17, v21
v_permlane16_swap_b32 v18, v22
v_permlane16_swap_b32 v19, v23
v_permlane16_swap_b32 v24, v28
v_permlane16_swap_b32 v25, v29
v_permlane16_swap_b32 v26, v30
v_permlane16_swap_b32 v27, v31
v_permlane16_swap_b32 v32, v36
v_permlane16_swap_b32 v33, v37
v_permlane16_swap_b32 v34, v38
v_permlane16_swap_b32 v35, v39
v_permlane16_swap_b32 v40, v44
v_permlane16_swap_b32 v41, v45
v_permlane16_swap_b32 v42, v46
v_permlane16_swap_b32 v43, v47
v_permlane16_swap_b32 v48, v52
v_permlane16_swap_b32 v49, v53
v_permlane16_swap_b32 v50, v54
v_permlane16_swap_b32 v51, v55
v_permlane16_swap_b32 v56, v60
v_permlane16_swap_b32 v57, v61
v_permlane16_swap_b32 v58, v62
v_permlane16_swap_b32 v59, v63
v_permlane16_swap_b32 v64, v68
v_permlane16_swap_b32 v65, v69
v_permlane16_swap_b32 v66, v70
v_permlane16_swap_b32 v67, v71
v_permlane16_swap_b32 v72, v76
v_permlane16_swap_b32 v73, v77
v_permlane16_swap_b32 v74, v78
v_permlane16_swap_b32 v75, v79
v_mov_b32 v2, 0
v_mov_b32 v3, 0
v_mov_b32 v4, 0
v_mov_b32 v5, 0
v_xor_b32 v244, 0x8000, v10
s_waitcnt vmcnt(28)
s_barrier
ds_read_b128 a[128:131], v244 offset:16384
ds_read_b128 a[132:135], v244 offset:17408
ds_read_b128 a[136:139], v244 offset:18432
ds_read_b128 a[140:143], v244 offset:19456
ds_read_b128 a[144:147], v244 offset:20480
ds_read_b128 a[148:151], v244 offset:21504
ds_read_b128 a[152:155], v244 offset:22528
ds_read_b128 a[156:159], v244 offset:23552
ds_read_b128 a[160:163], v244 offset:24576
ds_read_b128 a[164:167], v244 offset:25600
ds_read_b128 a[168:171], v244 offset:26624
ds_read_b128 a[172:175], v244 offset:27648
ds_read_b128 a[176:179], v244 offset:28672
ds_read_b128 a[180:183], v244 offset:29696
ds_read_b128 a[184:187], v244 offset:30720
ds_read_b128 a[188:191], v244 offset:31744
s_waitcnt lgkmcnt(15)
v_mfma_f32_32x32x16_bf16 v[80:95], a[128:131], v[16:19], 0
v_mfma_f32_32x32x16_bf16 v[96:111], a[128:131], v[48:51], 0
s_waitcnt lgkmcnt(14)
v_mfma_f32_32x32x16_bf16 v[80:95], a[132:135], v[20:23], v[80:95]
v_mfma_f32_32x32x16_bf16 v[96:111], a[132:135], v[52:55], v[96:111]
s_waitcnt lgkmcnt(13)
v_mfma_f32_32x32x16_bf16 v[80:95], a[136:139], v[24:27], v[80:95]
v_mfma_f32_32x32x16_bf16 v[96:111], a[136:139], v[56:59], v[96:111]
s_waitcnt lgkmcnt(12)
v_mfma_f32_32x32x16_bf16 v[80:95], a[140:143], v[28:31], v[80:95]
v_mfma_f32_32x32x16_bf16 v[96:111], a[140:143], v[60:63], v[96:111]
s_waitcnt lgkmcnt(11)
v_mfma_f32_32x32x16_bf16 v[80:95], a[144:147], v[32:35], v[80:95]
v_mfma_f32_32x32x16_bf16 v[96:111], a[144:147], v[64:67], v[96:111]
s_waitcnt lgkmcnt(10)
v_mfma_f32_32x32x16_bf16 v[80:95], a[148:151], v[36:39], v[80:95]
v_mfma_f32_32x32x16_bf16 v[96:111], a[148:151], v[68:71], v[96:111]
s_waitcnt lgkmcnt(9)
v_mfma_f32_32x32x16_bf16 v[80:95], a[152:155], v[40:43], v[80:95]
v_mfma_f32_32x32x16_bf16 v[96:111], a[152:155], v[72:75], v[96:111]
s_waitcnt lgkmcnt(8)
v_mfma_f32_32x32x16_bf16 v[80:95], a[156:159], v[44:47], v[80:95]
v_mfma_f32_32x32x16_bf16 v[96:111], a[156:159], v[76:79], v[96:111]
s_waitcnt lgkmcnt(7)
v_mfma_f32_32x32x16_bf16 v[112:127], a[160:163], v[16:19], 0
v_mfma_f32_32x32x16_bf16 v[128:143], a[160:163], v[48:51], 0
s_waitcnt lgkmcnt(6)
v_mfma_f32_32x32x16_bf16 v[112:127], a[164:167], v[20:23], v[112:127]
v_mfma_f32_32x32x16_bf16 v[128:143], a[164:167], v[52:55], v[128:143]
s_waitcnt lgkmcnt(5)
v_mfma_f32_32x32x16_bf16 v[112:127], a[168:171], v[24:27], v[112:127]
v_mfma_f32_32x32x16_bf16 v[128:143], a[168:171], v[56:59], v[128:143]
s_waitcnt lgkmcnt(4)
v_mfma_f32_32x32x16_bf16 v[112:127], a[172:175], v[28:31], v[112:127]
v_mfma_f32_32x32x16_bf16 v[128:143], a[172:175], v[60:63], v[128:143]
s_waitcnt lgkmcnt(3)
v_mfma_f32_32x32x16_bf16 v[112:127], a[176:179], v[32:35], v[112:127]
v_mfma_f32_32x32x16_bf16 v[128:143], a[176:179], v[64:67], v[128:143]
s_waitcnt lgkmcnt(2)
v_mfma_f32_32x32x16_bf16 v[112:127], a[180:183], v[36:39], v[112:127]
v_mfma_f32_32x32x16_bf16 v[128:143], a[180:183], v[68:71], v[128:143]
s_waitcnt lgkmcnt(1)
v_mfma_f32_32x32x16_bf16 v[112:127], a[184:187], v[40:43], v[112:127]
v_mfma_f32_32x32x16_bf16 v[128:143], a[184:187], v[72:75], v[128:143]
s_waitcnt lgkmcnt(0)
v_mfma_f32_32x32x16_bf16 v[112:127], a[188:191], v[44:47], v[112:127]
v_mfma_f32_32x32x16_bf16 v[128:143], a[188:191], v[76:79], v[128:143]
s_waitcnt vmcnt(20)
s_barrier
s_add_u32 m0, s68, 16384
s_mov_b32 s80, 65536
buffer_load_dwordx4 v12, s[52:55], s80 offen offset:0 sc1 lds
buffer_load_dwordx4 v12, s[52:55], s80 offen offset:1024 sc1 lds
buffer_load_dwordx4 v12, s[52:55], s80 offen offset:2048 sc1 lds
buffer_load_dwordx4 v12, s[52:55], s80 offen offset:3072 sc1 lds
s_add_u32 m0, s68, 65536
s_mov_b32 s80, 65536
buffer_load_dwordx4 v12, s[56:59], s80 offen offset:0 sc1 lds
buffer_load_dwordx4 v12, s[56:59], s80 offen offset:1024 sc1 lds
buffer_load_dwordx4 v12, s[56:59], s80 offen offset:2048 sc1 lds
buffer_load_dwordx4 v12, s[56:59], s80 offen offset:3072 sc1 lds
ds_read_b128 a[128:131], v10 offset:0
ds_read_b128 a[132:135], v10 offset:1024
ds_read_b128 a[136:139], v10 offset:2048
ds_read_b128 a[140:143], v10 offset:3072
ds_read_b128 a[144:147], v10 offset:4096
ds_read_b128 a[148:151], v10 offset:5120
ds_read_b128 a[152:155], v10 offset:6144
ds_read_b128 a[156:159], v10 offset:7168
ds_read_b128 a[160:163], v10 offset:8192
ds_read_b128 a[164:167], v10 offset:9216
ds_read_b128 a[168:171], v10 offset:10240
ds_read_b128 a[172:175], v10 offset:11264
ds_read_b128 a[176:179], v10 offset:12288
ds_read_b128 a[180:183], v10 offset:13312
ds_read_b128 a[184:187], v10 offset:14336
ds_read_b128 a[188:191], v10 offset:15360
s_mov_b32 s71, 81920
s_mov_b32 s75, 1
s_mov_b32 s80, 0
s_cmp_eq_u32 s76, 2
s_cbranch_scc1 L_p3_pmask
L_p3_pmask_ret:
v_max3_f32 v6, v80, v81, v82
v_max3_f32 v7, v96, v97, v98
v_max3_f32 v6, v6, v83, v84
v_max3_f32 v7, v7, v99, v100
v_max3_f32 v6, v6, v85, v86
v_max3_f32 v7, v7, v101, v102
v_max3_f32 v6, v6, v87, v88
v_max3_f32 v7, v7, v103, v104
v_max3_f32 v6, v6, v89, v90
v_max3_f32 v7, v7, v105, v106
v_max3_f32 v6, v6, v91, v92
v_max3_f32 v7, v7, v107, v108
v_max3_f32 v6, v6, v93, v94
v_max3_f32 v7, v7, v109, v110
v_max3_f32 v6, v6, v95, v112
v_max3_f32 v7, v7, v111, v128
v_max3_f32 v6, v6, v113, v114
v_max3_f32 v7, v7, v129, v130
v_max3_f32 v6, v6, v115, v116
v_max3_f32 v7, v7, v131, v132
v_max3_f32 v6, v6, v117, v118
v_max3_f32 v7, v7, v133, v134
v_max3_f32 v6, v6, v119, v120
v_max3_f32 v7, v7, v135, v136
v_max3_f32 v6, v6, v121, v122
v_max3_f32 v7, v7, v137, v138
v_max3_f32 v6, v6, v123, v124
v_max3_f32 v7, v7, v139, v140
v_max3_f32 v6, v6, v125, v126
v_max3_f32 v7, v7, v141, v142
v_max_f32 v6, v6, v127
v_max_f32 v7, v7, v143
v_mov_b32 v240, v6
v_mov_b32 v241, v6
s_nop 1
v_permlane32_swap_b32 v240, v241
v_max_f32 v242, v240, v241
v_sub_f32 v208, 0, v242
v_sub_f32 v209, 0, v242
v_sub_f32 v210, 0, v242
v_sub_f32 v211, 0, v242
v_sub_f32 v212, 0, v242
v_sub_f32 v213, 0, v242
v_sub_f32 v214, 0, v242
v_sub_f32 v215, 0, v242
v_sub_f32 v216, 0, v242
v_sub_f32 v217, 0, v242
v_sub_f32 v218, 0, v242
v_sub_f32 v219, 0, v242
v_sub_f32 v220, 0, v242
v_sub_f32 v221, 0, v242
v_sub_f32 v222, 0, v242
v_sub_f32 v223, 0, v242
v_sub_f32 v80, v80, v242
v_sub_f32 v81, v81, v242
v_sub_f32 v82, v82, v242
v_sub_f32 v83, v83, v242
v_sub_f32 v84, v84, v242
v_sub_f32 v85, v85, v242
v_sub_f32 v86, v86, v242
v_sub_f32 v87, v87, v242
v_sub_f32 v88, v88, v242
v_sub_f32 v89, v89, v242
v_sub_f32 v90, v90, v242
v_sub_f32 v91, v91, v242
v_sub_f32 v92, v92, v242
v_sub_f32 v93, v93, v242
v_sub_f32 v94, v94, v242
v_sub_f32 v95, v95, v242
v_sub_f32 v112, v112, v242
v_sub_f32 v113, v113, v242
v_sub_f32 v114, v114, v242
v_sub_f32 v115, v115, v242
v_sub_f32 v116, v116, v242
v_sub_f32 v117, v117, v242
v_sub_f32 v118, v118, v242
v_sub_f32 v119, v119, v242
v_sub_f32 v120, v120, v242
v_sub_f32 v121, v121, v242
v_sub_f32 v122, v122, v242
v_sub_f32 v123, v123, v242
v_sub_f32 v124, v124, v242
v_sub_f32 v125, v125, v242
v_sub_f32 v126, v126, v242
v_sub_f32 v127, v127, v242
v_mov_b32 v240, v7
v_mov_b32 v241, v7
s_nop 1
v_permlane32_swap_b32 v240, v241
v_max_f32 v242, v240, v241
v_sub_f32 v224, 0, v242
v_sub_f32 v225, 0, v242
v_sub_f32 v226, 0, v242
v_sub_f32 v227, 0, v242
v_sub_f32 v228, 0, v242
v_sub_f32 v229, 0, v242
v_sub_f32 v230, 0, v242
v_sub_f32 v231, 0, v242
v_sub_f32 v232, 0, v242
v_sub_f32 v233, 0, v242
v_sub_f32 v234, 0, v242
v_sub_f32 v235, 0, v242
v_sub_f32 v236, 0, v242
v_sub_f32 v237, 0, v242
v_sub_f32 v238, 0, v242
v_sub_f32 v239, 0, v242
v_sub_f32 v96, v96, v242
v_sub_f32 v97, v97, v242
v_sub_f32 v98, v98, v242
v_sub_f32 v99, v99, v242
v_sub_f32 v100, v100, v242
v_sub_f32 v101, v101, v242
v_sub_f32 v102, v102, v242
v_sub_f32 v103, v103, v242
v_sub_f32 v104, v104, v242
v_sub_f32 v105, v105, v242
v_sub_f32 v106, v106, v242
v_sub_f32 v107, v107, v242
v_sub_f32 v108, v108, v242
v_sub_f32 v109, v109, v242
v_sub_f32 v110, v110, v242
v_sub_f32 v111, v111, v242
v_sub_f32 v128, v128, v242
v_sub_f32 v129, v129, v242
v_sub_f32 v130, v130, v242
v_sub_f32 v131, v131, v242
v_sub_f32 v132, v132, v242
v_sub_f32 v133, v133, v242
v_sub_f32 v134, v134, v242
v_sub_f32 v135, v135, v242
v_sub_f32 v136, v136, v242
v_sub_f32 v137, v137, v242
v_sub_f32 v138, v138, v242
v_sub_f32 v139, v139, v242
v_sub_f32 v140, v140, v242
v_sub_f32 v141, v141, v242
v_sub_f32 v142, v142, v242
v_sub_f32 v143, v143, v242
v_exp_f32 v80, v80
v_exp_f32 v81, v81
v_exp_f32 v82, v82
v_add_f32 v2, v2, v80
v_exp_f32 v83, v83
v_add_f32 v3, v3, v81
v_cvt_pk_bf16_f32 v80, v80, v81
v_exp_f32 v84, v84
v_add_f32 v2, v2, v82
v_exp_f32 v85, v85
v_add_f32 v3, v3, v83
v_cvt_pk_bf16_f32 v81, v82, v83
v_exp_f32 v86, v86
v_add_f32 v2, v2, v84
v_exp_f32 v87, v87
v_add_f32 v3, v3, v85
v_cvt_pk_bf16_f32 v82, v84, v85
v_exp_f32 v88, v88
v_add_f32 v2, v2, v86
v_exp_f32 v89, v89
v_add_f32 v3, v3, v87
v_cvt_pk_bf16_f32 v83, v86, v87
v_exp_f32 v90, v90
v_add_f32 v2, v2, v88
v_exp_f32 v91, v91
v_add_f32 v3, v3, v89
v_cvt_pk_bf16_f32 v88, v88, v89
v_exp_f32 v92, v92
v_add_f32 v2, v2, v90
v_exp_f32 v93, v93
v_add_f32 v3, v3, v91
v_cvt_pk_bf16_f32 v89, v90, v91
v_exp_f32 v94, v94
v_add_f32 v2, v2, v92
v_exp_f32 v95, v95
v_add_f32 v3, v3, v93
v_cvt_pk_bf16_f32 v90, v92, v93
v_exp_f32 v96, v96
v_add_f32 v2, v2, v94
v_exp_f32 v97, v97
v_add_f32 v3, v3, v95
v_cvt_pk_bf16_f32 v91, v94, v95
v_exp_f32 v98, v98
v_add_f32 v4, v4, v96
v_exp_f32 v99, v99
v_add_f32 v5, v5, v97
v_cvt_pk_bf16_f32 v96, v96, v97
v_exp_f32 v100, v100
v_add_f32 v4, v4, v98
v_exp_f32 v101, v101
v_add_f32 v5, v5, v99
v_cvt_pk_bf16_f32 v97, v98, v99
v_exp_f32 v102, v102
v_add_f32 v4, v4, v100
v_exp_f32 v103, v103
v_add_f32 v5, v5, v101
v_cvt_pk_bf16_f32 v98, v100, v101
v_add_f32 v4, v4, v102
v_add_f32 v5, v5, v103
v_cvt_pk_bf16_f32 v99, v102, v103
s_sub_u32 s74, s76, 1
.p2align 5
L_p3_dual:
s_waitcnt lgkmcnt(0)
v_mfma_f32_32x32x16_bf16 v[144:159], a[128:131], v[16:19], v[208:223]
ds_read_b128 a[192:195], v11 offset:16384
v_exp_f32 v104, v104
v_exp_f32 v105, v105
v_exp_f32 v106, v106
v_add_f32 v4, v4, v104
v_mfma_f32_32x32x16_bf16 v[160:175], a[128:131], v[48:51], v[224:239]
ds_read_b128 a[196:199], v11 offset:17408
v_exp_f32 v107, v107
v_add_f32 v5, v5, v105
v_cvt_pk_bf16_f32 v104, v104, v105
v_mfma_f32_32x32x16_bf16 v[144:159], a[132:135], v[20:23], v[144:159]
v_exp_f32 v108, v108
v_add_f32 v4, v4, v106
v_exp_f32 v109, v109
v_mfma_f32_32x32x16_bf16 v[160:175], a[132:135], v[52:55], v[160:175]
ds_read_b128 a[200:203], v11 offset:18432
v_add_f32 v5, v5, v107
v_cvt_pk_bf16_f32 v105, v106, v107
v_exp_f32 v110, v110
v_mfma_f32_32x32x16_bf16 v[144:159], a[136:139], v[24:27], v[144:159]
ds_read_b128 a[204:207], v11 offset:19456
v_add_f32 v4, v4, v108
v_exp_f32 v111, v111
v_add_f32 v5, v5, v109
v_mfma_f32_32x32x16_bf16 v[160:175], a[136:139], v[56:59], v[160:175]
v_cvt_pk_bf16_f32 v106, v108, v109
v_exp_f32 v112, v112
v_add_f32 v4, v4, v110
v_mfma_f32_32x32x16_bf16 v[144:159], a[140:143], v[28:31], v[144:159]
ds_read_b128 a[208:211], v11 offset:20480
v_exp_f32 v113, v113
v_add_f32 v5, v5, v111
v_cvt_pk_bf16_f32 v107, v110, v111
v_mfma_f32_32x32x16_bf16 v[160:175], a[140:143], v[60:63], v[160:175]
ds_read_b128 a[212:215], v11 offset:21504
v_exp_f32 v114, v114
v_add_f32 v2, v2, v112
v_exp_f32 v115, v115
v_mfma_f32_32x32x16_bf16 v[144:159], a[144:147], v[32:35], v[144:159]
v_add_f32 v3, v3, v113
v_cvt_pk_bf16_f32 v112, v112, v113
v_exp_f32 v116, v116
v_add_f32 v2, v2, v114
v_mfma_f32_32x32x16_bf16 v[160:175], a[144:147], v[64:67], v[160:175]
ds_read_b128 a[216:219], v11 offset:22528
v_exp_f32 v117, v117
v_add_f32 v3, v3, v115
v_cvt_pk_bf16_f32 v113, v114, v115
v_mfma_f32_32x32x16_bf16 v[144:159], a[148:151], v[36:39], v[144:159]
ds_read_b128 a[220:223], v11 offset:23552
v_exp_f32 v118, v118
v_add_f32 v2, v2, v116
v_exp_f32 v119, v119
v_mfma_f32_32x32x16_bf16 v[160:175], a[148:151], v[68:71], v[160:175]
v_add_f32 v3, v3, v117
v_cvt_pk_bf16_f32 v114, v116, v117
v_exp_f32 v120, v120
v_mfma_f32_32x32x16_bf16 v[144:159], a[152:155], v[40:43], v[144:159]
ds_read_b128 a[224:227], v11 offset:24576
v_add_f32 v2, v2, v118
v_exp_f32 v121, v121
v_add_f32 v3, v3, v119
v_mfma_f32_32x32x16_bf16 v[160:175], a[152:155], v[72:75], v[160:175]
ds_read_b128 a[228:231], v11 offset:25600
v_cvt_pk_bf16_f32 v115, v118, v119
v_exp_f32 v122, v122
v_add_f32 v2, v2, v120
v_mfma_f32_32x32x16_bf16 v[144:159], a[156:159], v[44:47], v[144:159]
v_exp_f32 v123, v123
v_add_f32 v3, v3, v121
v_cvt_pk_bf16_f32 v120, v120, v121
v_mfma_f32_32x32x16_bf16 v[160:175], a[156:159], v[76:79], v[160:175]
ds_read_b128 a[232:235], v11 offset:26624
v_exp_f32 v124, v124
v_add_f32 v2, v2, v122
v_exp_f32 v125, v125
v_mfma_f32_32x32x16_bf16 v[176:191], a[160:163], v[16:19], v[208:223]
ds_read_b128 a[236:239], v11 offset:27648
v_add_f32 v3, v3, v123
v_cvt_pk_bf16_f32 v121, v122, v123
v_exp_f32 v126, v126
v_add_f32 v2, v2, v124
v_mfma_f32_32x32x16_bf16 v[192:207], a[160:163], v[48:51], v[224:239]
v_exp_f32 v127, v127
v_add_f32 v3, v3, v125
v_cvt_pk_bf16_f32 v122, v124, v125
v_mfma_f32_32x32x16_bf16 v[176:191], a[164:167], v[20:23], v[176:191]
ds_read_b128 a[240:243], v11 offset:28672
v_exp_f32 v128, v128
v_add_f32 v2, v2, v126
v_exp_f32 v129, v129
v_mfma_f32_32x32x16_bf16 v[192:207], a[164:167], v[52:55], v[192:207]
ds_read_b128 a[244:247], v11 offset:29696
v_add_f32 v3, v3, v127
v_cvt_pk_bf16_f32 v123, v126, v127
v_exp_f32 v130, v130
v_mfma_f32_32x32x16_bf16 v[176:191], a[168:171], v[24:27], v[176:191]
v_add_f32 v4, v4, v128
v_exp_f32 v131, v131
v_add_f32 v5, v5, v129
v_mfma_f32_32x32x16_bf16 v[192:207], a[168:171], v[56:59], v[192:207]
ds_read_b128 a[248:251], v11 offset:30720
v_cvt_pk_bf16_f32 v128, v128, v129
v_exp_f32 v132, v132
v_add_f32 v4, v4, v130
v_mfma_f32_32x32x16_bf16 v[176:191], a[172:175], v[28:31], v[176:191]
ds_read_b128 a[252:255], v11 offset:31744
v_exp_f32 v133, v133
v_add_f32 v5, v5, v131
v_cvt_pk_bf16_f32 v129, v130, v131
v_mfma_f32_32x32x16_bf16 v[192:207], a[172:175], v[60:63], v[192:207]
v_exp_f32 v134, v134
v_add_f32 v4, v4, v132
v_exp_f32 v135, v135
v_mfma_f32_32x32x16_bf16 v[176:191], a[176:179], v[32:35], v[176:191]
v_add_f32 v5, v5, v133
v_cvt_pk_bf16_f32 v130, v132, v133
v_exp_f32 v136, v136
v_add_f32 v4, v4, v134
v_mfma_f32_32x32x16_bf16 v[192:207], a[176:179], v[64:67], v[192:207]
v_exp_f32 v137, v137
v_add_f32 v5, v5, v135
v_cvt_pk_bf16_f32 v131, v134, v135
v_mfma_f32_32x32x16_bf16 v[176:191], a[180:183], v[36:39], v[176:191]
v_exp_f32 v138, v138
v_add_f32 v4, v4, v136
v_exp_f32 v139, v139
v_mfma_f32_32x32x16_bf16 v[192:207], a[180:183], v[68:71], v[192:207]
v_add_f32 v5, v5, v137
v_cvt_pk_bf16_f32 v136, v136, v137
v_exp_f32 v140, v140
v_mfma_f32_32x32x16_bf16 v[176:191], a[184:187], v[40:43], v[176:191]
v_add_f32 v4, v4, v138
v_exp_f32 v141, v141
v_add_f32 v5, v5, v139
v_mfma_f32_32x32x16_bf16 v[192:207], a[184:187], v[72:75], v[192:207]
v_cvt_pk_bf16_f32 v137, v138, v139
v_exp_f32 v142, v142
v_add_f32 v4, v4, v140
v_mfma_f32_32x32x16_bf16 v[176:191], a[188:191], v[44:47], v[176:191]
v_exp_f32 v143, v143
v_add_f32 v5, v5, v141
v_cvt_pk_bf16_f32 v138, v140, v141
v_mfma_f32_32x32x16_bf16 v[192:207], a[188:191], v[76:79], v[192:207]
v_add_f32 v4, v4, v142
v_add_f32 v5, v5, v143
v_cvt_pk_bf16_f32 v139, v142, v143
s_waitcnt vmcnt(16) lgkmcnt(0)
s_barrier
v_mfma_f32_32x32x16_bf16 a[0:15], a[192:195], v[80:83], a[0:15]
s_sub_u32 s80, s75, s76
s_add_u32 s80, s80, 2
v_mfma_f32_32x32x16_bf16 a[64:79], a[192:195], v[96:99], a[64:79]
s_cmp_lt_u32 s80, 2
s_cbranch_scc1 L_p3_d0_mask
L_p3_d0_mask_ret:
ds_read_b128 a[128:131], v10 offset:16384
v_mfma_f32_32x32x16_bf16 a[16:31], a[196:199], v[80:83], a[16:31]
v_max3_f32 v6, v144, v145, v146
v_max3_f32 v7, v160, v161, v162
v_max3_f32 v6, v6, v147, v148
v_max3_f32 v7, v7, v163, v164
v_max3_f32 v6, v6, v149, v150
v_max3_f32 v7, v7, v165, v166
ds_read_b128 a[132:135], v10 offset:17408
v_mfma_f32_32x32x16_bf16 a[80:95], a[196:199], v[96:99], a[80:95]
v_max3_f32 v6, v6, v151, v152
v_max3_f32 v7, v7, v167, v168
v_max3_f32 v6, v6, v153, v154
v_max3_f32 v7, v7, v169, v170
v_max3_f32 v6, v6, v155, v156
v_mfma_f32_32x32x16_bf16 a[32:47], a[200:203], v[80:83], a[32:47]
v_max3_f32 v7, v7, v171, v172
v_max3_f32 v6, v6, v157, v158
v_max3_f32 v7, v7, v173, v174
v_max3_f32 v6, v6, v159, v176
v_max3_f32 v7, v7, v175, v192
ds_read_b128 a[136:139], v10 offset:18432
v_mfma_f32_32x32x16_bf16 a[96:111], a[200:203], v[96:99], a[96:111]
v_max3_f32 v6, v6, v177, v178
v_max3_f32 v7, v7, v193, v194
v_max3_f32 v6, v6, v179, v180
v_max3_f32 v7, v7, v195, v196
v_max3_f32 v6, v6, v181, v182
v_max3_f32 v7, v7, v197, v198
v_mfma_f32_32x32x16_bf16 a[48:63], a[204:207], v[80:83], a[48:63]
v_max3_f32 v6, v6, v183, v184
v_max3_f32 v7, v7, v199, v200
v_max3_f32 v6, v6, v185, v186
v_max3_f32 v7, v7, v201, v202
v_max3_f32 v6, v6, v187, v188
ds_read_b128 a[140:143], v10 offset:19456
v_mfma_f32_32x32x16_bf16 a[112:127], a[204:207], v[96:99], a[112:127]
v_max3_f32 v7, v7, v203, v204
v_max3_f32 v6, v6, v189, v190
v_max3_f32 v7, v7, v205, v206
v_max_f32 v6, v6, v191
v_max_f32 v7, v7, v207
v_max_f32 v240, v6, v7
v_cmp_lt_f32 vcc, s79, v240
v_mfma_f32_32x32x16_bf16 a[0:15], a[208:211], v[88:91], a[0:15]
s_cbranch_vccnz L_p3_d0_rare
L_p3_d0_rare_ret:
s_add_u32 s75, s75, 1
ds_read_b128 a[144:147], v10 offset:20480
s_add_u32 m0, s72, 0
v_mfma_f32_32x32x16_bf16 a[64:79], a[208:211], v[104:107], a[64:79]
v_exp_f32 v144, v144
v_exp_f32 v145, v145
v_exp_f32 v146, v146
v_mfma_f32_32x32x16_bf16 a[16:31], a[212:215], v[88:91], a[16:31]
ds_read_b128 a[148:151], v10 offset:21504
buffer_load_dwordx4 v12, s[52:55], s71 offen offset:0 sc1 lds
v_add_f32 v2, v2, v144
v_exp_f32 v147, v147
v_add_f32 v3, v3, v145
v_mfma_f32_32x32x16_bf16 a[80:95], a[212:215], v[104:107], a[80:95]
ds_read_b128 a[152:155], v10 offset:22528
v_cvt_pk_bf16_f32 v144, v144, v145
v_exp_f32 v148, v148
v_mfma_f32_32x32x16_bf16 a[32:47], a[216:219], v[88:91], a[32:47]
buffer_load_dwordx4 v12, s[52:55], s71 offen offset:1024 sc1 lds
v_add_f32 v2, v2, v146
v_exp_f32 v149, v149
v_add_f32 v3, v3, v147
v_mfma_f32_32x32x16_bf16 a[96:111], a[216:219], v[104:107], a[96:111]
ds_read_b128 a[156:159], v10 offset:23552
v_cvt_pk_bf16_f32 v145, v146, v147
v_exp_f32 v150, v150
v_add_f32 v2, v2, v148
v_mfma_f32_32x32x16_bf16 a[48:63], a[220:223], v[88:91], a[48:63]
buffer_load_dwordx4 v12, s[52:55], s71 offen offset:2048 sc1 lds
v_exp_f32 v151, v151
v_add_f32 v3, v3, v149
v_mfma_f32_32x32x16_bf16 a[112:127], a[220:223], v[104:107], a[112:127]
ds_read_b128 a[160:163], v10 offset:24576
v_cvt_pk_bf16_f32 v146, v148, v149
v_exp_f32 v152, v152
v_add_f32 v2, v2, v150
v_mfma_f32_32x32x16_bf16 a[0:15], a[224:227], v[112:115], a[0:15]
buffer_load_dwordx4 v12, s[52:55], s71 offen offset:3072 sc1 lds
v_exp_f32 v153, v153
v_add_f32 v3, v3, v151
v_mfma_f32_32x32x16_bf16 a[64:79], a[224:227], v[128:131], a[64:79]
ds_read_b128 a[164:167], v10 offset:25600
v_cvt_pk_bf16_f32 v147, v150, v151
v_exp_f32 v154, v154
v_add_f32 v2, v2, v152
v_mfma_f32_32x32x16_bf16 a[16:31], a[228:231], v[112:115], a[16:31]
s_add_u32 m0, s73, 16384
v_exp_f32 v155, v155
v_add_f32 v3, v3, v153
v_cvt_pk_bf16_f32 v152, v152, v153
v_mfma_f32_32x32x16_bf16 a[80:95], a[228:231], v[128:131], a[80:95]
ds_read_b128 a[168:171], v10 offset:26624
v_exp_f32 v156, v156
v_add_f32 v2, v2, v154
v_mfma_f32_32x32x16_bf16 a[32:47], a[232:235], v[112:115], a[32:47]
ds_read_b128 a[172:175], v10 offset:27648
v_exp_f32 v157, v157
v_add_f32 v3, v3, v155
v_cvt_pk_bf16_f32 v153, v154, v155
v_mfma_f32_32x32x16_bf16 a[96:111], a[232:235], v[128:131], a[96:111]
buffer_load_dwordx4 v12, s[56:59], s71 offen offset:0 sc1 lds
v_exp_f32 v158, v158
v_add_f32 v2, v2, v156
v_mfma_f32_32x32x16_bf16 a[48:63], a[236:239], v[112:115], a[48:63]
ds_read_b128 a[176:179], v10 offset:28672
v_exp_f32 v159, v159
v_add_f32 v3, v3, v157
v_cvt_pk_bf16_f32 v154, v156, v157
v_mfma_f32_32x32x16_bf16 a[112:127], a[236:239], v[128:131], a[112:127]
buffer_load_dwordx4 v12, s[56:59], s71 offen offset:1024 sc1 lds
v_exp_f32 v160, v160
v_add_f32 v2, v2, v158
v_exp_f32 v161, v161
v_mfma_f32_32x32x16_bf16 a[0:15], a[240:243], v[120:123], a[0:15]
ds_read_b128 a[180:183], v10 offset:29696
v_add_f32 v3, v3, v159
v_cvt_pk_bf16_f32 v155, v158, v159
v_mfma_f32_32x32x16_bf16 a[64:79], a[240:243], v[136:139], a[64:79]
buffer_load_dwordx4 v12, s[56:59], s71 offen offset:2048 sc1 lds
v_exp_f32 v162, v162
v_add_f32 v4, v4, v160
v_exp_f32 v163, v163
v_mfma_f32_32x32x16_bf16 a[16:31], a[244:247], v[120:123], a[16:31]
ds_read_b128 a[184:187], v10 offset:30720
v_add_f32 v5, v5, v161
v_cvt_pk_bf16_f32 v160, v160, v161
v_mfma_f32_32x32x16_bf16 a[80:95], a[244:247], v[136:139], a[80:95]
buffer_load_dwordx4 v12, s[56:59], s71 offen offset:3072 sc1 lds
v_exp_f32 v164, v164
v_add_f32 v4, v4, v162
v_exp_f32 v165, v165
v_mfma_f32_32x32x16_bf16 a[32:47], a[248:251], v[120:123], a[32:47]
ds_read_b128 a[188:191], v10 offset:31744
v_add_f32 v5, v5, v163
v_cvt_pk_bf16_f32 v161, v162, v163
v_exp_f32 v166, v166
v_mfma_f32_32x32x16_bf16 a[96:111], a[248:251], v[136:139], a[96:111]
s_add_u32 s71, s71, 16384
v_add_f32 v4, v4, v164
v_exp_f32 v167, v167
v_mfma_f32_32x32x16_bf16 a[48:63], a[252:255], v[120:123], a[48:63]
v_add_f32 v5, v5, v165
v_cvt_pk_bf16_f32 v162, v164, v165
v_add_f32 v4, v4, v166
v_mfma_f32_32x32x16_bf16 a[112:127], a[252:255], v[136:139], a[112:127]
v_add_f32 v5, v5, v167
v_cvt_pk_bf16_f32 v163, v166, v167
s_cmp_lg_u32 s78, 0
s_cbranch_scc1 L_p3_d0_resc
L_p3_d0_resc_ret:
s_sub_u32 s74, s74, 1
s_cmp_eq_u32 s74, 0
s_cbranch_scc1 L_p3_mixed
v_xor_b32 v11, 0x8000, v11
s_waitcnt lgkmcnt(0)
v_mfma_f32_32x32x16_bf16 v[80:95], a[128:131], v[16:19], v[208:223]
ds_read_b128 a[192:195], v11 offset:0
v_exp_f32 v168, v168
v_exp_f32 v169, v169
v_exp_f32 v170, v170
v_add_f32 v4, v4, v168
v_mfma_f32_32x32x16_bf16 v[96:111], a[128:131], v[48:51], v[224:239]
ds_read_b128 a[196:199], v11 offset:1024
v_exp_f32 v171, v171
v_add_f32 v5, v5, v169
v_cvt_pk_bf16_f32 v168, v168, v169
v_mfma_f32_32x32x16_bf16 v[80:95], a[132:135], v[20:23], v[80:95]
v_exp_f32 v172, v172
v_add_f32 v4, v4, v170
v_exp_f32 v173, v173
v_mfma_f32_32x32x16_bf16 v[96:111], a[132:135], v[52:55], v[96:111]
ds_read_b128 a[200:203], v11 offset:2048
v_add_f32 v5, v5, v171
v_cvt_pk_bf16_f32 v169, v170, v171
v_exp_f32 v174, v174
v_mfma_f32_32x32x16_bf16 v[80:95], a[136:139], v[24:27], v[80:95]
ds_read_b128 a[204:207], v11 offset:3072
v_add_f32 v4, v4, v172
v_exp_f32 v175, v175
v_add_f32 v5, v5, v173
v_mfma_f32_32x32x16_bf16 v[96:111], a[136:139], v[56:59], v[96:111]
v_cvt_pk_bf16_f32 v170, v172, v173
v_exp_f32 v176, v176
v_add_f32 v4, v4, v174
v_mfma_f32_32x32x16_bf16 v[80:95], a[140:143], v[28:31], v[80:95]
ds_read_b128 a[208:211], v11 offset:4096
v_exp_f32 v177, v177
v_add_f32 v5, v5, v175
v_cvt_pk_bf16_f32 v171, v174, v175
v_mfma_f32_32x32x16_bf16 v[96:111], a[140:143], v[60:63], v[96:111]
ds_read_b128 a[212:215], v11 offset:5120
v_exp_f32 v178, v178
v_add_f32 v2, v2, v176
v_exp_f32 v179, v179
v_mfma_f32_32x32x16_bf16 v[80:95], a[144:147], v[32:35], v[80:95]
v_add_f32 v3, v3, v177
v_cvt_pk_bf16_f32 v176, v176, v177
v_exp_f32 v180, v180
v_add_f32 v2, v2, v178
v_mfma_f32_32x32x16_bf16 v[96:111], a[144:147], v[64:67], v[96:111]
ds_read_b128 a[216:219], v11 offset:6144
v_exp_f32 v181, v181
v_add_f32 v3, v3, v179
v_cvt_pk_bf16_f32 v177, v178, v179
v_mfma_f32_32x32x16_bf16 v[80:95], a[148:151], v[36:39], v[80:95]
ds_read_b128 a[220:223], v11 offset:7168
v_exp_f32 v182, v182
v_add_f32 v2, v2, v180
v_exp_f32 v183, v183
v_mfma_f32_32x32x16_bf16 v[96:111], a[148:151], v[68:71], v[96:111]
v_add_f32 v3, v3, v181
v_cvt_pk_bf16_f32 v178, v180, v181
v_exp_f32 v184, v184
v_mfma_f32_32x32x16_bf16 v[80:95], a[152:155], v[40:43], v[80:95]
ds_read_b128 a[224:227], v11 offset:8192
v_add_f32 v2, v2, v182
v_exp_f32 v185, v185
v_add_f32 v3, v3, v183
v_mfma_f32_32x32x16_bf16 v[96:111], a[152:155], v[72:75], v[96:111]
ds_read_b128 a[228:231], v11 offset:9216
v_cvt_pk_bf16_f32 v179, v182, v183
v_exp_f32 v186, v186
v_add_f32 v2, v2, v184
v_mfma_f32_32x32x16_bf16 v[80:95], a[156:159], v[44:47], v[80:95]
v_exp_f32 v187, v187
v_add_f32 v3, v3, v185
v_cvt_pk_bf16_f32 v184, v184, v185
v_mfma_f32_32x32x16_bf16 v[96:111], a[156:159], v[76:79], v[96:111]
ds_read_b128 a[232:235], v11 offset:10240
v_exp_f32 v188, v188
v_add_f32 v2, v2, v186
v_exp_f32 v189, v189
v_mfma_f32_32x32x16_bf16 v[112:127], a[160:163], v[16:19], v[208:223]
ds_read_b128 a[236:239], v11 offset:11264
v_add_f32 v3, v3, v187
v_cvt_pk_bf16_f32 v185, v186, v187
v_exp_f32 v190, v190
v_add_f32 v2, v2, v188
v_mfma_f32_32x32x16_bf16 v[128:143], a[160:163], v[48:51], v[224:239]
v_exp_f32 v191, v191
v_add_f32 v3, v3, v189
v_cvt_pk_bf16_f32 v186, v188, v189
v_mfma_f32_32x32x16_bf16 v[112:127], a[164:167], v[20:23], v[112:127]
ds_read_b128 a[240:243], v11 offset:12288
v_exp_f32 v192, v192
v_add_f32 v2, v2, v190
v_exp_f32 v193, v193
v_mfma_f32_32x32x16_bf16 v[128:143], a[164:167], v[52:55], v[128:143]
ds_read_b128 a[244:247], v11 offset:13312
v_add_f32 v3, v3, v191
v_cvt_pk_bf16_f32 v187, v190, v191
v_exp_f32 v194, v194
v_mfma_f32_32x32x16_bf16 v[112:127], a[168:171], v[24:27], v[112:127]
v_add_f32 v4, v4, v192
v_exp_f32 v195, v195
v_add_f32 v5, v5, v193
v_mfma_f32_32x32x16_bf16 v[128:143], a[168:171], v[56:59], v[128:143]
ds_read_b128 a[248:251], v11 offset:14336
v_cvt_pk_bf16_f32 v192, v192, v193
v_exp_f32 v196, v196
v_add_f32 v4, v4, v194
v_mfma_f32_32x32x16_bf16 v[112:127], a[172:175], v[28:31], v[112:127]
ds_read_b128 a[252:255], v11 offset:15360
v_exp_f32 v197, v197
v_add_f32 v5, v5, v195
v_cvt_pk_bf16_f32 v193, v194, v195
v_mfma_f32_32x32x16_bf16 v[128:143], a[172:175], v[60:63], v[128:143]
v_exp_f32 v198, v198
v_add_f32 v4, v4, v196
v_exp_f32 v199, v199
v_mfma_f32_32x32x16_bf16 v[112:127], a[176:179], v[32:35], v[112:127]
v_add_f32 v5, v5, v197
v_cvt_pk_bf16_f32 v194, v196, v197
v_exp_f32 v200, v200
v_add_f32 v4, v4, v198
v_mfma_f32_32x32x16_bf16 v[128:143], a[176:179], v[64:67], v[128:143]
v_exp_f32 v201, v201
v_add_f32 v5, v5, v199
v_cvt_pk_bf16_f32 v195, v198, v199
v_mfma_f32_32x32x16_bf16 v[112:127], a[180:183], v[36:39], v[112:127]
v_exp_f32 v202, v202
v_add_f32 v4, v4, v200
v_exp_f32 v203, v203
v_mfma_f32_32x32x16_bf16 v[128:143], a[180:183], v[68:71], v[128:143]
v_add_f32 v5, v5, v201
v_cvt_pk_bf16_f32 v200, v200, v201
v_exp_f32 v204, v204
v_mfma_f32_32x32x16_bf16 v[112:127], a[184:187], v[40:43], v[112:127]
v_add_f32 v4, v4, v202
v_exp_f32 v205, v205
v_add_f32 v5, v5, v203
v_mfma_f32_32x32x16_bf16 v[128:143], a[184:187], v[72:75], v[128:143]
v_cvt_pk_bf16_f32 v201, v202, v203
v_exp_f32 v206, v206
v_add_f32 v4, v4, v204
v_mfma_f32_32x32x16_bf16 v[112:127], a[188:191], v[44:47], v[112:127]
v_exp_f32 v207, v207
v_add_f32 v5, v5, v205
v_cvt_pk_bf16_f32 v202, v204, v205
v_mfma_f32_32x32x16_bf16 v[128:143], a[188:191], v[76:79], v[128:143]
v_add_f32 v4, v4, v206
v_add_f32 v5, v5, v207
v_cvt_pk_bf16_f32 v203, v206, v207
s_waitcnt vmcnt(16) lgkmcnt(0)
s_barrier
v_mfma_f32_32x32x16_bf16 a[0:15], a[192:195], v[144:147], a[0:15]
v_xor_b32 v10, 0x8000, v10
s_xor_b32 s73, s73, 0x8000
s_sub_u32 s80, s75, s76
s_add_u32 s80, s80, 2
v_mfma_f32_32x32x16_bf16 a[64:79], a[192:195], v[160:163], a[64:79]
s_cmp_lt_u32 s80, 2
s_cbranch_scc1 L_p3_d1_mask
L_p3_d1_mask_ret:
ds_read_b128 a[128:131], v10 offset:0
v_mfma_f32_32x32x16_bf16 a[16:31], a[196:199], v[144:147], a[16:31]
v_max3_f32 v6, v80, v81, v82
v_max3_f32 v7, v96, v97, v98
v_max3_f32 v6, v6, v83, v84
v_max3_f32 v7, v7, v99, v100
v_max3_f32 v6, v6, v85, v86
v_max3_f32 v7, v7, v101, v102
ds_read_b128 a[132:135], v10 offset:1024
v_mfma_f32_32x32x16_bf16 a[80:95], a[196:199], v[160:163], a[80:95]
v_max3_f32 v6, v6, v87, v88
v_max3_f32 v7, v7, v103, v104
v_max3_f32 v6, v6, v89, v90
v_max3_f32 v7, v7, v105, v106
v_max3_f32 v6, v6, v91, v92
v_mfma_f32_32x32x16_bf16 a[32:47], a[200:203], v[144:147], a[32:47]
v_max3_f32 v7, v7, v107, v108
v_max3_f32 v6, v6, v93, v94
v_max3_f32 v7, v7, v109, v110
v_max3_f32 v6, v6, v95, v112
v_max3_f32 v7, v7, v111, v128
ds_read_b128 a[136:139], v10 offset:2048
v_mfma_f32_32x32x16_bf16 a[96:111], a[200:203], v[160:163], a[96:111]
v_max3_f32 v6, v6, v113, v114
v_max3_f32 v7, v7, v129, v130
v_max3_f32 v6, v6, v115, v116
v_max3_f32 v7, v7, v131, v132
v_max3_f32 v6, v6, v117, v118
v_max3_f32 v7, v7, v133, v134
v_mfma_f32_32x32x16_bf16 a[48:63], a[204:207], v[144:147], a[48:63]
v_max3_f32 v6, v6, v119, v120
v_max3_f32 v7, v7, v135, v136
v_max3_f32 v6, v6, v121, v122
v_max3_f32 v7, v7, v137, v138
v_max3_f32 v6, v6, v123, v124
ds_read_b128 a[140:143], v10 offset:3072
v_mfma_f32_32x32x16_bf16 a[112:127], a[204:207], v[160:163], a[112:127]
v_max3_f32 v7, v7, v139, v140
v_max3_f32 v6, v6, v125, v126
v_max3_f32 v7, v7, v141, v142
v_max_f32 v6, v6, v127
v_max_f32 v7, v7, v143
v_max_f32 v240, v6, v7
v_cmp_lt_f32 vcc, s79, v240
v_mfma_f32_32x32x16_bf16 a[0:15], a[208:211], v[152:155], a[0:15]
s_cbranch_vccnz L_p3_d1_rare
L_p3_d1_rare_ret:
s_add_u32 s75, s75, 1
ds_read_b128 a[144:147], v10 offset:4096
s_add_u32 m0, s72, 16384
v_mfma_f32_32x32x16_bf16 a[64:79], a[208:211], v[168:171], a[64:79]
v_exp_f32 v80, v80
v_exp_f32 v81, v81
v_exp_f32 v82, v82
v_mfma_f32_32x32x16_bf16 a[16:31], a[212:215], v[152:155], a[16:31]
ds_read_b128 a[148:151], v10 offset:5120
buffer_load_dwordx4 v12, s[52:55], s71 offen offset:0 sc1 lds
v_add_f32 v2, v2, v80
v_exp_f32 v83, v83
v_add_f32 v3, v3, v81
v_mfma_f32_32x32x16_bf16 a[80:95], a[212:215], v[168:171], a[80:95]
ds_read_b128 a[152:155], v10 offset:6144
v_cvt_pk_bf16_f32 v80, v80, v81
v_exp_f32 v84, v84
v_mfma_f32_32x32x16_bf16 a[32:47], a[216:219], v[152:155], a[32:47]
buffer_load_dwordx4 v12, s[52:55], s71 offen offset:1024 sc1 lds
v_add_f32 v2, v2, v82
v_exp_f32 v85, v85
v_add_f32 v3, v3, v83
v_mfma_f32_32x32x16_bf16 a[96:111], a[216:219], v[168:171], a[96:111]
ds_read_b128 a[156:159], v10 offset:7168
v_cvt_pk_bf16_f32 v81, v82, v83
v_exp_f32 v86, v86
v_add_f32 v2, v2, v84
v_mfma_f32_32x32x16_bf16 a[48:63], a[220:223], v[152:155], a[48:63]
buffer_load_dwordx4 v12, s[52:55], s71 offen offset:2048 sc1 lds
v_exp_f32 v87, v87
v_add_f32 v3, v3, v85
v_mfma_f32_32x32x16_bf16 a[112:127], a[220:223], v[168:171], a[112:127]
ds_read_b128 a[160:163], v10 offset:8192
v_cvt_pk_bf16_f32 v82, v84, v85
v_exp_f32 v88, v88
v_add_f32 v2, v2, v86
v_mfma_f32_32x32x16_bf16 a[0:15], a[224:227], v[176:179], a[0:15]
buffer_load_dwordx4 v12, s[52:55], s71 offen offset:3072 sc1 lds
v_exp_f32 v89, v89
v_add_f32 v3, v3, v87
v_mfma_f32_32x32x16_bf16 a[64:79], a[224:227], v[192:195], a[64:79]
ds_read_b128 a[164:167], v10 offset:9216
v_cvt_pk_bf16_f32 v83, v86, v87
v_exp_f32 v90, v90
v_add_f32 v2, v2, v88
v_mfma_f32_32x32x16_bf16 a[16:31], a[228:231], v[176:179], a[16:31]
s_add_u32 m0, s73, 0
v_exp_f32 v91, v91
v_add_f32 v3, v3, v89
v_cvt_pk_bf16_f32 v88, v88, v89
v_mfma_f32_32x32x16_bf16 a[80:95], a[228:231], v[192:195], a[80:95]
ds_read_b128 a[168:171], v10 offset:10240
v_exp_f32 v92, v92
v_add_f32 v2, v2, v90
v_mfma_f32_32x32x16_bf16 a[32:47], a[232:235], v[176:179], a[32:47]
ds_read_b128 a[172:175], v10 offset:11264
v_exp_f32 v93, v93
v_add_f32 v3, v3, v91
v_cvt_pk_bf16_f32 v89, v90, v91
v_mfma_f32_32x32x16_bf16 a[96:111], a[232:235], v[192:195], a[96:111]
buffer_load_dwordx4 v12, s[56:59], s71 offen offset:0 sc1 lds
v_exp_f32 v94, v94
v_add_f32 v2, v2, v92
v_mfma_f32_32x32x16_bf16 a[48:63], a[236:239], v[176:179], a[48:63]
ds_read_b128 a[176:179], v10 offset:12288
v_exp_f32 v95, v95
v_add_f32 v3, v3, v93
v_cvt_pk_bf16_f32 v90, v92, v93
v_mfma_f32_32x32x16_bf16 a[112:127], a[236:239], v[192:195], a[112:127]
buffer_load_dwordx4 v12, s[56:59], s71 offen offset:1024 sc1 lds
v_exp_f32 v96, v96
v_add_f32 v2, v2, v94
v_exp_f32 v97, v97
v_mfma_f32_32x32x16_bf16 a[0:15], a[240:243], v[184:187], a[0:15]
ds_read_b128 a[180:183], v10 offset:13312
v_add_f32 v3, v3, v95
v_cvt_pk_bf16_f32 v91, v94, v95
v_mfma_f32_32x32x16_bf16 a[64:79], a[240:243], v[200:203], a[64:79]
buffer_load_dwordx4 v12, s[56:59], s71 offen offset:2048 sc1 lds
v_exp_f32 v98, v98
v_add_f32 v4, v4, v96
v_exp_f32 v99, v99
v_mfma_f32_32x32x16_bf16 a[16:31], a[244:247], v[184:187], a[16:31]
ds_read_b128 a[184:187], v10 offset:14336
v_add_f32 v5, v5, v97
v_cvt_pk_bf16_f32 v96, v96, v97
v_mfma_f32_32x32x16_bf16 a[80:95], a[244:247], v[200:203], a[80:95]
buffer_load_dwordx4 v12, s[56:59], s71 offen offset:3072 sc1 lds
v_exp_f32 v100, v100
v_add_f32 v4, v4, v98
v_exp_f32 v101, v101
v_mfma_f32_32x32x16_bf16 a[32:47], a[248:251], v[184:187], a[32:47]
ds_read_b128 a[188:191], v10 offset:15360
v_add_f32 v5, v5, v99
v_cvt_pk_bf16_f32 v97, v98, v99
v_exp_f32 v102, v102
v_mfma_f32_32x32x16_bf16 a[96:111], a[248:251], v[200:203], a[96:111]
s_add_u32 s71, s71, 16384
s_xor_b32 s72, s72, 0x8000
v_add_f32 v4, v4, v100
v_exp_f32 v103, v103
v_mfma_f32_32x32x16_bf16 a[48:63], a[252:255], v[184:187], a[48:63]
v_add_f32 v5, v5, v101
v_cvt_pk_bf16_f32 v98, v100, v101
v_add_f32 v4, v4, v102
v_mfma_f32_32x32x16_bf16 a[112:127], a[252:255], v[200:203], a[112:127]
v_add_f32 v5, v5, v103
v_cvt_pk_bf16_f32 v99, v102, v103
s_cmp_lg_u32 s78, 0
s_cbranch_scc1 L_p3_d1_resc
L_p3_d1_resc_ret:
s_sub_u32 s74, s74, 1
s_branch L_p3_dual
L_p3_mixed:
v_xor_b32 v11, 0x8000, v11
s_waitcnt lgkmcnt(0)
v_mfma_f32_32x32x16_bf16 v[80:95], a[128:131], v[16:19], v[208:223]
ds_read_b128 a[192:195], v11 offset:0
ds_read_b128 a[196:199], v11 offset:1024
v_exp_f32 v168, v168
v_exp_f32 v169, v169
v_exp_f32 v170, v170
v_add_f32 v4, v4, v168
v_exp_f32 v171, v171
v_add_f32 v5, v5, v169
v_cvt_pk_bf16_f32 v168, v168, v169
v_mfma_f32_32x32x16_bf16 v[80:95], a[132:135], v[20:23], v[80:95]
ds_read_b128 a[200:203], v11 offset:2048
v_exp_f32 v172, v172
v_add_f32 v4, v4, v170
v_exp_f32 v173, v173
v_add_f32 v5, v5, v171
v_cvt_pk_bf16_f32 v169, v170, v171
v_exp_f32 v174, v174
v_mfma_f32_32x32x16_bf16 v[80:95], a[136:139], v[24:27], v[80:95]
ds_read_b128 a[204:207], v11 offset:3072
v_add_f32 v4, v4, v172
v_exp_f32 v175, v175
v_add_f32 v5, v5, v173
v_cvt_pk_bf16_f32 v170, v172, v173
v_exp_f32 v176, v176
v_add_f32 v4, v4, v174
v_mfma_f32_32x32x16_bf16 v[80:95], a[140:143], v[28:31], v[80:95]
ds_read_b128 a[208:211], v11 offset:4096
ds_read_b128 a[212:215], v11 offset:5120
v_exp_f32 v177, v177
v_add_f32 v5, v5, v175
v_cvt_pk_bf16_f32 v171, v174, v175
v_exp_f32 v178, v178
v_add_f32 v2, v2, v176
v_exp_f32 v179, v179
v_mfma_f32_32x32x16_bf16 v[80:95], a[144:147], v[32:35], v[80:95]
ds_read_b128 a[216:219], v11 offset:6144
v_add_f32 v3, v3, v177
v_cvt_pk_bf16_f32 v176, v176, v177
v_exp_f32 v180, v180
v_add_f32 v2, v2, v178
v_exp_f32 v181, v181
v_add_f32 v3, v3, v179
v_cvt_pk_bf16_f32 v177, v178, v179
v_mfma_f32_32x32x16_bf16 v[80:95], a[148:151], v[36:39], v[80:95]
ds_read_b128 a[220:223], v11 offset:7168
v_exp_f32 v182, v182
v_add_f32 v2, v2, v180
v_exp_f32 v183, v183
v_add_f32 v3, v3, v181
v_cvt_pk_bf16_f32 v178, v180, v181
v_exp_f32 v184, v184
v_mfma_f32_32x32x16_bf16 v[80:95], a[152:155], v[40:43], v[80:95]
ds_read_b128 a[224:227], v11 offset:8192
ds_read_b128 a[228:231], v11 offset:9216
v_add_f32 v2, v2, v182
v_exp_f32 v185, v185
v_add_f32 v3, v3, v183
v_cvt_pk_bf16_f32 v179, v182, v183
v_exp_f32 v186, v186
v_add_f32 v2, v2, v184
v_mfma_f32_32x32x16_bf16 v[80:95], a[156:159], v[44:47], v[80:95]
ds_read_b128 a[232:235], v11 offset:10240
v_exp_f32 v187, v187
v_add_f32 v3, v3, v185
v_cvt_pk_bf16_f32 v184, v184, v185
v_exp_f32 v188, v188
v_add_f32 v2, v2, v186
v_exp_f32 v189, v189
v_mfma_f32_32x32x16_bf16 v[112:127], a[160:163], v[16:19], v[208:223]
ds_read_b128 a[236:239], v11 offset:11264
v_add_f32 v3, v3, v187
v_cvt_pk_bf16_f32 v185, v186, v187
v_exp_f32 v190, v190
v_add_f32 v2, v2, v188
v_exp_f32 v191, v191
v_add_f32 v3, v3, v189
v_cvt_pk_bf16_f32 v186, v188, v189
v_mfma_f32_32x32x16_bf16 v[112:127], a[164:167], v[20:23], v[112:127]
ds_read_b128 a[240:243], v11 offset:12288
ds_read_b128 a[244:247], v11 offset:13312
v_exp_f32 v192, v192
v_add_f32 v2, v2, v190
v_exp_f32 v193, v193
v_add_f32 v3, v3, v191
v_cvt_pk_bf16_f32 v187, v190, v191
v_exp_f32 v194, v194
v_mfma_f32_32x32x16_bf16 v[112:127], a[168:171], v[24:27], v[112:127]
ds_read_b128 a[248:251], v11 offset:14336
v_add_f32 v4, v4, v192
v_exp_f32 v195, v195
v_add_f32 v5, v5, v193
v_cvt_pk_bf16_f32 v192, v192, v193
v_exp_f32 v196, v196
v_add_f32 v4, v4, v194
v_mfma_f32_32x32x16_bf16 v[112:127], a[172:175], v[28:31], v[112:127]
ds_read_b128 a[252:255], v11 offset:15360
v_exp_f32 v197, v197
v_add_f32 v5, v5, v195
v_cvt_pk_bf16_f32 v193, v194, v195
v_exp_f32 v198, v198
v_add_f32 v4, v4, v196
v_exp_f32 v199, v199
v_mfma_f32_32x32x16_bf16 v[112:127], a[176:179], v[32:35], v[112:127]
v_add_f32 v5, v5, v197
v_cvt_pk_bf16_f32 v194, v196, v197
v_exp_f32 v200, v200
v_add_f32 v4, v4, v198
v_exp_f32 v201, v201
v_add_f32 v5, v5, v199
v_cvt_pk_bf16_f32 v195, v198, v199
v_mfma_f32_32x32x16_bf16 v[112:127], a[180:183], v[36:39], v[112:127]
v_exp_f32 v202, v202
v_add_f32 v4, v4, v200
v_exp_f32 v203, v203
v_add_f32 v5, v5, v201
v_cvt_pk_bf16_f32 v200, v200, v201
v_exp_f32 v204, v204
v_mfma_f32_32x32x16_bf16 v[112:127], a[184:187], v[40:43], v[112:127]
v_add_f32 v4, v4, v202
v_exp_f32 v205, v205
v_add_f32 v5, v5, v203
v_cvt_pk_bf16_f32 v201, v202, v203
v_exp_f32 v206, v206
v_add_f32 v4, v4, v204
v_mfma_f32_32x32x16_bf16 v[112:127], a[188:191], v[44:47], v[112:127]
v_exp_f32 v207, v207
v_add_f32 v5, v5, v205
v_cvt_pk_bf16_f32 v202, v204, v205
v_add_f32 v4, v4, v206
v_add_f32 v5, v5, v207
v_cvt_pk_bf16_f32 v203, v206, v207
s_waitcnt vmcnt(16) lgkmcnt(0)
s_barrier
v_mfma_f32_32x32x16_bf16 a[0:15], a[192:195], v[144:147], a[0:15]
v_xor_b32 v10, 0x8000, v10
s_xor_b32 s73, s73, 0x8000
s_sub_u32 s80, s75, s77
s_add_u32 s80, s80, 2
v_mfma_f32_32x32x16_bf16 a[64:79], a[192:195], v[160:163], a[64:79]
s_cmp_lt_u32 s80, 2
s_cbranch_scc1 L_p3_mx_mask
L_p3_mx_mask_ret:
ds_read_b128 a[128:131], v10 offset:0
v_mfma_f32_32x32x16_bf16 a[16:31], a[196:199], v[144:147], a[16:31]
v_max3_f32 v6, v80, v81, v82
v_max3_f32 v6, v6, v83, v84
v_max3_f32 v6, v6, v85, v86
v_max3_f32 v6, v6, v87, v88
ds_read_b128 a[132:135], v10 offset:1024
v_mfma_f32_32x32x16_bf16 a[80:95], a[196:199], v[160:163], a[80:95]
v_max3_f32 v6, v6, v89, v90
v_max3_f32 v6, v6, v91, v92
v_max3_f32 v6, v6, v93, v94
v_max3_f32 v6, v6, v95, v112
v_mfma_f32_32x32x16_bf16 a[32:47], a[200:203], v[144:147], a[32:47]
v_max3_f32 v6, v6, v113, v114
v_max3_f32 v6, v6, v115, v116
v_max3_f32 v6, v6, v117, v118
v_max3_f32 v6, v6, v119, v120
ds_read_b128 a[136:139], v10 offset:2048
v_mfma_f32_32x32x16_bf16 a[96:111], a[200:203], v[160:163], a[96:111]
v_max3_f32 v6, v6, v121, v122
v_max3_f32 v6, v6, v123, v124
v_max3_f32 v6, v6, v125, v126
v_max_f32 v6, v6, v127
v_cmp_lt_f32 vcc, s79, v6
v_mfma_f32_32x32x16_bf16 a[48:63], a[204:207], v[144:147], a[48:63]
s_cbranch_vccnz L_p3_mx_rare
L_p3_mx_rare_ret:
s_add_u32 s75, s75, 1
ds_read_b128 a[140:143], v10 offset:3072
s_add_u32 m0, s72, 16384
v_mfma_f32_32x32x16_bf16 a[112:127], a[204:207], v[160:163], a[112:127]
v_exp_f32 v80, v80
v_exp_f32 v81, v81
v_mfma_f32_32x32x16_bf16 a[0:15], a[208:211], v[152:155], a[0:15]
ds_read_b128 a[144:147], v10 offset:4096
buffer_load_dwordx4 v12, s[52:55], s71 offen offset:0 sc1 lds
v_exp_f32 v82, v82
v_mfma_f32_32x32x16_bf16 a[64:79], a[208:211], v[168:171], a[64:79]
v_add_f32 v2, v2, v80
v_mfma_f32_32x32x16_bf16 a[16:31], a[212:215], v[152:155], a[16:31]
ds_read_b128 a[148:151], v10 offset:5120
buffer_load_dwordx4 v12, s[52:55], s71 offen offset:1024 sc1 lds
v_exp_f32 v83, v83
v_mfma_f32_32x32x16_bf16 a[80:95], a[212:215], v[168:171], a[80:95]
ds_read_b128 a[152:155], v10 offset:6144
v_add_f32 v3, v3, v81
v_mfma_f32_32x32x16_bf16 a[32:47], a[216:219], v[152:155], a[32:47]
v_cvt_pk_bf16_f32 v80, v80, v81
v_exp_f32 v84, v84
v_mfma_f32_32x32x16_bf16 a[96:111], a[216:219], v[168:171], a[96:111]
ds_read_b128 a[156:159], v10 offset:7168
buffer_load_dwordx4 v12, s[52:55], s71 offen offset:2048 sc1 lds
v_add_f32 v2, v2, v82
v_mfma_f32_32x32x16_bf16 a[48:63], a[220:223], v[152:155], a[48:63]
v_exp_f32 v85, v85
v_mfma_f32_32x32x16_bf16 a[112:127], a[220:223], v[168:171], a[112:127]
ds_read_b128 a[160:163], v10 offset:8192
buffer_load_dwordx4 v12, s[52:55], s71 offen offset:3072 sc1 lds
v_add_f32 v3, v3, v83
v_mfma_f32_32x32x16_bf16 a[0:15], a[224:227], v[176:179], a[0:15]
v_cvt_pk_bf16_f32 v81, v82, v83
v_mfma_f32_32x32x16_bf16 a[64:79], a[224:227], v[192:195], a[64:79]
ds_read_b128 a[164:167], v10 offset:9216
s_add_u32 m0, s73, 0
v_exp_f32 v86, v86
v_add_f32 v2, v2, v84
v_mfma_f32_32x32x16_bf16 a[16:31], a[228:231], v[176:179], a[16:31]
v_exp_f32 v87, v87
v_mfma_f32_32x32x16_bf16 a[80:95], a[228:231], v[192:195], a[80:95]
ds_read_b128 a[168:171], v10 offset:10240
v_add_f32 v3, v3, v85
v_mfma_f32_32x32x16_bf16 a[32:47], a[232:235], v[176:179], a[32:47]
ds_read_b128 a[172:175], v10 offset:11264
buffer_load_dwordx4 v12, s[56:59], s71 offen offset:0 sc1 lds
v_cvt_pk_bf16_f32 v82, v84, v85
v_mfma_f32_32x32x16_bf16 a[96:111], a[232:235], v[192:195], a[96:111]
v_exp_f32 v88, v88
v_mfma_f32_32x32x16_bf16 a[48:63], a[236:239], v[176:179], a[48:63]
ds_read_b128 a[176:179], v10 offset:12288
buffer_load_dwordx4 v12, s[56:59], s71 offen offset:1024 sc1 lds
v_add_f32 v2, v2, v86
v_exp_f32 v89, v89
v_mfma_f32_32x32x16_bf16 a[112:127], a[236:239], v[192:195], a[112:127]
v_add_f32 v3, v3, v87
v_mfma_f32_32x32x16_bf16 a[0:15], a[240:243], v[184:187], a[0:15]
ds_read_b128 a[180:183], v10 offset:13312
buffer_load_dwordx4 v12, s[56:59], s71 offen offset:2048 sc1 lds
v_cvt_pk_bf16_f32 v83, v86, v87
v_mfma_f32_32x32x16_bf16 a[64:79], a[240:243], v[200:203], a[64:79]
v_exp_f32 v90, v90
v_mfma_f32_32x32x16_bf16 a[16:31], a[244:247], v[184:187], a[16:31]
ds_read_b128 a[184:187], v10 offset:14336
v_add_f32 v2, v2, v88
v_mfma_f32_32x32x16_bf16 a[80:95], a[244:247], v[200:203], a[80:95]
buffer_load_dwordx4 v12, s[56:59], s71 offen offset:3072 sc1 lds
v_exp_f32 v91, v91
v_add_f32 v3, v3, v89
v_mfma_f32_32x32x16_bf16 a[32:47], a[248:251], v[184:187], a[32:47]
ds_read_b128 a[188:191], v10 offset:15360
v_cvt_pk_bf16_f32 v88, v88, v89
v_mfma_f32_32x32x16_bf16 a[96:111], a[248:251], v[200:203], a[96:111]
s_add_u32 s71, s71, 16384
s_xor_b32 s72, s72, 0x8000
v_add_f32 v2, v2, v90
v_mfma_f32_32x32x16_bf16 a[48:63], a[252:255], v[184:187], a[48:63]
v_add_f32 v3, v3, v91
v_mfma_f32_32x32x16_bf16 a[112:127], a[252:255], v[200:203], a[112:127]
v_cvt_pk_bf16_f32 v89, v90, v91
s_cmp_lg_u32 s78, 0
s_cbranch_scc1 L_p3_mx_resc
L_p3_mx_resc_ret:
v_add_f32 v4, v4, v5
v_mov_b32 v5, v4
s_nop 1
v_permlane32_swap_b32 v4, v5
v_add_f32 v4, v4, v5
v_rcp_f32 v4, v4
s_nop 7
v_accvgpr_read_b32 v240, a64
v_accvgpr_read_b32 v241, a65
v_accvgpr_read_b32 v242, a66
v_accvgpr_read_b32 v243, a67
v_accvgpr_read_b32 v244, a68
v_accvgpr_read_b32 v245, a69
v_accvgpr_read_b32 v246, a70
v_accvgpr_read_b32 v247, a71
v_mul_f32 v240, v240, v4
v_mul_f32 v241, v241, v4
v_mul_f32 v242, v242, v4
v_mul_f32 v243, v243, v4
v_mul_f32 v244, v244, v4
v_mul_f32 v245, v245, v4
v_mul_f32 v246, v246, v4
v_mul_f32 v247, v247, v4
v_cvt_pk_bf16_f32 v248, v240, v241
v_cvt_pk_bf16_f32 v249, v242, v243
v_cvt_pk_bf16_f32 v250, v244, v245
v_cvt_pk_bf16_f32 v251, v246, v247
buffer_store_dwordx4 v[248:251], v15, s[60:63], s101 offen offset:0 sc1
v_accvgpr_read_b32 v240, a72
v_accvgpr_read_b32 v241, a73
v_accvgpr_read_b32 v242, a74
v_accvgpr_read_b32 v243, a75
v_accvgpr_read_b32 v244, a76
v_accvgpr_read_b32 v245, a77
v_accvgpr_read_b32 v246, a78
v_accvgpr_read_b32 v247, a79
v_mul_f32 v240, v240, v4
v_mul_f32 v241, v241, v4
v_mul_f32 v242, v242, v4
v_mul_f32 v243, v243, v4
v_mul_f32 v244, v244, v4
v_mul_f32 v245, v245, v4
v_mul_f32 v246, v246, v4
v_mul_f32 v247, v247, v4
v_cvt_pk_bf16_f32 v252, v240, v241
v_cvt_pk_bf16_f32 v253, v242, v243
v_cvt_pk_bf16_f32 v254, v244, v245
v_cvt_pk_bf16_f32 v255, v246, v247
buffer_store_dwordx4 v[252:255], v15, s[60:63], s101 offen offset:512 sc1
v_accvgpr_read_b32 v240, a80
v_accvgpr_read_b32 v241, a81
v_accvgpr_read_b32 v242, a82
v_accvgpr_read_b32 v243, a83
v_accvgpr_read_b32 v244, a84
v_accvgpr_read_b32 v245, a85
v_accvgpr_read_b32 v246, a86
v_accvgpr_read_b32 v247, a87
v_mul_f32 v240, v240, v4
v_mul_f32 v241, v241, v4
v_mul_f32 v242, v242, v4
v_mul_f32 v243, v243, v4
v_mul_f32 v244, v244, v4
v_mul_f32 v245, v245, v4
v_mul_f32 v246, v246, v4
v_mul_f32 v247, v247, v4
v_cvt_pk_bf16_f32 v248, v240, v241
v_cvt_pk_bf16_f32 v249, v242, v243
v_cvt_pk_bf16_f32 v250, v244, v245
v_cvt_pk_bf16_f32 v251, v246, v247
buffer_store_dwordx4 v[248:251], v15, s[60:63], s101 offen offset:1024 sc1
v_accvgpr_read_b32 v240, a88
v_accvgpr_read_b32 v241, a89
v_accvgpr_read_b32 v242, a90
v_accvgpr_read_b32 v243, a91
v_accvgpr_read_b32 v244, a92
v_accvgpr_read_b32 v245, a93
v_accvgpr_read_b32 v246, a94
v_accvgpr_read_b32 v247, a95
v_mul_f32 v240, v240, v4
v_mul_f32 v241, v241, v4
v_mul_f32 v242, v242, v4
v_mul_f32 v243, v243, v4
v_mul_f32 v244, v244, v4
v_mul_f32 v245, v245, v4
v_mul_f32 v246, v246, v4
v_mul_f32 v247, v247, v4
v_cvt_pk_bf16_f32 v252, v240, v241
v_cvt_pk_bf16_f32 v253, v242, v243
v_cvt_pk_bf16_f32 v254, v244, v245
v_cvt_pk_bf16_f32 v255, v246, v247
buffer_store_dwordx4 v[252:255], v15, s[60:63], s101 offen offset:1536 sc1
v_accvgpr_read_b32 v240, a96
v_accvgpr_read_b32 v241, a97
v_accvgpr_read_b32 v242, a98
v_accvgpr_read_b32 v243, a99
v_accvgpr_read_b32 v244, a100
v_accvgpr_read_b32 v245, a101
v_accvgpr_read_b32 v246, a102
v_accvgpr_read_b32 v247, a103
v_mul_f32 v240, v240, v4
v_mul_f32 v241, v241, v4
v_mul_f32 v242, v242, v4
v_mul_f32 v243, v243, v4
v_mul_f32 v244, v244, v4
v_mul_f32 v245, v245, v4
v_mul_f32 v246, v246, v4
v_mul_f32 v247, v247, v4
v_cvt_pk_bf16_f32 v248, v240, v241
v_cvt_pk_bf16_f32 v249, v242, v243
v_cvt_pk_bf16_f32 v250, v244, v245
v_cvt_pk_bf16_f32 v251, v246, v247
buffer_store_dwordx4 v[248:251], v15, s[60:63], s101 offen offset:2048 sc1
v_accvgpr_read_b32 v240, a104
v_accvgpr_read_b32 v241, a105
v_accvgpr_read_b32 v242, a106
v_accvgpr_read_b32 v243, a107
v_accvgpr_read_b32 v244, a108
v_accvgpr_read_b32 v245, a109
v_accvgpr_read_b32 v246, a110
v_accvgpr_read_b32 v247, a111
v_mul_f32 v240, v240, v4
v_mul_f32 v241, v241, v4
v_mul_f32 v242, v242, v4
v_mul_f32 v243, v243, v4
v_mul_f32 v244, v244, v4
v_mul_f32 v245, v245, v4
v_mul_f32 v246, v246, v4
v_mul_f32 v247, v247, v4
v_cvt_pk_bf16_f32 v252, v240, v241
v_cvt_pk_bf16_f32 v253, v242, v243
v_cvt_pk_bf16_f32 v254, v244, v245
v_cvt_pk_bf16_f32 v255, v246, v247
buffer_store_dwordx4 v[252:255], v15, s[60:63], s101 offen offset:2560 sc1
v_accvgpr_read_b32 v240, a112
v_accvgpr_read_b32 v241, a113
v_accvgpr_read_b32 v242, a114
v_accvgpr_read_b32 v243, a115
v_accvgpr_read_b32 v244, a116
v_accvgpr_read_b32 v245, a117
v_accvgpr_read_b32 v246, a118
v_accvgpr_read_b32 v247, a119
v_mul_f32 v240, v240, v4
v_mul_f32 v241, v241, v4
v_mul_f32 v242, v242, v4
v_mul_f32 v243, v243, v4
v_mul_f32 v244, v244, v4
v_mul_f32 v245, v245, v4
v_mul_f32 v246, v246, v4
v_mul_f32 v247, v247, v4
v_cvt_pk_bf16_f32 v248, v240, v241
v_cvt_pk_bf16_f32 v249, v242, v243
v_cvt_pk_bf16_f32 v250, v244, v245
v_cvt_pk_bf16_f32 v251, v246, v247
buffer_store_dwordx4 v[248:251], v15, s[60:63], s101 offen offset:3072 sc1
v_accvgpr_read_b32 v240, a120
v_accvgpr_read_b32 v241, a121
v_accvgpr_read_b32 v242, a122
v_accvgpr_read_b32 v243, a123
v_accvgpr_read_b32 v244, a124
v_accvgpr_read_b32 v245, a125
v_accvgpr_read_b32 v246, a126
v_accvgpr_read_b32 v247, a127
v_mul_f32 v240, v240, v4
v_mul_f32 v241, v241, v4
v_mul_f32 v242, v242, v4
v_mul_f32 v243, v243, v4
v_mul_f32 v244, v244, v4
v_mul_f32 v245, v245, v4
v_mul_f32 v246, v246, v4
v_mul_f32 v247, v247, v4
v_cvt_pk_bf16_f32 v252, v240, v241
v_cvt_pk_bf16_f32 v253, v242, v243
v_cvt_pk_bf16_f32 v254, v244, v245
v_cvt_pk_bf16_f32 v255, v246, v247
buffer_store_dwordx4 v[252:255], v15, s[60:63], s101 offen offset:3584 sc1
v_lshlrev_b32 v72, 4, v1
v_add_u32 v73, -8, v72
v_mov_b32 v75, 0
buffer_load_ushort v74, v75, s[28:31], s42 offen
buffer_load_dwordx2 v[48:49], v73, s[16:19], 0 offen
buffer_load_dwordx4 v[50:53], v72, s[16:19], 0 offen offset:0
buffer_load_dwordx2 v[54:55], v72, s[16:19], 0 offen offset:1016
buffer_load_dwordx4 v[56:59], v72, s[16:19], 0 offen offset:1024
buffer_load_dwordx2 v[60:61], v72, s[16:19], 0 offen offset:2040
buffer_load_dwordx4 v[62:65], v72, s[16:19], 0 offen offset:2048
buffer_load_dwordx2 v[66:67], v72, s[16:19], 0 offen offset:3064
buffer_load_dwordx4 v[68:71], v72, s[16:19], 0 offen offset:3072
s_sub_u32 s74, s77, s76
s_sub_u32 s74, s74, 1
.p2align 5
L_p3_single:
s_waitcnt lgkmcnt(0)
v_mfma_f32_32x32x16_bf16 v[144:159], a[128:131], v[16:19], v[208:223]
ds_read_b128 a[192:195], v11 offset:16384
ds_read_b128 a[196:199], v11 offset:17408
v_exp_f32 v92, v92
v_exp_f32 v93, v93
v_exp_f32 v94, v94
v_add_f32 v2, v2, v92
v_mfma_f32_32x32x16_bf16 v[144:159], a[132:135], v[20:23], v[144:159]
ds_read_b128 a[200:203], v11 offset:18432
v_exp_f32 v95, v95
v_add_f32 v3, v3, v93
v_cvt_pk_bf16_f32 v90, v92, v93
v_mfma_f32_32x32x16_bf16 v[144:159], a[136:139], v[24:27], v[144:159]
ds_read_b128 a[204:207], v11 offset:19456
v_exp_f32 v112, v112
v_add_f32 v2, v2, v94
v_exp_f32 v113, v113
v_mfma_f32_32x32x16_bf16 v[144:159], a[140:143], v[28:31], v[144:159]
ds_read_b128 a[208:211], v11 offset:20480
ds_read_b128 a[212:215], v11 offset:21504
v_add_f32 v3, v3, v95
v_cvt_pk_bf16_f32 v91, v94, v95
v_exp_f32 v114, v114
v_mfma_f32_32x32x16_bf16 v[144:159], a[144:147], v[32:35], v[144:159]
ds_read_b128 a[216:219], v11 offset:22528
v_add_f32 v2, v2, v112
v_exp_f32 v115, v115
v_add_f32 v3, v3, v113
v_mfma_f32_32x32x16_bf16 v[144:159], a[148:151], v[36:39], v[144:159]
ds_read_b128 a[220:223], v11 offset:23552
v_cvt_pk_bf16_f32 v112, v112, v113
v_exp_f32 v116, v116
v_add_f32 v2, v2, v114
v_mfma_f32_32x32x16_bf16 v[144:159], a[152:155], v[40:43], v[144:159]
ds_read_b128 a[224:227], v11 offset:24576
ds_read_b128 a[228:231], v11 offset:25600
v_exp_f32 v117, v117
v_add_f32 v3, v3, v115
v_cvt_pk_bf16_f32 v113, v114, v115
v_mfma_f32_32x32x16_bf16 v[144:159], a[156:159], v[44:47], v[144:159]
ds_read_b128 a[232:235], v11 offset:26624
v_exp_f32 v118, v118
v_add_f32 v2, v2, v116
v_exp_f32 v119, v119
v_mfma_f32_32x32x16_bf16 v[176:191], a[160:163], v[16:19], v[208:223]
ds_read_b128 a[236:239], v11 offset:27648
v_add_f32 v3, v3, v117
v_cvt_pk_bf16_f32 v114, v116, v117
v_exp_f32 v120, v120
v_add_f32 v2, v2, v118
v_mfma_f32_32x32x16_bf16 v[176:191], a[164:167], v[20:23], v[176:191]
ds_read_b128 a[240:243], v11 offset:28672
ds_read_b128 a[244:247], v11 offset:29696
v_exp_f32 v121, v121
v_add_f32 v3, v3, v119
v_cvt_pk_bf16_f32 v115, v118, v119
v_mfma_f32_32x32x16_bf16 v[176:191], a[168:171], v[24:27], v[176:191]
ds_read_b128 a[248:251], v11 offset:30720
v_exp_f32 v122, v122
v_add_f32 v2, v2, v120
v_exp_f32 v123, v123
v_mfma_f32_32x32x16_bf16 v[176:191], a[172:175], v[28:31], v[176:191]
ds_read_b128 a[252:255], v11 offset:31744
v_add_f32 v3, v3, v121
v_cvt_pk_bf16_f32 v120, v120, v121
v_exp_f32 v124, v124
v_mfma_f32_32x32x16_bf16 v[176:191], a[176:179], v[32:35], v[176:191]
v_add_f32 v2, v2, v122
v_exp_f32 v125, v125
v_add_f32 v3, v3, v123
v_mfma_f32_32x32x16_bf16 v[176:191], a[180:183], v[36:39], v[176:191]
v_cvt_pk_bf16_f32 v121, v122, v123
v_exp_f32 v126, v126
v_add_f32 v2, v2, v124
v_mfma_f32_32x32x16_bf16 v[176:191], a[184:187], v[40:43], v[176:191]
v_exp_f32 v127, v127
v_add_f32 v3, v3, v125
v_cvt_pk_bf16_f32 v122, v124, v125
v_mfma_f32_32x32x16_bf16 v[176:191], a[188:191], v[44:47], v[176:191]
v_add_f32 v2, v2, v126
v_add_f32 v3, v3, v127
v_cvt_pk_bf16_f32 v123, v126, v127
s_waitcnt vmcnt(16) lgkmcnt(0)
s_barrier
v_mfma_f32_32x32x16_bf16 a[0:15], a[192:195], v[80:83], a[0:15]
s_sub_u32 s80, s75, s77
s_add_u32 s80, s80, 2
v_mfma_f32_32x32x16_bf16 a[16:31], a[196:199], v[80:83], a[16:31]
s_cmp_lt_u32 s80, 2
s_cbranch_scc1 L_p3_s0_mask
L_p3_s0_mask_ret:
ds_read_b128 a[128:131], v10 offset:16384
ds_read_b128 a[132:135], v10 offset:17408
v_mfma_f32_32x32x16_bf16 a[32:47], a[200:203], v[80:83], a[32:47]
v_max3_f32 v6, v144, v145, v146
v_max3_f32 v6, v6, v147, v148
v_max3_f32 v6, v6, v149, v150
v_max3_f32 v6, v6, v151, v152
v_max3_f32 v6, v6, v153, v154
v_max3_f32 v6, v6, v155, v156
ds_read_b128 a[136:139], v10 offset:18432
v_mfma_f32_32x32x16_bf16 a[48:63], a[204:207], v[80:83], a[48:63]
v_max3_f32 v6, v6, v157, v158
v_max3_f32 v6, v6, v159, v176
v_max3_f32 v6, v6, v177, v178
v_max3_f32 v6, v6, v179, v180
v_max3_f32 v6, v6, v181, v182
ds_read_b128 a[140:143], v10 offset:19456
v_mfma_f32_32x32x16_bf16 a[0:15], a[208:211], v[88:91], a[0:15]
v_max3_f32 v6, v6, v183, v184
v_max3_f32 v6, v6, v185, v186
v_max3_f32 v6, v6, v187, v188
v_max3_f32 v6, v6, v189, v190
v_max_f32 v6, v6, v191
v_cmp_lt_f32 vcc, s79, v6
ds_read_b128 a[144:147], v10 offset:20480
v_mfma_f32_32x32x16_bf16 a[16:31], a[212:215], v[88:91], a[16:31]
s_cbranch_vccnz L_p3_s0_rare
L_p3_s0_rare_ret:
s_add_u32 s75, s75, 1
ds_read_b128 a[148:151], v10 offset:21504
ds_read_b128 a[152:155], v10 offset:22528
s_add_u32 m0, s72, 0
v_exp_f32 v144, v144
v_exp_f32 v145, v145
v_exp_f32 v146, v146
v_mfma_f32_32x32x16_bf16 a[32:47], a[216:219], v[88:91], a[32:47]
ds_read_b128 a[156:159], v10 offset:23552
buffer_load_dwordx4 v12, s[52:55], s71 offen offset:0 sc1 lds
v_add_f32 v2, v2, v144
v_exp_f32 v147, v147
v_add_f32 v3, v3, v145
v_mfma_f32_32x32x16_bf16 a[48:63], a[220:223], v[88:91], a[48:63]
ds_read_b128 a[160:163], v10 offset:24576
buffer_load_dwordx4 v12, s[52:55], s71 offen offset:1024 sc1 lds
v_cvt_pk_bf16_f32 v144, v144, v145
v_exp_f32 v148, v148
v_add_f32 v2, v2, v146
v_mfma_f32_32x32x16_bf16 a[0:15], a[224:227], v[112:115], a[0:15]
ds_read_b128 a[164:167], v10 offset:25600
buffer_load_dwordx4 v12, s[52:55], s71 offen offset:2048 sc1 lds
v_exp_f32 v149, v149
v_add_f32 v3, v3, v147
v_mfma_f32_32x32x16_bf16 a[16:31], a[228:231], v[112:115], a[16:31]
ds_read_b128 a[168:171], v10 offset:26624
ds_read_b128 a[172:175], v10 offset:27648
buffer_load_dwordx4 v12, s[52:55], s71 offen offset:3072 sc1 lds
v_cvt_pk_bf16_f32 v145, v146, v147
v_exp_f32 v150, v150
v_add_f32 v2, v2, v148
v_mfma_f32_32x32x16_bf16 a[32:47], a[232:235], v[112:115], a[32:47]
ds_read_b128 a[176:179], v10 offset:28672
s_add_u32 m0, s73, 16384
v_exp_f32 v151, v151
v_add_f32 v3, v3, v149
v_cvt_pk_bf16_f32 v146, v148, v149
v_mfma_f32_32x32x16_bf16 a[48:63], a[236:239], v[112:115], a[48:63]
ds_read_b128 a[180:183], v10 offset:29696
buffer_load_dwordx4 v12, s[56:59], s71 offen offset:0 sc1 lds
v_exp_f32 v152, v152
v_add_f32 v2, v2, v150
v_exp_f32 v153, v153
v_mfma_f32_32x32x16_bf16 a[0:15], a[240:243], v[120:123], a[0:15]
ds_read_b128 a[184:187], v10 offset:30720
buffer_load_dwordx4 v12, s[56:59], s71 offen offset:1024 sc1 lds
v_add_f32 v3, v3, v151
v_cvt_pk_bf16_f32 v147, v150, v151
v_mfma_f32_32x32x16_bf16 a[16:31], a[244:247], v[120:123], a[16:31]
ds_read_b128 a[188:191], v10 offset:31744
buffer_load_dwordx4 v12, s[56:59], s71 offen offset:2048 sc1 lds
v_exp_f32 v154, v154
v_add_f32 v2, v2, v152
v_exp_f32 v155, v155
v_mfma_f32_32x32x16_bf16 a[32:47], a[248:251], v[120:123], a[32:47]
buffer_load_dwordx4 v12, s[56:59], s71 offen offset:3072 sc1 lds
v_add_f32 v3, v3, v153
v_cvt_pk_bf16_f32 v152, v152, v153
v_add_f32 v2, v2, v154
v_mfma_f32_32x32x16_bf16 a[48:63], a[252:255], v[120:123], a[48:63]
s_add_u32 s71, s71, 16384
v_add_f32 v3, v3, v155
v_cvt_pk_bf16_f32 v153, v154, v155
s_cmp_lg_u32 s78, 0
s_cbranch_scc1 L_p3_s0_resc
L_p3_s0_resc_ret:
s_sub_u32 s74, s74, 1
s_cmp_eq_u32 s74, 0
s_cbranch_scc1 L_p3_last
v_xor_b32 v11, 0x8000, v11
s_waitcnt lgkmcnt(0)
v_mfma_f32_32x32x16_bf16 v[80:95], a[128:131], v[16:19], v[208:223]
ds_read_b128 a[192:195], v11 offset:0
ds_read_b128 a[196:199], v11 offset:1024
v_exp_f32 v156, v156
v_exp_f32 v157, v157
v_exp_f32 v158, v158
v_add_f32 v2, v2, v156
v_mfma_f32_32x32x16_bf16 v[80:95], a[132:135], v[20:23], v[80:95]
ds_read_b128 a[200:203], v11 offset:2048
v_exp_f32 v159, v159
v_add_f32 v3, v3, v157
v_cvt_pk_bf16_f32 v154, v156, v157
v_mfma_f32_32x32x16_bf16 v[80:95], a[136:139], v[24:27], v[80:95]
ds_read_b128 a[204:207], v11 offset:3072
v_exp_f32 v176, v176
v_add_f32 v2, v2, v158
v_exp_f32 v177, v177
v_mfma_f32_32x32x16_bf16 v[80:95], a[140:143], v[28:31], v[80:95]
ds_read_b128 a[208:211], v11 offset:4096
ds_read_b128 a[212:215], v11 offset:5120
v_add_f32 v3, v3, v159
v_cvt_pk_bf16_f32 v155, v158, v159
v_exp_f32 v178, v178
v_mfma_f32_32x32x16_bf16 v[80:95], a[144:147], v[32:35], v[80:95]
ds_read_b128 a[216:219], v11 offset:6144
v_add_f32 v2, v2, v176
v_exp_f32 v179, v179
v_add_f32 v3, v3, v177
v_mfma_f32_32x32x16_bf16 v[80:95], a[148:151], v[36:39], v[80:95]
ds_read_b128 a[220:223], v11 offset:7168
v_cvt_pk_bf16_f32 v176, v176, v177
v_exp_f32 v180, v180
v_add_f32 v2, v2, v178
v_mfma_f32_32x32x16_bf16 v[80:95], a[152:155], v[40:43], v[80:95]
ds_read_b128 a[224:227], v11 offset:8192
ds_read_b128 a[228:231], v11 offset:9216
v_exp_f32 v181, v181
v_add_f32 v3, v3, v179
v_cvt_pk_bf16_f32 v177, v178, v179
v_mfma_f32_32x32x16_bf16 v[80:95], a[156:159], v[44:47], v[80:95]
ds_read_b128 a[232:235], v11 offset:10240
v_exp_f32 v182, v182
v_add_f32 v2, v2, v180
v_exp_f32 v183, v183
v_mfma_f32_32x32x16_bf16 v[112:127], a[160:163], v[16:19], v[208:223]
ds_read_b128 a[236:239], v11 offset:11264
v_add_f32 v3, v3, v181
v_cvt_pk_bf16_f32 v178, v180, v181
v_exp_f32 v184, v184
v_add_f32 v2, v2, v182
v_mfma_f32_32x32x16_bf16 v[112:127], a[164:167], v[20:23], v[112:127]
ds_read_b128 a[240:243], v11 offset:12288
ds_read_b128 a[244:247], v11 offset:13312
v_exp_f32 v185, v185
v_add_f32 v3, v3, v183
v_cvt_pk_bf16_f32 v179, v182, v183
v_mfma_f32_32x32x16_bf16 v[112:127], a[168:171], v[24:27], v[112:127]
ds_read_b128 a[248:251], v11 offset:14336
v_exp_f32 v186, v186
v_add_f32 v2, v2, v184
v_exp_f32 v187, v187
v_mfma_f32_32x32x16_bf16 v[112:127], a[172:175], v[28:31], v[112:127]
ds_read_b128 a[252:255], v11 offset:15360
v_add_f32 v3, v3, v185
v_cvt_pk_bf16_f32 v184, v184, v185
v_exp_f32 v188, v188
v_mfma_f32_32x32x16_bf16 v[112:127], a[176:179], v[32:35], v[112:127]
v_add_f32 v2, v2, v186
v_exp_f32 v189, v189
v_add_f32 v3, v3, v187
v_mfma_f32_32x32x16_bf16 v[112:127], a[180:183], v[36:39], v[112:127]
v_cvt_pk_bf16_f32 v185, v186, v187
v_exp_f32 v190, v190
v_add_f32 v2, v2, v188
v_mfma_f32_32x32x16_bf16 v[112:127], a[184:187], v[40:43], v[112:127]
v_exp_f32 v191, v191
v_add_f32 v3, v3, v189
v_cvt_pk_bf16_f32 v186, v188, v189
v_mfma_f32_32x32x16_bf16 v[112:127], a[188:191], v[44:47], v[112:127]
v_add_f32 v2, v2, v190
v_add_f32 v3, v3, v191
v_cvt_pk_bf16_f32 v187, v190, v191
s_waitcnt vmcnt(16) lgkmcnt(0)
s_barrier
v_mfma_f32_32x32x16_bf16 a[0:15], a[192:195], v[144:147], a[0:15]
v_xor_b32 v10, 0x8000, v10
s_xor_b32 s73, s73, 0x8000
s_sub_u32 s80, s75, s77
s_add_u32 s80, s80, 2
v_mfma_f32_32x32x16_bf16 a[16:31], a[196:199], v[144:147], a[16:31]
s_cmp_lt_u32 s80, 2
s_cbranch_scc1 L_p3_s1_mask
L_p3_s1_mask_ret:
ds_read_b128 a[128:131], v10 offset:0
ds_read_b128 a[132:135], v10 offset:1024
v_mfma_f32_32x32x16_bf16 a[32:47], a[200:203], v[144:147], a[32:47]
v_max3_f32 v6, v80, v81, v82
v_max3_f32 v6, v6, v83, v84
v_max3_f32 v6, v6, v85, v86
v_max3_f32 v6, v6, v87, v88
v_max3_f32 v6, v6, v89, v90
v_max3_f32 v6, v6, v91, v92
ds_read_b128 a[136:139], v10 offset:2048
v_mfma_f32_32x32x16_bf16 a[48:63], a[204:207], v[144:147], a[48:63]
v_max3_f32 v6, v6, v93, v94
v_max3_f32 v6, v6, v95, v112
v_max3_f32 v6, v6, v113, v114
v_max3_f32 v6, v6, v115, v116
v_max3_f32 v6, v6, v117, v118
ds_read_b128 a[140:143], v10 offset:3072
v_mfma_f32_32x32x16_bf16 a[0:15], a[208:211], v[152:155], a[0:15]
v_max3_f32 v6, v6, v119, v120
v_max3_f32 v6, v6, v121, v122
v_max3_f32 v6, v6, v123, v124
v_max3_f32 v6, v6, v125, v126
v_max_f32 v6, v6, v127
v_cmp_lt_f32 vcc, s79, v6
ds_read_b128 a[144:147], v10 offset:4096
v_mfma_f32_32x32x16_bf16 a[16:31], a[212:215], v[152:155], a[16:31]
s_cbranch_vccnz L_p3_s1_rare
L_p3_s1_rare_ret:
s_add_u32 s75, s75, 1
ds_read_b128 a[148:151], v10 offset:5120
ds_read_b128 a[152:155], v10 offset:6144
s_add_u32 m0, s72, 16384
v_exp_f32 v80, v80
v_exp_f32 v81, v81
v_exp_f32 v82, v82
v_mfma_f32_32x32x16_bf16 a[32:47], a[216:219], v[152:155], a[32:47]
ds_read_b128 a[156:159], v10 offset:7168
buffer_load_dwordx4 v12, s[52:55], s71 offen offset:0 sc1 lds
v_add_f32 v2, v2, v80
v_exp_f32 v83, v83
v_add_f32 v3, v3, v81
v_mfma_f32_32x32x16_bf16 a[48:63], a[220:223], v[152:155], a[48:63]
ds_read_b128 a[160:163], v10 offset:8192
buffer_load_dwordx4 v12, s[52:55], s71 offen offset:1024 sc1 lds
v_cvt_pk_bf16_f32 v80, v80, v81
v_exp_f32 v84, v84
v_add_f32 v2, v2, v82
v_mfma_f32_32x32x16_bf16 a[0:15], a[224:227], v[176:179], a[0:15]
ds_read_b128 a[164:167], v10 offset:9216
buffer_load_dwordx4 v12, s[52:55], s71 offen offset:2048 sc1 lds
v_exp_f32 v85, v85
v_add_f32 v3, v3, v83
v_mfma_f32_32x32x16_bf16 a[16:31], a[228:231], v[176:179], a[16:31]
ds_read_b128 a[168:171], v10 offset:10240
ds_read_b128 a[172:175], v10 offset:11264
buffer_load_dwordx4 v12, s[52:55], s71 offen offset:3072 sc1 lds
v_cvt_pk_bf16_f32 v81, v82, v83
v_exp_f32 v86, v86
v_add_f32 v2, v2, v84
v_mfma_f32_32x32x16_bf16 a[32:47], a[232:235], v[176:179], a[32:47]
ds_read_b128 a[176:179], v10 offset:12288
s_add_u32 m0, s73, 0
v_exp_f32 v87, v87
v_add_f32 v3, v3, v85
v_cvt_pk_bf16_f32 v82, v84, v85
v_mfma_f32_32x32x16_bf16 a[48:63], a[236:239], v[176:179], a[48:63]
ds_read_b128 a[180:183], v10 offset:13312
buffer_load_dwordx4 v12, s[56:59], s71 offen offset:0 sc1 lds
v_exp_f32 v88, v88
v_add_f32 v2, v2, v86
v_exp_f32 v89, v89
v_mfma_f32_32x32x16_bf16 a[0:15], a[240:243], v[184:187], a[0:15]
ds_read_b128 a[184:187], v10 offset:14336
buffer_load_dwordx4 v12, s[56:59], s71 offen offset:1024 sc1 lds
v_add_f32 v3, v3, v87
v_cvt_pk_bf16_f32 v83, v86, v87
v_mfma_f32_32x32x16_bf16 a[16:31], a[244:247], v[184:187], a[16:31]
ds_read_b128 a[188:191], v10 offset:15360
buffer_load_dwordx4 v12, s[56:59], s71 offen offset:2048 sc1 lds
v_exp_f32 v90, v90
v_add_f32 v2, v2, v88
v_exp_f32 v91, v91
v_mfma_f32_32x32x16_bf16 a[32:47], a[248:251], v[184:187], a[32:47]
buffer_load_dwordx4 v12, s[56:59], s71 offen offset:3072 sc1 lds
v_add_f32 v3, v3, v89
v_cvt_pk_bf16_f32 v88, v88, v89
v_add_f32 v2, v2, v90
v_mfma_f32_32x32x16_bf16 a[48:63], a[252:255], v[184:187], a[48:63]
s_add_u32 s71, s71, 16384
s_xor_b32 s72, s72, 0x8000
v_add_f32 v3, v3, v91
v_cvt_pk_bf16_f32 v89, v90, v91
s_cmp_lg_u32 s78, 0
s_cbranch_scc1 L_p3_s1_resc
L_p3_s1_resc_ret:
s_sub_u32 s74, s74, 1
s_branch L_p3_single
L_p3_last:
s_load_dwordx2 s[84:85], s[0:1], 0
s_load_dwordx2 s[86:87], s[0:1], 88
s_load_dwordx2 s[88:89], s[0:1], 104
v_xor_b32 v11, 0x8000, v11
ds_read_b128 a[192:195], v11 offset:0
ds_read_b128 a[196:199], v11 offset:1024
ds_read_b128 a[200:203], v11 offset:2048
ds_read_b128 a[204:207], v11 offset:3072
ds_read_b128 a[208:211], v11 offset:4096
ds_read_b128 a[212:215], v11 offset:5120
ds_read_b128 a[216:219], v11 offset:6144
ds_read_b128 a[220:223], v11 offset:7168
ds_read_b128 a[224:227], v11 offset:8192
ds_read_b128 a[228:231], v11 offset:9216
ds_read_b128 a[232:235], v11 offset:10240
ds_read_b128 a[236:239], v11 offset:11264
ds_read_b128 a[240:243], v11 offset:12288
ds_read_b128 a[244:247], v11 offset:13312
ds_read_b128 a[248:251], v11 offset:14336
ds_read_b128 a[252:255], v11 offset:15360
v_exp_f32 v156, v156
v_exp_f32 v157, v157
v_exp_f32 v158, v158
v_add_f32 v2, v2, v156
v_exp_f32 v159, v159
v_add_f32 v3, v3, v157
v_cvt_pk_bf16_f32 v154, v156, v157
v_exp_f32 v176, v176
v_add_f32 v2, v2, v158
v_exp_f32 v177, v177
v_add_f32 v3, v3, v159
v_cvt_pk_bf16_f32 v155, v158, v159
v_exp_f32 v178, v178
v_add_f32 v2, v2, v176
v_exp_f32 v179, v179
v_add_f32 v3, v3, v177
v_cvt_pk_bf16_f32 v176, v176, v177
v_exp_f32 v180, v180
v_add_f32 v2, v2, v178
v_exp_f32 v181, v181
v_add_f32 v3, v3, v179
v_cvt_pk_bf16_f32 v177, v178, v179
v_exp_f32 v182, v182
v_add_f32 v2, v2, v180
v_exp_f32 v183, v183
v_add_f32 v3, v3, v181
v_cvt_pk_bf16_f32 v178, v180, v181
v_exp_f32 v184, v184
v_add_f32 v2, v2, v182
v_exp_f32 v185, v185
v_add_f32 v3, v3, v183
v_cvt_pk_bf16_f32 v179, v182, v183
v_exp_f32 v186, v186
v_add_f32 v2, v2, v184
v_exp_f32 v187, v187
v_add_f32 v3, v3, v185
v_cvt_pk_bf16_f32 v184, v184, v185
v_exp_f32 v188, v188
v_add_f32 v2, v2, v186
v_exp_f32 v189, v189
v_add_f32 v3, v3, v187
v_cvt_pk_bf16_f32 v185, v186, v187
v_exp_f32 v190, v190
v_add_f32 v2, v2, v188
v_exp_f32 v191, v191
v_add_f32 v3, v3, v189
v_cvt_pk_bf16_f32 v186, v188, v189
v_add_f32 v2, v2, v190
v_add_f32 v3, v3, v191
v_cvt_pk_bf16_f32 v187, v190, v191
s_waitcnt vmcnt(0) lgkmcnt(0)
s_barrier
v_mfma_f32_32x32x16_bf16 a[0:15], a[192:195], v[144:147], a[0:15]
v_mfma_f32_32x32x16_bf16 a[16:31], a[196:199], v[144:147], a[16:31]
v_mfma_f32_32x32x16_bf16 a[32:47], a[200:203], v[144:147], a[32:47]
v_mfma_f32_32x32x16_bf16 a[48:63], a[204:207], v[144:147], a[48:63]
v_mfma_f32_32x32x16_bf16 a[0:15], a[208:211], v[152:155], a[0:15]
v_mfma_f32_32x32x16_bf16 a[16:31], a[212:215], v[152:155], a[16:31]
v_mfma_f32_32x32x16_bf16 a[32:47], a[216:219], v[152:155], a[32:47]
v_mfma_f32_32x32x16_bf16 a[48:63], a[220:223], v[152:155], a[48:63]
v_mfma_f32_32x32x16_bf16 a[0:15], a[224:227], v[176:179], a[0:15]
v_mfma_f32_32x32x16_bf16 a[16:31], a[228:231], v[176:179], a[16:31]
v_mfma_f32_32x32x16_bf16 a[32:47], a[232:235], v[176:179], a[32:47]
v_mfma_f32_32x32x16_bf16 a[48:63], a[236:239], v[176:179], a[48:63]
v_mfma_f32_32x32x16_bf16 a[0:15], a[240:243], v[184:187], a[0:15]
v_mfma_f32_32x32x16_bf16 a[16:31], a[244:247], v[184:187], a[16:31]
v_mfma_f32_32x32x16_bf16 a[32:47], a[248:251], v[184:187], a[32:47]
v_mfma_f32_32x32x16_bf16 a[48:63], a[252:255], v[184:187], a[48:63]
v_add_f32 v2, v2, v3
v_mov_b32 v3, v2
s_nop 1
v_permlane32_swap_b32 v2, v3
v_add_f32 v2, v2, v3
v_rcp_f32 v2, v2
s_nop 7
v_accvgpr_read_b32 v240, a0
v_accvgpr_read_b32 v241, a1
v_accvgpr_read_b32 v242, a2
v_accvgpr_read_b32 v243, a3
v_accvgpr_read_b32 v244, a4
v_accvgpr_read_b32 v245, a5
v_accvgpr_read_b32 v246, a6
v_accvgpr_read_b32 v247, a7
v_mul_f32 v240, v240, v2
v_mul_f32 v241, v241, v2
v_mul_f32 v242, v242, v2
v_mul_f32 v243, v243, v2
v_mul_f32 v244, v244, v2
v_mul_f32 v245, v245, v2
v_mul_f32 v246, v246, v2
v_mul_f32 v247, v247, v2
v_cvt_pk_bf16_f32 v248, v240, v241
v_cvt_pk_bf16_f32 v249, v242, v243
v_cvt_pk_bf16_f32 v250, v244, v245
v_cvt_pk_bf16_f32 v251, v246, v247
buffer_store_dwordx4 v[248:251], v15, s[60:63], s100 offen offset:0 sc1
v_accvgpr_read_b32 v240, a8
v_accvgpr_read_b32 v241, a9
v_accvgpr_read_b32 v242, a10
v_accvgpr_read_b32 v243, a11
v_accvgpr_read_b32 v244, a12
v_accvgpr_read_b32 v245, a13
v_accvgpr_read_b32 v246, a14
v_accvgpr_read_b32 v247, a15
v_mul_f32 v240, v240, v2
v_mul_f32 v241, v241, v2
v_mul_f32 v242, v242, v2
v_mul_f32 v243, v243, v2
v_mul_f32 v244, v244, v2
v_mul_f32 v245, v245, v2
v_mul_f32 v246, v246, v2
v_mul_f32 v247, v247, v2
v_cvt_pk_bf16_f32 v252, v240, v241
v_cvt_pk_bf16_f32 v253, v242, v243
v_cvt_pk_bf16_f32 v254, v244, v245
v_cvt_pk_bf16_f32 v255, v246, v247
buffer_store_dwordx4 v[252:255], v15, s[60:63], s100 offen offset:512 sc1
v_accvgpr_read_b32 v240, a16
v_accvgpr_read_b32 v241, a17
v_accvgpr_read_b32 v242, a18
v_accvgpr_read_b32 v243, a19
v_accvgpr_read_b32 v244, a20
v_accvgpr_read_b32 v245, a21
v_accvgpr_read_b32 v246, a22
v_accvgpr_read_b32 v247, a23
v_mul_f32 v240, v240, v2
v_mul_f32 v241, v241, v2
v_mul_f32 v242, v242, v2
v_mul_f32 v243, v243, v2
v_mul_f32 v244, v244, v2
v_mul_f32 v245, v245, v2
v_mul_f32 v246, v246, v2
v_mul_f32 v247, v247, v2
v_cvt_pk_bf16_f32 v248, v240, v241
v_cvt_pk_bf16_f32 v249, v242, v243
v_cvt_pk_bf16_f32 v250, v244, v245
v_cvt_pk_bf16_f32 v251, v246, v247
buffer_store_dwordx4 v[248:251], v15, s[60:63], s100 offen offset:1024 sc1
v_accvgpr_read_b32 v240, a24
v_accvgpr_read_b32 v241, a25
v_accvgpr_read_b32 v242, a26
v_accvgpr_read_b32 v243, a27
v_accvgpr_read_b32 v244, a28
v_accvgpr_read_b32 v245, a29
v_accvgpr_read_b32 v246, a30
v_accvgpr_read_b32 v247, a31
v_mul_f32 v240, v240, v2
v_mul_f32 v241, v241, v2
v_mul_f32 v242, v242, v2
v_mul_f32 v243, v243, v2
v_mul_f32 v244, v244, v2
v_mul_f32 v245, v245, v2
v_mul_f32 v246, v246, v2
v_mul_f32 v247, v247, v2
v_cvt_pk_bf16_f32 v252, v240, v241
v_cvt_pk_bf16_f32 v253, v242, v243
v_cvt_pk_bf16_f32 v254, v244, v245
v_cvt_pk_bf16_f32 v255, v246, v247
buffer_store_dwordx4 v[252:255], v15, s[60:63], s100 offen offset:1536 sc1
v_accvgpr_read_b32 v240, a32
v_accvgpr_read_b32 v241, a33
v_accvgpr_read_b32 v242, a34
v_accvgpr_read_b32 v243, a35
v_accvgpr_read_b32 v244, a36
v_accvgpr_read_b32 v245, a37
v_accvgpr_read_b32 v246, a38
v_accvgpr_read_b32 v247, a39
v_mul_f32 v240, v240, v2
v_mul_f32 v241, v241, v2
v_mul_f32 v242, v242, v2
v_mul_f32 v243, v243, v2
v_mul_f32 v244, v244, v2
v_mul_f32 v245, v245, v2
v_mul_f32 v246, v246, v2
v_mul_f32 v247, v247, v2
v_cvt_pk_bf16_f32 v248, v240, v241
v_cvt_pk_bf16_f32 v249, v242, v243
v_cvt_pk_bf16_f32 v250, v244, v245
v_cvt_pk_bf16_f32 v251, v246, v247
buffer_store_dwordx4 v[248:251], v15, s[60:63], s100 offen offset:2048 sc1
v_accvgpr_read_b32 v240, a40
v_accvgpr_read_b32 v241, a41
v_accvgpr_read_b32 v242, a42
v_accvgpr_read_b32 v243, a43
v_accvgpr_read_b32 v244, a44
v_accvgpr_read_b32 v245, a45
v_accvgpr_read_b32 v246, a46
v_accvgpr_read_b32 v247, a47
v_mul_f32 v240, v240, v2
v_mul_f32 v241, v241, v2
v_mul_f32 v242, v242, v2
v_mul_f32 v243, v243, v2
v_mul_f32 v244, v244, v2
v_mul_f32 v245, v245, v2
v_mul_f32 v246, v246, v2
v_mul_f32 v247, v247, v2
v_cvt_pk_bf16_f32 v252, v240, v241
v_cvt_pk_bf16_f32 v253, v242, v243
v_cvt_pk_bf16_f32 v254, v244, v245
v_cvt_pk_bf16_f32 v255, v246, v247
buffer_store_dwordx4 v[252:255], v15, s[60:63], s100 offen offset:2560 sc1
v_accvgpr_read_b32 v240, a48
v_accvgpr_read_b32 v241, a49
v_accvgpr_read_b32 v242, a50
v_accvgpr_read_b32 v243, a51
v_accvgpr_read_b32 v244, a52
v_accvgpr_read_b32 v245, a53
v_accvgpr_read_b32 v246, a54
v_accvgpr_read_b32 v247, a55
v_mul_f32 v240, v240, v2
v_mul_f32 v241, v241, v2
v_mul_f32 v242, v242, v2
v_mul_f32 v243, v243, v2
v_mul_f32 v244, v244, v2
v_mul_f32 v245, v245, v2
v_mul_f32 v246, v246, v2
v_mul_f32 v247, v247, v2
v_cvt_pk_bf16_f32 v248, v240, v241
v_cvt_pk_bf16_f32 v249, v242, v243
v_cvt_pk_bf16_f32 v250, v244, v245
v_cvt_pk_bf16_f32 v251, v246, v247
buffer_store_dwordx4 v[248:251], v15, s[60:63], s100 offen offset:3072 sc1
v_accvgpr_read_b32 v240, a56
v_accvgpr_read_b32 v241, a57
v_accvgpr_read_b32 v242, a58
v_accvgpr_read_b32 v243, a59
v_accvgpr_read_b32 v244, a60
v_accvgpr_read_b32 v245, a61
v_accvgpr_read_b32 v246, a62
v_accvgpr_read_b32 v247, a63
v_mul_f32 v240, v240, v2
v_mul_f32 v241, v241, v2
v_mul_f32 v242, v242, v2
v_mul_f32 v243, v243, v2
v_mul_f32 v244, v244, v2
v_mul_f32 v245, v245, v2
v_mul_f32 v246, v246, v2
v_mul_f32 v247, v247, v2
v_cvt_pk_bf16_f32 v252, v240, v241
v_cvt_pk_bf16_f32 v253, v242, v243
v_cvt_pk_bf16_f32 v254, v244, v245
v_cvt_pk_bf16_f32 v255, v246, v247
buffer_store_dwordx4 v[252:255], v15, s[60:63], s100 offen offset:3584 sc1
s_mul_i32 s36, s3, 16640
v_and_b32 v12, 15, v1
v_lshrrev_b32 v13, 4, v1
v_add_u32 v14, 13, v12
v_and_b32 v15, 3, v14
v_cmp_eq_u32 vcc, 0, v15
v_lshrrev_b32 v14, 2, v14
v_mul_u32_u24 v15, 4160, v15
v_cndmask_b32 v15, v15, 8, vcc
v_lshl_add_u32 v15, v14, 3, v15
v_lshl_add_u32 v15, v13, 4, v15
v_add_u32 v4, s36, v15
v_add_u32 v6, s36, v72
v_lshlrev_b32 v14, 5, v12
v_lshlrev_b32 v15, 4, v13
v_sub_u32 v15, v15, v14
s_add_u32 s37, s43, 480
v_add_u32 v5, s37, v15
v_mul_u32_u24 v14, 136, v12
v_lshl_add_u32 v14, v13, 5, v14
s_lshl_b32 s37, s3, 1
s_add_u32 s37, s37, 66560
v_add_u32 v7, s37, v14
v_lshrrev_b32 v14, 3, v1
v_mul_u32_u24 v14, 136, v14
v_and_b32 v15, 7, v1
v_lshl_add_u32 v14, v15, 4, v14
s_mul_i32 s37, s3, 4352
s_add_u32 s37, s37, 66560
v_add_u32 v8, s37, v14
s_lshl_b32 s37, s3, 12
v_add_u32 v9, s37, v72
v_lshl_add_u32 v14, v13, 3, v12
v_sub_u32 v75, 15, v14
v_mov_b32 v16, 0
v_mov_b32 v17, 0
v_mov_b32 v18, 0
v_mov_b32 v19, 0
v_and_b32 v12, 3, v1
v_mul_u32_u24 v12, 4160, v12
v_lshrrev_b32 v13, 2, v1
v_min_u32 v13, 3, v13
v_lshl_add_u32 v12, v13, 4, v12
v_add_u32 v12, s36, v12
ds_write_b128 v12, v[16:19]
v_and_b32 v13, 31, v1
v_lshlrev_b32 v13, 4, v13
v_add_u32 v13, s43, v13
ds_write_b128 v13, v[16:19] offset:4096
v_alignbit_b32 v20, v49, v48, 16
v_alignbit_b32 v21, v50, v49, 16
v_alignbit_b32 v22, v51, v50, 16
v_alignbit_b32 v23, v52, v51, 16
v_alignbit_b32 v24, v53, v52, 16
ds_write_b128 v6, v[50:53] offset:64
ds_write_b128 v6, v[20:23] offset:4208
v_mov_b32 v12, v49
v_mov_b32 v13, v50
v_mov_b32 v14, v51
v_mov_b32 v15, v52
ds_write_b128 v6, v[12:15] offset:8368
v_mov_b32 v12, v21
v_mov_b32 v13, v22
v_mov_b32 v14, v23
v_mov_b32 v15, v24
ds_write_b128 v6, v[12:15] offset:12528
v_alignbit_b32 v26, v55, v54, 16
v_alignbit_b32 v27, v56, v55, 16
v_alignbit_b32 v28, v57, v56, 16
v_alignbit_b32 v29, v58, v57, 16
v_alignbit_b32 v30, v59, v58, 16
ds_write_b128 v6, v[56:59] offset:1088
ds_write_b128 v6, v[26:29] offset:5232
v_mov_b32 v12, v55
v_mov_b32 v13, v56
v_mov_b32 v14, v57
v_mov_b32 v15, v58
ds_write_b128 v6, v[12:15] offset:9392
v_mov_b32 v12, v27
v_mov_b32 v13, v28
v_mov_b32 v14, v29
v_mov_b32 v15, v30
ds_write_b128 v6, v[12:15] offset:13552
v_alignbit_b32 v20, v61, v60, 16
v_alignbit_b32 v21, v62, v61, 16
v_alignbit_b32 v22, v63, v62, 16
v_alignbit_b32 v23, v64, v63, 16
v_alignbit_b32 v24, v65, v64, 16
ds_write_b128 v6, v[62:65] offset:2112
ds_write_b128 v6, v[20:23] offset:6256
v_mov_b32 v12, v61
v_mov_b32 v13, v62
v_mov_b32 v14, v63
v_mov_b32 v15, v64
ds_write_b128 v6, v[12:15] offset:10416
v_mov_b32 v12, v21
v_mov_b32 v13, v22
v_mov_b32 v14, v23
v_mov_b32 v15, v24
ds_write_b128 v6, v[12:15] offset:14576
v_alignbit_b32 v26, v67, v66, 16
v_alignbit_b32 v27, v68, v67, 16
v_alignbit_b32 v28, v69, v68, 16
v_alignbit_b32 v29, v70, v69, 16
v_alignbit_b32 v30, v71, v70, 16
ds_write_b128 v6, v[68:71] offset:3136
ds_write_b128 v6, v[26:29] offset:7280
v_mov_b32 v12, v67
v_mov_b32 v13, v68
v_mov_b32 v14, v69
v_mov_b32 v15, v70
ds_write_b128 v6, v[12:15] offset:11440
v_mov_b32 v12, v27
v_mov_b32 v13, v28
v_mov_b32 v14, v29
v_mov_b32 v15, v30
ds_write_b128 v6, v[12:15] offset:15600
v_lshlrev_b32 v12, 16, v74
v_cmp_eq_u32 vcc, 0, v75
s_nop 1
v_cndmask_b32 v32, 0, v74, vcc
v_cmp_eq_u32 vcc, 1, v75
s_nop 1
v_cndmask_b32 v32, v32, v12, vcc
v_cmp_eq_u32 vcc, 2, v75
s_nop 1
v_cndmask_b32 v33, 0, v74, vcc
v_cmp_eq_u32 vcc, 3, v75
s_nop 1
v_cndmask_b32 v33, v33, v12, vcc
v_cmp_eq_u32 vcc, 4, v75
s_nop 1
v_cndmask_b32 v34, 0, v74, vcc
v_cmp_eq_u32 vcc, 5, v75
s_nop 1
v_cndmask_b32 v34, v34, v12, vcc
v_cmp_eq_u32 vcc, 6, v75
s_nop 1
v_cndmask_b32 v35, 0, v74, vcc
v_cmp_eq_u32 vcc, 7, v75
s_nop 1
v_cndmask_b32 v35, v35, v12, vcc
s_waitcnt lgkmcnt(0)
ds_read_b128 v[140:143], v5 offset:3584
ds_read_b64 v[108:109], v4 offset:0
ds_read_b64 v[110:111], v4 offset:8
ds_read_b128 v[144:147], v5 offset:3072
ds_read_b64 v[112:113], v4 offset:512
ds_read_b64 v[114:115], v4 offset:520
ds_read_b128 v[148:151], v5 offset:2560
ds_read_b64 v[116:117], v4 offset:1024
ds_read_b64 v[118:119], v4 offset:1032
ds_read_b128 v[152:155], v5 offset:2048
ds_read_b64 v[120:121], v4 offset:1536
ds_read_b64 v[122:123], v4 offset:1544
ds_read_b128 v[156:159], v5 offset:1536
ds_read_b64 v[124:125], v4 offset:2048
ds_read_b64 v[126:127], v4 offset:2056
ds_read_b128 v[160:163], v5 offset:1024
ds_read_b64 v[128:129], v4 offset:2560
ds_read_b64 v[130:131], v4 offset:2568
ds_read_b128 v[164:167], v5 offset:512
ds_read_b64 v[132:133], v4 offset:3072
ds_read_b64 v[134:135], v4 offset:3080
ds_read_b128 v[168:171], v5 offset:0
ds_read_b64 v[136:137], v4 offset:3584
ds_read_b64 v[138:139], v4 offset:3592
s_waitcnt lgkmcnt(15)
v_mfma_f32_16x16x32_bf16 v[76:79], v[108:111], v[140:143], 0
ds_read_b128 v[204:207], v5 offset:3648
v_mfma_f32_16x16x32_bf16 v[80:83], v[108:111], v[144:147], 0
ds_read_b64 v[172:173], v4 offset:64
s_and_b32 s81, s2, 3
s_lshl_b32 s81, s81, 1
v_mfma_f32_16x16x32_bf16 v[84:87], v[108:111], v[148:151], 0
ds_read_b64 v[174:175], v4 offset:72
s_sub_u32 s74, 14, s81
s_waitcnt lgkmcnt(15)
v_mfma_f32_16x16x32_bf16 v[88:91], v[108:111], v[152:155], 0
ds_read_b128 v[208:211], v5 offset:3136
s_bitcmp1_b32 s2, 4
s_cselect_b32 s81, s74, s81
s_waitcnt lgkmcnt(15)
v_mfma_f32_16x16x32_bf16 v[92:95], v[108:111], v[156:159], 0
s_bfe_u32 s74, s2, 0x10003
s_waitcnt lgkmcnt(12)
v_mfma_f32_16x16x32_bf16 v[96:99], v[108:111], v[160:163], 0
ds_read_b64 v[176:177], v4 offset:576
s_add_u32 s81, s81, s74
s_waitcnt lgkmcnt(10)
v_mfma_f32_16x16x32_bf16 v[100:103], v[108:111], v[164:167], 0
ds_read_b64 v[178:179], v4 offset:584
s_bfe_u32 s82, s2, 0x10002
s_waitcnt lgkmcnt(8)
v_mfma_f32_16x16x32_bf16 v[104:107], v[108:111], v[168:171], 0
ds_read_b128 v[212:215], v5 offset:2624
s_lshl_b32 s82, s82, 3
MV 76,v,32,v,140
ds_read_b64 v[180:181], v4 offset:1088
s_lshr_b32 s74, s2, 5
MV 80,v,32,v,144
s_add_u32 s82, s82, s74
MV 84,v,32,v,148
ds_read_b64 v[182:183], v4 offset:1096
s_mov_b32 s72, s81
MV 88,v,32,v,152
ds_read_b128 v[216:219], v5 offset:2112
s_mov_b32 s73, s82
MV 92,v,32,v,156
ds_read_b64 v[184:185], v4 offset:1600
s_lshl_b32 s74, s72, 2
MV 96,v,32,v,160
ds_read_b64 v[186:187], v4 offset:1608
s_add_u32 s74, s74, s3
MV 100,v,32,v,164
s_lshl_b32 s68, s74, 18
MV 104,v,32,v,168
ds_read_b128 v[220:223], v5 offset:1600
s_lshl_b32 s69, s3, 16
MV 80,v,112,v,140
ds_read_b64 v[188:189], v4 offset:2112
s_lshl_b32 s75, s73, 7
MV 84,v,112,v,144
ds_read_b64 v[190:191], v4 offset:2120
s_add_u32 s69, s69, s75
MV 88,v,112,v,148
ds_read_b128 v[224:227], v5 offset:1088
s_lshl_b32 s70, s3, 12
MV 92,v,112,v,152
s_lshl_b32 s78, s74, 16
MV 96,v,112,v,156
ds_read_b64 v[192:193], v4 offset:2624
s_add_u32 s78, s78, s75
MV 100,v,112,v,160
ds_read_b64 v[194:195], v4 offset:2632
s_lshl_b32 s79, s73, 18
MV 104,v,112,v,164
ds_read_b128 v[228:231], v5 offset:576
s_lshl_b32 s75, s74, 8
MV 84,v,116,v,140
ds_read_b64 v[196:197], v4 offset:3136
s_add_u32 s79, s79, s75
MV 88,v,116,v,144
s_lshl_b32 s80, s74, 7
MV 92,v,116,v,148
ds_read_b64 v[198:199], v4 offset:3144
v_lshlrev_b32 v236, 4, v1
MV 96,v,116,v,152
ds_read_b128 v[232:235], v5 offset:64
v_add_u32 v237, 0x20000, v236
MV 100,v,116,v,156
ds_read_b64 v[200:201], v4 offset:3648
v_lshrrev_b32 v36, 3, v1
MV 104,v,116,v,160
ds_read_b64 v[202:203], v4 offset:3656
v_lshlrev_b32 v36, 11, v36
MV 88,v,120,v,140
v_lshrrev_b32 v37, 4, v1
MV 92,v,120,v,144
v_lshlrev_b32 v38, 1, v37
MV 96,v,120,v,148
v_and_b32 v39, 7, v1
MV 100,v,120,v,152
v_xor_b32 v38, v38, v39
MV 104,v,120,v,156
v_lshl_add_u32 v36, v38, 4, v36
MV 92,v,124,v,140
v_add_u32 v238, 0, v36
MV 96,v,124,v,144
v_add_u32 v239, 15360, v36
MV 100,v,124,v,148
v_add_u32 v240, 30720, v36
MV 104,v,124,v,152
v_add_u32 v241, 46080, v36
MV 96,v,128,v,140
v_bfe_u32 v36, v1, 2, 2
MV 100,v,128,v,144
v_and_b32 v38, 1, v37
MV 104,v,128,v,148
v_lshrrev_b32 v39, 1, v36
MV 100,v,132,v,140
v_lshl_add_u32 v39, v38, 1, v39
MV 104,v,132,v,144
v_lshl_add_u32 v36, v38, 2, v36
s_waitcnt lgkmcnt(15)
MV 104,v,136,v,140
v_lshrrev_b32 v40, 5, v1
MV 76,v,172,v,204
ds_read_b128 v[140:143], v5 offset:3712
MV 80,v,172,v,208
ds_read_b64 v[108:109], v4 offset:128
v_lshl_add_u32 v36, v40, 4, v36
v_lshlrev_b32 v36, 7, v36
MV 84,v,172,v,212
ds_read_b64 v[110:111], v4 offset:136
v_and_b32 v41, 3, v1
s_waitcnt lgkmcnt(15)
MV 88,v,172,v,216
ds_read_b128 v[144:147], v5 offset:3200
v_lshl_add_u32 v36, v41, 3, v36
v_xor_b32 v41, 0, v39
s_waitcnt lgkmcnt(15)
MV 92,v,172,v,220
v_lshl_add_u32 v242, v41, 5, v36
s_waitcnt lgkmcnt(12)
MV 96,v,172,v,224
ds_read_b64 v[112:113], v4 offset:640
v_add_u32 v246, 0x10000, v242
s_waitcnt lgkmcnt(10)
MV 100,v,172,v,228
ds_read_b64 v[114:115], v4 offset:648
v_xor_b32 v41, 1, v39
v_lshl_add_u32 v243, v41, 5, v36
s_waitcnt lgkmcnt(8)
MV 104,v,172,v,232
ds_read_b128 v[148:151], v5 offset:2688
v_add_u32 v247, 0x10000, v243
MV 80,v,176,v,204
ds_read_b64 v[116:117], v4 offset:1152
v_xor_b32 v41, 2, v39
MV 84,v,176,v,208
v_lshl_add_u32 v244, v41, 5, v36
v_add_u32 v248, 0x10000, v244
MV 88,v,176,v,212
ds_read_b64 v[118:119], v4 offset:1160
v_xor_b32 v41, 3, v39
MV 92,v,176,v,216
ds_read_b128 v[152:155], v5 offset:2176
v_lshl_add_u32 v245, v41, 5, v36
MV 96,v,176,v,220
ds_read_b64 v[120:121], v4 offset:1664
v_add_u32 v249, 0x10000, v245
v_and_b32 v36, 15, v1
MV 100,v,176,v,224
ds_read_b64 v[122:123], v4 offset:1672
v_lshlrev_b32 v41, 5, v38
MV 104,v,176,v,228
v_lshl_add_u32 v41, v40, 4, v41
MV 84,v,180,v,204
ds_read_b128 v[156:159], v5 offset:1664
v_lshl_add_u32 v250, v36, 11, v41
v_lshlrev_b32 v41, 11, v41
MV 88,v,180,v,208
ds_read_b64 v[124:125], v4 offset:2176
v_lshl_add_u32 v251, v36, 3, v41
MV 92,v,180,v,212
ds_read_b64 v[126:127], v4 offset:2184
v_lshlrev_b32 v252, 2, v36
MV 96,v,180,v,216
ds_read_b128 v[160:163], v5 offset:1152
s_add_u32 s44, s40, 33554432
s_addc_u32 s45, s41, 0
s_mov_b32 s46, 16777216
MV 100,v,180,v,220
s_mov_b32 s47, 0x20000
MV 104,v,180,v,224
ds_read_b64 v[128:129], v4 offset:2688
s_mov_b32 s48, s86
MV 88,v,184,v,204
ds_read_b64 v[130:131], v4 offset:2696
s_mov_b32 s49, s87
s_mov_b32 s50, 8388608
MV 92,v,184,v,208
ds_read_b128 v[164:167], v5 offset:640
s_mov_b32 s51, 0x20000
MV 96,v,184,v,212
ds_read_b64 v[132:133], v4 offset:3200
s_mov_b32 s52, s84
MV 100,v,184,v,216
s_mov_b32 s53, s85
s_mov_b32 s54, 4194304
MV 104,v,184,v,220
ds_read_b64 v[134:135], v4 offset:3208
s_mov_b32 s55, 0x20000
MV 92,v,188,v,204
ds_read_b128 v[168:171], v5 offset:128
s_add_u32 s56, s40, 54525952
s_addc_u32 s57, s41, 0
MV 96,v,188,v,208
ds_read_b64 v[136:137], v4 offset:3712
s_mov_b32 s58, 4194304
s_mov_b32 s59, 0x20000
MV 100,v,188,v,212
ds_read_b64 v[138:139], v4 offset:3720
s_mov_b32 s60, s88
MV 104,v,188,v,216
s_mov_b32 s61, s89
MV 96,v,192,v,204
s_mov_b32 s62, 4194304
s_mov_b32 s63, 0x20000
MV 100,v,192,v,208
s_add_u32 s64, s40, 58720256
s_addc_u32 s65, s41, 0
MV 104,v,192,v,212
s_mov_b32 s66, 8192
MV 100,v,196,v,204
s_mov_b32 s67, 0x20000
v_lshlrev_b32 v255, 20, v1
MV 104,v,196,v,208
s_lshl_b32 s36, s3, 26
s_waitcnt lgkmcnt(15)
MV 104,v,200,v,204
v_add_u32 v255, s36, v255
s_waitcnt vmcnt(0)
s_barrier
v_mov_b32 v253, 1
s_lshl_b32 s36, s2, 2
buffer_store_dword v253, v255, s[8:11], s36 offen offset:2048 sc1
MV 76,v,108,v,140
ds_read_b128 v[204:207], v5 offset:3776
MV 80,v,108,v,144
ds_read_b64 v[172:173], v4 offset:192
s_sub_u32 s36, 15, s81
MV 84,v,108,v,148
ds_read_b64 v[174:175], v4 offset:200
s_waitcnt lgkmcnt(15)
MV 88,v,108,v,152
ds_read_b128 v[208:211], v5 offset:3264
s_waitcnt lgkmcnt(15)
MV 92,v,108,v,156
s_waitcnt lgkmcnt(12)
MV 96,v,108,v,160
ds_read_b64 v[176:177], v4 offset:704
s_min_u32 s36, s36, s81
s_waitcnt lgkmcnt(10)
MV 100,v,108,v,164
ds_read_b64 v[178:179], v4 offset:712
s_waitcnt lgkmcnt(8)
MV 104,v,108,v,168
ds_read_b128 v[212:215], v5 offset:2752
MV 80,v,112,v,140
ds_read_b64 v[180:181], v4 offset:1216
MV 84,v,112,v,144
s_lshl_b32 s36, s36, 5
MV 88,v,112,v,148
ds_read_b64 v[182:183], v4 offset:1224
MV 92,v,112,v,152
ds_read_b128 v[216:219], v5 offset:2240
MV 96,v,112,v,156
ds_read_b64 v[184:185], v4 offset:1728
MV 100,v,112,v,160
ds_read_b64 v[186:187], v4 offset:1736
MV 104,v,112,v,164
v_and_b32 v254, 3, v1
MV 84,v,116,v,140
ds_read_b128 v[220:223], v5 offset:1728
MV 88,v,116,v,144
ds_read_b64 v[188:189], v4 offset:2240
MV 92,v,116,v,148
ds_read_b64 v[190:191], v4 offset:2248
MV 96,v,116,v,152
ds_read_b128 v[224:227], v5 offset:1216
v_lshlrev_b32 v254, 3, v254
MV 100,v,116,v,156
MV 104,v,116,v,160
ds_read_b64 v[192:193], v4 offset:2752
MV 88,v,120,v,140
ds_read_b64 v[194:195], v4 offset:2760
MV 92,v,120,v,144
ds_read_b128 v[228:231], v5 offset:704
v_bfe_u32 v253, v1, 2, 3
MV 96,v,120,v,148
ds_read_b64 v[196:197], v4 offset:3264
MV 100,v,120,v,152
MV 104,v,120,v,156
ds_read_b64 v[198:199], v4 offset:3272
MV 92,v,124,v,140
ds_read_b128 v[232:235], v5 offset:192
MV 96,v,124,v,144
ds_read_b64 v[200:201], v4 offset:3776
v_add3_u32 v254, v254, v253, s36
MV 100,v,124,v,148
ds_read_b64 v[202:203], v4 offset:3784
MV 104,v,124,v,152
MV 96,v,128,v,140
MV 100,v,128,v,144
v_lshlrev_b32 v254, 2, v254
MV 104,v,128,v,148
MV 100,v,132,v,140
MV 104,v,132,v,144
s_waitcnt lgkmcnt(15)
MV 104,v,136,v,140
MV 76,v,172,v,204
ds_read_b128 v[140:143], v5 offset:3840
MV 80,v,172,v,208
ds_read_b64 v[108:109], v4 offset:256
s_add_u32 m0, s70, 98304
s_nop 0
buffer_load_dwordx4 v238, s[48:51], s69 offen offset:0 lds
MV 84,v,172,v,212
ds_read_b64 v[110:111], v4 offset:264
s_waitcnt lgkmcnt(15)
MV 88,v,172,v,216
ds_read_b128 v[144:147], v5 offset:3328
s_waitcnt lgkmcnt(15)
MV 92,v,172,v,220
s_waitcnt lgkmcnt(12)
MV 96,v,172,v,224
ds_read_b64 v[112:113], v4 offset:768
s_waitcnt lgkmcnt(10)
MV 100,v,172,v,228
ds_read_b64 v[114:115], v4 offset:776
s_waitcnt lgkmcnt(8)
MV 104,v,172,v,232
ds_read_b128 v[148:151], v5 offset:2816
MV 80,v,176,v,204
ds_read_b64 v[116:117], v4 offset:1280
MV 84,v,176,v,208
buffer_load_dwordx4 v239, s[48:51], s69 offen offset:1024 lds
MV 88,v,176,v,212
ds_read_b64 v[118:119], v4 offset:1288
MV 92,v,176,v,216
ds_read_b128 v[152:155], v5 offset:2304
MV 96,v,176,v,220
ds_read_b64 v[120:121], v4 offset:1792
MV 100,v,176,v,224
ds_read_b64 v[122:123], v4 offset:1800
MV 104,v,176,v,228
MV 84,v,180,v,204
ds_read_b128 v[156:159], v5 offset:1792
MV 88,v,180,v,208
ds_read_b64 v[124:125], v4 offset:2304
MV 92,v,180,v,212
ds_read_b64 v[126:127], v4 offset:2312
MV 96,v,180,v,216
ds_read_b128 v[160:163], v5 offset:1280
buffer_load_dwordx4 v240, s[48:51], s69 offen offset:2048 lds
MV 100,v,180,v,220
MV 104,v,180,v,224
ds_read_b64 v[128:129], v4 offset:2816
MV 88,v,184,v,204
ds_read_b64 v[130:131], v4 offset:2824
MV 92,v,184,v,208
ds_read_b128 v[164:167], v5 offset:768
MV 96,v,184,v,212
ds_read_b64 v[132:133], v4 offset:3328
MV 100,v,184,v,216
MV 104,v,184,v,220
ds_read_b64 v[134:135], v4 offset:3336
MV 92,v,188,v,204
ds_read_b128 v[168:171], v5 offset:256
MV 96,v,188,v,208
ds_read_b64 v[136:137], v4 offset:3840
buffer_load_dwordx4 v241, s[48:51], s69 offen offset:3072 lds
s_add_u32 s69, s69, 262144
MV 100,v,188,v,212
ds_read_b64 v[138:139], v4 offset:3848
MV 104,v,188,v,216
MV 96,v,192,v,204
MV 100,v,192,v,208
MV 104,v,192,v,212
MV 100,v,196,v,204
MV 104,v,196,v,208
s_waitcnt lgkmcnt(15)
MV 104,v,200,v,204
MV 76,v,108,v,140
ds_read_b128 v[204:207], v5 offset:3904
MV 80,v,108,v,144
ds_read_b64 v[172:173], v4 offset:320
s_add_u32 m0, s70, 114688
s_nop 0
buffer_load_dwordx4 v238, s[48:51], s69 offen offset:0 lds
MV 84,v,108,v,148
ds_read_b64 v[174:175], v4 offset:328
s_waitcnt lgkmcnt(15)
MV 88,v,108,v,152
ds_read_b128 v[208:211], v5 offset:3392
s_waitcnt lgkmcnt(15)
MV 92,v,108,v,156
s_waitcnt lgkmcnt(12)
MV 96,v,108,v,160
ds_read_b64 v[176:177], v4 offset:832
s_waitcnt lgkmcnt(10)
MV 100,v,108,v,164
ds_read_b64 v[178:179], v4 offset:840
s_waitcnt lgkmcnt(8)
MV 104,v,108,v,168
ds_read_b128 v[212:215], v5 offset:2880
MV 80,v,112,v,140
ds_read_b64 v[180:181], v4 offset:1344
MV 84,v,112,v,144
buffer_load_dwordx4 v239, s[48:51], s69 offen offset:1024 lds
MV 88,v,112,v,148
ds_read_b64 v[182:183], v4 offset:1352
MV 92,v,112,v,152
ds_read_b128 v[216:219], v5 offset:2368
MV 96,v,112,v,156
ds_read_b64 v[184:185], v4 offset:1856
MV 100,v,112,v,160
ds_read_b64 v[186:187], v4 offset:1864
MV 104,v,112,v,164
MV 84,v,116,v,140
ds_read_b128 v[220:223], v5 offset:1856
MV 88,v,116,v,144
ds_read_b64 v[188:189], v4 offset:2368
MV 92,v,116,v,148
ds_read_b64 v[190:191], v4 offset:2376
MV 96,v,116,v,152
ds_read_b128 v[224:227], v5 offset:1344
buffer_load_dwordx4 v240, s[48:51], s69 offen offset:2048 lds
MV 100,v,116,v,156
MV 104,v,116,v,160
ds_read_b64 v[192:193], v4 offset:2880
MV 88,v,120,v,140
ds_read_b64 v[194:195], v4 offset:2888
MV 92,v,120,v,144
ds_read_b128 v[228:231], v5 offset:832
MV 96,v,120,v,148
ds_read_b64 v[196:197], v4 offset:3392
MV 100,v,120,v,152
MV 104,v,120,v,156
ds_read_b64 v[198:199], v4 offset:3400
MV 92,v,124,v,140
ds_read_b128 v[232:235], v5 offset:320
MV 96,v,124,v,144
ds_read_b64 v[200:201], v4 offset:3904
buffer_load_dwordx4 v241, s[48:51], s69 offen offset:3072 lds
s_add_u32 s69, s69, 262144
MV 100,v,124,v,148
ds_read_b64 v[202:203], v4 offset:3912
MV 104,v,124,v,152
MV 96,v,128,v,140
MV 100,v,128,v,144
MV 104,v,128,v,148
MV 100,v,132,v,140
MV 104,v,132,v,144
s_waitcnt lgkmcnt(15)
MV 104,v,136,v,140
MV 76,v,172,v,204
ds_read_b128 v[140:143], v5 offset:3968
MV 80,v,172,v,208
ds_read_b64 v[108:109], v4 offset:384
MV 84,v,172,v,212
ds_read_b64 v[110:111], v4 offset:392
s_waitcnt lgkmcnt(15)
MV 88,v,172,v,216
ds_read_b128 v[144:147], v5 offset:3456
s_waitcnt lgkmcnt(15)
MV 92,v,172,v,220
s_waitcnt lgkmcnt(12)
MV 96,v,172,v,224
ds_read_b64 v[112:113], v4 offset:896
s_waitcnt lgkmcnt(10)
MV 100,v,172,v,228
ds_read_b64 v[114:115], v4 offset:904
s_waitcnt lgkmcnt(8)
MV 104,v,172,v,232
ds_read_b128 v[148:151], v5 offset:2944
MV 80,v,176,v,204
ds_read_b64 v[116:117], v4 offset:1408
MV 84,v,176,v,208
MV 88,v,176,v,212
ds_read_b64 v[118:119], v4 offset:1416
MV 92,v,176,v,216
ds_read_b128 v[152:155], v5 offset:2432
MV 96,v,176,v,220
ds_read_b64 v[120:121], v4 offset:1920
MV 100,v,176,v,224
ds_read_b64 v[122:123], v4 offset:1928
MV 104,v,176,v,228
MV 84,v,180,v,204
ds_read_b128 v[156:159], v5 offset:1920
MV 88,v,180,v,208
ds_read_b64 v[124:125], v4 offset:2432
MV 92,v,180,v,212
ds_read_b64 v[126:127], v4 offset:2440
MV 96,v,180,v,216
ds_read_b128 v[160:163], v5 offset:1408
MV 100,v,180,v,220
MV 104,v,180,v,224
ds_read_b64 v[128:129], v4 offset:2944
MV 88,v,184,v,204
ds_read_b64 v[130:131], v4 offset:2952
MV 92,v,184,v,208
ds_read_b128 v[164:167], v5 offset:896
MV 96,v,184,v,212
ds_read_b64 v[132:133], v4 offset:3456
MV 100,v,184,v,216
MV 104,v,184,v,220
ds_read_b64 v[134:135], v4 offset:3464
MV 92,v,188,v,204
ds_read_b128 v[168:171], v5 offset:384
MV 96,v,188,v,208
ds_read_b64 v[136:137], v4 offset:3968
MV 100,v,188,v,212
ds_read_b64 v[138:139], v4 offset:3976
MV 104,v,188,v,216
MV 96,v,192,v,204
MV 100,v,192,v,208
MV 104,v,192,v,212
MV 100,v,196,v,204
MV 104,v,196,v,208
s_waitcnt lgkmcnt(15)
MV 104,v,200,v,204
MV 76,v,108,v,140
ds_read_b128 v[204:207], v5 offset:4032
MV 80,v,108,v,144
ds_read_b64 v[172:173], v4 offset:448
MV 84,v,108,v,148
ds_read_b64 v[174:175], v4 offset:456
s_waitcnt lgkmcnt(15)
MV 88,v,108,v,152
ds_read_b128 v[208:211], v5 offset:3520
s_waitcnt lgkmcnt(15)
MV 92,v,108,v,156
s_waitcnt lgkmcnt(12)
MV 96,v,108,v,160
ds_read_b64 v[176:177], v4 offset:960
s_waitcnt lgkmcnt(10)
MV 100,v,108,v,164
ds_read_b64 v[178:179], v4 offset:968
s_waitcnt lgkmcnt(8)
MV 104,v,108,v,168
ds_read_b128 v[212:215], v5 offset:3008
MV 80,v,112,v,140
ds_read_b64 v[180:181], v4 offset:1472
MV 84,v,112,v,144
MV 88,v,112,v,148
ds_read_b64 v[182:183], v4 offset:1480
MV 92,v,112,v,152
ds_read_b128 v[216:219], v5 offset:2496
MV 96,v,112,v,156
ds_read_b64 v[184:185], v4 offset:1984
MV 100,v,112,v,160
ds_read_b64 v[186:187], v4 offset:1992
MV 104,v,112,v,164
MV 84,v,116,v,140
ds_read_b128 v[220:223], v5 offset:1984
MV 88,v,116,v,144
ds_read_b64 v[188:189], v4 offset:2496
MV 92,v,116,v,148
ds_read_b64 v[190:191], v4 offset:2504
MV 96,v,116,v,152
ds_read_b128 v[224:227], v5 offset:1472
MV 100,v,116,v,156
MV 104,v,116,v,160
ds_read_b64 v[192:193], v4 offset:3008
MV 88,v,120,v,140
ds_read_b64 v[194:195], v4 offset:3016
MV 92,v,120,v,144
ds_read_b128 v[228:231], v5 offset:960
MV 96,v,120,v,148
ds_read_b64 v[196:197], v4 offset:3520
MV 100,v,120,v,152
MV 104,v,120,v,156
ds_read_b64 v[198:199], v4 offset:3528
MV 92,v,124,v,140
ds_read_b128 v[232:235], v5 offset:448
MV 96,v,124,v,144
ds_read_b64 v[200:201], v4 offset:4032
MV 100,v,124,v,148
ds_read_b64 v[202:203], v4 offset:4040
MV 104,v,124,v,152
MV 96,v,128,v,140
MV 100,v,128,v,144
MV 104,v,128,v,148
MV 100,v,132,v,140
MV 104,v,132,v,144
s_waitcnt lgkmcnt(15)
MV 104,v,136,v,140
buffer_load_dword v253, v254, s[8:11], 0 offen offset:2048 sc1
MV 76,v,172,v,204
MV 80,v,172,v,208
MV 84,v,172,v,212
s_waitcnt lgkmcnt(14)
MV 88,v,172,v,216
s_waitcnt lgkmcnt(11)
MV 92,v,172,v,220
s_waitcnt lgkmcnt(8)
MV 96,v,172,v,224
s_waitcnt lgkmcnt(5)
MV 100,v,172,v,228
s_waitcnt lgkmcnt(2)
MV 104,v,172,v,232
MV 80,v,176,v,204
MV 84,v,176,v,208
MV 88,v,176,v,212
MV 92,v,176,v,216
MV 96,v,176,v,220
MV 100,v,176,v,224
MV 104,v,176,v,228
MV 84,v,180,v,204
MV 88,v,180,v,208
MV 92,v,180,v,212
MV 96,v,180,v,216
MV 100,v,180,v,220
MV 104,v,180,v,224
MV 88,v,184,v,204
MV 92,v,184,v,208
MV 96,v,184,v,212
MV 100,v,184,v,216
MV 104,v,184,v,220
MV 92,v,188,v,204
MV 96,v,188,v,208
MV 100,v,188,v,212
MV 104,v,188,v,216
MV 96,v,192,v,204
MV 100,v,192,v,208
MV 104,v,192,v,212
MV 100,v,196,v,204
MV 104,v,196,v,208
s_waitcnt lgkmcnt(0)
MV 104,v,200,v,204
s_waitcnt vmcnt(0)
v_cmp_ne_u32 vcc, 1, v253
s_nop 4
s_cbranch_vccnz L_spin_f2
L_spin_f2_ret:
buffer_load_dwordx4 a[0:3], v236, s[44:47], s68 offen offset:0 sc1
buffer_load_dwordx4 a[4:7], v237, s[44:47], s68 offen offset:0 sc1
buffer_load_dwordx4 a[8:11], v236, s[44:47], s68 offen offset:1024 sc1
buffer_load_dwordx4 a[12:15], v237, s[44:47], s68 offen offset:1024 sc1
buffer_load_dwordx4 a[16:19], v236, s[44:47], s68 offen offset:2048 sc1
buffer_load_dwordx4 a[20:23], v237, s[44:47], s68 offen offset:2048 sc1
buffer_load_dwordx4 a[24:27], v236, s[44:47], s68 offen offset:3072 sc1
buffer_load_dwordx4 a[28:31], v237, s[44:47], s68 offen offset:3072 sc1
s_add_u32 s68, s68, 4096
buffer_load_dwordx4 a[32:35], v236, s[44:47], s68 offen offset:0 sc1
buffer_load_dwordx4 a[36:39], v237, s[44:47], s68 offen offset:0 sc1
buffer_load_dwordx4 a[40:43], v236, s[44:47], s68 offen offset:1024 sc1
buffer_load_dwordx4 a[44:47], v237, s[44:47], s68 offen offset:1024 sc1
buffer_load_dwordx4 a[48:51], v236, s[44:47], s68 offen offset:2048 sc1
buffer_load_dwordx4 a[52:55], v237, s[44:47], s68 offen offset:2048 sc1
buffer_load_dwordx4 a[56:59], v236, s[44:47], s68 offen offset:3072 sc1
buffer_load_dwordx4 a[60:63], v237, s[44:47], s68 offen offset:3072 sc1
s_add_u32 s68, s68, 4096
buffer_load_dwordx4 a[64:67], v236, s[44:47], s68 offen offset:0 sc1
buffer_load_dwordx4 a[68:71], v237, s[44:47], s68 offen offset:0 sc1
buffer_load_dwordx4 a[72:75], v236, s[44:47], s68 offen offset:1024 sc1
buffer_load_dwordx4 a[76:79], v237, s[44:47], s68 offen offset:1024 sc1
buffer_load_dwordx4 a[80:83], v236, s[44:47], s68 offen offset:2048 sc1
buffer_load_dwordx4 a[84:87], v237, s[44:47], s68 offen offset:2048 sc1
buffer_load_dwordx4 a[88:91], v236, s[44:47], s68 offen offset:3072 sc1
buffer_load_dwordx4 a[92:95], v237, s[44:47], s68 offen offset:3072 sc1
s_add_u32 s68, s68, 4096
buffer_load_dwordx4 a[96:99], v236, s[44:47], s68 offen offset:0 sc1
buffer_load_dwordx4 a[100:103], v237, s[44:47], s68 offen offset:0 sc1
buffer_load_dwordx4 a[104:107], v236, s[44:47], s68 offen offset:1024 sc1
buffer_load_dwordx4 a[108:111], v237, s[44:47], s68 offen offset:1024 sc1
buffer_load_dwordx4 a[112:115], v236, s[44:47], s68 offen offset:2048 sc1
buffer_load_dwordx4 a[116:119], v237, s[44:47], s68 offen offset:2048 sc1
buffer_load_dwordx4 a[120:123], v236, s[44:47], s68 offen offset:3072 sc1
buffer_load_dwordx4 a[124:127], v237, s[44:47], s68 offen offset:3072 sc1
s_add_u32 s68, s68, 4096
v_cvt_pk_bf16_f32 v12, v76, v77
v_cvt_pk_bf16_f32 v13, v78, v79
ds_write_b16 v7, v12 offset:0
ds_write_b16_d16_hi v7, v12 offset:8
ds_write_b16 v7, v13 offset:16
ds_write_b16_d16_hi v7, v13 offset:24
v_cvt_pk_bf16_f32 v14, v80, v81
v_cvt_pk_bf16_f32 v15, v82, v83
ds_write_b16 v7, v14 offset:2176
ds_write_b16_d16_hi v7, v14 offset:2184
ds_write_b16 v7, v15 offset:2192
ds_write_b16_d16_hi v7, v15 offset:2200
v_cvt_pk_bf16_f32 v12, v84, v85
v_cvt_pk_bf16_f32 v13, v86, v87
ds_write_b16 v7, v12 offset:4352
ds_write_b16_d16_hi v7, v12 offset:4360
ds_write_b16 v7, v13 offset:4368
ds_write_b16_d16_hi v7, v13 offset:4376
v_cvt_pk_bf16_f32 v14, v88, v89
v_cvt_pk_bf16_f32 v15, v90, v91
ds_write_b16 v7, v14 offset:6528
ds_write_b16_d16_hi v7, v14 offset:6536
ds_write_b16 v7, v15 offset:6544
ds_write_b16_d16_hi v7, v15 offset:6552
v_cvt_pk_bf16_f32 v12, v92, v93
v_cvt_pk_bf16_f32 v13, v94, v95
ds_write_b16 v7, v12 offset:8704
ds_write_b16_d16_hi v7, v12 offset:8712
ds_write_b16 v7, v13 offset:8720
ds_write_b16_d16_hi v7, v13 offset:8728
v_cvt_pk_bf16_f32 v14, v96, v97
v_cvt_pk_bf16_f32 v15, v98, v99
ds_write_b16 v7, v14 offset:10880
ds_write_b16_d16_hi v7, v14 offset:10888
ds_write_b16 v7, v15 offset:10896
ds_write_b16_d16_hi v7, v15 offset:10904
v_cvt_pk_bf16_f32 v12, v100, v101
v_cvt_pk_bf16_f32 v13, v102, v103
ds_write_b16 v7, v12 offset:13056
ds_write_b16_d16_hi v7, v12 offset:13064
ds_write_b16 v7, v13 offset:13072
ds_write_b16_d16_hi v7, v13 offset:13080
v_cvt_pk_bf16_f32 v14, v104, v105
v_cvt_pk_bf16_f32 v15, v106, v107
ds_write_b16 v7, v14 offset:15232
ds_write_b16_d16_hi v7, v14 offset:15240
ds_write_b16 v7, v15 offset:15248
ds_write_b16_d16_hi v7, v15 offset:15256
s_waitcnt lgkmcnt(0)
s_barrier
s_add_u32 m0, s70, 0
s_nop 0
buffer_load_dwordx4 v238, s[48:51], s69 offen offset:0 lds
buffer_load_dwordx4 v239, s[48:51], s69 offen offset:1024 lds
buffer_load_dwordx4 v240, s[48:51], s69 offen offset:2048 lds
buffer_load_dwordx4 v241, s[48:51], s69 offen offset:3072 lds
s_add_u32 s69, s69, 262144
s_add_u32 m0, s70, 16384
s_nop 0
buffer_load_dwordx4 v238, s[48:51], s69 offen offset:0 lds
buffer_load_dwordx4 v239, s[48:51], s69 offen offset:1024 lds
buffer_load_dwordx4 v240, s[48:51], s69 offen offset:2048 lds
buffer_load_dwordx4 v241, s[48:51], s69 offen offset:3072 lds
s_add_u32 s69, s69, 262144
ds_read_b64 v[108:109], v8 offset:0
ds_read_b64 v[110:111], v8 offset:8
ds_read_b64 v[112:113], v8 offset:1088
ds_read_b64 v[114:115], v8 offset:1096
ds_read_b64 v[116:117], v8 offset:2176
ds_read_b64 v[118:119], v8 offset:2184
ds_read_b64 v[120:121], v8 offset:3264
ds_read_b64 v[122:123], v8 offset:3272
s_waitcnt lgkmcnt(6)
buffer_store_dwordx4 v[108:111], v9, s[24:27], 0 offen offset:0 sc1
s_waitcnt lgkmcnt(4)
buffer_store_dwordx4 v[112:115], v9, s[24:27], 0 offen offset:1024 sc1
s_waitcnt lgkmcnt(2)
buffer_store_dwordx4 v[116:119], v9, s[24:27], 0 offen offset:2048 sc1
s_waitcnt lgkmcnt(0)
buffer_store_dwordx4 v[120:123], v9, s[24:27], 0 offen offset:3072 sc1
s_nop 0
s_barrier
TR 52,246,32768
TR 54,246,33792
TR 56,247,32768
TR 58,247,33792
TR 60,248,32768
TR 62,248,33792
TR 64,249,32768
TR 66,249,33792
s_waitcnt vmcnt(43) lgkmcnt(6)
v_mfma_f32_16x16x32_bf16 v[20:23], v[52:55], a[0:3], 0
TR 68,246,36864
TR 70,246,37888
s_waitcnt vmcnt(42)
v_mfma_f32_16x16x32_bf16 v[24:27], v[52:55], a[4:7], 0
TR 72,247,36864
s_waitcnt lgkmcnt(7)
v_mfma_f32_16x16x32_bf16 v[28:31], v[56:59], a[0:3], 0
TR 74,247,37888
s_add_u32 m0, s70, 32768
v_mfma_f32_16x16x32_bf16 v[32:35], v[56:59], a[4:7], 0
TR 76,248,36864
TR 78,248,37888
s_waitcnt lgkmcnt(8)
v_mfma_f32_16x16x32_bf16 v[36:39], v[60:63], a[0:3], 0
TR 80,249,36864
buffer_load_dwordx4 v238, s[48:51], s69 offen offset:0 lds
v_mfma_f32_16x16x32_bf16 v[40:43], v[60:63], a[4:7], 0
TR 82,249,37888
s_waitcnt lgkmcnt(8)
v_mfma_f32_16x16x32_bf16 v[44:47], v[64:67], a[0:3], 0
buffer_load_dwordx4 a[0:3], v236, s[44:47], s68 offen offset:0 sc1
v_mfma_f32_16x16x32_bf16 v[48:51], v[64:67], a[4:7], 0
buffer_load_dwordx4 a[4:7], v237, s[44:47], s68 offen offset:0 sc1
s_waitcnt vmcnt(44) lgkmcnt(6)
MV 20,v,68,a,8
TR 52,246,40960
TR 54,246,41984
s_waitcnt vmcnt(43)
MV 24,v,68,a,12
TR 56,247,40960
s_waitcnt lgkmcnt(7)
MV 28,v,72,a,8
TR 58,247,41984
MV 32,v,72,a,12
TR 60,248,40960
TR 62,248,41984
s_waitcnt lgkmcnt(8)
MV 36,v,76,a,8
TR 64,249,40960
buffer_load_dwordx4 v239, s[48:51], s69 offen offset:1024 lds
MV 40,v,76,a,12
TR 66,249,41984
s_waitcnt lgkmcnt(8)
MV 44,v,80,a,8
buffer_load_dwordx4 a[8:11], v236, s[44:47], s68 offen offset:1024 sc1
MV 48,v,80,a,12
buffer_load_dwordx4 a[12:15], v237, s[44:47], s68 offen offset:1024 sc1
s_waitcnt vmcnt(45) lgkmcnt(6)
MV 20,v,52,a,16
TR 68,246,45056
TR 70,246,46080
s_waitcnt vmcnt(44)
MV 24,v,52,a,20
TR 72,247,45056
s_waitcnt lgkmcnt(7)
MV 28,v,56,a,16
TR 74,247,46080
MV 32,v,56,a,20
TR 76,248,45056
TR 78,248,46080
s_waitcnt lgkmcnt(8)
MV 36,v,60,a,16
TR 80,249,45056
buffer_load_dwordx4 v240, s[48:51], s69 offen offset:2048 lds
MV 40,v,60,a,20
TR 82,249,46080
s_waitcnt lgkmcnt(8)
MV 44,v,64,a,16
buffer_load_dwordx4 a[16:19], v236, s[44:47], s68 offen offset:2048 sc1
MV 48,v,64,a,20
buffer_load_dwordx4 a[20:23], v237, s[44:47], s68 offen offset:2048 sc1
s_nop 0
s_barrier
s_waitcnt vmcnt(46) lgkmcnt(6)
MV 20,v,68,a,24
TR 52,246,49152
TR 54,246,50176
s_waitcnt vmcnt(45)
MV 24,v,68,a,28
TR 56,247,49152
s_waitcnt lgkmcnt(7)
MV 28,v,72,a,24
TR 58,247,50176
MV 32,v,72,a,28
TR 60,248,49152
TR 62,248,50176
s_waitcnt lgkmcnt(8)
MV 36,v,76,a,24
TR 64,249,49152
buffer_load_dwordx4 v241, s[48:51], s69 offen offset:3072 lds
MV 40,v,76,a,28
TR 66,249,50176
s_waitcnt lgkmcnt(8)
MV 44,v,80,a,24
buffer_load_dwordx4 a[24:27], v236, s[44:47], s68 offen offset:3072 sc1
MV 48,v,80,a,28
buffer_load_dwordx4 a[28:31], v237, s[44:47], s68 offen offset:3072 sc1
s_add_u32 s68, s68, 4096
s_add_u32 s69, s69, 262144
s_waitcnt vmcnt(47) lgkmcnt(6)
MV 20,v,52,a,32
TR 68,246,53248
TR 70,246,54272
s_waitcnt vmcnt(46)
MV 24,v,52,a,36
TR 72,247,53248
s_waitcnt lgkmcnt(7)
MV 28,v,56,a,32
TR 74,247,54272
s_add_u32 m0, s70, 49152
MV 32,v,56,a,36
TR 76,248,53248
TR 78,248,54272
s_waitcnt lgkmcnt(8)
MV 36,v,60,a,32
TR 80,249,53248
buffer_load_dwordx4 v238, s[48:51], s69 offen offset:0 lds
MV 40,v,60,a,36
TR 82,249,54272
s_waitcnt lgkmcnt(8)
MV 44,v,64,a,32
buffer_load_dwordx4 a[32:35], v236, s[44:47], s68 offen offset:0 sc1
MV 48,v,64,a,36
buffer_load_dwordx4 a[36:39], v237, s[44:47], s68 offen offset:0 sc1
s_waitcnt vmcnt(48) lgkmcnt(6)
MV 20,v,68,a,40
TR 52,246,57344
TR 54,246,58368
s_waitcnt vmcnt(47)
MV 24,v,68,a,44
TR 56,247,57344
s_waitcnt lgkmcnt(7)
MV 28,v,72,a,40
TR 58,247,58368
MV 32,v,72,a,44
TR 60,248,57344
TR 62,248,58368
s_waitcnt lgkmcnt(8)
MV 36,v,76,a,40
TR 64,249,57344
buffer_load_dwordx4 v239, s[48:51], s69 offen offset:1024 lds
MV 40,v,76,a,44
TR 66,249,58368
s_waitcnt lgkmcnt(8)
MV 44,v,80,a,40
buffer_load_dwordx4 a[40:43], v236, s[44:47], s68 offen offset:1024 sc1
MV 48,v,80,a,44
buffer_load_dwordx4 a[44:47], v237, s[44:47], s68 offen offset:1024 sc1
s_waitcnt vmcnt(49) lgkmcnt(6)
MV 20,v,52,a,48
TR 68,246,61440
TR 70,246,62464
s_waitcnt vmcnt(48)
MV 24,v,52,a,52
TR 72,247,61440
s_waitcnt lgkmcnt(7)
MV 28,v,56,a,48
TR 74,247,62464
MV 32,v,56,a,52
TR 76,248,61440
TR 78,248,62464
s_waitcnt lgkmcnt(8)
MV 36,v,60,a,48
TR 80,249,61440
buffer_load_dwordx4 v240, s[48:51], s69 offen offset:2048 lds
MV 40,v,60,a,52
TR 82,249,62464
s_waitcnt lgkmcnt(8)
MV 44,v,64,a,48
buffer_load_dwordx4 a[48:51], v236, s[44:47], s68 offen offset:2048 sc1
MV 48,v,64,a,52
buffer_load_dwordx4 a[52:55], v237, s[44:47], s68 offen offset:2048 sc1
s_waitcnt vmcnt(29)
s_barrier
s_waitcnt lgkmcnt(6)
MV 20,v,68,a,56
TR 52,242,0
TR 54,242,1024
MV 24,v,68,a,60
TR 56,243,0
s_waitcnt lgkmcnt(7)
MV 28,v,72,a,56
TR 58,243,1024
MV 32,v,72,a,60
TR 60,244,0
TR 62,244,1024
s_waitcnt lgkmcnt(8)
MV 36,v,76,a,56
TR 64,245,0
buffer_load_dwordx4 v241, s[48:51], s69 offen offset:3072 lds
MV 40,v,76,a,60
TR 66,245,1024
s_waitcnt lgkmcnt(8)
MV 44,v,80,a,56
buffer_load_dwordx4 a[56:59], v236, s[44:47], s68 offen offset:3072 sc1
MV 48,v,80,a,60
buffer_load_dwordx4 a[60:63], v237, s[44:47], s68 offen offset:3072 sc1
s_add_u32 s68, s68, 4096
s_add_u32 s69, s69, 262144
s_waitcnt lgkmcnt(6)
MV 20,v,52,a,64
TR 68,242,4096
TR 70,242,5120
MV 24,v,52,a,68
TR 72,243,4096
s_waitcnt lgkmcnt(7)
MV 28,v,56,a,64
TR 74,243,5120
s_add_u32 m0, s70, 65536
MV 32,v,56,a,68
TR 76,244,4096
TR 78,244,5120
s_waitcnt lgkmcnt(8)
MV 36,v,60,a,64
TR 80,245,4096
buffer_load_dwordx4 v238, s[48:51], s69 offen offset:0 lds
MV 40,v,60,a,68
TR 82,245,5120
s_waitcnt lgkmcnt(8)
MV 44,v,64,a,64
buffer_load_dwordx4 a[64:67], v236, s[44:47], s68 offen offset:0 sc1
MV 48,v,64,a,68
buffer_load_dwordx4 a[68:71], v237, s[44:47], s68 offen offset:0 sc1
s_waitcnt lgkmcnt(6)
MV 20,v,68,a,72
TR 52,242,8192
TR 54,242,9216
MV 24,v,68,a,76
TR 56,243,8192
s_waitcnt lgkmcnt(7)
MV 28,v,72,a,72
TR 58,243,9216
MV 32,v,72,a,76
TR 60,244,8192
TR 62,244,9216
s_waitcnt lgkmcnt(8)
MV 36,v,76,a,72
TR 64,245,8192
buffer_load_dwordx4 v239, s[48:51], s69 offen offset:1024 lds
MV 40,v,76,a,76
TR 66,245,9216
s_waitcnt lgkmcnt(8)
MV 44,v,80,a,72
buffer_load_dwordx4 a[72:75], v236, s[44:47], s68 offen offset:1024 sc1
MV 48,v,80,a,76
buffer_load_dwordx4 a[76:79], v237, s[44:47], s68 offen offset:1024 sc1
s_waitcnt lgkmcnt(6)
MV 20,v,52,a,80
TR 68,242,12288
TR 70,242,13312
MV 24,v,52,a,84
TR 72,243,12288
s_waitcnt lgkmcnt(7)
MV 28,v,56,a,80
TR 74,243,13312
MV 32,v,56,a,84
TR 76,244,12288
TR 78,244,13312
s_waitcnt lgkmcnt(8)
MV 36,v,60,a,80
TR 80,245,12288
buffer_load_dwordx4 v240, s[48:51], s69 offen offset:2048 lds
MV 40,v,60,a,84
TR 82,245,13312
s_waitcnt lgkmcnt(8)
MV 44,v,64,a,80
buffer_load_dwordx4 a[80:83], v236, s[44:47], s68 offen offset:2048 sc1
MV 48,v,64,a,84
buffer_load_dwordx4 a[84:87], v237, s[44:47], s68 offen offset:2048 sc1
s_waitcnt vmcnt(37)
s_barrier
s_waitcnt lgkmcnt(6)
MV 20,v,68,a,88
TR 52,242,16384
TR 54,242,17408
MV 24,v,68,a,92
TR 56,243,16384
s_waitcnt lgkmcnt(7)
MV 28,v,72,a,88
TR 58,243,17408
MV 32,v,72,a,92
TR 60,244,16384
TR 62,244,17408
s_waitcnt lgkmcnt(8)
MV 36,v,76,a,88
TR 64,245,16384
buffer_load_dwordx4 v241, s[48:51], s69 offen offset:3072 lds
MV 40,v,76,a,92
TR 66,245,17408
s_waitcnt lgkmcnt(8)
MV 44,v,80,a,88
buffer_load_dwordx4 a[88:91], v236, s[44:47], s68 offen offset:3072 sc1
MV 48,v,80,a,92
buffer_load_dwordx4 a[92:95], v237, s[44:47], s68 offen offset:3072 sc1
s_add_u32 s68, s68, 4096
s_add_u32 s69, s69, 262144
s_waitcnt lgkmcnt(6)
MV 20,v,52,a,96
TR 68,242,20480
TR 70,242,21504
MV 24,v,52,a,100
TR 72,243,20480
s_waitcnt lgkmcnt(7)
MV 28,v,56,a,96
TR 74,243,21504
s_add_u32 m0, s70, 81920
MV 32,v,56,a,100
TR 76,244,20480
TR 78,244,21504
s_waitcnt lgkmcnt(8)
MV 36,v,60,a,96
TR 80,245,20480
buffer_load_dwordx4 v238, s[48:51], s69 offen offset:0 lds
MV 40,v,60,a,100
TR 82,245,21504
s_waitcnt lgkmcnt(8)
MV 44,v,64,a,96
buffer_load_dwordx4 a[96:99], v236, s[44:47], s68 offen offset:0 sc1
MV 48,v,64,a,100
buffer_load_dwordx4 a[100:103], v237, s[44:47], s68 offen offset:0 sc1
s_waitcnt lgkmcnt(6)
MV 20,v,68,a,104
TR 52,242,24576
TR 54,242,25600
MV 24,v,68,a,108
TR 56,243,24576
s_waitcnt lgkmcnt(7)
MV 28,v,72,a,104
TR 58,243,25600
MV 32,v,72,a,108
TR 60,244,24576
TR 62,244,25600
s_waitcnt lgkmcnt(8)
MV 36,v,76,a,104
TR 64,245,24576
buffer_load_dwordx4 v239, s[48:51], s69 offen offset:1024 lds
MV 40,v,76,a,108
TR 66,245,25600
s_waitcnt lgkmcnt(8)
MV 44,v,80,a,104
buffer_load_dwordx4 a[104:107], v236, s[44:47], s68 offen offset:1024 sc1
MV 48,v,80,a,108
buffer_load_dwordx4 a[108:111], v237, s[44:47], s68 offen offset:1024 sc1
s_waitcnt lgkmcnt(6)
MV 20,v,52,a,112
TR 68,242,28672
TR 70,242,29696
MV 24,v,52,a,116
TR 72,243,28672
s_waitcnt lgkmcnt(7)
MV 28,v,56,a,112
TR 74,243,29696
MV 32,v,56,a,116
TR 76,244,28672
TR 78,244,29696
s_waitcnt lgkmcnt(8)
MV 36,v,60,a,112
TR 80,245,28672
buffer_load_dwordx4 v240, s[48:51], s69 offen offset:2048 lds
MV 40,v,60,a,116
TR 82,245,29696
s_waitcnt lgkmcnt(8)
MV 44,v,64,a,112
buffer_load_dwordx4 a[112:115], v236, s[44:47], s68 offen offset:2048 sc1
MV 48,v,64,a,116
buffer_load_dwordx4 a[116:119], v237, s[44:47], s68 offen offset:2048 sc1
s_waitcnt vmcnt(35)
s_barrier
v_mov_b32 v253, 1
s_lshl_b32 s36, s2, 2
buffer_store_dword v253, v255, s[8:11], s36 offen offset:3072 sc1
s_waitcnt lgkmcnt(6)
MV 20,v,68,a,120
TR 52,242,32768
TR 54,242,33792
MV 24,v,68,a,124
TR 56,243,32768
s_waitcnt lgkmcnt(7)
MV 28,v,72,a,120
TR 58,243,33792
MV 32,v,72,a,124
TR 60,244,32768
TR 62,244,33792
s_waitcnt lgkmcnt(8)
MV 36,v,76,a,120
TR 64,245,32768
buffer_load_dwordx4 v241, s[48:51], s69 offen offset:3072 lds
MV 40,v,76,a,124
TR 66,245,33792
s_waitcnt lgkmcnt(8)
MV 44,v,80,a,120
buffer_load_dwordx4 a[120:123], v236, s[44:47], s68 offen offset:3072 sc1
MV 48,v,80,a,124
buffer_load_dwordx4 a[124:127], v237, s[44:47], s68 offen offset:3072 sc1
s_add_u32 s68, s68, 4096
s_add_u32 s69, s69, 262144
s_waitcnt lgkmcnt(6)
MV 20,v,52,a,0
TR 68,242,36864
TR 70,242,37888
MV 24,v,52,a,4
TR 72,243,36864
s_waitcnt lgkmcnt(7)
MV 28,v,56,a,0
TR 74,243,37888
s_add_u32 m0, s70, 98304
MV 32,v,56,a,4
TR 76,244,36864
TR 78,244,37888
s_waitcnt lgkmcnt(8)
MV 36,v,60,a,0
TR 80,245,36864
buffer_load_dwordx4 v238, s[48:51], s69 offen offset:0 lds
MV 40,v,60,a,4
TR 82,245,37888
s_waitcnt lgkmcnt(8)
MV 44,v,64,a,0
buffer_load_dwordx4 a[0:3], v236, s[44:47], s68 offen offset:0 sc1
MV 48,v,64,a,4
buffer_load_dwordx4 a[4:7], v237, s[44:47], s68 offen offset:0 sc1
s_waitcnt lgkmcnt(6)
MV 20,v,68,a,8
TR 52,242,40960
TR 54,242,41984
MV 24,v,68,a,12
TR 56,243,40960
s_waitcnt lgkmcnt(7)
MV 28,v,72,a,8
TR 58,243,41984
MV 32,v,72,a,12
TR 60,244,40960
TR 62,244,41984
s_waitcnt lgkmcnt(8)
MV 36,v,76,a,8
TR 64,245,40960
buffer_load_dwordx4 v239, s[48:51], s69 offen offset:1024 lds
MV 40,v,76,a,12
TR 66,245,41984
s_waitcnt lgkmcnt(8)
MV 44,v,80,a,8
buffer_load_dwordx4 a[8:11], v236, s[44:47], s68 offen offset:1024 sc1
MV 48,v,80,a,12
buffer_load_dwordx4 a[12:15], v237, s[44:47], s68 offen offset:1024 sc1
s_waitcnt lgkmcnt(6)
MV 20,v,52,a,16
TR 68,242,45056
TR 70,242,46080
MV 24,v,52,a,20
TR 72,243,45056
s_waitcnt lgkmcnt(7)
MV 28,v,56,a,16
TR 74,243,46080
MV 32,v,56,a,20
TR 76,244,45056
TR 78,244,46080
s_waitcnt lgkmcnt(8)
MV 36,v,60,a,16
TR 80,245,45056
buffer_load_dwordx4 v240, s[48:51], s69 offen offset:2048 lds
MV 40,v,60,a,20
TR 82,245,46080
s_waitcnt lgkmcnt(8)
MV 44,v,64,a,16
buffer_load_dwordx4 a[16:19], v236, s[44:47], s68 offen offset:2048 sc1
MV 48,v,64,a,20
buffer_load_dwordx4 a[20:23], v237, s[44:47], s68 offen offset:2048 sc1
s_waitcnt vmcnt(36)
s_barrier
s_waitcnt lgkmcnt(6)
MV 20,v,68,a,24
TR 52,242,49152
TR 54,242,50176
MV 24,v,68,a,28
TR 56,243,49152
s_waitcnt lgkmcnt(7)
MV 28,v,72,a,24
TR 58,243,50176
MV 32,v,72,a,28
TR 60,244,49152
TR 62,244,50176
s_waitcnt lgkmcnt(8)
MV 36,v,76,a,24
TR 64,245,49152
buffer_load_dwordx4 v241, s[48:51], s69 offen offset:3072 lds
MV 40,v,76,a,28
TR 66,245,50176
s_waitcnt lgkmcnt(8)
MV 44,v,80,a,24
buffer_load_dwordx4 a[24:27], v236, s[44:47], s68 offen offset:3072 sc1
MV 48,v,80,a,28
buffer_load_dwordx4 a[28:31], v237, s[44:47], s68 offen offset:3072 sc1
s_add_u32 s68, s68, 4096
s_add_u32 s69, s69, 262144
s_waitcnt lgkmcnt(6)
MV 20,v,52,a,32
TR 68,242,53248
TR 70,242,54272
MV 24,v,52,a,36
TR 72,243,53248
s_waitcnt lgkmcnt(7)
MV 28,v,56,a,32
TR 74,243,54272
s_add_u32 m0, s70, 114688
MV 32,v,56,a,36
TR 76,244,53248
TR 78,244,54272
s_waitcnt lgkmcnt(8)
MV 36,v,60,a,32
TR 80,245,53248
buffer_load_dwordx4 v238, s[48:51], s69 offen offset:0 lds
MV 40,v,60,a,36
TR 82,245,54272
s_waitcnt lgkmcnt(8)
MV 44,v,64,a,32
buffer_load_dwordx4 a[32:35], v236, s[44:47], s68 offen offset:0 sc1
MV 48,v,64,a,36
buffer_load_dwordx4 a[36:39], v237, s[44:47], s68 offen offset:0 sc1
s_waitcnt lgkmcnt(6)
MV 20,v,68,a,40
TR 52,242,57344
TR 54,242,58368
MV 24,v,68,a,44
TR 56,243,57344
s_waitcnt lgkmcnt(7)
MV 28,v,72,a,40
TR 58,243,58368
MV 32,v,72,a,44
TR 60,244,57344
TR 62,244,58368
s_waitcnt lgkmcnt(8)
MV 36,v,76,a,40
TR 64,245,57344
buffer_load_dwordx4 v239, s[48:51], s69 offen offset:1024 lds
MV 40,v,76,a,44
TR 66,245,58368
s_waitcnt lgkmcnt(8)
MV 44,v,80,a,40
buffer_load_dwordx4 a[40:43], v236, s[44:47], s68 offen offset:1024 sc1
MV 48,v,80,a,44
buffer_load_dwordx4 a[44:47], v237, s[44:47], s68 offen offset:1024 sc1
s_waitcnt lgkmcnt(6)
MV 20,v,52,a,48
TR 68,242,61440
TR 70,242,62464
MV 24,v,52,a,52
TR 72,243,61440
s_waitcnt lgkmcnt(7)
MV 28,v,56,a,48
TR 74,243,62464
MV 32,v,56,a,52
TR 76,244,61440
TR 78,244,62464
s_waitcnt lgkmcnt(8)
MV 36,v,60,a,48
TR 80,245,61440
buffer_load_dwordx4 v240, s[48:51], s69 offen offset:2048 lds
MV 40,v,60,a,52
TR 82,245,62464
s_waitcnt lgkmcnt(8)
MV 44,v,64,a,48
buffer_load_dwordx4 a[48:51], v236, s[44:47], s68 offen offset:2048 sc1
MV 48,v,64,a,52
buffer_load_dwordx4 a[52:55], v237, s[44:47], s68 offen offset:2048 sc1
s_waitcnt vmcnt(36)
s_barrier
s_waitcnt lgkmcnt(6)
MV 20,v,68,a,56
TR 52,246,0
TR 54,246,1024
MV 24,v,68,a,60
TR 56,247,0
s_waitcnt lgkmcnt(7)
MV 28,v,72,a,56
TR 58,247,1024
MV 32,v,72,a,60
TR 60,248,0
TR 62,248,1024
s_waitcnt lgkmcnt(8)
MV 36,v,76,a,56
TR 64,249,0
buffer_load_dwordx4 v241, s[48:51], s69 offen offset:3072 lds
MV 40,v,76,a,60
TR 66,249,1024
s_waitcnt lgkmcnt(8)
MV 44,v,80,a,56
buffer_load_dwordx4 a[56:59], v236, s[44:47], s68 offen offset:3072 sc1
MV 48,v,80,a,60
buffer_load_dwordx4 a[60:63], v237, s[44:47], s68 offen offset:3072 sc1
s_add_u32 s68, s68, 4096
s_add_u32 s69, s69, 262144
s_waitcnt lgkmcnt(6)
MV 20,v,52,a,64
TR 68,246,4096
TR 70,246,5120
s_add_u32 s72, s78, 0
buffer_load_dwordx4 v[84:87], v250, s[52:55], s72 offen offset:0
buffer_load_dwordx4 v[88:91], v250, s[52:55], s72 offen offset:64
MV 24,v,52,a,68
TR 72,247,4096
s_waitcnt lgkmcnt(7)
MV 28,v,56,a,64
TR 74,247,5120
s_add_u32 m0, s70, 0
MV 32,v,56,a,68
TR 76,248,4096
TR 78,248,5120
s_waitcnt lgkmcnt(8)
MV 36,v,60,a,64
TR 80,249,4096
buffer_load_dwordx4 v238, s[48:51], s69 offen offset:0 lds
MV 40,v,60,a,68
TR 82,249,5120
s_waitcnt lgkmcnt(8)
MV 44,v,64,a,64
buffer_load_dwordx4 a[64:67], v236, s[44:47], s68 offen offset:0 sc1
MV 48,v,64,a,68
buffer_load_dwordx4 a[68:71], v237, s[44:47], s68 offen offset:0 sc1
s_waitcnt lgkmcnt(6)
MV 20,v,68,a,72
TR 52,246,8192
TR 54,246,9216
buffer_load_dword v116, v252, s[64:67], s80 offen offset:0 sc1
MV 24,v,68,a,76
TR 56,247,8192
s_waitcnt lgkmcnt(7)
MV 28,v,72,a,72
TR 58,247,9216
MV 32,v,72,a,76
TR 60,248,8192
TR 62,248,9216
s_waitcnt lgkmcnt(8)
MV 36,v,76,a,72
TR 64,249,8192
buffer_load_dwordx4 v239, s[48:51], s69 offen offset:1024 lds
MV 40,v,76,a,76
TR 66,249,9216
s_waitcnt lgkmcnt(8)
MV 44,v,80,a,72
buffer_load_dwordx4 a[72:75], v236, s[44:47], s68 offen offset:1024 sc1
MV 48,v,80,a,76
buffer_load_dwordx4 a[76:79], v237, s[44:47], s68 offen offset:1024 sc1
s_waitcnt lgkmcnt(6)
MV 20,v,52,a,80
TR 68,246,12288
TR 70,246,13312
s_add_u32 s72, s78, 32768
buffer_load_dwordx4 v[92:95], v250, s[52:55], s72 offen offset:0
buffer_load_dwordx4 v[96:99], v250, s[52:55], s72 offen offset:64
MV 24,v,52,a,84
TR 72,247,12288
s_waitcnt lgkmcnt(7)
MV 28,v,56,a,80
TR 74,247,13312
MV 32,v,56,a,84
TR 76,248,12288
TR 78,248,13312
s_waitcnt lgkmcnt(8)
MV 36,v,60,a,80
TR 80,249,12288
buffer_load_dwordx4 v240, s[48:51], s69 offen offset:2048 lds
MV 40,v,60,a,84
TR 82,249,13312
s_waitcnt lgkmcnt(8)
MV 44,v,64,a,80
buffer_load_dwordx4 a[80:83], v236, s[44:47], s68 offen offset:2048 sc1
MV 48,v,64,a,84
buffer_load_dwordx4 a[84:87], v237, s[44:47], s68 offen offset:2048 sc1
s_waitcnt vmcnt(40)
s_barrier
s_waitcnt lgkmcnt(6)
MV 20,v,68,a,88
TR 52,246,16384
TR 54,246,17408
buffer_load_dword v117, v252, s[64:67], s80 offen offset:64 sc1
MV 24,v,68,a,92
TR 56,247,16384
s_waitcnt lgkmcnt(7)
MV 28,v,72,a,88
TR 58,247,17408
MV 32,v,72,a,92
TR 60,248,16384
TR 62,248,17408
s_waitcnt lgkmcnt(8)
MV 36,v,76,a,88
TR 64,249,16384
buffer_load_dwordx4 v241, s[48:51], s69 offen offset:3072 lds
MV 40,v,76,a,92
TR 66,249,17408
s_waitcnt lgkmcnt(8)
MV 44,v,80,a,88
buffer_load_dwordx4 a[88:91], v236, s[44:47], s68 offen offset:3072 sc1
MV 48,v,80,a,92
buffer_load_dwordx4 a[92:95], v237, s[44:47], s68 offen offset:3072 sc1
s_add_u32 s68, s68, 4096
s_add_u32 s69, s69, 262144
s_waitcnt lgkmcnt(6)
MV 20,v,52,a,96
TR 68,246,20480
TR 70,246,21504
MV 24,v,52,a,100
TR 72,247,20480
s_waitcnt lgkmcnt(7)
MV 28,v,56,a,96
TR 74,247,21504
s_add_u32 m0, s70, 16384
MV 32,v,56,a,100
TR 76,248,20480
TR 78,248,21504
s_waitcnt lgkmcnt(8)
MV 36,v,60,a,96
TR 80,249,20480
buffer_load_dwordx4 v238, s[48:51], s69 offen offset:0 lds
MV 40,v,60,a,100
TR 82,249,21504
s_waitcnt lgkmcnt(8)
MV 44,v,64,a,96
buffer_load_dwordx4 a[96:99], v236, s[44:47], s68 offen offset:0 sc1
MV 48,v,64,a,100
buffer_load_dwordx4 a[100:103], v237, s[44:47], s68 offen offset:0 sc1
s_waitcnt lgkmcnt(6)
MV 20,v,68,a,104
TR 52,246,24576
TR 54,246,25600
MV 24,v,68,a,108
TR 56,247,24576
s_waitcnt lgkmcnt(7)
MV 28,v,72,a,104
TR 58,247,25600
MV 32,v,72,a,108
TR 60,248,24576
TR 62,248,25600
s_waitcnt lgkmcnt(8)
MV 36,v,76,a,104
TR 64,249,24576
buffer_load_dwordx4 v239, s[48:51], s69 offen offset:1024 lds
MV 40,v,76,a,108
TR 66,249,25600
s_waitcnt lgkmcnt(8)
MV 44,v,80,a,104
buffer_load_dwordx4 a[104:107], v236, s[44:47], s68 offen offset:1024 sc1
MV 48,v,80,a,108
buffer_load_dwordx4 a[108:111], v237, s[44:47], s68 offen offset:1024 sc1
s_waitcnt lgkmcnt(6)
MV 20,v,52,a,112
TR 68,246,28672
TR 70,246,29696
MV 24,v,52,a,116
TR 72,247,28672
s_waitcnt lgkmcnt(7)
MV 28,v,56,a,112
TR 74,247,29696
MV 32,v,56,a,116
TR 76,248,28672
TR 78,248,29696
s_waitcnt lgkmcnt(8)
MV 36,v,60,a,112
TR 80,249,28672
buffer_load_dwordx4 v240, s[48:51], s69 offen offset:2048 lds
MV 40,v,60,a,116
TR 82,249,29696
s_waitcnt lgkmcnt(8)
MV 44,v,64,a,112
buffer_load_dwordx4 a[112:115], v236, s[44:47], s68 offen offset:2048 sc1
MV 48,v,64,a,116
buffer_load_dwordx4 a[116:119], v237, s[44:47], s68 offen offset:2048 sc1
s_waitcnt vmcnt(41)
s_barrier
s_waitcnt lgkmcnt(6)
MV 20,v,68,a,120
TR 52,246,32768
TR 54,246,33792
MV 24,v,68,a,124
TR 56,247,32768
s_waitcnt lgkmcnt(7)
MV 28,v,72,a,120
TR 58,247,33792
MV 32,v,72,a,124
TR 60,248,32768
TR 62,248,33792
s_waitcnt lgkmcnt(8)
MV 36,v,76,a,120
TR 64,249,32768
buffer_load_dwordx4 v241, s[48:51], s69 offen offset:3072 lds
MV 40,v,76,a,124
TR 66,249,33792
s_waitcnt lgkmcnt(8)
MV 44,v,80,a,120
buffer_load_dwordx4 a[120:123], v236, s[44:47], s68 offen offset:3072 sc1
MV 48,v,80,a,124
buffer_load_dwordx4 a[124:127], v237, s[44:47], s68 offen offset:3072 sc1
s_add_u32 s68, s68, 4096
s_add_u32 s69, s69, 262144
s_waitcnt lgkmcnt(6)
MV 20,v,52,a,0
TR 68,246,36864
TR 70,246,37888
MV 24,v,52,a,4
TR 72,247,36864
s_waitcnt lgkmcnt(7)
MV 28,v,56,a,0
TR 74,247,37888
s_add_u32 m0, s70, 32768
MV 32,v,56,a,4
TR 76,248,36864
TR 78,248,37888
s_waitcnt lgkmcnt(8)
MV 36,v,60,a,0
TR 80,249,36864
buffer_load_dwordx4 v238, s[48:51], s69 offen offset:0 lds
MV 40,v,60,a,4
TR 82,249,37888
s_waitcnt lgkmcnt(8)
MV 44,v,64,a,0
buffer_load_dwordx4 a[0:3], v236, s[44:47], s68 offen offset:0 sc1
MV 48,v,64,a,4
buffer_load_dwordx4 a[4:7], v237, s[44:47], s68 offen offset:0 sc1
s_waitcnt lgkmcnt(6)
MV 20,v,68,a,8
TR 52,246,40960
TR 54,246,41984
MV 24,v,68,a,12
TR 56,247,40960
s_waitcnt lgkmcnt(7)
MV 28,v,72,a,8
TR 58,247,41984
MV 32,v,72,a,12
TR 60,248,40960
TR 62,248,41984
s_waitcnt lgkmcnt(8)
MV 36,v,76,a,8
TR 64,249,40960
buffer_load_dwordx4 v239, s[48:51], s69 offen offset:1024 lds
MV 40,v,76,a,12
TR 66,249,41984
s_waitcnt lgkmcnt(8)
MV 44,v,80,a,8
buffer_load_dwordx4 a[8:11], v236, s[44:47], s68 offen offset:1024 sc1
MV 48,v,80,a,12
buffer_load_dwordx4 a[12:15], v237, s[44:47], s68 offen offset:1024 sc1
s_waitcnt lgkmcnt(6)
MV 20,v,52,a,16
TR 68,246,45056
TR 70,246,46080
MV 24,v,52,a,20
TR 72,247,45056
s_waitcnt lgkmcnt(7)
MV 28,v,56,a,16
TR 74,247,46080
MV 32,v,56,a,20
TR 76,248,45056
TR 78,248,46080
s_waitcnt lgkmcnt(8)
MV 36,v,60,a,16
TR 80,249,45056
buffer_load_dwordx4 v240, s[48:51], s69 offen offset:2048 lds
MV 40,v,60,a,20
TR 82,249,46080
s_waitcnt lgkmcnt(8)
MV 44,v,64,a,16
buffer_load_dwordx4 a[16:19], v236, s[44:47], s68 offen offset:2048 sc1
MV 48,v,64,a,20
buffer_load_dwordx4 a[20:23], v237, s[44:47], s68 offen offset:2048 sc1
s_waitcnt vmcnt(41)
s_barrier
s_waitcnt lgkmcnt(6)
MV 20,v,68,a,24
TR 52,246,49152
TR 54,246,50176
MV 24,v,68,a,28
TR 56,247,49152
s_waitcnt lgkmcnt(7)
MV 28,v,72,a,24
TR 58,247,50176
MV 32,v,72,a,28
TR 60,248,49152
TR 62,248,50176
s_waitcnt lgkmcnt(8)
MV 36,v,76,a,24
TR 64,249,49152
buffer_load_dwordx4 v241, s[48:51], s69 offen offset:3072 lds
MV 40,v,76,a,28
TR 66,249,50176
s_waitcnt lgkmcnt(8)
MV 44,v,80,a,24
buffer_load_dwordx4 a[24:27], v236, s[44:47], s68 offen offset:3072 sc1
MV 48,v,80,a,28
buffer_load_dwordx4 a[28:31], v237, s[44:47], s68 offen offset:3072 sc1
s_add_u32 s68, s68, 4096
s_add_u32 s69, s69, 262144
s_waitcnt lgkmcnt(6)
MV 20,v,52,a,32
TR 68,246,53248
TR 70,246,54272
MV 24,v,52,a,36
TR 72,247,53248
s_waitcnt lgkmcnt(7)
MV 28,v,56,a,32
TR 74,247,54272
s_add_u32 m0, s70, 49152
MV 32,v,56,a,36
TR 76,248,53248
TR 78,248,54272
s_waitcnt lgkmcnt(8)
MV 36,v,60,a,32
TR 80,249,53248
buffer_load_dwordx4 v238, s[48:51], s69 offen offset:0 lds
MV 40,v,60,a,36
TR 82,249,54272
s_waitcnt lgkmcnt(8)
MV 44,v,64,a,32
buffer_load_dwordx4 a[32:35], v236, s[44:47], s68 offen offset:0 sc1
MV 48,v,64,a,36
buffer_load_dwordx4 a[36:39], v237, s[44:47], s68 offen offset:0 sc1
s_waitcnt lgkmcnt(6)
MV 20,v,68,a,40
TR 52,246,57344
TR 54,246,58368
MV 24,v,68,a,44
TR 56,247,57344
s_waitcnt lgkmcnt(7)
MV 28,v,72,a,40
TR 58,247,58368
MV 32,v,72,a,44
TR 60,248,57344
TR 62,248,58368
s_waitcnt lgkmcnt(8)
MV 36,v,76,a,40
TR 64,249,57344
buffer_load_dwordx4 v239, s[48:51], s69 offen offset:1024 lds
MV 40,v,76,a,44
TR 66,249,58368
s_waitcnt lgkmcnt(8)
MV 44,v,80,a,40
buffer_load_dwordx4 a[40:43], v236, s[44:47], s68 offen offset:1024 sc1
MV 48,v,80,a,44
buffer_load_dwordx4 a[44:47], v237, s[44:47], s68 offen offset:1024 sc1
s_waitcnt lgkmcnt(6)
MV 20,v,52,a,48
TR 68,246,61440
TR 70,246,62464
MV 24,v,52,a,52
TR 72,247,61440
s_waitcnt lgkmcnt(7)
MV 28,v,56,a,48
TR 74,247,62464
MV 32,v,56,a,52
TR 76,248,61440
TR 78,248,62464
s_waitcnt lgkmcnt(8)
MV 36,v,60,a,48
TR 80,249,61440
buffer_load_dwordx4 v240, s[48:51], s69 offen offset:2048 lds
MV 40,v,60,a,52
TR 82,249,62464
s_waitcnt lgkmcnt(8)
MV 44,v,64,a,48
buffer_load_dwordx4 a[48:51], v236, s[44:47], s68 offen offset:2048 sc1
MV 48,v,64,a,52
buffer_load_dwordx4 a[52:55], v237, s[44:47], s68 offen offset:2048 sc1
s_waitcnt vmcnt(35)
s_barrier
s_waitcnt lgkmcnt(6)
MV 20,v,68,a,56
TR 52,242,0
TR 54,242,1024
MV 24,v,68,a,60
TR 56,243,0
s_waitcnt lgkmcnt(7)
MV 28,v,72,a,56
TR 58,243,1024
MV 32,v,72,a,60
TR 60,244,0
TR 62,244,1024
s_waitcnt lgkmcnt(8)
MV 36,v,76,a,56
TR 64,245,0
buffer_load_dwordx4 v241, s[48:51], s69 offen offset:3072 lds
MV 40,v,76,a,60
TR 66,245,1024
s_waitcnt lgkmcnt(8)
MV 44,v,80,a,56
buffer_load_dwordx4 a[56:59], v236, s[44:47], s68 offen offset:3072 sc1
MV 48,v,80,a,60
buffer_load_dwordx4 a[60:63], v237, s[44:47], s68 offen offset:3072 sc1
s_add_u32 s68, s68, 4096
s_add_u32 s69, s69, 262144
s_waitcnt lgkmcnt(6)
MV 20,v,52,a,64
TR 68,242,4096
TR 70,242,5120
MV 24,v,52,a,68
TR 72,243,4096
s_waitcnt lgkmcnt(7)
MV 28,v,56,a,64
TR 74,243,5120
s_add_u32 m0, s70, 65536
MV 32,v,56,a,68
TR 76,244,4096
TR 78,244,5120
s_waitcnt lgkmcnt(8)
MV 36,v,60,a,64
TR 80,245,4096
buffer_load_dwordx4 v238, s[48:51], s69 offen offset:0 lds
MV 40,v,60,a,68
TR 82,245,5120
s_waitcnt lgkmcnt(8)
MV 44,v,64,a,64
buffer_load_dwordx4 a[64:67], v236, s[44:47], s68 offen offset:0 sc1
MV 48,v,64,a,68
buffer_load_dwordx4 a[68:71], v237, s[44:47], s68 offen offset:0 sc1
s_waitcnt lgkmcnt(6)
MV 20,v,68,a,72
TR 52,242,8192
TR 54,242,9216
MV 24,v,68,a,76
TR 56,243,8192
s_waitcnt lgkmcnt(7)
MV 28,v,72,a,72
TR 58,243,9216
MV 32,v,72,a,76
TR 60,244,8192
TR 62,244,9216
s_waitcnt lgkmcnt(8)
MV 36,v,76,a,72
TR 64,245,8192
buffer_load_dwordx4 v239, s[48:51], s69 offen offset:1024 lds
MV 40,v,76,a,76
TR 66,245,9216
s_waitcnt lgkmcnt(8)
MV 44,v,80,a,72
buffer_load_dwordx4 a[72:75], v236, s[44:47], s68 offen offset:1024 sc1
MV 48,v,80,a,76
buffer_load_dwordx4 a[76:79], v237, s[44:47], s68 offen offset:1024 sc1
s_waitcnt lgkmcnt(6)
MV 20,v,52,a,80
TR 68,242,12288
TR 70,242,13312
MV 24,v,52,a,84
TR 72,243,12288
s_waitcnt lgkmcnt(7)
MV 28,v,56,a,80
TR 74,243,13312
MV 32,v,56,a,84
TR 76,244,12288
TR 78,244,13312
s_waitcnt lgkmcnt(8)
MV 36,v,60,a,80
TR 80,245,12288
buffer_load_dwordx4 v240, s[48:51], s69 offen offset:2048 lds
MV 40,v,60,a,84
TR 82,245,13312
s_waitcnt lgkmcnt(8)
MV 44,v,64,a,80
buffer_load_dwordx4 a[80:83], v236, s[44:47], s68 offen offset:2048 sc1
MV 48,v,64,a,84
buffer_load_dwordx4 a[84:87], v237, s[44:47], s68 offen offset:2048 sc1
s_waitcnt vmcnt(35)
s_barrier
s_waitcnt lgkmcnt(6)
MV 20,v,68,a,88
TR 52,242,16384
TR 54,242,17408
MV 24,v,68,a,92
TR 56,243,16384
s_waitcnt lgkmcnt(7)
MV 28,v,72,a,88
TR 58,243,17408
MV 32,v,72,a,92
TR 60,244,16384
TR 62,244,17408
s_waitcnt lgkmcnt(8)
MV 36,v,76,a,88
TR 64,245,16384
buffer_load_dwordx4 v241, s[48:51], s69 offen offset:3072 lds
MV 40,v,76,a,92
TR 66,245,17408
s_waitcnt lgkmcnt(8)
MV 44,v,80,a,88
buffer_load_dwordx4 a[88:91], v236, s[44:47], s68 offen offset:3072 sc1
MV 48,v,80,a,92
buffer_load_dwordx4 a[92:95], v237, s[44:47], s68 offen offset:3072 sc1
s_add_u32 s68, s68, 4096
s_add_u32 s69, s69, 262144
s_waitcnt lgkmcnt(6)
MV 20,v,52,a,96
TR 68,242,20480
TR 70,242,21504
v_and_b32 v254, 15, v1
MV 24,v,52,a,100
TR 72,243,20480
s_waitcnt lgkmcnt(7)
MV 28,v,56,a,96
TR 74,243,21504
s_add_u32 m0, s70, 81920
s_lshl_b32 s36, s82, 4
MV 32,v,56,a,100
TR 76,244,20480
TR 78,244,21504
s_waitcnt lgkmcnt(8)
MV 36,v,60,a,96
TR 80,245,20480
buffer_load_dwordx4 v238, s[48:51], s69 offen offset:0 lds
v_add_u32 v254, s36, v254
MV 40,v,60,a,100
TR 82,245,21504
s_waitcnt lgkmcnt(8)
MV 44,v,64,a,96
buffer_load_dwordx4 a[96:99], v236, s[44:47], s68 offen offset:0 sc1
v_lshlrev_b32 v254, 2, v254
MV 48,v,64,a,100
buffer_load_dwordx4 a[100:103], v237, s[44:47], s68 offen offset:0 sc1
s_waitcnt lgkmcnt(6)
MV 20,v,68,a,104
TR 52,242,24576
TR 54,242,25600
buffer_load_dword v253, v254, s[8:11], 0 offen offset:3072 sc1
MV 24,v,68,a,108
TR 56,243,24576
s_waitcnt lgkmcnt(7)
MV 28,v,72,a,104
TR 58,243,25600
MV 32,v,72,a,108
TR 60,244,24576
TR 62,244,25600
s_waitcnt lgkmcnt(8)
MV 36,v,76,a,104
TR 64,245,24576
buffer_load_dwordx4 v239, s[48:51], s69 offen offset:1024 lds
MV 40,v,76,a,108
TR 66,245,25600
s_waitcnt lgkmcnt(8)
MV 44,v,80,a,104
buffer_load_dwordx4 a[104:107], v236, s[44:47], s68 offen offset:1024 sc1
MV 48,v,80,a,108
buffer_load_dwordx4 a[108:111], v237, s[44:47], s68 offen offset:1024 sc1
s_waitcnt lgkmcnt(6)
MV 20,v,52,a,112
TR 68,242,28672
TR 70,242,29696
MV 24,v,52,a,116
TR 72,243,28672
s_waitcnt lgkmcnt(7)
MV 28,v,56,a,112
TR 74,243,29696
MV 32,v,56,a,116
TR 76,244,28672
TR 78,244,29696
s_waitcnt lgkmcnt(8)
MV 36,v,60,a,112
TR 80,245,28672
buffer_load_dwordx4 v240, s[48:51], s69 offen offset:2048 lds
MV 40,v,60,a,116
TR 82,245,29696
s_waitcnt lgkmcnt(8)
MV 44,v,64,a,112
buffer_load_dwordx4 a[112:115], v236, s[44:47], s68 offen offset:2048 sc1
MV 48,v,64,a,116
buffer_load_dwordx4 a[116:119], v237, s[44:47], s68 offen offset:2048 sc1
s_waitcnt vmcnt(36)
s_barrier
s_waitcnt lgkmcnt(6)
MV 20,v,68,a,120
TR 52,242,32768
TR 54,242,33792
MV 24,v,68,a,124
TR 56,243,32768
s_waitcnt lgkmcnt(7)
MV 28,v,72,a,120
TR 58,243,33792
MV 32,v,72,a,124
TR 60,244,32768
TR 62,244,33792
s_waitcnt lgkmcnt(8)
MV 36,v,76,a,120
TR 64,245,32768
buffer_load_dwordx4 v241, s[48:51], s69 offen offset:3072 lds
MV 40,v,76,a,124
TR 66,245,33792
s_waitcnt lgkmcnt(8)
MV 44,v,80,a,120
buffer_load_dwordx4 a[120:123], v236, s[44:47], s68 offen offset:3072 sc1
MV 48,v,80,a,124
buffer_load_dwordx4 a[124:127], v237, s[44:47], s68 offen offset:3072 sc1
s_add_u32 s68, s68, 4096
s_add_u32 s69, s69, 262144
s_waitcnt lgkmcnt(6)
MV 20,v,52,a,0
TR 68,242,36864
TR 70,242,37888
MV 24,v,52,a,4
TR 72,243,36864
s_waitcnt lgkmcnt(7)
MV 28,v,56,a,0
TR 74,243,37888
s_add_u32 m0, s70, 98304
MV 32,v,56,a,4
TR 76,244,36864
TR 78,244,37888
s_waitcnt lgkmcnt(8)
MV 36,v,60,a,0
TR 80,245,36864
buffer_load_dwordx4 v238, s[48:51], s69 offen offset:0 lds
MV 40,v,60,a,4
TR 82,245,37888
s_waitcnt lgkmcnt(8)
MV 44,v,64,a,0
buffer_load_dwordx4 a[0:3], v236, s[44:47], s68 offen offset:0 sc1
MV 48,v,64,a,4
buffer_load_dwordx4 a[4:7], v237, s[44:47], s68 offen offset:0 sc1
s_waitcnt lgkmcnt(6)
MV 20,v,68,a,8
TR 52,242,40960
TR 54,242,41984
MV 24,v,68,a,12
TR 56,243,40960
s_waitcnt lgkmcnt(7)
MV 28,v,72,a,8
TR 58,243,41984
MV 32,v,72,a,12
TR 60,244,40960
TR 62,244,41984
s_waitcnt lgkmcnt(8)
MV 36,v,76,a,8
TR 64,245,40960
buffer_load_dwordx4 v239, s[48:51], s69 offen offset:1024 lds
MV 40,v,76,a,12
TR 66,245,41984
s_waitcnt lgkmcnt(8)
MV 44,v,80,a,8
buffer_load_dwordx4 a[8:11], v236, s[44:47], s68 offen offset:1024 sc1
MV 48,v,80,a,12
buffer_load_dwordx4 a[12:15], v237, s[44:47], s68 offen offset:1024 sc1
s_waitcnt lgkmcnt(6)
MV 20,v,52,a,16
TR 68,242,45056
TR 70,242,46080
MV 24,v,52,a,20
TR 72,243,45056
s_waitcnt lgkmcnt(7)
MV 28,v,56,a,16
TR 74,243,46080
MV 32,v,56,a,20
TR 76,244,45056
TR 78,244,46080
s_waitcnt lgkmcnt(8)
MV 36,v,60,a,16
TR 80,245,45056
buffer_load_dwordx4 v240, s[48:51], s69 offen offset:2048 lds
MV 40,v,60,a,20
TR 82,245,46080
s_waitcnt lgkmcnt(8)
MV 44,v,64,a,16
buffer_load_dwordx4 a[16:19], v236, s[44:47], s68 offen offset:2048 sc1
MV 48,v,64,a,20
buffer_load_dwordx4 a[20:23], v237, s[44:47], s68 offen offset:2048 sc1
s_waitcnt vmcnt(36)
s_barrier
s_waitcnt lgkmcnt(6)
MV 20,v,68,a,24
TR 52,242,49152
TR 54,242,50176
MV 24,v,68,a,28
TR 56,243,49152
s_waitcnt lgkmcnt(7)
MV 28,v,72,a,24
TR 58,243,50176
MV 32,v,72,a,28
TR 60,244,49152
TR 62,244,50176
s_waitcnt lgkmcnt(8)
MV 36,v,76,a,24
TR 64,245,49152
buffer_load_dwordx4 v241, s[48:51], s69 offen offset:3072 lds
MV 40,v,76,a,28
TR 66,245,50176
s_waitcnt lgkmcnt(8)
MV 44,v,80,a,24
buffer_load_dwordx4 a[24:27], v236, s[44:47], s68 offen offset:3072 sc1
MV 48,v,80,a,28
buffer_load_dwordx4 a[28:31], v237, s[44:47], s68 offen offset:3072 sc1
s_add_u32 s68, s68, 4096
s_add_u32 s69, s69, 262144
s_waitcnt lgkmcnt(6)
MV 20,v,52,a,32
TR 68,242,53248
TR 70,242,54272
MV 24,v,52,a,36
TR 72,243,53248
s_waitcnt lgkmcnt(7)
MV 28,v,56,a,32
TR 74,243,54272
s_add_u32 m0, s70, 114688
MV 32,v,56,a,36
TR 76,244,53248
TR 78,244,54272
s_waitcnt lgkmcnt(8)
MV 36,v,60,a,32
TR 80,245,53248
buffer_load_dwordx4 v238, s[48:51], s69 offen offset:0 lds
MV 40,v,60,a,36
TR 82,245,54272
s_waitcnt lgkmcnt(8)
MV 44,v,64,a,32
buffer_load_dwordx4 a[32:35], v236, s[44:47], s68 offen offset:0 sc1
MV 48,v,64,a,36
buffer_load_dwordx4 a[36:39], v237, s[44:47], s68 offen offset:0 sc1
s_waitcnt lgkmcnt(6)
MV 20,v,68,a,40
TR 52,242,57344
TR 54,242,58368
MV 24,v,68,a,44
TR 56,243,57344
s_waitcnt lgkmcnt(7)
MV 28,v,72,a,40
TR 58,243,58368
MV 32,v,72,a,44
TR 60,244,57344
TR 62,244,58368
s_waitcnt lgkmcnt(8)
MV 36,v,76,a,40
TR 64,245,57344
buffer_load_dwordx4 v239, s[48:51], s69 offen offset:1024 lds
MV 40,v,76,a,44
TR 66,245,58368
s_waitcnt lgkmcnt(8)
MV 44,v,80,a,40
buffer_load_dwordx4 a[40:43], v236, s[44:47], s68 offen offset:1024 sc1
MV 48,v,80,a,44
buffer_load_dwordx4 a[44:47], v237, s[44:47], s68 offen offset:1024 sc1
s_waitcnt lgkmcnt(6)
MV 20,v,52,a,48
TR 68,242,61440
TR 70,242,62464
MV 24,v,52,a,52
TR 72,243,61440
s_waitcnt lgkmcnt(7)
MV 28,v,56,a,48
TR 74,243,62464
MV 32,v,56,a,52
TR 76,244,61440
TR 78,244,62464
s_waitcnt lgkmcnt(8)
MV 36,v,60,a,48
TR 80,245,61440
buffer_load_dwordx4 v240, s[48:51], s69 offen offset:2048 lds
MV 40,v,60,a,52
TR 82,245,62464
s_waitcnt lgkmcnt(8)
MV 44,v,64,a,48
buffer_load_dwordx4 a[48:51], v236, s[44:47], s68 offen offset:2048 sc1
MV 48,v,64,a,52
buffer_load_dwordx4 a[52:55], v237, s[44:47], s68 offen offset:2048 sc1
s_waitcnt vmcnt(36)
s_barrier
s_waitcnt lgkmcnt(6)
MV 20,v,68,a,56
TR 52,246,0
TR 54,246,1024
MV 24,v,68,a,60
TR 56,247,0
s_waitcnt lgkmcnt(7)
MV 28,v,72,a,56
TR 58,247,1024
MV 32,v,72,a,60
TR 60,248,0
TR 62,248,1024
s_waitcnt lgkmcnt(8)
MV 36,v,76,a,56
TR 64,249,0
buffer_load_dwordx4 v241, s[48:51], s69 offen offset:3072 lds
MV 40,v,76,a,60
TR 66,249,1024
s_waitcnt lgkmcnt(8)
MV 44,v,80,a,56
buffer_load_dwordx4 a[56:59], v236, s[44:47], s68 offen offset:3072 sc1
MV 48,v,80,a,60
buffer_load_dwordx4 a[60:63], v237, s[44:47], s68 offen offset:3072 sc1
s_add_u32 s68, s68, 4096
s_add_u32 s69, s69, 262144
s_waitcnt lgkmcnt(6)
MV 20,v,52,a,64
TR 68,246,4096
TR 70,246,5120
MV 24,v,52,a,68
TR 72,247,4096
s_waitcnt lgkmcnt(7)
MV 28,v,56,a,64
TR 74,247,5120
s_add_u32 m0, s70, 0
MV 32,v,56,a,68
TR 76,248,4096
TR 78,248,5120
s_waitcnt lgkmcnt(8)
MV 36,v,60,a,64
TR 80,249,4096
buffer_load_dwordx4 v238, s[48:51], s69 offen offset:0 lds
MV 40,v,60,a,68
TR 82,249,5120
s_waitcnt lgkmcnt(8)
MV 44,v,64,a,64
buffer_load_dwordx4 a[64:67], v236, s[44:47], s68 offen offset:0 sc1
MV 48,v,64,a,68
buffer_load_dwordx4 a[68:71], v237, s[44:47], s68 offen offset:0 sc1
s_waitcnt lgkmcnt(6)
MV 20,v,68,a,72
TR 52,246,8192
TR 54,246,9216
MV 24,v,68,a,76
TR 56,247,8192
s_waitcnt lgkmcnt(7)
MV 28,v,72,a,72
TR 58,247,9216
MV 32,v,72,a,76
TR 60,248,8192
TR 62,248,9216
s_waitcnt lgkmcnt(8)
MV 36,v,76,a,72
TR 64,249,8192
buffer_load_dwordx4 v239, s[48:51], s69 offen offset:1024 lds
MV 40,v,76,a,76
TR 66,249,9216
s_waitcnt lgkmcnt(8)
MV 44,v,80,a,72
buffer_load_dwordx4 a[72:75], v236, s[44:47], s68 offen offset:1024 sc1
MV 48,v,80,a,76
buffer_load_dwordx4 a[76:79], v237, s[44:47], s68 offen offset:1024 sc1
s_waitcnt lgkmcnt(6)
MV 20,v,52,a,80
TR 68,246,12288
TR 70,246,13312
MV 24,v,52,a,84
TR 72,247,12288
s_waitcnt lgkmcnt(7)
MV 28,v,56,a,80
TR 74,247,13312
MV 32,v,56,a,84
TR 76,248,12288
TR 78,248,13312
s_waitcnt lgkmcnt(8)
MV 36,v,60,a,80
TR 80,249,12288
buffer_load_dwordx4 v240, s[48:51], s69 offen offset:2048 lds
MV 40,v,60,a,84
TR 82,249,13312
s_waitcnt lgkmcnt(8)
MV 44,v,64,a,80
buffer_load_dwordx4 a[80:83], v236, s[44:47], s68 offen offset:2048 sc1
MV 48,v,64,a,84
buffer_load_dwordx4 a[84:87], v237, s[44:47], s68 offen offset:2048 sc1
s_waitcnt vmcnt(35)
s_barrier
s_waitcnt lgkmcnt(6)
MV 20,v,68,a,88
TR 52,246,16384
TR 54,246,17408
MV 24,v,68,a,92
TR 56,247,16384
s_waitcnt lgkmcnt(7)
MV 28,v,72,a,88
TR 58,247,17408
MV 32,v,72,a,92
TR 60,248,16384
TR 62,248,17408
s_waitcnt lgkmcnt(8)
MV 36,v,76,a,88
TR 64,249,16384
buffer_load_dwordx4 v241, s[48:51], s69 offen offset:3072 lds
MV 40,v,76,a,92
TR 66,249,17408
s_waitcnt lgkmcnt(8)
MV 44,v,80,a,88
buffer_load_dwordx4 a[88:91], v236, s[44:47], s68 offen offset:3072 sc1
MV 48,v,80,a,92
buffer_load_dwordx4 a[92:95], v237, s[44:47], s68 offen offset:3072 sc1
s_add_u32 s68, s68, 4096
s_add_u32 s69, s69, 262144
s_waitcnt lgkmcnt(6)
MV 20,v,52,a,96
TR 68,246,20480
TR 70,246,21504
MV 24,v,52,a,100
TR 72,247,20480
s_waitcnt lgkmcnt(7)
MV 28,v,56,a,96
TR 74,247,21504
s_add_u32 m0, s70, 16384
MV 32,v,56,a,100
TR 76,248,20480
TR 78,248,21504
s_waitcnt lgkmcnt(8)
MV 36,v,60,a,96
TR 80,249,20480
buffer_load_dwordx4 v238, s[48:51], s69 offen offset:0 lds
MV 40,v,60,a,100
TR 82,249,21504
s_waitcnt lgkmcnt(8)
MV 44,v,64,a,96
buffer_load_dwordx4 a[96:99], v236, s[44:47], s68 offen offset:0 sc1
MV 48,v,64,a,100
buffer_load_dwordx4 a[100:103], v237, s[44:47], s68 offen offset:0 sc1
s_waitcnt lgkmcnt(6)
MV 20,v,68,a,104
TR 52,246,24576
TR 54,246,25600
MV 24,v,68,a,108
TR 56,247,24576
s_waitcnt lgkmcnt(7)
MV 28,v,72,a,104
TR 58,247,25600
MV 32,v,72,a,108
TR 60,248,24576
TR 62,248,25600
s_waitcnt lgkmcnt(8)
MV 36,v,76,a,104
TR 64,249,24576
buffer_load_dwordx4 v239, s[48:51], s69 offen offset:1024 lds
MV 40,v,76,a,108
TR 66,249,25600
s_waitcnt lgkmcnt(8)
MV 44,v,80,a,104
buffer_load_dwordx4 a[104:107], v236, s[44:47], s68 offen offset:1024 sc1
MV 48,v,80,a,108
buffer_load_dwordx4 a[108:111], v237, s[44:47], s68 offen offset:1024 sc1
s_waitcnt lgkmcnt(6)
MV 20,v,52,a,112
TR 68,246,28672
TR 70,246,29696
MV 24,v,52,a,116
TR 72,247,28672
s_waitcnt lgkmcnt(7)
MV 28,v,56,a,112
TR 74,247,29696
MV 32,v,56,a,116
TR 76,248,28672
TR 78,248,29696
s_waitcnt lgkmcnt(8)
MV 36,v,60,a,112
TR 80,249,28672
buffer_load_dwordx4 v240, s[48:51], s69 offen offset:2048 lds
MV 40,v,60,a,116
TR 82,249,29696
s_waitcnt lgkmcnt(8)
MV 44,v,64,a,112
buffer_load_dwordx4 a[112:115], v236, s[44:47], s68 offen offset:2048 sc1
MV 48,v,64,a,116
buffer_load_dwordx4 a[116:119], v237, s[44:47], s68 offen offset:2048 sc1
s_waitcnt vmcnt(35)
s_barrier
s_waitcnt lgkmcnt(6)
MV 20,v,68,a,120
TR 52,246,32768
TR 54,246,33792
MV 24,v,68,a,124
TR 56,247,32768
s_waitcnt lgkmcnt(7)
MV 28,v,72,a,120
TR 58,247,33792
MV 32,v,72,a,124
TR 60,248,32768
TR 62,248,33792
s_waitcnt lgkmcnt(8)
MV 36,v,76,a,120
TR 64,249,32768
buffer_load_dwordx4 v241, s[48:51], s69 offen offset:3072 lds
MV 40,v,76,a,124
TR 66,249,33792
s_waitcnt lgkmcnt(8)
MV 44,v,80,a,120
buffer_load_dwordx4 a[120:123], v236, s[44:47], s68 offen offset:3072 sc1
MV 48,v,80,a,124
buffer_load_dwordx4 a[124:127], v237, s[44:47], s68 offen offset:3072 sc1
s_add_u32 s68, s68, 4096
s_add_u32 s69, s69, 262144
s_waitcnt lgkmcnt(6)
MV 20,v,52,a,0
TR 68,246,36864
TR 70,246,37888
v_cmp_ne_u32 vcc, 1, v253
s_nop 4
s_cbranch_vccnz L_spin_f3
L_spin_f3_ret:
MV 24,v,52,a,4
TR 72,247,36864
s_waitcnt lgkmcnt(7)
MV 28,v,56,a,0
TR 74,247,37888
s_add_u32 m0, s70, 32768
s_add_u32 s72, s79, 0
buffer_load_dwordx2 v[100:101], v251, s[56:59], s72 offen offset:0 sc1
MV 32,v,56,a,4
TR 76,248,36864
TR 78,248,37888
s_waitcnt lgkmcnt(8)
MV 36,v,60,a,0
TR 80,249,36864
buffer_load_dwordx4 v238, s[48:51], s69 offen offset:0 lds
MV 40,v,60,a,4
TR 82,249,37888
s_add_u32 s72, s79, 16384
buffer_load_dwordx2 v[102:103], v251, s[56:59], s72 offen offset:0 sc1
s_waitcnt lgkmcnt(8)
MV 44,v,64,a,0
buffer_load_dwordx4 a[0:3], v236, s[44:47], s68 offen offset:0 sc1
MV 48,v,64,a,4
buffer_load_dwordx4 a[4:7], v237, s[44:47], s68 offen offset:0 sc1
s_waitcnt lgkmcnt(6)
MV 20,v,68,a,8
TR 52,246,40960
TR 54,246,41984
s_add_u32 s72, s79, 131072
buffer_load_dwordx2 v[104:105], v251, s[56:59], s72 offen offset:0 sc1
MV 24,v,68,a,12
TR 56,247,40960
s_waitcnt lgkmcnt(7)
MV 28,v,72,a,8
TR 58,247,41984
MV 32,v,72,a,12
TR 60,248,40960
TR 62,248,41984
s_waitcnt lgkmcnt(8)
MV 36,v,76,a,8
TR 64,249,40960
buffer_load_dwordx4 v239, s[48:51], s69 offen offset:1024 lds
s_add_u32 s72, s79, 147456
buffer_load_dwordx2 v[106:107], v251, s[56:59], s72 offen offset:0 sc1
MV 40,v,76,a,12
TR 66,249,41984
s_waitcnt lgkmcnt(8)
MV 44,v,80,a,8
buffer_load_dwordx4 a[8:11], v236, s[44:47], s68 offen offset:1024 sc1
MV 48,v,80,a,12
buffer_load_dwordx4 a[12:15], v237, s[44:47], s68 offen offset:1024 sc1
s_waitcnt lgkmcnt(6)
MV 20,v,52,a,16
TR 68,246,45056
TR 70,246,46080
s_add_u32 s72, s79, 0
buffer_load_dwordx2 v[108:109], v251, s[56:59], s72 offen offset:128 sc1
MV 24,v,52,a,20
TR 72,247,45056
s_waitcnt lgkmcnt(7)
MV 28,v,56,a,16
TR 74,247,46080
MV 32,v,56,a,20
TR 76,248,45056
TR 78,248,46080
s_waitcnt lgkmcnt(8)
MV 36,v,60,a,16
TR 80,249,45056
buffer_load_dwordx4 v240, s[48:51], s69 offen offset:2048 lds
s_add_u32 s72, s79, 16384
buffer_load_dwordx2 v[110:111], v251, s[56:59], s72 offen offset:128 sc1
MV 40,v,60,a,20
TR 82,249,46080
s_waitcnt lgkmcnt(8)
MV 44,v,64,a,16
buffer_load_dwordx4 a[16:19], v236, s[44:47], s68 offen offset:2048 sc1
MV 48,v,64,a,20
buffer_load_dwordx4 a[20:23], v237, s[44:47], s68 offen offset:2048 sc1
s_waitcnt vmcnt(41)
s_barrier
s_waitcnt lgkmcnt(6)
MV 20,v,68,a,24
TR 52,246,49152
TR 54,246,50176
s_add_u32 s72, s79, 131072
buffer_load_dwordx2 v[112:113], v251, s[56:59], s72 offen offset:128 sc1
MV 24,v,68,a,28
TR 56,247,49152
s_waitcnt lgkmcnt(7)
MV 28,v,72,a,24
TR 58,247,50176
MV 32,v,72,a,28
TR 60,248,49152
TR 62,248,50176
s_waitcnt lgkmcnt(8)
MV 36,v,76,a,24
TR 64,249,49152
buffer_load_dwordx4 v241, s[48:51], s69 offen offset:3072 lds
s_add_u32 s72, s79, 147456
buffer_load_dwordx2 v[114:115], v251, s[56:59], s72 offen offset:128 sc1
MV 40,v,76,a,28
TR 66,249,50176
s_waitcnt lgkmcnt(8)
MV 44,v,80,a,24
buffer_load_dwordx4 a[24:27], v236, s[44:47], s68 offen offset:3072 sc1
MV 48,v,80,a,28
buffer_load_dwordx4 a[28:31], v237, s[44:47], s68 offen offset:3072 sc1
s_add_u32 s68, s68, 4096
s_add_u32 s69, s69, 262144
s_waitcnt lgkmcnt(6)
MV 20,v,52,a,32
TR 68,246,53248
TR 70,246,54272
MV 24,v,52,a,36
TR 72,247,53248
s_waitcnt lgkmcnt(7)
MV 28,v,56,a,32
TR 74,247,54272
s_add_u32 m0, s70, 49152
MV 32,v,56,a,36
TR 76,248,53248
TR 78,248,54272
s_waitcnt lgkmcnt(8)
MV 36,v,60,a,32
TR 80,249,53248
buffer_load_dwordx4 v238, s[48:51], s69 offen offset:0 lds
MV 40,v,60,a,36
TR 82,249,54272
s_waitcnt lgkmcnt(8)
MV 44,v,64,a,32
buffer_load_dwordx4 a[32:35], v236, s[44:47], s68 offen offset:0 sc1
MV 48,v,64,a,36
buffer_load_dwordx4 a[36:39], v237, s[44:47], s68 offen offset:0 sc1
s_waitcnt lgkmcnt(6)
MV 20,v,68,a,40
TR 52,246,57344
TR 54,246,58368
MV 24,v,68,a,44
TR 56,247,57344
s_waitcnt lgkmcnt(7)
MV 28,v,72,a,40
TR 58,247,58368
MV 32,v,72,a,44
TR 60,248,57344
TR 62,248,58368
s_waitcnt lgkmcnt(8)
MV 36,v,76,a,40
TR 64,249,57344
buffer_load_dwordx4 v239, s[48:51], s69 offen offset:1024 lds
MV 40,v,76,a,44
TR 66,249,58368
s_waitcnt lgkmcnt(8)
MV 44,v,80,a,40
buffer_load_dwordx4 a[40:43], v236, s[44:47], s68 offen offset:1024 sc1
MV 48,v,80,a,44
buffer_load_dwordx4 a[44:47], v237, s[44:47], s68 offen offset:1024 sc1
s_waitcnt lgkmcnt(6)
MV 20,v,52,a,48
TR 68,246,61440
TR 70,246,62464
MV 24,v,52,a,52
TR 72,247,61440
s_waitcnt lgkmcnt(7)
MV 28,v,56,a,48
TR 74,247,62464
MV 32,v,56,a,52
TR 76,248,61440
TR 78,248,62464
s_waitcnt lgkmcnt(8)
MV 36,v,60,a,48
TR 80,249,61440
buffer_load_dwordx4 v240, s[48:51], s69 offen offset:2048 lds
MV 40,v,60,a,52
TR 82,249,62464
s_waitcnt lgkmcnt(8)
MV 44,v,64,a,48
buffer_load_dwordx4 a[48:51], v236, s[44:47], s68 offen offset:2048 sc1
MV 48,v,64,a,52
buffer_load_dwordx4 a[52:55], v237, s[44:47], s68 offen offset:2048 sc1
s_waitcnt vmcnt(43)
s_barrier
s_waitcnt lgkmcnt(6)
MV 20,v,68,a,56
TR 52,242,0
TR 54,242,1024
MV 24,v,68,a,60
TR 56,243,0
s_waitcnt lgkmcnt(7)
MV 28,v,72,a,56
TR 58,243,1024
MV 32,v,72,a,60
TR 60,244,0
TR 62,244,1024
s_waitcnt lgkmcnt(8)
MV 36,v,76,a,56
TR 64,245,0
buffer_load_dwordx4 v241, s[48:51], s69 offen offset:3072 lds
MV 40,v,76,a,60
TR 66,245,1024
s_waitcnt lgkmcnt(8)
MV 44,v,80,a,56
buffer_load_dwordx4 a[56:59], v236, s[44:47], s68 offen offset:3072 sc1
MV 48,v,80,a,60
buffer_load_dwordx4 a[60:63], v237, s[44:47], s68 offen offset:3072 sc1
s_add_u32 s68, s68, 4096
s_add_u32 s69, s69, 262144
s_waitcnt lgkmcnt(6)
MV 20,v,52,a,64
TR 68,242,4096
TR 70,242,5120
MV 24,v,52,a,68
TR 72,243,4096
s_waitcnt lgkmcnt(7)
MV 28,v,56,a,64
TR 74,243,5120
s_add_u32 m0, s70, 65536
MV 32,v,56,a,68
TR 76,244,4096
TR 78,244,5120
s_waitcnt lgkmcnt(8)
MV 36,v,60,a,64
TR 80,245,4096
buffer_load_dwordx4 v238, s[48:51], s69 offen offset:0 lds
MV 40,v,60,a,68
TR 82,245,5120
s_waitcnt lgkmcnt(8)
MV 44,v,64,a,64
buffer_load_dwordx4 a[64:67], v236, s[44:47], s68 offen offset:0 sc1
MV 48,v,64,a,68
buffer_load_dwordx4 a[68:71], v237, s[44:47], s68 offen offset:0 sc1
s_waitcnt lgkmcnt(6)
MV 20,v,68,a,72
TR 52,242,8192
TR 54,242,9216
MV 24,v,68,a,76
TR 56,243,8192
s_waitcnt lgkmcnt(7)
MV 28,v,72,a,72
TR 58,243,9216
MV 32,v,72,a,76
TR 60,244,8192
TR 62,244,9216
s_waitcnt lgkmcnt(8)
MV 36,v,76,a,72
TR 64,245,8192
buffer_load_dwordx4 v239, s[48:51], s69 offen offset:1024 lds
MV 40,v,76,a,76
TR 66,245,9216
s_waitcnt lgkmcnt(8)
MV 44,v,80,a,72
buffer_load_dwordx4 a[72:75], v236, s[44:47], s68 offen offset:1024 sc1
MV 48,v,80,a,76
buffer_load_dwordx4 a[76:79], v237, s[44:47], s68 offen offset:1024 sc1
s_waitcnt lgkmcnt(6)
MV 20,v,52,a,80
TR 68,242,12288
TR 70,242,13312
MV 24,v,52,a,84
TR 72,243,12288
s_waitcnt lgkmcnt(7)
MV 28,v,56,a,80
TR 74,243,13312
MV 32,v,56,a,84
TR 76,244,12288
TR 78,244,13312
s_waitcnt lgkmcnt(8)
MV 36,v,60,a,80
TR 80,245,12288
buffer_load_dwordx4 v240, s[48:51], s69 offen offset:2048 lds
MV 40,v,60,a,84
TR 82,245,13312
s_waitcnt lgkmcnt(8)
MV 44,v,64,a,80
buffer_load_dwordx4 a[80:83], v236, s[44:47], s68 offen offset:2048 sc1
MV 48,v,64,a,84
buffer_load_dwordx4 a[84:87], v237, s[44:47], s68 offen offset:2048 sc1
s_waitcnt vmcnt(43)
s_barrier
s_waitcnt lgkmcnt(6)
MV 20,v,68,a,88
TR 52,242,16384
TR 54,242,17408
MV 24,v,68,a,92
TR 56,243,16384
s_waitcnt lgkmcnt(7)
MV 28,v,72,a,88
TR 58,243,17408
MV 32,v,72,a,92
TR 60,244,16384
TR 62,244,17408
s_waitcnt lgkmcnt(8)
MV 36,v,76,a,88
TR 64,245,16384
buffer_load_dwordx4 v241, s[48:51], s69 offen offset:3072 lds
MV 40,v,76,a,92
TR 66,245,17408
s_waitcnt lgkmcnt(8)
MV 44,v,80,a,88
buffer_load_dwordx4 a[88:91], v236, s[44:47], s68 offen offset:3072 sc1
MV 48,v,80,a,92
buffer_load_dwordx4 a[92:95], v237, s[44:47], s68 offen offset:3072 sc1
s_add_u32 s68, s68, 4096
s_add_u32 s69, s69, 262144
s_waitcnt lgkmcnt(6)
MV 20,v,52,a,96
TR 68,242,20480
TR 70,242,21504
MV 24,v,52,a,100
TR 72,243,20480
s_waitcnt lgkmcnt(7)
MV 28,v,56,a,96
TR 74,243,21504
s_add_u32 m0, s70, 81920
MV 32,v,56,a,100
TR 76,244,20480
TR 78,244,21504
s_waitcnt lgkmcnt(8)
MV 36,v,60,a,96
TR 80,245,20480
buffer_load_dwordx4 v238, s[48:51], s69 offen offset:0 lds
MV 40,v,60,a,100
TR 82,245,21504
s_waitcnt lgkmcnt(8)
MV 44,v,64,a,96
buffer_load_dwordx4 a[96:99], v236, s[44:47], s68 offen offset:0 sc1
MV 48,v,64,a,100
buffer_load_dwordx4 a[100:103], v237, s[44:47], s68 offen offset:0 sc1
s_waitcnt lgkmcnt(6)
MV 20,v,68,a,104
TR 52,242,24576
TR 54,242,25600
MV 24,v,68,a,108
TR 56,243,24576
s_waitcnt lgkmcnt(7)
MV 28,v,72,a,104
TR 58,243,25600
MV 32,v,72,a,108
TR 60,244,24576
TR 62,244,25600
s_waitcnt lgkmcnt(8)
MV 36,v,76,a,104
TR 64,245,24576
buffer_load_dwordx4 v239, s[48:51], s69 offen offset:1024 lds
MV 40,v,76,a,108
TR 66,245,25600
s_waitcnt lgkmcnt(8)
MV 44,v,80,a,104
buffer_load_dwordx4 a[104:107], v236, s[44:47], s68 offen offset:1024 sc1
MV 48,v,80,a,108
buffer_load_dwordx4 a[108:111], v237, s[44:47], s68 offen offset:1024 sc1
s_waitcnt lgkmcnt(6)
MV 20,v,52,a,112
TR 68,242,28672
TR 70,242,29696
MV 24,v,52,a,116
TR 72,243,28672
s_waitcnt lgkmcnt(7)
MV 28,v,56,a,112
TR 74,243,29696
MV 32,v,56,a,116
TR 76,244,28672
TR 78,244,29696
s_waitcnt lgkmcnt(8)
MV 36,v,60,a,112
TR 80,245,28672
buffer_load_dwordx4 v240, s[48:51], s69 offen offset:2048 lds
MV 40,v,60,a,116
TR 82,245,29696
s_waitcnt lgkmcnt(8)
MV 44,v,64,a,112
buffer_load_dwordx4 a[112:115], v236, s[44:47], s68 offen offset:2048 sc1
MV 48,v,64,a,116
buffer_load_dwordx4 a[116:119], v237, s[44:47], s68 offen offset:2048 sc1
s_waitcnt vmcnt(36)
s_barrier
s_waitcnt lgkmcnt(6)
MV 20,v,68,a,120
TR 52,242,32768
TR 54,242,33792
MV 24,v,68,a,124
TR 56,243,32768
s_waitcnt lgkmcnt(7)
MV 28,v,72,a,120
TR 58,243,33792
MV 32,v,72,a,124
TR 60,244,32768
TR 62,244,33792
s_waitcnt lgkmcnt(8)
MV 36,v,76,a,120
TR 64,245,32768
buffer_load_dwordx4 v241, s[48:51], s69 offen offset:3072 lds
MV 40,v,76,a,124
TR 66,245,33792
s_waitcnt lgkmcnt(8)
MV 44,v,80,a,120
buffer_load_dwordx4 a[120:123], v236, s[44:47], s68 offen offset:3072 sc1
MV 48,v,80,a,124
buffer_load_dwordx4 a[124:127], v237, s[44:47], s68 offen offset:3072 sc1
s_add_u32 s68, s68, 4096
s_add_u32 s69, s69, 262144
s_waitcnt lgkmcnt(6)
MV 20,v,52,a,0
TR 68,242,36864
TR 70,242,37888
MV 24,v,52,a,4
TR 72,243,36864
s_waitcnt lgkmcnt(7)
MV 28,v,56,a,0
TR 74,243,37888
s_add_u32 m0, s70, 98304
MV 32,v,56,a,4
TR 76,244,36864
TR 78,244,37888
s_waitcnt lgkmcnt(8)
MV 36,v,60,a,0
TR 80,245,36864
buffer_load_dwordx4 v238, s[48:51], s69 offen offset:0 lds
MV 40,v,60,a,4
TR 82,245,37888
s_waitcnt lgkmcnt(8)
MV 44,v,64,a,0
buffer_load_dwordx4 a[0:3], v236, s[44:47], s68 offen offset:0 sc1
MV 48,v,64,a,4
buffer_load_dwordx4 a[4:7], v237, s[44:47], s68 offen offset:0 sc1
s_waitcnt lgkmcnt(6)
MV 20,v,68,a,8
TR 52,242,40960
TR 54,242,41984
MV 24,v,68,a,12
TR 56,243,40960
s_waitcnt lgkmcnt(7)
MV 28,v,72,a,8
TR 58,243,41984
MV 32,v,72,a,12
TR 60,244,40960
TR 62,244,41984
s_waitcnt lgkmcnt(8)
MV 36,v,76,a,8
TR 64,245,40960
buffer_load_dwordx4 v239, s[48:51], s69 offen offset:1024 lds
MV 40,v,76,a,12
TR 66,245,41984
s_waitcnt lgkmcnt(8)
MV 44,v,80,a,8
buffer_load_dwordx4 a[8:11], v236, s[44:47], s68 offen offset:1024 sc1
MV 48,v,80,a,12
buffer_load_dwordx4 a[12:15], v237, s[44:47], s68 offen offset:1024 sc1
s_waitcnt lgkmcnt(6)
MV 20,v,52,a,16
TR 68,242,45056
TR 70,242,46080
MV 24,v,52,a,20
TR 72,243,45056
s_waitcnt lgkmcnt(7)
MV 28,v,56,a,16
TR 74,243,46080
MV 32,v,56,a,20
TR 76,244,45056
TR 78,244,46080
s_waitcnt lgkmcnt(8)
MV 36,v,60,a,16
TR 80,245,45056
buffer_load_dwordx4 v240, s[48:51], s69 offen offset:2048 lds
MV 40,v,60,a,20
TR 82,245,46080
s_waitcnt lgkmcnt(8)
MV 44,v,64,a,16
buffer_load_dwordx4 a[16:19], v236, s[44:47], s68 offen offset:2048 sc1
MV 48,v,64,a,20
buffer_load_dwordx4 a[20:23], v237, s[44:47], s68 offen offset:2048 sc1
s_waitcnt vmcnt(35)
s_barrier
s_waitcnt lgkmcnt(6)
MV 20,v,68,a,24
TR 52,242,49152
TR 54,242,50176
MV 24,v,68,a,28
TR 56,243,49152
s_waitcnt lgkmcnt(7)
MV 28,v,72,a,24
TR 58,243,50176
MV 32,v,72,a,28
TR 60,244,49152
TR 62,244,50176
s_waitcnt lgkmcnt(8)
MV 36,v,76,a,24
TR 64,245,49152
buffer_load_dwordx4 v241, s[48:51], s69 offen offset:3072 lds
MV 40,v,76,a,28
TR 66,245,50176
s_waitcnt lgkmcnt(8)
MV 44,v,80,a,24
buffer_load_dwordx4 a[24:27], v236, s[44:47], s68 offen offset:3072 sc1
MV 48,v,80,a,28
buffer_load_dwordx4 a[28:31], v237, s[44:47], s68 offen offset:3072 sc1
s_add_u32 s68, s68, 4096
s_add_u32 s69, s69, 262144
s_waitcnt lgkmcnt(6)
MV 20,v,52,a,32
TR 68,242,53248
TR 70,242,54272
MV 24,v,52,a,36
TR 72,243,53248
s_waitcnt lgkmcnt(7)
MV 28,v,56,a,32
TR 74,243,54272
s_add_u32 m0, s70, 114688
MV 32,v,56,a,36
TR 76,244,53248
TR 78,244,54272
s_waitcnt lgkmcnt(8)
MV 36,v,60,a,32
TR 80,245,53248
buffer_load_dwordx4 v238, s[48:51], s69 offen offset:0 lds
MV 40,v,60,a,36
TR 82,245,54272
s_waitcnt lgkmcnt(8)
MV 44,v,64,a,32
buffer_load_dwordx4 a[32:35], v236, s[44:47], s68 offen offset:0 sc1
MV 48,v,64,a,36
buffer_load_dwordx4 a[36:39], v237, s[44:47], s68 offen offset:0 sc1
s_waitcnt lgkmcnt(6)
MV 20,v,68,a,40
TR 52,242,57344
TR 54,242,58368
MV 24,v,68,a,44
TR 56,243,57344
s_waitcnt lgkmcnt(7)
MV 28,v,72,a,40
TR 58,243,58368
MV 32,v,72,a,44
TR 60,244,57344
TR 62,244,58368
s_waitcnt lgkmcnt(8)
MV 36,v,76,a,40
TR 64,245,57344
buffer_load_dwordx4 v239, s[48:51], s69 offen offset:1024 lds
MV 40,v,76,a,44
TR 66,245,58368
s_waitcnt lgkmcnt(8)
MV 44,v,80,a,40
buffer_load_dwordx4 a[40:43], v236, s[44:47], s68 offen offset:1024 sc1
MV 48,v,80,a,44
buffer_load_dwordx4 a[44:47], v237, s[44:47], s68 offen offset:1024 sc1
s_waitcnt lgkmcnt(6)
MV 20,v,52,a,48
TR 68,242,61440
TR 70,242,62464
MV 24,v,52,a,52
TR 72,243,61440
s_waitcnt lgkmcnt(7)
MV 28,v,56,a,48
TR 74,243,62464
MV 32,v,56,a,52
TR 76,244,61440
TR 78,244,62464
s_waitcnt lgkmcnt(8)
MV 36,v,60,a,48
TR 80,245,61440
buffer_load_dwordx4 v240, s[48:51], s69 offen offset:2048 lds
MV 40,v,60,a,52
TR 82,245,62464
s_waitcnt lgkmcnt(8)
MV 44,v,64,a,48
buffer_load_dwordx4 a[48:51], v236, s[44:47], s68 offen offset:2048 sc1
MV 48,v,64,a,52
buffer_load_dwordx4 a[52:55], v237, s[44:47], s68 offen offset:2048 sc1
s_waitcnt vmcnt(35)
s_barrier
s_waitcnt lgkmcnt(6)
MV 20,v,68,a,56
TR 52,246,0
TR 54,246,1024
MV 24,v,68,a,60
TR 56,247,0
s_waitcnt lgkmcnt(7)
MV 28,v,72,a,56
TR 58,247,1024
MV 32,v,72,a,60
TR 60,248,0
TR 62,248,1024
s_waitcnt lgkmcnt(8)
MV 36,v,76,a,56
TR 64,249,0
buffer_load_dwordx4 v241, s[48:51], s69 offen offset:3072 lds
MV 40,v,76,a,60
TR 66,249,1024
s_waitcnt lgkmcnt(8)
MV 44,v,80,a,56
buffer_load_dwordx4 a[56:59], v236, s[44:47], s68 offen offset:3072 sc1
MV 48,v,80,a,60
buffer_load_dwordx4 a[60:63], v237, s[44:47], s68 offen offset:3072 sc1
s_add_u32 s68, s68, 4096
s_add_u32 s69, s69, 262144
s_waitcnt lgkmcnt(6)
MV 20,v,52,a,64
TR 68,246,4096
TR 70,246,5120
v_sub_f32 v118, 1.0, v116
MV 24,v,52,a,68
TR 72,247,4096
v_lshlrev_b32 v120, 16, v84
s_waitcnt lgkmcnt(7)
MV 28,v,56,a,64
TR 74,247,5120
s_add_u32 m0, s70, 0
v_lshlrev_b32 v152, 16, v100
MV 32,v,56,a,68
TR 76,248,4096
TR 78,248,5120
s_waitcnt lgkmcnt(8)
MV 36,v,60,a,64
TR 80,249,4096
buffer_load_dwordx4 v238, s[48:51], s69 offen offset:0 lds
v_and_b32 v121, 0xffff0000, v84
MV 40,v,60,a,68
TR 82,249,5120
v_and_b32 v153, 0xffff0000, v100
s_waitcnt lgkmcnt(8)
MV 44,v,64,a,64
buffer_load_dwordx4 a[64:67], v236, s[44:47], s68 offen offset:0 sc1
v_mul_f32 v120, v120, v152
MV 48,v,64,a,68
buffer_load_dwordx4 a[68:71], v237, s[44:47], s68 offen offset:0 sc1
s_waitcnt lgkmcnt(6)
MV 20,v,68,a,72
TR 52,246,8192
TR 54,246,9216
v_mul_f32 v121, v121, v153
MV 24,v,68,a,76
TR 56,247,8192
v_mul_f32 v120, v120, v116
s_waitcnt lgkmcnt(7)
MV 28,v,72,a,72
TR 58,247,9216
v_mul_f32 v121, v121, v116
MV 32,v,72,a,76
TR 60,248,8192
TR 62,248,9216
v_lshlrev_b32 v122, 16, v85
s_waitcnt lgkmcnt(8)
MV 36,v,76,a,72
TR 64,249,8192
buffer_load_dwordx4 v239, s[48:51], s69 offen offset:1024 lds
v_lshlrev_b32 v152, 16, v101
MV 40,v,76,a,76
TR 66,249,9216
v_and_b32 v123, 0xffff0000, v85
s_waitcnt lgkmcnt(8)
MV 44,v,80,a,72
buffer_load_dwordx4 a[72:75], v236, s[44:47], s68 offen offset:1024 sc1
v_and_b32 v153, 0xffff0000, v101
MV 48,v,80,a,76
buffer_load_dwordx4 a[76:79], v237, s[44:47], s68 offen offset:1024 sc1
s_waitcnt lgkmcnt(6)
MV 20,v,52,a,80
TR 68,246,12288
TR 70,246,13312
v_mul_f32 v122, v122, v152
MV 24,v,52,a,84
TR 72,247,12288
v_mul_f32 v123, v123, v153
s_waitcnt lgkmcnt(7)
MV 28,v,56,a,80
TR 74,247,13312
v_mul_f32 v122, v122, v116
MV 32,v,56,a,84
TR 76,248,12288
TR 78,248,13312
s_waitcnt lgkmcnt(8)
MV 36,v,60,a,80
TR 80,249,12288
buffer_load_dwordx4 v240, s[48:51], s69 offen offset:2048 lds
v_mul_f32 v123, v123, v116
MV 40,v,60,a,84
TR 82,249,13312
v_lshlrev_b32 v124, 16, v86
s_waitcnt lgkmcnt(8)
MV 44,v,64,a,80
buffer_load_dwordx4 a[80:83], v236, s[44:47], s68 offen offset:2048 sc1
v_lshlrev_b32 v152, 16, v102
MV 48,v,64,a,84
buffer_load_dwordx4 a[84:87], v237, s[44:47], s68 offen offset:2048 sc1
s_waitcnt vmcnt(35)
s_barrier
s_waitcnt lgkmcnt(6)
MV 20,v,68,a,88
TR 52,246,16384
TR 54,246,17408
v_and_b32 v125, 0xffff0000, v86
MV 24,v,68,a,92
TR 56,247,16384
v_and_b32 v153, 0xffff0000, v102
s_waitcnt lgkmcnt(7)
MV 28,v,72,a,88
TR 58,247,17408
v_mul_f32 v124, v124, v152
MV 32,v,72,a,92
TR 60,248,16384
TR 62,248,17408
v_mul_f32 v125, v125, v153
s_waitcnt lgkmcnt(8)
MV 36,v,76,a,88
TR 64,249,16384
buffer_load_dwordx4 v241, s[48:51], s69 offen offset:3072 lds
v_mul_f32 v124, v124, v116
MV 40,v,76,a,92
TR 66,249,17408
v_mul_f32 v125, v125, v116
s_waitcnt lgkmcnt(8)
MV 44,v,80,a,88
buffer_load_dwordx4 a[88:91], v236, s[44:47], s68 offen offset:3072 sc1
v_lshlrev_b32 v126, 16, v87
MV 48,v,80,a,92
buffer_load_dwordx4 a[92:95], v237, s[44:47], s68 offen offset:3072 sc1
s_add_u32 s68, s68, 4096
s_add_u32 s69, s69, 262144
s_waitcnt lgkmcnt(6)
MV 20,v,52,a,96
TR 68,246,20480
TR 70,246,21504
v_lshlrev_b32 v152, 16, v103
MV 24,v,52,a,100
TR 72,247,20480
v_and_b32 v127, 0xffff0000, v87
s_waitcnt lgkmcnt(7)
MV 28,v,56,a,96
TR 74,247,21504
s_add_u32 m0, s70, 16384
v_and_b32 v153, 0xffff0000, v103
MV 32,v,56,a,100
TR 76,248,20480
TR 78,248,21504
s_waitcnt lgkmcnt(8)
MV 36,v,60,a,96
TR 80,249,20480
buffer_load_dwordx4 v238, s[48:51], s69 offen offset:0 lds
v_mul_f32 v126, v126, v152
MV 40,v,60,a,100
TR 82,249,21504
v_mul_f32 v127, v127, v153
s_waitcnt lgkmcnt(8)
MV 44,v,64,a,96
buffer_load_dwordx4 a[96:99], v236, s[44:47], s68 offen offset:0 sc1
v_mul_f32 v126, v126, v116
MV 48,v,64,a,100
buffer_load_dwordx4 a[100:103], v237, s[44:47], s68 offen offset:0 sc1
s_waitcnt lgkmcnt(6)
MV 20,v,68,a,104
TR 52,246,24576
TR 54,246,25600
v_mul_f32 v127, v127, v116
MV 24,v,68,a,108
TR 56,247,24576
v_lshlrev_b32 v128, 16, v88
s_waitcnt lgkmcnt(7)
MV 28,v,72,a,104
TR 58,247,25600
v_lshlrev_b32 v152, 16, v104
MV 32,v,72,a,108
TR 60,248,24576
TR 62,248,25600
v_and_b32 v129, 0xffff0000, v88
s_waitcnt lgkmcnt(8)
MV 36,v,76,a,104
TR 64,249,24576
buffer_load_dwordx4 v239, s[48:51], s69 offen offset:1024 lds
v_and_b32 v153, 0xffff0000, v104
MV 40,v,76,a,108
TR 66,249,25600
v_mul_f32 v128, v128, v152
s_waitcnt lgkmcnt(8)
MV 44,v,80,a,104
buffer_load_dwordx4 a[104:107], v236, s[44:47], s68 offen offset:1024 sc1
v_mul_f32 v129, v129, v153
MV 48,v,80,a,108
buffer_load_dwordx4 a[108:111], v237, s[44:47], s68 offen offset:1024 sc1
s_waitcnt lgkmcnt(6)
MV 20,v,52,a,112
TR 68,246,28672
TR 70,246,29696
v_mul_f32 v128, v128, v116
MV 24,v,52,a,116
TR 72,247,28672
v_mul_f32 v129, v129, v116
s_waitcnt lgkmcnt(7)
MV 28,v,56,a,112
TR 74,247,29696
v_lshlrev_b32 v130, 16, v89
MV 32,v,56,a,116
TR 76,248,28672
TR 78,248,29696
s_waitcnt lgkmcnt(8)
MV 36,v,60,a,112
TR 80,249,28672
buffer_load_dwordx4 v240, s[48:51], s69 offen offset:2048 lds
v_lshlrev_b32 v152, 16, v105
MV 40,v,60,a,116
TR 82,249,29696
v_and_b32 v131, 0xffff0000, v89
s_waitcnt lgkmcnt(8)
MV 44,v,64,a,112
buffer_load_dwordx4 a[112:115], v236, s[44:47], s68 offen offset:2048 sc1
v_and_b32 v153, 0xffff0000, v105
MV 48,v,64,a,116
buffer_load_dwordx4 a[116:119], v237, s[44:47], s68 offen offset:2048 sc1
s_waitcnt vmcnt(35)
s_barrier
s_waitcnt lgkmcnt(6)
MV 20,v,68,a,120
TR 52,246,32768
TR 54,246,33792
v_mul_f32 v130, v130, v152
MV 24,v,68,a,124
TR 56,247,32768
v_mul_f32 v131, v131, v153
s_waitcnt lgkmcnt(7)
MV 28,v,72,a,120
TR 58,247,33792
v_mul_f32 v130, v130, v116
MV 32,v,72,a,124
TR 60,248,32768
TR 62,248,33792
v_mul_f32 v131, v131, v116
s_waitcnt lgkmcnt(8)
MV 36,v,76,a,120
TR 64,249,32768
buffer_load_dwordx4 v241, s[48:51], s69 offen offset:3072 lds
v_lshlrev_b32 v132, 16, v90
MV 40,v,76,a,124
TR 66,249,33792
v_lshlrev_b32 v152, 16, v106
s_waitcnt lgkmcnt(8)
MV 44,v,80,a,120
buffer_load_dwordx4 a[120:123], v236, s[44:47], s68 offen offset:3072 sc1
v_and_b32 v133, 0xffff0000, v90
MV 48,v,80,a,124
buffer_load_dwordx4 a[124:127], v237, s[44:47], s68 offen offset:3072 sc1
s_add_u32 s68, s68, 4096
s_add_u32 s69, s69, 262144
s_waitcnt lgkmcnt(6)
MV 20,v,52,a,0
TR 68,246,36864
TR 70,246,37888
v_and_b32 v153, 0xffff0000, v106
MV 24,v,52,a,4
TR 72,247,36864
v_mul_f32 v132, v132, v152
s_waitcnt lgkmcnt(7)
MV 28,v,56,a,0
TR 74,247,37888
s_add_u32 m0, s70, 32768
v_mul_f32 v133, v133, v153
MV 32,v,56,a,4
TR 76,248,36864
TR 78,248,37888
s_waitcnt lgkmcnt(8)
MV 36,v,60,a,0
TR 80,249,36864
buffer_load_dwordx4 v238, s[48:51], s69 offen offset:0 lds
v_mul_f32 v132, v132, v116
MV 40,v,60,a,4
TR 82,249,37888
v_mul_f32 v133, v133, v116
s_waitcnt lgkmcnt(8)
MV 44,v,64,a,0
buffer_load_dwordx4 a[0:3], v236, s[44:47], s68 offen offset:0 sc1
v_lshlrev_b32 v134, 16, v91
MV 48,v,64,a,4
buffer_load_dwordx4 a[4:7], v237, s[44:47], s68 offen offset:0 sc1
s_waitcnt lgkmcnt(6)
MV 20,v,68,a,8
TR 52,246,40960
TR 54,246,41984
v_lshlrev_b32 v152, 16, v107
MV 24,v,68,a,12
TR 56,247,40960
v_and_b32 v135, 0xffff0000, v91
s_waitcnt lgkmcnt(7)
MV 28,v,72,a,8
TR 58,247,41984
v_and_b32 v153, 0xffff0000, v107
MV 32,v,72,a,12
TR 60,248,40960
TR 62,248,41984
v_mul_f32 v134, v134, v152
s_waitcnt lgkmcnt(8)
MV 36,v,76,a,8
TR 64,249,40960
buffer_load_dwordx4 v239, s[48:51], s69 offen offset:1024 lds
v_mul_f32 v135, v135, v153
MV 40,v,76,a,12
TR 66,249,41984
v_mul_f32 v134, v134, v116
s_waitcnt lgkmcnt(8)
MV 44,v,80,a,8
buffer_load_dwordx4 a[8:11], v236, s[44:47], s68 offen offset:1024 sc1
v_mul_f32 v135, v135, v116
MV 48,v,80,a,12
buffer_load_dwordx4 a[12:15], v237, s[44:47], s68 offen offset:1024 sc1
s_waitcnt lgkmcnt(6)
MV 20,v,52,a,16
TR 68,246,45056
TR 70,246,46080
v_sub_f32 v119, 1.0, v117
MV 24,v,52,a,20
TR 72,247,45056
v_lshlrev_b32 v136, 16, v92
s_waitcnt lgkmcnt(7)
MV 28,v,56,a,16
TR 74,247,46080
v_lshlrev_b32 v152, 16, v108
MV 32,v,56,a,20
TR 76,248,45056
TR 78,248,46080
s_waitcnt lgkmcnt(8)
MV 36,v,60,a,16
TR 80,249,45056
buffer_load_dwordx4 v240, s[48:51], s69 offen offset:2048 lds
v_and_b32 v137, 0xffff0000, v92
MV 40,v,60,a,20
TR 82,249,46080
v_and_b32 v153, 0xffff0000, v108
s_waitcnt lgkmcnt(8)
MV 44,v,64,a,16
buffer_load_dwordx4 a[16:19], v236, s[44:47], s68 offen offset:2048 sc1
v_mul_f32 v136, v136, v152
MV 48,v,64,a,20
buffer_load_dwordx4 a[20:23], v237, s[44:47], s68 offen offset:2048 sc1
s_waitcnt vmcnt(35)
s_barrier
s_waitcnt lgkmcnt(6)
MV 20,v,68,a,24
TR 52,246,49152
TR 54,246,50176
v_mul_f32 v137, v137, v153
MV 24,v,68,a,28
TR 56,247,49152
v_mul_f32 v136, v136, v117
s_waitcnt lgkmcnt(7)
MV 28,v,72,a,24
TR 58,247,50176
v_mul_f32 v137, v137, v117
MV 32,v,72,a,28
TR 60,248,49152
TR 62,248,50176
v_lshlrev_b32 v138, 16, v93
s_waitcnt lgkmcnt(8)
MV 36,v,76,a,24
TR 64,249,49152
buffer_load_dwordx4 v241, s[48:51], s69 offen offset:3072 lds
v_lshlrev_b32 v152, 16, v109
MV 40,v,76,a,28
TR 66,249,50176
v_and_b32 v139, 0xffff0000, v93
s_waitcnt lgkmcnt(8)
MV 44,v,80,a,24
buffer_load_dwordx4 a[24:27], v236, s[44:47], s68 offen offset:3072 sc1
v_and_b32 v153, 0xffff0000, v109
MV 48,v,80,a,28
buffer_load_dwordx4 a[28:31], v237, s[44:47], s68 offen offset:3072 sc1
s_add_u32 s68, s68, 4096
s_add_u32 s69, s69, 262144
s_waitcnt lgkmcnt(6)
MV 20,v,52,a,32
TR 68,246,53248
TR 70,246,54272
v_mul_f32 v138, v138, v152
MV 24,v,52,a,36
TR 72,247,53248
v_mul_f32 v139, v139, v153
s_waitcnt lgkmcnt(7)
MV 28,v,56,a,32
TR 74,247,54272
s_add_u32 m0, s70, 49152
v_mul_f32 v138, v138, v117
MV 32,v,56,a,36
TR 76,248,53248
TR 78,248,54272
s_waitcnt lgkmcnt(8)
MV 36,v,60,a,32
TR 80,249,53248
buffer_load_dwordx4 v238, s[48:51], s69 offen offset:0 lds
v_mul_f32 v139, v139, v117
MV 40,v,60,a,36
TR 82,249,54272
v_lshlrev_b32 v140, 16, v94
s_waitcnt lgkmcnt(8)
MV 44,v,64,a,32
buffer_load_dwordx4 a[32:35], v236, s[44:47], s68 offen offset:0 sc1
v_lshlrev_b32 v152, 16, v110
MV 48,v,64,a,36
buffer_load_dwordx4 a[36:39], v237, s[44:47], s68 offen offset:0 sc1
s_waitcnt lgkmcnt(6)
MV 20,v,68,a,40
TR 52,246,57344
TR 54,246,58368
v_and_b32 v141, 0xffff0000, v94
MV 24,v,68,a,44
TR 56,247,57344
v_and_b32 v153, 0xffff0000, v110
s_waitcnt lgkmcnt(7)
MV 28,v,72,a,40
TR 58,247,58368
v_mul_f32 v140, v140, v152
MV 32,v,72,a,44
TR 60,248,57344
TR 62,248,58368
v_mul_f32 v141, v141, v153
s_waitcnt lgkmcnt(8)
MV 36,v,76,a,40
TR 64,249,57344
buffer_load_dwordx4 v239, s[48:51], s69 offen offset:1024 lds
v_mul_f32 v140, v140, v117
MV 40,v,76,a,44
TR 66,249,58368
v_mul_f32 v141, v141, v117
s_waitcnt lgkmcnt(8)
MV 44,v,80,a,40
buffer_load_dwordx4 a[40:43], v236, s[44:47], s68 offen offset:1024 sc1
v_lshlrev_b32 v142, 16, v95
MV 48,v,80,a,44
buffer_load_dwordx4 a[44:47], v237, s[44:47], s68 offen offset:1024 sc1
s_waitcnt lgkmcnt(6)
MV 20,v,52,a,48
TR 68,246,61440
TR 70,246,62464
v_lshlrev_b32 v152, 16, v111
MV 24,v,52,a,52
TR 72,247,61440
v_and_b32 v143, 0xffff0000, v95
s_waitcnt lgkmcnt(7)
MV 28,v,56,a,48
TR 74,247,62464
v_and_b32 v153, 0xffff0000, v111
MV 32,v,56,a,52
TR 76,248,61440
TR 78,248,62464
s_waitcnt lgkmcnt(8)
MV 36,v,60,a,48
TR 80,249,61440
buffer_load_dwordx4 v240, s[48:51], s69 offen offset:2048 lds
v_mul_f32 v142, v142, v152
MV 40,v,60,a,52
TR 82,249,62464
v_mul_f32 v143, v143, v153
s_waitcnt lgkmcnt(8)
MV 44,v,64,a,48
buffer_load_dwordx4 a[48:51], v236, s[44:47], s68 offen offset:2048 sc1
v_mul_f32 v142, v142, v117
MV 48,v,64,a,52
buffer_load_dwordx4 a[52:55], v237, s[44:47], s68 offen offset:2048 sc1
s_waitcnt vmcnt(35)
s_barrier
s_waitcnt lgkmcnt(6)
MV 20,v,68,a,56
TR 52,242,0
TR 54,242,1024
v_mul_f32 v143, v143, v117
MV 24,v,68,a,60
TR 56,243,0
v_lshlrev_b32 v144, 16, v96
s_waitcnt lgkmcnt(7)
MV 28,v,72,a,56
TR 58,243,1024
v_lshlrev_b32 v152, 16, v112
MV 32,v,72,a,60
TR 60,244,0
TR 62,244,1024
v_and_b32 v145, 0xffff0000, v96
s_waitcnt lgkmcnt(8)
MV 36,v,76,a,56
TR 64,245,0
buffer_load_dwordx4 v241, s[48:51], s69 offen offset:3072 lds
v_and_b32 v153, 0xffff0000, v112
MV 40,v,76,a,60
TR 66,245,1024
v_mul_f32 v144, v144, v152
s_waitcnt lgkmcnt(8)
MV 44,v,80,a,56
buffer_load_dwordx4 a[56:59], v236, s[44:47], s68 offen offset:3072 sc1
v_mul_f32 v145, v145, v153
MV 48,v,80,a,60
buffer_load_dwordx4 a[60:63], v237, s[44:47], s68 offen offset:3072 sc1
s_add_u32 s68, s68, 4096
s_add_u32 s69, s69, 262144
s_waitcnt lgkmcnt(6)
MV 20,v,52,a,64
TR 68,242,4096
TR 70,242,5120
v_mul_f32 v144, v144, v117
MV 24,v,52,a,68
TR 72,243,4096
v_mul_f32 v145, v145, v117
s_waitcnt lgkmcnt(7)
MV 28,v,56,a,64
TR 74,243,5120
s_add_u32 m0, s70, 65536
v_lshlrev_b32 v146, 16, v97
MV 32,v,56,a,68
TR 76,244,4096
TR 78,244,5120
s_waitcnt lgkmcnt(8)
MV 36,v,60,a,64
TR 80,245,4096
buffer_load_dwordx4 v238, s[48:51], s69 offen offset:0 lds
v_lshlrev_b32 v152, 16, v113
MV 40,v,60,a,68
TR 82,245,5120
v_and_b32 v147, 0xffff0000, v97
s_waitcnt lgkmcnt(8)
MV 44,v,64,a,64
buffer_load_dwordx4 a[64:67], v236, s[44:47], s68 offen offset:0 sc1
v_and_b32 v153, 0xffff0000, v113
MV 48,v,64,a,68
buffer_load_dwordx4 a[68:71], v237, s[44:47], s68 offen offset:0 sc1
s_waitcnt lgkmcnt(6)
MV 20,v,68,a,72
TR 52,242,8192
TR 54,242,9216
v_mul_f32 v146, v146, v152
MV 24,v,68,a,76
TR 56,243,8192
v_mul_f32 v147, v147, v153
s_waitcnt lgkmcnt(7)
MV 28,v,72,a,72
TR 58,243,9216
v_mul_f32 v146, v146, v117
MV 32,v,72,a,76
TR 60,244,8192
TR 62,244,9216
v_mul_f32 v147, v147, v117
s_waitcnt lgkmcnt(8)
MV 36,v,76,a,72
TR 64,245,8192
buffer_load_dwordx4 v239, s[48:51], s69 offen offset:1024 lds
v_lshlrev_b32 v148, 16, v98
MV 40,v,76,a,76
TR 66,245,9216
v_lshlrev_b32 v152, 16, v114
s_waitcnt lgkmcnt(8)
MV 44,v,80,a,72
buffer_load_dwordx4 a[72:75], v236, s[44:47], s68 offen offset:1024 sc1
v_and_b32 v149, 0xffff0000, v98
MV 48,v,80,a,76
buffer_load_dwordx4 a[76:79], v237, s[44:47], s68 offen offset:1024 sc1
s_waitcnt lgkmcnt(6)
MV 20,v,52,a,80
TR 68,242,12288
TR 70,242,13312
v_and_b32 v153, 0xffff0000, v114
MV 24,v,52,a,84
TR 72,243,12288
v_mul_f32 v148, v148, v152
s_waitcnt lgkmcnt(7)
MV 28,v,56,a,80
TR 74,243,13312
v_mul_f32 v149, v149, v153
MV 32,v,56,a,84
TR 76,244,12288
TR 78,244,13312
s_waitcnt lgkmcnt(8)
MV 36,v,60,a,80
TR 80,245,12288
buffer_load_dwordx4 v240, s[48:51], s69 offen offset:2048 lds
v_mul_f32 v148, v148, v117
MV 40,v,60,a,84
TR 82,245,13312
v_mul_f32 v149, v149, v117
s_waitcnt lgkmcnt(8)
MV 44,v,64,a,80
buffer_load_dwordx4 a[80:83], v236, s[44:47], s68 offen offset:2048 sc1
v_lshlrev_b32 v150, 16, v99
MV 48,v,64,a,84
buffer_load_dwordx4 a[84:87], v237, s[44:47], s68 offen offset:2048 sc1
s_waitcnt vmcnt(35)
s_barrier
s_waitcnt lgkmcnt(6)
MV 20,v,68,a,88
TR 52,242,16384
TR 54,242,17408
v_lshlrev_b32 v152, 16, v115
MV 24,v,68,a,92
TR 56,243,16384
v_and_b32 v151, 0xffff0000, v99
s_waitcnt lgkmcnt(7)
MV 28,v,72,a,88
TR 58,243,17408
v_and_b32 v153, 0xffff0000, v115
MV 32,v,72,a,92
TR 60,244,16384
TR 62,244,17408
v_mul_f32 v150, v150, v152
s_waitcnt lgkmcnt(8)
MV 36,v,76,a,88
TR 64,245,16384
buffer_load_dwordx4 v241, s[48:51], s69 offen offset:3072 lds
v_mul_f32 v151, v151, v153
MV 40,v,76,a,92
TR 66,245,17408
v_mul_f32 v150, v150, v117
s_waitcnt lgkmcnt(8)
MV 44,v,80,a,88
buffer_load_dwordx4 a[88:91], v236, s[44:47], s68 offen offset:3072 sc1
v_mul_f32 v151, v151, v117
MV 48,v,80,a,92
buffer_load_dwordx4 a[92:95], v237, s[44:47], s68 offen offset:3072 sc1
s_add_u32 s68, s68, 4096
s_add_u32 s69, s69, 262144
s_waitcnt lgkmcnt(6)
MV 20,v,52,a,96
TR 68,242,20480
TR 70,242,21504
MV 24,v,52,a,100
TR 72,243,20480
s_waitcnt lgkmcnt(7)
MV 28,v,56,a,96
TR 74,243,21504
s_add_u32 m0, s70, 81920
MV 32,v,56,a,100
TR 76,244,20480
TR 78,244,21504
s_waitcnt lgkmcnt(8)
MV 36,v,60,a,96
TR 80,245,20480
buffer_load_dwordx4 v238, s[48:51], s69 offen offset:0 lds
MV 40,v,60,a,100
TR 82,245,21504
s_waitcnt lgkmcnt(8)
MV 44,v,64,a,96
buffer_load_dwordx4 a[96:99], v236, s[44:47], s68 offen offset:0 sc1
MV 48,v,64,a,100
buffer_load_dwordx4 a[100:103], v237, s[44:47], s68 offen offset:0 sc1
s_waitcnt lgkmcnt(6)
MV 20,v,68,a,104
TR 52,242,24576
TR 54,242,25600
MV 24,v,68,a,108
TR 56,243,24576
s_waitcnt lgkmcnt(7)
MV 28,v,72,a,104
TR 58,243,25600
MV 32,v,72,a,108
TR 60,244,24576
TR 62,244,25600
s_waitcnt lgkmcnt(8)
MV 36,v,76,a,104
TR 64,245,24576
buffer_load_dwordx4 v239, s[48:51], s69 offen offset:1024 lds
MV 40,v,76,a,108
TR 66,245,25600
s_waitcnt lgkmcnt(8)
MV 44,v,80,a,104
buffer_load_dwordx4 a[104:107], v236, s[44:47], s68 offen offset:1024 sc1
MV 48,v,80,a,108
buffer_load_dwordx4 a[108:111], v237, s[44:47], s68 offen offset:1024 sc1
s_waitcnt lgkmcnt(6)
MV 20,v,52,a,112
TR 68,242,28672
TR 70,242,29696
MV 24,v,52,a,116
TR 72,243,28672
s_waitcnt lgkmcnt(7)
MV 28,v,56,a,112
TR 74,243,29696
MV 32,v,56,a,116
TR 76,244,28672
TR 78,244,29696
s_waitcnt lgkmcnt(8)
MV 36,v,60,a,112
TR 80,245,28672
buffer_load_dwordx4 v240, s[48:51], s69 offen offset:2048 lds
MV 40,v,60,a,116
TR 82,245,29696
s_waitcnt lgkmcnt(8)
MV 44,v,64,a,112
buffer_load_dwordx4 a[112:115], v236, s[44:47], s68 offen offset:2048 sc1
MV 48,v,64,a,116
buffer_load_dwordx4 a[116:119], v237, s[44:47], s68 offen offset:2048 sc1
s_waitcnt vmcnt(35)
s_barrier
s_waitcnt lgkmcnt(6)
MV 20,v,68,a,120
TR 52,242,32768
TR 54,242,33792
MV 24,v,68,a,124
TR 56,243,32768
s_waitcnt lgkmcnt(7)
MV 28,v,72,a,120
TR 58,243,33792
MV 32,v,72,a,124
TR 60,244,32768
TR 62,244,33792
s_waitcnt lgkmcnt(8)
MV 36,v,76,a,120
TR 64,245,32768
buffer_load_dwordx4 v241, s[48:51], s69 offen offset:3072 lds
MV 40,v,76,a,124
TR 66,245,33792
s_waitcnt lgkmcnt(8)
MV 44,v,80,a,120
buffer_load_dwordx4 a[120:123], v236, s[44:47], s68 offen offset:3072 sc1
MV 48,v,80,a,124
buffer_load_dwordx4 a[124:127], v237, s[44:47], s68 offen offset:3072 sc1
s_add_u32 s68, s68, 4096
s_add_u32 s69, s69, 262144
s_waitcnt lgkmcnt(6)
MV 20,v,52,a,0
TR 68,242,36864
TR 70,242,37888
MV 24,v,52,a,4
TR 72,243,36864
s_waitcnt lgkmcnt(7)
MV 28,v,56,a,0
TR 74,243,37888
MV 32,v,56,a,4
TR 76,244,36864
TR 78,244,37888
s_waitcnt lgkmcnt(8)
MV 36,v,60,a,0
TR 80,245,36864
MV 40,v,60,a,4
TR 82,245,37888
s_waitcnt lgkmcnt(8)
MV 44,v,64,a,0
MV 48,v,64,a,4
s_waitcnt lgkmcnt(6)
MV 20,v,68,a,8
TR 52,242,40960
TR 54,242,41984
MV 24,v,68,a,12
TR 56,243,40960
s_waitcnt lgkmcnt(7)
MV 28,v,72,a,8
TR 58,243,41984
MV 32,v,72,a,12
TR 60,244,40960
TR 62,244,41984
s_waitcnt lgkmcnt(8)
MV 36,v,76,a,8
TR 64,245,40960
MV 40,v,76,a,12
TR 66,245,41984
s_waitcnt lgkmcnt(8)
MV 44,v,80,a,8
MV 48,v,80,a,12
s_waitcnt lgkmcnt(6)
MV 20,v,52,a,16
TR 68,242,45056
TR 70,242,46080
MV 24,v,52,a,20
TR 72,243,45056
s_waitcnt lgkmcnt(7)
MV 28,v,56,a,16
TR 74,243,46080
MV 32,v,56,a,20
TR 76,244,45056
TR 78,244,46080
s_waitcnt lgkmcnt(8)
MV 36,v,60,a,16
TR 80,245,45056
MV 40,v,60,a,20
TR 82,245,46080
s_waitcnt lgkmcnt(8)
MV 44,v,64,a,16
MV 48,v,64,a,20
s_waitcnt vmcnt(26)
s_barrier
s_waitcnt lgkmcnt(6)
MV 20,v,68,a,24
TR 52,242,49152
TR 54,242,50176
MV 24,v,68,a,28
TR 56,243,49152
s_waitcnt lgkmcnt(7)
MV 28,v,72,a,24
TR 58,243,50176
MV 32,v,72,a,28
TR 60,244,49152
TR 62,244,50176
s_waitcnt lgkmcnt(8)
MV 36,v,76,a,24
TR 64,245,49152
MV 40,v,76,a,28
TR 66,245,50176
s_waitcnt lgkmcnt(8)
MV 44,v,80,a,24
MV 48,v,80,a,28
s_waitcnt lgkmcnt(6)
MV 20,v,52,a,32
TR 68,242,53248
TR 70,242,54272
MV 24,v,52,a,36
TR 72,243,53248
s_waitcnt lgkmcnt(7)
MV 28,v,56,a,32
TR 74,243,54272
MV 32,v,56,a,36
TR 76,244,53248
TR 78,244,54272
s_waitcnt lgkmcnt(8)
MV 36,v,60,a,32
TR 80,245,53248
MV 40,v,60,a,36
TR 82,245,54272
s_waitcnt lgkmcnt(8)
MV 44,v,64,a,32
MV 48,v,64,a,36
s_waitcnt lgkmcnt(6)
MV 20,v,68,a,40
TR 52,242,57344
TR 54,242,58368
MV 24,v,68,a,44
TR 56,243,57344
s_waitcnt lgkmcnt(7)
MV 28,v,72,a,40
TR 58,243,58368
MV 32,v,72,a,44
TR 60,244,57344
TR 62,244,58368
s_waitcnt lgkmcnt(8)
MV 36,v,76,a,40
TR 64,245,57344
MV 40,v,76,a,44
TR 66,245,58368
s_waitcnt lgkmcnt(8)
MV 44,v,80,a,40
MV 48,v,80,a,44
s_waitcnt lgkmcnt(6)
MV 20,v,52,a,48
TR 68,242,61440
TR 70,242,62464
MV 24,v,52,a,52
TR 72,243,61440
s_waitcnt lgkmcnt(7)
MV 28,v,56,a,48
TR 74,243,62464
MV 32,v,56,a,52
TR 76,244,61440
TR 78,244,62464
s_waitcnt lgkmcnt(8)
MV 36,v,60,a,48
TR 80,245,61440
MV 40,v,60,a,52
TR 82,245,62464
s_waitcnt lgkmcnt(8)
MV 44,v,64,a,48
MV 48,v,64,a,52
s_waitcnt vmcnt(14)
s_barrier
s_waitcnt lgkmcnt(6)
MV 20,v,68,a,56
TR 52,246,0
TR 54,246,1024
MV 24,v,68,a,60
TR 56,247,0
s_waitcnt lgkmcnt(7)
MV 28,v,72,a,56
TR 58,247,1024
MV 32,v,72,a,60
TR 60,248,0
TR 62,248,1024
s_waitcnt lgkmcnt(8)
MV 36,v,76,a,56
TR 64,249,0
MV 40,v,76,a,60
TR 66,249,1024
s_waitcnt lgkmcnt(8)
MV 44,v,80,a,56
MV 48,v,80,a,60
s_waitcnt lgkmcnt(6)
MV 20,v,52,a,64
TR 68,246,4096
TR 70,246,5120
MV 24,v,52,a,68
TR 72,247,4096
s_waitcnt lgkmcnt(7)
MV 28,v,56,a,64
TR 74,247,5120
MV 32,v,56,a,68
TR 76,248,4096
TR 78,248,5120
s_waitcnt lgkmcnt(8)
MV 36,v,60,a,64
TR 80,249,4096
MV 40,v,60,a,68
TR 82,249,5120
s_waitcnt lgkmcnt(8)
MV 44,v,64,a,64
MV 48,v,64,a,68
s_waitcnt lgkmcnt(6)
MV 20,v,68,a,72
TR 52,246,8192
TR 54,246,9216
MV 24,v,68,a,76
TR 56,247,8192
s_waitcnt lgkmcnt(7)
MV 28,v,72,a,72
TR 58,247,9216
MV 32,v,72,a,76
TR 60,248,8192
TR 62,248,9216
s_waitcnt lgkmcnt(8)
MV 36,v,76,a,72
TR 64,249,8192
MV 40,v,76,a,76
TR 66,249,9216
s_waitcnt lgkmcnt(8)
MV 44,v,80,a,72
MV 48,v,80,a,76
s_waitcnt lgkmcnt(6)
MV 20,v,52,a,80
TR 68,246,12288
TR 70,246,13312
MV 24,v,52,a,84
TR 72,247,12288
s_waitcnt lgkmcnt(7)
MV 28,v,56,a,80
TR 74,247,13312
MV 32,v,56,a,84
TR 76,248,12288
TR 78,248,13312
s_waitcnt lgkmcnt(8)
MV 36,v,60,a,80
TR 80,249,12288
MV 40,v,60,a,84
TR 82,249,13312
s_waitcnt lgkmcnt(8)
MV 44,v,64,a,80
MV 48,v,64,a,84
s_waitcnt vmcnt(2)
s_barrier
s_waitcnt lgkmcnt(6)
MV 20,v,68,a,88
TR 52,246,16384
TR 54,246,17408
MV 24,v,68,a,92
TR 56,247,16384
s_waitcnt lgkmcnt(7)
MV 28,v,72,a,88
TR 58,247,17408
MV 32,v,72,a,92
TR 60,248,16384
TR 62,248,17408
s_waitcnt lgkmcnt(8)
MV 36,v,76,a,88
TR 64,249,16384
MV 40,v,76,a,92
TR 66,249,17408
s_waitcnt lgkmcnt(8)
MV 44,v,80,a,88
MV 48,v,80,a,92
s_waitcnt lgkmcnt(6)
MV 20,v,52,a,96
TR 68,246,20480
TR 70,246,21504
MV 24,v,52,a,100
TR 72,247,20480
s_waitcnt lgkmcnt(7)
MV 28,v,56,a,96
TR 74,247,21504
MV 32,v,56,a,100
TR 76,248,20480
TR 78,248,21504
s_waitcnt lgkmcnt(8)
MV 36,v,60,a,96
TR 80,249,20480
MV 40,v,60,a,100
TR 82,249,21504
s_waitcnt lgkmcnt(8)
MV 44,v,64,a,96
MV 48,v,64,a,100
s_waitcnt lgkmcnt(6)
MV 20,v,68,a,104
TR 52,246,24576
TR 54,246,25600
MV 24,v,68,a,108
TR 56,247,24576
s_waitcnt lgkmcnt(7)
MV 28,v,72,a,104
TR 58,247,25600
MV 32,v,72,a,108
TR 60,248,24576
TR 62,248,25600
s_waitcnt lgkmcnt(8)
MV 36,v,76,a,104
TR 64,249,24576
MV 40,v,76,a,108
TR 66,249,25600
s_waitcnt lgkmcnt(8)
MV 44,v,80,a,104
MV 48,v,80,a,108
s_waitcnt lgkmcnt(6)
MV 20,v,52,a,112
TR 68,246,28672
TR 70,246,29696
MV 24,v,52,a,116
TR 72,247,28672
s_waitcnt lgkmcnt(7)
MV 28,v,56,a,112
TR 74,247,29696
MV 32,v,56,a,116
TR 76,248,28672
TR 78,248,29696
s_waitcnt lgkmcnt(8)
MV 36,v,60,a,112
TR 80,249,28672
MV 40,v,60,a,116
TR 82,249,29696
s_waitcnt lgkmcnt(8)
MV 44,v,64,a,112
MV 48,v,64,a,116
s_waitcnt vmcnt(1) lgkmcnt(6)
MV 20,v,68,a,120
s_waitcnt vmcnt(0)
MV 24,v,68,a,124
s_waitcnt lgkmcnt(4)
MV 28,v,72,a,120
MV 32,v,72,a,124
s_waitcnt lgkmcnt(2)
MV 36,v,76,a,120
MV 40,v,76,a,124
s_waitcnt lgkmcnt(0)
MV 44,v,80,a,120
MV 48,v,80,a,124
s_nop 0
v_permlane16_swap_b32 v20, v28
v_permlane16_swap_b32 v21, v29
v_permlane16_swap_b32 v22, v30
v_permlane16_swap_b32 v23, v31
s_nop 1
v_permlane16_swap_b32 v36, v44
v_permlane16_swap_b32 v37, v45
v_permlane16_swap_b32 v38, v46
v_permlane16_swap_b32 v39, v47
v_permlane16_swap_b32 v24, v32
v_permlane16_swap_b32 v25, v33
v_permlane16_swap_b32 v26, v34
v_permlane16_swap_b32 v27, v35
v_permlane16_swap_b32 v40, v48
v_permlane16_swap_b32 v41, v49
v_permlane16_swap_b32 v42, v50
v_permlane16_swap_b32 v43, v51
s_add_u32 s72, s78, 0
v_fma_f32 v120, v20, v118, v120
v_fma_f32 v121, v21, v118, v121
v_fma_f32 v122, v22, v118, v122
v_fma_f32 v123, v23, v118, v123
v_fma_f32 v124, v28, v118, v124
v_fma_f32 v125, v29, v118, v125
v_fma_f32 v126, v30, v118, v126
v_fma_f32 v127, v31, v118, v127
v_cvt_pk_bf16_f32 v84, v120, v121
v_cvt_pk_bf16_f32 v85, v122, v123
v_cvt_pk_bf16_f32 v86, v124, v125
v_cvt_pk_bf16_f32 v87, v126, v127
buffer_store_dwordx4 v[84:87], v250, s[60:63], s72 offen offset:0
v_fma_f32 v128, v36, v118, v128
v_fma_f32 v129, v37, v118, v129
v_fma_f32 v130, v38, v118, v130
v_fma_f32 v131, v39, v118, v131
v_fma_f32 v132, v44, v118, v132
v_fma_f32 v133, v45, v118, v133
v_fma_f32 v134, v46, v118, v134
v_fma_f32 v135, v47, v118, v135
v_cvt_pk_bf16_f32 v88, v128, v129
v_cvt_pk_bf16_f32 v89, v130, v131
v_cvt_pk_bf16_f32 v90, v132, v133
v_cvt_pk_bf16_f32 v91, v134, v135
buffer_store_dwordx4 v[88:91], v250, s[60:63], s72 offen offset:64
s_add_u32 s72, s78, 32768
v_fma_f32 v136, v24, v119, v136
v_fma_f32 v137, v25, v119, v137
v_fma_f32 v138, v26, v119, v138
v_fma_f32 v139, v27, v119, v139
v_fma_f32 v140, v32, v119, v140
v_fma_f32 v141, v33, v119, v141
v_fma_f32 v142, v34, v119, v142
v_fma_f32 v143, v35, v119, v143
v_cvt_pk_bf16_f32 v92, v136, v137
v_cvt_pk_bf16_f32 v93, v138, v139
v_cvt_pk_bf16_f32 v94, v140, v141
v_cvt_pk_bf16_f32 v95, v142, v143
buffer_store_dwordx4 v[92:95], v250, s[60:63], s72 offen offset:0
v_fma_f32 v144, v40, v119, v144
v_fma_f32 v145, v41, v119, v145
v_fma_f32 v146, v42, v119, v146
v_fma_f32 v147, v43, v119, v147
v_fma_f32 v148, v48, v119, v148
v_fma_f32 v149, v49, v119, v149
v_fma_f32 v150, v50, v119, v150
v_fma_f32 v151, v51, v119, v151
v_cvt_pk_bf16_f32 v96, v144, v145
v_cvt_pk_bf16_f32 v97, v146, v147
v_cvt_pk_bf16_f32 v98, v148, v149
v_cvt_pk_bf16_f32 v99, v150, v151
buffer_store_dwordx4 v[96:99], v250, s[60:63], s72 offen offset:64
L_end:
s_endpgm
L_p3_pmask:
s_nop 7
s_lshl_b32 s81, s80, 1
s_sub_u32 s81, s3, s81
s_lshl_b32 s81, s81, 5
v_add_u32 v240, s81, v13
v_add_u32 v241, -32, v240
v_cmp_gt_i32_e64 s[84:85], 0, v240
v_cmp_gt_i32_e64 s[86:87], 1, v240
v_cmp_gt_i32_e64 s[88:89], 2, v240
v_cmp_gt_i32_e64 s[90:91], 3, v240
v_cmp_gt_i32_e64 s[92:93], 16, v240
v_cmp_gt_i32_e64 s[94:95], 17, v240
v_cmp_gt_i32_e64 s[96:97], 18, v240
v_cmp_gt_i32_e64 s[98:99], 19, v240
v_cndmask_b32_e64 v96, v96, v14, s[84:85]
v_cndmask_b32_e64 v97, v97, v14, s[86:87]
v_cndmask_b32_e64 v98, v98, v14, s[88:89]
v_cndmask_b32_e64 v99, v99, v14, s[90:91]
v_cndmask_b32_e64 v100, v100, v14, s[92:93]
v_cndmask_b32_e64 v101, v101, v14, s[94:95]
v_cndmask_b32_e64 v102, v102, v14, s[96:97]
v_cndmask_b32_e64 v103, v103, v14, s[98:99]
v_cmp_gt_i32_e64 s[84:85], 8, v240
v_cmp_gt_i32_e64 s[86:87], 9, v240
v_cmp_gt_i32_e64 s[88:89], 10, v240
v_cmp_gt_i32_e64 s[90:91], 11, v240
v_cmp_gt_i32_e64 s[92:93], 24, v240
v_cmp_gt_i32_e64 s[94:95], 25, v240
v_cmp_gt_i32_e64 s[96:97], 26, v240
v_cmp_gt_i32_e64 s[98:99], 27, v240
v_cndmask_b32_e64 v104, v104, v14, s[84:85]
v_cndmask_b32_e64 v105, v105, v14, s[86:87]
v_cndmask_b32_e64 v106, v106, v14, s[88:89]
v_cndmask_b32_e64 v107, v107, v14, s[90:91]
v_cndmask_b32_e64 v108, v108, v14, s[92:93]
v_cndmask_b32_e64 v109, v109, v14, s[94:95]
v_cndmask_b32_e64 v110, v110, v14, s[96:97]
v_cndmask_b32_e64 v111, v111, v14, s[98:99]
v_cmp_gt_i32_e64 s[84:85], 0, v241
v_cmp_gt_i32_e64 s[86:87], 1, v241
v_cmp_gt_i32_e64 s[88:89], 2, v241
v_cmp_gt_i32_e64 s[90:91], 3, v241
v_cmp_gt_i32_e64 s[92:93], 16, v241
v_cmp_gt_i32_e64 s[94:95], 17, v241
v_cmp_gt_i32_e64 s[96:97], 18, v241
v_cmp_gt_i32_e64 s[98:99], 19, v241
v_cndmask_b32_e64 v128, v128, v14, s[84:85]
v_cndmask_b32_e64 v129, v129, v14, s[86:87]
v_cndmask_b32_e64 v130, v130, v14, s[88:89]
v_cndmask_b32_e64 v131, v131, v14, s[90:91]
v_cndmask_b32_e64 v132, v132, v14, s[92:93]
v_cndmask_b32_e64 v133, v133, v14, s[94:95]
v_cndmask_b32_e64 v134, v134, v14, s[96:97]
v_cndmask_b32_e64 v135, v135, v14, s[98:99]
v_cmp_gt_i32_e64 s[84:85], 8, v241
v_cmp_gt_i32_e64 s[86:87], 9, v241
v_cmp_gt_i32_e64 s[88:89], 10, v241
v_cmp_gt_i32_e64 s[90:91], 11, v241
v_cmp_gt_i32_e64 s[92:93], 24, v241
v_cmp_gt_i32_e64 s[94:95], 25, v241
v_cmp_gt_i32_e64 s[96:97], 26, v241
v_cmp_gt_i32_e64 s[98:99], 27, v241
v_cndmask_b32_e64 v136, v136, v14, s[84:85]
v_cndmask_b32_e64 v137, v137, v14, s[86:87]
v_cndmask_b32_e64 v138, v138, v14, s[88:89]
v_cndmask_b32_e64 v139, v139, v14, s[90:91]
v_cndmask_b32_e64 v140, v140, v14, s[92:93]
v_cndmask_b32_e64 v141, v141, v14, s[94:95]
v_cndmask_b32_e64 v142, v142, v14, s[96:97]
v_cndmask_b32_e64 v143, v143, v14, s[98:99]
s_branch L_p3_pmask_ret
L_p3_d0_mask:
s_nop 7
s_lshl_b32 s81, s80, 1
s_sub_u32 s81, s3, s81
s_lshl_b32 s81, s81, 5
v_add_u32 v240, s81, v13
v_add_u32 v241, -32, v240
v_cmp_gt_i32_e64 s[84:85], 0, v240
v_cmp_gt_i32_e64 s[86:87], 1, v240
v_cmp_gt_i32_e64 s[88:89], 2, v240
v_cmp_gt_i32_e64 s[90:91], 3, v240
v_cmp_gt_i32_e64 s[92:93], 16, v240
v_cmp_gt_i32_e64 s[94:95], 17, v240
v_cmp_gt_i32_e64 s[96:97], 18, v240
v_cmp_gt_i32_e64 s[98:99], 19, v240
v_cndmask_b32_e64 v160, v160, v14, s[84:85]
v_cndmask_b32_e64 v161, v161, v14, s[86:87]
v_cndmask_b32_e64 v162, v162, v14, s[88:89]
v_cndmask_b32_e64 v163, v163, v14, s[90:91]
v_cndmask_b32_e64 v164, v164, v14, s[92:93]
v_cndmask_b32_e64 v165, v165, v14, s[94:95]
v_cndmask_b32_e64 v166, v166, v14, s[96:97]
v_cndmask_b32_e64 v167, v167, v14, s[98:99]
v_cmp_gt_i32_e64 s[84:85], 8, v240
v_cmp_gt_i32_e64 s[86:87], 9, v240
v_cmp_gt_i32_e64 s[88:89], 10, v240
v_cmp_gt_i32_e64 s[90:91], 11, v240
v_cmp_gt_i32_e64 s[92:93], 24, v240
v_cmp_gt_i32_e64 s[94:95], 25, v240
v_cmp_gt_i32_e64 s[96:97], 26, v240
v_cmp_gt_i32_e64 s[98:99], 27, v240
v_cndmask_b32_e64 v168, v168, v14, s[84:85]
v_cndmask_b32_e64 v169, v169, v14, s[86:87]
v_cndmask_b32_e64 v170, v170, v14, s[88:89]
v_cndmask_b32_e64 v171, v171, v14, s[90:91]
v_cndmask_b32_e64 v172, v172, v14, s[92:93]
v_cndmask_b32_e64 v173, v173, v14, s[94:95]
v_cndmask_b32_e64 v174, v174, v14, s[96:97]
v_cndmask_b32_e64 v175, v175, v14, s[98:99]
v_cmp_gt_i32_e64 s[84:85], 0, v241
v_cmp_gt_i32_e64 s[86:87], 1, v241
v_cmp_gt_i32_e64 s[88:89], 2, v241
v_cmp_gt_i32_e64 s[90:91], 3, v241
v_cmp_gt_i32_e64 s[92:93], 16, v241
v_cmp_gt_i32_e64 s[94:95], 17, v241
v_cmp_gt_i32_e64 s[96:97], 18, v241
v_cmp_gt_i32_e64 s[98:99], 19, v241
v_cndmask_b32_e64 v192, v192, v14, s[84:85]
v_cndmask_b32_e64 v193, v193, v14, s[86:87]
v_cndmask_b32_e64 v194, v194, v14, s[88:89]
v_cndmask_b32_e64 v195, v195, v14, s[90:91]
v_cndmask_b32_e64 v196, v196, v14, s[92:93]
v_cndmask_b32_e64 v197, v197, v14, s[94:95]
v_cndmask_b32_e64 v198, v198, v14, s[96:97]
v_cndmask_b32_e64 v199, v199, v14, s[98:99]
v_cmp_gt_i32_e64 s[84:85], 8, v241
v_cmp_gt_i32_e64 s[86:87], 9, v241
v_cmp_gt_i32_e64 s[88:89], 10, v241
v_cmp_gt_i32_e64 s[90:91], 11, v241
v_cmp_gt_i32_e64 s[92:93], 24, v241
v_cmp_gt_i32_e64 s[94:95], 25, v241
v_cmp_gt_i32_e64 s[96:97], 26, v241
v_cmp_gt_i32_e64 s[98:99], 27, v241
v_cndmask_b32_e64 v200, v200, v14, s[84:85]
v_cndmask_b32_e64 v201, v201, v14, s[86:87]
v_cndmask_b32_e64 v202, v202, v14, s[88:89]
v_cndmask_b32_e64 v203, v203, v14, s[90:91]
v_cndmask_b32_e64 v204, v204, v14, s[92:93]
v_cndmask_b32_e64 v205, v205, v14, s[94:95]
v_cndmask_b32_e64 v206, v206, v14, s[96:97]
v_cndmask_b32_e64 v207, v207, v14, s[98:99]
s_branch L_p3_d0_mask_ret
L_p3_d0_rare:
v_mov_b32 v240, v6
v_mov_b32 v241, v6
s_nop 1
v_permlane32_swap_b32 v240, v241
v_max_f32 v242, v240, v241
v_max_f32 v242, 0, v242
v_exp_f32 v8, -v242
v_sub_f32 v208, v208, v242
v_sub_f32 v209, v209, v242
v_sub_f32 v210, v210, v242
v_sub_f32 v211, v211, v242
v_sub_f32 v212, v212, v242
v_sub_f32 v213, v213, v242
v_sub_f32 v214, v214, v242
v_sub_f32 v215, v215, v242
v_sub_f32 v216, v216, v242
v_sub_f32 v217, v217, v242
v_sub_f32 v218, v218, v242
v_sub_f32 v219, v219, v242
v_sub_f32 v220, v220, v242
v_sub_f32 v221, v221, v242
v_sub_f32 v222, v222, v242
v_sub_f32 v223, v223, v242
v_mul_f32 v2, v2, v8
v_mul_f32 v3, v3, v8
v_sub_f32 v144, v144, v242
v_sub_f32 v145, v145, v242
v_sub_f32 v146, v146, v242
v_sub_f32 v147, v147, v242
v_sub_f32 v148, v148, v242
v_sub_f32 v149, v149, v242
v_sub_f32 v150, v150, v242
v_sub_f32 v151, v151, v242
v_sub_f32 v152, v152, v242
v_sub_f32 v153, v153, v242
v_sub_f32 v154, v154, v242
v_sub_f32 v155, v155, v242
v_sub_f32 v156, v156, v242
v_sub_f32 v157, v157, v242
v_sub_f32 v158, v158, v242
v_sub_f32 v159, v159, v242
v_sub_f32 v176, v176, v242
v_sub_f32 v177, v177, v242
v_sub_f32 v178, v178, v242
v_sub_f32 v179, v179, v242
v_sub_f32 v180, v180, v242
v_sub_f32 v181, v181, v242
v_sub_f32 v182, v182, v242
v_sub_f32 v183, v183, v242
v_sub_f32 v184, v184, v242
v_sub_f32 v185, v185, v242
v_sub_f32 v186, v186, v242
v_sub_f32 v187, v187, v242
v_sub_f32 v188, v188, v242
v_sub_f32 v189, v189, v242
v_sub_f32 v190, v190, v242
v_sub_f32 v191, v191, v242
v_mov_b32 v240, v7
v_mov_b32 v241, v7
s_nop 1
v_permlane32_swap_b32 v240, v241
v_max_f32 v242, v240, v241
v_max_f32 v242, 0, v242
v_exp_f32 v9, -v242
v_sub_f32 v224, v224, v242
v_sub_f32 v225, v225, v242
v_sub_f32 v226, v226, v242
v_sub_f32 v227, v227, v242
v_sub_f32 v228, v228, v242
v_sub_f32 v229, v229, v242
v_sub_f32 v230, v230, v242
v_sub_f32 v231, v231, v242
v_sub_f32 v232, v232, v242
v_sub_f32 v233, v233, v242
v_sub_f32 v234, v234, v242
v_sub_f32 v235, v235, v242
v_sub_f32 v236, v236, v242
v_sub_f32 v237, v237, v242
v_sub_f32 v238, v238, v242
v_sub_f32 v239, v239, v242
v_mul_f32 v4, v4, v9
v_mul_f32 v5, v5, v9
v_sub_f32 v160, v160, v242
v_sub_f32 v161, v161, v242
v_sub_f32 v162, v162, v242
v_sub_f32 v163, v163, v242
v_sub_f32 v164, v164, v242
v_sub_f32 v165, v165, v242
v_sub_f32 v166, v166, v242
v_sub_f32 v167, v167, v242
v_sub_f32 v168, v168, v242
v_sub_f32 v169, v169, v242
v_sub_f32 v170, v170, v242
v_sub_f32 v171, v171, v242
v_sub_f32 v172, v172, v242
v_sub_f32 v173, v173, v242
v_sub_f32 v174, v174, v242
v_sub_f32 v175, v175, v242
v_sub_f32 v192, v192, v242
v_sub_f32 v193, v193, v242
v_sub_f32 v194, v194, v242
v_sub_f32 v195, v195, v242
v_sub_f32 v196, v196, v242
v_sub_f32 v197, v197, v242
v_sub_f32 v198, v198, v242
v_sub_f32 v199, v199, v242
v_sub_f32 v200, v200, v242
v_sub_f32 v201, v201, v242
v_sub_f32 v202, v202, v242
v_sub_f32 v203, v203, v242
v_sub_f32 v204, v204, v242
v_sub_f32 v205, v205, v242
v_sub_f32 v206, v206, v242
v_sub_f32 v207, v207, v242
s_mov_b32 s78, 1
s_branch L_p3_d0_rare_ret
L_p3_d0_resc:
s_nop 15
v_accvgpr_read_b32 v240, a0
v_accvgpr_read_b32 v241, a1
v_accvgpr_read_b32 v242, a2
v_accvgpr_read_b32 v243, a3
v_accvgpr_read_b32 v244, a4
v_accvgpr_read_b32 v245, a5
v_accvgpr_read_b32 v246, a6
v_accvgpr_read_b32 v247, a7
v_mul_f32 v240, v240, v8
v_mul_f32 v241, v241, v8
v_mul_f32 v242, v242, v8
v_mul_f32 v243, v243, v8
v_mul_f32 v244, v244, v8
v_mul_f32 v245, v245, v8
v_mul_f32 v246, v246, v8
v_mul_f32 v247, v247, v8
v_accvgpr_write_b32 a0, v240
v_accvgpr_write_b32 a1, v241
v_accvgpr_write_b32 a2, v242
v_accvgpr_write_b32 a3, v243
v_accvgpr_write_b32 a4, v244
v_accvgpr_write_b32 a5, v245
v_accvgpr_write_b32 a6, v246
v_accvgpr_write_b32 a7, v247
v_accvgpr_read_b32 v240, a8
v_accvgpr_read_b32 v241, a9
v_accvgpr_read_b32 v242, a10
v_accvgpr_read_b32 v243, a11
v_accvgpr_read_b32 v244, a12
v_accvgpr_read_b32 v245, a13
v_accvgpr_read_b32 v246, a14
v_accvgpr_read_b32 v247, a15
v_mul_f32 v240, v240, v8
v_mul_f32 v241, v241, v8
v_mul_f32 v242, v242, v8
v_mul_f32 v243, v243, v8
v_mul_f32 v244, v244, v8
v_mul_f32 v245, v245, v8
v_mul_f32 v246, v246, v8
v_mul_f32 v247, v247, v8
v_accvgpr_write_b32 a8, v240
v_accvgpr_write_b32 a9, v241
v_accvgpr_write_b32 a10, v242
v_accvgpr_write_b32 a11, v243
v_accvgpr_write_b32 a12, v244
v_accvgpr_write_b32 a13, v245
v_accvgpr_write_b32 a14, v246
v_accvgpr_write_b32 a15, v247
v_accvgpr_read_b32 v240, a16
v_accvgpr_read_b32 v241, a17
v_accvgpr_read_b32 v242, a18
v_accvgpr_read_b32 v243, a19
v_accvgpr_read_b32 v244, a20
v_accvgpr_read_b32 v245, a21
v_accvgpr_read_b32 v246, a22
v_accvgpr_read_b32 v247, a23
v_mul_f32 v240, v240, v8
v_mul_f32 v241, v241, v8
v_mul_f32 v242, v242, v8
v_mul_f32 v243, v243, v8
v_mul_f32 v244, v244, v8
v_mul_f32 v245, v245, v8
v_mul_f32 v246, v246, v8
v_mul_f32 v247, v247, v8
v_accvgpr_write_b32 a16, v240
v_accvgpr_write_b32 a17, v241
v_accvgpr_write_b32 a18, v242
v_accvgpr_write_b32 a19, v243
v_accvgpr_write_b32 a20, v244
v_accvgpr_write_b32 a21, v245
v_accvgpr_write_b32 a22, v246
v_accvgpr_write_b32 a23, v247
v_accvgpr_read_b32 v240, a24
v_accvgpr_read_b32 v241, a25
v_accvgpr_read_b32 v242, a26
v_accvgpr_read_b32 v243, a27
v_accvgpr_read_b32 v244, a28
v_accvgpr_read_b32 v245, a29
v_accvgpr_read_b32 v246, a30
v_accvgpr_read_b32 v247, a31
v_mul_f32 v240, v240, v8
v_mul_f32 v241, v241, v8
v_mul_f32 v242, v242, v8
v_mul_f32 v243, v243, v8
v_mul_f32 v244, v244, v8
v_mul_f32 v245, v245, v8
v_mul_f32 v246, v246, v8
v_mul_f32 v247, v247, v8
v_accvgpr_write_b32 a24, v240
v_accvgpr_write_b32 a25, v241
v_accvgpr_write_b32 a26, v242
v_accvgpr_write_b32 a27, v243
v_accvgpr_write_b32 a28, v244
v_accvgpr_write_b32 a29, v245
v_accvgpr_write_b32 a30, v246
v_accvgpr_write_b32 a31, v247
v_accvgpr_read_b32 v240, a32
v_accvgpr_read_b32 v241, a33
v_accvgpr_read_b32 v242, a34
v_accvgpr_read_b32 v243, a35
v_accvgpr_read_b32 v244, a36
v_accvgpr_read_b32 v245, a37
v_accvgpr_read_b32 v246, a38
v_accvgpr_read_b32 v247, a39
v_mul_f32 v240, v240, v8
v_mul_f32 v241, v241, v8
v_mul_f32 v242, v242, v8
v_mul_f32 v243, v243, v8
v_mul_f32 v244, v244, v8
v_mul_f32 v245, v245, v8
v_mul_f32 v246, v246, v8
v_mul_f32 v247, v247, v8
v_accvgpr_write_b32 a32, v240
v_accvgpr_write_b32 a33, v241
v_accvgpr_write_b32 a34, v242
v_accvgpr_write_b32 a35, v243
v_accvgpr_write_b32 a36, v244
v_accvgpr_write_b32 a37, v245
v_accvgpr_write_b32 a38, v246
v_accvgpr_write_b32 a39, v247
v_accvgpr_read_b32 v240, a40
v_accvgpr_read_b32 v241, a41
v_accvgpr_read_b32 v242, a42
v_accvgpr_read_b32 v243, a43
v_accvgpr_read_b32 v244, a44
v_accvgpr_read_b32 v245, a45
v_accvgpr_read_b32 v246, a46
v_accvgpr_read_b32 v247, a47
v_mul_f32 v240, v240, v8
v_mul_f32 v241, v241, v8
v_mul_f32 v242, v242, v8
v_mul_f32 v243, v243, v8
v_mul_f32 v244, v244, v8
v_mul_f32 v245, v245, v8
v_mul_f32 v246, v246, v8
v_mul_f32 v247, v247, v8
v_accvgpr_write_b32 a40, v240
v_accvgpr_write_b32 a41, v241
v_accvgpr_write_b32 a42, v242
v_accvgpr_write_b32 a43, v243
v_accvgpr_write_b32 a44, v244
v_accvgpr_write_b32 a45, v245
v_accvgpr_write_b32 a46, v246
v_accvgpr_write_b32 a47, v247
v_accvgpr_read_b32 v240, a48
v_accvgpr_read_b32 v241, a49
v_accvgpr_read_b32 v242, a50
v_accvgpr_read_b32 v243, a51
v_accvgpr_read_b32 v244, a52
v_accvgpr_read_b32 v245, a53
v_accvgpr_read_b32 v246, a54
v_accvgpr_read_b32 v247, a55
v_mul_f32 v240, v240, v8
v_mul_f32 v241, v241, v8
v_mul_f32 v242, v242, v8
v_mul_f32 v243, v243, v8
v_mul_f32 v244, v244, v8
v_mul_f32 v245, v245, v8
v_mul_f32 v246, v246, v8
v_mul_f32 v247, v247, v8
v_accvgpr_write_b32 a48, v240
v_accvgpr_write_b32 a49, v241
v_accvgpr_write_b32 a50, v242
v_accvgpr_write_b32 a51, v243
v_accvgpr_write_b32 a52, v244
v_accvgpr_write_b32 a53, v245
v_accvgpr_write_b32 a54, v246
v_accvgpr_write_b32 a55, v247
v_accvgpr_read_b32 v240, a56
v_accvgpr_read_b32 v241, a57
v_accvgpr_read_b32 v242, a58
v_accvgpr_read_b32 v243, a59
v_accvgpr_read_b32 v244, a60
v_accvgpr_read_b32 v245, a61
v_accvgpr_read_b32 v246, a62
v_accvgpr_read_b32 v247, a63
v_mul_f32 v240, v240, v8
v_mul_f32 v241, v241, v8
v_mul_f32 v242, v242, v8
v_mul_f32 v243, v243, v8
v_mul_f32 v244, v244, v8
v_mul_f32 v245, v245, v8
v_mul_f32 v246, v246, v8
v_mul_f32 v247, v247, v8
v_accvgpr_write_b32 a56, v240
v_accvgpr_write_b32 a57, v241
v_accvgpr_write_b32 a58, v242
v_accvgpr_write_b32 a59, v243
v_accvgpr_write_b32 a60, v244
v_accvgpr_write_b32 a61, v245
v_accvgpr_write_b32 a62, v246
v_accvgpr_write_b32 a63, v247
v_accvgpr_read_b32 v240, a64
v_accvgpr_read_b32 v241, a65
v_accvgpr_read_b32 v242, a66
v_accvgpr_read_b32 v243, a67
v_accvgpr_read_b32 v244, a68
v_accvgpr_read_b32 v245, a69
v_accvgpr_read_b32 v246, a70
v_accvgpr_read_b32 v247, a71
v_mul_f32 v240, v240, v9
v_mul_f32 v241, v241, v9
v_mul_f32 v242, v242, v9
v_mul_f32 v243, v243, v9
v_mul_f32 v244, v244, v9
v_mul_f32 v245, v245, v9
v_mul_f32 v246, v246, v9
v_mul_f32 v247, v247, v9
v_accvgpr_write_b32 a64, v240
v_accvgpr_write_b32 a65, v241
v_accvgpr_write_b32 a66, v242
v_accvgpr_write_b32 a67, v243
v_accvgpr_write_b32 a68, v244
v_accvgpr_write_b32 a69, v245
v_accvgpr_write_b32 a70, v246
v_accvgpr_write_b32 a71, v247
v_accvgpr_read_b32 v240, a72
v_accvgpr_read_b32 v241, a73
v_accvgpr_read_b32 v242, a74
v_accvgpr_read_b32 v243, a75
v_accvgpr_read_b32 v244, a76
v_accvgpr_read_b32 v245, a77
v_accvgpr_read_b32 v246, a78
v_accvgpr_read_b32 v247, a79
v_mul_f32 v240, v240, v9
v_mul_f32 v241, v241, v9
v_mul_f32 v242, v242, v9
v_mul_f32 v243, v243, v9
v_mul_f32 v244, v244, v9
v_mul_f32 v245, v245, v9
v_mul_f32 v246, v246, v9
v_mul_f32 v247, v247, v9
v_accvgpr_write_b32 a72, v240
v_accvgpr_write_b32 a73, v241
v_accvgpr_write_b32 a74, v242
v_accvgpr_write_b32 a75, v243
v_accvgpr_write_b32 a76, v244
v_accvgpr_write_b32 a77, v245
v_accvgpr_write_b32 a78, v246
v_accvgpr_write_b32 a79, v247
v_accvgpr_read_b32 v240, a80
v_accvgpr_read_b32 v241, a81
v_accvgpr_read_b32 v242, a82
v_accvgpr_read_b32 v243, a83
v_accvgpr_read_b32 v244, a84
v_accvgpr_read_b32 v245, a85
v_accvgpr_read_b32 v246, a86
v_accvgpr_read_b32 v247, a87
v_mul_f32 v240, v240, v9
v_mul_f32 v241, v241, v9
v_mul_f32 v242, v242, v9
v_mul_f32 v243, v243, v9
v_mul_f32 v244, v244, v9
v_mul_f32 v245, v245, v9
v_mul_f32 v246, v246, v9
v_mul_f32 v247, v247, v9
v_accvgpr_write_b32 a80, v240
v_accvgpr_write_b32 a81, v241
v_accvgpr_write_b32 a82, v242
v_accvgpr_write_b32 a83, v243
v_accvgpr_write_b32 a84, v244
v_accvgpr_write_b32 a85, v245
v_accvgpr_write_b32 a86, v246
v_accvgpr_write_b32 a87, v247
v_accvgpr_read_b32 v240, a88
v_accvgpr_read_b32 v241, a89
v_accvgpr_read_b32 v242, a90
v_accvgpr_read_b32 v243, a91
v_accvgpr_read_b32 v244, a92
v_accvgpr_read_b32 v245, a93
v_accvgpr_read_b32 v246, a94
v_accvgpr_read_b32 v247, a95
v_mul_f32 v240, v240, v9
v_mul_f32 v241, v241, v9
v_mul_f32 v242, v242, v9
v_mul_f32 v243, v243, v9
v_mul_f32 v244, v244, v9
v_mul_f32 v245, v245, v9
v_mul_f32 v246, v246, v9
v_mul_f32 v247, v247, v9
v_accvgpr_write_b32 a88, v240
v_accvgpr_write_b32 a89, v241
v_accvgpr_write_b32 a90, v242
v_accvgpr_write_b32 a91, v243
v_accvgpr_write_b32 a92, v244
v_accvgpr_write_b32 a93, v245
v_accvgpr_write_b32 a94, v246
v_accvgpr_write_b32 a95, v247
v_accvgpr_read_b32 v240, a96
v_accvgpr_read_b32 v241, a97
v_accvgpr_read_b32 v242, a98
v_accvgpr_read_b32 v243, a99
v_accvgpr_read_b32 v244, a100
v_accvgpr_read_b32 v245, a101
v_accvgpr_read_b32 v246, a102
v_accvgpr_read_b32 v247, a103
v_mul_f32 v240, v240, v9
v_mul_f32 v241, v241, v9
v_mul_f32 v242, v242, v9
v_mul_f32 v243, v243, v9
v_mul_f32 v244, v244, v9
v_mul_f32 v245, v245, v9
v_mul_f32 v246, v246, v9
v_mul_f32 v247, v247, v9
v_accvgpr_write_b32 a96, v240
v_accvgpr_write_b32 a97, v241
v_accvgpr_write_b32 a98, v242
v_accvgpr_write_b32 a99, v243
v_accvgpr_write_b32 a100, v244
v_accvgpr_write_b32 a101, v245
v_accvgpr_write_b32 a102, v246
v_accvgpr_write_b32 a103, v247
v_accvgpr_read_b32 v240, a104
v_accvgpr_read_b32 v241, a105
v_accvgpr_read_b32 v242, a106
v_accvgpr_read_b32 v243, a107
v_accvgpr_read_b32 v244, a108
v_accvgpr_read_b32 v245, a109
v_accvgpr_read_b32 v246, a110
v_accvgpr_read_b32 v247, a111
v_mul_f32 v240, v240, v9
v_mul_f32 v241, v241, v9
v_mul_f32 v242, v242, v9
v_mul_f32 v243, v243, v9
v_mul_f32 v244, v244, v9
v_mul_f32 v245, v245, v9
v_mul_f32 v246, v246, v9
v_mul_f32 v247, v247, v9
v_accvgpr_write_b32 a104, v240
v_accvgpr_write_b32 a105, v241
v_accvgpr_write_b32 a106, v242
v_accvgpr_write_b32 a107, v243
v_accvgpr_write_b32 a108, v244
v_accvgpr_write_b32 a109, v245
v_accvgpr_write_b32 a110, v246
v_accvgpr_write_b32 a111, v247
v_accvgpr_read_b32 v240, a112
v_accvgpr_read_b32 v241, a113
v_accvgpr_read_b32 v242, a114
v_accvgpr_read_b32 v243, a115
v_accvgpr_read_b32 v244, a116
v_accvgpr_read_b32 v245, a117
v_accvgpr_read_b32 v246, a118
v_accvgpr_read_b32 v247, a119
v_mul_f32 v240, v240, v9
v_mul_f32 v241, v241, v9
v_mul_f32 v242, v242, v9
v_mul_f32 v243, v243, v9
v_mul_f32 v244, v244, v9
v_mul_f32 v245, v245, v9
v_mul_f32 v246, v246, v9
v_mul_f32 v247, v247, v9
v_accvgpr_write_b32 a112, v240
v_accvgpr_write_b32 a113, v241
v_accvgpr_write_b32 a114, v242
v_accvgpr_write_b32 a115, v243
v_accvgpr_write_b32 a116, v244
v_accvgpr_write_b32 a117, v245
v_accvgpr_write_b32 a118, v246
v_accvgpr_write_b32 a119, v247
v_accvgpr_read_b32 v240, a120
v_accvgpr_read_b32 v241, a121
v_accvgpr_read_b32 v242, a122
v_accvgpr_read_b32 v243, a123
v_accvgpr_read_b32 v244, a124
v_accvgpr_read_b32 v245, a125
v_accvgpr_read_b32 v246, a126
v_accvgpr_read_b32 v247, a127
v_mul_f32 v240, v240, v9
v_mul_f32 v241, v241, v9
v_mul_f32 v242, v242, v9
v_mul_f32 v243, v243, v9
v_mul_f32 v244, v244, v9
v_mul_f32 v245, v245, v9
v_mul_f32 v246, v246, v9
v_mul_f32 v247, v247, v9
v_accvgpr_write_b32 a120, v240
v_accvgpr_write_b32 a121, v241
v_accvgpr_write_b32 a122, v242
v_accvgpr_write_b32 a123, v243
v_accvgpr_write_b32 a124, v244
v_accvgpr_write_b32 a125, v245
v_accvgpr_write_b32 a126, v246
v_accvgpr_write_b32 a127, v247
s_mov_b32 s78, 0
s_nop 1
s_branch L_p3_d0_resc_ret
L_p3_d1_mask:
s_nop 7
s_lshl_b32 s81, s80, 1
s_sub_u32 s81, s3, s81
s_lshl_b32 s81, s81, 5
v_add_u32 v240, s81, v13
v_add_u32 v241, -32, v240
v_cmp_gt_i32_e64 s[84:85], 0, v240
v_cmp_gt_i32_e64 s[86:87], 1, v240
v_cmp_gt_i32_e64 s[88:89], 2, v240
v_cmp_gt_i32_e64 s[90:91], 3, v240
v_cmp_gt_i32_e64 s[92:93], 16, v240
v_cmp_gt_i32_e64 s[94:95], 17, v240
v_cmp_gt_i32_e64 s[96:97], 18, v240
v_cmp_gt_i32_e64 s[98:99], 19, v240
v_cndmask_b32_e64 v96, v96, v14, s[84:85]
v_cndmask_b32_e64 v97, v97, v14, s[86:87]
v_cndmask_b32_e64 v98, v98, v14, s[88:89]
v_cndmask_b32_e64 v99, v99, v14, s[90:91]
v_cndmask_b32_e64 v100, v100, v14, s[92:93]
v_cndmask_b32_e64 v101, v101, v14, s[94:95]
v_cndmask_b32_e64 v102, v102, v14, s[96:97]
v_cndmask_b32_e64 v103, v103, v14, s[98:99]
v_cmp_gt_i32_e64 s[84:85], 8, v240
v_cmp_gt_i32_e64 s[86:87], 9, v240
v_cmp_gt_i32_e64 s[88:89], 10, v240
v_cmp_gt_i32_e64 s[90:91], 11, v240
v_cmp_gt_i32_e64 s[92:93], 24, v240
v_cmp_gt_i32_e64 s[94:95], 25, v240
v_cmp_gt_i32_e64 s[96:97], 26, v240
v_cmp_gt_i32_e64 s[98:99], 27, v240
v_cndmask_b32_e64 v104, v104, v14, s[84:85]
v_cndmask_b32_e64 v105, v105, v14, s[86:87]
v_cndmask_b32_e64 v106, v106, v14, s[88:89]
v_cndmask_b32_e64 v107, v107, v14, s[90:91]
v_cndmask_b32_e64 v108, v108, v14, s[92:93]
v_cndmask_b32_e64 v109, v109, v14, s[94:95]
v_cndmask_b32_e64 v110, v110, v14, s[96:97]
v_cndmask_b32_e64 v111, v111, v14, s[98:99]
v_cmp_gt_i32_e64 s[84:85], 0, v241
v_cmp_gt_i32_e64 s[86:87], 1, v241
v_cmp_gt_i32_e64 s[88:89], 2, v241
v_cmp_gt_i32_e64 s[90:91], 3, v241
v_cmp_gt_i32_e64 s[92:93], 16, v241
v_cmp_gt_i32_e64 s[94:95], 17, v241
v_cmp_gt_i32_e64 s[96:97], 18, v241
v_cmp_gt_i32_e64 s[98:99], 19, v241
v_cndmask_b32_e64 v128, v128, v14, s[84:85]
v_cndmask_b32_e64 v129, v129, v14, s[86:87]
v_cndmask_b32_e64 v130, v130, v14, s[88:89]
v_cndmask_b32_e64 v131, v131, v14, s[90:91]
v_cndmask_b32_e64 v132, v132, v14, s[92:93]
v_cndmask_b32_e64 v133, v133, v14, s[94:95]
v_cndmask_b32_e64 v134, v134, v14, s[96:97]
v_cndmask_b32_e64 v135, v135, v14, s[98:99]
v_cmp_gt_i32_e64 s[84:85], 8, v241
v_cmp_gt_i32_e64 s[86:87], 9, v241
v_cmp_gt_i32_e64 s[88:89], 10, v241
v_cmp_gt_i32_e64 s[90:91], 11, v241
v_cmp_gt_i32_e64 s[92:93], 24, v241
v_cmp_gt_i32_e64 s[94:95], 25, v241
v_cmp_gt_i32_e64 s[96:97], 26, v241
v_cmp_gt_i32_e64 s[98:99], 27, v241
v_cndmask_b32_e64 v136, v136, v14, s[84:85]
v_cndmask_b32_e64 v137, v137, v14, s[86:87]
v_cndmask_b32_e64 v138, v138, v14, s[88:89]
v_cndmask_b32_e64 v139, v139, v14, s[90:91]
v_cndmask_b32_e64 v140, v140, v14, s[92:93]
v_cndmask_b32_e64 v141, v141, v14, s[94:95]
v_cndmask_b32_e64 v142, v142, v14, s[96:97]
v_cndmask_b32_e64 v143, v143, v14, s[98:99]
s_branch L_p3_d1_mask_ret
L_p3_d1_rare:
v_mov_b32 v240, v6
v_mov_b32 v241, v6
s_nop 1
v_permlane32_swap_b32 v240, v241
v_max_f32 v242, v240, v241
v_max_f32 v242, 0, v242
v_exp_f32 v8, -v242
v_sub_f32 v208, v208, v242
v_sub_f32 v209, v209, v242
v_sub_f32 v210, v210, v242
v_sub_f32 v211, v211, v242
v_sub_f32 v212, v212, v242
v_sub_f32 v213, v213, v242
v_sub_f32 v214, v214, v242
v_sub_f32 v215, v215, v242
v_sub_f32 v216, v216, v242
v_sub_f32 v217, v217, v242
v_sub_f32 v218, v218, v242
v_sub_f32 v219, v219, v242
v_sub_f32 v220, v220, v242
v_sub_f32 v221, v221, v242
v_sub_f32 v222, v222, v242
v_sub_f32 v223, v223, v242
v_mul_f32 v2, v2, v8
v_mul_f32 v3, v3, v8
v_sub_f32 v80, v80, v242
v_sub_f32 v81, v81, v242
v_sub_f32 v82, v82, v242
v_sub_f32 v83, v83, v242
v_sub_f32 v84, v84, v242
v_sub_f32 v85, v85, v242
v_sub_f32 v86, v86, v242
v_sub_f32 v87, v87, v242
v_sub_f32 v88, v88, v242
v_sub_f32 v89, v89, v242
v_sub_f32 v90, v90, v242
v_sub_f32 v91, v91, v242
v_sub_f32 v92, v92, v242
v_sub_f32 v93, v93, v242
v_sub_f32 v94, v94, v242
v_sub_f32 v95, v95, v242
v_sub_f32 v112, v112, v242
v_sub_f32 v113, v113, v242
v_sub_f32 v114, v114, v242
v_sub_f32 v115, v115, v242
v_sub_f32 v116, v116, v242
v_sub_f32 v117, v117, v242
v_sub_f32 v118, v118, v242
v_sub_f32 v119, v119, v242
v_sub_f32 v120, v120, v242
v_sub_f32 v121, v121, v242
v_sub_f32 v122, v122, v242
v_sub_f32 v123, v123, v242
v_sub_f32 v124, v124, v242
v_sub_f32 v125, v125, v242
v_sub_f32 v126, v126, v242
v_sub_f32 v127, v127, v242
v_mov_b32 v240, v7
v_mov_b32 v241, v7
s_nop 1
v_permlane32_swap_b32 v240, v241
v_max_f32 v242, v240, v241
v_max_f32 v242, 0, v242
v_exp_f32 v9, -v242
v_sub_f32 v224, v224, v242
v_sub_f32 v225, v225, v242
v_sub_f32 v226, v226, v242
v_sub_f32 v227, v227, v242
v_sub_f32 v228, v228, v242
v_sub_f32 v229, v229, v242
v_sub_f32 v230, v230, v242
v_sub_f32 v231, v231, v242
v_sub_f32 v232, v232, v242
v_sub_f32 v233, v233, v242
v_sub_f32 v234, v234, v242
v_sub_f32 v235, v235, v242
v_sub_f32 v236, v236, v242
v_sub_f32 v237, v237, v242
v_sub_f32 v238, v238, v242
v_sub_f32 v239, v239, v242
v_mul_f32 v4, v4, v9
v_mul_f32 v5, v5, v9
v_sub_f32 v96, v96, v242
v_sub_f32 v97, v97, v242
v_sub_f32 v98, v98, v242
v_sub_f32 v99, v99, v242
v_sub_f32 v100, v100, v242
v_sub_f32 v101, v101, v242
v_sub_f32 v102, v102, v242
v_sub_f32 v103, v103, v242
v_sub_f32 v104, v104, v242
v_sub_f32 v105, v105, v242
v_sub_f32 v106, v106, v242
v_sub_f32 v107, v107, v242
v_sub_f32 v108, v108, v242
v_sub_f32 v109, v109, v242
v_sub_f32 v110, v110, v242
v_sub_f32 v111, v111, v242
v_sub_f32 v128, v128, v242
v_sub_f32 v129, v129, v242
v_sub_f32 v130, v130, v242
v_sub_f32 v131, v131, v242
v_sub_f32 v132, v132, v242
v_sub_f32 v133, v133, v242
v_sub_f32 v134, v134, v242
v_sub_f32 v135, v135, v242
v_sub_f32 v136, v136, v242
v_sub_f32 v137, v137, v242
v_sub_f32 v138, v138, v242
v_sub_f32 v139, v139, v242
v_sub_f32 v140, v140, v242
v_sub_f32 v141, v141, v242
v_sub_f32 v142, v142, v242
v_sub_f32 v143, v143, v242
s_mov_b32 s78, 1
s_branch L_p3_d1_rare_ret
L_p3_d1_resc:
s_nop 15
v_accvgpr_read_b32 v240, a0
v_accvgpr_read_b32 v241, a1
v_accvgpr_read_b32 v242, a2
v_accvgpr_read_b32 v243, a3
v_accvgpr_read_b32 v244, a4
v_accvgpr_read_b32 v245, a5
v_accvgpr_read_b32 v246, a6
v_accvgpr_read_b32 v247, a7
v_mul_f32 v240, v240, v8
v_mul_f32 v241, v241, v8
v_mul_f32 v242, v242, v8
v_mul_f32 v243, v243, v8
v_mul_f32 v244, v244, v8
v_mul_f32 v245, v245, v8
v_mul_f32 v246, v246, v8
v_mul_f32 v247, v247, v8
v_accvgpr_write_b32 a0, v240
v_accvgpr_write_b32 a1, v241
v_accvgpr_write_b32 a2, v242
v_accvgpr_write_b32 a3, v243
v_accvgpr_write_b32 a4, v244
v_accvgpr_write_b32 a5, v245
v_accvgpr_write_b32 a6, v246
v_accvgpr_write_b32 a7, v247
v_accvgpr_read_b32 v240, a8
v_accvgpr_read_b32 v241, a9
v_accvgpr_read_b32 v242, a10
v_accvgpr_read_b32 v243, a11
v_accvgpr_read_b32 v244, a12
v_accvgpr_read_b32 v245, a13
v_accvgpr_read_b32 v246, a14
v_accvgpr_read_b32 v247, a15
v_mul_f32 v240, v240, v8
v_mul_f32 v241, v241, v8
v_mul_f32 v242, v242, v8
v_mul_f32 v243, v243, v8
v_mul_f32 v244, v244, v8
v_mul_f32 v245, v245, v8
v_mul_f32 v246, v246, v8
v_mul_f32 v247, v247, v8
v_accvgpr_write_b32 a8, v240
v_accvgpr_write_b32 a9, v241
v_accvgpr_write_b32 a10, v242
v_accvgpr_write_b32 a11, v243
v_accvgpr_write_b32 a12, v244
v_accvgpr_write_b32 a13, v245
v_accvgpr_write_b32 a14, v246
v_accvgpr_write_b32 a15, v247
v_accvgpr_read_b32 v240, a16
v_accvgpr_read_b32 v241, a17
v_accvgpr_read_b32 v242, a18
v_accvgpr_read_b32 v243, a19
v_accvgpr_read_b32 v244, a20
v_accvgpr_read_b32 v245, a21
v_accvgpr_read_b32 v246, a22
v_accvgpr_read_b32 v247, a23
v_mul_f32 v240, v240, v8
v_mul_f32 v241, v241, v8
v_mul_f32 v242, v242, v8
v_mul_f32 v243, v243, v8
v_mul_f32 v244, v244, v8
v_mul_f32 v245, v245, v8
v_mul_f32 v246, v246, v8
v_mul_f32 v247, v247, v8
v_accvgpr_write_b32 a16, v240
v_accvgpr_write_b32 a17, v241
v_accvgpr_write_b32 a18, v242
v_accvgpr_write_b32 a19, v243
v_accvgpr_write_b32 a20, v244
v_accvgpr_write_b32 a21, v245
v_accvgpr_write_b32 a22, v246
v_accvgpr_write_b32 a23, v247
v_accvgpr_read_b32 v240, a24
v_accvgpr_read_b32 v241, a25
v_accvgpr_read_b32 v242, a26
v_accvgpr_read_b32 v243, a27
v_accvgpr_read_b32 v244, a28
v_accvgpr_read_b32 v245, a29
v_accvgpr_read_b32 v246, a30
v_accvgpr_read_b32 v247, a31
v_mul_f32 v240, v240, v8
v_mul_f32 v241, v241, v8
v_mul_f32 v242, v242, v8
v_mul_f32 v243, v243, v8
v_mul_f32 v244, v244, v8
v_mul_f32 v245, v245, v8
v_mul_f32 v246, v246, v8
v_mul_f32 v247, v247, v8
v_accvgpr_write_b32 a24, v240
v_accvgpr_write_b32 a25, v241
v_accvgpr_write_b32 a26, v242
v_accvgpr_write_b32 a27, v243
v_accvgpr_write_b32 a28, v244
v_accvgpr_write_b32 a29, v245
v_accvgpr_write_b32 a30, v246
v_accvgpr_write_b32 a31, v247
v_accvgpr_read_b32 v240, a32
v_accvgpr_read_b32 v241, a33
v_accvgpr_read_b32 v242, a34
v_accvgpr_read_b32 v243, a35
v_accvgpr_read_b32 v244, a36
v_accvgpr_read_b32 v245, a37
v_accvgpr_read_b32 v246, a38
v_accvgpr_read_b32 v247, a39
v_mul_f32 v240, v240, v8
v_mul_f32 v241, v241, v8
v_mul_f32 v242, v242, v8
v_mul_f32 v243, v243, v8
v_mul_f32 v244, v244, v8
v_mul_f32 v245, v245, v8
v_mul_f32 v246, v246, v8
v_mul_f32 v247, v247, v8
v_accvgpr_write_b32 a32, v240
v_accvgpr_write_b32 a33, v241
v_accvgpr_write_b32 a34, v242
v_accvgpr_write_b32 a35, v243
v_accvgpr_write_b32 a36, v244
v_accvgpr_write_b32 a37, v245
v_accvgpr_write_b32 a38, v246
v_accvgpr_write_b32 a39, v247
v_accvgpr_read_b32 v240, a40
v_accvgpr_read_b32 v241, a41
v_accvgpr_read_b32 v242, a42
v_accvgpr_read_b32 v243, a43
v_accvgpr_read_b32 v244, a44
v_accvgpr_read_b32 v245, a45
v_accvgpr_read_b32 v246, a46
v_accvgpr_read_b32 v247, a47
v_mul_f32 v240, v240, v8
v_mul_f32 v241, v241, v8
v_mul_f32 v242, v242, v8
v_mul_f32 v243, v243, v8
v_mul_f32 v244, v244, v8
v_mul_f32 v245, v245, v8
v_mul_f32 v246, v246, v8
v_mul_f32 v247, v247, v8
v_accvgpr_write_b32 a40, v240
v_accvgpr_write_b32 a41, v241
v_accvgpr_write_b32 a42, v242
v_accvgpr_write_b32 a43, v243
v_accvgpr_write_b32 a44, v244
v_accvgpr_write_b32 a45, v245
v_accvgpr_write_b32 a46, v246
v_accvgpr_write_b32 a47, v247
v_accvgpr_read_b32 v240, a48
v_accvgpr_read_b32 v241, a49
v_accvgpr_read_b32 v242, a50
v_accvgpr_read_b32 v243, a51
v_accvgpr_read_b32 v244, a52
v_accvgpr_read_b32 v245, a53
v_accvgpr_read_b32 v246, a54
v_accvgpr_read_b32 v247, a55
v_mul_f32 v240, v240, v8
v_mul_f32 v241, v241, v8
v_mul_f32 v242, v242, v8
v_mul_f32 v243, v243, v8
v_mul_f32 v244, v244, v8
v_mul_f32 v245, v245, v8
v_mul_f32 v246, v246, v8
v_mul_f32 v247, v247, v8
v_accvgpr_write_b32 a48, v240
v_accvgpr_write_b32 a49, v241
v_accvgpr_write_b32 a50, v242
v_accvgpr_write_b32 a51, v243
v_accvgpr_write_b32 a52, v244
v_accvgpr_write_b32 a53, v245
v_accvgpr_write_b32 a54, v246
v_accvgpr_write_b32 a55, v247
v_accvgpr_read_b32 v240, a56
v_accvgpr_read_b32 v241, a57
v_accvgpr_read_b32 v242, a58
v_accvgpr_read_b32 v243, a59
v_accvgpr_read_b32 v244, a60
v_accvgpr_read_b32 v245, a61
v_accvgpr_read_b32 v246, a62
v_accvgpr_read_b32 v247, a63
v_mul_f32 v240, v240, v8
v_mul_f32 v241, v241, v8
v_mul_f32 v242, v242, v8
v_mul_f32 v243, v243, v8
v_mul_f32 v244, v244, v8
v_mul_f32 v245, v245, v8
v_mul_f32 v246, v246, v8
v_mul_f32 v247, v247, v8
v_accvgpr_write_b32 a56, v240
v_accvgpr_write_b32 a57, v241
v_accvgpr_write_b32 a58, v242
v_accvgpr_write_b32 a59, v243
v_accvgpr_write_b32 a60, v244
v_accvgpr_write_b32 a61, v245
v_accvgpr_write_b32 a62, v246
v_accvgpr_write_b32 a63, v247
v_accvgpr_read_b32 v240, a64
v_accvgpr_read_b32 v241, a65
v_accvgpr_read_b32 v242, a66
v_accvgpr_read_b32 v243, a67
v_accvgpr_read_b32 v244, a68
v_accvgpr_read_b32 v245, a69
v_accvgpr_read_b32 v246, a70
v_accvgpr_read_b32 v247, a71
v_mul_f32 v240, v240, v9
v_mul_f32 v241, v241, v9
v_mul_f32 v242, v242, v9
v_mul_f32 v243, v243, v9
v_mul_f32 v244, v244, v9
v_mul_f32 v245, v245, v9
v_mul_f32 v246, v246, v9
v_mul_f32 v247, v247, v9
v_accvgpr_write_b32 a64, v240
v_accvgpr_write_b32 a65, v241
v_accvgpr_write_b32 a66, v242
v_accvgpr_write_b32 a67, v243
v_accvgpr_write_b32 a68, v244
v_accvgpr_write_b32 a69, v245
v_accvgpr_write_b32 a70, v246
v_accvgpr_write_b32 a71, v247
v_accvgpr_read_b32 v240, a72
v_accvgpr_read_b32 v241, a73
v_accvgpr_read_b32 v242, a74
v_accvgpr_read_b32 v243, a75
v_accvgpr_read_b32 v244, a76
v_accvgpr_read_b32 v245, a77
v_accvgpr_read_b32 v246, a78
v_accvgpr_read_b32 v247, a79
v_mul_f32 v240, v240, v9
v_mul_f32 v241, v241, v9
v_mul_f32 v242, v242, v9
v_mul_f32 v243, v243, v9
v_mul_f32 v244, v244, v9
v_mul_f32 v245, v245, v9
v_mul_f32 v246, v246, v9
v_mul_f32 v247, v247, v9
v_accvgpr_write_b32 a72, v240
v_accvgpr_write_b32 a73, v241
v_accvgpr_write_b32 a74, v242
v_accvgpr_write_b32 a75, v243
v_accvgpr_write_b32 a76, v244
v_accvgpr_write_b32 a77, v245
v_accvgpr_write_b32 a78, v246
v_accvgpr_write_b32 a79, v247
v_accvgpr_read_b32 v240, a80
v_accvgpr_read_b32 v241, a81
v_accvgpr_read_b32 v242, a82
v_accvgpr_read_b32 v243, a83
v_accvgpr_read_b32 v244, a84
v_accvgpr_read_b32 v245, a85
v_accvgpr_read_b32 v246, a86
v_accvgpr_read_b32 v247, a87
v_mul_f32 v240, v240, v9
v_mul_f32 v241, v241, v9
v_mul_f32 v242, v242, v9
v_mul_f32 v243, v243, v9
v_mul_f32 v244, v244, v9
v_mul_f32 v245, v245, v9
v_mul_f32 v246, v246, v9
v_mul_f32 v247, v247, v9
v_accvgpr_write_b32 a80, v240
v_accvgpr_write_b32 a81, v241
v_accvgpr_write_b32 a82, v242
v_accvgpr_write_b32 a83, v243
v_accvgpr_write_b32 a84, v244
v_accvgpr_write_b32 a85, v245
v_accvgpr_write_b32 a86, v246
v_accvgpr_write_b32 a87, v247
v_accvgpr_read_b32 v240, a88
v_accvgpr_read_b32 v241, a89
v_accvgpr_read_b32 v242, a90
v_accvgpr_read_b32 v243, a91
v_accvgpr_read_b32 v244, a92
v_accvgpr_read_b32 v245, a93
v_accvgpr_read_b32 v246, a94
v_accvgpr_read_b32 v247, a95
v_mul_f32 v240, v240, v9
v_mul_f32 v241, v241, v9
v_mul_f32 v242, v242, v9
v_mul_f32 v243, v243, v9
v_mul_f32 v244, v244, v9
v_mul_f32 v245, v245, v9
v_mul_f32 v246, v246, v9
v_mul_f32 v247, v247, v9
v_accvgpr_write_b32 a88, v240
v_accvgpr_write_b32 a89, v241
v_accvgpr_write_b32 a90, v242
v_accvgpr_write_b32 a91, v243
v_accvgpr_write_b32 a92, v244
v_accvgpr_write_b32 a93, v245
v_accvgpr_write_b32 a94, v246
v_accvgpr_write_b32 a95, v247
v_accvgpr_read_b32 v240, a96
v_accvgpr_read_b32 v241, a97
v_accvgpr_read_b32 v242, a98
v_accvgpr_read_b32 v243, a99
v_accvgpr_read_b32 v244, a100
v_accvgpr_read_b32 v245, a101
v_accvgpr_read_b32 v246, a102
v_accvgpr_read_b32 v247, a103
v_mul_f32 v240, v240, v9
v_mul_f32 v241, v241, v9
v_mul_f32 v242, v242, v9
v_mul_f32 v243, v243, v9
v_mul_f32 v244, v244, v9
v_mul_f32 v245, v245, v9
v_mul_f32 v246, v246, v9
v_mul_f32 v247, v247, v9
v_accvgpr_write_b32 a96, v240
v_accvgpr_write_b32 a97, v241
v_accvgpr_write_b32 a98, v242
v_accvgpr_write_b32 a99, v243
v_accvgpr_write_b32 a100, v244
v_accvgpr_write_b32 a101, v245
v_accvgpr_write_b32 a102, v246
v_accvgpr_write_b32 a103, v247
v_accvgpr_read_b32 v240, a104
v_accvgpr_read_b32 v241, a105
v_accvgpr_read_b32 v242, a106
v_accvgpr_read_b32 v243, a107
v_accvgpr_read_b32 v244, a108
v_accvgpr_read_b32 v245, a109
v_accvgpr_read_b32 v246, a110
v_accvgpr_read_b32 v247, a111
v_mul_f32 v240, v240, v9
v_mul_f32 v241, v241, v9
v_mul_f32 v242, v242, v9
v_mul_f32 v243, v243, v9
v_mul_f32 v244, v244, v9
v_mul_f32 v245, v245, v9
v_mul_f32 v246, v246, v9
v_mul_f32 v247, v247, v9
v_accvgpr_write_b32 a104, v240
v_accvgpr_write_b32 a105, v241
v_accvgpr_write_b32 a106, v242
v_accvgpr_write_b32 a107, v243
v_accvgpr_write_b32 a108, v244
v_accvgpr_write_b32 a109, v245
v_accvgpr_write_b32 a110, v246
v_accvgpr_write_b32 a111, v247
v_accvgpr_read_b32 v240, a112
v_accvgpr_read_b32 v241, a113
v_accvgpr_read_b32 v242, a114
v_accvgpr_read_b32 v243, a115
v_accvgpr_read_b32 v244, a116
v_accvgpr_read_b32 v245, a117
v_accvgpr_read_b32 v246, a118
v_accvgpr_read_b32 v247, a119
v_mul_f32 v240, v240, v9
v_mul_f32 v241, v241, v9
v_mul_f32 v242, v242, v9
v_mul_f32 v243, v243, v9
v_mul_f32 v244, v244, v9
v_mul_f32 v245, v245, v9
v_mul_f32 v246, v246, v9
v_mul_f32 v247, v247, v9
v_accvgpr_write_b32 a112, v240
v_accvgpr_write_b32 a113, v241
v_accvgpr_write_b32 a114, v242
v_accvgpr_write_b32 a115, v243
v_accvgpr_write_b32 a116, v244
v_accvgpr_write_b32 a117, v245
v_accvgpr_write_b32 a118, v246
v_accvgpr_write_b32 a119, v247
v_accvgpr_read_b32 v240, a120
v_accvgpr_read_b32 v241, a121
v_accvgpr_read_b32 v242, a122
v_accvgpr_read_b32 v243, a123
v_accvgpr_read_b32 v244, a124
v_accvgpr_read_b32 v245, a125
v_accvgpr_read_b32 v246, a126
v_accvgpr_read_b32 v247, a127
v_mul_f32 v240, v240, v9
v_mul_f32 v241, v241, v9
v_mul_f32 v242, v242, v9
v_mul_f32 v243, v243, v9
v_mul_f32 v244, v244, v9
v_mul_f32 v245, v245, v9
v_mul_f32 v246, v246, v9
v_mul_f32 v247, v247, v9
v_accvgpr_write_b32 a120, v240
v_accvgpr_write_b32 a121, v241
v_accvgpr_write_b32 a122, v242
v_accvgpr_write_b32 a123, v243
v_accvgpr_write_b32 a124, v244
v_accvgpr_write_b32 a125, v245
v_accvgpr_write_b32 a126, v246
v_accvgpr_write_b32 a127, v247
s_mov_b32 s78, 0
s_nop 1
s_branch L_p3_d1_resc_ret
L_p3_mx_mask:
s_nop 7
s_lshl_b32 s81, s80, 1
s_sub_u32 s81, s3, s81
s_lshl_b32 s81, s81, 5
v_add_u32 v240, s81, v13
v_add_u32 v241, -32, v240
v_cmp_gt_i32_e64 s[84:85], 0, v240
v_cmp_gt_i32_e64 s[86:87], 1, v240
v_cmp_gt_i32_e64 s[88:89], 2, v240
v_cmp_gt_i32_e64 s[90:91], 3, v240
v_cmp_gt_i32_e64 s[92:93], 16, v240
v_cmp_gt_i32_e64 s[94:95], 17, v240
v_cmp_gt_i32_e64 s[96:97], 18, v240
v_cmp_gt_i32_e64 s[98:99], 19, v240
v_cndmask_b32_e64 v80, v80, v14, s[84:85]
v_cndmask_b32_e64 v81, v81, v14, s[86:87]
v_cndmask_b32_e64 v82, v82, v14, s[88:89]
v_cndmask_b32_e64 v83, v83, v14, s[90:91]
v_cndmask_b32_e64 v84, v84, v14, s[92:93]
v_cndmask_b32_e64 v85, v85, v14, s[94:95]
v_cndmask_b32_e64 v86, v86, v14, s[96:97]
v_cndmask_b32_e64 v87, v87, v14, s[98:99]
v_cmp_gt_i32_e64 s[84:85], 8, v240
v_cmp_gt_i32_e64 s[86:87], 9, v240
v_cmp_gt_i32_e64 s[88:89], 10, v240
v_cmp_gt_i32_e64 s[90:91], 11, v240
v_cmp_gt_i32_e64 s[92:93], 24, v240
v_cmp_gt_i32_e64 s[94:95], 25, v240
v_cmp_gt_i32_e64 s[96:97], 26, v240
v_cmp_gt_i32_e64 s[98:99], 27, v240
v_cndmask_b32_e64 v88, v88, v14, s[84:85]
v_cndmask_b32_e64 v89, v89, v14, s[86:87]
v_cndmask_b32_e64 v90, v90, v14, s[88:89]
v_cndmask_b32_e64 v91, v91, v14, s[90:91]
v_cndmask_b32_e64 v92, v92, v14, s[92:93]
v_cndmask_b32_e64 v93, v93, v14, s[94:95]
v_cndmask_b32_e64 v94, v94, v14, s[96:97]
v_cndmask_b32_e64 v95, v95, v14, s[98:99]
v_cmp_gt_i32_e64 s[84:85], 0, v241
v_cmp_gt_i32_e64 s[86:87], 1, v241
v_cmp_gt_i32_e64 s[88:89], 2, v241
v_cmp_gt_i32_e64 s[90:91], 3, v241
v_cmp_gt_i32_e64 s[92:93], 16, v241
v_cmp_gt_i32_e64 s[94:95], 17, v241
v_cmp_gt_i32_e64 s[96:97], 18, v241
v_cmp_gt_i32_e64 s[98:99], 19, v241
v_cndmask_b32_e64 v112, v112, v14, s[84:85]
v_cndmask_b32_e64 v113, v113, v14, s[86:87]
v_cndmask_b32_e64 v114, v114, v14, s[88:89]
v_cndmask_b32_e64 v115, v115, v14, s[90:91]
v_cndmask_b32_e64 v116, v116, v14, s[92:93]
v_cndmask_b32_e64 v117, v117, v14, s[94:95]
v_cndmask_b32_e64 v118, v118, v14, s[96:97]
v_cndmask_b32_e64 v119, v119, v14, s[98:99]
v_cmp_gt_i32_e64 s[84:85], 8, v241
v_cmp_gt_i32_e64 s[86:87], 9, v241
v_cmp_gt_i32_e64 s[88:89], 10, v241
v_cmp_gt_i32_e64 s[90:91], 11, v241
v_cmp_gt_i32_e64 s[92:93], 24, v241
v_cmp_gt_i32_e64 s[94:95], 25, v241
v_cmp_gt_i32_e64 s[96:97], 26, v241
v_cmp_gt_i32_e64 s[98:99], 27, v241
v_cndmask_b32_e64 v120, v120, v14, s[84:85]
v_cndmask_b32_e64 v121, v121, v14, s[86:87]
v_cndmask_b32_e64 v122, v122, v14, s[88:89]
v_cndmask_b32_e64 v123, v123, v14, s[90:91]
v_cndmask_b32_e64 v124, v124, v14, s[92:93]
v_cndmask_b32_e64 v125, v125, v14, s[94:95]
v_cndmask_b32_e64 v126, v126, v14, s[96:97]
v_cndmask_b32_e64 v127, v127, v14, s[98:99]
s_branch L_p3_mx_mask_ret
L_p3_mx_rare:
v_mov_b32 v240, v6
v_mov_b32 v241, v6
s_nop 1
v_permlane32_swap_b32 v240, v241
v_max_f32 v242, v240, v241
v_max_f32 v242, 0, v242
v_exp_f32 v8, -v242
v_sub_f32 v208, v208, v242
v_sub_f32 v209, v209, v242
v_sub_f32 v210, v210, v242
v_sub_f32 v211, v211, v242
v_sub_f32 v212, v212, v242
v_sub_f32 v213, v213, v242
v_sub_f32 v214, v214, v242
v_sub_f32 v215, v215, v242
v_sub_f32 v216, v216, v242
v_sub_f32 v217, v217, v242
v_sub_f32 v218, v218, v242
v_sub_f32 v219, v219, v242
v_sub_f32 v220, v220, v242
v_sub_f32 v221, v221, v242
v_sub_f32 v222, v222, v242
v_sub_f32 v223, v223, v242
v_mul_f32 v2, v2, v8
v_mul_f32 v3, v3, v8
v_sub_f32 v80, v80, v242
v_sub_f32 v81, v81, v242
v_sub_f32 v82, v82, v242
v_sub_f32 v83, v83, v242
v_sub_f32 v84, v84, v242
v_sub_f32 v85, v85, v242
v_sub_f32 v86, v86, v242
v_sub_f32 v87, v87, v242
v_sub_f32 v88, v88, v242
v_sub_f32 v89, v89, v242
v_sub_f32 v90, v90, v242
v_sub_f32 v91, v91, v242
v_sub_f32 v92, v92, v242
v_sub_f32 v93, v93, v242
v_sub_f32 v94, v94, v242
v_sub_f32 v95, v95, v242
v_sub_f32 v112, v112, v242
v_sub_f32 v113, v113, v242
v_sub_f32 v114, v114, v242
v_sub_f32 v115, v115, v242
v_sub_f32 v116, v116, v242
v_sub_f32 v117, v117, v242
v_sub_f32 v118, v118, v242
v_sub_f32 v119, v119, v242
v_sub_f32 v120, v120, v242
v_sub_f32 v121, v121, v242
v_sub_f32 v122, v122, v242
v_sub_f32 v123, v123, v242
v_sub_f32 v124, v124, v242
v_sub_f32 v125, v125, v242
v_sub_f32 v126, v126, v242
v_sub_f32 v127, v127, v242
s_mov_b32 s78, 1
s_branch L_p3_mx_rare_ret
L_p3_mx_resc:
s_nop 15
v_accvgpr_read_b32 v240, a0
v_accvgpr_read_b32 v241, a1
v_accvgpr_read_b32 v242, a2
v_accvgpr_read_b32 v243, a3
v_accvgpr_read_b32 v244, a4
v_accvgpr_read_b32 v245, a5
v_accvgpr_read_b32 v246, a6
v_accvgpr_read_b32 v247, a7
v_mul_f32 v240, v240, v8
v_mul_f32 v241, v241, v8
v_mul_f32 v242, v242, v8
v_mul_f32 v243, v243, v8
v_mul_f32 v244, v244, v8
v_mul_f32 v245, v245, v8
v_mul_f32 v246, v246, v8
v_mul_f32 v247, v247, v8
v_accvgpr_write_b32 a0, v240
v_accvgpr_write_b32 a1, v241
v_accvgpr_write_b32 a2, v242
v_accvgpr_write_b32 a3, v243
v_accvgpr_write_b32 a4, v244
v_accvgpr_write_b32 a5, v245
v_accvgpr_write_b32 a6, v246
v_accvgpr_write_b32 a7, v247
v_accvgpr_read_b32 v240, a8
v_accvgpr_read_b32 v241, a9
v_accvgpr_read_b32 v242, a10
v_accvgpr_read_b32 v243, a11
v_accvgpr_read_b32 v244, a12
v_accvgpr_read_b32 v245, a13
v_accvgpr_read_b32 v246, a14
v_accvgpr_read_b32 v247, a15
v_mul_f32 v240, v240, v8
v_mul_f32 v241, v241, v8
v_mul_f32 v242, v242, v8
v_mul_f32 v243, v243, v8
v_mul_f32 v244, v244, v8
v_mul_f32 v245, v245, v8
v_mul_f32 v246, v246, v8
v_mul_f32 v247, v247, v8
v_accvgpr_write_b32 a8, v240
v_accvgpr_write_b32 a9, v241
v_accvgpr_write_b32 a10, v242
v_accvgpr_write_b32 a11, v243
v_accvgpr_write_b32 a12, v244
v_accvgpr_write_b32 a13, v245
v_accvgpr_write_b32 a14, v246
v_accvgpr_write_b32 a15, v247
v_accvgpr_read_b32 v240, a16
v_accvgpr_read_b32 v241, a17
v_accvgpr_read_b32 v242, a18
v_accvgpr_read_b32 v243, a19
v_accvgpr_read_b32 v244, a20
v_accvgpr_read_b32 v245, a21
v_accvgpr_read_b32 v246, a22
v_accvgpr_read_b32 v247, a23
v_mul_f32 v240, v240, v8
v_mul_f32 v241, v241, v8
v_mul_f32 v242, v242, v8
v_mul_f32 v243, v243, v8
v_mul_f32 v244, v244, v8
v_mul_f32 v245, v245, v8
v_mul_f32 v246, v246, v8
v_mul_f32 v247, v247, v8
v_accvgpr_write_b32 a16, v240
v_accvgpr_write_b32 a17, v241
v_accvgpr_write_b32 a18, v242
v_accvgpr_write_b32 a19, v243
v_accvgpr_write_b32 a20, v244
v_accvgpr_write_b32 a21, v245
v_accvgpr_write_b32 a22, v246
v_accvgpr_write_b32 a23, v247
v_accvgpr_read_b32 v240, a24
v_accvgpr_read_b32 v241, a25
v_accvgpr_read_b32 v242, a26
v_accvgpr_read_b32 v243, a27
v_accvgpr_read_b32 v244, a28
v_accvgpr_read_b32 v245, a29
v_accvgpr_read_b32 v246, a30
v_accvgpr_read_b32 v247, a31
v_mul_f32 v240, v240, v8
v_mul_f32 v241, v241, v8
v_mul_f32 v242, v242, v8
v_mul_f32 v243, v243, v8
v_mul_f32 v244, v244, v8
v_mul_f32 v245, v245, v8
v_mul_f32 v246, v246, v8
v_mul_f32 v247, v247, v8
v_accvgpr_write_b32 a24, v240
v_accvgpr_write_b32 a25, v241
v_accvgpr_write_b32 a26, v242
v_accvgpr_write_b32 a27, v243
v_accvgpr_write_b32 a28, v244
v_accvgpr_write_b32 a29, v245
v_accvgpr_write_b32 a30, v246
v_accvgpr_write_b32 a31, v247
v_accvgpr_read_b32 v240, a32
v_accvgpr_read_b32 v241, a33
v_accvgpr_read_b32 v242, a34
v_accvgpr_read_b32 v243, a35
v_accvgpr_read_b32 v244, a36
v_accvgpr_read_b32 v245, a37
v_accvgpr_read_b32 v246, a38
v_accvgpr_read_b32 v247, a39
v_mul_f32 v240, v240, v8
v_mul_f32 v241, v241, v8
v_mul_f32 v242, v242, v8
v_mul_f32 v243, v243, v8
v_mul_f32 v244, v244, v8
v_mul_f32 v245, v245, v8
v_mul_f32 v246, v246, v8
v_mul_f32 v247, v247, v8
v_accvgpr_write_b32 a32, v240
v_accvgpr_write_b32 a33, v241
v_accvgpr_write_b32 a34, v242
v_accvgpr_write_b32 a35, v243
v_accvgpr_write_b32 a36, v244
v_accvgpr_write_b32 a37, v245
v_accvgpr_write_b32 a38, v246
v_accvgpr_write_b32 a39, v247
v_accvgpr_read_b32 v240, a40
v_accvgpr_read_b32 v241, a41
v_accvgpr_read_b32 v242, a42
v_accvgpr_read_b32 v243, a43
v_accvgpr_read_b32 v244, a44
v_accvgpr_read_b32 v245, a45
v_accvgpr_read_b32 v246, a46
v_accvgpr_read_b32 v247, a47
v_mul_f32 v240, v240, v8
v_mul_f32 v241, v241, v8
v_mul_f32 v242, v242, v8
v_mul_f32 v243, v243, v8
v_mul_f32 v244, v244, v8
v_mul_f32 v245, v245, v8
v_mul_f32 v246, v246, v8
v_mul_f32 v247, v247, v8
v_accvgpr_write_b32 a40, v240
v_accvgpr_write_b32 a41, v241
v_accvgpr_write_b32 a42, v242
v_accvgpr_write_b32 a43, v243
v_accvgpr_write_b32 a44, v244
v_accvgpr_write_b32 a45, v245
v_accvgpr_write_b32 a46, v246
v_accvgpr_write_b32 a47, v247
v_accvgpr_read_b32 v240, a48
v_accvgpr_read_b32 v241, a49
v_accvgpr_read_b32 v242, a50
v_accvgpr_read_b32 v243, a51
v_accvgpr_read_b32 v244, a52
v_accvgpr_read_b32 v245, a53
v_accvgpr_read_b32 v246, a54
v_accvgpr_read_b32 v247, a55
v_mul_f32 v240, v240, v8
v_mul_f32 v241, v241, v8
v_mul_f32 v242, v242, v8
v_mul_f32 v243, v243, v8
v_mul_f32 v244, v244, v8
v_mul_f32 v245, v245, v8
v_mul_f32 v246, v246, v8
v_mul_f32 v247, v247, v8
v_accvgpr_write_b32 a48, v240
v_accvgpr_write_b32 a49, v241
v_accvgpr_write_b32 a50, v242
v_accvgpr_write_b32 a51, v243
v_accvgpr_write_b32 a52, v244
v_accvgpr_write_b32 a53, v245
v_accvgpr_write_b32 a54, v246
v_accvgpr_write_b32 a55, v247
v_accvgpr_read_b32 v240, a56
v_accvgpr_read_b32 v241, a57
v_accvgpr_read_b32 v242, a58
v_accvgpr_read_b32 v243, a59
v_accvgpr_read_b32 v244, a60
v_accvgpr_read_b32 v245, a61
v_accvgpr_read_b32 v246, a62
v_accvgpr_read_b32 v247, a63
v_mul_f32 v240, v240, v8
v_mul_f32 v241, v241, v8
v_mul_f32 v242, v242, v8
v_mul_f32 v243, v243, v8
v_mul_f32 v244, v244, v8
v_mul_f32 v245, v245, v8
v_mul_f32 v246, v246, v8
v_mul_f32 v247, v247, v8
v_accvgpr_write_b32 a56, v240
v_accvgpr_write_b32 a57, v241
v_accvgpr_write_b32 a58, v242
v_accvgpr_write_b32 a59, v243
v_accvgpr_write_b32 a60, v244
v_accvgpr_write_b32 a61, v245
v_accvgpr_write_b32 a62, v246
v_accvgpr_write_b32 a63, v247
s_mov_b32 s78, 0
s_nop 1
s_branch L_p3_mx_resc_ret
L_p3_s0_mask:
s_nop 7
s_lshl_b32 s81, s80, 1
s_sub_u32 s81, s3, s81
s_lshl_b32 s81, s81, 5
v_add_u32 v240, s81, v13
v_add_u32 v241, -32, v240
v_cmp_gt_i32_e64 s[84:85], 0, v240
v_cmp_gt_i32_e64 s[86:87], 1, v240
v_cmp_gt_i32_e64 s[88:89], 2, v240
v_cmp_gt_i32_e64 s[90:91], 3, v240
v_cmp_gt_i32_e64 s[92:93], 16, v240
v_cmp_gt_i32_e64 s[94:95], 17, v240
v_cmp_gt_i32_e64 s[96:97], 18, v240
v_cmp_gt_i32_e64 s[98:99], 19, v240
v_cndmask_b32_e64 v144, v144, v14, s[84:85]
v_cndmask_b32_e64 v145, v145, v14, s[86:87]
v_cndmask_b32_e64 v146, v146, v14, s[88:89]
v_cndmask_b32_e64 v147, v147, v14, s[90:91]
v_cndmask_b32_e64 v148, v148, v14, s[92:93]
v_cndmask_b32_e64 v149, v149, v14, s[94:95]
v_cndmask_b32_e64 v150, v150, v14, s[96:97]
v_cndmask_b32_e64 v151, v151, v14, s[98:99]
v_cmp_gt_i32_e64 s[84:85], 8, v240
v_cmp_gt_i32_e64 s[86:87], 9, v240
v_cmp_gt_i32_e64 s[88:89], 10, v240
v_cmp_gt_i32_e64 s[90:91], 11, v240
v_cmp_gt_i32_e64 s[92:93], 24, v240
v_cmp_gt_i32_e64 s[94:95], 25, v240
v_cmp_gt_i32_e64 s[96:97], 26, v240
v_cmp_gt_i32_e64 s[98:99], 27, v240
v_cndmask_b32_e64 v152, v152, v14, s[84:85]
v_cndmask_b32_e64 v153, v153, v14, s[86:87]
v_cndmask_b32_e64 v154, v154, v14, s[88:89]
v_cndmask_b32_e64 v155, v155, v14, s[90:91]
v_cndmask_b32_e64 v156, v156, v14, s[92:93]
v_cndmask_b32_e64 v157, v157, v14, s[94:95]
v_cndmask_b32_e64 v158, v158, v14, s[96:97]
v_cndmask_b32_e64 v159, v159, v14, s[98:99]
v_cmp_gt_i32_e64 s[84:85], 0, v241
v_cmp_gt_i32_e64 s[86:87], 1, v241
v_cmp_gt_i32_e64 s[88:89], 2, v241
v_cmp_gt_i32_e64 s[90:91], 3, v241
v_cmp_gt_i32_e64 s[92:93], 16, v241
v_cmp_gt_i32_e64 s[94:95], 17, v241
v_cmp_gt_i32_e64 s[96:97], 18, v241
v_cmp_gt_i32_e64 s[98:99], 19, v241
v_cndmask_b32_e64 v176, v176, v14, s[84:85]
v_cndmask_b32_e64 v177, v177, v14, s[86:87]
v_cndmask_b32_e64 v178, v178, v14, s[88:89]
v_cndmask_b32_e64 v179, v179, v14, s[90:91]
v_cndmask_b32_e64 v180, v180, v14, s[92:93]
v_cndmask_b32_e64 v181, v181, v14, s[94:95]
v_cndmask_b32_e64 v182, v182, v14, s[96:97]
v_cndmask_b32_e64 v183, v183, v14, s[98:99]
v_cmp_gt_i32_e64 s[84:85], 8, v241
v_cmp_gt_i32_e64 s[86:87], 9, v241
v_cmp_gt_i32_e64 s[88:89], 10, v241
v_cmp_gt_i32_e64 s[90:91], 11, v241
v_cmp_gt_i32_e64 s[92:93], 24, v241
v_cmp_gt_i32_e64 s[94:95], 25, v241
v_cmp_gt_i32_e64 s[96:97], 26, v241
v_cmp_gt_i32_e64 s[98:99], 27, v241
v_cndmask_b32_e64 v184, v184, v14, s[84:85]
v_cndmask_b32_e64 v185, v185, v14, s[86:87]
v_cndmask_b32_e64 v186, v186, v14, s[88:89]
v_cndmask_b32_e64 v187, v187, v14, s[90:91]
v_cndmask_b32_e64 v188, v188, v14, s[92:93]
v_cndmask_b32_e64 v189, v189, v14, s[94:95]
v_cndmask_b32_e64 v190, v190, v14, s[96:97]
v_cndmask_b32_e64 v191, v191, v14, s[98:99]
s_branch L_p3_s0_mask_ret
L_p3_s0_rare:
v_mov_b32 v240, v6
v_mov_b32 v241, v6
s_nop 1
v_permlane32_swap_b32 v240, v241
v_max_f32 v242, v240, v241
v_max_f32 v242, 0, v242
v_exp_f32 v8, -v242
v_sub_f32 v208, v208, v242
v_sub_f32 v209, v209, v242
v_sub_f32 v210, v210, v242
v_sub_f32 v211, v211, v242
v_sub_f32 v212, v212, v242
v_sub_f32 v213, v213, v242
v_sub_f32 v214, v214, v242
v_sub_f32 v215, v215, v242
v_sub_f32 v216, v216, v242
v_sub_f32 v217, v217, v242
v_sub_f32 v218, v218, v242
v_sub_f32 v219, v219, v242
v_sub_f32 v220, v220, v242
v_sub_f32 v221, v221, v242
v_sub_f32 v222, v222, v242
v_sub_f32 v223, v223, v242
v_mul_f32 v2, v2, v8
v_mul_f32 v3, v3, v8
v_sub_f32 v144, v144, v242
v_sub_f32 v145, v145, v242
v_sub_f32 v146, v146, v242
v_sub_f32 v147, v147, v242
v_sub_f32 v148, v148, v242
v_sub_f32 v149, v149, v242
v_sub_f32 v150, v150, v242
v_sub_f32 v151, v151, v242
v_sub_f32 v152, v152, v242
v_sub_f32 v153, v153, v242
v_sub_f32 v154, v154, v242
v_sub_f32 v155, v155, v242
v_sub_f32 v156, v156, v242
v_sub_f32 v157, v157, v242
v_sub_f32 v158, v158, v242
v_sub_f32 v159, v159, v242
v_sub_f32 v176, v176, v242
v_sub_f32 v177, v177, v242
v_sub_f32 v178, v178, v242
v_sub_f32 v179, v179, v242
v_sub_f32 v180, v180, v242
v_sub_f32 v181, v181, v242
v_sub_f32 v182, v182, v242
v_sub_f32 v183, v183, v242
v_sub_f32 v184, v184, v242
v_sub_f32 v185, v185, v242
v_sub_f32 v186, v186, v242
v_sub_f32 v187, v187, v242
v_sub_f32 v188, v188, v242
v_sub_f32 v189, v189, v242
v_sub_f32 v190, v190, v242
v_sub_f32 v191, v191, v242
s_mov_b32 s78, 1
s_branch L_p3_s0_rare_ret
L_p3_s0_resc:
s_nop 15
v_accvgpr_read_b32 v240, a0
v_accvgpr_read_b32 v241, a1
v_accvgpr_read_b32 v242, a2
v_accvgpr_read_b32 v243, a3
v_accvgpr_read_b32 v244, a4
v_accvgpr_read_b32 v245, a5
v_accvgpr_read_b32 v246, a6
v_accvgpr_read_b32 v247, a7
v_mul_f32 v240, v240, v8
v_mul_f32 v241, v241, v8
v_mul_f32 v242, v242, v8
v_mul_f32 v243, v243, v8
v_mul_f32 v244, v244, v8
v_mul_f32 v245, v245, v8
v_mul_f32 v246, v246, v8
v_mul_f32 v247, v247, v8
v_accvgpr_write_b32 a0, v240
v_accvgpr_write_b32 a1, v241
v_accvgpr_write_b32 a2, v242
v_accvgpr_write_b32 a3, v243
v_accvgpr_write_b32 a4, v244
v_accvgpr_write_b32 a5, v245
v_accvgpr_write_b32 a6, v246
v_accvgpr_write_b32 a7, v247
v_accvgpr_read_b32 v240, a8
v_accvgpr_read_b32 v241, a9
v_accvgpr_read_b32 v242, a10
v_accvgpr_read_b32 v243, a11
v_accvgpr_read_b32 v244, a12
v_accvgpr_read_b32 v245, a13
v_accvgpr_read_b32 v246, a14
v_accvgpr_read_b32 v247, a15
v_mul_f32 v240, v240, v8
v_mul_f32 v241, v241, v8
v_mul_f32 v242, v242, v8
v_mul_f32 v243, v243, v8
v_mul_f32 v244, v244, v8
v_mul_f32 v245, v245, v8
v_mul_f32 v246, v246, v8
v_mul_f32 v247, v247, v8
v_accvgpr_write_b32 a8, v240
v_accvgpr_write_b32 a9, v241
v_accvgpr_write_b32 a10, v242
v_accvgpr_write_b32 a11, v243
v_accvgpr_write_b32 a12, v244
v_accvgpr_write_b32 a13, v245
v_accvgpr_write_b32 a14, v246
v_accvgpr_write_b32 a15, v247
v_accvgpr_read_b32 v240, a16
v_accvgpr_read_b32 v241, a17
v_accvgpr_read_b32 v242, a18
v_accvgpr_read_b32 v243, a19
v_accvgpr_read_b32 v244, a20
v_accvgpr_read_b32 v245, a21
v_accvgpr_read_b32 v246, a22
v_accvgpr_read_b32 v247, a23
v_mul_f32 v240, v240, v8
v_mul_f32 v241, v241, v8
v_mul_f32 v242, v242, v8
v_mul_f32 v243, v243, v8
v_mul_f32 v244, v244, v8
v_mul_f32 v245, v245, v8
v_mul_f32 v246, v246, v8
v_mul_f32 v247, v247, v8
v_accvgpr_write_b32 a16, v240
v_accvgpr_write_b32 a17, v241
v_accvgpr_write_b32 a18, v242
v_accvgpr_write_b32 a19, v243
v_accvgpr_write_b32 a20, v244
v_accvgpr_write_b32 a21, v245
v_accvgpr_write_b32 a22, v246
v_accvgpr_write_b32 a23, v247
v_accvgpr_read_b32 v240, a24
v_accvgpr_read_b32 v241, a25
v_accvgpr_read_b32 v242, a26
v_accvgpr_read_b32 v243, a27
v_accvgpr_read_b32 v244, a28
v_accvgpr_read_b32 v245, a29
v_accvgpr_read_b32 v246, a30
v_accvgpr_read_b32 v247, a31
v_mul_f32 v240, v240, v8
v_mul_f32 v241, v241, v8
v_mul_f32 v242, v242, v8
v_mul_f32 v243, v243, v8
v_mul_f32 v244, v244, v8
v_mul_f32 v245, v245, v8
v_mul_f32 v246, v246, v8
v_mul_f32 v247, v247, v8
v_accvgpr_write_b32 a24, v240
v_accvgpr_write_b32 a25, v241
v_accvgpr_write_b32 a26, v242
v_accvgpr_write_b32 a27, v243
v_accvgpr_write_b32 a28, v244
v_accvgpr_write_b32 a29, v245
v_accvgpr_write_b32 a30, v246
v_accvgpr_write_b32 a31, v247
v_accvgpr_read_b32 v240, a32
v_accvgpr_read_b32 v241, a33
v_accvgpr_read_b32 v242, a34
v_accvgpr_read_b32 v243, a35
v_accvgpr_read_b32 v244, a36
v_accvgpr_read_b32 v245, a37
v_accvgpr_read_b32 v246, a38
v_accvgpr_read_b32 v247, a39
v_mul_f32 v240, v240, v8
v_mul_f32 v241, v241, v8
v_mul_f32 v242, v242, v8
v_mul_f32 v243, v243, v8
v_mul_f32 v244, v244, v8
v_mul_f32 v245, v245, v8
v_mul_f32 v246, v246, v8
v_mul_f32 v247, v247, v8
v_accvgpr_write_b32 a32, v240
v_accvgpr_write_b32 a33, v241
v_accvgpr_write_b32 a34, v242
v_accvgpr_write_b32 a35, v243
v_accvgpr_write_b32 a36, v244
v_accvgpr_write_b32 a37, v245
v_accvgpr_write_b32 a38, v246
v_accvgpr_write_b32 a39, v247
v_accvgpr_read_b32 v240, a40
v_accvgpr_read_b32 v241, a41
v_accvgpr_read_b32 v242, a42
v_accvgpr_read_b32 v243, a43
v_accvgpr_read_b32 v244, a44
v_accvgpr_read_b32 v245, a45
v_accvgpr_read_b32 v246, a46
v_accvgpr_read_b32 v247, a47
v_mul_f32 v240, v240, v8
v_mul_f32 v241, v241, v8
v_mul_f32 v242, v242, v8
v_mul_f32 v243, v243, v8
v_mul_f32 v244, v244, v8
v_mul_f32 v245, v245, v8
v_mul_f32 v246, v246, v8
v_mul_f32 v247, v247, v8
v_accvgpr_write_b32 a40, v240
v_accvgpr_write_b32 a41, v241
v_accvgpr_write_b32 a42, v242
v_accvgpr_write_b32 a43, v243
v_accvgpr_write_b32 a44, v244
v_accvgpr_write_b32 a45, v245
v_accvgpr_write_b32 a46, v246
v_accvgpr_write_b32 a47, v247
v_accvgpr_read_b32 v240, a48
v_accvgpr_read_b32 v241, a49
v_accvgpr_read_b32 v242, a50
v_accvgpr_read_b32 v243, a51
v_accvgpr_read_b32 v244, a52
v_accvgpr_read_b32 v245, a53
v_accvgpr_read_b32 v246, a54
v_accvgpr_read_b32 v247, a55
v_mul_f32 v240, v240, v8
v_mul_f32 v241, v241, v8
v_mul_f32 v242, v242, v8
v_mul_f32 v243, v243, v8
v_mul_f32 v244, v244, v8
v_mul_f32 v245, v245, v8
v_mul_f32 v246, v246, v8
v_mul_f32 v247, v247, v8
v_accvgpr_write_b32 a48, v240
v_accvgpr_write_b32 a49, v241
v_accvgpr_write_b32 a50, v242
v_accvgpr_write_b32 a51, v243
v_accvgpr_write_b32 a52, v244
v_accvgpr_write_b32 a53, v245
v_accvgpr_write_b32 a54, v246
v_accvgpr_write_b32 a55, v247
v_accvgpr_read_b32 v240, a56
v_accvgpr_read_b32 v241, a57
v_accvgpr_read_b32 v242, a58
v_accvgpr_read_b32 v243, a59
v_accvgpr_read_b32 v244, a60
v_accvgpr_read_b32 v245, a61
v_accvgpr_read_b32 v246, a62
v_accvgpr_read_b32 v247, a63
v_mul_f32 v240, v240, v8
v_mul_f32 v241, v241, v8
v_mul_f32 v242, v242, v8
v_mul_f32 v243, v243, v8
v_mul_f32 v244, v244, v8
v_mul_f32 v245, v245, v8
v_mul_f32 v246, v246, v8
v_mul_f32 v247, v247, v8
v_accvgpr_write_b32 a56, v240
v_accvgpr_write_b32 a57, v241
v_accvgpr_write_b32 a58, v242
v_accvgpr_write_b32 a59, v243
v_accvgpr_write_b32 a60, v244
v_accvgpr_write_b32 a61, v245
v_accvgpr_write_b32 a62, v246
v_accvgpr_write_b32 a63, v247
s_mov_b32 s78, 0
s_nop 1
s_branch L_p3_s0_resc_ret
L_p3_s1_mask:
s_nop 7
s_lshl_b32 s81, s80, 1
s_sub_u32 s81, s3, s81
s_lshl_b32 s81, s81, 5
v_add_u32 v240, s81, v13
v_add_u32 v241, -32, v240
v_cmp_gt_i32_e64 s[84:85], 0, v240
v_cmp_gt_i32_e64 s[86:87], 1, v240
v_cmp_gt_i32_e64 s[88:89], 2, v240
v_cmp_gt_i32_e64 s[90:91], 3, v240
v_cmp_gt_i32_e64 s[92:93], 16, v240
v_cmp_gt_i32_e64 s[94:95], 17, v240
v_cmp_gt_i32_e64 s[96:97], 18, v240
v_cmp_gt_i32_e64 s[98:99], 19, v240
v_cndmask_b32_e64 v80, v80, v14, s[84:85]
v_cndmask_b32_e64 v81, v81, v14, s[86:87]
v_cndmask_b32_e64 v82, v82, v14, s[88:89]
v_cndmask_b32_e64 v83, v83, v14, s[90:91]
v_cndmask_b32_e64 v84, v84, v14, s[92:93]
v_cndmask_b32_e64 v85, v85, v14, s[94:95]
v_cndmask_b32_e64 v86, v86, v14, s[96:97]
v_cndmask_b32_e64 v87, v87, v14, s[98:99]
v_cmp_gt_i32_e64 s[84:85], 8, v240
v_cmp_gt_i32_e64 s[86:87], 9, v240
v_cmp_gt_i32_e64 s[88:89], 10, v240
v_cmp_gt_i32_e64 s[90:91], 11, v240
v_cmp_gt_i32_e64 s[92:93], 24, v240
v_cmp_gt_i32_e64 s[94:95], 25, v240
v_cmp_gt_i32_e64 s[96:97], 26, v240
v_cmp_gt_i32_e64 s[98:99], 27, v240
v_cndmask_b32_e64 v88, v88, v14, s[84:85]
v_cndmask_b32_e64 v89, v89, v14, s[86:87]
v_cndmask_b32_e64 v90, v90, v14, s[88:89]
v_cndmask_b32_e64 v91, v91, v14, s[90:91]
v_cndmask_b32_e64 v92, v92, v14, s[92:93]
v_cndmask_b32_e64 v93, v93, v14, s[94:95]
v_cndmask_b32_e64 v94, v94, v14, s[96:97]
v_cndmask_b32_e64 v95, v95, v14, s[98:99]
v_cmp_gt_i32_e64 s[84:85], 0, v241
v_cmp_gt_i32_e64 s[86:87], 1, v241
v_cmp_gt_i32_e64 s[88:89], 2, v241
v_cmp_gt_i32_e64 s[90:91], 3, v241
v_cmp_gt_i32_e64 s[92:93], 16, v241
v_cmp_gt_i32_e64 s[94:95], 17, v241
v_cmp_gt_i32_e64 s[96:97], 18, v241
v_cmp_gt_i32_e64 s[98:99], 19, v241
v_cndmask_b32_e64 v112, v112, v14, s[84:85]
v_cndmask_b32_e64 v113, v113, v14, s[86:87]
v_cndmask_b32_e64 v114, v114, v14, s[88:89]
v_cndmask_b32_e64 v115, v115, v14, s[90:91]
v_cndmask_b32_e64 v116, v116, v14, s[92:93]
v_cndmask_b32_e64 v117, v117, v14, s[94:95]
v_cndmask_b32_e64 v118, v118, v14, s[96:97]
v_cndmask_b32_e64 v119, v119, v14, s[98:99]
v_cmp_gt_i32_e64 s[84:85], 8, v241
v_cmp_gt_i32_e64 s[86:87], 9, v241
v_cmp_gt_i32_e64 s[88:89], 10, v241
v_cmp_gt_i32_e64 s[90:91], 11, v241
v_cmp_gt_i32_e64 s[92:93], 24, v241
v_cmp_gt_i32_e64 s[94:95], 25, v241
v_cmp_gt_i32_e64 s[96:97], 26, v241
v_cmp_gt_i32_e64 s[98:99], 27, v241
v_cndmask_b32_e64 v120, v120, v14, s[84:85]
v_cndmask_b32_e64 v121, v121, v14, s[86:87]
v_cndmask_b32_e64 v122, v122, v14, s[88:89]
v_cndmask_b32_e64 v123, v123, v14, s[90:91]
v_cndmask_b32_e64 v124, v124, v14, s[92:93]
v_cndmask_b32_e64 v125, v125, v14, s[94:95]
v_cndmask_b32_e64 v126, v126, v14, s[96:97]
v_cndmask_b32_e64 v127, v127, v14, s[98:99]
s_branch L_p3_s1_mask_ret
L_p3_s1_rare:
v_mov_b32 v240, v6
v_mov_b32 v241, v6
s_nop 1
v_permlane32_swap_b32 v240, v241
v_max_f32 v242, v240, v241
v_max_f32 v242, 0, v242
v_exp_f32 v8, -v242
v_sub_f32 v208, v208, v242
v_sub_f32 v209, v209, v242
v_sub_f32 v210, v210, v242
v_sub_f32 v211, v211, v242
v_sub_f32 v212, v212, v242
v_sub_f32 v213, v213, v242
v_sub_f32 v214, v214, v242
v_sub_f32 v215, v215, v242
v_sub_f32 v216, v216, v242
v_sub_f32 v217, v217, v242
v_sub_f32 v218, v218, v242
v_sub_f32 v219, v219, v242
v_sub_f32 v220, v220, v242
v_sub_f32 v221, v221, v242
v_sub_f32 v222, v222, v242
v_sub_f32 v223, v223, v242
v_mul_f32 v2, v2, v8
v_mul_f32 v3, v3, v8
v_sub_f32 v80, v80, v242
v_sub_f32 v81, v81, v242
v_sub_f32 v82, v82, v242
v_sub_f32 v83, v83, v242
v_sub_f32 v84, v84, v242
v_sub_f32 v85, v85, v242
v_sub_f32 v86, v86, v242
v_sub_f32 v87, v87, v242
v_sub_f32 v88, v88, v242
v_sub_f32 v89, v89, v242
v_sub_f32 v90, v90, v242
v_sub_f32 v91, v91, v242
v_sub_f32 v92, v92, v242
v_sub_f32 v93, v93, v242
v_sub_f32 v94, v94, v242
v_sub_f32 v95, v95, v242
v_sub_f32 v112, v112, v242
v_sub_f32 v113, v113, v242
v_sub_f32 v114, v114, v242
v_sub_f32 v115, v115, v242
v_sub_f32 v116, v116, v242
v_sub_f32 v117, v117, v242
v_sub_f32 v118, v118, v242
v_sub_f32 v119, v119, v242
v_sub_f32 v120, v120, v242
v_sub_f32 v121, v121, v242
v_sub_f32 v122, v122, v242
v_sub_f32 v123, v123, v242
v_sub_f32 v124, v124, v242
v_sub_f32 v125, v125, v242
v_sub_f32 v126, v126, v242
v_sub_f32 v127, v127, v242
s_mov_b32 s78, 1
s_branch L_p3_s1_rare_ret
L_p3_s1_resc:
s_nop 15
v_accvgpr_read_b32 v240, a0
v_accvgpr_read_b32 v241, a1
v_accvgpr_read_b32 v242, a2
v_accvgpr_read_b32 v243, a3
v_accvgpr_read_b32 v244, a4
v_accvgpr_read_b32 v245, a5
v_accvgpr_read_b32 v246, a6
v_accvgpr_read_b32 v247, a7
v_mul_f32 v240, v240, v8
v_mul_f32 v241, v241, v8
v_mul_f32 v242, v242, v8
v_mul_f32 v243, v243, v8
v_mul_f32 v244, v244, v8
v_mul_f32 v245, v245, v8
v_mul_f32 v246, v246, v8
v_mul_f32 v247, v247, v8
v_accvgpr_write_b32 a0, v240
v_accvgpr_write_b32 a1, v241
v_accvgpr_write_b32 a2, v242
v_accvgpr_write_b32 a3, v243
v_accvgpr_write_b32 a4, v244
v_accvgpr_write_b32 a5, v245
v_accvgpr_write_b32 a6, v246
v_accvgpr_write_b32 a7, v247
v_accvgpr_read_b32 v240, a8
v_accvgpr_read_b32 v241, a9
v_accvgpr_read_b32 v242, a10
v_accvgpr_read_b32 v243, a11
v_accvgpr_read_b32 v244, a12
v_accvgpr_read_b32 v245, a13
v_accvgpr_read_b32 v246, a14
v_accvgpr_read_b32 v247, a15
v_mul_f32 v240, v240, v8
v_mul_f32 v241, v241, v8
v_mul_f32 v242, v242, v8
v_mul_f32 v243, v243, v8
v_mul_f32 v244, v244, v8
v_mul_f32 v245, v245, v8
v_mul_f32 v246, v246, v8
v_mul_f32 v247, v247, v8
v_accvgpr_write_b32 a8, v240
v_accvgpr_write_b32 a9, v241
v_accvgpr_write_b32 a10, v242
v_accvgpr_write_b32 a11, v243
v_accvgpr_write_b32 a12, v244
v_accvgpr_write_b32 a13, v245
v_accvgpr_write_b32 a14, v246
v_accvgpr_write_b32 a15, v247
v_accvgpr_read_b32 v240, a16
v_accvgpr_read_b32 v241, a17
v_accvgpr_read_b32 v242, a18
v_accvgpr_read_b32 v243, a19
v_accvgpr_read_b32 v244, a20
v_accvgpr_read_b32 v245, a21
v_accvgpr_read_b32 v246, a22
v_accvgpr_read_b32 v247, a23
v_mul_f32 v240, v240, v8
v_mul_f32 v241, v241, v8
v_mul_f32 v242, v242, v8
v_mul_f32 v243, v243, v8
v_mul_f32 v244, v244, v8
v_mul_f32 v245, v245, v8
v_mul_f32 v246, v246, v8
v_mul_f32 v247, v247, v8
v_accvgpr_write_b32 a16, v240
v_accvgpr_write_b32 a17, v241
v_accvgpr_write_b32 a18, v242
v_accvgpr_write_b32 a19, v243
v_accvgpr_write_b32 a20, v244
v_accvgpr_write_b32 a21, v245
v_accvgpr_write_b32 a22, v246
v_accvgpr_write_b32 a23, v247
v_accvgpr_read_b32 v240, a24
v_accvgpr_read_b32 v241, a25
v_accvgpr_read_b32 v242, a26
v_accvgpr_read_b32 v243, a27
v_accvgpr_read_b32 v244, a28
v_accvgpr_read_b32 v245, a29
v_accvgpr_read_b32 v246, a30
v_accvgpr_read_b32 v247, a31
v_mul_f32 v240, v240, v8
v_mul_f32 v241, v241, v8
v_mul_f32 v242, v242, v8
v_mul_f32 v243, v243, v8
v_mul_f32 v244, v244, v8
v_mul_f32 v245, v245, v8
v_mul_f32 v246, v246, v8
v_mul_f32 v247, v247, v8
v_accvgpr_write_b32 a24, v240
v_accvgpr_write_b32 a25, v241
v_accvgpr_write_b32 a26, v242
v_accvgpr_write_b32 a27, v243
v_accvgpr_write_b32 a28, v244
v_accvgpr_write_b32 a29, v245
v_accvgpr_write_b32 a30, v246
v_accvgpr_write_b32 a31, v247
v_accvgpr_read_b32 v240, a32
v_accvgpr_read_b32 v241, a33
v_accvgpr_read_b32 v242, a34
v_accvgpr_read_b32 v243, a35
v_accvgpr_read_b32 v244, a36
v_accvgpr_read_b32 v245, a37
v_accvgpr_read_b32 v246, a38
v_accvgpr_read_b32 v247, a39
v_mul_f32 v240, v240, v8
v_mul_f32 v241, v241, v8
v_mul_f32 v242, v242, v8
v_mul_f32 v243, v243, v8
v_mul_f32 v244, v244, v8
v_mul_f32 v245, v245, v8
v_mul_f32 v246, v246, v8
v_mul_f32 v247, v247, v8
v_accvgpr_write_b32 a32, v240
v_accvgpr_write_b32 a33, v241
v_accvgpr_write_b32 a34, v242
v_accvgpr_write_b32 a35, v243
v_accvgpr_write_b32 a36, v244
v_accvgpr_write_b32 a37, v245
v_accvgpr_write_b32 a38, v246
v_accvgpr_write_b32 a39, v247
v_accvgpr_read_b32 v240, a40
v_accvgpr_read_b32 v241, a41
v_accvgpr_read_b32 v242, a42
v_accvgpr_read_b32 v243, a43
v_accvgpr_read_b32 v244, a44
v_accvgpr_read_b32 v245, a45
v_accvgpr_read_b32 v246, a46
v_accvgpr_read_b32 v247, a47
v_mul_f32 v240, v240, v8
v_mul_f32 v241, v241, v8
v_mul_f32 v242, v242, v8
v_mul_f32 v243, v243, v8
v_mul_f32 v244, v244, v8
v_mul_f32 v245, v245, v8
v_mul_f32 v246, v246, v8
v_mul_f32 v247, v247, v8
v_accvgpr_write_b32 a40, v240
v_accvgpr_write_b32 a41, v241
v_accvgpr_write_b32 a42, v242
v_accvgpr_write_b32 a43, v243
v_accvgpr_write_b32 a44, v244
v_accvgpr_write_b32 a45, v245
v_accvgpr_write_b32 a46, v246
v_accvgpr_write_b32 a47, v247
v_accvgpr_read_b32 v240, a48
v_accvgpr_read_b32 v241, a49
v_accvgpr_read_b32 v242, a50
v_accvgpr_read_b32 v243, a51
v_accvgpr_read_b32 v244, a52
v_accvgpr_read_b32 v245, a53
v_accvgpr_read_b32 v246, a54
v_accvgpr_read_b32 v247, a55
v_mul_f32 v240, v240, v8
v_mul_f32 v241, v241, v8
v_mul_f32 v242, v242, v8
v_mul_f32 v243, v243, v8
v_mul_f32 v244, v244, v8
v_mul_f32 v245, v245, v8
v_mul_f32 v246, v246, v8
v_mul_f32 v247, v247, v8
v_accvgpr_write_b32 a48, v240
v_accvgpr_write_b32 a49, v241
v_accvgpr_write_b32 a50, v242
v_accvgpr_write_b32 a51, v243
v_accvgpr_write_b32 a52, v244
v_accvgpr_write_b32 a53, v245
v_accvgpr_write_b32 a54, v246
v_accvgpr_write_b32 a55, v247
v_accvgpr_read_b32 v240, a56
v_accvgpr_read_b32 v241, a57
v_accvgpr_read_b32 v242, a58
v_accvgpr_read_b32 v243, a59
v_accvgpr_read_b32 v244, a60
v_accvgpr_read_b32 v245, a61
v_accvgpr_read_b32 v246, a62
v_accvgpr_read_b32 v247, a63
v_mul_f32 v240, v240, v8
v_mul_f32 v241, v241, v8
v_mul_f32 v242, v242, v8
v_mul_f32 v243, v243, v8
v_mul_f32 v244, v244, v8
v_mul_f32 v245, v245, v8
v_mul_f32 v246, v246, v8
v_mul_f32 v247, v247, v8
v_accvgpr_write_b32 a56, v240
v_accvgpr_write_b32 a57, v241
v_accvgpr_write_b32 a58, v242
v_accvgpr_write_b32 a59, v243
v_accvgpr_write_b32 a60, v244
v_accvgpr_write_b32 a61, v245
v_accvgpr_write_b32 a62, v246
v_accvgpr_write_b32 a63, v247
s_mov_b32 s78, 0
s_nop 1
s_branch L_p3_s1_resc_ret
L_spin_go:
s_mov_b32 s36, 400000
L_spin_go_l:
s_sleep 1
buffer_load_dword v254, off, s[12:15], 0 sc1
s_waitcnt vmcnt(0)
v_cmp_ne_u32 vcc, 1, v254
s_nop 4
s_cbranch_vccz L_spin_go_ret
s_sub_u32 s36, s36, 1
s_cmp_lg_u32 s36, 0
s_cbranch_scc1 L_spin_go_l
s_branch L_spin_go_ret
L_spin_f1:
s_mov_b32 s36, 400000
L_spin_f1_l:
s_sleep 1
buffer_load_dword v237, v233, s[8:11], 0 offen offset:0 sc1
s_waitcnt vmcnt(0)
v_cmp_ne_u32 vcc, 1, v237
s_nop 4
s_cbranch_vccz L_spin_f1_ret
s_sub_u32 s36, s36, 1
s_cmp_lg_u32 s36, 0
s_cbranch_scc1 L_spin_f1_l
s_branch L_spin_f1_ret
L_spin_f2:
s_mov_b32 s36, 400000
L_spin_f2_l:
s_sleep 1
buffer_load_dword v253, v254, s[8:11], 0 offen offset:2048 sc1
s_waitcnt vmcnt(0)
v_cmp_ne_u32 vcc, 1, v253
s_nop 4
s_cbranch_vccz L_spin_f2_ret
s_sub_u32 s36, s36, 1
s_cmp_lg_u32 s36, 0
s_cbranch_scc1 L_spin_f2_l
s_branch L_spin_f2_ret
L_spin_f3:
s_mov_b32 s36, 400000
L_spin_f3_l:
s_sleep 1
buffer_load_dword v253, v254, s[8:11], 0 offen offset:3072 sc1
s_waitcnt vmcnt(0)
v_cmp_ne_u32 vcc, 1, v253
s_nop 4
s_cbranch_vccz L_spin_f3_ret
s_sub_u32 s36, s36, 1
s_cmp_lg_u32 s36, 0
s_cbranch_scc1 L_spin_f3_l
s_branch L_spin_f3_ret
L_code_end:
s_endpgm
.section .rodata,"a"
.p2align 6
.amdhsa_kernel gated_mix__ssm_conv_h3__compressed_kv_cla__prompt_kernel
  .amdhsa_next_free_vgpr 512
  .amdhsa_next_free_sgpr 102
  .amdhsa_accum_offset 256
  .amdhsa_group_segment_fixed_size 0
  .amdhsa_kernarg_size 128
  .amdhsa_user_sgpr_count 2
  .amdhsa_user_sgpr_kernarg_segment_ptr 1
  .amdhsa_system_sgpr_workgroup_id_x 1
  .amdhsa_float_denorm_mode_32 3
.end_amdhsa_kernel
.text
```

```asm
; @launch grid=(256,1,1) block=(256,1,1) lds=163840
.amdgcn_target "amdgcn-amd-amdhsa--gfx950"
.text
.macro MA d,x,a,y,b
v_mfma_f32_16x16x32_bf16 a[\d:\d+3], \x[\a:\a+3], \y[\b:\b+3], a[\d:\d+3]
.endm
.macro MV d,x,a,y,b
v_mfma_f32_16x16x32_bf16 v[\d:\d+3], \x[\a:\a+3], \y[\b:\b+3], v[\d:\d+3]
.endm
.macro TR d,a,o
ds_read_b64_tr_b16 v[\d:\d+1], v\a offset:\o
.endm
.globl gated_mix__ssm_conv_h3__compressed_kv_cla__prompt_kernel
.p2align 8
.type gated_mix__ssm_conv_h3__compressed_kv_cla__prompt_kernel,@function
gated_mix__ssm_conv_h3__compressed_kv_cla__prompt_kernel:
s_cmp_ge_u32 s2, 256
s_cbranch_scc1 L_end
s_load_dwordx2 s[88:89], s[0:1], 56
s_load_dwordx4 s[92:95], s[0:1], 72
s_load_dwordx2 s[40:41], s[0:1], 120
s_load_dwordx2 s[96:97], s[0:1], 112
s_load_dwordx2 s[32:33], s[0:1], 0
s_load_dwordx2 s[34:35], s[0:1], 64
v_lshrrev_b32 v2, 6, v0
v_and_b32 v1, 63, v0
v_lshlrev_b32 v3, 4, v0
v_readfirstlane_b32 s3, v2
s_and_b32 s36, s2, 7
s_lshr_b32 s37, s2, 3
s_and_b32 s38, s37, 7
s_lshr_b32 s37, s37, 3
s_lshr_b32 s42, s37, 1
s_and_b32 s37, s37, 1
s_lshl_b32 s36, s36, 1
s_add_u32 s36, s36, s37
s_lshl_b32 s24, s38, 18
s_lshl_b32 s39, s3, 16
s_add_u32 s24, s24, s39
s_lshl_b32 s25, s3, 17
s_lshl_b32 s39, s36, 9
s_add_u32 s25, s25, s39
s_and_b32 s20, s2, 7
s_lshl_b32 s21, s20, 19
s_lshl_b32 s20, s20, 7
s_lshl_b32 s22, s3, 13
s_add_u32 s23, s22, 98304
v_lshrrev_b32 v204, 3, v1
v_lshlrev_b32 v204, 10, v204
v_lshrrev_b32 v205, 4, v1
v_and_b32 v206, 7, v1
v_xor_b32 v206, v206, v205
v_lshl_add_u32 v204, v206, 4, v204
v_xor_b32 v207, 64, v204
v_add_u32 v176, 0, v204
v_add_u32 v177, 7168, v207
v_add_u32 v178, 14336, v204
v_add_u32 v179, 21504, v207
v_add_u32 v180, 32768, v204
v_add_u32 v181, 39936, v207
v_add_u32 v182, 47104, v204
v_add_u32 v183, 54272, v207
v_lshrrev_b32 v204, 5, v1
v_and_b32 v206, 31, v1
v_lshlrev_b32 v207, 1, v204
v_xor_b32 v206, v206, v207
v_lshlrev_b32 v204, 13, v204
v_xor_b32 v207, 0, v206
v_lshl_add_u32 v207, v207, 4, v204
v_add_u32 v184, 0, v207
v_xor_b32 v207, 4, v206
v_lshl_add_u32 v207, v207, 4, v204
v_add_u32 v185, 15360, v207
v_xor_b32 v207, 0, v206
v_lshl_add_u32 v207, v207, 4, v204
v_add_u32 v186, 30720, v207
v_xor_b32 v207, 4, v206
v_lshl_add_u32 v207, v207, 4, v204
v_add_u32 v187, 46080, v207
v_xor_b32 v207, 8, v206
v_lshl_add_u32 v207, v207, 4, v204
v_add_u32 v188, 65536, v207
v_xor_b32 v207, 12, v206
v_lshl_add_u32 v207, v207, 4, v204
v_add_u32 v189, 80896, v207
v_xor_b32 v207, 8, v206
v_lshl_add_u32 v207, v207, 4, v204
v_add_u32 v190, 96256, v207
v_xor_b32 v207, 12, v206
v_lshl_add_u32 v207, v207, 4, v204
v_add_u32 v191, 111616, v207
s_waitcnt lgkmcnt(0)
s_add_u32 s8, s88, s24
s_addc_u32 s9, s89, 0
s_mov_b32 s10, 65536
s_mov_b32 s11, 0x20000
s_cmp_eq_u32 s42, 0
s_cselect_b32 s12, s92, s94
s_cselect_b32 s13, s93, s95
s_add_u32 s12, s12, s25
s_addc_u32 s13, s13, 0
s_sub_u32 s14, 4194304, s25
s_mov_b32 s15, 0x20000
s_add_u32 s4, s40, 59768832
s_addc_u32 s5, s41, 0
s_mov_b32 s6, 4096
s_mov_b32 s7, 0x20000
s_lshl_b32 s43, s2, 20
v_add_u32 v3, s43, v3
v_mov_b32 v4, 0
v_mov_b32 v5, 0
v_mov_b32 v6, 0
v_mov_b32 v7, 0
buffer_store_dwordx4 v[4:7], v3, s[4:7], 0 offen sc1
s_add_u32 m0, s23, 0
s_nop 0
buffer_load_dwordx4 v184, s[12:15], s21 offen offset:0 lds
buffer_load_dwordx4 v185, s[12:15], s21 offen offset:1024 lds
buffer_load_dwordx4 v186, s[12:15], s21 offen offset:2048 lds
buffer_load_dwordx4 v187, s[12:15], s21 offen offset:3072 lds
s_add_u32 m0, s23, 4096
s_nop 0
buffer_load_dwordx4 v188, s[12:15], s21 offen offset:0 lds
buffer_load_dwordx4 v189, s[12:15], s21 offen offset:1024 lds
buffer_load_dwordx4 v190, s[12:15], s21 offen offset:2048 lds
buffer_load_dwordx4 v191, s[12:15], s21 offen offset:3072 lds
s_add_u32 s21, s21, 524288
s_and_b32 s21, s21, 4194303
s_add_u32 m0, s22, 0
s_nop 0
buffer_load_dwordx4 v176, s[8:11], s20 offen offset:0 lds
buffer_load_dwordx4 v177, s[8:11], s20 offen offset:1024 lds
buffer_load_dwordx4 v178, s[8:11], s20 offen offset:2048 lds
buffer_load_dwordx4 v179, s[8:11], s20 offen offset:3072 lds
s_add_u32 m0, s22, 4096
s_nop 0
buffer_load_dwordx4 v180, s[8:11], s20 offen offset:0 lds
buffer_load_dwordx4 v181, s[8:11], s20 offen offset:1024 lds
buffer_load_dwordx4 v182, s[8:11], s20 offen offset:2048 lds
buffer_load_dwordx4 v183, s[8:11], s20 offen offset:3072 lds
s_add_u32 s20, s20, 128
s_and_b32 s20, s20, 1023
v_and_b32 v204, 15, v1
v_lshrrev_b32 v206, 1, v204
v_xor_b32 v206, v206, v205
v_lshlrev_b32 v206, 4, v206
v_lshl_add_u32 v206, v204, 7, v206
s_and_b32 s39, s3, 1
s_lshl_b32 s39, s39, 14
v_add_u32 v192, s39, v206
v_xor_b32 v193, 64, v192
v_add_u32 v194, 0x10000, v192
v_add_u32 v195, 0x10000, v193
v_bfe_u32 v204, v1, 2, 2
v_and_b32 v206, 1, v205
v_lshl_or_b32 v206, v206, 2, v204
v_lshl_add_u32 v204, v205, 3, v204
v_lshlrev_b32 v204, 9, v204
v_and_b32 v207, 3, v1
v_lshl_add_u32 v204, v207, 3, v204
s_lshr_b32 s39, s3, 1
s_lshl_b32 s39, s39, 8
s_add_u32 s39, s39, 98304
v_add_u32 v204, s39, v204
v_xor_b32 v207, 0, v206
v_lshl_add_u32 v196, v207, 5, v204
v_xor_b32 v207, 1, v206
v_lshl_add_u32 v197, v207, 5, v204
v_xor_b32 v207, 2, v206
v_lshl_add_u32 v198, v207, 5, v204
v_xor_b32 v207, 3, v206
v_lshl_add_u32 v199, v207, 5, v204
v_xor_b32 v207, 4, v206
v_lshl_add_u32 v200, v207, 5, v204
v_xor_b32 v207, 5, v206
v_lshl_add_u32 v201, v207, 5, v204
v_xor_b32 v207, 6, v206
v_lshl_add_u32 v202, v207, 5, v204
v_xor_b32 v207, 7, v206
v_lshl_add_u32 v203, v207, 5, v204
s_lshl_b32 s36, s36, 1
s_lshr_b32 s39, s3, 1
s_add_u32 s36, s36, s39
s_lshl_b32 s24, s36, 19
s_lshl_b32 s38, s38, 16
s_add_u32 s24, s24, s38
s_and_b32 s39, s3, 1
s_lshl_b32 s39, s39, 15
s_add_u32 s24, s24, s39
s_lshl_b32 s36, s42, 24
s_add_u32 s16, s40, s36
s_addc_u32 s17, s41, 0
s_mov_b32 s18, 16777216
s_mov_b32 s19, 0x20000
s_mov_b32 s98, 256
s_mov_b32 s99, 0x20000
v_lshlrev_b32 v3, 16, v3
v_mov_b32 v4, 1
s_cmp_lg_u32 s2, 0
s_cselect_b32 s43, 0x10000000, 0
v_or_b32 v3, s43, v3
s_waitcnt vmcnt(0)
s_barrier
buffer_store_dword v4, v3, s[96:99], 0 offen sc1
ds_read_b128 v[80:83], v192 offset:0
ds_read_b128 v[84:87], v192 offset:2048
ds_read_b128 v[88:91], v192 offset:4096
ds_read_b128 v[92:95], v192 offset:6144
ds_read_b128 v[96:99], v192 offset:8192
ds_read_b128 v[100:103], v192 offset:10240
ds_read_b128 v[104:107], v192 offset:12288
ds_read_b128 v[108:111], v192 offset:14336
TR 144,196,0
TR 146,196,2048
TR 148,197,0
TR 150,197,2048
TR 152,198,0
TR 154,198,2048
TR 156,199,0
TR 158,199,2048
TR 160,200,0
TR 162,200,2048
TR 164,201,0
TR 166,201,2048
TR 168,202,0
TR 170,202,2048
TR 172,203,0
TR 174,203,2048
s_cmp_eq_u32 s42, 0
s_cbranch_scc0 L_p1_V
s_waitcnt lgkmcnt(14)
v_mfma_f32_16x16x32_bf16 a[0:3], v[144:147], v[80:83], 0
s_add_u32 m0, s23, 32768
s_add_u32 s25, s24, 128
v_mfma_f32_16x16x32_bf16 a[8:11], v[144:147], v[84:87], 0
ds_read_b128 v[112:115], v193 offset:0
v_mfma_f32_16x16x32_bf16 a[64:67], v[144:147], v[88:91], 0
buffer_load_dwordx4 v184, s[12:15], s21 offen offset:0 lds
v_mfma_f32_16x16x32_bf16 a[72:75], v[144:147], v[92:95], 0
v_mfma_f32_16x16x32_bf16 a[128:131], v[144:147], v[96:99], 0
v_mfma_f32_16x16x32_bf16 a[136:139], v[144:147], v[100:103], 0
buffer_load_dwordx4 v185, s[12:15], s21 offen offset:1024 lds
v_mfma_f32_16x16x32_bf16 a[192:195], v[144:147], v[104:107], 0
v_mfma_f32_16x16x32_bf16 a[200:203], v[144:147], v[108:111], 0
TR 144,196,16384
TR 146,196,18432
s_waitcnt lgkmcnt(15)
v_mfma_f32_16x16x32_bf16 a[4:7], v[148:151], v[80:83], 0
ds_read_b128 v[116:119], v193 offset:2048
buffer_load_dwordx4 v186, s[12:15], s21 offen offset:2048 lds
v_mfma_f32_16x16x32_bf16 a[12:15], v[148:151], v[84:87], 0
s_add_u32 s26, s24, 2048
v_mfma_f32_16x16x32_bf16 a[68:71], v[148:151], v[88:91], 0
buffer_load_dwordx4 v187, s[12:15], s21 offen offset:3072 lds
v_mfma_f32_16x16x32_bf16 a[76:79], v[148:151], v[92:95], 0
v_mfma_f32_16x16x32_bf16 a[132:135], v[148:151], v[96:99], 0
s_add_u32 m0, s23, 36864
v_mfma_f32_16x16x32_bf16 a[140:143], v[148:151], v[100:103], 0
ds_read_b128 v[120:123], v193 offset:4096
v_mfma_f32_16x16x32_bf16 a[196:199], v[148:151], v[104:107], 0
v_mfma_f32_16x16x32_bf16 a[204:207], v[148:151], v[108:111], 0
TR 148,197,16384
TR 150,197,18432
s_waitcnt lgkmcnt(15)
v_mfma_f32_16x16x32_bf16 a[16:19], v[152:155], v[80:83], 0
buffer_load_dwordx4 v188, s[12:15], s21 offen offset:0 lds
v_mfma_f32_16x16x32_bf16 a[24:27], v[152:155], v[84:87], 0
s_add_u32 s27, s24, 2176
v_mfma_f32_16x16x32_bf16 a[80:83], v[152:155], v[88:91], 0
buffer_load_dwordx4 v189, s[12:15], s21 offen offset:1024 lds
v_mfma_f32_16x16x32_bf16 a[88:91], v[152:155], v[92:95], 0
v_mfma_f32_16x16x32_bf16 a[144:147], v[152:155], v[96:99], 0
ds_read_b128 v[124:127], v193 offset:6144
buffer_load_dwordx4 v190, s[12:15], s21 offen offset:2048 lds
v_mfma_f32_16x16x32_bf16 a[152:155], v[152:155], v[100:103], 0
v_mfma_f32_16x16x32_bf16 a[208:211], v[152:155], v[104:107], 0
v_mfma_f32_16x16x32_bf16 a[216:219], v[152:155], v[108:111], 0
TR 152,198,16384
TR 154,198,18432
v_mfma_f32_16x16x32_bf16 a[20:23], v[156:159], v[80:83], 0
buffer_load_dwordx4 v191, s[12:15], s21 offen offset:3072 lds
v_mfma_f32_16x16x32_bf16 a[28:31], v[156:159], v[84:87], 0
s_add_u32 s21, s21, 524288
v_mfma_f32_16x16x32_bf16 a[84:87], v[156:159], v[88:91], 0
ds_read_b128 v[128:131], v193 offset:8192
s_add_u32 s28, s24, 4096
v_mfma_f32_16x16x32_bf16 a[92:95], v[156:159], v[92:95], 0
v_mfma_f32_16x16x32_bf16 a[148:151], v[156:159], v[96:99], 0
s_and_b32 s21, s21, 4194303
v_mfma_f32_16x16x32_bf16 a[156:159], v[156:159], v[100:103], 0
v_mfma_f32_16x16x32_bf16 a[212:215], v[156:159], v[104:107], 0
v_mfma_f32_16x16x32_bf16 a[220:223], v[156:159], v[108:111], 0
TR 156,199,16384
TR 158,199,18432
s_waitcnt lgkmcnt(15)
v_mfma_f32_16x16x32_bf16 a[32:35], v[160:163], v[80:83], 0
ds_read_b128 v[132:135], v193 offset:10240
s_add_u32 m0, s22, 32768
v_mfma_f32_16x16x32_bf16 a[40:43], v[160:163], v[84:87], 0
buffer_load_dwordx4 v176, s[8:11], s20 offen offset:0 lds
v_mfma_f32_16x16x32_bf16 a[96:99], v[160:163], v[88:91], 0
v_mfma_f32_16x16x32_bf16 a[104:107], v[160:163], v[92:95], 0
s_add_u32 s29, s24, 4224
v_mfma_f32_16x16x32_bf16 a[160:163], v[160:163], v[96:99], 0
buffer_load_dwordx4 v177, s[8:11], s20 offen offset:1024 lds
v_mfma_f32_16x16x32_bf16 a[168:171], v[160:163], v[100:103], 0
v_mfma_f32_16x16x32_bf16 a[224:227], v[160:163], v[104:107], 0
buffer_load_dwordx4 v178, s[8:11], s20 offen offset:2048 lds
v_mfma_f32_16x16x32_bf16 a[232:235], v[160:163], v[108:111], 0
TR 160,200,16384
TR 162,200,18432
v_mfma_f32_16x16x32_bf16 a[36:39], v[164:167], v[80:83], 0
ds_read_b128 v[136:139], v193 offset:12288
v_mfma_f32_16x16x32_bf16 a[44:47], v[164:167], v[84:87], 0
buffer_load_dwordx4 v179, s[8:11], s20 offen offset:3072 lds
v_mfma_f32_16x16x32_bf16 a[100:103], v[164:167], v[88:91], 0
v_mfma_f32_16x16x32_bf16 a[108:111], v[164:167], v[92:95], 0
s_add_u32 m0, s22, 36864
v_mfma_f32_16x16x32_bf16 a[164:167], v[164:167], v[96:99], 0
s_add_u32 s30, s24, 6144
v_mfma_f32_16x16x32_bf16 a[172:175], v[164:167], v[100:103], 0
ds_read_b128 v[140:143], v193 offset:14336
v_mfma_f32_16x16x32_bf16 a[228:231], v[164:167], v[104:107], 0
buffer_load_dwordx4 v180, s[8:11], s20 offen offset:0 lds
v_mfma_f32_16x16x32_bf16 a[236:239], v[164:167], v[108:111], 0
TR 164,201,16384
TR 166,201,18432
v_mfma_f32_16x16x32_bf16 a[48:51], v[168:171], v[80:83], 0
v_mfma_f32_16x16x32_bf16 a[56:59], v[168:171], v[84:87], 0
buffer_load_dwordx4 v181, s[8:11], s20 offen offset:1024 lds
v_mfma_f32_16x16x32_bf16 a[112:115], v[168:171], v[88:91], 0
v_mfma_f32_16x16x32_bf16 a[120:123], v[168:171], v[92:95], 0
buffer_load_dwordx4 v182, s[8:11], s20 offen offset:2048 lds
v_mfma_f32_16x16x32_bf16 a[176:179], v[168:171], v[96:99], 0
v_mfma_f32_16x16x32_bf16 a[184:187], v[168:171], v[100:103], 0
s_add_u32 s31, s24, 6272
v_mfma_f32_16x16x32_bf16 a[240:243], v[168:171], v[104:107], 0
buffer_load_dwordx4 v183, s[8:11], s20 offen offset:3072 lds
v_mfma_f32_16x16x32_bf16 a[248:251], v[168:171], v[108:111], 0
TR 168,202,16384
TR 170,202,18432
s_waitcnt lgkmcnt(15)
v_mfma_f32_16x16x32_bf16 a[52:55], v[172:175], v[80:83], 0
s_add_u32 s20, s20, 128
v_mfma_f32_16x16x32_bf16 a[60:63], v[172:175], v[84:87], 0
v_mfma_f32_16x16x32_bf16 a[116:119], v[172:175], v[88:91], 0
v_mfma_f32_16x16x32_bf16 a[124:127], v[172:175], v[92:95], 0
s_and_b32 s20, s20, 1023
v_mfma_f32_16x16x32_bf16 a[180:183], v[172:175], v[96:99], 0
v_mfma_f32_16x16x32_bf16 a[188:191], v[172:175], v[100:103], 0
v_mfma_f32_16x16x32_bf16 a[244:247], v[172:175], v[104:107], 0
v_mfma_f32_16x16x32_bf16 a[252:255], v[172:175], v[108:111], 0
TR 172,203,16384
TR 174,203,18432
s_waitcnt lgkmcnt(2)
MA 0,v,144,v,112
s_add_u32 m0, s22, 65536
MA 8,v,144,v,116
MA 64,v,144,v,120
MA 72,v,144,v,124
buffer_load_dwordx4 v176, s[8:11], s20 offen offset:0 lds
MA 128,v,144,v,128
MA 136,v,144,v,132
MA 192,v,144,v,136
MA 200,v,144,v,140
buffer_load_dwordx4 v177, s[8:11], s20 offen offset:1024 lds
MA 4,v,148,v,112
MA 12,v,148,v,116
MA 68,v,148,v,120
buffer_load_dwordx4 v178, s[8:11], s20 offen offset:2048 lds
MA 76,v,148,v,124
MA 132,v,148,v,128
MA 140,v,148,v,132
MA 196,v,148,v,136
buffer_load_dwordx4 v179, s[8:11], s20 offen offset:3072 lds
MA 204,v,148,v,140
MA 16,v,152,v,112
MA 24,v,152,v,116
s_add_u32 m0, s22, 69632
MA 80,v,152,v,120
MA 88,v,152,v,124
MA 144,v,152,v,128
MA 152,v,152,v,132
buffer_load_dwordx4 v180, s[8:11], s20 offen offset:0 lds
MA 208,v,152,v,136
MA 216,v,152,v,140
MA 20,v,156,v,112
MA 28,v,156,v,116
buffer_load_dwordx4 v181, s[8:11], s20 offen offset:1024 lds
MA 84,v,156,v,120
MA 92,v,156,v,124
MA 148,v,156,v,128
buffer_load_dwordx4 v182, s[8:11], s20 offen offset:2048 lds
MA 156,v,156,v,132
MA 212,v,156,v,136
MA 220,v,156,v,140
MA 32,v,160,v,112
buffer_load_dwordx4 v183, s[8:11], s20 offen offset:3072 lds
MA 40,v,160,v,116
MA 96,v,160,v,120
MA 104,v,160,v,124
s_add_u32 s20, s20, 128
MA 160,v,160,v,128
MA 168,v,160,v,132
MA 224,v,160,v,136
MA 232,v,160,v,140
s_and_b32 s20, s20, 1023
MA 36,v,164,v,112
MA 44,v,164,v,116
MA 100,v,164,v,120
MA 108,v,164,v,124
MA 164,v,164,v,128
s_waitcnt vmcnt(8) lgkmcnt(0)
s_barrier
MA 172,v,164,v,132
TR 144,196,32768
TR 146,196,34816
MA 228,v,164,v,136
ds_read_b128 v[80:83], v192 offset:32768
s_add_u32 m0, s23, 0
MA 236,v,164,v,140
TR 148,197,32768
TR 150,197,34816
MA 48,v,168,v,112
ds_read_b128 v[84:87], v192 offset:34816
ds_read_b128 v[88:91], v192 offset:36864
MA 56,v,168,v,116
TR 152,198,32768
TR 154,198,34816
MA 112,v,168,v,120
ds_read_b128 v[92:95], v192 offset:38912
ds_read_b128 v[96:99], v192 offset:40960
MA 120,v,168,v,124
TR 156,199,32768
TR 158,199,34816
MA 176,v,168,v,128
ds_read_b128 v[100:103], v192 offset:43008
ds_read_b128 v[104:107], v192 offset:45056
MA 184,v,168,v,132
TR 160,200,32768
TR 162,200,34816
MA 240,v,168,v,136
ds_read_b128 v[108:111], v192 offset:47104
buffer_load_dwordx4 v184, s[12:15], s21 offen offset:0 lds
MA 248,v,168,v,140
TR 164,201,32768
TR 166,201,34816
MA 52,v,172,v,112
buffer_load_dwordx4 v185, s[12:15], s21 offen offset:1024 lds
buffer_load_dwordx4 v186, s[12:15], s21 offen offset:2048 lds
MA 60,v,172,v,116
TR 168,202,32768
TR 170,202,34816
MA 116,v,172,v,120
buffer_load_dwordx4 v187, s[12:15], s21 offen offset:3072 lds
s_add_u32 m0, s23, 4096
MA 124,v,172,v,124
buffer_load_dwordx4 v188, s[12:15], s21 offen offset:0 lds
buffer_load_dwordx4 v189, s[12:15], s21 offen offset:1024 lds
MA 180,v,172,v,128
buffer_load_dwordx4 v190, s[12:15], s21 offen offset:2048 lds
buffer_load_dwordx4 v191, s[12:15], s21 offen offset:3072 lds
MA 188,v,172,v,132
s_add_u32 s21, s21, 524288
s_and_b32 s21, s21, 4194303
MA 244,v,172,v,136
MA 252,v,172,v,140
TR 172,203,32768
TR 174,203,34816
s_waitcnt lgkmcnt(2)
MA 0,v,144,v,80
s_add_u32 m0, s22, 0
v_lshlrev_b32 v8, 7, v1
MA 8,v,144,v,84
ds_read_b128 v[112:115], v193 offset:32768
s_getpc_b64 s[4:5]
L_pcK:
MA 64,v,144,v,88
s_lshr_b32 s98, s2, 3
s_lshl_b32 s98, s98, 2
MA 72,v,144,v,92
s_add_u32 s98, s98, s3
MA 128,v,144,v,96
s_lshl_b32 s98, s98, 10
MA 136,v,144,v,100
buffer_load_dwordx4 v176, s[8:11], s20 offen offset:0 lds
v_and_b32 v9, 0x380, v8
MA 192,v,144,v,104
v_add_u32 v9, s98, v9
MA 200,v,144,v,108
TR 144,196,49152
TR 146,196,51200
MA 4,v,148,v,80
ds_read_b128 v[116:119], v193 offset:34816
v_min_u32 v9, L_code_end - L_pcK - 4, v9
MA 12,v,148,v,84
v_mov_b32 v11, s5
MA 68,v,148,v,88
buffer_load_dwordx4 v177, s[8:11], s20 offen offset:1024 lds
MA 76,v,148,v,92
v_add_co_u32 v10, vcc, s4, v9
s_nop 1
v_addc_co_u32 v11, vcc, 0, v11, vcc
MA 132,v,148,v,96
global_load_dword v79, v[10:11], off
MA 140,v,148,v,100
ds_read_b128 v[120:123], v193 offset:36864
s_and_b32 s80, s2, 7
MA 196,v,148,v,104
s_lshr_b32 s81, s2, 3
MA 204,v,148,v,108
TR 148,197,49152
TR 150,197,51200
MA 16,v,152,v,80
buffer_load_dwordx4 v178, s[8:11], s20 offen offset:2048 lds
s_and_b32 s69, s81, 3
MA 24,v,152,v,84
s_lshl_b32 s80, s80, 2
s_add_u32 s69, s69, s80
MA 80,v,152,v,88
s_lshr_b32 s70, s81, 2
MA 88,v,152,v,92
s_lshl_b32 s80, s3, 16
MA 144,v,152,v,96
ds_read_b128 v[124:127], v193 offset:38912
buffer_load_dwordx4 v179, s[8:11], s20 offen offset:3072 lds
MA 152,v,152,v,100
s_lshl_b32 s65, s70, 18
s_sub_u32 s64, 3932160, s65
MA 208,v,152,v,104
s_add_u32 s65, s65, s80
s_add_u32 s64, s64, s80
MA 216,v,152,v,108
TR 152,198,49152
TR 154,198,51200
MA 20,v,156,v,80
s_lshl_b32 s81, s69, 12
s_lshl_b32 s100, s64, 2
MA 28,v,156,v,84
s_add_u32 m0, s22, 4096
s_add_u32 s100, s100, s81
MA 84,v,156,v,88
ds_read_b128 v[128:131], v193 offset:40960
s_lshl_b32 s101, s65, 2
MA 92,v,156,v,92
s_add_u32 s101, s101, s81
MA 148,v,156,v,96
s_lshl_b32 s66, s3, 17
MA 156,v,156,v,100
s_lshl_b32 s81, s69, 8
MA 212,v,156,v,104
s_add_u32 s66, s66, s81
MA 220,v,156,v,108
TR 156,199,49152
TR 158,199,51200
MA 32,v,160,v,80
ds_read_b128 v[132:135], v193 offset:43008
buffer_load_dwordx4 v180, s[8:11], s20 offen offset:0 lds
MA 40,v,160,v,84
s_and_b32 s74, s2, 7
s_lshl_b32 s74, s74, 8
MA 96,v,160,v,88
s_mov_b32 s82, s66
s_lshl_b32 s66, s74, 12
MA 104,v,160,v,92
s_lshl_b32 s67, s3, 13
s_lshl_b32 s68, s3, 12
MA 160,v,160,v,96
buffer_load_dwordx4 v181, s[8:11], s20 offen offset:1024 lds
s_lshl_b32 s76, s70, 1
MA 168,v,160,v,100
s_sub_u32 s77, 32, s76
MA 224,v,160,v,104
s_add_u32 s76, s76, 2
MA 232,v,160,v,108
TR 160,200,49152
TR 162,200,51200
MA 36,v,164,v,80
ds_read_b128 v[136:139], v193 offset:45056
s_mov_b32 s79, 0x41000000
MA 44,v,164,v,84
buffer_load_dwordx4 v182, s[8:11], s20 offen offset:2048 lds
v_lshrrev_b32 v16, 3, v1
MA 100,v,164,v,88
v_lshlrev_b32 v16, 11, v16
v_lshrrev_b32 v17, 4, v1
MA 108,v,164,v,92
v_and_b32 v18, 7, v1
v_xor_b32 v18, v18, v17
MA 164,v,164,v,96
v_lshl_add_u32 v16, v18, 4, v16
MA 172,v,164,v,100
ds_read_b128 v[140:143], v193 offset:47104
v_xor_b32 v19, 64, v16
MA 228,v,164,v,104
buffer_load_dwordx4 v183, s[8:11], s20 offen offset:3072 lds
v_add_u32 v208, 0, v16
MA 236,v,164,v,108
TR 164,201,49152
TR 166,201,51200
MA 48,v,168,v,80
v_add_u32 v209, 15360, v19
v_add_u32 v210, 30720, v16
MA 56,v,168,v,84
v_add_u32 v211, 46080, v19
MA 112,v,168,v,88
v_and_b32 v18, 15, v1
MA 120,v,168,v,92
s_add_u32 s20, s20, 128
v_lshlrev_b32 v19, 1, v17
MA 176,v,168,v,96
v_xor_b32 v18, v18, v19
v_lshlrev_b32 v16, 13, v17
MA 184,v,168,v,100
v_xor_b32 v19, 0, v18
MA 240,v,168,v,104
v_lshl_add_u32 v19, v19, 4, v16
MA 248,v,168,v,108
TR 168,202,49152
TR 170,202,51200
s_waitcnt lgkmcnt(15)
MA 52,v,172,v,80
s_and_b32 s20, s20, 1023
v_add_u32 v212, 0, v19
MA 60,v,172,v,84
v_xor_b32 v19, 0, v18
v_lshl_add_u32 v19, v19, 4, v16
MA 116,v,172,v,88
v_add_u32 v213, 31744, v19
MA 124,v,172,v,92
v_xor_b32 v19, 8, v18
MA 180,v,172,v,96
v_lshl_add_u32 v19, v19, 4, v16
MA 188,v,172,v,100
v_add_u32 v214, 63488, v19
MA 244,v,172,v,104
MA 252,v,172,v,108
TR 172,203,49152
TR 174,203,51200
s_waitcnt lgkmcnt(2)
MA 0,v,144,v,112
MA 8,v,144,v,116
MA 64,v,144,v,120
MA 72,v,144,v,124
MA 128,v,144,v,128
MA 136,v,144,v,132
MA 192,v,144,v,136
MA 200,v,144,v,140
MA 4,v,148,v,112
MA 12,v,148,v,116
s_waitcnt vmcnt(9) lgkmcnt(0)
s_barrier
MA 68,v,148,v,120
TR 144,196,0
TR 146,196,2048
MA 76,v,148,v,124
ds_read_b128 v[80:83], v194 offset:0
s_add_u32 m0, s23, 32768
MA 132,v,148,v,128
v_xor_b32 v19, 8, v18
v_lshl_add_u32 v19, v19, 4, v16
MA 140,v,148,v,132
v_add_u32 v215, 95232, v19
v_and_b32 v16, 15, v1
MA 196,v,148,v,136
buffer_load_dwordx4 v184, s[12:15], s21 offen offset:0 lds
v_lshrrev_b32 v18, 1, v16
MA 204,v,148,v,140
TR 148,197,0
TR 150,197,2048
MA 16,v,152,v,112
ds_read_b128 v[84:87], v194 offset:2048
v_xor_b32 v18, v18, v17
MA 24,v,152,v,116
v_lshlrev_b32 v18, 4, v18
v_lshl_add_u32 v18, v16, 7, v18
MA 80,v,152,v,120
buffer_load_dwordx4 v185, s[12:15], s21 offen offset:1024 lds
v_add_u32 v224, s67, v18
MA 88,v,152,v,124
v_xor_b32 v225, 64, v224
v_add_u32 v226, 0x10000, v224
MA 144,v,152,v,128
v_add_u32 v227, 0x10000, v225
v_bfe_u32 v16, v1, 2, 2
MA 152,v,152,v,132
ds_read_b128 v[88:91], v194 offset:4096
v_and_b32 v18, 1, v17
MA 208,v,152,v,136
v_lshl_or_b32 v18, v18, 2, v16
MA 216,v,152,v,140
TR 152,198,0
TR 154,198,2048
MA 20,v,156,v,112
buffer_load_dwordx4 v186, s[12:15], s21 offen offset:2048 lds
v_lshl_add_u32 v16, v17, 3, v16
MA 28,v,156,v,116
v_lshlrev_b32 v16, 8, v16
v_and_b32 v19, 3, v1
MA 84,v,156,v,120
ds_read_b128 v[92:95], v194 offset:6144
v_lshl_add_u32 v16, v19, 3, v16
MA 92,v,156,v,124
buffer_load_dwordx4 v187, s[12:15], s21 offen offset:3072 lds
v_add_u32 v16, 98304, v16
MA 148,v,156,v,128
v_xor_b32 v19, 0, v18
v_lshl_add_u32 v216, v19, 5, v16
MA 156,v,156,v,132
v_xor_b32 v19, 1, v18
MA 212,v,156,v,136
v_lshl_add_u32 v217, v19, 5, v16
MA 220,v,156,v,140
TR 156,199,0
TR 158,199,2048
MA 32,v,160,v,112
ds_read_b128 v[96:99], v194 offset:8192
s_add_u32 m0, s23, 36864
MA 40,v,160,v,116
v_xor_b32 v19, 2, v18
v_lshl_add_u32 v218, v19, 5, v16
MA 96,v,160,v,120
v_xor_b32 v19, 3, v18
v_lshl_add_u32 v219, v19, 5, v16
MA 104,v,160,v,124
v_xor_b32 v19, 4, v18
v_lshl_add_u32 v220, v19, 5, v16
MA 160,v,160,v,128
ds_read_b128 v[100:103], v194 offset:10240
buffer_load_dwordx4 v188, s[12:15], s21 offen offset:0 lds
MA 168,v,160,v,132
v_xor_b32 v19, 5, v18
v_lshl_add_u32 v221, v19, 5, v16
MA 224,v,160,v,136
v_xor_b32 v19, 6, v18
MA 232,v,160,v,140
TR 160,200,0
TR 162,200,2048
MA 36,v,164,v,112
buffer_load_dwordx4 v189, s[12:15], s21 offen offset:1024 lds
v_lshl_add_u32 v222, v19, 5, v16
MA 44,v,164,v,116
ds_read_b128 v[104:107], v194 offset:12288
v_xor_b32 v19, 7, v18
MA 100,v,164,v,120
v_lshl_add_u32 v223, v19, 5, v16
s_mov_b32 s44, s32
MA 108,v,164,v,124
s_mov_b32 s45, s33
s_mov_b32 s46, 4194304
MA 164,v,164,v,128
buffer_load_dwordx4 v190, s[12:15], s21 offen offset:2048 lds
s_mov_b32 s47, 0x20000
MA 172,v,164,v,132
s_add_u32 s48, s34, s82
s_addc_u32 s49, s35, 0
MA 228,v,164,v,136
ds_read_b128 v[108:111], v194 offset:14336
MA 236,v,164,v,140
TR 164,201,0
TR 166,201,2048
MA 48,v,168,v,112
s_sub_u32 s50, 8388608, s82
s_mov_b32 s51, 0x20000
MA 56,v,168,v,116
buffer_load_dwordx4 v191, s[12:15], s21 offen offset:3072 lds
MA 112,v,168,v,120
s_add_u32 s60, s40, 33554432
s_addc_u32 s61, s41, 0
MA 120,v,168,v,124
s_mov_b32 s62, 16777216
s_mov_b32 s63, 0x20000
MA 176,v,168,v,128
s_lshl_b32 s80, s69, 19
MA 184,v,168,v,132
s_add_u32 s21, s21, 524288
MA 240,v,168,v,136
s_add_u32 s52, s40, s80
s_addc_u32 s53, s41, 0
MA 248,v,168,v,140
TR 168,202,0
TR 170,202,2048
MA 52,v,172,v,112
s_lshl_b32 s54, s77, 14
s_mov_b32 s55, 0x20000
MA 60,v,172,v,116
s_and_b32 s21, s21, 4194303
s_add_u32 s80, s80, 16760832
MA 116,v,172,v,120
s_add_u32 s56, s40, s80
s_addc_u32 s57, s41, 0
MA 124,v,172,v,124
s_add_u32 s58, s54, 16384
MA 180,v,172,v,128
s_mov_b32 s59, 0x20000
MA 188,v,172,v,132
s_load_dwordx2 s[38:39], s[0:1], 112
MA 244,v,172,v,136
MA 252,v,172,v,140
TR 172,203,0
TR 174,203,2048
s_waitcnt lgkmcnt(2)
MA 0,v,144,v,80
s_add_u32 m0, s22, 32768
s_load_dwordx2 s[84:85], s[0:1], 8
MA 8,v,144,v,84
ds_read_b128 v[112:115], v195 offset:0
MA 64,v,144,v,88
MA 72,v,144,v,92
MA 128,v,144,v,96
MA 136,v,144,v,100
buffer_load_dwordx4 v176, s[8:11], s20 offen offset:0 lds
MA 192,v,144,v,104
MA 200,v,144,v,108
TR 144,196,16384
TR 146,196,18432
MA 4,v,148,v,80
ds_read_b128 v[116:119], v195 offset:2048
MA 12,v,148,v,84
MA 68,v,148,v,88
buffer_load_dwordx4 v177, s[8:11], s20 offen offset:1024 lds
MA 76,v,148,v,92
MA 132,v,148,v,96
s_load_dwordx2 s[88:89], s[0:1], 16
MA 140,v,148,v,100
ds_read_b128 v[120:123], v195 offset:4096
MA 196,v,148,v,104
MA 204,v,148,v,108
TR 148,197,16384
TR 150,197,18432
MA 16,v,152,v,80
buffer_load_dwordx4 v178, s[8:11], s20 offen offset:2048 lds
MA 24,v,152,v,84
MA 80,v,152,v,88
MA 88,v,152,v,92
MA 144,v,152,v,96
ds_read_b128 v[124:127], v195 offset:6144
buffer_load_dwordx4 v179, s[8:11], s20 offen offset:3072 lds
MA 152,v,152,v,100
MA 208,v,152,v,104
MA 216,v,152,v,108
TR 152,198,16384
TR 154,198,18432
MA 20,v,156,v,80
s_load_dwordx2 s[92:93], s[0:1], 0
MA 28,v,156,v,84
s_add_u32 m0, s22, 36864
MA 84,v,156,v,88
ds_read_b128 v[128:131], v195 offset:8192
MA 92,v,156,v,92
MA 148,v,156,v,96
MA 156,v,156,v,100
MA 212,v,156,v,104
MA 220,v,156,v,108
TR 156,199,16384
TR 158,199,18432
MA 32,v,160,v,80
ds_read_b128 v[132:135], v195 offset:10240
buffer_load_dwordx4 v180, s[8:11], s20 offen offset:0 lds
MA 40,v,160,v,84
MA 96,v,160,v,88
MA 104,v,160,v,92
MA 160,v,160,v,96
buffer_load_dwordx4 v181, s[8:11], s20 offen offset:1024 lds
MA 168,v,160,v,100
s_load_dwordx2 s[96:97], s[0:1], 24
MA 224,v,160,v,104
MA 232,v,160,v,108
TR 160,200,16384
TR 162,200,18432
MA 36,v,164,v,80
ds_read_b128 v[136:139], v195 offset:12288
MA 44,v,164,v,84
buffer_load_dwordx4 v182, s[8:11], s20 offen offset:2048 lds
MA 100,v,164,v,88
MA 108,v,164,v,92
MA 164,v,164,v,96
MA 172,v,164,v,100
ds_read_b128 v[140:143], v195 offset:14336
MA 228,v,164,v,104
buffer_load_dwordx4 v183, s[8:11], s20 offen offset:3072 lds
MA 236,v,164,v,108
TR 164,201,16384
TR 166,201,18432
MA 48,v,168,v,80
MA 56,v,168,v,84
s_load_dwordx2 s[4:5], s[0:1], 96
MA 112,v,168,v,88
MA 120,v,168,v,92
s_add_u32 s20, s20, 128
MA 176,v,168,v,96
MA 184,v,168,v,100
MA 240,v,168,v,104
MA 248,v,168,v,108
TR 168,202,16384
TR 170,202,18432
s_waitcnt lgkmcnt(15)
MA 52,v,172,v,80
s_and_b32 s20, s20, 1023
MA 60,v,172,v,84
MA 116,v,172,v,88
MA 124,v,172,v,92
MA 180,v,172,v,96
MA 188,v,172,v,100
MA 244,v,172,v,104
MA 252,v,172,v,108
TR 172,203,16384
TR 174,203,18432
s_waitcnt lgkmcnt(2)
MA 0,v,144,v,112
MA 8,v,144,v,116
MA 64,v,144,v,120
MA 72,v,144,v,124
MA 128,v,144,v,128
MA 136,v,144,v,132
MA 192,v,144,v,136
MA 200,v,144,v,140
MA 4,v,148,v,112
MA 12,v,148,v,116
s_waitcnt vmcnt(8) lgkmcnt(0)
s_barrier
MA 68,v,148,v,120
TR 144,196,32768
TR 146,196,34816
MA 76,v,148,v,124
ds_read_b128 v[80:83], v192 offset:0
s_add_u32 m0, s23, 0
MA 132,v,148,v,128
s_mov_b32 s86, 4194304
s_mov_b32 s87, 0x20000
MA 140,v,148,v,132
s_mov_b32 s90, 4194304
MA 196,v,148,v,136
buffer_load_dwordx4 v184, s[12:15], s21 offen offset:0 lds
s_mov_b32 s91, 0x20000
MA 204,v,148,v,140
TR 148,197,32768
TR 150,197,34816
MA 16,v,152,v,112
ds_read_b128 v[84:87], v192 offset:2048
s_mov_b32 s94, 4194304
MA 24,v,152,v,116
s_mov_b32 s95, 0x20000
MA 80,v,152,v,120
buffer_load_dwordx4 v185, s[12:15], s21 offen offset:1024 lds
s_mov_b32 s98, 8192
MA 88,v,152,v,124
s_mov_b32 s99, 0x20000
MA 144,v,152,v,128
MA 152,v,152,v,132
ds_read_b128 v[88:91], v192 offset:4096
s_mov_b32 s6, 2048
MA 208,v,152,v,136
s_mov_b32 s7, 0x20000
MA 216,v,152,v,140
TR 152,198,32768
TR 154,198,34816
MA 20,v,156,v,112
buffer_load_dwordx4 v186, s[12:15], s21 offen offset:2048 lds
s_and_b32 s36, s2, 15
MA 28,v,156,v,116
s_lshl_b32 s36, s36, 4
MA 84,v,156,v,120
ds_read_b128 v[92:95], v192 offset:6144
v_and_b32 v252, 15, v1
MA 92,v,156,v,124
buffer_load_dwordx4 v187, s[12:15], s21 offen offset:3072 lds
MA 148,v,156,v,128
v_add_u32 v252, s36, v252
MA 156,v,156,v,132
s_lshr_b32 s36, s2, 4
MA 212,v,156,v,136
MA 220,v,156,v,140
TR 156,199,32768
TR 158,199,34816
MA 32,v,160,v,112
ds_read_b128 v[96:99], v192 offset:8192
s_add_u32 m0, s23, 4096
MA 40,v,160,v,116
s_lshl_b32 s36, s36, 2
s_add_u32 s36, s36, s3
MA 96,v,160,v,120
s_lshl_b32 s36, s36, 2
MA 104,v,160,v,124
v_lshrrev_b32 v253, 4, v1
MA 160,v,160,v,128
ds_read_b128 v[100:103], v192 offset:10240
buffer_load_dwordx4 v188, s[12:15], s21 offen offset:0 lds
MA 168,v,160,v,132
v_add_u32 v253, s36, v253
MA 224,v,160,v,136
v_lshlrev_b32 v254, 14, v253
MA 232,v,160,v,140
TR 160,200,32768
TR 162,200,34816
MA 36,v,164,v,112
buffer_load_dwordx4 v189, s[12:15], s21 offen offset:1024 lds
v_lshl_add_u32 v254, v252, 3, v254
MA 44,v,164,v,116
ds_read_b128 v[104:107], v192 offset:12288
v_add_u32 v229, -6144, v254
MA 100,v,164,v,120
v_lshlrev_b32 v62, 5, v252
MA 108,v,164,v,124
v_lshlrev_b32 v254, 4, v253
MA 164,v,164,v,128
buffer_load_dwordx4 v190, s[12:15], s21 offen offset:2048 lds
MA 172,v,164,v,132
v_sub_u32 v254, 4080, v254
MA 228,v,164,v,136
ds_read_b128 v[108:111], v192 offset:14336
v_lshl_add_u32 v10, v252, 14, v254
MA 236,v,164,v,140
TR 164,201,32768
TR 166,201,34816
MA 48,v,168,v,112
v_and_b32 v252, 31, v1
MA 56,v,168,v,116
buffer_load_dwordx4 v191, s[12:15], s21 offen offset:3072 lds
v_lshlrev_b32 v64, 4, v252
MA 112,v,168,v,120
s_lshl_b32 s36, s2, 2
MA 120,v,168,v,124
MA 176,v,168,v,128
s_add_u32 s36, s36, s3
MA 184,v,168,v,132
s_add_u32 s21, s21, 524288
s_lshl_b32 s36, s36, 1
MA 240,v,168,v,136
v_lshrrev_b32 v253, 5, v1
MA 248,v,168,v,140
TR 168,202,32768
TR 170,202,34816
MA 52,v,172,v,112
v_add_u32 v253, s36, v253
MA 60,v,172,v,116
s_and_b32 s21, s21, 4194303
v_lshl_add_u32 v63, v253, 11, v64
MA 116,v,172,v,120
MA 124,v,172,v,124
v_lshlrev_b32 v253, 2, v253
MA 180,v,172,v,128
v_lshl_add_u32 v11, v252, 20, v253
MA 188,v,172,v,132
MA 244,v,172,v,136
MA 252,v,172,v,140
TR 172,203,32768
TR 174,203,34816
s_waitcnt lgkmcnt(2)
MA 0,v,144,v,80
s_add_u32 m0, s22, 65536
buffer_load_dwordx4 v[230:233], v63, s[92:95], 0 offen offset:0
MA 8,v,144,v,84
ds_read_b128 v[112:115], v193 offset:0
MA 64,v,144,v,88
MA 72,v,144,v,92
buffer_load_dwordx4 v[2:5], v64, s[4:7], 0 offen offset:0
MA 128,v,144,v,96
MA 136,v,144,v,100
buffer_load_dwordx4 v176, s[8:11], s20 offen offset:0 lds
MA 192,v,144,v,104
buffer_load_dwordx4 v[234:237], v63, s[92:95], 0 offen offset:512
MA 200,v,144,v,108
TR 144,196,49152
TR 146,196,51200
MA 4,v,148,v,80
ds_read_b128 v[116:119], v193 offset:2048
MA 12,v,148,v,84
buffer_load_dwordx4 v[6:9], v64, s[4:7], 0 offen offset:512
MA 68,v,148,v,88
buffer_load_dwordx4 v177, s[8:11], s20 offen offset:1024 lds
MA 76,v,148,v,92
MA 132,v,148,v,96
buffer_load_dwordx4 v[238:241], v63, s[92:95], 0 offen offset:1024
MA 140,v,148,v,100
ds_read_b128 v[120:123], v193 offset:4096
MA 196,v,148,v,104
MA 204,v,148,v,108
TR 148,197,49152
TR 150,197,51200
MA 16,v,152,v,80
buffer_load_dwordx4 v178, s[8:11], s20 offen offset:2048 lds
buffer_load_dwordx4 v[12:15], v64, s[4:7], 0 offen offset:1024
MA 24,v,152,v,84
MA 80,v,152,v,88
buffer_load_dwordx4 v[242:245], v63, s[92:95], 0 offen offset:1536
MA 88,v,152,v,92
MA 144,v,152,v,96
ds_read_b128 v[124:127], v193 offset:6144
buffer_load_dwordx4 v179, s[8:11], s20 offen offset:3072 lds
MA 152,v,152,v,100
buffer_load_dwordx4 v[246:249], v64, s[4:7], 0 offen offset:1536
MA 208,v,152,v,104
MA 216,v,152,v,108
TR 152,198,49152
TR 154,198,51200
MA 20,v,156,v,80
buffer_load_dwordx4 v[54:57], v62, s[96:99], 0 offen offset:0
MA 28,v,156,v,84
s_add_u32 m0, s22, 69632
MA 84,v,156,v,88
ds_read_b128 v[128:131], v193 offset:8192
MA 92,v,156,v,92
buffer_load_dwordx4 v[58:61], v62, s[96:99], 0 offen offset:16
MA 148,v,156,v,96
MA 156,v,156,v,100
MA 212,v,156,v,104
MA 220,v,156,v,108
TR 156,199,49152
TR 158,199,51200
MA 32,v,160,v,80
ds_read_b128 v[132:135], v193 offset:10240
buffer_load_dwordx4 v180, s[8:11], s20 offen offset:0 lds
MA 40,v,160,v,84
v_add_u32 v252, 0, v229
MA 96,v,160,v,88
buffer_load_dwordx2 v[16:17], v252, s[84:87], 0 offen
MA 104,v,160,v,92
MA 160,v,160,v,96
buffer_load_dwordx4 v181, s[8:11], s20 offen offset:1024 lds
MA 168,v,160,v,100
v_add_u32 v253, 2048, v229
MA 224,v,160,v,104
MA 232,v,160,v,108
TR 160,200,49152
TR 162,200,51200
MA 36,v,164,v,80
ds_read_b128 v[136:139], v193 offset:12288
buffer_load_dwordx2 v[18:19], v253, s[84:87], 0 offen
MA 44,v,164,v,84
buffer_load_dwordx4 v182, s[8:11], s20 offen offset:2048 lds
MA 100,v,164,v,88
MA 108,v,164,v,92
v_add_u32 v254, 4096, v229
MA 164,v,164,v,96
MA 172,v,164,v,100
ds_read_b128 v[140:143], v193 offset:14336
MA 228,v,164,v,104
buffer_load_dwordx4 v183, s[8:11], s20 offen offset:3072 lds
buffer_load_dwordx2 v[20:21], v254, s[84:87], 0 offen
MA 236,v,164,v,108
TR 164,201,49152
TR 166,201,51200
MA 48,v,168,v,80
MA 56,v,168,v,84
v_add_u32 v255, 6144, v229
MA 112,v,168,v,88
MA 120,v,168,v,92
s_add_u32 s20, s20, 128
MA 176,v,168,v,96
buffer_load_dwordx2 v[22:23], v255, s[84:87], 0 offen
MA 184,v,168,v,100
MA 240,v,168,v,104
MA 248,v,168,v,108
TR 168,202,49152
TR 170,202,51200
s_waitcnt lgkmcnt(15)
MA 52,v,172,v,80
s_and_b32 s20, s20, 1023
buffer_load_dwordx2 v[38:39], v255, s[88:91], 0 offen
MA 60,v,172,v,84
MA 116,v,172,v,88
v_add_u32 v252, 8192, v229
MA 124,v,172,v,92
MA 180,v,172,v,96
MA 188,v,172,v,100
MA 244,v,172,v,104
MA 252,v,172,v,108
TR 172,203,49152
TR 174,203,51200
s_waitcnt lgkmcnt(2)
MA 0,v,144,v,112
MA 8,v,144,v,116
MA 64,v,144,v,120
MA 72,v,144,v,124
MA 128,v,144,v,128
MA 136,v,144,v,132
MA 192,v,144,v,136
MA 200,v,144,v,140
MA 4,v,148,v,112
MA 12,v,148,v,116
s_waitcnt vmcnt(23) lgkmcnt(0)
s_barrier
MA 68,v,148,v,120
TR 144,196,0
TR 146,196,2048
MA 76,v,148,v,124
ds_read_b128 v[80:83], v192 offset:32768
s_add_u32 m0, s23, 32768
MA 132,v,148,v,128
MA 140,v,148,v,132
MA 196,v,148,v,136
buffer_load_dwordx4 v184, s[12:15], s21 offen offset:0 lds
MA 204,v,148,v,140
TR 148,197,0
TR 150,197,2048
MA 16,v,152,v,112
ds_read_b128 v[84:87], v192 offset:34816
MA 24,v,152,v,116
MA 80,v,152,v,120
buffer_load_dwordx4 v185, s[12:15], s21 offen offset:1024 lds
MA 88,v,152,v,124
MA 144,v,152,v,128
MA 152,v,152,v,132
ds_read_b128 v[88:91], v192 offset:36864
MA 208,v,152,v,136
MA 216,v,152,v,140
TR 152,198,0
TR 154,198,2048
MA 20,v,156,v,112
buffer_load_dwordx4 v186, s[12:15], s21 offen offset:2048 lds
MA 28,v,156,v,116
MA 84,v,156,v,120
ds_read_b128 v[92:95], v192 offset:38912
MA 92,v,156,v,124
buffer_load_dwordx4 v187, s[12:15], s21 offen offset:3072 lds
MA 148,v,156,v,128
MA 156,v,156,v,132
MA 212,v,156,v,136
MA 220,v,156,v,140
TR 156,199,0
TR 158,199,2048
MA 32,v,160,v,112
ds_read_b128 v[96:99], v192 offset:40960
s_add_u32 m0, s23, 36864
MA 40,v,160,v,116
MA 96,v,160,v,120
MA 104,v,160,v,124
MA 160,v,160,v,128
ds_read_b128 v[100:103], v192 offset:43008
buffer_load_dwordx4 v188, s[12:15], s21 offen offset:0 lds
MA 168,v,160,v,132
MA 224,v,160,v,136
MA 232,v,160,v,140
TR 160,200,0
TR 162,200,2048
MA 36,v,164,v,112
buffer_load_dwordx4 v189, s[12:15], s21 offen offset:1024 lds
MA 44,v,164,v,116
ds_read_b128 v[104:107], v192 offset:45056
MA 100,v,164,v,120
MA 108,v,164,v,124
MA 164,v,164,v,128
buffer_load_dwordx4 v190, s[12:15], s21 offen offset:2048 lds
MA 172,v,164,v,132
MA 228,v,164,v,136
ds_read_b128 v[108:111], v192 offset:47104
MA 236,v,164,v,140
TR 164,201,0
TR 166,201,2048
MA 48,v,168,v,112
MA 56,v,168,v,116
buffer_load_dwordx4 v191, s[12:15], s21 offen offset:3072 lds
MA 112,v,168,v,120
MA 120,v,168,v,124
MA 176,v,168,v,128
MA 184,v,168,v,132
s_add_u32 s21, s21, 524288
MA 240,v,168,v,136
MA 248,v,168,v,140
TR 168,202,0
TR 170,202,2048
MA 52,v,172,v,112
MA 60,v,172,v,116
s_and_b32 s21, s21, 4194303
MA 116,v,172,v,120
MA 124,v,172,v,124
MA 180,v,172,v,128
MA 188,v,172,v,132
MA 244,v,172,v,136
MA 252,v,172,v,140
TR 172,203,0
TR 174,203,2048
s_waitcnt lgkmcnt(2)
MA 0,v,144,v,80
s_add_u32 m0, s22, 0
buffer_load_dwordx2 v[24:25], v252, s[84:87], 0 offen
MA 8,v,144,v,84
ds_read_b128 v[112:115], v193 offset:32768
MA 64,v,144,v,88
MA 72,v,144,v,92
buffer_load_dwordx2 v[40:41], v252, s[88:91], 0 offen
MA 128,v,144,v,96
MA 136,v,144,v,100
buffer_load_dwordx4 v176, s[8:11], s20 offen offset:0 lds
MA 192,v,144,v,104
v_add_u32 v253, 10240, v229
MA 200,v,144,v,108
TR 144,196,16384
TR 146,196,18432
MA 4,v,148,v,80
ds_read_b128 v[116:119], v193 offset:34816
MA 12,v,148,v,84
buffer_load_dwordx2 v[26:27], v253, s[84:87], 0 offen
MA 68,v,148,v,88
buffer_load_dwordx4 v177, s[8:11], s20 offen offset:1024 lds
MA 76,v,148,v,92
MA 132,v,148,v,96
buffer_load_dwordx2 v[42:43], v253, s[88:91], 0 offen
MA 140,v,148,v,100
ds_read_b128 v[120:123], v193 offset:36864
MA 196,v,148,v,104
MA 204,v,148,v,108
TR 148,197,16384
TR 150,197,18432
MA 16,v,152,v,80
buffer_load_dwordx4 v178, s[8:11], s20 offen offset:2048 lds
v_add_u32 v254, 12288, v229
MA 24,v,152,v,84
MA 80,v,152,v,88
buffer_load_dwordx2 v[28:29], v254, s[84:87], 0 offen
MA 88,v,152,v,92
MA 144,v,152,v,96
ds_read_b128 v[124:127], v193 offset:38912
buffer_load_dwordx4 v179, s[8:11], s20 offen offset:3072 lds
MA 152,v,152,v,100
buffer_load_dwordx2 v[44:45], v254, s[88:91], 0 offen
MA 208,v,152,v,104
MA 216,v,152,v,108
TR 152,198,16384
TR 154,198,18432
MA 20,v,156,v,80
v_add_u32 v255, 14336, v229
MA 28,v,156,v,84
s_add_u32 m0, s22, 4096
MA 84,v,156,v,88
ds_read_b128 v[128:131], v193 offset:40960
MA 92,v,156,v,92
buffer_load_dwordx2 v[30:31], v255, s[84:87], 0 offen
MA 148,v,156,v,96
MA 156,v,156,v,100
MA 212,v,156,v,104
MA 220,v,156,v,108
TR 156,199,16384
TR 158,199,18432
MA 32,v,160,v,80
ds_read_b128 v[132:135], v193 offset:43008
buffer_load_dwordx4 v180, s[8:11], s20 offen offset:0 lds
MA 40,v,160,v,84
buffer_load_dwordx2 v[46:47], v255, s[88:91], 0 offen
MA 96,v,160,v,88
v_add_u32 v252, 16384, v229
MA 104,v,160,v,92
MA 160,v,160,v,96
buffer_load_dwordx4 v181, s[8:11], s20 offen offset:1024 lds
MA 168,v,160,v,100
buffer_load_dwordx2 v[32:33], v252, s[84:87], 0 offen
MA 224,v,160,v,104
MA 232,v,160,v,108
TR 160,200,16384
TR 162,200,18432
MA 36,v,164,v,80
ds_read_b128 v[136:139], v193 offset:45056
buffer_load_dwordx2 v[48:49], v252, s[88:91], 0 offen
MA 44,v,164,v,84
buffer_load_dwordx4 v182, s[8:11], s20 offen offset:2048 lds
MA 100,v,164,v,88
MA 108,v,164,v,92
v_add_u32 v253, 18432, v229
MA 164,v,164,v,96
MA 172,v,164,v,100
ds_read_b128 v[140:143], v193 offset:47104
MA 228,v,164,v,104
buffer_load_dwordx4 v183, s[8:11], s20 offen offset:3072 lds
buffer_load_dwordx2 v[34:35], v253, s[84:87], 0 offen
MA 236,v,164,v,108
TR 164,201,16384
TR 166,201,18432
MA 48,v,168,v,80
MA 56,v,168,v,84
buffer_load_dwordx2 v[50:51], v253, s[88:91], 0 offen
MA 112,v,168,v,88
MA 120,v,168,v,92
s_add_u32 s20, s20, 128
MA 176,v,168,v,96
v_add_u32 v254, 20480, v229
MA 184,v,168,v,100
MA 240,v,168,v,104
MA 248,v,168,v,108
TR 168,202,16384
TR 170,202,18432
s_waitcnt lgkmcnt(15)
MA 52,v,172,v,80
s_and_b32 s20, s20, 1023
buffer_load_dwordx2 v[36:37], v254, s[84:87], 0 offen
MA 60,v,172,v,84
MA 116,v,172,v,88
buffer_load_dwordx2 v[52:53], v254, s[88:91], 0 offen
MA 124,v,172,v,92
MA 180,v,172,v,96
MA 188,v,172,v,100
MA 244,v,172,v,104
MA 252,v,172,v,108
TR 172,203,16384
TR 174,203,18432
s_waitcnt lgkmcnt(2)
MA 0,v,144,v,112
MA 8,v,144,v,116
MA 64,v,144,v,120
MA 72,v,144,v,124
MA 128,v,144,v,128
MA 136,v,144,v,132
MA 192,v,144,v,136
MA 200,v,144,v,140
MA 4,v,148,v,112
MA 12,v,148,v,116
s_waitcnt vmcnt(22) lgkmcnt(0)
s_barrier
MA 68,v,148,v,120
TR 144,196,32768
TR 146,196,34816
MA 76,v,148,v,124
ds_read_b128 v[80:83], v194 offset:0
s_add_u32 m0, s23, 0
MA 132,v,148,v,128
MA 140,v,148,v,132
MA 196,v,148,v,136
buffer_load_dwordx4 v184, s[12:15], s21 offen offset:0 lds
MA 204,v,148,v,140
TR 148,197,32768
TR 150,197,34816
MA 16,v,152,v,112
ds_read_b128 v[84:87], v194 offset:2048
MA 24,v,152,v,116
MA 80,v,152,v,120
buffer_load_dwordx4 v185, s[12:15], s21 offen offset:1024 lds
MA 88,v,152,v,124
MA 144,v,152,v,128
MA 152,v,152,v,132
ds_read_b128 v[88:91], v194 offset:4096
MA 208,v,152,v,136
MA 216,v,152,v,140
TR 152,198,32768
TR 154,198,34816
MA 20,v,156,v,112
buffer_load_dwordx4 v186, s[12:15], s21 offen offset:2048 lds
MA 28,v,156,v,116
MA 84,v,156,v,120
ds_read_b128 v[92:95], v194 offset:6144
MA 92,v,156,v,124
buffer_load_dwordx4 v187, s[12:15], s21 offen offset:3072 lds
MA 148,v,156,v,128
MA 156,v,156,v,132
MA 212,v,156,v,136
MA 220,v,156,v,140
TR 156,199,32768
TR 158,199,34816
MA 32,v,160,v,112
ds_read_b128 v[96:99], v194 offset:8192
s_add_u32 m0, s23, 4096
MA 40,v,160,v,116
MA 96,v,160,v,120
MA 104,v,160,v,124
MA 160,v,160,v,128
ds_read_b128 v[100:103], v194 offset:10240
buffer_load_dwordx4 v188, s[12:15], s21 offen offset:0 lds
MA 168,v,160,v,132
MA 224,v,160,v,136
MA 232,v,160,v,140
TR 160,200,32768
TR 162,200,34816
MA 36,v,164,v,112
buffer_load_dwordx4 v189, s[12:15], s21 offen offset:1024 lds
MA 44,v,164,v,116
ds_read_b128 v[104:107], v194 offset:12288
MA 100,v,164,v,120
MA 108,v,164,v,124
MA 164,v,164,v,128
buffer_load_dwordx4 v190, s[12:15], s21 offen offset:2048 lds
MA 172,v,164,v,132
MA 228,v,164,v,136
ds_read_b128 v[108:111], v194 offset:14336
MA 236,v,164,v,140
TR 164,201,32768
TR 166,201,34816
MA 48,v,168,v,112
MA 56,v,168,v,116
buffer_load_dwordx4 v191, s[12:15], s21 offen offset:3072 lds
MA 112,v,168,v,120
MA 120,v,168,v,124
MA 176,v,168,v,128
MA 184,v,168,v,132
s_add_u32 s21, s21, 524288
MA 240,v,168,v,136
MA 248,v,168,v,140
TR 168,202,32768
TR 170,202,34816
MA 52,v,172,v,112
MA 60,v,172,v,116
s_and_b32 s21, s21, 4194303
MA 116,v,172,v,120
MA 124,v,172,v,124
MA 180,v,172,v,128
MA 188,v,172,v,132
MA 244,v,172,v,136
MA 252,v,172,v,140
TR 172,203,32768
TR 174,203,34816
s_waitcnt lgkmcnt(2)
MA 0,v,144,v,80
s_add_u32 m0, s22, 32768
MA 8,v,144,v,84
ds_read_b128 v[112:115], v195 offset:0
MA 64,v,144,v,88
MA 72,v,144,v,92
MA 128,v,144,v,96
MA 136,v,144,v,100
buffer_load_dwordx4 v176, s[8:11], s20 offen offset:0 lds
MA 192,v,144,v,104
MA 200,v,144,v,108
TR 144,196,49152
TR 146,196,51200
MA 4,v,148,v,80
ds_read_b128 v[116:119], v195 offset:2048
MA 12,v,148,v,84
MA 68,v,148,v,88
buffer_load_dwordx4 v177, s[8:11], s20 offen offset:1024 lds
MA 76,v,148,v,92
MA 132,v,148,v,96
MA 140,v,148,v,100
ds_read_b128 v[120:123], v195 offset:4096
MA 196,v,148,v,104
MA 204,v,148,v,108
TR 148,197,49152
TR 150,197,51200
MA 16,v,152,v,80
buffer_load_dwordx4 v178, s[8:11], s20 offen offset:2048 lds
MA 24,v,152,v,84
MA 80,v,152,v,88
MA 88,v,152,v,92
MA 144,v,152,v,96
ds_read_b128 v[124:127], v195 offset:6144
buffer_load_dwordx4 v179, s[8:11], s20 offen offset:3072 lds
MA 152,v,152,v,100
MA 208,v,152,v,104
MA 216,v,152,v,108
TR 152,198,49152
TR 154,198,51200
MA 20,v,156,v,80
MA 28,v,156,v,84
s_add_u32 m0, s22, 36864
MA 84,v,156,v,88
ds_read_b128 v[128:131], v195 offset:8192
MA 92,v,156,v,92
MA 148,v,156,v,96
MA 156,v,156,v,100
MA 212,v,156,v,104
MA 220,v,156,v,108
TR 156,199,49152
TR 158,199,51200
MA 32,v,160,v,80
ds_read_b128 v[132:135], v195 offset:10240
buffer_load_dwordx4 v180, s[8:11], s20 offen offset:0 lds
MA 40,v,160,v,84
MA 96,v,160,v,88
MA 104,v,160,v,92
MA 160,v,160,v,96
buffer_load_dwordx4 v181, s[8:11], s20 offen offset:1024 lds
MA 168,v,160,v,100
MA 224,v,160,v,104
MA 232,v,160,v,108
TR 160,200,49152
TR 162,200,51200
MA 36,v,164,v,80
ds_read_b128 v[136:139], v195 offset:12288
MA 44,v,164,v,84
buffer_load_dwordx4 v182, s[8:11], s20 offen offset:2048 lds
MA 100,v,164,v,88
MA 108,v,164,v,92
MA 164,v,164,v,96
MA 172,v,164,v,100
ds_read_b128 v[140:143], v195 offset:14336
MA 228,v,164,v,104
buffer_load_dwordx4 v183, s[8:11], s20 offen offset:3072 lds
MA 236,v,164,v,108
TR 164,201,49152
TR 166,201,51200
MA 48,v,168,v,80
MA 56,v,168,v,84
MA 112,v,168,v,88
MA 120,v,168,v,92
s_add_u32 s20, s20, 128
MA 176,v,168,v,96
MA 184,v,168,v,100
MA 240,v,168,v,104
MA 248,v,168,v,108
TR 168,202,49152
TR 170,202,51200
s_waitcnt lgkmcnt(15)
MA 52,v,172,v,80
s_and_b32 s20, s20, 1023
MA 60,v,172,v,84
MA 116,v,172,v,88
MA 124,v,172,v,92
MA 180,v,172,v,96
MA 188,v,172,v,100
MA 244,v,172,v,104
MA 252,v,172,v,108
TR 172,203,49152
TR 174,203,51200
s_waitcnt lgkmcnt(2)
MA 0,v,144,v,112
MA 8,v,144,v,116
MA 64,v,144,v,120
MA 72,v,144,v,124
MA 128,v,144,v,128
MA 136,v,144,v,132
MA 192,v,144,v,136
MA 200,v,144,v,140
MA 4,v,148,v,112
MA 12,v,148,v,116
s_waitcnt vmcnt(8) lgkmcnt(0)
s_barrier
MA 68,v,148,v,120
TR 144,196,0
TR 146,196,2048
MA 76,v,148,v,124
ds_read_b128 v[80:83], v192 offset:0
s_add_u32 m0, s23, 32768
MA 132,v,148,v,128
s_add_u32 s84, s40, 50331648
s_addc_u32 s85, s41, 0
MA 140,v,148,v,132
s_mov_b32 s86, 4194304
s_mov_b32 s87, 0x20000
MA 196,v,148,v,136
buffer_load_dwordx4 v184, s[12:15], s21 offen offset:0 lds
MA 204,v,148,v,140
TR 148,197,0
TR 150,197,2048
MA 16,v,152,v,112
ds_read_b128 v[84:87], v192 offset:2048
MA 24,v,152,v,116
s_add_u32 s88, s40, 58720256
s_addc_u32 s89, s41, 0
MA 80,v,152,v,120
buffer_load_dwordx4 v185, s[12:15], s21 offen offset:1024 lds
s_mov_b32 s90, 8192
MA 88,v,152,v,124
s_mov_b32 s91, 0x20000
v_mov_b32 v252, 0
MA 144,v,152,v,128
v_mov_b32 v253, 0
v_dot2_f32_bf16 v252, v230, v2, v252
MA 152,v,152,v,132
ds_read_b128 v[88:91], v192 offset:4096
v_dot2_f32_bf16 v253, v231, v3, v253
MA 208,v,152,v,136
v_dot2_f32_bf16 v252, v232, v4, v252
v_dot2_f32_bf16 v253, v233, v5, v253
MA 216,v,152,v,140
TR 152,198,0
TR 154,198,2048
MA 20,v,156,v,112
buffer_load_dwordx4 v186, s[12:15], s21 offen offset:2048 lds
v_dot2_f32_bf16 v252, v234, v6, v252
MA 28,v,156,v,116
v_dot2_f32_bf16 v253, v235, v7, v253
v_dot2_f32_bf16 v252, v236, v8, v252
MA 84,v,156,v,120
ds_read_b128 v[92:95], v192 offset:6144
v_dot2_f32_bf16 v253, v237, v9, v253
MA 92,v,156,v,124
buffer_load_dwordx4 v187, s[12:15], s21 offen offset:3072 lds
v_dot2_f32_bf16 v252, v238, v12, v252
MA 148,v,156,v,128
v_dot2_f32_bf16 v253, v239, v13, v253
v_dot2_f32_bf16 v252, v240, v14, v252
MA 156,v,156,v,132
v_dot2_f32_bf16 v253, v241, v15, v253
v_dot2_f32_bf16 v252, v242, v246, v252
MA 212,v,156,v,136
v_dot2_f32_bf16 v253, v243, v247, v253
v_dot2_f32_bf16 v252, v244, v248, v252
MA 220,v,156,v,140
TR 156,199,0
TR 158,199,2048
MA 32,v,160,v,112
ds_read_b128 v[96:99], v192 offset:8192
s_add_u32 m0, s23, 36864
MA 40,v,160,v,116
v_dot2_f32_bf16 v253, v245, v249, v253
MA 96,v,160,v,120
s_nop 2
v_add_f32 v252, v252, v253
MA 104,v,160,v,124
s_nop 0
v_add_f32_dpp v252, v252, v252 row_ror:8 row_mask:0xf bank_mask:0xf
s_nop 1
v_add_f32_dpp v252, v252, v252 row_ror:4 row_mask:0xf bank_mask:0xf
MA 160,v,160,v,128
ds_read_b128 v[100:103], v192 offset:10240
buffer_load_dwordx4 v188, s[12:15], s21 offen offset:0 lds
MA 168,v,160,v,132
v_add_f32_dpp v252, v252, v252 row_ror:2 row_mask:0xf bank_mask:0xf
s_nop 1
v_add_f32_dpp v252, v252, v252 row_ror:1 row_mask:0xf bank_mask:0xf
MA 224,v,160,v,136
v_mov_b32 v253, v252
s_nop 1
v_permlane16_swap_b32 v252, v253
MA 232,v,160,v,140
TR 160,200,0
TR 162,200,2048
MA 36,v,164,v,112
buffer_load_dwordx4 v189, s[12:15], s21 offen offset:1024 lds
v_add_f32 v252, v252, v253
MA 44,v,164,v,116
ds_read_b128 v[104:107], v192 offset:12288
v_mul_f32 v252, 0xbfb8aa3b, v252
MA 100,v,164,v,120
v_exp_f32 v252, v252
MA 108,v,164,v,124
v_add_f32 v252, 1.0, v252
MA 164,v,164,v,128
buffer_load_dwordx4 v190, s[12:15], s21 offen offset:2048 lds
MA 172,v,164,v,132
v_rcp_f32 v252, v252
MA 228,v,164,v,136
ds_read_b128 v[108:111], v192 offset:14336
MA 236,v,164,v,140
TR 164,201,0
TR 166,201,2048
MA 48,v,168,v,112
s_nop 0
buffer_store_dword v252, v11, s[88:91], 0 offen sc1
MA 56,v,168,v,116
buffer_load_dwordx4 v191, s[12:15], s21 offen offset:3072 lds
v_lshlrev_b32 v2, 16, v54
MA 112,v,168,v,120
v_and_b32 v3, 0xffff0000, v54
v_lshlrev_b32 v4, 16, v55
MA 120,v,168,v,124
v_and_b32 v5, 0xffff0000, v55
v_lshlrev_b32 v6, 16, v56
MA 176,v,168,v,128
v_and_b32 v7, 0xffff0000, v56
v_lshlrev_b32 v8, 16, v57
MA 184,v,168,v,132
s_add_u32 s21, s21, 524288
v_and_b32 v9, 0xffff0000, v57
MA 240,v,168,v,136
v_lshlrev_b32 v230, 16, v16
v_and_b32 v231, 0xffff0000, v16
MA 248,v,168,v,140
TR 168,202,0
TR 170,202,2048
MA 52,v,172,v,112
v_lshlrev_b32 v232, 16, v18
v_and_b32 v233, 0xffff0000, v18
MA 60,v,172,v,116
s_and_b32 s21, s21, 4194303
v_lshlrev_b32 v234, 16, v20
MA 116,v,172,v,120
v_and_b32 v235, 0xffff0000, v20
v_lshlrev_b32 v236, 16, v22
MA 124,v,172,v,124
v_and_b32 v237, 0xffff0000, v22
v_lshlrev_b32 v238, 16, v24
MA 180,v,172,v,128
v_and_b32 v239, 0xffff0000, v24
v_lshlrev_b32 v240, 16, v26
MA 188,v,172,v,132
v_and_b32 v241, 0xffff0000, v26
v_lshlrev_b32 v242, 16, v28
MA 244,v,172,v,136
v_and_b32 v243, 0xffff0000, v28
v_lshlrev_b32 v244, 16, v30
MA 252,v,172,v,140
TR 172,203,0
TR 174,203,2048
v_and_b32 v245, 0xffff0000, v30
v_lshlrev_b32 v246, 16, v32
v_and_b32 v247, 0xffff0000, v32
v_lshlrev_b32 v248, 16, v34
v_and_b32 v249, 0xffff0000, v34
v_lshlrev_b32 v250, 16, v36
v_and_b32 v251, 0xffff0000, v36
v_lshlrev_b32 v254, 16, v38
v_and_b32 v255, 0xffff0000, v38
v_mul_f32 v62, v236, v2
v_mul_f32 v70, v237, v6
v_fmac_f32 v62, v234, v3
v_fmac_f32 v70, v235, v7
v_fmac_f32 v62, v232, v4
v_fmac_f32 v70, v233, v8
v_fmac_f32 v62, v230, v5
v_fmac_f32 v70, v231, v9
v_mul_f32 v62, v62, v254
s_waitcnt lgkmcnt(2)
MA 0,v,144,v,80
s_add_u32 s75, s64, s74
v_mul_f32 v70, v70, v255
MA 8,v,144,v,84
ds_read_b128 v[112:115], v193 offset:0
v_lshlrev_b32 v254, 16, v40
MA 64,v,144,v,88
v_and_b32 v255, 0xffff0000, v40
v_mul_f32 v63, v238, v2
MA 72,v,144,v,92
v_mul_f32 v71, v239, v6
v_fmac_f32 v63, v236, v3
MA 128,v,144,v,96
s_add_u32 m0, s67, 65536
v_fmac_f32 v71, v237, v7
MA 136,v,144,v,100
v_fmac_f32 v63, v234, v4
MA 192,v,144,v,104
v_fmac_f32 v71, v235, v8
MA 200,v,144,v,108
TR 144,196,16384
TR 146,196,18432
MA 4,v,148,v,80
ds_read_b128 v[116:119], v193 offset:2048
buffer_load_dwordx4 v208, s[44:47], s75 offen offset:0 lds
MA 12,v,148,v,84
v_fmac_f32 v63, v232, v5
v_fmac_f32 v71, v233, v9
MA 68,v,148,v,88
v_mul_f32 v63, v63, v254
v_mul_f32 v71, v71, v255
MA 76,v,148,v,92
v_lshlrev_b32 v254, 16, v42
v_and_b32 v255, 0xffff0000, v42
MA 132,v,148,v,96
v_mul_f32 v64, v240, v2
v_mul_f32 v72, v241, v6
MA 140,v,148,v,100
ds_read_b128 v[120:123], v193 offset:4096
buffer_load_dwordx4 v209, s[44:47], s75 offen offset:1024 lds
MA 196,v,148,v,104
v_fmac_f32 v64, v238, v3
v_fmac_f32 v72, v239, v7
MA 204,v,148,v,108
TR 148,197,16384
TR 150,197,18432
MA 16,v,152,v,80
v_fmac_f32 v64, v236, v4
v_fmac_f32 v72, v237, v8
MA 24,v,152,v,84
buffer_load_dwordx4 v210, s[44:47], s75 offen offset:2048 lds
v_fmac_f32 v64, v234, v5
MA 80,v,152,v,88
v_fmac_f32 v72, v235, v9
v_mul_f32 v64, v64, v254
MA 88,v,152,v,92
v_mul_f32 v72, v72, v255
v_lshlrev_b32 v254, 16, v44
MA 144,v,152,v,96
ds_read_b128 v[124:127], v193 offset:6144
v_and_b32 v255, 0xffff0000, v44
MA 152,v,152,v,100
v_mul_f32 v65, v242, v2
MA 208,v,152,v,104
buffer_load_dwordx4 v211, s[44:47], s75 offen offset:3072 lds
v_mul_f32 v73, v243, v6
MA 216,v,152,v,108
TR 152,198,16384
TR 154,198,18432
MA 20,v,156,v,80
v_fmac_f32 v65, v240, v3
v_fmac_f32 v73, v241, v7
MA 28,v,156,v,84
v_fmac_f32 v65, v238, v4
v_fmac_f32 v73, v239, v8
MA 84,v,156,v,88
ds_read_b128 v[128:131], v193 offset:8192
s_add_u32 s75, s65, s74
MA 92,v,156,v,92
v_fmac_f32 v65, v236, v5
v_fmac_f32 v73, v237, v9
MA 148,v,156,v,96
v_mul_f32 v65, v65, v254
v_mul_f32 v73, v73, v255
MA 156,v,156,v,100
v_lshlrev_b32 v254, 16, v46
MA 212,v,156,v,104
v_and_b32 v255, 0xffff0000, v46
MA 220,v,156,v,108
TR 156,199,16384
TR 158,199,18432
MA 32,v,160,v,80
ds_read_b128 v[132:135], v193 offset:10240
s_add_u32 m0, s67, 69632
MA 40,v,160,v,84
v_mul_f32 v66, v244, v2
v_mul_f32 v74, v245, v6
MA 96,v,160,v,88
v_fmac_f32 v66, v242, v3
v_fmac_f32 v74, v243, v7
MA 104,v,160,v,92
buffer_load_dwordx4 v208, s[44:47], s75 offen offset:0 lds
v_fmac_f32 v66, v240, v4
MA 160,v,160,v,96
v_fmac_f32 v74, v241, v8
v_fmac_f32 v66, v238, v5
MA 168,v,160,v,100
v_fmac_f32 v74, v239, v9
v_mul_f32 v66, v66, v254
MA 224,v,160,v,104
v_mul_f32 v74, v74, v255
v_lshlrev_b32 v254, 16, v48
MA 232,v,160,v,108
TR 160,200,16384
TR 162,200,18432
MA 36,v,164,v,80
ds_read_b128 v[136:139], v193 offset:12288
buffer_load_dwordx4 v209, s[44:47], s75 offen offset:1024 lds
MA 44,v,164,v,84
v_and_b32 v255, 0xffff0000, v48
v_mul_f32 v67, v246, v2
MA 100,v,164,v,88
v_mul_f32 v75, v247, v6
v_fmac_f32 v67, v244, v3
MA 108,v,164,v,92
v_fmac_f32 v75, v245, v7
v_fmac_f32 v67, v242, v4
MA 164,v,164,v,96
buffer_load_dwordx4 v210, s[44:47], s75 offen offset:2048 lds
v_fmac_f32 v75, v243, v8
MA 172,v,164,v,100
ds_read_b128 v[140:143], v193 offset:14336
v_fmac_f32 v67, v240, v5
MA 228,v,164,v,104
v_fmac_f32 v75, v241, v9
v_mul_f32 v67, v67, v254
MA 236,v,164,v,108
TR 164,201,16384
TR 166,201,18432
MA 48,v,168,v,80
buffer_load_dwordx4 v211, s[44:47], s75 offen offset:3072 lds
v_mul_f32 v75, v75, v255
MA 56,v,168,v,84
v_lshlrev_b32 v254, 16, v50
v_and_b32 v255, 0xffff0000, v50
MA 112,v,168,v,88
v_mul_f32 v68, v248, v2
v_mul_f32 v76, v249, v6
MA 120,v,168,v,92
v_fmac_f32 v68, v246, v3
MA 176,v,168,v,96
v_fmac_f32 v76, v247, v7
MA 184,v,168,v,100
s_add_u32 s74, s74, 128
v_fmac_f32 v68, v244, v4
MA 240,v,168,v,104
v_fmac_f32 v76, v245, v8
v_fmac_f32 v68, v242, v5
MA 248,v,168,v,108
TR 168,202,16384
TR 170,202,18432
s_waitcnt lgkmcnt(15)
MA 52,v,172,v,80
v_fmac_f32 v76, v243, v9
v_mul_f32 v68, v68, v254
MA 60,v,172,v,84
s_and_b32 s74, s74, 2047
v_mul_f32 v76, v76, v255
MA 116,v,172,v,88
v_lshlrev_b32 v254, 16, v52
v_and_b32 v255, 0xffff0000, v52
MA 124,v,172,v,92
v_mul_f32 v69, v250, v2
MA 180,v,172,v,96
v_mul_f32 v77, v251, v6
MA 188,v,172,v,100
v_fmac_f32 v69, v248, v3
MA 244,v,172,v,104
MA 252,v,172,v,108
TR 172,203,16384
TR 174,203,18432
s_waitcnt lgkmcnt(2)
MA 0,v,144,v,112
MA 8,v,144,v,116
MA 64,v,144,v,120
MA 72,v,144,v,124
MA 128,v,144,v,128
MA 136,v,144,v,132
MA 192,v,144,v,136
MA 200,v,144,v,140
MA 4,v,148,v,112
MA 12,v,148,v,116
s_waitcnt vmcnt(8) lgkmcnt(0)
s_barrier
MA 68,v,148,v,120
TR 144,196,32768
TR 146,196,34816
MA 76,v,148,v,124
ds_read_b128 v[80:83], v192 offset:32768
s_add_u32 m0, s68, 98304
MA 132,v,148,v,128
v_fmac_f32 v77, v249, v7
v_fmac_f32 v69, v246, v4
MA 140,v,148,v,132
buffer_load_dwordx4 v212, s[48:51], s66 offen offset:0 lds
v_fmac_f32 v77, v247, v8
MA 196,v,148,v,136
v_fmac_f32 v69, v244, v5
v_fmac_f32 v77, v245, v9
MA 204,v,148,v,140
TR 148,197,32768
TR 150,197,34816
MA 16,v,152,v,112
ds_read_b128 v[84:87], v192 offset:34816
v_mul_f32 v69, v69, v254
MA 24,v,152,v,116
buffer_load_dwordx4 v213, s[48:51], s66 offen offset:1024 lds
v_mul_f32 v77, v77, v255
MA 80,v,152,v,120
v_cvt_pk_bf16_f32 v12, v69, v68
v_cvt_pk_bf16_f32 v13, v67, v66
MA 88,v,152,v,124
v_cvt_pk_bf16_f32 v14, v65, v64
v_cvt_pk_bf16_f32 v15, v63, v62
MA 144,v,152,v,128
s_mov_b32 s36, 0
buffer_store_dwordx4 v[12:15], v10, s[84:87], s36 offen sc1
MA 152,v,152,v,132
ds_read_b128 v[88:91], v192 offset:36864
buffer_load_dwordx4 v214, s[48:51], s66 offen offset:2048 lds
MA 208,v,152,v,136
v_cvt_pk_bf16_f32 v54, v77, v76
v_cvt_pk_bf16_f32 v55, v75, v74
MA 216,v,152,v,140
TR 152,198,32768
TR 154,198,34816
MA 20,v,156,v,112
buffer_load_dwordx4 v215, s[48:51], s66 offen offset:3072 lds
v_cvt_pk_bf16_f32 v56, v73, v72
MA 28,v,156,v,116
v_cvt_pk_bf16_f32 v57, v71, v70
s_mov_b32 s36, 4096
MA 84,v,156,v,120
ds_read_b128 v[92:95], v192 offset:38912
buffer_store_dwordx4 v[54:57], v10, s[84:87], s36 offen sc1
MA 92,v,156,v,124
v_lshlrev_b32 v2, 16, v58
v_and_b32 v3, 0xffff0000, v58
MA 148,v,156,v,128
s_add_u32 s66, s66, 524288
v_lshlrev_b32 v4, 16, v59
MA 156,v,156,v,132
v_and_b32 v5, 0xffff0000, v59
v_lshlrev_b32 v6, 16, v60
MA 212,v,156,v,136
v_and_b32 v7, 0xffff0000, v60
v_lshlrev_b32 v8, 16, v61
MA 220,v,156,v,140
TR 156,199,32768
TR 158,199,34816
MA 32,v,160,v,112
ds_read_b128 v[96:99], v192 offset:40960
s_and_b32 s66, s66, 8388607
MA 40,v,160,v,116
v_and_b32 v9, 0xffff0000, v61
v_lshlrev_b32 v230, 16, v17
MA 96,v,160,v,120
v_and_b32 v231, 0xffff0000, v17
v_lshlrev_b32 v232, 16, v19
MA 104,v,160,v,124
v_and_b32 v233, 0xffff0000, v19
v_lshlrev_b32 v234, 16, v21
MA 160,v,160,v,128
ds_read_b128 v[100:103], v192 offset:43008
s_add_u32 m0, s68, 114688
MA 168,v,160,v,132
v_and_b32 v235, 0xffff0000, v21
v_lshlrev_b32 v236, 16, v23
MA 224,v,160,v,136
v_and_b32 v237, 0xffff0000, v23
v_lshlrev_b32 v238, 16, v25
MA 232,v,160,v,140
TR 160,200,32768
TR 162,200,34816
MA 36,v,164,v,112
buffer_load_dwordx4 v212, s[48:51], s66 offen offset:0 lds
v_and_b32 v239, 0xffff0000, v25
MA 44,v,164,v,116
ds_read_b128 v[104:107], v192 offset:45056
v_lshlrev_b32 v240, 16, v27
MA 100,v,164,v,120
v_and_b32 v241, 0xffff0000, v27
v_lshlrev_b32 v242, 16, v29
MA 108,v,164,v,124
buffer_load_dwordx4 v213, s[48:51], s66 offen offset:1024 lds
v_and_b32 v243, 0xffff0000, v29
MA 164,v,164,v,128
v_lshlrev_b32 v244, 16, v31
v_and_b32 v245, 0xffff0000, v31
MA 172,v,164,v,132
v_lshlrev_b32 v246, 16, v33
v_and_b32 v247, 0xffff0000, v33
MA 228,v,164,v,136
ds_read_b128 v[108:111], v192 offset:47104
v_lshlrev_b32 v248, 16, v35
MA 236,v,164,v,140
TR 164,201,32768
TR 166,201,34816
MA 48,v,168,v,112
buffer_load_dwordx4 v214, s[48:51], s66 offen offset:2048 lds
v_and_b32 v249, 0xffff0000, v35
MA 56,v,168,v,116
v_lshlrev_b32 v250, 16, v37
v_and_b32 v251, 0xffff0000, v37
MA 112,v,168,v,120
buffer_load_dwordx4 v215, s[48:51], s66 offen offset:3072 lds
v_lshlrev_b32 v254, 16, v39
MA 120,v,168,v,124
v_and_b32 v255, 0xffff0000, v39
v_mul_f32 v62, v236, v2
MA 176,v,168,v,128
v_mul_f32 v70, v237, v6
v_fmac_f32 v62, v234, v3
MA 184,v,168,v,132
v_fmac_f32 v70, v235, v7
v_fmac_f32 v62, v232, v4
MA 240,v,168,v,136
s_add_u32 s66, s66, 524288
v_fmac_f32 v70, v233, v8
MA 248,v,168,v,140
TR 168,202,32768
TR 170,202,34816
MA 52,v,172,v,112
v_fmac_f32 v62, v230, v5
v_fmac_f32 v70, v231, v9
MA 60,v,172,v,116
v_mul_f32 v62, v62, v254
v_mul_f32 v70, v70, v255
MA 116,v,172,v,120
s_and_b32 s66, s66, 8388607
v_lshlrev_b32 v254, 16, v41
MA 124,v,172,v,124
v_and_b32 v255, 0xffff0000, v41
v_mul_f32 v63, v238, v2
MA 180,v,172,v,128
v_mul_f32 v71, v239, v6
v_fmac_f32 v63, v236, v3
MA 188,v,172,v,132
v_fmac_f32 v71, v237, v7
v_fmac_f32 v63, v234, v4
MA 244,v,172,v,136
v_fmac_f32 v71, v235, v8
v_fmac_f32 v63, v232, v5
MA 252,v,172,v,140
TR 172,203,32768
TR 174,203,34816
v_fmac_f32 v71, v233, v9
v_mul_f32 v63, v63, v254
v_mul_f32 v71, v71, v255
v_lshlrev_b32 v254, 16, v43
v_and_b32 v255, 0xffff0000, v43
v_mul_f32 v64, v240, v2
v_mul_f32 v72, v241, v6
v_fmac_f32 v64, v238, v3
s_waitcnt lgkmcnt(2)
MA 0,v,144,v,80
s_add_u32 s75, s64, s74
v_fmac_f32 v72, v239, v7
MA 8,v,144,v,84
ds_read_b128 v[112:115], v193 offset:32768
v_fmac_f32 v64, v236, v4
MA 64,v,144,v,88
v_fmac_f32 v72, v237, v8
v_fmac_f32 v64, v234, v5
MA 72,v,144,v,92
v_fmac_f32 v72, v235, v9
v_mul_f32 v64, v64, v254
MA 128,v,144,v,96
s_add_u32 m0, s67, 0
v_mul_f32 v72, v72, v255
MA 136,v,144,v,100
v_lshlrev_b32 v254, 16, v45
v_and_b32 v255, 0xffff0000, v45
MA 192,v,144,v,104
v_mul_f32 v65, v242, v2
MA 200,v,144,v,108
TR 144,196,49152
TR 146,196,51200
MA 4,v,148,v,80
ds_read_b128 v[116:119], v193 offset:34816
buffer_load_dwordx4 v208, s[44:47], s75 offen offset:0 lds
MA 12,v,148,v,84
v_mul_f32 v73, v243, v6
v_fmac_f32 v65, v240, v3
MA 68,v,148,v,88
v_fmac_f32 v73, v241, v7
v_fmac_f32 v65, v238, v4
MA 76,v,148,v,92
v_fmac_f32 v73, v239, v8
v_fmac_f32 v65, v236, v5
MA 132,v,148,v,96
v_fmac_f32 v73, v237, v9
v_mul_f32 v65, v65, v254
MA 140,v,148,v,100
ds_read_b128 v[120:123], v193 offset:36864
buffer_load_dwordx4 v209, s[44:47], s75 offen offset:1024 lds
MA 196,v,148,v,104
v_mul_f32 v73, v73, v255
v_lshlrev_b32 v254, 16, v47
MA 204,v,148,v,108
TR 148,197,49152
TR 150,197,51200
MA 16,v,152,v,80
v_and_b32 v255, 0xffff0000, v47
v_mul_f32 v66, v244, v2
MA 24,v,152,v,84
buffer_load_dwordx4 v210, s[44:47], s75 offen offset:2048 lds
v_mul_f32 v74, v245, v6
MA 80,v,152,v,88
v_fmac_f32 v66, v242, v3
v_fmac_f32 v74, v243, v7
MA 88,v,152,v,92
v_fmac_f32 v66, v240, v4
v_fmac_f32 v74, v241, v8
MA 144,v,152,v,96
ds_read_b128 v[124:127], v193 offset:38912
v_fmac_f32 v66, v238, v5
MA 152,v,152,v,100
v_fmac_f32 v74, v239, v9
v_mul_f32 v66, v66, v254
MA 208,v,152,v,104
buffer_load_dwordx4 v211, s[44:47], s75 offen offset:3072 lds
v_mul_f32 v74, v74, v255
MA 216,v,152,v,108
TR 152,198,49152
TR 154,198,51200
MA 20,v,156,v,80
v_lshlrev_b32 v254, 16, v49
v_and_b32 v255, 0xffff0000, v49
MA 28,v,156,v,84
v_mul_f32 v67, v246, v2
v_mul_f32 v75, v247, v6
MA 84,v,156,v,88
ds_read_b128 v[128:131], v193 offset:40960
s_add_u32 s75, s65, s74
MA 92,v,156,v,92
v_fmac_f32 v67, v244, v3
v_fmac_f32 v75, v245, v7
MA 148,v,156,v,96
v_fmac_f32 v67, v242, v4
v_fmac_f32 v75, v243, v8
MA 156,v,156,v,100
v_fmac_f32 v67, v240, v5
v_fmac_f32 v75, v241, v9
MA 212,v,156,v,104
v_mul_f32 v67, v67, v254
v_mul_f32 v75, v75, v255
MA 220,v,156,v,108
TR 156,199,49152
TR 158,199,51200
MA 32,v,160,v,80
ds_read_b128 v[132:135], v193 offset:43008
s_add_u32 m0, s67, 4096
MA 40,v,160,v,84
v_lshlrev_b32 v254, 16, v51
v_and_b32 v255, 0xffff0000, v51
MA 96,v,160,v,88
v_mul_f32 v68, v248, v2
v_mul_f32 v76, v249, v6
MA 104,v,160,v,92
buffer_load_dwordx4 v208, s[44:47], s75 offen offset:0 lds
v_fmac_f32 v68, v246, v3
MA 160,v,160,v,96
v_fmac_f32 v76, v247, v7
v_fmac_f32 v68, v244, v4
MA 168,v,160,v,100
v_fmac_f32 v76, v245, v8
v_fmac_f32 v68, v242, v5
MA 224,v,160,v,104
v_fmac_f32 v76, v243, v9
v_mul_f32 v68, v68, v254
MA 232,v,160,v,108
TR 160,200,49152
TR 162,200,51200
MA 36,v,164,v,80
ds_read_b128 v[136:139], v193 offset:45056
buffer_load_dwordx4 v209, s[44:47], s75 offen offset:1024 lds
MA 44,v,164,v,84
v_mul_f32 v76, v76, v255
v_lshlrev_b32 v254, 16, v53
MA 100,v,164,v,88
v_and_b32 v255, 0xffff0000, v53
v_mul_f32 v69, v250, v2
MA 108,v,164,v,92
v_mul_f32 v77, v251, v6
v_fmac_f32 v69, v248, v3
MA 164,v,164,v,96
buffer_load_dwordx4 v210, s[44:47], s75 offen offset:2048 lds
v_fmac_f32 v77, v249, v7
MA 172,v,164,v,100
ds_read_b128 v[140:143], v193 offset:47104
v_fmac_f32 v69, v246, v4
MA 228,v,164,v,104
v_fmac_f32 v77, v247, v8
v_fmac_f32 v69, v244, v5
MA 236,v,164,v,108
TR 164,201,49152
TR 166,201,51200
MA 48,v,168,v,80
buffer_load_dwordx4 v211, s[44:47], s75 offen offset:3072 lds
v_fmac_f32 v77, v245, v9
MA 56,v,168,v,84
v_mul_f32 v69, v69, v254
v_mul_f32 v77, v77, v255
MA 112,v,168,v,88
v_cvt_pk_bf16_f32 v230, v69, v68
v_cvt_pk_bf16_f32 v231, v67, v66
MA 120,v,168,v,92
v_cvt_pk_bf16_f32 v232, v65, v64
v_cvt_pk_bf16_f32 v233, v63, v62
MA 176,v,168,v,96
s_mov_b32 s36, 8192
buffer_store_dwordx4 v[230:233], v10, s[84:87], s36 offen sc1
MA 184,v,168,v,100
s_add_u32 s74, s74, 128
v_cvt_pk_bf16_f32 v234, v77, v76
MA 240,v,168,v,104
v_cvt_pk_bf16_f32 v235, v75, v74
v_cvt_pk_bf16_f32 v236, v73, v72
MA 248,v,168,v,108
TR 168,202,49152
TR 170,202,51200
s_waitcnt lgkmcnt(15)
MA 52,v,172,v,80
v_cvt_pk_bf16_f32 v237, v71, v70
s_mov_b32 s36, 12288
MA 60,v,172,v,84
s_and_b32 s74, s74, 2047
buffer_store_dwordx4 v[234:237], v10, s[84:87], s36 offen sc1
MA 116,v,172,v,88
v_bfe_u32 v230, v1, 4, 1
v_lshlrev_b32 v230, 10, v230
MA 124,v,172,v,92
v_bfe_u32 v231, v1, 3, 1
v_lshl_add_u32 v230, v231, 8, v230
MA 180,v,172,v,96
v_and_b32 v231, 7, v1
v_lshl_add_u32 v230, v231, 4, v230
MA 188,v,172,v,100
v_lshrrev_b32 v231, 5, v1
v_lshl_add_u32 v228, v231, 9, v230
MA 244,v,172,v,104
MA 252,v,172,v,108
TR 172,203,49152
TR 174,203,51200
s_waitcnt lgkmcnt(2)
MA 0,v,144,v,112
MA 8,v,144,v,116
MA 64,v,144,v,120
MA 72,v,144,v,124
MA 128,v,144,v,128
MA 136,v,144,v,132
MA 192,v,144,v,136
MA 200,v,144,v,140
MA 4,v,148,v,112
MA 12,v,148,v,116
s_waitcnt vmcnt(15) lgkmcnt(0)
s_barrier
MA 68,v,148,v,120
ds_read_b128 v[48:51], v226 offset:0
s_add_u32 m0, s68, 131072
MA 76,v,148,v,124
MA 132,v,148,v,128
ds_read_b128 v[52:55], v226 offset:2048
buffer_load_dwordx4 v212, s[48:51], s66 offen offset:0 lds
MA 140,v,148,v,132
MA 196,v,148,v,136
ds_read_b128 v[56:59], v226 offset:4096
buffer_load_dwordx4 v213, s[48:51], s66 offen offset:1024 lds
MA 204,v,148,v,140
MA 16,v,152,v,112
ds_read_b128 v[60:63], v226 offset:6144
MA 24,v,152,v,116
buffer_load_dwordx4 v214, s[48:51], s66 offen offset:2048 lds
MA 80,v,152,v,120
TR 16,216,0
MA 88,v,152,v,124
buffer_load_dwordx4 v215, s[48:51], s66 offen offset:3072 lds
MA 144,v,152,v,128
TR 18,216,1024
MA 152,v,152,v,132
MA 208,v,152,v,136
TR 20,217,0
s_add_u32 s66, s66, 524288
MA 216,v,152,v,140
MA 20,v,156,v,112
TR 22,217,1024
s_and_b32 s66, s66, 8388607
MA 28,v,156,v,116
MA 84,v,156,v,120
TR 24,218,0
MA 92,v,156,v,124
s_add_u32 s75, s64, s74
MA 148,v,156,v,128
TR 26,218,1024
MA 156,v,156,v,132
s_add_u32 m0, s67, 32768
MA 212,v,156,v,136
TR 28,219,0
MA 220,v,156,v,140
MA 32,v,160,v,112
TR 30,219,1024
buffer_load_dwordx4 v208, s[44:47], s75 offen offset:0 lds
MA 40,v,160,v,116
MA 96,v,160,v,120
TR 32,220,0
buffer_load_dwordx4 v209, s[44:47], s75 offen offset:1024 lds
MA 104,v,160,v,124
MA 160,v,160,v,128
TR 34,220,1024
MA 168,v,160,v,132
buffer_load_dwordx4 v210, s[44:47], s75 offen offset:2048 lds
MA 224,v,160,v,136
TR 36,221,0
MA 232,v,160,v,140
buffer_load_dwordx4 v211, s[44:47], s75 offen offset:3072 lds
MA 36,v,164,v,112
TR 38,221,1024
MA 44,v,164,v,116
MA 100,v,164,v,120
TR 40,222,0
s_add_u32 s75, s65, s74
MA 108,v,164,v,124
MA 164,v,164,v,128
TR 42,222,1024
s_add_u32 m0, s67, 36864
MA 172,v,164,v,132
MA 228,v,164,v,136
TR 44,223,0
MA 236,v,164,v,140
buffer_load_dwordx4 v208, s[44:47], s75 offen offset:0 lds
MA 48,v,168,v,112
TR 46,223,1024
MA 56,v,168,v,116
buffer_load_dwordx4 v209, s[44:47], s75 offen offset:1024 lds
MA 112,v,168,v,120
MA 120,v,168,v,124
MA 176,v,168,v,128
buffer_load_dwordx4 v210, s[44:47], s75 offen offset:2048 lds
MA 184,v,168,v,132
MA 240,v,168,v,136
buffer_load_dwordx4 v211, s[44:47], s75 offen offset:3072 lds
MA 248,v,168,v,140
MA 52,v,172,v,112
MA 60,v,172,v,116
s_add_u32 s74, s74, 128
MA 116,v,172,v,120
MA 124,v,172,v,124
s_and_b32 s74, s74, 2047
MA 180,v,172,v,128
MA 188,v,172,v,132
MA 244,v,172,v,136
MA 252,v,172,v,140
s_branch L_p2
L_p1_V:
s_waitcnt lgkmcnt(14)
v_mfma_f32_16x16x32_bf16 a[0:3], v[80:83], v[144:147], 0
s_add_u32 m0, s23, 32768
s_add_u32 s25, s24, 256
v_mfma_f32_16x16x32_bf16 a[4:7], v[84:87], v[144:147], 0
ds_read_b128 v[112:115], v193 offset:0
v_mfma_f32_16x16x32_bf16 a[64:67], v[88:91], v[144:147], 0
buffer_load_dwordx4 v184, s[12:15], s21 offen offset:0 lds
v_mfma_f32_16x16x32_bf16 a[68:71], v[92:95], v[144:147], 0
v_mfma_f32_16x16x32_bf16 a[128:131], v[96:99], v[144:147], 0
v_mfma_f32_16x16x32_bf16 a[132:135], v[100:103], v[144:147], 0
buffer_load_dwordx4 v185, s[12:15], s21 offen offset:1024 lds
v_mfma_f32_16x16x32_bf16 a[192:195], v[104:107], v[144:147], 0
v_mfma_f32_16x16x32_bf16 a[196:199], v[108:111], v[144:147], 0
TR 144,196,16384
TR 146,196,18432
s_waitcnt lgkmcnt(15)
v_mfma_f32_16x16x32_bf16 a[8:11], v[80:83], v[148:151], 0
ds_read_b128 v[116:119], v193 offset:2048
buffer_load_dwordx4 v186, s[12:15], s21 offen offset:2048 lds
v_mfma_f32_16x16x32_bf16 a[12:15], v[84:87], v[148:151], 0
s_add_u32 s26, s24, 1024
v_mfma_f32_16x16x32_bf16 a[72:75], v[88:91], v[148:151], 0
buffer_load_dwordx4 v187, s[12:15], s21 offen offset:3072 lds
v_mfma_f32_16x16x32_bf16 a[76:79], v[92:95], v[148:151], 0
v_mfma_f32_16x16x32_bf16 a[136:139], v[96:99], v[148:151], 0
s_add_u32 m0, s23, 36864
v_mfma_f32_16x16x32_bf16 a[140:143], v[100:103], v[148:151], 0
ds_read_b128 v[120:123], v193 offset:4096
v_mfma_f32_16x16x32_bf16 a[200:203], v[104:107], v[148:151], 0
v_mfma_f32_16x16x32_bf16 a[204:207], v[108:111], v[148:151], 0
TR 148,197,16384
TR 150,197,18432
s_waitcnt lgkmcnt(15)
v_mfma_f32_16x16x32_bf16 a[16:19], v[80:83], v[152:155], 0
buffer_load_dwordx4 v188, s[12:15], s21 offen offset:0 lds
v_mfma_f32_16x16x32_bf16 a[20:23], v[84:87], v[152:155], 0
s_add_u32 s27, s24, 1280
v_mfma_f32_16x16x32_bf16 a[80:83], v[88:91], v[152:155], 0
buffer_load_dwordx4 v189, s[12:15], s21 offen offset:1024 lds
v_mfma_f32_16x16x32_bf16 a[84:87], v[92:95], v[152:155], 0
v_mfma_f32_16x16x32_bf16 a[144:147], v[96:99], v[152:155], 0
ds_read_b128 v[124:127], v193 offset:6144
buffer_load_dwordx4 v190, s[12:15], s21 offen offset:2048 lds
v_mfma_f32_16x16x32_bf16 a[148:151], v[100:103], v[152:155], 0
v_mfma_f32_16x16x32_bf16 a[208:211], v[104:107], v[152:155], 0
v_mfma_f32_16x16x32_bf16 a[212:215], v[108:111], v[152:155], 0
TR 152,198,16384
TR 154,198,18432
v_mfma_f32_16x16x32_bf16 a[24:27], v[80:83], v[156:159], 0
buffer_load_dwordx4 v191, s[12:15], s21 offen offset:3072 lds
v_mfma_f32_16x16x32_bf16 a[28:31], v[84:87], v[156:159], 0
s_add_u32 s21, s21, 524288
v_mfma_f32_16x16x32_bf16 a[88:91], v[88:91], v[156:159], 0
ds_read_b128 v[128:131], v193 offset:8192
s_add_u32 s28, s24, 2048
v_mfma_f32_16x16x32_bf16 a[92:95], v[92:95], v[156:159], 0
v_mfma_f32_16x16x32_bf16 a[152:155], v[96:99], v[156:159], 0
s_and_b32 s21, s21, 4194303
v_mfma_f32_16x16x32_bf16 a[156:159], v[100:103], v[156:159], 0
v_mfma_f32_16x16x32_bf16 a[216:219], v[104:107], v[156:159], 0
v_mfma_f32_16x16x32_bf16 a[220:223], v[108:111], v[156:159], 0
TR 156,199,16384
TR 158,199,18432
s_waitcnt lgkmcnt(15)
v_mfma_f32_16x16x32_bf16 a[32:35], v[80:83], v[160:163], 0
ds_read_b128 v[132:135], v193 offset:10240
s_add_u32 m0, s22, 32768
v_mfma_f32_16x16x32_bf16 a[36:39], v[84:87], v[160:163], 0
buffer_load_dwordx4 v176, s[8:11], s20 offen offset:0 lds
v_mfma_f32_16x16x32_bf16 a[96:99], v[88:91], v[160:163], 0
v_mfma_f32_16x16x32_bf16 a[100:103], v[92:95], v[160:163], 0
s_add_u32 s29, s24, 2304
v_mfma_f32_16x16x32_bf16 a[160:163], v[96:99], v[160:163], 0
buffer_load_dwordx4 v177, s[8:11], s20 offen offset:1024 lds
v_mfma_f32_16x16x32_bf16 a[164:167], v[100:103], v[160:163], 0
v_mfma_f32_16x16x32_bf16 a[224:227], v[104:107], v[160:163], 0
buffer_load_dwordx4 v178, s[8:11], s20 offen offset:2048 lds
v_mfma_f32_16x16x32_bf16 a[228:231], v[108:111], v[160:163], 0
TR 160,200,16384
TR 162,200,18432
v_mfma_f32_16x16x32_bf16 a[40:43], v[80:83], v[164:167], 0
ds_read_b128 v[136:139], v193 offset:12288
v_mfma_f32_16x16x32_bf16 a[44:47], v[84:87], v[164:167], 0
buffer_load_dwordx4 v179, s[8:11], s20 offen offset:3072 lds
v_mfma_f32_16x16x32_bf16 a[104:107], v[88:91], v[164:167], 0
v_mfma_f32_16x16x32_bf16 a[108:111], v[92:95], v[164:167], 0
s_add_u32 m0, s22, 36864
v_mfma_f32_16x16x32_bf16 a[168:171], v[96:99], v[164:167], 0
s_add_u32 s30, s24, 3072
v_mfma_f32_16x16x32_bf16 a[172:175], v[100:103], v[164:167], 0
ds_read_b128 v[140:143], v193 offset:14336
v_mfma_f32_16x16x32_bf16 a[232:235], v[104:107], v[164:167], 0
buffer_load_dwordx4 v180, s[8:11], s20 offen offset:0 lds
v_mfma_f32_16x16x32_bf16 a[236:239], v[108:111], v[164:167], 0
TR 164,201,16384
TR 166,201,18432
v_mfma_f32_16x16x32_bf16 a[48:51], v[80:83], v[168:171], 0
v_mfma_f32_16x16x32_bf16 a[52:55], v[84:87], v[168:171], 0
buffer_load_dwordx4 v181, s[8:11], s20 offen offset:1024 lds
v_mfma_f32_16x16x32_bf16 a[112:115], v[88:91], v[168:171], 0
v_mfma_f32_16x16x32_bf16 a[116:119], v[92:95], v[168:171], 0
buffer_load_dwordx4 v182, s[8:11], s20 offen offset:2048 lds
v_mfma_f32_16x16x32_bf16 a[176:179], v[96:99], v[168:171], 0
v_mfma_f32_16x16x32_bf16 a[180:183], v[100:103], v[168:171], 0
s_add_u32 s31, s24, 3328
v_mfma_f32_16x16x32_bf16 a[240:243], v[104:107], v[168:171], 0
buffer_load_dwordx4 v183, s[8:11], s20 offen offset:3072 lds
v_mfma_f32_16x16x32_bf16 a[244:247], v[108:111], v[168:171], 0
TR 168,202,16384
TR 170,202,18432
s_waitcnt lgkmcnt(15)
v_mfma_f32_16x16x32_bf16 a[56:59], v[80:83], v[172:175], 0
s_add_u32 s20, s20, 128
v_mfma_f32_16x16x32_bf16 a[60:63], v[84:87], v[172:175], 0
v_mfma_f32_16x16x32_bf16 a[120:123], v[88:91], v[172:175], 0
v_mfma_f32_16x16x32_bf16 a[124:127], v[92:95], v[172:175], 0
s_and_b32 s20, s20, 1023
v_mfma_f32_16x16x32_bf16 a[184:187], v[96:99], v[172:175], 0
v_mfma_f32_16x16x32_bf16 a[188:191], v[100:103], v[172:175], 0
v_mfma_f32_16x16x32_bf16 a[248:251], v[104:107], v[172:175], 0
v_mfma_f32_16x16x32_bf16 a[252:255], v[108:111], v[172:175], 0
TR 172,203,16384
TR 174,203,18432
s_waitcnt lgkmcnt(2)
MA 0,v,112,v,144
s_add_u32 m0, s22, 65536
MA 4,v,116,v,144
MA 64,v,120,v,144
MA 68,v,124,v,144
buffer_load_dwordx4 v176, s[8:11], s20 offen offset:0 lds
MA 128,v,128,v,144
MA 132,v,132,v,144
MA 192,v,136,v,144
MA 196,v,140,v,144
buffer_load_dwordx4 v177, s[8:11], s20 offen offset:1024 lds
MA 8,v,112,v,148
MA 12,v,116,v,148
MA 72,v,120,v,148
buffer_load_dwordx4 v178, s[8:11], s20 offen offset:2048 lds
MA 76,v,124,v,148
MA 136,v,128,v,148
MA 140,v,132,v,148
MA 200,v,136,v,148
buffer_load_dwordx4 v179, s[8:11], s20 offen offset:3072 lds
MA 204,v,140,v,148
MA 16,v,112,v,152
MA 20,v,116,v,152
s_add_u32 m0, s22, 69632
MA 80,v,120,v,152
MA 84,v,124,v,152
MA 144,v,128,v,152
MA 148,v,132,v,152
buffer_load_dwordx4 v180, s[8:11], s20 offen offset:0 lds
MA 208,v,136,v,152
MA 212,v,140,v,152
MA 24,v,112,v,156
MA 28,v,116,v,156
buffer_load_dwordx4 v181, s[8:11], s20 offen offset:1024 lds
MA 88,v,120,v,156
MA 92,v,124,v,156
MA 152,v,128,v,156
buffer_load_dwordx4 v182, s[8:11], s20 offen offset:2048 lds
MA 156,v,132,v,156
MA 216,v,136,v,156
MA 220,v,140,v,156
MA 32,v,112,v,160
buffer_load_dwordx4 v183, s[8:11], s20 offen offset:3072 lds
MA 36,v,116,v,160
MA 96,v,120,v,160
MA 100,v,124,v,160
s_add_u32 s20, s20, 128
MA 160,v,128,v,160
MA 164,v,132,v,160
MA 224,v,136,v,160
MA 228,v,140,v,160
s_and_b32 s20, s20, 1023
MA 40,v,112,v,164
MA 44,v,116,v,164
MA 104,v,120,v,164
MA 108,v,124,v,164
MA 168,v,128,v,164
s_waitcnt vmcnt(8) lgkmcnt(0)
s_barrier
MA 172,v,132,v,164
TR 144,196,32768
TR 146,196,34816
MA 232,v,136,v,164
ds_read_b128 v[80:83], v192 offset:32768
s_add_u32 m0, s23, 0
MA 236,v,140,v,164
TR 148,197,32768
TR 150,197,34816
MA 48,v,112,v,168
ds_read_b128 v[84:87], v192 offset:34816
ds_read_b128 v[88:91], v192 offset:36864
MA 52,v,116,v,168
TR 152,198,32768
TR 154,198,34816
MA 112,v,120,v,168
ds_read_b128 v[92:95], v192 offset:38912
ds_read_b128 v[96:99], v192 offset:40960
MA 116,v,124,v,168
TR 156,199,32768
TR 158,199,34816
MA 176,v,128,v,168
ds_read_b128 v[100:103], v192 offset:43008
ds_read_b128 v[104:107], v192 offset:45056
MA 180,v,132,v,168
TR 160,200,32768
TR 162,200,34816
MA 240,v,136,v,168
ds_read_b128 v[108:111], v192 offset:47104
buffer_load_dwordx4 v184, s[12:15], s21 offen offset:0 lds
MA 244,v,140,v,168
TR 164,201,32768
TR 166,201,34816
MA 56,v,112,v,172
buffer_load_dwordx4 v185, s[12:15], s21 offen offset:1024 lds
buffer_load_dwordx4 v186, s[12:15], s21 offen offset:2048 lds
MA 60,v,116,v,172
TR 168,202,32768
TR 170,202,34816
MA 120,v,120,v,172
buffer_load_dwordx4 v187, s[12:15], s21 offen offset:3072 lds
s_add_u32 m0, s23, 4096
MA 124,v,124,v,172
buffer_load_dwordx4 v188, s[12:15], s21 offen offset:0 lds
buffer_load_dwordx4 v189, s[12:15], s21 offen offset:1024 lds
MA 184,v,128,v,172
buffer_load_dwordx4 v190, s[12:15], s21 offen offset:2048 lds
buffer_load_dwordx4 v191, s[12:15], s21 offen offset:3072 lds
MA 188,v,132,v,172
s_add_u32 s21, s21, 524288
s_and_b32 s21, s21, 4194303
MA 248,v,136,v,172
MA 252,v,140,v,172
TR 172,203,32768
TR 174,203,34816
s_waitcnt lgkmcnt(2)
MA 0,v,80,v,144
s_add_u32 m0, s22, 0
v_lshlrev_b32 v8, 7, v1
MA 4,v,84,v,144
ds_read_b128 v[112:115], v193 offset:32768
s_getpc_b64 s[4:5]
L_pcV:
MA 64,v,88,v,144
s_lshr_b32 s98, s2, 3
s_lshl_b32 s98, s98, 2
MA 68,v,92,v,144
s_add_u32 s98, s98, s3
MA 128,v,96,v,144
s_lshl_b32 s98, s98, 10
MA 132,v,100,v,144
buffer_load_dwordx4 v176, s[8:11], s20 offen offset:0 lds
v_and_b32 v9, 0x380, v8
MA 192,v,104,v,144
v_add_u32 v9, s98, v9
MA 196,v,108,v,144
TR 144,196,49152
TR 146,196,51200
MA 8,v,80,v,148
ds_read_b128 v[116:119], v193 offset:34816
v_min_u32 v9, L_code_end - L_pcV - 4, v9
MA 12,v,84,v,148
v_mov_b32 v11, s5
MA 72,v,88,v,148
buffer_load_dwordx4 v177, s[8:11], s20 offen offset:1024 lds
MA 76,v,92,v,148
v_add_co_u32 v10, vcc, s4, v9
s_nop 1
v_addc_co_u32 v11, vcc, 0, v11, vcc
MA 136,v,96,v,148
global_load_dword v79, v[10:11], off
MA 140,v,100,v,148
ds_read_b128 v[120:123], v193 offset:36864
s_and_b32 s80, s2, 7
MA 200,v,104,v,148
s_lshr_b32 s81, s2, 3
MA 204,v,108,v,148
TR 148,197,49152
TR 150,197,51200
MA 16,v,80,v,152
buffer_load_dwordx4 v178, s[8:11], s20 offen offset:2048 lds
s_and_b32 s69, s81, 3
MA 20,v,84,v,152
s_lshl_b32 s80, s80, 2
s_add_u32 s69, s69, s80
MA 80,v,88,v,152
s_lshr_b32 s70, s81, 2
MA 84,v,92,v,152
s_lshl_b32 s80, s3, 16
MA 144,v,96,v,152
ds_read_b128 v[124:127], v193 offset:38912
buffer_load_dwordx4 v179, s[8:11], s20 offen offset:3072 lds
MA 148,v,100,v,152
s_lshl_b32 s65, s70, 18
s_sub_u32 s64, 3932160, s65
MA 208,v,104,v,152
s_add_u32 s65, s65, s80
s_add_u32 s64, s64, s80
MA 212,v,108,v,152
TR 152,198,49152
TR 154,198,51200
MA 24,v,80,v,156
s_lshl_b32 s81, s69, 12
s_lshl_b32 s100, s64, 2
MA 28,v,84,v,156
s_add_u32 m0, s22, 4096
s_add_u32 s100, s100, s81
MA 88,v,88,v,156
ds_read_b128 v[128:131], v193 offset:40960
s_lshl_b32 s101, s65, 2
MA 92,v,92,v,156
s_add_u32 s101, s101, s81
MA 152,v,96,v,156
s_lshl_b32 s66, s3, 17
MA 156,v,100,v,156
s_lshl_b32 s81, s69, 8
MA 216,v,104,v,156
s_add_u32 s66, s66, s81
MA 220,v,108,v,156
TR 156,199,49152
TR 158,199,51200
MA 32,v,80,v,160
ds_read_b128 v[132:135], v193 offset:43008
buffer_load_dwordx4 v180, s[8:11], s20 offen offset:0 lds
MA 36,v,84,v,160
s_and_b32 s74, s2, 7
s_lshl_b32 s74, s74, 8
MA 96,v,88,v,160
s_mov_b32 s82, s66
s_lshl_b32 s66, s74, 12
MA 100,v,92,v,160
s_lshl_b32 s67, s3, 13
s_lshl_b32 s68, s3, 12
MA 160,v,96,v,160
buffer_load_dwordx4 v181, s[8:11], s20 offen offset:1024 lds
s_lshl_b32 s76, s70, 1
MA 164,v,100,v,160
s_sub_u32 s77, 32, s76
MA 224,v,104,v,160
s_add_u32 s76, s76, 2
MA 228,v,108,v,160
TR 160,200,49152
TR 162,200,51200
MA 40,v,80,v,164
ds_read_b128 v[136:139], v193 offset:45056
s_mov_b32 s79, 0x41000000
MA 44,v,84,v,164
buffer_load_dwordx4 v182, s[8:11], s20 offen offset:2048 lds
v_lshrrev_b32 v16, 3, v1
MA 104,v,88,v,164
v_lshlrev_b32 v16, 11, v16
v_lshrrev_b32 v17, 4, v1
MA 108,v,92,v,164
v_and_b32 v18, 7, v1
v_xor_b32 v18, v18, v17
MA 168,v,96,v,164
v_lshl_add_u32 v16, v18, 4, v16
MA 172,v,100,v,164
ds_read_b128 v[140:143], v193 offset:47104
v_xor_b32 v19, 64, v16
MA 232,v,104,v,164
buffer_load_dwordx4 v183, s[8:11], s20 offen offset:3072 lds
v_add_u32 v208, 0, v16
MA 236,v,108,v,164
TR 164,201,49152
TR 166,201,51200
MA 48,v,80,v,168
v_add_u32 v209, 15360, v19
v_add_u32 v210, 30720, v16
MA 52,v,84,v,168
v_add_u32 v211, 46080, v19
MA 112,v,88,v,168
v_and_b32 v18, 15, v1
MA 116,v,92,v,168
s_add_u32 s20, s20, 128
v_lshlrev_b32 v19, 1, v17
MA 176,v,96,v,168
v_xor_b32 v18, v18, v19
v_lshlrev_b32 v16, 13, v17
MA 180,v,100,v,168
v_xor_b32 v19, 0, v18
MA 240,v,104,v,168
v_lshl_add_u32 v19, v19, 4, v16
MA 244,v,108,v,168
TR 168,202,49152
TR 170,202,51200
s_waitcnt lgkmcnt(15)
MA 56,v,80,v,172
s_and_b32 s20, s20, 1023
v_add_u32 v212, 0, v19
MA 60,v,84,v,172
v_xor_b32 v19, 0, v18
v_lshl_add_u32 v19, v19, 4, v16
MA 120,v,88,v,172
v_add_u32 v213, 31744, v19
MA 124,v,92,v,172
v_xor_b32 v19, 8, v18
MA 184,v,96,v,172
v_lshl_add_u32 v19, v19, 4, v16
MA 188,v,100,v,172
v_add_u32 v214, 63488, v19
MA 248,v,104,v,172
MA 252,v,108,v,172
TR 172,203,49152
TR 174,203,51200
s_waitcnt lgkmcnt(2)
MA 0,v,112,v,144
MA 4,v,116,v,144
MA 64,v,120,v,144
MA 68,v,124,v,144
MA 128,v,128,v,144
MA 132,v,132,v,144
MA 192,v,136,v,144
MA 196,v,140,v,144
MA 8,v,112,v,148
MA 12,v,116,v,148
s_waitcnt vmcnt(9) lgkmcnt(0)
s_barrier
MA 72,v,120,v,148
TR 144,196,0
TR 146,196,2048
MA 76,v,124,v,148
ds_read_b128 v[80:83], v194 offset:0
s_add_u32 m0, s23, 32768
MA 136,v,128,v,148
v_xor_b32 v19, 8, v18
v_lshl_add_u32 v19, v19, 4, v16
MA 140,v,132,v,148
v_add_u32 v215, 95232, v19
v_and_b32 v16, 15, v1
MA 200,v,136,v,148
buffer_load_dwordx4 v184, s[12:15], s21 offen offset:0 lds
v_lshrrev_b32 v18, 1, v16
MA 204,v,140,v,148
TR 148,197,0
TR 150,197,2048
MA 16,v,112,v,152
ds_read_b128 v[84:87], v194 offset:2048
v_xor_b32 v18, v18, v17
MA 20,v,116,v,152
v_lshlrev_b32 v18, 4, v18
v_lshl_add_u32 v18, v16, 7, v18
MA 80,v,120,v,152
buffer_load_dwordx4 v185, s[12:15], s21 offen offset:1024 lds
v_add_u32 v224, s67, v18
MA 84,v,124,v,152
v_xor_b32 v225, 64, v224
v_add_u32 v226, 0x10000, v224
MA 144,v,128,v,152
v_add_u32 v227, 0x10000, v225
v_bfe_u32 v16, v1, 2, 2
MA 148,v,132,v,152
ds_read_b128 v[88:91], v194 offset:4096
v_and_b32 v18, 1, v17
MA 208,v,136,v,152
v_lshl_or_b32 v18, v18, 2, v16
MA 212,v,140,v,152
TR 152,198,0
TR 154,198,2048
MA 24,v,112,v,156
buffer_load_dwordx4 v186, s[12:15], s21 offen offset:2048 lds
v_lshl_add_u32 v16, v17, 3, v16
MA 28,v,116,v,156
v_lshlrev_b32 v16, 8, v16
v_and_b32 v19, 3, v1
MA 88,v,120,v,156
ds_read_b128 v[92:95], v194 offset:6144
v_lshl_add_u32 v16, v19, 3, v16
MA 92,v,124,v,156
buffer_load_dwordx4 v187, s[12:15], s21 offen offset:3072 lds
v_add_u32 v16, 98304, v16
MA 152,v,128,v,156
v_xor_b32 v19, 0, v18
v_lshl_add_u32 v216, v19, 5, v16
MA 156,v,132,v,156
v_xor_b32 v19, 1, v18
MA 216,v,136,v,156
v_lshl_add_u32 v217, v19, 5, v16
MA 220,v,140,v,156
TR 156,199,0
TR 158,199,2048
MA 32,v,112,v,160
ds_read_b128 v[96:99], v194 offset:8192
s_add_u32 m0, s23, 36864
MA 36,v,116,v,160
v_xor_b32 v19, 2, v18
v_lshl_add_u32 v218, v19, 5, v16
MA 96,v,120,v,160
v_xor_b32 v19, 3, v18
v_lshl_add_u32 v219, v19, 5, v16
MA 100,v,124,v,160
v_xor_b32 v19, 4, v18
v_lshl_add_u32 v220, v19, 5, v16
MA 160,v,128,v,160
ds_read_b128 v[100:103], v194 offset:10240
buffer_load_dwordx4 v188, s[12:15], s21 offen offset:0 lds
MA 164,v,132,v,160
v_xor_b32 v19, 5, v18
v_lshl_add_u32 v221, v19, 5, v16
MA 224,v,136,v,160
v_xor_b32 v19, 6, v18
MA 228,v,140,v,160
TR 160,200,0
TR 162,200,2048
MA 40,v,112,v,164
buffer_load_dwordx4 v189, s[12:15], s21 offen offset:1024 lds
v_lshl_add_u32 v222, v19, 5, v16
MA 44,v,116,v,164
ds_read_b128 v[104:107], v194 offset:12288
v_xor_b32 v19, 7, v18
MA 104,v,120,v,164
v_lshl_add_u32 v223, v19, 5, v16
s_mov_b32 s44, s32
MA 108,v,124,v,164
s_mov_b32 s45, s33
s_mov_b32 s46, 4194304
MA 168,v,128,v,164
buffer_load_dwordx4 v190, s[12:15], s21 offen offset:2048 lds
s_mov_b32 s47, 0x20000
MA 172,v,132,v,164
s_add_u32 s48, s34, s82
s_addc_u32 s49, s35, 0
MA 232,v,136,v,164
ds_read_b128 v[108:111], v194 offset:14336
MA 236,v,140,v,164
TR 164,201,0
TR 166,201,2048
MA 48,v,112,v,168
s_sub_u32 s50, 8388608, s82
s_mov_b32 s51, 0x20000
MA 52,v,116,v,168
buffer_load_dwordx4 v191, s[12:15], s21 offen offset:3072 lds
MA 112,v,120,v,168
s_add_u32 s60, s40, 33554432
s_addc_u32 s61, s41, 0
MA 116,v,124,v,168
s_mov_b32 s62, 16777216
s_mov_b32 s63, 0x20000
MA 176,v,128,v,168
s_lshl_b32 s80, s69, 19
MA 180,v,132,v,168
s_add_u32 s21, s21, 524288
MA 240,v,136,v,168
s_add_u32 s52, s40, s80
s_addc_u32 s53, s41, 0
MA 244,v,140,v,168
TR 168,202,0
TR 170,202,2048
MA 56,v,112,v,172
s_lshl_b32 s54, s77, 14
s_mov_b32 s55, 0x20000
MA 60,v,116,v,172
s_and_b32 s21, s21, 4194303
s_add_u32 s80, s80, 16760832
MA 120,v,120,v,172
s_add_u32 s56, s40, s80
s_addc_u32 s57, s41, 0
MA 124,v,124,v,172
s_add_u32 s58, s54, 16384
MA 184,v,128,v,172
s_mov_b32 s59, 0x20000
MA 188,v,132,v,172
s_load_dwordx2 s[38:39], s[0:1], 112
MA 248,v,136,v,172
MA 252,v,140,v,172
TR 172,203,0
TR 174,203,2048
s_waitcnt lgkmcnt(2)
MA 0,v,80,v,144
s_add_u32 m0, s22, 32768
s_load_dwordx2 s[84:85], s[0:1], 8
MA 4,v,84,v,144
ds_read_b128 v[112:115], v195 offset:0
MA 64,v,88,v,144
MA 68,v,92,v,144
MA 128,v,96,v,144
MA 132,v,100,v,144
buffer_load_dwordx4 v176, s[8:11], s20 offen offset:0 lds
MA 192,v,104,v,144
MA 196,v,108,v,144
TR 144,196,16384
TR 146,196,18432
MA 8,v,80,v,148
ds_read_b128 v[116:119], v195 offset:2048
MA 12,v,84,v,148
MA 72,v,88,v,148
buffer_load_dwordx4 v177, s[8:11], s20 offen offset:1024 lds
MA 76,v,92,v,148
MA 136,v,96,v,148
s_load_dwordx2 s[88:89], s[0:1], 16
MA 140,v,100,v,148
ds_read_b128 v[120:123], v195 offset:4096
MA 200,v,104,v,148
MA 204,v,108,v,148
TR 148,197,16384
TR 150,197,18432
MA 16,v,80,v,152
buffer_load_dwordx4 v178, s[8:11], s20 offen offset:2048 lds
MA 20,v,84,v,152
MA 80,v,88,v,152
MA 84,v,92,v,152
MA 144,v,96,v,152
ds_read_b128 v[124:127], v195 offset:6144
buffer_load_dwordx4 v179, s[8:11], s20 offen offset:3072 lds
MA 148,v,100,v,152
MA 208,v,104,v,152
MA 212,v,108,v,152
TR 152,198,16384
TR 154,198,18432
MA 24,v,80,v,156
s_load_dwordx2 s[92:93], s[0:1], 0
MA 28,v,84,v,156
s_add_u32 m0, s22, 36864
MA 88,v,88,v,156
ds_read_b128 v[128:131], v195 offset:8192
MA 92,v,92,v,156
MA 152,v,96,v,156
MA 156,v,100,v,156
MA 216,v,104,v,156
MA 220,v,108,v,156
TR 156,199,16384
TR 158,199,18432
MA 32,v,80,v,160
ds_read_b128 v[132:135], v195 offset:10240
buffer_load_dwordx4 v180, s[8:11], s20 offen offset:0 lds
MA 36,v,84,v,160
MA 96,v,88,v,160
MA 100,v,92,v,160
MA 160,v,96,v,160
buffer_load_dwordx4 v181, s[8:11], s20 offen offset:1024 lds
MA 164,v,100,v,160
s_load_dwordx2 s[96:97], s[0:1], 24
MA 224,v,104,v,160
MA 228,v,108,v,160
TR 160,200,16384
TR 162,200,18432
MA 40,v,80,v,164
ds_read_b128 v[136:139], v195 offset:12288
MA 44,v,84,v,164
buffer_load_dwordx4 v182, s[8:11], s20 offen offset:2048 lds
MA 104,v,88,v,164
MA 108,v,92,v,164
MA 168,v,96,v,164
MA 172,v,100,v,164
ds_read_b128 v[140:143], v195 offset:14336
MA 232,v,104,v,164
buffer_load_dwordx4 v183, s[8:11], s20 offen offset:3072 lds
MA 236,v,108,v,164
TR 164,201,16384
TR 166,201,18432
MA 48,v,80,v,168
MA 52,v,84,v,168
s_load_dwordx2 s[4:5], s[0:1], 96
MA 112,v,88,v,168
MA 116,v,92,v,168
s_add_u32 s20, s20, 128
MA 176,v,96,v,168
MA 180,v,100,v,168
MA 240,v,104,v,168
MA 244,v,108,v,168
TR 168,202,16384
TR 170,202,18432
s_waitcnt lgkmcnt(15)
MA 56,v,80,v,172
s_and_b32 s20, s20, 1023
MA 60,v,84,v,172
MA 120,v,88,v,172
MA 124,v,92,v,172
MA 184,v,96,v,172
MA 188,v,100,v,172
MA 248,v,104,v,172
MA 252,v,108,v,172
TR 172,203,16384
TR 174,203,18432
s_waitcnt lgkmcnt(2)
MA 0,v,112,v,144
MA 4,v,116,v,144
MA 64,v,120,v,144
MA 68,v,124,v,144
MA 128,v,128,v,144
MA 132,v,132,v,144
MA 192,v,136,v,144
MA 196,v,140,v,144
MA 8,v,112,v,148
MA 12,v,116,v,148
s_waitcnt vmcnt(8) lgkmcnt(0)
s_barrier
MA 72,v,120,v,148
TR 144,196,32768
TR 146,196,34816
MA 76,v,124,v,148
ds_read_b128 v[80:83], v192 offset:0
s_add_u32 m0, s23, 0
MA 136,v,128,v,148
s_mov_b32 s86, 4194304
s_mov_b32 s87, 0x20000
MA 140,v,132,v,148
s_mov_b32 s90, 4194304
MA 200,v,136,v,148
buffer_load_dwordx4 v184, s[12:15], s21 offen offset:0 lds
s_mov_b32 s91, 0x20000
MA 204,v,140,v,148
TR 148,197,32768
TR 150,197,34816
MA 16,v,112,v,152
ds_read_b128 v[84:87], v192 offset:2048
s_mov_b32 s94, 4194304
MA 20,v,116,v,152
s_mov_b32 s95, 0x20000
MA 80,v,120,v,152
buffer_load_dwordx4 v185, s[12:15], s21 offen offset:1024 lds
s_mov_b32 s98, 8192
MA 84,v,124,v,152
s_mov_b32 s99, 0x20000
MA 144,v,128,v,152
MA 148,v,132,v,152
ds_read_b128 v[88:91], v192 offset:4096
s_mov_b32 s6, 2048
MA 208,v,136,v,152
s_mov_b32 s7, 0x20000
MA 212,v,140,v,152
TR 152,198,32768
TR 154,198,34816
MA 24,v,112,v,156
buffer_load_dwordx4 v186, s[12:15], s21 offen offset:2048 lds
s_and_b32 s36, s2, 15
MA 28,v,116,v,156
s_lshl_b32 s36, s36, 4
MA 88,v,120,v,156
ds_read_b128 v[92:95], v192 offset:6144
v_and_b32 v252, 15, v1
MA 92,v,124,v,156
buffer_load_dwordx4 v187, s[12:15], s21 offen offset:3072 lds
MA 152,v,128,v,156
v_add_u32 v252, s36, v252
MA 156,v,132,v,156
s_lshr_b32 s36, s2, 4
MA 216,v,136,v,156
MA 220,v,140,v,156
TR 156,199,32768
TR 158,199,34816
MA 32,v,112,v,160
ds_read_b128 v[96:99], v192 offset:8192
s_add_u32 m0, s23, 4096
MA 36,v,116,v,160
s_lshl_b32 s36, s36, 2
s_add_u32 s36, s36, s3
MA 96,v,120,v,160
s_lshl_b32 s36, s36, 2
MA 100,v,124,v,160
v_lshrrev_b32 v253, 4, v1
MA 160,v,128,v,160
ds_read_b128 v[100:103], v192 offset:10240
buffer_load_dwordx4 v188, s[12:15], s21 offen offset:0 lds
MA 164,v,132,v,160
v_add_u32 v253, s36, v253
MA 224,v,136,v,160
v_lshlrev_b32 v254, 14, v253
MA 228,v,140,v,160
TR 160,200,32768
TR 162,200,34816
MA 40,v,112,v,164
buffer_load_dwordx4 v189, s[12:15], s21 offen offset:1024 lds
v_lshl_add_u32 v254, v252, 3, v254
MA 44,v,116,v,164
ds_read_b128 v[104:107], v192 offset:12288
v_add_u32 v229, -6144, v254
MA 104,v,120,v,164
v_lshlrev_b32 v62, 5, v252
MA 108,v,124,v,164
v_lshlrev_b32 v254, 4, v253
MA 168,v,128,v,164
buffer_load_dwordx4 v190, s[12:15], s21 offen offset:2048 lds
MA 172,v,132,v,164
v_sub_u32 v254, 4080, v254
MA 232,v,136,v,164
ds_read_b128 v[108:111], v192 offset:14336
v_lshl_add_u32 v10, v252, 14, v254
MA 236,v,140,v,164
TR 164,201,32768
TR 166,201,34816
MA 48,v,112,v,168
v_and_b32 v252, 31, v1
MA 52,v,116,v,168
buffer_load_dwordx4 v191, s[12:15], s21 offen offset:3072 lds
v_lshlrev_b32 v64, 4, v252
MA 112,v,120,v,168
s_lshl_b32 s36, s2, 2
MA 116,v,124,v,168
MA 176,v,128,v,168
s_add_u32 s36, s36, s3
MA 180,v,132,v,168
s_add_u32 s21, s21, 524288
s_lshl_b32 s36, s36, 1
MA 240,v,136,v,168
v_lshrrev_b32 v253, 5, v1
MA 244,v,140,v,168
TR 168,202,32768
TR 170,202,34816
MA 56,v,112,v,172
v_add_u32 v253, s36, v253
MA 60,v,116,v,172
s_and_b32 s21, s21, 4194303
v_lshl_add_u32 v63, v253, 11, v64
MA 120,v,120,v,172
MA 124,v,124,v,172
v_lshlrev_b32 v253, 2, v253
MA 184,v,128,v,172
v_lshl_add_u32 v11, v252, 20, v253
MA 188,v,132,v,172
MA 248,v,136,v,172
MA 252,v,140,v,172
TR 172,203,32768
TR 174,203,34816
s_waitcnt lgkmcnt(2)
MA 0,v,80,v,144
s_add_u32 m0, s22, 65536
buffer_load_dwordx4 v[230:233], v63, s[92:95], 0 offen offset:0
MA 4,v,84,v,144
ds_read_b128 v[112:115], v193 offset:0
MA 64,v,88,v,144
MA 68,v,92,v,144
buffer_load_dwordx4 v[2:5], v64, s[4:7], 0 offen offset:0
MA 128,v,96,v,144
MA 132,v,100,v,144
buffer_load_dwordx4 v176, s[8:11], s20 offen offset:0 lds
MA 192,v,104,v,144
buffer_load_dwordx4 v[234:237], v63, s[92:95], 0 offen offset:512
MA 196,v,108,v,144
TR 144,196,49152
TR 146,196,51200
MA 8,v,80,v,148
ds_read_b128 v[116:119], v193 offset:2048
MA 12,v,84,v,148
buffer_load_dwordx4 v[6:9], v64, s[4:7], 0 offen offset:512
MA 72,v,88,v,148
buffer_load_dwordx4 v177, s[8:11], s20 offen offset:1024 lds
MA 76,v,92,v,148
MA 136,v,96,v,148
buffer_load_dwordx4 v[238:241], v63, s[92:95], 0 offen offset:1024
MA 140,v,100,v,148
ds_read_b128 v[120:123], v193 offset:4096
MA 200,v,104,v,148
MA 204,v,108,v,148
TR 148,197,49152
TR 150,197,51200
MA 16,v,80,v,152
buffer_load_dwordx4 v178, s[8:11], s20 offen offset:2048 lds
buffer_load_dwordx4 v[12:15], v64, s[4:7], 0 offen offset:1024
MA 20,v,84,v,152
MA 80,v,88,v,152
buffer_load_dwordx4 v[242:245], v63, s[92:95], 0 offen offset:1536
MA 84,v,92,v,152
MA 144,v,96,v,152
ds_read_b128 v[124:127], v193 offset:6144
buffer_load_dwordx4 v179, s[8:11], s20 offen offset:3072 lds
MA 148,v,100,v,152
buffer_load_dwordx4 v[246:249], v64, s[4:7], 0 offen offset:1536
MA 208,v,104,v,152
MA 212,v,108,v,152
TR 152,198,49152
TR 154,198,51200
MA 24,v,80,v,156
buffer_load_dwordx4 v[54:57], v62, s[96:99], 0 offen offset:0
MA 28,v,84,v,156
s_add_u32 m0, s22, 69632
MA 88,v,88,v,156
ds_read_b128 v[128:131], v193 offset:8192
MA 92,v,92,v,156
buffer_load_dwordx4 v[58:61], v62, s[96:99], 0 offen offset:16
MA 152,v,96,v,156
MA 156,v,100,v,156
MA 216,v,104,v,156
MA 220,v,108,v,156
TR 156,199,49152
TR 158,199,51200
MA 32,v,80,v,160
ds_read_b128 v[132:135], v193 offset:10240
buffer_load_dwordx4 v180, s[8:11], s20 offen offset:0 lds
MA 36,v,84,v,160
v_add_u32 v252, 0, v229
MA 96,v,88,v,160
buffer_load_dwordx2 v[16:17], v252, s[84:87], 0 offen
MA 100,v,92,v,160
MA 160,v,96,v,160
buffer_load_dwordx4 v181, s[8:11], s20 offen offset:1024 lds
MA 164,v,100,v,160
v_add_u32 v253, 2048, v229
MA 224,v,104,v,160
MA 228,v,108,v,160
TR 160,200,49152
TR 162,200,51200
MA 40,v,80,v,164
ds_read_b128 v[136:139], v193 offset:12288
buffer_load_dwordx2 v[18:19], v253, s[84:87], 0 offen
MA 44,v,84,v,164
buffer_load_dwordx4 v182, s[8:11], s20 offen offset:2048 lds
MA 104,v,88,v,164
MA 108,v,92,v,164
v_add_u32 v254, 4096, v229
MA 168,v,96,v,164
MA 172,v,100,v,164
ds_read_b128 v[140:143], v193 offset:14336
MA 232,v,104,v,164
buffer_load_dwordx4 v183, s[8:11], s20 offen offset:3072 lds
buffer_load_dwordx2 v[20:21], v254, s[84:87], 0 offen
MA 236,v,108,v,164
TR 164,201,49152
TR 166,201,51200
MA 48,v,80,v,168
MA 52,v,84,v,168
v_add_u32 v255, 6144, v229
MA 112,v,88,v,168
MA 116,v,92,v,168
s_add_u32 s20, s20, 128
MA 176,v,96,v,168
buffer_load_dwordx2 v[22:23], v255, s[84:87], 0 offen
MA 180,v,100,v,168
MA 240,v,104,v,168
MA 244,v,108,v,168
TR 168,202,49152
TR 170,202,51200
s_waitcnt lgkmcnt(15)
MA 56,v,80,v,172
s_and_b32 s20, s20, 1023
buffer_load_dwordx2 v[38:39], v255, s[88:91], 0 offen
MA 60,v,84,v,172
MA 120,v,88,v,172
v_add_u32 v252, 8192, v229
MA 124,v,92,v,172
MA 184,v,96,v,172
MA 188,v,100,v,172
MA 248,v,104,v,172
MA 252,v,108,v,172
TR 172,203,49152
TR 174,203,51200
s_waitcnt lgkmcnt(2)
MA 0,v,112,v,144
MA 4,v,116,v,144
MA 64,v,120,v,144
MA 68,v,124,v,144
MA 128,v,128,v,144
MA 132,v,132,v,144
MA 192,v,136,v,144
MA 196,v,140,v,144
MA 8,v,112,v,148
MA 12,v,116,v,148
s_waitcnt vmcnt(23) lgkmcnt(0)
s_barrier
MA 72,v,120,v,148
TR 144,196,0
TR 146,196,2048
MA 76,v,124,v,148
ds_read_b128 v[80:83], v192 offset:32768
s_add_u32 m0, s23, 32768
MA 136,v,128,v,148
MA 140,v,132,v,148
MA 200,v,136,v,148
buffer_load_dwordx4 v184, s[12:15], s21 offen offset:0 lds
MA 204,v,140,v,148
TR 148,197,0
TR 150,197,2048
MA 16,v,112,v,152
ds_read_b128 v[84:87], v192 offset:34816
MA 20,v,116,v,152
MA 80,v,120,v,152
buffer_load_dwordx4 v185, s[12:15], s21 offen offset:1024 lds
MA 84,v,124,v,152
MA 144,v,128,v,152
MA 148,v,132,v,152
ds_read_b128 v[88:91], v192 offset:36864
MA 208,v,136,v,152
MA 212,v,140,v,152
TR 152,198,0
TR 154,198,2048
MA 24,v,112,v,156
buffer_load_dwordx4 v186, s[12:15], s21 offen offset:2048 lds
MA 28,v,116,v,156
MA 88,v,120,v,156
ds_read_b128 v[92:95], v192 offset:38912
MA 92,v,124,v,156
buffer_load_dwordx4 v187, s[12:15], s21 offen offset:3072 lds
MA 152,v,128,v,156
MA 156,v,132,v,156
MA 216,v,136,v,156
MA 220,v,140,v,156
TR 156,199,0
TR 158,199,2048
MA 32,v,112,v,160
ds_read_b128 v[96:99], v192 offset:40960
s_add_u32 m0, s23, 36864
MA 36,v,116,v,160
MA 96,v,120,v,160
MA 100,v,124,v,160
MA 160,v,128,v,160
ds_read_b128 v[100:103], v192 offset:43008
buffer_load_dwordx4 v188, s[12:15], s21 offen offset:0 lds
MA 164,v,132,v,160
MA 224,v,136,v,160
MA 228,v,140,v,160
TR 160,200,0
TR 162,200,2048
MA 40,v,112,v,164
buffer_load_dwordx4 v189, s[12:15], s21 offen offset:1024 lds
MA 44,v,116,v,164
ds_read_b128 v[104:107], v192 offset:45056
MA 104,v,120,v,164
MA 108,v,124,v,164
MA 168,v,128,v,164
buffer_load_dwordx4 v190, s[12:15], s21 offen offset:2048 lds
MA 172,v,132,v,164
MA 232,v,136,v,164
ds_read_b128 v[108:111], v192 offset:47104
MA 236,v,140,v,164
TR 164,201,0
TR 166,201,2048
MA 48,v,112,v,168
MA 52,v,116,v,168
buffer_load_dwordx4 v191, s[12:15], s21 offen offset:3072 lds
MA 112,v,120,v,168
MA 116,v,124,v,168
MA 176,v,128,v,168
MA 180,v,132,v,168
s_add_u32 s21, s21, 524288
MA 240,v,136,v,168
MA 244,v,140,v,168
TR 168,202,0
TR 170,202,2048
MA 56,v,112,v,172
MA 60,v,116,v,172
s_and_b32 s21, s21, 4194303
MA 120,v,120,v,172
MA 124,v,124,v,172
MA 184,v,128,v,172
MA 188,v,132,v,172
MA 248,v,136,v,172
MA 252,v,140,v,172
TR 172,203,0
TR 174,203,2048
s_waitcnt lgkmcnt(2)
MA 0,v,80,v,144
s_add_u32 m0, s22, 0
buffer_load_dwordx2 v[24:25], v252, s[84:87], 0 offen
MA 4,v,84,v,144
ds_read_b128 v[112:115], v193 offset:32768
MA 64,v,88,v,144
MA 68,v,92,v,144
buffer_load_dwordx2 v[40:41], v252, s[88:91], 0 offen
MA 128,v,96,v,144
MA 132,v,100,v,144
buffer_load_dwordx4 v176, s[8:11], s20 offen offset:0 lds
MA 192,v,104,v,144
v_add_u32 v253, 10240, v229
MA 196,v,108,v,144
TR 144,196,16384
TR 146,196,18432
MA 8,v,80,v,148
ds_read_b128 v[116:119], v193 offset:34816
MA 12,v,84,v,148
buffer_load_dwordx2 v[26:27], v253, s[84:87], 0 offen
MA 72,v,88,v,148
buffer_load_dwordx4 v177, s[8:11], s20 offen offset:1024 lds
MA 76,v,92,v,148
MA 136,v,96,v,148
buffer_load_dwordx2 v[42:43], v253, s[88:91], 0 offen
MA 140,v,100,v,148
ds_read_b128 v[120:123], v193 offset:36864
MA 200,v,104,v,148
MA 204,v,108,v,148
TR 148,197,16384
TR 150,197,18432
MA 16,v,80,v,152
buffer_load_dwordx4 v178, s[8:11], s20 offen offset:2048 lds
v_add_u32 v254, 12288, v229
MA 20,v,84,v,152
MA 80,v,88,v,152
buffer_load_dwordx2 v[28:29], v254, s[84:87], 0 offen
MA 84,v,92,v,152
MA 144,v,96,v,152
ds_read_b128 v[124:127], v193 offset:38912
buffer_load_dwordx4 v179, s[8:11], s20 offen offset:3072 lds
MA 148,v,100,v,152
buffer_load_dwordx2 v[44:45], v254, s[88:91], 0 offen
MA 208,v,104,v,152
MA 212,v,108,v,152
TR 152,198,16384
TR 154,198,18432
MA 24,v,80,v,156
v_add_u32 v255, 14336, v229
MA 28,v,84,v,156
s_add_u32 m0, s22, 4096
MA 88,v,88,v,156
ds_read_b128 v[128:131], v193 offset:40960
MA 92,v,92,v,156
buffer_load_dwordx2 v[30:31], v255, s[84:87], 0 offen
MA 152,v,96,v,156
MA 156,v,100,v,156
MA 216,v,104,v,156
MA 220,v,108,v,156
TR 156,199,16384
TR 158,199,18432
MA 32,v,80,v,160
ds_read_b128 v[132:135], v193 offset:43008
buffer_load_dwordx4 v180, s[8:11], s20 offen offset:0 lds
MA 36,v,84,v,160
buffer_load_dwordx2 v[46:47], v255, s[88:91], 0 offen
MA 96,v,88,v,160
v_add_u32 v252, 16384, v229
MA 100,v,92,v,160
MA 160,v,96,v,160
buffer_load_dwordx4 v181, s[8:11], s20 offen offset:1024 lds
MA 164,v,100,v,160
buffer_load_dwordx2 v[32:33], v252, s[84:87], 0 offen
MA 224,v,104,v,160
MA 228,v,108,v,160
TR 160,200,16384
TR 162,200,18432
MA 40,v,80,v,164
ds_read_b128 v[136:139], v193 offset:45056
buffer_load_dwordx2 v[48:49], v252, s[88:91], 0 offen
MA 44,v,84,v,164
buffer_load_dwordx4 v182, s[8:11], s20 offen offset:2048 lds
MA 104,v,88,v,164
MA 108,v,92,v,164
v_add_u32 v253, 18432, v229
MA 168,v,96,v,164
MA 172,v,100,v,164
ds_read_b128 v[140:143], v193 offset:47104
MA 232,v,104,v,164
buffer_load_dwordx4 v183, s[8:11], s20 offen offset:3072 lds
buffer_load_dwordx2 v[34:35], v253, s[84:87], 0 offen
MA 236,v,108,v,164
TR 164,201,16384
TR 166,201,18432
MA 48,v,80,v,168
MA 52,v,84,v,168
buffer_load_dwordx2 v[50:51], v253, s[88:91], 0 offen
MA 112,v,88,v,168
MA 116,v,92,v,168
s_add_u32 s20, s20, 128
MA 176,v,96,v,168
v_add_u32 v254, 20480, v229
MA 180,v,100,v,168
MA 240,v,104,v,168
MA 244,v,108,v,168
TR 168,202,16384
TR 170,202,18432
s_waitcnt lgkmcnt(15)
MA 56,v,80,v,172
s_and_b32 s20, s20, 1023
buffer_load_dwordx2 v[36:37], v254, s[84:87], 0 offen
MA 60,v,84,v,172
MA 120,v,88,v,172
buffer_load_dwordx2 v[52:53], v254, s[88:91], 0 offen
MA 124,v,92,v,172
MA 184,v,96,v,172
MA 188,v,100,v,172
MA 248,v,104,v,172
MA 252,v,108,v,172
TR 172,203,16384
TR 174,203,18432
s_waitcnt lgkmcnt(2)
MA 0,v,112,v,144
MA 4,v,116,v,144
MA 64,v,120,v,144
MA 68,v,124,v,144
MA 128,v,128,v,144
MA 132,v,132,v,144
MA 192,v,136,v,144
MA 196,v,140,v,144
MA 8,v,112,v,148
MA 12,v,116,v,148
s_waitcnt vmcnt(22) lgkmcnt(0)
s_barrier
MA 72,v,120,v,148
TR 144,196,32768
TR 146,196,34816
MA 76,v,124,v,148
ds_read_b128 v[80:83], v194 offset:0
s_add_u32 m0, s23, 0
MA 136,v,128,v,148
MA 140,v,132,v,148
MA 200,v,136,v,148
buffer_load_dwordx4 v184, s[12:15], s21 offen offset:0 lds
MA 204,v,140,v,148
TR 148,197,32768
TR 150,197,34816
MA 16,v,112,v,152
ds_read_b128 v[84:87], v194 offset:2048
MA 20,v,116,v,152
MA 80,v,120,v,152
buffer_load_dwordx4 v185, s[12:15], s21 offen offset:1024 lds
MA 84,v,124,v,152
MA 144,v,128,v,152
MA 148,v,132,v,152
ds_read_b128 v[88:91], v194 offset:4096
MA 208,v,136,v,152
MA 212,v,140,v,152
TR 152,198,32768
TR 154,198,34816
MA 24,v,112,v,156
buffer_load_dwordx4 v186, s[12:15], s21 offen offset:2048 lds
MA 28,v,116,v,156
MA 88,v,120,v,156
ds_read_b128 v[92:95], v194 offset:6144
MA 92,v,124,v,156
buffer_load_dwordx4 v187, s[12:15], s21 offen offset:3072 lds
MA 152,v,128,v,156
MA 156,v,132,v,156
MA 216,v,136,v,156
MA 220,v,140,v,156
TR 156,199,32768
TR 158,199,34816
MA 32,v,112,v,160
ds_read_b128 v[96:99], v194 offset:8192
s_add_u32 m0, s23, 4096
MA 36,v,116,v,160
MA 96,v,120,v,160
MA 100,v,124,v,160
MA 160,v,128,v,160
ds_read_b128 v[100:103], v194 offset:10240
buffer_load_dwordx4 v188, s[12:15], s21 offen offset:0 lds
MA 164,v,132,v,160
MA 224,v,136,v,160
MA 228,v,140,v,160
TR 160,200,32768
TR 162,200,34816
MA 40,v,112,v,164
buffer_load_dwordx4 v189, s[12:15], s21 offen offset:1024 lds
MA 44,v,116,v,164
ds_read_b128 v[104:107], v194 offset:12288
MA 104,v,120,v,164
MA 108,v,124,v,164
MA 168,v,128,v,164
buffer_load_dwordx4 v190, s[12:15], s21 offen offset:2048 lds
MA 172,v,132,v,164
MA 232,v,136,v,164
ds_read_b128 v[108:111], v194 offset:14336
MA 236,v,140,v,164
TR 164,201,32768
TR 166,201,34816
MA 48,v,112,v,168
MA 52,v,116,v,168
buffer_load_dwordx4 v191, s[12:15], s21 offen offset:3072 lds
MA 112,v,120,v,168
MA 116,v,124,v,168
MA 176,v,128,v,168
MA 180,v,132,v,168
s_add_u32 s21, s21, 524288
MA 240,v,136,v,168
MA 244,v,140,v,168
TR 168,202,32768
TR 170,202,34816
MA 56,v,112,v,172
MA 60,v,116,v,172
s_and_b32 s21, s21, 4194303
MA 120,v,120,v,172
MA 124,v,124,v,172
MA 184,v,128,v,172
MA 188,v,132,v,172
MA 248,v,136,v,172
MA 252,v,140,v,172
TR 172,203,32768
TR 174,203,34816
s_waitcnt lgkmcnt(2)
MA 0,v,80,v,144
s_add_u32 m0, s22, 32768
MA 4,v,84,v,144
ds_read_b128 v[112:115], v195 offset:0
MA 64,v,88,v,144
MA 68,v,92,v,144
MA 128,v,96,v,144
MA 132,v,100,v,144
buffer_load_dwordx4 v176, s[8:11], s20 offen offset:0 lds
MA 192,v,104,v,144
MA 196,v,108,v,144
TR 144,196,49152
TR 146,196,51200
MA 8,v,80,v,148
ds_read_b128 v[116:119], v195 offset:2048
MA 12,v,84,v,148
MA 72,v,88,v,148
buffer_load_dwordx4 v177, s[8:11], s20 offen offset:1024 lds
MA 76,v,92,v,148
MA 136,v,96,v,148
MA 140,v,100,v,148
ds_read_b128 v[120:123], v195 offset:4096
MA 200,v,104,v,148
MA 204,v,108,v,148
TR 148,197,49152
TR 150,197,51200
MA 16,v,80,v,152
buffer_load_dwordx4 v178, s[8:11], s20 offen offset:2048 lds
MA 20,v,84,v,152
MA 80,v,88,v,152
MA 84,v,92,v,152
MA 144,v,96,v,152
ds_read_b128 v[124:127], v195 offset:6144
buffer_load_dwordx4 v179, s[8:11], s20 offen offset:3072 lds
MA 148,v,100,v,152
MA 208,v,104,v,152
MA 212,v,108,v,152
TR 152,198,49152
TR 154,198,51200
MA 24,v,80,v,156
MA 28,v,84,v,156
s_add_u32 m0, s22, 36864
MA 88,v,88,v,156
ds_read_b128 v[128:131], v195 offset:8192
MA 92,v,92,v,156
MA 152,v,96,v,156
MA 156,v,100,v,156
MA 216,v,104,v,156
MA 220,v,108,v,156
TR 156,199,49152
TR 158,199,51200
MA 32,v,80,v,160
ds_read_b128 v[132:135], v195 offset:10240
buffer_load_dwordx4 v180, s[8:11], s20 offen offset:0 lds
MA 36,v,84,v,160
MA 96,v,88,v,160
MA 100,v,92,v,160
MA 160,v,96,v,160
buffer_load_dwordx4 v181, s[8:11], s20 offen offset:1024 lds
MA 164,v,100,v,160
MA 224,v,104,v,160
MA 228,v,108,v,160
TR 160,200,49152
TR 162,200,51200
MA 40,v,80,v,164
ds_read_b128 v[136:139], v195 offset:12288
MA 44,v,84,v,164
buffer_load_dwordx4 v182, s[8:11], s20 offen offset:2048 lds
MA 104,v,88,v,164
MA 108,v,92,v,164
MA 168,v,96,v,164
MA 172,v,100,v,164
ds_read_b128 v[140:143], v195 offset:14336
MA 232,v,104,v,164
buffer_load_dwordx4 v183, s[8:11], s20 offen offset:3072 lds
MA 236,v,108,v,164
TR 164,201,49152
TR 166,201,51200
MA 48,v,80,v,168
MA 52,v,84,v,168
MA 112,v,88,v,168
MA 116,v,92,v,168
s_add_u32 s20, s20, 128
MA 176,v,96,v,168
MA 180,v,100,v,168
MA 240,v,104,v,168
MA 244,v,108,v,168
TR 168,202,49152
TR 170,202,51200
s_waitcnt lgkmcnt(15)
MA 56,v,80,v,172
s_and_b32 s20, s20, 1023
MA 60,v,84,v,172
MA 120,v,88,v,172
MA 124,v,92,v,172
MA 184,v,96,v,172
MA 188,v,100,v,172
MA 248,v,104,v,172
MA 252,v,108,v,172
TR 172,203,49152
TR 174,203,51200
s_waitcnt lgkmcnt(2)
MA 0,v,112,v,144
MA 4,v,116,v,144
MA 64,v,120,v,144
MA 68,v,124,v,144
MA 128,v,128,v,144
MA 132,v,132,v,144
MA 192,v,136,v,144
MA 196,v,140,v,144
MA 8,v,112,v,148
MA 12,v,116,v,148
s_waitcnt vmcnt(8) lgkmcnt(0)
s_barrier
MA 72,v,120,v,148
TR 144,196,0
TR 146,196,2048
MA 76,v,124,v,148
ds_read_b128 v[80:83], v192 offset:0
s_add_u32 m0, s23, 32768
MA 136,v,128,v,148
s_add_u32 s84, s40, 50331648
s_addc_u32 s85, s41, 0
MA 140,v,132,v,148
s_mov_b32 s86, 4194304
s_mov_b32 s87, 0x20000
MA 200,v,136,v,148
buffer_load_dwordx4 v184, s[12:15], s21 offen offset:0 lds
MA 204,v,140,v,148
TR 148,197,0
TR 150,197,2048
MA 16,v,112,v,152
ds_read_b128 v[84:87], v192 offset:2048
MA 20,v,116,v,152
s_add_u32 s88, s40, 58720256
s_addc_u32 s89, s41, 0
MA 80,v,120,v,152
buffer_load_dwordx4 v185, s[12:15], s21 offen offset:1024 lds
s_mov_b32 s90, 8192
MA 84,v,124,v,152
s_mov_b32 s91, 0x20000
v_mov_b32 v252, 0
MA 144,v,128,v,152
v_mov_b32 v253, 0
v_dot2_f32_bf16 v252, v230, v2, v252
MA 148,v,132,v,152
ds_read_b128 v[88:91], v192 offset:4096
v_dot2_f32_bf16 v253, v231, v3, v253
MA 208,v,136,v,152
v_dot2_f32_bf16 v252, v232, v4, v252
v_dot2_f32_bf16 v253, v233, v5, v253
MA 212,v,140,v,152
TR 152,198,0
TR 154,198,2048
MA 24,v,112,v,156
buffer_load_dwordx4 v186, s[12:15], s21 offen offset:2048 lds
v_dot2_f32_bf16 v252, v234, v6, v252
MA 28,v,116,v,156
v_dot2_f32_bf16 v253, v235, v7, v253
v_dot2_f32_bf16 v252, v236, v8, v252
MA 88,v,120,v,156
ds_read_b128 v[92:95], v192 offset:6144
v_dot2_f32_bf16 v253, v237, v9, v253
MA 92,v,124,v,156
buffer_load_dwordx4 v187, s[12:15], s21 offen offset:3072 lds
v_dot2_f32_bf16 v252, v238, v12, v252
MA 152,v,128,v,156
v_dot2_f32_bf16 v253, v239, v13, v253
v_dot2_f32_bf16 v252, v240, v14, v252
MA 156,v,132,v,156
v_dot2_f32_bf16 v253, v241, v15, v253
v_dot2_f32_bf16 v252, v242, v246, v252
MA 216,v,136,v,156
v_dot2_f32_bf16 v253, v243, v247, v253
v_dot2_f32_bf16 v252, v244, v248, v252
MA 220,v,140,v,156
TR 156,199,0
TR 158,199,2048
MA 32,v,112,v,160
ds_read_b128 v[96:99], v192 offset:8192
s_add_u32 m0, s23, 36864
MA 36,v,116,v,160
v_dot2_f32_bf16 v253, v245, v249, v253
MA 96,v,120,v,160
s_nop 2
v_add_f32 v252, v252, v253
MA 100,v,124,v,160
s_nop 0
v_add_f32_dpp v252, v252, v252 row_ror:8 row_mask:0xf bank_mask:0xf
s_nop 1
v_add_f32_dpp v252, v252, v252 row_ror:4 row_mask:0xf bank_mask:0xf
MA 160,v,128,v,160
ds_read_b128 v[100:103], v192 offset:10240
buffer_load_dwordx4 v188, s[12:15], s21 offen offset:0 lds
MA 164,v,132,v,160
v_add_f32_dpp v252, v252, v252 row_ror:2 row_mask:0xf bank_mask:0xf
s_nop 1
v_add_f32_dpp v252, v252, v252 row_ror:1 row_mask:0xf bank_mask:0xf
MA 224,v,136,v,160
v_mov_b32 v253, v252
s_nop 1
v_permlane16_swap_b32 v252, v253
MA 228,v,140,v,160
TR 160,200,0
TR 162,200,2048
MA 40,v,112,v,164
buffer_load_dwordx4 v189, s[12:15], s21 offen offset:1024 lds
v_add_f32 v252, v252, v253
MA 44,v,116,v,164
ds_read_b128 v[104:107], v192 offset:12288
v_mul_f32 v252, 0xbfb8aa3b, v252
MA 104,v,120,v,164
v_exp_f32 v252, v252
MA 108,v,124,v,164
v_add_f32 v252, 1.0, v252
MA 168,v,128,v,164
buffer_load_dwordx4 v190, s[12:15], s21 offen offset:2048 lds
MA 172,v,132,v,164
v_rcp_f32 v252, v252
MA 232,v,136,v,164
ds_read_b128 v[108:111], v192 offset:14336
MA 236,v,140,v,164
TR 164,201,0
TR 166,201,2048
MA 48,v,112,v,168
s_nop 0
buffer_store_dword v252, v11, s[88:91], 0 offen sc1
MA 52,v,116,v,168
buffer_load_dwordx4 v191, s[12:15], s21 offen offset:3072 lds
v_lshlrev_b32 v2, 16, v54
MA 112,v,120,v,168
v_and_b32 v3, 0xffff0000, v54
v_lshlrev_b32 v4, 16, v55
MA 116,v,124,v,168
v_and_b32 v5, 0xffff0000, v55
v_lshlrev_b32 v6, 16, v56
MA 176,v,128,v,168
v_and_b32 v7, 0xffff0000, v56
v_lshlrev_b32 v8, 16, v57
MA 180,v,132,v,168
s_add_u32 s21, s21, 524288
v_and_b32 v9, 0xffff0000, v57
MA 240,v,136,v,168
v_lshlrev_b32 v230, 16, v16
v_and_b32 v231, 0xffff0000, v16
MA 244,v,140,v,168
TR 168,202,0
TR 170,202,2048
MA 56,v,112,v,172
v_lshlrev_b32 v232, 16, v18
v_and_b32 v233, 0xffff0000, v18
MA 60,v,116,v,172
s_and_b32 s21, s21, 4194303
v_lshlrev_b32 v234, 16, v20
MA 120,v,120,v,172
v_and_b32 v235, 0xffff0000, v20
v_lshlrev_b32 v236, 16, v22
MA 124,v,124,v,172
v_and_b32 v237, 0xffff0000, v22
v_lshlrev_b32 v238, 16, v24
MA 184,v,128,v,172
v_and_b32 v239, 0xffff0000, v24
v_lshlrev_b32 v240, 16, v26
MA 188,v,132,v,172
v_and_b32 v241, 0xffff0000, v26
v_lshlrev_b32 v242, 16, v28
MA 248,v,136,v,172
v_and_b32 v243, 0xffff0000, v28
v_lshlrev_b32 v244, 16, v30
MA 252,v,140,v,172
TR 172,203,0
TR 174,203,2048
v_and_b32 v245, 0xffff0000, v30
v_lshlrev_b32 v246, 16, v32
v_and_b32 v247, 0xffff0000, v32
v_lshlrev_b32 v248, 16, v34
v_and_b32 v249, 0xffff0000, v34
v_lshlrev_b32 v250, 16, v36
v_and_b32 v251, 0xffff0000, v36
v_lshlrev_b32 v254, 16, v38
v_and_b32 v255, 0xffff0000, v38
v_mul_f32 v62, v236, v2
v_mul_f32 v70, v237, v6
v_fmac_f32 v62, v234, v3
v_fmac_f32 v70, v235, v7
v_fmac_f32 v62, v232, v4
v_fmac_f32 v70, v233, v8
v_fmac_f32 v62, v230, v5
v_fmac_f32 v70, v231, v9
v_mul_f32 v62, v62, v254
s_waitcnt lgkmcnt(2)
MA 0,v,80,v,144
s_add_u32 s75, s64, s74
v_mul_f32 v70, v70, v255
MA 4,v,84,v,144
ds_read_b128 v[112:115], v193 offset:0
v_lshlrev_b32 v254, 16, v40
MA 64,v,88,v,144
v_and_b32 v255, 0xffff0000, v40
v_mul_f32 v63, v238, v2
MA 68,v,92,v,144
v_mul_f32 v71, v239, v6
v_fmac_f32 v63, v236, v3
MA 128,v,96,v,144
s_add_u32 m0, s67, 65536
v_fmac_f32 v71, v237, v7
MA 132,v,100,v,144
v_fmac_f32 v63, v234, v4
MA 192,v,104,v,144
v_fmac_f32 v71, v235, v8
MA 196,v,108,v,144
TR 144,196,16384
TR 146,196,18432
MA 8,v,80,v,148
ds_read_b128 v[116:119], v193 offset:2048
buffer_load_dwordx4 v208, s[44:47], s75 offen offset:0 lds
MA 12,v,84,v,148
v_fmac_f32 v63, v232, v5
v_fmac_f32 v71, v233, v9
MA 72,v,88,v,148
v_mul_f32 v63, v63, v254
v_mul_f32 v71, v71, v255
MA 76,v,92,v,148
v_lshlrev_b32 v254, 16, v42
v_and_b32 v255, 0xffff0000, v42
MA 136,v,96,v,148
v_mul_f32 v64, v240, v2
v_mul_f32 v72, v241, v6
MA 140,v,100,v,148
ds_read_b128 v[120:123], v193 offset:4096
buffer_load_dwordx4 v209, s[44:47], s75 offen offset:1024 lds
MA 200,v,104,v,148
v_fmac_f32 v64, v238, v3
v_fmac_f32 v72, v239, v7
MA 204,v,108,v,148
TR 148,197,16384
TR 150,197,18432
MA 16,v,80,v,152
v_fmac_f32 v64, v236, v4
v_fmac_f32 v72, v237, v8
MA 20,v,84,v,152
buffer_load_dwordx4 v210, s[44:47], s75 offen offset:2048 lds
v_fmac_f32 v64, v234, v5
MA 80,v,88,v,152
v_fmac_f32 v72, v235, v9
v_mul_f32 v64, v64, v254
MA 84,v,92,v,152
v_mul_f32 v72, v72, v255
v_lshlrev_b32 v254, 16, v44
MA 144,v,96,v,152
ds_read_b128 v[124:127], v193 offset:6144
v_and_b32 v255, 0xffff0000, v44
MA 148,v,100,v,152
v_mul_f32 v65, v242, v2
MA 208,v,104,v,152
buffer_load_dwordx4 v211, s[44:47], s75 offen offset:3072 lds
v_mul_f32 v73, v243, v6
MA 212,v,108,v,152
TR 152,198,16384
TR 154,198,18432
MA 24,v,80,v,156
v_fmac_f32 v65, v240, v3
v_fmac_f32 v73, v241, v7
MA 28,v,84,v,156
v_fmac_f32 v65, v238, v4
v_fmac_f32 v73, v239, v8
MA 88,v,88,v,156
ds_read_b128 v[128:131], v193 offset:8192
s_add_u32 s75, s65, s74
MA 92,v,92,v,156
v_fmac_f32 v65, v236, v5
v_fmac_f32 v73, v237, v9
MA 152,v,96,v,156
v_mul_f32 v65, v65, v254
v_mul_f32 v73, v73, v255
MA 156,v,100,v,156
v_lshlrev_b32 v254, 16, v46
MA 216,v,104,v,156
v_and_b32 v255, 0xffff0000, v46
MA 220,v,108,v,156
TR 156,199,16384
TR 158,199,18432
MA 32,v,80,v,160
ds_read_b128 v[132:135], v193 offset:10240
s_add_u32 m0, s67, 69632
MA 36,v,84,v,160
v_mul_f32 v66, v244, v2
v_mul_f32 v74, v245, v6
MA 96,v,88,v,160
v_fmac_f32 v66, v242, v3
v_fmac_f32 v74, v243, v7
MA 100,v,92,v,160
buffer_load_dwordx4 v208, s[44:47], s75 offen offset:0 lds
v_fmac_f32 v66, v240, v4
MA 160,v,96,v,160
v_fmac_f32 v74, v241, v8
v_fmac_f32 v66, v238, v5
MA 164,v,100,v,160
v_fmac_f32 v74, v239, v9
v_mul_f32 v66, v66, v254
MA 224,v,104,v,160
v_mul_f32 v74, v74, v255
v_lshlrev_b32 v254, 16, v48
MA 228,v,108,v,160
TR 160,200,16384
TR 162,200,18432
MA 40,v,80,v,164
ds_read_b128 v[136:139], v193 offset:12288
buffer_load_dwordx4 v209, s[44:47], s75 offen offset:1024 lds
MA 44,v,84,v,164
v_and_b32 v255, 0xffff0000, v48
v_mul_f32 v67, v246, v2
MA 104,v,88,v,164
v_mul_f32 v75, v247, v6
v_fmac_f32 v67, v244, v3
MA 108,v,92,v,164
v_fmac_f32 v75, v245, v7
v_fmac_f32 v67, v242, v4
MA 168,v,96,v,164
buffer_load_dwordx4 v210, s[44:47], s75 offen offset:2048 lds
v_fmac_f32 v75, v243, v8
MA 172,v,100,v,164
ds_read_b128 v[140:143], v193 offset:14336
v_fmac_f32 v67, v240, v5
MA 232,v,104,v,164
v_fmac_f32 v75, v241, v9
v_mul_f32 v67, v67, v254
MA 236,v,108,v,164
TR 164,201,16384
TR 166,201,18432
MA 48,v,80,v,168
buffer_load_dwordx4 v211, s[44:47], s75 offen offset:3072 lds
v_mul_f32 v75, v75, v255
MA 52,v,84,v,168
v_lshlrev_b32 v254, 16, v50
v_and_b32 v255, 0xffff0000, v50
MA 112,v,88,v,168
v_mul_f32 v68, v248, v2
v_mul_f32 v76, v249, v6
MA 116,v,92,v,168
v_fmac_f32 v68, v246, v3
MA 176,v,96,v,168
v_fmac_f32 v76, v247, v7
MA 180,v,100,v,168
s_add_u32 s74, s74, 128
v_fmac_f32 v68, v244, v4
MA 240,v,104,v,168
v_fmac_f32 v76, v245, v8
v_fmac_f32 v68, v242, v5
MA 244,v,108,v,168
TR 168,202,16384
TR 170,202,18432
s_waitcnt lgkmcnt(15)
MA 56,v,80,v,172
v_fmac_f32 v76, v243, v9
v_mul_f32 v68, v68, v254
MA 60,v,84,v,172
s_and_b32 s74, s74, 2047
v_mul_f32 v76, v76, v255
MA 120,v,88,v,172
v_lshlrev_b32 v254, 16, v52
v_and_b32 v255, 0xffff0000, v52
MA 124,v,92,v,172
v_mul_f32 v69, v250, v2
MA 184,v,96,v,172
v_mul_f32 v77, v251, v6
MA 188,v,100,v,172
v_fmac_f32 v69, v248, v3
MA 248,v,104,v,172
MA 252,v,108,v,172
TR 172,203,16384
TR 174,203,18432
s_waitcnt lgkmcnt(2)
MA 0,v,112,v,144
MA 4,v,116,v,144
MA 64,v,120,v,144
MA 68,v,124,v,144
MA 128,v,128,v,144
MA 132,v,132,v,144
MA 192,v,136,v,144
MA 196,v,140,v,144
MA 8,v,112,v,148
MA 12,v,116,v,148
s_waitcnt vmcnt(8) lgkmcnt(0)
s_barrier
MA 72,v,120,v,148
TR 144,196,32768
TR 146,196,34816
MA 76,v,124,v,148
ds_read_b128 v[80:83], v192 offset:32768
s_add_u32 m0, s68, 98304
MA 136,v,128,v,148
v_fmac_f32 v77, v249, v7
v_fmac_f32 v69, v246, v4
MA 140,v,132,v,148
buffer_load_dwordx4 v212, s[48:51], s66 offen offset:0 lds
v_fmac_f32 v77, v247, v8
MA 200,v,136,v,148
v_fmac_f32 v69, v244, v5
v_fmac_f32 v77, v245, v9
MA 204,v,140,v,148
TR 148,197,32768
TR 150,197,34816
MA 16,v,112,v,152
ds_read_b128 v[84:87], v192 offset:34816
v_mul_f32 v69, v69, v254
MA 20,v,116,v,152
buffer_load_dwordx4 v213, s[48:51], s66 offen offset:1024 lds
v_mul_f32 v77, v77, v255
MA 80,v,120,v,152
v_cvt_pk_bf16_f32 v12, v69, v68
v_cvt_pk_bf16_f32 v13, v67, v66
MA 84,v,124,v,152
v_cvt_pk_bf16_f32 v14, v65, v64
v_cvt_pk_bf16_f32 v15, v63, v62
MA 144,v,128,v,152
s_mov_b32 s36, 0
buffer_store_dwordx4 v[12:15], v10, s[84:87], s36 offen sc1
MA 148,v,132,v,152
ds_read_b128 v[88:91], v192 offset:36864
buffer_load_dwordx4 v214, s[48:51], s66 offen offset:2048 lds
MA 208,v,136,v,152
v_cvt_pk_bf16_f32 v54, v77, v76
v_cvt_pk_bf16_f32 v55, v75, v74
MA 212,v,140,v,152
TR 152,198,32768
TR 154,198,34816
MA 24,v,112,v,156
buffer_load_dwordx4 v215, s[48:51], s66 offen offset:3072 lds
v_cvt_pk_bf16_f32 v56, v73, v72
MA 28,v,116,v,156
v_cvt_pk_bf16_f32 v57, v71, v70
s_mov_b32 s36, 4096
MA 88,v,120,v,156
ds_read_b128 v[92:95], v192 offset:38912
buffer_store_dwordx4 v[54:57], v10, s[84:87], s36 offen sc1
MA 92,v,124,v,156
v_lshlrev_b32 v2, 16, v58
v_and_b32 v3, 0xffff0000, v58
MA 152,v,128,v,156
s_add_u32 s66, s66, 524288
v_lshlrev_b32 v4, 16, v59
MA 156,v,132,v,156
v_and_b32 v5, 0xffff0000, v59
v_lshlrev_b32 v6, 16, v60
MA 216,v,136,v,156
v_and_b32 v7, 0xffff0000, v60
v_lshlrev_b32 v8, 16, v61
MA 220,v,140,v,156
TR 156,199,32768
TR 158,199,34816
MA 32,v,112,v,160
ds_read_b128 v[96:99], v192 offset:40960
s_and_b32 s66, s66, 8388607
MA 36,v,116,v,160
v_and_b32 v9, 0xffff0000, v61
v_lshlrev_b32 v230, 16, v17
MA 96,v,120,v,160
v_and_b32 v231, 0xffff0000, v17
v_lshlrev_b32 v232, 16, v19
MA 100,v,124,v,160
v_and_b32 v233, 0xffff0000, v19
v_lshlrev_b32 v234, 16, v21
MA 160,v,128,v,160
ds_read_b128 v[100:103], v192 offset:43008
s_add_u32 m0, s68, 114688
MA 164,v,132,v,160
v_and_b32 v235, 0xffff0000, v21
v_lshlrev_b32 v236, 16, v23
MA 224,v,136,v,160
v_and_b32 v237, 0xffff0000, v23
v_lshlrev_b32 v238, 16, v25
MA 228,v,140,v,160
TR 160,200,32768
TR 162,200,34816
MA 40,v,112,v,164
buffer_load_dwordx4 v212, s[48:51], s66 offen offset:0 lds
v_and_b32 v239, 0xffff0000, v25
MA 44,v,116,v,164
ds_read_b128 v[104:107], v192 offset:45056
v_lshlrev_b32 v240, 16, v27
MA 104,v,120,v,164
v_and_b32 v241, 0xffff0000, v27
v_lshlrev_b32 v242, 16, v29
MA 108,v,124,v,164
buffer_load_dwordx4 v213, s[48:51], s66 offen offset:1024 lds
v_and_b32 v243, 0xffff0000, v29
MA 168,v,128,v,164
v_lshlrev_b32 v244, 16, v31
v_and_b32 v245, 0xffff0000, v31
MA 172,v,132,v,164
v_lshlrev_b32 v246, 16, v33
v_and_b32 v247, 0xffff0000, v33
MA 232,v,136,v,164
ds_read_b128 v[108:111], v192 offset:47104
v_lshlrev_b32 v248, 16, v35
MA 236,v,140,v,164
TR 164,201,32768
TR 166,201,34816
MA 48,v,112,v,168
buffer_load_dwordx4 v214, s[48:51], s66 offen offset:2048 lds
v_and_b32 v249, 0xffff0000, v35
MA 52,v,116,v,168
v_lshlrev_b32 v250, 16, v37
v_and_b32 v251, 0xffff0000, v37
MA 112,v,120,v,168
buffer_load_dwordx4 v215, s[48:51], s66 offen offset:3072 lds
v_lshlrev_b32 v254, 16, v39
MA 116,v,124,v,168
v_and_b32 v255, 0xffff0000, v39
v_mul_f32 v62, v236, v2
MA 176,v,128,v,168
v_mul_f32 v70, v237, v6
v_fmac_f32 v62, v234, v3
MA 180,v,132,v,168
v_fmac_f32 v70, v235, v7
v_fmac_f32 v62, v232, v4
MA 240,v,136,v,168
s_add_u32 s66, s66, 524288
v_fmac_f32 v70, v233, v8
MA 244,v,140,v,168
TR 168,202,32768
TR 170,202,34816
MA 56,v,112,v,172
v_fmac_f32 v62, v230, v5
v_fmac_f32 v70, v231, v9
MA 60,v,116,v,172
v_mul_f32 v62, v62, v254
v_mul_f32 v70, v70, v255
MA 120,v,120,v,172
s_and_b32 s66, s66, 8388607
v_lshlrev_b32 v254, 16, v41
MA 124,v,124,v,172
v_and_b32 v255, 0xffff0000, v41
v_mul_f32 v63, v238, v2
MA 184,v,128,v,172
v_mul_f32 v71, v239, v6
v_fmac_f32 v63, v236, v3
MA 188,v,132,v,172
v_fmac_f32 v71, v237, v7
v_fmac_f32 v63, v234, v4
MA 248,v,136,v,172
v_fmac_f32 v71, v235, v8
v_fmac_f32 v63, v232, v5
MA 252,v,140,v,172
TR 172,203,32768
TR 174,203,34816
v_fmac_f32 v71, v233, v9
v_mul_f32 v63, v63, v254
v_mul_f32 v71, v71, v255
v_lshlrev_b32 v254, 16, v43
v_and_b32 v255, 0xffff0000, v43
v_mul_f32 v64, v240, v2
v_mul_f32 v72, v241, v6
v_fmac_f32 v64, v238, v3
s_waitcnt lgkmcnt(2)
MA 0,v,80,v,144
s_add_u32 s75, s64, s74
v_fmac_f32 v72, v239, v7
MA 4,v,84,v,144
ds_read_b128 v[112:115], v193 offset:32768
v_fmac_f32 v64, v236, v4
MA 64,v,88,v,144
v_fmac_f32 v72, v237, v8
v_fmac_f32 v64, v234, v5
MA 68,v,92,v,144
v_fmac_f32 v72, v235, v9
v_mul_f32 v64, v64, v254
MA 128,v,96,v,144
s_add_u32 m0, s67, 0
v_mul_f32 v72, v72, v255
MA 132,v,100,v,144
v_lshlrev_b32 v254, 16, v45
v_and_b32 v255, 0xffff0000, v45
MA 192,v,104,v,144
v_mul_f32 v65, v242, v2
MA 196,v,108,v,144
TR 144,196,49152
TR 146,196,51200
MA 8,v,80,v,148
ds_read_b128 v[116:119], v193 offset:34816
buffer_load_dwordx4 v208, s[44:47], s75 offen offset:0 lds
MA 12,v,84,v,148
v_mul_f32 v73, v243, v6
v_fmac_f32 v65, v240, v3
MA 72,v,88,v,148
v_fmac_f32 v73, v241, v7
v_fmac_f32 v65, v238, v4
MA 76,v,92,v,148
v_fmac_f32 v73, v239, v8
v_fmac_f32 v65, v236, v5
MA 136,v,96,v,148
v_fmac_f32 v73, v237, v9
v_mul_f32 v65, v65, v254
MA 140,v,100,v,148
ds_read_b128 v[120:123], v193 offset:36864
buffer_load_dwordx4 v209, s[44:47], s75 offen offset:1024 lds
MA 200,v,104,v,148
v_mul_f32 v73, v73, v255
v_lshlrev_b32 v254, 16, v47
MA 204,v,108,v,148
TR 148,197,49152
TR 150,197,51200
MA 16,v,80,v,152
v_and_b32 v255, 0xffff0000, v47
v_mul_f32 v66, v244, v2
MA 20,v,84,v,152
buffer_load_dwordx4 v210, s[44:47], s75 offen offset:2048 lds
v_mul_f32 v74, v245, v6
MA 80,v,88,v,152
v_fmac_f32 v66, v242, v3
v_fmac_f32 v74, v243, v7
MA 84,v,92,v,152
v_fmac_f32 v66, v240, v4
v_fmac_f32 v74, v241, v8
MA 144,v,96,v,152
ds_read_b128 v[124:127], v193 offset:38912
v_fmac_f32 v66, v238, v5
MA 148,v,100,v,152
v_fmac_f32 v74, v239, v9
v_mul_f32 v66, v66, v254
MA 208,v,104,v,152
buffer_load_dwordx4 v211, s[44:47], s75 offen offset:3072 lds
v_mul_f32 v74, v74, v255
MA 212,v,108,v,152
TR 152,198,49152
TR 154,198,51200
MA 24,v,80,v,156
v_lshlrev_b32 v254, 16, v49
v_and_b32 v255, 0xffff0000, v49
MA 28,v,84,v,156
v_mul_f32 v67, v246, v2
v_mul_f32 v75, v247, v6
MA 88,v,88,v,156
ds_read_b128 v[128:131], v193 offset:40960
s_add_u32 s75, s65, s74
MA 92,v,92,v,156
v_fmac_f32 v67, v244, v3
v_fmac_f32 v75, v245, v7
MA 152,v,96,v,156
v_fmac_f32 v67, v242, v4
v_fmac_f32 v75, v243, v8
MA 156,v,100,v,156
v_fmac_f32 v67, v240, v5
v_fmac_f32 v75, v241, v9
MA 216,v,104,v,156
v_mul_f32 v67, v67, v254
v_mul_f32 v75, v75, v255
MA 220,v,108,v,156
TR 156,199,49152
TR 158,199,51200
MA 32,v,80,v,160
ds_read_b128 v[132:135], v193 offset:43008
s_add_u32 m0, s67, 4096
MA 36,v,84,v,160
v_lshlrev_b32 v254, 16, v51
v_and_b32 v255, 0xffff0000, v51
MA 96,v,88,v,160
v_mul_f32 v68, v248, v2
v_mul_f32 v76, v249, v6
MA 100,v,92,v,160
buffer_load_dwordx4 v208, s[44:47], s75 offen offset:0 lds
v_fmac_f32 v68, v246, v3
MA 160,v,96,v,160
v_fmac_f32 v76, v247, v7
v_fmac_f32 v68, v244, v4
MA 164,v,100,v,160
v_fmac_f32 v76, v245, v8
v_fmac_f32 v68, v242, v5
MA 224,v,104,v,160
v_fmac_f32 v76, v243, v9
v_mul_f32 v68, v68, v254
MA 228,v,108,v,160
TR 160,200,49152
TR 162,200,51200
MA 40,v,80,v,164
ds_read_b128 v[136:139], v193 offset:45056
buffer_load_dwordx4 v209, s[44:47], s75 offen offset:1024 lds
MA 44,v,84,v,164
v_mul_f32 v76, v76, v255
v_lshlrev_b32 v254, 16, v53
MA 104,v,88,v,164
v_and_b32 v255, 0xffff0000, v53
v_mul_f32 v69, v250, v2
MA 108,v,92,v,164
v_mul_f32 v77, v251, v6
v_fmac_f32 v69, v248, v3
MA 168,v,96,v,164
buffer_load_dwordx4 v210, s[44:47], s75 offen offset:2048 lds
v_fmac_f32 v77, v249, v7
MA 172,v,100,v,164
ds_read_b128 v[140:143], v193 offset:47104
v_fmac_f32 v69, v246, v4
MA 232,v,104,v,164
v_fmac_f32 v77, v247, v8
v_fmac_f32 v69, v244, v5
MA 236,v,108,v,164
TR 164,201,49152
TR 166,201,51200
MA 48,v,80,v,168
buffer_load_dwordx4 v211, s[44:47], s75 offen offset:3072 lds
v_fmac_f32 v77, v245, v9
MA 52,v,84,v,168
v_mul_f32 v69, v69, v254
v_mul_f32 v77, v77, v255
MA 112,v,88,v,168
v_cvt_pk_bf16_f32 v230, v69, v68
v_cvt_pk_bf16_f32 v231, v67, v66
MA 116,v,92,v,168
v_cvt_pk_bf16_f32 v232, v65, v64
v_cvt_pk_bf16_f32 v233, v63, v62
MA 176,v,96,v,168
s_mov_b32 s36, 8192
buffer_store_dwordx4 v[230:233], v10, s[84:87], s36 offen sc1
MA 180,v,100,v,168
s_add_u32 s74, s74, 128
v_cvt_pk_bf16_f32 v234, v77, v76
MA 240,v,104,v,168
v_cvt_pk_bf16_f32 v235, v75, v74
v_cvt_pk_bf16_f32 v236, v73, v72
MA 244,v,108,v,168
TR 168,202,49152
TR 170,202,51200
s_waitcnt lgkmcnt(15)
MA 56,v,80,v,172
v_cvt_pk_bf16_f32 v237, v71, v70
s_mov_b32 s36, 12288
MA 60,v,84,v,172
s_and_b32 s74, s74, 2047
buffer_store_dwordx4 v[234:237], v10, s[84:87], s36 offen sc1
MA 120,v,88,v,172
v_lshrrev_b32 v230, 5, v1
v_lshlrev_b32 v230, 12, v230
MA 124,v,92,v,172
v_and_b32 v231, 15, v1
v_lshl_add_u32 v230, v231, 4, v230
MA 184,v,96,v,172
v_bfe_u32 v231, v1, 4, 1
MA 188,v,100,v,172
v_lshl_add_u32 v228, v231, 9, v230
MA 248,v,104,v,172
MA 252,v,108,v,172
TR 172,203,49152
TR 174,203,51200
s_waitcnt lgkmcnt(2)
MA 0,v,112,v,144
MA 4,v,116,v,144
MA 64,v,120,v,144
MA 68,v,124,v,144
MA 128,v,128,v,144
MA 132,v,132,v,144
MA 192,v,136,v,144
MA 196,v,140,v,144
MA 8,v,112,v,148
MA 12,v,116,v,148
s_waitcnt vmcnt(15) lgkmcnt(0)
s_barrier
MA 72,v,120,v,148
ds_read_b128 v[48:51], v226 offset:0
s_add_u32 m0, s68, 131072
MA 76,v,124,v,148
MA 136,v,128,v,148
ds_read_b128 v[52:55], v226 offset:2048
buffer_load_dwordx4 v212, s[48:51], s66 offen offset:0 lds
MA 140,v,132,v,148
MA 200,v,136,v,148
ds_read_b128 v[56:59], v226 offset:4096
buffer_load_dwordx4 v213, s[48:51], s66 offen offset:1024 lds
MA 204,v,140,v,148
MA 16,v,112,v,152
ds_read_b128 v[60:63], v226 offset:6144
MA 20,v,116,v,152
buffer_load_dwordx4 v214, s[48:51], s66 offen offset:2048 lds
MA 80,v,120,v,152
TR 16,216,0
MA 84,v,124,v,152
buffer_load_dwordx4 v215, s[48:51], s66 offen offset:3072 lds
MA 144,v,128,v,152
TR 18,216,1024
MA 148,v,132,v,152
MA 208,v,136,v,152
TR 20,217,0
s_add_u32 s66, s66, 524288
MA 212,v,140,v,152
MA 24,v,112,v,156
TR 22,217,1024
s_and_b32 s66, s66, 8388607
MA 28,v,116,v,156
MA 88,v,120,v,156
TR 24,218,0
MA 92,v,124,v,156
s_add_u32 s75, s64, s74
MA 152,v,128,v,156
TR 26,218,1024
MA 156,v,132,v,156
s_add_u32 m0, s67, 32768
MA 216,v,136,v,156
TR 28,219,0
MA 220,v,140,v,156
MA 32,v,112,v,160
TR 30,219,1024
buffer_load_dwordx4 v208, s[44:47], s75 offen offset:0 lds
MA 36,v,116,v,160
MA 96,v,120,v,160
TR 32,220,0
buffer_load_dwordx4 v209, s[44:47], s75 offen offset:1024 lds
MA 100,v,124,v,160
MA 160,v,128,v,160
TR 34,220,1024
MA 164,v,132,v,160
buffer_load_dwordx4 v210, s[44:47], s75 offen offset:2048 lds
MA 224,v,136,v,160
TR 36,221,0
MA 228,v,140,v,160
buffer_load_dwordx4 v211, s[44:47], s75 offen offset:3072 lds
MA 40,v,112,v,164
TR 38,221,1024
MA 44,v,116,v,164
MA 104,v,120,v,164
TR 40,222,0
s_add_u32 s75, s65, s74
MA 108,v,124,v,164
MA 168,v,128,v,164
TR 42,222,1024
s_add_u32 m0, s67, 36864
MA 172,v,132,v,164
MA 232,v,136,v,164
TR 44,223,0
MA 236,v,140,v,164
buffer_load_dwordx4 v208, s[44:47], s75 offen offset:0 lds
MA 48,v,112,v,168
TR 46,223,1024
MA 52,v,116,v,168
buffer_load_dwordx4 v209, s[44:47], s75 offen offset:1024 lds
MA 112,v,120,v,168
MA 116,v,124,v,168
MA 176,v,128,v,168
buffer_load_dwordx4 v210, s[44:47], s75 offen offset:2048 lds
MA 180,v,132,v,168
MA 240,v,136,v,168
buffer_load_dwordx4 v211, s[44:47], s75 offen offset:3072 lds
MA 244,v,140,v,168
MA 56,v,112,v,172
MA 60,v,116,v,172
s_add_u32 s74, s74, 128
MA 120,v,120,v,172
MA 124,v,124,v,172
s_and_b32 s74, s74, 2047
MA 184,v,128,v,172
MA 188,v,132,v,172
MA 248,v,136,v,172
MA 252,v,140,v,172
L_p2:
s_waitcnt lgkmcnt(4)
v_mfma_f32_16x16x32_bf16 v[80:83], v[16:19], v[48:51], 0
s_add_u32 s8, s40, 59768832
s_addc_u32 s9, s41, 0
v_mfma_f32_16x16x32_bf16 v[84:87], v[16:19], v[52:55], 0
ds_read_b128 v[64:67], v227 offset:0
v_mfma_f32_16x16x32_bf16 v[88:91], v[16:19], v[56:59], 0
s_mov_b32 s10, 4096
v_mfma_f32_16x16x32_bf16 v[92:95], v[16:19], v[60:63], 0
TR 16,216,8192
TR 18,216,9216
v_mfma_f32_16x16x32_bf16 v[96:99], v[20:23], v[48:51], 0
s_mov_b32 s11, 0x20000
s_mov_b32 s12, s38
v_mfma_f32_16x16x32_bf16 v[100:103], v[20:23], v[52:55], 0
s_mov_b32 s13, s39
v_mfma_f32_16x16x32_bf16 v[104:107], v[20:23], v[56:59], 0
ds_read_b128 v[68:71], v227 offset:2048
s_mov_b32 s14, 256
v_mfma_f32_16x16x32_bf16 v[108:111], v[20:23], v[60:63], 0
TR 20,217,8192
TR 22,217,9216
v_mfma_f32_16x16x32_bf16 v[112:115], v[24:27], v[48:51], 0
s_mov_b32 s15, 0x20000
v_accvgpr_read_b32 v234, a0
v_mfma_f32_16x16x32_bf16 v[116:119], v[24:27], v[52:55], 0
v_accvgpr_read_b32 v235, a1
v_mfma_f32_16x16x32_bf16 v[120:123], v[24:27], v[56:59], 0
v_accvgpr_read_b32 v236, a2
v_mfma_f32_16x16x32_bf16 v[124:127], v[24:27], v[60:63], 0
TR 24,218,8192
TR 26,218,9216
v_mfma_f32_16x16x32_bf16 v[128:131], v[28:31], v[48:51], 0
ds_read_b128 v[72:75], v227 offset:4096
v_accvgpr_read_b32 v237, a3
v_mfma_f32_16x16x32_bf16 v[132:135], v[28:31], v[52:55], 0
v_accvgpr_read_b32 v238, a4
v_accvgpr_read_b32 v239, a5
v_mfma_f32_16x16x32_bf16 v[136:139], v[28:31], v[56:59], 0
v_accvgpr_read_b32 v240, a6
v_mfma_f32_16x16x32_bf16 v[140:143], v[28:31], v[60:63], 0
TR 28,219,8192
TR 30,219,9216
v_mfma_f32_16x16x32_bf16 v[144:147], v[32:35], v[48:51], 0
v_accvgpr_read_b32 v241, a7
v_cvt_pk_bf16_f32 v230, v234, v235
v_mfma_f32_16x16x32_bf16 v[148:151], v[32:35], v[52:55], 0
v_cvt_pk_bf16_f32 v231, v236, v237
v_mfma_f32_16x16x32_bf16 v[152:155], v[32:35], v[56:59], 0
ds_read_b128 v[76:79], v227 offset:6144
v_cvt_pk_bf16_f32 v232, v238, v239
v_mfma_f32_16x16x32_bf16 v[156:159], v[32:35], v[60:63], 0
TR 32,220,8192
TR 34,220,9216
v_mfma_f32_16x16x32_bf16 v[160:163], v[36:39], v[48:51], 0
v_cvt_pk_bf16_f32 v233, v240, v241
buffer_store_dwordx4 v[230:233], v228, s[16:19], s24 offen sc1
v_mfma_f32_16x16x32_bf16 v[164:167], v[36:39], v[52:55], 0
v_accvgpr_read_b32 v246, a8
v_mfma_f32_16x16x32_bf16 v[168:171], v[36:39], v[56:59], 0
v_accvgpr_read_b32 v247, a9
v_mfma_f32_16x16x32_bf16 v[172:175], v[36:39], v[60:63], 0
TR 36,221,8192
TR 38,221,9216
s_waitcnt lgkmcnt(15)
v_mfma_f32_16x16x32_bf16 v[176:179], v[40:43], v[48:51], 0
v_accvgpr_read_b32 v248, a10
v_accvgpr_read_b32 v249, a11
v_mfma_f32_16x16x32_bf16 v[180:183], v[40:43], v[52:55], 0
v_accvgpr_read_b32 v250, a12
v_mfma_f32_16x16x32_bf16 v[184:187], v[40:43], v[56:59], 0
v_accvgpr_read_b32 v251, a13
v_mfma_f32_16x16x32_bf16 v[188:191], v[40:43], v[60:63], 0
TR 40,222,8192
TR 42,222,9216
v_mfma_f32_16x16x32_bf16 v[192:195], v[44:47], v[48:51], 0
v_accvgpr_read_b32 v252, a14
v_accvgpr_read_b32 v253, a15
v_mfma_f32_16x16x32_bf16 v[196:199], v[44:47], v[52:55], 0
v_cvt_pk_bf16_f32 v242, v246, v247
v_mfma_f32_16x16x32_bf16 v[200:203], v[44:47], v[56:59], 0
v_mfma_f32_16x16x32_bf16 v[204:207], v[44:47], v[60:63], 0
TR 44,223,8192
TR 46,223,9216
s_waitcnt lgkmcnt(4)
MV 80,v,16,v,64
v_cvt_pk_bf16_f32 v243, v248, v249
MV 84,v,16,v,68
v_cvt_pk_bf16_f32 v244, v250, v251
MV 88,v,16,v,72
v_cvt_pk_bf16_f32 v245, v252, v253
MV 92,v,16,v,76
MV 96,v,20,v,64
buffer_store_dwordx4 v[242:245], v228, s[16:19], s25 offen sc1
MV 100,v,20,v,68
v_accvgpr_read_b32 v234, a16
MV 104,v,20,v,72
v_accvgpr_read_b32 v235, a17
MV 108,v,20,v,76
s_waitcnt vmcnt(16) lgkmcnt(0)
s_barrier
MV 112,v,24,v,64
TR 16,216,16384
TR 18,216,17408
MV 116,v,24,v,68
ds_read_b128 v[48:51], v224 offset:0
s_add_u32 m0, s68, 98304
MV 120,v,24,v,72
TR 20,217,16384
TR 22,217,17408
MV 124,v,24,v,76
buffer_load_dwordx4 v212, s[48:51], s66 offen offset:0 lds
v_accvgpr_read_b32 v236, a18
MV 128,v,28,v,64
TR 24,218,16384
TR 26,218,17408
MV 132,v,28,v,68
ds_read_b128 v[52:55], v224 offset:2048
buffer_load_dwordx4 v213, s[48:51], s66 offen offset:1024 lds
MV 136,v,28,v,72
buffer_load_dwordx4 v214, s[48:51], s66 offen offset:2048 lds
v_accvgpr_read_b32 v237, a19
MV 140,v,28,v,76
TR 28,219,16384
TR 30,219,17408
MV 144,v,32,v,64
ds_read_b128 v[56:59], v224 offset:4096
v_accvgpr_read_b32 v238, a20
MV 148,v,32,v,68
buffer_load_dwordx4 v215, s[48:51], s66 offen offset:3072 lds
v_accvgpr_read_b32 v239, a21
MV 152,v,32,v,72
v_accvgpr_read_b32 v240, a22
v_accvgpr_read_b32 v241, a23
MV 156,v,32,v,76
TR 32,220,16384
TR 34,220,17408
MV 160,v,36,v,64
ds_read_b128 v[60:63], v224 offset:6144
s_add_u32 s66, s66, 524288
MV 164,v,36,v,68
s_and_b32 s66, s66, 8388607
v_cvt_pk_bf16_f32 v230, v234, v235
MV 168,v,36,v,72
v_cvt_pk_bf16_f32 v231, v236, v237
v_cvt_pk_bf16_f32 v232, v238, v239
MV 172,v,36,v,76
TR 36,221,16384
TR 38,221,17408
MV 176,v,40,v,64
s_add_u32 s75, s64, s74
v_cvt_pk_bf16_f32 v233, v240, v241
MV 180,v,40,v,68
buffer_store_dwordx4 v[230:233], v228, s[16:19], s26 offen sc1
v_accvgpr_read_b32 v246, a24
MV 184,v,40,v,72
s_add_u32 m0, s67, 65536
v_accvgpr_read_b32 v247, a25
MV 188,v,40,v,76
TR 40,222,16384
TR 42,222,17408
MV 192,v,44,v,64
buffer_load_dwordx4 v208, s[44:47], s75 offen offset:0 lds
v_accvgpr_read_b32 v248, a26
MV 196,v,44,v,68
v_accvgpr_read_b32 v249, a27
v_accvgpr_read_b32 v250, a28
MV 200,v,44,v,72
MV 204,v,44,v,76
TR 44,223,16384
TR 46,223,17408
s_waitcnt lgkmcnt(4)
MV 80,v,16,v,48
buffer_load_dwordx4 v209, s[44:47], s75 offen offset:1024 lds
v_accvgpr_read_b32 v251, a29
MV 84,v,16,v,52
ds_read_b128 v[64:67], v225 offset:0
v_accvgpr_read_b32 v252, a30
MV 88,v,16,v,56
buffer_load_dwordx4 v210, s[44:47], s75 offen offset:2048 lds
v_accvgpr_read_b32 v253, a31
MV 92,v,16,v,60
TR 16,216,24576
TR 18,216,25600
MV 96,v,20,v,48
v_cvt_pk_bf16_f32 v242, v246, v247
MV 100,v,20,v,52
buffer_load_dwordx4 v211, s[44:47], s75 offen offset:3072 lds
v_cvt_pk_bf16_f32 v243, v248, v249
MV 104,v,20,v,56
ds_read_b128 v[68:71], v225 offset:2048
v_cvt_pk_bf16_f32 v244, v250, v251
MV 108,v,20,v,60
TR 20,217,24576
TR 22,217,25600
MV 112,v,24,v,48
s_add_u32 s75, s65, s74
v_cvt_pk_bf16_f32 v245, v252, v253
MV 116,v,24,v,52
buffer_store_dwordx4 v[242:245], v228, s[16:19], s27 offen sc1
MV 120,v,24,v,56
v_accvgpr_read_b32 v234, a32
MV 124,v,24,v,60
TR 24,218,24576
TR 26,218,25600
MV 128,v,28,v,48
ds_read_b128 v[72:75], v225 offset:4096
s_add_u32 m0, s67, 69632
MV 132,v,28,v,52
v_accvgpr_read_b32 v235, a33
v_accvgpr_read_b32 v236, a34
MV 136,v,28,v,56
buffer_load_dwordx4 v208, s[44:47], s75 offen offset:0 lds
MV 140,v,28,v,60
TR 28,219,24576
TR 30,219,25600
MV 144,v,32,v,48
buffer_load_dwordx4 v209, s[44:47], s75 offen offset:1024 lds
v_accvgpr_read_b32 v237, a35
MV 148,v,32,v,52
v_accvgpr_read_b32 v238, a36
v_accvgpr_read_b32 v239, a37
MV 152,v,32,v,56
ds_read_b128 v[76:79], v225 offset:6144
MV 156,v,32,v,60
TR 32,220,24576
TR 34,220,25600
MV 160,v,36,v,48
buffer_load_dwordx4 v210, s[44:47], s75 offen offset:2048 lds
v_accvgpr_read_b32 v240, a38
MV 164,v,36,v,52
v_accvgpr_read_b32 v241, a39
v_cvt_pk_bf16_f32 v230, v234, v235
MV 168,v,36,v,56
buffer_load_dwordx4 v211, s[44:47], s75 offen offset:3072 lds
MV 172,v,36,v,60
TR 36,221,24576
TR 38,221,25600
s_waitcnt lgkmcnt(15)
MV 176,v,40,v,48
v_cvt_pk_bf16_f32 v231, v236, v237
v_cvt_pk_bf16_f32 v232, v238, v239
MV 180,v,40,v,52
s_add_u32 s74, s74, 128
v_cvt_pk_bf16_f32 v233, v240, v241
MV 184,v,40,v,56
MV 188,v,40,v,60
TR 40,222,24576
TR 42,222,25600
MV 192,v,44,v,48
s_and_b32 s74, s74, 2047
buffer_store_dwordx4 v[230:233], v228, s[16:19], s28 offen sc1
MV 196,v,44,v,52
v_accvgpr_read_b32 v246, a40
MV 200,v,44,v,56
MV 204,v,44,v,60
TR 44,223,24576
TR 46,223,25600
s_waitcnt lgkmcnt(4)
MV 80,v,16,v,64
v_accvgpr_read_b32 v247, a41
MV 84,v,16,v,68
v_accvgpr_read_b32 v248, a42
MV 88,v,16,v,72
v_accvgpr_read_b32 v249, a43
MV 92,v,16,v,76
MV 96,v,20,v,64
v_accvgpr_read_b32 v250, a44
MV 100,v,20,v,68
v_accvgpr_read_b32 v251, a45
MV 104,v,20,v,72
v_accvgpr_read_b32 v252, a46
MV 108,v,20,v,76
s_waitcnt vmcnt(17) lgkmcnt(0)
s_barrier
MV 112,v,24,v,64
TR 16,216,32768
TR 18,216,33792
MV 116,v,24,v,68
ds_read_b128 v[48:51], v224 offset:32768
s_add_u32 m0, s68, 114688
MV 120,v,24,v,72
TR 20,217,32768
TR 22,217,33792
MV 124,v,24,v,76
buffer_load_dwordx4 v212, s[48:51], s66 offen offset:0 lds
v_accvgpr_read_b32 v253, a47
MV 128,v,28,v,64
TR 24,218,32768
TR 26,218,33792
MV 132,v,28,v,68
ds_read_b128 v[52:55], v224 offset:34816
buffer_load_dwordx4 v213, s[48:51], s66 offen offset:1024 lds
MV 136,v,28,v,72
buffer_load_dwordx4 v214, s[48:51], s66 offen offset:2048 lds
v_cvt_pk_bf16_f32 v242, v246, v247
MV 140,v,28,v,76
TR 28,219,32768
TR 30,219,33792
MV 144,v,32,v,64
ds_read_b128 v[56:59], v224 offset:36864
v_cvt_pk_bf16_f32 v243, v248, v249
MV 148,v,32,v,68
buffer_load_dwordx4 v215, s[48:51], s66 offen offset:3072 lds
v_cvt_pk_bf16_f32 v244, v250, v251
MV 152,v,32,v,72
v_cvt_pk_bf16_f32 v245, v252, v253
buffer_store_dwordx4 v[242:245], v228, s[16:19], s29 offen sc1
MV 156,v,32,v,76
TR 32,220,32768
TR 34,220,33792
MV 160,v,36,v,64
ds_read_b128 v[60:63], v224 offset:38912
s_add_u32 s66, s66, 524288
MV 164,v,36,v,68
s_and_b32 s66, s66, 8388607
v_accvgpr_read_b32 v234, a48
MV 168,v,36,v,72
v_accvgpr_read_b32 v235, a49
v_accvgpr_read_b32 v236, a50
MV 172,v,36,v,76
TR 36,221,32768
TR 38,221,33792
MV 176,v,40,v,64
s_add_u32 s75, s64, s74
v_accvgpr_read_b32 v237, a51
MV 180,v,40,v,68
v_accvgpr_read_b32 v238, a52
v_accvgpr_read_b32 v239, a53
MV 184,v,40,v,72
s_add_u32 m0, s67, 0
v_accvgpr_read_b32 v240, a54
MV 188,v,40,v,76
TR 40,222,32768
TR 42,222,33792
MV 192,v,44,v,64
buffer_load_dwordx4 v208, s[44:47], s75 offen offset:0 lds
v_accvgpr_read_b32 v241, a55
MV 196,v,44,v,68
v_cvt_pk_bf16_f32 v230, v234, v235
v_cvt_pk_bf16_f32 v231, v236, v237
MV 200,v,44,v,72
MV 204,v,44,v,76
TR 44,223,32768
TR 46,223,33792
s_waitcnt lgkmcnt(4)
MV 80,v,16,v,48
buffer_load_dwordx4 v209, s[44:47], s75 offen offset:1024 lds
v_cvt_pk_bf16_f32 v232, v238, v239
MV 84,v,16,v,52
ds_read_b128 v[64:67], v225 offset:32768
v_cvt_pk_bf16_f32 v233, v240, v241
MV 88,v,16,v,56
buffer_load_dwordx4 v210, s[44:47], s75 offen offset:2048 lds
buffer_store_dwordx4 v[230:233], v228, s[16:19], s30 offen sc1
MV 92,v,16,v,60
TR 16,216,40960
TR 18,216,41984
MV 96,v,20,v,48
v_accvgpr_read_b32 v246, a56
MV 100,v,20,v,52
buffer_load_dwordx4 v211, s[44:47], s75 offen offset:3072 lds
v_accvgpr_read_b32 v247, a57
MV 104,v,20,v,56
ds_read_b128 v[68:71], v225 offset:34816
v_accvgpr_read_b32 v248, a58
MV 108,v,20,v,60
TR 20,217,40960
TR 22,217,41984
MV 112,v,24,v,48
s_add_u32 s75, s65, s74
v_accvgpr_read_b32 v249, a59
MV 116,v,24,v,52
v_accvgpr_read_b32 v250, a60
MV 120,v,24,v,56
v_accvgpr_read_b32 v251, a61
MV 124,v,24,v,60
TR 24,218,40960
TR 26,218,41984
MV 128,v,28,v,48
ds_read_b128 v[72:75], v225 offset:36864
s_add_u32 m0, s67, 4096
MV 132,v,28,v,52
v_accvgpr_read_b32 v252, a62
v_accvgpr_read_b32 v253, a63
MV 136,v,28,v,56
buffer_load_dwordx4 v208, s[44:47], s75 offen offset:0 lds
MV 140,v,28,v,60
TR 28,219,40960
TR 30,219,41984
MV 144,v,32,v,48
buffer_load_dwordx4 v209, s[44:47], s75 offen offset:1024 lds
v_cvt_pk_bf16_f32 v242, v246, v247
MV 148,v,32,v,52
v_cvt_pk_bf16_f32 v243, v248, v249
v_cvt_pk_bf16_f32 v244, v250, v251
MV 152,v,32,v,56
ds_read_b128 v[76:79], v225 offset:38912
MV 156,v,32,v,60
TR 32,220,40960
TR 34,220,41984
MV 160,v,36,v,48
buffer_load_dwordx4 v210, s[44:47], s75 offen offset:2048 lds
v_cvt_pk_bf16_f32 v245, v252, v253
MV 164,v,36,v,52
buffer_store_dwordx4 v[242:245], v228, s[16:19], s31 offen sc1
v_accvgpr_read_b32 v234, a64
MV 168,v,36,v,56
buffer_load_dwordx4 v211, s[44:47], s75 offen offset:3072 lds
MV 172,v,36,v,60
TR 36,221,40960
TR 38,221,41984
s_waitcnt lgkmcnt(15)
MV 176,v,40,v,48
v_accvgpr_read_b32 v235, a65
v_accvgpr_read_b32 v236, a66
MV 180,v,40,v,52
s_add_u32 s74, s74, 128
v_accvgpr_read_b32 v237, a67
MV 184,v,40,v,56
MV 188,v,40,v,60
TR 40,222,40960
TR 42,222,41984
MV 192,v,44,v,48
s_and_b32 s74, s74, 2047
v_accvgpr_read_b32 v238, a68
MV 196,v,44,v,52
v_accvgpr_read_b32 v239, a69
MV 200,v,44,v,56
MV 204,v,44,v,60
TR 44,223,40960
TR 46,223,41984
s_waitcnt lgkmcnt(4)
MV 80,v,16,v,64
v_accvgpr_read_b32 v240, a70
MV 84,v,16,v,68
v_accvgpr_read_b32 v241, a71
MV 88,v,16,v,72
v_cvt_pk_bf16_f32 v230, v234, v235
MV 92,v,16,v,76
MV 96,v,20,v,64
v_cvt_pk_bf16_f32 v231, v236, v237
MV 100,v,20,v,68
v_cvt_pk_bf16_f32 v232, v238, v239
MV 104,v,20,v,72
v_cvt_pk_bf16_f32 v233, v240, v241
MV 108,v,20,v,76
s_waitcnt vmcnt(16) lgkmcnt(0)
s_barrier
MV 112,v,24,v,64
TR 16,216,0
TR 18,216,1024
MV 116,v,24,v,68
ds_read_b128 v[48:51], v226 offset:0
s_add_u32 m0, s68, 131072
MV 120,v,24,v,72
TR 20,217,0
TR 22,217,1024
MV 124,v,24,v,76
buffer_load_dwordx4 v212, s[48:51], s66 offen offset:0 lds
s_add_u32 s36, s24, 8192
MV 128,v,28,v,64
TR 24,218,0
TR 26,218,1024
MV 132,v,28,v,68
ds_read_b128 v[52:55], v226 offset:2048
buffer_load_dwordx4 v213, s[48:51], s66 offen offset:1024 lds
MV 136,v,28,v,72
buffer_load_dwordx4 v214, s[48:51], s66 offen offset:2048 lds
buffer_store_dwordx4 v[230:233], v228, s[16:19], s36 offen sc1
MV 140,v,28,v,76
TR 28,219,0
TR 30,219,1024
MV 144,v,32,v,64
ds_read_b128 v[56:59], v226 offset:4096
v_accvgpr_read_b32 v246, a72
MV 148,v,32,v,68
buffer_load_dwordx4 v215, s[48:51], s66 offen offset:3072 lds
v_accvgpr_read_b32 v247, a73
MV 152,v,32,v,72
v_accvgpr_read_b32 v248, a74
v_accvgpr_read_b32 v249, a75
MV 156,v,32,v,76
TR 32,220,0
TR 34,220,1024
MV 160,v,36,v,64
ds_read_b128 v[60:63], v226 offset:6144
s_add_u32 s66, s66, 524288
MV 164,v,36,v,68
s_and_b32 s66, s66, 8388607
v_accvgpr_read_b32 v250, a76
MV 168,v,36,v,72
v_accvgpr_read_b32 v251, a77
v_accvgpr_read_b32 v252, a78
MV 172,v,36,v,76
TR 36,221,0
TR 38,221,1024
MV 176,v,40,v,64
s_add_u32 s75, s64, s74
v_accvgpr_read_b32 v253, a79
MV 180,v,40,v,68
v_cvt_pk_bf16_f32 v242, v246, v247
v_cvt_pk_bf16_f32 v243, v248, v249
MV 184,v,40,v,72
s_add_u32 m0, s67, 32768
v_cvt_pk_bf16_f32 v244, v250, v251
MV 188,v,40,v,76
TR 40,222,0
TR 42,222,1024
MV 192,v,44,v,64
buffer_load_dwordx4 v208, s[44:47], s75 offen offset:0 lds
v_cvt_pk_bf16_f32 v245, v252, v253
MV 196,v,44,v,68
s_add_u32 s36, s25, 8192
buffer_store_dwordx4 v[242:245], v228, s[16:19], s36 offen sc1
MV 200,v,44,v,72
MV 204,v,44,v,76
TR 44,223,0
TR 46,223,1024
s_waitcnt lgkmcnt(4)
MV 80,v,16,v,48
buffer_load_dwordx4 v209, s[44:47], s75 offen offset:1024 lds
v_accvgpr_read_b32 v234, a80
MV 84,v,16,v,52
ds_read_b128 v[64:67], v227 offset:0
v_accvgpr_read_b32 v235, a81
MV 88,v,16,v,56
buffer_load_dwordx4 v210, s[44:47], s75 offen offset:2048 lds
v_accvgpr_read_b32 v236, a82
MV 92,v,16,v,60
TR 16,216,8192
TR 18,216,9216
MV 96,v,20,v,48
v_accvgpr_read_b32 v237, a83
MV 100,v,20,v,52
buffer_load_dwordx4 v211, s[44:47], s75 offen offset:3072 lds
v_accvgpr_read_b32 v238, a84
MV 104,v,20,v,56
ds_read_b128 v[68:71], v227 offset:2048
v_accvgpr_read_b32 v239, a85
MV 108,v,20,v,60
TR 20,217,8192
TR 22,217,9216
MV 112,v,24,v,48
s_add_u32 s75, s65, s74
v_accvgpr_read_b32 v240, a86
MV 116,v,24,v,52
v_accvgpr_read_b32 v241, a87
MV 120,v,24,v,56
v_cvt_pk_bf16_f32 v230, v234, v235
MV 124,v,24,v,60
TR 24,218,8192
TR 26,218,9216
MV 128,v,28,v,48
ds_read_b128 v[72:75], v227 offset:4096
s_add_u32 m0, s67, 36864
MV 132,v,28,v,52
v_cvt_pk_bf16_f32 v231, v236, v237
v_cvt_pk_bf16_f32 v232, v238, v239
MV 136,v,28,v,56
buffer_load_dwordx4 v208, s[44:47], s75 offen offset:0 lds
MV 140,v,28,v,60
TR 28,219,8192
TR 30,219,9216
MV 144,v,32,v,48
buffer_load_dwordx4 v209, s[44:47], s75 offen offset:1024 lds
v_cvt_pk_bf16_f32 v233, v240, v241
MV 148,v,32,v,52
s_add_u32 s36, s26, 8192
buffer_store_dwordx4 v[230:233], v228, s[16:19], s36 offen sc1
MV 152,v,32,v,56
ds_read_b128 v[76:79], v227 offset:6144
MV 156,v,32,v,60
TR 32,220,8192
TR 34,220,9216
MV 160,v,36,v,48
buffer_load_dwordx4 v210, s[44:47], s75 offen offset:2048 lds
v_accvgpr_read_b32 v246, a88
MV 164,v,36,v,52
v_accvgpr_read_b32 v247, a89
v_accvgpr_read_b32 v248, a90
MV 168,v,36,v,56
buffer_load_dwordx4 v211, s[44:47], s75 offen offset:3072 lds
MV 172,v,36,v,60
TR 36,221,8192
TR 38,221,9216
s_waitcnt lgkmcnt(15)
MV 176,v,40,v,48
v_accvgpr_read_b32 v249, a91
v_accvgpr_read_b32 v250, a92
MV 180,v,40,v,52
s_add_u32 s74, s74, 128
v_accvgpr_read_b32 v251, a93
MV 184,v,40,v,56
MV 188,v,40,v,60
TR 40,222,8192
TR 42,222,9216
MV 192,v,44,v,48
s_and_b32 s74, s74, 2047
v_accvgpr_read_b32 v252, a94
MV 196,v,44,v,52
v_accvgpr_read_b32 v253, a95
MV 200,v,44,v,56
MV 204,v,44,v,60
TR 44,223,8192
TR 46,223,9216
s_waitcnt lgkmcnt(4)
MV 80,v,16,v,64
v_cvt_pk_bf16_f32 v242, v246, v247
MV 84,v,16,v,68
v_cvt_pk_bf16_f32 v243, v248, v249
MV 88,v,16,v,72
v_cvt_pk_bf16_f32 v244, v250, v251
MV 92,v,16,v,76
MV 96,v,20,v,64
v_cvt_pk_bf16_f32 v245, v252, v253
MV 100,v,20,v,68
s_add_u32 s36, s27, 8192
MV 104,v,20,v,72
buffer_store_dwordx4 v[242:245], v228, s[16:19], s36 offen sc1
MV 108,v,20,v,76
s_waitcnt vmcnt(16) lgkmcnt(0)
s_barrier
MV 112,v,24,v,64
TR 16,216,16384
TR 18,216,17408
MV 116,v,24,v,68
ds_read_b128 v[48:51], v224 offset:0
s_add_u32 m0, s68, 98304
MV 120,v,24,v,72
TR 20,217,16384
TR 22,217,17408
MV 124,v,24,v,76
buffer_load_dwordx4 v212, s[48:51], s66 offen offset:0 lds
v_accvgpr_read_b32 v234, a96
MV 128,v,28,v,64
TR 24,218,16384
TR 26,218,17408
MV 132,v,28,v,68
ds_read_b128 v[52:55], v224 offset:2048
buffer_load_dwordx4 v213, s[48:51], s66 offen offset:1024 lds
MV 136,v,28,v,72
buffer_load_dwordx4 v214, s[48:51], s66 offen offset:2048 lds
v_accvgpr_read_b32 v235, a97
MV 140,v,28,v,76
TR 28,219,16384
TR 30,219,17408
MV 144,v,32,v,64
ds_read_b128 v[56:59], v224 offset:4096
v_accvgpr_read_b32 v236, a98
MV 148,v,32,v,68
buffer_load_dwordx4 v215, s[48:51], s66 offen offset:3072 lds
v_accvgpr_read_b32 v237, a99
MV 152,v,32,v,72
v_accvgpr_read_b32 v238, a100
v_accvgpr_read_b32 v239, a101
MV 156,v,32,v,76
TR 32,220,16384
TR 34,220,17408
MV 160,v,36,v,64
ds_read_b128 v[60:63], v224 offset:6144
s_add_u32 s66, s66, 524288
MV 164,v,36,v,68
s_and_b32 s66, s66, 8388607
v_accvgpr_read_b32 v240, a102
MV 168,v,36,v,72
v_accvgpr_read_b32 v241, a103
v_cvt_pk_bf16_f32 v230, v234, v235
MV 172,v,36,v,76
TR 36,221,16384
TR 38,221,17408
MV 176,v,40,v,64
s_add_u32 s75, s64, s74
v_cvt_pk_bf16_f32 v231, v236, v237
MV 180,v,40,v,68
v_cvt_pk_bf16_f32 v232, v238, v239
v_cvt_pk_bf16_f32 v233, v240, v241
MV 184,v,40,v,72
s_add_u32 m0, s67, 65536
s_add_u32 s36, s28, 8192
MV 188,v,40,v,76
TR 40,222,16384
TR 42,222,17408
MV 192,v,44,v,64
buffer_load_dwordx4 v208, s[44:47], s75 offen offset:0 lds
buffer_store_dwordx4 v[230:233], v228, s[16:19], s36 offen sc1
MV 196,v,44,v,68
v_accvgpr_read_b32 v246, a104
v_accvgpr_read_b32 v247, a105
MV 200,v,44,v,72
MV 204,v,44,v,76
TR 44,223,16384
TR 46,223,17408
s_waitcnt lgkmcnt(4)
MV 80,v,16,v,48
buffer_load_dwordx4 v209, s[44:47], s75 offen offset:1024 lds
v_accvgpr_read_b32 v248, a106
MV 84,v,16,v,52
ds_read_b128 v[64:67], v225 offset:0
v_accvgpr_read_b32 v249, a107
MV 88,v,16,v,56
buffer_load_dwordx4 v210, s[44:47], s75 offen offset:2048 lds
v_accvgpr_read_b32 v250, a108
MV 92,v,16,v,60
TR 16,216,24576
TR 18,216,25600
MV 96,v,20,v,48
v_accvgpr_read_b32 v251, a109
MV 100,v,20,v,52
buffer_load_dwordx4 v211, s[44:47], s75 offen offset:3072 lds
v_accvgpr_read_b32 v252, a110
MV 104,v,20,v,56
ds_read_b128 v[68:71], v225 offset:2048
v_accvgpr_read_b32 v253, a111
MV 108,v,20,v,60
TR 20,217,24576
TR 22,217,25600
MV 112,v,24,v,48
s_add_u32 s75, s65, s74
v_cvt_pk_bf16_f32 v242, v246, v247
MV 116,v,24,v,52
v_cvt_pk_bf16_f32 v243, v248, v249
MV 120,v,24,v,56
v_cvt_pk_bf16_f32 v244, v250, v251
MV 124,v,24,v,60
TR 24,218,24576
TR 26,218,25600
MV 128,v,28,v,48
ds_read_b128 v[72:75], v225 offset:4096
s_add_u32 m0, s67, 69632
MV 132,v,28,v,52
v_cvt_pk_bf16_f32 v245, v252, v253
s_add_u32 s36, s29, 8192
MV 136,v,28,v,56
buffer_load_dwordx4 v208, s[44:47], s75 offen offset:0 lds
MV 140,v,28,v,60
TR 28,219,24576
TR 30,219,25600
MV 144,v,32,v,48
buffer_load_dwordx4 v209, s[44:47], s75 offen offset:1024 lds
buffer_store_dwordx4 v[242:245], v228, s[16:19], s36 offen sc1
MV 148,v,32,v,52
v_accvgpr_read_b32 v234, a112
v_accvgpr_read_b32 v235, a113
MV 152,v,32,v,56
ds_read_b128 v[76:79], v225 offset:6144
MV 156,v,32,v,60
TR 32,220,24576
TR 34,220,25600
MV 160,v,36,v,48
buffer_load_dwordx4 v210, s[44:47], s75 offen offset:2048 lds
v_accvgpr_read_b32 v236, a114
MV 164,v,36,v,52
v_accvgpr_read_b32 v237, a115
v_accvgpr_read_b32 v238, a116
MV 168,v,36,v,56
buffer_load_dwordx4 v211, s[44:47], s75 offen offset:3072 lds
MV 172,v,36,v,60
TR 36,221,24576
TR 38,221,25600
s_waitcnt lgkmcnt(15)
MV 176,v,40,v,48
v_accvgpr_read_b32 v239, a117
v_accvgpr_read_b32 v240, a118
MV 180,v,40,v,52
s_add_u32 s74, s74, 128
v_accvgpr_read_b32 v241, a119
MV 184,v,40,v,56
MV 188,v,40,v,60
TR 40,222,24576
TR 42,222,25600
MV 192,v,44,v,48
s_and_b32 s74, s74, 2047
v_cvt_pk_bf16_f32 v230, v234, v235
MV 196,v,44,v,52
v_cvt_pk_bf16_f32 v231, v236, v237
MV 200,v,44,v,56
MV 204,v,44,v,60
TR 44,223,24576
TR 46,223,25600
s_waitcnt lgkmcnt(4)
MV 80,v,16,v,64
v_cvt_pk_bf16_f32 v232, v238, v239
MV 84,v,16,v,68
v_cvt_pk_bf16_f32 v233, v240, v241
MV 88,v,16,v,72
s_add_u32 s36, s30, 8192
MV 92,v,16,v,76
MV 96,v,20,v,64
buffer_store_dwordx4 v[230:233], v228, s[16:19], s36 offen sc1
MV 100,v,20,v,68
v_accvgpr_read_b32 v246, a120
MV 104,v,20,v,72
v_accvgpr_read_b32 v247, a121
MV 108,v,20,v,76
s_waitcnt vmcnt(16) lgkmcnt(0)
s_barrier
MV 112,v,24,v,64
TR 16,216,32768
TR 18,216,33792
MV 116,v,24,v,68
ds_read_b128 v[48:51], v224 offset:32768
s_add_u32 m0, s68, 114688
MV 120,v,24,v,72
TR 20,217,32768
TR 22,217,33792
MV 124,v,24,v,76
buffer_load_dwordx4 v212, s[48:51], s66 offen offset:0 lds
v_accvgpr_read_b32 v248, a122
MV 128,v,28,v,64
TR 24,218,32768
TR 26,218,33792
MV 132,v,28,v,68
ds_read_b128 v[52:55], v224 offset:34816
buffer_load_dwordx4 v213, s[48:51], s66 offen offset:1024 lds
MV 136,v,28,v,72
buffer_load_dwordx4 v214, s[48:51], s66 offen offset:2048 lds
v_accvgpr_read_b32 v249, a123
MV 140,v,28,v,76
TR 28,219,32768
TR 30,219,33792
MV 144,v,32,v,64
ds_read_b128 v[56:59], v224 offset:36864
v_accvgpr_read_b32 v250, a124
MV 148,v,32,v,68
buffer_load_dwordx4 v215, s[48:51], s66 offen offset:3072 lds
v_accvgpr_read_b32 v251, a125
MV 152,v,32,v,72
v_accvgpr_read_b32 v252, a126
v_accvgpr_read_b32 v253, a127
MV 156,v,32,v,76
TR 32,220,32768
TR 34,220,33792
MV 160,v,36,v,64
ds_read_b128 v[60:63], v224 offset:38912
s_add_u32 s66, s66, 524288
MV 164,v,36,v,68
s_and_b32 s66, s66, 8388607
v_cvt_pk_bf16_f32 v242, v246, v247
MV 168,v,36,v,72
v_cvt_pk_bf16_f32 v243, v248, v249
v_cvt_pk_bf16_f32 v244, v250, v251
MV 172,v,36,v,76
TR 36,221,32768
TR 38,221,33792
MV 176,v,40,v,64
s_add_u32 s75, s64, s74
v_cvt_pk_bf16_f32 v245, v252, v253
MV 180,v,40,v,68
s_add_u32 s36, s31, 8192
buffer_store_dwordx4 v[242:245], v228, s[16:19], s36 offen sc1
MV 184,v,40,v,72
s_add_u32 m0, s67, 0
v_accvgpr_read_b32 v234, a128
MV 188,v,40,v,76
TR 40,222,32768
TR 42,222,33792
MV 192,v,44,v,64
buffer_load_dwordx4 v208, s[44:47], s75 offen offset:0 lds
v_accvgpr_read_b32 v235, a129
MV 196,v,44,v,68
v_accvgpr_read_b32 v236, a130
v_accvgpr_read_b32 v237, a131
MV 200,v,44,v,72
MV 204,v,44,v,76
TR 44,223,32768
TR 46,223,33792
s_waitcnt lgkmcnt(4)
MV 80,v,16,v,48
buffer_load_dwordx4 v209, s[44:47], s75 offen offset:1024 lds
v_accvgpr_read_b32 v238, a132
MV 84,v,16,v,52
ds_read_b128 v[64:67], v225 offset:32768
v_accvgpr_read_b32 v239, a133
MV 88,v,16,v,56
buffer_load_dwordx4 v210, s[44:47], s75 offen offset:2048 lds
v_accvgpr_read_b32 v240, a134
MV 92,v,16,v,60
TR 16,216,40960
TR 18,216,41984
MV 96,v,20,v,48
v_accvgpr_read_b32 v241, a135
MV 100,v,20,v,52
buffer_load_dwordx4 v211, s[44:47], s75 offen offset:3072 lds
v_cvt_pk_bf16_f32 v230, v234, v235
MV 104,v,20,v,56
ds_read_b128 v[68:71], v225 offset:34816
v_cvt_pk_bf16_f32 v231, v236, v237
MV 108,v,20,v,60
TR 20,217,40960
TR 22,217,41984
MV 112,v,24,v,48
s_add_u32 s75, s65, s74
v_cvt_pk_bf16_f32 v232, v238, v239
MV 116,v,24,v,52
v_cvt_pk_bf16_f32 v233, v240, v241
MV 120,v,24,v,56
s_add_u32 s36, s24, 16384
MV 124,v,24,v,60
TR 24,218,40960
TR 26,218,41984
MV 128,v,28,v,48
ds_read_b128 v[72:75], v225 offset:36864
s_add_u32 m0, s67, 4096
MV 132,v,28,v,52
buffer_store_dwordx4 v[230:233], v228, s[16:19], s36 offen sc1
v_accvgpr_read_b32 v246, a136
MV 136,v,28,v,56
buffer_load_dwordx4 v208, s[44:47], s75 offen offset:0 lds
MV 140,v,28,v,60
TR 28,219,40960
TR 30,219,41984
MV 144,v,32,v,48
buffer_load_dwordx4 v209, s[44:47], s75 offen offset:1024 lds
v_accvgpr_read_b32 v247, a137
MV 148,v,32,v,52
v_accvgpr_read_b32 v248, a138
v_accvgpr_read_b32 v249, a139
MV 152,v,32,v,56
ds_read_b128 v[76:79], v225 offset:38912
MV 156,v,32,v,60
TR 32,220,40960
TR 34,220,41984
MV 160,v,36,v,48
buffer_load_dwordx4 v210, s[44:47], s75 offen offset:2048 lds
v_accvgpr_read_b32 v250, a140
MV 164,v,36,v,52
v_accvgpr_read_b32 v251, a141
v_accvgpr_read_b32 v252, a142
MV 168,v,36,v,56
buffer_load_dwordx4 v211, s[44:47], s75 offen offset:3072 lds
MV 172,v,36,v,60
TR 36,221,40960
TR 38,221,41984
s_waitcnt lgkmcnt(15)
MV 176,v,40,v,48
v_accvgpr_read_b32 v253, a143
v_cvt_pk_bf16_f32 v242, v246, v247
MV 180,v,40,v,52
s_add_u32 s74, s74, 128
v_cvt_pk_bf16_f32 v243, v248, v249
MV 184,v,40,v,56
MV 188,v,40,v,60
TR 40,222,40960
TR 42,222,41984
MV 192,v,44,v,48
s_and_b32 s74, s74, 2047
v_cvt_pk_bf16_f32 v244, v250, v251
MV 196,v,44,v,52
v_cvt_pk_bf16_f32 v245, v252, v253
MV 200,v,44,v,56
MV 204,v,44,v,60
TR 44,223,40960
TR 46,223,41984
s_waitcnt lgkmcnt(4)
MV 80,v,16,v,64
s_add_u32 s36, s25, 16384
MV 84,v,16,v,68
buffer_store_dwordx4 v[242:245], v228, s[16:19], s36 offen sc1
MV 88,v,16,v,72
v_accvgpr_read_b32 v234, a144
MV 92,v,16,v,76
MV 96,v,20,v,64
v_accvgpr_read_b32 v235, a145
MV 100,v,20,v,68
v_accvgpr_read_b32 v236, a146
MV 104,v,20,v,72
v_accvgpr_read_b32 v237, a147
MV 108,v,20,v,76
s_waitcnt vmcnt(16) lgkmcnt(0)
s_barrier
MV 112,v,24,v,64
TR 16,216,0
TR 18,216,1024
MV 116,v,24,v,68
ds_read_b128 v[48:51], v226 offset:0
s_add_u32 m0, s68, 131072
MV 120,v,24,v,72
TR 20,217,0
TR 22,217,1024
MV 124,v,24,v,76
buffer_load_dwordx4 v212, s[48:51], s66 offen offset:0 lds
v_accvgpr_read_b32 v238, a148
MV 128,v,28,v,64
TR 24,218,0
TR 26,218,1024
MV 132,v,28,v,68
ds_read_b128 v[52:55], v226 offset:2048
buffer_load_dwordx4 v213, s[48:51], s66 offen offset:1024 lds
MV 136,v,28,v,72
buffer_load_dwordx4 v214, s[48:51], s66 offen offset:2048 lds
v_accvgpr_read_b32 v239, a149
MV 140,v,28,v,76
TR 28,219,0
TR 30,219,1024
MV 144,v,32,v,64
ds_read_b128 v[56:59], v226 offset:4096
v_accvgpr_read_b32 v240, a150
MV 148,v,32,v,68
buffer_load_dwordx4 v215, s[48:51], s66 offen offset:3072 lds
v_accvgpr_read_b32 v241, a151
MV 152,v,32,v,72
v_cvt_pk_bf16_f32 v230, v234, v235
v_cvt_pk_bf16_f32 v231, v236, v237
MV 156,v,32,v,76
TR 32,220,0
TR 34,220,1024
MV 160,v,36,v,64
ds_read_b128 v[60:63], v226 offset:6144
s_add_u32 s66, s66, 524288
MV 164,v,36,v,68
s_and_b32 s66, s66, 8388607
v_cvt_pk_bf16_f32 v232, v238, v239
MV 168,v,36,v,72
v_cvt_pk_bf16_f32 v233, v240, v241
s_add_u32 s36, s26, 16384
MV 172,v,36,v,76
TR 36,221,0
TR 38,221,1024
MV 176,v,40,v,64
s_add_u32 s75, s64, s74
buffer_store_dwordx4 v[230:233], v228, s[16:19], s36 offen sc1
MV 180,v,40,v,68
v_accvgpr_read_b32 v246, a152
v_accvgpr_read_b32 v247, a153
MV 184,v,40,v,72
s_add_u32 m0, s67, 32768
v_accvgpr_read_b32 v248, a154
MV 188,v,40,v,76
TR 40,222,0
TR 42,222,1024
MV 192,v,44,v,64
buffer_load_dwordx4 v208, s[44:47], s75 offen offset:0 lds
v_accvgpr_read_b32 v249, a155
MV 196,v,44,v,68
v_accvgpr_read_b32 v250, a156
v_accvgpr_read_b32 v251, a157
MV 200,v,44,v,72
MV 204,v,44,v,76
TR 44,223,0
TR 46,223,1024
s_waitcnt lgkmcnt(4)
MV 80,v,16,v,48
buffer_load_dwordx4 v209, s[44:47], s75 offen offset:1024 lds
v_accvgpr_read_b32 v252, a158
MV 84,v,16,v,52
ds_read_b128 v[64:67], v227 offset:0
v_accvgpr_read_b32 v253, a159
MV 88,v,16,v,56
buffer_load_dwordx4 v210, s[44:47], s75 offen offset:2048 lds
v_cvt_pk_bf16_f32 v242, v246, v247
MV 92,v,16,v,60
TR 16,216,8192
TR 18,216,9216
MV 96,v,20,v,48
v_cvt_pk_bf16_f32 v243, v248, v249
MV 100,v,20,v,52
buffer_load_dwordx4 v211, s[44:47], s75 offen offset:3072 lds
v_cvt_pk_bf16_f32 v244, v250, v251
MV 104,v,20,v,56
ds_read_b128 v[68:71], v227 offset:2048
v_cvt_pk_bf16_f32 v245, v252, v253
MV 108,v,20,v,60
TR 20,217,8192
TR 22,217,9216
MV 112,v,24,v,48
s_add_u32 s75, s65, s74
s_add_u32 s36, s27, 16384
MV 116,v,24,v,52
buffer_store_dwordx4 v[242:245], v228, s[16:19], s36 offen sc1
MV 120,v,24,v,56
v_accvgpr_read_b32 v234, a160
MV 124,v,24,v,60
TR 24,218,8192
TR 26,218,9216
MV 128,v,28,v,48
ds_read_b128 v[72:75], v227 offset:4096
s_add_u32 m0, s67, 36864
MV 132,v,28,v,52
v_accvgpr_read_b32 v235, a161
v_accvgpr_read_b32 v236, a162
MV 136,v,28,v,56
buffer_load_dwordx4 v208, s[44:47], s75 offen offset:0 lds
MV 140,v,28,v,60
TR 28,219,8192
TR 30,219,9216
MV 144,v,32,v,48
buffer_load_dwordx4 v209, s[44:47], s75 offen offset:1024 lds
v_accvgpr_read_b32 v237, a163
MV 148,v,32,v,52
v_accvgpr_read_b32 v238, a164
v_accvgpr_read_b32 v239, a165
MV 152,v,32,v,56
ds_read_b128 v[76:79], v227 offset:6144
MV 156,v,32,v,60
TR 32,220,8192
TR 34,220,9216
MV 160,v,36,v,48
buffer_load_dwordx4 v210, s[44:47], s75 offen offset:2048 lds
v_accvgpr_read_b32 v240, a166
MV 164,v,36,v,52
v_accvgpr_read_b32 v241, a167
v_cvt_pk_bf16_f32 v230, v234, v235
MV 168,v,36,v,56
buffer_load_dwordx4 v211, s[44:47], s75 offen offset:3072 lds
MV 172,v,36,v,60
TR 36,221,8192
TR 38,221,9216
s_waitcnt lgkmcnt(15)
MV 176,v,40,v,48
v_cvt_pk_bf16_f32 v231, v236, v237
v_cvt_pk_bf16_f32 v232, v238, v239
MV 180,v,40,v,52
s_add_u32 s74, s74, 128
v_cvt_pk_bf16_f32 v233, v240, v241
MV 184,v,40,v,56
MV 188,v,40,v,60
TR 40,222,8192
TR 42,222,9216
MV 192,v,44,v,48
s_and_b32 s74, s74, 2047
s_add_u32 s36, s28, 16384
MV 196,v,44,v,52
buffer_store_dwordx4 v[230:233], v228, s[16:19], s36 offen sc1
MV 200,v,44,v,56
MV 204,v,44,v,60
TR 44,223,8192
TR 46,223,9216
s_waitcnt lgkmcnt(4)
MV 80,v,16,v,64
v_accvgpr_read_b32 v246, a168
MV 84,v,16,v,68
v_accvgpr_read_b32 v247, a169
MV 88,v,16,v,72
v_accvgpr_read_b32 v248, a170
MV 92,v,16,v,76
MV 96,v,20,v,64
v_accvgpr_read_b32 v249, a171
MV 100,v,20,v,68
v_accvgpr_read_b32 v250, a172
MV 104,v,20,v,72
v_accvgpr_read_b32 v251, a173
MV 108,v,20,v,76
s_waitcnt vmcnt(16) lgkmcnt(0)
s_barrier
MV 112,v,24,v,64
TR 16,216,16384
TR 18,216,17408
MV 116,v,24,v,68
ds_read_b128 v[48:51], v224 offset:0
s_add_u32 m0, s68, 98304
MV 120,v,24,v,72
TR 20,217,16384
TR 22,217,17408
MV 124,v,24,v,76
buffer_load_dwordx4 v212, s[48:51], s66 offen offset:0 lds
v_accvgpr_read_b32 v252, a174
MV 128,v,28,v,64
TR 24,218,16384
TR 26,218,17408
MV 132,v,28,v,68
ds_read_b128 v[52:55], v224 offset:2048
buffer_load_dwordx4 v213, s[48:51], s66 offen offset:1024 lds
MV 136,v,28,v,72
buffer_load_dwordx4 v214, s[48:51], s66 offen offset:2048 lds
v_accvgpr_read_b32 v253, a175
MV 140,v,28,v,76
TR 28,219,16384
TR 30,219,17408
MV 144,v,32,v,64
ds_read_b128 v[56:59], v224 offset:4096
v_cvt_pk_bf16_f32 v242, v246, v247
MV 148,v,32,v,68
buffer_load_dwordx4 v215, s[48:51], s66 offen offset:3072 lds
v_cvt_pk_bf16_f32 v243, v248, v249
MV 152,v,32,v,72
v_cvt_pk_bf16_f32 v244, v250, v251
v_cvt_pk_bf16_f32 v245, v252, v253
MV 156,v,32,v,76
TR 32,220,16384
TR 34,220,17408
MV 160,v,36,v,64
ds_read_b128 v[60:63], v224 offset:6144
s_add_u32 s66, s66, 524288
MV 164,v,36,v,68
s_and_b32 s66, s66, 8388607
s_add_u32 s36, s29, 16384
MV 168,v,36,v,72
buffer_store_dwordx4 v[242:245], v228, s[16:19], s36 offen sc1
v_accvgpr_read_b32 v234, a176
MV 172,v,36,v,76
TR 36,221,16384
TR 38,221,17408
MV 176,v,40,v,64
s_add_u32 s75, s64, s74
v_accvgpr_read_b32 v235, a177
MV 180,v,40,v,68
v_accvgpr_read_b32 v236, a178
v_accvgpr_read_b32 v237, a179
MV 184,v,40,v,72
s_add_u32 m0, s67, 65536
v_accvgpr_read_b32 v238, a180
MV 188,v,40,v,76
TR 40,222,16384
TR 42,222,17408
MV 192,v,44,v,64
buffer_load_dwordx4 v208, s[44:47], s75 offen offset:0 lds
v_accvgpr_read_b32 v239, a181
MV 196,v,44,v,68
v_accvgpr_read_b32 v240, a182
v_accvgpr_read_b32 v241, a183
MV 200,v,44,v,72
MV 204,v,44,v,76
TR 44,223,16384
TR 46,223,17408
s_waitcnt lgkmcnt(4)
MV 80,v,16,v,48
buffer_load_dwordx4 v209, s[44:47], s75 offen offset:1024 lds
v_cvt_pk_bf16_f32 v230, v234, v235
MV 84,v,16,v,52
ds_read_b128 v[64:67], v225 offset:0
v_cvt_pk_bf16_f32 v231, v236, v237
MV 88,v,16,v,56
buffer_load_dwordx4 v210, s[44:47], s75 offen offset:2048 lds
v_cvt_pk_bf16_f32 v232, v238, v239
MV 92,v,16,v,60
TR 16,216,24576
TR 18,216,25600
MV 96,v,20,v,48
v_cvt_pk_bf16_f32 v233, v240, v241
MV 100,v,20,v,52
buffer_load_dwordx4 v211, s[44:47], s75 offen offset:3072 lds
s_add_u32 s36, s30, 16384
MV 104,v,20,v,56
ds_read_b128 v[68:71], v225 offset:2048
buffer_store_dwordx4 v[230:233], v228, s[16:19], s36 offen sc1
MV 108,v,20,v,60
TR 20,217,24576
TR 22,217,25600
MV 112,v,24,v,48
s_add_u32 s75, s65, s74
v_accvgpr_read_b32 v246, a184
MV 116,v,24,v,52
v_accvgpr_read_b32 v247, a185
MV 120,v,24,v,56
v_accvgpr_read_b32 v248, a186
MV 124,v,24,v,60
TR 24,218,24576
TR 26,218,25600
MV 128,v,28,v,48
ds_read_b128 v[72:75], v225 offset:4096
s_add_u32 m0, s67, 69632
MV 132,v,28,v,52
v_accvgpr_read_b32 v249, a187
v_accvgpr_read_b32 v250, a188
MV 136,v,28,v,56
buffer_load_dwordx4 v208, s[44:47], s75 offen offset:0 lds
v_accvgpr_read_b32 v251, a189
MV 140,v,28,v,60
TR 28,219,24576
TR 30,219,25600
MV 144,v,32,v,48
buffer_load_dwordx4 v209, s[44:47], s75 offen offset:1024 lds
v_accvgpr_read_b32 v252, a190
MV 148,v,32,v,52
v_accvgpr_read_b32 v253, a191
MV 152,v,32,v,56
ds_read_b128 v[76:79], v225 offset:6144
v_cvt_pk_bf16_f32 v242, v246, v247
MV 156,v,32,v,60
TR 32,220,24576
TR 34,220,25600
MV 160,v,36,v,48
buffer_load_dwordx4 v210, s[44:47], s75 offen offset:2048 lds
v_cvt_pk_bf16_f32 v243, v248, v249
MV 164,v,36,v,52
v_cvt_pk_bf16_f32 v244, v250, v251
MV 168,v,36,v,56
buffer_load_dwordx4 v211, s[44:47], s75 offen offset:3072 lds
v_cvt_pk_bf16_f32 v245, v252, v253
MV 172,v,36,v,60
TR 36,221,24576
TR 38,221,25600
s_waitcnt lgkmcnt(15)
MV 176,v,40,v,48
s_add_u32 s36, s31, 16384
buffer_store_dwordx4 v[242:245], v228, s[16:19], s36 offen sc1
MV 180,v,40,v,52
s_add_u32 s74, s74, 128
MV 184,v,40,v,56
v_accvgpr_read_b32 v234, a192
MV 188,v,40,v,60
TR 40,222,24576
TR 42,222,25600
MV 192,v,44,v,48
s_and_b32 s74, s74, 2047
v_accvgpr_read_b32 v235, a193
MV 196,v,44,v,52
buffer_load_dword v254, off, s[12:15], 0 sc1
MV 200,v,44,v,56
MV 204,v,44,v,60
TR 44,223,24576
TR 46,223,25600
s_waitcnt lgkmcnt(4)
MV 80,v,16,v,64
v_accvgpr_read_b32 v236, a194
MV 84,v,16,v,68
v_accvgpr_read_b32 v237, a195
MV 88,v,16,v,72
v_accvgpr_read_b32 v238, a196
MV 92,v,16,v,76
MV 96,v,20,v,64
v_accvgpr_read_b32 v239, a197
MV 100,v,20,v,68
v_accvgpr_read_b32 v240, a198
MV 104,v,20,v,72
v_accvgpr_read_b32 v241, a199
MV 108,v,20,v,76
s_waitcnt vmcnt(17) lgkmcnt(0)
s_barrier
MV 112,v,24,v,64
TR 16,216,32768
TR 18,216,33792
MV 116,v,24,v,68
ds_read_b128 v[48:51], v224 offset:32768
s_add_u32 m0, s68, 114688
MV 120,v,24,v,72
TR 20,217,32768
TR 22,217,33792
MV 124,v,24,v,76
buffer_load_dwordx4 v212, s[48:51], s66 offen offset:0 lds
v_cvt_pk_bf16_f32 v230, v234, v235
MV 128,v,28,v,64
TR 24,218,32768
TR 26,218,33792
MV 132,v,28,v,68
ds_read_b128 v[52:55], v224 offset:34816
buffer_load_dwordx4 v213, s[48:51], s66 offen offset:1024 lds
MV 136,v,28,v,72
buffer_load_dwordx4 v214, s[48:51], s66 offen offset:2048 lds
v_cvt_pk_bf16_f32 v231, v236, v237
MV 140,v,28,v,76
TR 28,219,32768
TR 30,219,33792
MV 144,v,32,v,64
ds_read_b128 v[56:59], v224 offset:36864
v_cvt_pk_bf16_f32 v232, v238, v239
MV 148,v,32,v,68
buffer_load_dwordx4 v215, s[48:51], s66 offen offset:3072 lds
v_cvt_pk_bf16_f32 v233, v240, v241
MV 152,v,32,v,72
s_add_u32 s36, s24, 24576
buffer_store_dwordx4 v[230:233], v228, s[16:19], s36 offen sc1
MV 156,v,32,v,76
TR 32,220,32768
TR 34,220,33792
MV 160,v,36,v,64
ds_read_b128 v[60:63], v224 offset:38912
s_add_u32 s66, s66, 524288
MV 164,v,36,v,68
s_and_b32 s66, s66, 8388607
v_accvgpr_read_b32 v246, a200
MV 168,v,36,v,72
v_accvgpr_read_b32 v247, a201
v_accvgpr_read_b32 v248, a202
MV 172,v,36,v,76
TR 36,221,32768
TR 38,221,33792
MV 176,v,40,v,64
s_add_u32 s75, s64, s74
v_accvgpr_read_b32 v249, a203
MV 180,v,40,v,68
v_accvgpr_read_b32 v250, a204
v_accvgpr_read_b32 v251, a205
MV 184,v,40,v,72
s_add_u32 m0, s67, 0
v_accvgpr_read_b32 v252, a206
MV 188,v,40,v,76
TR 40,222,32768
TR 42,222,33792
MV 192,v,44,v,64
buffer_load_dwordx4 v208, s[44:47], s75 offen offset:0 lds
v_accvgpr_read_b32 v253, a207
MV 196,v,44,v,68
v_cvt_pk_bf16_f32 v242, v246, v247
v_cvt_pk_bf16_f32 v243, v248, v249
MV 200,v,44,v,72
MV 204,v,44,v,76
TR 44,223,32768
TR 46,223,33792
s_waitcnt lgkmcnt(4)
MV 80,v,16,v,48
buffer_load_dwordx4 v209, s[44:47], s75 offen offset:1024 lds
v_cvt_pk_bf16_f32 v244, v250, v251
MV 84,v,16,v,52
ds_read_b128 v[64:67], v225 offset:32768
v_cvt_pk_bf16_f32 v245, v252, v253
MV 88,v,16,v,56
buffer_load_dwordx4 v210, s[44:47], s75 offen offset:2048 lds
s_add_u32 s36, s25, 24576
MV 92,v,16,v,60
TR 16,216,40960
TR 18,216,41984
MV 96,v,20,v,48
buffer_store_dwordx4 v[242:245], v228, s[16:19], s36 offen sc1
MV 100,v,20,v,52
buffer_load_dwordx4 v211, s[44:47], s75 offen offset:3072 lds
v_accvgpr_read_b32 v234, a208
MV 104,v,20,v,56
ds_read_b128 v[68:71], v225 offset:34816
v_accvgpr_read_b32 v235, a209
MV 108,v,20,v,60
TR 20,217,40960
TR 22,217,41984
MV 112,v,24,v,48
s_add_u32 s75, s65, s74
v_accvgpr_read_b32 v236, a210
MV 116,v,24,v,52
v_accvgpr_read_b32 v237, a211
MV 120,v,24,v,56
v_accvgpr_read_b32 v238, a212
MV 124,v,24,v,60
TR 24,218,40960
TR 26,218,41984
MV 128,v,28,v,48
ds_read_b128 v[72:75], v225 offset:36864
s_add_u32 m0, s67, 4096
MV 132,v,28,v,52
v_accvgpr_read_b32 v239, a213
v_accvgpr_read_b32 v240, a214
MV 136,v,28,v,56
buffer_load_dwordx4 v208, s[44:47], s75 offen offset:0 lds
MV 140,v,28,v,60
TR 28,219,40960
TR 30,219,41984
MV 144,v,32,v,48
buffer_load_dwordx4 v209, s[44:47], s75 offen offset:1024 lds
v_accvgpr_read_b32 v241, a215
MV 148,v,32,v,52
v_cvt_pk_bf16_f32 v230, v234, v235
v_cvt_pk_bf16_f32 v231, v236, v237
MV 152,v,32,v,56
ds_read_b128 v[76:79], v225 offset:38912
MV 156,v,32,v,60
TR 32,220,40960
TR 34,220,41984
MV 160,v,36,v,48
buffer_load_dwordx4 v210, s[44:47], s75 offen offset:2048 lds
v_cvt_pk_bf16_f32 v232, v238, v239
MV 164,v,36,v,52
v_cvt_pk_bf16_f32 v233, v240, v241
s_add_u32 s36, s26, 24576
MV 168,v,36,v,56
buffer_load_dwordx4 v211, s[44:47], s75 offen offset:3072 lds
MV 172,v,36,v,60
TR 36,221,40960
TR 38,221,41984
s_waitcnt lgkmcnt(15)
MV 176,v,40,v,48
buffer_store_dwordx4 v[230:233], v228, s[16:19], s36 offen sc1
v_accvgpr_read_b32 v246, a216
MV 180,v,40,v,52
s_add_u32 s74, s74, 128
v_accvgpr_read_b32 v247, a217
MV 184,v,40,v,56
MV 188,v,40,v,60
TR 40,222,40960
TR 42,222,41984
MV 192,v,44,v,48
s_and_b32 s74, s74, 2047
v_accvgpr_read_b32 v248, a218
MV 196,v,44,v,52
v_accvgpr_read_b32 v249, a219
MV 200,v,44,v,56
MV 204,v,44,v,60
TR 44,223,40960
TR 46,223,41984
s_waitcnt lgkmcnt(4)
MV 80,v,16,v,64
v_accvgpr_read_b32 v250, a220
MV 84,v,16,v,68
v_accvgpr_read_b32 v251, a221
MV 88,v,16,v,72
v_accvgpr_read_b32 v252, a222
MV 92,v,16,v,76
MV 96,v,20,v,64
v_accvgpr_read_b32 v253, a223
MV 100,v,20,v,68
v_cvt_pk_bf16_f32 v242, v246, v247
MV 104,v,20,v,72
v_cvt_pk_bf16_f32 v243, v248, v249
MV 108,v,20,v,76
s_waitcnt vmcnt(17) lgkmcnt(0)
s_barrier
MV 112,v,24,v,64
TR 16,216,0
TR 18,216,1024
MV 116,v,24,v,68
ds_read_b128 v[48:51], v226 offset:0
s_add_u32 m0, s68, 131072
MV 120,v,24,v,72
TR 20,217,0
TR 22,217,1024
MV 124,v,24,v,76
buffer_load_dwordx4 v212, s[48:51], s66 offen offset:0 lds
v_cvt_pk_bf16_f32 v244, v250, v251
MV 128,v,28,v,64
TR 24,218,0
TR 26,218,1024
MV 132,v,28,v,68
ds_read_b128 v[52:55], v226 offset:2048
buffer_load_dwordx4 v213, s[48:51], s66 offen offset:1024 lds
MV 136,v,28,v,72
buffer_load_dwordx4 v214, s[48:51], s66 offen offset:2048 lds
v_cvt_pk_bf16_f32 v245, v252, v253
MV 140,v,28,v,76
TR 28,219,0
TR 30,219,1024
MV 144,v,32,v,64
ds_read_b128 v[56:59], v226 offset:4096
s_add_u32 s36, s27, 24576
MV 148,v,32,v,68
buffer_load_dwordx4 v215, s[48:51], s66 offen offset:3072 lds
buffer_store_dwordx4 v[242:245], v228, s[16:19], s36 offen sc1
MV 152,v,32,v,72
v_accvgpr_read_b32 v234, a224
v_accvgpr_read_b32 v235, a225
MV 156,v,32,v,76
TR 32,220,0
TR 34,220,1024
MV 160,v,36,v,64
ds_read_b128 v[60:63], v226 offset:6144
s_add_u32 s66, s66, 524288
MV 164,v,36,v,68
s_and_b32 s66, s66, 8388607
v_accvgpr_read_b32 v236, a226
MV 168,v,36,v,72
v_accvgpr_read_b32 v237, a227
v_accvgpr_read_b32 v238, a228
MV 172,v,36,v,76
TR 36,221,0
TR 38,221,1024
MV 176,v,40,v,64
s_add_u32 s75, s64, s74
v_accvgpr_read_b32 v239, a229
MV 180,v,40,v,68
v_accvgpr_read_b32 v240, a230
v_accvgpr_read_b32 v241, a231
MV 184,v,40,v,72
s_add_u32 m0, s67, 32768
v_cvt_pk_bf16_f32 v230, v234, v235
MV 188,v,40,v,76
TR 40,222,0
TR 42,222,1024
MV 192,v,44,v,64
buffer_load_dwordx4 v208, s[44:47], s75 offen offset:0 lds
v_cvt_pk_bf16_f32 v231, v236, v237
MV 196,v,44,v,68
v_cvt_pk_bf16_f32 v232, v238, v239
v_cvt_pk_bf16_f32 v233, v240, v241
MV 200,v,44,v,72
MV 204,v,44,v,76
TR 44,223,0
TR 46,223,1024
s_waitcnt lgkmcnt(4)
MV 80,v,16,v,48
buffer_load_dwordx4 v209, s[44:47], s75 offen offset:1024 lds
s_add_u32 s36, s28, 24576
MV 84,v,16,v,52
ds_read_b128 v[64:67], v227 offset:0
buffer_store_dwordx4 v[230:233], v228, s[16:19], s36 offen sc1
MV 88,v,16,v,56
buffer_load_dwordx4 v210, s[44:47], s75 offen offset:2048 lds
v_accvgpr_read_b32 v246, a232
MV 92,v,16,v,60
TR 16,216,8192
TR 18,216,9216
MV 96,v,20,v,48
v_accvgpr_read_b32 v247, a233
MV 100,v,20,v,52
buffer_load_dwordx4 v211, s[44:47], s75 offen offset:3072 lds
v_accvgpr_read_b32 v248, a234
MV 104,v,20,v,56
ds_read_b128 v[68:71], v227 offset:2048
v_accvgpr_read_b32 v249, a235
MV 108,v,20,v,60
TR 20,217,8192
TR 22,217,9216
MV 112,v,24,v,48
s_add_u32 s75, s65, s74
v_accvgpr_read_b32 v250, a236
MV 116,v,24,v,52
v_accvgpr_read_b32 v251, a237
MV 120,v,24,v,56
v_accvgpr_read_b32 v252, a238
MV 124,v,24,v,60
TR 24,218,8192
TR 26,218,9216
MV 128,v,28,v,48
ds_read_b128 v[72:75], v227 offset:4096
s_add_u32 m0, s67, 36864
MV 132,v,28,v,52
v_accvgpr_read_b32 v253, a239
v_cvt_pk_bf16_f32 v242, v246, v247
MV 136,v,28,v,56
buffer_load_dwordx4 v208, s[44:47], s75 offen offset:0 lds
MV 140,v,28,v,60
TR 28,219,8192
TR 30,219,9216
MV 144,v,32,v,48
buffer_load_dwordx4 v209, s[44:47], s75 offen offset:1024 lds
v_cvt_pk_bf16_f32 v243, v248, v249
MV 148,v,32,v,52
v_cvt_pk_bf16_f32 v244, v250, v251
v_cvt_pk_bf16_f32 v245, v252, v253
MV 152,v,32,v,56
ds_read_b128 v[76:79], v227 offset:6144
MV 156,v,32,v,60
TR 32,220,8192
TR 34,220,9216
MV 160,v,36,v,48
buffer_load_dwordx4 v210, s[44:47], s75 offen offset:2048 lds
s_add_u32 s36, s29, 24576
MV 164,v,36,v,52
buffer_store_dwordx4 v[242:245], v228, s[16:19], s36 offen sc1
v_accvgpr_read_b32 v234, a240
MV 168,v,36,v,56
buffer_load_dwordx4 v211, s[44:47], s75 offen offset:3072 lds
MV 172,v,36,v,60
TR 36,221,8192
TR 38,221,9216
s_waitcnt lgkmcnt(15)
MV 176,v,40,v,48
v_accvgpr_read_b32 v235, a241
v_accvgpr_read_b32 v236, a242
MV 180,v,40,v,52
s_add_u32 s74, s74, 128
v_accvgpr_read_b32 v237, a243
MV 184,v,40,v,56
MV 188,v,40,v,60
TR 40,222,8192
TR 42,222,9216
MV 192,v,44,v,48
s_and_b32 s74, s74, 2047
v_accvgpr_read_b32 v238, a244
MV 196,v,44,v,52
v_accvgpr_read_b32 v239, a245
MV 200,v,44,v,56
MV 204,v,44,v,60
TR 44,223,8192
TR 46,223,9216
s_waitcnt lgkmcnt(4)
MV 80,v,16,v,64
v_accvgpr_read_b32 v240, a246
MV 84,v,16,v,68
v_accvgpr_read_b32 v241, a247
MV 88,v,16,v,72
v_cvt_pk_bf16_f32 v230, v234, v235
MV 92,v,16,v,76
MV 96,v,20,v,64
v_cvt_pk_bf16_f32 v231, v236, v237
MV 100,v,20,v,68
v_cvt_pk_bf16_f32 v232, v238, v239
MV 104,v,20,v,72
v_cvt_pk_bf16_f32 v233, v240, v241
MV 108,v,20,v,76
s_waitcnt vmcnt(16) lgkmcnt(0)
s_barrier
MV 112,v,24,v,64
TR 16,216,16384
TR 18,216,17408
MV 116,v,24,v,68
ds_read_b128 v[48:51], v224 offset:0
s_add_u32 m0, s68, 98304
MV 120,v,24,v,72
TR 20,217,16384
TR 22,217,17408
MV 124,v,24,v,76
buffer_load_dwordx4 v212, s[48:51], s66 offen offset:0 lds
s_add_u32 s36, s30, 24576
MV 128,v,28,v,64
TR 24,218,16384
TR 26,218,17408
MV 132,v,28,v,68
ds_read_b128 v[52:55], v224 offset:2048
buffer_load_dwordx4 v213, s[48:51], s66 offen offset:1024 lds
MV 136,v,28,v,72
buffer_load_dwordx4 v214, s[48:51], s66 offen offset:2048 lds
buffer_store_dwordx4 v[230:233], v228, s[16:19], s36 offen sc1
MV 140,v,28,v,76
TR 28,219,16384
TR 30,219,17408
MV 144,v,32,v,64
ds_read_b128 v[56:59], v224 offset:4096
v_accvgpr_read_b32 v246, a248
MV 148,v,32,v,68
buffer_load_dwordx4 v215, s[48:51], s66 offen offset:3072 lds
v_accvgpr_read_b32 v247, a249
MV 152,v,32,v,72
v_accvgpr_read_b32 v248, a250
v_accvgpr_read_b32 v249, a251
MV 156,v,32,v,76
TR 32,220,16384
TR 34,220,17408
MV 160,v,36,v,64
ds_read_b128 v[60:63], v224 offset:6144
s_add_u32 s66, s66, 524288
MV 164,v,36,v,68
s_and_b32 s66, s66, 8388607
v_accvgpr_read_b32 v250, a252
MV 168,v,36,v,72
v_accvgpr_read_b32 v251, a253
v_accvgpr_read_b32 v252, a254
MV 172,v,36,v,76
TR 36,221,16384
TR 38,221,17408
MV 176,v,40,v,64
s_add_u32 s75, s64, s74
v_accvgpr_read_b32 v253, a255
MV 180,v,40,v,68
v_cvt_pk_bf16_f32 v242, v246, v247
v_cvt_pk_bf16_f32 v243, v248, v249
MV 184,v,40,v,72
s_add_u32 m0, s67, 65536
v_cvt_pk_bf16_f32 v244, v250, v251
MV 188,v,40,v,76
TR 40,222,16384
TR 42,222,17408
MV 192,v,44,v,64
buffer_load_dwordx4 v208, s[44:47], s75 offen offset:0 lds
v_cvt_pk_bf16_f32 v245, v252, v253
MV 196,v,44,v,68
s_add_u32 s36, s31, 24576
buffer_store_dwordx4 v[242:245], v228, s[16:19], s36 offen sc1
MV 200,v,44,v,72
MV 204,v,44,v,76
TR 44,223,16384
TR 46,223,17408
s_waitcnt lgkmcnt(4)
MV 80,v,16,v,48
buffer_load_dwordx4 v209, s[44:47], s75 offen offset:1024 lds
v_lshlrev_b32 v255, 20, v1
MV 84,v,16,v,52
ds_read_b128 v[64:67], v225 offset:0
MV 88,v,16,v,56
buffer_load_dwordx4 v210, s[44:47], s75 offen offset:2048 lds
MV 92,v,16,v,60
TR 16,216,24576
TR 18,216,25600
MV 96,v,20,v,48
MV 100,v,20,v,52
buffer_load_dwordx4 v211, s[44:47], s75 offen offset:3072 lds
MV 104,v,20,v,56
ds_read_b128 v[68:71], v225 offset:2048
MV 108,v,20,v,60
TR 20,217,24576
TR 22,217,25600
MV 112,v,24,v,48
s_add_u32 s75, s65, s74
MV 116,v,24,v,52
MV 120,v,24,v,56
s_lshl_b32 s36, s3, 26
MV 124,v,24,v,60
TR 24,218,24576
TR 26,218,25600
MV 128,v,28,v,48
ds_read_b128 v[72:75], v225 offset:4096
s_add_u32 m0, s67, 69632
MV 132,v,28,v,52
MV 136,v,28,v,56
buffer_load_dwordx4 v208, s[44:47], s75 offen offset:0 lds
MV 140,v,28,v,60
TR 28,219,24576
TR 30,219,25600
MV 144,v,32,v,48
buffer_load_dwordx4 v209, s[44:47], s75 offen offset:1024 lds
MV 148,v,32,v,52
MV 152,v,32,v,56
ds_read_b128 v[76:79], v225 offset:6144
MV 156,v,32,v,60
TR 32,220,24576
TR 34,220,25600
MV 160,v,36,v,48
buffer_load_dwordx4 v210, s[44:47], s75 offen offset:2048 lds
v_add_u32 v255, s36, v255
MV 164,v,36,v,52
MV 168,v,36,v,56
buffer_load_dwordx4 v211, s[44:47], s75 offen offset:3072 lds
MV 172,v,36,v,60
TR 36,221,24576
TR 38,221,25600
s_waitcnt lgkmcnt(15)
MV 176,v,40,v,48
MV 180,v,40,v,52
s_add_u32 s74, s74, 128
MV 184,v,40,v,56
MV 188,v,40,v,60
TR 40,222,24576
TR 42,222,25600
MV 192,v,44,v,48
s_and_b32 s74, s74, 2047
MV 196,v,44,v,52
MV 200,v,44,v,56
MV 204,v,44,v,60
TR 44,223,24576
TR 46,223,25600
s_waitcnt lgkmcnt(4)
MV 80,v,16,v,64
v_lshlrev_b32 v230, 4, v1
MV 84,v,16,v,68
s_lshl_b32 s80, s3, 12
MV 88,v,16,v,72
MV 92,v,16,v,76
v_add_u32 v12, s80, v230
MV 96,v,20,v,64
v_add_u32 v10, 0x8000, v230
MV 100,v,20,v,68
MV 104,v,20,v,72
v_add_u32 v11, 0x10000, v230
MV 108,v,20,v,76
s_waitcnt vmcnt(14) lgkmcnt(0)
s_barrier
MV 112,v,24,v,64
TR 16,216,32768
TR 18,216,33792
MV 116,v,24,v,68
ds_read_b128 v[48:51], v224 offset:32768
s_add_u32 m0, s68, 114688
MV 120,v,24,v,72
TR 20,217,32768
TR 22,217,33792
MV 124,v,24,v,76
buffer_load_dwordx4 v212, s[48:51], s66 offen offset:0 lds
s_add_u32 s72, s80, 0x8000
MV 128,v,28,v,64
TR 24,218,32768
TR 26,218,33792
MV 132,v,28,v,68
ds_read_b128 v[52:55], v224 offset:34816
buffer_load_dwordx4 v213, s[48:51], s66 offen offset:1024 lds
MV 136,v,28,v,72
buffer_load_dwordx4 v214, s[48:51], s66 offen offset:2048 lds
s_add_u32 s73, s80, 0x10000
MV 140,v,28,v,76
TR 28,219,32768
TR 30,219,33792
MV 144,v,32,v,64
ds_read_b128 v[56:59], v224 offset:36864
v_and_b32 v230, 31, v1
MV 148,v,32,v,68
buffer_load_dwordx4 v215, s[48:51], s66 offen offset:3072 lds
v_lshrrev_b32 v232, 5, v1
MV 152,v,32,v,72
v_lshlrev_b32 v233, 2, v232
v_sub_u32 v13, v230, v233
MV 156,v,32,v,76
TR 32,220,32768
TR 34,220,33792
MV 160,v,36,v,64
ds_read_b128 v[60:63], v224 offset:38912
s_add_u32 s66, s66, 524288
MV 164,v,36,v,68
s_and_b32 s66, s66, 8388607
s_lshl_b32 s81, s3, 5
MV 168,v,36,v,72
v_add_u32 v13, s81, v13
v_mov_b32 v14, 0xff800000
MV 172,v,36,v,76
TR 36,221,32768
TR 38,221,33792
MV 176,v,40,v,64
s_add_u32 s75, s64, s74
v_and_b32 v230, 15, v1
MV 180,v,40,v,68
v_lshl_add_u32 v230, v232, 4, v230
v_lshlrev_b32 v230, 4, v230
MV 184,v,40,v,72
s_add_u32 m0, s67, 0
v_bfe_u32 v233, v1, 4, 1
MV 188,v,40,v,76
TR 40,222,32768
TR 42,222,33792
MV 192,v,44,v,64
buffer_load_dwordx4 v208, s[44:47], s75 offen offset:0 lds
v_lshl_add_u32 v15, v233, 17, v230
MV 196,v,44,v,68
MV 200,v,44,v,72
MV 204,v,44,v,76
TR 44,223,32768
TR 46,223,33792
s_waitcnt lgkmcnt(4)
MV 80,v,16,v,48
buffer_load_dwordx4 v209, s[44:47], s75 offen offset:1024 lds
v_accvgpr_write_b32 a0, 0
MV 84,v,16,v,52
ds_read_b128 v[64:67], v225 offset:32768
v_accvgpr_write_b32 a1, 0
MV 88,v,16,v,56
buffer_load_dwordx4 v210, s[44:47], s75 offen offset:2048 lds
MV 92,v,16,v,60
TR 16,216,40960
TR 18,216,41984
MV 96,v,20,v,48
v_accvgpr_write_b32 a2, 0
MV 100,v,20,v,52
buffer_load_dwordx4 v211, s[44:47], s75 offen offset:3072 lds
v_accvgpr_write_b32 a3, 0
MV 104,v,20,v,56
ds_read_b128 v[68:71], v225 offset:34816
MV 108,v,20,v,60
TR 20,217,40960
TR 22,217,41984
MV 112,v,24,v,48
s_add_u32 s75, s65, s74
v_accvgpr_write_b32 a4, 0
MV 116,v,24,v,52
v_accvgpr_write_b32 a5, 0
MV 120,v,24,v,56
MV 124,v,24,v,60
TR 24,218,40960
TR 26,218,41984
MV 128,v,28,v,48
ds_read_b128 v[72:75], v225 offset:36864
s_add_u32 m0, s67, 4096
MV 132,v,28,v,52
v_accvgpr_write_b32 a6, 0
v_accvgpr_write_b32 a7, 0
MV 136,v,28,v,56
buffer_load_dwordx4 v208, s[44:47], s75 offen offset:0 lds
MV 140,v,28,v,60
TR 28,219,40960
TR 30,219,41984
MV 144,v,32,v,48
buffer_load_dwordx4 v209, s[44:47], s75 offen offset:1024 lds
v_accvgpr_write_b32 a8, 0
MV 148,v,32,v,52
v_accvgpr_write_b32 a9, 0
MV 152,v,32,v,56
ds_read_b128 v[76:79], v225 offset:38912
v_accvgpr_write_b32 a10, 0
MV 156,v,32,v,60
TR 32,220,40960
TR 34,220,41984
MV 160,v,36,v,48
buffer_load_dwordx4 v210, s[44:47], s75 offen offset:2048 lds
v_accvgpr_write_b32 a11, 0
MV 164,v,36,v,52
MV 168,v,36,v,56
buffer_load_dwordx4 v211, s[44:47], s75 offen offset:3072 lds
v_accvgpr_write_b32 a12, 0
MV 172,v,36,v,60
TR 36,221,40960
TR 38,221,41984
s_waitcnt lgkmcnt(15)
MV 176,v,40,v,48
v_accvgpr_write_b32 a13, 0
MV 180,v,40,v,52
s_add_u32 s74, s74, 128
MV 184,v,40,v,56
v_accvgpr_write_b32 a14, 0
MV 188,v,40,v,60
TR 40,222,40960
TR 42,222,41984
MV 192,v,44,v,48
s_and_b32 s74, s74, 2047
v_accvgpr_write_b32 a15, 0
MV 196,v,44,v,52
MV 200,v,44,v,56
MV 204,v,44,v,60
TR 44,223,40960
TR 46,223,41984
s_waitcnt lgkmcnt(4)
MV 80,v,16,v,64
v_accvgpr_write_b32 a16, 0
MV 84,v,16,v,68
v_accvgpr_write_b32 a17, 0
MV 88,v,16,v,72
MV 92,v,16,v,76
v_accvgpr_write_b32 a18, 0
MV 96,v,20,v,64
MV 100,v,20,v,68
v_accvgpr_write_b32 a19, 0
MV 104,v,20,v,72
MV 108,v,20,v,76
s_waitcnt vmcnt(12) lgkmcnt(0)
s_barrier
MV 112,v,24,v,64
v_cmp_gt_u32 vcc, 1, v254
s_nop 4
s_cbranch_vccnz L_spin_go
L_spin_go_ret:
v_mov_b32 v254, 1
s_lshl_b32 s36, s2, 2
buffer_store_dword v254, v255, s[8:11], s36 offen offset:0 sc1
s_load_dwordx4 s[32:35], s[0:1], 32
MV 116,v,24,v,68
TR 16,216,0
TR 18,216,1024
MV 120,v,24,v,72
TR 20,217,0
TR 22,217,1024
MV 124,v,24,v,76
ds_read_b128 v[48:51], v226 offset:0
s_add_u32 m0, s68, 131072
MV 128,v,28,v,64
TR 24,218,0
TR 26,218,1024
MV 132,v,28,v,68
ds_read_b128 v[52:55], v226 offset:2048
buffer_load_dwordx4 v212, s[48:51], s66 offen offset:0 lds
MV 136,v,28,v,72
buffer_load_dwordx4 v213, s[48:51], s66 offen offset:1024 lds
buffer_load_dwordx4 v214, s[48:51], s66 offen offset:2048 lds
MV 140,v,28,v,76
TR 28,219,0
TR 30,219,1024
MV 144,v,32,v,64
ds_read_b128 v[56:59], v226 offset:4096
v_accvgpr_write_b32 a20, 0
MV 148,v,32,v,68
buffer_load_dwordx4 v215, s[48:51], s66 offen offset:3072 lds
v_accvgpr_write_b32 a21, 0
MV 152,v,32,v,72
v_accvgpr_write_b32 a22, 0
v_accvgpr_write_b32 a23, 0
MV 156,v,32,v,76
TR 32,220,0
TR 34,220,1024
MV 160,v,36,v,64
ds_read_b128 v[60:63], v226 offset:6144
s_add_u32 s66, s66, 524288
MV 164,v,36,v,68
s_and_b32 s66, s66, 8388607
v_accvgpr_write_b32 a24, 0
MV 168,v,36,v,72
v_accvgpr_write_b32 a25, 0
v_accvgpr_write_b32 a26, 0
MV 172,v,36,v,76
TR 36,221,0
TR 38,221,1024
MV 176,v,40,v,64
s_add_u32 s75, s64, s74
v_accvgpr_write_b32 a27, 0
MV 180,v,40,v,68
v_accvgpr_write_b32 a28, 0
v_accvgpr_write_b32 a29, 0
MV 184,v,40,v,72
s_add_u32 m0, s67, 32768
v_accvgpr_write_b32 a30, 0
MV 188,v,40,v,76
TR 40,222,0
TR 42,222,1024
MV 192,v,44,v,64
buffer_load_dwordx4 v208, s[44:47], s75 offen offset:0 lds
v_accvgpr_write_b32 a31, 0
MV 196,v,44,v,68
MV 200,v,44,v,72
MV 204,v,44,v,76
TR 44,223,0
TR 46,223,1024
s_waitcnt lgkmcnt(4)
MV 80,v,16,v,48
buffer_load_dwordx4 v209, s[44:47], s75 offen offset:1024 lds
v_accvgpr_write_b32 a32, 0
MV 84,v,16,v,52
ds_read_b128 v[64:67], v227 offset:0
v_accvgpr_write_b32 a33, 0
MV 88,v,16,v,56
buffer_load_dwordx4 v210, s[44:47], s75 offen offset:2048 lds
v_accvgpr_write_b32 a34, 0
MV 92,v,16,v,60
TR 16,216,8192
TR 18,216,9216
MV 96,v,20,v,48
v_accvgpr_write_b32 a35, 0
v_accvgpr_write_b32 a36, 0
MV 100,v,20,v,52
buffer_load_dwordx4 v211, s[44:47], s75 offen offset:3072 lds
v_accvgpr_write_b32 a37, 0
MV 104,v,20,v,56
ds_read_b128 v[68:71], v227 offset:2048
v_accvgpr_write_b32 a38, 0
MV 108,v,20,v,60
TR 20,217,8192
TR 22,217,9216
MV 112,v,24,v,48
s_add_u32 s75, s65, s74
v_accvgpr_write_b32 a39, 0
MV 116,v,24,v,52
v_accvgpr_write_b32 a40, 0
v_accvgpr_write_b32 a41, 0
MV 120,v,24,v,56
v_accvgpr_write_b32 a42, 0
v_accvgpr_write_b32 a43, 0
MV 124,v,24,v,60
TR 24,218,8192
TR 26,218,9216
MV 128,v,28,v,48
ds_read_b128 v[72:75], v227 offset:4096
s_add_u32 m0, s67, 36864
MV 132,v,28,v,52
v_accvgpr_write_b32 a44, 0
v_accvgpr_write_b32 a45, 0
MV 136,v,28,v,56
buffer_load_dwordx4 v208, s[44:47], s75 offen offset:0 lds
v_accvgpr_write_b32 a46, 0
MV 140,v,28,v,60
TR 28,219,8192
TR 30,219,9216
MV 144,v,32,v,48
buffer_load_dwordx4 v209, s[44:47], s75 offen offset:1024 lds
v_accvgpr_write_b32 a47, 0
MV 148,v,32,v,52
s_and_b32 s36, s2, 3
s_lshl_b32 s36, s36, 1
MV 152,v,32,v,56
ds_read_b128 v[76:79], v227 offset:6144
s_sub_u32 s43, 14, s36
MV 156,v,32,v,60
TR 32,220,8192
TR 34,220,9216
MV 160,v,36,v,48
buffer_load_dwordx4 v210, s[44:47], s75 offen offset:2048 lds
MV 164,v,36,v,52
s_bitcmp1_b32 s2, 4
s_cselect_b32 s36, s43, s36
MV 168,v,36,v,56
buffer_load_dwordx4 v211, s[44:47], s75 offen offset:3072 lds
s_bfe_u32 s43, s2, 0x10003
MV 172,v,36,v,60
TR 36,221,8192
TR 38,221,9216
s_waitcnt lgkmcnt(15)
MV 176,v,40,v,48
s_add_u32 s36, s36, s43
s_bfe_u32 s37, s2, 0x10002
MV 180,v,40,v,52
s_add_u32 s74, s74, 128
s_lshr_b32 s43, s2, 5
MV 184,v,40,v,56
s_lshl_b32 s43, s43, 1
s_add_u32 s37, s37, s43
MV 188,v,40,v,60
TR 40,222,8192
TR 42,222,9216
MV 192,v,44,v,48
s_and_b32 s74, s74, 2047
v_and_b32 v230, 15, v1
MV 196,v,44,v,52
s_lshl_b32 s36, s36, 4
v_add_u32 v231, s36, v230
MV 200,v,44,v,56
s_lshr_b32 s36, s2, 4
v_lshl_add_u32 v232, v230, 4, s36
MV 204,v,44,v,60
TR 44,223,8192
TR 46,223,9216
v_and_b32 v233, 7, v1
v_bfe_u32 v234, v1, 3, 1
v_lshlrev_b32 v233, 3, v233
v_lshl_add_u32 v233, v234, 7, v233
s_bfe_u32 s36, s2, 0x10004
s_lshl_b32 s36, s36, 6
s_and_b32 s37, s2, 7
s_add_u32 s36, s36, s37
v_add_u32 v233, s36, v233
v_lshrrev_b32 v234, 4, v1
v_cmp_eq_u32 vcc, 1, v234
s_nop 1
v_cndmask_b32 v233, v233, v232, vcc
v_cmp_eq_u32 vcc, 2, v234
s_nop 1
v_cndmask_b32 v233, v233, v231, vcc
v_lshlrev_b32 v233, 2, v233
s_waitcnt lgkmcnt(4)
MV 80,v,16,v,64
v_accvgpr_write_b32 a48, 0
MV 84,v,16,v,68
v_accvgpr_write_b32 a49, 0
MV 88,v,16,v,72
MV 92,v,16,v,76
v_accvgpr_write_b32 a50, 0
MV 96,v,20,v,64
MV 100,v,20,v,68
v_accvgpr_write_b32 a51, 0
MV 104,v,20,v,72
MV 108,v,20,v,76
s_waitcnt vmcnt(13) lgkmcnt(0)
s_barrier
MV 112,v,24,v,64
TR 16,216,16384
TR 18,216,17408
MV 116,v,24,v,68
ds_read_b128 v[48:51], v224 offset:0
s_add_u32 m0, s68, 98304
MV 120,v,24,v,72
TR 20,217,16384
TR 22,217,17408
MV 124,v,24,v,76
buffer_load_dwordx4 v212, s[48:51], s66 offen offset:0 lds
v_accvgpr_write_b32 a52, 0
MV 128,v,28,v,64
TR 24,218,16384
TR 26,218,17408
MV 132,v,28,v,68
ds_read_b128 v[52:55], v224 offset:2048
buffer_load_dwordx4 v213, s[48:51], s66 offen offset:1024 lds
MV 136,v,28,v,72
buffer_load_dwordx4 v214, s[48:51], s66 offen offset:2048 lds
v_accvgpr_write_b32 a53, 0
MV 140,v,28,v,76
TR 28,219,16384
TR 30,219,17408
MV 144,v,32,v,64
ds_read_b128 v[56:59], v224 offset:4096
v_accvgpr_write_b32 a54, 0
MV 148,v,32,v,68
buffer_load_dwordx4 v215, s[48:51], s66 offen offset:3072 lds
v_accvgpr_write_b32 a55, 0
MV 152,v,32,v,72
v_accvgpr_write_b32 a56, 0
v_accvgpr_write_b32 a57, 0
MV 156,v,32,v,76
TR 32,220,16384
TR 34,220,17408
MV 160,v,36,v,64
ds_read_b128 v[60:63], v224 offset:6144
s_add_u32 s66, s66, 524288
MV 164,v,36,v,68
s_and_b32 s66, s66, 8388607
v_accvgpr_write_b32 a58, 0
MV 168,v,36,v,72
v_accvgpr_write_b32 a59, 0
v_accvgpr_write_b32 a60, 0
MV 172,v,36,v,76
TR 36,221,16384
TR 38,221,17408
MV 176,v,40,v,64
s_add_u32 s75, s64, s74
v_accvgpr_write_b32 a61, 0
MV 180,v,40,v,68
MV 184,v,40,v,72
s_add_u32 m0, s67, 65536
v_accvgpr_write_b32 a62, 0
MV 188,v,40,v,76
TR 40,222,16384
TR 42,222,17408
MV 192,v,44,v,64
buffer_load_dwordx4 v208, s[44:47], s75 offen offset:0 lds
v_accvgpr_write_b32 a63, 0
MV 196,v,44,v,68
MV 200,v,44,v,72
MV 204,v,44,v,76
TR 44,223,16384
TR 46,223,17408
s_waitcnt lgkmcnt(4)
MV 80,v,16,v,48
buffer_load_dwordx4 v209, s[44:47], s75 offen offset:1024 lds
v_accvgpr_write_b32 a64, 0
MV 84,v,16,v,52
ds_read_b128 v[64:67], v225 offset:0
v_accvgpr_write_b32 a65, 0
MV 88,v,16,v,56
buffer_load_dwordx4 v210, s[44:47], s75 offen offset:2048 lds
v_accvgpr_write_b32 a66, 0
MV 92,v,16,v,60
TR 16,216,24576
TR 18,216,25600
MV 96,v,20,v,48
v_accvgpr_write_b32 a67, 0
v_accvgpr_write_b32 a68, 0
MV 100,v,20,v,52
buffer_load_dwordx4 v211, s[44:47], s75 offen offset:3072 lds
v_accvgpr_write_b32 a69, 0
MV 104,v,20,v,56
ds_read_b128 v[68:71], v225 offset:2048
v_accvgpr_write_b32 a70, 0
MV 108,v,20,v,60
TR 20,217,24576
TR 22,217,25600
MV 112,v,24,v,48
s_add_u32 s75, s65, s74
v_accvgpr_write_b32 a71, 0
MV 116,v,24,v,52
v_accvgpr_write_b32 a72, 0
v_accvgpr_write_b32 a73, 0
MV 120,v,24,v,56
v_accvgpr_write_b32 a74, 0
v_accvgpr_write_b32 a75, 0
MV 124,v,24,v,60
TR 24,218,24576
TR 26,218,25600
MV 128,v,28,v,48
ds_read_b128 v[72:75], v225 offset:4096
s_add_u32 m0, s67, 69632
MV 132,v,28,v,52
v_accvgpr_write_b32 a76, 0
v_accvgpr_write_b32 a77, 0
MV 136,v,28,v,56
buffer_load_dwordx4 v208, s[44:47], s75 offen offset:0 lds
v_accvgpr_write_b32 a78, 0
MV 140,v,28,v,60
TR 28,219,24576
TR 30,219,25600
MV 144,v,32,v,48
buffer_load_dwordx4 v209, s[44:47], s75 offen offset:1024 lds
v_accvgpr_write_b32 a79, 0
MV 148,v,32,v,52
s_lshl_b32 s36, s2, 2
s_add_u32 s36, s36, s3
MV 152,v,32,v,56
ds_read_b128 v[76:79], v225 offset:6144
s_lshl_b32 s42, s36, 1
MV 156,v,32,v,60
TR 32,220,24576
TR 34,220,25600
MV 160,v,36,v,48
buffer_load_dwordx4 v210, s[44:47], s75 offen offset:2048 lds
s_lshl_b32 s37, s36, 12
MV 164,v,36,v,52
s_add_u32 s16, s32, s37
s_addc_u32 s17, s33, 0
MV 168,v,36,v,56
buffer_load_dwordx4 v211, s[44:47], s75 offen offset:3072 lds
s_mov_b32 s18, 4096
MV 172,v,36,v,60
TR 36,221,24576
TR 38,221,25600
s_waitcnt lgkmcnt(15)
MV 176,v,40,v,48
s_mov_b32 s19, 0x20000
s_add_u32 s37, s37, 50331648
MV 180,v,40,v,52
s_add_u32 s74, s74, 128
MV 184,v,40,v,56
s_add_u32 s20, s40, s37
s_addc_u32 s21, s41, 0
MV 188,v,40,v,60
TR 40,222,24576
TR 42,222,25600
MV 192,v,44,v,48
s_and_b32 s74, s74, 2047
s_mov_b32 s22, 4096
MV 196,v,44,v,52
s_mov_b32 s23, 0x20000
s_lshl_b32 s37, s2, 14
MV 200,v,44,v,56
s_add_u32 s37, s37, 54525952
MV 204,v,44,v,60
TR 44,223,24576
TR 46,223,25600
s_add_u32 s24, s40, s37
s_addc_u32 s25, s41, 0
s_mov_b32 s26, 16384
s_mov_b32 s27, 0x20000
s_mov_b32 s28, s34
s_mov_b32 s29, s35
s_mov_b32 s30, 2048
s_mov_b32 s31, 0x20000
s_mul_i32 s43, s3, 4608
s_add_u32 s43, s43, 132096
s_waitcnt lgkmcnt(4)
MV 80,v,16,v,64
v_accvgpr_write_b32 a80, 0
MV 84,v,16,v,68
v_accvgpr_write_b32 a81, 0
MV 88,v,16,v,72
MV 92,v,16,v,76
v_accvgpr_write_b32 a82, 0
MV 96,v,20,v,64
MV 100,v,20,v,68
v_accvgpr_write_b32 a83, 0
MV 104,v,20,v,72
MV 108,v,20,v,76
s_waitcnt vmcnt(12) lgkmcnt(0)
s_barrier
MV 112,v,24,v,64
s_load_dwordx2 s[32:33], s[0:1], 88
TR 16,216,32768
MV 116,v,24,v,68
TR 18,216,33792
ds_read_b128 v[48:51], v224 offset:32768
MV 120,v,24,v,72
TR 20,217,32768
TR 22,217,33792
MV 124,v,24,v,76
v_accvgpr_write_b32 a84, 0
v_accvgpr_write_b32 a85, 0
MV 128,v,28,v,64
TR 24,218,32768
TR 26,218,33792
MV 132,v,28,v,68
ds_read_b128 v[52:55], v224 offset:34816
v_accvgpr_write_b32 a86, 0
MV 136,v,28,v,72
v_accvgpr_write_b32 a87, 0
MV 140,v,28,v,76
TR 28,219,32768
TR 30,219,33792
MV 144,v,32,v,64
ds_read_b128 v[56:59], v224 offset:36864
v_accvgpr_write_b32 a88, 0
MV 148,v,32,v,68
v_accvgpr_write_b32 a89, 0
MV 152,v,32,v,72
v_accvgpr_write_b32 a90, 0
MV 156,v,32,v,76
TR 32,220,32768
TR 34,220,33792
MV 160,v,36,v,64
ds_read_b128 v[60:63], v224 offset:38912
v_accvgpr_write_b32 a91, 0
MV 164,v,36,v,68
MV 168,v,36,v,72
v_accvgpr_write_b32 a92, 0
MV 172,v,36,v,76
TR 36,221,32768
TR 38,221,33792
MV 176,v,40,v,64
v_accvgpr_write_b32 a93, 0
MV 180,v,40,v,68
MV 184,v,40,v,72
v_accvgpr_write_b32 a94, 0
MV 188,v,40,v,76
TR 40,222,32768
TR 42,222,33792
MV 192,v,44,v,64
v_accvgpr_write_b32 a95, 0
MV 196,v,44,v,68
MV 200,v,44,v,72
MV 204,v,44,v,76
TR 44,223,32768
TR 46,223,33792
s_waitcnt lgkmcnt(4)
MV 80,v,16,v,48
v_accvgpr_write_b32 a96, 0
MV 84,v,16,v,52
ds_read_b128 v[64:67], v225 offset:32768
v_accvgpr_write_b32 a97, 0
MV 88,v,16,v,56
MV 92,v,16,v,60
TR 16,216,40960
TR 18,216,41984
MV 96,v,20,v,48
v_accvgpr_write_b32 a98, 0
MV 100,v,20,v,52
v_accvgpr_write_b32 a99, 0
MV 104,v,20,v,56
ds_read_b128 v[68:71], v225 offset:34816
MV 108,v,20,v,60
TR 20,217,40960
TR 22,217,41984
MV 112,v,24,v,48
v_accvgpr_write_b32 a100, 0
MV 116,v,24,v,52
v_accvgpr_write_b32 a101, 0
MV 120,v,24,v,56
MV 124,v,24,v,60
TR 24,218,40960
TR 26,218,41984
MV 128,v,28,v,48
ds_read_b128 v[72:75], v225 offset:36864
v_accvgpr_write_b32 a102, 0
MV 132,v,28,v,52
v_accvgpr_write_b32 a103, 0
MV 136,v,28,v,56
MV 140,v,28,v,60
TR 28,219,40960
TR 30,219,41984
MV 144,v,32,v,48
v_accvgpr_write_b32 a104, 0
v_accvgpr_write_b32 a105, 0
MV 148,v,32,v,52
MV 152,v,32,v,56
ds_read_b128 v[76:79], v225 offset:38912
v_accvgpr_write_b32 a106, 0
MV 156,v,32,v,60
TR 32,220,40960
TR 34,220,41984
MV 160,v,36,v,48
v_accvgpr_write_b32 a107, 0
MV 164,v,36,v,52
MV 168,v,36,v,56
v_accvgpr_write_b32 a108, 0
MV 172,v,36,v,60
TR 36,221,40960
TR 38,221,41984
s_waitcnt lgkmcnt(15)
MV 176,v,40,v,48
v_accvgpr_write_b32 a109, 0
MV 180,v,40,v,52
MV 184,v,40,v,56
v_accvgpr_write_b32 a110, 0
MV 188,v,40,v,60
TR 40,222,40960
TR 42,222,41984
MV 192,v,44,v,48
v_accvgpr_write_b32 a111, 0
MV 196,v,44,v,52
MV 200,v,44,v,56
MV 204,v,44,v,60
TR 44,223,40960
TR 46,223,41984
s_waitcnt lgkmcnt(4)
MV 80,v,16,v,64
v_accvgpr_write_b32 a112, 0
MV 84,v,16,v,68
v_accvgpr_write_b32 a113, 0
MV 88,v,16,v,72
MV 92,v,16,v,76
v_accvgpr_write_b32 a114, 0
MV 96,v,20,v,64
MV 100,v,20,v,68
v_accvgpr_write_b32 a115, 0
MV 104,v,20,v,72
MV 108,v,20,v,76
s_waitcnt vmcnt(0) lgkmcnt(0)
s_barrier
MV 112,v,24,v,64
TR 16,216,0
TR 18,216,1024
MV 116,v,24,v,68
ds_read_b128 v[48:51], v226 offset:0
v_accvgpr_write_b32 a116, 0
MV 120,v,24,v,72
TR 20,217,0
TR 22,217,1024
MV 124,v,24,v,76
v_accvgpr_write_b32 a117, 0
v_accvgpr_write_b32 a118, 0
MV 128,v,28,v,64
TR 24,218,0
TR 26,218,1024
MV 132,v,28,v,68
ds_read_b128 v[52:55], v226 offset:2048
v_accvgpr_write_b32 a119, 0
MV 136,v,28,v,72
MV 140,v,28,v,76
TR 28,219,0
TR 30,219,1024
MV 144,v,32,v,64
ds_read_b128 v[56:59], v226 offset:4096
v_accvgpr_write_b32 a120, 0
MV 148,v,32,v,68
v_accvgpr_write_b32 a121, 0
MV 152,v,32,v,72
v_accvgpr_write_b32 a122, 0
MV 156,v,32,v,76
TR 32,220,0
TR 34,220,1024
MV 160,v,36,v,64
ds_read_b128 v[60:63], v226 offset:6144
v_accvgpr_write_b32 a123, 0
MV 164,v,36,v,68
MV 168,v,36,v,72
v_accvgpr_write_b32 a124, 0
MV 172,v,36,v,76
TR 36,221,0
TR 38,221,1024
MV 176,v,40,v,64
v_accvgpr_write_b32 a125, 0
MV 180,v,40,v,68
MV 184,v,40,v,72
v_accvgpr_write_b32 a126, 0
MV 188,v,40,v,76
TR 40,222,0
TR 42,222,1024
MV 192,v,44,v,64
v_accvgpr_write_b32 a127, 0
MV 196,v,44,v,68
MV 200,v,44,v,72
MV 204,v,44,v,76
TR 44,223,0
TR 46,223,1024
s_waitcnt lgkmcnt(4)
MV 80,v,16,v,48
buffer_load_dword v237, v233, s[8:11], 0 offen offset:0 sc1
MV 84,v,16,v,52
ds_read_b128 v[64:67], v227 offset:0
s_lshr_b32 s36, s2, 3
MV 88,v,16,v,56
s_lshl_b32 s36, s36, 18
MV 92,v,16,v,60
TR 16,216,8192
TR 18,216,9216
MV 96,v,20,v,48
s_and_b32 s37, s2, 7
s_lshl_b32 s37, s37, 8
MV 100,v,20,v,52
s_add_u32 s36, s36, s37
MV 104,v,20,v,56
ds_read_b128 v[68:71], v227 offset:2048
s_lshl_b32 s37, s3, 16
MV 108,v,20,v,60
TR 20,217,8192
TR 22,217,9216
MV 112,v,24,v,48
s_add_u32 s36, s36, s37
MV 116,v,24,v,52
s_add_u32 s32, s32, s36
s_addc_u32 s33, s33, 0
MV 120,v,24,v,56
MV 124,v,24,v,60
TR 24,218,8192
TR 26,218,9216
MV 128,v,28,v,48
ds_read_b128 v[72:75], v227 offset:4096
s_mov_b32 s34, 65536
MV 132,v,28,v,52
s_mov_b32 s35, 0x20000
v_lshrrev_b32 v238, 4, v1
MV 136,v,28,v,56
MV 140,v,28,v,60
TR 28,219,8192
TR 30,219,9216
MV 144,v,32,v,48
v_and_b32 v239, 15, v1
v_lshlrev_b32 v240, 1, v238
MV 148,v,32,v,52
v_xor_b32 v239, v239, v240
MV 152,v,32,v,56
ds_read_b128 v[76:79], v227 offset:6144
v_lshlrev_b32 v238, 11, v238
MV 156,v,32,v,60
TR 32,220,8192
TR 34,220,9216
MV 160,v,36,v,48
v_lshl_add_u32 v238, v239, 4, v238
v_xor_b32 v239, 128, v238
MV 164,v,36,v,52
s_lshl_b32 s36, s3, 13
MV 168,v,36,v,56
MV 172,v,36,v,60
TR 36,221,8192
TR 38,221,9216
s_waitcnt lgkmcnt(15)
MV 176,v,40,v,48
s_add_u32 m0, s36, 131072
s_mov_b32 s37, 0
MV 180,v,40,v,52
buffer_load_dwordx4 v238, s[32:35], s37 offen offset:0 lds
MV 184,v,40,v,56
s_mov_b32 s37, 7168
MV 188,v,40,v,60
TR 40,222,8192
TR 42,222,9216
MV 192,v,44,v,48
buffer_load_dwordx4 v239, s[32:35], s37 offen offset:1024 lds
s_mov_b32 s37, 14336
MV 196,v,44,v,52
MV 200,v,44,v,56
MV 204,v,44,v,60
TR 44,223,8192
TR 46,223,9216
s_waitcnt lgkmcnt(4)
MV 80,v,16,v,64
buffer_load_dwordx4 v238, s[32:35], s37 offen offset:2048 lds
MV 84,v,16,v,68
MV 88,v,16,v,72
s_mov_b32 s37, 21504
MV 92,v,16,v,76
MV 96,v,20,v,64
MV 100,v,20,v,68
buffer_load_dwordx4 v239, s[32:35], s37 offen offset:3072 lds
MV 104,v,20,v,72
MV 108,v,20,v,76
s_add_u32 m0, s36, 135168
MV 112,v,24,v,64
MV 116,v,24,v,68
MV 120,v,24,v,72
s_mov_b32 s37, 32768
MV 124,v,24,v,76
MV 128,v,28,v,64
buffer_load_dwordx4 v238, s[32:35], s37 offen offset:0 lds
MV 132,v,28,v,68
MV 136,v,28,v,72
MV 140,v,28,v,76
s_mov_b32 s37, 39936
MV 144,v,32,v,64
MV 148,v,32,v,68
buffer_load_dwordx4 v239, s[32:35], s37 offen offset:1024 lds
MV 152,v,32,v,72
MV 156,v,32,v,76
MV 160,v,36,v,64
s_mov_b32 s37, 47104
MV 164,v,36,v,68
MV 168,v,36,v,72
buffer_load_dwordx4 v238, s[32:35], s37 offen offset:2048 lds
MV 172,v,36,v,76
s_waitcnt lgkmcnt(2)
MV 176,v,40,v,64
MV 180,v,40,v,68
s_mov_b32 s37, 54272
MV 184,v,40,v,72
MV 188,v,40,v,76
buffer_load_dwordx4 v239, s[32:35], s37 offen offset:3072 lds
s_waitcnt lgkmcnt(0)
MV 192,v,44,v,64
MV 196,v,44,v,68
MV 200,v,44,v,72
MV 204,v,44,v,76
s_waitcnt vmcnt(8)
v_cmp_gt_u32 vcc, 1, v237
s_nop 4
s_cbranch_vccnz L_spin_f1
L_spin_f1_ret:
s_waitcnt lgkmcnt(0)
s_barrier
s_add_u32 m0, s68, 16384
s_mov_b32 s80, 0
buffer_load_dwordx4 v12, s[52:55], s80 offen offset:0 sc1 lds
buffer_load_dwordx4 v12, s[52:55], s80 offen offset:1024 sc1 lds
buffer_load_dwordx4 v12, s[52:55], s80 offen offset:2048 sc1 lds
buffer_load_dwordx4 v12, s[52:55], s80 offen offset:3072 sc1 lds
s_add_u32 m0, s68, 32768
s_mov_b32 s80, 16384
buffer_load_dwordx4 v12, s[52:55], s80 offen offset:0 sc1 lds
buffer_load_dwordx4 v12, s[52:55], s80 offen offset:1024 sc1 lds
buffer_load_dwordx4 v12, s[52:55], s80 offen offset:2048 sc1 lds
buffer_load_dwordx4 v12, s[52:55], s80 offen offset:3072 sc1 lds
s_mov_b32 s82, 0x3e0293ee
s_mov_b32 s83, 0x3e0293ee
v_pk_mul_f32 v[80:81], v[80:81], s[82:83]
v_pk_mul_f32 v[82:83], v[82:83], s[82:83]
v_pk_mul_f32 v[84:85], v[84:85], s[82:83]
v_pk_mul_f32 v[86:87], v[86:87], s[82:83]
s_add_u32 m0, s68, 81920
v_pk_mul_f32 v[88:89], v[88:89], s[82:83]
v_pk_mul_f32 v[90:91], v[90:91], s[82:83]
v_pk_mul_f32 v[92:93], v[92:93], s[82:83]
v_pk_mul_f32 v[94:95], v[94:95], s[82:83]
v_pk_mul_f32 v[96:97], v[96:97], s[82:83]
v_pk_mul_f32 v[98:99], v[98:99], s[82:83]
v_pk_mul_f32 v[100:101], v[100:101], s[82:83]
s_mov_b32 s80, 16384
v_pk_mul_f32 v[102:103], v[102:103], s[82:83]
v_pk_mul_f32 v[104:105], v[104:105], s[82:83]
v_pk_mul_f32 v[106:107], v[106:107], s[82:83]
v_pk_mul_f32 v[108:109], v[108:109], s[82:83]
v_pk_mul_f32 v[110:111], v[110:111], s[82:83]
v_cvt_pk_bf16_f32 v16, v80, v81
buffer_load_dwordx4 v12, s[56:59], s80 offen offset:0 sc1 lds
v_cvt_pk_bf16_f32 v17, v82, v83
v_cvt_pk_bf16_f32 v18, v96, v97
v_cvt_pk_bf16_f32 v19, v98, v99
v_cvt_pk_bf16_f32 v20, v84, v85
v_cvt_pk_bf16_f32 v21, v86, v87
v_cvt_pk_bf16_f32 v22, v100, v101
v_cvt_pk_bf16_f32 v23, v102, v103
buffer_load_dwordx4 v12, s[56:59], s80 offen offset:1024 sc1 lds
v_cvt_pk_bf16_f32 v48, v88, v89
v_cvt_pk_bf16_f32 v49, v90, v91
v_cvt_pk_bf16_f32 v50, v104, v105
v_cvt_pk_bf16_f32 v51, v106, v107
v_cvt_pk_bf16_f32 v52, v92, v93
v_cvt_pk_bf16_f32 v53, v94, v95
v_cvt_pk_bf16_f32 v54, v108, v109
buffer_load_dwordx4 v12, s[56:59], s80 offen offset:2048 sc1 lds
v_cvt_pk_bf16_f32 v55, v110, v111
v_permlane16_swap_b32 v16, v20
v_permlane16_swap_b32 v17, v21
v_permlane16_swap_b32 v18, v22
v_permlane16_swap_b32 v19, v23
v_permlane16_swap_b32 v48, v52
buffer_load_dwordx4 v12, s[56:59], s80 offen offset:3072 sc1 lds
v_permlane16_swap_b32 v49, v53
v_permlane16_swap_b32 v50, v54
v_permlane16_swap_b32 v51, v55
v_pk_mul_f32 v[112:113], v[112:113], s[82:83]
v_pk_mul_f32 v[114:115], v[114:115], s[82:83]
v_pk_mul_f32 v[116:117], v[116:117], s[82:83]
v_pk_mul_f32 v[118:119], v[118:119], s[82:83]
s_add_u32 m0, s68, 49152
v_pk_mul_f32 v[120:121], v[120:121], s[82:83]
v_pk_mul_f32 v[122:123], v[122:123], s[82:83]
v_pk_mul_f32 v[124:125], v[124:125], s[82:83]
v_pk_mul_f32 v[126:127], v[126:127], s[82:83]
v_pk_mul_f32 v[128:129], v[128:129], s[82:83]
v_pk_mul_f32 v[130:131], v[130:131], s[82:83]
v_pk_mul_f32 v[132:133], v[132:133], s[82:83]
s_mov_b32 s80, 32768
v_pk_mul_f32 v[134:135], v[134:135], s[82:83]
v_pk_mul_f32 v[136:137], v[136:137], s[82:83]
v_pk_mul_f32 v[138:139], v[138:139], s[82:83]
v_pk_mul_f32 v[140:141], v[140:141], s[82:83]
v_pk_mul_f32 v[142:143], v[142:143], s[82:83]
v_cvt_pk_bf16_f32 v24, v112, v113
buffer_load_dwordx4 v12, s[52:55], s80 offen offset:0 sc1 lds
v_cvt_pk_bf16_f32 v25, v114, v115
v_cvt_pk_bf16_f32 v26, v128, v129
v_cvt_pk_bf16_f32 v27, v130, v131
v_cvt_pk_bf16_f32 v28, v116, v117
v_cvt_pk_bf16_f32 v29, v118, v119
v_cvt_pk_bf16_f32 v30, v132, v133
v_cvt_pk_bf16_f32 v31, v134, v135
buffer_load_dwordx4 v12, s[52:55], s80 offen offset:1024 sc1 lds
v_cvt_pk_bf16_f32 v56, v120, v121
v_cvt_pk_bf16_f32 v57, v122, v123
v_cvt_pk_bf16_f32 v58, v136, v137
v_cvt_pk_bf16_f32 v59, v138, v139
v_cvt_pk_bf16_f32 v60, v124, v125
v_cvt_pk_bf16_f32 v61, v126, v127
buffer_load_dwordx4 v12, s[52:55], s80 offen offset:2048 sc1 lds
v_cvt_pk_bf16_f32 v62, v140, v141
v_cvt_pk_bf16_f32 v63, v142, v143
v_permlane16_swap_b32 v24, v28
v_permlane16_swap_b32 v25, v29
v_permlane16_swap_b32 v26, v30
v_permlane16_swap_b32 v27, v31
v_permlane16_swap_b32 v56, v60
buffer_load_dwordx4 v12, s[52:55], s80 offen offset:3072 sc1 lds
v_permlane16_swap_b32 v57, v61
v_permlane16_swap_b32 v58, v62
v_permlane16_swap_b32 v59, v63
v_pk_mul_f32 v[144:145], v[144:145], s[82:83]
v_pk_mul_f32 v[146:147], v[146:147], s[82:83]
v_pk_mul_f32 v[148:149], v[148:149], s[82:83]
v_pk_mul_f32 v[150:151], v[150:151], s[82:83]
s_add_u32 m0, s68, 98304
v_pk_mul_f32 v[152:153], v[152:153], s[82:83]
v_pk_mul_f32 v[154:155], v[154:155], s[82:83]
v_pk_mul_f32 v[156:157], v[156:157], s[82:83]
v_pk_mul_f32 v[158:159], v[158:159], s[82:83]
v_pk_mul_f32 v[160:161], v[160:161], s[82:83]
v_pk_mul_f32 v[162:163], v[162:163], s[82:83]
s_mov_b32 s80, 32768
v_pk_mul_f32 v[164:165], v[164:165], s[82:83]
v_pk_mul_f32 v[166:167], v[166:167], s[82:83]
v_pk_mul_f32 v[168:169], v[168:169], s[82:83]
v_pk_mul_f32 v[170:171], v[170:171], s[82:83]
v_pk_mul_f32 v[172:173], v[172:173], s[82:83]
v_pk_mul_f32 v[174:175], v[174:175], s[82:83]
v_cvt_pk_bf16_f32 v32, v144, v145
buffer_load_dwordx4 v12, s[56:59], s80 offen offset:0 sc1 lds
v_cvt_pk_bf16_f32 v33, v146, v147
v_cvt_pk_bf16_f32 v34, v160, v161
v_cvt_pk_bf16_f32 v35, v162, v163
v_cvt_pk_bf16_f32 v36, v148, v149
v_cvt_pk_bf16_f32 v37, v150, v151
v_cvt_pk_bf16_f32 v38, v164, v165
v_cvt_pk_bf16_f32 v39, v166, v167
buffer_load_dwordx4 v12, s[56:59], s80 offen offset:1024 sc1 lds
v_cvt_pk_bf16_f32 v64, v152, v153
v_cvt_pk_bf16_f32 v65, v154, v155
v_cvt_pk_bf16_f32 v66, v168, v169
v_cvt_pk_bf16_f32 v67, v170, v171
v_cvt_pk_bf16_f32 v68, v156, v157
v_cvt_pk_bf16_f32 v69, v158, v159
buffer_load_dwordx4 v12, s[56:59], s80 offen offset:2048 sc1 lds
v_cvt_pk_bf16_f32 v70, v172, v173
v_cvt_pk_bf16_f32 v71, v174, v175
v_permlane16_swap_b32 v32, v36
v_permlane16_swap_b32 v33, v37
v_permlane16_swap_b32 v34, v38
v_permlane16_swap_b32 v35, v39
v_permlane16_swap_b32 v64, v68
buffer_load_dwordx4 v12, s[56:59], s80 offen offset:3072 sc1 lds
v_permlane16_swap_b32 v65, v69
v_permlane16_swap_b32 v66, v70
v_permlane16_swap_b32 v67, v71
v_pk_mul_f32 v[176:177], v[176:177], s[82:83]
v_pk_mul_f32 v[178:179], v[178:179], s[82:83]
v_pk_mul_f32 v[180:181], v[180:181], s[82:83]
v_pk_mul_f32 v[182:183], v[182:183], s[82:83]
s_add_u32 m0, s68, 0
v_pk_mul_f32 v[184:185], v[184:185], s[82:83]
v_pk_mul_f32 v[186:187], v[186:187], s[82:83]
v_pk_mul_f32 v[188:189], v[188:189], s[82:83]
v_pk_mul_f32 v[190:191], v[190:191], s[82:83]
v_pk_mul_f32 v[192:193], v[192:193], s[82:83]
v_pk_mul_f32 v[194:195], v[194:195], s[82:83]
s_mov_b32 s80, 49152
v_pk_mul_f32 v[196:197], v[196:197], s[82:83]
v_pk_mul_f32 v[198:199], v[198:199], s[82:83]
v_pk_mul_f32 v[200:201], v[200:201], s[82:83]
v_pk_mul_f32 v[202:203], v[202:203], s[82:83]
v_pk_mul_f32 v[204:205], v[204:205], s[82:83]
v_pk_mul_f32 v[206:207], v[206:207], s[82:83]
v_cvt_pk_bf16_f32 v40, v176, v177
buffer_load_dwordx4 v12, s[52:55], s80 offen offset:0 sc1 lds
v_cvt_pk_bf16_f32 v41, v178, v179
v_cvt_pk_bf16_f32 v42, v192, v193
v_cvt_pk_bf16_f32 v43, v194, v195
v_cvt_pk_bf16_f32 v44, v180, v181
v_cvt_pk_bf16_f32 v45, v182, v183
v_cvt_pk_bf16_f32 v46, v196, v197
buffer_load_dwordx4 v12, s[52:55], s80 offen offset:1024 sc1 lds
v_cvt_pk_bf16_f32 v47, v198, v199
v_cvt_pk_bf16_f32 v72, v184, v185
v_cvt_pk_bf16_f32 v73, v186, v187
v_cvt_pk_bf16_f32 v74, v200, v201
v_cvt_pk_bf16_f32 v75, v202, v203
v_cvt_pk_bf16_f32 v76, v188, v189
v_cvt_pk_bf16_f32 v77, v190, v191
buffer_load_dwordx4 v12, s[52:55], s80 offen offset:2048 sc1 lds
v_cvt_pk_bf16_f32 v78, v204, v205
v_cvt_pk_bf16_f32 v79, v206, v207
v_permlane16_swap_b32 v40, v44
v_permlane16_swap_b32 v41, v45
v_permlane16_swap_b32 v42, v46
v_permlane16_swap_b32 v43, v47
v_permlane16_swap_b32 v72, v76
buffer_load_dwordx4 v12, s[52:55], s80 offen offset:3072 sc1 lds
v_permlane16_swap_b32 v73, v77
v_permlane16_swap_b32 v74, v78
v_permlane16_swap_b32 v75, v79
v_mov_b32 v208, 0
v_mov_b32 v209, 0
v_mov_b32 v210, 0
s_add_u32 m0, s68, 114688
v_mov_b32 v211, 0
v_mov_b32 v212, 0
v_mov_b32 v213, 0
v_mov_b32 v214, 0
v_mov_b32 v215, 0
v_mov_b32 v216, 0
v_mov_b32 v217, 0
s_mov_b32 s80, 49152
v_mov_b32 v218, 0
v_mov_b32 v219, 0
v_mov_b32 v220, 0
v_mov_b32 v221, 0
v_mov_b32 v222, 0
v_mov_b32 v223, 0
v_mov_b32 v224, 0
buffer_load_dwordx4 v12, s[56:59], s80 offen offset:0 sc1 lds
v_mov_b32 v225, 0
v_mov_b32 v226, 0
v_mov_b32 v227, 0
v_mov_b32 v228, 0
v_mov_b32 v229, 0
v_mov_b32 v230, 0
buffer_load_dwordx4 v12, s[56:59], s80 offen offset:1024 sc1 lds
v_mov_b32 v231, 0
v_mov_b32 v232, 0
v_mov_b32 v233, 0
v_mov_b32 v234, 0
v_mov_b32 v235, 0
v_mov_b32 v236, 0
v_mov_b32 v237, 0
buffer_load_dwordx4 v12, s[56:59], s80 offen offset:2048 sc1 lds
v_mov_b32 v238, 0
v_mov_b32 v239, 0
v_mov_b32 v2, 0
v_mov_b32 v3, 0
v_mov_b32 v4, 0
v_mov_b32 v5, 0
v_xor_b32 v244, 0x8000, v10
buffer_load_dwordx4 v12, s[56:59], s80 offen offset:3072 sc1 lds
s_waitcnt vmcnt(24)
s_barrier
ds_read_b128 a[128:131], v244 offset:16384
ds_read_b128 a[132:135], v244 offset:17408
ds_read_b128 a[136:139], v244 offset:18432
ds_read_b128 a[140:143], v244 offset:19456
ds_read_b128 a[144:147], v244 offset:20480
ds_read_b128 a[148:151], v244 offset:21504
ds_read_b128 a[152:155], v244 offset:22528
ds_read_b128 a[156:159], v244 offset:23552
ds_read_b128 a[160:163], v244 offset:24576
ds_read_b128 a[164:167], v244 offset:25600
ds_read_b128 a[168:171], v244 offset:26624
ds_read_b128 a[172:175], v244 offset:27648
ds_read_b128 a[176:179], v244 offset:28672
ds_read_b128 a[180:183], v244 offset:29696
ds_read_b128 a[184:187], v244 offset:30720
ds_read_b128 a[188:191], v244 offset:31744
s_waitcnt lgkmcnt(15)
v_mfma_f32_32x32x16_bf16 v[80:95], a[128:131], v[16:19], 0
v_mfma_f32_32x32x16_bf16 v[96:111], a[128:131], v[48:51], 0
s_waitcnt lgkmcnt(14)
v_mfma_f32_32x32x16_bf16 v[80:95], a[132:135], v[20:23], v[80:95]
v_mfma_f32_32x32x16_bf16 v[96:111], a[132:135], v[52:55], v[96:111]
s_waitcnt lgkmcnt(13)
v_mfma_f32_32x32x16_bf16 v[80:95], a[136:139], v[24:27], v[80:95]
v_mfma_f32_32x32x16_bf16 v[96:111], a[136:139], v[56:59], v[96:111]
s_waitcnt lgkmcnt(12)
v_mfma_f32_32x32x16_bf16 v[80:95], a[140:143], v[28:31], v[80:95]
v_mfma_f32_32x32x16_bf16 v[96:111], a[140:143], v[60:63], v[96:111]
s_waitcnt lgkmcnt(11)
v_mfma_f32_32x32x16_bf16 v[80:95], a[144:147], v[32:35], v[80:95]
v_mfma_f32_32x32x16_bf16 v[96:111], a[144:147], v[64:67], v[96:111]
s_waitcnt lgkmcnt(10)
v_mfma_f32_32x32x16_bf16 v[80:95], a[148:151], v[36:39], v[80:95]
v_mfma_f32_32x32x16_bf16 v[96:111], a[148:151], v[68:71], v[96:111]
s_waitcnt lgkmcnt(9)
v_mfma_f32_32x32x16_bf16 v[80:95], a[152:155], v[40:43], v[80:95]
v_mfma_f32_32x32x16_bf16 v[96:111], a[152:155], v[72:75], v[96:111]
s_waitcnt vmcnt(16) lgkmcnt(0)
s_barrier
v_mfma_f32_32x32x16_bf16 v[80:95], a[156:159], v[44:47], v[80:95]
ds_read_b128 a[128:131], v10 offset:0
ds_read_b128 a[132:135], v10 offset:1024
s_add_u32 m0, s68, 16384
v_mfma_f32_32x32x16_bf16 v[96:111], a[156:159], v[76:79], v[96:111]
ds_read_b128 a[136:139], v10 offset:2048
ds_read_b128 a[140:143], v10 offset:3072
v_mfma_f32_32x32x16_bf16 v[112:127], a[160:163], v[16:19], 0
ds_read_b128 a[144:147], v10 offset:4096
ds_read_b128 a[148:151], v10 offset:5120
s_mov_b32 s80, 65536
v_mfma_f32_32x32x16_bf16 v[128:143], a[160:163], v[48:51], 0
ds_read_b128 a[152:155], v10 offset:6144
ds_read_b128 a[156:159], v10 offset:7168
v_mfma_f32_32x32x16_bf16 v[112:127], a[164:167], v[20:23], v[112:127]
ds_read_b128 a[160:163], v10 offset:8192
buffer_load_dwordx4 v12, s[52:55], s80 offen offset:0 sc1 lds
v_mfma_f32_32x32x16_bf16 v[128:143], a[164:167], v[52:55], v[128:143]
ds_read_b128 a[164:167], v10 offset:9216
v_mfma_f32_32x32x16_bf16 v[112:127], a[168:171], v[24:27], v[112:127]
v_mfma_f32_32x32x16_bf16 v[128:143], a[168:171], v[56:59], v[128:143]
ds_read_b128 a[168:171], v10 offset:10240
buffer_load_dwordx4 v12, s[52:55], s80 offen offset:1024 sc1 lds
v_mfma_f32_32x32x16_bf16 v[112:127], a[172:175], v[28:31], v[112:127]
v_mfma_f32_32x32x16_bf16 v[128:143], a[172:175], v[60:63], v[128:143]
ds_read_b128 a[172:175], v10 offset:11264
buffer_load_dwordx4 v12, s[52:55], s80 offen offset:2048 sc1 lds
v_mfma_f32_32x32x16_bf16 v[112:127], a[176:179], v[32:35], v[112:127]
v_mfma_f32_32x32x16_bf16 v[128:143], a[176:179], v[64:67], v[128:143]
ds_read_b128 a[176:179], v10 offset:12288
v_mfma_f32_32x32x16_bf16 v[112:127], a[180:183], v[36:39], v[112:127]
buffer_load_dwordx4 v12, s[52:55], s80 offen offset:3072 sc1 lds
v_mfma_f32_32x32x16_bf16 v[128:143], a[180:183], v[68:71], v[128:143]
ds_read_b128 a[180:183], v10 offset:13312
v_mfma_f32_32x32x16_bf16 v[112:127], a[184:187], v[40:43], v[112:127]
s_mov_b32 s71, 65536
v_mfma_f32_32x32x16_bf16 v[128:143], a[184:187], v[72:75], v[128:143]
ds_read_b128 a[184:187], v10 offset:14336
v_mfma_f32_32x32x16_bf16 v[112:127], a[188:191], v[44:47], v[112:127]
v_mfma_f32_32x32x16_bf16 v[128:143], a[188:191], v[76:79], v[128:143]
ds_read_b128 a[188:191], v10 offset:15360
s_cmp_eq_u32 s70, 0
s_cbranch_scc1 L_p3_pmask
L_p3_pmask_ret:
v_max3_f32 v6, v80, v81, v82
v_max3_f32 v7, v96, v97, v98
v_max3_f32 v6, v6, v83, v84
v_max3_f32 v7, v7, v99, v100
v_max3_f32 v6, v6, v85, v86
v_max3_f32 v7, v7, v101, v102
v_max3_f32 v6, v6, v87, v88
v_max3_f32 v7, v7, v103, v104
v_max3_f32 v6, v6, v89, v90
v_max3_f32 v7, v7, v105, v106
v_max3_f32 v6, v6, v91, v92
v_max3_f32 v7, v7, v107, v108
v_max3_f32 v6, v6, v93, v94
v_max3_f32 v7, v7, v109, v110
v_max3_f32 v6, v6, v95, v112
v_max3_f32 v7, v7, v111, v128
v_max3_f32 v6, v6, v113, v114
v_max3_f32 v7, v7, v129, v130
v_max3_f32 v6, v6, v115, v116
v_max3_f32 v7, v7, v131, v132
v_max3_f32 v6, v6, v117, v118
v_max3_f32 v7, v7, v133, v134
v_max3_f32 v6, v6, v119, v120
v_max3_f32 v7, v7, v135, v136
v_max3_f32 v6, v6, v121, v122
v_max3_f32 v7, v7, v137, v138
v_max3_f32 v6, v6, v123, v124
v_max3_f32 v7, v7, v139, v140
v_max3_f32 v6, v6, v125, v126
v_max3_f32 v7, v7, v141, v142
v_max_f32 v6, v6, v127
v_max_f32 v7, v7, v143
v_mov_b32 v240, v6
v_mov_b32 v241, v7
s_nop 0
v_permlane32_swap_b32 v6, v240
v_permlane32_swap_b32 v7, v241
v_max_f32 v6, v6, v240
v_max_f32 v7, v7, v241
v_max_f32 v240, abs(v6), abs(v7)
v_cmp_nge_f32 vcc, s79, v240
s_nop 4
s_cbranch_vccnz L_p3_pfix
L_p3_pfix_ret:
v_exp_f32 v80, v80
v_exp_f32 v81, v81
v_exp_f32 v82, v82
v_add_f32 v2, v2, v80
v_exp_f32 v83, v83
v_add_f32 v3, v3, v81
v_cvt_pk_bf16_f32 v80, v80, v81
v_exp_f32 v84, v84
v_add_f32 v2, v2, v82
v_exp_f32 v85, v85
v_add_f32 v3, v3, v83
v_cvt_pk_bf16_f32 v81, v82, v83
v_exp_f32 v86, v86
v_add_f32 v2, v2, v84
v_exp_f32 v87, v87
v_add_f32 v3, v3, v85
v_cvt_pk_bf16_f32 v82, v84, v85
v_exp_f32 v88, v88
v_add_f32 v2, v2, v86
v_exp_f32 v89, v89
v_add_f32 v3, v3, v87
v_cvt_pk_bf16_f32 v83, v86, v87
v_exp_f32 v90, v90
v_add_f32 v2, v2, v88
v_exp_f32 v91, v91
v_add_f32 v3, v3, v89
v_cvt_pk_bf16_f32 v88, v88, v89
v_exp_f32 v92, v92
v_add_f32 v2, v2, v90
v_exp_f32 v93, v93
v_add_f32 v3, v3, v91
v_cvt_pk_bf16_f32 v89, v90, v91
v_exp_f32 v94, v94
v_add_f32 v2, v2, v92
v_exp_f32 v95, v95
v_add_f32 v3, v3, v93
v_cvt_pk_bf16_f32 v90, v92, v93
v_exp_f32 v96, v96
v_add_f32 v2, v2, v94
v_exp_f32 v97, v97
v_add_f32 v3, v3, v95
v_cvt_pk_bf16_f32 v91, v94, v95
v_exp_f32 v98, v98
v_add_f32 v4, v4, v96
v_exp_f32 v99, v99
v_add_f32 v5, v5, v97
v_cvt_pk_bf16_f32 v96, v96, v97
v_exp_f32 v100, v100
v_add_f32 v4, v4, v98
v_exp_f32 v101, v101
v_add_f32 v5, v5, v99
v_cvt_pk_bf16_f32 v97, v98, v99
v_exp_f32 v102, v102
v_add_f32 v4, v4, v100
v_exp_f32 v103, v103
v_add_f32 v5, v5, v101
v_cvt_pk_bf16_f32 v98, v100, v101
v_add_f32 v4, v4, v102
v_add_f32 v5, v5, v103
v_cvt_pk_bf16_f32 v99, v102, v103
s_sub_u32 s74, s70, 1
s_cbranch_scc1 L_p3_d0m_top
.p2align 5
L_p3_d0_top:
s_waitcnt lgkmcnt(0)
v_mfma_f32_32x32x16_bf16 v[144:159], a[128:131], v[16:19], v[208:223]
s_add_u32 m0, s73, 0
ds_read_b128 a[192:195], v11 offset:16384
v_exp_f32 v104, v104
v_exp_f32 v105, v105
v_mfma_f32_32x32x16_bf16 v[160:175], a[128:131], v[48:51], v[224:239]
ds_read_b128 a[196:199], v11 offset:17408
buffer_load_dwordx4 v12, s[56:59], s71 offen offset:0 sc1 lds
v_exp_f32 v106, v106
v_add_f32 v4, v4, v104
v_mfma_f32_32x32x16_bf16 v[144:159], a[132:135], v[20:23], v[144:159]
ds_read_b128 a[200:203], v11 offset:18432
v_exp_f32 v107, v107
v_add_f32 v5, v5, v105
v_cvt_pk_bf16_f32 v104, v104, v105
v_mfma_f32_32x32x16_bf16 v[160:175], a[132:135], v[52:55], v[160:175]
v_exp_f32 v108, v108
v_add_f32 v4, v4, v106
v_exp_f32 v109, v109
v_add_f32 v5, v5, v107
v_mfma_f32_32x32x16_bf16 v[144:159], a[136:139], v[24:27], v[144:159]
ds_read_b128 a[204:207], v11 offset:19456
v_cvt_pk_bf16_f32 v105, v106, v107
v_exp_f32 v110, v110
v_add_f32 v4, v4, v108
v_mfma_f32_32x32x16_bf16 v[160:175], a[136:139], v[56:59], v[160:175]
ds_read_b128 a[208:211], v11 offset:20480
v_exp_f32 v111, v111
v_add_f32 v5, v5, v109
v_cvt_pk_bf16_f32 v106, v108, v109
v_mfma_f32_32x32x16_bf16 v[144:159], a[140:143], v[28:31], v[144:159]
ds_read_b128 a[212:215], v11 offset:21504
v_exp_f32 v112, v112
v_add_f32 v4, v4, v110
v_exp_f32 v113, v113
v_mfma_f32_32x32x16_bf16 v[160:175], a[140:143], v[60:63], v[160:175]
buffer_load_dwordx4 v12, s[56:59], s71 offen offset:1024 sc1 lds
v_add_f32 v5, v5, v111
v_cvt_pk_bf16_f32 v107, v110, v111
v_exp_f32 v114, v114
v_add_f32 v2, v2, v112
v_mfma_f32_32x32x16_bf16 v[144:159], a[144:147], v[32:35], v[144:159]
ds_read_b128 a[216:219], v11 offset:22528
v_exp_f32 v115, v115
v_add_f32 v3, v3, v113
v_cvt_pk_bf16_f32 v112, v112, v113
v_mfma_f32_32x32x16_bf16 v[160:175], a[144:147], v[64:67], v[160:175]
ds_read_b128 a[220:223], v11 offset:23552
v_exp_f32 v116, v116
v_add_f32 v2, v2, v114
v_exp_f32 v117, v117
v_mfma_f32_32x32x16_bf16 v[144:159], a[148:151], v[36:39], v[144:159]
v_add_f32 v3, v3, v115
v_cvt_pk_bf16_f32 v113, v114, v115
v_exp_f32 v118, v118
v_add_f32 v2, v2, v116
v_mfma_f32_32x32x16_bf16 v[160:175], a[148:151], v[68:71], v[160:175]
ds_read_b128 a[224:227], v11 offset:24576
v_exp_f32 v119, v119
v_add_f32 v3, v3, v117
v_cvt_pk_bf16_f32 v114, v116, v117
v_mfma_f32_32x32x16_bf16 v[144:159], a[152:155], v[40:43], v[144:159]
ds_read_b128 a[228:231], v11 offset:25600
v_exp_f32 v120, v120
v_add_f32 v2, v2, v118
v_exp_f32 v121, v121
v_mfma_f32_32x32x16_bf16 v[160:175], a[152:155], v[72:75], v[160:175]
ds_read_b128 a[232:235], v11 offset:26624
buffer_load_dwordx4 v12, s[56:59], s71 offen offset:2048 sc1 lds
v_add_f32 v3, v3, v119
v_cvt_pk_bf16_f32 v115, v118, v119
v_exp_f32 v122, v122
v_mfma_f32_32x32x16_bf16 v[144:159], a[156:159], v[44:47], v[144:159]
v_add_f32 v2, v2, v120
v_exp_f32 v123, v123
v_add_f32 v3, v3, v121
v_mfma_f32_32x32x16_bf16 v[160:175], a[156:159], v[76:79], v[160:175]
ds_read_b128 a[236:239], v11 offset:27648
v_cvt_pk_bf16_f32 v120, v120, v121
v_exp_f32 v124, v124
v_add_f32 v2, v2, v122
v_mfma_f32_32x32x16_bf16 v[176:191], a[160:163], v[16:19], v[208:223]
ds_read_b128 a[240:243], v11 offset:28672
v_exp_f32 v125, v125
v_add_f32 v3, v3, v123
v_cvt_pk_bf16_f32 v121, v122, v123
v_mfma_f32_32x32x16_bf16 v[192:207], a[160:163], v[48:51], v[224:239]
ds_read_b128 a[244:247], v11 offset:29696
v_exp_f32 v126, v126
v_add_f32 v2, v2, v124
v_exp_f32 v127, v127
v_mfma_f32_32x32x16_bf16 v[176:191], a[164:167], v[20:23], v[176:191]
v_add_f32 v3, v3, v125
v_cvt_pk_bf16_f32 v122, v124, v125
v_exp_f32 v128, v128
v_add_f32 v2, v2, v126
v_mfma_f32_32x32x16_bf16 v[192:207], a[164:167], v[52:55], v[192:207]
ds_read_b128 a[248:251], v11 offset:30720
buffer_load_dwordx4 v12, s[56:59], s71 offen offset:3072 sc1 lds
v_exp_f32 v129, v129
v_add_f32 v3, v3, v127
v_cvt_pk_bf16_f32 v123, v126, v127
v_mfma_f32_32x32x16_bf16 v[176:191], a[168:171], v[24:27], v[176:191]
ds_read_b128 a[252:255], v11 offset:31744
v_exp_f32 v130, v130
v_add_f32 v4, v4, v128
v_exp_f32 v131, v131
v_mfma_f32_32x32x16_bf16 v[192:207], a[168:171], v[56:59], v[192:207]
v_add_f32 v5, v5, v129
v_cvt_pk_bf16_f32 v128, v128, v129
v_exp_f32 v132, v132
v_mfma_f32_32x32x16_bf16 v[176:191], a[172:175], v[28:31], v[176:191]
v_add_f32 v4, v4, v130
v_exp_f32 v133, v133
v_add_f32 v5, v5, v131
v_mfma_f32_32x32x16_bf16 v[192:207], a[172:175], v[60:63], v[192:207]
v_cvt_pk_bf16_f32 v129, v130, v131
v_exp_f32 v134, v134
v_add_f32 v4, v4, v132
v_mfma_f32_32x32x16_bf16 v[176:191], a[176:179], v[32:35], v[176:191]
v_exp_f32 v135, v135
v_add_f32 v5, v5, v133
v_cvt_pk_bf16_f32 v130, v132, v133
v_exp_f32 v136, v136
v_mfma_f32_32x32x16_bf16 v[192:207], a[176:179], v[64:67], v[192:207]
s_add_u32 s71, s71, 16384
v_add_f32 v4, v4, v134
v_exp_f32 v137, v137
v_mfma_f32_32x32x16_bf16 v[176:191], a[180:183], v[36:39], v[176:191]
v_add_f32 v5, v5, v135
v_cvt_pk_bf16_f32 v131, v134, v135
v_exp_f32 v138, v138
v_add_f32 v4, v4, v136
v_mfma_f32_32x32x16_bf16 v[192:207], a[180:183], v[68:71], v[192:207]
v_exp_f32 v139, v139
v_add_f32 v5, v5, v137
v_cvt_pk_bf16_f32 v136, v136, v137
v_mfma_f32_32x32x16_bf16 v[176:191], a[184:187], v[40:43], v[176:191]
v_exp_f32 v140, v140
v_add_f32 v4, v4, v138
v_exp_f32 v141, v141
v_mfma_f32_32x32x16_bf16 v[192:207], a[184:187], v[72:75], v[192:207]
v_add_f32 v5, v5, v139
v_cvt_pk_bf16_f32 v137, v138, v139
v_exp_f32 v142, v142
v_mfma_f32_32x32x16_bf16 v[176:191], a[188:191], v[44:47], v[176:191]
v_add_f32 v4, v4, v140
v_exp_f32 v143, v143
v_add_f32 v5, v5, v141
v_mfma_f32_32x32x16_bf16 v[192:207], a[188:191], v[76:79], v[192:207]
v_cvt_pk_bf16_f32 v138, v140, v141
v_add_f32 v4, v4, v142
v_add_f32 v5, v5, v143
v_cvt_pk_bf16_f32 v139, v142, v143
s_waitcnt vmcnt(16) lgkmcnt(0)
v_mfma_f32_32x32x16_bf16 a[0:15], a[192:195], v[80:83], a[0:15]
s_barrier
v_mfma_f32_32x32x16_bf16 a[64:79], a[192:195], v[96:99], a[64:79]
ds_read_b128 a[128:131], v10 offset:16384
v_max3_f32 v6, v144, v145, v146
v_max3_f32 v7, v160, v161, v162
v_max3_f32 v6, v6, v147, v148
v_max3_f32 v7, v7, v163, v164
v_max3_f32 v6, v6, v149, v150
v_mfma_f32_32x32x16_bf16 a[16:31], a[196:199], v[80:83], a[16:31]
ds_read_b128 a[132:135], v10 offset:17408
v_max3_f32 v7, v7, v165, v166
v_max3_f32 v6, v6, v151, v152
v_max3_f32 v7, v7, v167, v168
v_max3_f32 v6, v6, v153, v154
v_max3_f32 v7, v7, v169, v170
v_mfma_f32_32x32x16_bf16 a[80:95], a[196:199], v[96:99], a[80:95]
v_max3_f32 v6, v6, v155, v156
v_max3_f32 v7, v7, v171, v172
v_max3_f32 v6, v6, v157, v158
v_max3_f32 v7, v7, v173, v174
v_max3_f32 v6, v6, v159, v176
v_mfma_f32_32x32x16_bf16 a[32:47], a[200:203], v[80:83], a[32:47]
ds_read_b128 a[136:139], v10 offset:18432
v_max3_f32 v7, v7, v175, v192
v_max3_f32 v6, v6, v177, v178
v_max3_f32 v7, v7, v193, v194
v_max3_f32 v6, v6, v179, v180
v_max3_f32 v7, v7, v195, v196
v_mfma_f32_32x32x16_bf16 a[96:111], a[200:203], v[96:99], a[96:111]
v_max3_f32 v6, v6, v181, v182
v_max3_f32 v7, v7, v197, v198
v_max3_f32 v6, v6, v183, v184
v_max3_f32 v7, v7, v199, v200
v_max3_f32 v6, v6, v185, v186
v_mfma_f32_32x32x16_bf16 a[48:63], a[204:207], v[80:83], a[48:63]
ds_read_b128 a[140:143], v10 offset:19456
v_max3_f32 v7, v7, v201, v202
v_max3_f32 v6, v6, v187, v188
v_max3_f32 v7, v7, v203, v204
v_max3_f32 v6, v6, v189, v190
v_max3_f32 v7, v7, v205, v206
v_mfma_f32_32x32x16_bf16 a[112:127], a[204:207], v[96:99], a[112:127]
v_max_f32 v6, v6, v191
v_max_f32 v7, v7, v207
v_max_f32 v240, v6, v7
v_cmp_lt_f32 vcc, s79, v240
v_mfma_f32_32x32x16_bf16 a[0:15], a[208:211], v[88:91], a[0:15]
s_cbranch_vccnz L_p3_d0_rare
s_add_u32 m0, s72, 0
ds_read_b128 a[144:147], v10 offset:20480
v_exp_f32 v144, v144
v_exp_f32 v145, v145
v_mfma_f32_32x32x16_bf16 a[64:79], a[208:211], v[104:107], a[64:79]
ds_read_b128 a[148:151], v10 offset:21504
buffer_load_dwordx4 v12, s[52:55], s71 offen offset:0 sc1 lds
v_exp_f32 v146, v146
v_add_f32 v2, v2, v144
v_mfma_f32_32x32x16_bf16 a[16:31], a[212:215], v[88:91], a[16:31]
v_exp_f32 v147, v147
v_add_f32 v3, v3, v145
v_cvt_pk_bf16_f32 v144, v144, v145
v_mfma_f32_32x32x16_bf16 a[80:95], a[212:215], v[104:107], a[80:95]
ds_read_b128 a[152:155], v10 offset:22528
v_exp_f32 v148, v148
v_add_f32 v2, v2, v146
v_mfma_f32_32x32x16_bf16 a[32:47], a[216:219], v[88:91], a[32:47]
v_exp_f32 v149, v149
v_add_f32 v3, v3, v147
v_cvt_pk_bf16_f32 v145, v146, v147
v_mfma_f32_32x32x16_bf16 a[96:111], a[216:219], v[104:107], a[96:111]
ds_read_b128 a[156:159], v10 offset:23552
buffer_load_dwordx4 v12, s[52:55], s71 offen offset:1024 sc1 lds
v_exp_f32 v150, v150
v_add_f32 v2, v2, v148
v_mfma_f32_32x32x16_bf16 a[48:63], a[220:223], v[88:91], a[48:63]
ds_read_b128 a[160:163], v10 offset:24576
v_exp_f32 v151, v151
v_add_f32 v3, v3, v149
v_cvt_pk_bf16_f32 v146, v148, v149
v_mfma_f32_32x32x16_bf16 a[112:127], a[220:223], v[104:107], a[112:127]
v_exp_f32 v152, v152
v_add_f32 v2, v2, v150
v_mfma_f32_32x32x16_bf16 a[0:15], a[224:227], v[112:115], a[0:15]
ds_read_b128 a[164:167], v10 offset:25600
v_exp_f32 v153, v153
v_add_f32 v3, v3, v151
v_cvt_pk_bf16_f32 v147, v150, v151
v_mfma_f32_32x32x16_bf16 a[64:79], a[224:227], v[128:131], a[64:79]
v_exp_f32 v154, v154
v_add_f32 v2, v2, v152
v_mfma_f32_32x32x16_bf16 a[16:31], a[228:231], v[112:115], a[16:31]
ds_read_b128 a[168:171], v10 offset:26624
buffer_load_dwordx4 v12, s[52:55], s71 offen offset:2048 sc1 lds
v_exp_f32 v155, v155
v_add_f32 v3, v3, v153
v_cvt_pk_bf16_f32 v152, v152, v153
v_mfma_f32_32x32x16_bf16 a[80:95], a[228:231], v[128:131], a[80:95]
ds_read_b128 a[172:175], v10 offset:27648
v_exp_f32 v156, v156
v_add_f32 v2, v2, v154
v_mfma_f32_32x32x16_bf16 a[32:47], a[232:235], v[112:115], a[32:47]
v_exp_f32 v157, v157
v_add_f32 v3, v3, v155
v_cvt_pk_bf16_f32 v153, v154, v155
v_mfma_f32_32x32x16_bf16 a[96:111], a[232:235], v[128:131], a[96:111]
ds_read_b128 a[176:179], v10 offset:28672
v_exp_f32 v158, v158
v_add_f32 v2, v2, v156
v_mfma_f32_32x32x16_bf16 a[48:63], a[236:239], v[112:115], a[48:63]
buffer_load_dwordx4 v12, s[52:55], s71 offen offset:3072 sc1 lds
v_exp_f32 v159, v159
v_add_f32 v3, v3, v157
v_cvt_pk_bf16_f32 v154, v156, v157
v_mfma_f32_32x32x16_bf16 a[112:127], a[236:239], v[128:131], a[112:127]
ds_read_b128 a[180:183], v10 offset:29696
v_exp_f32 v160, v160
v_add_f32 v2, v2, v158
v_mfma_f32_32x32x16_bf16 a[0:15], a[240:243], v[120:123], a[0:15]
ds_read_b128 a[184:187], v10 offset:30720
v_exp_f32 v161, v161
v_add_f32 v3, v3, v159
v_cvt_pk_bf16_f32 v155, v158, v159
v_mfma_f32_32x32x16_bf16 a[64:79], a[240:243], v[136:139], a[64:79]
v_exp_f32 v162, v162
v_add_f32 v4, v4, v160
v_mfma_f32_32x32x16_bf16 a[16:31], a[244:247], v[120:123], a[16:31]
ds_read_b128 a[188:191], v10 offset:31744
v_exp_f32 v163, v163
v_add_f32 v5, v5, v161
v_cvt_pk_bf16_f32 v160, v160, v161
v_mfma_f32_32x32x16_bf16 a[80:95], a[244:247], v[136:139], a[80:95]
s_sub_u32 s74, s74, 1
v_exp_f32 v164, v164
v_add_f32 v4, v4, v162
v_mfma_f32_32x32x16_bf16 a[32:47], a[248:251], v[120:123], a[32:47]
v_exp_f32 v165, v165
v_add_f32 v5, v5, v163
v_cvt_pk_bf16_f32 v161, v162, v163
v_mfma_f32_32x32x16_bf16 a[96:111], a[248:251], v[136:139], a[96:111]
v_exp_f32 v166, v166
v_add_f32 v4, v4, v164
v_mfma_f32_32x32x16_bf16 a[48:63], a[252:255], v[120:123], a[48:63]
v_exp_f32 v167, v167
v_add_f32 v5, v5, v165
v_cvt_pk_bf16_f32 v162, v164, v165
v_mfma_f32_32x32x16_bf16 a[112:127], a[252:255], v[136:139], a[112:127]
v_add_f32 v4, v4, v166
v_add_f32 v5, v5, v167
v_cvt_pk_bf16_f32 v163, v166, v167
L_p3_d0_end:
s_cbranch_scc1 L_p3_d1m_top
s_waitcnt lgkmcnt(0)
v_xor_b32 v11, 0x8000, v11
v_mfma_f32_32x32x16_bf16 v[80:95], a[128:131], v[16:19], v[208:223]
s_add_u32 m0, s73, 16384
ds_read_b128 a[192:195], v11 offset:0
v_exp_f32 v168, v168
v_exp_f32 v169, v169
v_mfma_f32_32x32x16_bf16 v[96:111], a[128:131], v[48:51], v[224:239]
ds_read_b128 a[196:199], v11 offset:1024
buffer_load_dwordx4 v12, s[56:59], s71 offen offset:0 sc1 lds
v_exp_f32 v170, v170
v_add_f32 v4, v4, v168
v_mfma_f32_32x32x16_bf16 v[80:95], a[132:135], v[20:23], v[80:95]
ds_read_b128 a[200:203], v11 offset:2048
v_exp_f32 v171, v171
v_add_f32 v5, v5, v169
v_cvt_pk_bf16_f32 v168, v168, v169
v_mfma_f32_32x32x16_bf16 v[96:111], a[132:135], v[52:55], v[96:111]
v_exp_f32 v172, v172
v_add_f32 v4, v4, v170
v_exp_f32 v173, v173
v_add_f32 v5, v5, v171
v_mfma_f32_32x32x16_bf16 v[80:95], a[136:139], v[24:27], v[80:95]
ds_read_b128 a[204:207], v11 offset:3072
v_cvt_pk_bf16_f32 v169, v170, v171
v_exp_f32 v174, v174
v_add_f32 v4, v4, v172
v_mfma_f32_32x32x16_bf16 v[96:111], a[136:139], v[56:59], v[96:111]
ds_read_b128 a[208:211], v11 offset:4096
v_exp_f32 v175, v175
v_add_f32 v5, v5, v173
v_cvt_pk_bf16_f32 v170, v172, v173
v_mfma_f32_32x32x16_bf16 v[80:95], a[140:143], v[28:31], v[80:95]
ds_read_b128 a[212:215], v11 offset:5120
buffer_load_dwordx4 v12, s[56:59], s71 offen offset:1024 sc1 lds
v_exp_f32 v176, v176
v_add_f32 v4, v4, v174
v_mfma_f32_32x32x16_bf16 v[96:111], a[140:143], v[60:63], v[96:111]
v_exp_f32 v177, v177
v_add_f32 v5, v5, v175
v_cvt_pk_bf16_f32 v171, v174, v175
v_exp_f32 v178, v178
v_mfma_f32_32x32x16_bf16 v[80:95], a[144:147], v[32:35], v[80:95]
ds_read_b128 a[216:219], v11 offset:6144
v_add_f32 v2, v2, v176
v_exp_f32 v179, v179
v_add_f32 v3, v3, v177
v_cvt_pk_bf16_f32 v176, v176, v177
v_mfma_f32_32x32x16_bf16 v[96:111], a[144:147], v[64:67], v[96:111]
ds_read_b128 a[220:223], v11 offset:7168
v_exp_f32 v180, v180
v_add_f32 v2, v2, v178
v_exp_f32 v181, v181
v_mfma_f32_32x32x16_bf16 v[80:95], a[148:151], v[36:39], v[80:95]
v_add_f32 v3, v3, v179
v_cvt_pk_bf16_f32 v177, v178, v179
v_exp_f32 v182, v182
v_add_f32 v2, v2, v180
v_mfma_f32_32x32x16_bf16 v[96:111], a[148:151], v[68:71], v[96:111]
ds_read_b128 a[224:227], v11 offset:8192
buffer_load_dwordx4 v12, s[56:59], s71 offen offset:2048 sc1 lds
v_exp_f32 v183, v183
v_add_f32 v3, v3, v181
v_cvt_pk_bf16_f32 v178, v180, v181
v_mfma_f32_32x32x16_bf16 v[80:95], a[152:155], v[40:43], v[80:95]
ds_read_b128 a[228:231], v11 offset:9216
v_exp_f32 v184, v184
v_add_f32 v2, v2, v182
v_exp_f32 v185, v185
v_mfma_f32_32x32x16_bf16 v[96:111], a[152:155], v[72:75], v[96:111]
ds_read_b128 a[232:235], v11 offset:10240
v_add_f32 v3, v3, v183
v_cvt_pk_bf16_f32 v179, v182, v183
v_exp_f32 v186, v186
v_mfma_f32_32x32x16_bf16 v[80:95], a[156:159], v[44:47], v[80:95]
v_add_f32 v2, v2, v184
v_exp_f32 v187, v187
v_add_f32 v3, v3, v185
v_mfma_f32_32x32x16_bf16 v[96:111], a[156:159], v[76:79], v[96:111]
ds_read_b128 a[236:239], v11 offset:11264
v_cvt_pk_bf16_f32 v184, v184, v185
v_exp_f32 v188, v188
v_add_f32 v2, v2, v186
v_mfma_f32_32x32x16_bf16 v[112:127], a[160:163], v[16:19], v[208:223]
ds_read_b128 a[240:243], v11 offset:12288
buffer_load_dwordx4 v12, s[56:59], s71 offen offset:3072 sc1 lds
v_exp_f32 v189, v189
v_add_f32 v3, v3, v187
v_cvt_pk_bf16_f32 v185, v186, v187
v_mfma_f32_32x32x16_bf16 v[128:143], a[160:163], v[48:51], v[224:239]
ds_read_b128 a[244:247], v11 offset:13312
v_exp_f32 v190, v190
v_add_f32 v2, v2, v188
v_exp_f32 v191, v191
v_mfma_f32_32x32x16_bf16 v[112:127], a[164:167], v[20:23], v[112:127]
v_add_f32 v3, v3, v189
v_cvt_pk_bf16_f32 v186, v188, v189
v_exp_f32 v192, v192
v_add_f32 v2, v2, v190
v_mfma_f32_32x32x16_bf16 v[128:143], a[164:167], v[52:55], v[128:143]
ds_read_b128 a[248:251], v11 offset:14336
v_exp_f32 v193, v193
v_add_f32 v3, v3, v191
v_cvt_pk_bf16_f32 v187, v190, v191
v_mfma_f32_32x32x16_bf16 v[112:127], a[168:171], v[24:27], v[112:127]
ds_read_b128 a[252:255], v11 offset:15360
v_exp_f32 v194, v194
v_add_f32 v4, v4, v192
v_exp_f32 v195, v195
v_mfma_f32_32x32x16_bf16 v[128:143], a[168:171], v[56:59], v[128:143]
s_add_u32 s71, s71, 16384
v_add_f32 v5, v5, v193
v_cvt_pk_bf16_f32 v192, v192, v193
v_exp_f32 v196, v196
v_mfma_f32_32x32x16_bf16 v[112:127], a[172:175], v[28:31], v[112:127]
v_add_f32 v4, v4, v194
v_exp_f32 v197, v197
v_add_f32 v5, v5, v195
v_mfma_f32_32x32x16_bf16 v[128:143], a[172:175], v[60:63], v[128:143]
v_cvt_pk_bf16_f32 v193, v194, v195
v_exp_f32 v198, v198
v_add_f32 v4, v4, v196
v_mfma_f32_32x32x16_bf16 v[112:127], a[176:179], v[32:35], v[112:127]
v_exp_f32 v199, v199
v_add_f32 v5, v5, v197
v_cvt_pk_bf16_f32 v194, v196, v197
v_exp_f32 v200, v200
v_mfma_f32_32x32x16_bf16 v[128:143], a[176:179], v[64:67], v[128:143]
v_add_f32 v4, v4, v198
v_exp_f32 v201, v201
v_mfma_f32_32x32x16_bf16 v[112:127], a[180:183], v[36:39], v[112:127]
s_xor_b32 s73, s73, 0x8000
v_add_f32 v5, v5, v199
v_cvt_pk_bf16_f32 v195, v198, v199
v_exp_f32 v202, v202
v_add_f32 v4, v4, v200
v_mfma_f32_32x32x16_bf16 v[128:143], a[180:183], v[68:71], v[128:143]
v_exp_f32 v203, v203
v_add_f32 v5, v5, v201
v_cvt_pk_bf16_f32 v200, v200, v201
v_mfma_f32_32x32x16_bf16 v[112:127], a[184:187], v[40:43], v[112:127]
v_exp_f32 v204, v204
v_add_f32 v4, v4, v202
v_exp_f32 v205, v205
v_mfma_f32_32x32x16_bf16 v[128:143], a[184:187], v[72:75], v[128:143]
v_add_f32 v5, v5, v203
v_cvt_pk_bf16_f32 v201, v202, v203
v_exp_f32 v206, v206
v_mfma_f32_32x32x16_bf16 v[112:127], a[188:191], v[44:47], v[112:127]
v_add_f32 v4, v4, v204
v_exp_f32 v207, v207
v_add_f32 v5, v5, v205
v_mfma_f32_32x32x16_bf16 v[128:143], a[188:191], v[76:79], v[128:143]
v_cvt_pk_bf16_f32 v202, v204, v205
v_add_f32 v4, v4, v206
v_add_f32 v5, v5, v207
v_cvt_pk_bf16_f32 v203, v206, v207
s_waitcnt vmcnt(16) lgkmcnt(0)
v_mfma_f32_32x32x16_bf16 a[0:15], a[192:195], v[144:147], a[0:15]
s_barrier
v_xor_b32 v10, 0x8000, v10
v_mfma_f32_32x32x16_bf16 a[64:79], a[192:195], v[160:163], a[64:79]
ds_read_b128 a[128:131], v10 offset:0
v_max3_f32 v6, v80, v81, v82
v_max3_f32 v7, v96, v97, v98
v_max3_f32 v6, v6, v83, v84
v_max3_f32 v7, v7, v99, v100
v_max3_f32 v6, v6, v85, v86
v_mfma_f32_32x32x16_bf16 a[16:31], a[196:199], v[144:147], a[16:31]
ds_read_b128 a[132:135], v10 offset:1024
v_max3_f32 v7, v7, v101, v102
v_max3_f32 v6, v6, v87, v88
v_max3_f32 v7, v7, v103, v104
v_max3_f32 v6, v6, v89, v90
v_max3_f32 v7, v7, v105, v106
v_mfma_f32_32x32x16_bf16 a[80:95], a[196:199], v[160:163], a[80:95]
v_max3_f32 v6, v6, v91, v92
v_max3_f32 v7, v7, v107, v108
v_max3_f32 v6, v6, v93, v94
v_max3_f32 v7, v7, v109, v110
v_max3_f32 v6, v6, v95, v112
v_mfma_f32_32x32x16_bf16 a[32:47], a[200:203], v[144:147], a[32:47]
ds_read_b128 a[136:139], v10 offset:2048
v_max3_f32 v7, v7, v111, v128
v_max3_f32 v6, v6, v113, v114
v_max3_f32 v7, v7, v129, v130
v_max3_f32 v6, v6, v115, v116
v_max3_f32 v7, v7, v131, v132
v_mfma_f32_32x32x16_bf16 a[96:111], a[200:203], v[160:163], a[96:111]
v_max3_f32 v6, v6, v117, v118
v_max3_f32 v7, v7, v133, v134
v_max3_f32 v6, v6, v119, v120
v_max3_f32 v7, v7, v135, v136
v_max3_f32 v6, v6, v121, v122
v_mfma_f32_32x32x16_bf16 a[48:63], a[204:207], v[144:147], a[48:63]
ds_read_b128 a[140:143], v10 offset:3072
v_max3_f32 v7, v7, v137, v138
v_max3_f32 v6, v6, v123, v124
v_max3_f32 v7, v7, v139, v140
v_max3_f32 v6, v6, v125, v126
v_max3_f32 v7, v7, v141, v142
v_mfma_f32_32x32x16_bf16 a[112:127], a[204:207], v[160:163], a[112:127]
v_max_f32 v6, v6, v127
v_max_f32 v7, v7, v143
v_max_f32 v240, v6, v7
v_cmp_lt_f32 vcc, s79, v240
v_mfma_f32_32x32x16_bf16 a[0:15], a[208:211], v[152:155], a[0:15]
s_cbranch_vccnz L_p3_d1_rare
s_add_u32 m0, s72, 16384
ds_read_b128 a[144:147], v10 offset:4096
v_exp_f32 v80, v80
v_exp_f32 v81, v81
v_mfma_f32_32x32x16_bf16 a[64:79], a[208:211], v[168:171], a[64:79]
ds_read_b128 a[148:151], v10 offset:5120
buffer_load_dwordx4 v12, s[52:55], s71 offen offset:0 sc1 lds
v_exp_f32 v82, v82
v_add_f32 v2, v2, v80
v_mfma_f32_32x32x16_bf16 a[16:31], a[212:215], v[152:155], a[16:31]
v_exp_f32 v83, v83
v_add_f32 v3, v3, v81
v_cvt_pk_bf16_f32 v80, v80, v81
v_mfma_f32_32x32x16_bf16 a[80:95], a[212:215], v[168:171], a[80:95]
ds_read_b128 a[152:155], v10 offset:6144
v_exp_f32 v84, v84
v_add_f32 v2, v2, v82
v_mfma_f32_32x32x16_bf16 a[32:47], a[216:219], v[152:155], a[32:47]
v_exp_f32 v85, v85
v_add_f32 v3, v3, v83
v_cvt_pk_bf16_f32 v81, v82, v83
v_mfma_f32_32x32x16_bf16 a[96:111], a[216:219], v[168:171], a[96:111]
ds_read_b128 a[156:159], v10 offset:7168
buffer_load_dwordx4 v12, s[52:55], s71 offen offset:1024 sc1 lds
v_exp_f32 v86, v86
v_add_f32 v2, v2, v84
v_mfma_f32_32x32x16_bf16 a[48:63], a[220:223], v[152:155], a[48:63]
ds_read_b128 a[160:163], v10 offset:8192
v_exp_f32 v87, v87
v_add_f32 v3, v3, v85
v_cvt_pk_bf16_f32 v82, v84, v85
v_mfma_f32_32x32x16_bf16 a[112:127], a[220:223], v[168:171], a[112:127]
v_exp_f32 v88, v88
v_add_f32 v2, v2, v86
v_mfma_f32_32x32x16_bf16 a[0:15], a[224:227], v[176:179], a[0:15]
ds_read_b128 a[164:167], v10 offset:9216
v_exp_f32 v89, v89
v_add_f32 v3, v3, v87
v_cvt_pk_bf16_f32 v83, v86, v87
v_mfma_f32_32x32x16_bf16 a[64:79], a[224:227], v[192:195], a[64:79]
v_exp_f32 v90, v90
v_add_f32 v2, v2, v88
v_mfma_f32_32x32x16_bf16 a[16:31], a[228:231], v[176:179], a[16:31]
ds_read_b128 a[168:171], v10 offset:10240
buffer_load_dwordx4 v12, s[52:55], s71 offen offset:2048 sc1 lds
v_exp_f32 v91, v91
v_add_f32 v3, v3, v89
v_cvt_pk_bf16_f32 v88, v88, v89
v_mfma_f32_32x32x16_bf16 a[80:95], a[228:231], v[192:195], a[80:95]
ds_read_b128 a[172:175], v10 offset:11264
v_exp_f32 v92, v92
v_add_f32 v2, v2, v90
v_mfma_f32_32x32x16_bf16 a[32:47], a[232:235], v[176:179], a[32:47]
v_exp_f32 v93, v93
v_add_f32 v3, v3, v91
v_cvt_pk_bf16_f32 v89, v90, v91
v_mfma_f32_32x32x16_bf16 a[96:111], a[232:235], v[192:195], a[96:111]
ds_read_b128 a[176:179], v10 offset:12288
v_exp_f32 v94, v94
v_add_f32 v2, v2, v92
v_mfma_f32_32x32x16_bf16 a[48:63], a[236:239], v[176:179], a[48:63]
buffer_load_dwordx4 v12, s[52:55], s71 offen offset:3072 sc1 lds
v_exp_f32 v95, v95
v_add_f32 v3, v3, v93
v_cvt_pk_bf16_f32 v90, v92, v93
v_mfma_f32_32x32x16_bf16 a[112:127], a[236:239], v[192:195], a[112:127]
ds_read_b128 a[180:183], v10 offset:13312
v_exp_f32 v96, v96
v_add_f32 v2, v2, v94
v_mfma_f32_32x32x16_bf16 a[0:15], a[240:243], v[184:187], a[0:15]
ds_read_b128 a[184:187], v10 offset:14336
v_exp_f32 v97, v97
v_add_f32 v3, v3, v95
v_cvt_pk_bf16_f32 v91, v94, v95
v_mfma_f32_32x32x16_bf16 a[64:79], a[240:243], v[200:203], a[64:79]
v_exp_f32 v98, v98
v_add_f32 v4, v4, v96
v_mfma_f32_32x32x16_bf16 a[16:31], a[244:247], v[184:187], a[16:31]
ds_read_b128 a[188:191], v10 offset:15360
v_exp_f32 v99, v99
v_add_f32 v5, v5, v97
v_cvt_pk_bf16_f32 v96, v96, v97
v_mfma_f32_32x32x16_bf16 a[80:95], a[244:247], v[200:203], a[80:95]
s_xor_b32 s72, s72, 0x8000
v_exp_f32 v100, v100
v_add_f32 v4, v4, v98
v_mfma_f32_32x32x16_bf16 a[32:47], a[248:251], v[184:187], a[32:47]
v_exp_f32 v101, v101
v_add_f32 v5, v5, v99
v_cvt_pk_bf16_f32 v97, v98, v99
v_mfma_f32_32x32x16_bf16 a[96:111], a[248:251], v[200:203], a[96:111]
v_exp_f32 v102, v102
v_add_f32 v4, v4, v100
v_mfma_f32_32x32x16_bf16 a[48:63], a[252:255], v[184:187], a[48:63]
v_exp_f32 v103, v103
v_add_f32 v5, v5, v101
v_cvt_pk_bf16_f32 v98, v100, v101
v_mfma_f32_32x32x16_bf16 a[112:127], a[252:255], v[200:203], a[112:127]
v_add_f32 v4, v4, v102
v_add_f32 v5, v5, v103
v_cvt_pk_bf16_f32 v99, v102, v103
L_p3_d1_end:
s_branch L_p3_d0_top
L_p3_d1m_top:
s_waitcnt lgkmcnt(0)
v_xor_b32 v11, 0x8000, v11
v_mfma_f32_32x32x16_bf16 v[80:95], a[128:131], v[16:19], v[208:223]
s_add_u32 m0, s73, 16384
ds_read_b128 a[192:195], v11 offset:0
v_exp_f32 v168, v168
v_exp_f32 v169, v169
v_mfma_f32_32x32x16_bf16 v[96:111], a[128:131], v[48:51], v[224:239]
ds_read_b128 a[196:199], v11 offset:1024
buffer_load_dwordx4 v12, s[56:59], s71 offen offset:0 sc1 lds
v_exp_f32 v170, v170
v_add_f32 v4, v4, v168
v_mfma_f32_32x32x16_bf16 v[80:95], a[132:135], v[20:23], v[80:95]
ds_read_b128 a[200:203], v11 offset:2048
v_exp_f32 v171, v171
v_add_f32 v5, v5, v169
v_cvt_pk_bf16_f32 v168, v168, v169
v_mfma_f32_32x32x16_bf16 v[96:111], a[132:135], v[52:55], v[96:111]
v_exp_f32 v172, v172
v_add_f32 v4, v4, v170
v_exp_f32 v173, v173
v_add_f32 v5, v5, v171
v_mfma_f32_32x32x16_bf16 v[80:95], a[136:139], v[24:27], v[80:95]
ds_read_b128 a[204:207], v11 offset:3072
v_cvt_pk_bf16_f32 v169, v170, v171
v_exp_f32 v174, v174
v_add_f32 v4, v4, v172
v_mfma_f32_32x32x16_bf16 v[96:111], a[136:139], v[56:59], v[96:111]
ds_read_b128 a[208:211], v11 offset:4096
v_exp_f32 v175, v175
v_add_f32 v5, v5, v173
v_cvt_pk_bf16_f32 v170, v172, v173
v_mfma_f32_32x32x16_bf16 v[80:95], a[140:143], v[28:31], v[80:95]
ds_read_b128 a[212:215], v11 offset:5120
buffer_load_dwordx4 v12, s[56:59], s71 offen offset:1024 sc1 lds
v_exp_f32 v176, v176
v_add_f32 v4, v4, v174
v_mfma_f32_32x32x16_bf16 v[96:111], a[140:143], v[60:63], v[96:111]
v_exp_f32 v177, v177
v_add_f32 v5, v5, v175
v_cvt_pk_bf16_f32 v171, v174, v175
v_exp_f32 v178, v178
v_mfma_f32_32x32x16_bf16 v[80:95], a[144:147], v[32:35], v[80:95]
ds_read_b128 a[216:219], v11 offset:6144
v_add_f32 v2, v2, v176
v_exp_f32 v179, v179
v_add_f32 v3, v3, v177
v_cvt_pk_bf16_f32 v176, v176, v177
v_mfma_f32_32x32x16_bf16 v[96:111], a[144:147], v[64:67], v[96:111]
ds_read_b128 a[220:223], v11 offset:7168
v_exp_f32 v180, v180
v_add_f32 v2, v2, v178
v_exp_f32 v181, v181
v_mfma_f32_32x32x16_bf16 v[80:95], a[148:151], v[36:39], v[80:95]
v_add_f32 v3, v3, v179
v_cvt_pk_bf16_f32 v177, v178, v179
v_exp_f32 v182, v182
v_add_f32 v2, v2, v180
v_mfma_f32_32x32x16_bf16 v[96:111], a[148:151], v[68:71], v[96:111]
ds_read_b128 a[224:227], v11 offset:8192
buffer_load_dwordx4 v12, s[56:59], s71 offen offset:2048 sc1 lds
v_exp_f32 v183, v183
v_add_f32 v3, v3, v181
v_cvt_pk_bf16_f32 v178, v180, v181
v_mfma_f32_32x32x16_bf16 v[80:95], a[152:155], v[40:43], v[80:95]
ds_read_b128 a[228:231], v11 offset:9216
v_exp_f32 v184, v184
v_add_f32 v2, v2, v182
v_exp_f32 v185, v185
v_mfma_f32_32x32x16_bf16 v[96:111], a[152:155], v[72:75], v[96:111]
ds_read_b128 a[232:235], v11 offset:10240
v_add_f32 v3, v3, v183
v_cvt_pk_bf16_f32 v179, v182, v183
v_exp_f32 v186, v186
v_mfma_f32_32x32x16_bf16 v[80:95], a[156:159], v[44:47], v[80:95]
v_add_f32 v2, v2, v184
v_exp_f32 v187, v187
v_add_f32 v3, v3, v185
v_mfma_f32_32x32x16_bf16 v[96:111], a[156:159], v[76:79], v[96:111]
ds_read_b128 a[236:239], v11 offset:11264
v_cvt_pk_bf16_f32 v184, v184, v185
v_exp_f32 v188, v188
v_add_f32 v2, v2, v186
v_mfma_f32_32x32x16_bf16 v[112:127], a[160:163], v[16:19], v[208:223]
ds_read_b128 a[240:243], v11 offset:12288
buffer_load_dwordx4 v12, s[56:59], s71 offen offset:3072 sc1 lds
v_exp_f32 v189, v189
v_add_f32 v3, v3, v187
v_cvt_pk_bf16_f32 v185, v186, v187
v_mfma_f32_32x32x16_bf16 v[128:143], a[160:163], v[48:51], v[224:239]
ds_read_b128 a[244:247], v11 offset:13312
v_exp_f32 v190, v190
v_add_f32 v2, v2, v188
v_exp_f32 v191, v191
v_mfma_f32_32x32x16_bf16 v[112:127], a[164:167], v[20:23], v[112:127]
v_add_f32 v3, v3, v189
v_cvt_pk_bf16_f32 v186, v188, v189
v_exp_f32 v192, v192
v_add_f32 v2, v2, v190
v_mfma_f32_32x32x16_bf16 v[128:143], a[164:167], v[52:55], v[128:143]
ds_read_b128 a[248:251], v11 offset:14336
v_exp_f32 v193, v193
v_add_f32 v3, v3, v191
v_cvt_pk_bf16_f32 v187, v190, v191
v_add_u32 v246, 0, v13
v_mfma_f32_32x32x16_bf16 v[112:127], a[168:171], v[24:27], v[112:127]
ds_read_b128 a[252:255], v11 offset:15360
v_cmp_gt_i32_e64 s[84:85], 0, v246
v_cmp_gt_i32_e64 s[86:87], 1, v246
v_exp_f32 v194, v194
v_add_f32 v4, v4, v192
v_mfma_f32_32x32x16_bf16 v[128:143], a[168:171], v[56:59], v[128:143]
s_add_u32 s71, s71, 16384
v_exp_f32 v195, v195
v_cmp_gt_i32_e64 s[88:89], 2, v246
v_cmp_gt_i32_e64 s[90:91], 3, v246
v_cndmask_b32_e64 v96, v96, v14, s[84:85]
v_mfma_f32_32x32x16_bf16 v[112:127], a[172:175], v[28:31], v[112:127]
v_add_f32 v5, v5, v193
v_cvt_pk_bf16_f32 v192, v192, v193
v_exp_f32 v196, v196
v_cndmask_b32_e64 v97, v97, v14, s[86:87]
v_cndmask_b32_e64 v98, v98, v14, s[88:89]
v_mfma_f32_32x32x16_bf16 v[128:143], a[172:175], v[60:63], v[128:143]
v_add_f32 v4, v4, v194
v_exp_f32 v197, v197
v_add_f32 v5, v5, v195
v_cndmask_b32_e64 v99, v99, v14, s[90:91]
v_cmp_gt_i32_e64 s[92:93], 16, v246
v_mfma_f32_32x32x16_bf16 v[112:127], a[176:179], v[32:35], v[112:127]
v_cmp_gt_i32_e64 s[94:95], 17, v246
v_cvt_pk_bf16_f32 v193, v194, v195
v_exp_f32 v198, v198
v_add_f32 v4, v4, v196
v_cmp_gt_i32_e64 s[96:97], 18, v246
v_mfma_f32_32x32x16_bf16 v[128:143], a[176:179], v[64:67], v[128:143]
v_cmp_gt_i32_e64 s[98:99], 19, v246
v_exp_f32 v199, v199
v_add_f32 v5, v5, v197
v_cvt_pk_bf16_f32 v194, v196, v197
v_cndmask_b32_e64 v100, v100, v14, s[92:93]
v_mfma_f32_32x32x16_bf16 v[112:127], a[180:183], v[36:39], v[112:127]
s_xor_b32 s73, s73, 0x8000
v_exp_f32 v200, v200
v_cndmask_b32_e64 v101, v101, v14, s[94:95]
v_cndmask_b32_e64 v102, v102, v14, s[96:97]
v_add_f32 v4, v4, v198
v_mfma_f32_32x32x16_bf16 v[128:143], a[180:183], v[68:71], v[128:143]
v_exp_f32 v201, v201
v_cndmask_b32_e64 v103, v103, v14, s[98:99]
v_cmp_gt_i32_e64 s[84:85], 8, v246
v_add_f32 v5, v5, v199
v_cvt_pk_bf16_f32 v195, v198, v199
v_mfma_f32_32x32x16_bf16 v[112:127], a[184:187], v[40:43], v[112:127]
v_exp_f32 v202, v202
v_add_f32 v4, v4, v200
v_cmp_gt_i32_e64 s[86:87], 9, v246
v_cmp_gt_i32_e64 s[88:89], 10, v246
v_cmp_gt_i32_e64 s[90:91], 11, v246
v_mfma_f32_32x32x16_bf16 v[128:143], a[184:187], v[72:75], v[128:143]
v_exp_f32 v203, v203
v_add_f32 v5, v5, v201
v_cvt_pk_bf16_f32 v200, v200, v201
v_cndmask_b32_e64 v104, v104, v14, s[84:85]
v_cndmask_b32_e64 v105, v105, v14, s[86:87]
v_mfma_f32_32x32x16_bf16 v[112:127], a[188:191], v[44:47], v[112:127]
v_exp_f32 v204, v204
v_add_f32 v4, v4, v202
v_exp_f32 v205, v205
v_cndmask_b32_e64 v106, v106, v14, s[88:89]
v_mfma_f32_32x32x16_bf16 v[128:143], a[188:191], v[76:79], v[128:143]
v_cndmask_b32_e64 v107, v107, v14, s[90:91]
v_cmp_gt_i32_e64 s[92:93], 24, v246
v_add_f32 v5, v5, v203
v_cvt_pk_bf16_f32 v201, v202, v203
v_exp_f32 v206, v206
v_cmp_gt_i32_e64 s[94:95], 25, v246
v_cmp_gt_i32_e64 s[96:97], 26, v246
v_add_f32 v4, v4, v204
v_exp_f32 v207, v207
v_add_f32 v5, v5, v205
v_cmp_gt_i32_e64 s[98:99], 27, v246
v_cndmask_b32_e64 v108, v108, v14, s[92:93]
v_cndmask_b32_e64 v109, v109, v14, s[94:95]
v_cvt_pk_bf16_f32 v202, v204, v205
v_add_f32 v4, v4, v206
v_add_f32 v5, v5, v207
v_cvt_pk_bf16_f32 v203, v206, v207
v_cndmask_b32_e64 v110, v110, v14, s[96:97]
v_cndmask_b32_e64 v111, v111, v14, s[98:99]
s_waitcnt vmcnt(16) lgkmcnt(0)
v_mfma_f32_32x32x16_bf16 a[0:15], a[192:195], v[144:147], a[0:15]
s_barrier
v_xor_b32 v10, 0x8000, v10
v_mfma_f32_32x32x16_bf16 a[64:79], a[192:195], v[160:163], a[64:79]
ds_read_b128 a[128:131], v10 offset:0
v_max3_f32 v6, v80, v81, v82
v_max3_f32 v7, v96, v97, v98
v_max3_f32 v6, v6, v83, v84
v_max3_f32 v7, v7, v99, v100
v_max3_f32 v6, v6, v85, v86
v_mfma_f32_32x32x16_bf16 a[16:31], a[196:199], v[144:147], a[16:31]
ds_read_b128 a[132:135], v10 offset:1024
v_max3_f32 v7, v7, v101, v102
v_max3_f32 v6, v6, v87, v88
v_max3_f32 v7, v7, v103, v104
v_max3_f32 v6, v6, v89, v90
v_max3_f32 v7, v7, v105, v106
v_mfma_f32_32x32x16_bf16 a[80:95], a[196:199], v[160:163], a[80:95]
v_max3_f32 v6, v6, v91, v92
v_max3_f32 v7, v7, v107, v108
v_max3_f32 v6, v6, v93, v94
v_max3_f32 v7, v7, v109, v110
v_add_u32 v247, -32, v13
v_mfma_f32_32x32x16_bf16 a[32:47], a[200:203], v[144:147], a[32:47]
ds_read_b128 a[136:139], v10 offset:2048
v_cmp_gt_i32_e64 s[84:85], 0, v247
v_cmp_gt_i32_e64 s[86:87], 1, v247
v_cmp_gt_i32_e64 s[88:89], 2, v247
v_cmp_gt_i32_e64 s[90:91], 3, v247
v_cndmask_b32_e64 v128, v128, v14, s[84:85]
v_mfma_f32_32x32x16_bf16 a[96:111], a[200:203], v[160:163], a[96:111]
v_cndmask_b32_e64 v129, v129, v14, s[86:87]
v_cndmask_b32_e64 v130, v130, v14, s[88:89]
v_cndmask_b32_e64 v131, v131, v14, s[90:91]
v_cmp_gt_i32_e64 s[92:93], 16, v247
v_mfma_f32_32x32x16_bf16 a[48:63], a[204:207], v[144:147], a[48:63]
ds_read_b128 a[140:143], v10 offset:3072
v_cmp_gt_i32_e64 s[94:95], 17, v247
v_cmp_gt_i32_e64 s[96:97], 18, v247
v_cmp_gt_i32_e64 s[98:99], 19, v247
v_cndmask_b32_e64 v132, v132, v14, s[92:93]
v_cndmask_b32_e64 v133, v133, v14, s[94:95]
v_mfma_f32_32x32x16_bf16 a[112:127], a[204:207], v[160:163], a[112:127]
v_cndmask_b32_e64 v134, v134, v14, s[96:97]
v_cndmask_b32_e64 v135, v135, v14, s[98:99]
v_cmp_gt_i32_e64 s[84:85], 8, v247
v_cmp_gt_i32_e64 s[86:87], 9, v247
v_cmp_gt_i32_e64 s[88:89], 10, v247
v_mfma_f32_32x32x16_bf16 a[0:15], a[208:211], v[152:155], a[0:15]
ds_read_b128 a[144:147], v10 offset:4096
v_cmp_gt_i32_e64 s[90:91], 11, v247
v_cndmask_b32_e64 v136, v136, v14, s[84:85]
v_cndmask_b32_e64 v137, v137, v14, s[86:87]
v_cndmask_b32_e64 v138, v138, v14, s[88:89]
v_cndmask_b32_e64 v139, v139, v14, s[90:91]
v_mfma_f32_32x32x16_bf16 a[64:79], a[208:211], v[168:171], a[64:79]
ds_read_b128 a[148:151], v10 offset:5120
v_cmp_gt_i32_e64 s[92:93], 24, v247
v_cmp_gt_i32_e64 s[94:95], 25, v247
v_cmp_gt_i32_e64 s[96:97], 26, v247
v_cmp_gt_i32_e64 s[98:99], 27, v247
v_cndmask_b32_e64 v140, v140, v14, s[92:93]
v_mfma_f32_32x32x16_bf16 a[16:31], a[212:215], v[152:155], a[16:31]
v_cndmask_b32_e64 v141, v141, v14, s[94:95]
v_cndmask_b32_e64 v142, v142, v14, s[96:97]
v_cndmask_b32_e64 v143, v143, v14, s[98:99]
v_max3_f32 v6, v6, v95, v112
v_mfma_f32_32x32x16_bf16 a[80:95], a[212:215], v[168:171], a[80:95]
ds_read_b128 a[152:155], v10 offset:6144
v_max3_f32 v7, v7, v111, v128
v_max3_f32 v6, v6, v113, v114
v_max3_f32 v7, v7, v129, v130
v_max3_f32 v6, v6, v115, v116
v_max3_f32 v7, v7, v131, v132
v_mfma_f32_32x32x16_bf16 a[32:47], a[216:219], v[152:155], a[32:47]
v_max3_f32 v6, v6, v117, v118
v_max3_f32 v7, v7, v133, v134
v_max3_f32 v6, v6, v119, v120
v_max3_f32 v7, v7, v135, v136
v_max3_f32 v6, v6, v121, v122
v_mfma_f32_32x32x16_bf16 a[96:111], a[216:219], v[168:171], a[96:111]
ds_read_b128 a[156:159], v10 offset:7168
v_max3_f32 v7, v7, v137, v138
v_max3_f32 v6, v6, v123, v124
v_max3_f32 v7, v7, v139, v140
v_max3_f32 v6, v6, v125, v126
v_max3_f32 v7, v7, v141, v142
v_mfma_f32_32x32x16_bf16 a[48:63], a[220:223], v[152:155], a[48:63]
v_max_f32 v6, v6, v127
v_max_f32 v7, v7, v143
v_max_f32 v240, v6, v7
v_cmp_lt_f32 vcc, s79, v240
v_mfma_f32_32x32x16_bf16 a[112:127], a[220:223], v[168:171], a[112:127]
s_cbranch_vccnz L_p3_d1m_rare
s_add_u32 m0, s72, 16384
ds_read_b128 a[160:163], v10 offset:8192
v_exp_f32 v80, v80
v_exp_f32 v81, v81
v_mfma_f32_32x32x16_bf16 a[0:15], a[224:227], v[176:179], a[0:15]
ds_read_b128 a[164:167], v10 offset:9216
buffer_load_dwordx4 v12, s[52:55], s71 offen offset:0 sc1 lds
v_exp_f32 v82, v82
v_add_f32 v2, v2, v80
v_mfma_f32_32x32x16_bf16 a[64:79], a[224:227], v[192:195], a[64:79]
v_exp_f32 v83, v83
v_add_f32 v3, v3, v81
v_cvt_pk_bf16_f32 v80, v80, v81
v_exp_f32 v84, v84
v_mfma_f32_32x32x16_bf16 a[16:31], a[228:231], v[176:179], a[16:31]
ds_read_b128 a[168:171], v10 offset:10240
v_add_f32 v2, v2, v82
v_exp_f32 v85, v85
v_add_f32 v3, v3, v83
v_cvt_pk_bf16_f32 v81, v82, v83
v_mfma_f32_32x32x16_bf16 a[80:95], a[228:231], v[192:195], a[80:95]
ds_read_b128 a[172:175], v10 offset:11264
buffer_load_dwordx4 v12, s[52:55], s71 offen offset:1024 sc1 lds
v_exp_f32 v86, v86
v_add_f32 v2, v2, v84
v_mfma_f32_32x32x16_bf16 a[32:47], a[232:235], v[176:179], a[32:47]
v_exp_f32 v87, v87
v_add_f32 v3, v3, v85
v_cvt_pk_bf16_f32 v82, v84, v85
v_exp_f32 v88, v88
v_mfma_f32_32x32x16_bf16 a[96:111], a[232:235], v[192:195], a[96:111]
ds_read_b128 a[176:179], v10 offset:12288
v_add_f32 v2, v2, v86
v_exp_f32 v89, v89
v_add_f32 v3, v3, v87
v_cvt_pk_bf16_f32 v83, v86, v87
v_mfma_f32_32x32x16_bf16 a[48:63], a[236:239], v[176:179], a[48:63]
buffer_load_dwordx4 v12, s[52:55], s71 offen offset:2048 sc1 lds
v_exp_f32 v90, v90
v_add_f32 v2, v2, v88
v_exp_f32 v91, v91
v_mfma_f32_32x32x16_bf16 a[112:127], a[236:239], v[192:195], a[112:127]
ds_read_b128 a[180:183], v10 offset:13312
v_add_f32 v3, v3, v89
v_cvt_pk_bf16_f32 v88, v88, v89
v_exp_f32 v92, v92
v_add_f32 v2, v2, v90
v_mfma_f32_32x32x16_bf16 a[0:15], a[240:243], v[184:187], a[0:15]
ds_read_b128 a[184:187], v10 offset:14336
v_exp_f32 v93, v93
v_add_f32 v3, v3, v91
v_cvt_pk_bf16_f32 v89, v90, v91
v_mfma_f32_32x32x16_bf16 a[64:79], a[240:243], v[200:203], a[64:79]
buffer_load_dwordx4 v12, s[52:55], s71 offen offset:3072 sc1 lds
v_exp_f32 v94, v94
v_add_f32 v2, v2, v92
v_exp_f32 v95, v95
v_mfma_f32_32x32x16_bf16 a[16:31], a[244:247], v[184:187], a[16:31]
ds_read_b128 a[188:191], v10 offset:15360
v_add_f32 v3, v3, v93
v_cvt_pk_bf16_f32 v90, v92, v93
v_exp_f32 v96, v96
v_add_f32 v2, v2, v94
v_mfma_f32_32x32x16_bf16 a[80:95], a[244:247], v[200:203], a[80:95]
v_exp_f32 v97, v97
v_add_f32 v3, v3, v95
v_cvt_pk_bf16_f32 v91, v94, v95
v_exp_f32 v98, v98
v_mfma_f32_32x32x16_bf16 a[32:47], a[248:251], v[184:187], a[32:47]
s_xor_b32 s72, s72, 0x8000
v_add_f32 v4, v4, v96
v_exp_f32 v99, v99
v_add_f32 v5, v5, v97
v_cvt_pk_bf16_f32 v96, v96, v97
v_mfma_f32_32x32x16_bf16 a[96:111], a[248:251], v[200:203], a[96:111]
v_exp_f32 v100, v100
v_add_f32 v4, v4, v98
v_exp_f32 v101, v101
v_add_f32 v5, v5, v99
v_mfma_f32_32x32x16_bf16 a[48:63], a[252:255], v[184:187], a[48:63]
v_cvt_pk_bf16_f32 v97, v98, v99
v_exp_f32 v102, v102
v_add_f32 v4, v4, v100
v_exp_f32 v103, v103
v_mfma_f32_32x32x16_bf16 a[112:127], a[252:255], v[200:203], a[112:127]
v_add_f32 v5, v5, v101
v_cvt_pk_bf16_f32 v98, v100, v101
v_add_f32 v4, v4, v102
v_add_f32 v5, v5, v103
v_cvt_pk_bf16_f32 v99, v102, v103
L_p3_d1m_end:
L_p3_d0m_top:
s_waitcnt lgkmcnt(0)
v_mfma_f32_32x32x16_bf16 v[144:159], a[128:131], v[16:19], v[208:223]
s_add_u32 m0, s73, 0
ds_read_b128 a[192:195], v11 offset:16384
v_exp_f32 v104, v104
v_exp_f32 v105, v105
v_mfma_f32_32x32x16_bf16 v[160:175], a[128:131], v[48:51], v[224:239]
ds_read_b128 a[196:199], v11 offset:17408
buffer_load_dwordx4 v12, s[56:59], s71 offen offset:0 sc1 lds
v_exp_f32 v106, v106
v_add_f32 v4, v4, v104
v_mfma_f32_32x32x16_bf16 v[144:159], a[132:135], v[20:23], v[144:159]
ds_read_b128 a[200:203], v11 offset:18432
v_exp_f32 v107, v107
v_add_f32 v5, v5, v105
v_cvt_pk_bf16_f32 v104, v104, v105
v_mfma_f32_32x32x16_bf16 v[160:175], a[132:135], v[52:55], v[160:175]
v_exp_f32 v108, v108
v_add_f32 v4, v4, v106
v_exp_f32 v109, v109
v_add_f32 v5, v5, v107
v_mfma_f32_32x32x16_bf16 v[144:159], a[136:139], v[24:27], v[144:159]
ds_read_b128 a[204:207], v11 offset:19456
v_cvt_pk_bf16_f32 v105, v106, v107
v_exp_f32 v110, v110
v_add_f32 v4, v4, v108
v_mfma_f32_32x32x16_bf16 v[160:175], a[136:139], v[56:59], v[160:175]
ds_read_b128 a[208:211], v11 offset:20480
v_exp_f32 v111, v111
v_add_f32 v5, v5, v109
v_cvt_pk_bf16_f32 v106, v108, v109
v_mfma_f32_32x32x16_bf16 v[144:159], a[140:143], v[28:31], v[144:159]
ds_read_b128 a[212:215], v11 offset:21504
v_exp_f32 v112, v112
v_add_f32 v4, v4, v110
v_exp_f32 v113, v113
v_mfma_f32_32x32x16_bf16 v[160:175], a[140:143], v[60:63], v[160:175]
buffer_load_dwordx4 v12, s[56:59], s71 offen offset:1024 sc1 lds
v_add_f32 v5, v5, v111
v_cvt_pk_bf16_f32 v107, v110, v111
v_exp_f32 v114, v114
v_add_f32 v2, v2, v112
v_mfma_f32_32x32x16_bf16 v[144:159], a[144:147], v[32:35], v[144:159]
ds_read_b128 a[216:219], v11 offset:22528
v_exp_f32 v115, v115
v_add_f32 v3, v3, v113
v_cvt_pk_bf16_f32 v112, v112, v113
v_mfma_f32_32x32x16_bf16 v[160:175], a[144:147], v[64:67], v[160:175]
ds_read_b128 a[220:223], v11 offset:23552
v_exp_f32 v116, v116
v_add_f32 v2, v2, v114
v_exp_f32 v117, v117
v_mfma_f32_32x32x16_bf16 v[144:159], a[148:151], v[36:39], v[144:159]
v_add_f32 v3, v3, v115
v_cvt_pk_bf16_f32 v113, v114, v115
v_exp_f32 v118, v118
v_add_f32 v2, v2, v116
v_mfma_f32_32x32x16_bf16 v[160:175], a[148:151], v[68:71], v[160:175]
ds_read_b128 a[224:227], v11 offset:24576
v_exp_f32 v119, v119
v_add_f32 v3, v3, v117
v_cvt_pk_bf16_f32 v114, v116, v117
v_mfma_f32_32x32x16_bf16 v[144:159], a[152:155], v[40:43], v[144:159]
ds_read_b128 a[228:231], v11 offset:25600
v_exp_f32 v120, v120
v_add_f32 v2, v2, v118
v_exp_f32 v121, v121
v_mfma_f32_32x32x16_bf16 v[160:175], a[152:155], v[72:75], v[160:175]
ds_read_b128 a[232:235], v11 offset:26624
buffer_load_dwordx4 v12, s[56:59], s71 offen offset:2048 sc1 lds
v_add_f32 v3, v3, v119
v_cvt_pk_bf16_f32 v115, v118, v119
v_exp_f32 v122, v122
v_mfma_f32_32x32x16_bf16 v[144:159], a[156:159], v[44:47], v[144:159]
v_add_f32 v2, v2, v120
v_exp_f32 v123, v123
v_add_f32 v3, v3, v121
v_mfma_f32_32x32x16_bf16 v[160:175], a[156:159], v[76:79], v[160:175]
ds_read_b128 a[236:239], v11 offset:27648
v_cvt_pk_bf16_f32 v120, v120, v121
v_exp_f32 v124, v124
v_add_f32 v2, v2, v122
v_mfma_f32_32x32x16_bf16 v[176:191], a[160:163], v[16:19], v[208:223]
ds_read_b128 a[240:243], v11 offset:28672
v_exp_f32 v125, v125
v_add_f32 v3, v3, v123
v_cvt_pk_bf16_f32 v121, v122, v123
v_mfma_f32_32x32x16_bf16 v[192:207], a[160:163], v[48:51], v[224:239]
ds_read_b128 a[244:247], v11 offset:29696
v_exp_f32 v126, v126
v_add_f32 v2, v2, v124
v_exp_f32 v127, v127
v_mfma_f32_32x32x16_bf16 v[176:191], a[164:167], v[20:23], v[176:191]
v_add_f32 v3, v3, v125
v_cvt_pk_bf16_f32 v122, v124, v125
v_exp_f32 v128, v128
v_add_f32 v2, v2, v126
v_mfma_f32_32x32x16_bf16 v[192:207], a[164:167], v[52:55], v[192:207]
ds_read_b128 a[248:251], v11 offset:30720
buffer_load_dwordx4 v12, s[56:59], s71 offen offset:3072 sc1 lds
v_exp_f32 v129, v129
v_add_f32 v3, v3, v127
v_cvt_pk_bf16_f32 v123, v126, v127
v_mfma_f32_32x32x16_bf16 v[176:191], a[168:171], v[24:27], v[176:191]
ds_read_b128 a[252:255], v11 offset:31744
v_add_u32 v246, -64, v13
v_cmp_gt_i32_e64 s[84:85], 0, v246
v_cmp_gt_i32_e64 s[86:87], 1, v246
v_exp_f32 v130, v130
v_mfma_f32_32x32x16_bf16 v[192:207], a[168:171], v[56:59], v[192:207]
v_add_f32 v4, v4, v128
v_exp_f32 v131, v131
v_cmp_gt_i32_e64 s[88:89], 2, v246
v_cmp_gt_i32_e64 s[90:91], 3, v246
v_cndmask_b32_e64 v160, v160, v14, s[84:85]
v_mfma_f32_32x32x16_bf16 v[176:191], a[172:175], v[28:31], v[176:191]
v_add_f32 v5, v5, v129
v_cvt_pk_bf16_f32 v128, v128, v129
v_exp_f32 v132, v132
v_cndmask_b32_e64 v161, v161, v14, s[86:87]
v_cndmask_b32_e64 v162, v162, v14, s[88:89]
v_mfma_f32_32x32x16_bf16 v[192:207], a[172:175], v[60:63], v[192:207]
v_add_f32 v4, v4, v130
v_exp_f32 v133, v133
v_add_f32 v5, v5, v131
v_cndmask_b32_e64 v163, v163, v14, s[90:91]
v_cmp_gt_i32_e64 s[92:93], 16, v246
v_mfma_f32_32x32x16_bf16 v[176:191], a[176:179], v[32:35], v[176:191]
v_cmp_gt_i32_e64 s[94:95], 17, v246
v_cvt_pk_bf16_f32 v129, v130, v131
v_exp_f32 v134, v134
v_add_f32 v4, v4, v132
v_cmp_gt_i32_e64 s[96:97], 18, v246
v_mfma_f32_32x32x16_bf16 v[192:207], a[176:179], v[64:67], v[192:207]
s_add_u32 s71, s71, 16384
v_cmp_gt_i32_e64 s[98:99], 19, v246
v_exp_f32 v135, v135
v_add_f32 v5, v5, v133
v_cvt_pk_bf16_f32 v130, v132, v133
v_mfma_f32_32x32x16_bf16 v[176:191], a[180:183], v[36:39], v[176:191]
v_exp_f32 v136, v136
v_cndmask_b32_e64 v164, v164, v14, s[92:93]
v_cndmask_b32_e64 v165, v165, v14, s[94:95]
v_cndmask_b32_e64 v166, v166, v14, s[96:97]
v_add_f32 v4, v4, v134
v_mfma_f32_32x32x16_bf16 v[192:207], a[180:183], v[68:71], v[192:207]
v_exp_f32 v137, v137
v_cndmask_b32_e64 v167, v167, v14, s[98:99]
v_cmp_gt_i32_e64 s[84:85], 8, v246
v_add_f32 v5, v5, v135
v_cvt_pk_bf16_f32 v131, v134, v135
v_mfma_f32_32x32x16_bf16 v[176:191], a[184:187], v[40:43], v[176:191]
v_exp_f32 v138, v138
v_add_f32 v4, v4, v136
v_cmp_gt_i32_e64 s[86:87], 9, v246
v_cmp_gt_i32_e64 s[88:89], 10, v246
v_cmp_gt_i32_e64 s[90:91], 11, v246
v_mfma_f32_32x32x16_bf16 v[192:207], a[184:187], v[72:75], v[192:207]
v_exp_f32 v139, v139
v_add_f32 v5, v5, v137
v_cvt_pk_bf16_f32 v136, v136, v137
v_cndmask_b32_e64 v168, v168, v14, s[84:85]
v_cndmask_b32_e64 v169, v169, v14, s[86:87]
v_mfma_f32_32x32x16_bf16 v[176:191], a[188:191], v[44:47], v[176:191]
v_exp_f32 v140, v140
v_add_f32 v4, v4, v138
v_exp_f32 v141, v141
v_cndmask_b32_e64 v170, v170, v14, s[88:89]
v_mfma_f32_32x32x16_bf16 v[192:207], a[188:191], v[76:79], v[192:207]
v_cndmask_b32_e64 v171, v171, v14, s[90:91]
v_cmp_gt_i32_e64 s[92:93], 24, v246
v_add_f32 v5, v5, v139
v_cvt_pk_bf16_f32 v137, v138, v139
v_exp_f32 v142, v142
v_cmp_gt_i32_e64 s[94:95], 25, v246
v_cmp_gt_i32_e64 s[96:97], 26, v246
v_add_f32 v4, v4, v140
v_exp_f32 v143, v143
v_add_f32 v5, v5, v141
v_cmp_gt_i32_e64 s[98:99], 27, v246
v_cndmask_b32_e64 v172, v172, v14, s[92:93]
v_cndmask_b32_e64 v173, v173, v14, s[94:95]
v_cvt_pk_bf16_f32 v138, v140, v141
v_add_f32 v4, v4, v142
v_add_f32 v5, v5, v143
v_cvt_pk_bf16_f32 v139, v142, v143
v_cndmask_b32_e64 v174, v174, v14, s[96:97]
v_cndmask_b32_e64 v175, v175, v14, s[98:99]
s_waitcnt vmcnt(16) lgkmcnt(0)
v_mfma_f32_32x32x16_bf16 a[0:15], a[192:195], v[80:83], a[0:15]
s_barrier
v_mfma_f32_32x32x16_bf16 a[64:79], a[192:195], v[96:99], a[64:79]
ds_read_b128 a[128:131], v10 offset:16384
v_max3_f32 v6, v144, v145, v146
v_max3_f32 v7, v160, v161, v162
v_max3_f32 v6, v6, v147, v148
v_max3_f32 v7, v7, v163, v164
v_max3_f32 v6, v6, v149, v150
v_mfma_f32_32x32x16_bf16 a[16:31], a[196:199], v[80:83], a[16:31]
ds_read_b128 a[132:135], v10 offset:17408
v_max3_f32 v7, v7, v165, v166
v_max3_f32 v6, v6, v151, v152
v_max3_f32 v7, v7, v167, v168
v_max3_f32 v6, v6, v153, v154
v_max3_f32 v7, v7, v169, v170
v_mfma_f32_32x32x16_bf16 a[80:95], a[196:199], v[96:99], a[80:95]
v_max3_f32 v6, v6, v155, v156
v_max3_f32 v7, v7, v171, v172
v_max3_f32 v6, v6, v157, v158
v_max3_f32 v7, v7, v173, v174
v_add_u32 v247, -96, v13
v_mfma_f32_32x32x16_bf16 a[32:47], a[200:203], v[80:83], a[32:47]
ds_read_b128 a[136:139], v10 offset:18432
v_cmp_gt_i32_e64 s[84:85], 0, v247
v_cmp_gt_i32_e64 s[86:87], 1, v247
v_cmp_gt_i32_e64 s[88:89], 2, v247
v_cmp_gt_i32_e64 s[90:91], 3, v247
v_cndmask_b32_e64 v192, v192, v14, s[84:85]
v_mfma_f32_32x32x16_bf16 a[96:111], a[200:203], v[96:99], a[96:111]
v_cndmask_b32_e64 v193, v193, v14, s[86:87]
v_cndmask_b32_e64 v194, v194, v14, s[88:89]
v_cndmask_b32_e64 v195, v195, v14, s[90:91]
v_cmp_gt_i32_e64 s[92:93], 16, v247
v_mfma_f32_32x32x16_bf16 a[48:63], a[204:207], v[80:83], a[48:63]
ds_read_b128 a[140:143], v10 offset:19456
v_cmp_gt_i32_e64 s[94:95], 17, v247
v_cmp_gt_i32_e64 s[96:97], 18, v247
v_cmp_gt_i32_e64 s[98:99], 19, v247
v_cndmask_b32_e64 v196, v196, v14, s[92:93]
v_cndmask_b32_e64 v197, v197, v14, s[94:95]
v_mfma_f32_32x32x16_bf16 a[112:127], a[204:207], v[96:99], a[112:127]
v_cndmask_b32_e64 v198, v198, v14, s[96:97]
v_cndmask_b32_e64 v199, v199, v14, s[98:99]
v_cmp_gt_i32_e64 s[84:85], 8, v247
v_cmp_gt_i32_e64 s[86:87], 9, v247
v_cmp_gt_i32_e64 s[88:89], 10, v247
v_mfma_f32_32x32x16_bf16 a[0:15], a[208:211], v[88:91], a[0:15]
ds_read_b128 a[144:147], v10 offset:20480
v_cmp_gt_i32_e64 s[90:91], 11, v247
v_cndmask_b32_e64 v200, v200, v14, s[84:85]
v_cndmask_b32_e64 v201, v201, v14, s[86:87]
v_cndmask_b32_e64 v202, v202, v14, s[88:89]
v_cndmask_b32_e64 v203, v203, v14, s[90:91]
v_mfma_f32_32x32x16_bf16 a[64:79], a[208:211], v[104:107], a[64:79]
ds_read_b128 a[148:151], v10 offset:21504
v_cmp_gt_i32_e64 s[92:93], 24, v247
v_cmp_gt_i32_e64 s[94:95], 25, v247
v_cmp_gt_i32_e64 s[96:97], 26, v247
v_cmp_gt_i32_e64 s[98:99], 27, v247
v_cndmask_b32_e64 v204, v204, v14, s[92:93]
v_mfma_f32_32x32x16_bf16 a[16:31], a[212:215], v[88:91], a[16:31]
v_cndmask_b32_e64 v205, v205, v14, s[94:95]
v_cndmask_b32_e64 v206, v206, v14, s[96:97]
v_cndmask_b32_e64 v207, v207, v14, s[98:99]
v_max3_f32 v6, v6, v159, v176
v_mfma_f32_32x32x16_bf16 a[80:95], a[212:215], v[104:107], a[80:95]
ds_read_b128 a[152:155], v10 offset:22528
v_max3_f32 v7, v7, v175, v192
v_max3_f32 v6, v6, v177, v178
v_max3_f32 v7, v7, v193, v194
v_max3_f32 v6, v6, v179, v180
v_max3_f32 v7, v7, v195, v196
v_mfma_f32_32x32x16_bf16 a[32:47], a[216:219], v[88:91], a[32:47]
v_max3_f32 v6, v6, v181, v182
v_max3_f32 v7, v7, v197, v198
v_max3_f32 v6, v6, v183, v184
v_max3_f32 v7, v7, v199, v200
v_max3_f32 v6, v6, v185, v186
v_mfma_f32_32x32x16_bf16 a[96:111], a[216:219], v[104:107], a[96:111]
ds_read_b128 a[156:159], v10 offset:23552
v_max3_f32 v7, v7, v201, v202
v_max3_f32 v6, v6, v187, v188
v_max3_f32 v7, v7, v203, v204
v_max3_f32 v6, v6, v189, v190
v_max3_f32 v7, v7, v205, v206
v_mfma_f32_32x32x16_bf16 a[48:63], a[220:223], v[88:91], a[48:63]
v_max_f32 v6, v6, v191
v_max_f32 v7, v7, v207
v_max_f32 v240, v6, v7
v_cmp_lt_f32 vcc, s79, v240
v_mfma_f32_32x32x16_bf16 a[112:127], a[220:223], v[104:107], a[112:127]
s_cbranch_vccnz L_p3_d0m_rare
s_add_u32 m0, s72, 0
ds_read_b128 a[160:163], v10 offset:24576
v_exp_f32 v144, v144
v_exp_f32 v145, v145
v_mfma_f32_32x32x16_bf16 a[0:15], a[224:227], v[112:115], a[0:15]
ds_read_b128 a[164:167], v10 offset:25600
buffer_load_dwordx4 v12, s[52:55], s71 offen offset:0 sc1 lds
v_exp_f32 v146, v146
v_add_f32 v2, v2, v144
v_mfma_f32_32x32x16_bf16 a[64:79], a[224:227], v[128:131], a[64:79]
v_exp_f32 v147, v147
v_add_f32 v3, v3, v145
v_cvt_pk_bf16_f32 v144, v144, v145
v_exp_f32 v148, v148
v_mfma_f32_32x32x16_bf16 a[16:31], a[228:231], v[112:115], a[16:31]
ds_read_b128 a[168:171], v10 offset:26624
v_add_f32 v2, v2, v146
v_exp_f32 v149, v149
v_add_f32 v3, v3, v147
v_cvt_pk_bf16_f32 v145, v146, v147
v_mfma_f32_32x32x16_bf16 a[80:95], a[228:231], v[128:131], a[80:95]
ds_read_b128 a[172:175], v10 offset:27648
buffer_load_dwordx4 v12, s[52:55], s71 offen offset:1024 sc1 lds
v_exp_f32 v150, v150
v_add_f32 v2, v2, v148
v_mfma_f32_32x32x16_bf16 a[32:47], a[232:235], v[112:115], a[32:47]
v_exp_f32 v151, v151
v_add_f32 v3, v3, v149
v_cvt_pk_bf16_f32 v146, v148, v149
v_exp_f32 v152, v152
v_mfma_f32_32x32x16_bf16 a[96:111], a[232:235], v[128:131], a[96:111]
ds_read_b128 a[176:179], v10 offset:28672
v_add_f32 v2, v2, v150
v_exp_f32 v153, v153
v_add_f32 v3, v3, v151
v_cvt_pk_bf16_f32 v147, v150, v151
v_mfma_f32_32x32x16_bf16 a[48:63], a[236:239], v[112:115], a[48:63]
buffer_load_dwordx4 v12, s[52:55], s71 offen offset:2048 sc1 lds
v_exp_f32 v154, v154
v_add_f32 v2, v2, v152
v_exp_f32 v155, v155
v_mfma_f32_32x32x16_bf16 a[112:127], a[236:239], v[128:131], a[112:127]
ds_read_b128 a[180:183], v10 offset:29696
v_add_f32 v3, v3, v153
v_cvt_pk_bf16_f32 v152, v152, v153
v_exp_f32 v156, v156
v_add_f32 v2, v2, v154
v_mfma_f32_32x32x16_bf16 a[0:15], a[240:243], v[120:123], a[0:15]
ds_read_b128 a[184:187], v10 offset:30720
v_exp_f32 v157, v157
v_add_f32 v3, v3, v155
v_cvt_pk_bf16_f32 v153, v154, v155
v_mfma_f32_32x32x16_bf16 a[64:79], a[240:243], v[136:139], a[64:79]
buffer_load_dwordx4 v12, s[52:55], s71 offen offset:3072 sc1 lds
v_exp_f32 v158, v158
v_add_f32 v2, v2, v156
v_exp_f32 v159, v159
v_mfma_f32_32x32x16_bf16 a[16:31], a[244:247], v[120:123], a[16:31]
ds_read_b128 a[188:191], v10 offset:31744
v_add_f32 v3, v3, v157
v_cvt_pk_bf16_f32 v154, v156, v157
v_exp_f32 v160, v160
v_add_f32 v2, v2, v158
v_mfma_f32_32x32x16_bf16 a[80:95], a[244:247], v[136:139], a[80:95]
v_exp_f32 v161, v161
v_add_f32 v3, v3, v159
v_cvt_pk_bf16_f32 v155, v158, v159
v_exp_f32 v162, v162
v_mfma_f32_32x32x16_bf16 a[32:47], a[248:251], v[120:123], a[32:47]
s_cmp_eq_u32 s70, 7
v_add_f32 v4, v4, v160
v_exp_f32 v163, v163
v_add_f32 v5, v5, v161
v_cvt_pk_bf16_f32 v160, v160, v161
v_mfma_f32_32x32x16_bf16 a[96:111], a[248:251], v[136:139], a[96:111]
v_exp_f32 v164, v164
v_add_f32 v4, v4, v162
v_exp_f32 v165, v165
v_add_f32 v5, v5, v163
v_mfma_f32_32x32x16_bf16 a[48:63], a[252:255], v[120:123], a[48:63]
v_cvt_pk_bf16_f32 v161, v162, v163
v_exp_f32 v166, v166
v_add_f32 v4, v4, v164
v_exp_f32 v167, v167
v_mfma_f32_32x32x16_bf16 a[112:127], a[252:255], v[136:139], a[112:127]
v_add_f32 v5, v5, v165
v_cvt_pk_bf16_f32 v162, v164, v165
v_add_f32 v4, v4, v166
v_add_f32 v5, v5, v167
v_cvt_pk_bf16_f32 v163, v166, v167
L_p3_d0m_end:
s_cbranch_scc1 L_p3_mxm_top
s_waitcnt lgkmcnt(0)
v_xor_b32 v11, 0x8000, v11
v_mfma_f32_32x32x16_bf16 v[80:95], a[128:131], v[16:19], v[208:223]
s_add_u32 m0, s73, 16384
ds_read_b128 a[192:195], v11 offset:0
ds_read_b128 a[196:199], v11 offset:1024
v_exp_f32 v168, v168
v_mfma_f32_32x32x16_bf16 v[80:95], a[132:135], v[20:23], v[80:95]
ds_read_b128 a[200:203], v11 offset:2048
buffer_load_dwordx4 v12, s[56:59], s71 offen offset:0 sc1 lds
v_exp_f32 v169, v169
v_exp_f32 v170, v170
v_mfma_f32_32x32x16_bf16 v[80:95], a[136:139], v[24:27], v[80:95]
ds_read_b128 a[204:207], v11 offset:3072
ds_read_b128 a[208:211], v11 offset:4096
v_add_f32 v4, v4, v168
v_exp_f32 v171, v171
v_add_f32 v5, v5, v169
v_mfma_f32_32x32x16_bf16 v[80:95], a[140:143], v[28:31], v[80:95]
ds_read_b128 a[212:215], v11 offset:5120
buffer_load_dwordx4 v12, s[56:59], s71 offen offset:1024 sc1 lds
v_cvt_pk_bf16_f32 v168, v168, v169
v_exp_f32 v172, v172
v_add_f32 v4, v4, v170
v_mfma_f32_32x32x16_bf16 v[80:95], a[144:147], v[32:35], v[80:95]
ds_read_b128 a[216:219], v11 offset:6144
ds_read_b128 a[220:223], v11 offset:7168
v_exp_f32 v173, v173
v_add_f32 v5, v5, v171
v_cvt_pk_bf16_f32 v169, v170, v171
v_mfma_f32_32x32x16_bf16 v[80:95], a[148:151], v[36:39], v[80:95]
ds_read_b128 a[224:227], v11 offset:8192
v_exp_f32 v174, v174
v_add_f32 v4, v4, v172
v_exp_f32 v175, v175
v_mfma_f32_32x32x16_bf16 v[80:95], a[152:155], v[40:43], v[80:95]
ds_read_b128 a[228:231], v11 offset:9216
ds_read_b128 a[232:235], v11 offset:10240
buffer_load_dwordx4 v12, s[56:59], s71 offen offset:2048 sc1 lds
v_add_f32 v5, v5, v173
v_cvt_pk_bf16_f32 v170, v172, v173
v_mfma_f32_32x32x16_bf16 v[80:95], a[156:159], v[44:47], v[80:95]
ds_read_b128 a[236:239], v11 offset:11264
v_exp_f32 v176, v176
v_add_f32 v4, v4, v174
v_exp_f32 v177, v177
v_mfma_f32_32x32x16_bf16 v[112:127], a[160:163], v[16:19], v[208:223]
ds_read_b128 a[240:243], v11 offset:12288
ds_read_b128 a[244:247], v11 offset:13312
buffer_load_dwordx4 v12, s[56:59], s71 offen offset:3072 sc1 lds
v_add_f32 v5, v5, v175
v_cvt_pk_bf16_f32 v171, v174, v175
v_mfma_f32_32x32x16_bf16 v[112:127], a[164:167], v[20:23], v[112:127]
ds_read_b128 a[248:251], v11 offset:14336
v_exp_f32 v178, v178
v_add_f32 v2, v2, v176
v_exp_f32 v179, v179
v_mfma_f32_32x32x16_bf16 v[112:127], a[168:171], v[24:27], v[112:127]
ds_read_b128 a[252:255], v11 offset:15360
v_add_f32 v3, v3, v177
v_cvt_pk_bf16_f32 v176, v176, v177
v_exp_f32 v180, v180
v_add_f32 v2, v2, v178
v_mfma_f32_32x32x16_bf16 v[112:127], a[172:175], v[28:31], v[112:127]
s_add_u32 s71, s71, 16384
v_exp_f32 v181, v181
v_add_f32 v3, v3, v179
v_cvt_pk_bf16_f32 v177, v178, v179
v_mfma_f32_32x32x16_bf16 v[112:127], a[176:179], v[32:35], v[112:127]
v_exp_f32 v182, v182
v_add_f32 v2, v2, v180
v_exp_f32 v183, v183
v_add_f32 v3, v3, v181
v_mfma_f32_32x32x16_bf16 v[112:127], a[180:183], v[36:39], v[112:127]
s_xor_b32 s73, s73, 0x8000
v_cvt_pk_bf16_f32 v178, v180, v181
v_exp_f32 v184, v184
v_add_f32 v2, v2, v182
v_mfma_f32_32x32x16_bf16 v[112:127], a[184:187], v[40:43], v[112:127]
v_exp_f32 v185, v185
v_add_f32 v3, v3, v183
v_cvt_pk_bf16_f32 v179, v182, v183
v_exp_f32 v186, v186
v_mfma_f32_32x32x16_bf16 v[112:127], a[188:191], v[44:47], v[112:127]
v_add_f32 v2, v2, v184
v_exp_f32 v187, v187
v_add_f32 v3, v3, v185
v_cvt_pk_bf16_f32 v184, v184, v185
v_exp_f32 v188, v188
v_add_f32 v2, v2, v186
v_exp_f32 v189, v189
v_add_f32 v3, v3, v187
v_cvt_pk_bf16_f32 v185, v186, v187
v_exp_f32 v190, v190
v_add_f32 v2, v2, v188
v_exp_f32 v191, v191
v_add_f32 v3, v3, v189
v_cvt_pk_bf16_f32 v186, v188, v189
v_exp_f32 v192, v192
v_add_f32 v2, v2, v190
v_exp_f32 v193, v193
v_add_f32 v3, v3, v191
v_cvt_pk_bf16_f32 v187, v190, v191
v_exp_f32 v194, v194
v_add_f32 v4, v4, v192
v_exp_f32 v195, v195
v_add_f32 v5, v5, v193
v_cvt_pk_bf16_f32 v192, v192, v193
v_exp_f32 v196, v196
v_add_f32 v4, v4, v194
v_exp_f32 v197, v197
v_add_f32 v5, v5, v195
v_cvt_pk_bf16_f32 v193, v194, v195
v_exp_f32 v198, v198
v_add_f32 v4, v4, v196
v_exp_f32 v199, v199
v_add_f32 v5, v5, v197
v_cvt_pk_bf16_f32 v194, v196, v197
v_exp_f32 v200, v200
v_add_f32 v4, v4, v198
v_exp_f32 v201, v201
v_add_f32 v5, v5, v199
v_cvt_pk_bf16_f32 v195, v198, v199
v_exp_f32 v202, v202
v_add_f32 v4, v4, v200
v_exp_f32 v203, v203
v_add_f32 v5, v5, v201
v_cvt_pk_bf16_f32 v200, v200, v201
v_exp_f32 v204, v204
v_add_f32 v4, v4, v202
v_exp_f32 v205, v205
v_add_f32 v5, v5, v203
v_cvt_pk_bf16_f32 v201, v202, v203
v_exp_f32 v206, v206
v_add_f32 v4, v4, v204
v_exp_f32 v207, v207
v_add_f32 v5, v5, v205
v_cvt_pk_bf16_f32 v202, v204, v205
v_add_f32 v4, v4, v206
v_add_f32 v5, v5, v207
v_cvt_pk_bf16_f32 v203, v206, v207
s_waitcnt vmcnt(16) lgkmcnt(0)
v_mfma_f32_32x32x16_bf16 a[0:15], a[192:195], v[144:147], a[0:15]
s_barrier
v_xor_b32 v10, 0x8000, v10
v_mfma_f32_32x32x16_bf16 a[64:79], a[192:195], v[160:163], a[64:79]
ds_read_b128 a[128:131], v10 offset:0
v_max3_f32 v6, v80, v81, v82
v_max3_f32 v6, v6, v83, v84
v_max3_f32 v6, v6, v85, v86
v_max3_f32 v6, v6, v87, v88
v_max3_f32 v6, v6, v89, v90
v_mfma_f32_32x32x16_bf16 a[16:31], a[196:199], v[144:147], a[16:31]
v_max3_f32 v6, v6, v91, v92
v_max3_f32 v6, v6, v93, v94
v_max3_f32 v6, v6, v95, v112
v_max3_f32 v6, v6, v113, v114
v_mfma_f32_32x32x16_bf16 a[80:95], a[196:199], v[160:163], a[80:95]
ds_read_b128 a[132:135], v10 offset:1024
v_max3_f32 v6, v6, v115, v116
v_max3_f32 v6, v6, v117, v118
v_max3_f32 v6, v6, v119, v120
v_max3_f32 v6, v6, v121, v122
v_mfma_f32_32x32x16_bf16 a[32:47], a[200:203], v[144:147], a[32:47]
v_max3_f32 v6, v6, v123, v124
v_max3_f32 v6, v6, v125, v126
v_max_f32 v6, v6, v127
v_cmp_lt_f32 vcc, s79, v6
v_mfma_f32_32x32x16_bf16 a[96:111], a[200:203], v[160:163], a[96:111]
s_cbranch_vccnz L_p3_mx_rare
s_add_u32 m0, s72, 16384
ds_read_b128 a[136:139], v10 offset:2048
v_exp_f32 v80, v80
v_bfe_u32 v248, v1, 2, 2
v_bfe_u32 v249, v1, 4, 1
v_mfma_f32_32x32x16_bf16 a[48:63], a[204:207], v[144:147], a[48:63]
ds_read_b128 a[140:143], v10 offset:3072
buffer_load_dwordx4 v12, s[52:55], s71 offen offset:0 sc1 lds
v_lshl_add_u32 v248, v249, 2, v248
v_lshrrev_b32 v249, 5, v1
v_exp_f32 v81, v81
v_mfma_f32_32x32x16_bf16 a[112:127], a[204:207], v[160:163], a[112:127]
v_lshl_add_u32 v249, v249, 4, v248
v_lshlrev_b32 v249, 8, v249
v_and_b32 v250, 3, v1
v_exp_f32 v82, v82
v_lshl_add_u32 v249, v250, 3, v249
v_mfma_f32_32x32x16_bf16 a[0:15], a[208:211], v[152:155], a[0:15]
ds_read_b128 a[144:147], v10 offset:4096
s_lshl_b32 s36, s3, 13
s_add_u32 s36, s36, 131072
v_add_f32 v2, v2, v80
v_add_u32 v249, s36, v249
v_xor_b32 v250, 0, v248
v_mfma_f32_32x32x16_bf16 a[64:79], a[208:211], v[168:171], a[64:79]
ds_read_b128 a[148:151], v10 offset:5120
v_lshl_add_u32 v250, v250, 5, v249
TR 96,250,0
v_exp_f32 v83, v83
TR 98,250,2048
v_mfma_f32_32x32x16_bf16 a[16:31], a[212:215], v[152:155], a[16:31]
v_xor_b32 v250, 1, v248
v_lshl_add_u32 v250, v250, 5, v249
v_add_f32 v3, v3, v81
TR 100,250,0
TR 102,250,2048
v_xor_b32 v250, 2, v248
v_mfma_f32_32x32x16_bf16 a[80:95], a[212:215], v[168:171], a[80:95]
ds_read_b128 a[152:155], v10 offset:6144
buffer_load_dwordx4 v12, s[52:55], s71 offen offset:1024 sc1 lds
v_cvt_pk_bf16_f32 v80, v80, v81
v_lshl_add_u32 v250, v250, 5, v249
TR 104,250,0
TR 106,250,2048
v_mfma_f32_32x32x16_bf16 a[32:47], a[216:219], v[152:155], a[32:47]
v_exp_f32 v84, v84
v_xor_b32 v250, 3, v248
v_lshl_add_u32 v250, v250, 5, v249
TR 108,250,0
TR 110,250,2048
v_mfma_f32_32x32x16_bf16 a[96:111], a[216:219], v[168:171], a[96:111]
ds_read_b128 a[156:159], v10 offset:7168
v_add_f32 v2, v2, v82
v_xor_b32 v250, 4, v248
v_lshl_add_u32 v250, v250, 5, v249
TR 128,250,0
v_mfma_f32_32x32x16_bf16 a[48:63], a[220:223], v[152:155], a[48:63]
ds_read_b128 a[160:163], v10 offset:8192
v_exp_f32 v85, v85
TR 130,250,2048
v_xor_b32 v250, 5, v248
v_lshl_add_u32 v250, v250, 5, v249
v_mfma_f32_32x32x16_bf16 a[112:127], a[220:223], v[168:171], a[112:127]
v_add_f32 v3, v3, v83
v_cvt_pk_bf16_f32 v81, v82, v83
TR 132,250,0
TR 134,250,2048
v_xor_b32 v250, 6, v248
v_mfma_f32_32x32x16_bf16 a[0:15], a[224:227], v[176:179], a[0:15]
ds_read_b128 a[164:167], v10 offset:9216
buffer_load_dwordx4 v12, s[52:55], s71 offen offset:2048 sc1 lds
v_exp_f32 v86, v86
v_lshl_add_u32 v250, v250, 5, v249
TR 136,250,0
v_mfma_f32_32x32x16_bf16 a[64:79], a[224:227], v[192:195], a[64:79]
TR 138,250,2048
v_xor_b32 v250, 7, v248
v_add_f32 v2, v2, v84
v_lshl_add_u32 v250, v250, 5, v249
TR 140,250,0
TR 142,250,2048
v_mfma_f32_32x32x16_bf16 a[16:31], a[228:231], v[176:179], a[16:31]
ds_read_b128 a[168:171], v10 offset:10240
v_exp_f32 v87, v87
s_add_u32 s32, s40, 100663296
s_addc_u32 s33, s41, 0
s_mov_b32 s34, 8388608
v_mfma_f32_32x32x16_bf16 a[80:95], a[228:231], v[192:195], a[80:95]
ds_read_b128 a[172:175], v10 offset:11264
v_add_f32 v3, v3, v85
s_mov_b32 s35, 0x20000
s_and_b32 s36, s2, 7
s_lshl_b32 s36, s36, 20
v_mfma_f32_32x32x16_bf16 a[32:47], a[232:235], v[176:179], a[32:47]
v_cvt_pk_bf16_f32 v82, v84, v85
s_lshr_b32 s37, s2, 3
s_lshl_b32 s37, s37, 15
s_add_u32 s36, s36, s37
s_lshl_b32 s37, s3, 12
v_mfma_f32_32x32x16_bf16 a[96:111], a[232:235], v[192:195], a[96:111]
ds_read_b128 a[176:179], v10 offset:12288
buffer_load_dwordx4 v12, s[52:55], s71 offen offset:3072 sc1 lds
v_exp_f32 v88, v88
s_add_u32 s36, s36, s37
s_add_u32 s37, s36, 4096
v_mfma_f32_32x32x16_bf16 a[48:63], a[236:239], v[176:179], a[48:63]
s_waitcnt lgkmcnt(15)
buffer_store_dwordx4 v[96:99], v12, s[32:35], s36 offen offset:0 sc1
v_add_f32 v2, v2, v86
buffer_store_dwordx4 v[100:103], v12, s[32:35], s36 offen offset:1024 sc1
buffer_store_dwordx4 v[104:107], v12, s[32:35], s36 offen offset:2048 sc1
s_waitcnt lgkmcnt(14)
buffer_store_dwordx4 v[108:111], v12, s[32:35], s36 offen offset:3072 sc1
v_mfma_f32_32x32x16_bf16 a[112:127], a[236:239], v[192:195], a[112:127]
ds_read_b128 a[180:183], v10 offset:13312
v_exp_f32 v89, v89
s_waitcnt lgkmcnt(11)
buffer_store_dwordx4 v[128:131], v12, s[32:35], s37 offen offset:0 sc1
s_waitcnt lgkmcnt(9)
buffer_store_dwordx4 v[132:135], v12, s[32:35], s37 offen offset:1024 sc1
s_waitcnt lgkmcnt(6)
buffer_store_dwordx4 v[136:139], v12, s[32:35], s37 offen offset:2048 sc1
v_mfma_f32_32x32x16_bf16 a[0:15], a[240:243], v[184:187], a[0:15]
ds_read_b128 a[184:187], v10 offset:14336
v_add_f32 v3, v3, v87
v_cvt_pk_bf16_f32 v83, v86, v87
s_waitcnt lgkmcnt(5)
buffer_store_dwordx4 v[140:143], v12, s[32:35], s37 offen offset:3072 sc1
s_add_u32 s32, s40, 109051904
s_addc_u32 s33, s41, 0
v_mfma_f32_32x32x16_bf16 a[64:79], a[240:243], v[200:203], a[64:79]
s_mov_b32 s34, 4194304
v_exp_f32 v90, v90
s_mov_b32 s35, 0x20000
s_lshl_b32 s36, s2, 14
v_mov_b32 v252, -1
v_mfma_f32_32x32x16_bf16 a[16:31], a[244:247], v[184:187], a[16:31]
ds_read_b128 a[188:191], v10 offset:15360
s_xor_b32 s72, s72, 0x8000
v_add_f32 v2, v2, v88
v_mov_b32 v253, -1
v_mov_b32 v254, -1
v_mov_b32 v255, -1
v_mfma_f32_32x32x16_bf16 a[80:95], a[244:247], v[200:203], a[80:95]
v_exp_f32 v91, v91
buffer_store_dwordx4 v[252:255], v12, s[32:35], s36 offen offset:0 sc1
buffer_store_dwordx4 v[252:255], v12, s[32:35], s36 offen offset:1024 sc1
buffer_store_dwordx4 v[252:255], v12, s[32:35], s36 offen offset:2048 sc1
v_mfma_f32_32x32x16_bf16 a[32:47], a[248:251], v[184:187], a[32:47]
v_add_f32 v3, v3, v89
buffer_store_dwordx4 v[252:255], v12, s[32:35], s36 offen offset:3072 sc1
v_lshlrev_b32 v72, 4, v1
v_add_u32 v73, -8, v72
v_mov_b32 v75, 0
v_mfma_f32_32x32x16_bf16 a[96:111], a[248:251], v[200:203], a[96:111]
v_cvt_pk_bf16_f32 v88, v88, v89
buffer_load_ushort v74, v75, s[28:31], s42 offen
buffer_load_dwordx2 v[48:49], v73, s[16:19], 0 offen
buffer_load_dwordx4 v[50:53], v72, s[16:19], 0 offen offset:0
v_mfma_f32_32x32x16_bf16 a[48:63], a[252:255], v[184:187], a[48:63]
v_add_f32 v2, v2, v90
v_add_f32 v3, v3, v91
buffer_load_dwordx2 v[54:55], v72, s[16:19], 0 offen offset:1016
buffer_load_dwordx4 v[56:59], v72, s[16:19], 0 offen offset:1024
buffer_load_dwordx2 v[60:61], v72, s[16:19], 0 offen offset:2040
v_mfma_f32_32x32x16_bf16 a[112:127], a[252:255], v[200:203], a[112:127]
v_cvt_pk_bf16_f32 v89, v90, v91
buffer_load_dwordx4 v[62:65], v72, s[16:19], 0 offen offset:2048
buffer_load_dwordx2 v[66:67], v72, s[16:19], 0 offen offset:3064
buffer_load_dwordx4 v[68:71], v72, s[16:19], 0 offen offset:3072
L_p3_mx_end:
L_p3_eps:
v_add_f32 v4, v4, v5
v_mov_b32 v5, v4
s_nop 1
v_permlane32_swap_b32 v4, v5
v_add_f32 v4, v4, v5
v_rcp_f32 v4, v4
s_nop 7
v_accvgpr_read_b32 v240, a64
v_accvgpr_read_b32 v241, a65
v_accvgpr_read_b32 v242, a66
v_accvgpr_read_b32 v243, a67
v_accvgpr_read_b32 v244, a68
v_accvgpr_read_b32 v245, a69
v_accvgpr_read_b32 v246, a70
v_accvgpr_read_b32 v247, a71
v_mul_f32 v240, v240, v4
v_mul_f32 v241, v241, v4
v_mul_f32 v242, v242, v4
v_mul_f32 v243, v243, v4
v_mul_f32 v244, v244, v4
v_mul_f32 v245, v245, v4
v_mul_f32 v246, v246, v4
v_mul_f32 v247, v247, v4
v_cvt_pk_bf16_f32 v248, v240, v241
v_cvt_pk_bf16_f32 v249, v242, v243
v_cvt_pk_bf16_f32 v250, v244, v245
v_cvt_pk_bf16_f32 v251, v246, v247
buffer_store_dwordx4 v[248:251], v15, s[60:63], s101 offen offset:0 sc1
v_accvgpr_read_b32 v240, a72
v_accvgpr_read_b32 v241, a73
v_accvgpr_read_b32 v242, a74
v_accvgpr_read_b32 v243, a75
v_accvgpr_read_b32 v244, a76
v_accvgpr_read_b32 v245, a77
v_accvgpr_read_b32 v246, a78
v_accvgpr_read_b32 v247, a79
v_mul_f32 v240, v240, v4
v_mul_f32 v241, v241, v4
v_mul_f32 v242, v242, v4
v_mul_f32 v243, v243, v4
v_mul_f32 v244, v244, v4
v_mul_f32 v245, v245, v4
v_mul_f32 v246, v246, v4
v_mul_f32 v247, v247, v4
v_cvt_pk_bf16_f32 v252, v240, v241
v_cvt_pk_bf16_f32 v253, v242, v243
v_cvt_pk_bf16_f32 v254, v244, v245
v_cvt_pk_bf16_f32 v255, v246, v247
buffer_store_dwordx4 v[252:255], v15, s[60:63], s101 offen offset:512 sc1
v_accvgpr_read_b32 v240, a80
v_accvgpr_read_b32 v241, a81
v_accvgpr_read_b32 v242, a82
v_accvgpr_read_b32 v243, a83
v_accvgpr_read_b32 v244, a84
v_accvgpr_read_b32 v245, a85
v_accvgpr_read_b32 v246, a86
v_accvgpr_read_b32 v247, a87
v_mul_f32 v240, v240, v4
v_mul_f32 v241, v241, v4
v_mul_f32 v242, v242, v4
v_mul_f32 v243, v243, v4
v_mul_f32 v244, v244, v4
v_mul_f32 v245, v245, v4
v_mul_f32 v246, v246, v4
v_mul_f32 v247, v247, v4
v_cvt_pk_bf16_f32 v248, v240, v241
v_cvt_pk_bf16_f32 v249, v242, v243
v_cvt_pk_bf16_f32 v250, v244, v245
v_cvt_pk_bf16_f32 v251, v246, v247
buffer_store_dwordx4 v[248:251], v15, s[60:63], s101 offen offset:1024 sc1
v_accvgpr_read_b32 v240, a88
v_accvgpr_read_b32 v241, a89
v_accvgpr_read_b32 v242, a90
v_accvgpr_read_b32 v243, a91
v_accvgpr_read_b32 v244, a92
v_accvgpr_read_b32 v245, a93
v_accvgpr_read_b32 v246, a94
v_accvgpr_read_b32 v247, a95
v_mul_f32 v240, v240, v4
v_mul_f32 v241, v241, v4
v_mul_f32 v242, v242, v4
v_mul_f32 v243, v243, v4
v_mul_f32 v244, v244, v4
v_mul_f32 v245, v245, v4
v_mul_f32 v246, v246, v4
v_mul_f32 v247, v247, v4
v_cvt_pk_bf16_f32 v252, v240, v241
v_cvt_pk_bf16_f32 v253, v242, v243
v_cvt_pk_bf16_f32 v254, v244, v245
v_cvt_pk_bf16_f32 v255, v246, v247
buffer_store_dwordx4 v[252:255], v15, s[60:63], s101 offen offset:1536 sc1
v_accvgpr_read_b32 v240, a96
v_accvgpr_read_b32 v241, a97
v_accvgpr_read_b32 v242, a98
v_accvgpr_read_b32 v243, a99
v_accvgpr_read_b32 v244, a100
v_accvgpr_read_b32 v245, a101
v_accvgpr_read_b32 v246, a102
v_accvgpr_read_b32 v247, a103
v_mul_f32 v240, v240, v4
v_mul_f32 v241, v241, v4
v_mul_f32 v242, v242, v4
v_mul_f32 v243, v243, v4
v_mul_f32 v244, v244, v4
v_mul_f32 v245, v245, v4
v_mul_f32 v246, v246, v4
v_mul_f32 v247, v247, v4
v_cvt_pk_bf16_f32 v248, v240, v241
v_cvt_pk_bf16_f32 v249, v242, v243
v_cvt_pk_bf16_f32 v250, v244, v245
v_cvt_pk_bf16_f32 v251, v246, v247
buffer_store_dwordx4 v[248:251], v15, s[60:63], s101 offen offset:2048 sc1
v_accvgpr_read_b32 v240, a104
v_accvgpr_read_b32 v241, a105
v_accvgpr_read_b32 v242, a106
v_accvgpr_read_b32 v243, a107
v_accvgpr_read_b32 v244, a108
v_accvgpr_read_b32 v245, a109
v_accvgpr_read_b32 v246, a110
v_accvgpr_read_b32 v247, a111
v_mul_f32 v240, v240, v4
v_mul_f32 v241, v241, v4
v_mul_f32 v242, v242, v4
v_mul_f32 v243, v243, v4
v_mul_f32 v244, v244, v4
v_mul_f32 v245, v245, v4
v_mul_f32 v246, v246, v4
v_mul_f32 v247, v247, v4
v_cvt_pk_bf16_f32 v252, v240, v241
v_cvt_pk_bf16_f32 v253, v242, v243
v_cvt_pk_bf16_f32 v254, v244, v245
v_cvt_pk_bf16_f32 v255, v246, v247
buffer_store_dwordx4 v[252:255], v15, s[60:63], s101 offen offset:2560 sc1
v_accvgpr_read_b32 v240, a112
v_accvgpr_read_b32 v241, a113
v_accvgpr_read_b32 v242, a114
v_accvgpr_read_b32 v243, a115
v_accvgpr_read_b32 v244, a116
v_accvgpr_read_b32 v245, a117
v_accvgpr_read_b32 v246, a118
v_accvgpr_read_b32 v247, a119
v_mul_f32 v240, v240, v4
v_mul_f32 v241, v241, v4
v_mul_f32 v242, v242, v4
v_mul_f32 v243, v243, v4
v_mul_f32 v244, v244, v4
v_mul_f32 v245, v245, v4
v_mul_f32 v246, v246, v4
v_mul_f32 v247, v247, v4
v_cvt_pk_bf16_f32 v248, v240, v241
v_cvt_pk_bf16_f32 v249, v242, v243
v_cvt_pk_bf16_f32 v250, v244, v245
v_cvt_pk_bf16_f32 v251, v246, v247
buffer_store_dwordx4 v[248:251], v15, s[60:63], s101 offen offset:3072 sc1
v_accvgpr_read_b32 v240, a120
v_accvgpr_read_b32 v241, a121
v_accvgpr_read_b32 v242, a122
v_accvgpr_read_b32 v243, a123
v_accvgpr_read_b32 v244, a124
v_accvgpr_read_b32 v245, a125
v_accvgpr_read_b32 v246, a126
v_accvgpr_read_b32 v247, a127
v_mul_f32 v240, v240, v4
v_mul_f32 v241, v241, v4
v_mul_f32 v242, v242, v4
v_mul_f32 v243, v243, v4
v_mul_f32 v244, v244, v4
v_mul_f32 v245, v245, v4
v_mul_f32 v246, v246, v4
v_mul_f32 v247, v247, v4
v_cvt_pk_bf16_f32 v252, v240, v241
v_cvt_pk_bf16_f32 v253, v242, v243
v_cvt_pk_bf16_f32 v254, v244, v245
v_cvt_pk_bf16_f32 v255, v246, v247
buffer_store_dwordx4 v[252:255], v15, s[60:63], s101 offen offset:3584 sc1
s_and_b32 s36, s2, 3
s_lshl_b32 s36, s36, 1
s_sub_u32 s32, 14, s36
s_bitcmp1_b32 s2, 4
s_cselect_b32 s36, s32, s36
s_bfe_u32 s32, s2, 0x10003
s_add_u32 s36, s36, s32
s_bfe_u32 s37, s2, 0x10002
s_lshr_b32 s32, s2, 5
s_lshl_b32 s32, s32, 1
s_add_u32 s37, s37, s32
s_lshl_b32 s36, s36, 2
s_add_u32 s36, s36, s3
s_lshl_b32 s37, s37, 7
s_lshl_b32 s32, s36, 16
s_add_u32 s37, s37, s32
s_lshl_b32 s36, s36, 7
v_and_b32 v240, 15, v1
v_bfe_u32 v241, v1, 4, 1
v_lshlrev_b32 v241, 5, v241
v_lshrrev_b32 v242, 5, v1
v_lshl_add_u32 v241, v242, 4, v241
v_lshl_add_u32 v241, v240, 11, v241
v_lshlrev_b32 v240, 2, v240
s_add_u32 s32, s40, 58720256
s_addc_u32 s33, s41, 0
s_mov_b32 s34, 8192
s_mov_b32 s35, 0x20000
buffer_load_dwordx4 v[192:195], v241, s[44:47], s37 offen offset:0
buffer_load_dwordx4 v[196:199], v241, s[44:47], s37 offen offset:64
buffer_load_dword v224, v240, s[32:35], s36 offen offset:0 sc1
s_add_u32 s37, s37, 32768
buffer_load_dwordx4 v[200:203], v241, s[44:47], s37 offen offset:0
buffer_load_dwordx4 v[204:207], v241, s[44:47], s37 offen offset:64
buffer_load_dword v225, v240, s[32:35], s36 offen offset:64 sc1
v_lshlrev_b32 v76, 20, v1
s_lshl_b32 s36, s3, 26
v_add_u32 v76, s36, v76
v_mov_b32 v77, 1
s_lshl_b32 s37, s2, 2
s_lshl_b32 s74, s70, 1
s_sub_u32 s74, 13, s74
s_cbranch_scc1 L_p3_s0m_top
.p2align 5
L_p3_s0_top:
s_waitcnt lgkmcnt(0)
v_mfma_f32_32x32x16_bf16 v[144:159], a[128:131], v[16:19], v[208:223]
s_add_u32 m0, s73, 0
ds_read_b128 a[192:195], v11 offset:16384
ds_read_b128 a[196:199], v11 offset:17408
v_exp_f32 v92, v92
v_mfma_f32_32x32x16_bf16 v[144:159], a[132:135], v[20:23], v[144:159]
ds_read_b128 a[200:203], v11 offset:18432
buffer_load_dwordx4 v12, s[56:59], s71 offen offset:0 sc1 lds
v_exp_f32 v93, v93
v_exp_f32 v94, v94
v_mfma_f32_32x32x16_bf16 v[144:159], a[136:139], v[24:27], v[144:159]
ds_read_b128 a[204:207], v11 offset:19456
ds_read_b128 a[208:211], v11 offset:20480
v_add_f32 v2, v2, v92
v_exp_f32 v95, v95
v_add_f32 v3, v3, v93
v_mfma_f32_32x32x16_bf16 v[144:159], a[140:143], v[28:31], v[144:159]
ds_read_b128 a[212:215], v11 offset:21504
v_cvt_pk_bf16_f32 v90, v92, v93
v_exp_f32 v112, v112
v_add_f32 v2, v2, v94
v_mfma_f32_32x32x16_bf16 v[144:159], a[144:147], v[32:35], v[144:159]
ds_read_b128 a[216:219], v11 offset:22528
ds_read_b128 a[220:223], v11 offset:23552
buffer_load_dwordx4 v12, s[56:59], s71 offen offset:1024 sc1 lds
v_exp_f32 v113, v113
v_add_f32 v3, v3, v95
v_mfma_f32_32x32x16_bf16 v[144:159], a[148:151], v[36:39], v[144:159]
ds_read_b128 a[224:227], v11 offset:24576
v_cvt_pk_bf16_f32 v91, v94, v95
v_exp_f32 v114, v114
v_add_f32 v2, v2, v112
v_mfma_f32_32x32x16_bf16 v[144:159], a[152:155], v[40:43], v[144:159]
ds_read_b128 a[228:231], v11 offset:25600
ds_read_b128 a[232:235], v11 offset:26624
v_exp_f32 v115, v115
v_add_f32 v3, v3, v113
v_cvt_pk_bf16_f32 v112, v112, v113
v_mfma_f32_32x32x16_bf16 v[144:159], a[156:159], v[44:47], v[144:159]
ds_read_b128 a[236:239], v11 offset:27648
buffer_load_dwordx4 v12, s[56:59], s71 offen offset:2048 sc1 lds
v_exp_f32 v116, v116
v_add_f32 v2, v2, v114
v_mfma_f32_32x32x16_bf16 v[176:191], a[160:163], v[16:19], v[208:223]
ds_read_b128 a[240:243], v11 offset:28672
ds_read_b128 a[244:247], v11 offset:29696
v_exp_f32 v117, v117
v_add_f32 v3, v3, v115
v_cvt_pk_bf16_f32 v113, v114, v115
v_mfma_f32_32x32x16_bf16 v[176:191], a[164:167], v[20:23], v[176:191]
ds_read_b128 a[248:251], v11 offset:30720
v_exp_f32 v118, v118
v_add_f32 v2, v2, v116
v_exp_f32 v119, v119
v_mfma_f32_32x32x16_bf16 v[176:191], a[168:171], v[24:27], v[176:191]
ds_read_b128 a[252:255], v11 offset:31744
buffer_load_dwordx4 v12, s[56:59], s71 offen offset:3072 sc1 lds
v_add_f32 v3, v3, v117
v_cvt_pk_bf16_f32 v114, v116, v117
v_exp_f32 v120, v120
v_mfma_f32_32x32x16_bf16 v[176:191], a[172:175], v[28:31], v[176:191]
v_add_f32 v2, v2, v118
v_exp_f32 v121, v121
v_add_f32 v3, v3, v119
v_cvt_pk_bf16_f32 v115, v118, v119
v_mfma_f32_32x32x16_bf16 v[176:191], a[176:179], v[32:35], v[176:191]
v_exp_f32 v122, v122
v_add_f32 v2, v2, v120
v_exp_f32 v123, v123
v_add_f32 v3, v3, v121
v_mfma_f32_32x32x16_bf16 v[176:191], a[180:183], v[36:39], v[176:191]
s_add_u32 s71, s71, 16384
v_cvt_pk_bf16_f32 v120, v120, v121
v_exp_f32 v124, v124
v_add_f32 v2, v2, v122
v_mfma_f32_32x32x16_bf16 v[176:191], a[184:187], v[40:43], v[176:191]
v_exp_f32 v125, v125
v_add_f32 v3, v3, v123
v_cvt_pk_bf16_f32 v121, v122, v123
v_exp_f32 v126, v126
v_mfma_f32_32x32x16_bf16 v[176:191], a[188:191], v[44:47], v[176:191]
v_add_f32 v2, v2, v124
v_exp_f32 v127, v127
v_add_f32 v3, v3, v125
v_cvt_pk_bf16_f32 v122, v124, v125
v_add_f32 v2, v2, v126
v_add_f32 v3, v3, v127
v_cvt_pk_bf16_f32 v123, v126, v127
s_waitcnt vmcnt(16) lgkmcnt(0)
v_mfma_f32_32x32x16_bf16 a[0:15], a[192:195], v[80:83], a[0:15]
s_barrier
v_mfma_f32_32x32x16_bf16 a[16:31], a[196:199], v[80:83], a[16:31]
ds_read_b128 a[128:131], v10 offset:16384
ds_read_b128 a[132:135], v10 offset:17408
v_max3_f32 v6, v144, v145, v146
v_max3_f32 v6, v6, v147, v148
v_max3_f32 v6, v6, v149, v150
v_max3_f32 v6, v6, v151, v152
v_mfma_f32_32x32x16_bf16 a[32:47], a[200:203], v[80:83], a[32:47]
ds_read_b128 a[136:139], v10 offset:18432
v_max3_f32 v6, v6, v153, v154
v_max3_f32 v6, v6, v155, v156
v_max3_f32 v6, v6, v157, v158
v_max3_f32 v6, v6, v159, v176
v_max3_f32 v6, v6, v177, v178
v_mfma_f32_32x32x16_bf16 a[48:63], a[204:207], v[80:83], a[48:63]
ds_read_b128 a[140:143], v10 offset:19456
ds_read_b128 a[144:147], v10 offset:20480
v_max3_f32 v6, v6, v179, v180
v_max3_f32 v6, v6, v181, v182
v_max3_f32 v6, v6, v183, v184
v_max3_f32 v6, v6, v185, v186
v_mfma_f32_32x32x16_bf16 a[0:15], a[208:211], v[88:91], a[0:15]
ds_read_b128 a[148:151], v10 offset:21504
v_max3_f32 v6, v6, v187, v188
v_max3_f32 v6, v6, v189, v190
v_max_f32 v6, v6, v191
v_cmp_lt_f32 vcc, s79, v6
v_mfma_f32_32x32x16_bf16 a[16:31], a[212:215], v[88:91], a[16:31]
s_cbranch_vccnz L_p3_s0_rare
s_add_u32 m0, s72, 0
ds_read_b128 a[152:155], v10 offset:22528
ds_read_b128 a[156:159], v10 offset:23552
v_exp_f32 v144, v144
v_mfma_f32_32x32x16_bf16 a[32:47], a[216:219], v[88:91], a[32:47]
ds_read_b128 a[160:163], v10 offset:24576
buffer_load_dwordx4 v12, s[52:55], s71 offen offset:0 sc1 lds
v_exp_f32 v145, v145
v_exp_f32 v146, v146
v_mfma_f32_32x32x16_bf16 a[48:63], a[220:223], v[88:91], a[48:63]
ds_read_b128 a[164:167], v10 offset:25600
ds_read_b128 a[168:171], v10 offset:26624
v_add_f32 v2, v2, v144
v_exp_f32 v147, v147
v_add_f32 v3, v3, v145
v_mfma_f32_32x32x16_bf16 a[0:15], a[224:227], v[112:115], a[0:15]
ds_read_b128 a[172:175], v10 offset:27648
buffer_load_dwordx4 v12, s[52:55], s71 offen offset:1024 sc1 lds
v_cvt_pk_bf16_f32 v144, v144, v145
v_exp_f32 v148, v148
v_add_f32 v2, v2, v146
v_mfma_f32_32x32x16_bf16 a[16:31], a[228:231], v[112:115], a[16:31]
ds_read_b128 a[176:179], v10 offset:28672
ds_read_b128 a[180:183], v10 offset:29696
v_exp_f32 v149, v149
v_add_f32 v3, v3, v147
v_cvt_pk_bf16_f32 v145, v146, v147
v_mfma_f32_32x32x16_bf16 a[32:47], a[232:235], v[112:115], a[32:47]
ds_read_b128 a[184:187], v10 offset:30720
buffer_load_dwordx4 v12, s[52:55], s71 offen offset:2048 sc1 lds
v_exp_f32 v150, v150
v_add_f32 v2, v2, v148
v_mfma_f32_32x32x16_bf16 a[48:63], a[236:239], v[112:115], a[48:63]
ds_read_b128 a[188:191], v10 offset:31744
v_exp_f32 v151, v151
v_add_f32 v3, v3, v149
v_cvt_pk_bf16_f32 v146, v148, v149
v_mfma_f32_32x32x16_bf16 a[0:15], a[240:243], v[120:123], a[0:15]
buffer_load_dwordx4 v12, s[52:55], s71 offen offset:3072 sc1 lds
v_exp_f32 v152, v152
v_add_f32 v2, v2, v150
v_exp_f32 v153, v153
v_mfma_f32_32x32x16_bf16 a[16:31], a[244:247], v[120:123], a[16:31]
v_add_f32 v3, v3, v151
v_cvt_pk_bf16_f32 v147, v150, v151
v_exp_f32 v154, v154
v_add_f32 v2, v2, v152
v_mfma_f32_32x32x16_bf16 a[32:47], a[248:251], v[120:123], a[32:47]
s_sub_u32 s74, s74, 1
v_exp_f32 v155, v155
v_add_f32 v3, v3, v153
v_cvt_pk_bf16_f32 v152, v152, v153
v_mfma_f32_32x32x16_bf16 a[48:63], a[252:255], v[120:123], a[48:63]
v_add_f32 v2, v2, v154
v_add_f32 v3, v3, v155
v_cvt_pk_bf16_f32 v153, v154, v155
L_p3_s0_end:
s_cbranch_scc1 L_p3_s1m_top
s_waitcnt lgkmcnt(0)
v_xor_b32 v11, 0x8000, v11
v_mfma_f32_32x32x16_bf16 v[80:95], a[128:131], v[16:19], v[208:223]
s_add_u32 m0, s73, 16384
ds_read_b128 a[192:195], v11 offset:0
ds_read_b128 a[196:199], v11 offset:1024
v_exp_f32 v156, v156
v_mfma_f32_32x32x16_bf16 v[80:95], a[132:135], v[20:23], v[80:95]
ds_read_b128 a[200:203], v11 offset:2048
buffer_load_dwordx4 v12, s[56:59], s71 offen offset:0 sc1 lds
v_exp_f32 v157, v157
v_exp_f32 v158, v158
v_mfma_f32_32x32x16_bf16 v[80:95], a[136:139], v[24:27], v[80:95]
ds_read_b128 a[204:207], v11 offset:3072
ds_read_b128 a[208:211], v11 offset:4096
v_add_f32 v2, v2, v156
v_exp_f32 v159, v159
v_add_f32 v3, v3, v157
v_mfma_f32_32x32x16_bf16 v[80:95], a[140:143], v[28:31], v[80:95]
ds_read_b128 a[212:215], v11 offset:5120
buffer_load_dwordx4 v12, s[56:59], s71 offen offset:1024 sc1 lds
v_cvt_pk_bf16_f32 v154, v156, v157
v_exp_f32 v176, v176
v_add_f32 v2, v2, v158
v_mfma_f32_32x32x16_bf16 v[80:95], a[144:147], v[32:35], v[80:95]
ds_read_b128 a[216:219], v11 offset:6144
ds_read_b128 a[220:223], v11 offset:7168
v_exp_f32 v177, v177
v_add_f32 v3, v3, v159
v_cvt_pk_bf16_f32 v155, v158, v159
v_mfma_f32_32x32x16_bf16 v[80:95], a[148:151], v[36:39], v[80:95]
ds_read_b128 a[224:227], v11 offset:8192
v_exp_f32 v178, v178
v_add_f32 v2, v2, v176
v_exp_f32 v179, v179
v_mfma_f32_32x32x16_bf16 v[80:95], a[152:155], v[40:43], v[80:95]
ds_read_b128 a[228:231], v11 offset:9216
ds_read_b128 a[232:235], v11 offset:10240
buffer_load_dwordx4 v12, s[56:59], s71 offen offset:2048 sc1 lds
v_add_f32 v3, v3, v177
v_cvt_pk_bf16_f32 v176, v176, v177
v_mfma_f32_32x32x16_bf16 v[80:95], a[156:159], v[44:47], v[80:95]
ds_read_b128 a[236:239], v11 offset:11264
v_exp_f32 v180, v180
v_add_f32 v2, v2, v178
v_exp_f32 v181, v181
v_mfma_f32_32x32x16_bf16 v[112:127], a[160:163], v[16:19], v[208:223]
ds_read_b128 a[240:243], v11 offset:12288
ds_read_b128 a[244:247], v11 offset:13312
buffer_load_dwordx4 v12, s[56:59], s71 offen offset:3072 sc1 lds
v_add_f32 v3, v3, v179
v_cvt_pk_bf16_f32 v177, v178, v179
v_mfma_f32_32x32x16_bf16 v[112:127], a[164:167], v[20:23], v[112:127]
ds_read_b128 a[248:251], v11 offset:14336
v_exp_f32 v182, v182
v_add_f32 v2, v2, v180
v_exp_f32 v183, v183
v_mfma_f32_32x32x16_bf16 v[112:127], a[168:171], v[24:27], v[112:127]
ds_read_b128 a[252:255], v11 offset:15360
v_add_f32 v3, v3, v181
v_cvt_pk_bf16_f32 v178, v180, v181
v_exp_f32 v184, v184
v_add_f32 v2, v2, v182
v_mfma_f32_32x32x16_bf16 v[112:127], a[172:175], v[28:31], v[112:127]
s_add_u32 s71, s71, 16384
v_exp_f32 v185, v185
v_add_f32 v3, v3, v183
v_cvt_pk_bf16_f32 v179, v182, v183
v_mfma_f32_32x32x16_bf16 v[112:127], a[176:179], v[32:35], v[112:127]
v_exp_f32 v186, v186
v_add_f32 v2, v2, v184
v_exp_f32 v187, v187
v_add_f32 v3, v3, v185
v_mfma_f32_32x32x16_bf16 v[112:127], a[180:183], v[36:39], v[112:127]
s_xor_b32 s73, s73, 0x8000
v_cvt_pk_bf16_f32 v184, v184, v185
v_exp_f32 v188, v188
v_add_f32 v2, v2, v186
v_mfma_f32_32x32x16_bf16 v[112:127], a[184:187], v[40:43], v[112:127]
v_exp_f32 v189, v189
v_add_f32 v3, v3, v187
v_cvt_pk_bf16_f32 v185, v186, v187
v_exp_f32 v190, v190
v_mfma_f32_32x32x16_bf16 v[112:127], a[188:191], v[44:47], v[112:127]
v_add_f32 v2, v2, v188
v_exp_f32 v191, v191
v_add_f32 v3, v3, v189
v_cvt_pk_bf16_f32 v186, v188, v189
v_add_f32 v2, v2, v190
v_add_f32 v3, v3, v191
v_cvt_pk_bf16_f32 v187, v190, v191
s_waitcnt vmcnt(16) lgkmcnt(0)
v_mfma_f32_32x32x16_bf16 a[0:15], a[192:195], v[144:147], a[0:15]
s_barrier
v_xor_b32 v10, 0x8000, v10
v_mfma_f32_32x32x16_bf16 a[16:31], a[196:199], v[144:147], a[16:31]
ds_read_b128 a[128:131], v10 offset:0
ds_read_b128 a[132:135], v10 offset:1024
v_max3_f32 v6, v80, v81, v82
v_max3_f32 v6, v6, v83, v84
v_max3_f32 v6, v6, v85, v86
v_max3_f32 v6, v6, v87, v88
v_mfma_f32_32x32x16_bf16 a[32:47], a[200:203], v[144:147], a[32:47]
ds_read_b128 a[136:139], v10 offset:2048
v_max3_f32 v6, v6, v89, v90
v_max3_f32 v6, v6, v91, v92
v_max3_f32 v6, v6, v93, v94
v_max3_f32 v6, v6, v95, v112
v_max3_f32 v6, v6, v113, v114
v_mfma_f32_32x32x16_bf16 a[48:63], a[204:207], v[144:147], a[48:63]
ds_read_b128 a[140:143], v10 offset:3072
ds_read_b128 a[144:147], v10 offset:4096
v_max3_f32 v6, v6, v115, v116
v_max3_f32 v6, v6, v117, v118
v_max3_f32 v6, v6, v119, v120
v_max3_f32 v6, v6, v121, v122
v_mfma_f32_32x32x16_bf16 a[0:15], a[208:211], v[152:155], a[0:15]
ds_read_b128 a[148:151], v10 offset:5120
v_max3_f32 v6, v6, v123, v124
v_max3_f32 v6, v6, v125, v126
v_max_f32 v6, v6, v127
v_cmp_lt_f32 vcc, s79, v6
v_mfma_f32_32x32x16_bf16 a[16:31], a[212:215], v[152:155], a[16:31]
s_cbranch_vccnz L_p3_s1_rare
s_add_u32 m0, s72, 16384
ds_read_b128 a[152:155], v10 offset:6144
ds_read_b128 a[156:159], v10 offset:7168
v_exp_f32 v80, v80
v_mfma_f32_32x32x16_bf16 a[32:47], a[216:219], v[152:155], a[32:47]
ds_read_b128 a[160:163], v10 offset:8192
buffer_load_dwordx4 v12, s[52:55], s71 offen offset:0 sc1 lds
v_exp_f32 v81, v81
v_exp_f32 v82, v82
v_mfma_f32_32x32x16_bf16 a[48:63], a[220:223], v[152:155], a[48:63]
ds_read_b128 a[164:167], v10 offset:9216
ds_read_b128 a[168:171], v10 offset:10240
buffer_load_dwordx4 v12, s[52:55], s71 offen offset:1024 sc1 lds
v_add_f32 v2, v2, v80
v_exp_f32 v83, v83
v_mfma_f32_32x32x16_bf16 a[0:15], a[224:227], v[176:179], a[0:15]
ds_read_b128 a[172:175], v10 offset:11264
v_add_f32 v3, v3, v81
v_cvt_pk_bf16_f32 v80, v80, v81
v_exp_f32 v84, v84
v_add_f32 v2, v2, v82
v_mfma_f32_32x32x16_bf16 a[16:31], a[228:231], v[176:179], a[16:31]
ds_read_b128 a[176:179], v10 offset:12288
ds_read_b128 a[180:183], v10 offset:13312
buffer_load_dwordx4 v12, s[52:55], s71 offen offset:2048 sc1 lds
v_exp_f32 v85, v85
v_add_f32 v3, v3, v83
v_mfma_f32_32x32x16_bf16 a[32:47], a[232:235], v[176:179], a[32:47]
ds_read_b128 a[184:187], v10 offset:14336
v_cvt_pk_bf16_f32 v81, v82, v83
v_exp_f32 v86, v86
v_add_f32 v2, v2, v84
v_mfma_f32_32x32x16_bf16 a[48:63], a[236:239], v[176:179], a[48:63]
ds_read_b128 a[188:191], v10 offset:15360
buffer_load_dwordx4 v12, s[52:55], s71 offen offset:3072 sc1 lds
v_exp_f32 v87, v87
v_add_f32 v3, v3, v85
v_cvt_pk_bf16_f32 v82, v84, v85
v_mfma_f32_32x32x16_bf16 a[0:15], a[240:243], v[184:187], a[0:15]
s_xor_b32 s72, s72, 0x8000
v_exp_f32 v88, v88
v_add_f32 v2, v2, v86
v_exp_f32 v89, v89
v_mfma_f32_32x32x16_bf16 a[16:31], a[244:247], v[184:187], a[16:31]
v_add_f32 v3, v3, v87
v_cvt_pk_bf16_f32 v83, v86, v87
v_exp_f32 v90, v90
v_add_f32 v2, v2, v88
v_mfma_f32_32x32x16_bf16 a[32:47], a[248:251], v[184:187], a[32:47]
buffer_store_dword v77, v76, s[8:11], s37 offen offset:1024 sc1
v_exp_f32 v91, v91
v_add_f32 v3, v3, v89
v_cvt_pk_bf16_f32 v88, v88, v89
v_mfma_f32_32x32x16_bf16 a[48:63], a[252:255], v[184:187], a[48:63]
v_add_f32 v2, v2, v90
v_add_f32 v3, v3, v91
v_cvt_pk_bf16_f32 v89, v90, v91
L_p3_s1_end:
s_branch L_p3_s0_top
L_p3_s1m_top:
s_waitcnt lgkmcnt(0)
v_xor_b32 v11, 0x8000, v11
v_mfma_f32_32x32x16_bf16 v[80:95], a[128:131], v[16:19], v[208:223]
s_add_u32 m0, s73, 16384
ds_read_b128 a[192:195], v11 offset:0
ds_read_b128 a[196:199], v11 offset:1024
v_exp_f32 v156, v156
v_mfma_f32_32x32x16_bf16 v[80:95], a[132:135], v[20:23], v[80:95]
ds_read_b128 a[200:203], v11 offset:2048
buffer_load_dwordx4 v12, s[56:59], s71 offen offset:0 sc1 lds
v_exp_f32 v157, v157
v_exp_f32 v158, v158
v_mfma_f32_32x32x16_bf16 v[80:95], a[136:139], v[24:27], v[80:95]
ds_read_b128 a[204:207], v11 offset:3072
ds_read_b128 a[208:211], v11 offset:4096
v_add_f32 v2, v2, v156
v_exp_f32 v159, v159
v_add_f32 v3, v3, v157
v_mfma_f32_32x32x16_bf16 v[80:95], a[140:143], v[28:31], v[80:95]
ds_read_b128 a[212:215], v11 offset:5120
buffer_load_dwordx4 v12, s[56:59], s71 offen offset:1024 sc1 lds
v_cvt_pk_bf16_f32 v154, v156, v157
v_exp_f32 v176, v176
v_add_f32 v2, v2, v158
v_mfma_f32_32x32x16_bf16 v[80:95], a[144:147], v[32:35], v[80:95]
ds_read_b128 a[216:219], v11 offset:6144
ds_read_b128 a[220:223], v11 offset:7168
v_exp_f32 v177, v177
v_add_f32 v3, v3, v159
v_cvt_pk_bf16_f32 v155, v158, v159
v_mfma_f32_32x32x16_bf16 v[80:95], a[148:151], v[36:39], v[80:95]
ds_read_b128 a[224:227], v11 offset:8192
v_exp_f32 v178, v178
v_add_f32 v2, v2, v176
v_exp_f32 v179, v179
v_mfma_f32_32x32x16_bf16 v[80:95], a[152:155], v[40:43], v[80:95]
ds_read_b128 a[228:231], v11 offset:9216
ds_read_b128 a[232:235], v11 offset:10240
buffer_load_dwordx4 v12, s[56:59], s71 offen offset:2048 sc1 lds
v_add_f32 v3, v3, v177
v_cvt_pk_bf16_f32 v176, v176, v177
v_mfma_f32_32x32x16_bf16 v[80:95], a[156:159], v[44:47], v[80:95]
ds_read_b128 a[236:239], v11 offset:11264
v_exp_f32 v180, v180
v_add_f32 v2, v2, v178
v_exp_f32 v181, v181
v_mfma_f32_32x32x16_bf16 v[112:127], a[160:163], v[16:19], v[208:223]
ds_read_b128 a[240:243], v11 offset:12288
ds_read_b128 a[244:247], v11 offset:13312
buffer_load_dwordx4 v12, s[56:59], s71 offen offset:3072 sc1 lds
v_add_f32 v3, v3, v179
v_cvt_pk_bf16_f32 v177, v178, v179
v_mfma_f32_32x32x16_bf16 v[112:127], a[164:167], v[20:23], v[112:127]
ds_read_b128 a[248:251], v11 offset:14336
v_exp_f32 v182, v182
v_add_f32 v2, v2, v180
v_exp_f32 v183, v183
v_mfma_f32_32x32x16_bf16 v[112:127], a[168:171], v[24:27], v[112:127]
ds_read_b128 a[252:255], v11 offset:15360
v_add_f32 v3, v3, v181
v_cvt_pk_bf16_f32 v178, v180, v181
v_exp_f32 v184, v184
v_add_f32 v2, v2, v182
v_mfma_f32_32x32x16_bf16 v[112:127], a[172:175], v[28:31], v[112:127]
s_add_u32 s71, s71, 16384
v_exp_f32 v185, v185
v_add_f32 v3, v3, v183
v_cvt_pk_bf16_f32 v179, v182, v183
v_add_u32 v246, 0, v13
v_mfma_f32_32x32x16_bf16 v[112:127], a[176:179], v[32:35], v[112:127]
v_exp_f32 v186, v186
v_add_f32 v2, v2, v184
v_exp_f32 v187, v187
v_add_f32 v3, v3, v185
v_mfma_f32_32x32x16_bf16 v[112:127], a[180:183], v[36:39], v[112:127]
s_xor_b32 s73, s73, 0x8000
v_cvt_pk_bf16_f32 v184, v184, v185
v_cmp_gt_i32_e64 s[84:85], 0, v246
v_cmp_gt_i32_e64 s[86:87], 1, v246
v_cmp_gt_i32_e64 s[88:89], 2, v246
v_cmp_gt_i32_e64 s[90:91], 3, v246
v_mfma_f32_32x32x16_bf16 v[112:127], a[184:187], v[40:43], v[112:127]
v_cndmask_b32_e64 v80, v80, v14, s[84:85]
v_cndmask_b32_e64 v81, v81, v14, s[86:87]
v_exp_f32 v188, v188
v_add_f32 v2, v2, v186
v_cndmask_b32_e64 v82, v82, v14, s[88:89]
v_mfma_f32_32x32x16_bf16 v[112:127], a[188:191], v[44:47], v[112:127]
v_exp_f32 v189, v189
v_cndmask_b32_e64 v83, v83, v14, s[90:91]
v_cmp_gt_i32_e64 s[92:93], 16, v246
v_cmp_gt_i32_e64 s[94:95], 17, v246
v_cmp_gt_i32_e64 s[96:97], 18, v246
v_cmp_gt_i32_e64 s[98:99], 19, v246
v_cndmask_b32_e64 v84, v84, v14, s[92:93]
v_add_f32 v3, v3, v187
v_cvt_pk_bf16_f32 v185, v186, v187
v_exp_f32 v190, v190
v_cndmask_b32_e64 v85, v85, v14, s[94:95]
v_cndmask_b32_e64 v86, v86, v14, s[96:97]
v_cndmask_b32_e64 v87, v87, v14, s[98:99]
v_cmp_gt_i32_e64 s[84:85], 8, v246
v_cmp_gt_i32_e64 s[86:87], 9, v246
v_cmp_gt_i32_e64 s[88:89], 10, v246
v_add_f32 v2, v2, v188
v_exp_f32 v191, v191
v_add_f32 v3, v3, v189
v_cmp_gt_i32_e64 s[90:91], 11, v246
v_cndmask_b32_e64 v88, v88, v14, s[84:85]
v_cndmask_b32_e64 v89, v89, v14, s[86:87]
v_cndmask_b32_e64 v90, v90, v14, s[88:89]
v_cndmask_b32_e64 v91, v91, v14, s[90:91]
v_cmp_gt_i32_e64 s[92:93], 24, v246
v_cmp_gt_i32_e64 s[94:95], 25, v246
v_cvt_pk_bf16_f32 v186, v188, v189
v_add_f32 v2, v2, v190
v_add_f32 v3, v3, v191
v_cvt_pk_bf16_f32 v187, v190, v191
v_cmp_gt_i32_e64 s[96:97], 26, v246
v_cmp_gt_i32_e64 s[98:99], 27, v246
v_cndmask_b32_e64 v92, v92, v14, s[92:93]
v_cndmask_b32_e64 v93, v93, v14, s[94:95]
v_cndmask_b32_e64 v94, v94, v14, s[96:97]
v_cndmask_b32_e64 v95, v95, v14, s[98:99]
s_waitcnt vmcnt(16) lgkmcnt(0)
v_mfma_f32_32x32x16_bf16 a[0:15], a[192:195], v[144:147], a[0:15]
s_barrier
v_xor_b32 v10, 0x8000, v10
v_mfma_f32_32x32x16_bf16 a[16:31], a[196:199], v[144:147], a[16:31]
ds_read_b128 a[128:131], v10 offset:0
ds_read_b128 a[132:135], v10 offset:1024
v_max3_f32 v6, v80, v81, v82
v_max3_f32 v6, v6, v83, v84
v_max3_f32 v6, v6, v85, v86
v_max3_f32 v6, v6, v87, v88
v_mfma_f32_32x32x16_bf16 a[32:47], a[200:203], v[144:147], a[32:47]
ds_read_b128 a[136:139], v10 offset:2048
ds_read_b128 a[140:143], v10 offset:3072
v_max3_f32 v6, v6, v89, v90
v_max3_f32 v6, v6, v91, v92
v_max3_f32 v6, v6, v93, v94
v_add_u32 v247, -32, v13
v_mfma_f32_32x32x16_bf16 a[48:63], a[204:207], v[144:147], a[48:63]
ds_read_b128 a[144:147], v10 offset:4096
v_cmp_gt_i32_e64 s[84:85], 0, v247
v_cmp_gt_i32_e64 s[86:87], 1, v247
v_cmp_gt_i32_e64 s[88:89], 2, v247
v_cmp_gt_i32_e64 s[90:91], 3, v247
v_cndmask_b32_e64 v112, v112, v14, s[84:85]
v_mfma_f32_32x32x16_bf16 a[0:15], a[208:211], v[152:155], a[0:15]
ds_read_b128 a[148:151], v10 offset:5120
ds_read_b128 a[152:155], v10 offset:6144
v_cndmask_b32_e64 v113, v113, v14, s[86:87]
v_cndmask_b32_e64 v114, v114, v14, s[88:89]
v_cndmask_b32_e64 v115, v115, v14, s[90:91]
v_cmp_gt_i32_e64 s[92:93], 16, v247
v_mfma_f32_32x32x16_bf16 a[16:31], a[212:215], v[152:155], a[16:31]
ds_read_b128 a[156:159], v10 offset:7168
v_cmp_gt_i32_e64 s[94:95], 17, v247
v_cmp_gt_i32_e64 s[96:97], 18, v247
v_cmp_gt_i32_e64 s[98:99], 19, v247
v_cndmask_b32_e64 v116, v116, v14, s[92:93]
v_cndmask_b32_e64 v117, v117, v14, s[94:95]
v_mfma_f32_32x32x16_bf16 a[32:47], a[216:219], v[152:155], a[32:47]
ds_read_b128 a[160:163], v10 offset:8192
ds_read_b128 a[164:167], v10 offset:9216
v_cndmask_b32_e64 v118, v118, v14, s[96:97]
v_cndmask_b32_e64 v119, v119, v14, s[98:99]
v_cmp_gt_i32_e64 s[84:85], 8, v247
v_cmp_gt_i32_e64 s[86:87], 9, v247
v_mfma_f32_32x32x16_bf16 a[48:63], a[220:223], v[152:155], a[48:63]
ds_read_b128 a[168:171], v10 offset:10240
ds_read_b128 a[172:175], v10 offset:11264
v_cmp_gt_i32_e64 s[88:89], 10, v247
v_cmp_gt_i32_e64 s[90:91], 11, v247
v_cndmask_b32_e64 v120, v120, v14, s[84:85]
v_cndmask_b32_e64 v121, v121, v14, s[86:87]
v_mfma_f32_32x32x16_bf16 a[0:15], a[224:227], v[176:179], a[0:15]
ds_read_b128 a[176:179], v10 offset:12288
v_cndmask_b32_e64 v122, v122, v14, s[88:89]
v_cndmask_b32_e64 v123, v123, v14, s[90:91]
v_cmp_gt_i32_e64 s[92:93], 24, v247
v_cmp_gt_i32_e64 s[94:95], 25, v247
v_cmp_gt_i32_e64 s[96:97], 26, v247
v_mfma_f32_32x32x16_bf16 a[16:31], a[228:231], v[176:179], a[16:31]
ds_read_b128 a[180:183], v10 offset:13312
ds_read_b128 a[184:187], v10 offset:14336
v_cmp_gt_i32_e64 s[98:99], 27, v247
v_cndmask_b32_e64 v124, v124, v14, s[92:93]
v_cndmask_b32_e64 v125, v125, v14, s[94:95]
v_cndmask_b32_e64 v126, v126, v14, s[96:97]
v_mfma_f32_32x32x16_bf16 a[32:47], a[232:235], v[176:179], a[32:47]
ds_read_b128 a[188:191], v10 offset:15360
v_cndmask_b32_e64 v127, v127, v14, s[98:99]
v_max3_f32 v6, v6, v95, v112
v_max3_f32 v6, v6, v113, v114
v_max3_f32 v6, v6, v115, v116
v_max3_f32 v6, v6, v117, v118
v_max3_f32 v6, v6, v119, v120
v_max3_f32 v6, v6, v121, v122
v_max3_f32 v6, v6, v123, v124
v_max3_f32 v6, v6, v125, v126
v_max_f32 v6, v6, v127
v_cmp_lt_f32 vcc, s79, v6
v_mfma_f32_32x32x16_bf16 a[48:63], a[236:239], v[176:179], a[48:63]
s_cbranch_vccnz L_p3_s1m_rare
s_add_u32 m0, s72, 16384
v_exp_f32 v80, v80
v_exp_f32 v81, v81
v_mfma_f32_32x32x16_bf16 a[0:15], a[240:243], v[184:187], a[0:15]
buffer_load_dwordx4 v12, s[52:55], s71 offen offset:0 sc1 lds
buffer_load_dwordx4 v12, s[52:55], s71 offen offset:1024 sc1 lds
v_exp_f32 v82, v82
v_add_f32 v2, v2, v80
v_mfma_f32_32x32x16_bf16 a[16:31], a[244:247], v[184:187], a[16:31]
buffer_load_dwordx4 v12, s[52:55], s71 offen offset:2048 sc1 lds
v_exp_f32 v83, v83
v_add_f32 v3, v3, v81
v_cvt_pk_bf16_f32 v80, v80, v81
v_mfma_f32_32x32x16_bf16 a[32:47], a[248:251], v[184:187], a[32:47]
buffer_load_dwordx4 v12, s[52:55], s71 offen offset:3072 sc1 lds
v_exp_f32 v84, v84
v_add_f32 v2, v2, v82
v_exp_f32 v85, v85
v_mfma_f32_32x32x16_bf16 a[48:63], a[252:255], v[184:187], a[48:63]
s_xor_b32 s72, s72, 0x8000
v_add_f32 v3, v3, v83
v_cvt_pk_bf16_f32 v81, v82, v83
v_exp_f32 v86, v86
v_add_f32 v2, v2, v84
v_exp_f32 v87, v87
v_add_f32 v3, v3, v85
v_cvt_pk_bf16_f32 v82, v84, v85
v_exp_f32 v88, v88
v_add_f32 v2, v2, v86
v_exp_f32 v89, v89
v_add_f32 v3, v3, v87
v_cvt_pk_bf16_f32 v83, v86, v87
v_exp_f32 v90, v90
v_add_f32 v2, v2, v88
v_exp_f32 v91, v91
v_add_f32 v3, v3, v89
v_cvt_pk_bf16_f32 v88, v88, v89
v_add_f32 v2, v2, v90
v_add_f32 v3, v3, v91
v_cvt_pk_bf16_f32 v89, v90, v91
L_p3_s1m_end:
L_p3_s0m_top:
s_waitcnt lgkmcnt(0)
v_mfma_f32_32x32x16_bf16 v[144:159], a[128:131], v[16:19], v[208:223]
s_add_u32 m0, s73, 0
ds_read_b128 a[192:195], v11 offset:16384
ds_read_b128 a[196:199], v11 offset:17408
v_exp_f32 v92, v92
v_mfma_f32_32x32x16_bf16 v[144:159], a[132:135], v[20:23], v[144:159]
ds_read_b128 a[200:203], v11 offset:18432
buffer_load_dwordx4 v12, s[56:59], s71 offen offset:0 sc1 lds
v_exp_f32 v93, v93
v_exp_f32 v94, v94
v_mfma_f32_32x32x16_bf16 v[144:159], a[136:139], v[24:27], v[144:159]
ds_read_b128 a[204:207], v11 offset:19456
ds_read_b128 a[208:211], v11 offset:20480
v_add_f32 v2, v2, v92
v_exp_f32 v95, v95
v_add_f32 v3, v3, v93
v_mfma_f32_32x32x16_bf16 v[144:159], a[140:143], v[28:31], v[144:159]
ds_read_b128 a[212:215], v11 offset:21504
v_cvt_pk_bf16_f32 v90, v92, v93
v_exp_f32 v112, v112
v_add_f32 v2, v2, v94
v_mfma_f32_32x32x16_bf16 v[144:159], a[144:147], v[32:35], v[144:159]
ds_read_b128 a[216:219], v11 offset:22528
ds_read_b128 a[220:223], v11 offset:23552
buffer_load_dwordx4 v12, s[56:59], s71 offen offset:1024 sc1 lds
v_exp_f32 v113, v113
v_add_f32 v3, v3, v95
v_mfma_f32_32x32x16_bf16 v[144:159], a[148:151], v[36:39], v[144:159]
ds_read_b128 a[224:227], v11 offset:24576
v_cvt_pk_bf16_f32 v91, v94, v95
v_exp_f32 v114, v114
v_add_f32 v2, v2, v112
v_mfma_f32_32x32x16_bf16 v[144:159], a[152:155], v[40:43], v[144:159]
ds_read_b128 a[228:231], v11 offset:25600
ds_read_b128 a[232:235], v11 offset:26624
v_exp_f32 v115, v115
v_add_f32 v3, v3, v113
v_cvt_pk_bf16_f32 v112, v112, v113
v_mfma_f32_32x32x16_bf16 v[144:159], a[156:159], v[44:47], v[144:159]
ds_read_b128 a[236:239], v11 offset:27648
buffer_load_dwordx4 v12, s[56:59], s71 offen offset:2048 sc1 lds
v_exp_f32 v116, v116
v_add_f32 v2, v2, v114
v_mfma_f32_32x32x16_bf16 v[176:191], a[160:163], v[16:19], v[208:223]
ds_read_b128 a[240:243], v11 offset:28672
ds_read_b128 a[244:247], v11 offset:29696
v_exp_f32 v117, v117
v_add_f32 v3, v3, v115
v_cvt_pk_bf16_f32 v113, v114, v115
v_mfma_f32_32x32x16_bf16 v[176:191], a[164:167], v[20:23], v[176:191]
ds_read_b128 a[248:251], v11 offset:30720
v_exp_f32 v118, v118
v_add_f32 v2, v2, v116
v_exp_f32 v119, v119
v_mfma_f32_32x32x16_bf16 v[176:191], a[168:171], v[24:27], v[176:191]
ds_read_b128 a[252:255], v11 offset:31744
buffer_load_dwordx4 v12, s[56:59], s71 offen offset:3072 sc1 lds
v_add_f32 v3, v3, v117
v_cvt_pk_bf16_f32 v114, v116, v117
v_exp_f32 v120, v120
v_mfma_f32_32x32x16_bf16 v[176:191], a[172:175], v[28:31], v[176:191]
v_add_f32 v2, v2, v118
v_exp_f32 v121, v121
v_add_f32 v3, v3, v119
v_cvt_pk_bf16_f32 v115, v118, v119
v_add_u32 v246, -64, v13
v_mfma_f32_32x32x16_bf16 v[176:191], a[176:179], v[32:35], v[176:191]
v_exp_f32 v122, v122
v_add_f32 v2, v2, v120
v_exp_f32 v123, v123
v_add_f32 v3, v3, v121
v_mfma_f32_32x32x16_bf16 v[176:191], a[180:183], v[36:39], v[176:191]
s_add_u32 s71, s71, 16384
v_cvt_pk_bf16_f32 v120, v120, v121
v_cmp_gt_i32_e64 s[84:85], 0, v246
v_cmp_gt_i32_e64 s[86:87], 1, v246
v_cmp_gt_i32_e64 s[88:89], 2, v246
v_cmp_gt_i32_e64 s[90:91], 3, v246
v_mfma_f32_32x32x16_bf16 v[176:191], a[184:187], v[40:43], v[176:191]
v_cndmask_b32_e64 v144, v144, v14, s[84:85]
v_cndmask_b32_e64 v145, v145, v14, s[86:87]
v_exp_f32 v124, v124
v_add_f32 v2, v2, v122
v_cndmask_b32_e64 v146, v146, v14, s[88:89]
v_mfma_f32_32x32x16_bf16 v[176:191], a[188:191], v[44:47], v[176:191]
v_exp_f32 v125, v125
v_cndmask_b32_e64 v147, v147, v14, s[90:91]
v_cmp_gt_i32_e64 s[92:93], 16, v246
v_cmp_gt_i32_e64 s[94:95], 17, v246
v_cmp_gt_i32_e64 s[96:97], 18, v246
v_cmp_gt_i32_e64 s[98:99], 19, v246
v_cndmask_b32_e64 v148, v148, v14, s[92:93]
v_add_f32 v3, v3, v123
v_cvt_pk_bf16_f32 v121, v122, v123
v_exp_f32 v126, v126
v_cndmask_b32_e64 v149, v149, v14, s[94:95]
v_cndmask_b32_e64 v150, v150, v14, s[96:97]
v_cndmask_b32_e64 v151, v151, v14, s[98:99]
v_cmp_gt_i32_e64 s[84:85], 8, v246
v_cmp_gt_i32_e64 s[86:87], 9, v246
v_cmp_gt_i32_e64 s[88:89], 10, v246
v_add_f32 v2, v2, v124
v_exp_f32 v127, v127
v_add_f32 v3, v3, v125
v_cmp_gt_i32_e64 s[90:91], 11, v246
v_cndmask_b32_e64 v152, v152, v14, s[84:85]
v_cndmask_b32_e64 v153, v153, v14, s[86:87]
v_cndmask_b32_e64 v154, v154, v14, s[88:89]
v_cndmask_b32_e64 v155, v155, v14, s[90:91]
v_cmp_gt_i32_e64 s[92:93], 24, v246
v_cmp_gt_i32_e64 s[94:95], 25, v246
v_cvt_pk_bf16_f32 v122, v124, v125
v_add_f32 v2, v2, v126
v_add_f32 v3, v3, v127
v_cvt_pk_bf16_f32 v123, v126, v127
v_cmp_gt_i32_e64 s[96:97], 26, v246
v_cmp_gt_i32_e64 s[98:99], 27, v246
v_cndmask_b32_e64 v156, v156, v14, s[92:93]
v_cndmask_b32_e64 v157, v157, v14, s[94:95]
v_cndmask_b32_e64 v158, v158, v14, s[96:97]
v_cndmask_b32_e64 v159, v159, v14, s[98:99]
s_waitcnt vmcnt(16) lgkmcnt(0)
v_mfma_f32_32x32x16_bf16 a[0:15], a[192:195], v[80:83], a[0:15]
s_barrier
v_mfma_f32_32x32x16_bf16 a[16:31], a[196:199], v[80:83], a[16:31]
ds_read_b128 a[128:131], v10 offset:16384
ds_read_b128 a[132:135], v10 offset:17408
v_max3_f32 v6, v144, v145, v146
v_max3_f32 v6, v6, v147, v148
v_max3_f32 v6, v6, v149, v150
v_max3_f32 v6, v6, v151, v152
v_mfma_f32_32x32x16_bf16 a[32:47], a[200:203], v[80:83], a[32:47]
ds_read_b128 a[136:139], v10 offset:18432
ds_read_b128 a[140:143], v10 offset:19456
v_max3_f32 v6, v6, v153, v154
v_max3_f32 v6, v6, v155, v156
v_max3_f32 v6, v6, v157, v158
v_add_u32 v247, -96, v13
v_mfma_f32_32x32x16_bf16 a[48:63], a[204:207], v[80:83], a[48:63]
ds_read_b128 a[144:147], v10 offset:20480
v_cmp_gt_i32_e64 s[84:85], 0, v247
v_cmp_gt_i32_e64 s[86:87], 1, v247
v_cmp_gt_i32_e64 s[88:89], 2, v247
v_cmp_gt_i32_e64 s[90:91], 3, v247
v_cndmask_b32_e64 v176, v176, v14, s[84:85]
v_mfma_f32_32x32x16_bf16 a[0:15], a[208:211], v[88:91], a[0:15]
ds_read_b128 a[148:151], v10 offset:21504
ds_read_b128 a[152:155], v10 offset:22528
v_cndmask_b32_e64 v177, v177, v14, s[86:87]
v_cndmask_b32_e64 v178, v178, v14, s[88:89]
v_cndmask_b32_e64 v179, v179, v14, s[90:91]
v_cmp_gt_i32_e64 s[92:93], 16, v247
v_mfma_f32_32x32x16_bf16 a[16:31], a[212:215], v[88:91], a[16:31]
ds_read_b128 a[156:159], v10 offset:23552
v_cmp_gt_i32_e64 s[94:95], 17, v247
v_cmp_gt_i32_e64 s[96:97], 18, v247
v_cmp_gt_i32_e64 s[98:99], 19, v247
v_cndmask_b32_e64 v180, v180, v14, s[92:93]
v_cndmask_b32_e64 v181, v181, v14, s[94:95]
v_mfma_f32_32x32x16_bf16 a[32:47], a[216:219], v[88:91], a[32:47]
ds_read_b128 a[160:163], v10 offset:24576
ds_read_b128 a[164:167], v10 offset:25600
v_cndmask_b32_e64 v182, v182, v14, s[96:97]
v_cndmask_b32_e64 v183, v183, v14, s[98:99]
v_cmp_gt_i32_e64 s[84:85], 8, v247
v_cmp_gt_i32_e64 s[86:87], 9, v247
v_mfma_f32_32x32x16_bf16 a[48:63], a[220:223], v[88:91], a[48:63]
ds_read_b128 a[168:171], v10 offset:26624
ds_read_b128 a[172:175], v10 offset:27648
v_cmp_gt_i32_e64 s[88:89], 10, v247
v_cmp_gt_i32_e64 s[90:91], 11, v247
v_cndmask_b32_e64 v184, v184, v14, s[84:85]
v_cndmask_b32_e64 v185, v185, v14, s[86:87]
v_mfma_f32_32x32x16_bf16 a[0:15], a[224:227], v[112:115], a[0:15]
ds_read_b128 a[176:179], v10 offset:28672
v_cndmask_b32_e64 v186, v186, v14, s[88:89]
v_cndmask_b32_e64 v187, v187, v14, s[90:91]
v_cmp_gt_i32_e64 s[92:93], 24, v247
v_cmp_gt_i32_e64 s[94:95], 25, v247
v_cmp_gt_i32_e64 s[96:97], 26, v247
v_mfma_f32_32x32x16_bf16 a[16:31], a[228:231], v[112:115], a[16:31]
ds_read_b128 a[180:183], v10 offset:29696
ds_read_b128 a[184:187], v10 offset:30720
v_cmp_gt_i32_e64 s[98:99], 27, v247
v_cndmask_b32_e64 v188, v188, v14, s[92:93]
v_cndmask_b32_e64 v189, v189, v14, s[94:95]
v_cndmask_b32_e64 v190, v190, v14, s[96:97]
v_mfma_f32_32x32x16_bf16 a[32:47], a[232:235], v[112:115], a[32:47]
ds_read_b128 a[188:191], v10 offset:31744
v_cndmask_b32_e64 v191, v191, v14, s[98:99]
v_max3_f32 v6, v6, v159, v176
v_max3_f32 v6, v6, v177, v178
v_max3_f32 v6, v6, v179, v180
v_max3_f32 v6, v6, v181, v182
v_max3_f32 v6, v6, v183, v184
v_max3_f32 v6, v6, v185, v186
v_max3_f32 v6, v6, v187, v188
v_max3_f32 v6, v6, v189, v190
v_max_f32 v6, v6, v191
v_cmp_lt_f32 vcc, s79, v6
v_mfma_f32_32x32x16_bf16 a[48:63], a[236:239], v[112:115], a[48:63]
s_cbranch_vccnz L_p3_s0m_rare
s_add_u32 m0, s72, 0
v_exp_f32 v144, v144
v_exp_f32 v145, v145
v_mfma_f32_32x32x16_bf16 a[0:15], a[240:243], v[120:123], a[0:15]
buffer_load_dwordx4 v12, s[52:55], s71 offen offset:0 sc1 lds
buffer_load_dwordx4 v12, s[52:55], s71 offen offset:1024 sc1 lds
buffer_load_dwordx4 v12, s[52:55], s71 offen offset:2048 sc1 lds
v_exp_f32 v146, v146
v_add_f32 v2, v2, v144
v_mfma_f32_32x32x16_bf16 a[16:31], a[244:247], v[120:123], a[16:31]
buffer_load_dwordx4 v12, s[52:55], s71 offen offset:3072 sc1 lds
v_lshlrev_b32 v245, 4, v1
s_mov_b32 m0, s43
v_exp_f32 v147, v147
v_add_f32 v3, v3, v145
v_mfma_f32_32x32x16_bf16 a[32:47], a[248:251], v[120:123], a[32:47]
s_nop 0
buffer_load_dwordx4 v245, s[20:23], 0 offen offset:0 sc1 lds
buffer_load_dwordx4 v245, s[20:23], 0 offen offset:1024 sc1 lds
v_cvt_pk_bf16_f32 v144, v144, v145
v_exp_f32 v148, v148
v_mfma_f32_32x32x16_bf16 a[48:63], a[252:255], v[120:123], a[48:63]
buffer_load_dwordx4 v245, s[20:23], 0 offen offset:2048 sc1 lds
buffer_load_dwordx4 v245, s[20:23], 0 offen offset:3072 sc1 lds
v_add_f32 v2, v2, v146
v_exp_f32 v149, v149
v_add_f32 v3, v3, v147
v_cvt_pk_bf16_f32 v145, v146, v147
v_exp_f32 v150, v150
v_add_f32 v2, v2, v148
v_exp_f32 v151, v151
v_add_f32 v3, v3, v149
v_cvt_pk_bf16_f32 v146, v148, v149
v_exp_f32 v152, v152
v_add_f32 v2, v2, v150
v_exp_f32 v153, v153
v_add_f32 v3, v3, v151
v_cvt_pk_bf16_f32 v147, v150, v151
v_exp_f32 v154, v154
v_add_f32 v2, v2, v152
v_exp_f32 v155, v155
v_add_f32 v3, v3, v153
v_cvt_pk_bf16_f32 v152, v152, v153
v_add_f32 v2, v2, v154
v_add_f32 v3, v3, v155
v_cvt_pk_bf16_f32 v153, v154, v155
L_p3_s0m_end:
s_load_dwordx2 s[88:89], s[0:1], 104
s_waitcnt lgkmcnt(0)
v_xor_b32 v11, 0x8000, v11
ds_read_b128 a[192:195], v11 offset:0
ds_read_b128 a[196:199], v11 offset:1024
ds_read_b128 a[200:203], v11 offset:2048
ds_read_b128 a[204:207], v11 offset:3072
ds_read_b128 a[208:211], v11 offset:4096
ds_read_b128 a[212:215], v11 offset:5120
ds_read_b128 a[216:219], v11 offset:6144
ds_read_b128 a[220:223], v11 offset:7168
ds_read_b128 a[224:227], v11 offset:8192
ds_read_b128 a[228:231], v11 offset:9216
ds_read_b128 a[232:235], v11 offset:10240
ds_read_b128 a[236:239], v11 offset:11264
ds_read_b128 a[240:243], v11 offset:12288
ds_read_b128 a[244:247], v11 offset:13312
ds_read_b128 a[248:251], v11 offset:14336
ds_read_b128 a[252:255], v11 offset:15360
v_exp_f32 v156, v156
v_exp_f32 v157, v157
v_exp_f32 v158, v158
v_add_f32 v2, v2, v156
v_exp_f32 v159, v159
v_add_f32 v3, v3, v157
v_cvt_pk_bf16_f32 v154, v156, v157
v_exp_f32 v176, v176
v_add_f32 v2, v2, v158
v_exp_f32 v177, v177
v_add_f32 v3, v3, v159
v_cvt_pk_bf16_f32 v155, v158, v159
v_exp_f32 v178, v178
v_add_f32 v2, v2, v176
v_exp_f32 v179, v179
v_add_f32 v3, v3, v177
v_cvt_pk_bf16_f32 v176, v176, v177
v_exp_f32 v180, v180
v_add_f32 v2, v2, v178
v_exp_f32 v181, v181
v_add_f32 v3, v3, v179
v_cvt_pk_bf16_f32 v177, v178, v179
v_exp_f32 v182, v182
v_add_f32 v2, v2, v180
v_exp_f32 v183, v183
v_add_f32 v3, v3, v181
v_cvt_pk_bf16_f32 v178, v180, v181
v_exp_f32 v184, v184
v_add_f32 v2, v2, v182
v_exp_f32 v185, v185
v_add_f32 v3, v3, v183
v_cvt_pk_bf16_f32 v179, v182, v183
v_exp_f32 v186, v186
v_add_f32 v2, v2, v184
v_exp_f32 v187, v187
v_add_f32 v3, v3, v185
v_cvt_pk_bf16_f32 v184, v184, v185
v_exp_f32 v188, v188
v_add_f32 v2, v2, v186
v_exp_f32 v189, v189
v_add_f32 v3, v3, v187
v_cvt_pk_bf16_f32 v185, v186, v187
v_exp_f32 v190, v190
v_add_f32 v2, v2, v188
v_exp_f32 v191, v191
v_add_f32 v3, v3, v189
v_cvt_pk_bf16_f32 v186, v188, v189
v_add_f32 v2, v2, v190
v_add_f32 v3, v3, v191
v_cvt_pk_bf16_f32 v187, v190, v191
s_waitcnt vmcnt(0) lgkmcnt(0)
s_barrier
buffer_store_dword v77, v76, s[8:11], s37 offen offset:1024 sc1
v_mfma_f32_32x32x16_bf16 a[0:15], a[192:195], v[144:147], a[0:15]
s_mul_i32 s36, s3, 16640
v_and_b32 v16, 15, v1
v_lshrrev_b32 v17, 4, v1
v_add_u32 v18, 13, v16
v_and_b32 v19, 3, v18
v_cmp_eq_u32 vcc, 0, v19
v_mfma_f32_32x32x16_bf16 a[16:31], a[196:199], v[144:147], a[16:31]
v_lshrrev_b32 v18, 2, v18
v_mul_u32_u24 v19, 4160, v19
v_cndmask_b32 v19, v19, 8, vcc
v_lshl_add_u32 v19, v18, 3, v19
v_lshl_add_u32 v19, v17, 4, v19
v_add_u32 v4, s36, v19
v_mfma_f32_32x32x16_bf16 a[32:47], a[200:203], v[144:147], a[32:47]
v_add_u32 v6, s36, v72
v_lshlrev_b32 v18, 5, v16
v_lshlrev_b32 v19, 4, v17
v_sub_u32 v19, v19, v18
s_add_u32 s37, s43, 480
v_add_u32 v5, s37, v19
v_mfma_f32_32x32x16_bf16 a[48:63], a[204:207], v[144:147], a[48:63]
v_mul_u32_u24 v18, 136, v16
v_lshl_add_u32 v18, v17, 5, v18
s_lshl_b32 s37, s3, 1
s_add_u32 s37, s37, 49152
v_add_u32 v7, s37, v18
v_lshrrev_b32 v18, 3, v1
v_mfma_f32_32x32x16_bf16 a[0:15], a[208:211], v[152:155], a[0:15]
v_mul_u32_u24 v18, 136, v18
v_and_b32 v19, 7, v1
v_lshl_add_u32 v18, v19, 4, v18
s_mul_i32 s37, s3, 4352
s_add_u32 s37, s37, 49152
v_add_u32 v8, s37, v18
v_mfma_f32_32x32x16_bf16 a[16:31], a[212:215], v[152:155], a[16:31]
s_lshl_b32 s37, s3, 12
v_add_u32 v9, s37, v72
v_lshl_add_u32 v18, v17, 3, v16
v_sub_u32 v75, 15, v18
v_mov_b32 v20, 0
v_mov_b32 v21, 0
v_mfma_f32_32x32x16_bf16 a[32:47], a[216:219], v[152:155], a[32:47]
v_mov_b32 v22, 0
v_mov_b32 v23, 0
v_and_b32 v16, 3, v1
v_mul_u32_u24 v16, 4160, v16
v_lshrrev_b32 v17, 2, v1
v_min_u32 v17, 3, v17
v_mfma_f32_32x32x16_bf16 a[48:63], a[220:223], v[152:155], a[48:63]
v_lshl_add_u32 v16, v17, 4, v16
v_add_u32 v16, s36, v16
ds_write_b128 v16, v[20:23]
v_and_b32 v17, 31, v1
v_lshlrev_b32 v17, 4, v17
v_add_u32 v17, s43, v17
v_mfma_f32_32x32x16_bf16 a[0:15], a[224:227], v[176:179], a[0:15]
ds_write_b128 v17, v[20:23] offset:4096
v_alignbit_b32 v24, v49, v48, 16
v_alignbit_b32 v25, v50, v49, 16
v_alignbit_b32 v26, v51, v50, 16
v_alignbit_b32 v27, v52, v51, 16
v_alignbit_b32 v28, v53, v52, 16
v_mfma_f32_32x32x16_bf16 a[16:31], a[228:231], v[176:179], a[16:31]
ds_write_b128 v6, v[50:53] offset:64
ds_write_b128 v6, v[24:27] offset:4208
v_mov_b32 v16, v49
v_mov_b32 v17, v50
v_mov_b32 v18, v51
v_mov_b32 v19, v52
v_mfma_f32_32x32x16_bf16 a[32:47], a[232:235], v[176:179], a[32:47]
ds_write_b128 v6, v[16:19] offset:8368
v_mov_b32 v16, v25
v_mov_b32 v17, v26
v_mov_b32 v18, v27
v_mov_b32 v19, v28
ds_write_b128 v6, v[16:19] offset:12528
v_mfma_f32_32x32x16_bf16 a[48:63], a[236:239], v[176:179], a[48:63]
v_alignbit_b32 v30, v55, v54, 16
v_alignbit_b32 v31, v56, v55, 16
v_alignbit_b32 v32, v57, v56, 16
v_alignbit_b32 v33, v58, v57, 16
v_alignbit_b32 v34, v59, v58, 16
ds_write_b128 v6, v[56:59] offset:1088
v_mfma_f32_32x32x16_bf16 a[0:15], a[240:243], v[184:187], a[0:15]
ds_write_b128 v6, v[30:33] offset:5232
v_mov_b32 v16, v55
v_mov_b32 v17, v56
v_mov_b32 v18, v57
v_mov_b32 v19, v58
ds_write_b128 v6, v[16:19] offset:9392
v_mfma_f32_32x32x16_bf16 a[16:31], a[244:247], v[184:187], a[16:31]
v_mov_b32 v16, v31
v_mov_b32 v17, v32
v_mov_b32 v18, v33
v_mov_b32 v19, v34
ds_write_b128 v6, v[16:19] offset:13552
v_alignbit_b32 v24, v61, v60, 16
v_mfma_f32_32x32x16_bf16 a[32:47], a[248:251], v[184:187], a[32:47]
v_alignbit_b32 v25, v62, v61, 16
v_alignbit_b32 v26, v63, v62, 16
v_alignbit_b32 v27, v64, v63, 16
v_alignbit_b32 v28, v65, v64, 16
ds_write_b128 v6, v[62:65] offset:2112
ds_write_b128 v6, v[24:27] offset:6256
v_mfma_f32_32x32x16_bf16 a[48:63], a[252:255], v[184:187], a[48:63]
v_mov_b32 v16, v61
v_mov_b32 v17, v62
v_mov_b32 v18, v63
v_mov_b32 v19, v64
ds_write_b128 v6, v[16:19] offset:10416
v_mov_b32 v16, v25
v_mov_b32 v17, v26
v_mov_b32 v18, v27
v_mov_b32 v19, v28
ds_write_b128 v6, v[16:19] offset:14576
v_alignbit_b32 v30, v67, v66, 16
v_alignbit_b32 v31, v68, v67, 16
v_alignbit_b32 v32, v69, v68, 16
v_alignbit_b32 v33, v70, v69, 16
v_alignbit_b32 v34, v71, v70, 16
ds_write_b128 v6, v[68:71] offset:3136
ds_write_b128 v6, v[30:33] offset:7280
v_mov_b32 v16, v67
v_mov_b32 v17, v68
v_mov_b32 v18, v69
v_mov_b32 v19, v70
ds_write_b128 v6, v[16:19] offset:11440
v_mov_b32 v16, v31
v_mov_b32 v17, v32
v_mov_b32 v18, v33
v_mov_b32 v19, v34
ds_write_b128 v6, v[16:19] offset:15600
v_lshlrev_b32 v16, 16, v74
v_cmp_eq_u32 vcc, 0, v75
s_nop 1
v_cndmask_b32 v44, 0, v74, vcc
v_cmp_eq_u32 vcc, 1, v75
s_nop 1
v_cndmask_b32 v44, v44, v16, vcc
v_cmp_eq_u32 vcc, 2, v75
s_nop 1
v_cndmask_b32 v45, 0, v74, vcc
v_cmp_eq_u32 vcc, 3, v75
s_nop 1
v_cndmask_b32 v45, v45, v16, vcc
v_cmp_eq_u32 vcc, 4, v75
s_nop 1
v_cndmask_b32 v46, 0, v74, vcc
v_cmp_eq_u32 vcc, 5, v75
s_nop 1
v_cndmask_b32 v46, v46, v16, vcc
v_cmp_eq_u32 vcc, 6, v75
s_nop 1
v_cndmask_b32 v47, 0, v74, vcc
v_cmp_eq_u32 vcc, 7, v75
s_nop 1
v_cndmask_b32 v47, v47, v16, vcc
v_add_f32 v2, v2, v3
v_mov_b32 v3, v2
s_nop 1
v_permlane32_swap_b32 v2, v3
v_add_f32 v2, v2, v3
v_rcp_f32 v2, v2
s_nop 7
v_accvgpr_read_b32 v240, a0
v_accvgpr_read_b32 v241, a1
v_accvgpr_read_b32 v242, a2
v_accvgpr_read_b32 v243, a3
v_accvgpr_read_b32 v244, a4
v_accvgpr_read_b32 v245, a5
v_accvgpr_read_b32 v246, a6
v_accvgpr_read_b32 v247, a7
v_mul_f32 v240, v240, v2
v_mul_f32 v241, v241, v2
v_mul_f32 v242, v242, v2
v_mul_f32 v243, v243, v2
v_mul_f32 v244, v244, v2
v_mul_f32 v245, v245, v2
v_mul_f32 v246, v246, v2
v_mul_f32 v247, v247, v2
v_cvt_pk_bf16_f32 v248, v240, v241
v_cvt_pk_bf16_f32 v249, v242, v243
v_cvt_pk_bf16_f32 v250, v244, v245
v_cvt_pk_bf16_f32 v251, v246, v247
buffer_store_dwordx4 v[248:251], v15, s[60:63], s100 offen offset:0 sc1
v_accvgpr_read_b32 v240, a8
v_accvgpr_read_b32 v241, a9
v_accvgpr_read_b32 v242, a10
v_accvgpr_read_b32 v243, a11
v_accvgpr_read_b32 v244, a12
v_accvgpr_read_b32 v245, a13
v_accvgpr_read_b32 v246, a14
v_accvgpr_read_b32 v247, a15
v_mul_f32 v240, v240, v2
v_mul_f32 v241, v241, v2
v_mul_f32 v242, v242, v2
v_mul_f32 v243, v243, v2
v_mul_f32 v244, v244, v2
v_mul_f32 v245, v245, v2
v_mul_f32 v246, v246, v2
v_mul_f32 v247, v247, v2
v_cvt_pk_bf16_f32 v252, v240, v241
v_cvt_pk_bf16_f32 v253, v242, v243
v_cvt_pk_bf16_f32 v254, v244, v245
v_cvt_pk_bf16_f32 v255, v246, v247
buffer_store_dwordx4 v[252:255], v15, s[60:63], s100 offen offset:512 sc1
v_accvgpr_read_b32 v240, a16
v_accvgpr_read_b32 v241, a17
v_accvgpr_read_b32 v242, a18
v_accvgpr_read_b32 v243, a19
v_accvgpr_read_b32 v244, a20
v_accvgpr_read_b32 v245, a21
v_accvgpr_read_b32 v246, a22
v_accvgpr_read_b32 v247, a23
v_mul_f32 v240, v240, v2
v_mul_f32 v241, v241, v2
v_mul_f32 v242, v242, v2
v_mul_f32 v243, v243, v2
v_mul_f32 v244, v244, v2
v_mul_f32 v245, v245, v2
v_mul_f32 v246, v246, v2
v_mul_f32 v247, v247, v2
v_cvt_pk_bf16_f32 v248, v240, v241
v_cvt_pk_bf16_f32 v249, v242, v243
v_cvt_pk_bf16_f32 v250, v244, v245
v_cvt_pk_bf16_f32 v251, v246, v247
buffer_store_dwordx4 v[248:251], v15, s[60:63], s100 offen offset:1024 sc1
v_accvgpr_read_b32 v240, a24
v_accvgpr_read_b32 v241, a25
v_accvgpr_read_b32 v242, a26
v_accvgpr_read_b32 v243, a27
v_accvgpr_read_b32 v244, a28
v_accvgpr_read_b32 v245, a29
v_accvgpr_read_b32 v246, a30
v_accvgpr_read_b32 v247, a31
v_mul_f32 v240, v240, v2
v_mul_f32 v241, v241, v2
v_mul_f32 v242, v242, v2
v_mul_f32 v243, v243, v2
v_mul_f32 v244, v244, v2
v_mul_f32 v245, v245, v2
v_mul_f32 v246, v246, v2
v_mul_f32 v247, v247, v2
v_cvt_pk_bf16_f32 v252, v240, v241
v_cvt_pk_bf16_f32 v253, v242, v243
v_cvt_pk_bf16_f32 v254, v244, v245
v_cvt_pk_bf16_f32 v255, v246, v247
buffer_store_dwordx4 v[252:255], v15, s[60:63], s100 offen offset:1536 sc1
v_accvgpr_read_b32 v240, a32
v_accvgpr_read_b32 v241, a33
v_accvgpr_read_b32 v242, a34
v_accvgpr_read_b32 v243, a35
v_accvgpr_read_b32 v244, a36
v_accvgpr_read_b32 v245, a37
v_accvgpr_read_b32 v246, a38
v_accvgpr_read_b32 v247, a39
v_mul_f32 v240, v240, v2
v_mul_f32 v241, v241, v2
v_mul_f32 v242, v242, v2
v_mul_f32 v243, v243, v2
v_mul_f32 v244, v244, v2
v_mul_f32 v245, v245, v2
v_mul_f32 v246, v246, v2
v_mul_f32 v247, v247, v2
v_cvt_pk_bf16_f32 v248, v240, v241
v_cvt_pk_bf16_f32 v249, v242, v243
v_cvt_pk_bf16_f32 v250, v244, v245
v_cvt_pk_bf16_f32 v251, v246, v247
buffer_store_dwordx4 v[248:251], v15, s[60:63], s100 offen offset:2048 sc1
v_accvgpr_read_b32 v240, a40
v_accvgpr_read_b32 v241, a41
v_accvgpr_read_b32 v242, a42
v_accvgpr_read_b32 v243, a43
v_accvgpr_read_b32 v244, a44
v_accvgpr_read_b32 v245, a45
v_accvgpr_read_b32 v246, a46
v_accvgpr_read_b32 v247, a47
v_mul_f32 v240, v240, v2
v_mul_f32 v241, v241, v2
v_mul_f32 v242, v242, v2
v_mul_f32 v243, v243, v2
v_mul_f32 v244, v244, v2
v_mul_f32 v245, v245, v2
v_mul_f32 v246, v246, v2
v_mul_f32 v247, v247, v2
v_cvt_pk_bf16_f32 v252, v240, v241
v_cvt_pk_bf16_f32 v253, v242, v243
v_cvt_pk_bf16_f32 v254, v244, v245
v_cvt_pk_bf16_f32 v255, v246, v247
buffer_store_dwordx4 v[252:255], v15, s[60:63], s100 offen offset:2560 sc1
v_accvgpr_read_b32 v240, a48
v_accvgpr_read_b32 v241, a49
v_accvgpr_read_b32 v242, a50
v_accvgpr_read_b32 v243, a51
v_accvgpr_read_b32 v244, a52
v_accvgpr_read_b32 v245, a53
v_accvgpr_read_b32 v246, a54
v_accvgpr_read_b32 v247, a55
v_mul_f32 v240, v240, v2
v_mul_f32 v241, v241, v2
v_mul_f32 v242, v242, v2
v_mul_f32 v243, v243, v2
v_mul_f32 v244, v244, v2
v_mul_f32 v245, v245, v2
v_mul_f32 v246, v246, v2
v_mul_f32 v247, v247, v2
v_cvt_pk_bf16_f32 v248, v240, v241
v_cvt_pk_bf16_f32 v249, v242, v243
v_cvt_pk_bf16_f32 v250, v244, v245
v_cvt_pk_bf16_f32 v251, v246, v247
buffer_store_dwordx4 v[248:251], v15, s[60:63], s100 offen offset:3072 sc1
v_accvgpr_read_b32 v240, a56
v_accvgpr_read_b32 v241, a57
v_accvgpr_read_b32 v242, a58
v_accvgpr_read_b32 v243, a59
v_accvgpr_read_b32 v244, a60
v_accvgpr_read_b32 v245, a61
v_accvgpr_read_b32 v246, a62
v_accvgpr_read_b32 v247, a63
v_mul_f32 v240, v240, v2
v_mul_f32 v241, v241, v2
v_mul_f32 v242, v242, v2
v_mul_f32 v243, v243, v2
v_mul_f32 v244, v244, v2
v_mul_f32 v245, v245, v2
v_mul_f32 v246, v246, v2
v_mul_f32 v247, v247, v2
v_cvt_pk_bf16_f32 v252, v240, v241
v_cvt_pk_bf16_f32 v253, v242, v243
v_cvt_pk_bf16_f32 v254, v244, v245
v_cvt_pk_bf16_f32 v255, v246, v247
buffer_store_dwordx4 v[252:255], v15, s[60:63], s100 offen offset:3584 sc1
s_waitcnt lgkmcnt(0)
ds_read_b128 a[160:163], v5 offset:3584
ds_read_b64 a[128:129], v4 offset:0
ds_read_b64 a[130:131], v4 offset:8
ds_read_b128 a[164:167], v5 offset:3072
ds_read_b64 a[132:133], v4 offset:512
ds_read_b64 a[134:135], v4 offset:520
ds_read_b128 a[168:171], v5 offset:2560
ds_read_b64 a[136:137], v4 offset:1024
ds_read_b64 a[138:139], v4 offset:1032
ds_read_b128 a[172:175], v5 offset:2048
ds_read_b64 a[140:141], v4 offset:1536
ds_read_b64 a[142:143], v4 offset:1544
ds_read_b128 a[176:179], v5 offset:1536
ds_read_b64 a[144:145], v4 offset:2048
ds_read_b64 a[146:147], v4 offset:2056
ds_read_b128 a[180:183], v5 offset:1024
ds_read_b64 a[148:149], v4 offset:2560
ds_read_b64 a[150:151], v4 offset:2568
ds_read_b128 a[184:187], v5 offset:512
ds_read_b64 a[152:153], v4 offset:3072
ds_read_b64 a[154:155], v4 offset:3080
ds_read_b128 a[188:191], v5 offset:0
ds_read_b64 a[156:157], v4 offset:3584
ds_read_b64 a[158:159], v4 offset:3592
v_lshlrev_b32 v255, 20, v1
s_lshl_b32 s36, s3, 26
v_add_u32 v255, s36, v255
s_waitcnt lgkmcnt(15)
v_mfma_f32_16x16x32_bf16 v[76:79], a[128:131], a[160:163], 0
ds_read_b128 a[224:227], v5 offset:3648
s_and_b32 s81, s2, 3
v_mfma_f32_16x16x32_bf16 v[80:83], a[128:131], a[164:167], 0
ds_read_b64 a[192:193], v4 offset:64
s_lshl_b32 s81, s81, 1
v_mfma_f32_16x16x32_bf16 v[84:87], a[128:131], a[168:171], 0
ds_read_b64 a[194:195], v4 offset:72
s_sub_u32 s74, 14, s81
s_waitcnt lgkmcnt(15)
v_mfma_f32_16x16x32_bf16 v[88:91], a[128:131], a[172:175], 0
ds_read_b128 a[228:231], v5 offset:3136
s_waitcnt lgkmcnt(15)
v_mfma_f32_16x16x32_bf16 v[92:95], a[128:131], a[176:179], 0
s_bitcmp1_b32 s2, 4
s_cselect_b32 s81, s74, s81
s_waitcnt lgkmcnt(12)
v_mfma_f32_16x16x32_bf16 v[96:99], a[128:131], a[180:183], 0
ds_read_b64 a[196:197], v4 offset:576
s_waitcnt lgkmcnt(10)
v_mfma_f32_16x16x32_bf16 v[100:103], a[128:131], a[184:187], 0
ds_read_b64 a[198:199], v4 offset:584
s_waitcnt lgkmcnt(8)
v_mfma_f32_16x16x32_bf16 v[104:107], a[128:131], a[188:191], 0
ds_read_b128 a[232:235], v5 offset:2624
s_bfe_u32 s74, s2, 0x10003
MV 76,v,44,a,160
ds_read_b64 a[200:201], v4 offset:1088
s_add_u32 s81, s81, s74
MV 80,v,44,a,164
MV 84,v,44,a,168
ds_read_b64 a[202:203], v4 offset:1096
s_bfe_u32 s82, s2, 0x10002
MV 88,v,44,a,172
ds_read_b128 a[236:239], v5 offset:2112
s_lshr_b32 s74, s2, 5
MV 92,v,44,a,176
ds_read_b64 a[204:205], v4 offset:1600
s_lshl_b32 s74, s74, 1
MV 96,v,44,a,180
ds_read_b64 a[206:207], v4 offset:1608
MV 100,v,44,a,184
s_add_u32 s82, s82, s74
MV 104,v,44,a,188
ds_read_b128 a[240:243], v5 offset:1600
s_mov_b32 s72, s81
MV 80,a,132,a,160
ds_read_b64 a[208:209], v4 offset:2112
MV 84,a,132,a,164
ds_read_b64 a[210:211], v4 offset:2120
s_mov_b32 s73, s82
MV 88,a,132,a,168
ds_read_b128 a[244:247], v5 offset:1088
s_lshl_b32 s74, s72, 2
MV 92,a,132,a,172
MV 96,a,132,a,176
ds_read_b64 a[212:213], v4 offset:2624
s_add_u32 s74, s74, s3
MV 100,a,132,a,180
ds_read_b64 a[214:215], v4 offset:2632
s_lshl_b32 s68, s74, 18
MV 104,a,132,a,184
ds_read_b128 a[248:251], v5 offset:576
s_and_b32 s80, s73, 1
MV 84,a,136,a,160
ds_read_b64 a[216:217], v4 offset:3136
MV 88,a,136,a,164
s_lshl_b32 s75, s80, 16
MV 92,a,136,a,168
ds_read_b64 a[218:219], v4 offset:3144
s_add_u32 s68, s68, s75
MV 96,a,136,a,172
ds_read_b128 a[252:255], v5 offset:64
MV 100,a,136,a,176
ds_read_b64 a[220:221], v4 offset:3648
s_lshl_b32 s69, s73, 19
MV 104,a,136,a,180
ds_read_b64 a[222:223], v4 offset:3656
s_lshl_b32 s75, s73, 7
MV 88,a,140,a,160
MV 92,a,140,a,164
s_lshl_b32 s70, s3, 12
MV 96,a,140,a,168
s_lshl_b32 s78, s74, 16
MV 100,a,140,a,172
s_add_u32 s78, s78, s75
MV 104,a,140,a,176
MV 92,a,144,a,160
s_lshl_b32 s79, s73, 18
MV 96,a,144,a,164
s_lshl_b32 s75, s74, 8
MV 100,a,144,a,168
MV 104,a,144,a,172
s_add_u32 s79, s79, s75
MV 96,a,148,a,160
v_lshlrev_b32 v236, 4, v1
MV 100,a,148,a,164
MV 104,a,148,a,168
v_add_u32 v237, 0x20000, v236
MV 100,a,152,a,160
v_add_u32 v238, s70, v236
MV 104,a,152,a,164
s_waitcnt lgkmcnt(15)
MV 104,a,156,a,160
s_waitcnt vmcnt(0)
s_barrier
v_mov_b32 v253, 1
s_lshl_b32 s36, s2, 2
buffer_store_dword v253, v255, s[8:11], s36 offen offset:2048 sc1
MV 76,a,192,a,224
ds_read_b128 a[160:163], v5 offset:3712
s_lshl_b32 s75, s80, 12
MV 80,a,192,a,228
ds_read_b64 a[128:129], v4 offset:128
v_add_u32 v244, s75, v236
MV 84,a,192,a,232
ds_read_b64 a[130:131], v4 offset:136
v_xor_b32 v245, 0x1000, v244
s_waitcnt lgkmcnt(15)
MV 88,a,192,a,236
ds_read_b128 a[164:167], v5 offset:3200
v_add_u32 v242, 66560, v244
s_waitcnt lgkmcnt(15)
MV 92,a,192,a,240
v_add_u32 v243, 66560, v245
s_waitcnt lgkmcnt(12)
MV 96,a,192,a,244
ds_read_b64 a[132:133], v4 offset:640
v_bfe_u32 v38, v1, 4, 1
s_waitcnt lgkmcnt(10)
MV 100,a,192,a,248
ds_read_b64 a[134:135], v4 offset:648
v_lshrrev_b32 v40, 5, v1
s_waitcnt lgkmcnt(8)
MV 104,a,192,a,252
ds_read_b128 a[168:171], v5 offset:2688
v_and_b32 v36, 15, v1
MV 80,a,196,a,224
ds_read_b64 a[136:137], v4 offset:1152
v_lshlrev_b32 v41, 5, v38
MV 84,a,196,a,228
v_lshl_add_u32 v41, v40, 4, v41
MV 88,a,196,a,232
ds_read_b64 a[138:139], v4 offset:1160
v_lshl_add_u32 v250, v36, 11, v41
MV 92,a,196,a,236
ds_read_b128 a[172:175], v5 offset:2176
v_lshlrev_b32 v41, 11, v41
MV 96,a,196,a,240
ds_read_b64 a[140:141], v4 offset:1664
v_lshl_add_u32 v251, v36, 3, v41
MV 100,a,196,a,244
ds_read_b64 a[142:143], v4 offset:1672
MV 104,a,196,a,248
s_add_u32 s44, s40, 33554432
s_addc_u32 s45, s41, 0
MV 84,a,200,a,224
ds_read_b128 a[176:179], v5 offset:1664
s_mov_b32 s46, 16777216
MV 88,a,200,a,228
ds_read_b64 a[144:145], v4 offset:2176
s_mov_b32 s47, 0x20000
MV 92,a,200,a,232
ds_read_b64 a[146:147], v4 offset:2184
MV 96,a,200,a,236
ds_read_b128 a[180:183], v5 offset:1152
MV 100,a,200,a,240
s_add_u32 s48, s40, 100663296
s_addc_u32 s49, s41, 0
MV 104,a,200,a,244
ds_read_b64 a[148:149], v4 offset:2688
s_mov_b32 s50, 8388608
MV 88,a,204,a,224
ds_read_b64 a[150:151], v4 offset:2696
s_mov_b32 s51, 0x20000
MV 92,a,204,a,228
ds_read_b128 a[184:187], v5 offset:640
MV 96,a,204,a,232
ds_read_b64 a[152:153], v4 offset:3200
MV 100,a,204,a,236
s_add_u32 s52, s40, 109051904
s_addc_u32 s53, s41, 0
MV 104,a,204,a,240
ds_read_b64 a[154:155], v4 offset:3208
s_mov_b32 s54, 4194304
MV 92,a,208,a,224
ds_read_b128 a[188:191], v5 offset:128
s_mov_b32 s55, 0x20000
MV 96,a,208,a,228
ds_read_b64 a[156:157], v4 offset:3712
MV 100,a,208,a,232
ds_read_b64 a[158:159], v4 offset:3720
MV 104,a,208,a,236
s_add_u32 s56, s40, 54525952
s_addc_u32 s57, s41, 0
MV 96,a,212,a,224
s_mov_b32 s58, 4194304
s_mov_b32 s59, 0x20000
MV 100,a,212,a,228
s_mov_b32 s60, s88
s_mov_b32 s61, s89
MV 104,a,212,a,232
s_mov_b32 s62, 4194304
MV 100,a,216,a,224
s_mov_b32 s63, 0x20000
MV 104,a,216,a,228
s_waitcnt lgkmcnt(15)
MV 104,a,220,a,224
MV 76,a,128,a,160
ds_read_b128 a[224:227], v5 offset:3776
s_sub_u32 s36, 15, s81
MV 80,a,128,a,164
ds_read_b64 a[192:193], v4 offset:192
s_min_u32 s36, s36, s81
MV 84,a,128,a,168
ds_read_b64 a[194:195], v4 offset:200
s_lshl_b32 s36, s36, 5
s_waitcnt lgkmcnt(15)
MV 88,a,128,a,172
ds_read_b128 a[228:231], v5 offset:3264
s_waitcnt lgkmcnt(15)
MV 92,a,128,a,176
s_lshl_b32 s37, s80, 2
s_waitcnt lgkmcnt(12)
MV 96,a,128,a,180
ds_read_b64 a[196:197], v4 offset:704
s_add_u32 s36, s36, s37
s_waitcnt lgkmcnt(10)
MV 100,a,128,a,184
ds_read_b64 a[198:199], v4 offset:712
s_add_u32 s36, s36, 256
s_waitcnt lgkmcnt(8)
MV 104,a,128,a,188
ds_read_b128 a[232:235], v5 offset:2752
MV 80,a,132,a,160
ds_read_b64 a[200:201], v4 offset:1216
v_and_b32 v254, 3, v1
MV 84,a,132,a,164
v_lshlrev_b32 v254, 3, v254
MV 88,a,132,a,168
ds_read_b64 a[202:203], v4 offset:1224
v_bfe_u32 v253, v1, 2, 2
MV 92,a,132,a,172
ds_read_b128 a[236:239], v5 offset:2240
MV 96,a,132,a,176
ds_read_b64 a[204:205], v4 offset:1728
v_add3_u32 v254, v254, v253, s36
MV 100,a,132,a,180
ds_read_b64 a[206:207], v4 offset:1736
s_lshr_b32 s36, s82, 1
MV 104,a,132,a,184
s_lshl_b32 s37, s80, 7
MV 84,a,136,a,160
ds_read_b128 a[240:243], v5 offset:1728
MV 88,a,136,a,164
ds_read_b64 a[208:209], v4 offset:2240
s_add_u32 s36, s36, s37
MV 92,a,136,a,168
ds_read_b64 a[210:211], v4 offset:2248
v_and_b32 v253, 15, v1
MV 96,a,136,a,172
ds_read_b128 a[244:247], v5 offset:1216
v_lshl_add_u32 v253, v253, 3, s36
MV 100,a,136,a,176
MV 104,a,136,a,180
ds_read_b64 a[212:213], v4 offset:2752
s_xor_b32 s36, s2, 4
MV 88,a,140,a,160
ds_read_b64 a[214:215], v4 offset:2760
v_mov_b32 v228, s36
MV 92,a,140,a,164
ds_read_b128 a[248:251], v5 offset:704
MV 96,a,140,a,168
ds_read_b64 a[216:217], v4 offset:3264
MV 100,a,140,a,172
v_cmp_lt_u32 vcc, 15, v1
s_nop 1
v_cndmask_b32 v254, v254, v228, vcc
MV 104,a,140,a,176
ds_read_b64 a[218:219], v4 offset:3272
MV 92,a,144,a,160
ds_read_b128 a[252:255], v5 offset:192
MV 96,a,144,a,164
ds_read_b64 a[220:221], v4 offset:3776
MV 100,a,144,a,168
ds_read_b64 a[222:223], v4 offset:3784
MV 104,a,144,a,172
v_cmp_lt_u32 vcc, 31, v1
s_nop 1
v_cndmask_b32 v254, v254, v253, vcc
MV 96,a,148,a,160
MV 100,a,148,a,164
MV 104,a,148,a,168
MV 100,a,152,a,160
v_lshlrev_b32 v254, 2, v254
MV 104,a,152,a,164
s_waitcnt lgkmcnt(15)
MV 104,a,156,a,160
MV 76,a,192,a,224
ds_read_b128 a[160:163], v5 offset:3840
MV 80,a,192,a,228
ds_read_b64 a[128:129], v4 offset:256
MV 84,a,192,a,232
ds_read_b64 a[130:131], v4 offset:264
s_waitcnt lgkmcnt(15)
MV 88,a,192,a,236
ds_read_b128 a[164:167], v5 offset:3328
s_waitcnt lgkmcnt(15)
MV 92,a,192,a,240
s_waitcnt lgkmcnt(12)
MV 96,a,192,a,244
ds_read_b64 a[132:133], v4 offset:768
s_waitcnt lgkmcnt(10)
MV 100,a,192,a,248
ds_read_b64 a[134:135], v4 offset:776
s_waitcnt lgkmcnt(8)
MV 104,a,192,a,252
ds_read_b128 a[168:171], v5 offset:2816
MV 80,a,196,a,224
ds_read_b64 a[136:137], v4 offset:1280
MV 84,a,196,a,228
MV 88,a,196,a,232
ds_read_b64 a[138:139], v4 offset:1288
MV 92,a,196,a,236
ds_read_b128 a[172:175], v5 offset:2304
MV 96,a,196,a,240
ds_read_b64 a[140:141], v4 offset:1792
MV 100,a,196,a,244
ds_read_b64 a[142:143], v4 offset:1800
MV 104,a,196,a,248
MV 84,a,200,a,224
ds_read_b128 a[176:179], v5 offset:1792
MV 88,a,200,a,228
ds_read_b64 a[144:145], v4 offset:2304
MV 92,a,200,a,232
ds_read_b64 a[146:147], v4 offset:2312
MV 96,a,200,a,236
ds_read_b128 a[180:183], v5 offset:1280
MV 100,a,200,a,240
MV 104,a,200,a,244
ds_read_b64 a[148:149], v4 offset:2816
MV 88,a,204,a,224
ds_read_b64 a[150:151], v4 offset:2824
MV 92,a,204,a,228
ds_read_b128 a[184:187], v5 offset:768
MV 96,a,204,a,232
ds_read_b64 a[152:153], v4 offset:3328
MV 100,a,204,a,236
MV 104,a,204,a,240
ds_read_b64 a[154:155], v4 offset:3336
MV 92,a,208,a,224
ds_read_b128 a[188:191], v5 offset:256
MV 96,a,208,a,228
ds_read_b64 a[156:157], v4 offset:3840
MV 100,a,208,a,232
ds_read_b64 a[158:159], v4 offset:3848
MV 104,a,208,a,236
MV 96,a,212,a,224
MV 100,a,212,a,228
MV 104,a,212,a,232
MV 100,a,216,a,224
MV 104,a,216,a,228
s_waitcnt lgkmcnt(15)
MV 104,a,220,a,224
MV 76,a,128,a,160
ds_read_b128 a[224:227], v5 offset:3904
MV 80,a,128,a,164
ds_read_b64 a[192:193], v4 offset:320
MV 84,a,128,a,168
ds_read_b64 a[194:195], v4 offset:328
s_waitcnt lgkmcnt(15)
MV 88,a,128,a,172
ds_read_b128 a[228:231], v5 offset:3392
s_waitcnt lgkmcnt(15)
MV 92,a,128,a,176
s_waitcnt lgkmcnt(12)
MV 96,a,128,a,180
ds_read_b64 a[196:197], v4 offset:832
s_waitcnt lgkmcnt(10)
MV 100,a,128,a,184
ds_read_b64 a[198:199], v4 offset:840
s_waitcnt lgkmcnt(8)
MV 104,a,128,a,188
ds_read_b128 a[232:235], v5 offset:2880
MV 80,a,132,a,160
ds_read_b64 a[200:201], v4 offset:1344
MV 84,a,132,a,164
MV 88,a,132,a,168
ds_read_b64 a[202:203], v4 offset:1352
MV 92,a,132,a,172
ds_read_b128 a[236:239], v5 offset:2368
MV 96,a,132,a,176
ds_read_b64 a[204:205], v4 offset:1856
MV 100,a,132,a,180
ds_read_b64 a[206:207], v4 offset:1864
MV 104,a,132,a,184
MV 84,a,136,a,160
ds_read_b128 a[240:243], v5 offset:1856
MV 88,a,136,a,164
ds_read_b64 a[208:209], v4 offset:2368
MV 92,a,136,a,168
ds_read_b64 a[210:211], v4 offset:2376
MV 96,a,136,a,172
ds_read_b128 a[244:247], v5 offset:1344
MV 100,a,136,a,176
MV 104,a,136,a,180
ds_read_b64 a[212:213], v4 offset:2880
MV 88,a,140,a,160
ds_read_b64 a[214:215], v4 offset:2888
MV 92,a,140,a,164
ds_read_b128 a[248:251], v5 offset:832
MV 96,a,140,a,168
ds_read_b64 a[216:217], v4 offset:3392
MV 100,a,140,a,172
MV 104,a,140,a,176
ds_read_b64 a[218:219], v4 offset:3400
MV 92,a,144,a,160
ds_read_b128 a[252:255], v5 offset:320
MV 96,a,144,a,164
ds_read_b64 a[220:221], v4 offset:3904
MV 100,a,144,a,168
ds_read_b64 a[222:223], v4 offset:3912
MV 104,a,144,a,172
MV 96,a,148,a,160
MV 100,a,148,a,164
MV 104,a,148,a,168
MV 100,a,152,a,160
MV 104,a,152,a,164
s_waitcnt lgkmcnt(15)
MV 104,a,156,a,160
MV 76,a,192,a,224
ds_read_b128 a[160:163], v5 offset:3968
MV 80,a,192,a,228
ds_read_b64 a[128:129], v4 offset:384
MV 84,a,192,a,232
ds_read_b64 a[130:131], v4 offset:392
s_waitcnt lgkmcnt(15)
MV 88,a,192,a,236
ds_read_b128 a[164:167], v5 offset:3456
s_waitcnt lgkmcnt(15)
MV 92,a,192,a,240
s_waitcnt lgkmcnt(12)
MV 96,a,192,a,244
ds_read_b64 a[132:133], v4 offset:896
s_waitcnt lgkmcnt(10)
MV 100,a,192,a,248
ds_read_b64 a[134:135], v4 offset:904
s_waitcnt lgkmcnt(8)
MV 104,a,192,a,252
ds_read_b128 a[168:171], v5 offset:2944
MV 80,a,196,a,224
ds_read_b64 a[136:137], v4 offset:1408
MV 84,a,196,a,228
MV 88,a,196,a,232
ds_read_b64 a[138:139], v4 offset:1416
MV 92,a,196,a,236
ds_read_b128 a[172:175], v5 offset:2432
MV 96,a,196,a,240
ds_read_b64 a[140:141], v4 offset:1920
MV 100,a,196,a,244
ds_read_b64 a[142:143], v4 offset:1928
MV 104,a,196,a,248
MV 84,a,200,a,224
ds_read_b128 a[176:179], v5 offset:1920
MV 88,a,200,a,228
ds_read_b64 a[144:145], v4 offset:2432
MV 92,a,200,a,232
ds_read_b64 a[146:147], v4 offset:2440
MV 96,a,200,a,236
ds_read_b128 a[180:183], v5 offset:1408
MV 100,a,200,a,240
MV 104,a,200,a,244
ds_read_b64 a[148:149], v4 offset:2944
MV 88,a,204,a,224
ds_read_b64 a[150:151], v4 offset:2952
MV 92,a,204,a,228
ds_read_b128 a[184:187], v5 offset:896
MV 96,a,204,a,232
ds_read_b64 a[152:153], v4 offset:3456
MV 100,a,204,a,236
MV 104,a,204,a,240
ds_read_b64 a[154:155], v4 offset:3464
MV 92,a,208,a,224
ds_read_b128 a[188:191], v5 offset:384
MV 96,a,208,a,228
ds_read_b64 a[156:157], v4 offset:3968
MV 100,a,208,a,232
ds_read_b64 a[158:159], v4 offset:3976
MV 104,a,208,a,236
MV 96,a,212,a,224
MV 100,a,212,a,228
MV 104,a,212,a,232
MV 100,a,216,a,224
MV 104,a,216,a,228
s_waitcnt lgkmcnt(15)
MV 104,a,220,a,224
MV 76,a,128,a,160
ds_read_b128 a[224:227], v5 offset:4032
MV 80,a,128,a,164
ds_read_b64 a[192:193], v4 offset:448
MV 84,a,128,a,168
ds_read_b64 a[194:195], v4 offset:456
s_waitcnt lgkmcnt(15)
MV 88,a,128,a,172
ds_read_b128 a[228:231], v5 offset:3520
s_waitcnt lgkmcnt(15)
MV 92,a,128,a,176
s_waitcnt lgkmcnt(12)
MV 96,a,128,a,180
ds_read_b64 a[196:197], v4 offset:960
s_waitcnt lgkmcnt(10)
MV 100,a,128,a,184
ds_read_b64 a[198:199], v4 offset:968
s_waitcnt lgkmcnt(8)
MV 104,a,128,a,188
ds_read_b128 a[232:235], v5 offset:3008
MV 80,a,132,a,160
ds_read_b64 a[200:201], v4 offset:1472
MV 84,a,132,a,164
MV 88,a,132,a,168
ds_read_b64 a[202:203], v4 offset:1480
MV 92,a,132,a,172
ds_read_b128 a[236:239], v5 offset:2496
MV 96,a,132,a,176
ds_read_b64 a[204:205], v4 offset:1984
MV 100,a,132,a,180
ds_read_b64 a[206:207], v4 offset:1992
MV 104,a,132,a,184
MV 84,a,136,a,160
ds_read_b128 a[240:243], v5 offset:1984
MV 88,a,136,a,164
ds_read_b64 a[208:209], v4 offset:2496
MV 92,a,136,a,168
ds_read_b64 a[210:211], v4 offset:2504
MV 96,a,136,a,172
ds_read_b128 a[244:247], v5 offset:1472
MV 100,a,136,a,176
MV 104,a,136,a,180
ds_read_b64 a[212:213], v4 offset:3008
MV 88,a,140,a,160
ds_read_b64 a[214:215], v4 offset:3016
MV 92,a,140,a,164
ds_read_b128 a[248:251], v5 offset:960
MV 96,a,140,a,168
ds_read_b64 a[216:217], v4 offset:3520
MV 100,a,140,a,172
MV 104,a,140,a,176
ds_read_b64 a[218:219], v4 offset:3528
MV 92,a,144,a,160
ds_read_b128 a[252:255], v5 offset:448
MV 96,a,144,a,164
ds_read_b64 a[220:221], v4 offset:4032
MV 100,a,144,a,168
ds_read_b64 a[222:223], v4 offset:4040
MV 104,a,144,a,172
MV 96,a,148,a,160
MV 100,a,148,a,164
MV 104,a,148,a,168
MV 100,a,152,a,160
MV 104,a,152,a,164
s_waitcnt lgkmcnt(15)
MV 104,a,156,a,160
buffer_load_dword v253, v254, s[8:11], 0 offen offset:1024 sc1
s_waitcnt vmcnt(0)
v_cmp_gt_u32 vcc, 1, v253
s_nop 4
s_cbranch_vccnz L_spin_f2
L_spin_f2_ret:
s_add_u32 m0, s70, 66560
s_nop 0
buffer_load_dwordx4 v238, s[48:51], s69 offen offset:0 sc1 lds
buffer_load_dwordx4 v238, s[48:51], s69 offen offset:1024 sc1 lds
buffer_load_dwordx4 v238, s[48:51], s69 offen offset:2048 sc1 lds
buffer_load_dwordx4 v238, s[48:51], s69 offen offset:3072 sc1 lds
s_add_u32 s69, s69, 16384
buffer_load_dwordx4 a[0:3], v236, s[44:47], s68 offen offset:0 sc1
buffer_load_dwordx4 a[4:7], v237, s[44:47], s68 offen offset:0 sc1
buffer_load_dwordx4 a[8:11], v236, s[44:47], s68 offen offset:1024 sc1
buffer_load_dwordx4 a[12:15], v237, s[44:47], s68 offen offset:1024 sc1
s_add_u32 s68, s68, 2048
MV 76,a,192,a,224
s_add_u32 m0, s70, 82944
s_nop 0
buffer_load_dwordx4 v238, s[48:51], s69 offen offset:0 sc1 lds
MV 80,a,192,a,228
buffer_load_dwordx4 v238, s[48:51], s69 offen offset:1024 sc1 lds
MV 84,a,192,a,232
buffer_load_dwordx4 v238, s[48:51], s69 offen offset:2048 sc1 lds
buffer_load_dwordx4 v238, s[48:51], s69 offen offset:3072 sc1 lds
s_waitcnt lgkmcnt(14)
MV 88,a,192,a,236
s_add_u32 s69, s69, 16384
s_waitcnt lgkmcnt(11)
MV 92,a,192,a,240
buffer_load_dwordx4 a[16:19], v236, s[44:47], s68 offen offset:0 sc1
s_waitcnt lgkmcnt(8)
MV 96,a,192,a,244
buffer_load_dwordx4 a[20:23], v237, s[44:47], s68 offen offset:0 sc1
buffer_load_dwordx4 a[24:27], v236, s[44:47], s68 offen offset:1024 sc1
s_waitcnt lgkmcnt(5)
MV 100,a,192,a,248
buffer_load_dwordx4 a[28:31], v237, s[44:47], s68 offen offset:1024 sc1
s_waitcnt lgkmcnt(2)
MV 104,a,192,a,252
s_add_u32 s68, s68, 2048
MV 80,a,196,a,224
s_add_u32 m0, s70, 99328
s_nop 0
buffer_load_dwordx4 v238, s[48:51], s69 offen offset:0 sc1 lds
MV 84,a,196,a,228
buffer_load_dwordx4 v238, s[48:51], s69 offen offset:1024 sc1 lds
MV 88,a,196,a,232
buffer_load_dwordx4 v238, s[48:51], s69 offen offset:2048 sc1 lds
buffer_load_dwordx4 v238, s[48:51], s69 offen offset:3072 sc1 lds
MV 92,a,196,a,236
s_add_u32 s69, s69, 16384
MV 96,a,196,a,240
buffer_load_dwordx4 a[32:35], v236, s[44:47], s68 offen offset:0 sc1
MV 100,a,196,a,244
buffer_load_dwordx4 a[36:39], v237, s[44:47], s68 offen offset:0 sc1
buffer_load_dwordx4 a[40:43], v236, s[44:47], s68 offen offset:1024 sc1
MV 104,a,196,a,248
buffer_load_dwordx4 a[44:47], v237, s[44:47], s68 offen offset:1024 sc1
MV 84,a,200,a,224
s_add_u32 s68, s68, 2048
MV 88,a,200,a,228
s_add_u32 m0, s70, 115712
s_nop 0
buffer_load_dwordx4 v238, s[48:51], s69 offen offset:0 sc1 lds
MV 92,a,200,a,232
buffer_load_dwordx4 v238, s[48:51], s69 offen offset:1024 sc1 lds
MV 96,a,200,a,236
buffer_load_dwordx4 v238, s[48:51], s69 offen offset:2048 sc1 lds
buffer_load_dwordx4 v238, s[48:51], s69 offen offset:3072 sc1 lds
MV 100,a,200,a,240
s_add_u32 s69, s69, 16384
MV 104,a,200,a,244
buffer_load_dwordx4 a[48:51], v236, s[44:47], s68 offen offset:0 sc1
MV 88,a,204,a,224
buffer_load_dwordx4 a[52:55], v237, s[44:47], s68 offen offset:0 sc1
buffer_load_dwordx4 a[56:59], v236, s[44:47], s68 offen offset:1024 sc1
MV 92,a,204,a,228
buffer_load_dwordx4 a[60:63], v237, s[44:47], s68 offen offset:1024 sc1
MV 96,a,204,a,232
s_add_u32 s68, s68, 2048
MV 100,a,204,a,236
buffer_load_dwordx4 a[64:67], v236, s[44:47], s68 offen offset:0 sc1
buffer_load_dwordx4 a[68:71], v237, s[44:47], s68 offen offset:0 sc1
MV 104,a,204,a,240
buffer_load_dwordx4 a[72:75], v236, s[44:47], s68 offen offset:1024 sc1
MV 92,a,208,a,224
buffer_load_dwordx4 a[76:79], v237, s[44:47], s68 offen offset:1024 sc1
s_add_u32 s68, s68, 2048
MV 96,a,208,a,228
buffer_load_dwordx4 a[80:83], v236, s[44:47], s68 offen offset:0 sc1
MV 100,a,208,a,232
buffer_load_dwordx4 a[84:87], v237, s[44:47], s68 offen offset:0 sc1
MV 104,a,208,a,236
buffer_load_dwordx4 a[88:91], v236, s[44:47], s68 offen offset:1024 sc1
buffer_load_dwordx4 a[92:95], v237, s[44:47], s68 offen offset:1024 sc1
MV 96,a,212,a,224
s_add_u32 s68, s68, 2048
MV 100,a,212,a,228
buffer_load_dwordx4 a[96:99], v236, s[44:47], s68 offen offset:0 sc1
MV 104,a,212,a,232
buffer_load_dwordx4 a[100:103], v237, s[44:47], s68 offen offset:0 sc1
buffer_load_dwordx4 a[104:107], v236, s[44:47], s68 offen offset:1024 sc1
MV 100,a,216,a,224
buffer_load_dwordx4 a[108:111], v237, s[44:47], s68 offen offset:1024 sc1
MV 104,a,216,a,228
s_add_u32 s68, s68, 2048
s_waitcnt lgkmcnt(0)
MV 104,a,220,a,224
s_waitcnt vmcnt(40) lgkmcnt(0)
s_barrier
ds_read_b128 a[128:131], v242 offset:0
ds_read_b128 a[132:135], v242 offset:1024
ds_read_b128 a[136:139], v242 offset:2048
ds_read_b128 a[140:143], v242 offset:3072
ds_read_b128 a[144:147], v243 offset:0
ds_read_b128 a[148:151], v243 offset:1024
ds_read_b128 a[152:155], v243 offset:2048
ds_read_b128 a[156:159], v243 offset:3072
s_add_u32 m0, s70, 0
s_nop 0
buffer_load_dwordx4 v238, s[48:51], s69 offen offset:0 sc1 lds
buffer_load_dwordx4 v238, s[48:51], s69 offen offset:1024 sc1 lds
buffer_load_dwordx4 v238, s[48:51], s69 offen offset:2048 sc1 lds
buffer_load_dwordx4 v238, s[48:51], s69 offen offset:3072 sc1 lds
s_add_u32 s69, s69, 16384
s_add_u32 m0, s70, 16384
s_nop 0
buffer_load_dwordx4 v238, s[48:51], s69 offen offset:0 sc1 lds
buffer_load_dwordx4 v238, s[48:51], s69 offen offset:1024 sc1 lds
buffer_load_dwordx4 v238, s[48:51], s69 offen offset:2048 sc1 lds
buffer_load_dwordx4 v238, s[48:51], s69 offen offset:3072 sc1 lds
s_add_u32 s69, s69, 16384
s_waitcnt vmcnt(47) lgkmcnt(7)
v_mfma_f32_16x16x32_bf16 v[124:127], a[128:131], a[0:3], 0
ds_read_b128 a[160:163], v242 offset:8192
v_cvt_pk_bf16_f32 v16, v76, v77
s_waitcnt vmcnt(46)
v_mfma_f32_16x16x32_bf16 v[128:131], a[128:131], a[4:7], 0
ds_read_b128 a[164:167], v242 offset:9216
s_add_u32 m0, s70, 32768
s_waitcnt lgkmcnt(8)
v_mfma_f32_16x16x32_bf16 v[132:135], a[132:135], a[0:3], 0
v_cvt_pk_bf16_f32 v17, v78, v79
v_mfma_f32_16x16x32_bf16 v[136:139], a[132:135], a[4:7], 0
ds_read_b128 a[168:171], v242 offset:10240
ds_write_b16 v7, v16 offset:0
s_waitcnt lgkmcnt(9)
v_mfma_f32_16x16x32_bf16 v[140:143], a[136:139], a[0:3], 0
ds_read_b128 a[172:175], v242 offset:11264
v_mfma_f32_16x16x32_bf16 v[144:147], a[136:139], a[4:7], 0
buffer_load_dwordx4 v238, s[48:51], s69 offen offset:0 sc1 lds
ds_write_b16_d16_hi v7, v16 offset:8
s_waitcnt lgkmcnt(10)
v_mfma_f32_16x16x32_bf16 v[148:151], a[140:143], a[0:3], 0
ds_read_b128 a[176:179], v243 offset:8192
v_mfma_f32_16x16x32_bf16 v[152:155], a[140:143], a[4:7], 0
ds_read_b128 a[180:183], v243 offset:9216
ds_write_b16 v7, v17 offset:16
s_waitcnt lgkmcnt(12)
v_mfma_f32_16x16x32_bf16 v[156:159], a[144:147], a[0:3], 0
ds_write_b16_d16_hi v7, v17 offset:24
v_mfma_f32_16x16x32_bf16 v[160:163], a[144:147], a[4:7], 0
ds_read_b128 a[184:187], v243 offset:10240
buffer_load_dwordx4 v238, s[48:51], s69 offen offset:1024 sc1 lds
s_waitcnt lgkmcnt(13)
v_mfma_f32_16x16x32_bf16 v[164:167], a[148:151], a[0:3], 0
ds_read_b128 a[188:191], v243 offset:11264
v_cvt_pk_bf16_f32 v18, v80, v81
v_mfma_f32_16x16x32_bf16 v[168:171], a[148:151], a[4:7], 0
s_waitcnt lgkmcnt(13)
v_mfma_f32_16x16x32_bf16 v[172:175], a[152:155], a[0:3], 0
v_cvt_pk_bf16_f32 v19, v82, v83
v_mfma_f32_16x16x32_bf16 v[176:179], a[152:155], a[4:7], 0
s_waitcnt lgkmcnt(12)
v_mfma_f32_16x16x32_bf16 v[180:183], a[156:159], a[0:3], 0
buffer_load_dwordx4 a[0:3], v236, s[44:47], s68 offen offset:0 sc1
ds_write_b16 v7, v18 offset:2176
v_mfma_f32_16x16x32_bf16 v[184:187], a[156:159], a[4:7], 0
buffer_load_dwordx4 a[4:7], v237, s[44:47], s68 offen offset:0 sc1
s_waitcnt vmcnt(44) lgkmcnt(0)
s_barrier
MV 124,a,160,a,8
ds_read_b128 a[128:131], v242 offset:16384
ds_write_b16_d16_hi v7, v18 offset:2184
MV 128,a,160,a,12
ds_read_b128 a[132:135], v242 offset:17408
buffer_load_dwordx4 v238, s[48:51], s69 offen offset:2048 sc1 lds
MV 132,a,164,a,8
ds_write_b16 v7, v19 offset:2192
MV 136,a,164,a,12
ds_read_b128 a[136:139], v242 offset:18432
ds_write_b16_d16_hi v7, v19 offset:2200
MV 140,a,168,a,8
ds_read_b128 a[140:143], v242 offset:19456
v_cvt_pk_bf16_f32 v16, v84, v85
MV 144,a,168,a,12
buffer_load_dwordx4 v238, s[48:51], s69 offen offset:3072 sc1 lds
MV 148,a,172,a,8
ds_read_b128 a[144:147], v243 offset:16384
v_cvt_pk_bf16_f32 v17, v86, v87
MV 152,a,172,a,12
ds_read_b128 a[148:151], v243 offset:17408
MV 156,a,176,a,8
ds_write_b16 v7, v16 offset:4352
MV 160,a,176,a,12
ds_read_b128 a[152:155], v243 offset:18432
s_add_u32 s69, s69, 16384
MV 164,a,180,a,8
ds_read_b128 a[156:159], v243 offset:19456
ds_write_b16_d16_hi v7, v16 offset:4360
MV 168,a,180,a,12
ds_write_b16 v7, v17 offset:4368
MV 172,a,184,a,8
ds_write_b16_d16_hi v7, v17 offset:4376
MV 176,a,184,a,12
MV 180,a,188,a,8
buffer_load_dwordx4 a[8:11], v236, s[44:47], s68 offen offset:1024 sc1
v_cvt_pk_bf16_f32 v18, v88, v89
MV 184,a,188,a,12
buffer_load_dwordx4 a[12:15], v237, s[44:47], s68 offen offset:1024 sc1
s_add_u32 s68, s68, 2048
s_waitcnt vmcnt(47) lgkmcnt(14)
MV 124,a,128,a,16
ds_read_b128 a[160:163], v242 offset:24576
v_cvt_pk_bf16_f32 v19, v90, v91
s_waitcnt vmcnt(46)
MV 128,a,128,a,20
ds_read_b128 a[164:167], v242 offset:25600
s_add_u32 m0, s70, 66560
s_waitcnt lgkmcnt(14)
MV 132,a,132,a,16
ds_write_b16 v7, v18 offset:6528
MV 136,a,132,a,20
ds_read_b128 a[168:171], v242 offset:26624
ds_write_b16_d16_hi v7, v18 offset:6536
s_waitcnt lgkmcnt(15)
MV 140,a,136,a,16
ds_read_b128 a[172:175], v242 offset:27648
MV 144,a,136,a,20
buffer_load_dwordx4 v238, s[48:51], s69 offen offset:0 sc1 lds
ds_write_b16 v7, v19 offset:6544
s_waitcnt lgkmcnt(15)
MV 148,a,140,a,16
ds_read_b128 a[176:179], v243 offset:24576
MV 152,a,140,a,20
ds_read_b128 a[180:183], v243 offset:25600
ds_write_b16_d16_hi v7, v19 offset:6552
s_waitcnt lgkmcnt(15)
MV 156,a,144,a,16
v_cvt_pk_bf16_f32 v16, v92, v93
MV 160,a,144,a,20
ds_read_b128 a[184:187], v243 offset:26624
buffer_load_dwordx4 v238, s[48:51], s69 offen offset:1024 sc1 lds
MV 164,a,148,a,16
ds_read_b128 a[188:191], v243 offset:27648
v_cvt_pk_bf16_f32 v17, v94, v95
MV 168,a,148,a,20
s_waitcnt lgkmcnt(15)
MV 172,a,152,a,16
ds_write_b16 v7, v16 offset:8704
MV 176,a,152,a,20
MV 180,a,156,a,16
buffer_load_dwordx4 a[16:19], v236, s[44:47], s68 offen offset:0 sc1
ds_write_b16_d16_hi v7, v16 offset:8712
MV 184,a,156,a,20
buffer_load_dwordx4 a[20:23], v237, s[44:47], s68 offen offset:0 sc1
s_waitcnt vmcnt(44) lgkmcnt(0)
s_barrier
MV 124,a,160,a,24
ds_read_b128 a[128:131], v242 offset:32768
ds_write_b16 v7, v17 offset:8720
MV 128,a,160,a,28
ds_read_b128 a[132:135], v242 offset:33792
buffer_load_dwordx4 v238, s[48:51], s69 offen offset:2048 sc1 lds
MV 132,a,164,a,24
ds_write_b16_d16_hi v7, v17 offset:8728
MV 136,a,164,a,28
ds_read_b128 a[136:139], v242 offset:34816
v_cvt_pk_bf16_f32 v18, v96, v97
MV 140,a,168,a,24
ds_read_b128 a[140:143], v242 offset:35840
v_cvt_pk_bf16_f32 v19, v98, v99
MV 144,a,168,a,28
buffer_load_dwordx4 v238, s[48:51], s69 offen offset:3072 sc1 lds
MV 148,a,172,a,24
ds_read_b128 a[144:147], v243 offset:32768
ds_write_b16 v7, v18 offset:10880
MV 152,a,172,a,28
ds_read_b128 a[148:151], v243 offset:33792
MV 156,a,176,a,24
ds_write_b16_d16_hi v7, v18 offset:10888
MV 160,a,176,a,28
ds_read_b128 a[152:155], v243 offset:34816
s_add_u32 s69, s69, 16384
MV 164,a,180,a,24
ds_read_b128 a[156:159], v243 offset:35840
ds_write_b16 v7, v19 offset:10896
MV 168,a,180,a,28
ds_write_b16_d16_hi v7, v19 offset:10904
MV 172,a,184,a,24
v_cvt_pk_bf16_f32 v16, v100, v101
MV 176,a,184,a,28
MV 180,a,188,a,24
buffer_load_dwordx4 a[24:27], v236, s[44:47], s68 offen offset:1024 sc1
v_cvt_pk_bf16_f32 v17, v102, v103
MV 184,a,188,a,28
buffer_load_dwordx4 a[28:31], v237, s[44:47], s68 offen offset:1024 sc1
s_add_u32 s68, s68, 2048
s_waitcnt vmcnt(47) lgkmcnt(13)
MV 124,a,128,a,32
ds_read_b128 a[160:163], v242 offset:40960
ds_write_b16 v7, v16 offset:13056
s_waitcnt vmcnt(46)
MV 128,a,128,a,36
ds_read_b128 a[164:167], v242 offset:41984
s_add_u32 m0, s70, 82944
s_waitcnt lgkmcnt(14)
MV 132,a,132,a,32
ds_write_b16_d16_hi v7, v16 offset:13064
MV 136,a,132,a,36
ds_read_b128 a[168:171], v242 offset:43008
ds_write_b16 v7, v17 offset:13072
s_waitcnt lgkmcnt(15)
MV 140,a,136,a,32
ds_read_b128 a[172:175], v242 offset:44032
ds_write_b16_d16_hi v7, v17 offset:13080
MV 144,a,136,a,36
buffer_load_dwordx4 v238, s[48:51], s69 offen offset:0 sc1 lds
s_waitcnt lgkmcnt(15)
MV 148,a,140,a,32
ds_read_b128 a[176:179], v243 offset:40960
v_cvt_pk_bf16_f32 v18, v104, v105
MV 152,a,140,a,36
ds_read_b128 a[180:183], v243 offset:41984
MV 156,a,144,a,32
v_cvt_pk_bf16_f32 v19, v106, v107
MV 160,a,144,a,36
ds_read_b128 a[184:187], v243 offset:43008
buffer_load_dwordx4 v238, s[48:51], s69 offen offset:1024 sc1 lds
s_waitcnt lgkmcnt(15)
MV 164,a,148,a,32
ds_read_b128 a[188:191], v243 offset:44032
ds_write_b16 v7, v18 offset:15232
MV 168,a,148,a,36
ds_write_b16_d16_hi v7, v18 offset:15240
s_waitcnt lgkmcnt(15)
MV 172,a,152,a,32
ds_write_b16 v7, v19 offset:15248
MV 176,a,152,a,36
MV 180,a,156,a,32
buffer_load_dwordx4 a[32:35], v236, s[44:47], s68 offen offset:0 sc1
ds_write_b16_d16_hi v7, v19 offset:15256
MV 184,a,156,a,36
buffer_load_dwordx4 a[36:39], v237, s[44:47], s68 offen offset:0 sc1
s_waitcnt vmcnt(44) lgkmcnt(0)
s_barrier
MV 124,a,160,a,40
ds_read_b128 a[128:131], v242 offset:49152
ds_read_b64 v[108:109], v8 offset:0
MV 128,a,160,a,44
ds_read_b128 a[132:135], v242 offset:50176
buffer_load_dwordx4 v238, s[48:51], s69 offen offset:2048 sc1 lds
MV 132,a,164,a,40
ds_read_b64 v[110:111], v8 offset:8
MV 136,a,164,a,44
ds_read_b128 a[136:139], v242 offset:51200
MV 140,a,168,a,40
ds_read_b128 a[140:143], v242 offset:52224
ds_read_b64 v[112:113], v8 offset:1088
MV 144,a,168,a,44
buffer_load_dwordx4 v238, s[48:51], s69 offen offset:3072 sc1 lds
MV 148,a,172,a,40
ds_read_b128 a[144:147], v243 offset:49152
ds_read_b64 v[114:115], v8 offset:1096
MV 152,a,172,a,44
ds_read_b128 a[148:151], v243 offset:50176
MV 156,a,176,a,40
ds_read_b64 v[116:117], v8 offset:2176
MV 160,a,176,a,44
ds_read_b128 a[152:155], v243 offset:51200
s_add_u32 s69, s69, 16384
MV 164,a,180,a,40
ds_read_b128 a[156:159], v243 offset:52224
ds_read_b64 v[118:119], v8 offset:2184
MV 168,a,180,a,44
MV 172,a,184,a,40
ds_read_b64 v[120:121], v8 offset:3264
MV 176,a,184,a,44
MV 180,a,188,a,40
buffer_load_dwordx4 a[40:43], v236, s[44:47], s68 offen offset:1024 sc1
ds_read_b64 v[122:123], v8 offset:3272
MV 184,a,188,a,44
buffer_load_dwordx4 a[44:47], v237, s[44:47], s68 offen offset:1024 sc1
s_add_u32 s68, s68, 2048
s_waitcnt vmcnt(47) lgkmcnt(15)
MV 124,a,128,a,48
ds_read_b128 a[160:163], v242 offset:57344
s_waitcnt lgkmcnt(13)
buffer_store_dwordx4 v[108:111], v9, s[24:27], 0 offen offset:0 sc1
s_waitcnt vmcnt(47)
MV 128,a,128,a,52
ds_read_b128 a[164:167], v242 offset:58368
s_add_u32 m0, s70, 99328
MV 132,a,132,a,48
MV 136,a,132,a,52
ds_read_b128 a[168:171], v242 offset:59392
s_waitcnt lgkmcnt(14)
MV 140,a,136,a,48
ds_read_b128 a[172:175], v242 offset:60416
MV 144,a,136,a,52
buffer_load_dwordx4 v238, s[48:51], s69 offen offset:0 sc1 lds
s_waitcnt lgkmcnt(14)
MV 148,a,140,a,48
ds_read_b128 a[176:179], v243 offset:57344
MV 152,a,140,a,52
ds_read_b128 a[180:183], v243 offset:58368
s_waitcnt lgkmcnt(14)
MV 156,a,144,a,48
s_waitcnt lgkmcnt(13)
buffer_store_dwordx4 v[112:115], v9, s[24:27], 0 offen offset:1024 sc1
MV 160,a,144,a,52
ds_read_b128 a[184:187], v243 offset:59392
buffer_load_dwordx4 v238, s[48:51], s69 offen offset:1024 sc1 lds
s_waitcnt lgkmcnt(13)
MV 164,a,148,a,48
ds_read_b128 a[188:191], v243 offset:60416
MV 168,a,148,a,52
s_waitcnt lgkmcnt(12)
MV 172,a,152,a,48
MV 176,a,152,a,52
s_waitcnt lgkmcnt(11)
MV 180,a,156,a,48
buffer_load_dwordx4 a[48:51], v236, s[44:47], s68 offen offset:0 sc1
MV 184,a,156,a,52
buffer_load_dwordx4 a[52:55], v237, s[44:47], s68 offen offset:0 sc1
s_waitcnt vmcnt(34) lgkmcnt(0)
s_barrier
MV 124,a,160,a,56
ds_read_b128 a[128:131], v244 offset:0
buffer_store_dwordx4 v[116:119], v9, s[24:27], 0 offen offset:2048 sc1
MV 128,a,160,a,60
ds_read_b128 a[132:135], v244 offset:1024
buffer_load_dwordx4 v238, s[48:51], s69 offen offset:2048 sc1 lds
MV 132,a,164,a,56
MV 136,a,164,a,60
ds_read_b128 a[136:139], v244 offset:2048
MV 140,a,168,a,56
ds_read_b128 a[140:143], v244 offset:3072
MV 144,a,168,a,60
buffer_load_dwordx4 v238, s[48:51], s69 offen offset:3072 sc1 lds
MV 148,a,172,a,56
ds_read_b128 a[144:147], v245 offset:0
MV 152,a,172,a,60
ds_read_b128 a[148:151], v245 offset:1024
MV 156,a,176,a,56
buffer_store_dwordx4 v[120:123], v9, s[24:27], 0 offen offset:3072 sc1
MV 160,a,176,a,60
ds_read_b128 a[152:155], v245 offset:2048
s_add_u32 s69, s69, 16384
MV 164,a,180,a,56
ds_read_b128 a[156:159], v245 offset:3072
MV 168,a,180,a,60
MV 172,a,184,a,56
MV 176,a,184,a,60
MV 180,a,188,a,56
buffer_load_dwordx4 a[56:59], v236, s[44:47], s68 offen offset:1024 sc1
MV 184,a,188,a,60
buffer_load_dwordx4 a[60:63], v237, s[44:47], s68 offen offset:1024 sc1
s_add_u32 s68, s68, 2048
s_waitcnt lgkmcnt(7)
MV 124,a,128,a,64
ds_read_b128 a[160:163], v244 offset:8192
MV 128,a,128,a,68
ds_read_b128 a[164:167], v244 offset:9216
s_add_u32 m0, s70, 115712
s_waitcnt lgkmcnt(8)
MV 132,a,132,a,64
MV 136,a,132,a,68
ds_read_b128 a[168:171], v244 offset:10240
s_waitcnt lgkmcnt(8)
MV 140,a,136,a,64
ds_read_b128 a[172:175], v244 offset:11264
MV 144,a,136,a,68
buffer_load_dwordx4 v238, s[48:51], s69 offen offset:0 sc1 lds
s_waitcnt lgkmcnt(8)
MV 148,a,140,a,64
ds_read_b128 a[176:179], v245 offset:8192
MV 152,a,140,a,68
ds_read_b128 a[180:183], v245 offset:9216
s_waitcnt lgkmcnt(9)
MV 156,a,144,a,64
MV 160,a,144,a,68
ds_read_b128 a[184:187], v245 offset:10240
buffer_load_dwordx4 v238, s[48:51], s69 offen offset:1024 sc1 lds
s_waitcnt lgkmcnt(9)
MV 164,a,148,a,64
ds_read_b128 a[188:191], v245 offset:11264
MV 168,a,148,a,68
s_waitcnt lgkmcnt(9)
MV 172,a,152,a,64
MV 176,a,152,a,68
s_waitcnt lgkmcnt(8)
MV 180,a,156,a,64
buffer_load_dwordx4 a[64:67], v236, s[44:47], s68 offen offset:0 sc1
MV 184,a,156,a,68
buffer_load_dwordx4 a[68:71], v237, s[44:47], s68 offen offset:0 sc1
s_waitcnt vmcnt(40) lgkmcnt(0)
s_barrier
MV 124,a,160,a,72
ds_read_b128 a[128:131], v244 offset:16384
MV 128,a,160,a,76
ds_read_b128 a[132:135], v244 offset:17408
buffer_load_dwordx4 v238, s[48:51], s69 offen offset:2048 sc1 lds
MV 132,a,164,a,72
MV 136,a,164,a,76
ds_read_b128 a[136:139], v244 offset:18432
MV 140,a,168,a,72
ds_read_b128 a[140:143], v244 offset:19456
MV 144,a,168,a,76
buffer_load_dwordx4 v238, s[48:51], s69 offen offset:3072 sc1 lds
MV 148,a,172,a,72
ds_read_b128 a[144:147], v245 offset:16384
MV 152,a,172,a,76
ds_read_b128 a[148:151], v245 offset:17408
MV 156,a,176,a,72
MV 160,a,176,a,76
ds_read_b128 a[152:155], v245 offset:18432
s_add_u32 s69, s69, 16384
MV 164,a,180,a,72
ds_read_b128 a[156:159], v245 offset:19456
MV 168,a,180,a,76
MV 172,a,184,a,72
MV 176,a,184,a,76
MV 180,a,188,a,72
buffer_load_dwordx4 a[72:75], v236, s[44:47], s68 offen offset:1024 sc1
MV 184,a,188,a,76
buffer_load_dwordx4 a[76:79], v237, s[44:47], s68 offen offset:1024 sc1
s_add_u32 s68, s68, 2048
s_waitcnt lgkmcnt(7)
MV 124,a,128,a,80
ds_read_b128 a[160:163], v244 offset:24576
MV 128,a,128,a,84
ds_read_b128 a[164:167], v244 offset:25600
s_add_u32 m0, s70, 0
s_waitcnt lgkmcnt(8)
MV 132,a,132,a,80
MV 136,a,132,a,84
ds_read_b128 a[168:171], v244 offset:26624
s_waitcnt lgkmcnt(8)
MV 140,a,136,a,80
ds_read_b128 a[172:175], v244 offset:27648
MV 144,a,136,a,84
buffer_load_dwordx4 v238, s[48:51], s69 offen offset:0 sc1 lds
s_waitcnt lgkmcnt(8)
MV 148,a,140,a,80
ds_read_b128 a[176:179], v245 offset:24576
MV 152,a,140,a,84
ds_read_b128 a[180:183], v245 offset:25600
s_waitcnt lgkmcnt(9)
MV 156,a,144,a,80
MV 160,a,144,a,84
ds_read_b128 a[184:187], v245 offset:26624
buffer_load_dwordx4 v238, s[48:51], s69 offen offset:1024 sc1 lds
s_waitcnt lgkmcnt(9)
MV 164,a,148,a,80
ds_read_b128 a[188:191], v245 offset:27648
MV 168,a,148,a,84
s_waitcnt lgkmcnt(9)
MV 172,a,152,a,80
MV 176,a,152,a,84
s_waitcnt lgkmcnt(8)
MV 180,a,156,a,80
buffer_load_dwordx4 a[80:83], v236, s[44:47], s68 offen offset:0 sc1
MV 184,a,156,a,84
buffer_load_dwordx4 a[84:87], v237, s[44:47], s68 offen offset:0 sc1
s_waitcnt vmcnt(42) lgkmcnt(0)
s_barrier
MV 124,a,160,a,88
ds_read_b128 a[128:131], v244 offset:32768
MV 128,a,160,a,92
ds_read_b128 a[132:135], v244 offset:33792
buffer_load_dwordx4 v238, s[48:51], s69 offen offset:2048 sc1 lds
MV 132,a,164,a,88
MV 136,a,164,a,92
ds_read_b128 a[136:139], v244 offset:34816
MV 140,a,168,a,88
ds_read_b128 a[140:143], v244 offset:35840
MV 144,a,168,a,92
buffer_load_dwordx4 v238, s[48:51], s69 offen offset:3072 sc1 lds
MV 148,a,172,a,88
ds_read_b128 a[144:147], v245 offset:32768
MV 152,a,172,a,92
ds_read_b128 a[148:151], v245 offset:33792
MV 156,a,176,a,88
MV 160,a,176,a,92
ds_read_b128 a[152:155], v245 offset:34816
s_add_u32 s69, s69, 16384
MV 164,a,180,a,88
ds_read_b128 a[156:159], v245 offset:35840
MV 168,a,180,a,92
MV 172,a,184,a,88
MV 176,a,184,a,92
MV 180,a,188,a,88
buffer_load_dwordx4 a[88:91], v236, s[44:47], s68 offen offset:1024 sc1
MV 184,a,188,a,92
buffer_load_dwordx4 a[92:95], v237, s[44:47], s68 offen offset:1024 sc1
s_add_u32 s68, s68, 2048
s_waitcnt lgkmcnt(7)
MV 124,a,128,a,96
ds_read_b128 a[160:163], v244 offset:40960
MV 128,a,128,a,100
ds_read_b128 a[164:167], v244 offset:41984
s_add_u32 m0, s70, 16384
s_waitcnt lgkmcnt(8)
MV 132,a,132,a,96
MV 136,a,132,a,100
ds_read_b128 a[168:171], v244 offset:43008
s_waitcnt lgkmcnt(8)
MV 140,a,136,a,96
ds_read_b128 a[172:175], v244 offset:44032
MV 144,a,136,a,100
buffer_load_dwordx4 v238, s[48:51], s69 offen offset:0 sc1 lds
s_waitcnt lgkmcnt(8)
MV 148,a,140,a,96
ds_read_b128 a[176:179], v245 offset:40960
MV 152,a,140,a,100
ds_read_b128 a[180:183], v245 offset:41984
s_waitcnt lgkmcnt(9)
MV 156,a,144,a,96
MV 160,a,144,a,100
ds_read_b128 a[184:187], v245 offset:43008
buffer_load_dwordx4 v238, s[48:51], s69 offen offset:1024 sc1 lds
s_waitcnt lgkmcnt(9)
MV 164,a,148,a,96
ds_read_b128 a[188:191], v245 offset:44032
MV 168,a,148,a,100
s_waitcnt lgkmcnt(9)
MV 172,a,152,a,96
MV 176,a,152,a,100
s_waitcnt lgkmcnt(8)
MV 180,a,156,a,96
buffer_load_dwordx4 a[96:99], v236, s[44:47], s68 offen offset:0 sc1
MV 184,a,156,a,100
buffer_load_dwordx4 a[100:103], v237, s[44:47], s68 offen offset:0 sc1
s_waitcnt vmcnt(42) lgkmcnt(0)
s_barrier
MV 124,a,160,a,104
ds_read_b128 a[128:131], v242 offset:0
MV 128,a,160,a,108
ds_read_b128 a[132:135], v242 offset:1024
buffer_load_dwordx4 v238, s[48:51], s69 offen offset:2048 sc1 lds
MV 132,a,164,a,104
MV 136,a,164,a,108
ds_read_b128 a[136:139], v242 offset:2048
MV 140,a,168,a,104
ds_read_b128 a[140:143], v242 offset:3072
MV 144,a,168,a,108
buffer_load_dwordx4 v238, s[48:51], s69 offen offset:3072 sc1 lds
MV 148,a,172,a,104
ds_read_b128 a[144:147], v243 offset:0
MV 152,a,172,a,108
ds_read_b128 a[148:151], v243 offset:1024
MV 156,a,176,a,104
MV 160,a,176,a,108
ds_read_b128 a[152:155], v243 offset:2048
s_add_u32 s69, s69, 16384
MV 164,a,180,a,104
ds_read_b128 a[156:159], v243 offset:3072
MV 168,a,180,a,108
MV 172,a,184,a,104
MV 176,a,184,a,108
MV 180,a,188,a,104
buffer_load_dwordx4 a[104:107], v236, s[44:47], s68 offen offset:1024 sc1
MV 184,a,188,a,108
buffer_load_dwordx4 a[108:111], v237, s[44:47], s68 offen offset:1024 sc1
s_add_u32 s68, s68, 2048
s_waitcnt lgkmcnt(7)
MV 124,a,128,a,0
ds_read_b128 a[160:163], v242 offset:8192
MV 128,a,128,a,4
ds_read_b128 a[164:167], v242 offset:9216
s_add_u32 m0, s70, 32768
s_waitcnt lgkmcnt(8)
MV 132,a,132,a,0
MV 136,a,132,a,4
ds_read_b128 a[168:171], v242 offset:10240
s_waitcnt lgkmcnt(8)
MV 140,a,136,a,0
ds_read_b128 a[172:175], v242 offset:11264
MV 144,a,136,a,4
buffer_load_dwordx4 v238, s[48:51], s69 offen offset:0 sc1 lds
s_waitcnt lgkmcnt(8)
MV 148,a,140,a,0
ds_read_b128 a[176:179], v243 offset:8192
MV 152,a,140,a,4
ds_read_b128 a[180:183], v243 offset:9216
s_waitcnt lgkmcnt(9)
MV 156,a,144,a,0
MV 160,a,144,a,4
ds_read_b128 a[184:187], v243 offset:10240
buffer_load_dwordx4 v238, s[48:51], s69 offen offset:1024 sc1 lds
s_waitcnt lgkmcnt(9)
MV 164,a,148,a,0
ds_read_b128 a[188:191], v243 offset:11264
MV 168,a,148,a,4
s_waitcnt lgkmcnt(9)
MV 172,a,152,a,0
MV 176,a,152,a,4
s_waitcnt lgkmcnt(8)
MV 180,a,156,a,0
buffer_load_dwordx4 a[0:3], v236, s[44:47], s68 offen offset:0 sc1
MV 184,a,156,a,4
buffer_load_dwordx4 a[4:7], v237, s[44:47], s68 offen offset:0 sc1
s_waitcnt vmcnt(42) lgkmcnt(0)
s_barrier
MV 124,a,160,a,8
ds_read_b128 a[128:131], v242 offset:16384
MV 128,a,160,a,12
ds_read_b128 a[132:135], v242 offset:17408
buffer_load_dwordx4 v238, s[48:51], s69 offen offset:2048 sc1 lds
MV 132,a,164,a,8
MV 136,a,164,a,12
ds_read_b128 a[136:139], v242 offset:18432
MV 140,a,168,a,8
ds_read_b128 a[140:143], v242 offset:19456
MV 144,a,168,a,12
buffer_load_dwordx4 v238, s[48:51], s69 offen offset:3072 sc1 lds
MV 148,a,172,a,8
ds_read_b128 a[144:147], v243 offset:16384
MV 152,a,172,a,12
ds_read_b128 a[148:151], v243 offset:17408
MV 156,a,176,a,8
MV 160,a,176,a,12
ds_read_b128 a[152:155], v243 offset:18432
s_add_u32 s69, s69, 16384
MV 164,a,180,a,8
ds_read_b128 a[156:159], v243 offset:19456
MV 168,a,180,a,12
MV 172,a,184,a,8
MV 176,a,184,a,12
MV 180,a,188,a,8
buffer_load_dwordx4 a[8:11], v236, s[44:47], s68 offen offset:1024 sc1
MV 184,a,188,a,12
buffer_load_dwordx4 a[12:15], v237, s[44:47], s68 offen offset:1024 sc1
s_add_u32 s68, s68, 2048
s_waitcnt lgkmcnt(7)
MV 124,a,128,a,16
ds_read_b128 a[160:163], v242 offset:24576
MV 128,a,128,a,20
ds_read_b128 a[164:167], v242 offset:25600
s_add_u32 m0, s70, 66560
s_waitcnt lgkmcnt(8)
MV 132,a,132,a,16
MV 136,a,132,a,20
ds_read_b128 a[168:171], v242 offset:26624
s_waitcnt lgkmcnt(8)
MV 140,a,136,a,16
ds_read_b128 a[172:175], v242 offset:27648
MV 144,a,136,a,20
buffer_load_dwordx4 v238, s[48:51], s69 offen offset:0 sc1 lds
s_waitcnt lgkmcnt(8)
MV 148,a,140,a,16
ds_read_b128 a[176:179], v243 offset:24576
MV 152,a,140,a,20
ds_read_b128 a[180:183], v243 offset:25600
s_waitcnt lgkmcnt(9)
MV 156,a,144,a,16
MV 160,a,144,a,20
ds_read_b128 a[184:187], v243 offset:26624
buffer_load_dwordx4 v238, s[48:51], s69 offen offset:1024 sc1 lds
s_waitcnt lgkmcnt(9)
MV 164,a,148,a,16
ds_read_b128 a[188:191], v243 offset:27648
MV 168,a,148,a,20
s_waitcnt lgkmcnt(9)
MV 172,a,152,a,16
MV 176,a,152,a,20
s_waitcnt lgkmcnt(8)
MV 180,a,156,a,16
buffer_load_dwordx4 a[16:19], v236, s[44:47], s68 offen offset:0 sc1
MV 184,a,156,a,20
buffer_load_dwordx4 a[20:23], v237, s[44:47], s68 offen offset:0 sc1
s_waitcnt vmcnt(39) lgkmcnt(0)
s_barrier
MV 124,a,160,a,24
ds_read_b128 a[128:131], v242 offset:32768
MV 128,a,160,a,28
ds_read_b128 a[132:135], v242 offset:33792
buffer_load_dwordx4 v238, s[48:51], s69 offen offset:2048 sc1 lds
MV 132,a,164,a,24
MV 136,a,164,a,28
ds_read_b128 a[136:139], v242 offset:34816
MV 140,a,168,a,24
ds_read_b128 a[140:143], v242 offset:35840
MV 144,a,168,a,28
buffer_load_dwordx4 v238, s[48:51], s69 offen offset:3072 sc1 lds
MV 148,a,172,a,24
ds_read_b128 a[144:147], v243 offset:32768
MV 152,a,172,a,28
ds_read_b128 a[148:151], v243 offset:33792
MV 156,a,176,a,24
MV 160,a,176,a,28
ds_read_b128 a[152:155], v243 offset:34816
s_add_u32 s69, s69, 16384
MV 164,a,180,a,24
ds_read_b128 a[156:159], v243 offset:35840
MV 168,a,180,a,28
MV 172,a,184,a,24
MV 176,a,184,a,28
MV 180,a,188,a,24
buffer_load_dwordx4 a[24:27], v236, s[44:47], s68 offen offset:1024 sc1
MV 184,a,188,a,28
buffer_load_dwordx4 a[28:31], v237, s[44:47], s68 offen offset:1024 sc1
s_add_u32 s68, s68, 2048
s_waitcnt lgkmcnt(7)
MV 124,a,128,a,32
ds_read_b128 a[160:163], v242 offset:40960
MV 128,a,128,a,36
ds_read_b128 a[164:167], v242 offset:41984
s_add_u32 m0, s70, 82944
s_waitcnt lgkmcnt(8)
MV 132,a,132,a,32
MV 136,a,132,a,36
ds_read_b128 a[168:171], v242 offset:43008
s_waitcnt lgkmcnt(8)
MV 140,a,136,a,32
ds_read_b128 a[172:175], v242 offset:44032
MV 144,a,136,a,36
buffer_load_dwordx4 v238, s[48:51], s69 offen offset:0 sc1 lds
s_waitcnt lgkmcnt(8)
MV 148,a,140,a,32
ds_read_b128 a[176:179], v243 offset:40960
MV 152,a,140,a,36
ds_read_b128 a[180:183], v243 offset:41984
s_waitcnt lgkmcnt(9)
MV 156,a,144,a,32
MV 160,a,144,a,36
ds_read_b128 a[184:187], v243 offset:43008
buffer_load_dwordx4 v238, s[48:51], s69 offen offset:1024 sc1 lds
s_waitcnt lgkmcnt(9)
MV 164,a,148,a,32
ds_read_b128 a[188:191], v243 offset:44032
MV 168,a,148,a,36
s_waitcnt lgkmcnt(9)
MV 172,a,152,a,32
MV 176,a,152,a,36
s_waitcnt lgkmcnt(8)
MV 180,a,156,a,32
buffer_load_dwordx4 a[32:35], v236, s[44:47], s68 offen offset:0 sc1
MV 184,a,156,a,36
buffer_load_dwordx4 a[36:39], v237, s[44:47], s68 offen offset:0 sc1
s_waitcnt vmcnt(38) lgkmcnt(0)
s_barrier
MV 124,a,160,a,40
ds_read_b128 a[128:131], v242 offset:49152
MV 128,a,160,a,44
ds_read_b128 a[132:135], v242 offset:50176
buffer_load_dwordx4 v238, s[48:51], s69 offen offset:2048 sc1 lds
MV 132,a,164,a,40
MV 136,a,164,a,44
ds_read_b128 a[136:139], v242 offset:51200
MV 140,a,168,a,40
ds_read_b128 a[140:143], v242 offset:52224
MV 144,a,168,a,44
buffer_load_dwordx4 v238, s[48:51], s69 offen offset:3072 sc1 lds
MV 148,a,172,a,40
ds_read_b128 a[144:147], v243 offset:49152
MV 152,a,172,a,44
ds_read_b128 a[148:151], v243 offset:50176
MV 156,a,176,a,40
MV 160,a,176,a,44
ds_read_b128 a[152:155], v243 offset:51200
s_add_u32 s69, s69, 16384
MV 164,a,180,a,40
ds_read_b128 a[156:159], v243 offset:52224
MV 168,a,180,a,44
MV 172,a,184,a,40
MV 176,a,184,a,44
MV 180,a,188,a,40
buffer_load_dwordx4 a[40:43], v236, s[44:47], s68 offen offset:1024 sc1
MV 184,a,188,a,44
buffer_load_dwordx4 a[44:47], v237, s[44:47], s68 offen offset:1024 sc1
s_add_u32 s68, s68, 2048
s_waitcnt lgkmcnt(7)
MV 124,a,128,a,48
ds_read_b128 a[160:163], v242 offset:57344
MV 128,a,128,a,52
ds_read_b128 a[164:167], v242 offset:58368
s_add_u32 m0, s70, 99328
s_waitcnt lgkmcnt(8)
MV 132,a,132,a,48
MV 136,a,132,a,52
ds_read_b128 a[168:171], v242 offset:59392
s_waitcnt lgkmcnt(8)
MV 140,a,136,a,48
ds_read_b128 a[172:175], v242 offset:60416
MV 144,a,136,a,52
buffer_load_dwordx4 v238, s[48:51], s69 offen offset:0 sc1 lds
s_waitcnt lgkmcnt(8)
MV 148,a,140,a,48
ds_read_b128 a[176:179], v243 offset:57344
MV 152,a,140,a,52
ds_read_b128 a[180:183], v243 offset:58368
s_waitcnt lgkmcnt(9)
MV 156,a,144,a,48
MV 160,a,144,a,52
ds_read_b128 a[184:187], v243 offset:59392
buffer_load_dwordx4 v238, s[48:51], s69 offen offset:1024 sc1 lds
s_waitcnt lgkmcnt(9)
MV 164,a,148,a,48
ds_read_b128 a[188:191], v243 offset:60416
MV 168,a,148,a,52
s_waitcnt lgkmcnt(9)
MV 172,a,152,a,48
MV 176,a,152,a,52
s_waitcnt lgkmcnt(8)
MV 180,a,156,a,48
buffer_load_dwordx4 a[48:51], v236, s[44:47], s68 offen offset:0 sc1
MV 184,a,156,a,52
buffer_load_dwordx4 a[52:55], v237, s[44:47], s68 offen offset:0 sc1
s_waitcnt vmcnt(38) lgkmcnt(0)
s_barrier
v_mov_b32 v253, 1
s_lshl_b32 s36, s2, 2
buffer_store_dword v253, v255, s[8:11], s36 offen offset:3072 sc1
MV 124,a,160,a,56
ds_read_b128 a[128:131], v244 offset:0
MV 128,a,160,a,60
ds_read_b128 a[132:135], v244 offset:1024
buffer_load_dwordx4 v238, s[48:51], s69 offen offset:2048 sc1 lds
MV 132,a,164,a,56
MV 136,a,164,a,60
ds_read_b128 a[136:139], v244 offset:2048
MV 140,a,168,a,56
ds_read_b128 a[140:143], v244 offset:3072
MV 144,a,168,a,60
buffer_load_dwordx4 v238, s[48:51], s69 offen offset:3072 sc1 lds
MV 148,a,172,a,56
ds_read_b128 a[144:147], v245 offset:0
MV 152,a,172,a,60
ds_read_b128 a[148:151], v245 offset:1024
MV 156,a,176,a,56
MV 160,a,176,a,60
ds_read_b128 a[152:155], v245 offset:2048
s_add_u32 s69, s69, 16384
MV 164,a,180,a,56
ds_read_b128 a[156:159], v245 offset:3072
MV 168,a,180,a,60
MV 172,a,184,a,56
MV 176,a,184,a,60
MV 180,a,188,a,56
buffer_load_dwordx4 a[56:59], v236, s[44:47], s68 offen offset:1024 sc1
MV 184,a,188,a,60
buffer_load_dwordx4 a[60:63], v237, s[44:47], s68 offen offset:1024 sc1
s_add_u32 s68, s68, 2048
s_waitcnt lgkmcnt(7)
MV 124,a,128,a,64
ds_read_b128 a[160:163], v244 offset:8192
MV 128,a,128,a,68
ds_read_b128 a[164:167], v244 offset:9216
s_add_u32 m0, s70, 115712
s_waitcnt lgkmcnt(8)
MV 132,a,132,a,64
MV 136,a,132,a,68
ds_read_b128 a[168:171], v244 offset:10240
s_waitcnt lgkmcnt(8)
MV 140,a,136,a,64
ds_read_b128 a[172:175], v244 offset:11264
MV 144,a,136,a,68
buffer_load_dwordx4 v238, s[48:51], s69 offen offset:0 sc1 lds
s_waitcnt lgkmcnt(8)
MV 148,a,140,a,64
ds_read_b128 a[176:179], v245 offset:8192
MV 152,a,140,a,68
ds_read_b128 a[180:183], v245 offset:9216
s_waitcnt lgkmcnt(9)
MV 156,a,144,a,64
MV 160,a,144,a,68
ds_read_b128 a[184:187], v245 offset:10240
buffer_load_dwordx4 v238, s[48:51], s69 offen offset:1024 sc1 lds
s_waitcnt lgkmcnt(9)
MV 164,a,148,a,64
ds_read_b128 a[188:191], v245 offset:11264
MV 168,a,148,a,68
s_waitcnt lgkmcnt(9)
MV 172,a,152,a,64
MV 176,a,152,a,68
s_waitcnt lgkmcnt(8)
MV 180,a,156,a,64
buffer_load_dwordx4 a[64:67], v236, s[44:47], s68 offen offset:0 sc1
MV 184,a,156,a,68
buffer_load_dwordx4 a[68:71], v237, s[44:47], s68 offen offset:0 sc1
s_waitcnt vmcnt(39) lgkmcnt(0)
s_barrier
MV 124,a,160,a,72
ds_read_b128 a[128:131], v244 offset:16384
MV 128,a,160,a,76
ds_read_b128 a[132:135], v244 offset:17408
buffer_load_dwordx4 v238, s[48:51], s69 offen offset:2048 sc1 lds
MV 132,a,164,a,72
MV 136,a,164,a,76
ds_read_b128 a[136:139], v244 offset:18432
MV 140,a,168,a,72
ds_read_b128 a[140:143], v244 offset:19456
MV 144,a,168,a,76
buffer_load_dwordx4 v238, s[48:51], s69 offen offset:3072 sc1 lds
MV 148,a,172,a,72
ds_read_b128 a[144:147], v245 offset:16384
MV 152,a,172,a,76
ds_read_b128 a[148:151], v245 offset:17408
MV 156,a,176,a,72
MV 160,a,176,a,76
ds_read_b128 a[152:155], v245 offset:18432
s_add_u32 s69, s69, 16384
MV 164,a,180,a,72
ds_read_b128 a[156:159], v245 offset:19456
MV 168,a,180,a,76
MV 172,a,184,a,72
MV 176,a,184,a,76
MV 180,a,188,a,72
buffer_load_dwordx4 a[72:75], v236, s[44:47], s68 offen offset:1024 sc1
MV 184,a,188,a,76
buffer_load_dwordx4 a[76:79], v237, s[44:47], s68 offen offset:1024 sc1
s_add_u32 s68, s68, 2048
s_waitcnt lgkmcnt(7)
MV 124,a,128,a,80
ds_read_b128 a[160:163], v244 offset:24576
v_and_b32 v254, 15, v1
MV 128,a,128,a,84
ds_read_b128 a[164:167], v244 offset:25600
s_add_u32 m0, s70, 0
s_waitcnt lgkmcnt(8)
MV 132,a,132,a,80
MV 136,a,132,a,84
ds_read_b128 a[168:171], v244 offset:26624
s_waitcnt lgkmcnt(8)
MV 140,a,136,a,80
ds_read_b128 a[172:175], v244 offset:27648
s_lshl_b32 s36, s82, 4
MV 144,a,136,a,84
buffer_load_dwordx4 v238, s[48:51], s69 offen offset:0 sc1 lds
s_waitcnt lgkmcnt(8)
MV 148,a,140,a,80
ds_read_b128 a[176:179], v245 offset:24576
MV 152,a,140,a,84
ds_read_b128 a[180:183], v245 offset:25600
s_waitcnt lgkmcnt(9)
MV 156,a,144,a,80
v_add_u32 v254, s36, v254
MV 160,a,144,a,84
ds_read_b128 a[184:187], v245 offset:26624
buffer_load_dwordx4 v238, s[48:51], s69 offen offset:1024 sc1 lds
s_waitcnt lgkmcnt(9)
MV 164,a,148,a,80
ds_read_b128 a[188:191], v245 offset:27648
MV 168,a,148,a,84
s_waitcnt lgkmcnt(9)
MV 172,a,152,a,80
v_lshlrev_b32 v254, 2, v254
MV 176,a,152,a,84
s_waitcnt lgkmcnt(8)
MV 180,a,156,a,80
buffer_load_dwordx4 a[80:83], v236, s[44:47], s68 offen offset:0 sc1
MV 184,a,156,a,84
buffer_load_dwordx4 a[84:87], v237, s[44:47], s68 offen offset:0 sc1
s_waitcnt vmcnt(39) lgkmcnt(0)
s_barrier
MV 124,a,160,a,88
ds_read_b128 a[128:131], v244 offset:32768
buffer_load_dword v253, v254, s[8:11], 0 offen offset:3072 sc1
MV 128,a,160,a,92
ds_read_b128 a[132:135], v244 offset:33792
buffer_load_dwordx4 v238, s[48:51], s69 offen offset:2048 sc1 lds
MV 132,a,164,a,88
MV 136,a,164,a,92
ds_read_b128 a[136:139], v244 offset:34816
MV 140,a,168,a,88
ds_read_b128 a[140:143], v244 offset:35840
MV 144,a,168,a,92
buffer_load_dwordx4 v238, s[48:51], s69 offen offset:3072 sc1 lds
MV 148,a,172,a,88
ds_read_b128 a[144:147], v245 offset:32768
MV 152,a,172,a,92
ds_read_b128 a[148:151], v245 offset:33792
MV 156,a,176,a,88
MV 160,a,176,a,92
ds_read_b128 a[152:155], v245 offset:34816
s_add_u32 s69, s69, 16384
MV 164,a,180,a,88
ds_read_b128 a[156:159], v245 offset:35840
MV 168,a,180,a,92
MV 172,a,184,a,88
MV 176,a,184,a,92
MV 180,a,188,a,88
buffer_load_dwordx4 a[88:91], v236, s[44:47], s68 offen offset:1024 sc1
MV 184,a,188,a,92
buffer_load_dwordx4 a[92:95], v237, s[44:47], s68 offen offset:1024 sc1
s_add_u32 s68, s68, 2048
s_waitcnt lgkmcnt(7)
MV 124,a,128,a,96
ds_read_b128 a[160:163], v244 offset:40960
MV 128,a,128,a,100
ds_read_b128 a[164:167], v244 offset:41984
s_add_u32 m0, s70, 16384
s_waitcnt lgkmcnt(8)
MV 132,a,132,a,96
MV 136,a,132,a,100
ds_read_b128 a[168:171], v244 offset:43008
s_waitcnt lgkmcnt(8)
MV 140,a,136,a,96
ds_read_b128 a[172:175], v244 offset:44032
MV 144,a,136,a,100
buffer_load_dwordx4 v238, s[48:51], s69 offen offset:0 sc1 lds
s_waitcnt lgkmcnt(8)
MV 148,a,140,a,96
ds_read_b128 a[176:179], v245 offset:40960
MV 152,a,140,a,100
ds_read_b128 a[180:183], v245 offset:41984
s_waitcnt lgkmcnt(9)
MV 156,a,144,a,96
MV 160,a,144,a,100
ds_read_b128 a[184:187], v245 offset:43008
buffer_load_dwordx4 v238, s[48:51], s69 offen offset:1024 sc1 lds
s_waitcnt lgkmcnt(9)
MV 164,a,148,a,96
ds_read_b128 a[188:191], v245 offset:44032
MV 168,a,148,a,100
s_waitcnt lgkmcnt(9)
MV 172,a,152,a,96
MV 176,a,152,a,100
s_waitcnt lgkmcnt(8)
MV 180,a,156,a,96
buffer_load_dwordx4 a[96:99], v236, s[44:47], s68 offen offset:0 sc1
MV 184,a,156,a,100
buffer_load_dwordx4 a[100:103], v237, s[44:47], s68 offen offset:0 sc1
s_waitcnt vmcnt(40) lgkmcnt(0)
s_barrier
MV 124,a,160,a,104
ds_read_b128 a[128:131], v242 offset:0
MV 128,a,160,a,108
ds_read_b128 a[132:135], v242 offset:1024
buffer_load_dwordx4 v238, s[48:51], s69 offen offset:2048 sc1 lds
MV 132,a,164,a,104
MV 136,a,164,a,108
ds_read_b128 a[136:139], v242 offset:2048
MV 140,a,168,a,104
ds_read_b128 a[140:143], v242 offset:3072
MV 144,a,168,a,108
buffer_load_dwordx4 v238, s[48:51], s69 offen offset:3072 sc1 lds
MV 148,a,172,a,104
ds_read_b128 a[144:147], v243 offset:0
MV 152,a,172,a,108
ds_read_b128 a[148:151], v243 offset:1024
MV 156,a,176,a,104
MV 160,a,176,a,108
ds_read_b128 a[152:155], v243 offset:2048
s_add_u32 s69, s69, 16384
MV 164,a,180,a,104
ds_read_b128 a[156:159], v243 offset:3072
MV 168,a,180,a,108
MV 172,a,184,a,104
MV 176,a,184,a,108
MV 180,a,188,a,104
buffer_load_dwordx4 a[104:107], v236, s[44:47], s68 offen offset:1024 sc1
MV 184,a,188,a,108
buffer_load_dwordx4 a[108:111], v237, s[44:47], s68 offen offset:1024 sc1
s_add_u32 s68, s68, 2048
s_waitcnt lgkmcnt(7)
MV 124,a,128,a,0
ds_read_b128 a[160:163], v242 offset:8192
MV 128,a,128,a,4
ds_read_b128 a[164:167], v242 offset:9216
s_add_u32 m0, s70, 32768
s_waitcnt lgkmcnt(8)
MV 132,a,132,a,0
MV 136,a,132,a,4
ds_read_b128 a[168:171], v242 offset:10240
s_waitcnt lgkmcnt(8)
MV 140,a,136,a,0
ds_read_b128 a[172:175], v242 offset:11264
MV 144,a,136,a,4
buffer_load_dwordx4 v238, s[48:51], s69 offen offset:0 sc1 lds
s_waitcnt lgkmcnt(8)
MV 148,a,140,a,0
ds_read_b128 a[176:179], v243 offset:8192
MV 152,a,140,a,4
ds_read_b128 a[180:183], v243 offset:9216
s_waitcnt lgkmcnt(9)
MV 156,a,144,a,0
MV 160,a,144,a,4
ds_read_b128 a[184:187], v243 offset:10240
buffer_load_dwordx4 v238, s[48:51], s69 offen offset:1024 sc1 lds
s_waitcnt lgkmcnt(9)
MV 164,a,148,a,0
ds_read_b128 a[188:191], v243 offset:11264
MV 168,a,148,a,4
s_waitcnt lgkmcnt(9)
MV 172,a,152,a,0
MV 176,a,152,a,4
s_waitcnt lgkmcnt(8)
MV 180,a,156,a,0
buffer_load_dwordx4 a[0:3], v236, s[44:47], s68 offen offset:0 sc1
MV 184,a,156,a,4
buffer_load_dwordx4 a[4:7], v237, s[44:47], s68 offen offset:0 sc1
s_waitcnt vmcnt(40) lgkmcnt(0)
s_barrier
MV 124,a,160,a,8
ds_read_b128 a[128:131], v242 offset:16384
MV 128,a,160,a,12
ds_read_b128 a[132:135], v242 offset:17408
buffer_load_dwordx4 v238, s[48:51], s69 offen offset:2048 sc1 lds
MV 132,a,164,a,8
MV 136,a,164,a,12
ds_read_b128 a[136:139], v242 offset:18432
MV 140,a,168,a,8
ds_read_b128 a[140:143], v242 offset:19456
MV 144,a,168,a,12
buffer_load_dwordx4 v238, s[48:51], s69 offen offset:3072 sc1 lds
MV 148,a,172,a,8
ds_read_b128 a[144:147], v243 offset:16384
MV 152,a,172,a,12
ds_read_b128 a[148:151], v243 offset:17408
MV 156,a,176,a,8
MV 160,a,176,a,12
ds_read_b128 a[152:155], v243 offset:18432
s_add_u32 s69, s69, 16384
MV 164,a,180,a,8
ds_read_b128 a[156:159], v243 offset:19456
MV 168,a,180,a,12
MV 172,a,184,a,8
MV 176,a,184,a,12
MV 180,a,188,a,8
buffer_load_dwordx4 a[8:11], v236, s[44:47], s68 offen offset:1024 sc1
MV 184,a,188,a,12
buffer_load_dwordx4 a[12:15], v237, s[44:47], s68 offen offset:1024 sc1
s_add_u32 s68, s68, 2048
s_waitcnt lgkmcnt(7)
MV 124,a,128,a,16
ds_read_b128 a[160:163], v242 offset:24576
MV 128,a,128,a,20
ds_read_b128 a[164:167], v242 offset:25600
s_add_u32 m0, s70, 66560
s_waitcnt lgkmcnt(8)
MV 132,a,132,a,16
MV 136,a,132,a,20
ds_read_b128 a[168:171], v242 offset:26624
s_waitcnt lgkmcnt(8)
MV 140,a,136,a,16
ds_read_b128 a[172:175], v242 offset:27648
MV 144,a,136,a,20
buffer_load_dwordx4 v238, s[48:51], s69 offen offset:0 sc1 lds
s_waitcnt lgkmcnt(8)
MV 148,a,140,a,16
ds_read_b128 a[176:179], v243 offset:24576
MV 152,a,140,a,20
ds_read_b128 a[180:183], v243 offset:25600
s_waitcnt lgkmcnt(9)
MV 156,a,144,a,16
MV 160,a,144,a,20
ds_read_b128 a[184:187], v243 offset:26624
buffer_load_dwordx4 v238, s[48:51], s69 offen offset:1024 sc1 lds
s_waitcnt lgkmcnt(9)
MV 164,a,148,a,16
ds_read_b128 a[188:191], v243 offset:27648
MV 168,a,148,a,20
s_waitcnt lgkmcnt(9)
MV 172,a,152,a,16
MV 176,a,152,a,20
s_waitcnt lgkmcnt(8)
MV 180,a,156,a,16
buffer_load_dwordx4 a[16:19], v236, s[44:47], s68 offen offset:0 sc1
MV 184,a,156,a,20
buffer_load_dwordx4 a[20:23], v237, s[44:47], s68 offen offset:0 sc1
s_waitcnt vmcnt(39) lgkmcnt(0)
s_barrier
MV 124,a,160,a,24
ds_read_b128 a[128:131], v242 offset:32768
MV 128,a,160,a,28
ds_read_b128 a[132:135], v242 offset:33792
buffer_load_dwordx4 v238, s[48:51], s69 offen offset:2048 sc1 lds
MV 132,a,164,a,24
MV 136,a,164,a,28
ds_read_b128 a[136:139], v242 offset:34816
MV 140,a,168,a,24
ds_read_b128 a[140:143], v242 offset:35840
MV 144,a,168,a,28
buffer_load_dwordx4 v238, s[48:51], s69 offen offset:3072 sc1 lds
MV 148,a,172,a,24
ds_read_b128 a[144:147], v243 offset:32768
MV 152,a,172,a,28
ds_read_b128 a[148:151], v243 offset:33792
MV 156,a,176,a,24
MV 160,a,176,a,28
ds_read_b128 a[152:155], v243 offset:34816
s_add_u32 s69, s69, 16384
MV 164,a,180,a,24
ds_read_b128 a[156:159], v243 offset:35840
MV 168,a,180,a,28
MV 172,a,184,a,24
MV 176,a,184,a,28
MV 180,a,188,a,24
buffer_load_dwordx4 a[24:27], v236, s[44:47], s68 offen offset:1024 sc1
MV 184,a,188,a,28
buffer_load_dwordx4 a[28:31], v237, s[44:47], s68 offen offset:1024 sc1
s_add_u32 s68, s68, 2048
s_waitcnt lgkmcnt(7)
MV 124,a,128,a,32
ds_read_b128 a[160:163], v242 offset:40960
MV 128,a,128,a,36
ds_read_b128 a[164:167], v242 offset:41984
s_add_u32 m0, s70, 82944
s_waitcnt lgkmcnt(8)
MV 132,a,132,a,32
MV 136,a,132,a,36
ds_read_b128 a[168:171], v242 offset:43008
s_waitcnt lgkmcnt(8)
MV 140,a,136,a,32
ds_read_b128 a[172:175], v242 offset:44032
MV 144,a,136,a,36
buffer_load_dwordx4 v238, s[48:51], s69 offen offset:0 sc1 lds
s_waitcnt lgkmcnt(8)
MV 148,a,140,a,32
ds_read_b128 a[176:179], v243 offset:40960
MV 152,a,140,a,36
ds_read_b128 a[180:183], v243 offset:41984
s_waitcnt lgkmcnt(9)
MV 156,a,144,a,32
MV 160,a,144,a,36
ds_read_b128 a[184:187], v243 offset:43008
buffer_load_dwordx4 v238, s[48:51], s69 offen offset:1024 sc1 lds
s_waitcnt lgkmcnt(9)
MV 164,a,148,a,32
ds_read_b128 a[188:191], v243 offset:44032
MV 168,a,148,a,36
s_waitcnt lgkmcnt(9)
MV 172,a,152,a,32
MV 176,a,152,a,36
s_waitcnt lgkmcnt(8)
MV 180,a,156,a,32
buffer_load_dwordx4 a[32:35], v236, s[44:47], s68 offen offset:0 sc1
MV 184,a,156,a,36
buffer_load_dwordx4 a[36:39], v237, s[44:47], s68 offen offset:0 sc1
s_waitcnt vmcnt(39) lgkmcnt(0)
s_barrier
MV 124,a,160,a,40
ds_read_b128 a[128:131], v242 offset:49152
MV 128,a,160,a,44
ds_read_b128 a[132:135], v242 offset:50176
buffer_load_dwordx4 v238, s[48:51], s69 offen offset:2048 sc1 lds
MV 132,a,164,a,40
MV 136,a,164,a,44
ds_read_b128 a[136:139], v242 offset:51200
MV 140,a,168,a,40
ds_read_b128 a[140:143], v242 offset:52224
MV 144,a,168,a,44
buffer_load_dwordx4 v238, s[48:51], s69 offen offset:3072 sc1 lds
MV 148,a,172,a,40
ds_read_b128 a[144:147], v243 offset:49152
MV 152,a,172,a,44
ds_read_b128 a[148:151], v243 offset:50176
MV 156,a,176,a,40
MV 160,a,176,a,44
ds_read_b128 a[152:155], v243 offset:51200
s_add_u32 s69, s69, 16384
MV 164,a,180,a,40
ds_read_b128 a[156:159], v243 offset:52224
MV 168,a,180,a,44
MV 172,a,184,a,40
MV 176,a,184,a,44
MV 180,a,188,a,40
buffer_load_dwordx4 a[40:43], v236, s[44:47], s68 offen offset:1024 sc1
MV 184,a,188,a,44
buffer_load_dwordx4 a[44:47], v237, s[44:47], s68 offen offset:1024 sc1
s_add_u32 s68, s68, 2048
s_waitcnt lgkmcnt(7)
MV 124,a,128,a,48
ds_read_b128 a[160:163], v242 offset:57344
MV 128,a,128,a,52
ds_read_b128 a[164:167], v242 offset:58368
s_add_u32 m0, s70, 99328
s_waitcnt lgkmcnt(8)
MV 132,a,132,a,48
MV 136,a,132,a,52
ds_read_b128 a[168:171], v242 offset:59392
s_waitcnt lgkmcnt(8)
MV 140,a,136,a,48
ds_read_b128 a[172:175], v242 offset:60416
MV 144,a,136,a,52
buffer_load_dwordx4 v238, s[48:51], s69 offen offset:0 sc1 lds
s_waitcnt lgkmcnt(8)
MV 148,a,140,a,48
ds_read_b128 a[176:179], v243 offset:57344
MV 152,a,140,a,52
ds_read_b128 a[180:183], v243 offset:58368
s_waitcnt lgkmcnt(9)
MV 156,a,144,a,48
MV 160,a,144,a,52
ds_read_b128 a[184:187], v243 offset:59392
buffer_load_dwordx4 v238, s[48:51], s69 offen offset:1024 sc1 lds
s_waitcnt lgkmcnt(9)
MV 164,a,148,a,48
ds_read_b128 a[188:191], v243 offset:60416
MV 168,a,148,a,52
s_waitcnt lgkmcnt(9)
MV 172,a,152,a,48
MV 176,a,152,a,52
s_waitcnt lgkmcnt(8)
MV 180,a,156,a,48
buffer_load_dwordx4 a[48:51], v236, s[44:47], s68 offen offset:0 sc1
MV 184,a,156,a,52
buffer_load_dwordx4 a[52:55], v237, s[44:47], s68 offen offset:0 sc1
s_waitcnt vmcnt(38) lgkmcnt(0)
s_barrier
MV 124,a,160,a,56
ds_read_b128 a[128:131], v244 offset:0
MV 128,a,160,a,60
ds_read_b128 a[132:135], v244 offset:1024
buffer_load_dwordx4 v238, s[48:51], s69 offen offset:2048 sc1 lds
MV 132,a,164,a,56
MV 136,a,164,a,60
ds_read_b128 a[136:139], v244 offset:2048
MV 140,a,168,a,56
ds_read_b128 a[140:143], v244 offset:3072
MV 144,a,168,a,60
buffer_load_dwordx4 v238, s[48:51], s69 offen offset:3072 sc1 lds
MV 148,a,172,a,56
ds_read_b128 a[144:147], v245 offset:0
MV 152,a,172,a,60
ds_read_b128 a[148:151], v245 offset:1024
MV 156,a,176,a,56
MV 160,a,176,a,60
ds_read_b128 a[152:155], v245 offset:2048
s_add_u32 s69, s69, 16384
MV 164,a,180,a,56
ds_read_b128 a[156:159], v245 offset:3072
MV 168,a,180,a,60
MV 172,a,184,a,56
MV 176,a,184,a,60
MV 180,a,188,a,56
buffer_load_dwordx4 a[56:59], v236, s[44:47], s68 offen offset:1024 sc1
MV 184,a,188,a,60
buffer_load_dwordx4 a[60:63], v237, s[44:47], s68 offen offset:1024 sc1
s_add_u32 s68, s68, 2048
s_waitcnt lgkmcnt(7)
MV 124,a,128,a,64
ds_read_b128 a[160:163], v244 offset:8192
MV 128,a,128,a,68
ds_read_b128 a[164:167], v244 offset:9216
s_add_u32 m0, s70, 115712
s_waitcnt lgkmcnt(8)
MV 132,a,132,a,64
MV 136,a,132,a,68
ds_read_b128 a[168:171], v244 offset:10240
s_waitcnt lgkmcnt(8)
MV 140,a,136,a,64
ds_read_b128 a[172:175], v244 offset:11264
MV 144,a,136,a,68
buffer_load_dwordx4 v238, s[48:51], s69 offen offset:0 sc1 lds
s_waitcnt lgkmcnt(8)
MV 148,a,140,a,64
ds_read_b128 a[176:179], v245 offset:8192
MV 152,a,140,a,68
ds_read_b128 a[180:183], v245 offset:9216
s_waitcnt lgkmcnt(9)
MV 156,a,144,a,64
MV 160,a,144,a,68
ds_read_b128 a[184:187], v245 offset:10240
buffer_load_dwordx4 v238, s[48:51], s69 offen offset:1024 sc1 lds
s_waitcnt lgkmcnt(9)
MV 164,a,148,a,64
ds_read_b128 a[188:191], v245 offset:11264
MV 168,a,148,a,68
s_waitcnt lgkmcnt(9)
MV 172,a,152,a,64
MV 176,a,152,a,68
s_waitcnt lgkmcnt(8)
MV 180,a,156,a,64
buffer_load_dwordx4 a[64:67], v236, s[44:47], s68 offen offset:0 sc1
MV 184,a,156,a,68
buffer_load_dwordx4 a[68:71], v237, s[44:47], s68 offen offset:0 sc1
s_waitcnt vmcnt(38) lgkmcnt(0)
s_barrier
MV 124,a,160,a,72
ds_read_b128 a[128:131], v244 offset:16384
MV 128,a,160,a,76
ds_read_b128 a[132:135], v244 offset:17408
buffer_load_dwordx4 v238, s[48:51], s69 offen offset:2048 sc1 lds
MV 132,a,164,a,72
MV 136,a,164,a,76
ds_read_b128 a[136:139], v244 offset:18432
MV 140,a,168,a,72
ds_read_b128 a[140:143], v244 offset:19456
MV 144,a,168,a,76
buffer_load_dwordx4 v238, s[48:51], s69 offen offset:3072 sc1 lds
MV 148,a,172,a,72
ds_read_b128 a[144:147], v245 offset:16384
MV 152,a,172,a,76
ds_read_b128 a[148:151], v245 offset:17408
MV 156,a,176,a,72
MV 160,a,176,a,76
ds_read_b128 a[152:155], v245 offset:18432
s_add_u32 s69, s69, 16384
MV 164,a,180,a,72
ds_read_b128 a[156:159], v245 offset:19456
MV 168,a,180,a,76
MV 172,a,184,a,72
MV 176,a,184,a,76
MV 180,a,188,a,72
buffer_load_dwordx4 a[72:75], v236, s[44:47], s68 offen offset:1024 sc1
MV 184,a,188,a,76
buffer_load_dwordx4 a[76:79], v237, s[44:47], s68 offen offset:1024 sc1
s_add_u32 s68, s68, 2048
s_waitcnt lgkmcnt(7)
MV 124,a,128,a,80
ds_read_b128 a[160:163], v244 offset:24576
MV 128,a,128,a,84
ds_read_b128 a[164:167], v244 offset:25600
s_add_u32 m0, s70, 0
s_waitcnt lgkmcnt(8)
MV 132,a,132,a,80
v_cmp_gt_u32 vcc, 1, v253
s_nop 4
s_cbranch_vccnz L_spin_f3
L_spin_f3_ret:
MV 136,a,132,a,84
ds_read_b128 a[168:171], v244 offset:26624
s_waitcnt lgkmcnt(8)
MV 140,a,136,a,80
ds_read_b128 a[172:175], v244 offset:27648
MV 144,a,136,a,84
buffer_load_dwordx4 v238, s[48:51], s69 offen offset:0 sc1 lds
s_waitcnt lgkmcnt(8)
MV 148,a,140,a,80
ds_read_b128 a[176:179], v245 offset:24576
MV 152,a,140,a,84
ds_read_b128 a[180:183], v245 offset:25600
s_waitcnt lgkmcnt(9)
MV 156,a,144,a,80
MV 160,a,144,a,84
ds_read_b128 a[184:187], v245 offset:26624
buffer_load_dwordx4 v238, s[48:51], s69 offen offset:1024 sc1 lds
s_waitcnt lgkmcnt(9)
MV 164,a,148,a,80
ds_read_b128 a[188:191], v245 offset:27648
MV 168,a,148,a,84
s_waitcnt lgkmcnt(9)
MV 172,a,152,a,80
s_add_u32 s72, s79, 0
MV 176,a,152,a,84
s_waitcnt lgkmcnt(8)
MV 180,a,156,a,80
buffer_load_dwordx4 a[80:83], v236, s[44:47], s68 offen offset:0 sc1
buffer_load_dwordx2 v[208:209], v251, s[56:59], s72 offen offset:0 sc1
MV 184,a,156,a,84
buffer_load_dwordx4 a[84:87], v237, s[44:47], s68 offen offset:0 sc1
s_waitcnt vmcnt(39) lgkmcnt(0)
s_barrier
MV 124,a,160,a,88
ds_read_b128 a[128:131], v244 offset:32768
s_add_u32 s72, s79, 16384
MV 128,a,160,a,92
ds_read_b128 a[132:135], v244 offset:33792
buffer_load_dwordx4 v238, s[48:51], s69 offen offset:2048 sc1 lds
MV 132,a,164,a,88
MV 136,a,164,a,92
ds_read_b128 a[136:139], v244 offset:34816
MV 140,a,168,a,88
ds_read_b128 a[140:143], v244 offset:35840
MV 144,a,168,a,92
buffer_load_dwordx4 v238, s[48:51], s69 offen offset:3072 sc1 lds
MV 148,a,172,a,88
ds_read_b128 a[144:147], v245 offset:32768
MV 152,a,172,a,92
ds_read_b128 a[148:151], v245 offset:33792
MV 156,a,176,a,88
buffer_load_dwordx2 v[210:211], v251, s[56:59], s72 offen offset:0 sc1
MV 160,a,176,a,92
ds_read_b128 a[152:155], v245 offset:34816
s_add_u32 s69, s69, 16384
MV 164,a,180,a,88
ds_read_b128 a[156:159], v245 offset:35840
MV 168,a,180,a,92
MV 172,a,184,a,88
MV 176,a,184,a,92
MV 180,a,188,a,88
buffer_load_dwordx4 a[88:91], v236, s[44:47], s68 offen offset:1024 sc1
MV 184,a,188,a,92
buffer_load_dwordx4 a[92:95], v237, s[44:47], s68 offen offset:1024 sc1
s_add_u32 s68, s68, 2048
s_waitcnt lgkmcnt(7)
MV 124,a,128,a,96
ds_read_b128 a[160:163], v244 offset:40960
s_add_u32 s72, s79, 131072
MV 128,a,128,a,100
ds_read_b128 a[164:167], v244 offset:41984
s_add_u32 m0, s70, 16384
s_waitcnt lgkmcnt(8)
MV 132,a,132,a,96
MV 136,a,132,a,100
ds_read_b128 a[168:171], v244 offset:43008
s_waitcnt lgkmcnt(8)
MV 140,a,136,a,96
ds_read_b128 a[172:175], v244 offset:44032
MV 144,a,136,a,100
buffer_load_dwordx4 v238, s[48:51], s69 offen offset:0 sc1 lds
s_waitcnt lgkmcnt(8)
MV 148,a,140,a,96
ds_read_b128 a[176:179], v245 offset:40960
MV 152,a,140,a,100
ds_read_b128 a[180:183], v245 offset:41984
s_waitcnt lgkmcnt(9)
MV 156,a,144,a,96
buffer_load_dwordx2 v[212:213], v251, s[56:59], s72 offen offset:0 sc1
MV 160,a,144,a,100
ds_read_b128 a[184:187], v245 offset:43008
buffer_load_dwordx4 v238, s[48:51], s69 offen offset:1024 sc1 lds
s_waitcnt lgkmcnt(9)
MV 164,a,148,a,96
ds_read_b128 a[188:191], v245 offset:44032
MV 168,a,148,a,100
s_waitcnt lgkmcnt(9)
MV 172,a,152,a,96
MV 176,a,152,a,100
s_waitcnt lgkmcnt(8)
MV 180,a,156,a,96
buffer_load_dwordx4 a[96:99], v236, s[44:47], s68 offen offset:0 sc1
MV 184,a,156,a,100
buffer_load_dwordx4 a[100:103], v237, s[44:47], s68 offen offset:0 sc1
s_waitcnt vmcnt(41) lgkmcnt(0)
s_barrier
MV 124,a,160,a,104
ds_read_b128 a[128:131], v242 offset:0
s_add_u32 s72, s79, 147456
MV 128,a,160,a,108
ds_read_b128 a[132:135], v242 offset:1024
buffer_load_dwordx4 v238, s[48:51], s69 offen offset:2048 sc1 lds
MV 132,a,164,a,104
MV 136,a,164,a,108
ds_read_b128 a[136:139], v242 offset:2048
MV 140,a,168,a,104
ds_read_b128 a[140:143], v242 offset:3072
MV 144,a,168,a,108
buffer_load_dwordx4 v238, s[48:51], s69 offen offset:3072 sc1 lds
MV 148,a,172,a,104
ds_read_b128 a[144:147], v243 offset:0
MV 152,a,172,a,108
ds_read_b128 a[148:151], v243 offset:1024
MV 156,a,176,a,104
buffer_load_dwordx2 v[214:215], v251, s[56:59], s72 offen offset:0 sc1
MV 160,a,176,a,108
ds_read_b128 a[152:155], v243 offset:2048
s_add_u32 s69, s69, 16384
MV 164,a,180,a,104
ds_read_b128 a[156:159], v243 offset:3072
MV 168,a,180,a,108
MV 172,a,184,a,104
MV 176,a,184,a,108
MV 180,a,188,a,104
buffer_load_dwordx4 a[104:107], v236, s[44:47], s68 offen offset:1024 sc1
MV 184,a,188,a,108
buffer_load_dwordx4 a[108:111], v237, s[44:47], s68 offen offset:1024 sc1
s_add_u32 s68, s68, 2048
s_waitcnt lgkmcnt(7)
MV 124,a,128,a,0
ds_read_b128 a[160:163], v242 offset:8192
s_add_u32 s72, s79, 0
MV 128,a,128,a,4
ds_read_b128 a[164:167], v242 offset:9216
s_add_u32 m0, s70, 32768
s_waitcnt lgkmcnt(8)
MV 132,a,132,a,0
MV 136,a,132,a,4
ds_read_b128 a[168:171], v242 offset:10240
s_waitcnt lgkmcnt(8)
MV 140,a,136,a,0
ds_read_b128 a[172:175], v242 offset:11264
MV 144,a,136,a,4
buffer_load_dwordx4 v238, s[48:51], s69 offen offset:0 sc1 lds
s_waitcnt lgkmcnt(8)
MV 148,a,140,a,0
ds_read_b128 a[176:179], v243 offset:8192
MV 152,a,140,a,4
ds_read_b128 a[180:183], v243 offset:9216
s_waitcnt lgkmcnt(9)
MV 156,a,144,a,0
buffer_load_dwordx2 v[216:217], v251, s[56:59], s72 offen offset:128 sc1
MV 160,a,144,a,4
ds_read_b128 a[184:187], v243 offset:10240
buffer_load_dwordx4 v238, s[48:51], s69 offen offset:1024 sc1 lds
s_waitcnt lgkmcnt(9)
MV 164,a,148,a,0
ds_read_b128 a[188:191], v243 offset:11264
MV 168,a,148,a,4
s_waitcnt lgkmcnt(9)
MV 172,a,152,a,0
MV 176,a,152,a,4
s_waitcnt lgkmcnt(8)
MV 180,a,156,a,0
buffer_load_dwordx4 a[0:3], v236, s[44:47], s68 offen offset:0 sc1
MV 184,a,156,a,4
buffer_load_dwordx4 a[4:7], v237, s[44:47], s68 offen offset:0 sc1
s_waitcnt vmcnt(43) lgkmcnt(0)
s_barrier
MV 124,a,160,a,8
ds_read_b128 a[128:131], v242 offset:16384
s_add_u32 s72, s79, 16384
MV 128,a,160,a,12
ds_read_b128 a[132:135], v242 offset:17408
buffer_load_dwordx4 v238, s[48:51], s69 offen offset:2048 sc1 lds
MV 132,a,164,a,8
MV 136,a,164,a,12
ds_read_b128 a[136:139], v242 offset:18432
MV 140,a,168,a,8
ds_read_b128 a[140:143], v242 offset:19456
MV 144,a,168,a,12
buffer_load_dwordx4 v238, s[48:51], s69 offen offset:3072 sc1 lds
MV 148,a,172,a,8
ds_read_b128 a[144:147], v243 offset:16384
MV 152,a,172,a,12
ds_read_b128 a[148:151], v243 offset:17408
MV 156,a,176,a,8
buffer_load_dwordx2 v[218:219], v251, s[56:59], s72 offen offset:128 sc1
MV 160,a,176,a,12
ds_read_b128 a[152:155], v243 offset:18432
s_add_u32 s69, s69, 16384
MV 164,a,180,a,8
ds_read_b128 a[156:159], v243 offset:19456
MV 168,a,180,a,12
MV 172,a,184,a,8
MV 176,a,184,a,12
MV 180,a,188,a,8
buffer_load_dwordx4 a[8:11], v236, s[44:47], s68 offen offset:1024 sc1
MV 184,a,188,a,12
buffer_load_dwordx4 a[12:15], v237, s[44:47], s68 offen offset:1024 sc1
s_add_u32 s68, s68, 2048
s_waitcnt lgkmcnt(7)
MV 124,a,128,a,16
ds_read_b128 a[160:163], v242 offset:24576
s_add_u32 s72, s79, 131072
MV 128,a,128,a,20
ds_read_b128 a[164:167], v242 offset:25600
s_add_u32 m0, s70, 66560
s_waitcnt lgkmcnt(8)
MV 132,a,132,a,16
MV 136,a,132,a,20
ds_read_b128 a[168:171], v242 offset:26624
s_waitcnt lgkmcnt(8)
MV 140,a,136,a,16
ds_read_b128 a[172:175], v242 offset:27648
MV 144,a,136,a,20
buffer_load_dwordx4 v238, s[48:51], s69 offen offset:0 sc1 lds
s_waitcnt lgkmcnt(8)
MV 148,a,140,a,16
ds_read_b128 a[176:179], v243 offset:24576
MV 152,a,140,a,20
ds_read_b128 a[180:183], v243 offset:25600
s_waitcnt lgkmcnt(9)
MV 156,a,144,a,16
buffer_load_dwordx2 v[220:221], v251, s[56:59], s72 offen offset:128 sc1
MV 160,a,144,a,20
ds_read_b128 a[184:187], v243 offset:26624
buffer_load_dwordx4 v238, s[48:51], s69 offen offset:1024 sc1 lds
s_waitcnt lgkmcnt(9)
MV 164,a,148,a,16
ds_read_b128 a[188:191], v243 offset:27648
MV 168,a,148,a,20
s_waitcnt lgkmcnt(9)
MV 172,a,152,a,16
MV 176,a,152,a,20
s_waitcnt lgkmcnt(8)
MV 180,a,156,a,16
buffer_load_dwordx4 a[16:19], v236, s[44:47], s68 offen offset:0 sc1
MV 184,a,156,a,20
buffer_load_dwordx4 a[20:23], v237, s[44:47], s68 offen offset:0 sc1
s_waitcnt vmcnt(45) lgkmcnt(0)
s_barrier
MV 124,a,160,a,24
ds_read_b128 a[128:131], v242 offset:32768
s_add_u32 s72, s79, 147456
MV 128,a,160,a,28
ds_read_b128 a[132:135], v242 offset:33792
buffer_load_dwordx4 v238, s[48:51], s69 offen offset:2048 sc1 lds
MV 132,a,164,a,24
MV 136,a,164,a,28
ds_read_b128 a[136:139], v242 offset:34816
MV 140,a,168,a,24
ds_read_b128 a[140:143], v242 offset:35840
MV 144,a,168,a,28
buffer_load_dwordx4 v238, s[48:51], s69 offen offset:3072 sc1 lds
MV 148,a,172,a,24
ds_read_b128 a[144:147], v243 offset:32768
MV 152,a,172,a,28
ds_read_b128 a[148:151], v243 offset:33792
MV 156,a,176,a,24
buffer_load_dwordx2 v[222:223], v251, s[56:59], s72 offen offset:128 sc1
MV 160,a,176,a,28
ds_read_b128 a[152:155], v243 offset:34816
s_add_u32 s69, s69, 16384
MV 164,a,180,a,24
ds_read_b128 a[156:159], v243 offset:35840
MV 168,a,180,a,28
MV 172,a,184,a,24
MV 176,a,184,a,28
MV 180,a,188,a,24
buffer_load_dwordx4 a[24:27], v236, s[44:47], s68 offen offset:1024 sc1
MV 184,a,188,a,28
buffer_load_dwordx4 a[28:31], v237, s[44:47], s68 offen offset:1024 sc1
s_add_u32 s68, s68, 2048
s_waitcnt lgkmcnt(7)
MV 124,a,128,a,32
ds_read_b128 a[160:163], v242 offset:40960
MV 128,a,128,a,36
ds_read_b128 a[164:167], v242 offset:41984
s_add_u32 m0, s70, 82944
s_waitcnt lgkmcnt(8)
MV 132,a,132,a,32
MV 136,a,132,a,36
ds_read_b128 a[168:171], v242 offset:43008
s_waitcnt lgkmcnt(8)
MV 140,a,136,a,32
ds_read_b128 a[172:175], v242 offset:44032
MV 144,a,136,a,36
buffer_load_dwordx4 v238, s[48:51], s69 offen offset:0 sc1 lds
s_waitcnt lgkmcnt(8)
MV 148,a,140,a,32
ds_read_b128 a[176:179], v243 offset:40960
MV 152,a,140,a,36
ds_read_b128 a[180:183], v243 offset:41984
s_waitcnt lgkmcnt(9)
MV 156,a,144,a,32
MV 160,a,144,a,36
ds_read_b128 a[184:187], v243 offset:43008
buffer_load_dwordx4 v238, s[48:51], s69 offen offset:1024 sc1 lds
s_waitcnt lgkmcnt(9)
MV 164,a,148,a,32
ds_read_b128 a[188:191], v243 offset:44032
MV 168,a,148,a,36
s_waitcnt lgkmcnt(9)
MV 172,a,152,a,32
MV 176,a,152,a,36
s_waitcnt lgkmcnt(8)
MV 180,a,156,a,32
buffer_load_dwordx4 a[32:35], v236, s[44:47], s68 offen offset:0 sc1
MV 184,a,156,a,36
buffer_load_dwordx4 a[36:39], v237, s[44:47], s68 offen offset:0 sc1
s_waitcnt vmcnt(46) lgkmcnt(0)
s_barrier
MV 124,a,160,a,40
ds_read_b128 a[128:131], v242 offset:49152
MV 128,a,160,a,44
ds_read_b128 a[132:135], v242 offset:50176
buffer_load_dwordx4 v238, s[48:51], s69 offen offset:2048 sc1 lds
MV 132,a,164,a,40
MV 136,a,164,a,44
ds_read_b128 a[136:139], v242 offset:51200
MV 140,a,168,a,40
ds_read_b128 a[140:143], v242 offset:52224
MV 144,a,168,a,44
buffer_load_dwordx4 v238, s[48:51], s69 offen offset:3072 sc1 lds
MV 148,a,172,a,40
ds_read_b128 a[144:147], v243 offset:49152
MV 152,a,172,a,44
ds_read_b128 a[148:151], v243 offset:50176
MV 156,a,176,a,40
MV 160,a,176,a,44
ds_read_b128 a[152:155], v243 offset:51200
s_add_u32 s69, s69, 16384
MV 164,a,180,a,40
ds_read_b128 a[156:159], v243 offset:52224
MV 168,a,180,a,44
MV 172,a,184,a,40
MV 176,a,184,a,44
MV 180,a,188,a,40
buffer_load_dwordx4 a[40:43], v236, s[44:47], s68 offen offset:1024 sc1
MV 184,a,188,a,44
buffer_load_dwordx4 a[44:47], v237, s[44:47], s68 offen offset:1024 sc1
s_add_u32 s68, s68, 2048
s_waitcnt lgkmcnt(7)
MV 124,a,128,a,48
ds_read_b128 a[160:163], v242 offset:57344
MV 128,a,128,a,52
ds_read_b128 a[164:167], v242 offset:58368
s_add_u32 m0, s70, 99328
s_waitcnt lgkmcnt(8)
MV 132,a,132,a,48
MV 136,a,132,a,52
ds_read_b128 a[168:171], v242 offset:59392
s_waitcnt lgkmcnt(8)
MV 140,a,136,a,48
ds_read_b128 a[172:175], v242 offset:60416
MV 144,a,136,a,52
buffer_load_dwordx4 v238, s[48:51], s69 offen offset:0 sc1 lds
s_waitcnt lgkmcnt(8)
MV 148,a,140,a,48
ds_read_b128 a[176:179], v243 offset:57344
MV 152,a,140,a,52
ds_read_b128 a[180:183], v243 offset:58368
s_waitcnt lgkmcnt(9)
MV 156,a,144,a,48
MV 160,a,144,a,52
ds_read_b128 a[184:187], v243 offset:59392
buffer_load_dwordx4 v238, s[48:51], s69 offen offset:1024 sc1 lds
s_waitcnt lgkmcnt(9)
MV 164,a,148,a,48
ds_read_b128 a[188:191], v243 offset:60416
MV 168,a,148,a,52
s_waitcnt lgkmcnt(9)
MV 172,a,152,a,48
MV 176,a,152,a,52
s_waitcnt lgkmcnt(8)
MV 180,a,156,a,48
buffer_load_dwordx4 a[48:51], v236, s[44:47], s68 offen offset:0 sc1
MV 184,a,156,a,52
buffer_load_dwordx4 a[52:55], v237, s[44:47], s68 offen offset:0 sc1
s_waitcnt vmcnt(45) lgkmcnt(0)
s_barrier
MV 124,a,160,a,56
ds_read_b128 a[128:131], v244 offset:0
MV 128,a,160,a,60
ds_read_b128 a[132:135], v244 offset:1024
buffer_load_dwordx4 v238, s[48:51], s69 offen offset:2048 sc1 lds
MV 132,a,164,a,56
MV 136,a,164,a,60
ds_read_b128 a[136:139], v244 offset:2048
MV 140,a,168,a,56
ds_read_b128 a[140:143], v244 offset:3072
MV 144,a,168,a,60
buffer_load_dwordx4 v238, s[48:51], s69 offen offset:3072 sc1 lds
MV 148,a,172,a,56
ds_read_b128 a[144:147], v245 offset:0
MV 152,a,172,a,60
ds_read_b128 a[148:151], v245 offset:1024
MV 156,a,176,a,56
MV 160,a,176,a,60
ds_read_b128 a[152:155], v245 offset:2048
s_add_u32 s69, s69, 16384
MV 164,a,180,a,56
ds_read_b128 a[156:159], v245 offset:3072
MV 168,a,180,a,60
MV 172,a,184,a,56
MV 176,a,184,a,60
MV 180,a,188,a,56
buffer_load_dwordx4 a[56:59], v236, s[44:47], s68 offen offset:1024 sc1
MV 184,a,188,a,60
buffer_load_dwordx4 a[60:63], v237, s[44:47], s68 offen offset:1024 sc1
s_add_u32 s68, s68, 2048
s_waitcnt lgkmcnt(7)
MV 124,a,128,a,64
ds_read_b128 a[160:163], v244 offset:8192
MV 128,a,128,a,68
ds_read_b128 a[164:167], v244 offset:9216
s_add_u32 m0, s70, 115712
s_waitcnt lgkmcnt(8)
MV 132,a,132,a,64
MV 136,a,132,a,68
ds_read_b128 a[168:171], v244 offset:10240
s_waitcnt lgkmcnt(8)
MV 140,a,136,a,64
ds_read_b128 a[172:175], v244 offset:11264
MV 144,a,136,a,68
buffer_load_dwordx4 v238, s[48:51], s69 offen offset:0 sc1 lds
s_waitcnt lgkmcnt(8)
MV 148,a,140,a,64
ds_read_b128 a[176:179], v245 offset:8192
MV 152,a,140,a,68
ds_read_b128 a[180:183], v245 offset:9216
s_waitcnt lgkmcnt(9)
MV 156,a,144,a,64
MV 160,a,144,a,68
ds_read_b128 a[184:187], v245 offset:10240
buffer_load_dwordx4 v238, s[48:51], s69 offen offset:1024 sc1 lds
s_waitcnt lgkmcnt(9)
MV 164,a,148,a,64
ds_read_b128 a[188:191], v245 offset:11264
MV 168,a,148,a,68
s_waitcnt lgkmcnt(9)
MV 172,a,152,a,64
MV 176,a,152,a,68
s_waitcnt lgkmcnt(8)
MV 180,a,156,a,64
MV 184,a,156,a,68
s_waitcnt vmcnt(41) lgkmcnt(0)
s_barrier
MV 124,a,160,a,72
ds_read_b128 a[128:131], v244 offset:16384
MV 128,a,160,a,76
ds_read_b128 a[132:135], v244 offset:17408
buffer_load_dwordx4 v238, s[48:51], s69 offen offset:2048 sc1 lds
MV 132,a,164,a,72
MV 136,a,164,a,76
ds_read_b128 a[136:139], v244 offset:18432
MV 140,a,168,a,72
ds_read_b128 a[140:143], v244 offset:19456
MV 144,a,168,a,76
buffer_load_dwordx4 v238, s[48:51], s69 offen offset:3072 sc1 lds
MV 148,a,172,a,72
ds_read_b128 a[144:147], v245 offset:16384
MV 152,a,172,a,76
ds_read_b128 a[148:151], v245 offset:17408
MV 156,a,176,a,72
MV 160,a,176,a,76
ds_read_b128 a[152:155], v245 offset:18432
s_add_u32 s69, s69, 16384
MV 164,a,180,a,72
ds_read_b128 a[156:159], v245 offset:19456
MV 168,a,180,a,76
MV 172,a,184,a,72
MV 176,a,184,a,76
MV 180,a,188,a,72
MV 184,a,188,a,76
s_waitcnt lgkmcnt(7)
MV 124,a,128,a,80
ds_read_b128 a[160:163], v244 offset:24576
MV 128,a,128,a,84
ds_read_b128 a[164:167], v244 offset:25600
s_waitcnt lgkmcnt(8)
MV 132,a,132,a,80
MV 136,a,132,a,84
ds_read_b128 a[168:171], v244 offset:26624
s_waitcnt lgkmcnt(8)
MV 140,a,136,a,80
ds_read_b128 a[172:175], v244 offset:27648
MV 144,a,136,a,84
s_waitcnt lgkmcnt(8)
MV 148,a,140,a,80
ds_read_b128 a[176:179], v245 offset:24576
MV 152,a,140,a,84
ds_read_b128 a[180:183], v245 offset:25600
s_waitcnt lgkmcnt(9)
MV 156,a,144,a,80
MV 160,a,144,a,84
ds_read_b128 a[184:187], v245 offset:26624
s_waitcnt lgkmcnt(9)
MV 164,a,148,a,80
ds_read_b128 a[188:191], v245 offset:27648
MV 168,a,148,a,84
s_waitcnt lgkmcnt(9)
MV 172,a,152,a,80
MV 176,a,152,a,84
s_waitcnt lgkmcnt(8)
MV 180,a,156,a,80
MV 184,a,156,a,84
s_waitcnt vmcnt(33) lgkmcnt(0)
s_barrier
MV 124,a,160,a,88
ds_read_b128 a[128:131], v244 offset:32768
MV 128,a,160,a,92
ds_read_b128 a[132:135], v244 offset:33792
MV 132,a,164,a,88
MV 136,a,164,a,92
ds_read_b128 a[136:139], v244 offset:34816
MV 140,a,168,a,88
ds_read_b128 a[140:143], v244 offset:35840
MV 144,a,168,a,92
MV 148,a,172,a,88
ds_read_b128 a[144:147], v245 offset:32768
MV 152,a,172,a,92
ds_read_b128 a[148:151], v245 offset:33792
MV 156,a,176,a,88
MV 160,a,176,a,92
ds_read_b128 a[152:155], v245 offset:34816
MV 164,a,180,a,88
ds_read_b128 a[156:159], v245 offset:35840
MV 168,a,180,a,92
MV 172,a,184,a,88
MV 176,a,184,a,92
MV 180,a,188,a,88
MV 184,a,188,a,92
s_waitcnt lgkmcnt(7)
MV 124,a,128,a,96
ds_read_b128 a[160:163], v244 offset:40960
v_sub_f32 v226, 1.0, v224
MV 128,a,128,a,100
ds_read_b128 a[164:167], v244 offset:41984
v_lshlrev_b32 v36, 16, v192
s_waitcnt lgkmcnt(8)
MV 132,a,132,a,96
v_lshlrev_b32 v228, 16, v208
MV 136,a,132,a,100
ds_read_b128 a[168:171], v244 offset:43008
v_and_b32 v37, 0xffff0000, v192
s_waitcnt lgkmcnt(8)
MV 140,a,136,a,96
ds_read_b128 a[172:175], v244 offset:44032
v_and_b32 v229, 0xffff0000, v208
MV 144,a,136,a,100
s_waitcnt lgkmcnt(8)
MV 148,a,140,a,96
ds_read_b128 a[176:179], v245 offset:40960
v_mul_f32 v36, v36, v228
MV 152,a,140,a,100
ds_read_b128 a[180:183], v245 offset:41984
v_mul_f32 v37, v37, v229
s_waitcnt lgkmcnt(9)
MV 156,a,144,a,96
v_mul_f32 v36, v36, v224
MV 160,a,144,a,100
ds_read_b128 a[184:187], v245 offset:43008
v_mul_f32 v37, v37, v224
s_waitcnt lgkmcnt(9)
MV 164,a,148,a,96
ds_read_b128 a[188:191], v245 offset:44032
MV 168,a,148,a,100
v_lshlrev_b32 v38, 16, v193
s_waitcnt lgkmcnt(9)
MV 172,a,152,a,96
v_lshlrev_b32 v228, 16, v209
MV 176,a,152,a,100
v_and_b32 v39, 0xffff0000, v193
s_waitcnt lgkmcnt(8)
MV 180,a,156,a,96
v_and_b32 v229, 0xffff0000, v209
MV 184,a,156,a,100
s_waitcnt vmcnt(23) lgkmcnt(0)
s_barrier
MV 124,a,160,a,104
ds_read_b128 a[128:131], v242 offset:0
v_mul_f32 v38, v38, v228
MV 128,a,160,a,108
ds_read_b128 a[132:135], v242 offset:1024
v_mul_f32 v39, v39, v229
MV 132,a,164,a,104
v_mul_f32 v38, v38, v224
MV 136,a,164,a,108
ds_read_b128 a[136:139], v242 offset:2048
v_mul_f32 v39, v39, v224
MV 140,a,168,a,104
ds_read_b128 a[140:143], v242 offset:3072
v_lshlrev_b32 v40, 16, v194
MV 144,a,168,a,108
MV 148,a,172,a,104
ds_read_b128 a[144:147], v243 offset:0
v_lshlrev_b32 v228, 16, v210
MV 152,a,172,a,108
ds_read_b128 a[148:151], v243 offset:1024
v_and_b32 v41, 0xffff0000, v194
MV 156,a,176,a,104
v_and_b32 v229, 0xffff0000, v210
MV 160,a,176,a,108
ds_read_b128 a[152:155], v243 offset:2048
v_mul_f32 v40, v40, v228
MV 164,a,180,a,104
ds_read_b128 a[156:159], v243 offset:3072
MV 168,a,180,a,108
v_mul_f32 v41, v41, v229
MV 172,a,184,a,104
v_mul_f32 v40, v40, v224
MV 176,a,184,a,108
v_mul_f32 v41, v41, v224
MV 180,a,188,a,104
v_lshlrev_b32 v42, 16, v195
MV 184,a,188,a,108
s_waitcnt lgkmcnt(7)
MV 124,a,128,a,0
ds_read_b128 a[160:163], v242 offset:8192
v_lshlrev_b32 v228, 16, v211
MV 128,a,128,a,4
ds_read_b128 a[164:167], v242 offset:9216
v_and_b32 v43, 0xffff0000, v195
s_waitcnt lgkmcnt(8)
MV 132,a,132,a,0
v_and_b32 v229, 0xffff0000, v211
MV 136,a,132,a,4
ds_read_b128 a[168:171], v242 offset:10240
v_mul_f32 v42, v42, v228
s_waitcnt lgkmcnt(8)
MV 140,a,136,a,0
ds_read_b128 a[172:175], v242 offset:11264
v_mul_f32 v43, v43, v229
MV 144,a,136,a,4
s_waitcnt lgkmcnt(8)
MV 148,a,140,a,0
ds_read_b128 a[176:179], v243 offset:8192
v_mul_f32 v42, v42, v224
MV 152,a,140,a,4
ds_read_b128 a[180:183], v243 offset:9216
v_mul_f32 v43, v43, v224
s_waitcnt lgkmcnt(9)
MV 156,a,144,a,0
v_lshlrev_b32 v44, 16, v196
MV 160,a,144,a,4
ds_read_b128 a[184:187], v243 offset:10240
v_lshlrev_b32 v228, 16, v212
s_waitcnt lgkmcnt(9)
MV 164,a,148,a,0
ds_read_b128 a[188:191], v243 offset:11264
MV 168,a,148,a,4
v_and_b32 v45, 0xffff0000, v196
s_waitcnt lgkmcnt(9)
MV 172,a,152,a,0
v_and_b32 v229, 0xffff0000, v212
MV 176,a,152,a,4
v_mul_f32 v44, v44, v228
s_waitcnt lgkmcnt(8)
MV 180,a,156,a,0
v_mul_f32 v45, v45, v229
MV 184,a,156,a,4
s_waitcnt vmcnt(14) lgkmcnt(0)
s_barrier
MV 124,a,160,a,8
ds_read_b128 a[128:131], v242 offset:16384
v_mul_f32 v44, v44, v224
MV 128,a,160,a,12
ds_read_b128 a[132:135], v242 offset:17408
v_mul_f32 v45, v45, v224
MV 132,a,164,a,8
v_lshlrev_b32 v46, 16, v197
MV 136,a,164,a,12
ds_read_b128 a[136:139], v242 offset:18432
v_lshlrev_b32 v228, 16, v213
MV 140,a,168,a,8
ds_read_b128 a[140:143], v242 offset:19456
v_and_b32 v47, 0xffff0000, v197
MV 144,a,168,a,12
MV 148,a,172,a,8
ds_read_b128 a[144:147], v243 offset:16384
v_and_b32 v229, 0xffff0000, v213
MV 152,a,172,a,12
ds_read_b128 a[148:151], v243 offset:17408
v_mul_f32 v46, v46, v228
MV 156,a,176,a,8
v_mul_f32 v47, v47, v229
MV 160,a,176,a,12
ds_read_b128 a[152:155], v243 offset:18432
v_mul_f32 v46, v46, v224
MV 164,a,180,a,8
ds_read_b128 a[156:159], v243 offset:19456
MV 168,a,180,a,12
v_mul_f32 v47, v47, v224
MV 172,a,184,a,8
v_lshlrev_b32 v48, 16, v198
MV 176,a,184,a,12
v_lshlrev_b32 v228, 16, v214
MV 180,a,188,a,8
v_and_b32 v49, 0xffff0000, v198
MV 184,a,188,a,12
s_waitcnt lgkmcnt(7)
MV 124,a,128,a,16
ds_read_b128 a[160:163], v242 offset:24576
v_and_b32 v229, 0xffff0000, v214
MV 128,a,128,a,20
ds_read_b128 a[164:167], v242 offset:25600
v_mul_f32 v48, v48, v228
s_waitcnt lgkmcnt(8)
MV 132,a,132,a,16
v_mul_f32 v49, v49, v229
MV 136,a,132,a,20
ds_read_b128 a[168:171], v242 offset:26624
v_mul_f32 v48, v48, v224
s_waitcnt lgkmcnt(8)
MV 140,a,136,a,16
ds_read_b128 a[172:175], v242 offset:27648
v_mul_f32 v49, v49, v224
MV 144,a,136,a,20
s_waitcnt lgkmcnt(8)
MV 148,a,140,a,16
ds_read_b128 a[176:179], v243 offset:24576
v_lshlrev_b32 v50, 16, v199
MV 152,a,140,a,20
ds_read_b128 a[180:183], v243 offset:25600
v_lshlrev_b32 v228, 16, v215
s_waitcnt lgkmcnt(9)
MV 156,a,144,a,16
v_and_b32 v51, 0xffff0000, v199
MV 160,a,144,a,20
ds_read_b128 a[184:187], v243 offset:26624
v_and_b32 v229, 0xffff0000, v215
s_waitcnt lgkmcnt(9)
MV 164,a,148,a,16
ds_read_b128 a[188:191], v243 offset:27648
MV 168,a,148,a,20
v_mul_f32 v50, v50, v228
s_waitcnt lgkmcnt(9)
MV 172,a,152,a,16
v_mul_f32 v51, v51, v229
MV 176,a,152,a,20
v_mul_f32 v50, v50, v224
s_waitcnt lgkmcnt(8)
MV 180,a,156,a,16
v_mul_f32 v51, v51, v224
MV 184,a,156,a,20
s_waitcnt vmcnt(6) lgkmcnt(0)
s_barrier
MV 124,a,160,a,24
ds_read_b128 a[128:131], v242 offset:32768
v_sub_f32 v227, 1.0, v225
MV 128,a,160,a,28
ds_read_b128 a[132:135], v242 offset:33792
v_lshlrev_b32 v52, 16, v200
MV 132,a,164,a,24
v_lshlrev_b32 v228, 16, v216
MV 136,a,164,a,28
ds_read_b128 a[136:139], v242 offset:34816
v_and_b32 v53, 0xffff0000, v200
MV 140,a,168,a,24
ds_read_b128 a[140:143], v242 offset:35840
v_and_b32 v229, 0xffff0000, v216
MV 144,a,168,a,28
MV 148,a,172,a,24
ds_read_b128 a[144:147], v243 offset:32768
v_mul_f32 v52, v52, v228
MV 152,a,172,a,28
ds_read_b128 a[148:151], v243 offset:33792
v_mul_f32 v53, v53, v229
MV 156,a,176,a,24
v_mul_f32 v52, v52, v225
MV 160,a,176,a,28
ds_read_b128 a[152:155], v243 offset:34816
v_mul_f32 v53, v53, v225
MV 164,a,180,a,24
ds_read_b128 a[156:159], v243 offset:35840
MV 168,a,180,a,28
v_lshlrev_b32 v54, 16, v201
MV 172,a,184,a,24
v_lshlrev_b32 v228, 16, v217
MV 176,a,184,a,28
v_and_b32 v55, 0xffff0000, v201
MV 180,a,188,a,24
v_and_b32 v229, 0xffff0000, v217
MV 184,a,188,a,28
s_waitcnt lgkmcnt(7)
MV 124,a,128,a,32
ds_read_b128 a[160:163], v242 offset:40960
v_mul_f32 v54, v54, v228
MV 128,a,128,a,36
ds_read_b128 a[164:167], v242 offset:41984
v_mul_f32 v55, v55, v229
s_waitcnt lgkmcnt(8)
MV 132,a,132,a,32
v_mul_f32 v54, v54, v225
MV 136,a,132,a,36
ds_read_b128 a[168:171], v242 offset:43008
v_mul_f32 v55, v55, v225
s_waitcnt lgkmcnt(8)
MV 140,a,136,a,32
ds_read_b128 a[172:175], v242 offset:44032
v_lshlrev_b32 v56, 16, v202
MV 144,a,136,a,36
s_waitcnt lgkmcnt(8)
MV 148,a,140,a,32
ds_read_b128 a[176:179], v243 offset:40960
v_lshlrev_b32 v228, 16, v218
MV 152,a,140,a,36
ds_read_b128 a[180:183], v243 offset:41984
v_and_b32 v57, 0xffff0000, v202
s_waitcnt lgkmcnt(9)
MV 156,a,144,a,32
v_and_b32 v229, 0xffff0000, v218
MV 160,a,144,a,36
ds_read_b128 a[184:187], v243 offset:43008
v_mul_f32 v56, v56, v228
s_waitcnt lgkmcnt(9)
MV 164,a,148,a,32
ds_read_b128 a[188:191], v243 offset:44032
MV 168,a,148,a,36
v_mul_f32 v57, v57, v229
s_waitcnt lgkmcnt(9)
MV 172,a,152,a,32
v_mul_f32 v56, v56, v225
MV 176,a,152,a,36
v_mul_f32 v57, v57, v225
s_waitcnt lgkmcnt(8)
MV 180,a,156,a,32
v_lshlrev_b32 v58, 16, v203
MV 184,a,156,a,36
s_waitcnt vmcnt(0) lgkmcnt(0)
s_barrier
MV 124,a,160,a,40
ds_read_b128 a[128:131], v242 offset:49152
v_lshlrev_b32 v228, 16, v219
MV 128,a,160,a,44
ds_read_b128 a[132:135], v242 offset:50176
v_and_b32 v59, 0xffff0000, v203
MV 132,a,164,a,40
v_and_b32 v229, 0xffff0000, v219
MV 136,a,164,a,44
ds_read_b128 a[136:139], v242 offset:51200
v_mul_f32 v58, v58, v228
MV 140,a,168,a,40
ds_read_b128 a[140:143], v242 offset:52224
v_mul_f32 v59, v59, v229
MV 144,a,168,a,44
MV 148,a,172,a,40
ds_read_b128 a[144:147], v243 offset:49152
v_mul_f32 v58, v58, v225
MV 152,a,172,a,44
ds_read_b128 a[148:151], v243 offset:50176
v_mul_f32 v59, v59, v225
MV 156,a,176,a,40
v_lshlrev_b32 v60, 16, v204
MV 160,a,176,a,44
ds_read_b128 a[152:155], v243 offset:51200
v_lshlrev_b32 v228, 16, v220
MV 164,a,180,a,40
ds_read_b128 a[156:159], v243 offset:52224
MV 168,a,180,a,44
v_and_b32 v61, 0xffff0000, v204
MV 172,a,184,a,40
v_and_b32 v229, 0xffff0000, v220
MV 176,a,184,a,44
v_mul_f32 v60, v60, v228
MV 180,a,188,a,40
v_mul_f32 v61, v61, v229
MV 184,a,188,a,44
s_waitcnt lgkmcnt(7)
MV 124,a,128,a,48
ds_read_b128 a[160:163], v242 offset:57344
v_mul_f32 v60, v60, v225
MV 128,a,128,a,52
ds_read_b128 a[164:167], v242 offset:58368
v_mul_f32 v61, v61, v225
s_waitcnt lgkmcnt(8)
MV 132,a,132,a,48
v_lshlrev_b32 v62, 16, v205
MV 136,a,132,a,52
ds_read_b128 a[168:171], v242 offset:59392
v_lshlrev_b32 v228, 16, v221
s_waitcnt lgkmcnt(8)
MV 140,a,136,a,48
ds_read_b128 a[172:175], v242 offset:60416
v_and_b32 v63, 0xffff0000, v205
MV 144,a,136,a,52
s_waitcnt lgkmcnt(8)
MV 148,a,140,a,48
ds_read_b128 a[176:179], v243 offset:57344
v_and_b32 v229, 0xffff0000, v221
MV 152,a,140,a,52
ds_read_b128 a[180:183], v243 offset:58368
v_mul_f32 v62, v62, v228
s_waitcnt lgkmcnt(9)
MV 156,a,144,a,48
v_mul_f32 v63, v63, v229
MV 160,a,144,a,52
ds_read_b128 a[184:187], v243 offset:59392
v_mul_f32 v62, v62, v225
s_waitcnt lgkmcnt(9)
MV 164,a,148,a,48
ds_read_b128 a[188:191], v243 offset:60416
MV 168,a,148,a,52
v_mul_f32 v63, v63, v225
s_waitcnt lgkmcnt(9)
MV 172,a,152,a,48
v_lshlrev_b32 v64, 16, v206
MV 176,a,152,a,52
v_lshlrev_b32 v228, 16, v222
s_waitcnt lgkmcnt(8)
MV 180,a,156,a,48
v_and_b32 v65, 0xffff0000, v206
MV 184,a,156,a,52
s_waitcnt lgkmcnt(3)
MV 156,a,176,a,56
v_and_b32 v229, 0xffff0000, v222
MV 160,a,176,a,60
v_mul_f32 v64, v64, v228
s_waitcnt lgkmcnt(2)
MV 164,a,180,a,56
v_mul_f32 v65, v65, v229
MV 168,a,180,a,60
v_mul_f32 v64, v64, v225
s_waitcnt lgkmcnt(1)
MV 172,a,184,a,56
v_mul_f32 v65, v65, v225
MV 176,a,184,a,60
s_waitcnt lgkmcnt(0)
MV 180,a,188,a,56
v_lshlrev_b32 v66, 16, v207
MV 184,a,188,a,60
v_lshlrev_b32 v228, 16, v223
MV 124,a,160,a,56
v_and_b32 v67, 0xffff0000, v207
MV 128,a,160,a,60
v_and_b32 v229, 0xffff0000, v223
MV 132,a,164,a,56
MV 136,a,164,a,60
v_mul_f32 v66, v66, v228
MV 140,a,168,a,56
v_mul_f32 v67, v67, v229
MV 144,a,168,a,60
v_mul_f32 v66, v66, v225
MV 148,a,172,a,56
v_mul_f32 v67, v67, v225
MV 152,a,172,a,60
s_xor_b32 s72, s2, 4
s_lshl_b32 s72, s72, 14
v_cvt_pk_bf16_f32 v156, v156, v157
v_cvt_pk_bf16_f32 v157, v158, v159
v_cvt_pk_bf16_f32 v158, v160, v161
v_cvt_pk_bf16_f32 v159, v162, v163
buffer_store_dwordx4 v[156:159], v238, s[52:55], s72 offen offset:0 sc1
v_cvt_pk_bf16_f32 v164, v164, v165
v_cvt_pk_bf16_f32 v165, v166, v167
v_cvt_pk_bf16_f32 v166, v168, v169
v_cvt_pk_bf16_f32 v167, v170, v171
buffer_store_dwordx4 v[164:167], v238, s[52:55], s72 offen offset:1024 sc1
v_cvt_pk_bf16_f32 v172, v172, v173
v_cvt_pk_bf16_f32 v173, v174, v175
v_cvt_pk_bf16_f32 v174, v176, v177
v_cvt_pk_bf16_f32 v175, v178, v179
buffer_store_dwordx4 v[172:175], v238, s[52:55], s72 offen offset:2048 sc1
v_cvt_pk_bf16_f32 v180, v180, v181
v_cvt_pk_bf16_f32 v181, v182, v183
v_cvt_pk_bf16_f32 v182, v184, v185
v_cvt_pk_bf16_f32 v183, v186, v187
buffer_store_dwordx4 v[180:183], v238, s[52:55], s72 offen offset:3072 sc1
s_lshl_b32 s72, s2, 14
s_mov_b32 s73, 400000
L_xb:
buffer_load_dwordx4 v[76:79], v238, s[52:55], s72 offen offset:0 sc1
buffer_load_dwordx4 v[80:83], v238, s[52:55], s72 offen offset:1024 sc1
buffer_load_dwordx4 v[84:87], v238, s[52:55], s72 offen offset:2048 sc1
buffer_load_dwordx4 v[88:91], v238, s[52:55], s72 offen offset:3072 sc1
s_sub_u32 s73, s73, 1
s_cbranch_scc1 L_xb_done
s_waitcnt vmcnt(3)
v_max3_u32 v228, v76, v77, v78
s_waitcnt vmcnt(2)
v_max3_u32 v228, v228, v79, v80
v_max3_u32 v228, v228, v81, v82
s_waitcnt vmcnt(1)
v_max3_u32 v228, v228, v83, v84
v_max3_u32 v228, v228, v85, v86
s_waitcnt vmcnt(0)
v_max3_u32 v228, v228, v87, v88
v_max3_u32 v228, v228, v89, v90
v_max_u32 v228, v228, v91
v_cmp_eq_u32 vcc, -1, v228
s_nop 4
s_cbranch_vccnz L_xb
L_xb_done:
s_waitcnt vmcnt(0)
v_lshlrev_b32 v92, 16, v76
v_and_b32 v93, 0xffff0000, v76
v_add_f32 v124, v124, v92
v_add_f32 v125, v125, v93
v_lshlrev_b32 v92, 16, v77
v_and_b32 v93, 0xffff0000, v77
v_add_f32 v126, v126, v92
v_add_f32 v127, v127, v93
v_lshlrev_b32 v92, 16, v78
v_and_b32 v93, 0xffff0000, v78
v_add_f32 v128, v128, v92
v_add_f32 v129, v129, v93
v_lshlrev_b32 v92, 16, v79
v_and_b32 v93, 0xffff0000, v79
v_add_f32 v130, v130, v92
v_add_f32 v131, v131, v93
v_lshlrev_b32 v92, 16, v80
v_and_b32 v93, 0xffff0000, v80
v_add_f32 v132, v132, v92
v_add_f32 v133, v133, v93
v_lshlrev_b32 v92, 16, v81
v_and_b32 v93, 0xffff0000, v81
v_add_f32 v134, v134, v92
v_add_f32 v135, v135, v93
v_lshlrev_b32 v92, 16, v82
v_and_b32 v93, 0xffff0000, v82
v_add_f32 v136, v136, v92
v_add_f32 v137, v137, v93
v_lshlrev_b32 v92, 16, v83
v_and_b32 v93, 0xffff0000, v83
v_add_f32 v138, v138, v92
v_add_f32 v139, v139, v93
v_lshlrev_b32 v92, 16, v84
v_and_b32 v93, 0xffff0000, v84
v_add_f32 v140, v140, v92
v_add_f32 v141, v141, v93
v_lshlrev_b32 v92, 16, v85
v_and_b32 v93, 0xffff0000, v85
v_add_f32 v142, v142, v92
v_add_f32 v143, v143, v93
v_lshlrev_b32 v92, 16, v86
v_and_b32 v93, 0xffff0000, v86
v_add_f32 v144, v144, v92
v_add_f32 v145, v145, v93
v_lshlrev_b32 v92, 16, v87
v_and_b32 v93, 0xffff0000, v87
v_add_f32 v146, v146, v92
v_add_f32 v147, v147, v93
v_lshlrev_b32 v92, 16, v88
v_and_b32 v93, 0xffff0000, v88
v_add_f32 v148, v148, v92
v_add_f32 v149, v149, v93
v_lshlrev_b32 v92, 16, v89
v_and_b32 v93, 0xffff0000, v89
v_add_f32 v150, v150, v92
v_add_f32 v151, v151, v93
v_lshlrev_b32 v92, 16, v90
v_and_b32 v93, 0xffff0000, v90
v_add_f32 v152, v152, v92
v_add_f32 v153, v153, v93
v_lshlrev_b32 v92, 16, v91
v_and_b32 v93, 0xffff0000, v91
v_add_f32 v154, v154, v92
v_add_f32 v155, v155, v93
v_permlane16_swap_b32 v124, v132
v_permlane16_swap_b32 v125, v133
v_permlane16_swap_b32 v126, v134
v_permlane16_swap_b32 v127, v135
v_permlane16_swap_b32 v140, v148
v_permlane16_swap_b32 v141, v149
v_permlane16_swap_b32 v142, v150
v_permlane16_swap_b32 v143, v151
v_permlane16_swap_b32 v128, v136
v_permlane16_swap_b32 v129, v137
v_permlane16_swap_b32 v130, v138
v_permlane16_swap_b32 v131, v139
v_permlane16_swap_b32 v144, v152
v_permlane16_swap_b32 v145, v153
v_permlane16_swap_b32 v146, v154
v_permlane16_swap_b32 v147, v155
s_add_u32 s72, s78, 0
v_fma_f32 v36, v124, v226, v36
v_fma_f32 v37, v125, v226, v37
v_fma_f32 v38, v126, v226, v38
v_fma_f32 v39, v127, v226, v39
v_fma_f32 v40, v132, v226, v40
v_fma_f32 v41, v133, v226, v41
v_fma_f32 v42, v134, v226, v42
v_fma_f32 v43, v135, v226, v43
v_cvt_pk_bf16_f32 v192, v36, v37
v_cvt_pk_bf16_f32 v193, v38, v39
v_cvt_pk_bf16_f32 v194, v40, v41
v_cvt_pk_bf16_f32 v195, v42, v43
buffer_store_dwordx4 v[192:195], v250, s[60:63], s72 offen offset:0
v_fma_f32 v44, v140, v226, v44
v_fma_f32 v45, v141, v226, v45
v_fma_f32 v46, v142, v226, v46
v_fma_f32 v47, v143, v226, v47
v_fma_f32 v48, v148, v226, v48
v_fma_f32 v49, v149, v226, v49
v_fma_f32 v50, v150, v226, v50
v_fma_f32 v51, v151, v226, v51
v_cvt_pk_bf16_f32 v196, v44, v45
v_cvt_pk_bf16_f32 v197, v46, v47
v_cvt_pk_bf16_f32 v198, v48, v49
v_cvt_pk_bf16_f32 v199, v50, v51
buffer_store_dwordx4 v[196:199], v250, s[60:63], s72 offen offset:64
s_add_u32 s72, s78, 32768
v_fma_f32 v52, v128, v227, v52
v_fma_f32 v53, v129, v227, v53
v_fma_f32 v54, v130, v227, v54
v_fma_f32 v55, v131, v227, v55
v_fma_f32 v56, v136, v227, v56
v_fma_f32 v57, v137, v227, v57
v_fma_f32 v58, v138, v227, v58
v_fma_f32 v59, v139, v227, v59
v_cvt_pk_bf16_f32 v200, v52, v53
v_cvt_pk_bf16_f32 v201, v54, v55
v_cvt_pk_bf16_f32 v202, v56, v57
v_cvt_pk_bf16_f32 v203, v58, v59
buffer_store_dwordx4 v[200:203], v250, s[60:63], s72 offen offset:0
v_fma_f32 v60, v144, v227, v60
v_fma_f32 v61, v145, v227, v61
v_fma_f32 v62, v146, v227, v62
v_fma_f32 v63, v147, v227, v63
v_fma_f32 v64, v152, v227, v64
v_fma_f32 v65, v153, v227, v65
v_fma_f32 v66, v154, v227, v66
v_fma_f32 v67, v155, v227, v67
v_cvt_pk_bf16_f32 v204, v60, v61
v_cvt_pk_bf16_f32 v205, v62, v63
v_cvt_pk_bf16_f32 v206, v64, v65
v_cvt_pk_bf16_f32 v207, v66, v67
buffer_store_dwordx4 v[204:207], v250, s[60:63], s72 offen offset:64
L_end:
s_endpgm
L_p3_pmask:
s_nop 7
v_add_u32 v246, 0, v13
v_cmp_gt_i32_e64 s[84:85], 0, v246
v_cmp_gt_i32_e64 s[86:87], 1, v246
v_cmp_gt_i32_e64 s[88:89], 2, v246
v_cmp_gt_i32_e64 s[90:91], 3, v246
v_cndmask_b32_e64 v96, v96, v14, s[84:85]
v_cndmask_b32_e64 v97, v97, v14, s[86:87]
v_cndmask_b32_e64 v98, v98, v14, s[88:89]
v_cndmask_b32_e64 v99, v99, v14, s[90:91]
v_cmp_gt_i32_e64 s[92:93], 16, v246
v_cmp_gt_i32_e64 s[94:95], 17, v246
v_cmp_gt_i32_e64 s[96:97], 18, v246
v_cmp_gt_i32_e64 s[98:99], 19, v246
v_cndmask_b32_e64 v100, v100, v14, s[92:93]
v_cndmask_b32_e64 v101, v101, v14, s[94:95]
v_cndmask_b32_e64 v102, v102, v14, s[96:97]
v_cndmask_b32_e64 v103, v103, v14, s[98:99]
v_cmp_gt_i32_e64 s[84:85], 8, v246
v_cmp_gt_i32_e64 s[86:87], 9, v246
v_cmp_gt_i32_e64 s[88:89], 10, v246
v_cmp_gt_i32_e64 s[90:91], 11, v246
v_cndmask_b32_e64 v104, v104, v14, s[84:85]
v_cndmask_b32_e64 v105, v105, v14, s[86:87]
v_cndmask_b32_e64 v106, v106, v14, s[88:89]
v_cndmask_b32_e64 v107, v107, v14, s[90:91]
v_cmp_gt_i32_e64 s[92:93], 24, v246
v_cmp_gt_i32_e64 s[94:95], 25, v246
v_cmp_gt_i32_e64 s[96:97], 26, v246
v_cmp_gt_i32_e64 s[98:99], 27, v246
v_cndmask_b32_e64 v108, v108, v14, s[92:93]
v_cndmask_b32_e64 v109, v109, v14, s[94:95]
v_cndmask_b32_e64 v110, v110, v14, s[96:97]
v_cndmask_b32_e64 v111, v111, v14, s[98:99]
v_add_u32 v247, -32, v13
v_cmp_gt_i32_e64 s[84:85], 0, v247
v_cmp_gt_i32_e64 s[86:87], 1, v247
v_cmp_gt_i32_e64 s[88:89], 2, v247
v_cmp_gt_i32_e64 s[90:91], 3, v247
v_cndmask_b32_e64 v128, v128, v14, s[84:85]
v_cndmask_b32_e64 v129, v129, v14, s[86:87]
v_cndmask_b32_e64 v130, v130, v14, s[88:89]
v_cndmask_b32_e64 v131, v131, v14, s[90:91]
v_cmp_gt_i32_e64 s[92:93], 16, v247
v_cmp_gt_i32_e64 s[94:95], 17, v247
v_cmp_gt_i32_e64 s[96:97], 18, v247
v_cmp_gt_i32_e64 s[98:99], 19, v247
v_cndmask_b32_e64 v132, v132, v14, s[92:93]
v_cndmask_b32_e64 v133, v133, v14, s[94:95]
v_cndmask_b32_e64 v134, v134, v14, s[96:97]
v_cndmask_b32_e64 v135, v135, v14, s[98:99]
v_cmp_gt_i32_e64 s[84:85], 8, v247
v_cmp_gt_i32_e64 s[86:87], 9, v247
v_cmp_gt_i32_e64 s[88:89], 10, v247
v_cmp_gt_i32_e64 s[90:91], 11, v247
v_cndmask_b32_e64 v136, v136, v14, s[84:85]
v_cndmask_b32_e64 v137, v137, v14, s[86:87]
v_cndmask_b32_e64 v138, v138, v14, s[88:89]
v_cndmask_b32_e64 v139, v139, v14, s[90:91]
v_cmp_gt_i32_e64 s[92:93], 24, v247
v_cmp_gt_i32_e64 s[94:95], 25, v247
v_cmp_gt_i32_e64 s[96:97], 26, v247
v_cmp_gt_i32_e64 s[98:99], 27, v247
v_cndmask_b32_e64 v140, v140, v14, s[92:93]
v_cndmask_b32_e64 v141, v141, v14, s[94:95]
v_cndmask_b32_e64 v142, v142, v14, s[96:97]
v_cndmask_b32_e64 v143, v143, v14, s[98:99]
s_branch L_p3_pmask_ret
L_p3_pfix:
v_sub_f32 v208, 0, v6
v_sub_f32 v209, 0, v6
v_sub_f32 v210, 0, v6
v_sub_f32 v211, 0, v6
v_sub_f32 v212, 0, v6
v_sub_f32 v213, 0, v6
v_sub_f32 v214, 0, v6
v_sub_f32 v215, 0, v6
v_sub_f32 v216, 0, v6
v_sub_f32 v217, 0, v6
v_sub_f32 v218, 0, v6
v_sub_f32 v219, 0, v6
v_sub_f32 v220, 0, v6
v_sub_f32 v221, 0, v6
v_sub_f32 v222, 0, v6
v_sub_f32 v223, 0, v6
v_sub_f32 v80, v80, v6
v_sub_f32 v81, v81, v6
v_sub_f32 v82, v82, v6
v_sub_f32 v83, v83, v6
v_sub_f32 v84, v84, v6
v_sub_f32 v85, v85, v6
v_sub_f32 v86, v86, v6
v_sub_f32 v87, v87, v6
v_sub_f32 v88, v88, v6
v_sub_f32 v89, v89, v6
v_sub_f32 v90, v90, v6
v_sub_f32 v91, v91, v6
v_sub_f32 v92, v92, v6
v_sub_f32 v93, v93, v6
v_sub_f32 v94, v94, v6
v_sub_f32 v95, v95, v6
v_sub_f32 v112, v112, v6
v_sub_f32 v113, v113, v6
v_sub_f32 v114, v114, v6
v_sub_f32 v115, v115, v6
v_sub_f32 v116, v116, v6
v_sub_f32 v117, v117, v6
v_sub_f32 v118, v118, v6
v_sub_f32 v119, v119, v6
v_sub_f32 v120, v120, v6
v_sub_f32 v121, v121, v6
v_sub_f32 v122, v122, v6
v_sub_f32 v123, v123, v6
v_sub_f32 v124, v124, v6
v_sub_f32 v125, v125, v6
v_sub_f32 v126, v126, v6
v_sub_f32 v127, v127, v6
v_sub_f32 v224, 0, v7
v_sub_f32 v225, 0, v7
v_sub_f32 v226, 0, v7
v_sub_f32 v227, 0, v7
v_sub_f32 v228, 0, v7
v_sub_f32 v229, 0, v7
v_sub_f32 v230, 0, v7
v_sub_f32 v231, 0, v7
v_sub_f32 v232, 0, v7
v_sub_f32 v233, 0, v7
v_sub_f32 v234, 0, v7
v_sub_f32 v235, 0, v7
v_sub_f32 v236, 0, v7
v_sub_f32 v237, 0, v7
v_sub_f32 v238, 0, v7
v_sub_f32 v239, 0, v7
v_sub_f32 v96, v96, v7
v_sub_f32 v97, v97, v7
v_sub_f32 v98, v98, v7
v_sub_f32 v99, v99, v7
v_sub_f32 v100, v100, v7
v_sub_f32 v101, v101, v7
v_sub_f32 v102, v102, v7
v_sub_f32 v103, v103, v7
v_sub_f32 v104, v104, v7
v_sub_f32 v105, v105, v7
v_sub_f32 v106, v106, v7
v_sub_f32 v107, v107, v7
v_sub_f32 v108, v108, v7
v_sub_f32 v109, v109, v7
v_sub_f32 v110, v110, v7
v_sub_f32 v111, v111, v7
v_sub_f32 v128, v128, v7
v_sub_f32 v129, v129, v7
v_sub_f32 v130, v130, v7
v_sub_f32 v131, v131, v7
v_sub_f32 v132, v132, v7
v_sub_f32 v133, v133, v7
v_sub_f32 v134, v134, v7
v_sub_f32 v135, v135, v7
v_sub_f32 v136, v136, v7
v_sub_f32 v137, v137, v7
v_sub_f32 v138, v138, v7
v_sub_f32 v139, v139, v7
v_sub_f32 v140, v140, v7
v_sub_f32 v141, v141, v7
v_sub_f32 v142, v142, v7
v_sub_f32 v143, v143, v7
s_branch L_p3_pfix_ret
L_p3_mxm_top:
s_waitcnt lgkmcnt(0)
v_xor_b32 v11, 0x8000, v11
v_mfma_f32_32x32x16_bf16 v[80:95], a[128:131], v[16:19], v[208:223]
s_add_u32 m0, s73, 16384
ds_read_b128 a[192:195], v11 offset:0
ds_read_b128 a[196:199], v11 offset:1024
v_exp_f32 v168, v168
v_mfma_f32_32x32x16_bf16 v[80:95], a[132:135], v[20:23], v[80:95]
ds_read_b128 a[200:203], v11 offset:2048
buffer_load_dwordx4 v12, s[56:59], s71 offen offset:0 sc1 lds
v_exp_f32 v169, v169
v_exp_f32 v170, v170
v_mfma_f32_32x32x16_bf16 v[80:95], a[136:139], v[24:27], v[80:95]
ds_read_b128 a[204:207], v11 offset:3072
ds_read_b128 a[208:211], v11 offset:4096
v_add_f32 v4, v4, v168
v_exp_f32 v171, v171
v_add_f32 v5, v5, v169
v_mfma_f32_32x32x16_bf16 v[80:95], a[140:143], v[28:31], v[80:95]
ds_read_b128 a[212:215], v11 offset:5120
buffer_load_dwordx4 v12, s[56:59], s71 offen offset:1024 sc1 lds
v_cvt_pk_bf16_f32 v168, v168, v169
v_exp_f32 v172, v172
v_add_f32 v4, v4, v170
v_mfma_f32_32x32x16_bf16 v[80:95], a[144:147], v[32:35], v[80:95]
ds_read_b128 a[216:219], v11 offset:6144
ds_read_b128 a[220:223], v11 offset:7168
v_exp_f32 v173, v173
v_add_f32 v5, v5, v171
v_cvt_pk_bf16_f32 v169, v170, v171
v_mfma_f32_32x32x16_bf16 v[80:95], a[148:151], v[36:39], v[80:95]
ds_read_b128 a[224:227], v11 offset:8192
v_exp_f32 v174, v174
v_add_f32 v4, v4, v172
v_exp_f32 v175, v175
v_mfma_f32_32x32x16_bf16 v[80:95], a[152:155], v[40:43], v[80:95]
ds_read_b128 a[228:231], v11 offset:9216
ds_read_b128 a[232:235], v11 offset:10240
buffer_load_dwordx4 v12, s[56:59], s71 offen offset:2048 sc1 lds
v_add_f32 v5, v5, v173
v_cvt_pk_bf16_f32 v170, v172, v173
v_mfma_f32_32x32x16_bf16 v[80:95], a[156:159], v[44:47], v[80:95]
ds_read_b128 a[236:239], v11 offset:11264
v_exp_f32 v176, v176
v_add_f32 v4, v4, v174
v_exp_f32 v177, v177
v_mfma_f32_32x32x16_bf16 v[112:127], a[160:163], v[16:19], v[208:223]
ds_read_b128 a[240:243], v11 offset:12288
ds_read_b128 a[244:247], v11 offset:13312
buffer_load_dwordx4 v12, s[56:59], s71 offen offset:3072 sc1 lds
v_add_f32 v5, v5, v175
v_cvt_pk_bf16_f32 v171, v174, v175
v_mfma_f32_32x32x16_bf16 v[112:127], a[164:167], v[20:23], v[112:127]
ds_read_b128 a[248:251], v11 offset:14336
v_exp_f32 v178, v178
v_add_f32 v2, v2, v176
v_exp_f32 v179, v179
v_mfma_f32_32x32x16_bf16 v[112:127], a[168:171], v[24:27], v[112:127]
ds_read_b128 a[252:255], v11 offset:15360
v_add_f32 v3, v3, v177
v_cvt_pk_bf16_f32 v176, v176, v177
v_exp_f32 v180, v180
v_add_f32 v2, v2, v178
v_mfma_f32_32x32x16_bf16 v[112:127], a[172:175], v[28:31], v[112:127]
s_add_u32 s71, s71, 16384
v_exp_f32 v181, v181
v_add_f32 v3, v3, v179
v_cvt_pk_bf16_f32 v177, v178, v179
v_add_u32 v246, 0, v13
v_mfma_f32_32x32x16_bf16 v[112:127], a[176:179], v[32:35], v[112:127]
v_exp_f32 v182, v182
v_add_f32 v2, v2, v180
v_exp_f32 v183, v183
v_add_f32 v3, v3, v181
v_mfma_f32_32x32x16_bf16 v[112:127], a[180:183], v[36:39], v[112:127]
s_xor_b32 s73, s73, 0x8000
v_cvt_pk_bf16_f32 v178, v180, v181
v_exp_f32 v184, v184
v_add_f32 v2, v2, v182
v_cmp_gt_i32_e64 s[84:85], 0, v246
v_mfma_f32_32x32x16_bf16 v[112:127], a[184:187], v[40:43], v[112:127]
v_exp_f32 v185, v185
v_add_f32 v3, v3, v183
v_cvt_pk_bf16_f32 v179, v182, v183
v_exp_f32 v186, v186
v_mfma_f32_32x32x16_bf16 v[112:127], a[188:191], v[44:47], v[112:127]
v_add_f32 v2, v2, v184
v_exp_f32 v187, v187
v_add_f32 v3, v3, v185
v_cvt_pk_bf16_f32 v184, v184, v185
v_exp_f32 v188, v188
v_add_f32 v2, v2, v186
v_exp_f32 v189, v189
v_add_f32 v3, v3, v187
v_cvt_pk_bf16_f32 v185, v186, v187
v_exp_f32 v190, v190
v_add_f32 v2, v2, v188
v_exp_f32 v191, v191
v_add_f32 v3, v3, v189
v_cvt_pk_bf16_f32 v186, v188, v189
v_exp_f32 v192, v192
v_add_f32 v2, v2, v190
v_exp_f32 v193, v193
v_add_f32 v3, v3, v191
v_cvt_pk_bf16_f32 v187, v190, v191
v_exp_f32 v194, v194
v_add_f32 v4, v4, v192
v_exp_f32 v195, v195
v_add_f32 v5, v5, v193
v_cvt_pk_bf16_f32 v192, v192, v193
v_exp_f32 v196, v196
v_add_f32 v4, v4, v194
v_exp_f32 v197, v197
v_add_f32 v5, v5, v195
v_cvt_pk_bf16_f32 v193, v194, v195
v_exp_f32 v198, v198
v_add_f32 v4, v4, v196
v_cmp_gt_i32_e64 s[86:87], 1, v246
v_cmp_gt_i32_e64 s[88:89], 2, v246
v_cmp_gt_i32_e64 s[90:91], 3, v246
v_cndmask_b32_e64 v80, v80, v14, s[84:85]
v_cndmask_b32_e64 v81, v81, v14, s[86:87]
v_exp_f32 v199, v199
v_add_f32 v5, v5, v197
v_cvt_pk_bf16_f32 v194, v196, v197
v_exp_f32 v200, v200
v_add_f32 v4, v4, v198
v_exp_f32 v201, v201
v_cndmask_b32_e64 v82, v82, v14, s[88:89]
v_cndmask_b32_e64 v83, v83, v14, s[90:91]
v_cmp_gt_i32_e64 s[92:93], 16, v246
v_cmp_gt_i32_e64 s[94:95], 17, v246
v_cmp_gt_i32_e64 s[96:97], 18, v246
v_cmp_gt_i32_e64 s[98:99], 19, v246
v_cndmask_b32_e64 v84, v84, v14, s[92:93]
v_add_f32 v5, v5, v199
v_cvt_pk_bf16_f32 v195, v198, v199
v_exp_f32 v202, v202
v_add_f32 v4, v4, v200
v_exp_f32 v203, v203
v_add_f32 v5, v5, v201
v_cvt_pk_bf16_f32 v200, v200, v201
v_cndmask_b32_e64 v85, v85, v14, s[94:95]
v_cndmask_b32_e64 v86, v86, v14, s[96:97]
v_cndmask_b32_e64 v87, v87, v14, s[98:99]
v_cmp_gt_i32_e64 s[84:85], 8, v246
v_cmp_gt_i32_e64 s[86:87], 9, v246
v_cmp_gt_i32_e64 s[88:89], 10, v246
v_exp_f32 v204, v204
v_add_f32 v4, v4, v202
v_exp_f32 v205, v205
v_add_f32 v5, v5, v203
v_cvt_pk_bf16_f32 v201, v202, v203
v_exp_f32 v206, v206
v_cmp_gt_i32_e64 s[90:91], 11, v246
v_cndmask_b32_e64 v88, v88, v14, s[84:85]
v_cndmask_b32_e64 v89, v89, v14, s[86:87]
v_cndmask_b32_e64 v90, v90, v14, s[88:89]
v_cndmask_b32_e64 v91, v91, v14, s[90:91]
v_cmp_gt_i32_e64 s[92:93], 24, v246
v_cmp_gt_i32_e64 s[94:95], 25, v246
v_add_f32 v4, v4, v204
v_exp_f32 v207, v207
v_add_f32 v5, v5, v205
v_cvt_pk_bf16_f32 v202, v204, v205
v_add_f32 v4, v4, v206
v_add_f32 v5, v5, v207
v_cvt_pk_bf16_f32 v203, v206, v207
v_cmp_gt_i32_e64 s[96:97], 26, v246
v_cmp_gt_i32_e64 s[98:99], 27, v246
v_cndmask_b32_e64 v92, v92, v14, s[92:93]
v_cndmask_b32_e64 v93, v93, v14, s[94:95]
v_cndmask_b32_e64 v94, v94, v14, s[96:97]
v_cndmask_b32_e64 v95, v95, v14, s[98:99]
s_waitcnt vmcnt(16) lgkmcnt(0)
v_mfma_f32_32x32x16_bf16 a[0:15], a[192:195], v[144:147], a[0:15]
s_barrier
v_xor_b32 v10, 0x8000, v10
v_mfma_f32_32x32x16_bf16 a[64:79], a[192:195], v[160:163], a[64:79]
ds_read_b128 a[128:131], v10 offset:0
v_max3_f32 v6, v80, v81, v82
v_max3_f32 v6, v6, v83, v84
v_max3_f32 v6, v6, v85, v86
v_max3_f32 v6, v6, v87, v88
v_max3_f32 v6, v6, v89, v90
v_mfma_f32_32x32x16_bf16 a[16:31], a[196:199], v[144:147], a[16:31]
ds_read_b128 a[132:135], v10 offset:1024
v_max3_f32 v6, v6, v91, v92
v_max3_f32 v6, v6, v93, v94
v_add_u32 v247, -32, v13
v_cmp_gt_i32_e64 s[84:85], 0, v247
v_cmp_gt_i32_e64 s[86:87], 1, v247
v_mfma_f32_32x32x16_bf16 a[80:95], a[196:199], v[160:163], a[80:95]
v_cmp_gt_i32_e64 s[88:89], 2, v247
v_cmp_gt_i32_e64 s[90:91], 3, v247
v_cndmask_b32_e64 v112, v112, v14, s[84:85]
v_cndmask_b32_e64 v113, v113, v14, s[86:87]
v_cndmask_b32_e64 v114, v114, v14, s[88:89]
v_mfma_f32_32x32x16_bf16 a[32:47], a[200:203], v[144:147], a[32:47]
ds_read_b128 a[136:139], v10 offset:2048
v_cndmask_b32_e64 v115, v115, v14, s[90:91]
v_cmp_gt_i32_e64 s[92:93], 16, v247
v_cmp_gt_i32_e64 s[94:95], 17, v247
v_cmp_gt_i32_e64 s[96:97], 18, v247
v_cmp_gt_i32_e64 s[98:99], 19, v247
v_mfma_f32_32x32x16_bf16 a[96:111], a[200:203], v[160:163], a[96:111]
v_cndmask_b32_e64 v116, v116, v14, s[92:93]
v_cndmask_b32_e64 v117, v117, v14, s[94:95]
v_cndmask_b32_e64 v118, v118, v14, s[96:97]
v_cndmask_b32_e64 v119, v119, v14, s[98:99]
v_cmp_gt_i32_e64 s[84:85], 8, v247
v_mfma_f32_32x32x16_bf16 a[48:63], a[204:207], v[144:147], a[48:63]
ds_read_b128 a[140:143], v10 offset:3072
v_cmp_gt_i32_e64 s[86:87], 9, v247
v_cmp_gt_i32_e64 s[88:89], 10, v247
v_cmp_gt_i32_e64 s[90:91], 11, v247
v_cndmask_b32_e64 v120, v120, v14, s[84:85]
v_cndmask_b32_e64 v121, v121, v14, s[86:87]
v_mfma_f32_32x32x16_bf16 a[112:127], a[204:207], v[160:163], a[112:127]
ds_read_b128 a[144:147], v10 offset:4096
v_cndmask_b32_e64 v122, v122, v14, s[88:89]
v_cndmask_b32_e64 v123, v123, v14, s[90:91]
v_cmp_gt_i32_e64 s[92:93], 24, v247
v_cmp_gt_i32_e64 s[94:95], 25, v247
v_cmp_gt_i32_e64 s[96:97], 26, v247
v_mfma_f32_32x32x16_bf16 a[0:15], a[208:211], v[152:155], a[0:15]
v_cmp_gt_i32_e64 s[98:99], 27, v247
v_cndmask_b32_e64 v124, v124, v14, s[92:93]
v_cndmask_b32_e64 v125, v125, v14, s[94:95]
v_cndmask_b32_e64 v126, v126, v14, s[96:97]
v_cndmask_b32_e64 v127, v127, v14, s[98:99]
v_mfma_f32_32x32x16_bf16 a[64:79], a[208:211], v[168:171], a[64:79]
ds_read_b128 a[148:151], v10 offset:5120
v_max3_f32 v6, v6, v95, v112
v_max3_f32 v6, v6, v113, v114
v_max3_f32 v6, v6, v115, v116
v_max3_f32 v6, v6, v117, v118
v_max3_f32 v6, v6, v119, v120
v_mfma_f32_32x32x16_bf16 a[16:31], a[212:215], v[152:155], a[16:31]
v_max3_f32 v6, v6, v121, v122
v_max3_f32 v6, v6, v123, v124
v_max3_f32 v6, v6, v125, v126
v_max_f32 v6, v6, v127
v_cmp_lt_f32 vcc, s79, v6
v_mfma_f32_32x32x16_bf16 a[80:95], a[212:215], v[168:171], a[80:95]
s_cbranch_vccnz L_p3_mxm_rare
s_add_u32 m0, s72, 16384
ds_read_b128 a[152:155], v10 offset:6144
v_exp_f32 v80, v80
v_bfe_u32 v248, v1, 2, 2
v_bfe_u32 v249, v1, 4, 1
v_mfma_f32_32x32x16_bf16 a[32:47], a[216:219], v[152:155], a[32:47]
ds_read_b128 a[156:159], v10 offset:7168
buffer_load_dwordx4 v12, s[52:55], s71 offen offset:0 sc1 lds
v_lshl_add_u32 v248, v249, 2, v248
v_lshrrev_b32 v249, 5, v1
v_lshl_add_u32 v249, v249, 4, v248
v_lshlrev_b32 v249, 8, v249
v_mfma_f32_32x32x16_bf16 a[96:111], a[216:219], v[168:171], a[96:111]
v_exp_f32 v81, v81
v_and_b32 v250, 3, v1
v_lshl_add_u32 v249, v250, 3, v249
s_lshl_b32 s36, s3, 13
s_add_u32 s36, s36, 131072
v_mfma_f32_32x32x16_bf16 a[48:63], a[220:223], v[152:155], a[48:63]
ds_read_b128 a[160:163], v10 offset:8192
v_exp_f32 v82, v82
v_add_u32 v249, s36, v249
v_xor_b32 v250, 0, v248
v_lshl_add_u32 v250, v250, 5, v249
v_mfma_f32_32x32x16_bf16 a[112:127], a[220:223], v[168:171], a[112:127]
v_add_f32 v2, v2, v80
v_exp_f32 v83, v83
TR 96,250,0
TR 98,250,2048
v_xor_b32 v250, 1, v248
v_mfma_f32_32x32x16_bf16 a[0:15], a[224:227], v[176:179], a[0:15]
ds_read_b128 a[164:167], v10 offset:9216
buffer_load_dwordx4 v12, s[52:55], s71 offen offset:1024 sc1 lds
v_lshl_add_u32 v250, v250, 5, v249
v_add_f32 v3, v3, v81
TR 100,250,0
TR 102,250,2048
v_mfma_f32_32x32x16_bf16 a[64:79], a[224:227], v[192:195], a[64:79]
ds_read_b128 a[168:171], v10 offset:10240
v_xor_b32 v250, 2, v248
v_lshl_add_u32 v250, v250, 5, v249
v_cvt_pk_bf16_f32 v80, v80, v81
v_exp_f32 v84, v84
v_mfma_f32_32x32x16_bf16 a[16:31], a[228:231], v[176:179], a[16:31]
TR 104,250,0
TR 106,250,2048
v_xor_b32 v250, 3, v248
v_lshl_add_u32 v250, v250, 5, v249
TR 108,250,0
v_add_f32 v2, v2, v82
v_mfma_f32_32x32x16_bf16 a[80:95], a[228:231], v[192:195], a[80:95]
ds_read_b128 a[172:175], v10 offset:11264
TR 110,250,2048
v_xor_b32 v250, 4, v248
v_lshl_add_u32 v250, v250, 5, v249
TR 128,250,0
TR 130,250,2048
v_mfma_f32_32x32x16_bf16 a[32:47], a[232:235], v[176:179], a[32:47]
buffer_load_dwordx4 v12, s[52:55], s71 offen offset:2048 sc1 lds
v_exp_f32 v85, v85
v_xor_b32 v250, 5, v248
v_lshl_add_u32 v250, v250, 5, v249
TR 132,250,0
v_mfma_f32_32x32x16_bf16 a[96:111], a[232:235], v[192:195], a[96:111]
ds_read_b128 a[176:179], v10 offset:12288
v_add_f32 v3, v3, v83
v_cvt_pk_bf16_f32 v81, v82, v83
TR 134,250,2048
v_xor_b32 v250, 6, v248
v_lshl_add_u32 v250, v250, 5, v249
v_mfma_f32_32x32x16_bf16 a[48:63], a[236:239], v[176:179], a[48:63]
ds_read_b128 a[180:183], v10 offset:13312
TR 136,250,0
v_exp_f32 v86, v86
TR 138,250,2048
v_xor_b32 v250, 7, v248
v_mfma_f32_32x32x16_bf16 a[112:127], a[236:239], v[192:195], a[112:127]
v_lshl_add_u32 v250, v250, 5, v249
TR 140,250,0
v_add_f32 v2, v2, v84
v_exp_f32 v87, v87
TR 142,250,2048
v_mfma_f32_32x32x16_bf16 a[0:15], a[240:243], v[184:187], a[0:15]
ds_read_b128 a[184:187], v10 offset:14336
buffer_load_dwordx4 v12, s[52:55], s71 offen offset:3072 sc1 lds
s_add_u32 s32, s40, 100663296
s_addc_u32 s33, s41, 0
s_mov_b32 s34, 8388608
s_mov_b32 s35, 0x20000
v_mfma_f32_32x32x16_bf16 a[64:79], a[240:243], v[200:203], a[64:79]
v_add_f32 v3, v3, v85
s_and_b32 s36, s2, 7
s_lshl_b32 s36, s36, 20
s_lshr_b32 s37, s2, 3
s_lshl_b32 s37, s37, 15
v_cvt_pk_bf16_f32 v82, v84, v85
v_mfma_f32_32x32x16_bf16 a[16:31], a[244:247], v[184:187], a[16:31]
ds_read_b128 a[188:191], v10 offset:15360
v_exp_f32 v88, v88
s_add_u32 s36, s36, s37
s_lshl_b32 s37, s3, 12
s_add_u32 s36, s36, s37
v_mfma_f32_32x32x16_bf16 a[80:95], a[244:247], v[200:203], a[80:95]
s_add_u32 s37, s36, 4096
v_add_f32 v2, v2, v86
s_waitcnt lgkmcnt(15)
buffer_store_dwordx4 v[96:99], v12, s[32:35], s36 offen offset:0 sc1
buffer_store_dwordx4 v[100:103], v12, s[32:35], s36 offen offset:1024 sc1
buffer_store_dwordx4 v[104:107], v12, s[32:35], s36 offen offset:2048 sc1
s_waitcnt lgkmcnt(12)
buffer_store_dwordx4 v[108:111], v12, s[32:35], s36 offen offset:3072 sc1
v_mfma_f32_32x32x16_bf16 a[32:47], a[248:251], v[184:187], a[32:47]
s_xor_b32 s72, s72, 0x8000
v_exp_f32 v89, v89
s_waitcnt lgkmcnt(10)
buffer_store_dwordx4 v[128:131], v12, s[32:35], s37 offen offset:0 sc1
s_waitcnt lgkmcnt(7)
buffer_store_dwordx4 v[132:135], v12, s[32:35], s37 offen offset:1024 sc1
s_waitcnt lgkmcnt(4)
buffer_store_dwordx4 v[136:139], v12, s[32:35], s37 offen offset:2048 sc1
v_mfma_f32_32x32x16_bf16 a[96:111], a[248:251], v[200:203], a[96:111]
s_waitcnt lgkmcnt(2)
buffer_store_dwordx4 v[140:143], v12, s[32:35], s37 offen offset:3072 sc1
v_add_f32 v3, v3, v87
v_cvt_pk_bf16_f32 v83, v86, v87
s_add_u32 s32, s40, 109051904
s_addc_u32 s33, s41, 0
s_mov_b32 s34, 4194304
v_mfma_f32_32x32x16_bf16 a[48:63], a[252:255], v[184:187], a[48:63]
s_mov_b32 s35, 0x20000
s_lshl_b32 s36, s2, 14
v_exp_f32 v90, v90
v_mov_b32 v252, -1
v_mov_b32 v253, -1
v_mfma_f32_32x32x16_bf16 a[112:127], a[252:255], v[200:203], a[112:127]
v_mov_b32 v254, -1
v_mov_b32 v255, -1
v_add_f32 v2, v2, v88
v_exp_f32 v91, v91
buffer_store_dwordx4 v[252:255], v12, s[32:35], s36 offen offset:0 sc1
buffer_store_dwordx4 v[252:255], v12, s[32:35], s36 offen offset:1024 sc1
buffer_store_dwordx4 v[252:255], v12, s[32:35], s36 offen offset:2048 sc1
buffer_store_dwordx4 v[252:255], v12, s[32:35], s36 offen offset:3072 sc1
v_add_f32 v3, v3, v89
v_lshlrev_b32 v72, 4, v1
v_add_u32 v73, -8, v72
v_mov_b32 v75, 0
buffer_load_ushort v74, v75, s[28:31], s42 offen
v_cvt_pk_bf16_f32 v88, v88, v89
v_add_f32 v2, v2, v90
buffer_load_dwordx2 v[48:49], v73, s[16:19], 0 offen
buffer_load_dwordx4 v[50:53], v72, s[16:19], 0 offen offset:0
buffer_load_dwordx2 v[54:55], v72, s[16:19], 0 offen offset:1016
buffer_load_dwordx4 v[56:59], v72, s[16:19], 0 offen offset:1024
v_add_f32 v3, v3, v91
v_cvt_pk_bf16_f32 v89, v90, v91
buffer_load_dwordx2 v[60:61], v72, s[16:19], 0 offen offset:2040
buffer_load_dwordx4 v[62:65], v72, s[16:19], 0 offen offset:2048
buffer_load_dwordx2 v[66:67], v72, s[16:19], 0 offen offset:3064
buffer_load_dwordx4 v[68:71], v72, s[16:19], 0 offen offset:3072
L_p3_mxm_end:
s_branch L_p3_eps
L_p3_d0_rare:
v_mov_b32 v240, v6
v_mov_b32 v241, v6
s_nop 1
v_permlane32_swap_b32 v240, v241
v_max_f32 v242, v240, v241
v_max_f32 v242, 0, v242
v_exp_f32 v8, -v242
v_sub_f32 v208, v208, v242
v_sub_f32 v209, v209, v242
v_sub_f32 v210, v210, v242
v_sub_f32 v211, v211, v242
v_sub_f32 v212, v212, v242
v_sub_f32 v213, v213, v242
v_sub_f32 v214, v214, v242
v_sub_f32 v215, v215, v242
v_sub_f32 v216, v216, v242
v_sub_f32 v217, v217, v242
v_sub_f32 v218, v218, v242
v_sub_f32 v219, v219, v242
v_sub_f32 v220, v220, v242
v_sub_f32 v221, v221, v242
v_sub_f32 v222, v222, v242
v_sub_f32 v223, v223, v242
v_mul_f32 v2, v2, v8
v_mul_f32 v3, v3, v8
v_sub_f32 v144, v144, v242
v_sub_f32 v145, v145, v242
v_sub_f32 v146, v146, v242
v_sub_f32 v147, v147, v242
v_sub_f32 v148, v148, v242
v_sub_f32 v149, v149, v242
v_sub_f32 v150, v150, v242
v_sub_f32 v151, v151, v242
v_sub_f32 v152, v152, v242
v_sub_f32 v153, v153, v242
v_sub_f32 v154, v154, v242
v_sub_f32 v155, v155, v242
v_sub_f32 v156, v156, v242
v_sub_f32 v157, v157, v242
v_sub_f32 v158, v158, v242
v_sub_f32 v159, v159, v242
v_sub_f32 v176, v176, v242
v_sub_f32 v177, v177, v242
v_sub_f32 v178, v178, v242
v_sub_f32 v179, v179, v242
v_sub_f32 v180, v180, v242
v_sub_f32 v181, v181, v242
v_sub_f32 v182, v182, v242
v_sub_f32 v183, v183, v242
v_sub_f32 v184, v184, v242
v_sub_f32 v185, v185, v242
v_sub_f32 v186, v186, v242
v_sub_f32 v187, v187, v242
v_sub_f32 v188, v188, v242
v_sub_f32 v189, v189, v242
v_sub_f32 v190, v190, v242
v_sub_f32 v191, v191, v242
v_mov_b32 v240, v7
v_mov_b32 v241, v7
s_nop 1
v_permlane32_swap_b32 v240, v241
v_max_f32 v242, v240, v241
v_max_f32 v242, 0, v242
v_exp_f32 v9, -v242
v_sub_f32 v224, v224, v242
v_sub_f32 v225, v225, v242
v_sub_f32 v226, v226, v242
v_sub_f32 v227, v227, v242
v_sub_f32 v228, v228, v242
v_sub_f32 v229, v229, v242
v_sub_f32 v230, v230, v242
v_sub_f32 v231, v231, v242
v_sub_f32 v232, v232, v242
v_sub_f32 v233, v233, v242
v_sub_f32 v234, v234, v242
v_sub_f32 v235, v235, v242
v_sub_f32 v236, v236, v242
v_sub_f32 v237, v237, v242
v_sub_f32 v238, v238, v242
v_sub_f32 v239, v239, v242
v_mul_f32 v4, v4, v9
v_mul_f32 v5, v5, v9
v_sub_f32 v160, v160, v242
v_sub_f32 v161, v161, v242
v_sub_f32 v162, v162, v242
v_sub_f32 v163, v163, v242
v_sub_f32 v164, v164, v242
v_sub_f32 v165, v165, v242
v_sub_f32 v166, v166, v242
v_sub_f32 v167, v167, v242
v_sub_f32 v168, v168, v242
v_sub_f32 v169, v169, v242
v_sub_f32 v170, v170, v242
v_sub_f32 v171, v171, v242
v_sub_f32 v172, v172, v242
v_sub_f32 v173, v173, v242
v_sub_f32 v174, v174, v242
v_sub_f32 v175, v175, v242
v_sub_f32 v192, v192, v242
v_sub_f32 v193, v193, v242
v_sub_f32 v194, v194, v242
v_sub_f32 v195, v195, v242
v_sub_f32 v196, v196, v242
v_sub_f32 v197, v197, v242
v_sub_f32 v198, v198, v242
v_sub_f32 v199, v199, v242
v_sub_f32 v200, v200, v242
v_sub_f32 v201, v201, v242
v_sub_f32 v202, v202, v242
v_sub_f32 v203, v203, v242
v_sub_f32 v204, v204, v242
v_sub_f32 v205, v205, v242
v_sub_f32 v206, v206, v242
v_sub_f32 v207, v207, v242
s_add_u32 m0, s72, 0
ds_read_b128 a[144:147], v10 offset:20480
v_exp_f32 v144, v144
v_exp_f32 v145, v145
v_mfma_f32_32x32x16_bf16 a[64:79], a[208:211], v[104:107], a[64:79]
ds_read_b128 a[148:151], v10 offset:21504
buffer_load_dwordx4 v12, s[52:55], s71 offen offset:0 sc1 lds
v_exp_f32 v146, v146
v_add_f32 v2, v2, v144
v_mfma_f32_32x32x16_bf16 a[16:31], a[212:215], v[88:91], a[16:31]
v_exp_f32 v147, v147
v_add_f32 v3, v3, v145
v_cvt_pk_bf16_f32 v144, v144, v145
v_mfma_f32_32x32x16_bf16 a[80:95], a[212:215], v[104:107], a[80:95]
ds_read_b128 a[152:155], v10 offset:22528
v_exp_f32 v148, v148
v_add_f32 v2, v2, v146
v_mfma_f32_32x32x16_bf16 a[32:47], a[216:219], v[88:91], a[32:47]
v_exp_f32 v149, v149
v_add_f32 v3, v3, v147
v_cvt_pk_bf16_f32 v145, v146, v147
v_mfma_f32_32x32x16_bf16 a[96:111], a[216:219], v[104:107], a[96:111]
ds_read_b128 a[156:159], v10 offset:23552
buffer_load_dwordx4 v12, s[52:55], s71 offen offset:1024 sc1 lds
v_exp_f32 v150, v150
v_add_f32 v2, v2, v148
v_mfma_f32_32x32x16_bf16 a[48:63], a[220:223], v[88:91], a[48:63]
ds_read_b128 a[160:163], v10 offset:24576
v_exp_f32 v151, v151
v_add_f32 v3, v3, v149
v_cvt_pk_bf16_f32 v146, v148, v149
v_mfma_f32_32x32x16_bf16 a[112:127], a[220:223], v[104:107], a[112:127]
v_exp_f32 v152, v152
v_add_f32 v2, v2, v150
v_mfma_f32_32x32x16_bf16 a[0:15], a[224:227], v[112:115], a[0:15]
ds_read_b128 a[164:167], v10 offset:25600
v_exp_f32 v153, v153
v_add_f32 v3, v3, v151
v_cvt_pk_bf16_f32 v147, v150, v151
v_mfma_f32_32x32x16_bf16 a[64:79], a[224:227], v[128:131], a[64:79]
v_exp_f32 v154, v154
v_add_f32 v2, v2, v152
v_mfma_f32_32x32x16_bf16 a[16:31], a[228:231], v[112:115], a[16:31]
ds_read_b128 a[168:171], v10 offset:26624
buffer_load_dwordx4 v12, s[52:55], s71 offen offset:2048 sc1 lds
v_exp_f32 v155, v155
v_add_f32 v3, v3, v153
v_cvt_pk_bf16_f32 v152, v152, v153
v_mfma_f32_32x32x16_bf16 a[80:95], a[228:231], v[128:131], a[80:95]
ds_read_b128 a[172:175], v10 offset:27648
v_exp_f32 v156, v156
v_add_f32 v2, v2, v154
v_mfma_f32_32x32x16_bf16 a[32:47], a[232:235], v[112:115], a[32:47]
v_exp_f32 v157, v157
v_add_f32 v3, v3, v155
v_cvt_pk_bf16_f32 v153, v154, v155
v_mfma_f32_32x32x16_bf16 a[96:111], a[232:235], v[128:131], a[96:111]
ds_read_b128 a[176:179], v10 offset:28672
v_exp_f32 v158, v158
v_add_f32 v2, v2, v156
v_mfma_f32_32x32x16_bf16 a[48:63], a[236:239], v[112:115], a[48:63]
buffer_load_dwordx4 v12, s[52:55], s71 offen offset:3072 sc1 lds
v_exp_f32 v159, v159
v_add_f32 v3, v3, v157
v_cvt_pk_bf16_f32 v154, v156, v157
v_mfma_f32_32x32x16_bf16 a[112:127], a[236:239], v[128:131], a[112:127]
ds_read_b128 a[180:183], v10 offset:29696
v_exp_f32 v160, v160
v_add_f32 v2, v2, v158
v_mfma_f32_32x32x16_bf16 a[0:15], a[240:243], v[120:123], a[0:15]
ds_read_b128 a[184:187], v10 offset:30720
v_exp_f32 v161, v161
v_add_f32 v3, v3, v159
v_cvt_pk_bf16_f32 v155, v158, v159
v_mfma_f32_32x32x16_bf16 a[64:79], a[240:243], v[136:139], a[64:79]
v_exp_f32 v162, v162
v_add_f32 v4, v4, v160
v_mfma_f32_32x32x16_bf16 a[16:31], a[244:247], v[120:123], a[16:31]
ds_read_b128 a[188:191], v10 offset:31744
v_exp_f32 v163, v163
v_add_f32 v5, v5, v161
v_cvt_pk_bf16_f32 v160, v160, v161
v_mfma_f32_32x32x16_bf16 a[80:95], a[244:247], v[136:139], a[80:95]
s_sub_u32 s74, s74, 1
v_exp_f32 v164, v164
v_add_f32 v4, v4, v162
v_mfma_f32_32x32x16_bf16 a[32:47], a[248:251], v[120:123], a[32:47]
v_exp_f32 v165, v165
v_add_f32 v5, v5, v163
v_cvt_pk_bf16_f32 v161, v162, v163
v_mfma_f32_32x32x16_bf16 a[96:111], a[248:251], v[136:139], a[96:111]
v_exp_f32 v166, v166
v_add_f32 v4, v4, v164
v_mfma_f32_32x32x16_bf16 a[48:63], a[252:255], v[120:123], a[48:63]
v_exp_f32 v167, v167
v_add_f32 v5, v5, v165
v_cvt_pk_bf16_f32 v162, v164, v165
v_mfma_f32_32x32x16_bf16 a[112:127], a[252:255], v[136:139], a[112:127]
v_add_f32 v4, v4, v166
v_add_f32 v5, v5, v167
v_cvt_pk_bf16_f32 v163, v166, v167
s_nop 15
v_accvgpr_read_b32 v240, a0
v_accvgpr_read_b32 v241, a1
v_accvgpr_read_b32 v242, a2
v_accvgpr_read_b32 v243, a3
v_accvgpr_read_b32 v244, a4
v_accvgpr_read_b32 v245, a5
v_accvgpr_read_b32 v246, a6
v_accvgpr_read_b32 v247, a7
v_mul_f32 v240, v240, v8
v_mul_f32 v241, v241, v8
v_mul_f32 v242, v242, v8
v_mul_f32 v243, v243, v8
v_mul_f32 v244, v244, v8
v_mul_f32 v245, v245, v8
v_mul_f32 v246, v246, v8
v_mul_f32 v247, v247, v8
v_accvgpr_write_b32 a0, v240
v_accvgpr_write_b32 a1, v241
v_accvgpr_write_b32 a2, v242
v_accvgpr_write_b32 a3, v243
v_accvgpr_write_b32 a4, v244
v_accvgpr_write_b32 a5, v245
v_accvgpr_write_b32 a6, v246
v_accvgpr_write_b32 a7, v247
v_accvgpr_read_b32 v240, a8
v_accvgpr_read_b32 v241, a9
v_accvgpr_read_b32 v242, a10
v_accvgpr_read_b32 v243, a11
v_accvgpr_read_b32 v244, a12
v_accvgpr_read_b32 v245, a13
v_accvgpr_read_b32 v246, a14
v_accvgpr_read_b32 v247, a15
v_mul_f32 v240, v240, v8
v_mul_f32 v241, v241, v8
v_mul_f32 v242, v242, v8
v_mul_f32 v243, v243, v8
v_mul_f32 v244, v244, v8
v_mul_f32 v245, v245, v8
v_mul_f32 v246, v246, v8
v_mul_f32 v247, v247, v8
v_accvgpr_write_b32 a8, v240
v_accvgpr_write_b32 a9, v241
v_accvgpr_write_b32 a10, v242
v_accvgpr_write_b32 a11, v243
v_accvgpr_write_b32 a12, v244
v_accvgpr_write_b32 a13, v245
v_accvgpr_write_b32 a14, v246
v_accvgpr_write_b32 a15, v247
v_accvgpr_read_b32 v240, a16
v_accvgpr_read_b32 v241, a17
v_accvgpr_read_b32 v242, a18
v_accvgpr_read_b32 v243, a19
v_accvgpr_read_b32 v244, a20
v_accvgpr_read_b32 v245, a21
v_accvgpr_read_b32 v246, a22
v_accvgpr_read_b32 v247, a23
v_mul_f32 v240, v240, v8
v_mul_f32 v241, v241, v8
v_mul_f32 v242, v242, v8
v_mul_f32 v243, v243, v8
v_mul_f32 v244, v244, v8
v_mul_f32 v245, v245, v8
v_mul_f32 v246, v246, v8
v_mul_f32 v247, v247, v8
v_accvgpr_write_b32 a16, v240
v_accvgpr_write_b32 a17, v241
v_accvgpr_write_b32 a18, v242
v_accvgpr_write_b32 a19, v243
v_accvgpr_write_b32 a20, v244
v_accvgpr_write_b32 a21, v245
v_accvgpr_write_b32 a22, v246
v_accvgpr_write_b32 a23, v247
v_accvgpr_read_b32 v240, a24
v_accvgpr_read_b32 v241, a25
v_accvgpr_read_b32 v242, a26
v_accvgpr_read_b32 v243, a27
v_accvgpr_read_b32 v244, a28
v_accvgpr_read_b32 v245, a29
v_accvgpr_read_b32 v246, a30
v_accvgpr_read_b32 v247, a31
v_mul_f32 v240, v240, v8
v_mul_f32 v241, v241, v8
v_mul_f32 v242, v242, v8
v_mul_f32 v243, v243, v8
v_mul_f32 v244, v244, v8
v_mul_f32 v245, v245, v8
v_mul_f32 v246, v246, v8
v_mul_f32 v247, v247, v8
v_accvgpr_write_b32 a24, v240
v_accvgpr_write_b32 a25, v241
v_accvgpr_write_b32 a26, v242
v_accvgpr_write_b32 a27, v243
v_accvgpr_write_b32 a28, v244
v_accvgpr_write_b32 a29, v245
v_accvgpr_write_b32 a30, v246
v_accvgpr_write_b32 a31, v247
v_accvgpr_read_b32 v240, a32
v_accvgpr_read_b32 v241, a33
v_accvgpr_read_b32 v242, a34
v_accvgpr_read_b32 v243, a35
v_accvgpr_read_b32 v244, a36
v_accvgpr_read_b32 v245, a37
v_accvgpr_read_b32 v246, a38
v_accvgpr_read_b32 v247, a39
v_mul_f32 v240, v240, v8
v_mul_f32 v241, v241, v8
v_mul_f32 v242, v242, v8
v_mul_f32 v243, v243, v8
v_mul_f32 v244, v244, v8
v_mul_f32 v245, v245, v8
v_mul_f32 v246, v246, v8
v_mul_f32 v247, v247, v8
v_accvgpr_write_b32 a32, v240
v_accvgpr_write_b32 a33, v241
v_accvgpr_write_b32 a34, v242
v_accvgpr_write_b32 a35, v243
v_accvgpr_write_b32 a36, v244
v_accvgpr_write_b32 a37, v245
v_accvgpr_write_b32 a38, v246
v_accvgpr_write_b32 a39, v247
v_accvgpr_read_b32 v240, a40
v_accvgpr_read_b32 v241, a41
v_accvgpr_read_b32 v242, a42
v_accvgpr_read_b32 v243, a43
v_accvgpr_read_b32 v244, a44
v_accvgpr_read_b32 v245, a45
v_accvgpr_read_b32 v246, a46
v_accvgpr_read_b32 v247, a47
v_mul_f32 v240, v240, v8
v_mul_f32 v241, v241, v8
v_mul_f32 v242, v242, v8
v_mul_f32 v243, v243, v8
v_mul_f32 v244, v244, v8
v_mul_f32 v245, v245, v8
v_mul_f32 v246, v246, v8
v_mul_f32 v247, v247, v8
v_accvgpr_write_b32 a40, v240
v_accvgpr_write_b32 a41, v241
v_accvgpr_write_b32 a42, v242
v_accvgpr_write_b32 a43, v243
v_accvgpr_write_b32 a44, v244
v_accvgpr_write_b32 a45, v245
v_accvgpr_write_b32 a46, v246
v_accvgpr_write_b32 a47, v247
v_accvgpr_read_b32 v240, a48
v_accvgpr_read_b32 v241, a49
v_accvgpr_read_b32 v242, a50
v_accvgpr_read_b32 v243, a51
v_accvgpr_read_b32 v244, a52
v_accvgpr_read_b32 v245, a53
v_accvgpr_read_b32 v246, a54
v_accvgpr_read_b32 v247, a55
v_mul_f32 v240, v240, v8
v_mul_f32 v241, v241, v8
v_mul_f32 v242, v242, v8
v_mul_f32 v243, v243, v8
v_mul_f32 v244, v244, v8
v_mul_f32 v245, v245, v8
v_mul_f32 v246, v246, v8
v_mul_f32 v247, v247, v8
v_accvgpr_write_b32 a48, v240
v_accvgpr_write_b32 a49, v241
v_accvgpr_write_b32 a50, v242
v_accvgpr_write_b32 a51, v243
v_accvgpr_write_b32 a52, v244
v_accvgpr_write_b32 a53, v245
v_accvgpr_write_b32 a54, v246
v_accvgpr_write_b32 a55, v247
v_accvgpr_read_b32 v240, a56
v_accvgpr_read_b32 v241, a57
v_accvgpr_read_b32 v242, a58
v_accvgpr_read_b32 v243, a59
v_accvgpr_read_b32 v244, a60
v_accvgpr_read_b32 v245, a61
v_accvgpr_read_b32 v246, a62
v_accvgpr_read_b32 v247, a63
v_mul_f32 v240, v240, v8
v_mul_f32 v241, v241, v8
v_mul_f32 v242, v242, v8
v_mul_f32 v243, v243, v8
v_mul_f32 v244, v244, v8
v_mul_f32 v245, v245, v8
v_mul_f32 v246, v246, v8
v_mul_f32 v247, v247, v8
v_accvgpr_write_b32 a56, v240
v_accvgpr_write_b32 a57, v241
v_accvgpr_write_b32 a58, v242
v_accvgpr_write_b32 a59, v243
v_accvgpr_write_b32 a60, v244
v_accvgpr_write_b32 a61, v245
v_accvgpr_write_b32 a62, v246
v_accvgpr_write_b32 a63, v247
v_accvgpr_read_b32 v240, a64
v_accvgpr_read_b32 v241, a65
v_accvgpr_read_b32 v242, a66
v_accvgpr_read_b32 v243, a67
v_accvgpr_read_b32 v244, a68
v_accvgpr_read_b32 v245, a69
v_accvgpr_read_b32 v246, a70
v_accvgpr_read_b32 v247, a71
v_mul_f32 v240, v240, v9
v_mul_f32 v241, v241, v9
v_mul_f32 v242, v242, v9
v_mul_f32 v243, v243, v9
v_mul_f32 v244, v244, v9
v_mul_f32 v245, v245, v9
v_mul_f32 v246, v246, v9
v_mul_f32 v247, v247, v9
v_accvgpr_write_b32 a64, v240
v_accvgpr_write_b32 a65, v241
v_accvgpr_write_b32 a66, v242
v_accvgpr_write_b32 a67, v243
v_accvgpr_write_b32 a68, v244
v_accvgpr_write_b32 a69, v245
v_accvgpr_write_b32 a70, v246
v_accvgpr_write_b32 a71, v247
v_accvgpr_read_b32 v240, a72
v_accvgpr_read_b32 v241, a73
v_accvgpr_read_b32 v242, a74
v_accvgpr_read_b32 v243, a75
v_accvgpr_read_b32 v244, a76
v_accvgpr_read_b32 v245, a77
v_accvgpr_read_b32 v246, a78
v_accvgpr_read_b32 v247, a79
v_mul_f32 v240, v240, v9
v_mul_f32 v241, v241, v9
v_mul_f32 v242, v242, v9
v_mul_f32 v243, v243, v9
v_mul_f32 v244, v244, v9
v_mul_f32 v245, v245, v9
v_mul_f32 v246, v246, v9
v_mul_f32 v247, v247, v9
v_accvgpr_write_b32 a72, v240
v_accvgpr_write_b32 a73, v241
v_accvgpr_write_b32 a74, v242
v_accvgpr_write_b32 a75, v243
v_accvgpr_write_b32 a76, v244
v_accvgpr_write_b32 a77, v245
v_accvgpr_write_b32 a78, v246
v_accvgpr_write_b32 a79, v247
v_accvgpr_read_b32 v240, a80
v_accvgpr_read_b32 v241, a81
v_accvgpr_read_b32 v242, a82
v_accvgpr_read_b32 v243, a83
v_accvgpr_read_b32 v244, a84
v_accvgpr_read_b32 v245, a85
v_accvgpr_read_b32 v246, a86
v_accvgpr_read_b32 v247, a87
v_mul_f32 v240, v240, v9
v_mul_f32 v241, v241, v9
v_mul_f32 v242, v242, v9
v_mul_f32 v243, v243, v9
v_mul_f32 v244, v244, v9
v_mul_f32 v245, v245, v9
v_mul_f32 v246, v246, v9
v_mul_f32 v247, v247, v9
v_accvgpr_write_b32 a80, v240
v_accvgpr_write_b32 a81, v241
v_accvgpr_write_b32 a82, v242
v_accvgpr_write_b32 a83, v243
v_accvgpr_write_b32 a84, v244
v_accvgpr_write_b32 a85, v245
v_accvgpr_write_b32 a86, v246
v_accvgpr_write_b32 a87, v247
v_accvgpr_read_b32 v240, a88
v_accvgpr_read_b32 v241, a89
v_accvgpr_read_b32 v242, a90
v_accvgpr_read_b32 v243, a91
v_accvgpr_read_b32 v244, a92
v_accvgpr_read_b32 v245, a93
v_accvgpr_read_b32 v246, a94
v_accvgpr_read_b32 v247, a95
v_mul_f32 v240, v240, v9
v_mul_f32 v241, v241, v9
v_mul_f32 v242, v242, v9
v_mul_f32 v243, v243, v9
v_mul_f32 v244, v244, v9
v_mul_f32 v245, v245, v9
v_mul_f32 v246, v246, v9
v_mul_f32 v247, v247, v9
v_accvgpr_write_b32 a88, v240
v_accvgpr_write_b32 a89, v241
v_accvgpr_write_b32 a90, v242
v_accvgpr_write_b32 a91, v243
v_accvgpr_write_b32 a92, v244
v_accvgpr_write_b32 a93, v245
v_accvgpr_write_b32 a94, v246
v_accvgpr_write_b32 a95, v247
v_accvgpr_read_b32 v240, a96
v_accvgpr_read_b32 v241, a97
v_accvgpr_read_b32 v242, a98
v_accvgpr_read_b32 v243, a99
v_accvgpr_read_b32 v244, a100
v_accvgpr_read_b32 v245, a101
v_accvgpr_read_b32 v246, a102
v_accvgpr_read_b32 v247, a103
v_mul_f32 v240, v240, v9
v_mul_f32 v241, v241, v9
v_mul_f32 v242, v242, v9
v_mul_f32 v243, v243, v9
v_mul_f32 v244, v244, v9
v_mul_f32 v245, v245, v9
v_mul_f32 v246, v246, v9
v_mul_f32 v247, v247, v9
v_accvgpr_write_b32 a96, v240
v_accvgpr_write_b32 a97, v241
v_accvgpr_write_b32 a98, v242
v_accvgpr_write_b32 a99, v243
v_accvgpr_write_b32 a100, v244
v_accvgpr_write_b32 a101, v245
v_accvgpr_write_b32 a102, v246
v_accvgpr_write_b32 a103, v247
v_accvgpr_read_b32 v240, a104
v_accvgpr_read_b32 v241, a105
v_accvgpr_read_b32 v242, a106
v_accvgpr_read_b32 v243, a107
v_accvgpr_read_b32 v244, a108
v_accvgpr_read_b32 v245, a109
v_accvgpr_read_b32 v246, a110
v_accvgpr_read_b32 v247, a111
v_mul_f32 v240, v240, v9
v_mul_f32 v241, v241, v9
v_mul_f32 v242, v242, v9
v_mul_f32 v243, v243, v9
v_mul_f32 v244, v244, v9
v_mul_f32 v245, v245, v9
v_mul_f32 v246, v246, v9
v_mul_f32 v247, v247, v9
v_accvgpr_write_b32 a104, v240
v_accvgpr_write_b32 a105, v241
v_accvgpr_write_b32 a106, v242
v_accvgpr_write_b32 a107, v243
v_accvgpr_write_b32 a108, v244
v_accvgpr_write_b32 a109, v245
v_accvgpr_write_b32 a110, v246
v_accvgpr_write_b32 a111, v247
v_accvgpr_read_b32 v240, a112
v_accvgpr_read_b32 v241, a113
v_accvgpr_read_b32 v242, a114
v_accvgpr_read_b32 v243, a115
v_accvgpr_read_b32 v244, a116
v_accvgpr_read_b32 v245, a117
v_accvgpr_read_b32 v246, a118
v_accvgpr_read_b32 v247, a119
v_mul_f32 v240, v240, v9
v_mul_f32 v241, v241, v9
v_mul_f32 v242, v242, v9
v_mul_f32 v243, v243, v9
v_mul_f32 v244, v244, v9
v_mul_f32 v245, v245, v9
v_mul_f32 v246, v246, v9
v_mul_f32 v247, v247, v9
v_accvgpr_write_b32 a112, v240
v_accvgpr_write_b32 a113, v241
v_accvgpr_write_b32 a114, v242
v_accvgpr_write_b32 a115, v243
v_accvgpr_write_b32 a116, v244
v_accvgpr_write_b32 a117, v245
v_accvgpr_write_b32 a118, v246
v_accvgpr_write_b32 a119, v247
v_accvgpr_read_b32 v240, a120
v_accvgpr_read_b32 v241, a121
v_accvgpr_read_b32 v242, a122
v_accvgpr_read_b32 v243, a123
v_accvgpr_read_b32 v244, a124
v_accvgpr_read_b32 v245, a125
v_accvgpr_read_b32 v246, a126
v_accvgpr_read_b32 v247, a127
v_mul_f32 v240, v240, v9
v_mul_f32 v241, v241, v9
v_mul_f32 v242, v242, v9
v_mul_f32 v243, v243, v9
v_mul_f32 v244, v244, v9
v_mul_f32 v245, v245, v9
v_mul_f32 v246, v246, v9
v_mul_f32 v247, v247, v9
v_accvgpr_write_b32 a120, v240
v_accvgpr_write_b32 a121, v241
v_accvgpr_write_b32 a122, v242
v_accvgpr_write_b32 a123, v243
v_accvgpr_write_b32 a124, v244
v_accvgpr_write_b32 a125, v245
v_accvgpr_write_b32 a126, v246
v_accvgpr_write_b32 a127, v247
s_nop 1
s_branch L_p3_d0_end
L_p3_d1_rare:
v_mov_b32 v240, v6
v_mov_b32 v241, v6
s_nop 1
v_permlane32_swap_b32 v240, v241
v_max_f32 v242, v240, v241
v_max_f32 v242, 0, v242
v_exp_f32 v8, -v242
v_sub_f32 v208, v208, v242
v_sub_f32 v209, v209, v242
v_sub_f32 v210, v210, v242
v_sub_f32 v211, v211, v242
v_sub_f32 v212, v212, v242
v_sub_f32 v213, v213, v242
v_sub_f32 v214, v214, v242
v_sub_f32 v215, v215, v242
v_sub_f32 v216, v216, v242
v_sub_f32 v217, v217, v242
v_sub_f32 v218, v218, v242
v_sub_f32 v219, v219, v242
v_sub_f32 v220, v220, v242
v_sub_f32 v221, v221, v242
v_sub_f32 v222, v222, v242
v_sub_f32 v223, v223, v242
v_mul_f32 v2, v2, v8
v_mul_f32 v3, v3, v8
v_sub_f32 v80, v80, v242
v_sub_f32 v81, v81, v242
v_sub_f32 v82, v82, v242
v_sub_f32 v83, v83, v242
v_sub_f32 v84, v84, v242
v_sub_f32 v85, v85, v242
v_sub_f32 v86, v86, v242
v_sub_f32 v87, v87, v242
v_sub_f32 v88, v88, v242
v_sub_f32 v89, v89, v242
v_sub_f32 v90, v90, v242
v_sub_f32 v91, v91, v242
v_sub_f32 v92, v92, v242
v_sub_f32 v93, v93, v242
v_sub_f32 v94, v94, v242
v_sub_f32 v95, v95, v242
v_sub_f32 v112, v112, v242
v_sub_f32 v113, v113, v242
v_sub_f32 v114, v114, v242
v_sub_f32 v115, v115, v242
v_sub_f32 v116, v116, v242
v_sub_f32 v117, v117, v242
v_sub_f32 v118, v118, v242
v_sub_f32 v119, v119, v242
v_sub_f32 v120, v120, v242
v_sub_f32 v121, v121, v242
v_sub_f32 v122, v122, v242
v_sub_f32 v123, v123, v242
v_sub_f32 v124, v124, v242
v_sub_f32 v125, v125, v242
v_sub_f32 v126, v126, v242
v_sub_f32 v127, v127, v242
v_mov_b32 v240, v7
v_mov_b32 v241, v7
s_nop 1
v_permlane32_swap_b32 v240, v241
v_max_f32 v242, v240, v241
v_max_f32 v242, 0, v242
v_exp_f32 v9, -v242
v_sub_f32 v224, v224, v242
v_sub_f32 v225, v225, v242
v_sub_f32 v226, v226, v242
v_sub_f32 v227, v227, v242
v_sub_f32 v228, v228, v242
v_sub_f32 v229, v229, v242
v_sub_f32 v230, v230, v242
v_sub_f32 v231, v231, v242
v_sub_f32 v232, v232, v242
v_sub_f32 v233, v233, v242
v_sub_f32 v234, v234, v242
v_sub_f32 v235, v235, v242
v_sub_f32 v236, v236, v242
v_sub_f32 v237, v237, v242
v_sub_f32 v238, v238, v242
v_sub_f32 v239, v239, v242
v_mul_f32 v4, v4, v9
v_mul_f32 v5, v5, v9
v_sub_f32 v96, v96, v242
v_sub_f32 v97, v97, v242
v_sub_f32 v98, v98, v242
v_sub_f32 v99, v99, v242
v_sub_f32 v100, v100, v242
v_sub_f32 v101, v101, v242
v_sub_f32 v102, v102, v242
v_sub_f32 v103, v103, v242
v_sub_f32 v104, v104, v242
v_sub_f32 v105, v105, v242
v_sub_f32 v106, v106, v242
v_sub_f32 v107, v107, v242
v_sub_f32 v108, v108, v242
v_sub_f32 v109, v109, v242
v_sub_f32 v110, v110, v242
v_sub_f32 v111, v111, v242
v_sub_f32 v128, v128, v242
v_sub_f32 v129, v129, v242
v_sub_f32 v130, v130, v242
v_sub_f32 v131, v131, v242
v_sub_f32 v132, v132, v242
v_sub_f32 v133, v133, v242
v_sub_f32 v134, v134, v242
v_sub_f32 v135, v135, v242
v_sub_f32 v136, v136, v242
v_sub_f32 v137, v137, v242
v_sub_f32 v138, v138, v242
v_sub_f32 v139, v139, v242
v_sub_f32 v140, v140, v242
v_sub_f32 v141, v141, v242
v_sub_f32 v142, v142, v242
v_sub_f32 v143, v143, v242
s_add_u32 m0, s72, 16384
ds_read_b128 a[144:147], v10 offset:4096
v_exp_f32 v80, v80
v_exp_f32 v81, v81
v_mfma_f32_32x32x16_bf16 a[64:79], a[208:211], v[168:171], a[64:79]
ds_read_b128 a[148:151], v10 offset:5120
buffer_load_dwordx4 v12, s[52:55], s71 offen offset:0 sc1 lds
v_exp_f32 v82, v82
v_add_f32 v2, v2, v80
v_mfma_f32_32x32x16_bf16 a[16:31], a[212:215], v[152:155], a[16:31]
v_exp_f32 v83, v83
v_add_f32 v3, v3, v81
v_cvt_pk_bf16_f32 v80, v80, v81
v_mfma_f32_32x32x16_bf16 a[80:95], a[212:215], v[168:171], a[80:95]
ds_read_b128 a[152:155], v10 offset:6144
v_exp_f32 v84, v84
v_add_f32 v2, v2, v82
v_mfma_f32_32x32x16_bf16 a[32:47], a[216:219], v[152:155], a[32:47]
v_exp_f32 v85, v85
v_add_f32 v3, v3, v83
v_cvt_pk_bf16_f32 v81, v82, v83
v_mfma_f32_32x32x16_bf16 a[96:111], a[216:219], v[168:171], a[96:111]
ds_read_b128 a[156:159], v10 offset:7168
buffer_load_dwordx4 v12, s[52:55], s71 offen offset:1024 sc1 lds
v_exp_f32 v86, v86
v_add_f32 v2, v2, v84
v_mfma_f32_32x32x16_bf16 a[48:63], a[220:223], v[152:155], a[48:63]
ds_read_b128 a[160:163], v10 offset:8192
v_exp_f32 v87, v87
v_add_f32 v3, v3, v85
v_cvt_pk_bf16_f32 v82, v84, v85
v_mfma_f32_32x32x16_bf16 a[112:127], a[220:223], v[168:171], a[112:127]
v_exp_f32 v88, v88
v_add_f32 v2, v2, v86
v_mfma_f32_32x32x16_bf16 a[0:15], a[224:227], v[176:179], a[0:15]
ds_read_b128 a[164:167], v10 offset:9216
v_exp_f32 v89, v89
v_add_f32 v3, v3, v87
v_cvt_pk_bf16_f32 v83, v86, v87
v_mfma_f32_32x32x16_bf16 a[64:79], a[224:227], v[192:195], a[64:79]
v_exp_f32 v90, v90
v_add_f32 v2, v2, v88
v_mfma_f32_32x32x16_bf16 a[16:31], a[228:231], v[176:179], a[16:31]
ds_read_b128 a[168:171], v10 offset:10240
buffer_load_dwordx4 v12, s[52:55], s71 offen offset:2048 sc1 lds
v_exp_f32 v91, v91
v_add_f32 v3, v3, v89
v_cvt_pk_bf16_f32 v88, v88, v89
v_mfma_f32_32x32x16_bf16 a[80:95], a[228:231], v[192:195], a[80:95]
ds_read_b128 a[172:175], v10 offset:11264
v_exp_f32 v92, v92
v_add_f32 v2, v2, v90
v_mfma_f32_32x32x16_bf16 a[32:47], a[232:235], v[176:179], a[32:47]
v_exp_f32 v93, v93
v_add_f32 v3, v3, v91
v_cvt_pk_bf16_f32 v89, v90, v91
v_mfma_f32_32x32x16_bf16 a[96:111], a[232:235], v[192:195], a[96:111]
ds_read_b128 a[176:179], v10 offset:12288
v_exp_f32 v94, v94
v_add_f32 v2, v2, v92
v_mfma_f32_32x32x16_bf16 a[48:63], a[236:239], v[176:179], a[48:63]
buffer_load_dwordx4 v12, s[52:55], s71 offen offset:3072 sc1 lds
v_exp_f32 v95, v95
v_add_f32 v3, v3, v93
v_cvt_pk_bf16_f32 v90, v92, v93
v_mfma_f32_32x32x16_bf16 a[112:127], a[236:239], v[192:195], a[112:127]
ds_read_b128 a[180:183], v10 offset:13312
v_exp_f32 v96, v96
v_add_f32 v2, v2, v94
v_mfma_f32_32x32x16_bf16 a[0:15], a[240:243], v[184:187], a[0:15]
ds_read_b128 a[184:187], v10 offset:14336
v_exp_f32 v97, v97
v_add_f32 v3, v3, v95
v_cvt_pk_bf16_f32 v91, v94, v95
v_mfma_f32_32x32x16_bf16 a[64:79], a[240:243], v[200:203], a[64:79]
v_exp_f32 v98, v98
v_add_f32 v4, v4, v96
v_mfma_f32_32x32x16_bf16 a[16:31], a[244:247], v[184:187], a[16:31]
ds_read_b128 a[188:191], v10 offset:15360
v_exp_f32 v99, v99
v_add_f32 v5, v5, v97
v_cvt_pk_bf16_f32 v96, v96, v97
v_mfma_f32_32x32x16_bf16 a[80:95], a[244:247], v[200:203], a[80:95]
s_xor_b32 s72, s72, 0x8000
v_exp_f32 v100, v100
v_add_f32 v4, v4, v98
v_mfma_f32_32x32x16_bf16 a[32:47], a[248:251], v[184:187], a[32:47]
v_exp_f32 v101, v101
v_add_f32 v5, v5, v99
v_cvt_pk_bf16_f32 v97, v98, v99
v_mfma_f32_32x32x16_bf16 a[96:111], a[248:251], v[200:203], a[96:111]
v_exp_f32 v102, v102
v_add_f32 v4, v4, v100
v_mfma_f32_32x32x16_bf16 a[48:63], a[252:255], v[184:187], a[48:63]
v_exp_f32 v103, v103
v_add_f32 v5, v5, v101
v_cvt_pk_bf16_f32 v98, v100, v101
v_mfma_f32_32x32x16_bf16 a[112:127], a[252:255], v[200:203], a[112:127]
v_add_f32 v4, v4, v102
v_add_f32 v5, v5, v103
v_cvt_pk_bf16_f32 v99, v102, v103
s_nop 15
v_accvgpr_read_b32 v240, a0
v_accvgpr_read_b32 v241, a1
v_accvgpr_read_b32 v242, a2
v_accvgpr_read_b32 v243, a3
v_accvgpr_read_b32 v244, a4
v_accvgpr_read_b32 v245, a5
v_accvgpr_read_b32 v246, a6
v_accvgpr_read_b32 v247, a7
v_mul_f32 v240, v240, v8
v_mul_f32 v241, v241, v8
v_mul_f32 v242, v242, v8
v_mul_f32 v243, v243, v8
v_mul_f32 v244, v244, v8
v_mul_f32 v245, v245, v8
v_mul_f32 v246, v246, v8
v_mul_f32 v247, v247, v8
v_accvgpr_write_b32 a0, v240
v_accvgpr_write_b32 a1, v241
v_accvgpr_write_b32 a2, v242
v_accvgpr_write_b32 a3, v243
v_accvgpr_write_b32 a4, v244
v_accvgpr_write_b32 a5, v245
v_accvgpr_write_b32 a6, v246
v_accvgpr_write_b32 a7, v247
v_accvgpr_read_b32 v240, a8
v_accvgpr_read_b32 v241, a9
v_accvgpr_read_b32 v242, a10
v_accvgpr_read_b32 v243, a11
v_accvgpr_read_b32 v244, a12
v_accvgpr_read_b32 v245, a13
v_accvgpr_read_b32 v246, a14
v_accvgpr_read_b32 v247, a15
v_mul_f32 v240, v240, v8
v_mul_f32 v241, v241, v8
v_mul_f32 v242, v242, v8
v_mul_f32 v243, v243, v8
v_mul_f32 v244, v244, v8
v_mul_f32 v245, v245, v8
v_mul_f32 v246, v246, v8
v_mul_f32 v247, v247, v8
v_accvgpr_write_b32 a8, v240
v_accvgpr_write_b32 a9, v241
v_accvgpr_write_b32 a10, v242
v_accvgpr_write_b32 a11, v243
v_accvgpr_write_b32 a12, v244
v_accvgpr_write_b32 a13, v245
v_accvgpr_write_b32 a14, v246
v_accvgpr_write_b32 a15, v247
v_accvgpr_read_b32 v240, a16
v_accvgpr_read_b32 v241, a17
v_accvgpr_read_b32 v242, a18
v_accvgpr_read_b32 v243, a19
v_accvgpr_read_b32 v244, a20
v_accvgpr_read_b32 v245, a21
v_accvgpr_read_b32 v246, a22
v_accvgpr_read_b32 v247, a23
v_mul_f32 v240, v240, v8
v_mul_f32 v241, v241, v8
v_mul_f32 v242, v242, v8
v_mul_f32 v243, v243, v8
v_mul_f32 v244, v244, v8
v_mul_f32 v245, v245, v8
v_mul_f32 v246, v246, v8
v_mul_f32 v247, v247, v8
v_accvgpr_write_b32 a16, v240
v_accvgpr_write_b32 a17, v241
v_accvgpr_write_b32 a18, v242
v_accvgpr_write_b32 a19, v243
v_accvgpr_write_b32 a20, v244
v_accvgpr_write_b32 a21, v245
v_accvgpr_write_b32 a22, v246
v_accvgpr_write_b32 a23, v247
v_accvgpr_read_b32 v240, a24
v_accvgpr_read_b32 v241, a25
v_accvgpr_read_b32 v242, a26
v_accvgpr_read_b32 v243, a27
v_accvgpr_read_b32 v244, a28
v_accvgpr_read_b32 v245, a29
v_accvgpr_read_b32 v246, a30
v_accvgpr_read_b32 v247, a31
v_mul_f32 v240, v240, v8
v_mul_f32 v241, v241, v8
v_mul_f32 v242, v242, v8
v_mul_f32 v243, v243, v8
v_mul_f32 v244, v244, v8
v_mul_f32 v245, v245, v8
v_mul_f32 v246, v246, v8
v_mul_f32 v247, v247, v8
v_accvgpr_write_b32 a24, v240
v_accvgpr_write_b32 a25, v241
v_accvgpr_write_b32 a26, v242
v_accvgpr_write_b32 a27, v243
v_accvgpr_write_b32 a28, v244
v_accvgpr_write_b32 a29, v245
v_accvgpr_write_b32 a30, v246
v_accvgpr_write_b32 a31, v247
v_accvgpr_read_b32 v240, a32
v_accvgpr_read_b32 v241, a33
v_accvgpr_read_b32 v242, a34
v_accvgpr_read_b32 v243, a35
v_accvgpr_read_b32 v244, a36
v_accvgpr_read_b32 v245, a37
v_accvgpr_read_b32 v246, a38
v_accvgpr_read_b32 v247, a39
v_mul_f32 v240, v240, v8
v_mul_f32 v241, v241, v8
v_mul_f32 v242, v242, v8
v_mul_f32 v243, v243, v8
v_mul_f32 v244, v244, v8
v_mul_f32 v245, v245, v8
v_mul_f32 v246, v246, v8
v_mul_f32 v247, v247, v8
v_accvgpr_write_b32 a32, v240
v_accvgpr_write_b32 a33, v241
v_accvgpr_write_b32 a34, v242
v_accvgpr_write_b32 a35, v243
v_accvgpr_write_b32 a36, v244
v_accvgpr_write_b32 a37, v245
v_accvgpr_write_b32 a38, v246
v_accvgpr_write_b32 a39, v247
v_accvgpr_read_b32 v240, a40
v_accvgpr_read_b32 v241, a41
v_accvgpr_read_b32 v242, a42
v_accvgpr_read_b32 v243, a43
v_accvgpr_read_b32 v244, a44
v_accvgpr_read_b32 v245, a45
v_accvgpr_read_b32 v246, a46
v_accvgpr_read_b32 v247, a47
v_mul_f32 v240, v240, v8
v_mul_f32 v241, v241, v8
v_mul_f32 v242, v242, v8
v_mul_f32 v243, v243, v8
v_mul_f32 v244, v244, v8
v_mul_f32 v245, v245, v8
v_mul_f32 v246, v246, v8
v_mul_f32 v247, v247, v8
v_accvgpr_write_b32 a40, v240
v_accvgpr_write_b32 a41, v241
v_accvgpr_write_b32 a42, v242
v_accvgpr_write_b32 a43, v243
v_accvgpr_write_b32 a44, v244
v_accvgpr_write_b32 a45, v245
v_accvgpr_write_b32 a46, v246
v_accvgpr_write_b32 a47, v247
v_accvgpr_read_b32 v240, a48
v_accvgpr_read_b32 v241, a49
v_accvgpr_read_b32 v242, a50
v_accvgpr_read_b32 v243, a51
v_accvgpr_read_b32 v244, a52
v_accvgpr_read_b32 v245, a53
v_accvgpr_read_b32 v246, a54
v_accvgpr_read_b32 v247, a55
v_mul_f32 v240, v240, v8
v_mul_f32 v241, v241, v8
v_mul_f32 v242, v242, v8
v_mul_f32 v243, v243, v8
v_mul_f32 v244, v244, v8
v_mul_f32 v245, v245, v8
v_mul_f32 v246, v246, v8
v_mul_f32 v247, v247, v8
v_accvgpr_write_b32 a48, v240
v_accvgpr_write_b32 a49, v241
v_accvgpr_write_b32 a50, v242
v_accvgpr_write_b32 a51, v243
v_accvgpr_write_b32 a52, v244
v_accvgpr_write_b32 a53, v245
v_accvgpr_write_b32 a54, v246
v_accvgpr_write_b32 a55, v247
v_accvgpr_read_b32 v240, a56
v_accvgpr_read_b32 v241, a57
v_accvgpr_read_b32 v242, a58
v_accvgpr_read_b32 v243, a59
v_accvgpr_read_b32 v244, a60
v_accvgpr_read_b32 v245, a61
v_accvgpr_read_b32 v246, a62
v_accvgpr_read_b32 v247, a63
v_mul_f32 v240, v240, v8
v_mul_f32 v241, v241, v8
v_mul_f32 v242, v242, v8
v_mul_f32 v243, v243, v8
v_mul_f32 v244, v244, v8
v_mul_f32 v245, v245, v8
v_mul_f32 v246, v246, v8
v_mul_f32 v247, v247, v8
v_accvgpr_write_b32 a56, v240
v_accvgpr_write_b32 a57, v241
v_accvgpr_write_b32 a58, v242
v_accvgpr_write_b32 a59, v243
v_accvgpr_write_b32 a60, v244
v_accvgpr_write_b32 a61, v245
v_accvgpr_write_b32 a62, v246
v_accvgpr_write_b32 a63, v247
v_accvgpr_read_b32 v240, a64
v_accvgpr_read_b32 v241, a65
v_accvgpr_read_b32 v242, a66
v_accvgpr_read_b32 v243, a67
v_accvgpr_read_b32 v244, a68
v_accvgpr_read_b32 v245, a69
v_accvgpr_read_b32 v246, a70
v_accvgpr_read_b32 v247, a71
v_mul_f32 v240, v240, v9
v_mul_f32 v241, v241, v9
v_mul_f32 v242, v242, v9
v_mul_f32 v243, v243, v9
v_mul_f32 v244, v244, v9
v_mul_f32 v245, v245, v9
v_mul_f32 v246, v246, v9
v_mul_f32 v247, v247, v9
v_accvgpr_write_b32 a64, v240
v_accvgpr_write_b32 a65, v241
v_accvgpr_write_b32 a66, v242
v_accvgpr_write_b32 a67, v243
v_accvgpr_write_b32 a68, v244
v_accvgpr_write_b32 a69, v245
v_accvgpr_write_b32 a70, v246
v_accvgpr_write_b32 a71, v247
v_accvgpr_read_b32 v240, a72
v_accvgpr_read_b32 v241, a73
v_accvgpr_read_b32 v242, a74
v_accvgpr_read_b32 v243, a75
v_accvgpr_read_b32 v244, a76
v_accvgpr_read_b32 v245, a77
v_accvgpr_read_b32 v246, a78
v_accvgpr_read_b32 v247, a79
v_mul_f32 v240, v240, v9
v_mul_f32 v241, v241, v9
v_mul_f32 v242, v242, v9
v_mul_f32 v243, v243, v9
v_mul_f32 v244, v244, v9
v_mul_f32 v245, v245, v9
v_mul_f32 v246, v246, v9
v_mul_f32 v247, v247, v9
v_accvgpr_write_b32 a72, v240
v_accvgpr_write_b32 a73, v241
v_accvgpr_write_b32 a74, v242
v_accvgpr_write_b32 a75, v243
v_accvgpr_write_b32 a76, v244
v_accvgpr_write_b32 a77, v245
v_accvgpr_write_b32 a78, v246
v_accvgpr_write_b32 a79, v247
v_accvgpr_read_b32 v240, a80
v_accvgpr_read_b32 v241, a81
v_accvgpr_read_b32 v242, a82
v_accvgpr_read_b32 v243, a83
v_accvgpr_read_b32 v244, a84
v_accvgpr_read_b32 v245, a85
v_accvgpr_read_b32 v246, a86
v_accvgpr_read_b32 v247, a87
v_mul_f32 v240, v240, v9
v_mul_f32 v241, v241, v9
v_mul_f32 v242, v242, v9
v_mul_f32 v243, v243, v9
v_mul_f32 v244, v244, v9
v_mul_f32 v245, v245, v9
v_mul_f32 v246, v246, v9
v_mul_f32 v247, v247, v9
v_accvgpr_write_b32 a80, v240
v_accvgpr_write_b32 a81, v241
v_accvgpr_write_b32 a82, v242
v_accvgpr_write_b32 a83, v243
v_accvgpr_write_b32 a84, v244
v_accvgpr_write_b32 a85, v245
v_accvgpr_write_b32 a86, v246
v_accvgpr_write_b32 a87, v247
v_accvgpr_read_b32 v240, a88
v_accvgpr_read_b32 v241, a89
v_accvgpr_read_b32 v242, a90
v_accvgpr_read_b32 v243, a91
v_accvgpr_read_b32 v244, a92
v_accvgpr_read_b32 v245, a93
v_accvgpr_read_b32 v246, a94
v_accvgpr_read_b32 v247, a95
v_mul_f32 v240, v240, v9
v_mul_f32 v241, v241, v9
v_mul_f32 v242, v242, v9
v_mul_f32 v243, v243, v9
v_mul_f32 v244, v244, v9
v_mul_f32 v245, v245, v9
v_mul_f32 v246, v246, v9
v_mul_f32 v247, v247, v9
v_accvgpr_write_b32 a88, v240
v_accvgpr_write_b32 a89, v241
v_accvgpr_write_b32 a90, v242
v_accvgpr_write_b32 a91, v243
v_accvgpr_write_b32 a92, v244
v_accvgpr_write_b32 a93, v245
v_accvgpr_write_b32 a94, v246
v_accvgpr_write_b32 a95, v247
v_accvgpr_read_b32 v240, a96
v_accvgpr_read_b32 v241, a97
v_accvgpr_read_b32 v242, a98
v_accvgpr_read_b32 v243, a99
v_accvgpr_read_b32 v244, a100
v_accvgpr_read_b32 v245, a101
v_accvgpr_read_b32 v246, a102
v_accvgpr_read_b32 v247, a103
v_mul_f32 v240, v240, v9
v_mul_f32 v241, v241, v9
v_mul_f32 v242, v242, v9
v_mul_f32 v243, v243, v9
v_mul_f32 v244, v244, v9
v_mul_f32 v245, v245, v9
v_mul_f32 v246, v246, v9
v_mul_f32 v247, v247, v9
v_accvgpr_write_b32 a96, v240
v_accvgpr_write_b32 a97, v241
v_accvgpr_write_b32 a98, v242
v_accvgpr_write_b32 a99, v243
v_accvgpr_write_b32 a100, v244
v_accvgpr_write_b32 a101, v245
v_accvgpr_write_b32 a102, v246
v_accvgpr_write_b32 a103, v247
v_accvgpr_read_b32 v240, a104
v_accvgpr_read_b32 v241, a105
v_accvgpr_read_b32 v242, a106
v_accvgpr_read_b32 v243, a107
v_accvgpr_read_b32 v244, a108
v_accvgpr_read_b32 v245, a109
v_accvgpr_read_b32 v246, a110
v_accvgpr_read_b32 v247, a111
v_mul_f32 v240, v240, v9
v_mul_f32 v241, v241, v9
v_mul_f32 v242, v242, v9
v_mul_f32 v243, v243, v9
v_mul_f32 v244, v244, v9
v_mul_f32 v245, v245, v9
v_mul_f32 v246, v246, v9
v_mul_f32 v247, v247, v9
v_accvgpr_write_b32 a104, v240
v_accvgpr_write_b32 a105, v241
v_accvgpr_write_b32 a106, v242
v_accvgpr_write_b32 a107, v243
v_accvgpr_write_b32 a108, v244
v_accvgpr_write_b32 a109, v245
v_accvgpr_write_b32 a110, v246
v_accvgpr_write_b32 a111, v247
v_accvgpr_read_b32 v240, a112
v_accvgpr_read_b32 v241, a113
v_accvgpr_read_b32 v242, a114
v_accvgpr_read_b32 v243, a115
v_accvgpr_read_b32 v244, a116
v_accvgpr_read_b32 v245, a117
v_accvgpr_read_b32 v246, a118
v_accvgpr_read_b32 v247, a119
v_mul_f32 v240, v240, v9
v_mul_f32 v241, v241, v9
v_mul_f32 v242, v242, v9
v_mul_f32 v243, v243, v9
v_mul_f32 v244, v244, v9
v_mul_f32 v245, v245, v9
v_mul_f32 v246, v246, v9
v_mul_f32 v247, v247, v9
v_accvgpr_write_b32 a112, v240
v_accvgpr_write_b32 a113, v241
v_accvgpr_write_b32 a114, v242
v_accvgpr_write_b32 a115, v243
v_accvgpr_write_b32 a116, v244
v_accvgpr_write_b32 a117, v245
v_accvgpr_write_b32 a118, v246
v_accvgpr_write_b32 a119, v247
v_accvgpr_read_b32 v240, a120
v_accvgpr_read_b32 v241, a121
v_accvgpr_read_b32 v242, a122
v_accvgpr_read_b32 v243, a123
v_accvgpr_read_b32 v244, a124
v_accvgpr_read_b32 v245, a125
v_accvgpr_read_b32 v246, a126
v_accvgpr_read_b32 v247, a127
v_mul_f32 v240, v240, v9
v_mul_f32 v241, v241, v9
v_mul_f32 v242, v242, v9
v_mul_f32 v243, v243, v9
v_mul_f32 v244, v244, v9
v_mul_f32 v245, v245, v9
v_mul_f32 v246, v246, v9
v_mul_f32 v247, v247, v9
v_accvgpr_write_b32 a120, v240
v_accvgpr_write_b32 a121, v241
v_accvgpr_write_b32 a122, v242
v_accvgpr_write_b32 a123, v243
v_accvgpr_write_b32 a124, v244
v_accvgpr_write_b32 a125, v245
v_accvgpr_write_b32 a126, v246
v_accvgpr_write_b32 a127, v247
s_nop 1
s_branch L_p3_d1_end
L_p3_d1m_rare:
v_mov_b32 v240, v6
v_mov_b32 v241, v6
s_nop 1
v_permlane32_swap_b32 v240, v241
v_max_f32 v242, v240, v241
v_max_f32 v242, 0, v242
v_exp_f32 v8, -v242
v_sub_f32 v208, v208, v242
v_sub_f32 v209, v209, v242
v_sub_f32 v210, v210, v242
v_sub_f32 v211, v211, v242
v_sub_f32 v212, v212, v242
v_sub_f32 v213, v213, v242
v_sub_f32 v214, v214, v242
v_sub_f32 v215, v215, v242
v_sub_f32 v216, v216, v242
v_sub_f32 v217, v217, v242
v_sub_f32 v218, v218, v242
v_sub_f32 v219, v219, v242
v_sub_f32 v220, v220, v242
v_sub_f32 v221, v221, v242
v_sub_f32 v222, v222, v242
v_sub_f32 v223, v223, v242
v_mul_f32 v2, v2, v8
v_mul_f32 v3, v3, v8
v_sub_f32 v80, v80, v242
v_sub_f32 v81, v81, v242
v_sub_f32 v82, v82, v242
v_sub_f32 v83, v83, v242
v_sub_f32 v84, v84, v242
v_sub_f32 v85, v85, v242
v_sub_f32 v86, v86, v242
v_sub_f32 v87, v87, v242
v_sub_f32 v88, v88, v242
v_sub_f32 v89, v89, v242
v_sub_f32 v90, v90, v242
v_sub_f32 v91, v91, v242
v_sub_f32 v92, v92, v242
v_sub_f32 v93, v93, v242
v_sub_f32 v94, v94, v242
v_sub_f32 v95, v95, v242
v_sub_f32 v112, v112, v242
v_sub_f32 v113, v113, v242
v_sub_f32 v114, v114, v242
v_sub_f32 v115, v115, v242
v_sub_f32 v116, v116, v242
v_sub_f32 v117, v117, v242
v_sub_f32 v118, v118, v242
v_sub_f32 v119, v119, v242
v_sub_f32 v120, v120, v242
v_sub_f32 v121, v121, v242
v_sub_f32 v122, v122, v242
v_sub_f32 v123, v123, v242
v_sub_f32 v124, v124, v242
v_sub_f32 v125, v125, v242
v_sub_f32 v126, v126, v242
v_sub_f32 v127, v127, v242
v_mov_b32 v240, v7
v_mov_b32 v241, v7
s_nop 1
v_permlane32_swap_b32 v240, v241
v_max_f32 v242, v240, v241
v_max_f32 v242, 0, v242
v_exp_f32 v9, -v242
v_sub_f32 v224, v224, v242
v_sub_f32 v225, v225, v242
v_sub_f32 v226, v226, v242
v_sub_f32 v227, v227, v242
v_sub_f32 v228, v228, v242
v_sub_f32 v229, v229, v242
v_sub_f32 v230, v230, v242
v_sub_f32 v231, v231, v242
v_sub_f32 v232, v232, v242
v_sub_f32 v233, v233, v242
v_sub_f32 v234, v234, v242
v_sub_f32 v235, v235, v242
v_sub_f32 v236, v236, v242
v_sub_f32 v237, v237, v242
v_sub_f32 v238, v238, v242
v_sub_f32 v239, v239, v242
v_mul_f32 v4, v4, v9
v_mul_f32 v5, v5, v9
v_sub_f32 v96, v96, v242
v_sub_f32 v97, v97, v242
v_sub_f32 v98, v98, v242
v_sub_f32 v99, v99, v242
v_sub_f32 v100, v100, v242
v_sub_f32 v101, v101, v242
v_sub_f32 v102, v102, v242
v_sub_f32 v103, v103, v242
v_sub_f32 v104, v104, v242
v_sub_f32 v105, v105, v242
v_sub_f32 v106, v106, v242
v_sub_f32 v107, v107, v242
v_sub_f32 v108, v108, v242
v_sub_f32 v109, v109, v242
v_sub_f32 v110, v110, v242
v_sub_f32 v111, v111, v242
v_sub_f32 v128, v128, v242
v_sub_f32 v129, v129, v242
v_sub_f32 v130, v130, v242
v_sub_f32 v131, v131, v242
v_sub_f32 v132, v132, v242
v_sub_f32 v133, v133, v242
v_sub_f32 v134, v134, v242
v_sub_f32 v135, v135, v242
v_sub_f32 v136, v136, v242
v_sub_f32 v137, v137, v242
v_sub_f32 v138, v138, v242
v_sub_f32 v139, v139, v242
v_sub_f32 v140, v140, v242
v_sub_f32 v141, v141, v242
v_sub_f32 v142, v142, v242
v_sub_f32 v143, v143, v242
s_add_u32 m0, s72, 16384
ds_read_b128 a[160:163], v10 offset:8192
v_exp_f32 v80, v80
v_exp_f32 v81, v81
v_mfma_f32_32x32x16_bf16 a[0:15], a[224:227], v[176:179], a[0:15]
ds_read_b128 a[164:167], v10 offset:9216
buffer_load_dwordx4 v12, s[52:55], s71 offen offset:0 sc1 lds
v_exp_f32 v82, v82
v_add_f32 v2, v2, v80
v_mfma_f32_32x32x16_bf16 a[64:79], a[224:227], v[192:195], a[64:79]
v_exp_f32 v83, v83
v_add_f32 v3, v3, v81
v_cvt_pk_bf16_f32 v80, v80, v81
v_exp_f32 v84, v84
v_mfma_f32_32x32x16_bf16 a[16:31], a[228:231], v[176:179], a[16:31]
ds_read_b128 a[168:171], v10 offset:10240
v_add_f32 v2, v2, v82
v_exp_f32 v85, v85
v_add_f32 v3, v3, v83
v_cvt_pk_bf16_f32 v81, v82, v83
v_mfma_f32_32x32x16_bf16 a[80:95], a[228:231], v[192:195], a[80:95]
ds_read_b128 a[172:175], v10 offset:11264
buffer_load_dwordx4 v12, s[52:55], s71 offen offset:1024 sc1 lds
v_exp_f32 v86, v86
v_add_f32 v2, v2, v84
v_mfma_f32_32x32x16_bf16 a[32:47], a[232:235], v[176:179], a[32:47]
v_exp_f32 v87, v87
v_add_f32 v3, v3, v85
v_cvt_pk_bf16_f32 v82, v84, v85
v_exp_f32 v88, v88
v_mfma_f32_32x32x16_bf16 a[96:111], a[232:235], v[192:195], a[96:111]
ds_read_b128 a[176:179], v10 offset:12288
v_add_f32 v2, v2, v86
v_exp_f32 v89, v89
v_add_f32 v3, v3, v87
v_cvt_pk_bf16_f32 v83, v86, v87
v_mfma_f32_32x32x16_bf16 a[48:63], a[236:239], v[176:179], a[48:63]
buffer_load_dwordx4 v12, s[52:55], s71 offen offset:2048 sc1 lds
v_exp_f32 v90, v90
v_add_f32 v2, v2, v88
v_exp_f32 v91, v91
v_mfma_f32_32x32x16_bf16 a[112:127], a[236:239], v[192:195], a[112:127]
ds_read_b128 a[180:183], v10 offset:13312
v_add_f32 v3, v3, v89
v_cvt_pk_bf16_f32 v88, v88, v89
v_exp_f32 v92, v92
v_add_f32 v2, v2, v90
v_mfma_f32_32x32x16_bf16 a[0:15], a[240:243], v[184:187], a[0:15]
ds_read_b128 a[184:187], v10 offset:14336
v_exp_f32 v93, v93
v_add_f32 v3, v3, v91
v_cvt_pk_bf16_f32 v89, v90, v91
v_mfma_f32_32x32x16_bf16 a[64:79], a[240:243], v[200:203], a[64:79]
buffer_load_dwordx4 v12, s[52:55], s71 offen offset:3072 sc1 lds
v_exp_f32 v94, v94
v_add_f32 v2, v2, v92
v_exp_f32 v95, v95
v_mfma_f32_32x32x16_bf16 a[16:31], a[244:247], v[184:187], a[16:31]
ds_read_b128 a[188:191], v10 offset:15360
v_add_f32 v3, v3, v93
v_cvt_pk_bf16_f32 v90, v92, v93
v_exp_f32 v96, v96
v_add_f32 v2, v2, v94
v_mfma_f32_32x32x16_bf16 a[80:95], a[244:247], v[200:203], a[80:95]
v_exp_f32 v97, v97
v_add_f32 v3, v3, v95
v_cvt_pk_bf16_f32 v91, v94, v95
v_exp_f32 v98, v98
v_mfma_f32_32x32x16_bf16 a[32:47], a[248:251], v[184:187], a[32:47]
s_xor_b32 s72, s72, 0x8000
v_add_f32 v4, v4, v96
v_exp_f32 v99, v99
v_add_f32 v5, v5, v97
v_cvt_pk_bf16_f32 v96, v96, v97
v_mfma_f32_32x32x16_bf16 a[96:111], a[248:251], v[200:203], a[96:111]
v_exp_f32 v100, v100
v_add_f32 v4, v4, v98
v_exp_f32 v101, v101
v_add_f32 v5, v5, v99
v_mfma_f32_32x32x16_bf16 a[48:63], a[252:255], v[184:187], a[48:63]
v_cvt_pk_bf16_f32 v97, v98, v99
v_exp_f32 v102, v102
v_add_f32 v4, v4, v100
v_exp_f32 v103, v103
v_mfma_f32_32x32x16_bf16 a[112:127], a[252:255], v[200:203], a[112:127]
v_add_f32 v5, v5, v101
v_cvt_pk_bf16_f32 v98, v100, v101
v_add_f32 v4, v4, v102
v_add_f32 v5, v5, v103
v_cvt_pk_bf16_f32 v99, v102, v103
s_nop 15
v_accvgpr_read_b32 v240, a0
v_accvgpr_read_b32 v241, a1
v_accvgpr_read_b32 v242, a2
v_accvgpr_read_b32 v243, a3
v_accvgpr_read_b32 v244, a4
v_accvgpr_read_b32 v245, a5
v_accvgpr_read_b32 v246, a6
v_accvgpr_read_b32 v247, a7
v_mul_f32 v240, v240, v8
v_mul_f32 v241, v241, v8
v_mul_f32 v242, v242, v8
v_mul_f32 v243, v243, v8
v_mul_f32 v244, v244, v8
v_mul_f32 v245, v245, v8
v_mul_f32 v246, v246, v8
v_mul_f32 v247, v247, v8
v_accvgpr_write_b32 a0, v240
v_accvgpr_write_b32 a1, v241
v_accvgpr_write_b32 a2, v242
v_accvgpr_write_b32 a3, v243
v_accvgpr_write_b32 a4, v244
v_accvgpr_write_b32 a5, v245
v_accvgpr_write_b32 a6, v246
v_accvgpr_write_b32 a7, v247
v_accvgpr_read_b32 v240, a8
v_accvgpr_read_b32 v241, a9
v_accvgpr_read_b32 v242, a10
v_accvgpr_read_b32 v243, a11
v_accvgpr_read_b32 v244, a12
v_accvgpr_read_b32 v245, a13
v_accvgpr_read_b32 v246, a14
v_accvgpr_read_b32 v247, a15
v_mul_f32 v240, v240, v8
v_mul_f32 v241, v241, v8
v_mul_f32 v242, v242, v8
v_mul_f32 v243, v243, v8
v_mul_f32 v244, v244, v8
v_mul_f32 v245, v245, v8
v_mul_f32 v246, v246, v8
v_mul_f32 v247, v247, v8
v_accvgpr_write_b32 a8, v240
v_accvgpr_write_b32 a9, v241
v_accvgpr_write_b32 a10, v242
v_accvgpr_write_b32 a11, v243
v_accvgpr_write_b32 a12, v244
v_accvgpr_write_b32 a13, v245
v_accvgpr_write_b32 a14, v246
v_accvgpr_write_b32 a15, v247
v_accvgpr_read_b32 v240, a16
v_accvgpr_read_b32 v241, a17
v_accvgpr_read_b32 v242, a18
v_accvgpr_read_b32 v243, a19
v_accvgpr_read_b32 v244, a20
v_accvgpr_read_b32 v245, a21
v_accvgpr_read_b32 v246, a22
v_accvgpr_read_b32 v247, a23
v_mul_f32 v240, v240, v8
v_mul_f32 v241, v241, v8
v_mul_f32 v242, v242, v8
v_mul_f32 v243, v243, v8
v_mul_f32 v244, v244, v8
v_mul_f32 v245, v245, v8
v_mul_f32 v246, v246, v8
v_mul_f32 v247, v247, v8
v_accvgpr_write_b32 a16, v240
v_accvgpr_write_b32 a17, v241
v_accvgpr_write_b32 a18, v242
v_accvgpr_write_b32 a19, v243
v_accvgpr_write_b32 a20, v244
v_accvgpr_write_b32 a21, v245
v_accvgpr_write_b32 a22, v246
v_accvgpr_write_b32 a23, v247
v_accvgpr_read_b32 v240, a24
v_accvgpr_read_b32 v241, a25
v_accvgpr_read_b32 v242, a26
v_accvgpr_read_b32 v243, a27
v_accvgpr_read_b32 v244, a28
v_accvgpr_read_b32 v245, a29
v_accvgpr_read_b32 v246, a30
v_accvgpr_read_b32 v247, a31
v_mul_f32 v240, v240, v8
v_mul_f32 v241, v241, v8
v_mul_f32 v242, v242, v8
v_mul_f32 v243, v243, v8
v_mul_f32 v244, v244, v8
v_mul_f32 v245, v245, v8
v_mul_f32 v246, v246, v8
v_mul_f32 v247, v247, v8
v_accvgpr_write_b32 a24, v240
v_accvgpr_write_b32 a25, v241
v_accvgpr_write_b32 a26, v242
v_accvgpr_write_b32 a27, v243
v_accvgpr_write_b32 a28, v244
v_accvgpr_write_b32 a29, v245
v_accvgpr_write_b32 a30, v246
v_accvgpr_write_b32 a31, v247
v_accvgpr_read_b32 v240, a32
v_accvgpr_read_b32 v241, a33
v_accvgpr_read_b32 v242, a34
v_accvgpr_read_b32 v243, a35
v_accvgpr_read_b32 v244, a36
v_accvgpr_read_b32 v245, a37
v_accvgpr_read_b32 v246, a38
v_accvgpr_read_b32 v247, a39
v_mul_f32 v240, v240, v8
v_mul_f32 v241, v241, v8
v_mul_f32 v242, v242, v8
v_mul_f32 v243, v243, v8
v_mul_f32 v244, v244, v8
v_mul_f32 v245, v245, v8
v_mul_f32 v246, v246, v8
v_mul_f32 v247, v247, v8
v_accvgpr_write_b32 a32, v240
v_accvgpr_write_b32 a33, v241
v_accvgpr_write_b32 a34, v242
v_accvgpr_write_b32 a35, v243
v_accvgpr_write_b32 a36, v244
v_accvgpr_write_b32 a37, v245
v_accvgpr_write_b32 a38, v246
v_accvgpr_write_b32 a39, v247
v_accvgpr_read_b32 v240, a40
v_accvgpr_read_b32 v241, a41
v_accvgpr_read_b32 v242, a42
v_accvgpr_read_b32 v243, a43
v_accvgpr_read_b32 v244, a44
v_accvgpr_read_b32 v245, a45
v_accvgpr_read_b32 v246, a46
v_accvgpr_read_b32 v247, a47
v_mul_f32 v240, v240, v8
v_mul_f32 v241, v241, v8
v_mul_f32 v242, v242, v8
v_mul_f32 v243, v243, v8
v_mul_f32 v244, v244, v8
v_mul_f32 v245, v245, v8
v_mul_f32 v246, v246, v8
v_mul_f32 v247, v247, v8
v_accvgpr_write_b32 a40, v240
v_accvgpr_write_b32 a41, v241
v_accvgpr_write_b32 a42, v242
v_accvgpr_write_b32 a43, v243
v_accvgpr_write_b32 a44, v244
v_accvgpr_write_b32 a45, v245
v_accvgpr_write_b32 a46, v246
v_accvgpr_write_b32 a47, v247
v_accvgpr_read_b32 v240, a48
v_accvgpr_read_b32 v241, a49
v_accvgpr_read_b32 v242, a50
v_accvgpr_read_b32 v243, a51
v_accvgpr_read_b32 v244, a52
v_accvgpr_read_b32 v245, a53
v_accvgpr_read_b32 v246, a54
v_accvgpr_read_b32 v247, a55
v_mul_f32 v240, v240, v8
v_mul_f32 v241, v241, v8
v_mul_f32 v242, v242, v8
v_mul_f32 v243, v243, v8
v_mul_f32 v244, v244, v8
v_mul_f32 v245, v245, v8
v_mul_f32 v246, v246, v8
v_mul_f32 v247, v247, v8
v_accvgpr_write_b32 a48, v240
v_accvgpr_write_b32 a49, v241
v_accvgpr_write_b32 a50, v242
v_accvgpr_write_b32 a51, v243
v_accvgpr_write_b32 a52, v244
v_accvgpr_write_b32 a53, v245
v_accvgpr_write_b32 a54, v246
v_accvgpr_write_b32 a55, v247
v_accvgpr_read_b32 v240, a56
v_accvgpr_read_b32 v241, a57
v_accvgpr_read_b32 v242, a58
v_accvgpr_read_b32 v243, a59
v_accvgpr_read_b32 v244, a60
v_accvgpr_read_b32 v245, a61
v_accvgpr_read_b32 v246, a62
v_accvgpr_read_b32 v247, a63
v_mul_f32 v240, v240, v8
v_mul_f32 v241, v241, v8
v_mul_f32 v242, v242, v8
v_mul_f32 v243, v243, v8
v_mul_f32 v244, v244, v8
v_mul_f32 v245, v245, v8
v_mul_f32 v246, v246, v8
v_mul_f32 v247, v247, v8
v_accvgpr_write_b32 a56, v240
v_accvgpr_write_b32 a57, v241
v_accvgpr_write_b32 a58, v242
v_accvgpr_write_b32 a59, v243
v_accvgpr_write_b32 a60, v244
v_accvgpr_write_b32 a61, v245
v_accvgpr_write_b32 a62, v246
v_accvgpr_write_b32 a63, v247
v_accvgpr_read_b32 v240, a64
v_accvgpr_read_b32 v241, a65
v_accvgpr_read_b32 v242, a66
v_accvgpr_read_b32 v243, a67
v_accvgpr_read_b32 v244, a68
v_accvgpr_read_b32 v245, a69
v_accvgpr_read_b32 v246, a70
v_accvgpr_read_b32 v247, a71
v_mul_f32 v240, v240, v9
v_mul_f32 v241, v241, v9
v_mul_f32 v242, v242, v9
v_mul_f32 v243, v243, v9
v_mul_f32 v244, v244, v9
v_mul_f32 v245, v245, v9
v_mul_f32 v246, v246, v9
v_mul_f32 v247, v247, v9
v_accvgpr_write_b32 a64, v240
v_accvgpr_write_b32 a65, v241
v_accvgpr_write_b32 a66, v242
v_accvgpr_write_b32 a67, v243
v_accvgpr_write_b32 a68, v244
v_accvgpr_write_b32 a69, v245
v_accvgpr_write_b32 a70, v246
v_accvgpr_write_b32 a71, v247
v_accvgpr_read_b32 v240, a72
v_accvgpr_read_b32 v241, a73
v_accvgpr_read_b32 v242, a74
v_accvgpr_read_b32 v243, a75
v_accvgpr_read_b32 v244, a76
v_accvgpr_read_b32 v245, a77
v_accvgpr_read_b32 v246, a78
v_accvgpr_read_b32 v247, a79
v_mul_f32 v240, v240, v9
v_mul_f32 v241, v241, v9
v_mul_f32 v242, v242, v9
v_mul_f32 v243, v243, v9
v_mul_f32 v244, v244, v9
v_mul_f32 v245, v245, v9
v_mul_f32 v246, v246, v9
v_mul_f32 v247, v247, v9
v_accvgpr_write_b32 a72, v240
v_accvgpr_write_b32 a73, v241
v_accvgpr_write_b32 a74, v242
v_accvgpr_write_b32 a75, v243
v_accvgpr_write_b32 a76, v244
v_accvgpr_write_b32 a77, v245
v_accvgpr_write_b32 a78, v246
v_accvgpr_write_b32 a79, v247
v_accvgpr_read_b32 v240, a80
v_accvgpr_read_b32 v241, a81
v_accvgpr_read_b32 v242, a82
v_accvgpr_read_b32 v243, a83
v_accvgpr_read_b32 v244, a84
v_accvgpr_read_b32 v245, a85
v_accvgpr_read_b32 v246, a86
v_accvgpr_read_b32 v247, a87
v_mul_f32 v240, v240, v9
v_mul_f32 v241, v241, v9
v_mul_f32 v242, v242, v9
v_mul_f32 v243, v243, v9
v_mul_f32 v244, v244, v9
v_mul_f32 v245, v245, v9
v_mul_f32 v246, v246, v9
v_mul_f32 v247, v247, v9
v_accvgpr_write_b32 a80, v240
v_accvgpr_write_b32 a81, v241
v_accvgpr_write_b32 a82, v242
v_accvgpr_write_b32 a83, v243
v_accvgpr_write_b32 a84, v244
v_accvgpr_write_b32 a85, v245
v_accvgpr_write_b32 a86, v246
v_accvgpr_write_b32 a87, v247
v_accvgpr_read_b32 v240, a88
v_accvgpr_read_b32 v241, a89
v_accvgpr_read_b32 v242, a90
v_accvgpr_read_b32 v243, a91
v_accvgpr_read_b32 v244, a92
v_accvgpr_read_b32 v245, a93
v_accvgpr_read_b32 v246, a94
v_accvgpr_read_b32 v247, a95
v_mul_f32 v240, v240, v9
v_mul_f32 v241, v241, v9
v_mul_f32 v242, v242, v9
v_mul_f32 v243, v243, v9
v_mul_f32 v244, v244, v9
v_mul_f32 v245, v245, v9
v_mul_f32 v246, v246, v9
v_mul_f32 v247, v247, v9
v_accvgpr_write_b32 a88, v240
v_accvgpr_write_b32 a89, v241
v_accvgpr_write_b32 a90, v242
v_accvgpr_write_b32 a91, v243
v_accvgpr_write_b32 a92, v244
v_accvgpr_write_b32 a93, v245
v_accvgpr_write_b32 a94, v246
v_accvgpr_write_b32 a95, v247
v_accvgpr_read_b32 v240, a96
v_accvgpr_read_b32 v241, a97
v_accvgpr_read_b32 v242, a98
v_accvgpr_read_b32 v243, a99
v_accvgpr_read_b32 v244, a100
v_accvgpr_read_b32 v245, a101
v_accvgpr_read_b32 v246, a102
v_accvgpr_read_b32 v247, a103
v_mul_f32 v240, v240, v9
v_mul_f32 v241, v241, v9
v_mul_f32 v242, v242, v9
v_mul_f32 v243, v243, v9
v_mul_f32 v244, v244, v9
v_mul_f32 v245, v245, v9
v_mul_f32 v246, v246, v9
v_mul_f32 v247, v247, v9
v_accvgpr_write_b32 a96, v240
v_accvgpr_write_b32 a97, v241
v_accvgpr_write_b32 a98, v242
v_accvgpr_write_b32 a99, v243
v_accvgpr_write_b32 a100, v244
v_accvgpr_write_b32 a101, v245
v_accvgpr_write_b32 a102, v246
v_accvgpr_write_b32 a103, v247
v_accvgpr_read_b32 v240, a104
v_accvgpr_read_b32 v241, a105
v_accvgpr_read_b32 v242, a106
v_accvgpr_read_b32 v243, a107
v_accvgpr_read_b32 v244, a108
v_accvgpr_read_b32 v245, a109
v_accvgpr_read_b32 v246, a110
v_accvgpr_read_b32 v247, a111
v_mul_f32 v240, v240, v9
v_mul_f32 v241, v241, v9
v_mul_f32 v242, v242, v9
v_mul_f32 v243, v243, v9
v_mul_f32 v244, v244, v9
v_mul_f32 v245, v245, v9
v_mul_f32 v246, v246, v9
v_mul_f32 v247, v247, v9
v_accvgpr_write_b32 a104, v240
v_accvgpr_write_b32 a105, v241
v_accvgpr_write_b32 a106, v242
v_accvgpr_write_b32 a107, v243
v_accvgpr_write_b32 a108, v244
v_accvgpr_write_b32 a109, v245
v_accvgpr_write_b32 a110, v246
v_accvgpr_write_b32 a111, v247
v_accvgpr_read_b32 v240, a112
v_accvgpr_read_b32 v241, a113
v_accvgpr_read_b32 v242, a114
v_accvgpr_read_b32 v243, a115
v_accvgpr_read_b32 v244, a116
v_accvgpr_read_b32 v245, a117
v_accvgpr_read_b32 v246, a118
v_accvgpr_read_b32 v247, a119
v_mul_f32 v240, v240, v9
v_mul_f32 v241, v241, v9
v_mul_f32 v242, v242, v9
v_mul_f32 v243, v243, v9
v_mul_f32 v244, v244, v9
v_mul_f32 v245, v245, v9
v_mul_f32 v246, v246, v9
v_mul_f32 v247, v247, v9
v_accvgpr_write_b32 a112, v240
v_accvgpr_write_b32 a113, v241
v_accvgpr_write_b32 a114, v242
v_accvgpr_write_b32 a115, v243
v_accvgpr_write_b32 a116, v244
v_accvgpr_write_b32 a117, v245
v_accvgpr_write_b32 a118, v246
v_accvgpr_write_b32 a119, v247
v_accvgpr_read_b32 v240, a120
v_accvgpr_read_b32 v241, a121
v_accvgpr_read_b32 v242, a122
v_accvgpr_read_b32 v243, a123
v_accvgpr_read_b32 v244, a124
v_accvgpr_read_b32 v245, a125
v_accvgpr_read_b32 v246, a126
v_accvgpr_read_b32 v247, a127
v_mul_f32 v240, v240, v9
v_mul_f32 v241, v241, v9
v_mul_f32 v242, v242, v9
v_mul_f32 v243, v243, v9
v_mul_f32 v244, v244, v9
v_mul_f32 v245, v245, v9
v_mul_f32 v246, v246, v9
v_mul_f32 v247, v247, v9
v_accvgpr_write_b32 a120, v240
v_accvgpr_write_b32 a121, v241
v_accvgpr_write_b32 a122, v242
v_accvgpr_write_b32 a123, v243
v_accvgpr_write_b32 a124, v244
v_accvgpr_write_b32 a125, v245
v_accvgpr_write_b32 a126, v246
v_accvgpr_write_b32 a127, v247
s_nop 1
s_branch L_p3_d1m_end
L_p3_d0m_rare:
v_mov_b32 v240, v6
v_mov_b32 v241, v6
s_nop 1
v_permlane32_swap_b32 v240, v241
v_max_f32 v242, v240, v241
v_max_f32 v242, 0, v242
v_exp_f32 v8, -v242
v_sub_f32 v208, v208, v242
v_sub_f32 v209, v209, v242
v_sub_f32 v210, v210, v242
v_sub_f32 v211, v211, v242
v_sub_f32 v212, v212, v242
v_sub_f32 v213, v213, v242
v_sub_f32 v214, v214, v242
v_sub_f32 v215, v215, v242
v_sub_f32 v216, v216, v242
v_sub_f32 v217, v217, v242
v_sub_f32 v218, v218, v242
v_sub_f32 v219, v219, v242
v_sub_f32 v220, v220, v242
v_sub_f32 v221, v221, v242
v_sub_f32 v222, v222, v242
v_sub_f32 v223, v223, v242
v_mul_f32 v2, v2, v8
v_mul_f32 v3, v3, v8
v_sub_f32 v144, v144, v242
v_sub_f32 v145, v145, v242
v_sub_f32 v146, v146, v242
v_sub_f32 v147, v147, v242
v_sub_f32 v148, v148, v242
v_sub_f32 v149, v149, v242
v_sub_f32 v150, v150, v242
v_sub_f32 v151, v151, v242
v_sub_f32 v152, v152, v242
v_sub_f32 v153, v153, v242
v_sub_f32 v154, v154, v242
v_sub_f32 v155, v155, v242
v_sub_f32 v156, v156, v242
v_sub_f32 v157, v157, v242
v_sub_f32 v158, v158, v242
v_sub_f32 v159, v159, v242
v_sub_f32 v176, v176, v242
v_sub_f32 v177, v177, v242
v_sub_f32 v178, v178, v242
v_sub_f32 v179, v179, v242
v_sub_f32 v180, v180, v242
v_sub_f32 v181, v181, v242
v_sub_f32 v182, v182, v242
v_sub_f32 v183, v183, v242
v_sub_f32 v184, v184, v242
v_sub_f32 v185, v185, v242
v_sub_f32 v186, v186, v242
v_sub_f32 v187, v187, v242
v_sub_f32 v188, v188, v242
v_sub_f32 v189, v189, v242
v_sub_f32 v190, v190, v242
v_sub_f32 v191, v191, v242
v_mov_b32 v240, v7
v_mov_b32 v241, v7
s_nop 1
v_permlane32_swap_b32 v240, v241
v_max_f32 v242, v240, v241
v_max_f32 v242, 0, v242
v_exp_f32 v9, -v242
v_sub_f32 v224, v224, v242
v_sub_f32 v225, v225, v242
v_sub_f32 v226, v226, v242
v_sub_f32 v227, v227, v242
v_sub_f32 v228, v228, v242
v_sub_f32 v229, v229, v242
v_sub_f32 v230, v230, v242
v_sub_f32 v231, v231, v242
v_sub_f32 v232, v232, v242
v_sub_f32 v233, v233, v242
v_sub_f32 v234, v234, v242
v_sub_f32 v235, v235, v242
v_sub_f32 v236, v236, v242
v_sub_f32 v237, v237, v242
v_sub_f32 v238, v238, v242
v_sub_f32 v239, v239, v242
v_mul_f32 v4, v4, v9
v_mul_f32 v5, v5, v9
v_sub_f32 v160, v160, v242
v_sub_f32 v161, v161, v242
v_sub_f32 v162, v162, v242
v_sub_f32 v163, v163, v242
v_sub_f32 v164, v164, v242
v_sub_f32 v165, v165, v242
v_sub_f32 v166, v166, v242
v_sub_f32 v167, v167, v242
v_sub_f32 v168, v168, v242
v_sub_f32 v169, v169, v242
v_sub_f32 v170, v170, v242
v_sub_f32 v171, v171, v242
v_sub_f32 v172, v172, v242
v_sub_f32 v173, v173, v242
v_sub_f32 v174, v174, v242
v_sub_f32 v175, v175, v242
v_sub_f32 v192, v192, v242
v_sub_f32 v193, v193, v242
v_sub_f32 v194, v194, v242
v_sub_f32 v195, v195, v242
v_sub_f32 v196, v196, v242
v_sub_f32 v197, v197, v242
v_sub_f32 v198, v198, v242
v_sub_f32 v199, v199, v242
v_sub_f32 v200, v200, v242
v_sub_f32 v201, v201, v242
v_sub_f32 v202, v202, v242
v_sub_f32 v203, v203, v242
v_sub_f32 v204, v204, v242
v_sub_f32 v205, v205, v242
v_sub_f32 v206, v206, v242
v_sub_f32 v207, v207, v242
s_add_u32 m0, s72, 0
ds_read_b128 a[160:163], v10 offset:24576
v_exp_f32 v144, v144
v_exp_f32 v145, v145
v_mfma_f32_32x32x16_bf16 a[0:15], a[224:227], v[112:115], a[0:15]
ds_read_b128 a[164:167], v10 offset:25600
buffer_load_dwordx4 v12, s[52:55], s71 offen offset:0 sc1 lds
v_exp_f32 v146, v146
v_add_f32 v2, v2, v144
v_mfma_f32_32x32x16_bf16 a[64:79], a[224:227], v[128:131], a[64:79]
v_exp_f32 v147, v147
v_add_f32 v3, v3, v145
v_cvt_pk_bf16_f32 v144, v144, v145
v_exp_f32 v148, v148
v_mfma_f32_32x32x16_bf16 a[16:31], a[228:231], v[112:115], a[16:31]
ds_read_b128 a[168:171], v10 offset:26624
v_add_f32 v2, v2, v146
v_exp_f32 v149, v149
v_add_f32 v3, v3, v147
v_cvt_pk_bf16_f32 v145, v146, v147
v_mfma_f32_32x32x16_bf16 a[80:95], a[228:231], v[128:131], a[80:95]
ds_read_b128 a[172:175], v10 offset:27648
buffer_load_dwordx4 v12, s[52:55], s71 offen offset:1024 sc1 lds
v_exp_f32 v150, v150
v_add_f32 v2, v2, v148
v_mfma_f32_32x32x16_bf16 a[32:47], a[232:235], v[112:115], a[32:47]
v_exp_f32 v151, v151
v_add_f32 v3, v3, v149
v_cvt_pk_bf16_f32 v146, v148, v149
v_exp_f32 v152, v152
v_mfma_f32_32x32x16_bf16 a[96:111], a[232:235], v[128:131], a[96:111]
ds_read_b128 a[176:179], v10 offset:28672
v_add_f32 v2, v2, v150
v_exp_f32 v153, v153
v_add_f32 v3, v3, v151
v_cvt_pk_bf16_f32 v147, v150, v151
v_mfma_f32_32x32x16_bf16 a[48:63], a[236:239], v[112:115], a[48:63]
buffer_load_dwordx4 v12, s[52:55], s71 offen offset:2048 sc1 lds
v_exp_f32 v154, v154
v_add_f32 v2, v2, v152
v_exp_f32 v155, v155
v_mfma_f32_32x32x16_bf16 a[112:127], a[236:239], v[128:131], a[112:127]
ds_read_b128 a[180:183], v10 offset:29696
v_add_f32 v3, v3, v153
v_cvt_pk_bf16_f32 v152, v152, v153
v_exp_f32 v156, v156
v_add_f32 v2, v2, v154
v_mfma_f32_32x32x16_bf16 a[0:15], a[240:243], v[120:123], a[0:15]
ds_read_b128 a[184:187], v10 offset:30720
v_exp_f32 v157, v157
v_add_f32 v3, v3, v155
v_cvt_pk_bf16_f32 v153, v154, v155
v_mfma_f32_32x32x16_bf16 a[64:79], a[240:243], v[136:139], a[64:79]
buffer_load_dwordx4 v12, s[52:55], s71 offen offset:3072 sc1 lds
v_exp_f32 v158, v158
v_add_f32 v2, v2, v156
v_exp_f32 v159, v159
v_mfma_f32_32x32x16_bf16 a[16:31], a[244:247], v[120:123], a[16:31]
ds_read_b128 a[188:191], v10 offset:31744
v_add_f32 v3, v3, v157
v_cvt_pk_bf16_f32 v154, v156, v157
v_exp_f32 v160, v160
v_add_f32 v2, v2, v158
v_mfma_f32_32x32x16_bf16 a[80:95], a[244:247], v[136:139], a[80:95]
v_exp_f32 v161, v161
v_add_f32 v3, v3, v159
v_cvt_pk_bf16_f32 v155, v158, v159
v_exp_f32 v162, v162
v_mfma_f32_32x32x16_bf16 a[32:47], a[248:251], v[120:123], a[32:47]
s_cmp_eq_u32 s70, 7
v_add_f32 v4, v4, v160
v_exp_f32 v163, v163
v_add_f32 v5, v5, v161
v_cvt_pk_bf16_f32 v160, v160, v161
v_mfma_f32_32x32x16_bf16 a[96:111], a[248:251], v[136:139], a[96:111]
v_exp_f32 v164, v164
v_add_f32 v4, v4, v162
v_exp_f32 v165, v165
v_add_f32 v5, v5, v163
v_mfma_f32_32x32x16_bf16 a[48:63], a[252:255], v[120:123], a[48:63]
v_cvt_pk_bf16_f32 v161, v162, v163
v_exp_f32 v166, v166
v_add_f32 v4, v4, v164
v_exp_f32 v167, v167
v_mfma_f32_32x32x16_bf16 a[112:127], a[252:255], v[136:139], a[112:127]
v_add_f32 v5, v5, v165
v_cvt_pk_bf16_f32 v162, v164, v165
v_add_f32 v4, v4, v166
v_add_f32 v5, v5, v167
v_cvt_pk_bf16_f32 v163, v166, v167
s_nop 15
v_accvgpr_read_b32 v240, a0
v_accvgpr_read_b32 v241, a1
v_accvgpr_read_b32 v242, a2
v_accvgpr_read_b32 v243, a3
v_accvgpr_read_b32 v244, a4
v_accvgpr_read_b32 v245, a5
v_accvgpr_read_b32 v246, a6
v_accvgpr_read_b32 v247, a7
v_mul_f32 v240, v240, v8
v_mul_f32 v241, v241, v8
v_mul_f32 v242, v242, v8
v_mul_f32 v243, v243, v8
v_mul_f32 v244, v244, v8
v_mul_f32 v245, v245, v8
v_mul_f32 v246, v246, v8
v_mul_f32 v247, v247, v8
v_accvgpr_write_b32 a0, v240
v_accvgpr_write_b32 a1, v241
v_accvgpr_write_b32 a2, v242
v_accvgpr_write_b32 a3, v243
v_accvgpr_write_b32 a4, v244
v_accvgpr_write_b32 a5, v245
v_accvgpr_write_b32 a6, v246
v_accvgpr_write_b32 a7, v247
v_accvgpr_read_b32 v240, a8
v_accvgpr_read_b32 v241, a9
v_accvgpr_read_b32 v242, a10
v_accvgpr_read_b32 v243, a11
v_accvgpr_read_b32 v244, a12
v_accvgpr_read_b32 v245, a13
v_accvgpr_read_b32 v246, a14
v_accvgpr_read_b32 v247, a15
v_mul_f32 v240, v240, v8
v_mul_f32 v241, v241, v8
v_mul_f32 v242, v242, v8
v_mul_f32 v243, v243, v8
v_mul_f32 v244, v244, v8
v_mul_f32 v245, v245, v8
v_mul_f32 v246, v246, v8
v_mul_f32 v247, v247, v8
v_accvgpr_write_b32 a8, v240
v_accvgpr_write_b32 a9, v241
v_accvgpr_write_b32 a10, v242
v_accvgpr_write_b32 a11, v243
v_accvgpr_write_b32 a12, v244
v_accvgpr_write_b32 a13, v245
v_accvgpr_write_b32 a14, v246
v_accvgpr_write_b32 a15, v247
v_accvgpr_read_b32 v240, a16
v_accvgpr_read_b32 v241, a17
v_accvgpr_read_b32 v242, a18
v_accvgpr_read_b32 v243, a19
v_accvgpr_read_b32 v244, a20
v_accvgpr_read_b32 v245, a21
v_accvgpr_read_b32 v246, a22
v_accvgpr_read_b32 v247, a23
v_mul_f32 v240, v240, v8
v_mul_f32 v241, v241, v8
v_mul_f32 v242, v242, v8
v_mul_f32 v243, v243, v8
v_mul_f32 v244, v244, v8
v_mul_f32 v245, v245, v8
v_mul_f32 v246, v246, v8
v_mul_f32 v247, v247, v8
v_accvgpr_write_b32 a16, v240
v_accvgpr_write_b32 a17, v241
v_accvgpr_write_b32 a18, v242
v_accvgpr_write_b32 a19, v243
v_accvgpr_write_b32 a20, v244
v_accvgpr_write_b32 a21, v245
v_accvgpr_write_b32 a22, v246
v_accvgpr_write_b32 a23, v247
v_accvgpr_read_b32 v240, a24
v_accvgpr_read_b32 v241, a25
v_accvgpr_read_b32 v242, a26
v_accvgpr_read_b32 v243, a27
v_accvgpr_read_b32 v244, a28
v_accvgpr_read_b32 v245, a29
v_accvgpr_read_b32 v246, a30
v_accvgpr_read_b32 v247, a31
v_mul_f32 v240, v240, v8
v_mul_f32 v241, v241, v8
v_mul_f32 v242, v242, v8
v_mul_f32 v243, v243, v8
v_mul_f32 v244, v244, v8
v_mul_f32 v245, v245, v8
v_mul_f32 v246, v246, v8
v_mul_f32 v247, v247, v8
v_accvgpr_write_b32 a24, v240
v_accvgpr_write_b32 a25, v241
v_accvgpr_write_b32 a26, v242
v_accvgpr_write_b32 a27, v243
v_accvgpr_write_b32 a28, v244
v_accvgpr_write_b32 a29, v245
v_accvgpr_write_b32 a30, v246
v_accvgpr_write_b32 a31, v247
v_accvgpr_read_b32 v240, a32
v_accvgpr_read_b32 v241, a33
v_accvgpr_read_b32 v242, a34
v_accvgpr_read_b32 v243, a35
v_accvgpr_read_b32 v244, a36
v_accvgpr_read_b32 v245, a37
v_accvgpr_read_b32 v246, a38
v_accvgpr_read_b32 v247, a39
v_mul_f32 v240, v240, v8
v_mul_f32 v241, v241, v8
v_mul_f32 v242, v242, v8
v_mul_f32 v243, v243, v8
v_mul_f32 v244, v244, v8
v_mul_f32 v245, v245, v8
v_mul_f32 v246, v246, v8
v_mul_f32 v247, v247, v8
v_accvgpr_write_b32 a32, v240
v_accvgpr_write_b32 a33, v241
v_accvgpr_write_b32 a34, v242
v_accvgpr_write_b32 a35, v243
v_accvgpr_write_b32 a36, v244
v_accvgpr_write_b32 a37, v245
v_accvgpr_write_b32 a38, v246
v_accvgpr_write_b32 a39, v247
v_accvgpr_read_b32 v240, a40
v_accvgpr_read_b32 v241, a41
v_accvgpr_read_b32 v242, a42
v_accvgpr_read_b32 v243, a43
v_accvgpr_read_b32 v244, a44
v_accvgpr_read_b32 v245, a45
v_accvgpr_read_b32 v246, a46
v_accvgpr_read_b32 v247, a47
v_mul_f32 v240, v240, v8
v_mul_f32 v241, v241, v8
v_mul_f32 v242, v242, v8
v_mul_f32 v243, v243, v8
v_mul_f32 v244, v244, v8
v_mul_f32 v245, v245, v8
v_mul_f32 v246, v246, v8
v_mul_f32 v247, v247, v8
v_accvgpr_write_b32 a40, v240
v_accvgpr_write_b32 a41, v241
v_accvgpr_write_b32 a42, v242
v_accvgpr_write_b32 a43, v243
v_accvgpr_write_b32 a44, v244
v_accvgpr_write_b32 a45, v245
v_accvgpr_write_b32 a46, v246
v_accvgpr_write_b32 a47, v247
v_accvgpr_read_b32 v240, a48
v_accvgpr_read_b32 v241, a49
v_accvgpr_read_b32 v242, a50
v_accvgpr_read_b32 v243, a51
v_accvgpr_read_b32 v244, a52
v_accvgpr_read_b32 v245, a53
v_accvgpr_read_b32 v246, a54
v_accvgpr_read_b32 v247, a55
v_mul_f32 v240, v240, v8
v_mul_f32 v241, v241, v8
v_mul_f32 v242, v242, v8
v_mul_f32 v243, v243, v8
v_mul_f32 v244, v244, v8
v_mul_f32 v245, v245, v8
v_mul_f32 v246, v246, v8
v_mul_f32 v247, v247, v8
v_accvgpr_write_b32 a48, v240
v_accvgpr_write_b32 a49, v241
v_accvgpr_write_b32 a50, v242
v_accvgpr_write_b32 a51, v243
v_accvgpr_write_b32 a52, v244
v_accvgpr_write_b32 a53, v245
v_accvgpr_write_b32 a54, v246
v_accvgpr_write_b32 a55, v247
v_accvgpr_read_b32 v240, a56
v_accvgpr_read_b32 v241, a57
v_accvgpr_read_b32 v242, a58
v_accvgpr_read_b32 v243, a59
v_accvgpr_read_b32 v244, a60
v_accvgpr_read_b32 v245, a61
v_accvgpr_read_b32 v246, a62
v_accvgpr_read_b32 v247, a63
v_mul_f32 v240, v240, v8
v_mul_f32 v241, v241, v8
v_mul_f32 v242, v242, v8
v_mul_f32 v243, v243, v8
v_mul_f32 v244, v244, v8
v_mul_f32 v245, v245, v8
v_mul_f32 v246, v246, v8
v_mul_f32 v247, v247, v8
v_accvgpr_write_b32 a56, v240
v_accvgpr_write_b32 a57, v241
v_accvgpr_write_b32 a58, v242
v_accvgpr_write_b32 a59, v243
v_accvgpr_write_b32 a60, v244
v_accvgpr_write_b32 a61, v245
v_accvgpr_write_b32 a62, v246
v_accvgpr_write_b32 a63, v247
v_accvgpr_read_b32 v240, a64
v_accvgpr_read_b32 v241, a65
v_accvgpr_read_b32 v242, a66
v_accvgpr_read_b32 v243, a67
v_accvgpr_read_b32 v244, a68
v_accvgpr_read_b32 v245, a69
v_accvgpr_read_b32 v246, a70
v_accvgpr_read_b32 v247, a71
v_mul_f32 v240, v240, v9
v_mul_f32 v241, v241, v9
v_mul_f32 v242, v242, v9
v_mul_f32 v243, v243, v9
v_mul_f32 v244, v244, v9
v_mul_f32 v245, v245, v9
v_mul_f32 v246, v246, v9
v_mul_f32 v247, v247, v9
v_accvgpr_write_b32 a64, v240
v_accvgpr_write_b32 a65, v241
v_accvgpr_write_b32 a66, v242
v_accvgpr_write_b32 a67, v243
v_accvgpr_write_b32 a68, v244
v_accvgpr_write_b32 a69, v245
v_accvgpr_write_b32 a70, v246
v_accvgpr_write_b32 a71, v247
v_accvgpr_read_b32 v240, a72
v_accvgpr_read_b32 v241, a73
v_accvgpr_read_b32 v242, a74
v_accvgpr_read_b32 v243, a75
v_accvgpr_read_b32 v244, a76
v_accvgpr_read_b32 v245, a77
v_accvgpr_read_b32 v246, a78
v_accvgpr_read_b32 v247, a79
v_mul_f32 v240, v240, v9
v_mul_f32 v241, v241, v9
v_mul_f32 v242, v242, v9
v_mul_f32 v243, v243, v9
v_mul_f32 v244, v244, v9
v_mul_f32 v245, v245, v9
v_mul_f32 v246, v246, v9
v_mul_f32 v247, v247, v9
v_accvgpr_write_b32 a72, v240
v_accvgpr_write_b32 a73, v241
v_accvgpr_write_b32 a74, v242
v_accvgpr_write_b32 a75, v243
v_accvgpr_write_b32 a76, v244
v_accvgpr_write_b32 a77, v245
v_accvgpr_write_b32 a78, v246
v_accvgpr_write_b32 a79, v247
v_accvgpr_read_b32 v240, a80
v_accvgpr_read_b32 v241, a81
v_accvgpr_read_b32 v242, a82
v_accvgpr_read_b32 v243, a83
v_accvgpr_read_b32 v244, a84
v_accvgpr_read_b32 v245, a85
v_accvgpr_read_b32 v246, a86
v_accvgpr_read_b32 v247, a87
v_mul_f32 v240, v240, v9
v_mul_f32 v241, v241, v9
v_mul_f32 v242, v242, v9
v_mul_f32 v243, v243, v9
v_mul_f32 v244, v244, v9
v_mul_f32 v245, v245, v9
v_mul_f32 v246, v246, v9
v_mul_f32 v247, v247, v9
v_accvgpr_write_b32 a80, v240
v_accvgpr_write_b32 a81, v241
v_accvgpr_write_b32 a82, v242
v_accvgpr_write_b32 a83, v243
v_accvgpr_write_b32 a84, v244
v_accvgpr_write_b32 a85, v245
v_accvgpr_write_b32 a86, v246
v_accvgpr_write_b32 a87, v247
v_accvgpr_read_b32 v240, a88
v_accvgpr_read_b32 v241, a89
v_accvgpr_read_b32 v242, a90
v_accvgpr_read_b32 v243, a91
v_accvgpr_read_b32 v244, a92
v_accvgpr_read_b32 v245, a93
v_accvgpr_read_b32 v246, a94
v_accvgpr_read_b32 v247, a95
v_mul_f32 v240, v240, v9
v_mul_f32 v241, v241, v9
v_mul_f32 v242, v242, v9
v_mul_f32 v243, v243, v9
v_mul_f32 v244, v244, v9
v_mul_f32 v245, v245, v9
v_mul_f32 v246, v246, v9
v_mul_f32 v247, v247, v9
v_accvgpr_write_b32 a88, v240
v_accvgpr_write_b32 a89, v241
v_accvgpr_write_b32 a90, v242
v_accvgpr_write_b32 a91, v243
v_accvgpr_write_b32 a92, v244
v_accvgpr_write_b32 a93, v245
v_accvgpr_write_b32 a94, v246
v_accvgpr_write_b32 a95, v247
v_accvgpr_read_b32 v240, a96
v_accvgpr_read_b32 v241, a97
v_accvgpr_read_b32 v242, a98
v_accvgpr_read_b32 v243, a99
v_accvgpr_read_b32 v244, a100
v_accvgpr_read_b32 v245, a101
v_accvgpr_read_b32 v246, a102
v_accvgpr_read_b32 v247, a103
v_mul_f32 v240, v240, v9
v_mul_f32 v241, v241, v9
v_mul_f32 v242, v242, v9
v_mul_f32 v243, v243, v9
v_mul_f32 v244, v244, v9
v_mul_f32 v245, v245, v9
v_mul_f32 v246, v246, v9
v_mul_f32 v247, v247, v9
v_accvgpr_write_b32 a96, v240
v_accvgpr_write_b32 a97, v241
v_accvgpr_write_b32 a98, v242
v_accvgpr_write_b32 a99, v243
v_accvgpr_write_b32 a100, v244
v_accvgpr_write_b32 a101, v245
v_accvgpr_write_b32 a102, v246
v_accvgpr_write_b32 a103, v247
v_accvgpr_read_b32 v240, a104
v_accvgpr_read_b32 v241, a105
v_accvgpr_read_b32 v242, a106
v_accvgpr_read_b32 v243, a107
v_accvgpr_read_b32 v244, a108
v_accvgpr_read_b32 v245, a109
v_accvgpr_read_b32 v246, a110
v_accvgpr_read_b32 v247, a111
v_mul_f32 v240, v240, v9
v_mul_f32 v241, v241, v9
v_mul_f32 v242, v242, v9
v_mul_f32 v243, v243, v9
v_mul_f32 v244, v244, v9
v_mul_f32 v245, v245, v9
v_mul_f32 v246, v246, v9
v_mul_f32 v247, v247, v9
v_accvgpr_write_b32 a104, v240
v_accvgpr_write_b32 a105, v241
v_accvgpr_write_b32 a106, v242
v_accvgpr_write_b32 a107, v243
v_accvgpr_write_b32 a108, v244
v_accvgpr_write_b32 a109, v245
v_accvgpr_write_b32 a110, v246
v_accvgpr_write_b32 a111, v247
v_accvgpr_read_b32 v240, a112
v_accvgpr_read_b32 v241, a113
v_accvgpr_read_b32 v242, a114
v_accvgpr_read_b32 v243, a115
v_accvgpr_read_b32 v244, a116
v_accvgpr_read_b32 v245, a117
v_accvgpr_read_b32 v246, a118
v_accvgpr_read_b32 v247, a119
v_mul_f32 v240, v240, v9
v_mul_f32 v241, v241, v9
v_mul_f32 v242, v242, v9
v_mul_f32 v243, v243, v9
v_mul_f32 v244, v244, v9
v_mul_f32 v245, v245, v9
v_mul_f32 v246, v246, v9
v_mul_f32 v247, v247, v9
v_accvgpr_write_b32 a112, v240
v_accvgpr_write_b32 a113, v241
v_accvgpr_write_b32 a114, v242
v_accvgpr_write_b32 a115, v243
v_accvgpr_write_b32 a116, v244
v_accvgpr_write_b32 a117, v245
v_accvgpr_write_b32 a118, v246
v_accvgpr_write_b32 a119, v247
v_accvgpr_read_b32 v240, a120
v_accvgpr_read_b32 v241, a121
v_accvgpr_read_b32 v242, a122
v_accvgpr_read_b32 v243, a123
v_accvgpr_read_b32 v244, a124
v_accvgpr_read_b32 v245, a125
v_accvgpr_read_b32 v246, a126
v_accvgpr_read_b32 v247, a127
v_mul_f32 v240, v240, v9
v_mul_f32 v241, v241, v9
v_mul_f32 v242, v242, v9
v_mul_f32 v243, v243, v9
v_mul_f32 v244, v244, v9
v_mul_f32 v245, v245, v9
v_mul_f32 v246, v246, v9
v_mul_f32 v247, v247, v9
v_accvgpr_write_b32 a120, v240
v_accvgpr_write_b32 a121, v241
v_accvgpr_write_b32 a122, v242
v_accvgpr_write_b32 a123, v243
v_accvgpr_write_b32 a124, v244
v_accvgpr_write_b32 a125, v245
v_accvgpr_write_b32 a126, v246
v_accvgpr_write_b32 a127, v247
s_nop 1
s_branch L_p3_d0m_end
L_p3_mx_rare:
v_mov_b32 v240, v6
v_mov_b32 v241, v6
s_nop 1
v_permlane32_swap_b32 v240, v241
v_max_f32 v242, v240, v241
v_max_f32 v242, 0, v242
v_exp_f32 v8, -v242
v_sub_f32 v208, v208, v242
v_sub_f32 v209, v209, v242
v_sub_f32 v210, v210, v242
v_sub_f32 v211, v211, v242
v_sub_f32 v212, v212, v242
v_sub_f32 v213, v213, v242
v_sub_f32 v214, v214, v242
v_sub_f32 v215, v215, v242
v_sub_f32 v216, v216, v242
v_sub_f32 v217, v217, v242
v_sub_f32 v218, v218, v242
v_sub_f32 v219, v219, v242
v_sub_f32 v220, v220, v242
v_sub_f32 v221, v221, v242
v_sub_f32 v222, v222, v242
v_sub_f32 v223, v223, v242
v_mul_f32 v2, v2, v8
v_mul_f32 v3, v3, v8
v_sub_f32 v80, v80, v242
v_sub_f32 v81, v81, v242
v_sub_f32 v82, v82, v242
v_sub_f32 v83, v83, v242
v_sub_f32 v84, v84, v242
v_sub_f32 v85, v85, v242
v_sub_f32 v86, v86, v242
v_sub_f32 v87, v87, v242
v_sub_f32 v88, v88, v242
v_sub_f32 v89, v89, v242
v_sub_f32 v90, v90, v242
v_sub_f32 v91, v91, v242
v_sub_f32 v92, v92, v242
v_sub_f32 v93, v93, v242
v_sub_f32 v94, v94, v242
v_sub_f32 v95, v95, v242
v_sub_f32 v112, v112, v242
v_sub_f32 v113, v113, v242
v_sub_f32 v114, v114, v242
v_sub_f32 v115, v115, v242
v_sub_f32 v116, v116, v242
v_sub_f32 v117, v117, v242
v_sub_f32 v118, v118, v242
v_sub_f32 v119, v119, v242
v_sub_f32 v120, v120, v242
v_sub_f32 v121, v121, v242
v_sub_f32 v122, v122, v242
v_sub_f32 v123, v123, v242
v_sub_f32 v124, v124, v242
v_sub_f32 v125, v125, v242
v_sub_f32 v126, v126, v242
v_sub_f32 v127, v127, v242
s_add_u32 m0, s72, 16384
ds_read_b128 a[136:139], v10 offset:2048
v_exp_f32 v80, v80
v_bfe_u32 v248, v1, 2, 2
v_bfe_u32 v249, v1, 4, 1
v_mfma_f32_32x32x16_bf16 a[48:63], a[204:207], v[144:147], a[48:63]
ds_read_b128 a[140:143], v10 offset:3072
buffer_load_dwordx4 v12, s[52:55], s71 offen offset:0 sc1 lds
v_lshl_add_u32 v248, v249, 2, v248
v_lshrrev_b32 v249, 5, v1
v_exp_f32 v81, v81
v_mfma_f32_32x32x16_bf16 a[112:127], a[204:207], v[160:163], a[112:127]
v_lshl_add_u32 v249, v249, 4, v248
v_lshlrev_b32 v249, 8, v249
v_and_b32 v250, 3, v1
v_exp_f32 v82, v82
v_lshl_add_u32 v249, v250, 3, v249
v_mfma_f32_32x32x16_bf16 a[0:15], a[208:211], v[152:155], a[0:15]
ds_read_b128 a[144:147], v10 offset:4096
s_lshl_b32 s36, s3, 13
s_add_u32 s36, s36, 131072
v_add_f32 v2, v2, v80
v_add_u32 v249, s36, v249
v_xor_b32 v250, 0, v248
v_mfma_f32_32x32x16_bf16 a[64:79], a[208:211], v[168:171], a[64:79]
ds_read_b128 a[148:151], v10 offset:5120
v_lshl_add_u32 v250, v250, 5, v249
TR 96,250,0
v_exp_f32 v83, v83
TR 98,250,2048
v_mfma_f32_32x32x16_bf16 a[16:31], a[212:215], v[152:155], a[16:31]
v_xor_b32 v250, 1, v248
v_lshl_add_u32 v250, v250, 5, v249
v_add_f32 v3, v3, v81
TR 100,250,0
TR 102,250,2048
v_xor_b32 v250, 2, v248
v_mfma_f32_32x32x16_bf16 a[80:95], a[212:215], v[168:171], a[80:95]
ds_read_b128 a[152:155], v10 offset:6144
buffer_load_dwordx4 v12, s[52:55], s71 offen offset:1024 sc1 lds
v_cvt_pk_bf16_f32 v80, v80, v81
v_lshl_add_u32 v250, v250, 5, v249
TR 104,250,0
TR 106,250,2048
v_mfma_f32_32x32x16_bf16 a[32:47], a[216:219], v[152:155], a[32:47]
v_exp_f32 v84, v84
v_xor_b32 v250, 3, v248
v_lshl_add_u32 v250, v250, 5, v249
TR 108,250,0
TR 110,250,2048
v_mfma_f32_32x32x16_bf16 a[96:111], a[216:219], v[168:171], a[96:111]
ds_read_b128 a[156:159], v10 offset:7168
v_add_f32 v2, v2, v82
v_xor_b32 v250, 4, v248
v_lshl_add_u32 v250, v250, 5, v249
TR 128,250,0
v_mfma_f32_32x32x16_bf16 a[48:63], a[220:223], v[152:155], a[48:63]
ds_read_b128 a[160:163], v10 offset:8192
v_exp_f32 v85, v85
TR 130,250,2048
v_xor_b32 v250, 5, v248
v_lshl_add_u32 v250, v250, 5, v249
v_mfma_f32_32x32x16_bf16 a[112:127], a[220:223], v[168:171], a[112:127]
v_add_f32 v3, v3, v83
v_cvt_pk_bf16_f32 v81, v82, v83
TR 132,250,0
TR 134,250,2048
v_xor_b32 v250, 6, v248
v_mfma_f32_32x32x16_bf16 a[0:15], a[224:227], v[176:179], a[0:15]
ds_read_b128 a[164:167], v10 offset:9216
buffer_load_dwordx4 v12, s[52:55], s71 offen offset:2048 sc1 lds
v_exp_f32 v86, v86
v_lshl_add_u32 v250, v250, 5, v249
TR 136,250,0
v_mfma_f32_32x32x16_bf16 a[64:79], a[224:227], v[192:195], a[64:79]
TR 138,250,2048
v_xor_b32 v250, 7, v248
v_add_f32 v2, v2, v84
v_lshl_add_u32 v250, v250, 5, v249
TR 140,250,0
TR 142,250,2048
v_mfma_f32_32x32x16_bf16 a[16:31], a[228:231], v[176:179], a[16:31]
ds_read_b128 a[168:171], v10 offset:10240
v_exp_f32 v87, v87
s_add_u32 s32, s40, 100663296
s_addc_u32 s33, s41, 0
s_mov_b32 s34, 8388608
v_mfma_f32_32x32x16_bf16 a[80:95], a[228:231], v[192:195], a[80:95]
ds_read_b128 a[172:175], v10 offset:11264
v_add_f32 v3, v3, v85
s_mov_b32 s35, 0x20000
s_and_b32 s36, s2, 7
s_lshl_b32 s36, s36, 20
v_mfma_f32_32x32x16_bf16 a[32:47], a[232:235], v[176:179], a[32:47]
v_cvt_pk_bf16_f32 v82, v84, v85
s_lshr_b32 s37, s2, 3
s_lshl_b32 s37, s37, 15
s_add_u32 s36, s36, s37
s_lshl_b32 s37, s3, 12
v_mfma_f32_32x32x16_bf16 a[96:111], a[232:235], v[192:195], a[96:111]
ds_read_b128 a[176:179], v10 offset:12288
buffer_load_dwordx4 v12, s[52:55], s71 offen offset:3072 sc1 lds
v_exp_f32 v88, v88
s_add_u32 s36, s36, s37
s_add_u32 s37, s36, 4096
v_mfma_f32_32x32x16_bf16 a[48:63], a[236:239], v[176:179], a[48:63]
s_waitcnt lgkmcnt(15)
buffer_store_dwordx4 v[96:99], v12, s[32:35], s36 offen offset:0 sc1
v_add_f32 v2, v2, v86
buffer_store_dwordx4 v[100:103], v12, s[32:35], s36 offen offset:1024 sc1
buffer_store_dwordx4 v[104:107], v12, s[32:35], s36 offen offset:2048 sc1
s_waitcnt lgkmcnt(14)
buffer_store_dwordx4 v[108:111], v12, s[32:35], s36 offen offset:3072 sc1
v_mfma_f32_32x32x16_bf16 a[112:127], a[236:239], v[192:195], a[112:127]
ds_read_b128 a[180:183], v10 offset:13312
v_exp_f32 v89, v89
s_waitcnt lgkmcnt(11)
buffer_store_dwordx4 v[128:131], v12, s[32:35], s37 offen offset:0 sc1
s_waitcnt lgkmcnt(9)
buffer_store_dwordx4 v[132:135], v12, s[32:35], s37 offen offset:1024 sc1
s_waitcnt lgkmcnt(6)
buffer_store_dwordx4 v[136:139], v12, s[32:35], s37 offen offset:2048 sc1
v_mfma_f32_32x32x16_bf16 a[0:15], a[240:243], v[184:187], a[0:15]
ds_read_b128 a[184:187], v10 offset:14336
v_add_f32 v3, v3, v87
v_cvt_pk_bf16_f32 v83, v86, v87
s_waitcnt lgkmcnt(5)
buffer_store_dwordx4 v[140:143], v12, s[32:35], s37 offen offset:3072 sc1
s_add_u32 s32, s40, 109051904
s_addc_u32 s33, s41, 0
v_mfma_f32_32x32x16_bf16 a[64:79], a[240:243], v[200:203], a[64:79]
s_mov_b32 s34, 4194304
v_exp_f32 v90, v90
s_mov_b32 s35, 0x20000
s_lshl_b32 s36, s2, 14
v_mov_b32 v252, -1
v_mfma_f32_32x32x16_bf16 a[16:31], a[244:247], v[184:187], a[16:31]
ds_read_b128 a[188:191], v10 offset:15360
s_xor_b32 s72, s72, 0x8000
v_add_f32 v2, v2, v88
v_mov_b32 v253, -1
v_mov_b32 v254, -1
v_mov_b32 v255, -1
v_mfma_f32_32x32x16_bf16 a[80:95], a[244:247], v[200:203], a[80:95]
v_exp_f32 v91, v91
buffer_store_dwordx4 v[252:255], v12, s[32:35], s36 offen offset:0 sc1
buffer_store_dwordx4 v[252:255], v12, s[32:35], s36 offen offset:1024 sc1
buffer_store_dwordx4 v[252:255], v12, s[32:35], s36 offen offset:2048 sc1
v_mfma_f32_32x32x16_bf16 a[32:47], a[248:251], v[184:187], a[32:47]
v_add_f32 v3, v3, v89
buffer_store_dwordx4 v[252:255], v12, s[32:35], s36 offen offset:3072 sc1
v_lshlrev_b32 v72, 4, v1
v_add_u32 v73, -8, v72
v_mov_b32 v75, 0
v_mfma_f32_32x32x16_bf16 a[96:111], a[248:251], v[200:203], a[96:111]
v_cvt_pk_bf16_f32 v88, v88, v89
buffer_load_ushort v74, v75, s[28:31], s42 offen
buffer_load_dwordx2 v[48:49], v73, s[16:19], 0 offen
buffer_load_dwordx4 v[50:53], v72, s[16:19], 0 offen offset:0
v_mfma_f32_32x32x16_bf16 a[48:63], a[252:255], v[184:187], a[48:63]
v_add_f32 v2, v2, v90
v_add_f32 v3, v3, v91
buffer_load_dwordx2 v[54:55], v72, s[16:19], 0 offen offset:1016
buffer_load_dwordx4 v[56:59], v72, s[16:19], 0 offen offset:1024
buffer_load_dwordx2 v[60:61], v72, s[16:19], 0 offen offset:2040
v_mfma_f32_32x32x16_bf16 a[112:127], a[252:255], v[200:203], a[112:127]
v_cvt_pk_bf16_f32 v89, v90, v91
buffer_load_dwordx4 v[62:65], v72, s[16:19], 0 offen offset:2048
buffer_load_dwordx2 v[66:67], v72, s[16:19], 0 offen offset:3064
buffer_load_dwordx4 v[68:71], v72, s[16:19], 0 offen offset:3072
s_nop 15
v_accvgpr_read_b32 v240, a0
v_accvgpr_read_b32 v241, a1
v_accvgpr_read_b32 v242, a2
v_accvgpr_read_b32 v243, a3
v_accvgpr_read_b32 v244, a4
v_accvgpr_read_b32 v245, a5
v_accvgpr_read_b32 v246, a6
v_accvgpr_read_b32 v247, a7
v_mul_f32 v240, v240, v8
v_mul_f32 v241, v241, v8
v_mul_f32 v242, v242, v8
v_mul_f32 v243, v243, v8
v_mul_f32 v244, v244, v8
v_mul_f32 v245, v245, v8
v_mul_f32 v246, v246, v8
v_mul_f32 v247, v247, v8
v_accvgpr_write_b32 a0, v240
v_accvgpr_write_b32 a1, v241
v_accvgpr_write_b32 a2, v242
v_accvgpr_write_b32 a3, v243
v_accvgpr_write_b32 a4, v244
v_accvgpr_write_b32 a5, v245
v_accvgpr_write_b32 a6, v246
v_accvgpr_write_b32 a7, v247
v_accvgpr_read_b32 v240, a8
v_accvgpr_read_b32 v241, a9
v_accvgpr_read_b32 v242, a10
v_accvgpr_read_b32 v243, a11
v_accvgpr_read_b32 v244, a12
v_accvgpr_read_b32 v245, a13
v_accvgpr_read_b32 v246, a14
v_accvgpr_read_b32 v247, a15
v_mul_f32 v240, v240, v8
v_mul_f32 v241, v241, v8
v_mul_f32 v242, v242, v8
v_mul_f32 v243, v243, v8
v_mul_f32 v244, v244, v8
v_mul_f32 v245, v245, v8
v_mul_f32 v246, v246, v8
v_mul_f32 v247, v247, v8
v_accvgpr_write_b32 a8, v240
v_accvgpr_write_b32 a9, v241
v_accvgpr_write_b32 a10, v242
v_accvgpr_write_b32 a11, v243
v_accvgpr_write_b32 a12, v244
v_accvgpr_write_b32 a13, v245
v_accvgpr_write_b32 a14, v246
v_accvgpr_write_b32 a15, v247
v_accvgpr_read_b32 v240, a16
v_accvgpr_read_b32 v241, a17
v_accvgpr_read_b32 v242, a18
v_accvgpr_read_b32 v243, a19
v_accvgpr_read_b32 v244, a20
v_accvgpr_read_b32 v245, a21
v_accvgpr_read_b32 v246, a22
v_accvgpr_read_b32 v247, a23
v_mul_f32 v240, v240, v8
v_mul_f32 v241, v241, v8
v_mul_f32 v242, v242, v8
v_mul_f32 v243, v243, v8
v_mul_f32 v244, v244, v8
v_mul_f32 v245, v245, v8
v_mul_f32 v246, v246, v8
v_mul_f32 v247, v247, v8
v_accvgpr_write_b32 a16, v240
v_accvgpr_write_b32 a17, v241
v_accvgpr_write_b32 a18, v242
v_accvgpr_write_b32 a19, v243
v_accvgpr_write_b32 a20, v244
v_accvgpr_write_b32 a21, v245
v_accvgpr_write_b32 a22, v246
v_accvgpr_write_b32 a23, v247
v_accvgpr_read_b32 v240, a24
v_accvgpr_read_b32 v241, a25
v_accvgpr_read_b32 v242, a26
v_accvgpr_read_b32 v243, a27
v_accvgpr_read_b32 v244, a28
v_accvgpr_read_b32 v245, a29
v_accvgpr_read_b32 v246, a30
v_accvgpr_read_b32 v247, a31
v_mul_f32 v240, v240, v8
v_mul_f32 v241, v241, v8
v_mul_f32 v242, v242, v8
v_mul_f32 v243, v243, v8
v_mul_f32 v244, v244, v8
v_mul_f32 v245, v245, v8
v_mul_f32 v246, v246, v8
v_mul_f32 v247, v247, v8
v_accvgpr_write_b32 a24, v240
v_accvgpr_write_b32 a25, v241
v_accvgpr_write_b32 a26, v242
v_accvgpr_write_b32 a27, v243
v_accvgpr_write_b32 a28, v244
v_accvgpr_write_b32 a29, v245
v_accvgpr_write_b32 a30, v246
v_accvgpr_write_b32 a31, v247
v_accvgpr_read_b32 v240, a32
v_accvgpr_read_b32 v241, a33
v_accvgpr_read_b32 v242, a34
v_accvgpr_read_b32 v243, a35
v_accvgpr_read_b32 v244, a36
v_accvgpr_read_b32 v245, a37
v_accvgpr_read_b32 v246, a38
v_accvgpr_read_b32 v247, a39
v_mul_f32 v240, v240, v8
v_mul_f32 v241, v241, v8
v_mul_f32 v242, v242, v8
v_mul_f32 v243, v243, v8
v_mul_f32 v244, v244, v8
v_mul_f32 v245, v245, v8
v_mul_f32 v246, v246, v8
v_mul_f32 v247, v247, v8
v_accvgpr_write_b32 a32, v240
v_accvgpr_write_b32 a33, v241
v_accvgpr_write_b32 a34, v242
v_accvgpr_write_b32 a35, v243
v_accvgpr_write_b32 a36, v244
v_accvgpr_write_b32 a37, v245
v_accvgpr_write_b32 a38, v246
v_accvgpr_write_b32 a39, v247
v_accvgpr_read_b32 v240, a40
v_accvgpr_read_b32 v241, a41
v_accvgpr_read_b32 v242, a42
v_accvgpr_read_b32 v243, a43
v_accvgpr_read_b32 v244, a44
v_accvgpr_read_b32 v245, a45
v_accvgpr_read_b32 v246, a46
v_accvgpr_read_b32 v247, a47
v_mul_f32 v240, v240, v8
v_mul_f32 v241, v241, v8
v_mul_f32 v242, v242, v8
v_mul_f32 v243, v243, v8
v_mul_f32 v244, v244, v8
v_mul_f32 v245, v245, v8
v_mul_f32 v246, v246, v8
v_mul_f32 v247, v247, v8
v_accvgpr_write_b32 a40, v240
v_accvgpr_write_b32 a41, v241
v_accvgpr_write_b32 a42, v242
v_accvgpr_write_b32 a43, v243
v_accvgpr_write_b32 a44, v244
v_accvgpr_write_b32 a45, v245
v_accvgpr_write_b32 a46, v246
v_accvgpr_write_b32 a47, v247
v_accvgpr_read_b32 v240, a48
v_accvgpr_read_b32 v241, a49
v_accvgpr_read_b32 v242, a50
v_accvgpr_read_b32 v243, a51
v_accvgpr_read_b32 v244, a52
v_accvgpr_read_b32 v245, a53
v_accvgpr_read_b32 v246, a54
v_accvgpr_read_b32 v247, a55
v_mul_f32 v240, v240, v8
v_mul_f32 v241, v241, v8
v_mul_f32 v242, v242, v8
v_mul_f32 v243, v243, v8
v_mul_f32 v244, v244, v8
v_mul_f32 v245, v245, v8
v_mul_f32 v246, v246, v8
v_mul_f32 v247, v247, v8
v_accvgpr_write_b32 a48, v240
v_accvgpr_write_b32 a49, v241
v_accvgpr_write_b32 a50, v242
v_accvgpr_write_b32 a51, v243
v_accvgpr_write_b32 a52, v244
v_accvgpr_write_b32 a53, v245
v_accvgpr_write_b32 a54, v246
v_accvgpr_write_b32 a55, v247
v_accvgpr_read_b32 v240, a56
v_accvgpr_read_b32 v241, a57
v_accvgpr_read_b32 v242, a58
v_accvgpr_read_b32 v243, a59
v_accvgpr_read_b32 v244, a60
v_accvgpr_read_b32 v245, a61
v_accvgpr_read_b32 v246, a62
v_accvgpr_read_b32 v247, a63
v_mul_f32 v240, v240, v8
v_mul_f32 v241, v241, v8
v_mul_f32 v242, v242, v8
v_mul_f32 v243, v243, v8
v_mul_f32 v244, v244, v8
v_mul_f32 v245, v245, v8
v_mul_f32 v246, v246, v8
v_mul_f32 v247, v247, v8
v_accvgpr_write_b32 a56, v240
v_accvgpr_write_b32 a57, v241
v_accvgpr_write_b32 a58, v242
v_accvgpr_write_b32 a59, v243
v_accvgpr_write_b32 a60, v244
v_accvgpr_write_b32 a61, v245
v_accvgpr_write_b32 a62, v246
v_accvgpr_write_b32 a63, v247
s_nop 1
s_branch L_p3_mx_end
L_p3_mxm_rare:
v_mov_b32 v240, v6
v_mov_b32 v241, v6
s_nop 1
v_permlane32_swap_b32 v240, v241
v_max_f32 v242, v240, v241
v_max_f32 v242, 0, v242
v_exp_f32 v8, -v242
v_sub_f32 v208, v208, v242
v_sub_f32 v209, v209, v242
v_sub_f32 v210, v210, v242
v_sub_f32 v211, v211, v242
v_sub_f32 v212, v212, v242
v_sub_f32 v213, v213, v242
v_sub_f32 v214, v214, v242
v_sub_f32 v215, v215, v242
v_sub_f32 v216, v216, v242
v_sub_f32 v217, v217, v242
v_sub_f32 v218, v218, v242
v_sub_f32 v219, v219, v242
v_sub_f32 v220, v220, v242
v_sub_f32 v221, v221, v242
v_sub_f32 v222, v222, v242
v_sub_f32 v223, v223, v242
v_mul_f32 v2, v2, v8
v_mul_f32 v3, v3, v8
v_sub_f32 v80, v80, v242
v_sub_f32 v81, v81, v242
v_sub_f32 v82, v82, v242
v_sub_f32 v83, v83, v242
v_sub_f32 v84, v84, v242
v_sub_f32 v85, v85, v242
v_sub_f32 v86, v86, v242
v_sub_f32 v87, v87, v242
v_sub_f32 v88, v88, v242
v_sub_f32 v89, v89, v242
v_sub_f32 v90, v90, v242
v_sub_f32 v91, v91, v242
v_sub_f32 v92, v92, v242
v_sub_f32 v93, v93, v242
v_sub_f32 v94, v94, v242
v_sub_f32 v95, v95, v242
v_sub_f32 v112, v112, v242
v_sub_f32 v113, v113, v242
v_sub_f32 v114, v114, v242
v_sub_f32 v115, v115, v242
v_sub_f32 v116, v116, v242
v_sub_f32 v117, v117, v242
v_sub_f32 v118, v118, v242
v_sub_f32 v119, v119, v242
v_sub_f32 v120, v120, v242
v_sub_f32 v121, v121, v242
v_sub_f32 v122, v122, v242
v_sub_f32 v123, v123, v242
v_sub_f32 v124, v124, v242
v_sub_f32 v125, v125, v242
v_sub_f32 v126, v126, v242
v_sub_f32 v127, v127, v242
s_add_u32 m0, s72, 16384
ds_read_b128 a[152:155], v10 offset:6144
v_exp_f32 v80, v80
v_bfe_u32 v248, v1, 2, 2
v_bfe_u32 v249, v1, 4, 1
v_mfma_f32_32x32x16_bf16 a[32:47], a[216:219], v[152:155], a[32:47]
ds_read_b128 a[156:159], v10 offset:7168
buffer_load_dwordx4 v12, s[52:55], s71 offen offset:0 sc1 lds
v_lshl_add_u32 v248, v249, 2, v248
v_lshrrev_b32 v249, 5, v1
v_lshl_add_u32 v249, v249, 4, v248
v_lshlrev_b32 v249, 8, v249
v_mfma_f32_32x32x16_bf16 a[96:111], a[216:219], v[168:171], a[96:111]
v_exp_f32 v81, v81
v_and_b32 v250, 3, v1
v_lshl_add_u32 v249, v250, 3, v249
s_lshl_b32 s36, s3, 13
s_add_u32 s36, s36, 131072
v_mfma_f32_32x32x16_bf16 a[48:63], a[220:223], v[152:155], a[48:63]
ds_read_b128 a[160:163], v10 offset:8192
v_exp_f32 v82, v82
v_add_u32 v249, s36, v249
v_xor_b32 v250, 0, v248
v_lshl_add_u32 v250, v250, 5, v249
v_mfma_f32_32x32x16_bf16 a[112:127], a[220:223], v[168:171], a[112:127]
v_add_f32 v2, v2, v80
v_exp_f32 v83, v83
TR 96,250,0
TR 98,250,2048
v_xor_b32 v250, 1, v248
v_mfma_f32_32x32x16_bf16 a[0:15], a[224:227], v[176:179], a[0:15]
ds_read_b128 a[164:167], v10 offset:9216
buffer_load_dwordx4 v12, s[52:55], s71 offen offset:1024 sc1 lds
v_lshl_add_u32 v250, v250, 5, v249
v_add_f32 v3, v3, v81
TR 100,250,0
TR 102,250,2048
v_mfma_f32_32x32x16_bf16 a[64:79], a[224:227], v[192:195], a[64:79]
ds_read_b128 a[168:171], v10 offset:10240
v_xor_b32 v250, 2, v248
v_lshl_add_u32 v250, v250, 5, v249
v_cvt_pk_bf16_f32 v80, v80, v81
v_exp_f32 v84, v84
v_mfma_f32_32x32x16_bf16 a[16:31], a[228:231], v[176:179], a[16:31]
TR 104,250,0
TR 106,250,2048
v_xor_b32 v250, 3, v248
v_lshl_add_u32 v250, v250, 5, v249
TR 108,250,0
v_add_f32 v2, v2, v82
v_mfma_f32_32x32x16_bf16 a[80:95], a[228:231], v[192:195], a[80:95]
ds_read_b128 a[172:175], v10 offset:11264
TR 110,250,2048
v_xor_b32 v250, 4, v248
v_lshl_add_u32 v250, v250, 5, v249
TR 128,250,0
TR 130,250,2048
v_mfma_f32_32x32x16_bf16 a[32:47], a[232:235], v[176:179], a[32:47]
buffer_load_dwordx4 v12, s[52:55], s71 offen offset:2048 sc1 lds
v_exp_f32 v85, v85
v_xor_b32 v250, 5, v248
v_lshl_add_u32 v250, v250, 5, v249
TR 132,250,0
v_mfma_f32_32x32x16_bf16 a[96:111], a[232:235], v[192:195], a[96:111]
ds_read_b128 a[176:179], v10 offset:12288
v_add_f32 v3, v3, v83
v_cvt_pk_bf16_f32 v81, v82, v83
TR 134,250,2048
v_xor_b32 v250, 6, v248
v_lshl_add_u32 v250, v250, 5, v249
v_mfma_f32_32x32x16_bf16 a[48:63], a[236:239], v[176:179], a[48:63]
ds_read_b128 a[180:183], v10 offset:13312
TR 136,250,0
v_exp_f32 v86, v86
TR 138,250,2048
v_xor_b32 v250, 7, v248
v_mfma_f32_32x32x16_bf16 a[112:127], a[236:239], v[192:195], a[112:127]
v_lshl_add_u32 v250, v250, 5, v249
TR 140,250,0
v_add_f32 v2, v2, v84
v_exp_f32 v87, v87
TR 142,250,2048
v_mfma_f32_32x32x16_bf16 a[0:15], a[240:243], v[184:187], a[0:15]
ds_read_b128 a[184:187], v10 offset:14336
buffer_load_dwordx4 v12, s[52:55], s71 offen offset:3072 sc1 lds
s_add_u32 s32, s40, 100663296
s_addc_u32 s33, s41, 0
s_mov_b32 s34, 8388608
s_mov_b32 s35, 0x20000
v_mfma_f32_32x32x16_bf16 a[64:79], a[240:243], v[200:203], a[64:79]
v_add_f32 v3, v3, v85
s_and_b32 s36, s2, 7
s_lshl_b32 s36, s36, 20
s_lshr_b32 s37, s2, 3
s_lshl_b32 s37, s37, 15
v_cvt_pk_bf16_f32 v82, v84, v85
v_mfma_f32_32x32x16_bf16 a[16:31], a[244:247], v[184:187], a[16:31]
ds_read_b128 a[188:191], v10 offset:15360
v_exp_f32 v88, v88
s_add_u32 s36, s36, s37
s_lshl_b32 s37, s3, 12
s_add_u32 s36, s36, s37
v_mfma_f32_32x32x16_bf16 a[80:95], a[244:247], v[200:203], a[80:95]
s_add_u32 s37, s36, 4096
v_add_f32 v2, v2, v86
s_waitcnt lgkmcnt(15)
buffer_store_dwordx4 v[96:99], v12, s[32:35], s36 offen offset:0 sc1
buffer_store_dwordx4 v[100:103], v12, s[32:35], s36 offen offset:1024 sc1
buffer_store_dwordx4 v[104:107], v12, s[32:35], s36 offen offset:2048 sc1
s_waitcnt lgkmcnt(12)
buffer_store_dwordx4 v[108:111], v12, s[32:35], s36 offen offset:3072 sc1
v_mfma_f32_32x32x16_bf16 a[32:47], a[248:251], v[184:187], a[32:47]
s_xor_b32 s72, s72, 0x8000
v_exp_f32 v89, v89
s_waitcnt lgkmcnt(10)
buffer_store_dwordx4 v[128:131], v12, s[32:35], s37 offen offset:0 sc1
s_waitcnt lgkmcnt(7)
buffer_store_dwordx4 v[132:135], v12, s[32:35], s37 offen offset:1024 sc1
s_waitcnt lgkmcnt(4)
buffer_store_dwordx4 v[136:139], v12, s[32:35], s37 offen offset:2048 sc1
v_mfma_f32_32x32x16_bf16 a[96:111], a[248:251], v[200:203], a[96:111]
s_waitcnt lgkmcnt(2)
buffer_store_dwordx4 v[140:143], v12, s[32:35], s37 offen offset:3072 sc1
v_add_f32 v3, v3, v87
v_cvt_pk_bf16_f32 v83, v86, v87
s_add_u32 s32, s40, 109051904
s_addc_u32 s33, s41, 0
s_mov_b32 s34, 4194304
v_mfma_f32_32x32x16_bf16 a[48:63], a[252:255], v[184:187], a[48:63]
s_mov_b32 s35, 0x20000
s_lshl_b32 s36, s2, 14
v_exp_f32 v90, v90
v_mov_b32 v252, -1
v_mov_b32 v253, -1
v_mfma_f32_32x32x16_bf16 a[112:127], a[252:255], v[200:203], a[112:127]
v_mov_b32 v254, -1
v_mov_b32 v255, -1
v_add_f32 v2, v2, v88
v_exp_f32 v91, v91
buffer_store_dwordx4 v[252:255], v12, s[32:35], s36 offen offset:0 sc1
buffer_store_dwordx4 v[252:255], v12, s[32:35], s36 offen offset:1024 sc1
buffer_store_dwordx4 v[252:255], v12, s[32:35], s36 offen offset:2048 sc1
buffer_store_dwordx4 v[252:255], v12, s[32:35], s36 offen offset:3072 sc1
v_add_f32 v3, v3, v89
v_lshlrev_b32 v72, 4, v1
v_add_u32 v73, -8, v72
v_mov_b32 v75, 0
buffer_load_ushort v74, v75, s[28:31], s42 offen
v_cvt_pk_bf16_f32 v88, v88, v89
v_add_f32 v2, v2, v90
buffer_load_dwordx2 v[48:49], v73, s[16:19], 0 offen
buffer_load_dwordx4 v[50:53], v72, s[16:19], 0 offen offset:0
buffer_load_dwordx2 v[54:55], v72, s[16:19], 0 offen offset:1016
buffer_load_dwordx4 v[56:59], v72, s[16:19], 0 offen offset:1024
v_add_f32 v3, v3, v91
v_cvt_pk_bf16_f32 v89, v90, v91
buffer_load_dwordx2 v[60:61], v72, s[16:19], 0 offen offset:2040
buffer_load_dwordx4 v[62:65], v72, s[16:19], 0 offen offset:2048
buffer_load_dwordx2 v[66:67], v72, s[16:19], 0 offen offset:3064
buffer_load_dwordx4 v[68:71], v72, s[16:19], 0 offen offset:3072
s_nop 15
v_accvgpr_read_b32 v240, a0
v_accvgpr_read_b32 v241, a1
v_accvgpr_read_b32 v242, a2
v_accvgpr_read_b32 v243, a3
v_accvgpr_read_b32 v244, a4
v_accvgpr_read_b32 v245, a5
v_accvgpr_read_b32 v246, a6
v_accvgpr_read_b32 v247, a7
v_mul_f32 v240, v240, v8
v_mul_f32 v241, v241, v8
v_mul_f32 v242, v242, v8
v_mul_f32 v243, v243, v8
v_mul_f32 v244, v244, v8
v_mul_f32 v245, v245, v8
v_mul_f32 v246, v246, v8
v_mul_f32 v247, v247, v8
v_accvgpr_write_b32 a0, v240
v_accvgpr_write_b32 a1, v241
v_accvgpr_write_b32 a2, v242
v_accvgpr_write_b32 a3, v243
v_accvgpr_write_b32 a4, v244
v_accvgpr_write_b32 a5, v245
v_accvgpr_write_b32 a6, v246
v_accvgpr_write_b32 a7, v247
v_accvgpr_read_b32 v240, a8
v_accvgpr_read_b32 v241, a9
v_accvgpr_read_b32 v242, a10
v_accvgpr_read_b32 v243, a11
v_accvgpr_read_b32 v244, a12
v_accvgpr_read_b32 v245, a13
v_accvgpr_read_b32 v246, a14
v_accvgpr_read_b32 v247, a15
v_mul_f32 v240, v240, v8
v_mul_f32 v241, v241, v8
v_mul_f32 v242, v242, v8
v_mul_f32 v243, v243, v8
v_mul_f32 v244, v244, v8
v_mul_f32 v245, v245, v8
v_mul_f32 v246, v246, v8
v_mul_f32 v247, v247, v8
v_accvgpr_write_b32 a8, v240
v_accvgpr_write_b32 a9, v241
v_accvgpr_write_b32 a10, v242
v_accvgpr_write_b32 a11, v243
v_accvgpr_write_b32 a12, v244
v_accvgpr_write_b32 a13, v245
v_accvgpr_write_b32 a14, v246
v_accvgpr_write_b32 a15, v247
v_accvgpr_read_b32 v240, a16
v_accvgpr_read_b32 v241, a17
v_accvgpr_read_b32 v242, a18
v_accvgpr_read_b32 v243, a19
v_accvgpr_read_b32 v244, a20
v_accvgpr_read_b32 v245, a21
v_accvgpr_read_b32 v246, a22
v_accvgpr_read_b32 v247, a23
v_mul_f32 v240, v240, v8
v_mul_f32 v241, v241, v8
v_mul_f32 v242, v242, v8
v_mul_f32 v243, v243, v8
v_mul_f32 v244, v244, v8
v_mul_f32 v245, v245, v8
v_mul_f32 v246, v246, v8
v_mul_f32 v247, v247, v8
v_accvgpr_write_b32 a16, v240
v_accvgpr_write_b32 a17, v241
v_accvgpr_write_b32 a18, v242
v_accvgpr_write_b32 a19, v243
v_accvgpr_write_b32 a20, v244
v_accvgpr_write_b32 a21, v245
v_accvgpr_write_b32 a22, v246
v_accvgpr_write_b32 a23, v247
v_accvgpr_read_b32 v240, a24
v_accvgpr_read_b32 v241, a25
v_accvgpr_read_b32 v242, a26
v_accvgpr_read_b32 v243, a27
v_accvgpr_read_b32 v244, a28
v_accvgpr_read_b32 v245, a29
v_accvgpr_read_b32 v246, a30
v_accvgpr_read_b32 v247, a31
v_mul_f32 v240, v240, v8
v_mul_f32 v241, v241, v8
v_mul_f32 v242, v242, v8
v_mul_f32 v243, v243, v8
v_mul_f32 v244, v244, v8
v_mul_f32 v245, v245, v8
v_mul_f32 v246, v246, v8
v_mul_f32 v247, v247, v8
v_accvgpr_write_b32 a24, v240
v_accvgpr_write_b32 a25, v241
v_accvgpr_write_b32 a26, v242
v_accvgpr_write_b32 a27, v243
v_accvgpr_write_b32 a28, v244
v_accvgpr_write_b32 a29, v245
v_accvgpr_write_b32 a30, v246
v_accvgpr_write_b32 a31, v247
v_accvgpr_read_b32 v240, a32
v_accvgpr_read_b32 v241, a33
v_accvgpr_read_b32 v242, a34
v_accvgpr_read_b32 v243, a35
v_accvgpr_read_b32 v244, a36
v_accvgpr_read_b32 v245, a37
v_accvgpr_read_b32 v246, a38
v_accvgpr_read_b32 v247, a39
v_mul_f32 v240, v240, v8
v_mul_f32 v241, v241, v8
v_mul_f32 v242, v242, v8
v_mul_f32 v243, v243, v8
v_mul_f32 v244, v244, v8
v_mul_f32 v245, v245, v8
v_mul_f32 v246, v246, v8
v_mul_f32 v247, v247, v8
v_accvgpr_write_b32 a32, v240
v_accvgpr_write_b32 a33, v241
v_accvgpr_write_b32 a34, v242
v_accvgpr_write_b32 a35, v243
v_accvgpr_write_b32 a36, v244
v_accvgpr_write_b32 a37, v245
v_accvgpr_write_b32 a38, v246
v_accvgpr_write_b32 a39, v247
v_accvgpr_read_b32 v240, a40
v_accvgpr_read_b32 v241, a41
v_accvgpr_read_b32 v242, a42
v_accvgpr_read_b32 v243, a43
v_accvgpr_read_b32 v244, a44
v_accvgpr_read_b32 v245, a45
v_accvgpr_read_b32 v246, a46
v_accvgpr_read_b32 v247, a47
v_mul_f32 v240, v240, v8
v_mul_f32 v241, v241, v8
v_mul_f32 v242, v242, v8
v_mul_f32 v243, v243, v8
v_mul_f32 v244, v244, v8
v_mul_f32 v245, v245, v8
v_mul_f32 v246, v246, v8
v_mul_f32 v247, v247, v8
v_accvgpr_write_b32 a40, v240
v_accvgpr_write_b32 a41, v241
v_accvgpr_write_b32 a42, v242
v_accvgpr_write_b32 a43, v243
v_accvgpr_write_b32 a44, v244
v_accvgpr_write_b32 a45, v245
v_accvgpr_write_b32 a46, v246
v_accvgpr_write_b32 a47, v247
v_accvgpr_read_b32 v240, a48
v_accvgpr_read_b32 v241, a49
v_accvgpr_read_b32 v242, a50
v_accvgpr_read_b32 v243, a51
v_accvgpr_read_b32 v244, a52
v_accvgpr_read_b32 v245, a53
v_accvgpr_read_b32 v246, a54
v_accvgpr_read_b32 v247, a55
v_mul_f32 v240, v240, v8
v_mul_f32 v241, v241, v8
v_mul_f32 v242, v242, v8
v_mul_f32 v243, v243, v8
v_mul_f32 v244, v244, v8
v_mul_f32 v245, v245, v8
v_mul_f32 v246, v246, v8
v_mul_f32 v247, v247, v8
v_accvgpr_write_b32 a48, v240
v_accvgpr_write_b32 a49, v241
v_accvgpr_write_b32 a50, v242
v_accvgpr_write_b32 a51, v243
v_accvgpr_write_b32 a52, v244
v_accvgpr_write_b32 a53, v245
v_accvgpr_write_b32 a54, v246
v_accvgpr_write_b32 a55, v247
v_accvgpr_read_b32 v240, a56
v_accvgpr_read_b32 v241, a57
v_accvgpr_read_b32 v242, a58
v_accvgpr_read_b32 v243, a59
v_accvgpr_read_b32 v244, a60
v_accvgpr_read_b32 v245, a61
v_accvgpr_read_b32 v246, a62
v_accvgpr_read_b32 v247, a63
v_mul_f32 v240, v240, v8
v_mul_f32 v241, v241, v8
v_mul_f32 v242, v242, v8
v_mul_f32 v243, v243, v8
v_mul_f32 v244, v244, v8
v_mul_f32 v245, v245, v8
v_mul_f32 v246, v246, v8
v_mul_f32 v247, v247, v8
v_accvgpr_write_b32 a56, v240
v_accvgpr_write_b32 a57, v241
v_accvgpr_write_b32 a58, v242
v_accvgpr_write_b32 a59, v243
v_accvgpr_write_b32 a60, v244
v_accvgpr_write_b32 a61, v245
v_accvgpr_write_b32 a62, v246
v_accvgpr_write_b32 a63, v247
s_nop 1
s_branch L_p3_mxm_end
L_p3_s0_rare:
v_mov_b32 v240, v6
v_mov_b32 v241, v6
s_nop 1
v_permlane32_swap_b32 v240, v241
v_max_f32 v242, v240, v241
v_max_f32 v242, 0, v242
v_exp_f32 v8, -v242
v_sub_f32 v208, v208, v242
v_sub_f32 v209, v209, v242
v_sub_f32 v210, v210, v242
v_sub_f32 v211, v211, v242
v_sub_f32 v212, v212, v242
v_sub_f32 v213, v213, v242
v_sub_f32 v214, v214, v242
v_sub_f32 v215, v215, v242
v_sub_f32 v216, v216, v242
v_sub_f32 v217, v217, v242
v_sub_f32 v218, v218, v242
v_sub_f32 v219, v219, v242
v_sub_f32 v220, v220, v242
v_sub_f32 v221, v221, v242
v_sub_f32 v222, v222, v242
v_sub_f32 v223, v223, v242
v_mul_f32 v2, v2, v8
v_mul_f32 v3, v3, v8
v_sub_f32 v144, v144, v242
v_sub_f32 v145, v145, v242
v_sub_f32 v146, v146, v242
v_sub_f32 v147, v147, v242
v_sub_f32 v148, v148, v242
v_sub_f32 v149, v149, v242
v_sub_f32 v150, v150, v242
v_sub_f32 v151, v151, v242
v_sub_f32 v152, v152, v242
v_sub_f32 v153, v153, v242
v_sub_f32 v154, v154, v242
v_sub_f32 v155, v155, v242
v_sub_f32 v156, v156, v242
v_sub_f32 v157, v157, v242
v_sub_f32 v158, v158, v242
v_sub_f32 v159, v159, v242
v_sub_f32 v176, v176, v242
v_sub_f32 v177, v177, v242
v_sub_f32 v178, v178, v242
v_sub_f32 v179, v179, v242
v_sub_f32 v180, v180, v242
v_sub_f32 v181, v181, v242
v_sub_f32 v182, v182, v242
v_sub_f32 v183, v183, v242
v_sub_f32 v184, v184, v242
v_sub_f32 v185, v185, v242
v_sub_f32 v186, v186, v242
v_sub_f32 v187, v187, v242
v_sub_f32 v188, v188, v242
v_sub_f32 v189, v189, v242
v_sub_f32 v190, v190, v242
v_sub_f32 v191, v191, v242
s_add_u32 m0, s72, 0
ds_read_b128 a[152:155], v10 offset:22528
ds_read_b128 a[156:159], v10 offset:23552
v_exp_f32 v144, v144
v_mfma_f32_32x32x16_bf16 a[32:47], a[216:219], v[88:91], a[32:47]
ds_read_b128 a[160:163], v10 offset:24576
buffer_load_dwordx4 v12, s[52:55], s71 offen offset:0 sc1 lds
v_exp_f32 v145, v145
v_exp_f32 v146, v146
v_mfma_f32_32x32x16_bf16 a[48:63], a[220:223], v[88:91], a[48:63]
ds_read_b128 a[164:167], v10 offset:25600
ds_read_b128 a[168:171], v10 offset:26624
v_add_f32 v2, v2, v144
v_exp_f32 v147, v147
v_add_f32 v3, v3, v145
v_mfma_f32_32x32x16_bf16 a[0:15], a[224:227], v[112:115], a[0:15]
ds_read_b128 a[172:175], v10 offset:27648
buffer_load_dwordx4 v12, s[52:55], s71 offen offset:1024 sc1 lds
v_cvt_pk_bf16_f32 v144, v144, v145
v_exp_f32 v148, v148
v_add_f32 v2, v2, v146
v_mfma_f32_32x32x16_bf16 a[16:31], a[228:231], v[112:115], a[16:31]
ds_read_b128 a[176:179], v10 offset:28672
ds_read_b128 a[180:183], v10 offset:29696
v_exp_f32 v149, v149
v_add_f32 v3, v3, v147
v_cvt_pk_bf16_f32 v145, v146, v147
v_mfma_f32_32x32x16_bf16 a[32:47], a[232:235], v[112:115], a[32:47]
ds_read_b128 a[184:187], v10 offset:30720
buffer_load_dwordx4 v12, s[52:55], s71 offen offset:2048 sc1 lds
v_exp_f32 v150, v150
v_add_f32 v2, v2, v148
v_mfma_f32_32x32x16_bf16 a[48:63], a[236:239], v[112:115], a[48:63]
ds_read_b128 a[188:191], v10 offset:31744
v_exp_f32 v151, v151
v_add_f32 v3, v3, v149
v_cvt_pk_bf16_f32 v146, v148, v149
v_mfma_f32_32x32x16_bf16 a[0:15], a[240:243], v[120:123], a[0:15]
buffer_load_dwordx4 v12, s[52:55], s71 offen offset:3072 sc1 lds
v_exp_f32 v152, v152
v_add_f32 v2, v2, v150
v_exp_f32 v153, v153
v_mfma_f32_32x32x16_bf16 a[16:31], a[244:247], v[120:123], a[16:31]
v_add_f32 v3, v3, v151
v_cvt_pk_bf16_f32 v147, v150, v151
v_exp_f32 v154, v154
v_add_f32 v2, v2, v152
v_mfma_f32_32x32x16_bf16 a[32:47], a[248:251], v[120:123], a[32:47]
s_sub_u32 s74, s74, 1
v_exp_f32 v155, v155
v_add_f32 v3, v3, v153
v_cvt_pk_bf16_f32 v152, v152, v153
v_mfma_f32_32x32x16_bf16 a[48:63], a[252:255], v[120:123], a[48:63]
v_add_f32 v2, v2, v154
v_add_f32 v3, v3, v155
v_cvt_pk_bf16_f32 v153, v154, v155
s_nop 15
v_accvgpr_read_b32 v240, a0
v_accvgpr_read_b32 v241, a1
v_accvgpr_read_b32 v242, a2
v_accvgpr_read_b32 v243, a3
v_accvgpr_read_b32 v244, a4
v_accvgpr_read_b32 v245, a5
v_accvgpr_read_b32 v246, a6
v_accvgpr_read_b32 v247, a7
v_mul_f32 v240, v240, v8
v_mul_f32 v241, v241, v8
v_mul_f32 v242, v242, v8
v_mul_f32 v243, v243, v8
v_mul_f32 v244, v244, v8
v_mul_f32 v245, v245, v8
v_mul_f32 v246, v246, v8
v_mul_f32 v247, v247, v8
v_accvgpr_write_b32 a0, v240
v_accvgpr_write_b32 a1, v241
v_accvgpr_write_b32 a2, v242
v_accvgpr_write_b32 a3, v243
v_accvgpr_write_b32 a4, v244
v_accvgpr_write_b32 a5, v245
v_accvgpr_write_b32 a6, v246
v_accvgpr_write_b32 a7, v247
v_accvgpr_read_b32 v240, a8
v_accvgpr_read_b32 v241, a9
v_accvgpr_read_b32 v242, a10
v_accvgpr_read_b32 v243, a11
v_accvgpr_read_b32 v244, a12
v_accvgpr_read_b32 v245, a13
v_accvgpr_read_b32 v246, a14
v_accvgpr_read_b32 v247, a15
v_mul_f32 v240, v240, v8
v_mul_f32 v241, v241, v8
v_mul_f32 v242, v242, v8
v_mul_f32 v243, v243, v8
v_mul_f32 v244, v244, v8
v_mul_f32 v245, v245, v8
v_mul_f32 v246, v246, v8
v_mul_f32 v247, v247, v8
v_accvgpr_write_b32 a8, v240
v_accvgpr_write_b32 a9, v241
v_accvgpr_write_b32 a10, v242
v_accvgpr_write_b32 a11, v243
v_accvgpr_write_b32 a12, v244
v_accvgpr_write_b32 a13, v245
v_accvgpr_write_b32 a14, v246
v_accvgpr_write_b32 a15, v247
v_accvgpr_read_b32 v240, a16
v_accvgpr_read_b32 v241, a17
v_accvgpr_read_b32 v242, a18
v_accvgpr_read_b32 v243, a19
v_accvgpr_read_b32 v244, a20
v_accvgpr_read_b32 v245, a21
v_accvgpr_read_b32 v246, a22
v_accvgpr_read_b32 v247, a23
v_mul_f32 v240, v240, v8
v_mul_f32 v241, v241, v8
v_mul_f32 v242, v242, v8
v_mul_f32 v243, v243, v8
v_mul_f32 v244, v244, v8
v_mul_f32 v245, v245, v8
v_mul_f32 v246, v246, v8
v_mul_f32 v247, v247, v8
v_accvgpr_write_b32 a16, v240
v_accvgpr_write_b32 a17, v241
v_accvgpr_write_b32 a18, v242
v_accvgpr_write_b32 a19, v243
v_accvgpr_write_b32 a20, v244
v_accvgpr_write_b32 a21, v245
v_accvgpr_write_b32 a22, v246
v_accvgpr_write_b32 a23, v247
v_accvgpr_read_b32 v240, a24
v_accvgpr_read_b32 v241, a25
v_accvgpr_read_b32 v242, a26
v_accvgpr_read_b32 v243, a27
v_accvgpr_read_b32 v244, a28
v_accvgpr_read_b32 v245, a29
v_accvgpr_read_b32 v246, a30
v_accvgpr_read_b32 v247, a31
v_mul_f32 v240, v240, v8
v_mul_f32 v241, v241, v8
v_mul_f32 v242, v242, v8
v_mul_f32 v243, v243, v8
v_mul_f32 v244, v244, v8
v_mul_f32 v245, v245, v8
v_mul_f32 v246, v246, v8
v_mul_f32 v247, v247, v8
v_accvgpr_write_b32 a24, v240
v_accvgpr_write_b32 a25, v241
v_accvgpr_write_b32 a26, v242
v_accvgpr_write_b32 a27, v243
v_accvgpr_write_b32 a28, v244
v_accvgpr_write_b32 a29, v245
v_accvgpr_write_b32 a30, v246
v_accvgpr_write_b32 a31, v247
v_accvgpr_read_b32 v240, a32
v_accvgpr_read_b32 v241, a33
v_accvgpr_read_b32 v242, a34
v_accvgpr_read_b32 v243, a35
v_accvgpr_read_b32 v244, a36
v_accvgpr_read_b32 v245, a37
v_accvgpr_read_b32 v246, a38
v_accvgpr_read_b32 v247, a39
v_mul_f32 v240, v240, v8
v_mul_f32 v241, v241, v8
v_mul_f32 v242, v242, v8
v_mul_f32 v243, v243, v8
v_mul_f32 v244, v244, v8
v_mul_f32 v245, v245, v8
v_mul_f32 v246, v246, v8
v_mul_f32 v247, v247, v8
v_accvgpr_write_b32 a32, v240
v_accvgpr_write_b32 a33, v241
v_accvgpr_write_b32 a34, v242
v_accvgpr_write_b32 a35, v243
v_accvgpr_write_b32 a36, v244
v_accvgpr_write_b32 a37, v245
v_accvgpr_write_b32 a38, v246
v_accvgpr_write_b32 a39, v247
v_accvgpr_read_b32 v240, a40
v_accvgpr_read_b32 v241, a41
v_accvgpr_read_b32 v242, a42
v_accvgpr_read_b32 v243, a43
v_accvgpr_read_b32 v244, a44
v_accvgpr_read_b32 v245, a45
v_accvgpr_read_b32 v246, a46
v_accvgpr_read_b32 v247, a47
v_mul_f32 v240, v240, v8
v_mul_f32 v241, v241, v8
v_mul_f32 v242, v242, v8
v_mul_f32 v243, v243, v8
v_mul_f32 v244, v244, v8
v_mul_f32 v245, v245, v8
v_mul_f32 v246, v246, v8
v_mul_f32 v247, v247, v8
v_accvgpr_write_b32 a40, v240
v_accvgpr_write_b32 a41, v241
v_accvgpr_write_b32 a42, v242
v_accvgpr_write_b32 a43, v243
v_accvgpr_write_b32 a44, v244
v_accvgpr_write_b32 a45, v245
v_accvgpr_write_b32 a46, v246
v_accvgpr_write_b32 a47, v247
v_accvgpr_read_b32 v240, a48
v_accvgpr_read_b32 v241, a49
v_accvgpr_read_b32 v242, a50
v_accvgpr_read_b32 v243, a51
v_accvgpr_read_b32 v244, a52
v_accvgpr_read_b32 v245, a53
v_accvgpr_read_b32 v246, a54
v_accvgpr_read_b32 v247, a55
v_mul_f32 v240, v240, v8
v_mul_f32 v241, v241, v8
v_mul_f32 v242, v242, v8
v_mul_f32 v243, v243, v8
v_mul_f32 v244, v244, v8
v_mul_f32 v245, v245, v8
v_mul_f32 v246, v246, v8
v_mul_f32 v247, v247, v8
v_accvgpr_write_b32 a48, v240
v_accvgpr_write_b32 a49, v241
v_accvgpr_write_b32 a50, v242
v_accvgpr_write_b32 a51, v243
v_accvgpr_write_b32 a52, v244
v_accvgpr_write_b32 a53, v245
v_accvgpr_write_b32 a54, v246
v_accvgpr_write_b32 a55, v247
v_accvgpr_read_b32 v240, a56
v_accvgpr_read_b32 v241, a57
v_accvgpr_read_b32 v242, a58
v_accvgpr_read_b32 v243, a59
v_accvgpr_read_b32 v244, a60
v_accvgpr_read_b32 v245, a61
v_accvgpr_read_b32 v246, a62
v_accvgpr_read_b32 v247, a63
v_mul_f32 v240, v240, v8
v_mul_f32 v241, v241, v8
v_mul_f32 v242, v242, v8
v_mul_f32 v243, v243, v8
v_mul_f32 v244, v244, v8
v_mul_f32 v245, v245, v8
v_mul_f32 v246, v246, v8
v_mul_f32 v247, v247, v8
v_accvgpr_write_b32 a56, v240
v_accvgpr_write_b32 a57, v241
v_accvgpr_write_b32 a58, v242
v_accvgpr_write_b32 a59, v243
v_accvgpr_write_b32 a60, v244
v_accvgpr_write_b32 a61, v245
v_accvgpr_write_b32 a62, v246
v_accvgpr_write_b32 a63, v247
s_nop 1
s_branch L_p3_s0_end
L_p3_s1_rare:
v_mov_b32 v240, v6
v_mov_b32 v241, v6
s_nop 1
v_permlane32_swap_b32 v240, v241
v_max_f32 v242, v240, v241
v_max_f32 v242, 0, v242
v_exp_f32 v8, -v242
v_sub_f32 v208, v208, v242
v_sub_f32 v209, v209, v242
v_sub_f32 v210, v210, v242
v_sub_f32 v211, v211, v242
v_sub_f32 v212, v212, v242
v_sub_f32 v213, v213, v242
v_sub_f32 v214, v214, v242
v_sub_f32 v215, v215, v242
v_sub_f32 v216, v216, v242
v_sub_f32 v217, v217, v242
v_sub_f32 v218, v218, v242
v_sub_f32 v219, v219, v242
v_sub_f32 v220, v220, v242
v_sub_f32 v221, v221, v242
v_sub_f32 v222, v222, v242
v_sub_f32 v223, v223, v242
v_mul_f32 v2, v2, v8
v_mul_f32 v3, v3, v8
v_sub_f32 v80, v80, v242
v_sub_f32 v81, v81, v242
v_sub_f32 v82, v82, v242
v_sub_f32 v83, v83, v242
v_sub_f32 v84, v84, v242
v_sub_f32 v85, v85, v242
v_sub_f32 v86, v86, v242
v_sub_f32 v87, v87, v242
v_sub_f32 v88, v88, v242
v_sub_f32 v89, v89, v242
v_sub_f32 v90, v90, v242
v_sub_f32 v91, v91, v242
v_sub_f32 v92, v92, v242
v_sub_f32 v93, v93, v242
v_sub_f32 v94, v94, v242
v_sub_f32 v95, v95, v242
v_sub_f32 v112, v112, v242
v_sub_f32 v113, v113, v242
v_sub_f32 v114, v114, v242
v_sub_f32 v115, v115, v242
v_sub_f32 v116, v116, v242
v_sub_f32 v117, v117, v242
v_sub_f32 v118, v118, v242
v_sub_f32 v119, v119, v242
v_sub_f32 v120, v120, v242
v_sub_f32 v121, v121, v242
v_sub_f32 v122, v122, v242
v_sub_f32 v123, v123, v242
v_sub_f32 v124, v124, v242
v_sub_f32 v125, v125, v242
v_sub_f32 v126, v126, v242
v_sub_f32 v127, v127, v242
s_add_u32 m0, s72, 16384
ds_read_b128 a[152:155], v10 offset:6144
ds_read_b128 a[156:159], v10 offset:7168
v_exp_f32 v80, v80
v_mfma_f32_32x32x16_bf16 a[32:47], a[216:219], v[152:155], a[32:47]
ds_read_b128 a[160:163], v10 offset:8192
buffer_load_dwordx4 v12, s[52:55], s71 offen offset:0 sc1 lds
v_exp_f32 v81, v81
v_exp_f32 v82, v82
v_mfma_f32_32x32x16_bf16 a[48:63], a[220:223], v[152:155], a[48:63]
ds_read_b128 a[164:167], v10 offset:9216
ds_read_b128 a[168:171], v10 offset:10240
buffer_load_dwordx4 v12, s[52:55], s71 offen offset:1024 sc1 lds
v_add_f32 v2, v2, v80
v_exp_f32 v83, v83
v_mfma_f32_32x32x16_bf16 a[0:15], a[224:227], v[176:179], a[0:15]
ds_read_b128 a[172:175], v10 offset:11264
v_add_f32 v3, v3, v81
v_cvt_pk_bf16_f32 v80, v80, v81
v_exp_f32 v84, v84
v_add_f32 v2, v2, v82
v_mfma_f32_32x32x16_bf16 a[16:31], a[228:231], v[176:179], a[16:31]
ds_read_b128 a[176:179], v10 offset:12288
ds_read_b128 a[180:183], v10 offset:13312
buffer_load_dwordx4 v12, s[52:55], s71 offen offset:2048 sc1 lds
v_exp_f32 v85, v85
v_add_f32 v3, v3, v83
v_mfma_f32_32x32x16_bf16 a[32:47], a[232:235], v[176:179], a[32:47]
ds_read_b128 a[184:187], v10 offset:14336
v_cvt_pk_bf16_f32 v81, v82, v83
v_exp_f32 v86, v86
v_add_f32 v2, v2, v84
v_mfma_f32_32x32x16_bf16 a[48:63], a[236:239], v[176:179], a[48:63]
ds_read_b128 a[188:191], v10 offset:15360
buffer_load_dwordx4 v12, s[52:55], s71 offen offset:3072 sc1 lds
v_exp_f32 v87, v87
v_add_f32 v3, v3, v85
v_cvt_pk_bf16_f32 v82, v84, v85
v_mfma_f32_32x32x16_bf16 a[0:15], a[240:243], v[184:187], a[0:15]
s_xor_b32 s72, s72, 0x8000
v_exp_f32 v88, v88
v_add_f32 v2, v2, v86
v_exp_f32 v89, v89
v_mfma_f32_32x32x16_bf16 a[16:31], a[244:247], v[184:187], a[16:31]
v_add_f32 v3, v3, v87
v_cvt_pk_bf16_f32 v83, v86, v87
v_exp_f32 v90, v90
v_add_f32 v2, v2, v88
v_mfma_f32_32x32x16_bf16 a[32:47], a[248:251], v[184:187], a[32:47]
buffer_store_dword v77, v76, s[8:11], s37 offen offset:1024 sc1
v_exp_f32 v91, v91
v_add_f32 v3, v3, v89
v_cvt_pk_bf16_f32 v88, v88, v89
v_mfma_f32_32x32x16_bf16 a[48:63], a[252:255], v[184:187], a[48:63]
v_add_f32 v2, v2, v90
v_add_f32 v3, v3, v91
v_cvt_pk_bf16_f32 v89, v90, v91
s_nop 15
v_accvgpr_read_b32 v240, a0
v_accvgpr_read_b32 v241, a1
v_accvgpr_read_b32 v242, a2
v_accvgpr_read_b32 v243, a3
v_accvgpr_read_b32 v244, a4
v_accvgpr_read_b32 v245, a5
v_accvgpr_read_b32 v246, a6
v_accvgpr_read_b32 v247, a7
v_mul_f32 v240, v240, v8
v_mul_f32 v241, v241, v8
v_mul_f32 v242, v242, v8
v_mul_f32 v243, v243, v8
v_mul_f32 v244, v244, v8
v_mul_f32 v245, v245, v8
v_mul_f32 v246, v246, v8
v_mul_f32 v247, v247, v8
v_accvgpr_write_b32 a0, v240
v_accvgpr_write_b32 a1, v241
v_accvgpr_write_b32 a2, v242
v_accvgpr_write_b32 a3, v243
v_accvgpr_write_b32 a4, v244
v_accvgpr_write_b32 a5, v245
v_accvgpr_write_b32 a6, v246
v_accvgpr_write_b32 a7, v247
v_accvgpr_read_b32 v240, a8
v_accvgpr_read_b32 v241, a9
v_accvgpr_read_b32 v242, a10
v_accvgpr_read_b32 v243, a11
v_accvgpr_read_b32 v244, a12
v_accvgpr_read_b32 v245, a13
v_accvgpr_read_b32 v246, a14
v_accvgpr_read_b32 v247, a15
v_mul_f32 v240, v240, v8
v_mul_f32 v241, v241, v8
v_mul_f32 v242, v242, v8
v_mul_f32 v243, v243, v8
v_mul_f32 v244, v244, v8
v_mul_f32 v245, v245, v8
v_mul_f32 v246, v246, v8
v_mul_f32 v247, v247, v8
v_accvgpr_write_b32 a8, v240
v_accvgpr_write_b32 a9, v241
v_accvgpr_write_b32 a10, v242
v_accvgpr_write_b32 a11, v243
v_accvgpr_write_b32 a12, v244
v_accvgpr_write_b32 a13, v245
v_accvgpr_write_b32 a14, v246
v_accvgpr_write_b32 a15, v247
v_accvgpr_read_b32 v240, a16
v_accvgpr_read_b32 v241, a17
v_accvgpr_read_b32 v242, a18
v_accvgpr_read_b32 v243, a19
v_accvgpr_read_b32 v244, a20
v_accvgpr_read_b32 v245, a21
v_accvgpr_read_b32 v246, a22
v_accvgpr_read_b32 v247, a23
v_mul_f32 v240, v240, v8
v_mul_f32 v241, v241, v8
v_mul_f32 v242, v242, v8
v_mul_f32 v243, v243, v8
v_mul_f32 v244, v244, v8
v_mul_f32 v245, v245, v8
v_mul_f32 v246, v246, v8
v_mul_f32 v247, v247, v8
v_accvgpr_write_b32 a16, v240
v_accvgpr_write_b32 a17, v241
v_accvgpr_write_b32 a18, v242
v_accvgpr_write_b32 a19, v243
v_accvgpr_write_b32 a20, v244
v_accvgpr_write_b32 a21, v245
v_accvgpr_write_b32 a22, v246
v_accvgpr_write_b32 a23, v247
v_accvgpr_read_b32 v240, a24
v_accvgpr_read_b32 v241, a25
v_accvgpr_read_b32 v242, a26
v_accvgpr_read_b32 v243, a27
v_accvgpr_read_b32 v244, a28
v_accvgpr_read_b32 v245, a29
v_accvgpr_read_b32 v246, a30
v_accvgpr_read_b32 v247, a31
v_mul_f32 v240, v240, v8
v_mul_f32 v241, v241, v8
v_mul_f32 v242, v242, v8
v_mul_f32 v243, v243, v8
v_mul_f32 v244, v244, v8
v_mul_f32 v245, v245, v8
v_mul_f32 v246, v246, v8
v_mul_f32 v247, v247, v8
v_accvgpr_write_b32 a24, v240
v_accvgpr_write_b32 a25, v241
v_accvgpr_write_b32 a26, v242
v_accvgpr_write_b32 a27, v243
v_accvgpr_write_b32 a28, v244
v_accvgpr_write_b32 a29, v245
v_accvgpr_write_b32 a30, v246
v_accvgpr_write_b32 a31, v247
v_accvgpr_read_b32 v240, a32
v_accvgpr_read_b32 v241, a33
v_accvgpr_read_b32 v242, a34
v_accvgpr_read_b32 v243, a35
v_accvgpr_read_b32 v244, a36
v_accvgpr_read_b32 v245, a37
v_accvgpr_read_b32 v246, a38
v_accvgpr_read_b32 v247, a39
v_mul_f32 v240, v240, v8
v_mul_f32 v241, v241, v8
v_mul_f32 v242, v242, v8
v_mul_f32 v243, v243, v8
v_mul_f32 v244, v244, v8
v_mul_f32 v245, v245, v8
v_mul_f32 v246, v246, v8
v_mul_f32 v247, v247, v8
v_accvgpr_write_b32 a32, v240
v_accvgpr_write_b32 a33, v241
v_accvgpr_write_b32 a34, v242
v_accvgpr_write_b32 a35, v243
v_accvgpr_write_b32 a36, v244
v_accvgpr_write_b32 a37, v245
v_accvgpr_write_b32 a38, v246
v_accvgpr_write_b32 a39, v247
v_accvgpr_read_b32 v240, a40
v_accvgpr_read_b32 v241, a41
v_accvgpr_read_b32 v242, a42
v_accvgpr_read_b32 v243, a43
v_accvgpr_read_b32 v244, a44
v_accvgpr_read_b32 v245, a45
v_accvgpr_read_b32 v246, a46
v_accvgpr_read_b32 v247, a47
v_mul_f32 v240, v240, v8
v_mul_f32 v241, v241, v8
v_mul_f32 v242, v242, v8
v_mul_f32 v243, v243, v8
v_mul_f32 v244, v244, v8
v_mul_f32 v245, v245, v8
v_mul_f32 v246, v246, v8
v_mul_f32 v247, v247, v8
v_accvgpr_write_b32 a40, v240
v_accvgpr_write_b32 a41, v241
v_accvgpr_write_b32 a42, v242
v_accvgpr_write_b32 a43, v243
v_accvgpr_write_b32 a44, v244
v_accvgpr_write_b32 a45, v245
v_accvgpr_write_b32 a46, v246
v_accvgpr_write_b32 a47, v247
v_accvgpr_read_b32 v240, a48
v_accvgpr_read_b32 v241, a49
v_accvgpr_read_b32 v242, a50
v_accvgpr_read_b32 v243, a51
v_accvgpr_read_b32 v244, a52
v_accvgpr_read_b32 v245, a53
v_accvgpr_read_b32 v246, a54
v_accvgpr_read_b32 v247, a55
v_mul_f32 v240, v240, v8
v_mul_f32 v241, v241, v8
v_mul_f32 v242, v242, v8
v_mul_f32 v243, v243, v8
v_mul_f32 v244, v244, v8
v_mul_f32 v245, v245, v8
v_mul_f32 v246, v246, v8
v_mul_f32 v247, v247, v8
v_accvgpr_write_b32 a48, v240
v_accvgpr_write_b32 a49, v241
v_accvgpr_write_b32 a50, v242
v_accvgpr_write_b32 a51, v243
v_accvgpr_write_b32 a52, v244
v_accvgpr_write_b32 a53, v245
v_accvgpr_write_b32 a54, v246
v_accvgpr_write_b32 a55, v247
v_accvgpr_read_b32 v240, a56
v_accvgpr_read_b32 v241, a57
v_accvgpr_read_b32 v242, a58
v_accvgpr_read_b32 v243, a59
v_accvgpr_read_b32 v244, a60
v_accvgpr_read_b32 v245, a61
v_accvgpr_read_b32 v246, a62
v_accvgpr_read_b32 v247, a63
v_mul_f32 v240, v240, v8
v_mul_f32 v241, v241, v8
v_mul_f32 v242, v242, v8
v_mul_f32 v243, v243, v8
v_mul_f32 v244, v244, v8
v_mul_f32 v245, v245, v8
v_mul_f32 v246, v246, v8
v_mul_f32 v247, v247, v8
v_accvgpr_write_b32 a56, v240
v_accvgpr_write_b32 a57, v241
v_accvgpr_write_b32 a58, v242
v_accvgpr_write_b32 a59, v243
v_accvgpr_write_b32 a60, v244
v_accvgpr_write_b32 a61, v245
v_accvgpr_write_b32 a62, v246
v_accvgpr_write_b32 a63, v247
s_nop 1
s_branch L_p3_s1_end
L_p3_s1m_rare:
v_mov_b32 v240, v6
v_mov_b32 v241, v6
s_nop 1
v_permlane32_swap_b32 v240, v241
v_max_f32 v242, v240, v241
v_max_f32 v242, 0, v242
v_exp_f32 v8, -v242
v_sub_f32 v208, v208, v242
v_sub_f32 v209, v209, v242
v_sub_f32 v210, v210, v242
v_sub_f32 v211, v211, v242
v_sub_f32 v212, v212, v242
v_sub_f32 v213, v213, v242
v_sub_f32 v214, v214, v242
v_sub_f32 v215, v215, v242
v_sub_f32 v216, v216, v242
v_sub_f32 v217, v217, v242
v_sub_f32 v218, v218, v242
v_sub_f32 v219, v219, v242
v_sub_f32 v220, v220, v242
v_sub_f32 v221, v221, v242
v_sub_f32 v222, v222, v242
v_sub_f32 v223, v223, v242
v_mul_f32 v2, v2, v8
v_mul_f32 v3, v3, v8
v_sub_f32 v80, v80, v242
v_sub_f32 v81, v81, v242
v_sub_f32 v82, v82, v242
v_sub_f32 v83, v83, v242
v_sub_f32 v84, v84, v242
v_sub_f32 v85, v85, v242
v_sub_f32 v86, v86, v242
v_sub_f32 v87, v87, v242
v_sub_f32 v88, v88, v242
v_sub_f32 v89, v89, v242
v_sub_f32 v90, v90, v242
v_sub_f32 v91, v91, v242
v_sub_f32 v92, v92, v242
v_sub_f32 v93, v93, v242
v_sub_f32 v94, v94, v242
v_sub_f32 v95, v95, v242
v_sub_f32 v112, v112, v242
v_sub_f32 v113, v113, v242
v_sub_f32 v114, v114, v242
v_sub_f32 v115, v115, v242
v_sub_f32 v116, v116, v242
v_sub_f32 v117, v117, v242
v_sub_f32 v118, v118, v242
v_sub_f32 v119, v119, v242
v_sub_f32 v120, v120, v242
v_sub_f32 v121, v121, v242
v_sub_f32 v122, v122, v242
v_sub_f32 v123, v123, v242
v_sub_f32 v124, v124, v242
v_sub_f32 v125, v125, v242
v_sub_f32 v126, v126, v242
v_sub_f32 v127, v127, v242
s_add_u32 m0, s72, 16384
v_exp_f32 v80, v80
v_exp_f32 v81, v81
v_mfma_f32_32x32x16_bf16 a[0:15], a[240:243], v[184:187], a[0:15]
buffer_load_dwordx4 v12, s[52:55], s71 offen offset:0 sc1 lds
buffer_load_dwordx4 v12, s[52:55], s71 offen offset:1024 sc1 lds
v_exp_f32 v82, v82
v_add_f32 v2, v2, v80
v_mfma_f32_32x32x16_bf16 a[16:31], a[244:247], v[184:187], a[16:31]
buffer_load_dwordx4 v12, s[52:55], s71 offen offset:2048 sc1 lds
v_exp_f32 v83, v83
v_add_f32 v3, v3, v81
v_cvt_pk_bf16_f32 v80, v80, v81
v_mfma_f32_32x32x16_bf16 a[32:47], a[248:251], v[184:187], a[32:47]
buffer_load_dwordx4 v12, s[52:55], s71 offen offset:3072 sc1 lds
v_exp_f32 v84, v84
v_add_f32 v2, v2, v82
v_exp_f32 v85, v85
v_mfma_f32_32x32x16_bf16 a[48:63], a[252:255], v[184:187], a[48:63]
s_xor_b32 s72, s72, 0x8000
v_add_f32 v3, v3, v83
v_cvt_pk_bf16_f32 v81, v82, v83
v_exp_f32 v86, v86
v_add_f32 v2, v2, v84
v_exp_f32 v87, v87
v_add_f32 v3, v3, v85
v_cvt_pk_bf16_f32 v82, v84, v85
v_exp_f32 v88, v88
v_add_f32 v2, v2, v86
v_exp_f32 v89, v89
v_add_f32 v3, v3, v87
v_cvt_pk_bf16_f32 v83, v86, v87
v_exp_f32 v90, v90
v_add_f32 v2, v2, v88
v_exp_f32 v91, v91
v_add_f32 v3, v3, v89
v_cvt_pk_bf16_f32 v88, v88, v89
v_add_f32 v2, v2, v90
v_add_f32 v3, v3, v91
v_cvt_pk_bf16_f32 v89, v90, v91
s_nop 15
v_accvgpr_read_b32 v240, a0
v_accvgpr_read_b32 v241, a1
v_accvgpr_read_b32 v242, a2
v_accvgpr_read_b32 v243, a3
v_accvgpr_read_b32 v244, a4
v_accvgpr_read_b32 v245, a5
v_accvgpr_read_b32 v246, a6
v_accvgpr_read_b32 v247, a7
v_mul_f32 v240, v240, v8
v_mul_f32 v241, v241, v8
v_mul_f32 v242, v242, v8
v_mul_f32 v243, v243, v8
v_mul_f32 v244, v244, v8
v_mul_f32 v245, v245, v8
v_mul_f32 v246, v246, v8
v_mul_f32 v247, v247, v8
v_accvgpr_write_b32 a0, v240
v_accvgpr_write_b32 a1, v241
v_accvgpr_write_b32 a2, v242
v_accvgpr_write_b32 a3, v243
v_accvgpr_write_b32 a4, v244
v_accvgpr_write_b32 a5, v245
v_accvgpr_write_b32 a6, v246
v_accvgpr_write_b32 a7, v247
v_accvgpr_read_b32 v240, a8
v_accvgpr_read_b32 v241, a9
v_accvgpr_read_b32 v242, a10
v_accvgpr_read_b32 v243, a11
v_accvgpr_read_b32 v244, a12
v_accvgpr_read_b32 v245, a13
v_accvgpr_read_b32 v246, a14
v_accvgpr_read_b32 v247, a15
v_mul_f32 v240, v240, v8
v_mul_f32 v241, v241, v8
v_mul_f32 v242, v242, v8
v_mul_f32 v243, v243, v8
v_mul_f32 v244, v244, v8
v_mul_f32 v245, v245, v8
v_mul_f32 v246, v246, v8
v_mul_f32 v247, v247, v8
v_accvgpr_write_b32 a8, v240
v_accvgpr_write_b32 a9, v241
v_accvgpr_write_b32 a10, v242
v_accvgpr_write_b32 a11, v243
v_accvgpr_write_b32 a12, v244
v_accvgpr_write_b32 a13, v245
v_accvgpr_write_b32 a14, v246
v_accvgpr_write_b32 a15, v247
v_accvgpr_read_b32 v240, a16
v_accvgpr_read_b32 v241, a17
v_accvgpr_read_b32 v242, a18
v_accvgpr_read_b32 v243, a19
v_accvgpr_read_b32 v244, a20
v_accvgpr_read_b32 v245, a21
v_accvgpr_read_b32 v246, a22
v_accvgpr_read_b32 v247, a23
v_mul_f32 v240, v240, v8
v_mul_f32 v241, v241, v8
v_mul_f32 v242, v242, v8
v_mul_f32 v243, v243, v8
v_mul_f32 v244, v244, v8
v_mul_f32 v245, v245, v8
v_mul_f32 v246, v246, v8
v_mul_f32 v247, v247, v8
v_accvgpr_write_b32 a16, v240
v_accvgpr_write_b32 a17, v241
v_accvgpr_write_b32 a18, v242
v_accvgpr_write_b32 a19, v243
v_accvgpr_write_b32 a20, v244
v_accvgpr_write_b32 a21, v245
v_accvgpr_write_b32 a22, v246
v_accvgpr_write_b32 a23, v247
v_accvgpr_read_b32 v240, a24
v_accvgpr_read_b32 v241, a25
v_accvgpr_read_b32 v242, a26
v_accvgpr_read_b32 v243, a27
v_accvgpr_read_b32 v244, a28
v_accvgpr_read_b32 v245, a29
v_accvgpr_read_b32 v246, a30
v_accvgpr_read_b32 v247, a31
v_mul_f32 v240, v240, v8
v_mul_f32 v241, v241, v8
v_mul_f32 v242, v242, v8
v_mul_f32 v243, v243, v8
v_mul_f32 v244, v244, v8
v_mul_f32 v245, v245, v8
v_mul_f32 v246, v246, v8
v_mul_f32 v247, v247, v8
v_accvgpr_write_b32 a24, v240
v_accvgpr_write_b32 a25, v241
v_accvgpr_write_b32 a26, v242
v_accvgpr_write_b32 a27, v243
v_accvgpr_write_b32 a28, v244
v_accvgpr_write_b32 a29, v245
v_accvgpr_write_b32 a30, v246
v_accvgpr_write_b32 a31, v247
v_accvgpr_read_b32 v240, a32
v_accvgpr_read_b32 v241, a33
v_accvgpr_read_b32 v242, a34
v_accvgpr_read_b32 v243, a35
v_accvgpr_read_b32 v244, a36
v_accvgpr_read_b32 v245, a37
v_accvgpr_read_b32 v246, a38
v_accvgpr_read_b32 v247, a39
v_mul_f32 v240, v240, v8
v_mul_f32 v241, v241, v8
v_mul_f32 v242, v242, v8
v_mul_f32 v243, v243, v8
v_mul_f32 v244, v244, v8
v_mul_f32 v245, v245, v8
v_mul_f32 v246, v246, v8
v_mul_f32 v247, v247, v8
v_accvgpr_write_b32 a32, v240
v_accvgpr_write_b32 a33, v241
v_accvgpr_write_b32 a34, v242
v_accvgpr_write_b32 a35, v243
v_accvgpr_write_b32 a36, v244
v_accvgpr_write_b32 a37, v245
v_accvgpr_write_b32 a38, v246
v_accvgpr_write_b32 a39, v247
v_accvgpr_read_b32 v240, a40
v_accvgpr_read_b32 v241, a41
v_accvgpr_read_b32 v242, a42
v_accvgpr_read_b32 v243, a43
v_accvgpr_read_b32 v244, a44
v_accvgpr_read_b32 v245, a45
v_accvgpr_read_b32 v246, a46
v_accvgpr_read_b32 v247, a47
v_mul_f32 v240, v240, v8
v_mul_f32 v241, v241, v8
v_mul_f32 v242, v242, v8
v_mul_f32 v243, v243, v8
v_mul_f32 v244, v244, v8
v_mul_f32 v245, v245, v8
v_mul_f32 v246, v246, v8
v_mul_f32 v247, v247, v8
v_accvgpr_write_b32 a40, v240
v_accvgpr_write_b32 a41, v241
v_accvgpr_write_b32 a42, v242
v_accvgpr_write_b32 a43, v243
v_accvgpr_write_b32 a44, v244
v_accvgpr_write_b32 a45, v245
v_accvgpr_write_b32 a46, v246
v_accvgpr_write_b32 a47, v247
v_accvgpr_read_b32 v240, a48
v_accvgpr_read_b32 v241, a49
v_accvgpr_read_b32 v242, a50
v_accvgpr_read_b32 v243, a51
v_accvgpr_read_b32 v244, a52
v_accvgpr_read_b32 v245, a53
v_accvgpr_read_b32 v246, a54
v_accvgpr_read_b32 v247, a55
v_mul_f32 v240, v240, v8
v_mul_f32 v241, v241, v8
v_mul_f32 v242, v242, v8
v_mul_f32 v243, v243, v8
v_mul_f32 v244, v244, v8
v_mul_f32 v245, v245, v8
v_mul_f32 v246, v246, v8
v_mul_f32 v247, v247, v8
v_accvgpr_write_b32 a48, v240
v_accvgpr_write_b32 a49, v241
v_accvgpr_write_b32 a50, v242
v_accvgpr_write_b32 a51, v243
v_accvgpr_write_b32 a52, v244
v_accvgpr_write_b32 a53, v245
v_accvgpr_write_b32 a54, v246
v_accvgpr_write_b32 a55, v247
v_accvgpr_read_b32 v240, a56
v_accvgpr_read_b32 v241, a57
v_accvgpr_read_b32 v242, a58
v_accvgpr_read_b32 v243, a59
v_accvgpr_read_b32 v244, a60
v_accvgpr_read_b32 v245, a61
v_accvgpr_read_b32 v246, a62
v_accvgpr_read_b32 v247, a63
v_mul_f32 v240, v240, v8
v_mul_f32 v241, v241, v8
v_mul_f32 v242, v242, v8
v_mul_f32 v243, v243, v8
v_mul_f32 v244, v244, v8
v_mul_f32 v245, v245, v8
v_mul_f32 v246, v246, v8
v_mul_f32 v247, v247, v8
v_accvgpr_write_b32 a56, v240
v_accvgpr_write_b32 a57, v241
v_accvgpr_write_b32 a58, v242
v_accvgpr_write_b32 a59, v243
v_accvgpr_write_b32 a60, v244
v_accvgpr_write_b32 a61, v245
v_accvgpr_write_b32 a62, v246
v_accvgpr_write_b32 a63, v247
s_nop 1
s_branch L_p3_s1m_end
L_p3_s0m_rare:
v_mov_b32 v240, v6
v_mov_b32 v241, v6
s_nop 1
v_permlane32_swap_b32 v240, v241
v_max_f32 v242, v240, v241
v_max_f32 v242, 0, v242
v_exp_f32 v8, -v242
v_sub_f32 v208, v208, v242
v_sub_f32 v209, v209, v242
v_sub_f32 v210, v210, v242
v_sub_f32 v211, v211, v242
v_sub_f32 v212, v212, v242
v_sub_f32 v213, v213, v242
v_sub_f32 v214, v214, v242
v_sub_f32 v215, v215, v242
v_sub_f32 v216, v216, v242
v_sub_f32 v217, v217, v242
v_sub_f32 v218, v218, v242
v_sub_f32 v219, v219, v242
v_sub_f32 v220, v220, v242
v_sub_f32 v221, v221, v242
v_sub_f32 v222, v222, v242
v_sub_f32 v223, v223, v242
v_mul_f32 v2, v2, v8
v_mul_f32 v3, v3, v8
v_sub_f32 v144, v144, v242
v_sub_f32 v145, v145, v242
v_sub_f32 v146, v146, v242
v_sub_f32 v147, v147, v242
v_sub_f32 v148, v148, v242
v_sub_f32 v149, v149, v242
v_sub_f32 v150, v150, v242
v_sub_f32 v151, v151, v242
v_sub_f32 v152, v152, v242
v_sub_f32 v153, v153, v242
v_sub_f32 v154, v154, v242
v_sub_f32 v155, v155, v242
v_sub_f32 v156, v156, v242
v_sub_f32 v157, v157, v242
v_sub_f32 v158, v158, v242
v_sub_f32 v159, v159, v242
v_sub_f32 v176, v176, v242
v_sub_f32 v177, v177, v242
v_sub_f32 v178, v178, v242
v_sub_f32 v179, v179, v242
v_sub_f32 v180, v180, v242
v_sub_f32 v181, v181, v242
v_sub_f32 v182, v182, v242
v_sub_f32 v183, v183, v242
v_sub_f32 v184, v184, v242
v_sub_f32 v185, v185, v242
v_sub_f32 v186, v186, v242
v_sub_f32 v187, v187, v242
v_sub_f32 v188, v188, v242
v_sub_f32 v189, v189, v242
v_sub_f32 v190, v190, v242
v_sub_f32 v191, v191, v242
s_add_u32 m0, s72, 0
v_exp_f32 v144, v144
v_exp_f32 v145, v145
v_mfma_f32_32x32x16_bf16 a[0:15], a[240:243], v[120:123], a[0:15]
buffer_load_dwordx4 v12, s[52:55], s71 offen offset:0 sc1 lds
buffer_load_dwordx4 v12, s[52:55], s71 offen offset:1024 sc1 lds
buffer_load_dwordx4 v12, s[52:55], s71 offen offset:2048 sc1 lds
v_exp_f32 v146, v146
v_add_f32 v2, v2, v144
v_mfma_f32_32x32x16_bf16 a[16:31], a[244:247], v[120:123], a[16:31]
buffer_load_dwordx4 v12, s[52:55], s71 offen offset:3072 sc1 lds
v_lshlrev_b32 v245, 4, v1
s_mov_b32 m0, s43
v_exp_f32 v147, v147
v_add_f32 v3, v3, v145
v_mfma_f32_32x32x16_bf16 a[32:47], a[248:251], v[120:123], a[32:47]
s_nop 0
buffer_load_dwordx4 v245, s[20:23], 0 offen offset:0 sc1 lds
buffer_load_dwordx4 v245, s[20:23], 0 offen offset:1024 sc1 lds
v_cvt_pk_bf16_f32 v144, v144, v145
v_exp_f32 v148, v148
v_mfma_f32_32x32x16_bf16 a[48:63], a[252:255], v[120:123], a[48:63]
buffer_load_dwordx4 v245, s[20:23], 0 offen offset:2048 sc1 lds
buffer_load_dwordx4 v245, s[20:23], 0 offen offset:3072 sc1 lds
v_add_f32 v2, v2, v146
v_exp_f32 v149, v149
v_add_f32 v3, v3, v147
v_cvt_pk_bf16_f32 v145, v146, v147
v_exp_f32 v150, v150
v_add_f32 v2, v2, v148
v_exp_f32 v151, v151
v_add_f32 v3, v3, v149
v_cvt_pk_bf16_f32 v146, v148, v149
v_exp_f32 v152, v152
v_add_f32 v2, v2, v150
v_exp_f32 v153, v153
v_add_f32 v3, v3, v151
v_cvt_pk_bf16_f32 v147, v150, v151
v_exp_f32 v154, v154
v_add_f32 v2, v2, v152
v_exp_f32 v155, v155
v_add_f32 v3, v3, v153
v_cvt_pk_bf16_f32 v152, v152, v153
v_add_f32 v2, v2, v154
v_add_f32 v3, v3, v155
v_cvt_pk_bf16_f32 v153, v154, v155
s_nop 15
v_accvgpr_read_b32 v240, a0
v_accvgpr_read_b32 v241, a1
v_accvgpr_read_b32 v242, a2
v_accvgpr_read_b32 v243, a3
v_accvgpr_read_b32 v244, a4
v_accvgpr_read_b32 v245, a5
v_accvgpr_read_b32 v246, a6
v_accvgpr_read_b32 v247, a7
v_mul_f32 v240, v240, v8
v_mul_f32 v241, v241, v8
v_mul_f32 v242, v242, v8
v_mul_f32 v243, v243, v8
v_mul_f32 v244, v244, v8
v_mul_f32 v245, v245, v8
v_mul_f32 v246, v246, v8
v_mul_f32 v247, v247, v8
v_accvgpr_write_b32 a0, v240
v_accvgpr_write_b32 a1, v241
v_accvgpr_write_b32 a2, v242
v_accvgpr_write_b32 a3, v243
v_accvgpr_write_b32 a4, v244
v_accvgpr_write_b32 a5, v245
v_accvgpr_write_b32 a6, v246
v_accvgpr_write_b32 a7, v247
v_accvgpr_read_b32 v240, a8
v_accvgpr_read_b32 v241, a9
v_accvgpr_read_b32 v242, a10
v_accvgpr_read_b32 v243, a11
v_accvgpr_read_b32 v244, a12
v_accvgpr_read_b32 v245, a13
v_accvgpr_read_b32 v246, a14
v_accvgpr_read_b32 v247, a15
v_mul_f32 v240, v240, v8
v_mul_f32 v241, v241, v8
v_mul_f32 v242, v242, v8
v_mul_f32 v243, v243, v8
v_mul_f32 v244, v244, v8
v_mul_f32 v245, v245, v8
v_mul_f32 v246, v246, v8
v_mul_f32 v247, v247, v8
v_accvgpr_write_b32 a8, v240
v_accvgpr_write_b32 a9, v241
v_accvgpr_write_b32 a10, v242
v_accvgpr_write_b32 a11, v243
v_accvgpr_write_b32 a12, v244
v_accvgpr_write_b32 a13, v245
v_accvgpr_write_b32 a14, v246
v_accvgpr_write_b32 a15, v247
v_accvgpr_read_b32 v240, a16
v_accvgpr_read_b32 v241, a17
v_accvgpr_read_b32 v242, a18
v_accvgpr_read_b32 v243, a19
v_accvgpr_read_b32 v244, a20
v_accvgpr_read_b32 v245, a21
v_accvgpr_read_b32 v246, a22
v_accvgpr_read_b32 v247, a23
v_mul_f32 v240, v240, v8
v_mul_f32 v241, v241, v8
v_mul_f32 v242, v242, v8
v_mul_f32 v243, v243, v8
v_mul_f32 v244, v244, v8
v_mul_f32 v245, v245, v8
v_mul_f32 v246, v246, v8
v_mul_f32 v247, v247, v8
v_accvgpr_write_b32 a16, v240
v_accvgpr_write_b32 a17, v241
v_accvgpr_write_b32 a18, v242
v_accvgpr_write_b32 a19, v243
v_accvgpr_write_b32 a20, v244
v_accvgpr_write_b32 a21, v245
v_accvgpr_write_b32 a22, v246
v_accvgpr_write_b32 a23, v247
v_accvgpr_read_b32 v240, a24
v_accvgpr_read_b32 v241, a25
v_accvgpr_read_b32 v242, a26
v_accvgpr_read_b32 v243, a27
v_accvgpr_read_b32 v244, a28
v_accvgpr_read_b32 v245, a29
v_accvgpr_read_b32 v246, a30
v_accvgpr_read_b32 v247, a31
v_mul_f32 v240, v240, v8
v_mul_f32 v241, v241, v8
v_mul_f32 v242, v242, v8
v_mul_f32 v243, v243, v8
v_mul_f32 v244, v244, v8
v_mul_f32 v245, v245, v8
v_mul_f32 v246, v246, v8
v_mul_f32 v247, v247, v8
v_accvgpr_write_b32 a24, v240
v_accvgpr_write_b32 a25, v241
v_accvgpr_write_b32 a26, v242
v_accvgpr_write_b32 a27, v243
v_accvgpr_write_b32 a28, v244
v_accvgpr_write_b32 a29, v245
v_accvgpr_write_b32 a30, v246
v_accvgpr_write_b32 a31, v247
v_accvgpr_read_b32 v240, a32
v_accvgpr_read_b32 v241, a33
v_accvgpr_read_b32 v242, a34
v_accvgpr_read_b32 v243, a35
v_accvgpr_read_b32 v244, a36
v_accvgpr_read_b32 v245, a37
v_accvgpr_read_b32 v246, a38
v_accvgpr_read_b32 v247, a39
v_mul_f32 v240, v240, v8
v_mul_f32 v241, v241, v8
v_mul_f32 v242, v242, v8
v_mul_f32 v243, v243, v8
v_mul_f32 v244, v244, v8
v_mul_f32 v245, v245, v8
v_mul_f32 v246, v246, v8
v_mul_f32 v247, v247, v8
v_accvgpr_write_b32 a32, v240
v_accvgpr_write_b32 a33, v241
v_accvgpr_write_b32 a34, v242
v_accvgpr_write_b32 a35, v243
v_accvgpr_write_b32 a36, v244
v_accvgpr_write_b32 a37, v245
v_accvgpr_write_b32 a38, v246
v_accvgpr_write_b32 a39, v247
v_accvgpr_read_b32 v240, a40
v_accvgpr_read_b32 v241, a41
v_accvgpr_read_b32 v242, a42
v_accvgpr_read_b32 v243, a43
v_accvgpr_read_b32 v244, a44
v_accvgpr_read_b32 v245, a45
v_accvgpr_read_b32 v246, a46
v_accvgpr_read_b32 v247, a47
v_mul_f32 v240, v240, v8
v_mul_f32 v241, v241, v8
v_mul_f32 v242, v242, v8
v_mul_f32 v243, v243, v8
v_mul_f32 v244, v244, v8
v_mul_f32 v245, v245, v8
v_mul_f32 v246, v246, v8
v_mul_f32 v247, v247, v8
v_accvgpr_write_b32 a40, v240
v_accvgpr_write_b32 a41, v241
v_accvgpr_write_b32 a42, v242
v_accvgpr_write_b32 a43, v243
v_accvgpr_write_b32 a44, v244
v_accvgpr_write_b32 a45, v245
v_accvgpr_write_b32 a46, v246
v_accvgpr_write_b32 a47, v247
v_accvgpr_read_b32 v240, a48
v_accvgpr_read_b32 v241, a49
v_accvgpr_read_b32 v242, a50
v_accvgpr_read_b32 v243, a51
v_accvgpr_read_b32 v244, a52
v_accvgpr_read_b32 v245, a53
v_accvgpr_read_b32 v246, a54
v_accvgpr_read_b32 v247, a55
v_mul_f32 v240, v240, v8
v_mul_f32 v241, v241, v8
v_mul_f32 v242, v242, v8
v_mul_f32 v243, v243, v8
v_mul_f32 v244, v244, v8
v_mul_f32 v245, v245, v8
v_mul_f32 v246, v246, v8
v_mul_f32 v247, v247, v8
v_accvgpr_write_b32 a48, v240
v_accvgpr_write_b32 a49, v241
v_accvgpr_write_b32 a50, v242
v_accvgpr_write_b32 a51, v243
v_accvgpr_write_b32 a52, v244
v_accvgpr_write_b32 a53, v245
v_accvgpr_write_b32 a54, v246
v_accvgpr_write_b32 a55, v247
v_accvgpr_read_b32 v240, a56
v_accvgpr_read_b32 v241, a57
v_accvgpr_read_b32 v242, a58
v_accvgpr_read_b32 v243, a59
v_accvgpr_read_b32 v244, a60
v_accvgpr_read_b32 v245, a61
v_accvgpr_read_b32 v246, a62
v_accvgpr_read_b32 v247, a63
v_mul_f32 v240, v240, v8
v_mul_f32 v241, v241, v8
v_mul_f32 v242, v242, v8
v_mul_f32 v243, v243, v8
v_mul_f32 v244, v244, v8
v_mul_f32 v245, v245, v8
v_mul_f32 v246, v246, v8
v_mul_f32 v247, v247, v8
v_accvgpr_write_b32 a56, v240
v_accvgpr_write_b32 a57, v241
v_accvgpr_write_b32 a58, v242
v_accvgpr_write_b32 a59, v243
v_accvgpr_write_b32 a60, v244
v_accvgpr_write_b32 a61, v245
v_accvgpr_write_b32 a62, v246
v_accvgpr_write_b32 a63, v247
s_nop 1
s_branch L_p3_s0m_end
L_spin_go:
s_mov_b32 s36, 400000
L_spin_go_l:
s_sleep 1
buffer_load_dword v254, off, s[12:15], 0 sc1
s_waitcnt vmcnt(0)
v_cmp_gt_u32 vcc, 1, v254
s_nop 4
s_cbranch_vccz L_spin_go_ret
s_sub_u32 s36, s36, 1
s_cmp_lg_u32 s36, 0
s_cbranch_scc1 L_spin_go_l
s_branch L_spin_go_ret
L_spin_f1:
s_mov_b32 s36, 400000
L_spin_f1_l:
s_sleep 1
buffer_load_dword v237, v233, s[8:11], 0 offen offset:0 sc1
s_waitcnt vmcnt(0)
v_cmp_gt_u32 vcc, 1, v237
s_nop 4
s_cbranch_vccz L_spin_f1_ret
s_sub_u32 s36, s36, 1
s_cmp_lg_u32 s36, 0
s_cbranch_scc1 L_spin_f1_l
s_branch L_spin_f1_ret
L_spin_f2:
s_mov_b32 s36, 400000
L_spin_f2_l:
s_sleep 1
buffer_load_dword v253, v254, s[8:11], 0 offen offset:1024 sc1
s_waitcnt vmcnt(0)
v_cmp_gt_u32 vcc, 1, v253
s_nop 4
s_cbranch_vccz L_spin_f2_ret
s_sub_u32 s36, s36, 1
s_cmp_lg_u32 s36, 0
s_cbranch_scc1 L_spin_f2_l
s_branch L_spin_f2_ret
L_spin_f3:
s_mov_b32 s36, 400000
L_spin_f3_l:
s_sleep 1
buffer_load_dword v253, v254, s[8:11], 0 offen offset:3072 sc1
s_waitcnt vmcnt(0)
v_cmp_gt_u32 vcc, 1, v253
s_nop 4
s_cbranch_vccz L_spin_f3_ret
s_sub_u32 s36, s36, 1
s_cmp_lg_u32 s36, 0
s_cbranch_scc1 L_spin_f3_l
s_branch L_spin_f3_ret
L_code_end:
s_endpgm
.section .rodata,"a"
.p2align 6
.amdhsa_kernel gated_mix__ssm_conv_h3__compressed_kv_cla__prompt_kernel
  .amdhsa_next_free_vgpr 512
  .amdhsa_next_free_sgpr 102
  .amdhsa_accum_offset 256
  .amdhsa_group_segment_fixed_size 0
  .amdhsa_kernarg_size 128
  .amdhsa_user_sgpr_count 2
  .amdhsa_user_sgpr_kernarg_segment_ptr 1
  .amdhsa_system_sgpr_workgroup_id_x 1
  .amdhsa_float_denorm_mode_32 3
.end_amdhsa_kernel
.text
```

```asm
; @launch grid=(256,1,1) block=(256,1,1) lds=163840
.amdgcn_target "amdgcn-amd-amdhsa--gfx950"
.text
.macro MA d,x,a,y,b
v_mfma_f32_16x16x32_bf16 a[\d:\d+3], \x[\a:\a+3], \y[\b:\b+3], a[\d:\d+3]
.endm
.macro MV d,x,a,y,b
v_mfma_f32_16x16x32_bf16 v[\d:\d+3], \x[\a:\a+3], \y[\b:\b+3], v[\d:\d+3]
.endm
.macro TR d,a,o
ds_read_b64_tr_b16 v[\d:\d+1], v\a offset:\o
.endm
.globl gated_mix__ssm_conv_h3__compressed_kv_cla__prompt_kernel
.p2align 8
.type gated_mix__ssm_conv_h3__compressed_kv_cla__prompt_kernel,@function
gated_mix__ssm_conv_h3__compressed_kv_cla__prompt_kernel:
s_cmp_ge_u32 s2, 256
s_cbranch_scc1 L_end
s_load_dwordx2 s[88:89], s[0:1], 56
s_load_dwordx4 s[92:95], s[0:1], 72
s_load_dwordx2 s[40:41], s[0:1], 120
s_load_dwordx2 s[96:97], s[0:1], 112
s_load_dwordx2 s[32:33], s[0:1], 0
s_load_dwordx2 s[34:35], s[0:1], 64
v_lshrrev_b32 v2, 6, v0
v_and_b32 v1, 63, v0
v_lshlrev_b32 v3, 4, v0
v_readfirstlane_b32 s3, v2
s_and_b32 s36, s2, 7
s_lshr_b32 s37, s2, 3
s_and_b32 s38, s37, 7
s_lshr_b32 s37, s37, 3
s_lshr_b32 s42, s37, 1
s_and_b32 s37, s37, 1
s_lshl_b32 s36, s36, 1
s_add_u32 s36, s36, s37
s_lshl_b32 s24, s38, 18
s_lshl_b32 s39, s3, 16
s_add_u32 s24, s24, s39
s_lshl_b32 s25, s3, 17
s_lshl_b32 s39, s36, 9
s_add_u32 s25, s25, s39
s_and_b32 s20, s2, 7
s_lshl_b32 s21, s20, 19
s_lshl_b32 s20, s20, 7
s_lshl_b32 s22, s3, 13
s_add_u32 s23, s22, 98304
v_lshrrev_b32 v204, 3, v1
v_lshlrev_b32 v204, 10, v204
v_lshrrev_b32 v205, 4, v1
v_and_b32 v206, 7, v1
v_xor_b32 v206, v206, v205
v_lshl_add_u32 v204, v206, 4, v204
v_xor_b32 v207, 64, v204
v_add_u32 v176, 0, v204
v_add_u32 v177, 7168, v207
v_add_u32 v178, 14336, v204
v_add_u32 v179, 21504, v207
v_add_u32 v180, 32768, v204
v_add_u32 v181, 39936, v207
v_add_u32 v182, 47104, v204
v_add_u32 v183, 54272, v207
v_lshrrev_b32 v204, 5, v1
v_and_b32 v206, 31, v1
v_lshlrev_b32 v207, 1, v204
v_xor_b32 v206, v206, v207
v_lshlrev_b32 v204, 13, v204
v_xor_b32 v207, 0, v206
v_lshl_add_u32 v207, v207, 4, v204
v_add_u32 v184, 0, v207
v_xor_b32 v207, 4, v206
v_lshl_add_u32 v207, v207, 4, v204
v_add_u32 v185, 15360, v207
v_xor_b32 v207, 0, v206
v_lshl_add_u32 v207, v207, 4, v204
v_add_u32 v186, 30720, v207
v_xor_b32 v207, 4, v206
v_lshl_add_u32 v207, v207, 4, v204
v_add_u32 v187, 46080, v207
v_xor_b32 v207, 8, v206
v_lshl_add_u32 v207, v207, 4, v204
v_add_u32 v188, 65536, v207
v_xor_b32 v207, 12, v206
v_lshl_add_u32 v207, v207, 4, v204
v_add_u32 v189, 80896, v207
v_xor_b32 v207, 8, v206
v_lshl_add_u32 v207, v207, 4, v204
v_add_u32 v190, 96256, v207
v_xor_b32 v207, 12, v206
v_lshl_add_u32 v207, v207, 4, v204
v_add_u32 v191, 111616, v207
s_waitcnt lgkmcnt(0)
s_add_u32 s8, s88, s24
s_addc_u32 s9, s89, 0
s_mov_b32 s10, 65536
s_mov_b32 s11, 0x20000
s_cmp_eq_u32 s42, 0
s_cselect_b32 s12, s92, s94
s_cselect_b32 s13, s93, s95
s_add_u32 s12, s12, s25
s_addc_u32 s13, s13, 0
s_sub_u32 s14, 4194304, s25
s_mov_b32 s15, 0x20000
s_add_u32 s4, s40, 59768832
s_addc_u32 s5, s41, 0
s_mov_b32 s6, 4096
s_mov_b32 s7, 0x20000
s_lshl_b32 s43, s2, 20
v_add_u32 v3, s43, v3
v_mov_b32 v4, 0
v_mov_b32 v5, 0
v_mov_b32 v6, 0
v_mov_b32 v7, 0
buffer_store_dwordx4 v[4:7], v3, s[4:7], 0 offen sc1
s_add_u32 m0, s23, 0
s_nop 0
buffer_load_dwordx4 v184, s[12:15], s21 offen offset:0 lds
buffer_load_dwordx4 v185, s[12:15], s21 offen offset:1024 lds
buffer_load_dwordx4 v186, s[12:15], s21 offen offset:2048 lds
buffer_load_dwordx4 v187, s[12:15], s21 offen offset:3072 lds
s_add_u32 m0, s23, 4096
s_nop 0
buffer_load_dwordx4 v188, s[12:15], s21 offen offset:0 lds
buffer_load_dwordx4 v189, s[12:15], s21 offen offset:1024 lds
buffer_load_dwordx4 v190, s[12:15], s21 offen offset:2048 lds
buffer_load_dwordx4 v191, s[12:15], s21 offen offset:3072 lds
s_add_u32 s21, s21, 524288
s_and_b32 s21, s21, 4194303
s_add_u32 m0, s22, 0
s_nop 0
buffer_load_dwordx4 v176, s[8:11], s20 offen offset:0 lds
buffer_load_dwordx4 v177, s[8:11], s20 offen offset:1024 lds
buffer_load_dwordx4 v178, s[8:11], s20 offen offset:2048 lds
buffer_load_dwordx4 v179, s[8:11], s20 offen offset:3072 lds
s_add_u32 m0, s22, 4096
s_nop 0
buffer_load_dwordx4 v180, s[8:11], s20 offen offset:0 lds
buffer_load_dwordx4 v181, s[8:11], s20 offen offset:1024 lds
buffer_load_dwordx4 v182, s[8:11], s20 offen offset:2048 lds
buffer_load_dwordx4 v183, s[8:11], s20 offen offset:3072 lds
s_add_u32 s20, s20, 128
s_and_b32 s20, s20, 1023
v_and_b32 v204, 15, v1
v_lshrrev_b32 v206, 1, v204
v_xor_b32 v206, v206, v205
v_lshlrev_b32 v206, 4, v206
v_lshl_add_u32 v206, v204, 7, v206
s_and_b32 s39, s3, 1
s_lshl_b32 s39, s39, 14
v_add_u32 v192, s39, v206
v_xor_b32 v193, 64, v192
v_add_u32 v194, 0x10000, v192
v_add_u32 v195, 0x10000, v193
v_bfe_u32 v204, v1, 2, 2
v_and_b32 v206, 1, v205
v_lshl_or_b32 v206, v206, 2, v204
v_lshl_add_u32 v204, v205, 3, v204
v_lshlrev_b32 v204, 9, v204
v_and_b32 v207, 3, v1
v_lshl_add_u32 v204, v207, 3, v204
s_lshr_b32 s39, s3, 1
s_lshl_b32 s39, s39, 8
s_add_u32 s39, s39, 98304
v_add_u32 v204, s39, v204
v_xor_b32 v207, 0, v206
v_lshl_add_u32 v196, v207, 5, v204
v_xor_b32 v207, 1, v206
v_lshl_add_u32 v197, v207, 5, v204
v_xor_b32 v207, 2, v206
v_lshl_add_u32 v198, v207, 5, v204
v_xor_b32 v207, 3, v206
v_lshl_add_u32 v199, v207, 5, v204
v_xor_b32 v207, 4, v206
v_lshl_add_u32 v200, v207, 5, v204
v_xor_b32 v207, 5, v206
v_lshl_add_u32 v201, v207, 5, v204
v_xor_b32 v207, 6, v206
v_lshl_add_u32 v202, v207, 5, v204
v_xor_b32 v207, 7, v206
v_lshl_add_u32 v203, v207, 5, v204
s_lshl_b32 s36, s36, 1
s_lshr_b32 s39, s3, 1
s_add_u32 s36, s36, s39
s_lshl_b32 s24, s36, 19
s_lshl_b32 s38, s38, 16
s_add_u32 s24, s24, s38
s_and_b32 s39, s3, 1
s_lshl_b32 s39, s39, 15
s_add_u32 s24, s24, s39
s_lshl_b32 s36, s42, 24
s_add_u32 s16, s40, s36
s_addc_u32 s17, s41, 0
s_mov_b32 s18, 16777216
s_mov_b32 s19, 0x20000
s_mov_b32 s98, 256
s_mov_b32 s99, 0x20000
v_lshlrev_b32 v3, 16, v3
v_mov_b32 v4, 1
s_cmp_lg_u32 s2, 0
s_cselect_b32 s43, 0x10000000, 0
v_or_b32 v3, s43, v3
s_waitcnt vmcnt(0)
s_barrier
buffer_store_dword v4, v3, s[96:99], 0 offen sc1
ds_read_b128 v[80:83], v192 offset:0
ds_read_b128 v[84:87], v192 offset:2048
ds_read_b128 v[88:91], v192 offset:4096
ds_read_b128 v[92:95], v192 offset:6144
ds_read_b128 v[96:99], v192 offset:8192
ds_read_b128 v[100:103], v192 offset:10240
ds_read_b128 v[104:107], v192 offset:12288
ds_read_b128 v[108:111], v192 offset:14336
TR 144,196,0
TR 146,196,2048
TR 148,197,0
TR 150,197,2048
TR 152,198,0
TR 154,198,2048
TR 156,199,0
TR 158,199,2048
TR 160,200,0
TR 162,200,2048
TR 164,201,0
TR 166,201,2048
TR 168,202,0
TR 170,202,2048
TR 172,203,0
TR 174,203,2048
s_cmp_eq_u32 s42, 0
s_cbranch_scc0 L_p1_V
s_waitcnt lgkmcnt(14)
v_mfma_f32_16x16x32_bf16 a[0:3], v[144:147], v[80:83], 0
s_add_u32 m0, s23, 32768
s_add_u32 s25, s24, 128
v_mfma_f32_16x16x32_bf16 a[8:11], v[144:147], v[84:87], 0
ds_read_b128 v[112:115], v193 offset:0
v_mfma_f32_16x16x32_bf16 a[64:67], v[144:147], v[88:91], 0
buffer_load_dwordx4 v184, s[12:15], s21 offen offset:0 lds
s_add_u32 s26, s24, 2048
v_mfma_f32_16x16x32_bf16 a[72:75], v[144:147], v[92:95], 0
v_mfma_f32_16x16x32_bf16 a[128:131], v[144:147], v[96:99], 0
v_mfma_f32_16x16x32_bf16 a[136:139], v[144:147], v[100:103], 0
buffer_load_dwordx4 v185, s[12:15], s21 offen offset:1024 lds
s_add_u32 s27, s24, 2176
v_mfma_f32_16x16x32_bf16 a[192:195], v[144:147], v[104:107], 0
v_mfma_f32_16x16x32_bf16 a[200:203], v[144:147], v[108:111], 0
TR 144,196,16384
TR 146,196,18432
s_waitcnt lgkmcnt(15)
v_mfma_f32_16x16x32_bf16 a[4:7], v[148:151], v[80:83], 0
ds_read_b128 v[116:119], v193 offset:2048
buffer_load_dwordx4 v186, s[12:15], s21 offen offset:2048 lds
v_mfma_f32_16x16x32_bf16 a[12:15], v[148:151], v[84:87], 0
s_add_u32 s28, s24, 4096
v_mfma_f32_16x16x32_bf16 a[68:71], v[148:151], v[88:91], 0
buffer_load_dwordx4 v187, s[12:15], s21 offen offset:3072 lds
v_mfma_f32_16x16x32_bf16 a[76:79], v[148:151], v[92:95], 0
s_add_u32 s29, s24, 4224
v_mfma_f32_16x16x32_bf16 a[132:135], v[148:151], v[96:99], 0
s_add_u32 m0, s23, 36864
v_mfma_f32_16x16x32_bf16 a[140:143], v[148:151], v[100:103], 0
ds_read_b128 v[120:123], v193 offset:4096
v_mfma_f32_16x16x32_bf16 a[196:199], v[148:151], v[104:107], 0
s_add_u32 s30, s24, 6144
v_mfma_f32_16x16x32_bf16 a[204:207], v[148:151], v[108:111], 0
TR 148,197,16384
TR 150,197,18432
s_waitcnt lgkmcnt(15)
v_mfma_f32_16x16x32_bf16 a[16:19], v[152:155], v[80:83], 0
buffer_load_dwordx4 v188, s[12:15], s21 offen offset:0 lds
s_add_u32 s31, s24, 6272
v_mfma_f32_16x16x32_bf16 a[24:27], v[152:155], v[84:87], 0
v_mfma_f32_16x16x32_bf16 a[80:83], v[152:155], v[88:91], 0
buffer_load_dwordx4 v189, s[12:15], s21 offen offset:1024 lds
v_mfma_f32_16x16x32_bf16 a[88:91], v[152:155], v[92:95], 0
v_lshlrev_b32 v8, 7, v1
v_mfma_f32_16x16x32_bf16 a[144:147], v[152:155], v[96:99], 0
ds_read_b128 v[124:127], v193 offset:6144
buffer_load_dwordx4 v190, s[12:15], s21 offen offset:2048 lds
v_mfma_f32_16x16x32_bf16 a[152:155], v[152:155], v[100:103], 0
v_mfma_f32_16x16x32_bf16 a[208:211], v[152:155], v[104:107], 0
s_getpc_b64 s[4:5]
L_pcK:
v_mfma_f32_16x16x32_bf16 a[216:219], v[152:155], v[108:111], 0
TR 152,198,16384
TR 154,198,18432
v_mfma_f32_16x16x32_bf16 a[20:23], v[156:159], v[80:83], 0
buffer_load_dwordx4 v191, s[12:15], s21 offen offset:3072 lds
v_mfma_f32_16x16x32_bf16 a[28:31], v[156:159], v[84:87], 0
s_add_u32 s21, s21, 524288
s_lshr_b32 s98, s2, 3
v_mfma_f32_16x16x32_bf16 a[84:87], v[156:159], v[88:91], 0
ds_read_b128 v[128:131], v193 offset:8192
v_mfma_f32_16x16x32_bf16 a[92:95], v[156:159], v[92:95], 0
v_mfma_f32_16x16x32_bf16 a[148:151], v[156:159], v[96:99], 0
s_and_b32 s21, s21, 4194303
s_lshl_b32 s98, s98, 2
v_mfma_f32_16x16x32_bf16 a[156:159], v[156:159], v[100:103], 0
v_mfma_f32_16x16x32_bf16 a[212:215], v[156:159], v[104:107], 0
v_mfma_f32_16x16x32_bf16 a[220:223], v[156:159], v[108:111], 0
TR 156,199,16384
TR 158,199,18432
s_waitcnt lgkmcnt(15)
v_mfma_f32_16x16x32_bf16 a[32:35], v[160:163], v[80:83], 0
ds_read_b128 v[132:135], v193 offset:10240
s_add_u32 m0, s22, 32768
v_mfma_f32_16x16x32_bf16 a[40:43], v[160:163], v[84:87], 0
buffer_load_dwordx4 v176, s[8:11], s20 offen offset:0 lds
s_add_u32 s98, s98, s3
v_mfma_f32_16x16x32_bf16 a[96:99], v[160:163], v[88:91], 0
s_lshl_b32 s98, s98, 10
v_mfma_f32_16x16x32_bf16 a[104:107], v[160:163], v[92:95], 0
v_mfma_f32_16x16x32_bf16 a[160:163], v[160:163], v[96:99], 0
buffer_load_dwordx4 v177, s[8:11], s20 offen offset:1024 lds
v_and_b32 v9, 0x380, v8
v_mfma_f32_16x16x32_bf16 a[168:171], v[160:163], v[100:103], 0
v_mfma_f32_16x16x32_bf16 a[224:227], v[160:163], v[104:107], 0
buffer_load_dwordx4 v178, s[8:11], s20 offen offset:2048 lds
v_mfma_f32_16x16x32_bf16 a[232:235], v[160:163], v[108:111], 0
TR 160,200,16384
TR 162,200,18432
v_mfma_f32_16x16x32_bf16 a[36:39], v[164:167], v[80:83], 0
ds_read_b128 v[136:139], v193 offset:12288
v_add_u32 v9, s98, v9
v_mfma_f32_16x16x32_bf16 a[44:47], v[164:167], v[84:87], 0
buffer_load_dwordx4 v179, s[8:11], s20 offen offset:3072 lds
v_mfma_f32_16x16x32_bf16 a[100:103], v[164:167], v[88:91], 0
v_min_u32 v9, L_code_end - L_pcK - 4, v9
v_mfma_f32_16x16x32_bf16 a[108:111], v[164:167], v[92:95], 0
s_add_u32 m0, s22, 36864
v_mfma_f32_16x16x32_bf16 a[164:167], v[164:167], v[96:99], 0
v_mfma_f32_16x16x32_bf16 a[172:175], v[164:167], v[100:103], 0
ds_read_b128 v[140:143], v193 offset:14336
v_mov_b32 v11, s5
v_mfma_f32_16x16x32_bf16 a[228:231], v[164:167], v[104:107], 0
buffer_load_dwordx4 v180, s[8:11], s20 offen offset:0 lds
v_mfma_f32_16x16x32_bf16 a[236:239], v[164:167], v[108:111], 0
TR 164,201,16384
TR 166,201,18432
v_mfma_f32_16x16x32_bf16 a[48:51], v[168:171], v[80:83], 0
v_add_co_u32 v10, vcc, s4, v9
s_nop 1
v_addc_co_u32 v11, vcc, 0, v11, vcc
v_mfma_f32_16x16x32_bf16 a[56:59], v[168:171], v[84:87], 0
buffer_load_dwordx4 v181, s[8:11], s20 offen offset:1024 lds
v_mfma_f32_16x16x32_bf16 a[112:115], v[168:171], v[88:91], 0
v_mfma_f32_16x16x32_bf16 a[120:123], v[168:171], v[92:95], 0
buffer_load_dwordx4 v182, s[8:11], s20 offen offset:2048 lds
v_mfma_f32_16x16x32_bf16 a[176:179], v[168:171], v[96:99], 0
v_mfma_f32_16x16x32_bf16 a[184:187], v[168:171], v[100:103], 0
v_mfma_f32_16x16x32_bf16 a[240:243], v[168:171], v[104:107], 0
buffer_load_dwordx4 v183, s[8:11], s20 offen offset:3072 lds
v_mfma_f32_16x16x32_bf16 a[248:251], v[168:171], v[108:111], 0
TR 168,202,16384
TR 170,202,18432
s_waitcnt lgkmcnt(15)
v_mfma_f32_16x16x32_bf16 a[52:55], v[172:175], v[80:83], 0
s_add_u32 s20, s20, 128
v_mfma_f32_16x16x32_bf16 a[60:63], v[172:175], v[84:87], 0
v_mfma_f32_16x16x32_bf16 a[116:119], v[172:175], v[88:91], 0
v_mfma_f32_16x16x32_bf16 a[124:127], v[172:175], v[92:95], 0
s_and_b32 s20, s20, 1023
global_load_dword v79, v[10:11], off
v_mfma_f32_16x16x32_bf16 a[180:183], v[172:175], v[96:99], 0
v_mfma_f32_16x16x32_bf16 a[188:191], v[172:175], v[100:103], 0
v_mfma_f32_16x16x32_bf16 a[244:247], v[172:175], v[104:107], 0
v_mfma_f32_16x16x32_bf16 a[252:255], v[172:175], v[108:111], 0
TR 172,203,16384
TR 174,203,18432
s_waitcnt lgkmcnt(2)
MA 0,v,144,v,112
s_add_u32 m0, s22, 65536
MA 8,v,144,v,116
MA 64,v,144,v,120
MA 72,v,144,v,124
buffer_load_dwordx4 v176, s[8:11], s20 offen offset:0 lds
MA 128,v,144,v,128
MA 136,v,144,v,132
MA 192,v,144,v,136
MA 200,v,144,v,140
buffer_load_dwordx4 v177, s[8:11], s20 offen offset:1024 lds
MA 4,v,148,v,112
MA 12,v,148,v,116
MA 68,v,148,v,120
buffer_load_dwordx4 v178, s[8:11], s20 offen offset:2048 lds
MA 76,v,148,v,124
MA 132,v,148,v,128
MA 140,v,148,v,132
MA 196,v,148,v,136
buffer_load_dwordx4 v179, s[8:11], s20 offen offset:3072 lds
MA 204,v,148,v,140
MA 16,v,152,v,112
MA 24,v,152,v,116
s_add_u32 m0, s22, 69632
MA 80,v,152,v,120
MA 88,v,152,v,124
MA 144,v,152,v,128
MA 152,v,152,v,132
buffer_load_dwordx4 v180, s[8:11], s20 offen offset:0 lds
MA 208,v,152,v,136
MA 216,v,152,v,140
MA 20,v,156,v,112
MA 28,v,156,v,116
buffer_load_dwordx4 v181, s[8:11], s20 offen offset:1024 lds
MA 84,v,156,v,120
MA 92,v,156,v,124
MA 148,v,156,v,128
buffer_load_dwordx4 v182, s[8:11], s20 offen offset:2048 lds
MA 156,v,156,v,132
MA 212,v,156,v,136
MA 220,v,156,v,140
MA 32,v,160,v,112
buffer_load_dwordx4 v183, s[8:11], s20 offen offset:3072 lds
MA 40,v,160,v,116
MA 96,v,160,v,120
MA 104,v,160,v,124
s_add_u32 s20, s20, 128
MA 160,v,160,v,128
MA 168,v,160,v,132
MA 224,v,160,v,136
MA 232,v,160,v,140
s_and_b32 s20, s20, 1023
MA 36,v,164,v,112
MA 44,v,164,v,116
MA 100,v,164,v,120
MA 108,v,164,v,124
MA 164,v,164,v,128
s_waitcnt vmcnt(9) lgkmcnt(0)
s_barrier
MA 172,v,164,v,132
TR 144,196,32768
TR 146,196,34816
MA 228,v,164,v,136
ds_read_b128 v[80:83], v192 offset:32768
s_add_u32 m0, s23, 0
MA 236,v,164,v,140
TR 148,197,32768
TR 150,197,34816
MA 48,v,168,v,112
ds_read_b128 v[84:87], v192 offset:34816
ds_read_b128 v[88:91], v192 offset:36864
MA 56,v,168,v,116
TR 152,198,32768
TR 154,198,34816
MA 112,v,168,v,120
ds_read_b128 v[92:95], v192 offset:38912
ds_read_b128 v[96:99], v192 offset:40960
MA 120,v,168,v,124
TR 156,199,32768
TR 158,199,34816
MA 176,v,168,v,128
ds_read_b128 v[100:103], v192 offset:43008
ds_read_b128 v[104:107], v192 offset:45056
MA 184,v,168,v,132
TR 160,200,32768
TR 162,200,34816
MA 240,v,168,v,136
ds_read_b128 v[108:111], v192 offset:47104
buffer_load_dwordx4 v184, s[12:15], s21 offen offset:0 lds
MA 248,v,168,v,140
TR 164,201,32768
TR 166,201,34816
MA 52,v,172,v,112
buffer_load_dwordx4 v185, s[12:15], s21 offen offset:1024 lds
buffer_load_dwordx4 v186, s[12:15], s21 offen offset:2048 lds
MA 60,v,172,v,116
TR 168,202,32768
TR 170,202,34816
MA 116,v,172,v,120
buffer_load_dwordx4 v187, s[12:15], s21 offen offset:3072 lds
s_add_u32 m0, s23, 4096
MA 124,v,172,v,124
buffer_load_dwordx4 v188, s[12:15], s21 offen offset:0 lds
buffer_load_dwordx4 v189, s[12:15], s21 offen offset:1024 lds
MA 180,v,172,v,128
buffer_load_dwordx4 v190, s[12:15], s21 offen offset:2048 lds
buffer_load_dwordx4 v191, s[12:15], s21 offen offset:3072 lds
MA 188,v,172,v,132
s_add_u32 s21, s21, 524288
s_and_b32 s21, s21, 4194303
MA 244,v,172,v,136
s_load_dwordx2 s[84:85], s[0:1], 8
s_load_dwordx2 s[88:89], s[0:1], 16
MA 252,v,172,v,140
TR 172,203,32768
TR 174,203,34816
s_load_dwordx2 s[92:93], s[0:1], 0
s_load_dwordx2 s[96:97], s[0:1], 24
s_load_dwordx2 s[76:77], s[0:1], 96
s_waitcnt lgkmcnt(2)
MA 0,v,144,v,80
s_add_u32 m0, s22, 0
MA 8,v,144,v,84
ds_read_b128 v[112:115], v193 offset:32768
MA 64,v,144,v,88
s_mov_b32 s4, s34
s_mov_b32 s5, s35
MA 72,v,144,v,92
MA 128,v,144,v,96
MA 136,v,144,v,100
buffer_load_dwordx4 v176, s[8:11], s20 offen offset:0 lds
MA 192,v,144,v,104
MA 200,v,144,v,108
TR 144,196,49152
TR 146,196,51200
MA 4,v,148,v,80
ds_read_b128 v[116:119], v193 offset:34816
MA 12,v,148,v,84
s_mov_b32 s6, 8388608
s_mov_b32 s7, 0x20000
MA 68,v,148,v,88
buffer_load_dwordx4 v177, s[8:11], s20 offen offset:1024 lds
MA 76,v,148,v,92
MA 132,v,148,v,96
MA 140,v,148,v,100
ds_read_b128 v[120:123], v193 offset:36864
MA 196,v,148,v,104
MA 204,v,148,v,108
TR 148,197,49152
TR 150,197,51200
MA 16,v,152,v,80
buffer_load_dwordx4 v178, s[8:11], s20 offen offset:2048 lds
s_lshr_b32 s43, s2, 3
MA 24,v,152,v,84
MA 80,v,152,v,88
MA 88,v,152,v,92
s_lshl_b32 s43, s43, 2
MA 144,v,152,v,96
ds_read_b128 v[124:127], v193 offset:38912
buffer_load_dwordx4 v179, s[8:11], s20 offen offset:3072 lds
MA 152,v,152,v,100
MA 208,v,152,v,104
MA 216,v,152,v,108
TR 152,198,49152
TR 154,198,51200
MA 20,v,156,v,80
s_add_u32 s43, s43, s3
MA 28,v,156,v,84
s_add_u32 m0, s22, 4096
MA 84,v,156,v,88
ds_read_b128 v[128:131], v193 offset:40960
MA 92,v,156,v,92
s_lshl_b32 s43, s43, 16
MA 148,v,156,v,96
MA 156,v,156,v,100
MA 212,v,156,v,104
MA 220,v,156,v,108
TR 156,199,49152
TR 158,199,51200
MA 32,v,160,v,80
ds_read_b128 v[132:135], v193 offset:43008
buffer_load_dwordx4 v180, s[8:11], s20 offen offset:0 lds
MA 40,v,160,v,84
s_and_b32 s37, s2, 7
MA 96,v,160,v,88
s_lshl_b32 s37, s37, 10
MA 104,v,160,v,92
MA 160,v,160,v,96
buffer_load_dwordx4 v181, s[8:11], s20 offen offset:1024 lds
MA 168,v,160,v,100
MA 224,v,160,v,104
s_add_u32 s43, s43, s37
MA 232,v,160,v,108
TR 160,200,49152
TR 162,200,51200
MA 36,v,164,v,80
ds_read_b128 v[136:139], v193 offset:45056
MA 44,v,164,v,84
buffer_load_dwordx4 v182, s[8:11], s20 offen offset:2048 lds
MA 100,v,164,v,88
v_lshrrev_b32 v78, 3, v1
MA 108,v,164,v,92
MA 164,v,164,v,96
MA 172,v,164,v,100
ds_read_b128 v[140:143], v193 offset:47104
MA 228,v,164,v,104
buffer_load_dwordx4 v183, s[8:11], s20 offen offset:3072 lds
s_waitcnt vmcnt(24)
v_and_b32 v79, 7, v1
MA 236,v,164,v,108
TR 164,201,49152
TR 166,201,51200
MA 48,v,168,v,80
MA 56,v,168,v,84
MA 112,v,168,v,88
v_lshlrev_b32 v79, 7, v79
MA 120,v,168,v,92
s_add_u32 s20, s20, 128
MA 176,v,168,v,96
MA 184,v,168,v,100
MA 240,v,168,v,104
v_lshl_add_u32 v78, v78, 13, v79
MA 248,v,168,v,108
TR 168,202,49152
TR 170,202,51200
s_waitcnt lgkmcnt(15)
MA 52,v,172,v,80
s_and_b32 s20, s20, 1023
MA 60,v,172,v,84
MA 116,v,172,v,88
v_add_u32 v78, s43, v78
MA 124,v,172,v,92
MA 180,v,172,v,96
MA 188,v,172,v,100
MA 244,v,172,v,104
MA 252,v,172,v,108
TR 172,203,49152
TR 174,203,51200
s_waitcnt lgkmcnt(2)
MA 0,v,144,v,112
MA 8,v,144,v,116
MA 64,v,144,v,120
MA 72,v,144,v,124
MA 128,v,144,v,128
MA 136,v,144,v,132
MA 192,v,144,v,136
MA 200,v,144,v,140
MA 4,v,148,v,112
MA 12,v,148,v,116
s_waitcnt vmcnt(8) lgkmcnt(0)
s_barrier
MA 68,v,148,v,120
TR 144,196,0
TR 146,196,2048
MA 76,v,148,v,124
ds_read_b128 v[80:83], v194 offset:0
s_add_u32 m0, s23, 32768
MA 132,v,148,v,128
s_mov_b32 s86, 4194304
s_mov_b32 s87, 0x20000
MA 140,v,148,v,132
s_mov_b32 s90, 4194304
s_mov_b32 s91, 0x20000
MA 196,v,148,v,136
buffer_load_dwordx4 v184, s[12:15], s21 offen offset:0 lds
MA 204,v,148,v,140
TR 148,197,0
TR 150,197,2048
MA 16,v,152,v,112
ds_read_b128 v[84:87], v194 offset:2048
s_mov_b32 s94, 4194304
MA 24,v,152,v,116
s_mov_b32 s95, 0x20000
s_mov_b32 s98, 8192
MA 80,v,152,v,120
buffer_load_dwordx4 v185, s[12:15], s21 offen offset:1024 lds
s_mov_b32 s99, 0x20000
MA 88,v,152,v,124
MA 144,v,152,v,128
s_mov_b32 s78, 2048
MA 152,v,152,v,132
ds_read_b128 v[88:91], v194 offset:4096
s_mov_b32 s79, 0x20000
MA 208,v,152,v,136
s_and_b32 s36, s2, 15
MA 216,v,152,v,140
TR 152,198,0
TR 154,198,2048
MA 20,v,156,v,112
buffer_load_dwordx4 v186, s[12:15], s21 offen offset:2048 lds
s_lshl_b32 s36, s36, 1
MA 28,v,156,v,116
s_lshr_b32 s37, s3, 1
MA 84,v,156,v,120
ds_read_b128 v[92:95], v194 offset:6144
s_add_u32 s36, s36, s37
MA 92,v,156,v,124
buffer_load_dwordx4 v187, s[12:15], s21 offen offset:3072 lds
s_lshl_b32 s36, s36, 3
MA 148,v,156,v,128
MA 156,v,156,v,132
v_and_b32 v252, 7, v1
MA 212,v,156,v,136
v_add_u32 v252, s36, v252
MA 220,v,156,v,140
TR 156,199,0
TR 158,199,2048
MA 32,v,160,v,112
ds_read_b128 v[96:99], v194 offset:8192
s_add_u32 m0, s23, 36864
MA 40,v,160,v,116
s_lshr_b32 s36, s2, 4
s_lshl_b32 s36, s36, 1
MA 96,v,160,v,120
s_and_b32 s37, s3, 1
MA 104,v,160,v,124
s_add_u32 s36, s36, s37
MA 160,v,160,v,128
ds_read_b128 v[100:103], v194 offset:10240
buffer_load_dwordx4 v188, s[12:15], s21 offen offset:0 lds
MA 168,v,160,v,132
s_lshl_b32 s36, s36, 3
v_lshrrev_b32 v253, 3, v1
MA 224,v,160,v,136
MA 232,v,160,v,140
TR 160,200,0
TR 162,200,2048
MA 36,v,164,v,112
buffer_load_dwordx4 v189, s[12:15], s21 offen offset:1024 lds
v_add_u32 v253, s36, v253
MA 44,v,164,v,116
ds_read_b128 v[104:107], v194 offset:12288
v_lshlrev_b32 v254, 14, v253
MA 100,v,164,v,120
v_lshl_add_u32 v254, v252, 3, v254
v_add_u32 v229, -6144, v254
MA 108,v,164,v,124
MA 164,v,164,v,128
buffer_load_dwordx4 v190, s[12:15], s21 offen offset:2048 lds
v_lshlrev_b32 v62, 5, v252
MA 172,v,164,v,132
v_lshlrev_b32 v254, 4, v253
MA 228,v,164,v,136
ds_read_b128 v[108:111], v194 offset:14336
v_sub_u32 v254, 4080, v254
MA 236,v,164,v,140
TR 164,201,0
TR 166,201,2048
MA 48,v,168,v,112
v_lshl_add_u32 v10, v252, 14, v254
MA 56,v,168,v,116
buffer_load_dwordx4 v191, s[12:15], s21 offen offset:3072 lds
v_and_b32 v252, 31, v1
MA 112,v,168,v,120
v_lshlrev_b32 v64, 4, v252
MA 120,v,168,v,124
s_lshl_b32 s36, s2, 2
MA 176,v,168,v,128
MA 184,v,168,v,132
s_add_u32 s21, s21, 524288
s_add_u32 s36, s36, s3
MA 240,v,168,v,136
s_lshl_b32 s36, s36, 1
MA 248,v,168,v,140
TR 168,202,0
TR 170,202,2048
MA 52,v,172,v,112
v_lshrrev_b32 v253, 5, v1
v_add_u32 v253, s36, v253
MA 60,v,172,v,116
s_and_b32 s21, s21, 4194303
MA 116,v,172,v,120
v_lshl_add_u32 v63, v253, 11, v64
MA 124,v,172,v,124
v_lshlrev_b32 v253, 2, v253
MA 180,v,172,v,128
v_lshl_add_u32 v11, v252, 20, v253
MA 188,v,172,v,132
MA 244,v,172,v,136
MA 252,v,172,v,140
TR 172,203,0
TR 174,203,2048
s_waitcnt lgkmcnt(2)
MA 0,v,144,v,80
s_add_u32 m0, s22, 32768
buffer_load_dwordx4 v[230:233], v63, s[92:95], 0 offen offset:0
MA 8,v,144,v,84
ds_read_b128 v[112:115], v195 offset:0
MA 64,v,144,v,88
MA 72,v,144,v,92
MA 128,v,144,v,96
buffer_load_dwordx4 v[2:5], v64, s[76:79], 0 offen offset:0
MA 136,v,144,v,100
buffer_load_dwordx4 v176, s[8:11], s20 offen offset:0 lds
MA 192,v,144,v,104
MA 200,v,144,v,108
TR 144,196,16384
TR 146,196,18432
MA 4,v,148,v,80
ds_read_b128 v[116:119], v195 offset:2048
MA 12,v,148,v,84
buffer_load_dwordx4 v[234:237], v63, s[92:95], 0 offen offset:512
MA 68,v,148,v,88
buffer_load_dwordx4 v177, s[8:11], s20 offen offset:1024 lds
MA 76,v,148,v,92
MA 132,v,148,v,96
MA 140,v,148,v,100
ds_read_b128 v[120:123], v195 offset:4096
MA 196,v,148,v,104
buffer_load_dwordx4 v[6:9], v64, s[76:79], 0 offen offset:512
MA 204,v,148,v,108
TR 148,197,16384
TR 150,197,18432
MA 16,v,152,v,80
buffer_load_dwordx4 v178, s[8:11], s20 offen offset:2048 lds
MA 24,v,152,v,84
MA 80,v,152,v,88
MA 88,v,152,v,92
buffer_load_dwordx4 v[238:241], v63, s[92:95], 0 offen offset:1024
MA 144,v,152,v,96
ds_read_b128 v[124:127], v195 offset:6144
buffer_load_dwordx4 v179, s[8:11], s20 offen offset:3072 lds
MA 152,v,152,v,100
MA 208,v,152,v,104
MA 216,v,152,v,108
TR 152,198,16384
TR 154,198,18432
MA 20,v,156,v,80
buffer_load_dwordx4 v[12:15], v64, s[76:79], 0 offen offset:1024
MA 28,v,156,v,84
s_add_u32 m0, s22, 36864
MA 84,v,156,v,88
ds_read_b128 v[128:131], v195 offset:8192
MA 92,v,156,v,92
MA 148,v,156,v,96
buffer_load_dwordx4 v[242:245], v63, s[92:95], 0 offen offset:1536
MA 156,v,156,v,100
MA 212,v,156,v,104
MA 220,v,156,v,108
TR 156,199,16384
TR 158,199,18432
MA 32,v,160,v,80
ds_read_b128 v[132:135], v195 offset:10240
buffer_load_dwordx4 v180, s[8:11], s20 offen offset:0 lds
MA 40,v,160,v,84
buffer_load_dwordx4 v[246:249], v64, s[76:79], 0 offen offset:1536
MA 96,v,160,v,88
MA 104,v,160,v,92
MA 160,v,160,v,96
buffer_load_dwordx4 v181, s[8:11], s20 offen offset:1024 lds
MA 168,v,160,v,100
MA 224,v,160,v,104
buffer_load_dwordx4 v[54:57], v62, s[96:99], 0 offen offset:0
MA 232,v,160,v,108
TR 160,200,16384
TR 162,200,18432
MA 36,v,164,v,80
ds_read_b128 v[136:139], v195 offset:12288
MA 44,v,164,v,84
buffer_load_dwordx4 v182, s[8:11], s20 offen offset:2048 lds
MA 100,v,164,v,88
buffer_load_dwordx4 v[58:61], v62, s[96:99], 0 offen offset:16
MA 108,v,164,v,92
MA 164,v,164,v,96
MA 172,v,164,v,100
ds_read_b128 v[140:143], v195 offset:14336
MA 228,v,164,v,104
buffer_load_dwordx4 v183, s[8:11], s20 offen offset:3072 lds
MA 236,v,164,v,108
TR 164,201,16384
TR 166,201,18432
MA 48,v,168,v,80
v_add_u32 v252, 0, v229
MA 56,v,168,v,84
MA 112,v,168,v,88
MA 120,v,168,v,92
s_add_u32 s20, s20, 128
MA 176,v,168,v,96
buffer_load_dwordx2 v[16:17], v252, s[84:87], 0 offen
MA 184,v,168,v,100
MA 240,v,168,v,104
MA 248,v,168,v,108
TR 168,202,16384
TR 170,202,18432
s_waitcnt lgkmcnt(15)
MA 52,v,172,v,80
s_and_b32 s20, s20, 1023
MA 60,v,172,v,84
v_add_u32 v253, 2048, v229
MA 116,v,172,v,88
MA 124,v,172,v,92
MA 180,v,172,v,96
MA 188,v,172,v,100
MA 244,v,172,v,104
MA 252,v,172,v,108
TR 172,203,16384
TR 174,203,18432
s_waitcnt lgkmcnt(2)
MA 0,v,144,v,112
MA 8,v,144,v,116
MA 64,v,144,v,120
MA 72,v,144,v,124
MA 128,v,144,v,128
MA 136,v,144,v,132
MA 192,v,144,v,136
MA 200,v,144,v,140
MA 4,v,148,v,112
MA 12,v,148,v,116
s_waitcnt vmcnt(19) lgkmcnt(0)
s_barrier
MA 68,v,148,v,120
TR 144,196,32768
TR 146,196,34816
MA 76,v,148,v,124
ds_read_b128 v[80:83], v192 offset:0
s_add_u32 m0, s23, 0
MA 132,v,148,v,128
s_and_b32 s80, s2, 7
s_lshr_b32 s81, s2, 3
MA 140,v,148,v,132
s_and_b32 s69, s81, 3
s_lshl_b32 s80, s80, 2
MA 196,v,148,v,136
buffer_load_dwordx4 v184, s[12:15], s21 offen offset:0 lds
s_add_u32 s69, s69, s80
MA 204,v,148,v,140
TR 148,197,32768
TR 150,197,34816
MA 16,v,152,v,112
ds_read_b128 v[84:87], v192 offset:2048
s_lshr_b32 s70, s81, 2
MA 24,v,152,v,116
s_lshl_b32 s80, s3, 16
s_lshl_b32 s65, s70, 18
MA 80,v,152,v,120
buffer_load_dwordx4 v185, s[12:15], s21 offen offset:1024 lds
s_sub_u32 s64, 3932160, s65
MA 88,v,152,v,124
s_add_u32 s65, s65, s80
s_add_u32 s64, s64, s80
MA 144,v,152,v,128
s_lshl_b32 s81, s69, 12
MA 152,v,152,v,132
ds_read_b128 v[88:91], v192 offset:4096
s_lshl_b32 s100, s64, 2
MA 208,v,152,v,136
s_add_u32 s100, s100, s81
MA 216,v,152,v,140
TR 152,198,32768
TR 154,198,34816
MA 20,v,156,v,112
buffer_load_dwordx4 v186, s[12:15], s21 offen offset:2048 lds
s_lshl_b32 s101, s65, 2
MA 28,v,156,v,116
s_add_u32 s101, s101, s81
s_lshl_b32 s66, s3, 17
MA 84,v,156,v,120
ds_read_b128 v[92:95], v192 offset:6144
s_lshl_b32 s81, s69, 8
MA 92,v,156,v,124
buffer_load_dwordx4 v187, s[12:15], s21 offen offset:3072 lds
s_add_u32 s66, s66, s81
MA 148,v,156,v,128
s_and_b32 s74, s2, 7
MA 156,v,156,v,132
s_lshl_b32 s74, s74, 8
MA 212,v,156,v,136
s_mov_b32 s82, s66
MA 220,v,156,v,140
TR 156,199,32768
TR 158,199,34816
MA 32,v,160,v,112
ds_read_b128 v[96:99], v192 offset:8192
s_add_u32 m0, s23, 4096
MA 40,v,160,v,116
s_lshl_b32 s66, s74, 12
s_lshl_b32 s67, s3, 13
MA 96,v,160,v,120
s_lshl_b32 s68, s3, 12
s_lshl_b32 s76, s70, 1
MA 104,v,160,v,124
s_sub_u32 s77, 32, s76
MA 160,v,160,v,128
ds_read_b128 v[100:103], v192 offset:10240
buffer_load_dwordx4 v188, s[12:15], s21 offen offset:0 lds
MA 168,v,160,v,132
s_add_u32 s76, s76, 2
s_mov_b32 s79, 0x41000000
MA 224,v,160,v,136
v_lshrrev_b32 v66, 3, v1
MA 232,v,160,v,140
TR 160,200,32768
TR 162,200,34816
MA 36,v,164,v,112
buffer_load_dwordx4 v189, s[12:15], s21 offen offset:1024 lds
v_lshlrev_b32 v66, 11, v66
MA 44,v,164,v,116
ds_read_b128 v[104:107], v192 offset:12288
v_lshrrev_b32 v67, 4, v1
MA 100,v,164,v,120
v_and_b32 v68, 7, v1
v_xor_b32 v68, v68, v67
MA 108,v,164,v,124
v_lshl_add_u32 v66, v68, 4, v66
MA 164,v,164,v,128
buffer_load_dwordx4 v190, s[12:15], s21 offen offset:2048 lds
v_xor_b32 v69, 64, v66
MA 172,v,164,v,132
v_add_u32 v208, 0, v66
MA 228,v,164,v,136
ds_read_b128 v[108:111], v192 offset:14336
v_add_u32 v209, 15360, v69
MA 236,v,164,v,140
TR 164,201,32768
TR 166,201,34816
MA 48,v,168,v,112
v_add_u32 v210, 30720, v66
v_add_u32 v211, 46080, v69
MA 56,v,168,v,116
buffer_load_dwordx4 v191, s[12:15], s21 offen offset:3072 lds
v_and_b32 v68, 15, v1
MA 112,v,168,v,120
v_lshlrev_b32 v69, 1, v67
MA 120,v,168,v,124
v_xor_b32 v68, v68, v69
MA 176,v,168,v,128
v_lshlrev_b32 v66, 13, v67
MA 184,v,168,v,132
s_add_u32 s21, s21, 524288
v_xor_b32 v69, 0, v68
MA 240,v,168,v,136
v_lshl_add_u32 v69, v69, 4, v66
MA 248,v,168,v,140
TR 168,202,32768
TR 170,202,34816
MA 52,v,172,v,112
v_add_u32 v212, 0, v69
v_xor_b32 v69, 0, v68
MA 60,v,172,v,116
s_and_b32 s21, s21, 4194303
v_lshl_add_u32 v69, v69, 4, v66
MA 116,v,172,v,120
v_add_u32 v213, 31744, v69
MA 124,v,172,v,124
v_xor_b32 v69, 8, v68
MA 180,v,172,v,128
v_lshl_add_u32 v69, v69, 4, v66
MA 188,v,172,v,132
v_add_u32 v214, 63488, v69
MA 244,v,172,v,136
MA 252,v,172,v,140
TR 172,203,32768
TR 174,203,34816
s_waitcnt lgkmcnt(2)
MA 0,v,144,v,80
s_add_u32 m0, s22, 65536
buffer_load_dwordx2 v[18:19], v253, s[84:87], 0 offen
MA 8,v,144,v,84
ds_read_b128 v[112:115], v193 offset:0
MA 64,v,144,v,88
MA 72,v,144,v,92
MA 128,v,144,v,96
v_add_u32 v254, 4096, v229
MA 136,v,144,v,100
buffer_load_dwordx4 v176, s[8:11], s20 offen offset:0 lds
MA 192,v,144,v,104
MA 200,v,144,v,108
TR 144,196,49152
TR 146,196,51200
MA 4,v,148,v,80
ds_read_b128 v[116:119], v193 offset:2048
MA 12,v,148,v,84
buffer_load_dwordx2 v[20:21], v254, s[84:87], 0 offen
MA 68,v,148,v,88
buffer_load_dwordx4 v177, s[8:11], s20 offen offset:1024 lds
MA 76,v,148,v,92
MA 132,v,148,v,96
MA 140,v,148,v,100
ds_read_b128 v[120:123], v193 offset:4096
MA 196,v,148,v,104
v_add_u32 v255, 6144, v229
MA 204,v,148,v,108
TR 148,197,49152
TR 150,197,51200
MA 16,v,152,v,80
buffer_load_dwordx4 v178, s[8:11], s20 offen offset:2048 lds
MA 24,v,152,v,84
MA 80,v,152,v,88
MA 88,v,152,v,92
buffer_load_dwordx2 v[22:23], v255, s[84:87], 0 offen
MA 144,v,152,v,96
ds_read_b128 v[124:127], v193 offset:6144
buffer_load_dwordx4 v179, s[8:11], s20 offen offset:3072 lds
MA 152,v,152,v,100
MA 208,v,152,v,104
MA 216,v,152,v,108
TR 152,198,49152
TR 154,198,51200
MA 20,v,156,v,80
buffer_load_dwordx2 v[38:39], v255, s[88:91], 0 offen
MA 28,v,156,v,84
s_add_u32 m0, s22, 69632
MA 84,v,156,v,88
ds_read_b128 v[128:131], v193 offset:8192
MA 92,v,156,v,92
MA 148,v,156,v,96
v_add_u32 v252, 8192, v229
MA 156,v,156,v,100
MA 212,v,156,v,104
MA 220,v,156,v,108
TR 156,199,49152
TR 158,199,51200
MA 32,v,160,v,80
ds_read_b128 v[132:135], v193 offset:10240
buffer_load_dwordx4 v180, s[8:11], s20 offen offset:0 lds
MA 40,v,160,v,84
buffer_load_dwordx2 v[24:25], v252, s[84:87], 0 offen
MA 96,v,160,v,88
MA 104,v,160,v,92
MA 160,v,160,v,96
buffer_load_dwordx4 v181, s[8:11], s20 offen offset:1024 lds
MA 168,v,160,v,100
MA 224,v,160,v,104
buffer_load_dwordx2 v[40:41], v252, s[88:91], 0 offen
MA 232,v,160,v,108
TR 160,200,49152
TR 162,200,51200
MA 36,v,164,v,80
ds_read_b128 v[136:139], v193 offset:12288
MA 44,v,164,v,84
buffer_load_dwordx4 v182, s[8:11], s20 offen offset:2048 lds
MA 100,v,164,v,88
v_add_u32 v253, 10240, v229
MA 108,v,164,v,92
MA 164,v,164,v,96
MA 172,v,164,v,100
ds_read_b128 v[140:143], v193 offset:14336
MA 228,v,164,v,104
buffer_load_dwordx4 v183, s[8:11], s20 offen offset:3072 lds
MA 236,v,164,v,108
TR 164,201,49152
TR 166,201,51200
MA 48,v,168,v,80
buffer_load_dwordx2 v[26:27], v253, s[84:87], 0 offen
MA 56,v,168,v,84
MA 112,v,168,v,88
MA 120,v,168,v,92
s_add_u32 s20, s20, 128
MA 176,v,168,v,96
buffer_load_dwordx2 v[42:43], v253, s[88:91], 0 offen
MA 184,v,168,v,100
MA 240,v,168,v,104
MA 248,v,168,v,108
TR 168,202,49152
TR 170,202,51200
s_waitcnt lgkmcnt(15)
MA 52,v,172,v,80
s_and_b32 s20, s20, 1023
MA 60,v,172,v,84
v_add_u32 v254, 12288, v229
MA 116,v,172,v,88
MA 124,v,172,v,92
MA 180,v,172,v,96
MA 188,v,172,v,100
MA 244,v,172,v,104
MA 252,v,172,v,108
TR 172,203,49152
TR 174,203,51200
s_waitcnt lgkmcnt(2)
MA 0,v,144,v,112
MA 8,v,144,v,116
MA 64,v,144,v,120
MA 72,v,144,v,124
MA 128,v,144,v,128
MA 136,v,144,v,132
MA 192,v,144,v,136
MA 200,v,144,v,140
MA 4,v,148,v,112
MA 12,v,148,v,116
s_waitcnt vmcnt(16) lgkmcnt(0)
s_barrier
MA 68,v,148,v,120
TR 144,196,0
TR 146,196,2048
MA 76,v,148,v,124
ds_read_b128 v[80:83], v192 offset:32768
s_add_u32 m0, s23, 32768
MA 132,v,148,v,128
v_xor_b32 v69, 8, v68
v_lshl_add_u32 v69, v69, 4, v66
MA 140,v,148,v,132
v_add_u32 v215, 95232, v69
v_and_b32 v66, 15, v1
MA 196,v,148,v,136
buffer_load_dwordx4 v184, s[12:15], s21 offen offset:0 lds
v_lshrrev_b32 v68, 1, v66
MA 204,v,148,v,140
TR 148,197,0
TR 150,197,2048
MA 16,v,152,v,112
ds_read_b128 v[84:87], v192 offset:34816
v_xor_b32 v68, v68, v67
MA 24,v,152,v,116
v_lshlrev_b32 v68, 4, v68
v_lshl_add_u32 v68, v66, 7, v68
MA 80,v,152,v,120
buffer_load_dwordx4 v185, s[12:15], s21 offen offset:1024 lds
v_add_u32 v224, s67, v68
MA 88,v,152,v,124
v_xor_b32 v225, 64, v224
v_add_u32 v226, 0x10000, v224
MA 144,v,152,v,128
v_add_u32 v227, 0x10000, v225
v_bfe_u32 v66, v1, 2, 2
MA 152,v,152,v,132
ds_read_b128 v[88:91], v192 offset:36864
v_and_b32 v68, 1, v67
MA 208,v,152,v,136
v_lshl_or_b32 v68, v68, 2, v66
MA 216,v,152,v,140
TR 152,198,0
TR 154,198,2048
MA 20,v,156,v,112
buffer_load_dwordx4 v186, s[12:15], s21 offen offset:2048 lds
v_lshl_add_u32 v66, v67, 3, v66
MA 28,v,156,v,116
v_lshlrev_b32 v66, 8, v66
v_and_b32 v69, 3, v1
MA 84,v,156,v,120
ds_read_b128 v[92:95], v192 offset:38912
v_lshl_add_u32 v66, v69, 3, v66
MA 92,v,156,v,124
buffer_load_dwordx4 v187, s[12:15], s21 offen offset:3072 lds
v_add_u32 v66, 98304, v66
MA 148,v,156,v,128
v_xor_b32 v69, 0, v68
v_lshl_add_u32 v216, v69, 5, v66
MA 156,v,156,v,132
v_xor_b32 v69, 1, v68
MA 212,v,156,v,136
v_lshl_add_u32 v217, v69, 5, v66
MA 220,v,156,v,140
TR 156,199,0
TR 158,199,2048
MA 32,v,160,v,112
ds_read_b128 v[96:99], v192 offset:40960
s_add_u32 m0, s23, 36864
MA 40,v,160,v,116
v_xor_b32 v69, 2, v68
v_lshl_add_u32 v218, v69, 5, v66
MA 96,v,160,v,120
v_xor_b32 v69, 3, v68
v_lshl_add_u32 v219, v69, 5, v66
MA 104,v,160,v,124
v_xor_b32 v69, 4, v68
v_lshl_add_u32 v220, v69, 5, v66
MA 160,v,160,v,128
ds_read_b128 v[100:103], v192 offset:43008
buffer_load_dwordx4 v188, s[12:15], s21 offen offset:0 lds
MA 168,v,160,v,132
v_xor_b32 v69, 5, v68
v_lshl_add_u32 v221, v69, 5, v66
MA 224,v,160,v,136
v_xor_b32 v69, 6, v68
MA 232,v,160,v,140
TR 160,200,0
TR 162,200,2048
MA 36,v,164,v,112
buffer_load_dwordx4 v189, s[12:15], s21 offen offset:1024 lds
v_lshl_add_u32 v222, v69, 5, v66
MA 44,v,164,v,116
ds_read_b128 v[104:107], v192 offset:45056
v_xor_b32 v69, 7, v68
MA 100,v,164,v,120
v_lshl_add_u32 v223, v69, 5, v66
s_mov_b32 s44, s32
MA 108,v,164,v,124
s_mov_b32 s45, s33
s_mov_b32 s46, 4194304
MA 164,v,164,v,128
buffer_load_dwordx4 v190, s[12:15], s21 offen offset:2048 lds
s_mov_b32 s47, 0x20000
MA 172,v,164,v,132
s_add_u32 s48, s34, s82
s_addc_u32 s49, s35, 0
MA 228,v,164,v,136
ds_read_b128 v[108:111], v192 offset:47104
MA 236,v,164,v,140
TR 164,201,0
TR 166,201,2048
MA 48,v,168,v,112
s_sub_u32 s50, 8388608, s82
s_mov_b32 s51, 0x20000
MA 56,v,168,v,116
buffer_load_dwordx4 v191, s[12:15], s21 offen offset:3072 lds
MA 112,v,168,v,120
s_add_u32 s60, s40, 33554432
s_addc_u32 s61, s41, 0
MA 120,v,168,v,124
s_mov_b32 s62, 16777216
s_mov_b32 s63, 0x20000
MA 176,v,168,v,128
s_lshl_b32 s80, s69, 19
MA 184,v,168,v,132
s_add_u32 s21, s21, 524288
MA 240,v,168,v,136
s_add_u32 s52, s40, s80
s_addc_u32 s53, s41, 0
MA 248,v,168,v,140
TR 168,202,0
TR 170,202,2048
MA 52,v,172,v,112
s_lshl_b32 s54, s77, 14
s_mov_b32 s55, 0x20000
MA 60,v,172,v,116
s_and_b32 s21, s21, 4194303
s_add_u32 s80, s80, 16760832
MA 116,v,172,v,120
s_add_u32 s56, s40, s80
s_addc_u32 s57, s41, 0
MA 124,v,172,v,124
s_add_u32 s58, s54, 16384
MA 180,v,172,v,128
s_mov_b32 s59, 0x20000
MA 188,v,172,v,132
s_load_dwordx2 s[38:39], s[0:1], 112
MA 244,v,172,v,136
MA 252,v,172,v,140
TR 172,203,0
TR 174,203,2048
s_waitcnt lgkmcnt(2)
MA 0,v,144,v,80
s_add_u32 m0, s22, 0
buffer_load_dwordx2 v[28:29], v254, s[84:87], 0 offen
MA 8,v,144,v,84
ds_read_b128 v[112:115], v193 offset:32768
MA 64,v,144,v,88
MA 72,v,144,v,92
MA 128,v,144,v,96
buffer_load_dwordx2 v[44:45], v254, s[88:91], 0 offen
MA 136,v,144,v,100
buffer_load_dwordx4 v176, s[8:11], s20 offen offset:0 lds
MA 192,v,144,v,104
MA 200,v,144,v,108
TR 144,196,16384
TR 146,196,18432
MA 4,v,148,v,80
ds_read_b128 v[116:119], v193 offset:34816
v_add_u32 v255, 14336, v229
MA 12,v,148,v,84
MA 68,v,148,v,88
buffer_load_dwordx4 v177, s[8:11], s20 offen offset:1024 lds
MA 76,v,148,v,92
MA 132,v,148,v,96
MA 140,v,148,v,100
ds_read_b128 v[120:123], v193 offset:36864
buffer_load_dwordx2 v[30:31], v255, s[84:87], 0 offen
MA 196,v,148,v,104
MA 204,v,148,v,108
TR 148,197,16384
TR 150,197,18432
MA 16,v,152,v,80
buffer_load_dwordx4 v178, s[8:11], s20 offen offset:2048 lds
MA 24,v,152,v,84
buffer_load_dwordx2 v[46:47], v255, s[88:91], 0 offen
MA 80,v,152,v,88
MA 88,v,152,v,92
MA 144,v,152,v,96
ds_read_b128 v[124:127], v193 offset:38912
buffer_load_dwordx4 v179, s[8:11], s20 offen offset:3072 lds
MA 152,v,152,v,100
MA 208,v,152,v,104
v_add_u32 v252, 16384, v229
MA 216,v,152,v,108
TR 152,198,16384
TR 154,198,18432
MA 20,v,156,v,80
MA 28,v,156,v,84
s_add_u32 m0, s22, 4096
MA 84,v,156,v,88
ds_read_b128 v[128:131], v193 offset:40960
buffer_load_dwordx2 v[32:33], v252, s[84:87], 0 offen
MA 92,v,156,v,92
MA 148,v,156,v,96
MA 156,v,156,v,100
MA 212,v,156,v,104
MA 220,v,156,v,108
TR 156,199,16384
TR 158,199,18432
MA 32,v,160,v,80
ds_read_b128 v[132:135], v193 offset:43008
buffer_load_dwordx4 v180, s[8:11], s20 offen offset:0 lds
MA 40,v,160,v,84
buffer_load_dwordx2 v[48:49], v252, s[88:91], 0 offen
MA 96,v,160,v,88
MA 104,v,160,v,92
v_add_u32 v253, 18432, v229
MA 160,v,160,v,96
buffer_load_dwordx4 v181, s[8:11], s20 offen offset:1024 lds
MA 168,v,160,v,100
MA 224,v,160,v,104
MA 232,v,160,v,108
TR 160,200,16384
TR 162,200,18432
MA 36,v,164,v,80
ds_read_b128 v[136:139], v193 offset:45056
buffer_load_dwordx2 v[34:35], v253, s[84:87], 0 offen
MA 44,v,164,v,84
buffer_load_dwordx4 v182, s[8:11], s20 offen offset:2048 lds
MA 100,v,164,v,88
MA 108,v,164,v,92
MA 164,v,164,v,96
buffer_load_dwordx2 v[50:51], v253, s[88:91], 0 offen
MA 172,v,164,v,100
ds_read_b128 v[140:143], v193 offset:47104
MA 228,v,164,v,104
buffer_load_dwordx4 v183, s[8:11], s20 offen offset:3072 lds
MA 236,v,164,v,108
TR 164,201,16384
TR 166,201,18432
MA 48,v,168,v,80
v_add_u32 v254, 20480, v229
MA 56,v,168,v,84
MA 112,v,168,v,88
MA 120,v,168,v,92
s_add_u32 s20, s20, 128
MA 176,v,168,v,96
MA 184,v,168,v,100
buffer_load_dwordx2 v[36:37], v254, s[84:87], 0 offen
MA 240,v,168,v,104
MA 248,v,168,v,108
TR 168,202,16384
TR 170,202,18432
s_waitcnt lgkmcnt(15)
MA 52,v,172,v,80
s_and_b32 s20, s20, 1023
MA 60,v,172,v,84
buffer_load_dwordx2 v[52:53], v254, s[88:91], 0 offen
MA 116,v,172,v,88
MA 124,v,172,v,92
MA 180,v,172,v,96
MA 188,v,172,v,100
MA 244,v,172,v,104
MA 252,v,172,v,108
TR 172,203,16384
TR 174,203,18432
s_waitcnt lgkmcnt(2)
MA 0,v,144,v,112
MA 8,v,144,v,116
MA 64,v,144,v,120
MA 72,v,144,v,124
MA 128,v,144,v,128
MA 136,v,144,v,132
MA 192,v,144,v,136
MA 200,v,144,v,140
MA 4,v,148,v,112
MA 12,v,148,v,116
s_waitcnt vmcnt(18) lgkmcnt(0)
s_barrier
MA 68,v,148,v,120
TR 144,196,32768
TR 146,196,34816
MA 76,v,148,v,124
ds_read_b128 v[80:83], v194 offset:0
s_add_u32 m0, s23, 0
MA 132,v,148,v,128
MA 140,v,148,v,132
MA 196,v,148,v,136
buffer_load_dwordx4 v184, s[12:15], s21 offen offset:0 lds
MA 204,v,148,v,140
TR 148,197,32768
TR 150,197,34816
MA 16,v,152,v,112
ds_read_b128 v[84:87], v194 offset:2048
MA 24,v,152,v,116
MA 80,v,152,v,120
buffer_load_dwordx4 v185, s[12:15], s21 offen offset:1024 lds
MA 88,v,152,v,124
MA 144,v,152,v,128
MA 152,v,152,v,132
ds_read_b128 v[88:91], v194 offset:4096
MA 208,v,152,v,136
MA 216,v,152,v,140
TR 152,198,32768
TR 154,198,34816
MA 20,v,156,v,112
buffer_load_dwordx4 v186, s[12:15], s21 offen offset:2048 lds
MA 28,v,156,v,116
MA 84,v,156,v,120
ds_read_b128 v[92:95], v194 offset:6144
MA 92,v,156,v,124
buffer_load_dwordx4 v187, s[12:15], s21 offen offset:3072 lds
MA 148,v,156,v,128
MA 156,v,156,v,132
MA 212,v,156,v,136
MA 220,v,156,v,140
TR 156,199,32768
TR 158,199,34816
MA 32,v,160,v,112
ds_read_b128 v[96:99], v194 offset:8192
s_add_u32 m0, s23, 4096
MA 40,v,160,v,116
MA 96,v,160,v,120
MA 104,v,160,v,124
MA 160,v,160,v,128
ds_read_b128 v[100:103], v194 offset:10240
buffer_load_dwordx4 v188, s[12:15], s21 offen offset:0 lds
MA 168,v,160,v,132
MA 224,v,160,v,136
MA 232,v,160,v,140
TR 160,200,32768
TR 162,200,34816
MA 36,v,164,v,112
buffer_load_dwordx4 v189, s[12:15], s21 offen offset:1024 lds
MA 44,v,164,v,116
ds_read_b128 v[104:107], v194 offset:12288
MA 100,v,164,v,120
MA 108,v,164,v,124
MA 164,v,164,v,128
buffer_load_dwordx4 v190, s[12:15], s21 offen offset:2048 lds
MA 172,v,164,v,132
MA 228,v,164,v,136
ds_read_b128 v[108:111], v194 offset:14336
MA 236,v,164,v,140
TR 164,201,32768
TR 166,201,34816
MA 48,v,168,v,112
MA 56,v,168,v,116
buffer_load_dwordx4 v191, s[12:15], s21 offen offset:3072 lds
MA 112,v,168,v,120
MA 120,v,168,v,124
MA 176,v,168,v,128
MA 184,v,168,v,132
s_add_u32 s21, s21, 524288
MA 240,v,168,v,136
MA 248,v,168,v,140
TR 168,202,32768
TR 170,202,34816
MA 52,v,172,v,112
MA 60,v,172,v,116
s_and_b32 s21, s21, 4194303
MA 116,v,172,v,120
MA 124,v,172,v,124
MA 180,v,172,v,128
MA 188,v,172,v,132
MA 244,v,172,v,136
MA 252,v,172,v,140
TR 172,203,32768
TR 174,203,34816
s_waitcnt lgkmcnt(2)
MA 0,v,144,v,80
s_add_u32 m0, s22, 32768
MA 8,v,144,v,84
ds_read_b128 v[112:115], v195 offset:0
MA 64,v,144,v,88
MA 72,v,144,v,92
MA 128,v,144,v,96
MA 136,v,144,v,100
buffer_load_dwordx4 v176, s[8:11], s20 offen offset:0 lds
MA 192,v,144,v,104
MA 200,v,144,v,108
TR 144,196,49152
TR 146,196,51200
MA 4,v,148,v,80
ds_read_b128 v[116:119], v195 offset:2048
MA 12,v,148,v,84
MA 68,v,148,v,88
buffer_load_dwordx4 v177, s[8:11], s20 offen offset:1024 lds
MA 76,v,148,v,92
MA 132,v,148,v,96
MA 140,v,148,v,100
ds_read_b128 v[120:123], v195 offset:4096
MA 196,v,148,v,104
MA 204,v,148,v,108
TR 148,197,49152
TR 150,197,51200
MA 16,v,152,v,80
buffer_load_dwordx4 v178, s[8:11], s20 offen offset:2048 lds
MA 24,v,152,v,84
MA 80,v,152,v,88
MA 88,v,152,v,92
MA 144,v,152,v,96
ds_read_b128 v[124:127], v195 offset:6144
buffer_load_dwordx4 v179, s[8:11], s20 offen offset:3072 lds
MA 152,v,152,v,100
MA 208,v,152,v,104
MA 216,v,152,v,108
TR 152,198,49152
TR 154,198,51200
MA 20,v,156,v,80
MA 28,v,156,v,84
s_add_u32 m0, s22, 36864
MA 84,v,156,v,88
ds_read_b128 v[128:131], v195 offset:8192
MA 92,v,156,v,92
MA 148,v,156,v,96
MA 156,v,156,v,100
MA 212,v,156,v,104
MA 220,v,156,v,108
TR 156,199,49152
TR 158,199,51200
MA 32,v,160,v,80
ds_read_b128 v[132:135], v195 offset:10240
buffer_load_dwordx4 v180, s[8:11], s20 offen offset:0 lds
MA 40,v,160,v,84
MA 96,v,160,v,88
MA 104,v,160,v,92
MA 160,v,160,v,96
buffer_load_dwordx4 v181, s[8:11], s20 offen offset:1024 lds
MA 168,v,160,v,100
MA 224,v,160,v,104
MA 232,v,160,v,108
TR 160,200,49152
TR 162,200,51200
MA 36,v,164,v,80
ds_read_b128 v[136:139], v195 offset:12288
MA 44,v,164,v,84
buffer_load_dwordx4 v182, s[8:11], s20 offen offset:2048 lds
MA 100,v,164,v,88
MA 108,v,164,v,92
MA 164,v,164,v,96
MA 172,v,164,v,100
ds_read_b128 v[140:143], v195 offset:14336
MA 228,v,164,v,104
buffer_load_dwordx4 v183, s[8:11], s20 offen offset:3072 lds
MA 236,v,164,v,108
TR 164,201,49152
TR 166,201,51200
MA 48,v,168,v,80
MA 56,v,168,v,84
MA 112,v,168,v,88
MA 120,v,168,v,92
s_add_u32 s20, s20, 128
MA 176,v,168,v,96
MA 184,v,168,v,100
MA 240,v,168,v,104
MA 248,v,168,v,108
TR 168,202,49152
TR 170,202,51200
s_waitcnt lgkmcnt(15)
MA 52,v,172,v,80
s_and_b32 s20, s20, 1023
MA 60,v,172,v,84
MA 116,v,172,v,88
MA 124,v,172,v,92
MA 180,v,172,v,96
MA 188,v,172,v,100
MA 244,v,172,v,104
MA 252,v,172,v,108
TR 172,203,49152
TR 174,203,51200
s_waitcnt lgkmcnt(2)
MA 0,v,144,v,112
MA 8,v,144,v,116
MA 64,v,144,v,120
MA 72,v,144,v,124
MA 128,v,144,v,128
MA 136,v,144,v,132
MA 192,v,144,v,136
MA 200,v,144,v,140
MA 4,v,148,v,112
MA 12,v,148,v,116
s_waitcnt vmcnt(8) lgkmcnt(0)
s_barrier
MA 68,v,148,v,120
TR 144,196,0
TR 146,196,2048
MA 76,v,148,v,124
ds_read_b128 v[80:83], v192 offset:0
s_add_u32 m0, s23, 32768
MA 132,v,148,v,128
buffer_load_dword v79, v78, s[4:7], 0 offen
MA 140,v,148,v,132
s_add_u32 s84, s40, 50331648
s_addc_u32 s85, s41, 0
MA 196,v,148,v,136
buffer_load_dwordx4 v184, s[12:15], s21 offen offset:0 lds
s_mov_b32 s86, 4194304
MA 204,v,148,v,140
TR 148,197,0
TR 150,197,2048
MA 16,v,152,v,112
ds_read_b128 v[84:87], v192 offset:2048
s_mov_b32 s87, 0x20000
MA 24,v,152,v,116
s_add_u32 s88, s40, 58720256
s_addc_u32 s89, s41, 0
MA 80,v,152,v,120
buffer_load_dwordx4 v185, s[12:15], s21 offen offset:1024 lds
s_mov_b32 s90, 8192
MA 88,v,152,v,124
s_mov_b32 s91, 0x20000
v_mov_b32 v252, 0
MA 144,v,152,v,128
v_mov_b32 v253, 0
v_dot2_f32_bf16 v252, v230, v2, v252
MA 152,v,152,v,132
ds_read_b128 v[88:91], v192 offset:4096
v_dot2_f32_bf16 v253, v231, v3, v253
MA 208,v,152,v,136
v_dot2_f32_bf16 v252, v232, v4, v252
v_dot2_f32_bf16 v253, v233, v5, v253
MA 216,v,152,v,140
TR 152,198,0
TR 154,198,2048
MA 20,v,156,v,112
buffer_load_dwordx4 v186, s[12:15], s21 offen offset:2048 lds
v_dot2_f32_bf16 v252, v234, v6, v252
MA 28,v,156,v,116
v_dot2_f32_bf16 v253, v235, v7, v253
v_dot2_f32_bf16 v252, v236, v8, v252
MA 84,v,156,v,120
ds_read_b128 v[92:95], v192 offset:6144
v_dot2_f32_bf16 v253, v237, v9, v253
MA 92,v,156,v,124
buffer_load_dwordx4 v187, s[12:15], s21 offen offset:3072 lds
v_dot2_f32_bf16 v252, v238, v12, v252
MA 148,v,156,v,128
v_dot2_f32_bf16 v253, v239, v13, v253
v_dot2_f32_bf16 v252, v240, v14, v252
MA 156,v,156,v,132
v_dot2_f32_bf16 v253, v241, v15, v253
v_dot2_f32_bf16 v252, v242, v246, v252
MA 212,v,156,v,136
v_dot2_f32_bf16 v253, v243, v247, v253
v_dot2_f32_bf16 v252, v244, v248, v252
MA 220,v,156,v,140
TR 156,199,0
TR 158,199,2048
MA 32,v,160,v,112
ds_read_b128 v[96:99], v192 offset:8192
s_add_u32 m0, s23, 36864
MA 40,v,160,v,116
v_dot2_f32_bf16 v253, v245, v249, v253
MA 96,v,160,v,120
s_nop 2
v_add_f32 v252, v252, v253
MA 104,v,160,v,124
s_nop 0
v_add_f32_dpp v252, v252, v252 row_ror:8 row_mask:0xf bank_mask:0xf
s_nop 1
v_add_f32_dpp v252, v252, v252 row_ror:4 row_mask:0xf bank_mask:0xf
MA 160,v,160,v,128
ds_read_b128 v[100:103], v192 offset:10240
buffer_load_dwordx4 v188, s[12:15], s21 offen offset:0 lds
MA 168,v,160,v,132
v_add_f32_dpp v252, v252, v252 row_ror:2 row_mask:0xf bank_mask:0xf
s_nop 1
v_add_f32_dpp v252, v252, v252 row_ror:1 row_mask:0xf bank_mask:0xf
MA 224,v,160,v,136
v_mov_b32 v253, v252
s_nop 1
v_permlane16_swap_b32 v252, v253
MA 232,v,160,v,140
TR 160,200,0
TR 162,200,2048
MA 36,v,164,v,112
buffer_load_dwordx4 v189, s[12:15], s21 offen offset:1024 lds
v_add_f32 v252, v252, v253
MA 44,v,164,v,116
ds_read_b128 v[104:107], v192 offset:12288
v_mul_f32 v252, 0xbfb8aa3b, v252
MA 100,v,164,v,120
v_exp_f32 v252, v252
MA 108,v,164,v,124
v_add_f32 v252, 1.0, v252
MA 164,v,164,v,128
buffer_load_dwordx4 v190, s[12:15], s21 offen offset:2048 lds
MA 172,v,164,v,132
v_rcp_f32 v252, v252
MA 228,v,164,v,136
ds_read_b128 v[108:111], v192 offset:14336
MA 236,v,164,v,140
TR 164,201,0
TR 166,201,2048
MA 48,v,168,v,112
s_nop 0
buffer_store_dword v252, v11, s[88:91], 0 offen sc1
MA 56,v,168,v,116
buffer_load_dwordx4 v191, s[12:15], s21 offen offset:3072 lds
v_lshlrev_b32 v2, 16, v54
MA 112,v,168,v,120
v_and_b32 v3, 0xffff0000, v54
v_lshlrev_b32 v4, 16, v55
MA 120,v,168,v,124
v_and_b32 v5, 0xffff0000, v55
v_lshlrev_b32 v6, 16, v56
MA 176,v,168,v,128
v_and_b32 v7, 0xffff0000, v56
v_lshlrev_b32 v8, 16, v57
MA 184,v,168,v,132
s_add_u32 s21, s21, 524288
v_and_b32 v9, 0xffff0000, v57
MA 240,v,168,v,136
v_lshlrev_b32 v230, 16, v16
v_and_b32 v231, 0xffff0000, v16
MA 248,v,168,v,140
TR 168,202,0
TR 170,202,2048
MA 52,v,172,v,112
v_lshlrev_b32 v232, 16, v18
v_and_b32 v233, 0xffff0000, v18
MA 60,v,172,v,116
s_and_b32 s21, s21, 4194303
v_lshlrev_b32 v234, 16, v20
MA 116,v,172,v,120
v_and_b32 v235, 0xffff0000, v20
v_lshlrev_b32 v236, 16, v22
MA 124,v,172,v,124
v_and_b32 v237, 0xffff0000, v22
v_lshlrev_b32 v238, 16, v24
MA 180,v,172,v,128
v_and_b32 v239, 0xffff0000, v24
v_lshlrev_b32 v240, 16, v26
MA 188,v,172,v,132
v_and_b32 v241, 0xffff0000, v26
v_lshlrev_b32 v242, 16, v28
MA 244,v,172,v,136
v_and_b32 v243, 0xffff0000, v28
v_lshlrev_b32 v244, 16, v30
MA 252,v,172,v,140
TR 172,203,0
TR 174,203,2048
v_and_b32 v245, 0xffff0000, v30
v_lshlrev_b32 v246, 16, v32
v_and_b32 v247, 0xffff0000, v32
v_lshlrev_b32 v248, 16, v34
v_and_b32 v249, 0xffff0000, v34
v_lshlrev_b32 v250, 16, v36
v_and_b32 v251, 0xffff0000, v36
v_lshlrev_b32 v254, 16, v38
v_and_b32 v255, 0xffff0000, v38
v_mul_f32 v62, v236, v2
v_mul_f32 v70, v237, v6
v_fmac_f32 v62, v234, v3
v_fmac_f32 v70, v235, v7
v_fmac_f32 v62, v232, v4
v_fmac_f32 v70, v233, v8
v_fmac_f32 v62, v230, v5
v_fmac_f32 v70, v231, v9
v_mul_f32 v62, v62, v254
s_waitcnt lgkmcnt(2)
MA 0,v,144,v,80
s_add_u32 s75, s64, s74
v_mul_f32 v70, v70, v255
MA 8,v,144,v,84
ds_read_b128 v[112:115], v193 offset:0
v_lshlrev_b32 v254, 16, v40
MA 64,v,144,v,88
v_and_b32 v255, 0xffff0000, v40
v_mul_f32 v63, v238, v2
MA 72,v,144,v,92
v_mul_f32 v71, v239, v6
v_fmac_f32 v63, v236, v3
MA 128,v,144,v,96
s_add_u32 m0, s67, 65536
v_fmac_f32 v71, v237, v7
MA 136,v,144,v,100
v_fmac_f32 v63, v234, v4
MA 192,v,144,v,104
v_fmac_f32 v71, v235, v8
MA 200,v,144,v,108
TR 144,196,16384
TR 146,196,18432
MA 4,v,148,v,80
ds_read_b128 v[116:119], v193 offset:2048
buffer_load_dwordx4 v208, s[44:47], s75 offen offset:0 lds
MA 12,v,148,v,84
v_fmac_f32 v63, v232, v5
v_fmac_f32 v71, v233, v9
MA 68,v,148,v,88
v_mul_f32 v63, v63, v254
v_mul_f32 v71, v71, v255
MA 76,v,148,v,92
v_lshlrev_b32 v254, 16, v42
v_and_b32 v255, 0xffff0000, v42
MA 132,v,148,v,96
v_mul_f32 v64, v240, v2
v_mul_f32 v72, v241, v6
MA 140,v,148,v,100
ds_read_b128 v[120:123], v193 offset:4096
buffer_load_dwordx4 v209, s[44:47], s75 offen offset:1024 lds
MA 196,v,148,v,104
v_fmac_f32 v64, v238, v3
v_fmac_f32 v72, v239, v7
MA 204,v,148,v,108
TR 148,197,16384
TR 150,197,18432
MA 16,v,152,v,80
v_fmac_f32 v64, v236, v4
v_fmac_f32 v72, v237, v8
MA 24,v,152,v,84
buffer_load_dwordx4 v210, s[44:47], s75 offen offset:2048 lds
v_fmac_f32 v64, v234, v5
MA 80,v,152,v,88
v_fmac_f32 v72, v235, v9
v_mul_f32 v64, v64, v254
MA 88,v,152,v,92
v_mul_f32 v72, v72, v255
v_lshlrev_b32 v254, 16, v44
MA 144,v,152,v,96
ds_read_b128 v[124:127], v193 offset:6144
v_and_b32 v255, 0xffff0000, v44
MA 152,v,152,v,100
v_mul_f32 v65, v242, v2
MA 208,v,152,v,104
buffer_load_dwordx4 v211, s[44:47], s75 offen offset:3072 lds
v_mul_f32 v73, v243, v6
MA 216,v,152,v,108
TR 152,198,16384
TR 154,198,18432
MA 20,v,156,v,80
v_fmac_f32 v65, v240, v3
v_fmac_f32 v73, v241, v7
MA 28,v,156,v,84
v_fmac_f32 v65, v238, v4
v_fmac_f32 v73, v239, v8
MA 84,v,156,v,88
ds_read_b128 v[128:131], v193 offset:8192
s_add_u32 s75, s65, s74
MA 92,v,156,v,92
v_fmac_f32 v65, v236, v5
v_fmac_f32 v73, v237, v9
MA 148,v,156,v,96
v_mul_f32 v65, v65, v254
v_mul_f32 v73, v73, v255
MA 156,v,156,v,100
v_lshlrev_b32 v254, 16, v46
MA 212,v,156,v,104
v_and_b32 v255, 0xffff0000, v46
MA 220,v,156,v,108
TR 156,199,16384
TR 158,199,18432
MA 32,v,160,v,80
ds_read_b128 v[132:135], v193 offset:10240
s_add_u32 m0, s67, 69632
MA 40,v,160,v,84
v_mul_f32 v66, v244, v2
v_mul_f32 v74, v245, v6
MA 96,v,160,v,88
v_fmac_f32 v66, v242, v3
v_fmac_f32 v74, v243, v7
MA 104,v,160,v,92
buffer_load_dwordx4 v208, s[44:47], s75 offen offset:0 lds
v_fmac_f32 v66, v240, v4
MA 160,v,160,v,96
v_fmac_f32 v74, v241, v8
v_fmac_f32 v66, v238, v5
MA 168,v,160,v,100
v_fmac_f32 v74, v239, v9
v_mul_f32 v66, v66, v254
MA 224,v,160,v,104
v_mul_f32 v74, v74, v255
v_lshlrev_b32 v254, 16, v48
MA 232,v,160,v,108
TR 160,200,16384
TR 162,200,18432
MA 36,v,164,v,80
ds_read_b128 v[136:139], v193 offset:12288
buffer_load_dwordx4 v209, s[44:47], s75 offen offset:1024 lds
MA 44,v,164,v,84
v_and_b32 v255, 0xffff0000, v48
v_mul_f32 v67, v246, v2
MA 100,v,164,v,88
v_mul_f32 v75, v247, v6
v_fmac_f32 v67, v244, v3
MA 108,v,164,v,92
v_fmac_f32 v75, v245, v7
v_fmac_f32 v67, v242, v4
MA 164,v,164,v,96
buffer_load_dwordx4 v210, s[44:47], s75 offen offset:2048 lds
v_fmac_f32 v75, v243, v8
MA 172,v,164,v,100
ds_read_b128 v[140:143], v193 offset:14336
v_fmac_f32 v67, v240, v5
MA 228,v,164,v,104
v_fmac_f32 v75, v241, v9
v_mul_f32 v67, v67, v254
MA 236,v,164,v,108
TR 164,201,16384
TR 166,201,18432
MA 48,v,168,v,80
buffer_load_dwordx4 v211, s[44:47], s75 offen offset:3072 lds
v_mul_f32 v75, v75, v255
MA 56,v,168,v,84
v_lshlrev_b32 v254, 16, v50
v_and_b32 v255, 0xffff0000, v50
MA 112,v,168,v,88
v_mul_f32 v68, v248, v2
v_mul_f32 v76, v249, v6
MA 120,v,168,v,92
v_fmac_f32 v68, v246, v3
MA 176,v,168,v,96
v_fmac_f32 v76, v247, v7
MA 184,v,168,v,100
s_add_u32 s74, s74, 128
v_fmac_f32 v68, v244, v4
MA 240,v,168,v,104
v_fmac_f32 v76, v245, v8
v_fmac_f32 v68, v242, v5
MA 248,v,168,v,108
TR 168,202,16384
TR 170,202,18432
s_waitcnt lgkmcnt(15)
MA 52,v,172,v,80
v_fmac_f32 v76, v243, v9
v_mul_f32 v68, v68, v254
MA 60,v,172,v,84
s_and_b32 s74, s74, 2047
v_mul_f32 v76, v76, v255
MA 116,v,172,v,88
v_lshlrev_b32 v254, 16, v52
v_and_b32 v255, 0xffff0000, v52
MA 124,v,172,v,92
v_mul_f32 v69, v250, v2
MA 180,v,172,v,96
v_mul_f32 v77, v251, v6
MA 188,v,172,v,100
v_fmac_f32 v69, v248, v3
MA 244,v,172,v,104
MA 252,v,172,v,108
TR 172,203,16384
TR 174,203,18432
s_waitcnt lgkmcnt(2)
MA 0,v,144,v,112
MA 8,v,144,v,116
MA 64,v,144,v,120
MA 72,v,144,v,124
MA 128,v,144,v,128
MA 136,v,144,v,132
MA 192,v,144,v,136
MA 200,v,144,v,140
MA 4,v,148,v,112
MA 12,v,148,v,116
s_waitcnt vmcnt(8) lgkmcnt(0)
s_barrier
MA 68,v,148,v,120
TR 144,196,32768
TR 146,196,34816
MA 76,v,148,v,124
ds_read_b128 v[80:83], v192 offset:32768
s_add_u32 m0, s68, 98304
MA 132,v,148,v,128
v_fmac_f32 v77, v249, v7
v_fmac_f32 v69, v246, v4
MA 140,v,148,v,132
buffer_load_dwordx4 v212, s[48:51], s66 offen offset:0 lds
v_fmac_f32 v77, v247, v8
MA 196,v,148,v,136
v_fmac_f32 v69, v244, v5
v_fmac_f32 v77, v245, v9
MA 204,v,148,v,140
TR 148,197,32768
TR 150,197,34816
MA 16,v,152,v,112
ds_read_b128 v[84:87], v192 offset:34816
v_mul_f32 v69, v69, v254
MA 24,v,152,v,116
buffer_load_dwordx4 v213, s[48:51], s66 offen offset:1024 lds
v_mul_f32 v77, v77, v255
MA 80,v,152,v,120
v_cvt_pk_bf16_f32 v12, v69, v68
v_cvt_pk_bf16_f32 v13, v67, v66
MA 88,v,152,v,124
v_cvt_pk_bf16_f32 v14, v65, v64
v_cvt_pk_bf16_f32 v15, v63, v62
MA 144,v,152,v,128
s_mov_b32 s36, 0
buffer_store_dwordx4 v[12:15], v10, s[84:87], s36 offen sc1
MA 152,v,152,v,132
ds_read_b128 v[88:91], v192 offset:36864
buffer_load_dwordx4 v214, s[48:51], s66 offen offset:2048 lds
MA 208,v,152,v,136
v_cvt_pk_bf16_f32 v54, v77, v76
v_cvt_pk_bf16_f32 v55, v75, v74
MA 216,v,152,v,140
TR 152,198,32768
TR 154,198,34816
MA 20,v,156,v,112
buffer_load_dwordx4 v215, s[48:51], s66 offen offset:3072 lds
v_cvt_pk_bf16_f32 v56, v73, v72
MA 28,v,156,v,116
v_cvt_pk_bf16_f32 v57, v71, v70
s_mov_b32 s36, 4096
MA 84,v,156,v,120
ds_read_b128 v[92:95], v192 offset:38912
buffer_store_dwordx4 v[54:57], v10, s[84:87], s36 offen sc1
MA 92,v,156,v,124
v_lshlrev_b32 v2, 16, v58
v_and_b32 v3, 0xffff0000, v58
MA 148,v,156,v,128
s_add_u32 s66, s66, 524288
v_lshlrev_b32 v4, 16, v59
MA 156,v,156,v,132
v_and_b32 v5, 0xffff0000, v59
v_lshlrev_b32 v6, 16, v60
MA 212,v,156,v,136
v_and_b32 v7, 0xffff0000, v60
v_lshlrev_b32 v8, 16, v61
MA 220,v,156,v,140
TR 156,199,32768
TR 158,199,34816
MA 32,v,160,v,112
ds_read_b128 v[96:99], v192 offset:40960
s_and_b32 s66, s66, 8388607
MA 40,v,160,v,116
v_and_b32 v9, 0xffff0000, v61
v_lshlrev_b32 v230, 16, v17
MA 96,v,160,v,120
v_and_b32 v231, 0xffff0000, v17
v_lshlrev_b32 v232, 16, v19
MA 104,v,160,v,124
v_and_b32 v233, 0xffff0000, v19
v_lshlrev_b32 v234, 16, v21
MA 160,v,160,v,128
ds_read_b128 v[100:103], v192 offset:43008
s_add_u32 m0, s68, 114688
MA 168,v,160,v,132
v_and_b32 v235, 0xffff0000, v21
v_lshlrev_b32 v236, 16, v23
MA 224,v,160,v,136
v_and_b32 v237, 0xffff0000, v23
v_lshlrev_b32 v238, 16, v25
MA 232,v,160,v,140
TR 160,200,32768
TR 162,200,34816
MA 36,v,164,v,112
buffer_load_dwordx4 v212, s[48:51], s66 offen offset:0 lds
v_and_b32 v239, 0xffff0000, v25
MA 44,v,164,v,116
ds_read_b128 v[104:107], v192 offset:45056
v_lshlrev_b32 v240, 16, v27
MA 100,v,164,v,120
v_and_b32 v241, 0xffff0000, v27
v_lshlrev_b32 v242, 16, v29
MA 108,v,164,v,124
buffer_load_dwordx4 v213, s[48:51], s66 offen offset:1024 lds
v_and_b32 v243, 0xffff0000, v29
MA 164,v,164,v,128
v_lshlrev_b32 v244, 16, v31
v_and_b32 v245, 0xffff0000, v31
MA 172,v,164,v,132
v_lshlrev_b32 v246, 16, v33
v_and_b32 v247, 0xffff0000, v33
MA 228,v,164,v,136
ds_read_b128 v[108:111], v192 offset:47104
v_lshlrev_b32 v248, 16, v35
MA 236,v,164,v,140
TR 164,201,32768
TR 166,201,34816
MA 48,v,168,v,112
buffer_load_dwordx4 v214, s[48:51], s66 offen offset:2048 lds
v_and_b32 v249, 0xffff0000, v35
MA 56,v,168,v,116
v_lshlrev_b32 v250, 16, v37
v_and_b32 v251, 0xffff0000, v37
MA 112,v,168,v,120
buffer_load_dwordx4 v215, s[48:51], s66 offen offset:3072 lds
v_lshlrev_b32 v254, 16, v39
MA 120,v,168,v,124
v_and_b32 v255, 0xffff0000, v39
v_mul_f32 v62, v236, v2
MA 176,v,168,v,128
v_mul_f32 v70, v237, v6
v_fmac_f32 v62, v234, v3
MA 184,v,168,v,132
v_fmac_f32 v70, v235, v7
v_fmac_f32 v62, v232, v4
MA 240,v,168,v,136
s_add_u32 s66, s66, 524288
v_fmac_f32 v70, v233, v8
MA 248,v,168,v,140
TR 168,202,32768
TR 170,202,34816
MA 52,v,172,v,112
v_fmac_f32 v62, v230, v5
v_fmac_f32 v70, v231, v9
MA 60,v,172,v,116
v_mul_f32 v62, v62, v254
v_mul_f32 v70, v70, v255
MA 116,v,172,v,120
s_and_b32 s66, s66, 8388607
v_lshlrev_b32 v254, 16, v41
MA 124,v,172,v,124
v_and_b32 v255, 0xffff0000, v41
v_mul_f32 v63, v238, v2
MA 180,v,172,v,128
v_mul_f32 v71, v239, v6
v_fmac_f32 v63, v236, v3
MA 188,v,172,v,132
v_fmac_f32 v71, v237, v7
v_fmac_f32 v63, v234, v4
MA 244,v,172,v,136
v_fmac_f32 v71, v235, v8
v_fmac_f32 v63, v232, v5
MA 252,v,172,v,140
TR 172,203,32768
TR 174,203,34816
v_fmac_f32 v71, v233, v9
v_mul_f32 v63, v63, v254
v_mul_f32 v71, v71, v255
v_lshlrev_b32 v254, 16, v43
v_and_b32 v255, 0xffff0000, v43
v_mul_f32 v64, v240, v2
v_mul_f32 v72, v241, v6
v_fmac_f32 v64, v238, v3
s_waitcnt lgkmcnt(2)
MA 0,v,144,v,80
s_add_u32 s75, s64, s74
v_fmac_f32 v72, v239, v7
MA 8,v,144,v,84
ds_read_b128 v[112:115], v193 offset:32768
v_fmac_f32 v64, v236, v4
MA 64,v,144,v,88
v_fmac_f32 v72, v237, v8
v_fmac_f32 v64, v234, v5
MA 72,v,144,v,92
v_fmac_f32 v72, v235, v9
v_mul_f32 v64, v64, v254
MA 128,v,144,v,96
s_add_u32 m0, s67, 0
v_mul_f32 v72, v72, v255
MA 136,v,144,v,100
v_lshlrev_b32 v254, 16, v45
v_and_b32 v255, 0xffff0000, v45
MA 192,v,144,v,104
v_mul_f32 v65, v242, v2
MA 200,v,144,v,108
TR 144,196,49152
TR 146,196,51200
MA 4,v,148,v,80
ds_read_b128 v[116:119], v193 offset:34816
buffer_load_dwordx4 v208, s[44:47], s75 offen offset:0 lds
MA 12,v,148,v,84
v_mul_f32 v73, v243, v6
v_fmac_f32 v65, v240, v3
MA 68,v,148,v,88
v_fmac_f32 v73, v241, v7
v_fmac_f32 v65, v238, v4
MA 76,v,148,v,92
v_fmac_f32 v73, v239, v8
v_fmac_f32 v65, v236, v5
MA 132,v,148,v,96
v_fmac_f32 v73, v237, v9
v_mul_f32 v65, v65, v254
MA 140,v,148,v,100
ds_read_b128 v[120:123], v193 offset:36864
buffer_load_dwordx4 v209, s[44:47], s75 offen offset:1024 lds
MA 196,v,148,v,104
v_mul_f32 v73, v73, v255
v_lshlrev_b32 v254, 16, v47
MA 204,v,148,v,108
TR 148,197,49152
TR 150,197,51200
MA 16,v,152,v,80
v_and_b32 v255, 0xffff0000, v47
v_mul_f32 v66, v244, v2
MA 24,v,152,v,84
buffer_load_dwordx4 v210, s[44:47], s75 offen offset:2048 lds
v_mul_f32 v74, v245, v6
MA 80,v,152,v,88
v_fmac_f32 v66, v242, v3
v_fmac_f32 v74, v243, v7
MA 88,v,152,v,92
v_fmac_f32 v66, v240, v4
v_fmac_f32 v74, v241, v8
MA 144,v,152,v,96
ds_read_b128 v[124:127], v193 offset:38912
v_fmac_f32 v66, v238, v5
MA 152,v,152,v,100
v_fmac_f32 v74, v239, v9
v_mul_f32 v66, v66, v254
MA 208,v,152,v,104
buffer_load_dwordx4 v211, s[44:47], s75 offen offset:3072 lds
v_mul_f32 v74, v74, v255
MA 216,v,152,v,108
TR 152,198,49152
TR 154,198,51200
MA 20,v,156,v,80
v_lshlrev_b32 v254, 16, v49
v_and_b32 v255, 0xffff0000, v49
MA 28,v,156,v,84
v_mul_f32 v67, v246, v2
v_mul_f32 v75, v247, v6
MA 84,v,156,v,88
ds_read_b128 v[128:131], v193 offset:40960
s_add_u32 s75, s65, s74
MA 92,v,156,v,92
v_fmac_f32 v67, v244, v3
v_fmac_f32 v75, v245, v7
MA 148,v,156,v,96
v_fmac_f32 v67, v242, v4
v_fmac_f32 v75, v243, v8
MA 156,v,156,v,100
v_fmac_f32 v67, v240, v5
v_fmac_f32 v75, v241, v9
MA 212,v,156,v,104
v_mul_f32 v67, v67, v254
v_mul_f32 v75, v75, v255
MA 220,v,156,v,108
TR 156,199,49152
TR 158,199,51200
MA 32,v,160,v,80
ds_read_b128 v[132:135], v193 offset:43008
s_add_u32 m0, s67, 4096
MA 40,v,160,v,84
v_lshlrev_b32 v254, 16, v51
v_and_b32 v255, 0xffff0000, v51
MA 96,v,160,v,88
v_mul_f32 v68, v248, v2
v_mul_f32 v76, v249, v6
MA 104,v,160,v,92
buffer_load_dwordx4 v208, s[44:47], s75 offen offset:0 lds
v_fmac_f32 v68, v246, v3
MA 160,v,160,v,96
v_fmac_f32 v76, v247, v7
v_fmac_f32 v68, v244, v4
MA 168,v,160,v,100
v_fmac_f32 v76, v245, v8
v_fmac_f32 v68, v242, v5
MA 224,v,160,v,104
v_fmac_f32 v76, v243, v9
v_mul_f32 v68, v68, v254
MA 232,v,160,v,108
TR 160,200,49152
TR 162,200,51200
MA 36,v,164,v,80
ds_read_b128 v[136:139], v193 offset:45056
buffer_load_dwordx4 v209, s[44:47], s75 offen offset:1024 lds
MA 44,v,164,v,84
v_mul_f32 v76, v76, v255
v_lshlrev_b32 v254, 16, v53
MA 100,v,164,v,88
v_and_b32 v255, 0xffff0000, v53
v_mul_f32 v69, v250, v2
MA 108,v,164,v,92
v_mul_f32 v77, v251, v6
v_fmac_f32 v69, v248, v3
MA 164,v,164,v,96
buffer_load_dwordx4 v210, s[44:47], s75 offen offset:2048 lds
v_fmac_f32 v77, v249, v7
MA 172,v,164,v,100
ds_read_b128 v[140:143], v193 offset:47104
v_fmac_f32 v69, v246, v4
MA 228,v,164,v,104
v_fmac_f32 v77, v247, v8
v_fmac_f32 v69, v244, v5
MA 236,v,164,v,108
TR 164,201,49152
TR 166,201,51200
MA 48,v,168,v,80
buffer_load_dwordx4 v211, s[44:47], s75 offen offset:3072 lds
v_fmac_f32 v77, v245, v9
MA 56,v,168,v,84
v_mul_f32 v69, v69, v254
v_mul_f32 v77, v77, v255
MA 112,v,168,v,88
v_cvt_pk_bf16_f32 v230, v69, v68
v_cvt_pk_bf16_f32 v231, v67, v66
MA 120,v,168,v,92
v_cvt_pk_bf16_f32 v232, v65, v64
v_cvt_pk_bf16_f32 v233, v63, v62
MA 176,v,168,v,96
s_mov_b32 s36, 8192
buffer_store_dwordx4 v[230:233], v10, s[84:87], s36 offen sc1
MA 184,v,168,v,100
s_add_u32 s74, s74, 128
v_cvt_pk_bf16_f32 v234, v77, v76
MA 240,v,168,v,104
v_cvt_pk_bf16_f32 v235, v75, v74
v_cvt_pk_bf16_f32 v236, v73, v72
MA 248,v,168,v,108
TR 168,202,49152
TR 170,202,51200
s_waitcnt lgkmcnt(15)
MA 52,v,172,v,80
v_cvt_pk_bf16_f32 v237, v71, v70
s_mov_b32 s36, 12288
MA 60,v,172,v,84
s_and_b32 s74, s74, 2047
buffer_store_dwordx4 v[234:237], v10, s[84:87], s36 offen sc1
MA 116,v,172,v,88
v_bfe_u32 v230, v1, 4, 1
v_lshlrev_b32 v230, 10, v230
MA 124,v,172,v,92
v_bfe_u32 v231, v1, 3, 1
v_lshl_add_u32 v230, v231, 8, v230
MA 180,v,172,v,96
v_and_b32 v231, 7, v1
v_lshl_add_u32 v230, v231, 4, v230
MA 188,v,172,v,100
v_lshrrev_b32 v231, 5, v1
v_lshl_add_u32 v228, v231, 9, v230
MA 244,v,172,v,104
MA 252,v,172,v,108
TR 172,203,49152
TR 174,203,51200
s_waitcnt lgkmcnt(2)
MA 0,v,144,v,112
MA 8,v,144,v,116
MA 64,v,144,v,120
MA 72,v,144,v,124
MA 128,v,144,v,128
MA 136,v,144,v,132
MA 192,v,144,v,136
MA 200,v,144,v,140
MA 4,v,148,v,112
MA 12,v,148,v,116
s_waitcnt vmcnt(15) lgkmcnt(0)
s_barrier
MA 68,v,148,v,120
ds_read_b128 v[48:51], v226 offset:0
s_add_u32 m0, s68, 131072
MA 76,v,148,v,124
MA 132,v,148,v,128
ds_read_b128 v[52:55], v226 offset:2048
buffer_load_dwordx4 v212, s[48:51], s66 offen offset:0 lds
MA 140,v,148,v,132
MA 196,v,148,v,136
ds_read_b128 v[56:59], v226 offset:4096
buffer_load_dwordx4 v213, s[48:51], s66 offen offset:1024 lds
MA 204,v,148,v,140
MA 16,v,152,v,112
ds_read_b128 v[60:63], v226 offset:6144
MA 24,v,152,v,116
buffer_load_dwordx4 v214, s[48:51], s66 offen offset:2048 lds
MA 80,v,152,v,120
TR 16,216,0
MA 88,v,152,v,124
buffer_load_dwordx4 v215, s[48:51], s66 offen offset:3072 lds
MA 144,v,152,v,128
TR 18,216,1024
MA 152,v,152,v,132
MA 208,v,152,v,136
TR 20,217,0
s_add_u32 s66, s66, 524288
MA 216,v,152,v,140
MA 20,v,156,v,112
TR 22,217,1024
s_and_b32 s66, s66, 8388607
MA 28,v,156,v,116
MA 84,v,156,v,120
TR 24,218,0
MA 92,v,156,v,124
s_add_u32 s75, s64, s74
MA 148,v,156,v,128
TR 26,218,1024
MA 156,v,156,v,132
s_add_u32 m0, s67, 32768
MA 212,v,156,v,136
TR 28,219,0
MA 220,v,156,v,140
MA 32,v,160,v,112
TR 30,219,1024
buffer_load_dwordx4 v208, s[44:47], s75 offen offset:0 lds
MA 40,v,160,v,116
MA 96,v,160,v,120
TR 32,220,0
buffer_load_dwordx4 v209, s[44:47], s75 offen offset:1024 lds
MA 104,v,160,v,124
MA 160,v,160,v,128
TR 34,220,1024
MA 168,v,160,v,132
buffer_load_dwordx4 v210, s[44:47], s75 offen offset:2048 lds
MA 224,v,160,v,136
TR 36,221,0
MA 232,v,160,v,140
buffer_load_dwordx4 v211, s[44:47], s75 offen offset:3072 lds
MA 36,v,164,v,112
TR 38,221,1024
MA 44,v,164,v,116
MA 100,v,164,v,120
TR 40,222,0
s_add_u32 s75, s65, s74
MA 108,v,164,v,124
MA 164,v,164,v,128
TR 42,222,1024
s_add_u32 m0, s67, 36864
MA 172,v,164,v,132
MA 228,v,164,v,136
TR 44,223,0
MA 236,v,164,v,140
buffer_load_dwordx4 v208, s[44:47], s75 offen offset:0 lds
MA 48,v,168,v,112
TR 46,223,1024
MA 56,v,168,v,116
buffer_load_dwordx4 v209, s[44:47], s75 offen offset:1024 lds
MA 112,v,168,v,120
MA 120,v,168,v,124
MA 176,v,168,v,128
buffer_load_dwordx4 v210, s[44:47], s75 offen offset:2048 lds
MA 184,v,168,v,132
MA 240,v,168,v,136
buffer_load_dwordx4 v211, s[44:47], s75 offen offset:3072 lds
MA 248,v,168,v,140
MA 52,v,172,v,112
MA 60,v,172,v,116
s_add_u32 s74, s74, 128
MA 116,v,172,v,120
MA 124,v,172,v,124
s_and_b32 s74, s74, 2047
MA 180,v,172,v,128
MA 188,v,172,v,132
MA 244,v,172,v,136
MA 252,v,172,v,140
s_branch L_p2
L_p1_V:
s_waitcnt lgkmcnt(14)
v_mfma_f32_16x16x32_bf16 a[0:3], v[80:83], v[144:147], 0
s_add_u32 m0, s23, 32768
s_add_u32 s25, s24, 256
v_mfma_f32_16x16x32_bf16 a[4:7], v[84:87], v[144:147], 0
ds_read_b128 v[112:115], v193 offset:0
v_mfma_f32_16x16x32_bf16 a[64:67], v[88:91], v[144:147], 0
buffer_load_dwordx4 v184, s[12:15], s21 offen offset:0 lds
s_add_u32 s26, s24, 1024
v_mfma_f32_16x16x32_bf16 a[68:71], v[92:95], v[144:147], 0
v_mfma_f32_16x16x32_bf16 a[128:131], v[96:99], v[144:147], 0
v_mfma_f32_16x16x32_bf16 a[132:135], v[100:103], v[144:147], 0
buffer_load_dwordx4 v185, s[12:15], s21 offen offset:1024 lds
s_add_u32 s27, s24, 1280
v_mfma_f32_16x16x32_bf16 a[192:195], v[104:107], v[144:147], 0
v_mfma_f32_16x16x32_bf16 a[196:199], v[108:111], v[144:147], 0
TR 144,196,16384
TR 146,196,18432
s_waitcnt lgkmcnt(15)
v_mfma_f32_16x16x32_bf16 a[8:11], v[80:83], v[148:151], 0
ds_read_b128 v[116:119], v193 offset:2048
buffer_load_dwordx4 v186, s[12:15], s21 offen offset:2048 lds
v_mfma_f32_16x16x32_bf16 a[12:15], v[84:87], v[148:151], 0
s_add_u32 s28, s24, 2048
v_mfma_f32_16x16x32_bf16 a[72:75], v[88:91], v[148:151], 0
buffer_load_dwordx4 v187, s[12:15], s21 offen offset:3072 lds
v_mfma_f32_16x16x32_bf16 a[76:79], v[92:95], v[148:151], 0
s_add_u32 s29, s24, 2304
v_mfma_f32_16x16x32_bf16 a[136:139], v[96:99], v[148:151], 0
s_add_u32 m0, s23, 36864
v_mfma_f32_16x16x32_bf16 a[140:143], v[100:103], v[148:151], 0
ds_read_b128 v[120:123], v193 offset:4096
v_mfma_f32_16x16x32_bf16 a[200:203], v[104:107], v[148:151], 0
s_add_u32 s30, s24, 3072
v_mfma_f32_16x16x32_bf16 a[204:207], v[108:111], v[148:151], 0
TR 148,197,16384
TR 150,197,18432
s_waitcnt lgkmcnt(15)
v_mfma_f32_16x16x32_bf16 a[16:19], v[80:83], v[152:155], 0
buffer_load_dwordx4 v188, s[12:15], s21 offen offset:0 lds
s_add_u32 s31, s24, 3328
v_mfma_f32_16x16x32_bf16 a[20:23], v[84:87], v[152:155], 0
v_mfma_f32_16x16x32_bf16 a[80:83], v[88:91], v[152:155], 0
buffer_load_dwordx4 v189, s[12:15], s21 offen offset:1024 lds
v_mfma_f32_16x16x32_bf16 a[84:87], v[92:95], v[152:155], 0
v_lshlrev_b32 v8, 7, v1
v_mfma_f32_16x16x32_bf16 a[144:147], v[96:99], v[152:155], 0
ds_read_b128 v[124:127], v193 offset:6144
buffer_load_dwordx4 v190, s[12:15], s21 offen offset:2048 lds
v_mfma_f32_16x16x32_bf16 a[148:151], v[100:103], v[152:155], 0
v_mfma_f32_16x16x32_bf16 a[208:211], v[104:107], v[152:155], 0
s_getpc_b64 s[4:5]
L_pcV:
v_mfma_f32_16x16x32_bf16 a[212:215], v[108:111], v[152:155], 0
TR 152,198,16384
TR 154,198,18432
v_mfma_f32_16x16x32_bf16 a[24:27], v[80:83], v[156:159], 0
buffer_load_dwordx4 v191, s[12:15], s21 offen offset:3072 lds
v_mfma_f32_16x16x32_bf16 a[28:31], v[84:87], v[156:159], 0
s_add_u32 s21, s21, 524288
s_lshr_b32 s98, s2, 3
v_mfma_f32_16x16x32_bf16 a[88:91], v[88:91], v[156:159], 0
ds_read_b128 v[128:131], v193 offset:8192
v_mfma_f32_16x16x32_bf16 a[92:95], v[92:95], v[156:159], 0
v_mfma_f32_16x16x32_bf16 a[152:155], v[96:99], v[156:159], 0
s_and_b32 s21, s21, 4194303
s_lshl_b32 s98, s98, 2
v_mfma_f32_16x16x32_bf16 a[156:159], v[100:103], v[156:159], 0
v_mfma_f32_16x16x32_bf16 a[216:219], v[104:107], v[156:159], 0
v_mfma_f32_16x16x32_bf16 a[220:223], v[108:111], v[156:159], 0
TR 156,199,16384
TR 158,199,18432
s_waitcnt lgkmcnt(15)
v_mfma_f32_16x16x32_bf16 a[32:35], v[80:83], v[160:163], 0
ds_read_b128 v[132:135], v193 offset:10240
s_add_u32 m0, s22, 32768
v_mfma_f32_16x16x32_bf16 a[36:39], v[84:87], v[160:163], 0
buffer_load_dwordx4 v176, s[8:11], s20 offen offset:0 lds
s_add_u32 s98, s98, s3
v_mfma_f32_16x16x32_bf16 a[96:99], v[88:91], v[160:163], 0
s_lshl_b32 s98, s98, 10
v_mfma_f32_16x16x32_bf16 a[100:103], v[92:95], v[160:163], 0
v_mfma_f32_16x16x32_bf16 a[160:163], v[96:99], v[160:163], 0
buffer_load_dwordx4 v177, s[8:11], s20 offen offset:1024 lds
v_and_b32 v9, 0x380, v8
v_mfma_f32_16x16x32_bf16 a[164:167], v[100:103], v[160:163], 0
v_mfma_f32_16x16x32_bf16 a[224:227], v[104:107], v[160:163], 0
buffer_load_dwordx4 v178, s[8:11], s20 offen offset:2048 lds
v_mfma_f32_16x16x32_bf16 a[228:231], v[108:111], v[160:163], 0
TR 160,200,16384
TR 162,200,18432
v_mfma_f32_16x16x32_bf16 a[40:43], v[80:83], v[164:167], 0
ds_read_b128 v[136:139], v193 offset:12288
v_add_u32 v9, s98, v9
v_mfma_f32_16x16x32_bf16 a[44:47], v[84:87], v[164:167], 0
buffer_load_dwordx4 v179, s[8:11], s20 offen offset:3072 lds
v_mfma_f32_16x16x32_bf16 a[104:107], v[88:91], v[164:167], 0
v_min_u32 v9, L_code_end - L_pcV - 4, v9
v_mfma_f32_16x16x32_bf16 a[108:111], v[92:95], v[164:167], 0
s_add_u32 m0, s22, 36864
v_mfma_f32_16x16x32_bf16 a[168:171], v[96:99], v[164:167], 0
v_mfma_f32_16x16x32_bf16 a[172:175], v[100:103], v[164:167], 0
ds_read_b128 v[140:143], v193 offset:14336
v_mov_b32 v11, s5
v_mfma_f32_16x16x32_bf16 a[232:235], v[104:107], v[164:167], 0
buffer_load_dwordx4 v180, s[8:11], s20 offen offset:0 lds
v_mfma_f32_16x16x32_bf16 a[236:239], v[108:111], v[164:167], 0
TR 164,201,16384
TR 166,201,18432
v_mfma_f32_16x16x32_bf16 a[48:51], v[80:83], v[168:171], 0
v_add_co_u32 v10, vcc, s4, v9
s_nop 1
v_addc_co_u32 v11, vcc, 0, v11, vcc
v_mfma_f32_16x16x32_bf16 a[52:55], v[84:87], v[168:171], 0
buffer_load_dwordx4 v181, s[8:11], s20 offen offset:1024 lds
v_mfma_f32_16x16x32_bf16 a[112:115], v[88:91], v[168:171], 0
v_mfma_f32_16x16x32_bf16 a[116:119], v[92:95], v[168:171], 0
buffer_load_dwordx4 v182, s[8:11], s20 offen offset:2048 lds
v_mfma_f32_16x16x32_bf16 a[176:179], v[96:99], v[168:171], 0
v_mfma_f32_16x16x32_bf16 a[180:183], v[100:103], v[168:171], 0
v_mfma_f32_16x16x32_bf16 a[240:243], v[104:107], v[168:171], 0
buffer_load_dwordx4 v183, s[8:11], s20 offen offset:3072 lds
v_mfma_f32_16x16x32_bf16 a[244:247], v[108:111], v[168:171], 0
TR 168,202,16384
TR 170,202,18432
s_waitcnt lgkmcnt(15)
v_mfma_f32_16x16x32_bf16 a[56:59], v[80:83], v[172:175], 0
s_add_u32 s20, s20, 128
v_mfma_f32_16x16x32_bf16 a[60:63], v[84:87], v[172:175], 0
v_mfma_f32_16x16x32_bf16 a[120:123], v[88:91], v[172:175], 0
v_mfma_f32_16x16x32_bf16 a[124:127], v[92:95], v[172:175], 0
s_and_b32 s20, s20, 1023
global_load_dword v79, v[10:11], off
v_mfma_f32_16x16x32_bf16 a[184:187], v[96:99], v[172:175], 0
v_mfma_f32_16x16x32_bf16 a[188:191], v[100:103], v[172:175], 0
v_mfma_f32_16x16x32_bf16 a[248:251], v[104:107], v[172:175], 0
v_mfma_f32_16x16x32_bf16 a[252:255], v[108:111], v[172:175], 0
TR 172,203,16384
TR 174,203,18432
s_waitcnt lgkmcnt(2)
MA 0,v,112,v,144
s_add_u32 m0, s22, 65536
MA 4,v,116,v,144
MA 64,v,120,v,144
MA 68,v,124,v,144
buffer_load_dwordx4 v176, s[8:11], s20 offen offset:0 lds
MA 128,v,128,v,144
MA 132,v,132,v,144
MA 192,v,136,v,144
MA 196,v,140,v,144
buffer_load_dwordx4 v177, s[8:11], s20 offen offset:1024 lds
MA 8,v,112,v,148
MA 12,v,116,v,148
MA 72,v,120,v,148
buffer_load_dwordx4 v178, s[8:11], s20 offen offset:2048 lds
MA 76,v,124,v,148
MA 136,v,128,v,148
MA 140,v,132,v,148
MA 200,v,136,v,148
buffer_load_dwordx4 v179, s[8:11], s20 offen offset:3072 lds
MA 204,v,140,v,148
MA 16,v,112,v,152
MA 20,v,116,v,152
s_add_u32 m0, s22, 69632
MA 80,v,120,v,152
MA 84,v,124,v,152
MA 144,v,128,v,152
MA 148,v,132,v,152
buffer_load_dwordx4 v180, s[8:11], s20 offen offset:0 lds
MA 208,v,136,v,152
MA 212,v,140,v,152
MA 24,v,112,v,156
MA 28,v,116,v,156
buffer_load_dwordx4 v181, s[8:11], s20 offen offset:1024 lds
MA 88,v,120,v,156
MA 92,v,124,v,156
MA 152,v,128,v,156
buffer_load_dwordx4 v182, s[8:11], s20 offen offset:2048 lds
MA 156,v,132,v,156
MA 216,v,136,v,156
MA 220,v,140,v,156
MA 32,v,112,v,160
buffer_load_dwordx4 v183, s[8:11], s20 offen offset:3072 lds
MA 36,v,116,v,160
MA 96,v,120,v,160
MA 100,v,124,v,160
s_add_u32 s20, s20, 128
MA 160,v,128,v,160
MA 164,v,132,v,160
MA 224,v,136,v,160
MA 228,v,140,v,160
s_and_b32 s20, s20, 1023
MA 40,v,112,v,164
MA 44,v,116,v,164
MA 104,v,120,v,164
MA 108,v,124,v,164
MA 168,v,128,v,164
s_waitcnt vmcnt(9) lgkmcnt(0)
s_barrier
MA 172,v,132,v,164
TR 144,196,32768
TR 146,196,34816
MA 232,v,136,v,164
ds_read_b128 v[80:83], v192 offset:32768
s_add_u32 m0, s23, 0
MA 236,v,140,v,164
TR 148,197,32768
TR 150,197,34816
MA 48,v,112,v,168
ds_read_b128 v[84:87], v192 offset:34816
ds_read_b128 v[88:91], v192 offset:36864
MA 52,v,116,v,168
TR 152,198,32768
TR 154,198,34816
MA 112,v,120,v,168
ds_read_b128 v[92:95], v192 offset:38912
ds_read_b128 v[96:99], v192 offset:40960
MA 116,v,124,v,168
TR 156,199,32768
TR 158,199,34816
MA 176,v,128,v,168
ds_read_b128 v[100:103], v192 offset:43008
ds_read_b128 v[104:107], v192 offset:45056
MA 180,v,132,v,168
TR 160,200,32768
TR 162,200,34816
MA 240,v,136,v,168
ds_read_b128 v[108:111], v192 offset:47104
buffer_load_dwordx4 v184, s[12:15], s21 offen offset:0 lds
MA 244,v,140,v,168
TR 164,201,32768
TR 166,201,34816
MA 56,v,112,v,172
buffer_load_dwordx4 v185, s[12:15], s21 offen offset:1024 lds
buffer_load_dwordx4 v186, s[12:15], s21 offen offset:2048 lds
MA 60,v,116,v,172
TR 168,202,32768
TR 170,202,34816
MA 120,v,120,v,172
buffer_load_dwordx4 v187, s[12:15], s21 offen offset:3072 lds
s_add_u32 m0, s23, 4096
MA 124,v,124,v,172
buffer_load_dwordx4 v188, s[12:15], s21 offen offset:0 lds
buffer_load_dwordx4 v189, s[12:15], s21 offen offset:1024 lds
MA 184,v,128,v,172
buffer_load_dwordx4 v190, s[12:15], s21 offen offset:2048 lds
buffer_load_dwordx4 v191, s[12:15], s21 offen offset:3072 lds
MA 188,v,132,v,172
s_add_u32 s21, s21, 524288
s_and_b32 s21, s21, 4194303
MA 248,v,136,v,172
s_load_dwordx2 s[84:85], s[0:1], 8
s_load_dwordx2 s[88:89], s[0:1], 16
MA 252,v,140,v,172
TR 172,203,32768
TR 174,203,34816
s_load_dwordx2 s[92:93], s[0:1], 0
s_load_dwordx2 s[96:97], s[0:1], 24
s_load_dwordx2 s[76:77], s[0:1], 96
s_waitcnt lgkmcnt(2)
MA 0,v,80,v,144
s_add_u32 m0, s22, 0
MA 4,v,84,v,144
ds_read_b128 v[112:115], v193 offset:32768
MA 64,v,88,v,144
s_mov_b32 s4, s34
s_mov_b32 s5, s35
MA 68,v,92,v,144
MA 128,v,96,v,144
MA 132,v,100,v,144
buffer_load_dwordx4 v176, s[8:11], s20 offen offset:0 lds
MA 192,v,104,v,144
MA 196,v,108,v,144
TR 144,196,49152
TR 146,196,51200
MA 8,v,80,v,148
ds_read_b128 v[116:119], v193 offset:34816
MA 12,v,84,v,148
s_mov_b32 s6, 8388608
s_mov_b32 s7, 0x20000
MA 72,v,88,v,148
buffer_load_dwordx4 v177, s[8:11], s20 offen offset:1024 lds
MA 76,v,92,v,148
MA 136,v,96,v,148
MA 140,v,100,v,148
ds_read_b128 v[120:123], v193 offset:36864
MA 200,v,104,v,148
MA 204,v,108,v,148
TR 148,197,49152
TR 150,197,51200
MA 16,v,80,v,152
buffer_load_dwordx4 v178, s[8:11], s20 offen offset:2048 lds
s_lshr_b32 s43, s2, 3
MA 20,v,84,v,152
MA 80,v,88,v,152
MA 84,v,92,v,152
s_lshl_b32 s43, s43, 2
MA 144,v,96,v,152
ds_read_b128 v[124:127], v193 offset:38912
buffer_load_dwordx4 v179, s[8:11], s20 offen offset:3072 lds
MA 148,v,100,v,152
MA 208,v,104,v,152
MA 212,v,108,v,152
TR 152,198,49152
TR 154,198,51200
MA 24,v,80,v,156
s_add_u32 s43, s43, s3
MA 28,v,84,v,156
s_add_u32 m0, s22, 4096
MA 88,v,88,v,156
ds_read_b128 v[128:131], v193 offset:40960
MA 92,v,92,v,156
s_lshl_b32 s43, s43, 16
MA 152,v,96,v,156
MA 156,v,100,v,156
MA 216,v,104,v,156
MA 220,v,108,v,156
TR 156,199,49152
TR 158,199,51200
MA 32,v,80,v,160
ds_read_b128 v[132:135], v193 offset:43008
buffer_load_dwordx4 v180, s[8:11], s20 offen offset:0 lds
MA 36,v,84,v,160
s_and_b32 s37, s2, 7
MA 96,v,88,v,160
s_lshl_b32 s37, s37, 10
MA 100,v,92,v,160
MA 160,v,96,v,160
buffer_load_dwordx4 v181, s[8:11], s20 offen offset:1024 lds
MA 164,v,100,v,160
MA 224,v,104,v,160
s_add_u32 s43, s43, s37
MA 228,v,108,v,160
TR 160,200,49152
TR 162,200,51200
MA 40,v,80,v,164
ds_read_b128 v[136:139], v193 offset:45056
MA 44,v,84,v,164
buffer_load_dwordx4 v182, s[8:11], s20 offen offset:2048 lds
MA 104,v,88,v,164
v_lshrrev_b32 v78, 3, v1
MA 108,v,92,v,164
MA 168,v,96,v,164
MA 172,v,100,v,164
ds_read_b128 v[140:143], v193 offset:47104
MA 232,v,104,v,164
buffer_load_dwordx4 v183, s[8:11], s20 offen offset:3072 lds
s_waitcnt vmcnt(24)
v_and_b32 v79, 7, v1
MA 236,v,108,v,164
TR 164,201,49152
TR 166,201,51200
MA 48,v,80,v,168
MA 52,v,84,v,168
MA 112,v,88,v,168
v_lshlrev_b32 v79, 7, v79
MA 116,v,92,v,168
s_add_u32 s20, s20, 128
MA 176,v,96,v,168
MA 180,v,100,v,168
MA 240,v,104,v,168
v_lshl_add_u32 v78, v78, 13, v79
MA 244,v,108,v,168
TR 168,202,49152
TR 170,202,51200
s_waitcnt lgkmcnt(15)
MA 56,v,80,v,172
s_and_b32 s20, s20, 1023
MA 60,v,84,v,172
MA 120,v,88,v,172
v_add_u32 v78, s43, v78
MA 124,v,92,v,172
MA 184,v,96,v,172
MA 188,v,100,v,172
MA 248,v,104,v,172
MA 252,v,108,v,172
TR 172,203,49152
TR 174,203,51200
s_waitcnt lgkmcnt(2)
MA 0,v,112,v,144
MA 4,v,116,v,144
MA 64,v,120,v,144
MA 68,v,124,v,144
MA 128,v,128,v,144
MA 132,v,132,v,144
MA 192,v,136,v,144
MA 196,v,140,v,144
MA 8,v,112,v,148
MA 12,v,116,v,148
s_waitcnt vmcnt(8) lgkmcnt(0)
s_barrier
MA 72,v,120,v,148
TR 144,196,0
TR 146,196,2048
MA 76,v,124,v,148
ds_read_b128 v[80:83], v194 offset:0
s_add_u32 m0, s23, 32768
MA 136,v,128,v,148
s_mov_b32 s86, 4194304
s_mov_b32 s87, 0x20000
MA 140,v,132,v,148
s_mov_b32 s90, 4194304
s_mov_b32 s91, 0x20000
MA 200,v,136,v,148
buffer_load_dwordx4 v184, s[12:15], s21 offen offset:0 lds
MA 204,v,140,v,148
TR 148,197,0
TR 150,197,2048
MA 16,v,112,v,152
ds_read_b128 v[84:87], v194 offset:2048
s_mov_b32 s94, 4194304
MA 20,v,116,v,152
s_mov_b32 s95, 0x20000
s_mov_b32 s98, 8192
MA 80,v,120,v,152
buffer_load_dwordx4 v185, s[12:15], s21 offen offset:1024 lds
s_mov_b32 s99, 0x20000
MA 84,v,124,v,152
MA 144,v,128,v,152
s_mov_b32 s78, 2048
MA 148,v,132,v,152
ds_read_b128 v[88:91], v194 offset:4096
s_mov_b32 s79, 0x20000
MA 208,v,136,v,152
s_and_b32 s36, s2, 15
MA 212,v,140,v,152
TR 152,198,0
TR 154,198,2048
MA 24,v,112,v,156
buffer_load_dwordx4 v186, s[12:15], s21 offen offset:2048 lds
s_lshl_b32 s36, s36, 1
MA 28,v,116,v,156
s_lshr_b32 s37, s3, 1
MA 88,v,120,v,156
ds_read_b128 v[92:95], v194 offset:6144
s_add_u32 s36, s36, s37
MA 92,v,124,v,156
buffer_load_dwordx4 v187, s[12:15], s21 offen offset:3072 lds
s_lshl_b32 s36, s36, 3
MA 152,v,128,v,156
MA 156,v,132,v,156
v_and_b32 v252, 7, v1
MA 216,v,136,v,156
v_add_u32 v252, s36, v252
MA 220,v,140,v,156
TR 156,199,0
TR 158,199,2048
MA 32,v,112,v,160
ds_read_b128 v[96:99], v194 offset:8192
s_add_u32 m0, s23, 36864
MA 36,v,116,v,160
s_lshr_b32 s36, s2, 4
s_lshl_b32 s36, s36, 1
MA 96,v,120,v,160
s_and_b32 s37, s3, 1
MA 100,v,124,v,160
s_add_u32 s36, s36, s37
MA 160,v,128,v,160
ds_read_b128 v[100:103], v194 offset:10240
buffer_load_dwordx4 v188, s[12:15], s21 offen offset:0 lds
MA 164,v,132,v,160
s_lshl_b32 s36, s36, 3
v_lshrrev_b32 v253, 3, v1
MA 224,v,136,v,160
MA 228,v,140,v,160
TR 160,200,0
TR 162,200,2048
MA 40,v,112,v,164
buffer_load_dwordx4 v189, s[12:15], s21 offen offset:1024 lds
v_add_u32 v253, s36, v253
MA 44,v,116,v,164
ds_read_b128 v[104:107], v194 offset:12288
v_lshlrev_b32 v254, 14, v253
MA 104,v,120,v,164
v_lshl_add_u32 v254, v252, 3, v254
v_add_u32 v229, -6144, v254
MA 108,v,124,v,164
MA 168,v,128,v,164
buffer_load_dwordx4 v190, s[12:15], s21 offen offset:2048 lds
v_lshlrev_b32 v62, 5, v252
MA 172,v,132,v,164
v_lshlrev_b32 v254, 4, v253
MA 232,v,136,v,164
ds_read_b128 v[108:111], v194 offset:14336
v_sub_u32 v254, 4080, v254
MA 236,v,140,v,164
TR 164,201,0
TR 166,201,2048
MA 48,v,112,v,168
v_lshl_add_u32 v10, v252, 14, v254
MA 52,v,116,v,168
buffer_load_dwordx4 v191, s[12:15], s21 offen offset:3072 lds
v_and_b32 v252, 31, v1
MA 112,v,120,v,168
v_lshlrev_b32 v64, 4, v252
MA 116,v,124,v,168
s_lshl_b32 s36, s2, 2
MA 176,v,128,v,168
MA 180,v,132,v,168
s_add_u32 s21, s21, 524288
s_add_u32 s36, s36, s3
MA 240,v,136,v,168
s_lshl_b32 s36, s36, 1
MA 244,v,140,v,168
TR 168,202,0
TR 170,202,2048
MA 56,v,112,v,172
v_lshrrev_b32 v253, 5, v1
v_add_u32 v253, s36, v253
MA 60,v,116,v,172
s_and_b32 s21, s21, 4194303
MA 120,v,120,v,172
v_lshl_add_u32 v63, v253, 11, v64
MA 124,v,124,v,172
v_lshlrev_b32 v253, 2, v253
MA 184,v,128,v,172
v_lshl_add_u32 v11, v252, 20, v253
MA 188,v,132,v,172
MA 248,v,136,v,172
MA 252,v,140,v,172
TR 172,203,0
TR 174,203,2048
s_waitcnt lgkmcnt(2)
MA 0,v,80,v,144
s_add_u32 m0, s22, 32768
buffer_load_dwordx4 v[230:233], v63, s[92:95], 0 offen offset:0
MA 4,v,84,v,144
ds_read_b128 v[112:115], v195 offset:0
MA 64,v,88,v,144
MA 68,v,92,v,144
MA 128,v,96,v,144
buffer_load_dwordx4 v[2:5], v64, s[76:79], 0 offen offset:0
MA 132,v,100,v,144
buffer_load_dwordx4 v176, s[8:11], s20 offen offset:0 lds
MA 192,v,104,v,144
MA 196,v,108,v,144
TR 144,196,16384
TR 146,196,18432
MA 8,v,80,v,148
ds_read_b128 v[116:119], v195 offset:2048
MA 12,v,84,v,148
buffer_load_dwordx4 v[234:237], v63, s[92:95], 0 offen offset:512
MA 72,v,88,v,148
buffer_load_dwordx4 v177, s[8:11], s20 offen offset:1024 lds
MA 76,v,92,v,148
MA 136,v,96,v,148
MA 140,v,100,v,148
ds_read_b128 v[120:123], v195 offset:4096
MA 200,v,104,v,148
buffer_load_dwordx4 v[6:9], v64, s[76:79], 0 offen offset:512
MA 204,v,108,v,148
TR 148,197,16384
TR 150,197,18432
MA 16,v,80,v,152
buffer_load_dwordx4 v178, s[8:11], s20 offen offset:2048 lds
MA 20,v,84,v,152
MA 80,v,88,v,152
MA 84,v,92,v,152
buffer_load_dwordx4 v[238:241], v63, s[92:95], 0 offen offset:1024
MA 144,v,96,v,152
ds_read_b128 v[124:127], v195 offset:6144
buffer_load_dwordx4 v179, s[8:11], s20 offen offset:3072 lds
MA 148,v,100,v,152
MA 208,v,104,v,152
MA 212,v,108,v,152
TR 152,198,16384
TR 154,198,18432
MA 24,v,80,v,156
buffer_load_dwordx4 v[12:15], v64, s[76:79], 0 offen offset:1024
MA 28,v,84,v,156
s_add_u32 m0, s22, 36864
MA 88,v,88,v,156
ds_read_b128 v[128:131], v195 offset:8192
MA 92,v,92,v,156
MA 152,v,96,v,156
buffer_load_dwordx4 v[242:245], v63, s[92:95], 0 offen offset:1536
MA 156,v,100,v,156
MA 216,v,104,v,156
MA 220,v,108,v,156
TR 156,199,16384
TR 158,199,18432
MA 32,v,80,v,160
ds_read_b128 v[132:135], v195 offset:10240
buffer_load_dwordx4 v180, s[8:11], s20 offen offset:0 lds
MA 36,v,84,v,160
buffer_load_dwordx4 v[246:249], v64, s[76:79], 0 offen offset:1536
MA 96,v,88,v,160
MA 100,v,92,v,160
MA 160,v,96,v,160
buffer_load_dwordx4 v181, s[8:11], s20 offen offset:1024 lds
MA 164,v,100,v,160
MA 224,v,104,v,160
buffer_load_dwordx4 v[54:57], v62, s[96:99], 0 offen offset:0
MA 228,v,108,v,160
TR 160,200,16384
TR 162,200,18432
MA 40,v,80,v,164
ds_read_b128 v[136:139], v195 offset:12288
MA 44,v,84,v,164
buffer_load_dwordx4 v182, s[8:11], s20 offen offset:2048 lds
MA 104,v,88,v,164
buffer_load_dwordx4 v[58:61], v62, s[96:99], 0 offen offset:16
MA 108,v,92,v,164
MA 168,v,96,v,164
MA 172,v,100,v,164
ds_read_b128 v[140:143], v195 offset:14336
MA 232,v,104,v,164
buffer_load_dwordx4 v183, s[8:11], s20 offen offset:3072 lds
MA 236,v,108,v,164
TR 164,201,16384
TR 166,201,18432
MA 48,v,80,v,168
v_add_u32 v252, 0, v229
MA 52,v,84,v,168
MA 112,v,88,v,168
MA 116,v,92,v,168
s_add_u32 s20, s20, 128
MA 176,v,96,v,168
buffer_load_dwordx2 v[16:17], v252, s[84:87], 0 offen
MA 180,v,100,v,168
MA 240,v,104,v,168
MA 244,v,108,v,168
TR 168,202,16384
TR 170,202,18432
s_waitcnt lgkmcnt(15)
MA 56,v,80,v,172
s_and_b32 s20, s20, 1023
MA 60,v,84,v,172
v_add_u32 v253, 2048, v229
MA 120,v,88,v,172
MA 124,v,92,v,172
MA 184,v,96,v,172
MA 188,v,100,v,172
MA 248,v,104,v,172
MA 252,v,108,v,172
TR 172,203,16384
TR 174,203,18432
s_waitcnt lgkmcnt(2)
MA 0,v,112,v,144
MA 4,v,116,v,144
MA 64,v,120,v,144
MA 68,v,124,v,144
MA 128,v,128,v,144
MA 132,v,132,v,144
MA 192,v,136,v,144
MA 196,v,140,v,144
MA 8,v,112,v,148
MA 12,v,116,v,148
s_waitcnt vmcnt(19) lgkmcnt(0)
s_barrier
MA 72,v,120,v,148
TR 144,196,32768
TR 146,196,34816
MA 76,v,124,v,148
ds_read_b128 v[80:83], v192 offset:0
s_add_u32 m0, s23, 0
MA 136,v,128,v,148
s_and_b32 s80, s2, 7
s_lshr_b32 s81, s2, 3
MA 140,v,132,v,148
s_and_b32 s69, s81, 3
s_lshl_b32 s80, s80, 2
MA 200,v,136,v,148
buffer_load_dwordx4 v184, s[12:15], s21 offen offset:0 lds
s_add_u32 s69, s69, s80
MA 204,v,140,v,148
TR 148,197,32768
TR 150,197,34816
MA 16,v,112,v,152
ds_read_b128 v[84:87], v192 offset:2048
s_lshr_b32 s70, s81, 2
MA 20,v,116,v,152
s_lshl_b32 s80, s3, 16
s_lshl_b32 s65, s70, 18
MA 80,v,120,v,152
buffer_load_dwordx4 v185, s[12:15], s21 offen offset:1024 lds
s_sub_u32 s64, 3932160, s65
MA 84,v,124,v,152
s_add_u32 s65, s65, s80
s_add_u32 s64, s64, s80
MA 144,v,128,v,152
s_lshl_b32 s81, s69, 12
MA 148,v,132,v,152
ds_read_b128 v[88:91], v192 offset:4096
s_lshl_b32 s100, s64, 2
MA 208,v,136,v,152
s_add_u32 s100, s100, s81
MA 212,v,140,v,152
TR 152,198,32768
TR 154,198,34816
MA 24,v,112,v,156
buffer_load_dwordx4 v186, s[12:15], s21 offen offset:2048 lds
s_lshl_b32 s101, s65, 2
MA 28,v,116,v,156
s_add_u32 s101, s101, s81
s_lshl_b32 s66, s3, 17
MA 88,v,120,v,156
ds_read_b128 v[92:95], v192 offset:6144
s_lshl_b32 s81, s69, 8
MA 92,v,124,v,156
buffer_load_dwordx4 v187, s[12:15], s21 offen offset:3072 lds
s_add_u32 s66, s66, s81
MA 152,v,128,v,156
s_and_b32 s74, s2, 7
MA 156,v,132,v,156
s_lshl_b32 s74, s74, 8
MA 216,v,136,v,156
s_mov_b32 s82, s66
MA 220,v,140,v,156
TR 156,199,32768
TR 158,199,34816
MA 32,v,112,v,160
ds_read_b128 v[96:99], v192 offset:8192
s_add_u32 m0, s23, 4096
MA 36,v,116,v,160
s_lshl_b32 s66, s74, 12
s_lshl_b32 s67, s3, 13
MA 96,v,120,v,160
s_lshl_b32 s68, s3, 12
s_lshl_b32 s76, s70, 1
MA 100,v,124,v,160
s_sub_u32 s77, 32, s76
MA 160,v,128,v,160
ds_read_b128 v[100:103], v192 offset:10240
buffer_load_dwordx4 v188, s[12:15], s21 offen offset:0 lds
MA 164,v,132,v,160
s_add_u32 s76, s76, 2
s_mov_b32 s79, 0x41000000
MA 224,v,136,v,160
v_lshrrev_b32 v66, 3, v1
MA 228,v,140,v,160
TR 160,200,32768
TR 162,200,34816
MA 40,v,112,v,164
buffer_load_dwordx4 v189, s[12:15], s21 offen offset:1024 lds
v_lshlrev_b32 v66, 11, v66
MA 44,v,116,v,164
ds_read_b128 v[104:107], v192 offset:12288
v_lshrrev_b32 v67, 4, v1
MA 104,v,120,v,164
v_and_b32 v68, 7, v1
v_xor_b32 v68, v68, v67
MA 108,v,124,v,164
v_lshl_add_u32 v66, v68, 4, v66
MA 168,v,128,v,164
buffer_load_dwordx4 v190, s[12:15], s21 offen offset:2048 lds
v_xor_b32 v69, 64, v66
MA 172,v,132,v,164
v_add_u32 v208, 0, v66
MA 232,v,136,v,164
ds_read_b128 v[108:111], v192 offset:14336
v_add_u32 v209, 15360, v69
MA 236,v,140,v,164
TR 164,201,32768
TR 166,201,34816
MA 48,v,112,v,168
v_add_u32 v210, 30720, v66
v_add_u32 v211, 46080, v69
MA 52,v,116,v,168
buffer_load_dwordx4 v191, s[12:15], s21 offen offset:3072 lds
v_and_b32 v68, 15, v1
MA 112,v,120,v,168
v_lshlrev_b32 v69, 1, v67
MA 116,v,124,v,168
v_xor_b32 v68, v68, v69
MA 176,v,128,v,168
v_lshlrev_b32 v66, 13, v67
MA 180,v,132,v,168
s_add_u32 s21, s21, 524288
v_xor_b32 v69, 0, v68
MA 240,v,136,v,168
v_lshl_add_u32 v69, v69, 4, v66
MA 244,v,140,v,168
TR 168,202,32768
TR 170,202,34816
MA 56,v,112,v,172
v_add_u32 v212, 0, v69
v_xor_b32 v69, 0, v68
MA 60,v,116,v,172
s_and_b32 s21, s21, 4194303
v_lshl_add_u32 v69, v69, 4, v66
MA 120,v,120,v,172
v_add_u32 v213, 31744, v69
MA 124,v,124,v,172
v_xor_b32 v69, 8, v68
MA 184,v,128,v,172
v_lshl_add_u32 v69, v69, 4, v66
MA 188,v,132,v,172
v_add_u32 v214, 63488, v69
MA 248,v,136,v,172
MA 252,v,140,v,172
TR 172,203,32768
TR 174,203,34816
s_waitcnt lgkmcnt(2)
MA 0,v,80,v,144
s_add_u32 m0, s22, 65536
buffer_load_dwordx2 v[18:19], v253, s[84:87], 0 offen
MA 4,v,84,v,144
ds_read_b128 v[112:115], v193 offset:0
MA 64,v,88,v,144
MA 68,v,92,v,144
MA 128,v,96,v,144
v_add_u32 v254, 4096, v229
MA 132,v,100,v,144
buffer_load_dwordx4 v176, s[8:11], s20 offen offset:0 lds
MA 192,v,104,v,144
MA 196,v,108,v,144
TR 144,196,49152
TR 146,196,51200
MA 8,v,80,v,148
ds_read_b128 v[116:119], v193 offset:2048
MA 12,v,84,v,148
buffer_load_dwordx2 v[20:21], v254, s[84:87], 0 offen
MA 72,v,88,v,148
buffer_load_dwordx4 v177, s[8:11], s20 offen offset:1024 lds
MA 76,v,92,v,148
MA 136,v,96,v,148
MA 140,v,100,v,148
ds_read_b128 v[120:123], v193 offset:4096
MA 200,v,104,v,148
v_add_u32 v255, 6144, v229
MA 204,v,108,v,148
TR 148,197,49152
TR 150,197,51200
MA 16,v,80,v,152
buffer_load_dwordx4 v178, s[8:11], s20 offen offset:2048 lds
MA 20,v,84,v,152
MA 80,v,88,v,152
MA 84,v,92,v,152
buffer_load_dwordx2 v[22:23], v255, s[84:87], 0 offen
MA 144,v,96,v,152
ds_read_b128 v[124:127], v193 offset:6144
buffer_load_dwordx4 v179, s[8:11], s20 offen offset:3072 lds
MA 148,v,100,v,152
MA 208,v,104,v,152
MA 212,v,108,v,152
TR 152,198,49152
TR 154,198,51200
MA 24,v,80,v,156
buffer_load_dwordx2 v[38:39], v255, s[88:91], 0 offen
MA 28,v,84,v,156
s_add_u32 m0, s22, 69632
MA 88,v,88,v,156
ds_read_b128 v[128:131], v193 offset:8192
MA 92,v,92,v,156
MA 152,v,96,v,156
v_add_u32 v252, 8192, v229
MA 156,v,100,v,156
MA 216,v,104,v,156
MA 220,v,108,v,156
TR 156,199,49152
TR 158,199,51200
MA 32,v,80,v,160
ds_read_b128 v[132:135], v193 offset:10240
buffer_load_dwordx4 v180, s[8:11], s20 offen offset:0 lds
MA 36,v,84,v,160
buffer_load_dwordx2 v[24:25], v252, s[84:87], 0 offen
MA 96,v,88,v,160
MA 100,v,92,v,160
MA 160,v,96,v,160
buffer_load_dwordx4 v181, s[8:11], s20 offen offset:1024 lds
MA 164,v,100,v,160
MA 224,v,104,v,160
buffer_load_dwordx2 v[40:41], v252, s[88:91], 0 offen
MA 228,v,108,v,160
TR 160,200,49152
TR 162,200,51200
MA 40,v,80,v,164
ds_read_b128 v[136:139], v193 offset:12288
MA 44,v,84,v,164
buffer_load_dwordx4 v182, s[8:11], s20 offen offset:2048 lds
MA 104,v,88,v,164
v_add_u32 v253, 10240, v229
MA 108,v,92,v,164
MA 168,v,96,v,164
MA 172,v,100,v,164
ds_read_b128 v[140:143], v193 offset:14336
MA 232,v,104,v,164
buffer_load_dwordx4 v183, s[8:11], s20 offen offset:3072 lds
MA 236,v,108,v,164
TR 164,201,49152
TR 166,201,51200
MA 48,v,80,v,168
buffer_load_dwordx2 v[26:27], v253, s[84:87], 0 offen
MA 52,v,84,v,168
MA 112,v,88,v,168
MA 116,v,92,v,168
s_add_u32 s20, s20, 128
MA 176,v,96,v,168
buffer_load_dwordx2 v[42:43], v253, s[88:91], 0 offen
MA 180,v,100,v,168
MA 240,v,104,v,168
MA 244,v,108,v,168
TR 168,202,49152
TR 170,202,51200
s_waitcnt lgkmcnt(15)
MA 56,v,80,v,172
s_and_b32 s20, s20, 1023
MA 60,v,84,v,172
v_add_u32 v254, 12288, v229
MA 120,v,88,v,172
MA 124,v,92,v,172
MA 184,v,96,v,172
MA 188,v,100,v,172
MA 248,v,104,v,172
MA 252,v,108,v,172
TR 172,203,49152
TR 174,203,51200
s_waitcnt lgkmcnt(2)
MA 0,v,112,v,144
MA 4,v,116,v,144
MA 64,v,120,v,144
MA 68,v,124,v,144
MA 128,v,128,v,144
MA 132,v,132,v,144
MA 192,v,136,v,144
MA 196,v,140,v,144
MA 8,v,112,v,148
MA 12,v,116,v,148
s_waitcnt vmcnt(16) lgkmcnt(0)
s_barrier
MA 72,v,120,v,148
TR 144,196,0
TR 146,196,2048
MA 76,v,124,v,148
ds_read_b128 v[80:83], v192 offset:32768
s_add_u32 m0, s23, 32768
MA 136,v,128,v,148
v_xor_b32 v69, 8, v68
v_lshl_add_u32 v69, v69, 4, v66
MA 140,v,132,v,148
v_add_u32 v215, 95232, v69
v_and_b32 v66, 15, v1
MA 200,v,136,v,148
buffer_load_dwordx4 v184, s[12:15], s21 offen offset:0 lds
v_lshrrev_b32 v68, 1, v66
MA 204,v,140,v,148
TR 148,197,0
TR 150,197,2048
MA 16,v,112,v,152
ds_read_b128 v[84:87], v192 offset:34816
v_xor_b32 v68, v68, v67
MA 20,v,116,v,152
v_lshlrev_b32 v68, 4, v68
v_lshl_add_u32 v68, v66, 7, v68
MA 80,v,120,v,152
buffer_load_dwordx4 v185, s[12:15], s21 offen offset:1024 lds
v_add_u32 v224, s67, v68
MA 84,v,124,v,152
v_xor_b32 v225, 64, v224
v_add_u32 v226, 0x10000, v224
MA 144,v,128,v,152
v_add_u32 v227, 0x10000, v225
v_bfe_u32 v66, v1, 2, 2
MA 148,v,132,v,152
ds_read_b128 v[88:91], v192 offset:36864
v_and_b32 v68, 1, v67
MA 208,v,136,v,152
v_lshl_or_b32 v68, v68, 2, v66
MA 212,v,140,v,152
TR 152,198,0
TR 154,198,2048
MA 24,v,112,v,156
buffer_load_dwordx4 v186, s[12:15], s21 offen offset:2048 lds
v_lshl_add_u32 v66, v67, 3, v66
MA 28,v,116,v,156
v_lshlrev_b32 v66, 8, v66
v_and_b32 v69, 3, v1
MA 88,v,120,v,156
ds_read_b128 v[92:95], v192 offset:38912
v_lshl_add_u32 v66, v69, 3, v66
MA 92,v,124,v,156
buffer_load_dwordx4 v187, s[12:15], s21 offen offset:3072 lds
v_add_u32 v66, 98304, v66
MA 152,v,128,v,156
v_xor_b32 v69, 0, v68
v_lshl_add_u32 v216, v69, 5, v66
MA 156,v,132,v,156
v_xor_b32 v69, 1, v68
MA 216,v,136,v,156
v_lshl_add_u32 v217, v69, 5, v66
MA 220,v,140,v,156
TR 156,199,0
TR 158,199,2048
MA 32,v,112,v,160
ds_read_b128 v[96:99], v192 offset:40960
s_add_u32 m0, s23, 36864
MA 36,v,116,v,160
v_xor_b32 v69, 2, v68
v_lshl_add_u32 v218, v69, 5, v66
MA 96,v,120,v,160
v_xor_b32 v69, 3, v68
v_lshl_add_u32 v219, v69, 5, v66
MA 100,v,124,v,160
v_xor_b32 v69, 4, v68
v_lshl_add_u32 v220, v69, 5, v66
MA 160,v,128,v,160
ds_read_b128 v[100:103], v192 offset:43008
buffer_load_dwordx4 v188, s[12:15], s21 offen offset:0 lds
MA 164,v,132,v,160
v_xor_b32 v69, 5, v68
v_lshl_add_u32 v221, v69, 5, v66
MA 224,v,136,v,160
v_xor_b32 v69, 6, v68
MA 228,v,140,v,160
TR 160,200,0
TR 162,200,2048
MA 40,v,112,v,164
buffer_load_dwordx4 v189, s[12:15], s21 offen offset:1024 lds
v_lshl_add_u32 v222, v69, 5, v66
MA 44,v,116,v,164
ds_read_b128 v[104:107], v192 offset:45056
v_xor_b32 v69, 7, v68
MA 104,v,120,v,164
v_lshl_add_u32 v223, v69, 5, v66
s_mov_b32 s44, s32
MA 108,v,124,v,164
s_mov_b32 s45, s33
s_mov_b32 s46, 4194304
MA 168,v,128,v,164
buffer_load_dwordx4 v190, s[12:15], s21 offen offset:2048 lds
s_mov_b32 s47, 0x20000
MA 172,v,132,v,164
s_add_u32 s48, s34, s82
s_addc_u32 s49, s35, 0
MA 232,v,136,v,164
ds_read_b128 v[108:111], v192 offset:47104
MA 236,v,140,v,164
TR 164,201,0
TR 166,201,2048
MA 48,v,112,v,168
s_sub_u32 s50, 8388608, s82
s_mov_b32 s51, 0x20000
MA 52,v,116,v,168
buffer_load_dwordx4 v191, s[12:15], s21 offen offset:3072 lds
MA 112,v,120,v,168
s_add_u32 s60, s40, 33554432
s_addc_u32 s61, s41, 0
MA 116,v,124,v,168
s_mov_b32 s62, 16777216
s_mov_b32 s63, 0x20000
MA 176,v,128,v,168
s_lshl_b32 s80, s69, 19
MA 180,v,132,v,168
s_add_u32 s21, s21, 524288
MA 240,v,136,v,168
s_add_u32 s52, s40, s80
s_addc_u32 s53, s41, 0
MA 244,v,140,v,168
TR 168,202,0
TR 170,202,2048
MA 56,v,112,v,172
s_lshl_b32 s54, s77, 14
s_mov_b32 s55, 0x20000
MA 60,v,116,v,172
s_and_b32 s21, s21, 4194303
s_add_u32 s80, s80, 16760832
MA 120,v,120,v,172
s_add_u32 s56, s40, s80
s_addc_u32 s57, s41, 0
MA 124,v,124,v,172
s_add_u32 s58, s54, 16384
MA 184,v,128,v,172
s_mov_b32 s59, 0x20000
MA 188,v,132,v,172
s_load_dwordx2 s[38:39], s[0:1], 112
MA 248,v,136,v,172
MA 252,v,140,v,172
TR 172,203,0
TR 174,203,2048
s_waitcnt lgkmcnt(2)
MA 0,v,80,v,144
s_add_u32 m0, s22, 0
buffer_load_dwordx2 v[28:29], v254, s[84:87], 0 offen
MA 4,v,84,v,144
ds_read_b128 v[112:115], v193 offset:32768
MA 64,v,88,v,144
MA 68,v,92,v,144
MA 128,v,96,v,144
buffer_load_dwordx2 v[44:45], v254, s[88:91], 0 offen
MA 132,v,100,v,144
buffer_load_dwordx4 v176, s[8:11], s20 offen offset:0 lds
MA 192,v,104,v,144
MA 196,v,108,v,144
TR 144,196,16384
TR 146,196,18432
MA 8,v,80,v,148
ds_read_b128 v[116:119], v193 offset:34816
v_add_u32 v255, 14336, v229
MA 12,v,84,v,148
MA 72,v,88,v,148
buffer_load_dwordx4 v177, s[8:11], s20 offen offset:1024 lds
MA 76,v,92,v,148
MA 136,v,96,v,148
MA 140,v,100,v,148
ds_read_b128 v[120:123], v193 offset:36864
buffer_load_dwordx2 v[30:31], v255, s[84:87], 0 offen
MA 200,v,104,v,148
MA 204,v,108,v,148
TR 148,197,16384
TR 150,197,18432
MA 16,v,80,v,152
buffer_load_dwordx4 v178, s[8:11], s20 offen offset:2048 lds
MA 20,v,84,v,152
buffer_load_dwordx2 v[46:47], v255, s[88:91], 0 offen
MA 80,v,88,v,152
MA 84,v,92,v,152
MA 144,v,96,v,152
ds_read_b128 v[124:127], v193 offset:38912
buffer_load_dwordx4 v179, s[8:11], s20 offen offset:3072 lds
MA 148,v,100,v,152
MA 208,v,104,v,152
v_add_u32 v252, 16384, v229
MA 212,v,108,v,152
TR 152,198,16384
TR 154,198,18432
MA 24,v,80,v,156
MA 28,v,84,v,156
s_add_u32 m0, s22, 4096
MA 88,v,88,v,156
ds_read_b128 v[128:131], v193 offset:40960
buffer_load_dwordx2 v[32:33], v252, s[84:87], 0 offen
MA 92,v,92,v,156
MA 152,v,96,v,156
MA 156,v,100,v,156
MA 216,v,104,v,156
MA 220,v,108,v,156
TR 156,199,16384
TR 158,199,18432
MA 32,v,80,v,160
ds_read_b128 v[132:135], v193 offset:43008
buffer_load_dwordx4 v180, s[8:11], s20 offen offset:0 lds
MA 36,v,84,v,160
buffer_load_dwordx2 v[48:49], v252, s[88:91], 0 offen
MA 96,v,88,v,160
MA 100,v,92,v,160
v_add_u32 v253, 18432, v229
MA 160,v,96,v,160
buffer_load_dwordx4 v181, s[8:11], s20 offen offset:1024 lds
MA 164,v,100,v,160
MA 224,v,104,v,160
MA 228,v,108,v,160
TR 160,200,16384
TR 162,200,18432
MA 40,v,80,v,164
ds_read_b128 v[136:139], v193 offset:45056
buffer_load_dwordx2 v[34:35], v253, s[84:87], 0 offen
MA 44,v,84,v,164
buffer_load_dwordx4 v182, s[8:11], s20 offen offset:2048 lds
MA 104,v,88,v,164
MA 108,v,92,v,164
MA 168,v,96,v,164
buffer_load_dwordx2 v[50:51], v253, s[88:91], 0 offen
MA 172,v,100,v,164
ds_read_b128 v[140:143], v193 offset:47104
MA 232,v,104,v,164
buffer_load_dwordx4 v183, s[8:11], s20 offen offset:3072 lds
MA 236,v,108,v,164
TR 164,201,16384
TR 166,201,18432
MA 48,v,80,v,168
v_add_u32 v254, 20480, v229
MA 52,v,84,v,168
MA 112,v,88,v,168
MA 116,v,92,v,168
s_add_u32 s20, s20, 128
MA 176,v,96,v,168
MA 180,v,100,v,168
buffer_load_dwordx2 v[36:37], v254, s[84:87], 0 offen
MA 240,v,104,v,168
MA 244,v,108,v,168
TR 168,202,16384
TR 170,202,18432
s_waitcnt lgkmcnt(15)
MA 56,v,80,v,172
s_and_b32 s20, s20, 1023
MA 60,v,84,v,172
buffer_load_dwordx2 v[52:53], v254, s[88:91], 0 offen
MA 120,v,88,v,172
MA 124,v,92,v,172
MA 184,v,96,v,172
MA 188,v,100,v,172
MA 248,v,104,v,172
MA 252,v,108,v,172
TR 172,203,16384
TR 174,203,18432
s_waitcnt lgkmcnt(2)
MA 0,v,112,v,144
MA 4,v,116,v,144
MA 64,v,120,v,144
MA 68,v,124,v,144
MA 128,v,128,v,144
MA 132,v,132,v,144
MA 192,v,136,v,144
MA 196,v,140,v,144
MA 8,v,112,v,148
MA 12,v,116,v,148
s_waitcnt vmcnt(18) lgkmcnt(0)
s_barrier
MA 72,v,120,v,148
TR 144,196,32768
TR 146,196,34816
MA 76,v,124,v,148
ds_read_b128 v[80:83], v194 offset:0
s_add_u32 m0, s23, 0
MA 136,v,128,v,148
MA 140,v,132,v,148
MA 200,v,136,v,148
buffer_load_dwordx4 v184, s[12:15], s21 offen offset:0 lds
MA 204,v,140,v,148
TR 148,197,32768
TR 150,197,34816
MA 16,v,112,v,152
ds_read_b128 v[84:87], v194 offset:2048
MA 20,v,116,v,152
MA 80,v,120,v,152
buffer_load_dwordx4 v185, s[12:15], s21 offen offset:1024 lds
MA 84,v,124,v,152
MA 144,v,128,v,152
MA 148,v,132,v,152
ds_read_b128 v[88:91], v194 offset:4096
MA 208,v,136,v,152
MA 212,v,140,v,152
TR 152,198,32768
TR 154,198,34816
MA 24,v,112,v,156
buffer_load_dwordx4 v186, s[12:15], s21 offen offset:2048 lds
MA 28,v,116,v,156
MA 88,v,120,v,156
ds_read_b128 v[92:95], v194 offset:6144
MA 92,v,124,v,156
buffer_load_dwordx4 v187, s[12:15], s21 offen offset:3072 lds
MA 152,v,128,v,156
MA 156,v,132,v,156
MA 216,v,136,v,156
MA 220,v,140,v,156
TR 156,199,32768
TR 158,199,34816
MA 32,v,112,v,160
ds_read_b128 v[96:99], v194 offset:8192
s_add_u32 m0, s23, 4096
MA 36,v,116,v,160
MA 96,v,120,v,160
MA 100,v,124,v,160
MA 160,v,128,v,160
ds_read_b128 v[100:103], v194 offset:10240
buffer_load_dwordx4 v188, s[12:15], s21 offen offset:0 lds
MA 164,v,132,v,160
MA 224,v,136,v,160
MA 228,v,140,v,160
TR 160,200,32768
TR 162,200,34816
MA 40,v,112,v,164
buffer_load_dwordx4 v189, s[12:15], s21 offen offset:1024 lds
MA 44,v,116,v,164
ds_read_b128 v[104:107], v194 offset:12288
MA 104,v,120,v,164
MA 108,v,124,v,164
MA 168,v,128,v,164
buffer_load_dwordx4 v190, s[12:15], s21 offen offset:2048 lds
MA 172,v,132,v,164
MA 232,v,136,v,164
ds_read_b128 v[108:111], v194 offset:14336
MA 236,v,140,v,164
TR 164,201,32768
TR 166,201,34816
MA 48,v,112,v,168
MA 52,v,116,v,168
buffer_load_dwordx4 v191, s[12:15], s21 offen offset:3072 lds
MA 112,v,120,v,168
MA 116,v,124,v,168
MA 176,v,128,v,168
MA 180,v,132,v,168
s_add_u32 s21, s21, 524288
MA 240,v,136,v,168
MA 244,v,140,v,168
TR 168,202,32768
TR 170,202,34816
MA 56,v,112,v,172
MA 60,v,116,v,172
s_and_b32 s21, s21, 4194303
MA 120,v,120,v,172
MA 124,v,124,v,172
MA 184,v,128,v,172
MA 188,v,132,v,172
MA 248,v,136,v,172
MA 252,v,140,v,172
TR 172,203,32768
TR 174,203,34816
s_waitcnt lgkmcnt(2)
MA 0,v,80,v,144
s_add_u32 m0, s22, 32768
MA 4,v,84,v,144
ds_read_b128 v[112:115], v195 offset:0
MA 64,v,88,v,144
MA 68,v,92,v,144
MA 128,v,96,v,144
MA 132,v,100,v,144
buffer_load_dwordx4 v176, s[8:11], s20 offen offset:0 lds
MA 192,v,104,v,144
MA 196,v,108,v,144
TR 144,196,49152
TR 146,196,51200
MA 8,v,80,v,148
ds_read_b128 v[116:119], v195 offset:2048
MA 12,v,84,v,148
MA 72,v,88,v,148
buffer_load_dwordx4 v177, s[8:11], s20 offen offset:1024 lds
MA 76,v,92,v,148
MA 136,v,96,v,148
MA 140,v,100,v,148
ds_read_b128 v[120:123], v195 offset:4096
MA 200,v,104,v,148
MA 204,v,108,v,148
TR 148,197,49152
TR 150,197,51200
MA 16,v,80,v,152
buffer_load_dwordx4 v178, s[8:11], s20 offen offset:2048 lds
MA 20,v,84,v,152
MA 80,v,88,v,152
MA 84,v,92,v,152
MA 144,v,96,v,152
ds_read_b128 v[124:127], v195 offset:6144
buffer_load_dwordx4 v179, s[8:11], s20 offen offset:3072 lds
MA 148,v,100,v,152
MA 208,v,104,v,152
MA 212,v,108,v,152
TR 152,198,49152
TR 154,198,51200
MA 24,v,80,v,156
MA 28,v,84,v,156
s_add_u32 m0, s22, 36864
MA 88,v,88,v,156
ds_read_b128 v[128:131], v195 offset:8192
MA 92,v,92,v,156
MA 152,v,96,v,156
MA 156,v,100,v,156
MA 216,v,104,v,156
MA 220,v,108,v,156
TR 156,199,49152
TR 158,199,51200
MA 32,v,80,v,160
ds_read_b128 v[132:135], v195 offset:10240
buffer_load_dwordx4 v180, s[8:11], s20 offen offset:0 lds
MA 36,v,84,v,160
MA 96,v,88,v,160
MA 100,v,92,v,160
MA 160,v,96,v,160
buffer_load_dwordx4 v181, s[8:11], s20 offen offset:1024 lds
MA 164,v,100,v,160
MA 224,v,104,v,160
MA 228,v,108,v,160
TR 160,200,49152
TR 162,200,51200
MA 40,v,80,v,164
ds_read_b128 v[136:139], v195 offset:12288
MA 44,v,84,v,164
buffer_load_dwordx4 v182, s[8:11], s20 offen offset:2048 lds
MA 104,v,88,v,164
MA 108,v,92,v,164
MA 168,v,96,v,164
MA 172,v,100,v,164
ds_read_b128 v[140:143], v195 offset:14336
MA 232,v,104,v,164
buffer_load_dwordx4 v183, s[8:11], s20 offen offset:3072 lds
MA 236,v,108,v,164
TR 164,201,49152
TR 166,201,51200
MA 48,v,80,v,168
MA 52,v,84,v,168
MA 112,v,88,v,168
MA 116,v,92,v,168
s_add_u32 s20, s20, 128
MA 176,v,96,v,168
MA 180,v,100,v,168
MA 240,v,104,v,168
MA 244,v,108,v,168
TR 168,202,49152
TR 170,202,51200
s_waitcnt lgkmcnt(15)
MA 56,v,80,v,172
s_and_b32 s20, s20, 1023
MA 60,v,84,v,172
MA 120,v,88,v,172
MA 124,v,92,v,172
MA 184,v,96,v,172
MA 188,v,100,v,172
MA 248,v,104,v,172
MA 252,v,108,v,172
TR 172,203,49152
TR 174,203,51200
s_waitcnt lgkmcnt(2)
MA 0,v,112,v,144
MA 4,v,116,v,144
MA 64,v,120,v,144
MA 68,v,124,v,144
MA 128,v,128,v,144
MA 132,v,132,v,144
MA 192,v,136,v,144
MA 196,v,140,v,144
MA 8,v,112,v,148
MA 12,v,116,v,148
s_waitcnt vmcnt(8) lgkmcnt(0)
s_barrier
MA 72,v,120,v,148
TR 144,196,0
TR 146,196,2048
MA 76,v,124,v,148
ds_read_b128 v[80:83], v192 offset:0
s_add_u32 m0, s23, 32768
MA 136,v,128,v,148
buffer_load_dword v79, v78, s[4:7], 0 offen
MA 140,v,132,v,148
s_add_u32 s84, s40, 50331648
s_addc_u32 s85, s41, 0
MA 200,v,136,v,148
buffer_load_dwordx4 v184, s[12:15], s21 offen offset:0 lds
s_mov_b32 s86, 4194304
MA 204,v,140,v,148
TR 148,197,0
TR 150,197,2048
MA 16,v,112,v,152
ds_read_b128 v[84:87], v192 offset:2048
s_mov_b32 s87, 0x20000
MA 20,v,116,v,152
s_add_u32 s88, s40, 58720256
s_addc_u32 s89, s41, 0
MA 80,v,120,v,152
buffer_load_dwordx4 v185, s[12:15], s21 offen offset:1024 lds
s_mov_b32 s90, 8192
MA 84,v,124,v,152
s_mov_b32 s91, 0x20000
v_mov_b32 v252, 0
MA 144,v,128,v,152
v_mov_b32 v253, 0
v_dot2_f32_bf16 v252, v230, v2, v252
MA 148,v,132,v,152
ds_read_b128 v[88:91], v192 offset:4096
v_dot2_f32_bf16 v253, v231, v3, v253
MA 208,v,136,v,152
v_dot2_f32_bf16 v252, v232, v4, v252
v_dot2_f32_bf16 v253, v233, v5, v253
MA 212,v,140,v,152
TR 152,198,0
TR 154,198,2048
MA 24,v,112,v,156
buffer_load_dwordx4 v186, s[12:15], s21 offen offset:2048 lds
v_dot2_f32_bf16 v252, v234, v6, v252
MA 28,v,116,v,156
v_dot2_f32_bf16 v253, v235, v7, v253
v_dot2_f32_bf16 v252, v236, v8, v252
MA 88,v,120,v,156
ds_read_b128 v[92:95], v192 offset:6144
v_dot2_f32_bf16 v253, v237, v9, v253
MA 92,v,124,v,156
buffer_load_dwordx4 v187, s[12:15], s21 offen offset:3072 lds
v_dot2_f32_bf16 v252, v238, v12, v252
MA 152,v,128,v,156
v_dot2_f32_bf16 v253, v239, v13, v253
v_dot2_f32_bf16 v252, v240, v14, v252
MA 156,v,132,v,156
v_dot2_f32_bf16 v253, v241, v15, v253
v_dot2_f32_bf16 v252, v242, v246, v252
MA 216,v,136,v,156
v_dot2_f32_bf16 v253, v243, v247, v253
v_dot2_f32_bf16 v252, v244, v248, v252
MA 220,v,140,v,156
TR 156,199,0
TR 158,199,2048
MA 32,v,112,v,160
ds_read_b128 v[96:99], v192 offset:8192
s_add_u32 m0, s23, 36864
MA 36,v,116,v,160
v_dot2_f32_bf16 v253, v245, v249, v253
MA 96,v,120,v,160
s_nop 2
v_add_f32 v252, v252, v253
MA 100,v,124,v,160
s_nop 0
v_add_f32_dpp v252, v252, v252 row_ror:8 row_mask:0xf bank_mask:0xf
s_nop 1
v_add_f32_dpp v252, v252, v252 row_ror:4 row_mask:0xf bank_mask:0xf
MA 160,v,128,v,160
ds_read_b128 v[100:103], v192 offset:10240
buffer_load_dwordx4 v188, s[12:15], s21 offen offset:0 lds
MA 164,v,132,v,160
v_add_f32_dpp v252, v252, v252 row_ror:2 row_mask:0xf bank_mask:0xf
s_nop 1
v_add_f32_dpp v252, v252, v252 row_ror:1 row_mask:0xf bank_mask:0xf
MA 224,v,136,v,160
v_mov_b32 v253, v252
s_nop 1
v_permlane16_swap_b32 v252, v253
MA 228,v,140,v,160
TR 160,200,0
TR 162,200,2048
MA 40,v,112,v,164
buffer_load_dwordx4 v189, s[12:15], s21 offen offset:1024 lds
v_add_f32 v252, v252, v253
MA 44,v,116,v,164
ds_read_b128 v[104:107], v192 offset:12288
v_mul_f32 v252, 0xbfb8aa3b, v252
MA 104,v,120,v,164
v_exp_f32 v252, v252
MA 108,v,124,v,164
v_add_f32 v252, 1.0, v252
MA 168,v,128,v,164
buffer_load_dwordx4 v190, s[12:15], s21 offen offset:2048 lds
MA 172,v,132,v,164
v_rcp_f32 v252, v252
MA 232,v,136,v,164
ds_read_b128 v[108:111], v192 offset:14336
MA 236,v,140,v,164
TR 164,201,0
TR 166,201,2048
MA 48,v,112,v,168
s_nop 0
buffer_store_dword v252, v11, s[88:91], 0 offen sc1
MA 52,v,116,v,168
buffer_load_dwordx4 v191, s[12:15], s21 offen offset:3072 lds
v_lshlrev_b32 v2, 16, v54
MA 112,v,120,v,168
v_and_b32 v3, 0xffff0000, v54
v_lshlrev_b32 v4, 16, v55
MA 116,v,124,v,168
v_and_b32 v5, 0xffff0000, v55
v_lshlrev_b32 v6, 16, v56
MA 176,v,128,v,168
v_and_b32 v7, 0xffff0000, v56
v_lshlrev_b32 v8, 16, v57
MA 180,v,132,v,168
s_add_u32 s21, s21, 524288
v_and_b32 v9, 0xffff0000, v57
MA 240,v,136,v,168
v_lshlrev_b32 v230, 16, v16
v_and_b32 v231, 0xffff0000, v16
MA 244,v,140,v,168
TR 168,202,0
TR 170,202,2048
MA 56,v,112,v,172
v_lshlrev_b32 v232, 16, v18
v_and_b32 v233, 0xffff0000, v18
MA 60,v,116,v,172
s_and_b32 s21, s21, 4194303
v_lshlrev_b32 v234, 16, v20
MA 120,v,120,v,172
v_and_b32 v235, 0xffff0000, v20
v_lshlrev_b32 v236, 16, v22
MA 124,v,124,v,172
v_and_b32 v237, 0xffff0000, v22
v_lshlrev_b32 v238, 16, v24
MA 184,v,128,v,172
v_and_b32 v239, 0xffff0000, v24
v_lshlrev_b32 v240, 16, v26
MA 188,v,132,v,172
v_and_b32 v241, 0xffff0000, v26
v_lshlrev_b32 v242, 16, v28
MA 248,v,136,v,172
v_and_b32 v243, 0xffff0000, v28
v_lshlrev_b32 v244, 16, v30
MA 252,v,140,v,172
TR 172,203,0
TR 174,203,2048
v_and_b32 v245, 0xffff0000, v30
v_lshlrev_b32 v246, 16, v32
v_and_b32 v247, 0xffff0000, v32
v_lshlrev_b32 v248, 16, v34
v_and_b32 v249, 0xffff0000, v34
v_lshlrev_b32 v250, 16, v36
v_and_b32 v251, 0xffff0000, v36
v_lshlrev_b32 v254, 16, v38
v_and_b32 v255, 0xffff0000, v38
v_mul_f32 v62, v236, v2
v_mul_f32 v70, v237, v6
v_fmac_f32 v62, v234, v3
v_fmac_f32 v70, v235, v7
v_fmac_f32 v62, v232, v4
v_fmac_f32 v70, v233, v8
v_fmac_f32 v62, v230, v5
v_fmac_f32 v70, v231, v9
v_mul_f32 v62, v62, v254
s_waitcnt lgkmcnt(2)
MA 0,v,80,v,144
s_add_u32 s75, s64, s74
v_mul_f32 v70, v70, v255
MA 4,v,84,v,144
ds_read_b128 v[112:115], v193 offset:0
v_lshlrev_b32 v254, 16, v40
MA 64,v,88,v,144
v_and_b32 v255, 0xffff0000, v40
v_mul_f32 v63, v238, v2
MA 68,v,92,v,144
v_mul_f32 v71, v239, v6
v_fmac_f32 v63, v236, v3
MA 128,v,96,v,144
s_add_u32 m0, s67, 65536
v_fmac_f32 v71, v237, v7
MA 132,v,100,v,144
v_fmac_f32 v63, v234, v4
MA 192,v,104,v,144
v_fmac_f32 v71, v235, v8
MA 196,v,108,v,144
TR 144,196,16384
TR 146,196,18432
MA 8,v,80,v,148
ds_read_b128 v[116:119], v193 offset:2048
buffer_load_dwordx4 v208, s[44:47], s75 offen offset:0 lds
MA 12,v,84,v,148
v_fmac_f32 v63, v232, v5
v_fmac_f32 v71, v233, v9
MA 72,v,88,v,148
v_mul_f32 v63, v63, v254
v_mul_f32 v71, v71, v255
MA 76,v,92,v,148
v_lshlrev_b32 v254, 16, v42
v_and_b32 v255, 0xffff0000, v42
MA 136,v,96,v,148
v_mul_f32 v64, v240, v2
v_mul_f32 v72, v241, v6
MA 140,v,100,v,148
ds_read_b128 v[120:123], v193 offset:4096
buffer_load_dwordx4 v209, s[44:47], s75 offen offset:1024 lds
MA 200,v,104,v,148
v_fmac_f32 v64, v238, v3
v_fmac_f32 v72, v239, v7
MA 204,v,108,v,148
TR 148,197,16384
TR 150,197,18432
MA 16,v,80,v,152
v_fmac_f32 v64, v236, v4
v_fmac_f32 v72, v237, v8
MA 20,v,84,v,152
buffer_load_dwordx4 v210, s[44:47], s75 offen offset:2048 lds
v_fmac_f32 v64, v234, v5
MA 80,v,88,v,152
v_fmac_f32 v72, v235, v9
v_mul_f32 v64, v64, v254
MA 84,v,92,v,152
v_mul_f32 v72, v72, v255
v_lshlrev_b32 v254, 16, v44
MA 144,v,96,v,152
ds_read_b128 v[124:127], v193 offset:6144
v_and_b32 v255, 0xffff0000, v44
MA 148,v,100,v,152
v_mul_f32 v65, v242, v2
MA 208,v,104,v,152
buffer_load_dwordx4 v211, s[44:47], s75 offen offset:3072 lds
v_mul_f32 v73, v243, v6
MA 212,v,108,v,152
TR 152,198,16384
TR 154,198,18432
MA 24,v,80,v,156
v_fmac_f32 v65, v240, v3
v_fmac_f32 v73, v241, v7
MA 28,v,84,v,156
v_fmac_f32 v65, v238, v4
v_fmac_f32 v73, v239, v8
MA 88,v,88,v,156
ds_read_b128 v[128:131], v193 offset:8192
s_add_u32 s75, s65, s74
MA 92,v,92,v,156
v_fmac_f32 v65, v236, v5
v_fmac_f32 v73, v237, v9
MA 152,v,96,v,156
v_mul_f32 v65, v65, v254
v_mul_f32 v73, v73, v255
MA 156,v,100,v,156
v_lshlrev_b32 v254, 16, v46
MA 216,v,104,v,156
v_and_b32 v255, 0xffff0000, v46
MA 220,v,108,v,156
TR 156,199,16384
TR 158,199,18432
MA 32,v,80,v,160
ds_read_b128 v[132:135], v193 offset:10240
s_add_u32 m0, s67, 69632
MA 36,v,84,v,160
v_mul_f32 v66, v244, v2
v_mul_f32 v74, v245, v6
MA 96,v,88,v,160
v_fmac_f32 v66, v242, v3
v_fmac_f32 v74, v243, v7
MA 100,v,92,v,160
buffer_load_dwordx4 v208, s[44:47], s75 offen offset:0 lds
v_fmac_f32 v66, v240, v4
MA 160,v,96,v,160
v_fmac_f32 v74, v241, v8
v_fmac_f32 v66, v238, v5
MA 164,v,100,v,160
v_fmac_f32 v74, v239, v9
v_mul_f32 v66, v66, v254
MA 224,v,104,v,160
v_mul_f32 v74, v74, v255
v_lshlrev_b32 v254, 16, v48
MA 228,v,108,v,160
TR 160,200,16384
TR 162,200,18432
MA 40,v,80,v,164
ds_read_b128 v[136:139], v193 offset:12288
buffer_load_dwordx4 v209, s[44:47], s75 offen offset:1024 lds
MA 44,v,84,v,164
v_and_b32 v255, 0xffff0000, v48
v_mul_f32 v67, v246, v2
MA 104,v,88,v,164
v_mul_f32 v75, v247, v6
v_fmac_f32 v67, v244, v3
MA 108,v,92,v,164
v_fmac_f32 v75, v245, v7
v_fmac_f32 v67, v242, v4
MA 168,v,96,v,164
buffer_load_dwordx4 v210, s[44:47], s75 offen offset:2048 lds
v_fmac_f32 v75, v243, v8
MA 172,v,100,v,164
ds_read_b128 v[140:143], v193 offset:14336
v_fmac_f32 v67, v240, v5
MA 232,v,104,v,164
v_fmac_f32 v75, v241, v9
v_mul_f32 v67, v67, v254
MA 236,v,108,v,164
TR 164,201,16384
TR 166,201,18432
MA 48,v,80,v,168
buffer_load_dwordx4 v211, s[44:47], s75 offen offset:3072 lds
v_mul_f32 v75, v75, v255
MA 52,v,84,v,168
v_lshlrev_b32 v254, 16, v50
v_and_b32 v255, 0xffff0000, v50
MA 112,v,88,v,168
v_mul_f32 v68, v248, v2
v_mul_f32 v76, v249, v6
MA 116,v,92,v,168
v_fmac_f32 v68, v246, v3
MA 176,v,96,v,168
v_fmac_f32 v76, v247, v7
MA 180,v,100,v,168
s_add_u32 s74, s74, 128
v_fmac_f32 v68, v244, v4
MA 240,v,104,v,168
v_fmac_f32 v76, v245, v8
v_fmac_f32 v68, v242, v5
MA 244,v,108,v,168
TR 168,202,16384
TR 170,202,18432
s_waitcnt lgkmcnt(15)
MA 56,v,80,v,172
v_fmac_f32 v76, v243, v9
v_mul_f32 v68, v68, v254
MA 60,v,84,v,172
s_and_b32 s74, s74, 2047
v_mul_f32 v76, v76, v255
MA 120,v,88,v,172
v_lshlrev_b32 v254, 16, v52
v_and_b32 v255, 0xffff0000, v52
MA 124,v,92,v,172
v_mul_f32 v69, v250, v2
MA 184,v,96,v,172
v_mul_f32 v77, v251, v6
MA 188,v,100,v,172
v_fmac_f32 v69, v248, v3
MA 248,v,104,v,172
MA 252,v,108,v,172
TR 172,203,16384
TR 174,203,18432
s_waitcnt lgkmcnt(2)
MA 0,v,112,v,144
MA 4,v,116,v,144
MA 64,v,120,v,144
MA 68,v,124,v,144
MA 128,v,128,v,144
MA 132,v,132,v,144
MA 192,v,136,v,144
MA 196,v,140,v,144
MA 8,v,112,v,148
MA 12,v,116,v,148
s_waitcnt vmcnt(8) lgkmcnt(0)
s_barrier
MA 72,v,120,v,148
TR 144,196,32768
TR 146,196,34816
MA 76,v,124,v,148
ds_read_b128 v[80:83], v192 offset:32768
s_add_u32 m0, s68, 98304
MA 136,v,128,v,148
v_fmac_f32 v77, v249, v7
v_fmac_f32 v69, v246, v4
MA 140,v,132,v,148
buffer_load_dwordx4 v212, s[48:51], s66 offen offset:0 lds
v_fmac_f32 v77, v247, v8
MA 200,v,136,v,148
v_fmac_f32 v69, v244, v5
v_fmac_f32 v77, v245, v9
MA 204,v,140,v,148
TR 148,197,32768
TR 150,197,34816
MA 16,v,112,v,152
ds_read_b128 v[84:87], v192 offset:34816
v_mul_f32 v69, v69, v254
MA 20,v,116,v,152
buffer_load_dwordx4 v213, s[48:51], s66 offen offset:1024 lds
v_mul_f32 v77, v77, v255
MA 80,v,120,v,152
v_cvt_pk_bf16_f32 v12, v69, v68
v_cvt_pk_bf16_f32 v13, v67, v66
MA 84,v,124,v,152
v_cvt_pk_bf16_f32 v14, v65, v64
v_cvt_pk_bf16_f32 v15, v63, v62
MA 144,v,128,v,152
s_mov_b32 s36, 0
buffer_store_dwordx4 v[12:15], v10, s[84:87], s36 offen sc1
MA 148,v,132,v,152
ds_read_b128 v[88:91], v192 offset:36864
buffer_load_dwordx4 v214, s[48:51], s66 offen offset:2048 lds
MA 208,v,136,v,152
v_cvt_pk_bf16_f32 v54, v77, v76
v_cvt_pk_bf16_f32 v55, v75, v74
MA 212,v,140,v,152
TR 152,198,32768
TR 154,198,34816
MA 24,v,112,v,156
buffer_load_dwordx4 v215, s[48:51], s66 offen offset:3072 lds
v_cvt_pk_bf16_f32 v56, v73, v72
MA 28,v,116,v,156
v_cvt_pk_bf16_f32 v57, v71, v70
s_mov_b32 s36, 4096
MA 88,v,120,v,156
ds_read_b128 v[92:95], v192 offset:38912
buffer_store_dwordx4 v[54:57], v10, s[84:87], s36 offen sc1
MA 92,v,124,v,156
v_lshlrev_b32 v2, 16, v58
v_and_b32 v3, 0xffff0000, v58
MA 152,v,128,v,156
s_add_u32 s66, s66, 524288
v_lshlrev_b32 v4, 16, v59
MA 156,v,132,v,156
v_and_b32 v5, 0xffff0000, v59
v_lshlrev_b32 v6, 16, v60
MA 216,v,136,v,156
v_and_b32 v7, 0xffff0000, v60
v_lshlrev_b32 v8, 16, v61
MA 220,v,140,v,156
TR 156,199,32768
TR 158,199,34816
MA 32,v,112,v,160
ds_read_b128 v[96:99], v192 offset:40960
s_and_b32 s66, s66, 8388607
MA 36,v,116,v,160
v_and_b32 v9, 0xffff0000, v61
v_lshlrev_b32 v230, 16, v17
MA 96,v,120,v,160
v_and_b32 v231, 0xffff0000, v17
v_lshlrev_b32 v232, 16, v19
MA 100,v,124,v,160
v_and_b32 v233, 0xffff0000, v19
v_lshlrev_b32 v234, 16, v21
MA 160,v,128,v,160
ds_read_b128 v[100:103], v192 offset:43008
s_add_u32 m0, s68, 114688
MA 164,v,132,v,160
v_and_b32 v235, 0xffff0000, v21
v_lshlrev_b32 v236, 16, v23
MA 224,v,136,v,160
v_and_b32 v237, 0xffff0000, v23
v_lshlrev_b32 v238, 16, v25
MA 228,v,140,v,160
TR 160,200,32768
TR 162,200,34816
MA 40,v,112,v,164
buffer_load_dwordx4 v212, s[48:51], s66 offen offset:0 lds
v_and_b32 v239, 0xffff0000, v25
MA 44,v,116,v,164
ds_read_b128 v[104:107], v192 offset:45056
v_lshlrev_b32 v240, 16, v27
MA 104,v,120,v,164
v_and_b32 v241, 0xffff0000, v27
v_lshlrev_b32 v242, 16, v29
MA 108,v,124,v,164
buffer_load_dwordx4 v213, s[48:51], s66 offen offset:1024 lds
v_and_b32 v243, 0xffff0000, v29
MA 168,v,128,v,164
v_lshlrev_b32 v244, 16, v31
v_and_b32 v245, 0xffff0000, v31
MA 172,v,132,v,164
v_lshlrev_b32 v246, 16, v33
v_and_b32 v247, 0xffff0000, v33
MA 232,v,136,v,164
ds_read_b128 v[108:111], v192 offset:47104
v_lshlrev_b32 v248, 16, v35
MA 236,v,140,v,164
TR 164,201,32768
TR 166,201,34816
MA 48,v,112,v,168
buffer_load_dwordx4 v214, s[48:51], s66 offen offset:2048 lds
v_and_b32 v249, 0xffff0000, v35
MA 52,v,116,v,168
v_lshlrev_b32 v250, 16, v37
v_and_b32 v251, 0xffff0000, v37
MA 112,v,120,v,168
buffer_load_dwordx4 v215, s[48:51], s66 offen offset:3072 lds
v_lshlrev_b32 v254, 16, v39
MA 116,v,124,v,168
v_and_b32 v255, 0xffff0000, v39
v_mul_f32 v62, v236, v2
MA 176,v,128,v,168
v_mul_f32 v70, v237, v6
v_fmac_f32 v62, v234, v3
MA 180,v,132,v,168
v_fmac_f32 v70, v235, v7
v_fmac_f32 v62, v232, v4
MA 240,v,136,v,168
s_add_u32 s66, s66, 524288
v_fmac_f32 v70, v233, v8
MA 244,v,140,v,168
TR 168,202,32768
TR 170,202,34816
MA 56,v,112,v,172
v_fmac_f32 v62, v230, v5
v_fmac_f32 v70, v231, v9
MA 60,v,116,v,172
v_mul_f32 v62, v62, v254
v_mul_f32 v70, v70, v255
MA 120,v,120,v,172
s_and_b32 s66, s66, 8388607
v_lshlrev_b32 v254, 16, v41
MA 124,v,124,v,172
v_and_b32 v255, 0xffff0000, v41
v_mul_f32 v63, v238, v2
MA 184,v,128,v,172
v_mul_f32 v71, v239, v6
v_fmac_f32 v63, v236, v3
MA 188,v,132,v,172
v_fmac_f32 v71, v237, v7
v_fmac_f32 v63, v234, v4
MA 248,v,136,v,172
v_fmac_f32 v71, v235, v8
v_fmac_f32 v63, v232, v5
MA 252,v,140,v,172
TR 172,203,32768
TR 174,203,34816
v_fmac_f32 v71, v233, v9
v_mul_f32 v63, v63, v254
v_mul_f32 v71, v71, v255
v_lshlrev_b32 v254, 16, v43
v_and_b32 v255, 0xffff0000, v43
v_mul_f32 v64, v240, v2
v_mul_f32 v72, v241, v6
v_fmac_f32 v64, v238, v3
s_waitcnt lgkmcnt(2)
MA 0,v,80,v,144
s_add_u32 s75, s64, s74
v_fmac_f32 v72, v239, v7
MA 4,v,84,v,144
ds_read_b128 v[112:115], v193 offset:32768
v_fmac_f32 v64, v236, v4
MA 64,v,88,v,144
v_fmac_f32 v72, v237, v8
v_fmac_f32 v64, v234, v5
MA 68,v,92,v,144
v_fmac_f32 v72, v235, v9
v_mul_f32 v64, v64, v254
MA 128,v,96,v,144
s_add_u32 m0, s67, 0
v_mul_f32 v72, v72, v255
MA 132,v,100,v,144
v_lshlrev_b32 v254, 16, v45
v_and_b32 v255, 0xffff0000, v45
MA 192,v,104,v,144
v_mul_f32 v65, v242, v2
MA 196,v,108,v,144
TR 144,196,49152
TR 146,196,51200
MA 8,v,80,v,148
ds_read_b128 v[116:119], v193 offset:34816
buffer_load_dwordx4 v208, s[44:47], s75 offen offset:0 lds
MA 12,v,84,v,148
v_mul_f32 v73, v243, v6
v_fmac_f32 v65, v240, v3
MA 72,v,88,v,148
v_fmac_f32 v73, v241, v7
v_fmac_f32 v65, v238, v4
MA 76,v,92,v,148
v_fmac_f32 v73, v239, v8
v_fmac_f32 v65, v236, v5
MA 136,v,96,v,148
v_fmac_f32 v73, v237, v9
v_mul_f32 v65, v65, v254
MA 140,v,100,v,148
ds_read_b128 v[120:123], v193 offset:36864
buffer_load_dwordx4 v209, s[44:47], s75 offen offset:1024 lds
MA 200,v,104,v,148
v_mul_f32 v73, v73, v255
v_lshlrev_b32 v254, 16, v47
MA 204,v,108,v,148
TR 148,197,49152
TR 150,197,51200
MA 16,v,80,v,152
v_and_b32 v255, 0xffff0000, v47
v_mul_f32 v66, v244, v2
MA 20,v,84,v,152
buffer_load_dwordx4 v210, s[44:47], s75 offen offset:2048 lds
v_mul_f32 v74, v245, v6
MA 80,v,88,v,152
v_fmac_f32 v66, v242, v3
v_fmac_f32 v74, v243, v7
MA 84,v,92,v,152
v_fmac_f32 v66, v240, v4
v_fmac_f32 v74, v241, v8
MA 144,v,96,v,152
ds_read_b128 v[124:127], v193 offset:38912
v_fmac_f32 v66, v238, v5
MA 148,v,100,v,152
v_fmac_f32 v74, v239, v9
v_mul_f32 v66, v66, v254
MA 208,v,104,v,152
buffer_load_dwordx4 v211, s[44:47], s75 offen offset:3072 lds
v_mul_f32 v74, v74, v255
MA 212,v,108,v,152
TR 152,198,49152
TR 154,198,51200
MA 24,v,80,v,156
v_lshlrev_b32 v254, 16, v49
v_and_b32 v255, 0xffff0000, v49
MA 28,v,84,v,156
v_mul_f32 v67, v246, v2
v_mul_f32 v75, v247, v6
MA 88,v,88,v,156
ds_read_b128 v[128:131], v193 offset:40960
s_add_u32 s75, s65, s74
MA 92,v,92,v,156
v_fmac_f32 v67, v244, v3
v_fmac_f32 v75, v245, v7
MA 152,v,96,v,156
v_fmac_f32 v67, v242, v4
v_fmac_f32 v75, v243, v8
MA 156,v,100,v,156
v_fmac_f32 v67, v240, v5
v_fmac_f32 v75, v241, v9
MA 216,v,104,v,156
v_mul_f32 v67, v67, v254
v_mul_f32 v75, v75, v255
MA 220,v,108,v,156
TR 156,199,49152
TR 158,199,51200
MA 32,v,80,v,160
ds_read_b128 v[132:135], v193 offset:43008
s_add_u32 m0, s67, 4096
MA 36,v,84,v,160
v_lshlrev_b32 v254, 16, v51
v_and_b32 v255, 0xffff0000, v51
MA 96,v,88,v,160
v_mul_f32 v68, v248, v2
v_mul_f32 v76, v249, v6
MA 100,v,92,v,160
buffer_load_dwordx4 v208, s[44:47], s75 offen offset:0 lds
v_fmac_f32 v68, v246, v3
MA 160,v,96,v,160
v_fmac_f32 v76, v247, v7
v_fmac_f32 v68, v244, v4
MA 164,v,100,v,160
v_fmac_f32 v76, v245, v8
v_fmac_f32 v68, v242, v5
MA 224,v,104,v,160
v_fmac_f32 v76, v243, v9
v_mul_f32 v68, v68, v254
MA 228,v,108,v,160
TR 160,200,49152
TR 162,200,51200
MA 40,v,80,v,164
ds_read_b128 v[136:139], v193 offset:45056
buffer_load_dwordx4 v209, s[44:47], s75 offen offset:1024 lds
MA 44,v,84,v,164
v_mul_f32 v76, v76, v255
v_lshlrev_b32 v254, 16, v53
MA 104,v,88,v,164
v_and_b32 v255, 0xffff0000, v53
v_mul_f32 v69, v250, v2
MA 108,v,92,v,164
v_mul_f32 v77, v251, v6
v_fmac_f32 v69, v248, v3
MA 168,v,96,v,164
buffer_load_dwordx4 v210, s[44:47], s75 offen offset:2048 lds
v_fmac_f32 v77, v249, v7
MA 172,v,100,v,164
ds_read_b128 v[140:143], v193 offset:47104
v_fmac_f32 v69, v246, v4
MA 232,v,104,v,164
v_fmac_f32 v77, v247, v8
v_fmac_f32 v69, v244, v5
MA 236,v,108,v,164
TR 164,201,49152
TR 166,201,51200
MA 48,v,80,v,168
buffer_load_dwordx4 v211, s[44:47], s75 offen offset:3072 lds
v_fmac_f32 v77, v245, v9
MA 52,v,84,v,168
v_mul_f32 v69, v69, v254
v_mul_f32 v77, v77, v255
MA 112,v,88,v,168
v_cvt_pk_bf16_f32 v230, v69, v68
v_cvt_pk_bf16_f32 v231, v67, v66
MA 116,v,92,v,168
v_cvt_pk_bf16_f32 v232, v65, v64
v_cvt_pk_bf16_f32 v233, v63, v62
MA 176,v,96,v,168
s_mov_b32 s36, 8192
buffer_store_dwordx4 v[230:233], v10, s[84:87], s36 offen sc1
MA 180,v,100,v,168
s_add_u32 s74, s74, 128
v_cvt_pk_bf16_f32 v234, v77, v76
MA 240,v,104,v,168
v_cvt_pk_bf16_f32 v235, v75, v74
v_cvt_pk_bf16_f32 v236, v73, v72
MA 244,v,108,v,168
TR 168,202,49152
TR 170,202,51200
s_waitcnt lgkmcnt(15)
MA 56,v,80,v,172
v_cvt_pk_bf16_f32 v237, v71, v70
s_mov_b32 s36, 12288
MA 60,v,84,v,172
s_and_b32 s74, s74, 2047
buffer_store_dwordx4 v[234:237], v10, s[84:87], s36 offen sc1
MA 120,v,88,v,172
v_lshrrev_b32 v230, 5, v1
v_lshlrev_b32 v230, 12, v230
MA 124,v,92,v,172
v_and_b32 v231, 15, v1
v_lshl_add_u32 v230, v231, 4, v230
MA 184,v,96,v,172
v_bfe_u32 v231, v1, 4, 1
MA 188,v,100,v,172
v_lshl_add_u32 v228, v231, 9, v230
MA 248,v,104,v,172
MA 252,v,108,v,172
TR 172,203,49152
TR 174,203,51200
s_waitcnt lgkmcnt(2)
MA 0,v,112,v,144
MA 4,v,116,v,144
MA 64,v,120,v,144
MA 68,v,124,v,144
MA 128,v,128,v,144
MA 132,v,132,v,144
MA 192,v,136,v,144
MA 196,v,140,v,144
MA 8,v,112,v,148
MA 12,v,116,v,148
s_waitcnt vmcnt(15) lgkmcnt(0)
s_barrier
MA 72,v,120,v,148
ds_read_b128 v[48:51], v226 offset:0
s_add_u32 m0, s68, 131072
MA 76,v,124,v,148
MA 136,v,128,v,148
ds_read_b128 v[52:55], v226 offset:2048
buffer_load_dwordx4 v212, s[48:51], s66 offen offset:0 lds
MA 140,v,132,v,148
MA 200,v,136,v,148
ds_read_b128 v[56:59], v226 offset:4096
buffer_load_dwordx4 v213, s[48:51], s66 offen offset:1024 lds
MA 204,v,140,v,148
MA 16,v,112,v,152
ds_read_b128 v[60:63], v226 offset:6144
MA 20,v,116,v,152
buffer_load_dwordx4 v214, s[48:51], s66 offen offset:2048 lds
MA 80,v,120,v,152
TR 16,216,0
MA 84,v,124,v,152
buffer_load_dwordx4 v215, s[48:51], s66 offen offset:3072 lds
MA 144,v,128,v,152
TR 18,216,1024
MA 148,v,132,v,152
MA 208,v,136,v,152
TR 20,217,0
s_add_u32 s66, s66, 524288
MA 212,v,140,v,152
MA 24,v,112,v,156
TR 22,217,1024
s_and_b32 s66, s66, 8388607
MA 28,v,116,v,156
MA 88,v,120,v,156
TR 24,218,0
MA 92,v,124,v,156
s_add_u32 s75, s64, s74
MA 152,v,128,v,156
TR 26,218,1024
MA 156,v,132,v,156
s_add_u32 m0, s67, 32768
MA 216,v,136,v,156
TR 28,219,0
MA 220,v,140,v,156
MA 32,v,112,v,160
TR 30,219,1024
buffer_load_dwordx4 v208, s[44:47], s75 offen offset:0 lds
MA 36,v,116,v,160
MA 96,v,120,v,160
TR 32,220,0
buffer_load_dwordx4 v209, s[44:47], s75 offen offset:1024 lds
MA 100,v,124,v,160
MA 160,v,128,v,160
TR 34,220,1024
MA 164,v,132,v,160
buffer_load_dwordx4 v210, s[44:47], s75 offen offset:2048 lds
MA 224,v,136,v,160
TR 36,221,0
MA 228,v,140,v,160
buffer_load_dwordx4 v211, s[44:47], s75 offen offset:3072 lds
MA 40,v,112,v,164
TR 38,221,1024
MA 44,v,116,v,164
MA 104,v,120,v,164
TR 40,222,0
s_add_u32 s75, s65, s74
MA 108,v,124,v,164
MA 168,v,128,v,164
TR 42,222,1024
s_add_u32 m0, s67, 36864
MA 172,v,132,v,164
MA 232,v,136,v,164
TR 44,223,0
MA 236,v,140,v,164
buffer_load_dwordx4 v208, s[44:47], s75 offen offset:0 lds
MA 48,v,112,v,168
TR 46,223,1024
MA 52,v,116,v,168
buffer_load_dwordx4 v209, s[44:47], s75 offen offset:1024 lds
MA 112,v,120,v,168
MA 116,v,124,v,168
MA 176,v,128,v,168
buffer_load_dwordx4 v210, s[44:47], s75 offen offset:2048 lds
MA 180,v,132,v,168
MA 240,v,136,v,168
buffer_load_dwordx4 v211, s[44:47], s75 offen offset:3072 lds
MA 244,v,140,v,168
MA 56,v,112,v,172
MA 60,v,116,v,172
s_add_u32 s74, s74, 128
MA 120,v,120,v,172
MA 124,v,124,v,172
s_and_b32 s74, s74, 2047
MA 184,v,128,v,172
MA 188,v,132,v,172
MA 248,v,136,v,172
MA 252,v,140,v,172
L_p2:
s_waitcnt lgkmcnt(4)
v_mfma_f32_16x16x32_bf16 v[80:83], v[16:19], v[48:51], 0
s_add_u32 s8, s40, 59768832
s_addc_u32 s9, s41, 0
v_mfma_f32_16x16x32_bf16 v[84:87], v[16:19], v[52:55], 0
ds_read_b128 v[64:67], v227 offset:0
v_mfma_f32_16x16x32_bf16 v[88:91], v[16:19], v[56:59], 0
s_mov_b32 s10, 4096
v_mfma_f32_16x16x32_bf16 v[92:95], v[16:19], v[60:63], 0
TR 16,216,8192
TR 18,216,9216
v_mfma_f32_16x16x32_bf16 v[96:99], v[20:23], v[48:51], 0
s_mov_b32 s11, 0x20000
s_mov_b32 s12, s38
v_mfma_f32_16x16x32_bf16 v[100:103], v[20:23], v[52:55], 0
s_mov_b32 s13, s39
v_mfma_f32_16x16x32_bf16 v[104:107], v[20:23], v[56:59], 0
ds_read_b128 v[68:71], v227 offset:2048
s_mov_b32 s14, 256
v_mfma_f32_16x16x32_bf16 v[108:111], v[20:23], v[60:63], 0
TR 20,217,8192
TR 22,217,9216
v_mfma_f32_16x16x32_bf16 v[112:115], v[24:27], v[48:51], 0
s_mov_b32 s15, 0x20000
v_accvgpr_read_b32 v234, a0
v_mfma_f32_16x16x32_bf16 v[116:119], v[24:27], v[52:55], 0
v_accvgpr_read_b32 v235, a1
v_mfma_f32_16x16x32_bf16 v[120:123], v[24:27], v[56:59], 0
v_accvgpr_read_b32 v236, a2
v_mfma_f32_16x16x32_bf16 v[124:127], v[24:27], v[60:63], 0
TR 24,218,8192
TR 26,218,9216
v_mfma_f32_16x16x32_bf16 v[128:131], v[28:31], v[48:51], 0
ds_read_b128 v[72:75], v227 offset:4096
v_accvgpr_read_b32 v237, a3
v_mfma_f32_16x16x32_bf16 v[132:135], v[28:31], v[52:55], 0
v_accvgpr_read_b32 v238, a4
v_accvgpr_read_b32 v239, a5
v_mfma_f32_16x16x32_bf16 v[136:139], v[28:31], v[56:59], 0
v_accvgpr_read_b32 v240, a6
v_mfma_f32_16x16x32_bf16 v[140:143], v[28:31], v[60:63], 0
TR 28,219,8192
TR 30,219,9216
v_mfma_f32_16x16x32_bf16 v[144:147], v[32:35], v[48:51], 0
v_accvgpr_read_b32 v241, a7
v_cvt_pk_bf16_f32 v230, v234, v235
v_mfma_f32_16x16x32_bf16 v[148:151], v[32:35], v[52:55], 0
v_cvt_pk_bf16_f32 v231, v236, v237
v_mfma_f32_16x16x32_bf16 v[152:155], v[32:35], v[56:59], 0
ds_read_b128 v[76:79], v227 offset:6144
v_cvt_pk_bf16_f32 v232, v238, v239
v_mfma_f32_16x16x32_bf16 v[156:159], v[32:35], v[60:63], 0
TR 32,220,8192
TR 34,220,9216
v_mfma_f32_16x16x32_bf16 v[160:163], v[36:39], v[48:51], 0
v_cvt_pk_bf16_f32 v233, v240, v241
buffer_store_dwordx4 v[230:233], v228, s[16:19], s24 offen sc1
v_mfma_f32_16x16x32_bf16 v[164:167], v[36:39], v[52:55], 0
v_accvgpr_read_b32 v246, a8
v_mfma_f32_16x16x32_bf16 v[168:171], v[36:39], v[56:59], 0
v_accvgpr_read_b32 v247, a9
v_mfma_f32_16x16x32_bf16 v[172:175], v[36:39], v[60:63], 0
TR 36,221,8192
TR 38,221,9216
s_waitcnt lgkmcnt(15)
v_mfma_f32_16x16x32_bf16 v[176:179], v[40:43], v[48:51], 0
v_accvgpr_read_b32 v248, a10
v_accvgpr_read_b32 v249, a11
v_mfma_f32_16x16x32_bf16 v[180:183], v[40:43], v[52:55], 0
v_accvgpr_read_b32 v250, a12
v_mfma_f32_16x16x32_bf16 v[184:187], v[40:43], v[56:59], 0
v_accvgpr_read_b32 v251, a13
v_mfma_f32_16x16x32_bf16 v[188:191], v[40:43], v[60:63], 0
TR 40,222,8192
TR 42,222,9216
v_mfma_f32_16x16x32_bf16 v[192:195], v[44:47], v[48:51], 0
v_accvgpr_read_b32 v252, a14
v_accvgpr_read_b32 v253, a15
v_mfma_f32_16x16x32_bf16 v[196:199], v[44:47], v[52:55], 0
v_cvt_pk_bf16_f32 v242, v246, v247
v_mfma_f32_16x16x32_bf16 v[200:203], v[44:47], v[56:59], 0
v_mfma_f32_16x16x32_bf16 v[204:207], v[44:47], v[60:63], 0
TR 44,223,8192
TR 46,223,9216
s_waitcnt lgkmcnt(4)
MV 80,v,16,v,64
v_cvt_pk_bf16_f32 v243, v248, v249
MV 84,v,16,v,68
v_cvt_pk_bf16_f32 v244, v250, v251
MV 88,v,16,v,72
v_cvt_pk_bf16_f32 v245, v252, v253
MV 92,v,16,v,76
MV 96,v,20,v,64
buffer_store_dwordx4 v[242:245], v228, s[16:19], s25 offen sc1
MV 100,v,20,v,68
v_accvgpr_read_b32 v234, a16
MV 104,v,20,v,72
v_accvgpr_read_b32 v235, a17
MV 108,v,20,v,76
s_waitcnt vmcnt(16) lgkmcnt(0)
s_barrier
MV 112,v,24,v,64
TR 16,216,16384
TR 18,216,17408
MV 116,v,24,v,68
ds_read_b128 v[48:51], v224 offset:0
s_add_u32 m0, s68, 98304
MV 120,v,24,v,72
TR 20,217,16384
TR 22,217,17408
MV 124,v,24,v,76
buffer_load_dwordx4 v212, s[48:51], s66 offen offset:0 lds
v_accvgpr_read_b32 v236, a18
MV 128,v,28,v,64
TR 24,218,16384
TR 26,218,17408
MV 132,v,28,v,68
ds_read_b128 v[52:55], v224 offset:2048
buffer_load_dwordx4 v213, s[48:51], s66 offen offset:1024 lds
MV 136,v,28,v,72
buffer_load_dwordx4 v214, s[48:51], s66 offen offset:2048 lds
v_accvgpr_read_b32 v237, a19
MV 140,v,28,v,76
TR 28,219,16384
TR 30,219,17408
MV 144,v,32,v,64
ds_read_b128 v[56:59], v224 offset:4096
v_accvgpr_read_b32 v238, a20
MV 148,v,32,v,68
buffer_load_dwordx4 v215, s[48:51], s66 offen offset:3072 lds
v_accvgpr_read_b32 v239, a21
MV 152,v,32,v,72
v_accvgpr_read_b32 v240, a22
v_accvgpr_read_b32 v241, a23
MV 156,v,32,v,76
TR 32,220,16384
TR 34,220,17408
MV 160,v,36,v,64
ds_read_b128 v[60:63], v224 offset:6144
s_add_u32 s66, s66, 524288
MV 164,v,36,v,68
s_and_b32 s66, s66, 8388607
v_cvt_pk_bf16_f32 v230, v234, v235
MV 168,v,36,v,72
v_cvt_pk_bf16_f32 v231, v236, v237
v_cvt_pk_bf16_f32 v232, v238, v239
MV 172,v,36,v,76
TR 36,221,16384
TR 38,221,17408
MV 176,v,40,v,64
s_add_u32 s75, s64, s74
v_cvt_pk_bf16_f32 v233, v240, v241
MV 180,v,40,v,68
buffer_store_dwordx4 v[230:233], v228, s[16:19], s26 offen sc1
v_accvgpr_read_b32 v246, a24
MV 184,v,40,v,72
s_add_u32 m0, s67, 65536
v_accvgpr_read_b32 v247, a25
MV 188,v,40,v,76
TR 40,222,16384
TR 42,222,17408
MV 192,v,44,v,64
buffer_load_dwordx4 v208, s[44:47], s75 offen offset:0 lds
v_accvgpr_read_b32 v248, a26
MV 196,v,44,v,68
v_accvgpr_read_b32 v249, a27
v_accvgpr_read_b32 v250, a28
MV 200,v,44,v,72
MV 204,v,44,v,76
TR 44,223,16384
TR 46,223,17408
s_waitcnt lgkmcnt(4)
MV 80,v,16,v,48
buffer_load_dwordx4 v209, s[44:47], s75 offen offset:1024 lds
v_accvgpr_read_b32 v251, a29
MV 84,v,16,v,52
ds_read_b128 v[64:67], v225 offset:0
v_accvgpr_read_b32 v252, a30
MV 88,v,16,v,56
buffer_load_dwordx4 v210, s[44:47], s75 offen offset:2048 lds
v_accvgpr_read_b32 v253, a31
MV 92,v,16,v,60
TR 16,216,24576
TR 18,216,25600
MV 96,v,20,v,48
v_cvt_pk_bf16_f32 v242, v246, v247
MV 100,v,20,v,52
buffer_load_dwordx4 v211, s[44:47], s75 offen offset:3072 lds
v_cvt_pk_bf16_f32 v243, v248, v249
MV 104,v,20,v,56
ds_read_b128 v[68:71], v225 offset:2048
v_cvt_pk_bf16_f32 v244, v250, v251
MV 108,v,20,v,60
TR 20,217,24576
TR 22,217,25600
MV 112,v,24,v,48
s_add_u32 s75, s65, s74
v_cvt_pk_bf16_f32 v245, v252, v253
MV 116,v,24,v,52
buffer_store_dwordx4 v[242:245], v228, s[16:19], s27 offen sc1
MV 120,v,24,v,56
v_accvgpr_read_b32 v234, a32
MV 124,v,24,v,60
TR 24,218,24576
TR 26,218,25600
MV 128,v,28,v,48
ds_read_b128 v[72:75], v225 offset:4096
s_add_u32 m0, s67, 69632
MV 132,v,28,v,52
v_accvgpr_read_b32 v235, a33
v_accvgpr_read_b32 v236, a34
MV 136,v,28,v,56
buffer_load_dwordx4 v208, s[44:47], s75 offen offset:0 lds
MV 140,v,28,v,60
TR 28,219,24576
TR 30,219,25600
MV 144,v,32,v,48
buffer_load_dwordx4 v209, s[44:47], s75 offen offset:1024 lds
v_accvgpr_read_b32 v237, a35
MV 148,v,32,v,52
v_accvgpr_read_b32 v238, a36
v_accvgpr_read_b32 v239, a37
MV 152,v,32,v,56
ds_read_b128 v[76:79], v225 offset:6144
MV 156,v,32,v,60
TR 32,220,24576
TR 34,220,25600
MV 160,v,36,v,48
buffer_load_dwordx4 v210, s[44:47], s75 offen offset:2048 lds
v_accvgpr_read_b32 v240, a38
MV 164,v,36,v,52
v_accvgpr_read_b32 v241, a39
v_cvt_pk_bf16_f32 v230, v234, v235
MV 168,v,36,v,56
buffer_load_dwordx4 v211, s[44:47], s75 offen offset:3072 lds
MV 172,v,36,v,60
TR 36,221,24576
TR 38,221,25600
s_waitcnt lgkmcnt(15)
MV 176,v,40,v,48
v_cvt_pk_bf16_f32 v231, v236, v237
v_cvt_pk_bf16_f32 v232, v238, v239
MV 180,v,40,v,52
s_add_u32 s74, s74, 128
v_cvt_pk_bf16_f32 v233, v240, v241
MV 184,v,40,v,56
MV 188,v,40,v,60
TR 40,222,24576
TR 42,222,25600
MV 192,v,44,v,48
s_and_b32 s74, s74, 2047
buffer_store_dwordx4 v[230:233], v228, s[16:19], s28 offen sc1
MV 196,v,44,v,52
v_accvgpr_read_b32 v246, a40
MV 200,v,44,v,56
MV 204,v,44,v,60
TR 44,223,24576
TR 46,223,25600
s_waitcnt lgkmcnt(4)
MV 80,v,16,v,64
v_accvgpr_read_b32 v247, a41
MV 84,v,16,v,68
v_accvgpr_read_b32 v248, a42
MV 88,v,16,v,72
v_accvgpr_read_b32 v249, a43
MV 92,v,16,v,76
MV 96,v,20,v,64
v_accvgpr_read_b32 v250, a44
MV 100,v,20,v,68
v_accvgpr_read_b32 v251, a45
MV 104,v,20,v,72
v_accvgpr_read_b32 v252, a46
MV 108,v,20,v,76
s_waitcnt vmcnt(17) lgkmcnt(0)
s_barrier
MV 112,v,24,v,64
TR 16,216,32768
TR 18,216,33792
MV 116,v,24,v,68
ds_read_b128 v[48:51], v224 offset:32768
s_add_u32 m0, s68, 114688
MV 120,v,24,v,72
TR 20,217,32768
TR 22,217,33792
MV 124,v,24,v,76
buffer_load_dwordx4 v212, s[48:51], s66 offen offset:0 lds
v_accvgpr_read_b32 v253, a47
MV 128,v,28,v,64
TR 24,218,32768
TR 26,218,33792
MV 132,v,28,v,68
ds_read_b128 v[52:55], v224 offset:34816
buffer_load_dwordx4 v213, s[48:51], s66 offen offset:1024 lds
MV 136,v,28,v,72
buffer_load_dwordx4 v214, s[48:51], s66 offen offset:2048 lds
v_cvt_pk_bf16_f32 v242, v246, v247
MV 140,v,28,v,76
TR 28,219,32768
TR 30,219,33792
MV 144,v,32,v,64
ds_read_b128 v[56:59], v224 offset:36864
v_cvt_pk_bf16_f32 v243, v248, v249
MV 148,v,32,v,68
buffer_load_dwordx4 v215, s[48:51], s66 offen offset:3072 lds
v_cvt_pk_bf16_f32 v244, v250, v251
MV 152,v,32,v,72
v_cvt_pk_bf16_f32 v245, v252, v253
buffer_store_dwordx4 v[242:245], v228, s[16:19], s29 offen sc1
MV 156,v,32,v,76
TR 32,220,32768
TR 34,220,33792
MV 160,v,36,v,64
ds_read_b128 v[60:63], v224 offset:38912
s_add_u32 s66, s66, 524288
MV 164,v,36,v,68
s_and_b32 s66, s66, 8388607
v_accvgpr_read_b32 v234, a48
MV 168,v,36,v,72
v_accvgpr_read_b32 v235, a49
v_accvgpr_read_b32 v236, a50
MV 172,v,36,v,76
TR 36,221,32768
TR 38,221,33792
MV 176,v,40,v,64
s_add_u32 s75, s64, s74
v_accvgpr_read_b32 v237, a51
MV 180,v,40,v,68
v_accvgpr_read_b32 v238, a52
v_accvgpr_read_b32 v239, a53
MV 184,v,40,v,72
s_add_u32 m0, s67, 0
v_accvgpr_read_b32 v240, a54
MV 188,v,40,v,76
TR 40,222,32768
TR 42,222,33792
MV 192,v,44,v,64
buffer_load_dwordx4 v208, s[44:47], s75 offen offset:0 lds
v_accvgpr_read_b32 v241, a55
MV 196,v,44,v,68
v_cvt_pk_bf16_f32 v230, v234, v235
v_cvt_pk_bf16_f32 v231, v236, v237
MV 200,v,44,v,72
MV 204,v,44,v,76
TR 44,223,32768
TR 46,223,33792
s_waitcnt lgkmcnt(4)
MV 80,v,16,v,48
buffer_load_dwordx4 v209, s[44:47], s75 offen offset:1024 lds
v_cvt_pk_bf16_f32 v232, v238, v239
MV 84,v,16,v,52
ds_read_b128 v[64:67], v225 offset:32768
v_cvt_pk_bf16_f32 v233, v240, v241
MV 88,v,16,v,56
buffer_load_dwordx4 v210, s[44:47], s75 offen offset:2048 lds
buffer_store_dwordx4 v[230:233], v228, s[16:19], s30 offen sc1
MV 92,v,16,v,60
TR 16,216,40960
TR 18,216,41984
MV 96,v,20,v,48
v_accvgpr_read_b32 v246, a56
MV 100,v,20,v,52
buffer_load_dwordx4 v211, s[44:47], s75 offen offset:3072 lds
v_accvgpr_read_b32 v247, a57
MV 104,v,20,v,56
ds_read_b128 v[68:71], v225 offset:34816
v_accvgpr_read_b32 v248, a58
MV 108,v,20,v,60
TR 20,217,40960
TR 22,217,41984
MV 112,v,24,v,48
s_add_u32 s75, s65, s74
v_accvgpr_read_b32 v249, a59
MV 116,v,24,v,52
v_accvgpr_read_b32 v250, a60
MV 120,v,24,v,56
v_accvgpr_read_b32 v251, a61
MV 124,v,24,v,60
TR 24,218,40960
TR 26,218,41984
MV 128,v,28,v,48
ds_read_b128 v[72:75], v225 offset:36864
s_add_u32 m0, s67, 4096
MV 132,v,28,v,52
v_accvgpr_read_b32 v252, a62
v_accvgpr_read_b32 v253, a63
MV 136,v,28,v,56
buffer_load_dwordx4 v208, s[44:47], s75 offen offset:0 lds
MV 140,v,28,v,60
TR 28,219,40960
TR 30,219,41984
MV 144,v,32,v,48
buffer_load_dwordx4 v209, s[44:47], s75 offen offset:1024 lds
v_cvt_pk_bf16_f32 v242, v246, v247
MV 148,v,32,v,52
v_cvt_pk_bf16_f32 v243, v248, v249
v_cvt_pk_bf16_f32 v244, v250, v251
MV 152,v,32,v,56
ds_read_b128 v[76:79], v225 offset:38912
MV 156,v,32,v,60
TR 32,220,40960
TR 34,220,41984
MV 160,v,36,v,48
buffer_load_dwordx4 v210, s[44:47], s75 offen offset:2048 lds
v_cvt_pk_bf16_f32 v245, v252, v253
MV 164,v,36,v,52
buffer_store_dwordx4 v[242:245], v228, s[16:19], s31 offen sc1
v_accvgpr_read_b32 v234, a64
MV 168,v,36,v,56
buffer_load_dwordx4 v211, s[44:47], s75 offen offset:3072 lds
MV 172,v,36,v,60
TR 36,221,40960
TR 38,221,41984
s_waitcnt lgkmcnt(15)
MV 176,v,40,v,48
v_accvgpr_read_b32 v235, a65
v_accvgpr_read_b32 v236, a66
MV 180,v,40,v,52
s_add_u32 s74, s74, 128
v_accvgpr_read_b32 v237, a67
MV 184,v,40,v,56
MV 188,v,40,v,60
TR 40,222,40960
TR 42,222,41984
MV 192,v,44,v,48
s_and_b32 s74, s74, 2047
v_accvgpr_read_b32 v238, a68
MV 196,v,44,v,52
v_accvgpr_read_b32 v239, a69
MV 200,v,44,v,56
MV 204,v,44,v,60
TR 44,223,40960
TR 46,223,41984
s_waitcnt lgkmcnt(4)
MV 80,v,16,v,64
v_accvgpr_read_b32 v240, a70
MV 84,v,16,v,68
v_accvgpr_read_b32 v241, a71
MV 88,v,16,v,72
v_cvt_pk_bf16_f32 v230, v234, v235
MV 92,v,16,v,76
MV 96,v,20,v,64
v_cvt_pk_bf16_f32 v231, v236, v237
MV 100,v,20,v,68
v_cvt_pk_bf16_f32 v232, v238, v239
MV 104,v,20,v,72
v_cvt_pk_bf16_f32 v233, v240, v241
MV 108,v,20,v,76
s_waitcnt vmcnt(16) lgkmcnt(0)
s_barrier
MV 112,v,24,v,64
TR 16,216,0
TR 18,216,1024
MV 116,v,24,v,68
ds_read_b128 v[48:51], v226 offset:0
s_add_u32 m0, s68, 131072
MV 120,v,24,v,72
TR 20,217,0
TR 22,217,1024
MV 124,v,24,v,76
buffer_load_dwordx4 v212, s[48:51], s66 offen offset:0 lds
s_add_u32 s36, s24, 8192
MV 128,v,28,v,64
TR 24,218,0
TR 26,218,1024
MV 132,v,28,v,68
ds_read_b128 v[52:55], v226 offset:2048
buffer_load_dwordx4 v213, s[48:51], s66 offen offset:1024 lds
MV 136,v,28,v,72
buffer_load_dwordx4 v214, s[48:51], s66 offen offset:2048 lds
buffer_store_dwordx4 v[230:233], v228, s[16:19], s36 offen sc1
MV 140,v,28,v,76
TR 28,219,0
TR 30,219,1024
MV 144,v,32,v,64
ds_read_b128 v[56:59], v226 offset:4096
v_accvgpr_read_b32 v246, a72
MV 148,v,32,v,68
buffer_load_dwordx4 v215, s[48:51], s66 offen offset:3072 lds
v_accvgpr_read_b32 v247, a73
MV 152,v,32,v,72
v_accvgpr_read_b32 v248, a74
v_accvgpr_read_b32 v249, a75
MV 156,v,32,v,76
TR 32,220,0
TR 34,220,1024
MV 160,v,36,v,64
ds_read_b128 v[60:63], v226 offset:6144
s_add_u32 s66, s66, 524288
MV 164,v,36,v,68
s_and_b32 s66, s66, 8388607
v_accvgpr_read_b32 v250, a76
MV 168,v,36,v,72
v_accvgpr_read_b32 v251, a77
v_accvgpr_read_b32 v252, a78
MV 172,v,36,v,76
TR 36,221,0
TR 38,221,1024
MV 176,v,40,v,64
s_add_u32 s75, s64, s74
v_accvgpr_read_b32 v253, a79
MV 180,v,40,v,68
v_cvt_pk_bf16_f32 v242, v246, v247
v_cvt_pk_bf16_f32 v243, v248, v249
MV 184,v,40,v,72
s_add_u32 m0, s67, 32768
v_cvt_pk_bf16_f32 v244, v250, v251
MV 188,v,40,v,76
TR 40,222,0
TR 42,222,1024
MV 192,v,44,v,64
buffer_load_dwordx4 v208, s[44:47], s75 offen offset:0 lds
v_cvt_pk_bf16_f32 v245, v252, v253
MV 196,v,44,v,68
s_add_u32 s36, s25, 8192
buffer_store_dwordx4 v[242:245], v228, s[16:19], s36 offen sc1
MV 200,v,44,v,72
MV 204,v,44,v,76
TR 44,223,0
TR 46,223,1024
s_waitcnt lgkmcnt(4)
MV 80,v,16,v,48
buffer_load_dwordx4 v209, s[44:47], s75 offen offset:1024 lds
v_accvgpr_read_b32 v234, a80
MV 84,v,16,v,52
ds_read_b128 v[64:67], v227 offset:0
v_accvgpr_read_b32 v235, a81
MV 88,v,16,v,56
buffer_load_dwordx4 v210, s[44:47], s75 offen offset:2048 lds
v_accvgpr_read_b32 v236, a82
MV 92,v,16,v,60
TR 16,216,8192
TR 18,216,9216
MV 96,v,20,v,48
v_accvgpr_read_b32 v237, a83
MV 100,v,20,v,52
buffer_load_dwordx4 v211, s[44:47], s75 offen offset:3072 lds
v_accvgpr_read_b32 v238, a84
MV 104,v,20,v,56
ds_read_b128 v[68:71], v227 offset:2048
v_accvgpr_read_b32 v239, a85
MV 108,v,20,v,60
TR 20,217,8192
TR 22,217,9216
MV 112,v,24,v,48
s_add_u32 s75, s65, s74
v_accvgpr_read_b32 v240, a86
MV 116,v,24,v,52
v_accvgpr_read_b32 v241, a87
MV 120,v,24,v,56
v_cvt_pk_bf16_f32 v230, v234, v235
MV 124,v,24,v,60
TR 24,218,8192
TR 26,218,9216
MV 128,v,28,v,48
ds_read_b128 v[72:75], v227 offset:4096
s_add_u32 m0, s67, 36864
MV 132,v,28,v,52
v_cvt_pk_bf16_f32 v231, v236, v237
v_cvt_pk_bf16_f32 v232, v238, v239
MV 136,v,28,v,56
buffer_load_dwordx4 v208, s[44:47], s75 offen offset:0 lds
MV 140,v,28,v,60
TR 28,219,8192
TR 30,219,9216
MV 144,v,32,v,48
buffer_load_dwordx4 v209, s[44:47], s75 offen offset:1024 lds
v_cvt_pk_bf16_f32 v233, v240, v241
MV 148,v,32,v,52
s_add_u32 s36, s26, 8192
buffer_store_dwordx4 v[230:233], v228, s[16:19], s36 offen sc1
MV 152,v,32,v,56
ds_read_b128 v[76:79], v227 offset:6144
MV 156,v,32,v,60
TR 32,220,8192
TR 34,220,9216
MV 160,v,36,v,48
buffer_load_dwordx4 v210, s[44:47], s75 offen offset:2048 lds
v_accvgpr_read_b32 v246, a88
MV 164,v,36,v,52
v_accvgpr_read_b32 v247, a89
v_accvgpr_read_b32 v248, a90
MV 168,v,36,v,56
buffer_load_dwordx4 v211, s[44:47], s75 offen offset:3072 lds
MV 172,v,36,v,60
TR 36,221,8192
TR 38,221,9216
s_waitcnt lgkmcnt(15)
MV 176,v,40,v,48
v_accvgpr_read_b32 v249, a91
v_accvgpr_read_b32 v250, a92
MV 180,v,40,v,52
s_add_u32 s74, s74, 128
v_accvgpr_read_b32 v251, a93
MV 184,v,40,v,56
MV 188,v,40,v,60
TR 40,222,8192
TR 42,222,9216
MV 192,v,44,v,48
s_and_b32 s74, s74, 2047
v_accvgpr_read_b32 v252, a94
MV 196,v,44,v,52
v_accvgpr_read_b32 v253, a95
MV 200,v,44,v,56
MV 204,v,44,v,60
TR 44,223,8192
TR 46,223,9216
s_waitcnt lgkmcnt(4)
MV 80,v,16,v,64
v_cvt_pk_bf16_f32 v242, v246, v247
MV 84,v,16,v,68
v_cvt_pk_bf16_f32 v243, v248, v249
MV 88,v,16,v,72
v_cvt_pk_bf16_f32 v244, v250, v251
MV 92,v,16,v,76
MV 96,v,20,v,64
v_cvt_pk_bf16_f32 v245, v252, v253
MV 100,v,20,v,68
s_add_u32 s36, s27, 8192
MV 104,v,20,v,72
buffer_store_dwordx4 v[242:245], v228, s[16:19], s36 offen sc1
MV 108,v,20,v,76
s_waitcnt vmcnt(16) lgkmcnt(0)
s_barrier
MV 112,v,24,v,64
TR 16,216,16384
TR 18,216,17408
MV 116,v,24,v,68
ds_read_b128 v[48:51], v224 offset:0
s_add_u32 m0, s68, 98304
MV 120,v,24,v,72
TR 20,217,16384
TR 22,217,17408
MV 124,v,24,v,76
buffer_load_dwordx4 v212, s[48:51], s66 offen offset:0 lds
v_accvgpr_read_b32 v234, a96
MV 128,v,28,v,64
TR 24,218,16384
TR 26,218,17408
MV 132,v,28,v,68
ds_read_b128 v[52:55], v224 offset:2048
buffer_load_dwordx4 v213, s[48:51], s66 offen offset:1024 lds
MV 136,v,28,v,72
buffer_load_dwordx4 v214, s[48:51], s66 offen offset:2048 lds
v_accvgpr_read_b32 v235, a97
MV 140,v,28,v,76
TR 28,219,16384
TR 30,219,17408
MV 144,v,32,v,64
ds_read_b128 v[56:59], v224 offset:4096
v_accvgpr_read_b32 v236, a98
MV 148,v,32,v,68
buffer_load_dwordx4 v215, s[48:51], s66 offen offset:3072 lds
v_accvgpr_read_b32 v237, a99
MV 152,v,32,v,72
v_accvgpr_read_b32 v238, a100
v_accvgpr_read_b32 v239, a101
MV 156,v,32,v,76
TR 32,220,16384
TR 34,220,17408
MV 160,v,36,v,64
ds_read_b128 v[60:63], v224 offset:6144
s_add_u32 s66, s66, 524288
MV 164,v,36,v,68
s_and_b32 s66, s66, 8388607
v_accvgpr_read_b32 v240, a102
MV 168,v,36,v,72
v_accvgpr_read_b32 v241, a103
v_cvt_pk_bf16_f32 v230, v234, v235
MV 172,v,36,v,76
TR 36,221,16384
TR 38,221,17408
MV 176,v,40,v,64
s_add_u32 s75, s64, s74
v_cvt_pk_bf16_f32 v231, v236, v237
MV 180,v,40,v,68
v_cvt_pk_bf16_f32 v232, v238, v239
v_cvt_pk_bf16_f32 v233, v240, v241
MV 184,v,40,v,72
s_add_u32 m0, s67, 65536
s_add_u32 s36, s28, 8192
MV 188,v,40,v,76
TR 40,222,16384
TR 42,222,17408
MV 192,v,44,v,64
buffer_load_dwordx4 v208, s[44:47], s75 offen offset:0 lds
buffer_store_dwordx4 v[230:233], v228, s[16:19], s36 offen sc1
MV 196,v,44,v,68
v_accvgpr_read_b32 v246, a104
v_accvgpr_read_b32 v247, a105
MV 200,v,44,v,72
MV 204,v,44,v,76
TR 44,223,16384
TR 46,223,17408
s_waitcnt lgkmcnt(4)
MV 80,v,16,v,48
buffer_load_dwordx4 v209, s[44:47], s75 offen offset:1024 lds
v_accvgpr_read_b32 v248, a106
MV 84,v,16,v,52
ds_read_b128 v[64:67], v225 offset:0
v_accvgpr_read_b32 v249, a107
MV 88,v,16,v,56
buffer_load_dwordx4 v210, s[44:47], s75 offen offset:2048 lds
v_accvgpr_read_b32 v250, a108
MV 92,v,16,v,60
TR 16,216,24576
TR 18,216,25600
MV 96,v,20,v,48
v_accvgpr_read_b32 v251, a109
MV 100,v,20,v,52
buffer_load_dwordx4 v211, s[44:47], s75 offen offset:3072 lds
v_accvgpr_read_b32 v252, a110
MV 104,v,20,v,56
ds_read_b128 v[68:71], v225 offset:2048
v_accvgpr_read_b32 v253, a111
MV 108,v,20,v,60
TR 20,217,24576
TR 22,217,25600
MV 112,v,24,v,48
s_add_u32 s75, s65, s74
v_cvt_pk_bf16_f32 v242, v246, v247
MV 116,v,24,v,52
v_cvt_pk_bf16_f32 v243, v248, v249
MV 120,v,24,v,56
v_cvt_pk_bf16_f32 v244, v250, v251
MV 124,v,24,v,60
TR 24,218,24576
TR 26,218,25600
MV 128,v,28,v,48
ds_read_b128 v[72:75], v225 offset:4096
s_add_u32 m0, s67, 69632
MV 132,v,28,v,52
v_cvt_pk_bf16_f32 v245, v252, v253
s_add_u32 s36, s29, 8192
MV 136,v,28,v,56
buffer_load_dwordx4 v208, s[44:47], s75 offen offset:0 lds
MV 140,v,28,v,60
TR 28,219,24576
TR 30,219,25600
MV 144,v,32,v,48
buffer_load_dwordx4 v209, s[44:47], s75 offen offset:1024 lds
buffer_store_dwordx4 v[242:245], v228, s[16:19], s36 offen sc1
MV 148,v,32,v,52
v_accvgpr_read_b32 v234, a112
v_accvgpr_read_b32 v235, a113
MV 152,v,32,v,56
ds_read_b128 v[76:79], v225 offset:6144
MV 156,v,32,v,60
TR 32,220,24576
TR 34,220,25600
MV 160,v,36,v,48
buffer_load_dwordx4 v210, s[44:47], s75 offen offset:2048 lds
v_accvgpr_read_b32 v236, a114
MV 164,v,36,v,52
v_accvgpr_read_b32 v237, a115
v_accvgpr_read_b32 v238, a116
MV 168,v,36,v,56
buffer_load_dwordx4 v211, s[44:47], s75 offen offset:3072 lds
MV 172,v,36,v,60
TR 36,221,24576
TR 38,221,25600
s_waitcnt lgkmcnt(15)
MV 176,v,40,v,48
v_accvgpr_read_b32 v239, a117
v_accvgpr_read_b32 v240, a118
MV 180,v,40,v,52
s_add_u32 s74, s74, 128
v_accvgpr_read_b32 v241, a119
MV 184,v,40,v,56
MV 188,v,40,v,60
TR 40,222,24576
TR 42,222,25600
MV 192,v,44,v,48
s_and_b32 s74, s74, 2047
v_cvt_pk_bf16_f32 v230, v234, v235
MV 196,v,44,v,52
v_cvt_pk_bf16_f32 v231, v236, v237
MV 200,v,44,v,56
MV 204,v,44,v,60
TR 44,223,24576
TR 46,223,25600
s_waitcnt lgkmcnt(4)
MV 80,v,16,v,64
v_cvt_pk_bf16_f32 v232, v238, v239
MV 84,v,16,v,68
v_cvt_pk_bf16_f32 v233, v240, v241
MV 88,v,16,v,72
s_add_u32 s36, s30, 8192
MV 92,v,16,v,76
MV 96,v,20,v,64
buffer_store_dwordx4 v[230:233], v228, s[16:19], s36 offen sc1
MV 100,v,20,v,68
v_accvgpr_read_b32 v246, a120
MV 104,v,20,v,72
v_accvgpr_read_b32 v247, a121
MV 108,v,20,v,76
s_waitcnt vmcnt(16) lgkmcnt(0)
s_barrier
MV 112,v,24,v,64
TR 16,216,32768
TR 18,216,33792
MV 116,v,24,v,68
ds_read_b128 v[48:51], v224 offset:32768
s_add_u32 m0, s68, 114688
MV 120,v,24,v,72
TR 20,217,32768
TR 22,217,33792
MV 124,v,24,v,76
buffer_load_dwordx4 v212, s[48:51], s66 offen offset:0 lds
v_accvgpr_read_b32 v248, a122
MV 128,v,28,v,64
TR 24,218,32768
TR 26,218,33792
MV 132,v,28,v,68
ds_read_b128 v[52:55], v224 offset:34816
buffer_load_dwordx4 v213, s[48:51], s66 offen offset:1024 lds
MV 136,v,28,v,72
buffer_load_dwordx4 v214, s[48:51], s66 offen offset:2048 lds
v_accvgpr_read_b32 v249, a123
MV 140,v,28,v,76
TR 28,219,32768
TR 30,219,33792
MV 144,v,32,v,64
ds_read_b128 v[56:59], v224 offset:36864
v_accvgpr_read_b32 v250, a124
MV 148,v,32,v,68
buffer_load_dwordx4 v215, s[48:51], s66 offen offset:3072 lds
v_accvgpr_read_b32 v251, a125
MV 152,v,32,v,72
v_accvgpr_read_b32 v252, a126
v_accvgpr_read_b32 v253, a127
MV 156,v,32,v,76
TR 32,220,32768
TR 34,220,33792
MV 160,v,36,v,64
ds_read_b128 v[60:63], v224 offset:38912
s_add_u32 s66, s66, 524288
MV 164,v,36,v,68
s_and_b32 s66, s66, 8388607
v_cvt_pk_bf16_f32 v242, v246, v247
MV 168,v,36,v,72
v_cvt_pk_bf16_f32 v243, v248, v249
v_cvt_pk_bf16_f32 v244, v250, v251
MV 172,v,36,v,76
TR 36,221,32768
TR 38,221,33792
MV 176,v,40,v,64
s_add_u32 s75, s64, s74
v_cvt_pk_bf16_f32 v245, v252, v253
MV 180,v,40,v,68
s_add_u32 s36, s31, 8192
buffer_store_dwordx4 v[242:245], v228, s[16:19], s36 offen sc1
MV 184,v,40,v,72
s_add_u32 m0, s67, 0
v_accvgpr_read_b32 v234, a128
MV 188,v,40,v,76
TR 40,222,32768
TR 42,222,33792
MV 192,v,44,v,64
buffer_load_dwordx4 v208, s[44:47], s75 offen offset:0 lds
v_accvgpr_read_b32 v235, a129
MV 196,v,44,v,68
v_accvgpr_read_b32 v236, a130
v_accvgpr_read_b32 v237, a131
MV 200,v,44,v,72
MV 204,v,44,v,76
TR 44,223,32768
TR 46,223,33792
s_waitcnt lgkmcnt(4)
MV 80,v,16,v,48
buffer_load_dwordx4 v209, s[44:47], s75 offen offset:1024 lds
v_accvgpr_read_b32 v238, a132
MV 84,v,16,v,52
ds_read_b128 v[64:67], v225 offset:32768
v_accvgpr_read_b32 v239, a133
MV 88,v,16,v,56
buffer_load_dwordx4 v210, s[44:47], s75 offen offset:2048 lds
v_accvgpr_read_b32 v240, a134
MV 92,v,16,v,60
TR 16,216,40960
TR 18,216,41984
MV 96,v,20,v,48
v_accvgpr_read_b32 v241, a135
MV 100,v,20,v,52
buffer_load_dwordx4 v211, s[44:47], s75 offen offset:3072 lds
v_cvt_pk_bf16_f32 v230, v234, v235
MV 104,v,20,v,56
ds_read_b128 v[68:71], v225 offset:34816
v_cvt_pk_bf16_f32 v231, v236, v237
MV 108,v,20,v,60
TR 20,217,40960
TR 22,217,41984
MV 112,v,24,v,48
s_add_u32 s75, s65, s74
v_cvt_pk_bf16_f32 v232, v238, v239
MV 116,v,24,v,52
v_cvt_pk_bf16_f32 v233, v240, v241
MV 120,v,24,v,56
s_add_u32 s36, s24, 16384
MV 124,v,24,v,60
TR 24,218,40960
TR 26,218,41984
MV 128,v,28,v,48
ds_read_b128 v[72:75], v225 offset:36864
s_add_u32 m0, s67, 4096
MV 132,v,28,v,52
buffer_store_dwordx4 v[230:233], v228, s[16:19], s36 offen sc1
v_accvgpr_read_b32 v246, a136
MV 136,v,28,v,56
buffer_load_dwordx4 v208, s[44:47], s75 offen offset:0 lds
MV 140,v,28,v,60
TR 28,219,40960
TR 30,219,41984
MV 144,v,32,v,48
buffer_load_dwordx4 v209, s[44:47], s75 offen offset:1024 lds
v_accvgpr_read_b32 v247, a137
MV 148,v,32,v,52
v_accvgpr_read_b32 v248, a138
v_accvgpr_read_b32 v249, a139
MV 152,v,32,v,56
ds_read_b128 v[76:79], v225 offset:38912
MV 156,v,32,v,60
TR 32,220,40960
TR 34,220,41984
MV 160,v,36,v,48
buffer_load_dwordx4 v210, s[44:47], s75 offen offset:2048 lds
v_accvgpr_read_b32 v250, a140
MV 164,v,36,v,52
v_accvgpr_read_b32 v251, a141
v_accvgpr_read_b32 v252, a142
MV 168,v,36,v,56
buffer_load_dwordx4 v211, s[44:47], s75 offen offset:3072 lds
MV 172,v,36,v,60
TR 36,221,40960
TR 38,221,41984
s_waitcnt lgkmcnt(15)
MV 176,v,40,v,48
v_accvgpr_read_b32 v253, a143
v_cvt_pk_bf16_f32 v242, v246, v247
MV 180,v,40,v,52
s_add_u32 s74, s74, 128
v_cvt_pk_bf16_f32 v243, v248, v249
MV 184,v,40,v,56
MV 188,v,40,v,60
TR 40,222,40960
TR 42,222,41984
MV 192,v,44,v,48
s_and_b32 s74, s74, 2047
v_cvt_pk_bf16_f32 v244, v250, v251
MV 196,v,44,v,52
v_cvt_pk_bf16_f32 v245, v252, v253
MV 200,v,44,v,56
MV 204,v,44,v,60
TR 44,223,40960
TR 46,223,41984
s_waitcnt lgkmcnt(4)
MV 80,v,16,v,64
s_add_u32 s36, s25, 16384
MV 84,v,16,v,68
buffer_store_dwordx4 v[242:245], v228, s[16:19], s36 offen sc1
MV 88,v,16,v,72
v_accvgpr_read_b32 v234, a144
MV 92,v,16,v,76
MV 96,v,20,v,64
v_accvgpr_read_b32 v235, a145
MV 100,v,20,v,68
v_accvgpr_read_b32 v236, a146
MV 104,v,20,v,72
v_accvgpr_read_b32 v237, a147
MV 108,v,20,v,76
s_waitcnt vmcnt(16) lgkmcnt(0)
s_barrier
MV 112,v,24,v,64
TR 16,216,0
TR 18,216,1024
MV 116,v,24,v,68
ds_read_b128 v[48:51], v226 offset:0
s_add_u32 m0, s68, 131072
MV 120,v,24,v,72
TR 20,217,0
TR 22,217,1024
MV 124,v,24,v,76
buffer_load_dwordx4 v212, s[48:51], s66 offen offset:0 lds
v_accvgpr_read_b32 v238, a148
MV 128,v,28,v,64
TR 24,218,0
TR 26,218,1024
MV 132,v,28,v,68
ds_read_b128 v[52:55], v226 offset:2048
buffer_load_dwordx4 v213, s[48:51], s66 offen offset:1024 lds
MV 136,v,28,v,72
buffer_load_dwordx4 v214, s[48:51], s66 offen offset:2048 lds
v_accvgpr_read_b32 v239, a149
MV 140,v,28,v,76
TR 28,219,0
TR 30,219,1024
MV 144,v,32,v,64
ds_read_b128 v[56:59], v226 offset:4096
v_accvgpr_read_b32 v240, a150
MV 148,v,32,v,68
buffer_load_dwordx4 v215, s[48:51], s66 offen offset:3072 lds
v_accvgpr_read_b32 v241, a151
MV 152,v,32,v,72
v_cvt_pk_bf16_f32 v230, v234, v235
v_cvt_pk_bf16_f32 v231, v236, v237
MV 156,v,32,v,76
TR 32,220,0
TR 34,220,1024
MV 160,v,36,v,64
ds_read_b128 v[60:63], v226 offset:6144
s_add_u32 s66, s66, 524288
MV 164,v,36,v,68
s_and_b32 s66, s66, 8388607
v_cvt_pk_bf16_f32 v232, v238, v239
MV 168,v,36,v,72
v_cvt_pk_bf16_f32 v233, v240, v241
s_add_u32 s36, s26, 16384
MV 172,v,36,v,76
TR 36,221,0
TR 38,221,1024
MV 176,v,40,v,64
s_add_u32 s75, s64, s74
buffer_store_dwordx4 v[230:233], v228, s[16:19], s36 offen sc1
MV 180,v,40,v,68
v_accvgpr_read_b32 v246, a152
v_accvgpr_read_b32 v247, a153
MV 184,v,40,v,72
s_add_u32 m0, s67, 32768
v_accvgpr_read_b32 v248, a154
MV 188,v,40,v,76
TR 40,222,0
TR 42,222,1024
MV 192,v,44,v,64
buffer_load_dwordx4 v208, s[44:47], s75 offen offset:0 lds
v_accvgpr_read_b32 v249, a155
MV 196,v,44,v,68
v_accvgpr_read_b32 v250, a156
v_accvgpr_read_b32 v251, a157
MV 200,v,44,v,72
MV 204,v,44,v,76
TR 44,223,0
TR 46,223,1024
s_waitcnt lgkmcnt(4)
MV 80,v,16,v,48
buffer_load_dwordx4 v209, s[44:47], s75 offen offset:1024 lds
v_accvgpr_read_b32 v252, a158
MV 84,v,16,v,52
ds_read_b128 v[64:67], v227 offset:0
v_accvgpr_read_b32 v253, a159
MV 88,v,16,v,56
buffer_load_dwordx4 v210, s[44:47], s75 offen offset:2048 lds
v_cvt_pk_bf16_f32 v242, v246, v247
MV 92,v,16,v,60
TR 16,216,8192
TR 18,216,9216
MV 96,v,20,v,48
v_cvt_pk_bf16_f32 v243, v248, v249
MV 100,v,20,v,52
buffer_load_dwordx4 v211, s[44:47], s75 offen offset:3072 lds
v_cvt_pk_bf16_f32 v244, v250, v251
MV 104,v,20,v,56
ds_read_b128 v[68:71], v227 offset:2048
v_cvt_pk_bf16_f32 v245, v252, v253
MV 108,v,20,v,60
TR 20,217,8192
TR 22,217,9216
MV 112,v,24,v,48
s_add_u32 s75, s65, s74
s_add_u32 s36, s27, 16384
MV 116,v,24,v,52
buffer_store_dwordx4 v[242:245], v228, s[16:19], s36 offen sc1
MV 120,v,24,v,56
v_accvgpr_read_b32 v234, a160
MV 124,v,24,v,60
TR 24,218,8192
TR 26,218,9216
MV 128,v,28,v,48
ds_read_b128 v[72:75], v227 offset:4096
s_add_u32 m0, s67, 36864
MV 132,v,28,v,52
v_accvgpr_read_b32 v235, a161
v_accvgpr_read_b32 v236, a162
MV 136,v,28,v,56
buffer_load_dwordx4 v208, s[44:47], s75 offen offset:0 lds
MV 140,v,28,v,60
TR 28,219,8192
TR 30,219,9216
MV 144,v,32,v,48
buffer_load_dwordx4 v209, s[44:47], s75 offen offset:1024 lds
v_accvgpr_read_b32 v237, a163
MV 148,v,32,v,52
v_accvgpr_read_b32 v238, a164
v_accvgpr_read_b32 v239, a165
MV 152,v,32,v,56
ds_read_b128 v[76:79], v227 offset:6144
MV 156,v,32,v,60
TR 32,220,8192
TR 34,220,9216
MV 160,v,36,v,48
buffer_load_dwordx4 v210, s[44:47], s75 offen offset:2048 lds
v_accvgpr_read_b32 v240, a166
MV 164,v,36,v,52
v_accvgpr_read_b32 v241, a167
v_cvt_pk_bf16_f32 v230, v234, v235
MV 168,v,36,v,56
buffer_load_dwordx4 v211, s[44:47], s75 offen offset:3072 lds
MV 172,v,36,v,60
TR 36,221,8192
TR 38,221,9216
s_waitcnt lgkmcnt(15)
MV 176,v,40,v,48
v_cvt_pk_bf16_f32 v231, v236, v237
v_cvt_pk_bf16_f32 v232, v238, v239
MV 180,v,40,v,52
s_add_u32 s74, s74, 128
v_cvt_pk_bf16_f32 v233, v240, v241
MV 184,v,40,v,56
MV 188,v,40,v,60
TR 40,222,8192
TR 42,222,9216
MV 192,v,44,v,48
s_and_b32 s74, s74, 2047
s_add_u32 s36, s28, 16384
MV 196,v,44,v,52
buffer_store_dwordx4 v[230:233], v228, s[16:19], s36 offen sc1
MV 200,v,44,v,56
MV 204,v,44,v,60
TR 44,223,8192
TR 46,223,9216
s_waitcnt lgkmcnt(4)
MV 80,v,16,v,64
v_accvgpr_read_b32 v246, a168
MV 84,v,16,v,68
v_accvgpr_read_b32 v247, a169
MV 88,v,16,v,72
v_accvgpr_read_b32 v248, a170
MV 92,v,16,v,76
MV 96,v,20,v,64
v_accvgpr_read_b32 v249, a171
MV 100,v,20,v,68
v_accvgpr_read_b32 v250, a172
MV 104,v,20,v,72
v_accvgpr_read_b32 v251, a173
MV 108,v,20,v,76
s_waitcnt vmcnt(16) lgkmcnt(0)
s_barrier
MV 112,v,24,v,64
TR 16,216,16384
TR 18,216,17408
MV 116,v,24,v,68
ds_read_b128 v[48:51], v224 offset:0
s_add_u32 m0, s68, 98304
MV 120,v,24,v,72
TR 20,217,16384
TR 22,217,17408
MV 124,v,24,v,76
buffer_load_dwordx4 v212, s[48:51], s66 offen offset:0 lds
v_accvgpr_read_b32 v252, a174
MV 128,v,28,v,64
TR 24,218,16384
TR 26,218,17408
MV 132,v,28,v,68
ds_read_b128 v[52:55], v224 offset:2048
buffer_load_dwordx4 v213, s[48:51], s66 offen offset:1024 lds
MV 136,v,28,v,72
buffer_load_dwordx4 v214, s[48:51], s66 offen offset:2048 lds
v_accvgpr_read_b32 v253, a175
MV 140,v,28,v,76
TR 28,219,16384
TR 30,219,17408
MV 144,v,32,v,64
ds_read_b128 v[56:59], v224 offset:4096
v_cvt_pk_bf16_f32 v242, v246, v247
MV 148,v,32,v,68
buffer_load_dwordx4 v215, s[48:51], s66 offen offset:3072 lds
v_cvt_pk_bf16_f32 v243, v248, v249
MV 152,v,32,v,72
v_cvt_pk_bf16_f32 v244, v250, v251
v_cvt_pk_bf16_f32 v245, v252, v253
MV 156,v,32,v,76
TR 32,220,16384
TR 34,220,17408
MV 160,v,36,v,64
ds_read_b128 v[60:63], v224 offset:6144
s_add_u32 s66, s66, 524288
MV 164,v,36,v,68
s_and_b32 s66, s66, 8388607
s_add_u32 s36, s29, 16384
MV 168,v,36,v,72
buffer_store_dwordx4 v[242:245], v228, s[16:19], s36 offen sc1
v_accvgpr_read_b32 v234, a176
MV 172,v,36,v,76
TR 36,221,16384
TR 38,221,17408
MV 176,v,40,v,64
s_add_u32 s75, s64, s74
v_accvgpr_read_b32 v235, a177
MV 180,v,40,v,68
v_accvgpr_read_b32 v236, a178
v_accvgpr_read_b32 v237, a179
MV 184,v,40,v,72
s_add_u32 m0, s67, 65536
v_accvgpr_read_b32 v238, a180
MV 188,v,40,v,76
TR 40,222,16384
TR 42,222,17408
MV 192,v,44,v,64
buffer_load_dwordx4 v208, s[44:47], s75 offen offset:0 lds
v_accvgpr_read_b32 v239, a181
MV 196,v,44,v,68
v_accvgpr_read_b32 v240, a182
v_accvgpr_read_b32 v241, a183
MV 200,v,44,v,72
MV 204,v,44,v,76
TR 44,223,16384
TR 46,223,17408
s_waitcnt lgkmcnt(4)
MV 80,v,16,v,48
buffer_load_dwordx4 v209, s[44:47], s75 offen offset:1024 lds
v_cvt_pk_bf16_f32 v230, v234, v235
MV 84,v,16,v,52
ds_read_b128 v[64:67], v225 offset:0
v_cvt_pk_bf16_f32 v231, v236, v237
MV 88,v,16,v,56
buffer_load_dwordx4 v210, s[44:47], s75 offen offset:2048 lds
v_cvt_pk_bf16_f32 v232, v238, v239
MV 92,v,16,v,60
TR 16,216,24576
TR 18,216,25600
MV 96,v,20,v,48
v_cvt_pk_bf16_f32 v233, v240, v241
MV 100,v,20,v,52
buffer_load_dwordx4 v211, s[44:47], s75 offen offset:3072 lds
s_add_u32 s36, s30, 16384
MV 104,v,20,v,56
ds_read_b128 v[68:71], v225 offset:2048
buffer_store_dwordx4 v[230:233], v228, s[16:19], s36 offen sc1
MV 108,v,20,v,60
TR 20,217,24576
TR 22,217,25600
MV 112,v,24,v,48
s_add_u32 s75, s65, s74
v_accvgpr_read_b32 v246, a184
MV 116,v,24,v,52
v_accvgpr_read_b32 v247, a185
MV 120,v,24,v,56
v_accvgpr_read_b32 v248, a186
MV 124,v,24,v,60
TR 24,218,24576
TR 26,218,25600
MV 128,v,28,v,48
ds_read_b128 v[72:75], v225 offset:4096
s_add_u32 m0, s67, 69632
MV 132,v,28,v,52
v_accvgpr_read_b32 v249, a187
v_accvgpr_read_b32 v250, a188
MV 136,v,28,v,56
buffer_load_dwordx4 v208, s[44:47], s75 offen offset:0 lds
v_accvgpr_read_b32 v251, a189
MV 140,v,28,v,60
TR 28,219,24576
TR 30,219,25600
MV 144,v,32,v,48
buffer_load_dwordx4 v209, s[44:47], s75 offen offset:1024 lds
v_accvgpr_read_b32 v252, a190
MV 148,v,32,v,52
v_accvgpr_read_b32 v253, a191
MV 152,v,32,v,56
ds_read_b128 v[76:79], v225 offset:6144
v_cvt_pk_bf16_f32 v242, v246, v247
MV 156,v,32,v,60
TR 32,220,24576
TR 34,220,25600
MV 160,v,36,v,48
buffer_load_dwordx4 v210, s[44:47], s75 offen offset:2048 lds
v_cvt_pk_bf16_f32 v243, v248, v249
MV 164,v,36,v,52
v_cvt_pk_bf16_f32 v244, v250, v251
MV 168,v,36,v,56
buffer_load_dwordx4 v211, s[44:47], s75 offen offset:3072 lds
v_cvt_pk_bf16_f32 v245, v252, v253
MV 172,v,36,v,60
TR 36,221,24576
TR 38,221,25600
s_waitcnt lgkmcnt(15)
MV 176,v,40,v,48
s_add_u32 s36, s31, 16384
buffer_store_dwordx4 v[242:245], v228, s[16:19], s36 offen sc1
MV 180,v,40,v,52
s_add_u32 s74, s74, 128
MV 184,v,40,v,56
v_accvgpr_read_b32 v234, a192
MV 188,v,40,v,60
TR 40,222,24576
TR 42,222,25600
MV 192,v,44,v,48
s_and_b32 s74, s74, 2047
v_accvgpr_read_b32 v235, a193
MV 196,v,44,v,52
buffer_load_dword v254, off, s[12:15], 0 sc1
MV 200,v,44,v,56
MV 204,v,44,v,60
TR 44,223,24576
TR 46,223,25600
s_waitcnt lgkmcnt(4)
MV 80,v,16,v,64
v_accvgpr_read_b32 v236, a194
MV 84,v,16,v,68
v_accvgpr_read_b32 v237, a195
MV 88,v,16,v,72
v_accvgpr_read_b32 v238, a196
MV 92,v,16,v,76
MV 96,v,20,v,64
v_accvgpr_read_b32 v239, a197
MV 100,v,20,v,68
v_accvgpr_read_b32 v240, a198
MV 104,v,20,v,72
v_accvgpr_read_b32 v241, a199
MV 108,v,20,v,76
s_waitcnt vmcnt(17) lgkmcnt(0)
s_barrier
MV 112,v,24,v,64
TR 16,216,32768
TR 18,216,33792
MV 116,v,24,v,68
ds_read_b128 v[48:51], v224 offset:32768
s_add_u32 m0, s68, 114688
MV 120,v,24,v,72
TR 20,217,32768
TR 22,217,33792
MV 124,v,24,v,76
buffer_load_dwordx4 v212, s[48:51], s66 offen offset:0 lds
v_cvt_pk_bf16_f32 v230, v234, v235
MV 128,v,28,v,64
TR 24,218,32768
TR 26,218,33792
MV 132,v,28,v,68
ds_read_b128 v[52:55], v224 offset:34816
buffer_load_dwordx4 v213, s[48:51], s66 offen offset:1024 lds
MV 136,v,28,v,72
buffer_load_dwordx4 v214, s[48:51], s66 offen offset:2048 lds
v_cvt_pk_bf16_f32 v231, v236, v237
MV 140,v,28,v,76
TR 28,219,32768
TR 30,219,33792
MV 144,v,32,v,64
ds_read_b128 v[56:59], v224 offset:36864
v_cvt_pk_bf16_f32 v232, v238, v239
MV 148,v,32,v,68
buffer_load_dwordx4 v215, s[48:51], s66 offen offset:3072 lds
v_cvt_pk_bf16_f32 v233, v240, v241
MV 152,v,32,v,72
s_add_u32 s36, s24, 24576
buffer_store_dwordx4 v[230:233], v228, s[16:19], s36 offen sc1
MV 156,v,32,v,76
TR 32,220,32768
TR 34,220,33792
MV 160,v,36,v,64
ds_read_b128 v[60:63], v224 offset:38912
s_add_u32 s66, s66, 524288
MV 164,v,36,v,68
s_and_b32 s66, s66, 8388607
v_accvgpr_read_b32 v246, a200
MV 168,v,36,v,72
v_accvgpr_read_b32 v247, a201
v_accvgpr_read_b32 v248, a202
MV 172,v,36,v,76
TR 36,221,32768
TR 38,221,33792
MV 176,v,40,v,64
s_add_u32 s75, s64, s74
v_accvgpr_read_b32 v249, a203
MV 180,v,40,v,68
v_accvgpr_read_b32 v250, a204
v_accvgpr_read_b32 v251, a205
MV 184,v,40,v,72
s_add_u32 m0, s67, 0
v_accvgpr_read_b32 v252, a206
MV 188,v,40,v,76
TR 40,222,32768
TR 42,222,33792
MV 192,v,44,v,64
buffer_load_dwordx4 v208, s[44:47], s75 offen offset:0 lds
v_accvgpr_read_b32 v253, a207
MV 196,v,44,v,68
v_cvt_pk_bf16_f32 v242, v246, v247
v_cvt_pk_bf16_f32 v243, v248, v249
MV 200,v,44,v,72
MV 204,v,44,v,76
TR 44,223,32768
TR 46,223,33792
s_waitcnt lgkmcnt(4)
MV 80,v,16,v,48
buffer_load_dwordx4 v209, s[44:47], s75 offen offset:1024 lds
v_cvt_pk_bf16_f32 v244, v250, v251
MV 84,v,16,v,52
ds_read_b128 v[64:67], v225 offset:32768
v_cvt_pk_bf16_f32 v245, v252, v253
MV 88,v,16,v,56
buffer_load_dwordx4 v210, s[44:47], s75 offen offset:2048 lds
s_add_u32 s36, s25, 24576
MV 92,v,16,v,60
TR 16,216,40960
TR 18,216,41984
MV 96,v,20,v,48
buffer_store_dwordx4 v[242:245], v228, s[16:19], s36 offen sc1
MV 100,v,20,v,52
buffer_load_dwordx4 v211, s[44:47], s75 offen offset:3072 lds
v_accvgpr_read_b32 v234, a208
MV 104,v,20,v,56
ds_read_b128 v[68:71], v225 offset:34816
v_accvgpr_read_b32 v235, a209
MV 108,v,20,v,60
TR 20,217,40960
TR 22,217,41984
MV 112,v,24,v,48
s_add_u32 s75, s65, s74
v_accvgpr_read_b32 v236, a210
MV 116,v,24,v,52
v_accvgpr_read_b32 v237, a211
MV 120,v,24,v,56
v_accvgpr_read_b32 v238, a212
MV 124,v,24,v,60
TR 24,218,40960
TR 26,218,41984
MV 128,v,28,v,48
ds_read_b128 v[72:75], v225 offset:36864
s_add_u32 m0, s67, 4096
MV 132,v,28,v,52
v_accvgpr_read_b32 v239, a213
v_accvgpr_read_b32 v240, a214
MV 136,v,28,v,56
buffer_load_dwordx4 v208, s[44:47], s75 offen offset:0 lds
MV 140,v,28,v,60
TR 28,219,40960
TR 30,219,41984
MV 144,v,32,v,48
buffer_load_dwordx4 v209, s[44:47], s75 offen offset:1024 lds
v_accvgpr_read_b32 v241, a215
MV 148,v,32,v,52
v_cvt_pk_bf16_f32 v230, v234, v235
v_cvt_pk_bf16_f32 v231, v236, v237
MV 152,v,32,v,56
ds_read_b128 v[76:79], v225 offset:38912
MV 156,v,32,v,60
TR 32,220,40960
TR 34,220,41984
MV 160,v,36,v,48
buffer_load_dwordx4 v210, s[44:47], s75 offen offset:2048 lds
v_cvt_pk_bf16_f32 v232, v238, v239
MV 164,v,36,v,52
v_cvt_pk_bf16_f32 v233, v240, v241
s_add_u32 s36, s26, 24576
MV 168,v,36,v,56
buffer_load_dwordx4 v211, s[44:47], s75 offen offset:3072 lds
MV 172,v,36,v,60
TR 36,221,40960
TR 38,221,41984
s_waitcnt lgkmcnt(15)
MV 176,v,40,v,48
buffer_store_dwordx4 v[230:233], v228, s[16:19], s36 offen sc1
v_accvgpr_read_b32 v246, a216
MV 180,v,40,v,52
s_add_u32 s74, s74, 128
v_accvgpr_read_b32 v247, a217
MV 184,v,40,v,56
MV 188,v,40,v,60
TR 40,222,40960
TR 42,222,41984
MV 192,v,44,v,48
s_and_b32 s74, s74, 2047
v_accvgpr_read_b32 v248, a218
MV 196,v,44,v,52
v_accvgpr_read_b32 v249, a219
MV 200,v,44,v,56
MV 204,v,44,v,60
TR 44,223,40960
TR 46,223,41984
s_waitcnt lgkmcnt(4)
MV 80,v,16,v,64
v_accvgpr_read_b32 v250, a220
MV 84,v,16,v,68
v_accvgpr_read_b32 v251, a221
MV 88,v,16,v,72
v_accvgpr_read_b32 v252, a222
MV 92,v,16,v,76
MV 96,v,20,v,64
v_accvgpr_read_b32 v253, a223
MV 100,v,20,v,68
v_cvt_pk_bf16_f32 v242, v246, v247
MV 104,v,20,v,72
v_cvt_pk_bf16_f32 v243, v248, v249
MV 108,v,20,v,76
s_waitcnt vmcnt(17) lgkmcnt(0)
s_barrier
MV 112,v,24,v,64
TR 16,216,0
TR 18,216,1024
MV 116,v,24,v,68
ds_read_b128 v[48:51], v226 offset:0
s_add_u32 m0, s68, 131072
MV 120,v,24,v,72
TR 20,217,0
TR 22,217,1024
MV 124,v,24,v,76
buffer_load_dwordx4 v212, s[48:51], s66 offen offset:0 lds
v_cvt_pk_bf16_f32 v244, v250, v251
MV 128,v,28,v,64
TR 24,218,0
TR 26,218,1024
MV 132,v,28,v,68
ds_read_b128 v[52:55], v226 offset:2048
buffer_load_dwordx4 v213, s[48:51], s66 offen offset:1024 lds
MV 136,v,28,v,72
buffer_load_dwordx4 v214, s[48:51], s66 offen offset:2048 lds
v_cvt_pk_bf16_f32 v245, v252, v253
MV 140,v,28,v,76
TR 28,219,0
TR 30,219,1024
MV 144,v,32,v,64
ds_read_b128 v[56:59], v226 offset:4096
s_add_u32 s36, s27, 24576
MV 148,v,32,v,68
buffer_load_dwordx4 v215, s[48:51], s66 offen offset:3072 lds
buffer_store_dwordx4 v[242:245], v228, s[16:19], s36 offen sc1
MV 152,v,32,v,72
v_accvgpr_read_b32 v234, a224
v_accvgpr_read_b32 v235, a225
MV 156,v,32,v,76
TR 32,220,0
TR 34,220,1024
MV 160,v,36,v,64
ds_read_b128 v[60:63], v226 offset:6144
s_add_u32 s66, s66, 524288
MV 164,v,36,v,68
s_and_b32 s66, s66, 8388607
v_accvgpr_read_b32 v236, a226
MV 168,v,36,v,72
v_accvgpr_read_b32 v237, a227
v_accvgpr_read_b32 v238, a228
MV 172,v,36,v,76
TR 36,221,0
TR 38,221,1024
MV 176,v,40,v,64
s_add_u32 s75, s64, s74
v_accvgpr_read_b32 v239, a229
MV 180,v,40,v,68
v_accvgpr_read_b32 v240, a230
v_accvgpr_read_b32 v241, a231
MV 184,v,40,v,72
s_add_u32 m0, s67, 32768
v_cvt_pk_bf16_f32 v230, v234, v235
MV 188,v,40,v,76
TR 40,222,0
TR 42,222,1024
MV 192,v,44,v,64
buffer_load_dwordx4 v208, s[44:47], s75 offen offset:0 lds
v_cvt_pk_bf16_f32 v231, v236, v237
MV 196,v,44,v,68
v_cvt_pk_bf16_f32 v232, v238, v239
v_cvt_pk_bf16_f32 v233, v240, v241
MV 200,v,44,v,72
MV 204,v,44,v,76
TR 44,223,0
TR 46,223,1024
s_waitcnt lgkmcnt(4)
MV 80,v,16,v,48
buffer_load_dwordx4 v209, s[44:47], s75 offen offset:1024 lds
s_add_u32 s36, s28, 24576
MV 84,v,16,v,52
ds_read_b128 v[64:67], v227 offset:0
buffer_store_dwordx4 v[230:233], v228, s[16:19], s36 offen sc1
MV 88,v,16,v,56
buffer_load_dwordx4 v210, s[44:47], s75 offen offset:2048 lds
v_accvgpr_read_b32 v246, a232
MV 92,v,16,v,60
TR 16,216,8192
TR 18,216,9216
MV 96,v,20,v,48
v_accvgpr_read_b32 v247, a233
MV 100,v,20,v,52
buffer_load_dwordx4 v211, s[44:47], s75 offen offset:3072 lds
v_accvgpr_read_b32 v248, a234
MV 104,v,20,v,56
ds_read_b128 v[68:71], v227 offset:2048
v_accvgpr_read_b32 v249, a235
MV 108,v,20,v,60
TR 20,217,8192
TR 22,217,9216
MV 112,v,24,v,48
s_add_u32 s75, s65, s74
v_accvgpr_read_b32 v250, a236
MV 116,v,24,v,52
v_accvgpr_read_b32 v251, a237
MV 120,v,24,v,56
v_accvgpr_read_b32 v252, a238
MV 124,v,24,v,60
TR 24,218,8192
TR 26,218,9216
MV 128,v,28,v,48
ds_read_b128 v[72:75], v227 offset:4096
s_add_u32 m0, s67, 36864
MV 132,v,28,v,52
v_accvgpr_read_b32 v253, a239
v_cvt_pk_bf16_f32 v242, v246, v247
MV 136,v,28,v,56
buffer_load_dwordx4 v208, s[44:47], s75 offen offset:0 lds
MV 140,v,28,v,60
TR 28,219,8192
TR 30,219,9216
MV 144,v,32,v,48
buffer_load_dwordx4 v209, s[44:47], s75 offen offset:1024 lds
v_cvt_pk_bf16_f32 v243, v248, v249
MV 148,v,32,v,52
v_cvt_pk_bf16_f32 v244, v250, v251
v_cvt_pk_bf16_f32 v245, v252, v253
MV 152,v,32,v,56
ds_read_b128 v[76:79], v227 offset:6144
MV 156,v,32,v,60
TR 32,220,8192
TR 34,220,9216
MV 160,v,36,v,48
buffer_load_dwordx4 v210, s[44:47], s75 offen offset:2048 lds
s_add_u32 s36, s29, 24576
MV 164,v,36,v,52
buffer_store_dwordx4 v[242:245], v228, s[16:19], s36 offen sc1
v_accvgpr_read_b32 v234, a240
MV 168,v,36,v,56
buffer_load_dwordx4 v211, s[44:47], s75 offen offset:3072 lds
MV 172,v,36,v,60
TR 36,221,8192
TR 38,221,9216
s_waitcnt lgkmcnt(15)
MV 176,v,40,v,48
v_accvgpr_read_b32 v235, a241
v_accvgpr_read_b32 v236, a242
MV 180,v,40,v,52
s_add_u32 s74, s74, 128
v_accvgpr_read_b32 v237, a243
MV 184,v,40,v,56
MV 188,v,40,v,60
TR 40,222,8192
TR 42,222,9216
MV 192,v,44,v,48
s_and_b32 s74, s74, 2047
v_accvgpr_read_b32 v238, a244
MV 196,v,44,v,52
v_accvgpr_read_b32 v239, a245
MV 200,v,44,v,56
MV 204,v,44,v,60
TR 44,223,8192
TR 46,223,9216
s_waitcnt lgkmcnt(4)
MV 80,v,16,v,64
v_accvgpr_read_b32 v240, a246
MV 84,v,16,v,68
v_accvgpr_read_b32 v241, a247
MV 88,v,16,v,72
v_cvt_pk_bf16_f32 v230, v234, v235
MV 92,v,16,v,76
MV 96,v,20,v,64
v_cvt_pk_bf16_f32 v231, v236, v237
MV 100,v,20,v,68
v_cvt_pk_bf16_f32 v232, v238, v239
MV 104,v,20,v,72
v_cvt_pk_bf16_f32 v233, v240, v241
MV 108,v,20,v,76
s_waitcnt vmcnt(16) lgkmcnt(0)
s_barrier
MV 112,v,24,v,64
TR 16,216,16384
TR 18,216,17408
MV 116,v,24,v,68
ds_read_b128 v[48:51], v224 offset:0
s_add_u32 m0, s68, 98304
MV 120,v,24,v,72
TR 20,217,16384
TR 22,217,17408
MV 124,v,24,v,76
buffer_load_dwordx4 v212, s[48:51], s66 offen offset:0 lds
s_add_u32 s36, s30, 24576
MV 128,v,28,v,64
TR 24,218,16384
TR 26,218,17408
MV 132,v,28,v,68
ds_read_b128 v[52:55], v224 offset:2048
buffer_load_dwordx4 v213, s[48:51], s66 offen offset:1024 lds
MV 136,v,28,v,72
buffer_load_dwordx4 v214, s[48:51], s66 offen offset:2048 lds
buffer_store_dwordx4 v[230:233], v228, s[16:19], s36 offen sc1
MV 140,v,28,v,76
TR 28,219,16384
TR 30,219,17408
MV 144,v,32,v,64
ds_read_b128 v[56:59], v224 offset:4096
v_accvgpr_read_b32 v246, a248
MV 148,v,32,v,68
buffer_load_dwordx4 v215, s[48:51], s66 offen offset:3072 lds
v_accvgpr_read_b32 v247, a249
MV 152,v,32,v,72
v_accvgpr_read_b32 v248, a250
v_accvgpr_read_b32 v249, a251
MV 156,v,32,v,76
TR 32,220,16384
TR 34,220,17408
MV 160,v,36,v,64
ds_read_b128 v[60:63], v224 offset:6144
s_add_u32 s66, s66, 524288
MV 164,v,36,v,68
s_and_b32 s66, s66, 8388607
v_accvgpr_read_b32 v250, a252
MV 168,v,36,v,72
v_accvgpr_read_b32 v251, a253
v_accvgpr_read_b32 v252, a254
MV 172,v,36,v,76
TR 36,221,16384
TR 38,221,17408
MV 176,v,40,v,64
s_add_u32 s75, s64, s74
v_accvgpr_read_b32 v253, a255
MV 180,v,40,v,68
v_cvt_pk_bf16_f32 v242, v246, v247
v_cvt_pk_bf16_f32 v243, v248, v249
MV 184,v,40,v,72
s_add_u32 m0, s67, 65536
v_cvt_pk_bf16_f32 v244, v250, v251
MV 188,v,40,v,76
TR 40,222,16384
TR 42,222,17408
MV 192,v,44,v,64
buffer_load_dwordx4 v208, s[44:47], s75 offen offset:0 lds
v_cvt_pk_bf16_f32 v245, v252, v253
MV 196,v,44,v,68
s_add_u32 s36, s31, 24576
buffer_store_dwordx4 v[242:245], v228, s[16:19], s36 offen sc1
MV 200,v,44,v,72
MV 204,v,44,v,76
TR 44,223,16384
TR 46,223,17408
s_waitcnt lgkmcnt(4)
MV 80,v,16,v,48
buffer_load_dwordx4 v209, s[44:47], s75 offen offset:1024 lds
v_lshlrev_b32 v255, 20, v1
MV 84,v,16,v,52
ds_read_b128 v[64:67], v225 offset:0
MV 88,v,16,v,56
buffer_load_dwordx4 v210, s[44:47], s75 offen offset:2048 lds
MV 92,v,16,v,60
TR 16,216,24576
TR 18,216,25600
MV 96,v,20,v,48
MV 100,v,20,v,52
buffer_load_dwordx4 v211, s[44:47], s75 offen offset:3072 lds
MV 104,v,20,v,56
ds_read_b128 v[68:71], v225 offset:2048
MV 108,v,20,v,60
TR 20,217,24576
TR 22,217,25600
MV 112,v,24,v,48
s_add_u32 s75, s65, s74
MV 116,v,24,v,52
MV 120,v,24,v,56
s_lshl_b32 s36, s3, 26
MV 124,v,24,v,60
TR 24,218,24576
TR 26,218,25600
MV 128,v,28,v,48
ds_read_b128 v[72:75], v225 offset:4096
s_add_u32 m0, s67, 69632
MV 132,v,28,v,52
MV 136,v,28,v,56
buffer_load_dwordx4 v208, s[44:47], s75 offen offset:0 lds
MV 140,v,28,v,60
TR 28,219,24576
TR 30,219,25600
MV 144,v,32,v,48
buffer_load_dwordx4 v209, s[44:47], s75 offen offset:1024 lds
MV 148,v,32,v,52
MV 152,v,32,v,56
ds_read_b128 v[76:79], v225 offset:6144
MV 156,v,32,v,60
TR 32,220,24576
TR 34,220,25600
MV 160,v,36,v,48
buffer_load_dwordx4 v210, s[44:47], s75 offen offset:2048 lds
v_add_u32 v255, s36, v255
MV 164,v,36,v,52
MV 168,v,36,v,56
buffer_load_dwordx4 v211, s[44:47], s75 offen offset:3072 lds
MV 172,v,36,v,60
TR 36,221,24576
TR 38,221,25600
s_waitcnt lgkmcnt(15)
MV 176,v,40,v,48
MV 180,v,40,v,52
s_add_u32 s74, s74, 128
MV 184,v,40,v,56
MV 188,v,40,v,60
TR 40,222,24576
TR 42,222,25600
MV 192,v,44,v,48
s_and_b32 s74, s74, 2047
MV 196,v,44,v,52
MV 200,v,44,v,56
MV 204,v,44,v,60
TR 44,223,24576
TR 46,223,25600
s_waitcnt lgkmcnt(4)
MV 80,v,16,v,64
v_lshlrev_b32 v230, 4, v1
MV 84,v,16,v,68
s_lshl_b32 s80, s3, 12
MV 88,v,16,v,72
MV 92,v,16,v,76
v_add_u32 v12, s80, v230
MV 96,v,20,v,64
v_add_u32 v10, 0x8000, v230
MV 100,v,20,v,68
MV 104,v,20,v,72
v_add_u32 v11, 0x10000, v230
MV 108,v,20,v,76
s_waitcnt vmcnt(14) lgkmcnt(0)
s_barrier
MV 112,v,24,v,64
TR 16,216,32768
TR 18,216,33792
MV 116,v,24,v,68
ds_read_b128 v[48:51], v224 offset:32768
s_add_u32 m0, s68, 114688
MV 120,v,24,v,72
TR 20,217,32768
TR 22,217,33792
MV 124,v,24,v,76
buffer_load_dwordx4 v212, s[48:51], s66 offen offset:0 lds
s_add_u32 s72, s80, 0x8000
MV 128,v,28,v,64
TR 24,218,32768
TR 26,218,33792
MV 132,v,28,v,68
ds_read_b128 v[52:55], v224 offset:34816
buffer_load_dwordx4 v213, s[48:51], s66 offen offset:1024 lds
MV 136,v,28,v,72
buffer_load_dwordx4 v214, s[48:51], s66 offen offset:2048 lds
s_add_u32 s73, s80, 0x10000
MV 140,v,28,v,76
TR 28,219,32768
TR 30,219,33792
MV 144,v,32,v,64
ds_read_b128 v[56:59], v224 offset:36864
v_and_b32 v230, 31, v1
MV 148,v,32,v,68
buffer_load_dwordx4 v215, s[48:51], s66 offen offset:3072 lds
v_lshrrev_b32 v232, 5, v1
MV 152,v,32,v,72
v_lshlrev_b32 v233, 2, v232
v_sub_u32 v13, v230, v233
MV 156,v,32,v,76
TR 32,220,32768
TR 34,220,33792
MV 160,v,36,v,64
ds_read_b128 v[60:63], v224 offset:38912
s_add_u32 s66, s66, 524288
MV 164,v,36,v,68
s_and_b32 s66, s66, 8388607
s_lshl_b32 s81, s3, 5
MV 168,v,36,v,72
v_add_u32 v13, s81, v13
v_mov_b32 v14, 0xff800000
MV 172,v,36,v,76
TR 36,221,32768
TR 38,221,33792
MV 176,v,40,v,64
s_add_u32 s75, s64, s74
v_and_b32 v230, 15, v1
MV 180,v,40,v,68
v_lshl_add_u32 v230, v232, 4, v230
v_lshlrev_b32 v230, 4, v230
MV 184,v,40,v,72
s_add_u32 m0, s67, 0
v_bfe_u32 v233, v1, 4, 1
MV 188,v,40,v,76
TR 40,222,32768
TR 42,222,33792
MV 192,v,44,v,64
buffer_load_dwordx4 v208, s[44:47], s75 offen offset:0 lds
v_lshl_add_u32 v15, v233, 17, v230
MV 196,v,44,v,68
MV 200,v,44,v,72
MV 204,v,44,v,76
TR 44,223,32768
TR 46,223,33792
s_waitcnt lgkmcnt(4)
MV 80,v,16,v,48
buffer_load_dwordx4 v209, s[44:47], s75 offen offset:1024 lds
v_accvgpr_write_b32 a0, 0
MV 84,v,16,v,52
ds_read_b128 v[64:67], v225 offset:32768
v_accvgpr_write_b32 a1, 0
MV 88,v,16,v,56
buffer_load_dwordx4 v210, s[44:47], s75 offen offset:2048 lds
MV 92,v,16,v,60
TR 16,216,40960
TR 18,216,41984
MV 96,v,20,v,48
v_accvgpr_write_b32 a2, 0
MV 100,v,20,v,52
buffer_load_dwordx4 v211, s[44:47], s75 offen offset:3072 lds
v_accvgpr_write_b32 a3, 0
MV 104,v,20,v,56
ds_read_b128 v[68:71], v225 offset:34816
MV 108,v,20,v,60
TR 20,217,40960
TR 22,217,41984
MV 112,v,24,v,48
s_add_u32 s75, s65, s74
v_accvgpr_write_b32 a4, 0
MV 116,v,24,v,52
v_accvgpr_write_b32 a5, 0
MV 120,v,24,v,56
MV 124,v,24,v,60
TR 24,218,40960
TR 26,218,41984
MV 128,v,28,v,48
ds_read_b128 v[72:75], v225 offset:36864
s_add_u32 m0, s67, 4096
MV 132,v,28,v,52
v_accvgpr_write_b32 a6, 0
v_accvgpr_write_b32 a7, 0
MV 136,v,28,v,56
buffer_load_dwordx4 v208, s[44:47], s75 offen offset:0 lds
MV 140,v,28,v,60
TR 28,219,40960
TR 30,219,41984
MV 144,v,32,v,48
buffer_load_dwordx4 v209, s[44:47], s75 offen offset:1024 lds
v_accvgpr_write_b32 a8, 0
MV 148,v,32,v,52
v_accvgpr_write_b32 a9, 0
MV 152,v,32,v,56
ds_read_b128 v[76:79], v225 offset:38912
v_accvgpr_write_b32 a10, 0
MV 156,v,32,v,60
TR 32,220,40960
TR 34,220,41984
MV 160,v,36,v,48
buffer_load_dwordx4 v210, s[44:47], s75 offen offset:2048 lds
v_accvgpr_write_b32 a11, 0
MV 164,v,36,v,52
MV 168,v,36,v,56
buffer_load_dwordx4 v211, s[44:47], s75 offen offset:3072 lds
v_accvgpr_write_b32 a12, 0
MV 172,v,36,v,60
TR 36,221,40960
TR 38,221,41984
s_waitcnt lgkmcnt(15)
MV 176,v,40,v,48
v_accvgpr_write_b32 a13, 0
MV 180,v,40,v,52
s_add_u32 s74, s74, 128
MV 184,v,40,v,56
v_accvgpr_write_b32 a14, 0
MV 188,v,40,v,60
TR 40,222,40960
TR 42,222,41984
MV 192,v,44,v,48
s_and_b32 s74, s74, 2047
v_accvgpr_write_b32 a15, 0
MV 196,v,44,v,52
MV 200,v,44,v,56
MV 204,v,44,v,60
TR 44,223,40960
TR 46,223,41984
s_waitcnt lgkmcnt(4)
MV 80,v,16,v,64
v_accvgpr_write_b32 a16, 0
MV 84,v,16,v,68
v_accvgpr_write_b32 a17, 0
MV 88,v,16,v,72
MV 92,v,16,v,76
v_accvgpr_write_b32 a18, 0
MV 96,v,20,v,64
MV 100,v,20,v,68
v_accvgpr_write_b32 a19, 0
MV 104,v,20,v,72
MV 108,v,20,v,76
s_waitcnt vmcnt(12) lgkmcnt(0)
s_barrier
MV 112,v,24,v,64
v_cmp_gt_u32 vcc, 1, v254
s_nop 4
s_cbranch_vccnz L_spin_go
L_spin_go_ret:
v_mov_b32 v254, 1
s_lshl_b32 s36, s2, 2
buffer_store_dword v254, v255, s[8:11], s36 offen offset:0 sc1
s_load_dwordx4 s[32:35], s[0:1], 32
MV 116,v,24,v,68
TR 16,216,0
TR 18,216,1024
MV 120,v,24,v,72
TR 20,217,0
TR 22,217,1024
MV 124,v,24,v,76
ds_read_b128 v[48:51], v226 offset:0
s_add_u32 m0, s68, 131072
MV 128,v,28,v,64
TR 24,218,0
TR 26,218,1024
MV 132,v,28,v,68
ds_read_b128 v[52:55], v226 offset:2048
buffer_load_dwordx4 v212, s[48:51], s66 offen offset:0 lds
MV 136,v,28,v,72
buffer_load_dwordx4 v213, s[48:51], s66 offen offset:1024 lds
buffer_load_dwordx4 v214, s[48:51], s66 offen offset:2048 lds
MV 140,v,28,v,76
TR 28,219,0
TR 30,219,1024
MV 144,v,32,v,64
ds_read_b128 v[56:59], v226 offset:4096
v_accvgpr_write_b32 a20, 0
MV 148,v,32,v,68
buffer_load_dwordx4 v215, s[48:51], s66 offen offset:3072 lds
v_accvgpr_write_b32 a21, 0
MV 152,v,32,v,72
v_accvgpr_write_b32 a22, 0
v_accvgpr_write_b32 a23, 0
MV 156,v,32,v,76
TR 32,220,0
TR 34,220,1024
MV 160,v,36,v,64
ds_read_b128 v[60:63], v226 offset:6144
s_add_u32 s66, s66, 524288
MV 164,v,36,v,68
s_and_b32 s66, s66, 8388607
v_accvgpr_write_b32 a24, 0
MV 168,v,36,v,72
v_accvgpr_write_b32 a25, 0
v_accvgpr_write_b32 a26, 0
MV 172,v,36,v,76
TR 36,221,0
TR 38,221,1024
MV 176,v,40,v,64
s_add_u32 s75, s64, s74
v_accvgpr_write_b32 a27, 0
MV 180,v,40,v,68
v_accvgpr_write_b32 a28, 0
v_accvgpr_write_b32 a29, 0
MV 184,v,40,v,72
s_add_u32 m0, s67, 32768
v_accvgpr_write_b32 a30, 0
MV 188,v,40,v,76
TR 40,222,0
TR 42,222,1024
MV 192,v,44,v,64
buffer_load_dwordx4 v208, s[44:47], s75 offen offset:0 lds
v_accvgpr_write_b32 a31, 0
MV 196,v,44,v,68
MV 200,v,44,v,72
MV 204,v,44,v,76
TR 44,223,0
TR 46,223,1024
s_waitcnt lgkmcnt(4)
MV 80,v,16,v,48
buffer_load_dwordx4 v209, s[44:47], s75 offen offset:1024 lds
v_accvgpr_write_b32 a32, 0
MV 84,v,16,v,52
ds_read_b128 v[64:67], v227 offset:0
v_accvgpr_write_b32 a33, 0
MV 88,v,16,v,56
buffer_load_dwordx4 v210, s[44:47], s75 offen offset:2048 lds
v_accvgpr_write_b32 a34, 0
MV 92,v,16,v,60
TR 16,216,8192
TR 18,216,9216
MV 96,v,20,v,48
v_accvgpr_write_b32 a35, 0
v_accvgpr_write_b32 a36, 0
MV 100,v,20,v,52
buffer_load_dwordx4 v211, s[44:47], s75 offen offset:3072 lds
v_accvgpr_write_b32 a37, 0
MV 104,v,20,v,56
ds_read_b128 v[68:71], v227 offset:2048
v_accvgpr_write_b32 a38, 0
MV 108,v,20,v,60
TR 20,217,8192
TR 22,217,9216
MV 112,v,24,v,48
s_add_u32 s75, s65, s74
v_accvgpr_write_b32 a39, 0
MV 116,v,24,v,52
v_accvgpr_write_b32 a40, 0
v_accvgpr_write_b32 a41, 0
MV 120,v,24,v,56
v_accvgpr_write_b32 a42, 0
v_accvgpr_write_b32 a43, 0
MV 124,v,24,v,60
TR 24,218,8192
TR 26,218,9216
MV 128,v,28,v,48
ds_read_b128 v[72:75], v227 offset:4096
s_add_u32 m0, s67, 36864
MV 132,v,28,v,52
v_accvgpr_write_b32 a44, 0
v_accvgpr_write_b32 a45, 0
MV 136,v,28,v,56
buffer_load_dwordx4 v208, s[44:47], s75 offen offset:0 lds
v_accvgpr_write_b32 a46, 0
MV 140,v,28,v,60
TR 28,219,8192
TR 30,219,9216
MV 144,v,32,v,48
buffer_load_dwordx4 v209, s[44:47], s75 offen offset:1024 lds
v_accvgpr_write_b32 a47, 0
MV 148,v,32,v,52
s_and_b32 s36, s2, 3
s_lshl_b32 s36, s36, 1
MV 152,v,32,v,56
ds_read_b128 v[76:79], v227 offset:6144
s_sub_u32 s43, 14, s36
MV 156,v,32,v,60
TR 32,220,8192
TR 34,220,9216
MV 160,v,36,v,48
buffer_load_dwordx4 v210, s[44:47], s75 offen offset:2048 lds
MV 164,v,36,v,52
s_bitcmp1_b32 s2, 4
s_cselect_b32 s36, s43, s36
MV 168,v,36,v,56
buffer_load_dwordx4 v211, s[44:47], s75 offen offset:3072 lds
s_bfe_u32 s43, s2, 0x10003
MV 172,v,36,v,60
TR 36,221,8192
TR 38,221,9216
s_waitcnt lgkmcnt(15)
MV 176,v,40,v,48
s_add_u32 s36, s36, s43
s_bfe_u32 s37, s2, 0x10002
MV 180,v,40,v,52
s_add_u32 s74, s74, 128
s_lshr_b32 s43, s2, 5
MV 184,v,40,v,56
s_lshl_b32 s43, s43, 1
s_add_u32 s37, s37, s43
MV 188,v,40,v,60
TR 40,222,8192
TR 42,222,9216
MV 192,v,44,v,48
s_and_b32 s74, s74, 2047
v_and_b32 v230, 15, v1
MV 196,v,44,v,52
s_lshl_b32 s36, s36, 4
v_add_u32 v231, s36, v230
MV 200,v,44,v,56
s_lshr_b32 s36, s2, 4
v_lshl_add_u32 v232, v230, 4, s36
MV 204,v,44,v,60
TR 44,223,8192
TR 46,223,9216
v_and_b32 v233, 7, v1
v_bfe_u32 v234, v1, 3, 1
v_lshlrev_b32 v233, 3, v233
v_lshl_add_u32 v233, v234, 7, v233
s_bfe_u32 s36, s2, 0x10004
s_lshl_b32 s36, s36, 6
s_and_b32 s37, s2, 7
s_add_u32 s36, s36, s37
v_add_u32 v233, s36, v233
v_lshrrev_b32 v234, 4, v1
v_cmp_eq_u32 vcc, 1, v234
s_nop 1
v_cndmask_b32 v233, v233, v232, vcc
v_cmp_eq_u32 vcc, 2, v234
s_nop 1
v_cndmask_b32 v233, v233, v231, vcc
v_lshlrev_b32 v233, 2, v233
s_waitcnt lgkmcnt(4)
MV 80,v,16,v,64
v_accvgpr_write_b32 a48, 0
MV 84,v,16,v,68
v_accvgpr_write_b32 a49, 0
MV 88,v,16,v,72
MV 92,v,16,v,76
v_accvgpr_write_b32 a50, 0
MV 96,v,20,v,64
MV 100,v,20,v,68
v_accvgpr_write_b32 a51, 0
MV 104,v,20,v,72
MV 108,v,20,v,76
s_waitcnt vmcnt(13) lgkmcnt(0)
s_barrier
MV 112,v,24,v,64
TR 16,216,16384
TR 18,216,17408
MV 116,v,24,v,68
ds_read_b128 v[48:51], v224 offset:0
s_add_u32 m0, s68, 98304
MV 120,v,24,v,72
TR 20,217,16384
TR 22,217,17408
MV 124,v,24,v,76
buffer_load_dwordx4 v212, s[48:51], s66 offen offset:0 lds
v_accvgpr_write_b32 a52, 0
MV 128,v,28,v,64
TR 24,218,16384
TR 26,218,17408
MV 132,v,28,v,68
ds_read_b128 v[52:55], v224 offset:2048
buffer_load_dwordx4 v213, s[48:51], s66 offen offset:1024 lds
MV 136,v,28,v,72
buffer_load_dwordx4 v214, s[48:51], s66 offen offset:2048 lds
v_accvgpr_write_b32 a53, 0
MV 140,v,28,v,76
TR 28,219,16384
TR 30,219,17408
MV 144,v,32,v,64
ds_read_b128 v[56:59], v224 offset:4096
v_accvgpr_write_b32 a54, 0
MV 148,v,32,v,68
buffer_load_dwordx4 v215, s[48:51], s66 offen offset:3072 lds
v_accvgpr_write_b32 a55, 0
MV 152,v,32,v,72
v_accvgpr_write_b32 a56, 0
v_accvgpr_write_b32 a57, 0
MV 156,v,32,v,76
TR 32,220,16384
TR 34,220,17408
MV 160,v,36,v,64
ds_read_b128 v[60:63], v224 offset:6144
s_add_u32 s66, s66, 524288
MV 164,v,36,v,68
s_and_b32 s66, s66, 8388607
v_accvgpr_write_b32 a58, 0
MV 168,v,36,v,72
v_accvgpr_write_b32 a59, 0
v_accvgpr_write_b32 a60, 0
MV 172,v,36,v,76
TR 36,221,16384
TR 38,221,17408
MV 176,v,40,v,64
s_add_u32 s75, s64, s74
v_accvgpr_write_b32 a61, 0
MV 180,v,40,v,68
MV 184,v,40,v,72
s_add_u32 m0, s67, 65536
v_accvgpr_write_b32 a62, 0
MV 188,v,40,v,76
TR 40,222,16384
TR 42,222,17408
MV 192,v,44,v,64
buffer_load_dwordx4 v208, s[44:47], s75 offen offset:0 lds
v_accvgpr_write_b32 a63, 0
MV 196,v,44,v,68
MV 200,v,44,v,72
MV 204,v,44,v,76
TR 44,223,16384
TR 46,223,17408
s_waitcnt lgkmcnt(4)
MV 80,v,16,v,48
buffer_load_dwordx4 v209, s[44:47], s75 offen offset:1024 lds
v_accvgpr_write_b32 a64, 0
MV 84,v,16,v,52
ds_read_b128 v[64:67], v225 offset:0
v_accvgpr_write_b32 a65, 0
MV 88,v,16,v,56
buffer_load_dwordx4 v210, s[44:47], s75 offen offset:2048 lds
v_accvgpr_write_b32 a66, 0
MV 92,v,16,v,60
TR 16,216,24576
TR 18,216,25600
MV 96,v,20,v,48
v_accvgpr_write_b32 a67, 0
v_accvgpr_write_b32 a68, 0
MV 100,v,20,v,52
buffer_load_dwordx4 v211, s[44:47], s75 offen offset:3072 lds
v_accvgpr_write_b32 a69, 0
MV 104,v,20,v,56
ds_read_b128 v[68:71], v225 offset:2048
v_accvgpr_write_b32 a70, 0
MV 108,v,20,v,60
TR 20,217,24576
TR 22,217,25600
MV 112,v,24,v,48
s_add_u32 s75, s65, s74
v_accvgpr_write_b32 a71, 0
MV 116,v,24,v,52
v_accvgpr_write_b32 a72, 0
v_accvgpr_write_b32 a73, 0
MV 120,v,24,v,56
v_accvgpr_write_b32 a74, 0
v_accvgpr_write_b32 a75, 0
MV 124,v,24,v,60
TR 24,218,24576
TR 26,218,25600
MV 128,v,28,v,48
ds_read_b128 v[72:75], v225 offset:4096
s_add_u32 m0, s67, 69632
MV 132,v,28,v,52
v_accvgpr_write_b32 a76, 0
v_accvgpr_write_b32 a77, 0
MV 136,v,28,v,56
buffer_load_dwordx4 v208, s[44:47], s75 offen offset:0 lds
v_accvgpr_write_b32 a78, 0
MV 140,v,28,v,60
TR 28,219,24576
TR 30,219,25600
MV 144,v,32,v,48
buffer_load_dwordx4 v209, s[44:47], s75 offen offset:1024 lds
v_accvgpr_write_b32 a79, 0
MV 148,v,32,v,52
s_lshl_b32 s36, s2, 2
s_add_u32 s36, s36, s3
MV 152,v,32,v,56
ds_read_b128 v[76:79], v225 offset:6144
s_lshl_b32 s42, s36, 1
MV 156,v,32,v,60
TR 32,220,24576
TR 34,220,25600
MV 160,v,36,v,48
buffer_load_dwordx4 v210, s[44:47], s75 offen offset:2048 lds
s_lshl_b32 s37, s36, 12
MV 164,v,36,v,52
s_add_u32 s16, s32, s37
s_addc_u32 s17, s33, 0
MV 168,v,36,v,56
buffer_load_dwordx4 v211, s[44:47], s75 offen offset:3072 lds
s_mov_b32 s18, 4096
MV 172,v,36,v,60
TR 36,221,24576
TR 38,221,25600
s_waitcnt lgkmcnt(15)
MV 176,v,40,v,48
s_mov_b32 s19, 0x20000
s_add_u32 s37, s37, 50331648
MV 180,v,40,v,52
s_add_u32 s74, s74, 128
MV 184,v,40,v,56
s_add_u32 s20, s40, s37
s_addc_u32 s21, s41, 0
MV 188,v,40,v,60
TR 40,222,24576
TR 42,222,25600
MV 192,v,44,v,48
s_and_b32 s74, s74, 2047
s_mov_b32 s22, 4096
MV 196,v,44,v,52
s_mov_b32 s23, 0x20000
s_lshl_b32 s37, s2, 14
MV 200,v,44,v,56
s_add_u32 s37, s37, 54525952
MV 204,v,44,v,60
TR 44,223,24576
TR 46,223,25600
s_add_u32 s24, s40, s37
s_addc_u32 s25, s41, 0
s_mov_b32 s26, 16384
s_mov_b32 s27, 0x20000
s_mov_b32 s28, s34
s_mov_b32 s29, s35
s_mov_b32 s30, 2048
s_mov_b32 s31, 0x20000
s_mul_i32 s43, s3, 4608
s_add_u32 s43, s43, 132096
s_waitcnt lgkmcnt(4)
MV 80,v,16,v,64
v_accvgpr_write_b32 a80, 0
MV 84,v,16,v,68
v_accvgpr_write_b32 a81, 0
MV 88,v,16,v,72
MV 92,v,16,v,76
v_accvgpr_write_b32 a82, 0
MV 96,v,20,v,64
MV 100,v,20,v,68
v_accvgpr_write_b32 a83, 0
MV 104,v,20,v,72
MV 108,v,20,v,76
s_waitcnt vmcnt(12) lgkmcnt(0)
s_barrier
MV 112,v,24,v,64
s_load_dwordx2 s[32:33], s[0:1], 88
TR 16,216,32768
MV 116,v,24,v,68
TR 18,216,33792
ds_read_b128 v[48:51], v224 offset:32768
MV 120,v,24,v,72
TR 20,217,32768
TR 22,217,33792
MV 124,v,24,v,76
v_accvgpr_write_b32 a84, 0
v_accvgpr_write_b32 a85, 0
MV 128,v,28,v,64
TR 24,218,32768
TR 26,218,33792
MV 132,v,28,v,68
ds_read_b128 v[52:55], v224 offset:34816
v_accvgpr_write_b32 a86, 0
MV 136,v,28,v,72
v_accvgpr_write_b32 a87, 0
MV 140,v,28,v,76
TR 28,219,32768
TR 30,219,33792
MV 144,v,32,v,64
ds_read_b128 v[56:59], v224 offset:36864
v_accvgpr_write_b32 a88, 0
MV 148,v,32,v,68
v_accvgpr_write_b32 a89, 0
MV 152,v,32,v,72
v_accvgpr_write_b32 a90, 0
MV 156,v,32,v,76
TR 32,220,32768
TR 34,220,33792
MV 160,v,36,v,64
ds_read_b128 v[60:63], v224 offset:38912
v_accvgpr_write_b32 a91, 0
MV 164,v,36,v,68
MV 168,v,36,v,72
v_accvgpr_write_b32 a92, 0
MV 172,v,36,v,76
TR 36,221,32768
TR 38,221,33792
MV 176,v,40,v,64
v_accvgpr_write_b32 a93, 0
MV 180,v,40,v,68
MV 184,v,40,v,72
v_accvgpr_write_b32 a94, 0
MV 188,v,40,v,76
TR 40,222,32768
TR 42,222,33792
MV 192,v,44,v,64
v_accvgpr_write_b32 a95, 0
MV 196,v,44,v,68
MV 200,v,44,v,72
MV 204,v,44,v,76
TR 44,223,32768
TR 46,223,33792
s_waitcnt lgkmcnt(4)
MV 80,v,16,v,48
v_accvgpr_write_b32 a96, 0
MV 84,v,16,v,52
ds_read_b128 v[64:67], v225 offset:32768
v_accvgpr_write_b32 a97, 0
MV 88,v,16,v,56
MV 92,v,16,v,60
TR 16,216,40960
TR 18,216,41984
MV 96,v,20,v,48
v_accvgpr_write_b32 a98, 0
MV 100,v,20,v,52
v_accvgpr_write_b32 a99, 0
MV 104,v,20,v,56
ds_read_b128 v[68:71], v225 offset:34816
MV 108,v,20,v,60
TR 20,217,40960
TR 22,217,41984
MV 112,v,24,v,48
v_accvgpr_write_b32 a100, 0
MV 116,v,24,v,52
v_accvgpr_write_b32 a101, 0
MV 120,v,24,v,56
MV 124,v,24,v,60
TR 24,218,40960
TR 26,218,41984
MV 128,v,28,v,48
ds_read_b128 v[72:75], v225 offset:36864
v_accvgpr_write_b32 a102, 0
MV 132,v,28,v,52
v_accvgpr_write_b32 a103, 0
MV 136,v,28,v,56
MV 140,v,28,v,60
TR 28,219,40960
TR 30,219,41984
MV 144,v,32,v,48
v_accvgpr_write_b32 a104, 0
v_accvgpr_write_b32 a105, 0
MV 148,v,32,v,52
MV 152,v,32,v,56
ds_read_b128 v[76:79], v225 offset:38912
v_accvgpr_write_b32 a106, 0
MV 156,v,32,v,60
TR 32,220,40960
TR 34,220,41984
MV 160,v,36,v,48
v_accvgpr_write_b32 a107, 0
MV 164,v,36,v,52
MV 168,v,36,v,56
v_accvgpr_write_b32 a108, 0
MV 172,v,36,v,60
TR 36,221,40960
TR 38,221,41984
s_waitcnt lgkmcnt(15)
MV 176,v,40,v,48
v_accvgpr_write_b32 a109, 0
MV 180,v,40,v,52
MV 184,v,40,v,56
v_accvgpr_write_b32 a110, 0
MV 188,v,40,v,60
TR 40,222,40960
TR 42,222,41984
MV 192,v,44,v,48
v_accvgpr_write_b32 a111, 0
MV 196,v,44,v,52
MV 200,v,44,v,56
MV 204,v,44,v,60
TR 44,223,40960
TR 46,223,41984
s_waitcnt lgkmcnt(4)
MV 80,v,16,v,64
v_accvgpr_write_b32 a112, 0
MV 84,v,16,v,68
v_accvgpr_write_b32 a113, 0
MV 88,v,16,v,72
MV 92,v,16,v,76
v_accvgpr_write_b32 a114, 0
MV 96,v,20,v,64
MV 100,v,20,v,68
v_accvgpr_write_b32 a115, 0
MV 104,v,20,v,72
MV 108,v,20,v,76
s_waitcnt vmcnt(0) lgkmcnt(0)
s_barrier
MV 112,v,24,v,64
TR 16,216,0
TR 18,216,1024
MV 116,v,24,v,68
ds_read_b128 v[48:51], v226 offset:0
v_accvgpr_write_b32 a116, 0
MV 120,v,24,v,72
TR 20,217,0
TR 22,217,1024
MV 124,v,24,v,76
v_accvgpr_write_b32 a117, 0
v_accvgpr_write_b32 a118, 0
MV 128,v,28,v,64
TR 24,218,0
TR 26,218,1024
MV 132,v,28,v,68
ds_read_b128 v[52:55], v226 offset:2048
v_accvgpr_write_b32 a119, 0
MV 136,v,28,v,72
MV 140,v,28,v,76
TR 28,219,0
TR 30,219,1024
MV 144,v,32,v,64
ds_read_b128 v[56:59], v226 offset:4096
v_accvgpr_write_b32 a120, 0
MV 148,v,32,v,68
v_accvgpr_write_b32 a121, 0
MV 152,v,32,v,72
v_accvgpr_write_b32 a122, 0
MV 156,v,32,v,76
TR 32,220,0
TR 34,220,1024
MV 160,v,36,v,64
ds_read_b128 v[60:63], v226 offset:6144
v_accvgpr_write_b32 a123, 0
MV 164,v,36,v,68
MV 168,v,36,v,72
v_accvgpr_write_b32 a124, 0
MV 172,v,36,v,76
TR 36,221,0
TR 38,221,1024
MV 176,v,40,v,64
v_accvgpr_write_b32 a125, 0
MV 180,v,40,v,68
MV 184,v,40,v,72
v_accvgpr_write_b32 a126, 0
MV 188,v,40,v,76
TR 40,222,0
TR 42,222,1024
MV 192,v,44,v,64
v_accvgpr_write_b32 a127, 0
MV 196,v,44,v,68
MV 200,v,44,v,72
MV 204,v,44,v,76
TR 44,223,0
TR 46,223,1024
s_waitcnt lgkmcnt(4)
MV 80,v,16,v,48
buffer_load_dword v237, v233, s[8:11], 0 offen offset:0 sc1
MV 84,v,16,v,52
ds_read_b128 v[64:67], v227 offset:0
s_lshr_b32 s36, s2, 3
MV 88,v,16,v,56
s_lshl_b32 s36, s36, 18
MV 92,v,16,v,60
TR 16,216,8192
TR 18,216,9216
MV 96,v,20,v,48
s_and_b32 s37, s2, 7
s_lshl_b32 s37, s37, 8
MV 100,v,20,v,52
s_add_u32 s36, s36, s37
MV 104,v,20,v,56
ds_read_b128 v[68:71], v227 offset:2048
s_lshl_b32 s37, s3, 16
MV 108,v,20,v,60
TR 20,217,8192
TR 22,217,9216
MV 112,v,24,v,48
s_add_u32 s36, s36, s37
MV 116,v,24,v,52
s_add_u32 s32, s32, s36
s_addc_u32 s33, s33, 0
MV 120,v,24,v,56
MV 124,v,24,v,60
TR 24,218,8192
TR 26,218,9216
MV 128,v,28,v,48
ds_read_b128 v[72:75], v227 offset:4096
s_mov_b32 s34, 65536
MV 132,v,28,v,52
s_mov_b32 s35, 0x20000
v_lshrrev_b32 v238, 4, v1
MV 136,v,28,v,56
MV 140,v,28,v,60
TR 28,219,8192
TR 30,219,9216
MV 144,v,32,v,48
v_and_b32 v239, 15, v1
v_lshlrev_b32 v240, 1, v238
MV 148,v,32,v,52
v_xor_b32 v239, v239, v240
MV 152,v,32,v,56
ds_read_b128 v[76:79], v227 offset:6144
v_lshlrev_b32 v238, 11, v238
MV 156,v,32,v,60
TR 32,220,8192
TR 34,220,9216
MV 160,v,36,v,48
v_lshl_add_u32 v238, v239, 4, v238
v_xor_b32 v239, 128, v238
MV 164,v,36,v,52
s_lshl_b32 s36, s3, 13
MV 168,v,36,v,56
MV 172,v,36,v,60
TR 36,221,8192
TR 38,221,9216
s_waitcnt lgkmcnt(15)
MV 176,v,40,v,48
s_add_u32 m0, s36, 131072
s_mov_b32 s37, 0
MV 180,v,40,v,52
buffer_load_dwordx4 v238, s[32:35], s37 offen offset:0 lds
MV 184,v,40,v,56
s_mov_b32 s37, 7168
MV 188,v,40,v,60
TR 40,222,8192
TR 42,222,9216
MV 192,v,44,v,48
buffer_load_dwordx4 v239, s[32:35], s37 offen offset:1024 lds
s_mov_b32 s37, 14336
MV 196,v,44,v,52
MV 200,v,44,v,56
MV 204,v,44,v,60
TR 44,223,8192
TR 46,223,9216
s_waitcnt lgkmcnt(4)
MV 80,v,16,v,64
buffer_load_dwordx4 v238, s[32:35], s37 offen offset:2048 lds
MV 84,v,16,v,68
MV 88,v,16,v,72
s_mov_b32 s37, 21504
MV 92,v,16,v,76
MV 96,v,20,v,64
MV 100,v,20,v,68
buffer_load_dwordx4 v239, s[32:35], s37 offen offset:3072 lds
MV 104,v,20,v,72
MV 108,v,20,v,76
s_add_u32 m0, s36, 135168
MV 112,v,24,v,64
MV 116,v,24,v,68
MV 120,v,24,v,72
s_mov_b32 s37, 32768
MV 124,v,24,v,76
MV 128,v,28,v,64
buffer_load_dwordx4 v238, s[32:35], s37 offen offset:0 lds
MV 132,v,28,v,68
MV 136,v,28,v,72
MV 140,v,28,v,76
s_mov_b32 s37, 39936
MV 144,v,32,v,64
MV 148,v,32,v,68
buffer_load_dwordx4 v239, s[32:35], s37 offen offset:1024 lds
MV 152,v,32,v,72
MV 156,v,32,v,76
MV 160,v,36,v,64
s_mov_b32 s37, 47104
MV 164,v,36,v,68
MV 168,v,36,v,72
buffer_load_dwordx4 v238, s[32:35], s37 offen offset:2048 lds
MV 172,v,36,v,76
s_waitcnt lgkmcnt(2)
MV 176,v,40,v,64
MV 180,v,40,v,68
s_mov_b32 s37, 54272
MV 184,v,40,v,72
MV 188,v,40,v,76
buffer_load_dwordx4 v239, s[32:35], s37 offen offset:3072 lds
s_waitcnt lgkmcnt(0)
MV 192,v,44,v,64
MV 196,v,44,v,68
MV 200,v,44,v,72
MV 204,v,44,v,76
s_waitcnt vmcnt(8)
v_cmp_gt_u32 vcc, 1, v237
s_nop 4
s_cbranch_vccnz L_spin_f1
L_spin_f1_ret:
s_waitcnt lgkmcnt(0)
s_barrier
s_add_u32 m0, s68, 16384
s_mov_b32 s80, 0
buffer_load_dwordx4 v12, s[52:55], s80 offen offset:0 sc1 lds
buffer_load_dwordx4 v12, s[52:55], s80 offen offset:1024 sc1 lds
buffer_load_dwordx4 v12, s[52:55], s80 offen offset:2048 sc1 lds
buffer_load_dwordx4 v12, s[52:55], s80 offen offset:3072 sc1 lds
s_add_u32 m0, s68, 32768
s_mov_b32 s80, 16384
buffer_load_dwordx4 v12, s[52:55], s80 offen offset:0 sc1 lds
buffer_load_dwordx4 v12, s[52:55], s80 offen offset:1024 sc1 lds
buffer_load_dwordx4 v12, s[52:55], s80 offen offset:2048 sc1 lds
buffer_load_dwordx4 v12, s[52:55], s80 offen offset:3072 sc1 lds
s_mov_b32 s82, 0x3e0293ee
s_mov_b32 s83, 0x3e0293ee
v_pk_mul_f32 v[80:81], v[80:81], s[82:83]
v_pk_mul_f32 v[82:83], v[82:83], s[82:83]
v_pk_mul_f32 v[84:85], v[84:85], s[82:83]
v_pk_mul_f32 v[86:87], v[86:87], s[82:83]
s_add_u32 m0, s68, 81920
v_pk_mul_f32 v[88:89], v[88:89], s[82:83]
v_pk_mul_f32 v[90:91], v[90:91], s[82:83]
v_pk_mul_f32 v[92:93], v[92:93], s[82:83]
v_pk_mul_f32 v[94:95], v[94:95], s[82:83]
v_pk_mul_f32 v[96:97], v[96:97], s[82:83]
v_pk_mul_f32 v[98:99], v[98:99], s[82:83]
v_pk_mul_f32 v[100:101], v[100:101], s[82:83]
s_mov_b32 s80, 16384
v_pk_mul_f32 v[102:103], v[102:103], s[82:83]
v_pk_mul_f32 v[104:105], v[104:105], s[82:83]
v_pk_mul_f32 v[106:107], v[106:107], s[82:83]
v_pk_mul_f32 v[108:109], v[108:109], s[82:83]
v_pk_mul_f32 v[110:111], v[110:111], s[82:83]
v_cvt_pk_bf16_f32 v16, v80, v81
buffer_load_dwordx4 v12, s[56:59], s80 offen offset:0 sc1 lds
v_cvt_pk_bf16_f32 v17, v82, v83
v_cvt_pk_bf16_f32 v18, v96, v97
v_cvt_pk_bf16_f32 v19, v98, v99
v_cvt_pk_bf16_f32 v20, v84, v85
v_cvt_pk_bf16_f32 v21, v86, v87
v_cvt_pk_bf16_f32 v22, v100, v101
v_cvt_pk_bf16_f32 v23, v102, v103
buffer_load_dwordx4 v12, s[56:59], s80 offen offset:1024 sc1 lds
v_cvt_pk_bf16_f32 v48, v88, v89
v_cvt_pk_bf16_f32 v49, v90, v91
v_cvt_pk_bf16_f32 v50, v104, v105
v_cvt_pk_bf16_f32 v51, v106, v107
v_cvt_pk_bf16_f32 v52, v92, v93
v_cvt_pk_bf16_f32 v53, v94, v95
v_cvt_pk_bf16_f32 v54, v108, v109
buffer_load_dwordx4 v12, s[56:59], s80 offen offset:2048 sc1 lds
v_cvt_pk_bf16_f32 v55, v110, v111
v_permlane16_swap_b32 v16, v20
v_permlane16_swap_b32 v17, v21
v_permlane16_swap_b32 v18, v22
v_permlane16_swap_b32 v19, v23
v_permlane16_swap_b32 v48, v52
buffer_load_dwordx4 v12, s[56:59], s80 offen offset:3072 sc1 lds
v_permlane16_swap_b32 v49, v53
v_permlane16_swap_b32 v50, v54
v_permlane16_swap_b32 v51, v55
v_pk_mul_f32 v[112:113], v[112:113], s[82:83]
v_pk_mul_f32 v[114:115], v[114:115], s[82:83]
v_pk_mul_f32 v[116:117], v[116:117], s[82:83]
v_pk_mul_f32 v[118:119], v[118:119], s[82:83]
s_add_u32 m0, s68, 49152
v_pk_mul_f32 v[120:121], v[120:121], s[82:83]
v_pk_mul_f32 v[122:123], v[122:123], s[82:83]
v_pk_mul_f32 v[124:125], v[124:125], s[82:83]
v_pk_mul_f32 v[126:127], v[126:127], s[82:83]
v_pk_mul_f32 v[128:129], v[128:129], s[82:83]
v_pk_mul_f32 v[130:131], v[130:131], s[82:83]
v_pk_mul_f32 v[132:133], v[132:133], s[82:83]
s_mov_b32 s80, 32768
v_pk_mul_f32 v[134:135], v[134:135], s[82:83]
v_pk_mul_f32 v[136:137], v[136:137], s[82:83]
v_pk_mul_f32 v[138:139], v[138:139], s[82:83]
v_pk_mul_f32 v[140:141], v[140:141], s[82:83]
v_pk_mul_f32 v[142:143], v[142:143], s[82:83]
v_cvt_pk_bf16_f32 v24, v112, v113
buffer_load_dwordx4 v12, s[52:55], s80 offen offset:0 sc1 lds
v_cvt_pk_bf16_f32 v25, v114, v115
v_cvt_pk_bf16_f32 v26, v128, v129
v_cvt_pk_bf16_f32 v27, v130, v131
v_cvt_pk_bf16_f32 v28, v116, v117
v_cvt_pk_bf16_f32 v29, v118, v119
v_cvt_pk_bf16_f32 v30, v132, v133
v_cvt_pk_bf16_f32 v31, v134, v135
buffer_load_dwordx4 v12, s[52:55], s80 offen offset:1024 sc1 lds
v_cvt_pk_bf16_f32 v56, v120, v121
v_cvt_pk_bf16_f32 v57, v122, v123
v_cvt_pk_bf16_f32 v58, v136, v137
v_cvt_pk_bf16_f32 v59, v138, v139
v_cvt_pk_bf16_f32 v60, v124, v125
v_cvt_pk_bf16_f32 v61, v126, v127
buffer_load_dwordx4 v12, s[52:55], s80 offen offset:2048 sc1 lds
v_cvt_pk_bf16_f32 v62, v140, v141
v_cvt_pk_bf16_f32 v63, v142, v143
v_permlane16_swap_b32 v24, v28
v_permlane16_swap_b32 v25, v29
v_permlane16_swap_b32 v26, v30
v_permlane16_swap_b32 v27, v31
v_permlane16_swap_b32 v56, v60
buffer_load_dwordx4 v12, s[52:55], s80 offen offset:3072 sc1 lds
v_permlane16_swap_b32 v57, v61
v_permlane16_swap_b32 v58, v62
v_permlane16_swap_b32 v59, v63
v_pk_mul_f32 v[144:145], v[144:145], s[82:83]
v_pk_mul_f32 v[146:147], v[146:147], s[82:83]
v_pk_mul_f32 v[148:149], v[148:149], s[82:83]
v_pk_mul_f32 v[150:151], v[150:151], s[82:83]
s_add_u32 m0, s68, 98304
v_pk_mul_f32 v[152:153], v[152:153], s[82:83]
v_pk_mul_f32 v[154:155], v[154:155], s[82:83]
v_pk_mul_f32 v[156:157], v[156:157], s[82:83]
v_pk_mul_f32 v[158:159], v[158:159], s[82:83]
v_pk_mul_f32 v[160:161], v[160:161], s[82:83]
v_pk_mul_f32 v[162:163], v[162:163], s[82:83]
s_mov_b32 s80, 32768
v_pk_mul_f32 v[164:165], v[164:165], s[82:83]
v_pk_mul_f32 v[166:167], v[166:167], s[82:83]
v_pk_mul_f32 v[168:169], v[168:169], s[82:83]
v_pk_mul_f32 v[170:171], v[170:171], s[82:83]
v_pk_mul_f32 v[172:173], v[172:173], s[82:83]
v_pk_mul_f32 v[174:175], v[174:175], s[82:83]
v_cvt_pk_bf16_f32 v32, v144, v145
buffer_load_dwordx4 v12, s[56:59], s80 offen offset:0 sc1 lds
v_cvt_pk_bf16_f32 v33, v146, v147
v_cvt_pk_bf16_f32 v34, v160, v161
v_cvt_pk_bf16_f32 v35, v162, v163
v_cvt_pk_bf16_f32 v36, v148, v149
v_cvt_pk_bf16_f32 v37, v150, v151
v_cvt_pk_bf16_f32 v38, v164, v165
v_cvt_pk_bf16_f32 v39, v166, v167
buffer_load_dwordx4 v12, s[56:59], s80 offen offset:1024 sc1 lds
v_cvt_pk_bf16_f32 v64, v152, v153
v_cvt_pk_bf16_f32 v65, v154, v155
v_cvt_pk_bf16_f32 v66, v168, v169
v_cvt_pk_bf16_f32 v67, v170, v171
v_cvt_pk_bf16_f32 v68, v156, v157
v_cvt_pk_bf16_f32 v69, v158, v159
buffer_load_dwordx4 v12, s[56:59], s80 offen offset:2048 sc1 lds
v_cvt_pk_bf16_f32 v70, v172, v173
v_cvt_pk_bf16_f32 v71, v174, v175
v_permlane16_swap_b32 v32, v36
v_permlane16_swap_b32 v33, v37
v_permlane16_swap_b32 v34, v38
v_permlane16_swap_b32 v35, v39
v_permlane16_swap_b32 v64, v68
buffer_load_dwordx4 v12, s[56:59], s80 offen offset:3072 sc1 lds
v_permlane16_swap_b32 v65, v69
v_permlane16_swap_b32 v66, v70
v_permlane16_swap_b32 v67, v71
v_pk_mul_f32 v[176:177], v[176:177], s[82:83]
v_pk_mul_f32 v[178:179], v[178:179], s[82:83]
v_pk_mul_f32 v[180:181], v[180:181], s[82:83]
v_pk_mul_f32 v[182:183], v[182:183], s[82:83]
s_add_u32 m0, s68, 0
v_pk_mul_f32 v[184:185], v[184:185], s[82:83]
v_pk_mul_f32 v[186:187], v[186:187], s[82:83]
v_pk_mul_f32 v[188:189], v[188:189], s[82:83]
v_pk_mul_f32 v[190:191], v[190:191], s[82:83]
v_pk_mul_f32 v[192:193], v[192:193], s[82:83]
v_pk_mul_f32 v[194:195], v[194:195], s[82:83]
s_mov_b32 s80, 49152
v_pk_mul_f32 v[196:197], v[196:197], s[82:83]
v_pk_mul_f32 v[198:199], v[198:199], s[82:83]
v_pk_mul_f32 v[200:201], v[200:201], s[82:83]
v_pk_mul_f32 v[202:203], v[202:203], s[82:83]
v_pk_mul_f32 v[204:205], v[204:205], s[82:83]
v_pk_mul_f32 v[206:207], v[206:207], s[82:83]
v_cvt_pk_bf16_f32 v40, v176, v177
buffer_load_dwordx4 v12, s[52:55], s80 offen offset:0 sc1 lds
v_cvt_pk_bf16_f32 v41, v178, v179
v_cvt_pk_bf16_f32 v42, v192, v193
v_cvt_pk_bf16_f32 v43, v194, v195
v_cvt_pk_bf16_f32 v44, v180, v181
v_cvt_pk_bf16_f32 v45, v182, v183
v_cvt_pk_bf16_f32 v46, v196, v197
buffer_load_dwordx4 v12, s[52:55], s80 offen offset:1024 sc1 lds
v_cvt_pk_bf16_f32 v47, v198, v199
v_cvt_pk_bf16_f32 v72, v184, v185
v_cvt_pk_bf16_f32 v73, v186, v187
v_cvt_pk_bf16_f32 v74, v200, v201
v_cvt_pk_bf16_f32 v75, v202, v203
v_cvt_pk_bf16_f32 v76, v188, v189
v_cvt_pk_bf16_f32 v77, v190, v191
buffer_load_dwordx4 v12, s[52:55], s80 offen offset:2048 sc1 lds
v_cvt_pk_bf16_f32 v78, v204, v205
v_cvt_pk_bf16_f32 v79, v206, v207
v_permlane16_swap_b32 v40, v44
v_permlane16_swap_b32 v41, v45
v_permlane16_swap_b32 v42, v46
v_permlane16_swap_b32 v43, v47
v_permlane16_swap_b32 v72, v76
buffer_load_dwordx4 v12, s[52:55], s80 offen offset:3072 sc1 lds
v_permlane16_swap_b32 v73, v77
v_permlane16_swap_b32 v74, v78
v_permlane16_swap_b32 v75, v79
v_mov_b32 v208, 0
v_mov_b32 v209, 0
v_mov_b32 v210, 0
s_add_u32 m0, s68, 114688
v_mov_b32 v211, 0
v_mov_b32 v212, 0
v_mov_b32 v213, 0
v_mov_b32 v214, 0
v_mov_b32 v215, 0
v_mov_b32 v216, 0
v_mov_b32 v217, 0
s_mov_b32 s80, 49152
v_mov_b32 v218, 0
v_mov_b32 v219, 0
v_mov_b32 v220, 0
v_mov_b32 v221, 0
v_mov_b32 v222, 0
v_mov_b32 v223, 0
v_mov_b32 v224, 0
buffer_load_dwordx4 v12, s[56:59], s80 offen offset:0 sc1 lds
v_mov_b32 v225, 0
v_mov_b32 v226, 0
v_mov_b32 v227, 0
v_mov_b32 v228, 0
v_mov_b32 v229, 0
v_mov_b32 v230, 0
buffer_load_dwordx4 v12, s[56:59], s80 offen offset:1024 sc1 lds
v_mov_b32 v231, 0
v_mov_b32 v232, 0
v_mov_b32 v233, 0
v_mov_b32 v234, 0
v_mov_b32 v235, 0
v_mov_b32 v236, 0
v_mov_b32 v237, 0
buffer_load_dwordx4 v12, s[56:59], s80 offen offset:2048 sc1 lds
v_mov_b32 v238, 0
v_mov_b32 v239, 0
v_mov_b32 v2, 0
v_mov_b32 v3, 0
v_mov_b32 v4, 0
v_mov_b32 v5, 0
v_xor_b32 v244, 0x8000, v10
buffer_load_dwordx4 v12, s[56:59], s80 offen offset:3072 sc1 lds
s_waitcnt vmcnt(24)
s_barrier
ds_read_b128 a[128:131], v244 offset:16384
ds_read_b128 a[132:135], v244 offset:17408
ds_read_b128 a[136:139], v244 offset:18432
ds_read_b128 a[140:143], v244 offset:19456
ds_read_b128 a[144:147], v244 offset:20480
ds_read_b128 a[148:151], v244 offset:21504
ds_read_b128 a[152:155], v244 offset:22528
ds_read_b128 a[156:159], v244 offset:23552
ds_read_b128 a[160:163], v244 offset:24576
ds_read_b128 a[164:167], v244 offset:25600
ds_read_b128 a[168:171], v244 offset:26624
ds_read_b128 a[172:175], v244 offset:27648
ds_read_b128 a[176:179], v244 offset:28672
ds_read_b128 a[180:183], v244 offset:29696
ds_read_b128 a[184:187], v244 offset:30720
ds_read_b128 a[188:191], v244 offset:31744
s_waitcnt lgkmcnt(15)
v_mfma_f32_32x32x16_bf16 v[80:95], a[128:131], v[16:19], 0
v_mfma_f32_32x32x16_bf16 v[96:111], a[128:131], v[48:51], 0
s_waitcnt lgkmcnt(14)
v_mfma_f32_32x32x16_bf16 v[80:95], a[132:135], v[20:23], v[80:95]
v_mfma_f32_32x32x16_bf16 v[96:111], a[132:135], v[52:55], v[96:111]
s_waitcnt lgkmcnt(13)
v_mfma_f32_32x32x16_bf16 v[80:95], a[136:139], v[24:27], v[80:95]
v_mfma_f32_32x32x16_bf16 v[96:111], a[136:139], v[56:59], v[96:111]
s_waitcnt lgkmcnt(12)
v_mfma_f32_32x32x16_bf16 v[80:95], a[140:143], v[28:31], v[80:95]
v_mfma_f32_32x32x16_bf16 v[96:111], a[140:143], v[60:63], v[96:111]
s_waitcnt lgkmcnt(11)
v_mfma_f32_32x32x16_bf16 v[80:95], a[144:147], v[32:35], v[80:95]
v_mfma_f32_32x32x16_bf16 v[96:111], a[144:147], v[64:67], v[96:111]
s_waitcnt lgkmcnt(10)
v_mfma_f32_32x32x16_bf16 v[80:95], a[148:151], v[36:39], v[80:95]
v_mfma_f32_32x32x16_bf16 v[96:111], a[148:151], v[68:71], v[96:111]
s_waitcnt lgkmcnt(9)
v_mfma_f32_32x32x16_bf16 v[80:95], a[152:155], v[40:43], v[80:95]
v_mfma_f32_32x32x16_bf16 v[96:111], a[152:155], v[72:75], v[96:111]
s_waitcnt vmcnt(16) lgkmcnt(0)
s_barrier
v_mfma_f32_32x32x16_bf16 v[80:95], a[156:159], v[44:47], v[80:95]
ds_read_b128 a[128:131], v10 offset:0
ds_read_b128 a[132:135], v10 offset:1024
s_add_u32 m0, s68, 16384
v_mfma_f32_32x32x16_bf16 v[96:111], a[156:159], v[76:79], v[96:111]
ds_read_b128 a[136:139], v10 offset:2048
ds_read_b128 a[140:143], v10 offset:3072
v_mfma_f32_32x32x16_bf16 v[112:127], a[160:163], v[16:19], 0
ds_read_b128 a[144:147], v10 offset:4096
ds_read_b128 a[148:151], v10 offset:5120
s_mov_b32 s80, 65536
v_mfma_f32_32x32x16_bf16 v[128:143], a[160:163], v[48:51], 0
ds_read_b128 a[152:155], v10 offset:6144
ds_read_b128 a[156:159], v10 offset:7168
v_mfma_f32_32x32x16_bf16 v[112:127], a[164:167], v[20:23], v[112:127]
ds_read_b128 a[160:163], v10 offset:8192
buffer_load_dwordx4 v12, s[52:55], s80 offen offset:0 sc1 lds
v_mfma_f32_32x32x16_bf16 v[128:143], a[164:167], v[52:55], v[128:143]
ds_read_b128 a[164:167], v10 offset:9216
v_mfma_f32_32x32x16_bf16 v[112:127], a[168:171], v[24:27], v[112:127]
v_mfma_f32_32x32x16_bf16 v[128:143], a[168:171], v[56:59], v[128:143]
ds_read_b128 a[168:171], v10 offset:10240
buffer_load_dwordx4 v12, s[52:55], s80 offen offset:1024 sc1 lds
v_mfma_f32_32x32x16_bf16 v[112:127], a[172:175], v[28:31], v[112:127]
v_mfma_f32_32x32x16_bf16 v[128:143], a[172:175], v[60:63], v[128:143]
ds_read_b128 a[172:175], v10 offset:11264
buffer_load_dwordx4 v12, s[52:55], s80 offen offset:2048 sc1 lds
v_mfma_f32_32x32x16_bf16 v[112:127], a[176:179], v[32:35], v[112:127]
v_mfma_f32_32x32x16_bf16 v[128:143], a[176:179], v[64:67], v[128:143]
ds_read_b128 a[176:179], v10 offset:12288
v_mfma_f32_32x32x16_bf16 v[112:127], a[180:183], v[36:39], v[112:127]
buffer_load_dwordx4 v12, s[52:55], s80 offen offset:3072 sc1 lds
v_mfma_f32_32x32x16_bf16 v[128:143], a[180:183], v[68:71], v[128:143]
ds_read_b128 a[180:183], v10 offset:13312
v_mfma_f32_32x32x16_bf16 v[112:127], a[184:187], v[40:43], v[112:127]
s_mov_b32 s71, 65536
v_mfma_f32_32x32x16_bf16 v[128:143], a[184:187], v[72:75], v[128:143]
ds_read_b128 a[184:187], v10 offset:14336
v_mfma_f32_32x32x16_bf16 v[112:127], a[188:191], v[44:47], v[112:127]
v_mfma_f32_32x32x16_bf16 v[128:143], a[188:191], v[76:79], v[128:143]
ds_read_b128 a[188:191], v10 offset:15360
s_cmp_eq_u32 s70, 0
s_cbranch_scc1 L_p3_pmask
L_p3_pmask_ret:
v_max3_f32 v6, v80, v81, v82
v_max3_f32 v7, v96, v97, v98
v_max3_f32 v6, v6, v83, v84
v_max3_f32 v7, v7, v99, v100
v_max3_f32 v6, v6, v85, v86
v_max3_f32 v7, v7, v101, v102
v_max3_f32 v6, v6, v87, v88
v_max3_f32 v7, v7, v103, v104
v_max3_f32 v6, v6, v89, v90
v_max3_f32 v7, v7, v105, v106
v_max3_f32 v6, v6, v91, v92
v_max3_f32 v7, v7, v107, v108
v_max3_f32 v6, v6, v93, v94
v_max3_f32 v7, v7, v109, v110
v_max3_f32 v6, v6, v95, v112
v_max3_f32 v7, v7, v111, v128
v_max3_f32 v6, v6, v113, v114
v_max3_f32 v7, v7, v129, v130
v_max3_f32 v6, v6, v115, v116
v_max3_f32 v7, v7, v131, v132
v_max3_f32 v6, v6, v117, v118
v_max3_f32 v7, v7, v133, v134
v_max3_f32 v6, v6, v119, v120
v_max3_f32 v7, v7, v135, v136
v_max3_f32 v6, v6, v121, v122
v_max3_f32 v7, v7, v137, v138
v_max3_f32 v6, v6, v123, v124
v_max3_f32 v7, v7, v139, v140
v_max3_f32 v6, v6, v125, v126
v_max3_f32 v7, v7, v141, v142
v_max_f32 v6, v6, v127
v_max_f32 v7, v7, v143
v_mov_b32 v240, v6
v_mov_b32 v241, v7
s_nop 0
v_permlane32_swap_b32 v6, v240
v_permlane32_swap_b32 v7, v241
v_max_f32 v6, v6, v240
v_max_f32 v7, v7, v241
v_max_f32 v240, abs(v6), abs(v7)
v_cmp_nge_f32 vcc, s79, v240
s_nop 4
s_cbranch_vccnz L_p3_pfix
L_p3_pfix_ret:
v_exp_f32 v80, v80
v_exp_f32 v81, v81
v_exp_f32 v82, v82
v_add_f32 v2, v2, v80
v_exp_f32 v83, v83
v_add_f32 v3, v3, v81
v_cvt_pk_bf16_f32 v80, v80, v81
v_exp_f32 v84, v84
v_add_f32 v2, v2, v82
v_exp_f32 v85, v85
v_add_f32 v3, v3, v83
v_cvt_pk_bf16_f32 v81, v82, v83
v_exp_f32 v86, v86
v_add_f32 v2, v2, v84
v_exp_f32 v87, v87
v_add_f32 v3, v3, v85
v_cvt_pk_bf16_f32 v82, v84, v85
v_exp_f32 v88, v88
v_add_f32 v2, v2, v86
v_exp_f32 v89, v89
v_add_f32 v3, v3, v87
v_cvt_pk_bf16_f32 v83, v86, v87
v_exp_f32 v90, v90
v_add_f32 v2, v2, v88
v_exp_f32 v91, v91
v_add_f32 v3, v3, v89
v_cvt_pk_bf16_f32 v88, v88, v89
v_exp_f32 v92, v92
v_add_f32 v2, v2, v90
v_exp_f32 v93, v93
v_add_f32 v3, v3, v91
v_cvt_pk_bf16_f32 v89, v90, v91
v_exp_f32 v94, v94
v_add_f32 v2, v2, v92
v_exp_f32 v95, v95
v_add_f32 v3, v3, v93
v_cvt_pk_bf16_f32 v90, v92, v93
v_exp_f32 v96, v96
v_add_f32 v2, v2, v94
v_exp_f32 v97, v97
v_add_f32 v3, v3, v95
v_cvt_pk_bf16_f32 v91, v94, v95
v_exp_f32 v98, v98
v_add_f32 v4, v4, v96
v_exp_f32 v99, v99
v_add_f32 v5, v5, v97
v_cvt_pk_bf16_f32 v96, v96, v97
v_exp_f32 v100, v100
v_add_f32 v4, v4, v98
v_exp_f32 v101, v101
v_add_f32 v5, v5, v99
v_cvt_pk_bf16_f32 v97, v98, v99
v_exp_f32 v102, v102
v_add_f32 v4, v4, v100
v_exp_f32 v103, v103
v_add_f32 v5, v5, v101
v_cvt_pk_bf16_f32 v98, v100, v101
v_add_f32 v4, v4, v102
v_add_f32 v5, v5, v103
v_cvt_pk_bf16_f32 v99, v102, v103
s_sub_u32 s74, s70, 1
s_cbranch_scc1 L_p3_d0m_top
.p2align 5
L_p3_d0_top:
s_waitcnt lgkmcnt(0)
v_mfma_f32_32x32x16_bf16 v[144:159], a[128:131], v[16:19], v[208:223]
s_add_u32 m0, s73, 0
ds_read_b128 a[192:195], v11 offset:16384
v_exp_f32 v104, v104
v_exp_f32 v105, v105
v_mfma_f32_32x32x16_bf16 v[160:175], a[128:131], v[48:51], v[224:239]
ds_read_b128 a[196:199], v11 offset:17408
buffer_load_dwordx4 v12, s[56:59], s71 offen offset:0 sc1 lds
v_exp_f32 v106, v106
v_add_f32 v4, v4, v104
v_mfma_f32_32x32x16_bf16 v[144:159], a[132:135], v[20:23], v[144:159]
ds_read_b128 a[200:203], v11 offset:18432
v_exp_f32 v107, v107
v_add_f32 v5, v5, v105
v_cvt_pk_bf16_f32 v104, v104, v105
v_mfma_f32_32x32x16_bf16 v[160:175], a[132:135], v[52:55], v[160:175]
v_exp_f32 v108, v108
v_add_f32 v4, v4, v106
v_exp_f32 v109, v109
v_add_f32 v5, v5, v107
v_mfma_f32_32x32x16_bf16 v[144:159], a[136:139], v[24:27], v[144:159]
ds_read_b128 a[204:207], v11 offset:19456
v_cvt_pk_bf16_f32 v105, v106, v107
v_exp_f32 v110, v110
v_add_f32 v4, v4, v108
v_mfma_f32_32x32x16_bf16 v[160:175], a[136:139], v[56:59], v[160:175]
ds_read_b128 a[208:211], v11 offset:20480
v_exp_f32 v111, v111
v_add_f32 v5, v5, v109
v_cvt_pk_bf16_f32 v106, v108, v109
v_mfma_f32_32x32x16_bf16 v[144:159], a[140:143], v[28:31], v[144:159]
ds_read_b128 a[212:215], v11 offset:21504
v_exp_f32 v112, v112
v_add_f32 v4, v4, v110
v_exp_f32 v113, v113
v_mfma_f32_32x32x16_bf16 v[160:175], a[140:143], v[60:63], v[160:175]
buffer_load_dwordx4 v12, s[56:59], s71 offen offset:1024 sc1 lds
v_add_f32 v5, v5, v111
v_cvt_pk_bf16_f32 v107, v110, v111
v_exp_f32 v114, v114
v_add_f32 v2, v2, v112
v_mfma_f32_32x32x16_bf16 v[144:159], a[144:147], v[32:35], v[144:159]
ds_read_b128 a[216:219], v11 offset:22528
v_exp_f32 v115, v115
v_add_f32 v3, v3, v113
v_cvt_pk_bf16_f32 v112, v112, v113
v_mfma_f32_32x32x16_bf16 v[160:175], a[144:147], v[64:67], v[160:175]
ds_read_b128 a[220:223], v11 offset:23552
v_exp_f32 v116, v116
v_add_f32 v2, v2, v114
v_exp_f32 v117, v117
v_mfma_f32_32x32x16_bf16 v[144:159], a[148:151], v[36:39], v[144:159]
v_add_f32 v3, v3, v115
v_cvt_pk_bf16_f32 v113, v114, v115
v_exp_f32 v118, v118
v_add_f32 v2, v2, v116
v_mfma_f32_32x32x16_bf16 v[160:175], a[148:151], v[68:71], v[160:175]
ds_read_b128 a[224:227], v11 offset:24576
v_exp_f32 v119, v119
v_add_f32 v3, v3, v117
v_cvt_pk_bf16_f32 v114, v116, v117
v_mfma_f32_32x32x16_bf16 v[144:159], a[152:155], v[40:43], v[144:159]
ds_read_b128 a[228:231], v11 offset:25600
v_exp_f32 v120, v120
v_add_f32 v2, v2, v118
v_exp_f32 v121, v121
v_mfma_f32_32x32x16_bf16 v[160:175], a[152:155], v[72:75], v[160:175]
ds_read_b128 a[232:235], v11 offset:26624
buffer_load_dwordx4 v12, s[56:59], s71 offen offset:2048 sc1 lds
v_add_f32 v3, v3, v119
v_cvt_pk_bf16_f32 v115, v118, v119
v_exp_f32 v122, v122
v_mfma_f32_32x32x16_bf16 v[144:159], a[156:159], v[44:47], v[144:159]
v_add_f32 v2, v2, v120
v_exp_f32 v123, v123
v_add_f32 v3, v3, v121
v_mfma_f32_32x32x16_bf16 v[160:175], a[156:159], v[76:79], v[160:175]
ds_read_b128 a[236:239], v11 offset:27648
v_cvt_pk_bf16_f32 v120, v120, v121
v_exp_f32 v124, v124
v_add_f32 v2, v2, v122
v_mfma_f32_32x32x16_bf16 v[176:191], a[160:163], v[16:19], v[208:223]
ds_read_b128 a[240:243], v11 offset:28672
v_exp_f32 v125, v125
v_add_f32 v3, v3, v123
v_cvt_pk_bf16_f32 v121, v122, v123
v_mfma_f32_32x32x16_bf16 v[192:207], a[160:163], v[48:51], v[224:239]
ds_read_b128 a[244:247], v11 offset:29696
v_exp_f32 v126, v126
v_add_f32 v2, v2, v124
v_exp_f32 v127, v127
v_mfma_f32_32x32x16_bf16 v[176:191], a[164:167], v[20:23], v[176:191]
v_add_f32 v3, v3, v125
v_cvt_pk_bf16_f32 v122, v124, v125
v_exp_f32 v128, v128
v_add_f32 v2, v2, v126
v_mfma_f32_32x32x16_bf16 v[192:207], a[164:167], v[52:55], v[192:207]
ds_read_b128 a[248:251], v11 offset:30720
buffer_load_dwordx4 v12, s[56:59], s71 offen offset:3072 sc1 lds
v_exp_f32 v129, v129
v_add_f32 v3, v3, v127
v_cvt_pk_bf16_f32 v123, v126, v127
v_mfma_f32_32x32x16_bf16 v[176:191], a[168:171], v[24:27], v[176:191]
ds_read_b128 a[252:255], v11 offset:31744
v_exp_f32 v130, v130
v_add_f32 v4, v4, v128
v_exp_f32 v131, v131
v_mfma_f32_32x32x16_bf16 v[192:207], a[168:171], v[56:59], v[192:207]
v_add_f32 v5, v5, v129
v_cvt_pk_bf16_f32 v128, v128, v129
v_exp_f32 v132, v132
v_mfma_f32_32x32x16_bf16 v[176:191], a[172:175], v[28:31], v[176:191]
v_add_f32 v4, v4, v130
v_exp_f32 v133, v133
v_add_f32 v5, v5, v131
v_mfma_f32_32x32x16_bf16 v[192:207], a[172:175], v[60:63], v[192:207]
v_cvt_pk_bf16_f32 v129, v130, v131
v_exp_f32 v134, v134
v_add_f32 v4, v4, v132
v_mfma_f32_32x32x16_bf16 v[176:191], a[176:179], v[32:35], v[176:191]
v_exp_f32 v135, v135
v_add_f32 v5, v5, v133
v_cvt_pk_bf16_f32 v130, v132, v133
v_exp_f32 v136, v136
v_mfma_f32_32x32x16_bf16 v[192:207], a[176:179], v[64:67], v[192:207]
s_add_u32 s71, s71, 16384
v_add_f32 v4, v4, v134
v_exp_f32 v137, v137
v_mfma_f32_32x32x16_bf16 v[176:191], a[180:183], v[36:39], v[176:191]
v_add_f32 v5, v5, v135
v_cvt_pk_bf16_f32 v131, v134, v135
v_exp_f32 v138, v138
v_add_f32 v4, v4, v136
v_mfma_f32_32x32x16_bf16 v[192:207], a[180:183], v[68:71], v[192:207]
v_exp_f32 v139, v139
v_add_f32 v5, v5, v137
v_cvt_pk_bf16_f32 v136, v136, v137
v_mfma_f32_32x32x16_bf16 v[176:191], a[184:187], v[40:43], v[176:191]
v_exp_f32 v140, v140
v_add_f32 v4, v4, v138
v_exp_f32 v141, v141
v_mfma_f32_32x32x16_bf16 v[192:207], a[184:187], v[72:75], v[192:207]
v_add_f32 v5, v5, v139
v_cvt_pk_bf16_f32 v137, v138, v139
v_exp_f32 v142, v142
v_mfma_f32_32x32x16_bf16 v[176:191], a[188:191], v[44:47], v[176:191]
v_add_f32 v4, v4, v140
v_exp_f32 v143, v143
v_add_f32 v5, v5, v141
v_mfma_f32_32x32x16_bf16 v[192:207], a[188:191], v[76:79], v[192:207]
v_cvt_pk_bf16_f32 v138, v140, v141
v_add_f32 v4, v4, v142
v_add_f32 v5, v5, v143
v_cvt_pk_bf16_f32 v139, v142, v143
s_waitcnt vmcnt(16) lgkmcnt(0)
v_mfma_f32_32x32x16_bf16 a[0:15], a[192:195], v[80:83], a[0:15]
s_barrier
v_mfma_f32_32x32x16_bf16 a[64:79], a[192:195], v[96:99], a[64:79]
ds_read_b128 a[128:131], v10 offset:16384
v_max3_f32 v6, v144, v145, v146
v_max3_f32 v7, v160, v161, v162
v_max3_f32 v6, v6, v147, v148
v_max3_f32 v7, v7, v163, v164
v_max3_f32 v6, v6, v149, v150
v_mfma_f32_32x32x16_bf16 a[16:31], a[196:199], v[80:83], a[16:31]
ds_read_b128 a[132:135], v10 offset:17408
v_max3_f32 v7, v7, v165, v166
v_max3_f32 v6, v6, v151, v152
v_max3_f32 v7, v7, v167, v168
v_max3_f32 v6, v6, v153, v154
v_max3_f32 v7, v7, v169, v170
v_mfma_f32_32x32x16_bf16 a[80:95], a[196:199], v[96:99], a[80:95]
v_max3_f32 v6, v6, v155, v156
v_max3_f32 v7, v7, v171, v172
v_max3_f32 v6, v6, v157, v158
v_max3_f32 v7, v7, v173, v174
v_max3_f32 v6, v6, v159, v176
v_mfma_f32_32x32x16_bf16 a[32:47], a[200:203], v[80:83], a[32:47]
ds_read_b128 a[136:139], v10 offset:18432
v_max3_f32 v7, v7, v175, v192
v_max3_f32 v6, v6, v177, v178
v_max3_f32 v7, v7, v193, v194
v_max3_f32 v6, v6, v179, v180
v_max3_f32 v7, v7, v195, v196
v_mfma_f32_32x32x16_bf16 a[96:111], a[200:203], v[96:99], a[96:111]
v_max3_f32 v6, v6, v181, v182
v_max3_f32 v7, v7, v197, v198
v_max3_f32 v6, v6, v183, v184
v_max3_f32 v7, v7, v199, v200
v_max3_f32 v6, v6, v185, v186
v_mfma_f32_32x32x16_bf16 a[48:63], a[204:207], v[80:83], a[48:63]
ds_read_b128 a[140:143], v10 offset:19456
v_max3_f32 v7, v7, v201, v202
v_max3_f32 v6, v6, v187, v188
v_max3_f32 v7, v7, v203, v204
v_max3_f32 v6, v6, v189, v190
v_max3_f32 v7, v7, v205, v206
v_mfma_f32_32x32x16_bf16 a[112:127], a[204:207], v[96:99], a[112:127]
v_max_f32 v6, v6, v191
v_max_f32 v7, v7, v207
v_max_f32 v240, v6, v7
v_cmp_lt_f32 vcc, s79, v240
v_mfma_f32_32x32x16_bf16 a[0:15], a[208:211], v[88:91], a[0:15]
s_cbranch_vccnz L_p3_d0_rare
s_add_u32 m0, s72, 0
ds_read_b128 a[144:147], v10 offset:20480
v_exp_f32 v144, v144
v_exp_f32 v145, v145
v_mfma_f32_32x32x16_bf16 a[64:79], a[208:211], v[104:107], a[64:79]
ds_read_b128 a[148:151], v10 offset:21504
buffer_load_dwordx4 v12, s[52:55], s71 offen offset:0 sc1 lds
v_exp_f32 v146, v146
v_add_f32 v2, v2, v144
v_mfma_f32_32x32x16_bf16 a[16:31], a[212:215], v[88:91], a[16:31]
v_exp_f32 v147, v147
v_add_f32 v3, v3, v145
v_cvt_pk_bf16_f32 v144, v144, v145
v_mfma_f32_32x32x16_bf16 a[80:95], a[212:215], v[104:107], a[80:95]
ds_read_b128 a[152:155], v10 offset:22528
v_exp_f32 v148, v148
v_add_f32 v2, v2, v146
v_mfma_f32_32x32x16_bf16 a[32:47], a[216:219], v[88:91], a[32:47]
v_exp_f32 v149, v149
v_add_f32 v3, v3, v147
v_cvt_pk_bf16_f32 v145, v146, v147
v_mfma_f32_32x32x16_bf16 a[96:111], a[216:219], v[104:107], a[96:111]
ds_read_b128 a[156:159], v10 offset:23552
buffer_load_dwordx4 v12, s[52:55], s71 offen offset:1024 sc1 lds
v_exp_f32 v150, v150
v_add_f32 v2, v2, v148
v_mfma_f32_32x32x16_bf16 a[48:63], a[220:223], v[88:91], a[48:63]
ds_read_b128 a[160:163], v10 offset:24576
v_exp_f32 v151, v151
v_add_f32 v3, v3, v149
v_cvt_pk_bf16_f32 v146, v148, v149
v_mfma_f32_32x32x16_bf16 a[112:127], a[220:223], v[104:107], a[112:127]
v_exp_f32 v152, v152
v_add_f32 v2, v2, v150
v_mfma_f32_32x32x16_bf16 a[0:15], a[224:227], v[112:115], a[0:15]
ds_read_b128 a[164:167], v10 offset:25600
v_exp_f32 v153, v153
v_add_f32 v3, v3, v151
v_cvt_pk_bf16_f32 v147, v150, v151
v_mfma_f32_32x32x16_bf16 a[64:79], a[224:227], v[128:131], a[64:79]
v_exp_f32 v154, v154
v_add_f32 v2, v2, v152
v_mfma_f32_32x32x16_bf16 a[16:31], a[228:231], v[112:115], a[16:31]
ds_read_b128 a[168:171], v10 offset:26624
buffer_load_dwordx4 v12, s[52:55], s71 offen offset:2048 sc1 lds
v_exp_f32 v155, v155
v_add_f32 v3, v3, v153
v_cvt_pk_bf16_f32 v152, v152, v153
v_mfma_f32_32x32x16_bf16 a[80:95], a[228:231], v[128:131], a[80:95]
ds_read_b128 a[172:175], v10 offset:27648
v_exp_f32 v156, v156
v_add_f32 v2, v2, v154
v_mfma_f32_32x32x16_bf16 a[32:47], a[232:235], v[112:115], a[32:47]
v_exp_f32 v157, v157
v_add_f32 v3, v3, v155
v_cvt_pk_bf16_f32 v153, v154, v155
v_mfma_f32_32x32x16_bf16 a[96:111], a[232:235], v[128:131], a[96:111]
ds_read_b128 a[176:179], v10 offset:28672
v_exp_f32 v158, v158
v_add_f32 v2, v2, v156
v_mfma_f32_32x32x16_bf16 a[48:63], a[236:239], v[112:115], a[48:63]
buffer_load_dwordx4 v12, s[52:55], s71 offen offset:3072 sc1 lds
v_exp_f32 v159, v159
v_add_f32 v3, v3, v157
v_cvt_pk_bf16_f32 v154, v156, v157
v_mfma_f32_32x32x16_bf16 a[112:127], a[236:239], v[128:131], a[112:127]
ds_read_b128 a[180:183], v10 offset:29696
v_exp_f32 v160, v160
v_add_f32 v2, v2, v158
v_mfma_f32_32x32x16_bf16 a[0:15], a[240:243], v[120:123], a[0:15]
ds_read_b128 a[184:187], v10 offset:30720
v_exp_f32 v161, v161
v_add_f32 v3, v3, v159
v_cvt_pk_bf16_f32 v155, v158, v159
v_mfma_f32_32x32x16_bf16 a[64:79], a[240:243], v[136:139], a[64:79]
v_exp_f32 v162, v162
v_add_f32 v4, v4, v160
v_mfma_f32_32x32x16_bf16 a[16:31], a[244:247], v[120:123], a[16:31]
ds_read_b128 a[188:191], v10 offset:31744
v_exp_f32 v163, v163
v_add_f32 v5, v5, v161
v_cvt_pk_bf16_f32 v160, v160, v161
v_mfma_f32_32x32x16_bf16 a[80:95], a[244:247], v[136:139], a[80:95]
s_sub_u32 s74, s74, 1
v_exp_f32 v164, v164
v_add_f32 v4, v4, v162
v_mfma_f32_32x32x16_bf16 a[32:47], a[248:251], v[120:123], a[32:47]
v_exp_f32 v165, v165
v_add_f32 v5, v5, v163
v_cvt_pk_bf16_f32 v161, v162, v163
v_mfma_f32_32x32x16_bf16 a[96:111], a[248:251], v[136:139], a[96:111]
v_exp_f32 v166, v166
v_add_f32 v4, v4, v164
v_mfma_f32_32x32x16_bf16 a[48:63], a[252:255], v[120:123], a[48:63]
v_exp_f32 v167, v167
v_add_f32 v5, v5, v165
v_cvt_pk_bf16_f32 v162, v164, v165
v_mfma_f32_32x32x16_bf16 a[112:127], a[252:255], v[136:139], a[112:127]
v_add_f32 v4, v4, v166
v_add_f32 v5, v5, v167
v_cvt_pk_bf16_f32 v163, v166, v167
L_p3_d0_end:
s_cbranch_scc1 L_p3_d1m_top
s_waitcnt lgkmcnt(0)
v_xor_b32 v11, 0x8000, v11
v_mfma_f32_32x32x16_bf16 v[80:95], a[128:131], v[16:19], v[208:223]
s_add_u32 m0, s73, 16384
ds_read_b128 a[192:195], v11 offset:0
v_exp_f32 v168, v168
v_exp_f32 v169, v169
v_mfma_f32_32x32x16_bf16 v[96:111], a[128:131], v[48:51], v[224:239]
ds_read_b128 a[196:199], v11 offset:1024
buffer_load_dwordx4 v12, s[56:59], s71 offen offset:0 sc1 lds
v_exp_f32 v170, v170
v_add_f32 v4, v4, v168
v_mfma_f32_32x32x16_bf16 v[80:95], a[132:135], v[20:23], v[80:95]
ds_read_b128 a[200:203], v11 offset:2048
v_exp_f32 v171, v171
v_add_f32 v5, v5, v169
v_cvt_pk_bf16_f32 v168, v168, v169
v_mfma_f32_32x32x16_bf16 v[96:111], a[132:135], v[52:55], v[96:111]
v_exp_f32 v172, v172
v_add_f32 v4, v4, v170
v_exp_f32 v173, v173
v_add_f32 v5, v5, v171
v_mfma_f32_32x32x16_bf16 v[80:95], a[136:139], v[24:27], v[80:95]
ds_read_b128 a[204:207], v11 offset:3072
v_cvt_pk_bf16_f32 v169, v170, v171
v_exp_f32 v174, v174
v_add_f32 v4, v4, v172
v_mfma_f32_32x32x16_bf16 v[96:111], a[136:139], v[56:59], v[96:111]
ds_read_b128 a[208:211], v11 offset:4096
v_exp_f32 v175, v175
v_add_f32 v5, v5, v173
v_cvt_pk_bf16_f32 v170, v172, v173
v_mfma_f32_32x32x16_bf16 v[80:95], a[140:143], v[28:31], v[80:95]
ds_read_b128 a[212:215], v11 offset:5120
buffer_load_dwordx4 v12, s[56:59], s71 offen offset:1024 sc1 lds
v_exp_f32 v176, v176
v_add_f32 v4, v4, v174
v_mfma_f32_32x32x16_bf16 v[96:111], a[140:143], v[60:63], v[96:111]
v_exp_f32 v177, v177
v_add_f32 v5, v5, v175
v_cvt_pk_bf16_f32 v171, v174, v175
v_exp_f32 v178, v178
v_mfma_f32_32x32x16_bf16 v[80:95], a[144:147], v[32:35], v[80:95]
ds_read_b128 a[216:219], v11 offset:6144
v_add_f32 v2, v2, v176
v_exp_f32 v179, v179
v_add_f32 v3, v3, v177
v_cvt_pk_bf16_f32 v176, v176, v177
v_mfma_f32_32x32x16_bf16 v[96:111], a[144:147], v[64:67], v[96:111]
ds_read_b128 a[220:223], v11 offset:7168
v_exp_f32 v180, v180
v_add_f32 v2, v2, v178
v_exp_f32 v181, v181
v_mfma_f32_32x32x16_bf16 v[80:95], a[148:151], v[36:39], v[80:95]
v_add_f32 v3, v3, v179
v_cvt_pk_bf16_f32 v177, v178, v179
v_exp_f32 v182, v182
v_add_f32 v2, v2, v180
v_mfma_f32_32x32x16_bf16 v[96:111], a[148:151], v[68:71], v[96:111]
ds_read_b128 a[224:227], v11 offset:8192
buffer_load_dwordx4 v12, s[56:59], s71 offen offset:2048 sc1 lds
v_exp_f32 v183, v183
v_add_f32 v3, v3, v181
v_cvt_pk_bf16_f32 v178, v180, v181
v_mfma_f32_32x32x16_bf16 v[80:95], a[152:155], v[40:43], v[80:95]
ds_read_b128 a[228:231], v11 offset:9216
v_exp_f32 v184, v184
v_add_f32 v2, v2, v182
v_exp_f32 v185, v185
v_mfma_f32_32x32x16_bf16 v[96:111], a[152:155], v[72:75], v[96:111]
ds_read_b128 a[232:235], v11 offset:10240
v_add_f32 v3, v3, v183
v_cvt_pk_bf16_f32 v179, v182, v183
v_exp_f32 v186, v186
v_mfma_f32_32x32x16_bf16 v[80:95], a[156:159], v[44:47], v[80:95]
v_add_f32 v2, v2, v184
v_exp_f32 v187, v187
v_add_f32 v3, v3, v185
v_mfma_f32_32x32x16_bf16 v[96:111], a[156:159], v[76:79], v[96:111]
ds_read_b128 a[236:239], v11 offset:11264
v_cvt_pk_bf16_f32 v184, v184, v185
v_exp_f32 v188, v188
v_add_f32 v2, v2, v186
v_mfma_f32_32x32x16_bf16 v[112:127], a[160:163], v[16:19], v[208:223]
ds_read_b128 a[240:243], v11 offset:12288
buffer_load_dwordx4 v12, s[56:59], s71 offen offset:3072 sc1 lds
v_exp_f32 v189, v189
v_add_f32 v3, v3, v187
v_cvt_pk_bf16_f32 v185, v186, v187
v_mfma_f32_32x32x16_bf16 v[128:143], a[160:163], v[48:51], v[224:239]
ds_read_b128 a[244:247], v11 offset:13312
v_exp_f32 v190, v190
v_add_f32 v2, v2, v188
v_exp_f32 v191, v191
v_mfma_f32_32x32x16_bf16 v[112:127], a[164:167], v[20:23], v[112:127]
v_add_f32 v3, v3, v189
v_cvt_pk_bf16_f32 v186, v188, v189
v_exp_f32 v192, v192
v_add_f32 v2, v2, v190
v_mfma_f32_32x32x16_bf16 v[128:143], a[164:167], v[52:55], v[128:143]
ds_read_b128 a[248:251], v11 offset:14336
v_exp_f32 v193, v193
v_add_f32 v3, v3, v191
v_cvt_pk_bf16_f32 v187, v190, v191
v_mfma_f32_32x32x16_bf16 v[112:127], a[168:171], v[24:27], v[112:127]
ds_read_b128 a[252:255], v11 offset:15360
v_exp_f32 v194, v194
v_add_f32 v4, v4, v192
v_exp_f32 v195, v195
v_mfma_f32_32x32x16_bf16 v[128:143], a[168:171], v[56:59], v[128:143]
s_add_u32 s71, s71, 16384
v_add_f32 v5, v5, v193
v_cvt_pk_bf16_f32 v192, v192, v193
v_exp_f32 v196, v196
v_mfma_f32_32x32x16_bf16 v[112:127], a[172:175], v[28:31], v[112:127]
v_add_f32 v4, v4, v194
v_exp_f32 v197, v197
v_add_f32 v5, v5, v195
v_mfma_f32_32x32x16_bf16 v[128:143], a[172:175], v[60:63], v[128:143]
v_cvt_pk_bf16_f32 v193, v194, v195
v_exp_f32 v198, v198
v_add_f32 v4, v4, v196
v_mfma_f32_32x32x16_bf16 v[112:127], a[176:179], v[32:35], v[112:127]
v_exp_f32 v199, v199
v_add_f32 v5, v5, v197
v_cvt_pk_bf16_f32 v194, v196, v197
v_exp_f32 v200, v200
v_mfma_f32_32x32x16_bf16 v[128:143], a[176:179], v[64:67], v[128:143]
v_add_f32 v4, v4, v198
v_exp_f32 v201, v201
v_mfma_f32_32x32x16_bf16 v[112:127], a[180:183], v[36:39], v[112:127]
s_xor_b32 s73, s73, 0x8000
v_add_f32 v5, v5, v199
v_cvt_pk_bf16_f32 v195, v198, v199
v_exp_f32 v202, v202
v_add_f32 v4, v4, v200
v_mfma_f32_32x32x16_bf16 v[128:143], a[180:183], v[68:71], v[128:143]
v_exp_f32 v203, v203
v_add_f32 v5, v5, v201
v_cvt_pk_bf16_f32 v200, v200, v201
v_mfma_f32_32x32x16_bf16 v[112:127], a[184:187], v[40:43], v[112:127]
v_exp_f32 v204, v204
v_add_f32 v4, v4, v202
v_exp_f32 v205, v205
v_mfma_f32_32x32x16_bf16 v[128:143], a[184:187], v[72:75], v[128:143]
v_add_f32 v5, v5, v203
v_cvt_pk_bf16_f32 v201, v202, v203
v_exp_f32 v206, v206
v_mfma_f32_32x32x16_bf16 v[112:127], a[188:191], v[44:47], v[112:127]
v_add_f32 v4, v4, v204
v_exp_f32 v207, v207
v_add_f32 v5, v5, v205
v_mfma_f32_32x32x16_bf16 v[128:143], a[188:191], v[76:79], v[128:143]
v_cvt_pk_bf16_f32 v202, v204, v205
v_add_f32 v4, v4, v206
v_add_f32 v5, v5, v207
v_cvt_pk_bf16_f32 v203, v206, v207
s_waitcnt vmcnt(16) lgkmcnt(0)
v_mfma_f32_32x32x16_bf16 a[0:15], a[192:195], v[144:147], a[0:15]
s_barrier
v_xor_b32 v10, 0x8000, v10
v_mfma_f32_32x32x16_bf16 a[64:79], a[192:195], v[160:163], a[64:79]
ds_read_b128 a[128:131], v10 offset:0
v_max3_f32 v6, v80, v81, v82
v_max3_f32 v7, v96, v97, v98
v_max3_f32 v6, v6, v83, v84
v_max3_f32 v7, v7, v99, v100
v_max3_f32 v6, v6, v85, v86
v_mfma_f32_32x32x16_bf16 a[16:31], a[196:199], v[144:147], a[16:31]
ds_read_b128 a[132:135], v10 offset:1024
v_max3_f32 v7, v7, v101, v102
v_max3_f32 v6, v6, v87, v88
v_max3_f32 v7, v7, v103, v104
v_max3_f32 v6, v6, v89, v90
v_max3_f32 v7, v7, v105, v106
v_mfma_f32_32x32x16_bf16 a[80:95], a[196:199], v[160:163], a[80:95]
v_max3_f32 v6, v6, v91, v92
v_max3_f32 v7, v7, v107, v108
v_max3_f32 v6, v6, v93, v94
v_max3_f32 v7, v7, v109, v110
v_max3_f32 v6, v6, v95, v112
v_mfma_f32_32x32x16_bf16 a[32:47], a[200:203], v[144:147], a[32:47]
ds_read_b128 a[136:139], v10 offset:2048
v_max3_f32 v7, v7, v111, v128
v_max3_f32 v6, v6, v113, v114
v_max3_f32 v7, v7, v129, v130
v_max3_f32 v6, v6, v115, v116
v_max3_f32 v7, v7, v131, v132
v_mfma_f32_32x32x16_bf16 a[96:111], a[200:203], v[160:163], a[96:111]
v_max3_f32 v6, v6, v117, v118
v_max3_f32 v7, v7, v133, v134
v_max3_f32 v6, v6, v119, v120
v_max3_f32 v7, v7, v135, v136
v_max3_f32 v6, v6, v121, v122
v_mfma_f32_32x32x16_bf16 a[48:63], a[204:207], v[144:147], a[48:63]
ds_read_b128 a[140:143], v10 offset:3072
v_max3_f32 v7, v7, v137, v138
v_max3_f32 v6, v6, v123, v124
v_max3_f32 v7, v7, v139, v140
v_max3_f32 v6, v6, v125, v126
v_max3_f32 v7, v7, v141, v142
v_mfma_f32_32x32x16_bf16 a[112:127], a[204:207], v[160:163], a[112:127]
v_max_f32 v6, v6, v127
v_max_f32 v7, v7, v143
v_max_f32 v240, v6, v7
v_cmp_lt_f32 vcc, s79, v240
v_mfma_f32_32x32x16_bf16 a[0:15], a[208:211], v[152:155], a[0:15]
s_cbranch_vccnz L_p3_d1_rare
s_add_u32 m0, s72, 16384
ds_read_b128 a[144:147], v10 offset:4096
v_exp_f32 v80, v80
v_exp_f32 v81, v81
v_mfma_f32_32x32x16_bf16 a[64:79], a[208:211], v[168:171], a[64:79]
ds_read_b128 a[148:151], v10 offset:5120
buffer_load_dwordx4 v12, s[52:55], s71 offen offset:0 sc1 lds
v_exp_f32 v82, v82
v_add_f32 v2, v2, v80
v_mfma_f32_32x32x16_bf16 a[16:31], a[212:215], v[152:155], a[16:31]
v_exp_f32 v83, v83
v_add_f32 v3, v3, v81
v_cvt_pk_bf16_f32 v80, v80, v81
v_mfma_f32_32x32x16_bf16 a[80:95], a[212:215], v[168:171], a[80:95]
ds_read_b128 a[152:155], v10 offset:6144
v_exp_f32 v84, v84
v_add_f32 v2, v2, v82
v_mfma_f32_32x32x16_bf16 a[32:47], a[216:219], v[152:155], a[32:47]
v_exp_f32 v85, v85
v_add_f32 v3, v3, v83
v_cvt_pk_bf16_f32 v81, v82, v83
v_mfma_f32_32x32x16_bf16 a[96:111], a[216:219], v[168:171], a[96:111]
ds_read_b128 a[156:159], v10 offset:7168
buffer_load_dwordx4 v12, s[52:55], s71 offen offset:1024 sc1 lds
v_exp_f32 v86, v86
v_add_f32 v2, v2, v84
v_mfma_f32_32x32x16_bf16 a[48:63], a[220:223], v[152:155], a[48:63]
ds_read_b128 a[160:163], v10 offset:8192
v_exp_f32 v87, v87
v_add_f32 v3, v3, v85
v_cvt_pk_bf16_f32 v82, v84, v85
v_mfma_f32_32x32x16_bf16 a[112:127], a[220:223], v[168:171], a[112:127]
v_exp_f32 v88, v88
v_add_f32 v2, v2, v86
v_mfma_f32_32x32x16_bf16 a[0:15], a[224:227], v[176:179], a[0:15]
ds_read_b128 a[164:167], v10 offset:9216
v_exp_f32 v89, v89
v_add_f32 v3, v3, v87
v_cvt_pk_bf16_f32 v83, v86, v87
v_mfma_f32_32x32x16_bf16 a[64:79], a[224:227], v[192:195], a[64:79]
v_exp_f32 v90, v90
v_add_f32 v2, v2, v88
v_mfma_f32_32x32x16_bf16 a[16:31], a[228:231], v[176:179], a[16:31]
ds_read_b128 a[168:171], v10 offset:10240
buffer_load_dwordx4 v12, s[52:55], s71 offen offset:2048 sc1 lds
v_exp_f32 v91, v91
v_add_f32 v3, v3, v89
v_cvt_pk_bf16_f32 v88, v88, v89
v_mfma_f32_32x32x16_bf16 a[80:95], a[228:231], v[192:195], a[80:95]
ds_read_b128 a[172:175], v10 offset:11264
v_exp_f32 v92, v92
v_add_f32 v2, v2, v90
v_mfma_f32_32x32x16_bf16 a[32:47], a[232:235], v[176:179], a[32:47]
v_exp_f32 v93, v93
v_add_f32 v3, v3, v91
v_cvt_pk_bf16_f32 v89, v90, v91
v_mfma_f32_32x32x16_bf16 a[96:111], a[232:235], v[192:195], a[96:111]
ds_read_b128 a[176:179], v10 offset:12288
v_exp_f32 v94, v94
v_add_f32 v2, v2, v92
v_mfma_f32_32x32x16_bf16 a[48:63], a[236:239], v[176:179], a[48:63]
buffer_load_dwordx4 v12, s[52:55], s71 offen offset:3072 sc1 lds
v_exp_f32 v95, v95
v_add_f32 v3, v3, v93
v_cvt_pk_bf16_f32 v90, v92, v93
v_mfma_f32_32x32x16_bf16 a[112:127], a[236:239], v[192:195], a[112:127]
ds_read_b128 a[180:183], v10 offset:13312
v_exp_f32 v96, v96
v_add_f32 v2, v2, v94
v_mfma_f32_32x32x16_bf16 a[0:15], a[240:243], v[184:187], a[0:15]
ds_read_b128 a[184:187], v10 offset:14336
v_exp_f32 v97, v97
v_add_f32 v3, v3, v95
v_cvt_pk_bf16_f32 v91, v94, v95
v_mfma_f32_32x32x16_bf16 a[64:79], a[240:243], v[200:203], a[64:79]
v_exp_f32 v98, v98
v_add_f32 v4, v4, v96
v_mfma_f32_32x32x16_bf16 a[16:31], a[244:247], v[184:187], a[16:31]
ds_read_b128 a[188:191], v10 offset:15360
v_exp_f32 v99, v99
v_add_f32 v5, v5, v97
v_cvt_pk_bf16_f32 v96, v96, v97
v_mfma_f32_32x32x16_bf16 a[80:95], a[244:247], v[200:203], a[80:95]
s_xor_b32 s72, s72, 0x8000
v_exp_f32 v100, v100
v_add_f32 v4, v4, v98
v_mfma_f32_32x32x16_bf16 a[32:47], a[248:251], v[184:187], a[32:47]
v_exp_f32 v101, v101
v_add_f32 v5, v5, v99
v_cvt_pk_bf16_f32 v97, v98, v99
v_mfma_f32_32x32x16_bf16 a[96:111], a[248:251], v[200:203], a[96:111]
v_exp_f32 v102, v102
v_add_f32 v4, v4, v100
v_mfma_f32_32x32x16_bf16 a[48:63], a[252:255], v[184:187], a[48:63]
v_exp_f32 v103, v103
v_add_f32 v5, v5, v101
v_cvt_pk_bf16_f32 v98, v100, v101
v_mfma_f32_32x32x16_bf16 a[112:127], a[252:255], v[200:203], a[112:127]
v_add_f32 v4, v4, v102
v_add_f32 v5, v5, v103
v_cvt_pk_bf16_f32 v99, v102, v103
L_p3_d1_end:
s_branch L_p3_d0_top
L_p3_d1m_top:
s_waitcnt lgkmcnt(0)
v_xor_b32 v11, 0x8000, v11
v_mfma_f32_32x32x16_bf16 v[80:95], a[128:131], v[16:19], v[208:223]
s_add_u32 m0, s73, 16384
ds_read_b128 a[192:195], v11 offset:0
v_exp_f32 v168, v168
v_exp_f32 v169, v169
v_mfma_f32_32x32x16_bf16 v[96:111], a[128:131], v[48:51], v[224:239]
ds_read_b128 a[196:199], v11 offset:1024
buffer_load_dwordx4 v12, s[56:59], s71 offen offset:0 sc1 lds
v_exp_f32 v170, v170
v_add_f32 v4, v4, v168
v_mfma_f32_32x32x16_bf16 v[80:95], a[132:135], v[20:23], v[80:95]
ds_read_b128 a[200:203], v11 offset:2048
v_exp_f32 v171, v171
v_add_f32 v5, v5, v169
v_cvt_pk_bf16_f32 v168, v168, v169
v_mfma_f32_32x32x16_bf16 v[96:111], a[132:135], v[52:55], v[96:111]
v_exp_f32 v172, v172
v_add_f32 v4, v4, v170
v_exp_f32 v173, v173
v_add_f32 v5, v5, v171
v_mfma_f32_32x32x16_bf16 v[80:95], a[136:139], v[24:27], v[80:95]
ds_read_b128 a[204:207], v11 offset:3072
v_cvt_pk_bf16_f32 v169, v170, v171
v_exp_f32 v174, v174
v_add_f32 v4, v4, v172
v_mfma_f32_32x32x16_bf16 v[96:111], a[136:139], v[56:59], v[96:111]
ds_read_b128 a[208:211], v11 offset:4096
v_exp_f32 v175, v175
v_add_f32 v5, v5, v173
v_cvt_pk_bf16_f32 v170, v172, v173
v_mfma_f32_32x32x16_bf16 v[80:95], a[140:143], v[28:31], v[80:95]
ds_read_b128 a[212:215], v11 offset:5120
buffer_load_dwordx4 v12, s[56:59], s71 offen offset:1024 sc1 lds
v_exp_f32 v176, v176
v_add_f32 v4, v4, v174
v_mfma_f32_32x32x16_bf16 v[96:111], a[140:143], v[60:63], v[96:111]
v_exp_f32 v177, v177
v_add_f32 v5, v5, v175
v_cvt_pk_bf16_f32 v171, v174, v175
v_exp_f32 v178, v178
v_mfma_f32_32x32x16_bf16 v[80:95], a[144:147], v[32:35], v[80:95]
ds_read_b128 a[216:219], v11 offset:6144
v_add_f32 v2, v2, v176
v_exp_f32 v179, v179
v_add_f32 v3, v3, v177
v_cvt_pk_bf16_f32 v176, v176, v177
v_mfma_f32_32x32x16_bf16 v[96:111], a[144:147], v[64:67], v[96:111]
ds_read_b128 a[220:223], v11 offset:7168
v_exp_f32 v180, v180
v_add_f32 v2, v2, v178
v_exp_f32 v181, v181
v_mfma_f32_32x32x16_bf16 v[80:95], a[148:151], v[36:39], v[80:95]
v_add_f32 v3, v3, v179
v_cvt_pk_bf16_f32 v177, v178, v179
v_exp_f32 v182, v182
v_add_f32 v2, v2, v180
v_mfma_f32_32x32x16_bf16 v[96:111], a[148:151], v[68:71], v[96:111]
ds_read_b128 a[224:227], v11 offset:8192
buffer_load_dwordx4 v12, s[56:59], s71 offen offset:2048 sc1 lds
v_exp_f32 v183, v183
v_add_f32 v3, v3, v181
v_cvt_pk_bf16_f32 v178, v180, v181
v_mfma_f32_32x32x16_bf16 v[80:95], a[152:155], v[40:43], v[80:95]
ds_read_b128 a[228:231], v11 offset:9216
v_exp_f32 v184, v184
v_add_f32 v2, v2, v182
v_exp_f32 v185, v185
v_mfma_f32_32x32x16_bf16 v[96:111], a[152:155], v[72:75], v[96:111]
ds_read_b128 a[232:235], v11 offset:10240
v_add_f32 v3, v3, v183
v_cvt_pk_bf16_f32 v179, v182, v183
v_exp_f32 v186, v186
v_mfma_f32_32x32x16_bf16 v[80:95], a[156:159], v[44:47], v[80:95]
v_add_f32 v2, v2, v184
v_exp_f32 v187, v187
v_add_f32 v3, v3, v185
v_mfma_f32_32x32x16_bf16 v[96:111], a[156:159], v[76:79], v[96:111]
ds_read_b128 a[236:239], v11 offset:11264
v_cvt_pk_bf16_f32 v184, v184, v185
v_exp_f32 v188, v188
v_add_f32 v2, v2, v186
v_mfma_f32_32x32x16_bf16 v[112:127], a[160:163], v[16:19], v[208:223]
ds_read_b128 a[240:243], v11 offset:12288
buffer_load_dwordx4 v12, s[56:59], s71 offen offset:3072 sc1 lds
v_exp_f32 v189, v189
v_add_f32 v3, v3, v187
v_cvt_pk_bf16_f32 v185, v186, v187
v_mfma_f32_32x32x16_bf16 v[128:143], a[160:163], v[48:51], v[224:239]
ds_read_b128 a[244:247], v11 offset:13312
v_exp_f32 v190, v190
v_add_f32 v2, v2, v188
v_exp_f32 v191, v191
v_mfma_f32_32x32x16_bf16 v[112:127], a[164:167], v[20:23], v[112:127]
v_add_f32 v3, v3, v189
v_cvt_pk_bf16_f32 v186, v188, v189
v_exp_f32 v192, v192
v_add_f32 v2, v2, v190
v_mfma_f32_32x32x16_bf16 v[128:143], a[164:167], v[52:55], v[128:143]
ds_read_b128 a[248:251], v11 offset:14336
v_exp_f32 v193, v193
v_add_f32 v3, v3, v191
v_cvt_pk_bf16_f32 v187, v190, v191
v_add_u32 v246, 0, v13
v_mfma_f32_32x32x16_bf16 v[112:127], a[168:171], v[24:27], v[112:127]
ds_read_b128 a[252:255], v11 offset:15360
v_cmp_gt_i32_e64 s[84:85], 0, v246
v_cmp_gt_i32_e64 s[86:87], 1, v246
v_exp_f32 v194, v194
v_add_f32 v4, v4, v192
v_mfma_f32_32x32x16_bf16 v[128:143], a[168:171], v[56:59], v[128:143]
s_add_u32 s71, s71, 16384
v_exp_f32 v195, v195
v_cmp_gt_i32_e64 s[88:89], 2, v246
v_cmp_gt_i32_e64 s[90:91], 3, v246
v_cndmask_b32_e64 v96, v96, v14, s[84:85]
v_mfma_f32_32x32x16_bf16 v[112:127], a[172:175], v[28:31], v[112:127]
v_add_f32 v5, v5, v193
v_cvt_pk_bf16_f32 v192, v192, v193
v_exp_f32 v196, v196
v_cndmask_b32_e64 v97, v97, v14, s[86:87]
v_cndmask_b32_e64 v98, v98, v14, s[88:89]
v_mfma_f32_32x32x16_bf16 v[128:143], a[172:175], v[60:63], v[128:143]
v_add_f32 v4, v4, v194
v_exp_f32 v197, v197
v_add_f32 v5, v5, v195
v_cndmask_b32_e64 v99, v99, v14, s[90:91]
v_cmp_gt_i32_e64 s[92:93], 16, v246
v_mfma_f32_32x32x16_bf16 v[112:127], a[176:179], v[32:35], v[112:127]
v_cmp_gt_i32_e64 s[94:95], 17, v246
v_cvt_pk_bf16_f32 v193, v194, v195
v_exp_f32 v198, v198
v_add_f32 v4, v4, v196
v_cmp_gt_i32_e64 s[96:97], 18, v246
v_mfma_f32_32x32x16_bf16 v[128:143], a[176:179], v[64:67], v[128:143]
v_cmp_gt_i32_e64 s[98:99], 19, v246
v_exp_f32 v199, v199
v_add_f32 v5, v5, v197
v_cvt_pk_bf16_f32 v194, v196, v197
v_cndmask_b32_e64 v100, v100, v14, s[92:93]
v_mfma_f32_32x32x16_bf16 v[112:127], a[180:183], v[36:39], v[112:127]
s_xor_b32 s73, s73, 0x8000
v_exp_f32 v200, v200
v_cndmask_b32_e64 v101, v101, v14, s[94:95]
v_cndmask_b32_e64 v102, v102, v14, s[96:97]
v_add_f32 v4, v4, v198
v_mfma_f32_32x32x16_bf16 v[128:143], a[180:183], v[68:71], v[128:143]
v_exp_f32 v201, v201
v_cndmask_b32_e64 v103, v103, v14, s[98:99]
v_cmp_gt_i32_e64 s[84:85], 8, v246
v_add_f32 v5, v5, v199
v_cvt_pk_bf16_f32 v195, v198, v199
v_mfma_f32_32x32x16_bf16 v[112:127], a[184:187], v[40:43], v[112:127]
v_exp_f32 v202, v202
v_add_f32 v4, v4, v200
v_cmp_gt_i32_e64 s[86:87], 9, v246
v_cmp_gt_i32_e64 s[88:89], 10, v246
v_cmp_gt_i32_e64 s[90:91], 11, v246
v_mfma_f32_32x32x16_bf16 v[128:143], a[184:187], v[72:75], v[128:143]
v_exp_f32 v203, v203
v_add_f32 v5, v5, v201
v_cvt_pk_bf16_f32 v200, v200, v201
v_cndmask_b32_e64 v104, v104, v14, s[84:85]
v_cndmask_b32_e64 v105, v105, v14, s[86:87]
v_mfma_f32_32x32x16_bf16 v[112:127], a[188:191], v[44:47], v[112:127]
v_exp_f32 v204, v204
v_add_f32 v4, v4, v202
v_exp_f32 v205, v205
v_cndmask_b32_e64 v106, v106, v14, s[88:89]
v_mfma_f32_32x32x16_bf16 v[128:143], a[188:191], v[76:79], v[128:143]
v_cndmask_b32_e64 v107, v107, v14, s[90:91]
v_cmp_gt_i32_e64 s[92:93], 24, v246
v_add_f32 v5, v5, v203
v_cvt_pk_bf16_f32 v201, v202, v203
v_exp_f32 v206, v206
v_cmp_gt_i32_e64 s[94:95], 25, v246
v_cmp_gt_i32_e64 s[96:97], 26, v246
v_add_f32 v4, v4, v204
v_exp_f32 v207, v207
v_add_f32 v5, v5, v205
v_cmp_gt_i32_e64 s[98:99], 27, v246
v_cndmask_b32_e64 v108, v108, v14, s[92:93]
v_cndmask_b32_e64 v109, v109, v14, s[94:95]
v_cvt_pk_bf16_f32 v202, v204, v205
v_add_f32 v4, v4, v206
v_add_f32 v5, v5, v207
v_cvt_pk_bf16_f32 v203, v206, v207
v_cndmask_b32_e64 v110, v110, v14, s[96:97]
v_cndmask_b32_e64 v111, v111, v14, s[98:99]
s_waitcnt vmcnt(16) lgkmcnt(0)
v_mfma_f32_32x32x16_bf16 a[0:15], a[192:195], v[144:147], a[0:15]
s_barrier
v_xor_b32 v10, 0x8000, v10
v_mfma_f32_32x32x16_bf16 a[64:79], a[192:195], v[160:163], a[64:79]
ds_read_b128 a[128:131], v10 offset:0
v_max3_f32 v6, v80, v81, v82
v_max3_f32 v7, v96, v97, v98
v_max3_f32 v6, v6, v83, v84
v_max3_f32 v7, v7, v99, v100
v_max3_f32 v6, v6, v85, v86
v_mfma_f32_32x32x16_bf16 a[16:31], a[196:199], v[144:147], a[16:31]
ds_read_b128 a[132:135], v10 offset:1024
v_max3_f32 v7, v7, v101, v102
v_max3_f32 v6, v6, v87, v88
v_max3_f32 v7, v7, v103, v104
v_max3_f32 v6, v6, v89, v90
v_max3_f32 v7, v7, v105, v106
v_mfma_f32_32x32x16_bf16 a[80:95], a[196:199], v[160:163], a[80:95]
v_max3_f32 v6, v6, v91, v92
v_max3_f32 v7, v7, v107, v108
v_max3_f32 v6, v6, v93, v94
v_max3_f32 v7, v7, v109, v110
v_add_u32 v247, -32, v13
v_mfma_f32_32x32x16_bf16 a[32:47], a[200:203], v[144:147], a[32:47]
ds_read_b128 a[136:139], v10 offset:2048
v_cmp_gt_i32_e64 s[84:85], 0, v247
v_cmp_gt_i32_e64 s[86:87], 1, v247
v_cmp_gt_i32_e64 s[88:89], 2, v247
v_cmp_gt_i32_e64 s[90:91], 3, v247
v_cndmask_b32_e64 v128, v128, v14, s[84:85]
v_mfma_f32_32x32x16_bf16 a[96:111], a[200:203], v[160:163], a[96:111]
v_cndmask_b32_e64 v129, v129, v14, s[86:87]
v_cndmask_b32_e64 v130, v130, v14, s[88:89]
v_cndmask_b32_e64 v131, v131, v14, s[90:91]
v_cmp_gt_i32_e64 s[92:93], 16, v247
v_mfma_f32_32x32x16_bf16 a[48:63], a[204:207], v[144:147], a[48:63]
ds_read_b128 a[140:143], v10 offset:3072
v_cmp_gt_i32_e64 s[94:95], 17, v247
v_cmp_gt_i32_e64 s[96:97], 18, v247
v_cmp_gt_i32_e64 s[98:99], 19, v247
v_cndmask_b32_e64 v132, v132, v14, s[92:93]
v_cndmask_b32_e64 v133, v133, v14, s[94:95]
v_mfma_f32_32x32x16_bf16 a[112:127], a[204:207], v[160:163], a[112:127]
v_cndmask_b32_e64 v134, v134, v14, s[96:97]
v_cndmask_b32_e64 v135, v135, v14, s[98:99]
v_cmp_gt_i32_e64 s[84:85], 8, v247
v_cmp_gt_i32_e64 s[86:87], 9, v247
v_cmp_gt_i32_e64 s[88:89], 10, v247
v_mfma_f32_32x32x16_bf16 a[0:15], a[208:211], v[152:155], a[0:15]
ds_read_b128 a[144:147], v10 offset:4096
v_cmp_gt_i32_e64 s[90:91], 11, v247
v_cndmask_b32_e64 v136, v136, v14, s[84:85]
v_cndmask_b32_e64 v137, v137, v14, s[86:87]
v_cndmask_b32_e64 v138, v138, v14, s[88:89]
v_cndmask_b32_e64 v139, v139, v14, s[90:91]
v_mfma_f32_32x32x16_bf16 a[64:79], a[208:211], v[168:171], a[64:79]
ds_read_b128 a[148:151], v10 offset:5120
v_cmp_gt_i32_e64 s[92:93], 24, v247
v_cmp_gt_i32_e64 s[94:95], 25, v247
v_cmp_gt_i32_e64 s[96:97], 26, v247
v_cmp_gt_i32_e64 s[98:99], 27, v247
v_cndmask_b32_e64 v140, v140, v14, s[92:93]
v_mfma_f32_32x32x16_bf16 a[16:31], a[212:215], v[152:155], a[16:31]
v_cndmask_b32_e64 v141, v141, v14, s[94:95]
v_cndmask_b32_e64 v142, v142, v14, s[96:97]
v_cndmask_b32_e64 v143, v143, v14, s[98:99]
v_max3_f32 v6, v6, v95, v112
v_mfma_f32_32x32x16_bf16 a[80:95], a[212:215], v[168:171], a[80:95]
ds_read_b128 a[152:155], v10 offset:6144
v_max3_f32 v7, v7, v111, v128
v_max3_f32 v6, v6, v113, v114
v_max3_f32 v7, v7, v129, v130
v_max3_f32 v6, v6, v115, v116
v_max3_f32 v7, v7, v131, v132
v_mfma_f32_32x32x16_bf16 a[32:47], a[216:219], v[152:155], a[32:47]
v_max3_f32 v6, v6, v117, v118
v_max3_f32 v7, v7, v133, v134
v_max3_f32 v6, v6, v119, v120
v_max3_f32 v7, v7, v135, v136
v_max3_f32 v6, v6, v121, v122
v_mfma_f32_32x32x16_bf16 a[96:111], a[216:219], v[168:171], a[96:111]
ds_read_b128 a[156:159], v10 offset:7168
v_max3_f32 v7, v7, v137, v138
v_max3_f32 v6, v6, v123, v124
v_max3_f32 v7, v7, v139, v140
v_max3_f32 v6, v6, v125, v126
v_max3_f32 v7, v7, v141, v142
v_mfma_f32_32x32x16_bf16 a[48:63], a[220:223], v[152:155], a[48:63]
v_max_f32 v6, v6, v127
v_max_f32 v7, v7, v143
v_max_f32 v240, v6, v7
v_cmp_lt_f32 vcc, s79, v240
v_mfma_f32_32x32x16_bf16 a[112:127], a[220:223], v[168:171], a[112:127]
s_cbranch_vccnz L_p3_d1m_rare
s_add_u32 m0, s72, 16384
ds_read_b128 a[160:163], v10 offset:8192
v_exp_f32 v80, v80
v_exp_f32 v81, v81
v_mfma_f32_32x32x16_bf16 a[0:15], a[224:227], v[176:179], a[0:15]
ds_read_b128 a[164:167], v10 offset:9216
buffer_load_dwordx4 v12, s[52:55], s71 offen offset:0 sc1 lds
v_exp_f32 v82, v82
v_add_f32 v2, v2, v80
v_mfma_f32_32x32x16_bf16 a[64:79], a[224:227], v[192:195], a[64:79]
v_exp_f32 v83, v83
v_add_f32 v3, v3, v81
v_cvt_pk_bf16_f32 v80, v80, v81
v_exp_f32 v84, v84
v_mfma_f32_32x32x16_bf16 a[16:31], a[228:231], v[176:179], a[16:31]
ds_read_b128 a[168:171], v10 offset:10240
v_add_f32 v2, v2, v82
v_exp_f32 v85, v85
v_add_f32 v3, v3, v83
v_cvt_pk_bf16_f32 v81, v82, v83
v_mfma_f32_32x32x16_bf16 a[80:95], a[228:231], v[192:195], a[80:95]
ds_read_b128 a[172:175], v10 offset:11264
buffer_load_dwordx4 v12, s[52:55], s71 offen offset:1024 sc1 lds
v_exp_f32 v86, v86
v_add_f32 v2, v2, v84
v_mfma_f32_32x32x16_bf16 a[32:47], a[232:235], v[176:179], a[32:47]
v_exp_f32 v87, v87
v_add_f32 v3, v3, v85
v_cvt_pk_bf16_f32 v82, v84, v85
v_exp_f32 v88, v88
v_mfma_f32_32x32x16_bf16 a[96:111], a[232:235], v[192:195], a[96:111]
ds_read_b128 a[176:179], v10 offset:12288
v_add_f32 v2, v2, v86
v_exp_f32 v89, v89
v_add_f32 v3, v3, v87
v_cvt_pk_bf16_f32 v83, v86, v87
v_mfma_f32_32x32x16_bf16 a[48:63], a[236:239], v[176:179], a[48:63]
buffer_load_dwordx4 v12, s[52:55], s71 offen offset:2048 sc1 lds
v_exp_f32 v90, v90
v_add_f32 v2, v2, v88
v_exp_f32 v91, v91
v_mfma_f32_32x32x16_bf16 a[112:127], a[236:239], v[192:195], a[112:127]
ds_read_b128 a[180:183], v10 offset:13312
v_add_f32 v3, v3, v89
v_cvt_pk_bf16_f32 v88, v88, v89
v_exp_f32 v92, v92
v_add_f32 v2, v2, v90
v_mfma_f32_32x32x16_bf16 a[0:15], a[240:243], v[184:187], a[0:15]
ds_read_b128 a[184:187], v10 offset:14336
v_exp_f32 v93, v93
v_add_f32 v3, v3, v91
v_cvt_pk_bf16_f32 v89, v90, v91
v_mfma_f32_32x32x16_bf16 a[64:79], a[240:243], v[200:203], a[64:79]
buffer_load_dwordx4 v12, s[52:55], s71 offen offset:3072 sc1 lds
v_exp_f32 v94, v94
v_add_f32 v2, v2, v92
v_exp_f32 v95, v95
v_mfma_f32_32x32x16_bf16 a[16:31], a[244:247], v[184:187], a[16:31]
ds_read_b128 a[188:191], v10 offset:15360
v_add_f32 v3, v3, v93
v_cvt_pk_bf16_f32 v90, v92, v93
v_exp_f32 v96, v96
v_add_f32 v2, v2, v94
v_mfma_f32_32x32x16_bf16 a[80:95], a[244:247], v[200:203], a[80:95]
v_exp_f32 v97, v97
v_add_f32 v3, v3, v95
v_cvt_pk_bf16_f32 v91, v94, v95
v_exp_f32 v98, v98
v_mfma_f32_32x32x16_bf16 a[32:47], a[248:251], v[184:187], a[32:47]
s_xor_b32 s72, s72, 0x8000
v_add_f32 v4, v4, v96
v_exp_f32 v99, v99
v_add_f32 v5, v5, v97
v_cvt_pk_bf16_f32 v96, v96, v97
v_mfma_f32_32x32x16_bf16 a[96:111], a[248:251], v[200:203], a[96:111]
v_exp_f32 v100, v100
v_add_f32 v4, v4, v98
v_exp_f32 v101, v101
v_add_f32 v5, v5, v99
v_mfma_f32_32x32x16_bf16 a[48:63], a[252:255], v[184:187], a[48:63]
v_cvt_pk_bf16_f32 v97, v98, v99
v_exp_f32 v102, v102
v_add_f32 v4, v4, v100
v_exp_f32 v103, v103
v_mfma_f32_32x32x16_bf16 a[112:127], a[252:255], v[200:203], a[112:127]
v_add_f32 v5, v5, v101
v_cvt_pk_bf16_f32 v98, v100, v101
v_add_f32 v4, v4, v102
v_add_f32 v5, v5, v103
v_cvt_pk_bf16_f32 v99, v102, v103
L_p3_d1m_end:
L_p3_d0m_top:
s_waitcnt lgkmcnt(0)
v_mfma_f32_32x32x16_bf16 v[144:159], a[128:131], v[16:19], v[208:223]
s_add_u32 m0, s73, 0
ds_read_b128 a[192:195], v11 offset:16384
v_exp_f32 v104, v104
v_exp_f32 v105, v105
v_mfma_f32_32x32x16_bf16 v[160:175], a[128:131], v[48:51], v[224:239]
ds_read_b128 a[196:199], v11 offset:17408
buffer_load_dwordx4 v12, s[56:59], s71 offen offset:0 sc1 lds
v_exp_f32 v106, v106
v_add_f32 v4, v4, v104
v_mfma_f32_32x32x16_bf16 v[144:159], a[132:135], v[20:23], v[144:159]
ds_read_b128 a[200:203], v11 offset:18432
v_exp_f32 v107, v107
v_add_f32 v5, v5, v105
v_cvt_pk_bf16_f32 v104, v104, v105
v_mfma_f32_32x32x16_bf16 v[160:175], a[132:135], v[52:55], v[160:175]
v_exp_f32 v108, v108
v_add_f32 v4, v4, v106
v_exp_f32 v109, v109
v_add_f32 v5, v5, v107
v_mfma_f32_32x32x16_bf16 v[144:159], a[136:139], v[24:27], v[144:159]
ds_read_b128 a[204:207], v11 offset:19456
v_cvt_pk_bf16_f32 v105, v106, v107
v_exp_f32 v110, v110
v_add_f32 v4, v4, v108
v_mfma_f32_32x32x16_bf16 v[160:175], a[136:139], v[56:59], v[160:175]
ds_read_b128 a[208:211], v11 offset:20480
v_exp_f32 v111, v111
v_add_f32 v5, v5, v109
v_cvt_pk_bf16_f32 v106, v108, v109
v_mfma_f32_32x32x16_bf16 v[144:159], a[140:143], v[28:31], v[144:159]
ds_read_b128 a[212:215], v11 offset:21504
v_exp_f32 v112, v112
v_add_f32 v4, v4, v110
v_exp_f32 v113, v113
v_mfma_f32_32x32x16_bf16 v[160:175], a[140:143], v[60:63], v[160:175]
buffer_load_dwordx4 v12, s[56:59], s71 offen offset:1024 sc1 lds
v_add_f32 v5, v5, v111
v_cvt_pk_bf16_f32 v107, v110, v111
v_exp_f32 v114, v114
v_add_f32 v2, v2, v112
v_mfma_f32_32x32x16_bf16 v[144:159], a[144:147], v[32:35], v[144:159]
ds_read_b128 a[216:219], v11 offset:22528
v_exp_f32 v115, v115
v_add_f32 v3, v3, v113
v_cvt_pk_bf16_f32 v112, v112, v113
v_mfma_f32_32x32x16_bf16 v[160:175], a[144:147], v[64:67], v[160:175]
ds_read_b128 a[220:223], v11 offset:23552
v_exp_f32 v116, v116
v_add_f32 v2, v2, v114
v_exp_f32 v117, v117
v_mfma_f32_32x32x16_bf16 v[144:159], a[148:151], v[36:39], v[144:159]
v_add_f32 v3, v3, v115
v_cvt_pk_bf16_f32 v113, v114, v115
v_exp_f32 v118, v118
v_add_f32 v2, v2, v116
v_mfma_f32_32x32x16_bf16 v[160:175], a[148:151], v[68:71], v[160:175]
ds_read_b128 a[224:227], v11 offset:24576
v_exp_f32 v119, v119
v_add_f32 v3, v3, v117
v_cvt_pk_bf16_f32 v114, v116, v117
v_mfma_f32_32x32x16_bf16 v[144:159], a[152:155], v[40:43], v[144:159]
ds_read_b128 a[228:231], v11 offset:25600
v_exp_f32 v120, v120
v_add_f32 v2, v2, v118
v_exp_f32 v121, v121
v_mfma_f32_32x32x16_bf16 v[160:175], a[152:155], v[72:75], v[160:175]
ds_read_b128 a[232:235], v11 offset:26624
buffer_load_dwordx4 v12, s[56:59], s71 offen offset:2048 sc1 lds
v_add_f32 v3, v3, v119
v_cvt_pk_bf16_f32 v115, v118, v119
v_exp_f32 v122, v122
v_mfma_f32_32x32x16_bf16 v[144:159], a[156:159], v[44:47], v[144:159]
v_add_f32 v2, v2, v120
v_exp_f32 v123, v123
v_add_f32 v3, v3, v121
v_mfma_f32_32x32x16_bf16 v[160:175], a[156:159], v[76:79], v[160:175]
ds_read_b128 a[236:239], v11 offset:27648
v_cvt_pk_bf16_f32 v120, v120, v121
v_exp_f32 v124, v124
v_add_f32 v2, v2, v122
v_mfma_f32_32x32x16_bf16 v[176:191], a[160:163], v[16:19], v[208:223]
ds_read_b128 a[240:243], v11 offset:28672
v_exp_f32 v125, v125
v_add_f32 v3, v3, v123
v_cvt_pk_bf16_f32 v121, v122, v123
v_mfma_f32_32x32x16_bf16 v[192:207], a[160:163], v[48:51], v[224:239]
ds_read_b128 a[244:247], v11 offset:29696
v_exp_f32 v126, v126
v_add_f32 v2, v2, v124
v_exp_f32 v127, v127
v_mfma_f32_32x32x16_bf16 v[176:191], a[164:167], v[20:23], v[176:191]
v_add_f32 v3, v3, v125
v_cvt_pk_bf16_f32 v122, v124, v125
v_exp_f32 v128, v128
v_add_f32 v2, v2, v126
v_mfma_f32_32x32x16_bf16 v[192:207], a[164:167], v[52:55], v[192:207]
ds_read_b128 a[248:251], v11 offset:30720
buffer_load_dwordx4 v12, s[56:59], s71 offen offset:3072 sc1 lds
v_exp_f32 v129, v129
v_add_f32 v3, v3, v127
v_cvt_pk_bf16_f32 v123, v126, v127
v_mfma_f32_32x32x16_bf16 v[176:191], a[168:171], v[24:27], v[176:191]
ds_read_b128 a[252:255], v11 offset:31744
v_add_u32 v246, -64, v13
v_cmp_gt_i32_e64 s[84:85], 0, v246
v_cmp_gt_i32_e64 s[86:87], 1, v246
v_exp_f32 v130, v130
v_mfma_f32_32x32x16_bf16 v[192:207], a[168:171], v[56:59], v[192:207]
v_add_f32 v4, v4, v128
v_exp_f32 v131, v131
v_cmp_gt_i32_e64 s[88:89], 2, v246
v_cmp_gt_i32_e64 s[90:91], 3, v246
v_cndmask_b32_e64 v160, v160, v14, s[84:85]
v_mfma_f32_32x32x16_bf16 v[176:191], a[172:175], v[28:31], v[176:191]
v_add_f32 v5, v5, v129
v_cvt_pk_bf16_f32 v128, v128, v129
v_exp_f32 v132, v132
v_cndmask_b32_e64 v161, v161, v14, s[86:87]
v_cndmask_b32_e64 v162, v162, v14, s[88:89]
v_mfma_f32_32x32x16_bf16 v[192:207], a[172:175], v[60:63], v[192:207]
v_add_f32 v4, v4, v130
v_exp_f32 v133, v133
v_add_f32 v5, v5, v131
v_cndmask_b32_e64 v163, v163, v14, s[90:91]
v_cmp_gt_i32_e64 s[92:93], 16, v246
v_mfma_f32_32x32x16_bf16 v[176:191], a[176:179], v[32:35], v[176:191]
v_cmp_gt_i32_e64 s[94:95], 17, v246
v_cvt_pk_bf16_f32 v129, v130, v131
v_exp_f32 v134, v134
v_add_f32 v4, v4, v132
v_cmp_gt_i32_e64 s[96:97], 18, v246
v_mfma_f32_32x32x16_bf16 v[192:207], a[176:179], v[64:67], v[192:207]
s_add_u32 s71, s71, 16384
v_cmp_gt_i32_e64 s[98:99], 19, v246
v_exp_f32 v135, v135
v_add_f32 v5, v5, v133
v_cvt_pk_bf16_f32 v130, v132, v133
v_mfma_f32_32x32x16_bf16 v[176:191], a[180:183], v[36:39], v[176:191]
v_exp_f32 v136, v136
v_cndmask_b32_e64 v164, v164, v14, s[92:93]
v_cndmask_b32_e64 v165, v165, v14, s[94:95]
v_cndmask_b32_e64 v166, v166, v14, s[96:97]
v_add_f32 v4, v4, v134
v_mfma_f32_32x32x16_bf16 v[192:207], a[180:183], v[68:71], v[192:207]
v_exp_f32 v137, v137
v_cndmask_b32_e64 v167, v167, v14, s[98:99]
v_cmp_gt_i32_e64 s[84:85], 8, v246
v_add_f32 v5, v5, v135
v_cvt_pk_bf16_f32 v131, v134, v135
v_mfma_f32_32x32x16_bf16 v[176:191], a[184:187], v[40:43], v[176:191]
v_exp_f32 v138, v138
v_add_f32 v4, v4, v136
v_cmp_gt_i32_e64 s[86:87], 9, v246
v_cmp_gt_i32_e64 s[88:89], 10, v246
v_cmp_gt_i32_e64 s[90:91], 11, v246
v_mfma_f32_32x32x16_bf16 v[192:207], a[184:187], v[72:75], v[192:207]
v_exp_f32 v139, v139
v_add_f32 v5, v5, v137
v_cvt_pk_bf16_f32 v136, v136, v137
v_cndmask_b32_e64 v168, v168, v14, s[84:85]
v_cndmask_b32_e64 v169, v169, v14, s[86:87]
v_mfma_f32_32x32x16_bf16 v[176:191], a[188:191], v[44:47], v[176:191]
v_exp_f32 v140, v140
v_add_f32 v4, v4, v138
v_exp_f32 v141, v141
v_cndmask_b32_e64 v170, v170, v14, s[88:89]
v_mfma_f32_32x32x16_bf16 v[192:207], a[188:191], v[76:79], v[192:207]
v_cndmask_b32_e64 v171, v171, v14, s[90:91]
v_cmp_gt_i32_e64 s[92:93], 24, v246
v_add_f32 v5, v5, v139
v_cvt_pk_bf16_f32 v137, v138, v139
v_exp_f32 v142, v142
v_cmp_gt_i32_e64 s[94:95], 25, v246
v_cmp_gt_i32_e64 s[96:97], 26, v246
v_add_f32 v4, v4, v140
v_exp_f32 v143, v143
v_add_f32 v5, v5, v141
v_cmp_gt_i32_e64 s[98:99], 27, v246
v_cndmask_b32_e64 v172, v172, v14, s[92:93]
v_cndmask_b32_e64 v173, v173, v14, s[94:95]
v_cvt_pk_bf16_f32 v138, v140, v141
v_add_f32 v4, v4, v142
v_add_f32 v5, v5, v143
v_cvt_pk_bf16_f32 v139, v142, v143
v_cndmask_b32_e64 v174, v174, v14, s[96:97]
v_cndmask_b32_e64 v175, v175, v14, s[98:99]
s_waitcnt vmcnt(16) lgkmcnt(0)
v_mfma_f32_32x32x16_bf16 a[0:15], a[192:195], v[80:83], a[0:15]
s_barrier
v_mfma_f32_32x32x16_bf16 a[64:79], a[192:195], v[96:99], a[64:79]
ds_read_b128 a[128:131], v10 offset:16384
v_max3_f32 v6, v144, v145, v146
v_max3_f32 v7, v160, v161, v162
v_max3_f32 v6, v6, v147, v148
v_max3_f32 v7, v7, v163, v164
v_max3_f32 v6, v6, v149, v150
v_mfma_f32_32x32x16_bf16 a[16:31], a[196:199], v[80:83], a[16:31]
ds_read_b128 a[132:135], v10 offset:17408
v_max3_f32 v7, v7, v165, v166
v_max3_f32 v6, v6, v151, v152
v_max3_f32 v7, v7, v167, v168
v_max3_f32 v6, v6, v153, v154
v_max3_f32 v7, v7, v169, v170
v_mfma_f32_32x32x16_bf16 a[80:95], a[196:199], v[96:99], a[80:95]
v_max3_f32 v6, v6, v155, v156
v_max3_f32 v7, v7, v171, v172
v_max3_f32 v6, v6, v157, v158
v_max3_f32 v7, v7, v173, v174
v_add_u32 v247, -96, v13
v_mfma_f32_32x32x16_bf16 a[32:47], a[200:203], v[80:83], a[32:47]
ds_read_b128 a[136:139], v10 offset:18432
v_cmp_gt_i32_e64 s[84:85], 0, v247
v_cmp_gt_i32_e64 s[86:87], 1, v247
v_cmp_gt_i32_e64 s[88:89], 2, v247
v_cmp_gt_i32_e64 s[90:91], 3, v247
v_cndmask_b32_e64 v192, v192, v14, s[84:85]
v_mfma_f32_32x32x16_bf16 a[96:111], a[200:203], v[96:99], a[96:111]
v_cndmask_b32_e64 v193, v193, v14, s[86:87]
v_cndmask_b32_e64 v194, v194, v14, s[88:89]
v_cndmask_b32_e64 v195, v195, v14, s[90:91]
v_cmp_gt_i32_e64 s[92:93], 16, v247
v_mfma_f32_32x32x16_bf16 a[48:63], a[204:207], v[80:83], a[48:63]
ds_read_b128 a[140:143], v10 offset:19456
v_cmp_gt_i32_e64 s[94:95], 17, v247
v_cmp_gt_i32_e64 s[96:97], 18, v247
v_cmp_gt_i32_e64 s[98:99], 19, v247
v_cndmask_b32_e64 v196, v196, v14, s[92:93]
v_cndmask_b32_e64 v197, v197, v14, s[94:95]
v_mfma_f32_32x32x16_bf16 a[112:127], a[204:207], v[96:99], a[112:127]
v_cndmask_b32_e64 v198, v198, v14, s[96:97]
v_cndmask_b32_e64 v199, v199, v14, s[98:99]
v_cmp_gt_i32_e64 s[84:85], 8, v247
v_cmp_gt_i32_e64 s[86:87], 9, v247
v_cmp_gt_i32_e64 s[88:89], 10, v247
v_mfma_f32_32x32x16_bf16 a[0:15], a[208:211], v[88:91], a[0:15]
ds_read_b128 a[144:147], v10 offset:20480
v_cmp_gt_i32_e64 s[90:91], 11, v247
v_cndmask_b32_e64 v200, v200, v14, s[84:85]
v_cndmask_b32_e64 v201, v201, v14, s[86:87]
v_cndmask_b32_e64 v202, v202, v14, s[88:89]
v_cndmask_b32_e64 v203, v203, v14, s[90:91]
v_mfma_f32_32x32x16_bf16 a[64:79], a[208:211], v[104:107], a[64:79]
ds_read_b128 a[148:151], v10 offset:21504
v_cmp_gt_i32_e64 s[92:93], 24, v247
v_cmp_gt_i32_e64 s[94:95], 25, v247
v_cmp_gt_i32_e64 s[96:97], 26, v247
v_cmp_gt_i32_e64 s[98:99], 27, v247
v_cndmask_b32_e64 v204, v204, v14, s[92:93]
v_mfma_f32_32x32x16_bf16 a[16:31], a[212:215], v[88:91], a[16:31]
v_cndmask_b32_e64 v205, v205, v14, s[94:95]
v_cndmask_b32_e64 v206, v206, v14, s[96:97]
v_cndmask_b32_e64 v207, v207, v14, s[98:99]
v_max3_f32 v6, v6, v159, v176
v_mfma_f32_32x32x16_bf16 a[80:95], a[212:215], v[104:107], a[80:95]
ds_read_b128 a[152:155], v10 offset:22528
v_max3_f32 v7, v7, v175, v192
v_max3_f32 v6, v6, v177, v178
v_max3_f32 v7, v7, v193, v194
v_max3_f32 v6, v6, v179, v180
v_max3_f32 v7, v7, v195, v196
v_mfma_f32_32x32x16_bf16 a[32:47], a[216:219], v[88:91], a[32:47]
v_max3_f32 v6, v6, v181, v182
v_max3_f32 v7, v7, v197, v198
v_max3_f32 v6, v6, v183, v184
v_max3_f32 v7, v7, v199, v200
v_max3_f32 v6, v6, v185, v186
v_mfma_f32_32x32x16_bf16 a[96:111], a[216:219], v[104:107], a[96:111]
ds_read_b128 a[156:159], v10 offset:23552
v_max3_f32 v7, v7, v201, v202
v_max3_f32 v6, v6, v187, v188
v_max3_f32 v7, v7, v203, v204
v_max3_f32 v6, v6, v189, v190
v_max3_f32 v7, v7, v205, v206
v_mfma_f32_32x32x16_bf16 a[48:63], a[220:223], v[88:91], a[48:63]
v_max_f32 v6, v6, v191
v_max_f32 v7, v7, v207
v_max_f32 v240, v6, v7
v_cmp_lt_f32 vcc, s79, v240
v_mfma_f32_32x32x16_bf16 a[112:127], a[220:223], v[104:107], a[112:127]
s_cbranch_vccnz L_p3_d0m_rare
s_add_u32 m0, s72, 0
ds_read_b128 a[160:163], v10 offset:24576
v_exp_f32 v144, v144
v_exp_f32 v145, v145
v_mfma_f32_32x32x16_bf16 a[0:15], a[224:227], v[112:115], a[0:15]
ds_read_b128 a[164:167], v10 offset:25600
buffer_load_dwordx4 v12, s[52:55], s71 offen offset:0 sc1 lds
v_exp_f32 v146, v146
v_add_f32 v2, v2, v144
v_mfma_f32_32x32x16_bf16 a[64:79], a[224:227], v[128:131], a[64:79]
v_exp_f32 v147, v147
v_add_f32 v3, v3, v145
v_cvt_pk_bf16_f32 v144, v144, v145
v_exp_f32 v148, v148
v_mfma_f32_32x32x16_bf16 a[16:31], a[228:231], v[112:115], a[16:31]
ds_read_b128 a[168:171], v10 offset:26624
v_add_f32 v2, v2, v146
v_exp_f32 v149, v149
v_add_f32 v3, v3, v147
v_cvt_pk_bf16_f32 v145, v146, v147
v_mfma_f32_32x32x16_bf16 a[80:95], a[228:231], v[128:131], a[80:95]
ds_read_b128 a[172:175], v10 offset:27648
buffer_load_dwordx4 v12, s[52:55], s71 offen offset:1024 sc1 lds
v_exp_f32 v150, v150
v_add_f32 v2, v2, v148
v_mfma_f32_32x32x16_bf16 a[32:47], a[232:235], v[112:115], a[32:47]
v_exp_f32 v151, v151
v_add_f32 v3, v3, v149
v_cvt_pk_bf16_f32 v146, v148, v149
v_exp_f32 v152, v152
v_mfma_f32_32x32x16_bf16 a[96:111], a[232:235], v[128:131], a[96:111]
ds_read_b128 a[176:179], v10 offset:28672
v_add_f32 v2, v2, v150
v_exp_f32 v153, v153
v_add_f32 v3, v3, v151
v_cvt_pk_bf16_f32 v147, v150, v151
v_mfma_f32_32x32x16_bf16 a[48:63], a[236:239], v[112:115], a[48:63]
buffer_load_dwordx4 v12, s[52:55], s71 offen offset:2048 sc1 lds
v_exp_f32 v154, v154
v_add_f32 v2, v2, v152
v_exp_f32 v155, v155
v_mfma_f32_32x32x16_bf16 a[112:127], a[236:239], v[128:131], a[112:127]
ds_read_b128 a[180:183], v10 offset:29696
v_add_f32 v3, v3, v153
v_cvt_pk_bf16_f32 v152, v152, v153
v_exp_f32 v156, v156
v_add_f32 v2, v2, v154
v_mfma_f32_32x32x16_bf16 a[0:15], a[240:243], v[120:123], a[0:15]
ds_read_b128 a[184:187], v10 offset:30720
v_exp_f32 v157, v157
v_add_f32 v3, v3, v155
v_cvt_pk_bf16_f32 v153, v154, v155
v_mfma_f32_32x32x16_bf16 a[64:79], a[240:243], v[136:139], a[64:79]
buffer_load_dwordx4 v12, s[52:55], s71 offen offset:3072 sc1 lds
v_exp_f32 v158, v158
v_add_f32 v2, v2, v156
v_exp_f32 v159, v159
v_mfma_f32_32x32x16_bf16 a[16:31], a[244:247], v[120:123], a[16:31]
ds_read_b128 a[188:191], v10 offset:31744
v_add_f32 v3, v3, v157
v_cvt_pk_bf16_f32 v154, v156, v157
v_exp_f32 v160, v160
v_add_f32 v2, v2, v158
v_mfma_f32_32x32x16_bf16 a[80:95], a[244:247], v[136:139], a[80:95]
v_exp_f32 v161, v161
v_add_f32 v3, v3, v159
v_cvt_pk_bf16_f32 v155, v158, v159
v_exp_f32 v162, v162
v_mfma_f32_32x32x16_bf16 a[32:47], a[248:251], v[120:123], a[32:47]
s_cmp_eq_u32 s70, 7
v_add_f32 v4, v4, v160
v_exp_f32 v163, v163
v_add_f32 v5, v5, v161
v_cvt_pk_bf16_f32 v160, v160, v161
v_mfma_f32_32x32x16_bf16 a[96:111], a[248:251], v[136:139], a[96:111]
v_exp_f32 v164, v164
v_add_f32 v4, v4, v162
v_exp_f32 v165, v165
v_add_f32 v5, v5, v163
v_mfma_f32_32x32x16_bf16 a[48:63], a[252:255], v[120:123], a[48:63]
v_cvt_pk_bf16_f32 v161, v162, v163
v_exp_f32 v166, v166
v_add_f32 v4, v4, v164
v_exp_f32 v167, v167
v_mfma_f32_32x32x16_bf16 a[112:127], a[252:255], v[136:139], a[112:127]
v_add_f32 v5, v5, v165
v_cvt_pk_bf16_f32 v162, v164, v165
v_add_f32 v4, v4, v166
v_add_f32 v5, v5, v167
v_cvt_pk_bf16_f32 v163, v166, v167
L_p3_d0m_end:
s_cbranch_scc1 L_p3_mxm_top
s_waitcnt lgkmcnt(0)
v_xor_b32 v11, 0x8000, v11
v_mfma_f32_32x32x16_bf16 v[80:95], a[128:131], v[16:19], v[208:223]
s_add_u32 m0, s73, 16384
ds_read_b128 a[192:195], v11 offset:0
ds_read_b128 a[196:199], v11 offset:1024
v_exp_f32 v168, v168
v_mfma_f32_32x32x16_bf16 v[80:95], a[132:135], v[20:23], v[80:95]
ds_read_b128 a[200:203], v11 offset:2048
buffer_load_dwordx4 v12, s[56:59], s71 offen offset:0 sc1 lds
v_exp_f32 v169, v169
v_exp_f32 v170, v170
v_mfma_f32_32x32x16_bf16 v[80:95], a[136:139], v[24:27], v[80:95]
ds_read_b128 a[204:207], v11 offset:3072
ds_read_b128 a[208:211], v11 offset:4096
v_add_f32 v4, v4, v168
v_exp_f32 v171, v171
v_add_f32 v5, v5, v169
v_mfma_f32_32x32x16_bf16 v[80:95], a[140:143], v[28:31], v[80:95]
ds_read_b128 a[212:215], v11 offset:5120
buffer_load_dwordx4 v12, s[56:59], s71 offen offset:1024 sc1 lds
v_cvt_pk_bf16_f32 v168, v168, v169
v_exp_f32 v172, v172
v_add_f32 v4, v4, v170
v_mfma_f32_32x32x16_bf16 v[80:95], a[144:147], v[32:35], v[80:95]
ds_read_b128 a[216:219], v11 offset:6144
ds_read_b128 a[220:223], v11 offset:7168
v_exp_f32 v173, v173
v_add_f32 v5, v5, v171
v_cvt_pk_bf16_f32 v169, v170, v171
v_mfma_f32_32x32x16_bf16 v[80:95], a[148:151], v[36:39], v[80:95]
ds_read_b128 a[224:227], v11 offset:8192
v_exp_f32 v174, v174
v_add_f32 v4, v4, v172
v_exp_f32 v175, v175
v_mfma_f32_32x32x16_bf16 v[80:95], a[152:155], v[40:43], v[80:95]
ds_read_b128 a[228:231], v11 offset:9216
ds_read_b128 a[232:235], v11 offset:10240
buffer_load_dwordx4 v12, s[56:59], s71 offen offset:2048 sc1 lds
v_add_f32 v5, v5, v173
v_cvt_pk_bf16_f32 v170, v172, v173
v_mfma_f32_32x32x16_bf16 v[80:95], a[156:159], v[44:47], v[80:95]
ds_read_b128 a[236:239], v11 offset:11264
v_exp_f32 v176, v176
v_add_f32 v4, v4, v174
v_exp_f32 v177, v177
v_mfma_f32_32x32x16_bf16 v[112:127], a[160:163], v[16:19], v[208:223]
ds_read_b128 a[240:243], v11 offset:12288
ds_read_b128 a[244:247], v11 offset:13312
buffer_load_dwordx4 v12, s[56:59], s71 offen offset:3072 sc1 lds
v_add_f32 v5, v5, v175
v_cvt_pk_bf16_f32 v171, v174, v175
v_mfma_f32_32x32x16_bf16 v[112:127], a[164:167], v[20:23], v[112:127]
ds_read_b128 a[248:251], v11 offset:14336
v_exp_f32 v178, v178
v_add_f32 v2, v2, v176
v_exp_f32 v179, v179
v_mfma_f32_32x32x16_bf16 v[112:127], a[168:171], v[24:27], v[112:127]
ds_read_b128 a[252:255], v11 offset:15360
v_add_f32 v3, v3, v177
v_cvt_pk_bf16_f32 v176, v176, v177
v_exp_f32 v180, v180
v_add_f32 v2, v2, v178
v_mfma_f32_32x32x16_bf16 v[112:127], a[172:175], v[28:31], v[112:127]
s_add_u32 s71, s71, 16384
v_exp_f32 v181, v181
v_add_f32 v3, v3, v179
v_cvt_pk_bf16_f32 v177, v178, v179
v_mfma_f32_32x32x16_bf16 v[112:127], a[176:179], v[32:35], v[112:127]
v_exp_f32 v182, v182
v_add_f32 v2, v2, v180
v_exp_f32 v183, v183
v_add_f32 v3, v3, v181
v_mfma_f32_32x32x16_bf16 v[112:127], a[180:183], v[36:39], v[112:127]
s_xor_b32 s73, s73, 0x8000
v_cvt_pk_bf16_f32 v178, v180, v181
v_exp_f32 v184, v184
v_add_f32 v2, v2, v182
v_mfma_f32_32x32x16_bf16 v[112:127], a[184:187], v[40:43], v[112:127]
v_exp_f32 v185, v185
v_add_f32 v3, v3, v183
v_cvt_pk_bf16_f32 v179, v182, v183
v_exp_f32 v186, v186
v_mfma_f32_32x32x16_bf16 v[112:127], a[188:191], v[44:47], v[112:127]
v_add_f32 v2, v2, v184
v_exp_f32 v187, v187
v_add_f32 v3, v3, v185
v_cvt_pk_bf16_f32 v184, v184, v185
v_exp_f32 v188, v188
v_add_f32 v2, v2, v186
v_exp_f32 v189, v189
v_add_f32 v3, v3, v187
v_cvt_pk_bf16_f32 v185, v186, v187
v_exp_f32 v190, v190
v_add_f32 v2, v2, v188
v_exp_f32 v191, v191
v_add_f32 v3, v3, v189
v_cvt_pk_bf16_f32 v186, v188, v189
v_exp_f32 v192, v192
v_add_f32 v2, v2, v190
v_exp_f32 v193, v193
v_add_f32 v3, v3, v191
v_cvt_pk_bf16_f32 v187, v190, v191
v_exp_f32 v194, v194
v_add_f32 v4, v4, v192
v_exp_f32 v195, v195
v_add_f32 v5, v5, v193
v_cvt_pk_bf16_f32 v192, v192, v193
v_exp_f32 v196, v196
v_add_f32 v4, v4, v194
v_exp_f32 v197, v197
v_add_f32 v5, v5, v195
v_cvt_pk_bf16_f32 v193, v194, v195
v_exp_f32 v198, v198
v_add_f32 v4, v4, v196
v_exp_f32 v199, v199
v_add_f32 v5, v5, v197
v_cvt_pk_bf16_f32 v194, v196, v197
v_exp_f32 v200, v200
v_add_f32 v4, v4, v198
v_exp_f32 v201, v201
v_add_f32 v5, v5, v199
v_cvt_pk_bf16_f32 v195, v198, v199
v_exp_f32 v202, v202
v_add_f32 v4, v4, v200
v_exp_f32 v203, v203
v_add_f32 v5, v5, v201
v_cvt_pk_bf16_f32 v200, v200, v201
v_exp_f32 v204, v204
v_add_f32 v4, v4, v202
v_exp_f32 v205, v205
v_add_f32 v5, v5, v203
v_cvt_pk_bf16_f32 v201, v202, v203
v_exp_f32 v206, v206
v_add_f32 v4, v4, v204
v_exp_f32 v207, v207
v_add_f32 v5, v5, v205
v_cvt_pk_bf16_f32 v202, v204, v205
v_add_f32 v4, v4, v206
v_add_f32 v5, v5, v207
v_cvt_pk_bf16_f32 v203, v206, v207
s_waitcnt vmcnt(16) lgkmcnt(0)
v_mfma_f32_32x32x16_bf16 a[0:15], a[192:195], v[144:147], a[0:15]
s_barrier
v_xor_b32 v10, 0x8000, v10
v_mfma_f32_32x32x16_bf16 a[64:79], a[192:195], v[160:163], a[64:79]
ds_read_b128 a[128:131], v10 offset:0
v_max3_f32 v6, v80, v81, v82
v_max3_f32 v6, v6, v83, v84
v_max3_f32 v6, v6, v85, v86
v_max3_f32 v6, v6, v87, v88
v_max3_f32 v6, v6, v89, v90
v_mfma_f32_32x32x16_bf16 a[16:31], a[196:199], v[144:147], a[16:31]
v_max3_f32 v6, v6, v91, v92
v_max3_f32 v6, v6, v93, v94
v_max3_f32 v6, v6, v95, v112
v_max3_f32 v6, v6, v113, v114
v_mfma_f32_32x32x16_bf16 a[80:95], a[196:199], v[160:163], a[80:95]
ds_read_b128 a[132:135], v10 offset:1024
v_max3_f32 v6, v6, v115, v116
v_max3_f32 v6, v6, v117, v118
v_max3_f32 v6, v6, v119, v120
v_max3_f32 v6, v6, v121, v122
v_mfma_f32_32x32x16_bf16 a[32:47], a[200:203], v[144:147], a[32:47]
v_max3_f32 v6, v6, v123, v124
v_max3_f32 v6, v6, v125, v126
v_max_f32 v6, v6, v127
v_cmp_lt_f32 vcc, s79, v6
v_mfma_f32_32x32x16_bf16 a[96:111], a[200:203], v[160:163], a[96:111]
s_cbranch_vccnz L_p3_mx_rare
s_add_u32 m0, s72, 16384
ds_read_b128 a[136:139], v10 offset:2048
v_exp_f32 v80, v80
v_bfe_u32 v248, v1, 2, 2
v_bfe_u32 v249, v1, 4, 1
v_mfma_f32_32x32x16_bf16 a[48:63], a[204:207], v[144:147], a[48:63]
ds_read_b128 a[140:143], v10 offset:3072
buffer_load_dwordx4 v12, s[52:55], s71 offen offset:0 sc1 lds
v_lshl_add_u32 v248, v249, 2, v248
v_lshrrev_b32 v249, 5, v1
v_exp_f32 v81, v81
v_mfma_f32_32x32x16_bf16 a[112:127], a[204:207], v[160:163], a[112:127]
v_lshl_add_u32 v249, v249, 4, v248
v_lshlrev_b32 v249, 8, v249
v_and_b32 v250, 3, v1
v_exp_f32 v82, v82
v_lshl_add_u32 v249, v250, 3, v249
v_mfma_f32_32x32x16_bf16 a[0:15], a[208:211], v[152:155], a[0:15]
ds_read_b128 a[144:147], v10 offset:4096
s_lshl_b32 s36, s3, 13
s_add_u32 s36, s36, 131072
v_add_f32 v2, v2, v80
v_add_u32 v249, s36, v249
v_xor_b32 v250, 0, v248
v_mfma_f32_32x32x16_bf16 a[64:79], a[208:211], v[168:171], a[64:79]
ds_read_b128 a[148:151], v10 offset:5120
v_lshl_add_u32 v250, v250, 5, v249
TR 96,250,0
v_exp_f32 v83, v83
TR 98,250,2048
v_mfma_f32_32x32x16_bf16 a[16:31], a[212:215], v[152:155], a[16:31]
v_xor_b32 v250, 1, v248
v_lshl_add_u32 v250, v250, 5, v249
v_add_f32 v3, v3, v81
TR 100,250,0
TR 102,250,2048
v_xor_b32 v250, 2, v248
v_mfma_f32_32x32x16_bf16 a[80:95], a[212:215], v[168:171], a[80:95]
ds_read_b128 a[152:155], v10 offset:6144
buffer_load_dwordx4 v12, s[52:55], s71 offen offset:1024 sc1 lds
v_cvt_pk_bf16_f32 v80, v80, v81
v_lshl_add_u32 v250, v250, 5, v249
TR 104,250,0
TR 106,250,2048
v_mfma_f32_32x32x16_bf16 a[32:47], a[216:219], v[152:155], a[32:47]
v_exp_f32 v84, v84
v_xor_b32 v250, 3, v248
v_lshl_add_u32 v250, v250, 5, v249
TR 108,250,0
TR 110,250,2048
v_mfma_f32_32x32x16_bf16 a[96:111], a[216:219], v[168:171], a[96:111]
ds_read_b128 a[156:159], v10 offset:7168
v_add_f32 v2, v2, v82
v_xor_b32 v250, 4, v248
v_lshl_add_u32 v250, v250, 5, v249
TR 128,250,0
v_mfma_f32_32x32x16_bf16 a[48:63], a[220:223], v[152:155], a[48:63]
ds_read_b128 a[160:163], v10 offset:8192
v_exp_f32 v85, v85
TR 130,250,2048
v_xor_b32 v250, 5, v248
v_lshl_add_u32 v250, v250, 5, v249
v_mfma_f32_32x32x16_bf16 a[112:127], a[220:223], v[168:171], a[112:127]
v_add_f32 v3, v3, v83
v_cvt_pk_bf16_f32 v81, v82, v83
TR 132,250,0
TR 134,250,2048
v_xor_b32 v250, 6, v248
v_mfma_f32_32x32x16_bf16 a[0:15], a[224:227], v[176:179], a[0:15]
ds_read_b128 a[164:167], v10 offset:9216
buffer_load_dwordx4 v12, s[52:55], s71 offen offset:2048 sc1 lds
v_exp_f32 v86, v86
v_lshl_add_u32 v250, v250, 5, v249
TR 136,250,0
v_mfma_f32_32x32x16_bf16 a[64:79], a[224:227], v[192:195], a[64:79]
TR 138,250,2048
v_xor_b32 v250, 7, v248
v_add_f32 v2, v2, v84
v_lshl_add_u32 v250, v250, 5, v249
TR 140,250,0
TR 142,250,2048
v_mfma_f32_32x32x16_bf16 a[16:31], a[228:231], v[176:179], a[16:31]
ds_read_b128 a[168:171], v10 offset:10240
v_exp_f32 v87, v87
s_add_u32 s32, s40, 100663296
s_addc_u32 s33, s41, 0
s_mov_b32 s34, 8388608
v_mfma_f32_32x32x16_bf16 a[80:95], a[228:231], v[192:195], a[80:95]
ds_read_b128 a[172:175], v10 offset:11264
v_add_f32 v3, v3, v85
s_mov_b32 s35, 0x20000
s_and_b32 s36, s2, 7
s_lshl_b32 s36, s36, 20
v_mfma_f32_32x32x16_bf16 a[32:47], a[232:235], v[176:179], a[32:47]
v_cvt_pk_bf16_f32 v82, v84, v85
s_lshr_b32 s37, s2, 3
s_lshl_b32 s37, s37, 15
s_add_u32 s36, s36, s37
s_lshl_b32 s37, s3, 12
v_mfma_f32_32x32x16_bf16 a[96:111], a[232:235], v[192:195], a[96:111]
ds_read_b128 a[176:179], v10 offset:12288
buffer_load_dwordx4 v12, s[52:55], s71 offen offset:3072 sc1 lds
v_exp_f32 v88, v88
s_add_u32 s36, s36, s37
s_add_u32 s37, s36, 4096
v_mfma_f32_32x32x16_bf16 a[48:63], a[236:239], v[176:179], a[48:63]
s_waitcnt lgkmcnt(15)
buffer_store_dwordx4 v[96:99], v12, s[32:35], s36 offen offset:0 sc1
v_add_f32 v2, v2, v86
buffer_store_dwordx4 v[100:103], v12, s[32:35], s36 offen offset:1024 sc1
buffer_store_dwordx4 v[104:107], v12, s[32:35], s36 offen offset:2048 sc1
s_waitcnt lgkmcnt(14)
buffer_store_dwordx4 v[108:111], v12, s[32:35], s36 offen offset:3072 sc1
v_mfma_f32_32x32x16_bf16 a[112:127], a[236:239], v[192:195], a[112:127]
ds_read_b128 a[180:183], v10 offset:13312
v_exp_f32 v89, v89
s_waitcnt lgkmcnt(11)
buffer_store_dwordx4 v[128:131], v12, s[32:35], s37 offen offset:0 sc1
s_waitcnt lgkmcnt(9)
buffer_store_dwordx4 v[132:135], v12, s[32:35], s37 offen offset:1024 sc1
s_waitcnt lgkmcnt(6)
buffer_store_dwordx4 v[136:139], v12, s[32:35], s37 offen offset:2048 sc1
v_mfma_f32_32x32x16_bf16 a[0:15], a[240:243], v[184:187], a[0:15]
ds_read_b128 a[184:187], v10 offset:14336
v_add_f32 v3, v3, v87
v_cvt_pk_bf16_f32 v83, v86, v87
s_waitcnt lgkmcnt(5)
buffer_store_dwordx4 v[140:143], v12, s[32:35], s37 offen offset:3072 sc1
s_add_u32 s32, s40, 109051904
s_addc_u32 s33, s41, 0
v_mfma_f32_32x32x16_bf16 a[64:79], a[240:243], v[200:203], a[64:79]
s_mov_b32 s34, 4194304
v_exp_f32 v90, v90
s_mov_b32 s35, 0x20000
s_lshl_b32 s36, s2, 14
v_mov_b32 v252, -1
v_mfma_f32_32x32x16_bf16 a[16:31], a[244:247], v[184:187], a[16:31]
ds_read_b128 a[188:191], v10 offset:15360
s_xor_b32 s72, s72, 0x8000
v_add_f32 v2, v2, v88
v_mov_b32 v253, -1
v_mov_b32 v254, -1
v_mov_b32 v255, -1
v_mfma_f32_32x32x16_bf16 a[80:95], a[244:247], v[200:203], a[80:95]
v_exp_f32 v91, v91
buffer_store_dwordx4 v[252:255], v12, s[32:35], s36 offen offset:0 sc1
buffer_store_dwordx4 v[252:255], v12, s[32:35], s36 offen offset:1024 sc1
buffer_store_dwordx4 v[252:255], v12, s[32:35], s36 offen offset:2048 sc1
v_mfma_f32_32x32x16_bf16 a[32:47], a[248:251], v[184:187], a[32:47]
v_add_f32 v3, v3, v89
buffer_store_dwordx4 v[252:255], v12, s[32:35], s36 offen offset:3072 sc1
v_lshlrev_b32 v72, 4, v1
v_add_u32 v73, -8, v72
v_mov_b32 v75, 0
v_mfma_f32_32x32x16_bf16 a[96:111], a[248:251], v[200:203], a[96:111]
v_cvt_pk_bf16_f32 v88, v88, v89
buffer_load_ushort v74, v75, s[28:31], s42 offen
buffer_load_dwordx2 v[48:49], v73, s[16:19], 0 offen
buffer_load_dwordx4 v[50:53], v72, s[16:19], 0 offen offset:0
v_mfma_f32_32x32x16_bf16 a[48:63], a[252:255], v[184:187], a[48:63]
v_add_f32 v2, v2, v90
v_add_f32 v3, v3, v91
buffer_load_dwordx2 v[54:55], v72, s[16:19], 0 offen offset:1016
buffer_load_dwordx4 v[56:59], v72, s[16:19], 0 offen offset:1024
buffer_load_dwordx2 v[60:61], v72, s[16:19], 0 offen offset:2040
v_mfma_f32_32x32x16_bf16 a[112:127], a[252:255], v[200:203], a[112:127]
v_cvt_pk_bf16_f32 v89, v90, v91
buffer_load_dwordx4 v[62:65], v72, s[16:19], 0 offen offset:2048
buffer_load_dwordx2 v[66:67], v72, s[16:19], 0 offen offset:3064
buffer_load_dwordx4 v[68:71], v72, s[16:19], 0 offen offset:3072
L_p3_mx_end:
L_p3_eps:
v_add_f32 v4, v4, v5
v_mov_b32 v5, v4
s_nop 1
v_permlane32_swap_b32 v4, v5
v_add_f32 v4, v4, v5
v_rcp_f32 v4, v4
s_nop 7
v_accvgpr_read_b32 v240, a64
v_accvgpr_read_b32 v241, a65
v_accvgpr_read_b32 v242, a66
v_accvgpr_read_b32 v243, a67
v_accvgpr_read_b32 v244, a68
v_accvgpr_read_b32 v245, a69
v_accvgpr_read_b32 v246, a70
v_accvgpr_read_b32 v247, a71
v_mul_f32 v240, v240, v4
v_mul_f32 v241, v241, v4
v_mul_f32 v242, v242, v4
v_mul_f32 v243, v243, v4
v_mul_f32 v244, v244, v4
v_mul_f32 v245, v245, v4
v_mul_f32 v246, v246, v4
v_mul_f32 v247, v247, v4
v_cvt_pk_bf16_f32 v248, v240, v241
v_cvt_pk_bf16_f32 v249, v242, v243
v_cvt_pk_bf16_f32 v250, v244, v245
v_cvt_pk_bf16_f32 v251, v246, v247
buffer_store_dwordx4 v[248:251], v15, s[60:63], s101 offen offset:0 sc1
v_accvgpr_read_b32 v240, a72
v_accvgpr_read_b32 v241, a73
v_accvgpr_read_b32 v242, a74
v_accvgpr_read_b32 v243, a75
v_accvgpr_read_b32 v244, a76
v_accvgpr_read_b32 v245, a77
v_accvgpr_read_b32 v246, a78
v_accvgpr_read_b32 v247, a79
v_mul_f32 v240, v240, v4
v_mul_f32 v241, v241, v4
v_mul_f32 v242, v242, v4
v_mul_f32 v243, v243, v4
v_mul_f32 v244, v244, v4
v_mul_f32 v245, v245, v4
v_mul_f32 v246, v246, v4
v_mul_f32 v247, v247, v4
v_cvt_pk_bf16_f32 v252, v240, v241
v_cvt_pk_bf16_f32 v253, v242, v243
v_cvt_pk_bf16_f32 v254, v244, v245
v_cvt_pk_bf16_f32 v255, v246, v247
buffer_store_dwordx4 v[252:255], v15, s[60:63], s101 offen offset:512 sc1
v_accvgpr_read_b32 v240, a80
v_accvgpr_read_b32 v241, a81
v_accvgpr_read_b32 v242, a82
v_accvgpr_read_b32 v243, a83
v_accvgpr_read_b32 v244, a84
v_accvgpr_read_b32 v245, a85
v_accvgpr_read_b32 v246, a86
v_accvgpr_read_b32 v247, a87
v_mul_f32 v240, v240, v4
v_mul_f32 v241, v241, v4
v_mul_f32 v242, v242, v4
v_mul_f32 v243, v243, v4
v_mul_f32 v244, v244, v4
v_mul_f32 v245, v245, v4
v_mul_f32 v246, v246, v4
v_mul_f32 v247, v247, v4
v_cvt_pk_bf16_f32 v248, v240, v241
v_cvt_pk_bf16_f32 v249, v242, v243
v_cvt_pk_bf16_f32 v250, v244, v245
v_cvt_pk_bf16_f32 v251, v246, v247
buffer_store_dwordx4 v[248:251], v15, s[60:63], s101 offen offset:1024 sc1
v_accvgpr_read_b32 v240, a88
v_accvgpr_read_b32 v241, a89
v_accvgpr_read_b32 v242, a90
v_accvgpr_read_b32 v243, a91
v_accvgpr_read_b32 v244, a92
v_accvgpr_read_b32 v245, a93
v_accvgpr_read_b32 v246, a94
v_accvgpr_read_b32 v247, a95
v_mul_f32 v240, v240, v4
v_mul_f32 v241, v241, v4
v_mul_f32 v242, v242, v4
v_mul_f32 v243, v243, v4
v_mul_f32 v244, v244, v4
v_mul_f32 v245, v245, v4
v_mul_f32 v246, v246, v4
v_mul_f32 v247, v247, v4
v_cvt_pk_bf16_f32 v252, v240, v241
v_cvt_pk_bf16_f32 v253, v242, v243
v_cvt_pk_bf16_f32 v254, v244, v245
v_cvt_pk_bf16_f32 v255, v246, v247
buffer_store_dwordx4 v[252:255], v15, s[60:63], s101 offen offset:1536 sc1
v_accvgpr_read_b32 v240, a96
v_accvgpr_read_b32 v241, a97
v_accvgpr_read_b32 v242, a98
v_accvgpr_read_b32 v243, a99
v_accvgpr_read_b32 v244, a100
v_accvgpr_read_b32 v245, a101
v_accvgpr_read_b32 v246, a102
v_accvgpr_read_b32 v247, a103
v_mul_f32 v240, v240, v4
v_mul_f32 v241, v241, v4
v_mul_f32 v242, v242, v4
v_mul_f32 v243, v243, v4
v_mul_f32 v244, v244, v4
v_mul_f32 v245, v245, v4
v_mul_f32 v246, v246, v4
v_mul_f32 v247, v247, v4
v_cvt_pk_bf16_f32 v248, v240, v241
v_cvt_pk_bf16_f32 v249, v242, v243
v_cvt_pk_bf16_f32 v250, v244, v245
v_cvt_pk_bf16_f32 v251, v246, v247
buffer_store_dwordx4 v[248:251], v15, s[60:63], s101 offen offset:2048 sc1
v_accvgpr_read_b32 v240, a104
v_accvgpr_read_b32 v241, a105
v_accvgpr_read_b32 v242, a106
v_accvgpr_read_b32 v243, a107
v_accvgpr_read_b32 v244, a108
v_accvgpr_read_b32 v245, a109
v_accvgpr_read_b32 v246, a110
v_accvgpr_read_b32 v247, a111
v_mul_f32 v240, v240, v4
v_mul_f32 v241, v241, v4
v_mul_f32 v242, v242, v4
v_mul_f32 v243, v243, v4
v_mul_f32 v244, v244, v4
v_mul_f32 v245, v245, v4
v_mul_f32 v246, v246, v4
v_mul_f32 v247, v247, v4
v_cvt_pk_bf16_f32 v252, v240, v241
v_cvt_pk_bf16_f32 v253, v242, v243
v_cvt_pk_bf16_f32 v254, v244, v245
v_cvt_pk_bf16_f32 v255, v246, v247
buffer_store_dwordx4 v[252:255], v15, s[60:63], s101 offen offset:2560 sc1
v_accvgpr_read_b32 v240, a112
v_accvgpr_read_b32 v241, a113
v_accvgpr_read_b32 v242, a114
v_accvgpr_read_b32 v243, a115
v_accvgpr_read_b32 v244, a116
v_accvgpr_read_b32 v245, a117
v_accvgpr_read_b32 v246, a118
v_accvgpr_read_b32 v247, a119
v_mul_f32 v240, v240, v4
v_mul_f32 v241, v241, v4
v_mul_f32 v242, v242, v4
v_mul_f32 v243, v243, v4
v_mul_f32 v244, v244, v4
v_mul_f32 v245, v245, v4
v_mul_f32 v246, v246, v4
v_mul_f32 v247, v247, v4
v_cvt_pk_bf16_f32 v248, v240, v241
v_cvt_pk_bf16_f32 v249, v242, v243
v_cvt_pk_bf16_f32 v250, v244, v245
v_cvt_pk_bf16_f32 v251, v246, v247
buffer_store_dwordx4 v[248:251], v15, s[60:63], s101 offen offset:3072 sc1
v_accvgpr_read_b32 v240, a120
v_accvgpr_read_b32 v241, a121
v_accvgpr_read_b32 v242, a122
v_accvgpr_read_b32 v243, a123
v_accvgpr_read_b32 v244, a124
v_accvgpr_read_b32 v245, a125
v_accvgpr_read_b32 v246, a126
v_accvgpr_read_b32 v247, a127
v_mul_f32 v240, v240, v4
v_mul_f32 v241, v241, v4
v_mul_f32 v242, v242, v4
v_mul_f32 v243, v243, v4
v_mul_f32 v244, v244, v4
v_mul_f32 v245, v245, v4
v_mul_f32 v246, v246, v4
v_mul_f32 v247, v247, v4
v_cvt_pk_bf16_f32 v252, v240, v241
v_cvt_pk_bf16_f32 v253, v242, v243
v_cvt_pk_bf16_f32 v254, v244, v245
v_cvt_pk_bf16_f32 v255, v246, v247
buffer_store_dwordx4 v[252:255], v15, s[60:63], s101 offen offset:3584 sc1
s_and_b32 s36, s2, 3
s_lshl_b32 s36, s36, 1
s_sub_u32 s32, 14, s36
s_bitcmp1_b32 s2, 4
s_cselect_b32 s36, s32, s36
s_bfe_u32 s32, s2, 0x10003
s_add_u32 s36, s36, s32
s_bfe_u32 s37, s2, 0x10002
s_lshr_b32 s32, s2, 5
s_lshl_b32 s32, s32, 1
s_add_u32 s37, s37, s32
s_lshl_b32 s36, s36, 2
s_add_u32 s36, s36, s3
s_lshl_b32 s37, s37, 7
s_lshl_b32 s32, s36, 16
s_add_u32 s37, s37, s32
s_lshl_b32 s36, s36, 7
v_and_b32 v240, 15, v1
v_bfe_u32 v241, v1, 4, 1
v_lshlrev_b32 v241, 5, v241
v_lshrrev_b32 v242, 5, v1
v_lshl_add_u32 v241, v242, 4, v241
v_lshl_add_u32 v241, v240, 11, v241
v_lshlrev_b32 v240, 2, v240
s_add_u32 s32, s40, 58720256
s_addc_u32 s33, s41, 0
s_mov_b32 s34, 8192
s_mov_b32 s35, 0x20000
buffer_load_dwordx4 v[192:195], v241, s[44:47], s37 offen offset:0
buffer_load_dwordx4 v[196:199], v241, s[44:47], s37 offen offset:64
buffer_load_dword v224, v240, s[32:35], s36 offen offset:0 sc1
s_add_u32 s37, s37, 32768
buffer_load_dwordx4 v[200:203], v241, s[44:47], s37 offen offset:0
buffer_load_dwordx4 v[204:207], v241, s[44:47], s37 offen offset:64
buffer_load_dword v225, v240, s[32:35], s36 offen offset:64 sc1
v_lshlrev_b32 v76, 20, v1
s_lshl_b32 s36, s3, 26
v_add_u32 v76, s36, v76
v_mov_b32 v77, 1
s_lshl_b32 s37, s2, 2
s_lshl_b32 s74, s70, 1
s_sub_u32 s74, 13, s74
s_cbranch_scc1 L_p3_s0m_top
.p2align 5
L_p3_s0_top:
s_waitcnt lgkmcnt(0)
v_mfma_f32_32x32x16_bf16 v[144:159], a[128:131], v[16:19], v[208:223]
s_add_u32 m0, s73, 0
ds_read_b128 a[192:195], v11 offset:16384
ds_read_b128 a[196:199], v11 offset:17408
v_exp_f32 v92, v92
v_mfma_f32_32x32x16_bf16 v[144:159], a[132:135], v[20:23], v[144:159]
ds_read_b128 a[200:203], v11 offset:18432
buffer_load_dwordx4 v12, s[56:59], s71 offen offset:0 sc1 lds
v_exp_f32 v93, v93
v_exp_f32 v94, v94
v_mfma_f32_32x32x16_bf16 v[144:159], a[136:139], v[24:27], v[144:159]
ds_read_b128 a[204:207], v11 offset:19456
ds_read_b128 a[208:211], v11 offset:20480
v_add_f32 v2, v2, v92
v_exp_f32 v95, v95
v_add_f32 v3, v3, v93
v_mfma_f32_32x32x16_bf16 v[144:159], a[140:143], v[28:31], v[144:159]
ds_read_b128 a[212:215], v11 offset:21504
v_cvt_pk_bf16_f32 v90, v92, v93
v_exp_f32 v112, v112
v_add_f32 v2, v2, v94
v_mfma_f32_32x32x16_bf16 v[144:159], a[144:147], v[32:35], v[144:159]
ds_read_b128 a[216:219], v11 offset:22528
ds_read_b128 a[220:223], v11 offset:23552
buffer_load_dwordx4 v12, s[56:59], s71 offen offset:1024 sc1 lds
v_exp_f32 v113, v113
v_add_f32 v3, v3, v95
v_mfma_f32_32x32x16_bf16 v[144:159], a[148:151], v[36:39], v[144:159]
ds_read_b128 a[224:227], v11 offset:24576
v_cvt_pk_bf16_f32 v91, v94, v95
v_exp_f32 v114, v114
v_add_f32 v2, v2, v112
v_mfma_f32_32x32x16_bf16 v[144:159], a[152:155], v[40:43], v[144:159]
ds_read_b128 a[228:231], v11 offset:25600
ds_read_b128 a[232:235], v11 offset:26624
v_exp_f32 v115, v115
v_add_f32 v3, v3, v113
v_cvt_pk_bf16_f32 v112, v112, v113
v_mfma_f32_32x32x16_bf16 v[144:159], a[156:159], v[44:47], v[144:159]
ds_read_b128 a[236:239], v11 offset:27648
buffer_load_dwordx4 v12, s[56:59], s71 offen offset:2048 sc1 lds
v_exp_f32 v116, v116
v_add_f32 v2, v2, v114
v_mfma_f32_32x32x16_bf16 v[176:191], a[160:163], v[16:19], v[208:223]
ds_read_b128 a[240:243], v11 offset:28672
ds_read_b128 a[244:247], v11 offset:29696
v_exp_f32 v117, v117
v_add_f32 v3, v3, v115
v_cvt_pk_bf16_f32 v113, v114, v115
v_mfma_f32_32x32x16_bf16 v[176:191], a[164:167], v[20:23], v[176:191]
ds_read_b128 a[248:251], v11 offset:30720
v_exp_f32 v118, v118
v_add_f32 v2, v2, v116
v_exp_f32 v119, v119
v_mfma_f32_32x32x16_bf16 v[176:191], a[168:171], v[24:27], v[176:191]
ds_read_b128 a[252:255], v11 offset:31744
buffer_load_dwordx4 v12, s[56:59], s71 offen offset:3072 sc1 lds
v_add_f32 v3, v3, v117
v_cvt_pk_bf16_f32 v114, v116, v117
v_exp_f32 v120, v120
v_mfma_f32_32x32x16_bf16 v[176:191], a[172:175], v[28:31], v[176:191]
v_add_f32 v2, v2, v118
v_exp_f32 v121, v121
v_add_f32 v3, v3, v119
v_cvt_pk_bf16_f32 v115, v118, v119
v_mfma_f32_32x32x16_bf16 v[176:191], a[176:179], v[32:35], v[176:191]
v_exp_f32 v122, v122
v_add_f32 v2, v2, v120
v_exp_f32 v123, v123
v_add_f32 v3, v3, v121
v_mfma_f32_32x32x16_bf16 v[176:191], a[180:183], v[36:39], v[176:191]
s_add_u32 s71, s71, 16384
v_cvt_pk_bf16_f32 v120, v120, v121
v_exp_f32 v124, v124
v_add_f32 v2, v2, v122
v_mfma_f32_32x32x16_bf16 v[176:191], a[184:187], v[40:43], v[176:191]
v_exp_f32 v125, v125
v_add_f32 v3, v3, v123
v_cvt_pk_bf16_f32 v121, v122, v123
v_exp_f32 v126, v126
v_mfma_f32_32x32x16_bf16 v[176:191], a[188:191], v[44:47], v[176:191]
v_add_f32 v2, v2, v124
v_exp_f32 v127, v127
v_add_f32 v3, v3, v125
v_cvt_pk_bf16_f32 v122, v124, v125
v_add_f32 v2, v2, v126
v_add_f32 v3, v3, v127
v_cvt_pk_bf16_f32 v123, v126, v127
s_waitcnt vmcnt(16) lgkmcnt(0)
v_mfma_f32_32x32x16_bf16 a[0:15], a[192:195], v[80:83], a[0:15]
s_barrier
v_mfma_f32_32x32x16_bf16 a[16:31], a[196:199], v[80:83], a[16:31]
ds_read_b128 a[128:131], v10 offset:16384
ds_read_b128 a[132:135], v10 offset:17408
v_max3_f32 v6, v144, v145, v146
v_max3_f32 v6, v6, v147, v148
v_max3_f32 v6, v6, v149, v150
v_max3_f32 v6, v6, v151, v152
v_mfma_f32_32x32x16_bf16 a[32:47], a[200:203], v[80:83], a[32:47]
ds_read_b128 a[136:139], v10 offset:18432
v_max3_f32 v6, v6, v153, v154
v_max3_f32 v6, v6, v155, v156
v_max3_f32 v6, v6, v157, v158
v_max3_f32 v6, v6, v159, v176
v_max3_f32 v6, v6, v177, v178
v_mfma_f32_32x32x16_bf16 a[48:63], a[204:207], v[80:83], a[48:63]
ds_read_b128 a[140:143], v10 offset:19456
ds_read_b128 a[144:147], v10 offset:20480
v_max3_f32 v6, v6, v179, v180
v_max3_f32 v6, v6, v181, v182
v_max3_f32 v6, v6, v183, v184
v_max3_f32 v6, v6, v185, v186
v_mfma_f32_32x32x16_bf16 a[0:15], a[208:211], v[88:91], a[0:15]
ds_read_b128 a[148:151], v10 offset:21504
v_max3_f32 v6, v6, v187, v188
v_max3_f32 v6, v6, v189, v190
v_max_f32 v6, v6, v191
v_cmp_lt_f32 vcc, s79, v6
v_mfma_f32_32x32x16_bf16 a[16:31], a[212:215], v[88:91], a[16:31]
s_cbranch_vccnz L_p3_s0_rare
s_add_u32 m0, s72, 0
ds_read_b128 a[152:155], v10 offset:22528
ds_read_b128 a[156:159], v10 offset:23552
v_exp_f32 v144, v144
v_mfma_f32_32x32x16_bf16 a[32:47], a[216:219], v[88:91], a[32:47]
ds_read_b128 a[160:163], v10 offset:24576
buffer_load_dwordx4 v12, s[52:55], s71 offen offset:0 sc1 lds
v_exp_f32 v145, v145
v_exp_f32 v146, v146
v_mfma_f32_32x32x16_bf16 a[48:63], a[220:223], v[88:91], a[48:63]
ds_read_b128 a[164:167], v10 offset:25600
ds_read_b128 a[168:171], v10 offset:26624
v_add_f32 v2, v2, v144
v_exp_f32 v147, v147
v_add_f32 v3, v3, v145
v_mfma_f32_32x32x16_bf16 a[0:15], a[224:227], v[112:115], a[0:15]
ds_read_b128 a[172:175], v10 offset:27648
buffer_load_dwordx4 v12, s[52:55], s71 offen offset:1024 sc1 lds
v_cvt_pk_bf16_f32 v144, v144, v145
v_exp_f32 v148, v148
v_add_f32 v2, v2, v146
v_mfma_f32_32x32x16_bf16 a[16:31], a[228:231], v[112:115], a[16:31]
ds_read_b128 a[176:179], v10 offset:28672
ds_read_b128 a[180:183], v10 offset:29696
v_exp_f32 v149, v149
v_add_f32 v3, v3, v147
v_cvt_pk_bf16_f32 v145, v146, v147
v_mfma_f32_32x32x16_bf16 a[32:47], a[232:235], v[112:115], a[32:47]
ds_read_b128 a[184:187], v10 offset:30720
buffer_load_dwordx4 v12, s[52:55], s71 offen offset:2048 sc1 lds
v_exp_f32 v150, v150
v_add_f32 v2, v2, v148
v_mfma_f32_32x32x16_bf16 a[48:63], a[236:239], v[112:115], a[48:63]
ds_read_b128 a[188:191], v10 offset:31744
v_exp_f32 v151, v151
v_add_f32 v3, v3, v149
v_cvt_pk_bf16_f32 v146, v148, v149
v_mfma_f32_32x32x16_bf16 a[0:15], a[240:243], v[120:123], a[0:15]
buffer_load_dwordx4 v12, s[52:55], s71 offen offset:3072 sc1 lds
v_exp_f32 v152, v152
v_add_f32 v2, v2, v150
v_exp_f32 v153, v153
v_mfma_f32_32x32x16_bf16 a[16:31], a[244:247], v[120:123], a[16:31]
v_add_f32 v3, v3, v151
v_cvt_pk_bf16_f32 v147, v150, v151
v_exp_f32 v154, v154
v_add_f32 v2, v2, v152
v_mfma_f32_32x32x16_bf16 a[32:47], a[248:251], v[120:123], a[32:47]
s_sub_u32 s74, s74, 1
v_exp_f32 v155, v155
v_add_f32 v3, v3, v153
v_cvt_pk_bf16_f32 v152, v152, v153
v_mfma_f32_32x32x16_bf16 a[48:63], a[252:255], v[120:123], a[48:63]
v_add_f32 v2, v2, v154
v_add_f32 v3, v3, v155
v_cvt_pk_bf16_f32 v153, v154, v155
L_p3_s0_end:
s_cbranch_scc1 L_p3_s1m_top
s_waitcnt lgkmcnt(0)
v_xor_b32 v11, 0x8000, v11
v_mfma_f32_32x32x16_bf16 v[80:95], a[128:131], v[16:19], v[208:223]
s_add_u32 m0, s73, 16384
ds_read_b128 a[192:195], v11 offset:0
ds_read_b128 a[196:199], v11 offset:1024
v_exp_f32 v156, v156
v_mfma_f32_32x32x16_bf16 v[80:95], a[132:135], v[20:23], v[80:95]
ds_read_b128 a[200:203], v11 offset:2048
buffer_load_dwordx4 v12, s[56:59], s71 offen offset:0 sc1 lds
v_exp_f32 v157, v157
v_exp_f32 v158, v158
v_mfma_f32_32x32x16_bf16 v[80:95], a[136:139], v[24:27], v[80:95]
ds_read_b128 a[204:207], v11 offset:3072
ds_read_b128 a[208:211], v11 offset:4096
v_add_f32 v2, v2, v156
v_exp_f32 v159, v159
v_add_f32 v3, v3, v157
v_mfma_f32_32x32x16_bf16 v[80:95], a[140:143], v[28:31], v[80:95]
ds_read_b128 a[212:215], v11 offset:5120
buffer_load_dwordx4 v12, s[56:59], s71 offen offset:1024 sc1 lds
v_cvt_pk_bf16_f32 v154, v156, v157
v_exp_f32 v176, v176
v_add_f32 v2, v2, v158
v_mfma_f32_32x32x16_bf16 v[80:95], a[144:147], v[32:35], v[80:95]
ds_read_b128 a[216:219], v11 offset:6144
ds_read_b128 a[220:223], v11 offset:7168
v_exp_f32 v177, v177
v_add_f32 v3, v3, v159
v_cvt_pk_bf16_f32 v155, v158, v159
v_mfma_f32_32x32x16_bf16 v[80:95], a[148:151], v[36:39], v[80:95]
ds_read_b128 a[224:227], v11 offset:8192
v_exp_f32 v178, v178
v_add_f32 v2, v2, v176
v_exp_f32 v179, v179
v_mfma_f32_32x32x16_bf16 v[80:95], a[152:155], v[40:43], v[80:95]
ds_read_b128 a[228:231], v11 offset:9216
ds_read_b128 a[232:235], v11 offset:10240
buffer_load_dwordx4 v12, s[56:59], s71 offen offset:2048 sc1 lds
v_add_f32 v3, v3, v177
v_cvt_pk_bf16_f32 v176, v176, v177
v_mfma_f32_32x32x16_bf16 v[80:95], a[156:159], v[44:47], v[80:95]
ds_read_b128 a[236:239], v11 offset:11264
v_exp_f32 v180, v180
v_add_f32 v2, v2, v178
v_exp_f32 v181, v181
v_mfma_f32_32x32x16_bf16 v[112:127], a[160:163], v[16:19], v[208:223]
ds_read_b128 a[240:243], v11 offset:12288
ds_read_b128 a[244:247], v11 offset:13312
buffer_load_dwordx4 v12, s[56:59], s71 offen offset:3072 sc1 lds
v_add_f32 v3, v3, v179
v_cvt_pk_bf16_f32 v177, v178, v179
v_mfma_f32_32x32x16_bf16 v[112:127], a[164:167], v[20:23], v[112:127]
ds_read_b128 a[248:251], v11 offset:14336
v_exp_f32 v182, v182
v_add_f32 v2, v2, v180
v_exp_f32 v183, v183
v_mfma_f32_32x32x16_bf16 v[112:127], a[168:171], v[24:27], v[112:127]
ds_read_b128 a[252:255], v11 offset:15360
v_add_f32 v3, v3, v181
v_cvt_pk_bf16_f32 v178, v180, v181
v_exp_f32 v184, v184
v_add_f32 v2, v2, v182
v_mfma_f32_32x32x16_bf16 v[112:127], a[172:175], v[28:31], v[112:127]
s_add_u32 s71, s71, 16384
v_exp_f32 v185, v185
v_add_f32 v3, v3, v183
v_cvt_pk_bf16_f32 v179, v182, v183
v_mfma_f32_32x32x16_bf16 v[112:127], a[176:179], v[32:35], v[112:127]
v_exp_f32 v186, v186
v_add_f32 v2, v2, v184
v_exp_f32 v187, v187
v_add_f32 v3, v3, v185
v_mfma_f32_32x32x16_bf16 v[112:127], a[180:183], v[36:39], v[112:127]
s_xor_b32 s73, s73, 0x8000
v_cvt_pk_bf16_f32 v184, v184, v185
v_exp_f32 v188, v188
v_add_f32 v2, v2, v186
v_mfma_f32_32x32x16_bf16 v[112:127], a[184:187], v[40:43], v[112:127]
v_exp_f32 v189, v189
v_add_f32 v3, v3, v187
v_cvt_pk_bf16_f32 v185, v186, v187
v_exp_f32 v190, v190
v_mfma_f32_32x32x16_bf16 v[112:127], a[188:191], v[44:47], v[112:127]
v_add_f32 v2, v2, v188
v_exp_f32 v191, v191
v_add_f32 v3, v3, v189
v_cvt_pk_bf16_f32 v186, v188, v189
v_add_f32 v2, v2, v190
v_add_f32 v3, v3, v191
v_cvt_pk_bf16_f32 v187, v190, v191
s_waitcnt vmcnt(16) lgkmcnt(0)
v_mfma_f32_32x32x16_bf16 a[0:15], a[192:195], v[144:147], a[0:15]
s_barrier
v_xor_b32 v10, 0x8000, v10
v_mfma_f32_32x32x16_bf16 a[16:31], a[196:199], v[144:147], a[16:31]
ds_read_b128 a[128:131], v10 offset:0
ds_read_b128 a[132:135], v10 offset:1024
v_max3_f32 v6, v80, v81, v82
v_max3_f32 v6, v6, v83, v84
v_max3_f32 v6, v6, v85, v86
v_max3_f32 v6, v6, v87, v88
v_mfma_f32_32x32x16_bf16 a[32:47], a[200:203], v[144:147], a[32:47]
ds_read_b128 a[136:139], v10 offset:2048
v_max3_f32 v6, v6, v89, v90
v_max3_f32 v6, v6, v91, v92
v_max3_f32 v6, v6, v93, v94
v_max3_f32 v6, v6, v95, v112
v_max3_f32 v6, v6, v113, v114
v_mfma_f32_32x32x16_bf16 a[48:63], a[204:207], v[144:147], a[48:63]
ds_read_b128 a[140:143], v10 offset:3072
ds_read_b128 a[144:147], v10 offset:4096
v_max3_f32 v6, v6, v115, v116
v_max3_f32 v6, v6, v117, v118
v_max3_f32 v6, v6, v119, v120
v_max3_f32 v6, v6, v121, v122
v_mfma_f32_32x32x16_bf16 a[0:15], a[208:211], v[152:155], a[0:15]
ds_read_b128 a[148:151], v10 offset:5120
v_max3_f32 v6, v6, v123, v124
v_max3_f32 v6, v6, v125, v126
v_max_f32 v6, v6, v127
v_cmp_lt_f32 vcc, s79, v6
v_mfma_f32_32x32x16_bf16 a[16:31], a[212:215], v[152:155], a[16:31]
s_cbranch_vccnz L_p3_s1_rare
s_add_u32 m0, s72, 16384
ds_read_b128 a[152:155], v10 offset:6144
ds_read_b128 a[156:159], v10 offset:7168
v_exp_f32 v80, v80
v_mfma_f32_32x32x16_bf16 a[32:47], a[216:219], v[152:155], a[32:47]
ds_read_b128 a[160:163], v10 offset:8192
buffer_load_dwordx4 v12, s[52:55], s71 offen offset:0 sc1 lds
v_exp_f32 v81, v81
v_exp_f32 v82, v82
v_mfma_f32_32x32x16_bf16 a[48:63], a[220:223], v[152:155], a[48:63]
ds_read_b128 a[164:167], v10 offset:9216
ds_read_b128 a[168:171], v10 offset:10240
buffer_load_dwordx4 v12, s[52:55], s71 offen offset:1024 sc1 lds
v_add_f32 v2, v2, v80
v_exp_f32 v83, v83
v_mfma_f32_32x32x16_bf16 a[0:15], a[224:227], v[176:179], a[0:15]
ds_read_b128 a[172:175], v10 offset:11264
v_add_f32 v3, v3, v81
v_cvt_pk_bf16_f32 v80, v80, v81
v_exp_f32 v84, v84
v_add_f32 v2, v2, v82
v_mfma_f32_32x32x16_bf16 a[16:31], a[228:231], v[176:179], a[16:31]
ds_read_b128 a[176:179], v10 offset:12288
ds_read_b128 a[180:183], v10 offset:13312
buffer_load_dwordx4 v12, s[52:55], s71 offen offset:2048 sc1 lds
v_exp_f32 v85, v85
v_add_f32 v3, v3, v83
v_mfma_f32_32x32x16_bf16 a[32:47], a[232:235], v[176:179], a[32:47]
ds_read_b128 a[184:187], v10 offset:14336
v_cvt_pk_bf16_f32 v81, v82, v83
v_exp_f32 v86, v86
v_add_f32 v2, v2, v84
v_mfma_f32_32x32x16_bf16 a[48:63], a[236:239], v[176:179], a[48:63]
ds_read_b128 a[188:191], v10 offset:15360
buffer_load_dwordx4 v12, s[52:55], s71 offen offset:3072 sc1 lds
v_exp_f32 v87, v87
v_add_f32 v3, v3, v85
v_cvt_pk_bf16_f32 v82, v84, v85
v_mfma_f32_32x32x16_bf16 a[0:15], a[240:243], v[184:187], a[0:15]
s_xor_b32 s72, s72, 0x8000
v_exp_f32 v88, v88
v_add_f32 v2, v2, v86
v_exp_f32 v89, v89
v_mfma_f32_32x32x16_bf16 a[16:31], a[244:247], v[184:187], a[16:31]
v_add_f32 v3, v3, v87
v_cvt_pk_bf16_f32 v83, v86, v87
v_exp_f32 v90, v90
v_add_f32 v2, v2, v88
v_mfma_f32_32x32x16_bf16 a[32:47], a[248:251], v[184:187], a[32:47]
buffer_store_dword v77, v76, s[8:11], s37 offen offset:1024 sc1
v_exp_f32 v91, v91
v_add_f32 v3, v3, v89
v_cvt_pk_bf16_f32 v88, v88, v89
v_mfma_f32_32x32x16_bf16 a[48:63], a[252:255], v[184:187], a[48:63]
v_add_f32 v2, v2, v90
v_add_f32 v3, v3, v91
v_cvt_pk_bf16_f32 v89, v90, v91
L_p3_s1_end:
s_branch L_p3_s0_top
L_p3_s1m_top:
s_waitcnt lgkmcnt(0)
v_xor_b32 v11, 0x8000, v11
v_mfma_f32_32x32x16_bf16 v[80:95], a[128:131], v[16:19], v[208:223]
s_add_u32 m0, s73, 16384
ds_read_b128 a[192:195], v11 offset:0
ds_read_b128 a[196:199], v11 offset:1024
v_exp_f32 v156, v156
v_mfma_f32_32x32x16_bf16 v[80:95], a[132:135], v[20:23], v[80:95]
ds_read_b128 a[200:203], v11 offset:2048
buffer_load_dwordx4 v12, s[56:59], s71 offen offset:0 sc1 lds
v_exp_f32 v157, v157
v_exp_f32 v158, v158
v_mfma_f32_32x32x16_bf16 v[80:95], a[136:139], v[24:27], v[80:95]
ds_read_b128 a[204:207], v11 offset:3072
ds_read_b128 a[208:211], v11 offset:4096
v_add_f32 v2, v2, v156
v_exp_f32 v159, v159
v_add_f32 v3, v3, v157
v_mfma_f32_32x32x16_bf16 v[80:95], a[140:143], v[28:31], v[80:95]
ds_read_b128 a[212:215], v11 offset:5120
buffer_load_dwordx4 v12, s[56:59], s71 offen offset:1024 sc1 lds
v_cvt_pk_bf16_f32 v154, v156, v157
v_exp_f32 v176, v176
v_add_f32 v2, v2, v158
v_mfma_f32_32x32x16_bf16 v[80:95], a[144:147], v[32:35], v[80:95]
ds_read_b128 a[216:219], v11 offset:6144
ds_read_b128 a[220:223], v11 offset:7168
v_exp_f32 v177, v177
v_add_f32 v3, v3, v159
v_cvt_pk_bf16_f32 v155, v158, v159
v_mfma_f32_32x32x16_bf16 v[80:95], a[148:151], v[36:39], v[80:95]
ds_read_b128 a[224:227], v11 offset:8192
v_exp_f32 v178, v178
v_add_f32 v2, v2, v176
v_exp_f32 v179, v179
v_mfma_f32_32x32x16_bf16 v[80:95], a[152:155], v[40:43], v[80:95]
ds_read_b128 a[228:231], v11 offset:9216
ds_read_b128 a[232:235], v11 offset:10240
buffer_load_dwordx4 v12, s[56:59], s71 offen offset:2048 sc1 lds
v_add_f32 v3, v3, v177
v_cvt_pk_bf16_f32 v176, v176, v177
v_mfma_f32_32x32x16_bf16 v[80:95], a[156:159], v[44:47], v[80:95]
ds_read_b128 a[236:239], v11 offset:11264
v_exp_f32 v180, v180
v_add_f32 v2, v2, v178
v_exp_f32 v181, v181
v_mfma_f32_32x32x16_bf16 v[112:127], a[160:163], v[16:19], v[208:223]
ds_read_b128 a[240:243], v11 offset:12288
ds_read_b128 a[244:247], v11 offset:13312
buffer_load_dwordx4 v12, s[56:59], s71 offen offset:3072 sc1 lds
v_add_f32 v3, v3, v179
v_cvt_pk_bf16_f32 v177, v178, v179
v_mfma_f32_32x32x16_bf16 v[112:127], a[164:167], v[20:23], v[112:127]
ds_read_b128 a[248:251], v11 offset:14336
v_exp_f32 v182, v182
v_add_f32 v2, v2, v180
v_exp_f32 v183, v183
v_mfma_f32_32x32x16_bf16 v[112:127], a[168:171], v[24:27], v[112:127]
ds_read_b128 a[252:255], v11 offset:15360
v_add_f32 v3, v3, v181
v_cvt_pk_bf16_f32 v178, v180, v181
v_exp_f32 v184, v184
v_add_f32 v2, v2, v182
v_mfma_f32_32x32x16_bf16 v[112:127], a[172:175], v[28:31], v[112:127]
s_add_u32 s71, s71, 16384
v_exp_f32 v185, v185
v_add_f32 v3, v3, v183
v_cvt_pk_bf16_f32 v179, v182, v183
v_add_u32 v246, 0, v13
v_mfma_f32_32x32x16_bf16 v[112:127], a[176:179], v[32:35], v[112:127]
v_exp_f32 v186, v186
v_add_f32 v2, v2, v184
v_exp_f32 v187, v187
v_add_f32 v3, v3, v185
v_mfma_f32_32x32x16_bf16 v[112:127], a[180:183], v[36:39], v[112:127]
s_xor_b32 s73, s73, 0x8000
v_cvt_pk_bf16_f32 v184, v184, v185
v_cmp_gt_i32_e64 s[84:85], 0, v246
v_cmp_gt_i32_e64 s[86:87], 1, v246
v_cmp_gt_i32_e64 s[88:89], 2, v246
v_cmp_gt_i32_e64 s[90:91], 3, v246
v_mfma_f32_32x32x16_bf16 v[112:127], a[184:187], v[40:43], v[112:127]
v_cndmask_b32_e64 v80, v80, v14, s[84:85]
v_cndmask_b32_e64 v81, v81, v14, s[86:87]
v_exp_f32 v188, v188
v_add_f32 v2, v2, v186
v_cndmask_b32_e64 v82, v82, v14, s[88:89]
v_mfma_f32_32x32x16_bf16 v[112:127], a[188:191], v[44:47], v[112:127]
v_exp_f32 v189, v189
v_cndmask_b32_e64 v83, v83, v14, s[90:91]
v_cmp_gt_i32_e64 s[92:93], 16, v246
v_cmp_gt_i32_e64 s[94:95], 17, v246
v_cmp_gt_i32_e64 s[96:97], 18, v246
v_cmp_gt_i32_e64 s[98:99], 19, v246
v_cndmask_b32_e64 v84, v84, v14, s[92:93]
v_add_f32 v3, v3, v187
v_cvt_pk_bf16_f32 v185, v186, v187
v_exp_f32 v190, v190
v_cndmask_b32_e64 v85, v85, v14, s[94:95]
v_cndmask_b32_e64 v86, v86, v14, s[96:97]
v_cndmask_b32_e64 v87, v87, v14, s[98:99]
v_cmp_gt_i32_e64 s[84:85], 8, v246
v_cmp_gt_i32_e64 s[86:87], 9, v246
v_cmp_gt_i32_e64 s[88:89], 10, v246
v_add_f32 v2, v2, v188
v_exp_f32 v191, v191
v_add_f32 v3, v3, v189
v_cmp_gt_i32_e64 s[90:91], 11, v246
v_cndmask_b32_e64 v88, v88, v14, s[84:85]
v_cndmask_b32_e64 v89, v89, v14, s[86:87]
v_cndmask_b32_e64 v90, v90, v14, s[88:89]
v_cndmask_b32_e64 v91, v91, v14, s[90:91]
v_cmp_gt_i32_e64 s[92:93], 24, v246
v_cmp_gt_i32_e64 s[94:95], 25, v246
v_cvt_pk_bf16_f32 v186, v188, v189
v_add_f32 v2, v2, v190
v_add_f32 v3, v3, v191
v_cvt_pk_bf16_f32 v187, v190, v191
v_cmp_gt_i32_e64 s[96:97], 26, v246
v_cmp_gt_i32_e64 s[98:99], 27, v246
v_cndmask_b32_e64 v92, v92, v14, s[92:93]
v_cndmask_b32_e64 v93, v93, v14, s[94:95]
v_cndmask_b32_e64 v94, v94, v14, s[96:97]
v_cndmask_b32_e64 v95, v95, v14, s[98:99]
s_waitcnt vmcnt(16) lgkmcnt(0)
v_mfma_f32_32x32x16_bf16 a[0:15], a[192:195], v[144:147], a[0:15]
s_barrier
v_xor_b32 v10, 0x8000, v10
v_mfma_f32_32x32x16_bf16 a[16:31], a[196:199], v[144:147], a[16:31]
ds_read_b128 a[128:131], v10 offset:0
ds_read_b128 a[132:135], v10 offset:1024
v_max3_f32 v6, v80, v81, v82
v_max3_f32 v6, v6, v83, v84
v_max3_f32 v6, v6, v85, v86
v_max3_f32 v6, v6, v87, v88
v_mfma_f32_32x32x16_bf16 a[32:47], a[200:203], v[144:147], a[32:47]
ds_read_b128 a[136:139], v10 offset:2048
ds_read_b128 a[140:143], v10 offset:3072
v_max3_f32 v6, v6, v89, v90
v_max3_f32 v6, v6, v91, v92
v_max3_f32 v6, v6, v93, v94
v_add_u32 v247, -32, v13
v_mfma_f32_32x32x16_bf16 a[48:63], a[204:207], v[144:147], a[48:63]
ds_read_b128 a[144:147], v10 offset:4096
v_cmp_gt_i32_e64 s[84:85], 0, v247
v_cmp_gt_i32_e64 s[86:87], 1, v247
v_cmp_gt_i32_e64 s[88:89], 2, v247
v_cmp_gt_i32_e64 s[90:91], 3, v247
v_cndmask_b32_e64 v112, v112, v14, s[84:85]
v_mfma_f32_32x32x16_bf16 a[0:15], a[208:211], v[152:155], a[0:15]
ds_read_b128 a[148:151], v10 offset:5120
ds_read_b128 a[152:155], v10 offset:6144
v_cndmask_b32_e64 v113, v113, v14, s[86:87]
v_cndmask_b32_e64 v114, v114, v14, s[88:89]
v_cndmask_b32_e64 v115, v115, v14, s[90:91]
v_cmp_gt_i32_e64 s[92:93], 16, v247
v_mfma_f32_32x32x16_bf16 a[16:31], a[212:215], v[152:155], a[16:31]
ds_read_b128 a[156:159], v10 offset:7168
v_cmp_gt_i32_e64 s[94:95], 17, v247
v_cmp_gt_i32_e64 s[96:97], 18, v247
v_cmp_gt_i32_e64 s[98:99], 19, v247
v_cndmask_b32_e64 v116, v116, v14, s[92:93]
v_cndmask_b32_e64 v117, v117, v14, s[94:95]
v_mfma_f32_32x32x16_bf16 a[32:47], a[216:219], v[152:155], a[32:47]
ds_read_b128 a[160:163], v10 offset:8192
ds_read_b128 a[164:167], v10 offset:9216
v_cndmask_b32_e64 v118, v118, v14, s[96:97]
v_cndmask_b32_e64 v119, v119, v14, s[98:99]
v_cmp_gt_i32_e64 s[84:85], 8, v247
v_cmp_gt_i32_e64 s[86:87], 9, v247
v_mfma_f32_32x32x16_bf16 a[48:63], a[220:223], v[152:155], a[48:63]
ds_read_b128 a[168:171], v10 offset:10240
ds_read_b128 a[172:175], v10 offset:11264
v_cmp_gt_i32_e64 s[88:89], 10, v247
v_cmp_gt_i32_e64 s[90:91], 11, v247
v_cndmask_b32_e64 v120, v120, v14, s[84:85]
v_cndmask_b32_e64 v121, v121, v14, s[86:87]
v_mfma_f32_32x32x16_bf16 a[0:15], a[224:227], v[176:179], a[0:15]
ds_read_b128 a[176:179], v10 offset:12288
v_cndmask_b32_e64 v122, v122, v14, s[88:89]
v_cndmask_b32_e64 v123, v123, v14, s[90:91]
v_cmp_gt_i32_e64 s[92:93], 24, v247
v_cmp_gt_i32_e64 s[94:95], 25, v247
v_cmp_gt_i32_e64 s[96:97], 26, v247
v_mfma_f32_32x32x16_bf16 a[16:31], a[228:231], v[176:179], a[16:31]
ds_read_b128 a[180:183], v10 offset:13312
ds_read_b128 a[184:187], v10 offset:14336
v_cmp_gt_i32_e64 s[98:99], 27, v247
v_cndmask_b32_e64 v124, v124, v14, s[92:93]
v_cndmask_b32_e64 v125, v125, v14, s[94:95]
v_cndmask_b32_e64 v126, v126, v14, s[96:97]
v_mfma_f32_32x32x16_bf16 a[32:47], a[232:235], v[176:179], a[32:47]
ds_read_b128 a[188:191], v10 offset:15360
v_cndmask_b32_e64 v127, v127, v14, s[98:99]
v_max3_f32 v6, v6, v95, v112
v_max3_f32 v6, v6, v113, v114
v_max3_f32 v6, v6, v115, v116
v_max3_f32 v6, v6, v117, v118
v_max3_f32 v6, v6, v119, v120
v_max3_f32 v6, v6, v121, v122
v_max3_f32 v6, v6, v123, v124
v_max3_f32 v6, v6, v125, v126
v_max_f32 v6, v6, v127
v_cmp_lt_f32 vcc, s79, v6
v_mfma_f32_32x32x16_bf16 a[48:63], a[236:239], v[176:179], a[48:63]
s_cbranch_vccnz L_p3_s1m_rare
s_add_u32 m0, s72, 16384
v_exp_f32 v80, v80
v_exp_f32 v81, v81
v_mfma_f32_32x32x16_bf16 a[0:15], a[240:243], v[184:187], a[0:15]
buffer_load_dwordx4 v12, s[52:55], s71 offen offset:0 sc1 lds
buffer_load_dwordx4 v12, s[52:55], s71 offen offset:1024 sc1 lds
v_exp_f32 v82, v82
v_add_f32 v2, v2, v80
v_mfma_f32_32x32x16_bf16 a[16:31], a[244:247], v[184:187], a[16:31]
buffer_load_dwordx4 v12, s[52:55], s71 offen offset:2048 sc1 lds
v_exp_f32 v83, v83
v_add_f32 v3, v3, v81
v_cvt_pk_bf16_f32 v80, v80, v81
v_mfma_f32_32x32x16_bf16 a[32:47], a[248:251], v[184:187], a[32:47]
buffer_load_dwordx4 v12, s[52:55], s71 offen offset:3072 sc1 lds
v_exp_f32 v84, v84
v_add_f32 v2, v2, v82
v_exp_f32 v85, v85
v_mfma_f32_32x32x16_bf16 a[48:63], a[252:255], v[184:187], a[48:63]
s_xor_b32 s72, s72, 0x8000
v_add_f32 v3, v3, v83
v_cvt_pk_bf16_f32 v81, v82, v83
v_exp_f32 v86, v86
v_add_f32 v2, v2, v84
v_exp_f32 v87, v87
v_add_f32 v3, v3, v85
v_cvt_pk_bf16_f32 v82, v84, v85
v_exp_f32 v88, v88
v_add_f32 v2, v2, v86
v_exp_f32 v89, v89
v_add_f32 v3, v3, v87
v_cvt_pk_bf16_f32 v83, v86, v87
v_exp_f32 v90, v90
v_add_f32 v2, v2, v88
v_exp_f32 v91, v91
v_add_f32 v3, v3, v89
v_cvt_pk_bf16_f32 v88, v88, v89
v_add_f32 v2, v2, v90
v_add_f32 v3, v3, v91
v_cvt_pk_bf16_f32 v89, v90, v91
L_p3_s1m_end:
L_p3_s0m_top:
s_waitcnt lgkmcnt(0)
v_mfma_f32_32x32x16_bf16 v[144:159], a[128:131], v[16:19], v[208:223]
s_add_u32 m0, s73, 0
ds_read_b128 a[192:195], v11 offset:16384
ds_read_b128 a[196:199], v11 offset:17408
v_exp_f32 v92, v92
v_mfma_f32_32x32x16_bf16 v[144:159], a[132:135], v[20:23], v[144:159]
ds_read_b128 a[200:203], v11 offset:18432
buffer_load_dwordx4 v12, s[56:59], s71 offen offset:0 sc1 lds
v_exp_f32 v93, v93
v_exp_f32 v94, v94
v_mfma_f32_32x32x16_bf16 v[144:159], a[136:139], v[24:27], v[144:159]
ds_read_b128 a[204:207], v11 offset:19456
ds_read_b128 a[208:211], v11 offset:20480
v_add_f32 v2, v2, v92
v_exp_f32 v95, v95
v_add_f32 v3, v3, v93
v_mfma_f32_32x32x16_bf16 v[144:159], a[140:143], v[28:31], v[144:159]
ds_read_b128 a[212:215], v11 offset:21504
v_cvt_pk_bf16_f32 v90, v92, v93
v_exp_f32 v112, v112
v_add_f32 v2, v2, v94
v_mfma_f32_32x32x16_bf16 v[144:159], a[144:147], v[32:35], v[144:159]
ds_read_b128 a[216:219], v11 offset:22528
ds_read_b128 a[220:223], v11 offset:23552
buffer_load_dwordx4 v12, s[56:59], s71 offen offset:1024 sc1 lds
v_exp_f32 v113, v113
v_add_f32 v3, v3, v95
v_mfma_f32_32x32x16_bf16 v[144:159], a[148:151], v[36:39], v[144:159]
ds_read_b128 a[224:227], v11 offset:24576
v_cvt_pk_bf16_f32 v91, v94, v95
v_exp_f32 v114, v114
v_add_f32 v2, v2, v112
v_mfma_f32_32x32x16_bf16 v[144:159], a[152:155], v[40:43], v[144:159]
ds_read_b128 a[228:231], v11 offset:25600
ds_read_b128 a[232:235], v11 offset:26624
v_exp_f32 v115, v115
v_add_f32 v3, v3, v113
v_cvt_pk_bf16_f32 v112, v112, v113
v_mfma_f32_32x32x16_bf16 v[144:159], a[156:159], v[44:47], v[144:159]
ds_read_b128 a[236:239], v11 offset:27648
buffer_load_dwordx4 v12, s[56:59], s71 offen offset:2048 sc1 lds
v_exp_f32 v116, v116
v_add_f32 v2, v2, v114
v_mfma_f32_32x32x16_bf16 v[176:191], a[160:163], v[16:19], v[208:223]
ds_read_b128 a[240:243], v11 offset:28672
ds_read_b128 a[244:247], v11 offset:29696
v_exp_f32 v117, v117
v_add_f32 v3, v3, v115
v_cvt_pk_bf16_f32 v113, v114, v115
v_mfma_f32_32x32x16_bf16 v[176:191], a[164:167], v[20:23], v[176:191]
ds_read_b128 a[248:251], v11 offset:30720
v_exp_f32 v118, v118
v_add_f32 v2, v2, v116
v_exp_f32 v119, v119
v_mfma_f32_32x32x16_bf16 v[176:191], a[168:171], v[24:27], v[176:191]
ds_read_b128 a[252:255], v11 offset:31744
buffer_load_dwordx4 v12, s[56:59], s71 offen offset:3072 sc1 lds
v_add_f32 v3, v3, v117
v_cvt_pk_bf16_f32 v114, v116, v117
v_exp_f32 v120, v120
v_mfma_f32_32x32x16_bf16 v[176:191], a[172:175], v[28:31], v[176:191]
v_add_f32 v2, v2, v118
v_exp_f32 v121, v121
v_add_f32 v3, v3, v119
v_cvt_pk_bf16_f32 v115, v118, v119
v_add_u32 v246, -64, v13
v_mfma_f32_32x32x16_bf16 v[176:191], a[176:179], v[32:35], v[176:191]
v_exp_f32 v122, v122
v_add_f32 v2, v2, v120
v_exp_f32 v123, v123
v_add_f32 v3, v3, v121
v_mfma_f32_32x32x16_bf16 v[176:191], a[180:183], v[36:39], v[176:191]
s_add_u32 s71, s71, 16384
v_cvt_pk_bf16_f32 v120, v120, v121
v_cmp_gt_i32_e64 s[84:85], 0, v246
v_cmp_gt_i32_e64 s[86:87], 1, v246
v_cmp_gt_i32_e64 s[88:89], 2, v246
v_cmp_gt_i32_e64 s[90:91], 3, v246
v_mfma_f32_32x32x16_bf16 v[176:191], a[184:187], v[40:43], v[176:191]
v_cndmask_b32_e64 v144, v144, v14, s[84:85]
v_cndmask_b32_e64 v145, v145, v14, s[86:87]
v_exp_f32 v124, v124
v_add_f32 v2, v2, v122
v_cndmask_b32_e64 v146, v146, v14, s[88:89]
v_mfma_f32_32x32x16_bf16 v[176:191], a[188:191], v[44:47], v[176:191]
v_exp_f32 v125, v125
v_cndmask_b32_e64 v147, v147, v14, s[90:91]
v_cmp_gt_i32_e64 s[92:93], 16, v246
v_cmp_gt_i32_e64 s[94:95], 17, v246
v_cmp_gt_i32_e64 s[96:97], 18, v246
v_cmp_gt_i32_e64 s[98:99], 19, v246
v_cndmask_b32_e64 v148, v148, v14, s[92:93]
v_add_f32 v3, v3, v123
v_cvt_pk_bf16_f32 v121, v122, v123
v_exp_f32 v126, v126
v_cndmask_b32_e64 v149, v149, v14, s[94:95]
v_cndmask_b32_e64 v150, v150, v14, s[96:97]
v_cndmask_b32_e64 v151, v151, v14, s[98:99]
v_cmp_gt_i32_e64 s[84:85], 8, v246
v_cmp_gt_i32_e64 s[86:87], 9, v246
v_cmp_gt_i32_e64 s[88:89], 10, v246
v_add_f32 v2, v2, v124
v_exp_f32 v127, v127
v_add_f32 v3, v3, v125
v_cmp_gt_i32_e64 s[90:91], 11, v246
v_cndmask_b32_e64 v152, v152, v14, s[84:85]
v_cndmask_b32_e64 v153, v153, v14, s[86:87]
v_cndmask_b32_e64 v154, v154, v14, s[88:89]
v_cndmask_b32_e64 v155, v155, v14, s[90:91]
v_cmp_gt_i32_e64 s[92:93], 24, v246
v_cmp_gt_i32_e64 s[94:95], 25, v246
v_cvt_pk_bf16_f32 v122, v124, v125
v_add_f32 v2, v2, v126
v_add_f32 v3, v3, v127
v_cvt_pk_bf16_f32 v123, v126, v127
v_cmp_gt_i32_e64 s[96:97], 26, v246
v_cmp_gt_i32_e64 s[98:99], 27, v246
v_cndmask_b32_e64 v156, v156, v14, s[92:93]
v_cndmask_b32_e64 v157, v157, v14, s[94:95]
v_cndmask_b32_e64 v158, v158, v14, s[96:97]
v_cndmask_b32_e64 v159, v159, v14, s[98:99]
s_waitcnt vmcnt(16) lgkmcnt(0)
v_mfma_f32_32x32x16_bf16 a[0:15], a[192:195], v[80:83], a[0:15]
s_barrier
v_mfma_f32_32x32x16_bf16 a[16:31], a[196:199], v[80:83], a[16:31]
ds_read_b128 a[128:131], v10 offset:16384
ds_read_b128 a[132:135], v10 offset:17408
v_max3_f32 v6, v144, v145, v146
v_max3_f32 v6, v6, v147, v148
v_max3_f32 v6, v6, v149, v150
v_max3_f32 v6, v6, v151, v152
v_mfma_f32_32x32x16_bf16 a[32:47], a[200:203], v[80:83], a[32:47]
ds_read_b128 a[136:139], v10 offset:18432
ds_read_b128 a[140:143], v10 offset:19456
v_max3_f32 v6, v6, v153, v154
v_max3_f32 v6, v6, v155, v156
v_max3_f32 v6, v6, v157, v158
v_add_u32 v247, -96, v13
v_mfma_f32_32x32x16_bf16 a[48:63], a[204:207], v[80:83], a[48:63]
ds_read_b128 a[144:147], v10 offset:20480
v_cmp_gt_i32_e64 s[84:85], 0, v247
v_cmp_gt_i32_e64 s[86:87], 1, v247
v_cmp_gt_i32_e64 s[88:89], 2, v247
v_cmp_gt_i32_e64 s[90:91], 3, v247
v_cndmask_b32_e64 v176, v176, v14, s[84:85]
v_mfma_f32_32x32x16_bf16 a[0:15], a[208:211], v[88:91], a[0:15]
ds_read_b128 a[148:151], v10 offset:21504
ds_read_b128 a[152:155], v10 offset:22528
v_cndmask_b32_e64 v177, v177, v14, s[86:87]
v_cndmask_b32_e64 v178, v178, v14, s[88:89]
v_cndmask_b32_e64 v179, v179, v14, s[90:91]
v_cmp_gt_i32_e64 s[92:93], 16, v247
v_mfma_f32_32x32x16_bf16 a[16:31], a[212:215], v[88:91], a[16:31]
ds_read_b128 a[156:159], v10 offset:23552
v_cmp_gt_i32_e64 s[94:95], 17, v247
v_cmp_gt_i32_e64 s[96:97], 18, v247
v_cmp_gt_i32_e64 s[98:99], 19, v247
v_cndmask_b32_e64 v180, v180, v14, s[92:93]
v_cndmask_b32_e64 v181, v181, v14, s[94:95]
v_mfma_f32_32x32x16_bf16 a[32:47], a[216:219], v[88:91], a[32:47]
ds_read_b128 a[160:163], v10 offset:24576
ds_read_b128 a[164:167], v10 offset:25600
v_cndmask_b32_e64 v182, v182, v14, s[96:97]
v_cndmask_b32_e64 v183, v183, v14, s[98:99]
v_cmp_gt_i32_e64 s[84:85], 8, v247
v_cmp_gt_i32_e64 s[86:87], 9, v247
v_mfma_f32_32x32x16_bf16 a[48:63], a[220:223], v[88:91], a[48:63]
ds_read_b128 a[168:171], v10 offset:26624
ds_read_b128 a[172:175], v10 offset:27648
v_cmp_gt_i32_e64 s[88:89], 10, v247
v_cmp_gt_i32_e64 s[90:91], 11, v247
v_cndmask_b32_e64 v184, v184, v14, s[84:85]
v_cndmask_b32_e64 v185, v185, v14, s[86:87]
v_mfma_f32_32x32x16_bf16 a[0:15], a[224:227], v[112:115], a[0:15]
ds_read_b128 a[176:179], v10 offset:28672
v_cndmask_b32_e64 v186, v186, v14, s[88:89]
v_cndmask_b32_e64 v187, v187, v14, s[90:91]
v_cmp_gt_i32_e64 s[92:93], 24, v247
v_cmp_gt_i32_e64 s[94:95], 25, v247
v_cmp_gt_i32_e64 s[96:97], 26, v247
v_mfma_f32_32x32x16_bf16 a[16:31], a[228:231], v[112:115], a[16:31]
ds_read_b128 a[180:183], v10 offset:29696
ds_read_b128 a[184:187], v10 offset:30720
v_cmp_gt_i32_e64 s[98:99], 27, v247
v_cndmask_b32_e64 v188, v188, v14, s[92:93]
v_cndmask_b32_e64 v189, v189, v14, s[94:95]
v_cndmask_b32_e64 v190, v190, v14, s[96:97]
v_mfma_f32_32x32x16_bf16 a[32:47], a[232:235], v[112:115], a[32:47]
ds_read_b128 a[188:191], v10 offset:31744
v_cndmask_b32_e64 v191, v191, v14, s[98:99]
v_max3_f32 v6, v6, v159, v176
v_max3_f32 v6, v6, v177, v178
v_max3_f32 v6, v6, v179, v180
v_max3_f32 v6, v6, v181, v182
v_max3_f32 v6, v6, v183, v184
v_max3_f32 v6, v6, v185, v186
v_max3_f32 v6, v6, v187, v188
v_max3_f32 v6, v6, v189, v190
v_max_f32 v6, v6, v191
v_cmp_lt_f32 vcc, s79, v6
v_mfma_f32_32x32x16_bf16 a[48:63], a[236:239], v[112:115], a[48:63]
s_cbranch_vccnz L_p3_s0m_rare
s_add_u32 m0, s72, 0
v_exp_f32 v144, v144
v_exp_f32 v145, v145
v_mfma_f32_32x32x16_bf16 a[0:15], a[240:243], v[120:123], a[0:15]
buffer_load_dwordx4 v12, s[52:55], s71 offen offset:0 sc1 lds
buffer_load_dwordx4 v12, s[52:55], s71 offen offset:1024 sc1 lds
buffer_load_dwordx4 v12, s[52:55], s71 offen offset:2048 sc1 lds
v_exp_f32 v146, v146
v_add_f32 v2, v2, v144
v_mfma_f32_32x32x16_bf16 a[16:31], a[244:247], v[120:123], a[16:31]
buffer_load_dwordx4 v12, s[52:55], s71 offen offset:3072 sc1 lds
v_lshlrev_b32 v245, 4, v1
s_mov_b32 m0, s43
v_exp_f32 v147, v147
v_add_f32 v3, v3, v145
v_mfma_f32_32x32x16_bf16 a[32:47], a[248:251], v[120:123], a[32:47]
s_nop 0
buffer_load_dwordx4 v245, s[20:23], 0 offen offset:0 sc1 lds
buffer_load_dwordx4 v245, s[20:23], 0 offen offset:1024 sc1 lds
v_cvt_pk_bf16_f32 v144, v144, v145
v_exp_f32 v148, v148
v_mfma_f32_32x32x16_bf16 a[48:63], a[252:255], v[120:123], a[48:63]
buffer_load_dwordx4 v245, s[20:23], 0 offen offset:2048 sc1 lds
buffer_load_dwordx4 v245, s[20:23], 0 offen offset:3072 sc1 lds
v_add_f32 v2, v2, v146
v_exp_f32 v149, v149
v_add_f32 v3, v3, v147
v_cvt_pk_bf16_f32 v145, v146, v147
v_exp_f32 v150, v150
v_add_f32 v2, v2, v148
v_exp_f32 v151, v151
v_add_f32 v3, v3, v149
v_cvt_pk_bf16_f32 v146, v148, v149
v_exp_f32 v152, v152
v_add_f32 v2, v2, v150
v_exp_f32 v153, v153
v_add_f32 v3, v3, v151
v_cvt_pk_bf16_f32 v147, v150, v151
v_exp_f32 v154, v154
v_add_f32 v2, v2, v152
v_exp_f32 v155, v155
v_add_f32 v3, v3, v153
v_cvt_pk_bf16_f32 v152, v152, v153
v_add_f32 v2, v2, v154
v_add_f32 v3, v3, v155
v_cvt_pk_bf16_f32 v153, v154, v155
L_p3_s0m_end:
s_load_dwordx2 s[88:89], s[0:1], 104
s_waitcnt lgkmcnt(0)
v_xor_b32 v11, 0x8000, v11
ds_read_b128 a[192:195], v11 offset:0
ds_read_b128 a[196:199], v11 offset:1024
ds_read_b128 a[200:203], v11 offset:2048
ds_read_b128 a[204:207], v11 offset:3072
ds_read_b128 a[208:211], v11 offset:4096
ds_read_b128 a[212:215], v11 offset:5120
ds_read_b128 a[216:219], v11 offset:6144
ds_read_b128 a[220:223], v11 offset:7168
ds_read_b128 a[224:227], v11 offset:8192
ds_read_b128 a[228:231], v11 offset:9216
ds_read_b128 a[232:235], v11 offset:10240
ds_read_b128 a[236:239], v11 offset:11264
ds_read_b128 a[240:243], v11 offset:12288
ds_read_b128 a[244:247], v11 offset:13312
ds_read_b128 a[248:251], v11 offset:14336
ds_read_b128 a[252:255], v11 offset:15360
v_exp_f32 v156, v156
v_exp_f32 v157, v157
v_exp_f32 v158, v158
v_add_f32 v2, v2, v156
v_exp_f32 v159, v159
v_add_f32 v3, v3, v157
v_cvt_pk_bf16_f32 v154, v156, v157
v_exp_f32 v176, v176
v_add_f32 v2, v2, v158
v_exp_f32 v177, v177
v_add_f32 v3, v3, v159
v_cvt_pk_bf16_f32 v155, v158, v159
v_exp_f32 v178, v178
v_add_f32 v2, v2, v176
v_exp_f32 v179, v179
v_add_f32 v3, v3, v177
v_cvt_pk_bf16_f32 v176, v176, v177
v_exp_f32 v180, v180
v_add_f32 v2, v2, v178
v_exp_f32 v181, v181
v_add_f32 v3, v3, v179
v_cvt_pk_bf16_f32 v177, v178, v179
v_exp_f32 v182, v182
v_add_f32 v2, v2, v180
v_exp_f32 v183, v183
v_add_f32 v3, v3, v181
v_cvt_pk_bf16_f32 v178, v180, v181
v_exp_f32 v184, v184
v_add_f32 v2, v2, v182
v_exp_f32 v185, v185
v_add_f32 v3, v3, v183
v_cvt_pk_bf16_f32 v179, v182, v183
v_exp_f32 v186, v186
v_add_f32 v2, v2, v184
v_exp_f32 v187, v187
v_add_f32 v3, v3, v185
v_cvt_pk_bf16_f32 v184, v184, v185
v_exp_f32 v188, v188
v_add_f32 v2, v2, v186
v_exp_f32 v189, v189
v_add_f32 v3, v3, v187
v_cvt_pk_bf16_f32 v185, v186, v187
v_exp_f32 v190, v190
v_add_f32 v2, v2, v188
v_exp_f32 v191, v191
v_add_f32 v3, v3, v189
v_cvt_pk_bf16_f32 v186, v188, v189
v_add_f32 v2, v2, v190
v_add_f32 v3, v3, v191
v_cvt_pk_bf16_f32 v187, v190, v191
s_waitcnt vmcnt(0) lgkmcnt(0)
s_barrier
buffer_store_dword v77, v76, s[8:11], s37 offen offset:1024 sc1
v_mfma_f32_32x32x16_bf16 a[0:15], a[192:195], v[144:147], a[0:15]
s_mul_i32 s36, s3, 16640
v_and_b32 v16, 15, v1
v_lshrrev_b32 v17, 4, v1
v_add_u32 v18, 13, v16
v_and_b32 v19, 3, v18
v_cmp_eq_u32 vcc, 0, v19
v_mfma_f32_32x32x16_bf16 a[16:31], a[196:199], v[144:147], a[16:31]
v_lshrrev_b32 v18, 2, v18
v_mul_u32_u24 v19, 4160, v19
v_cndmask_b32 v19, v19, 8, vcc
v_lshl_add_u32 v19, v18, 3, v19
v_lshl_add_u32 v19, v17, 4, v19
v_add_u32 v4, s36, v19
v_mfma_f32_32x32x16_bf16 a[32:47], a[200:203], v[144:147], a[32:47]
v_add_u32 v6, s36, v72
v_lshlrev_b32 v18, 5, v16
v_lshlrev_b32 v19, 4, v17
v_sub_u32 v19, v19, v18
s_add_u32 s37, s43, 480
v_add_u32 v5, s37, v19
v_mfma_f32_32x32x16_bf16 a[48:63], a[204:207], v[144:147], a[48:63]
v_mul_u32_u24 v18, 136, v16
v_lshl_add_u32 v18, v17, 5, v18
s_lshl_b32 s37, s3, 1
s_add_u32 s37, s37, 49152
v_add_u32 v7, s37, v18
v_lshrrev_b32 v18, 3, v1
v_mfma_f32_32x32x16_bf16 a[0:15], a[208:211], v[152:155], a[0:15]
v_mul_u32_u24 v18, 136, v18
v_and_b32 v19, 7, v1
v_lshl_add_u32 v18, v19, 4, v18
s_mul_i32 s37, s3, 4352
s_add_u32 s37, s37, 49152
v_add_u32 v8, s37, v18
v_mfma_f32_32x32x16_bf16 a[16:31], a[212:215], v[152:155], a[16:31]
s_lshl_b32 s37, s3, 12
v_add_u32 v9, s37, v72
v_lshl_add_u32 v18, v17, 3, v16
v_sub_u32 v75, 15, v18
v_mov_b32 v20, 0
v_mov_b32 v21, 0
v_mfma_f32_32x32x16_bf16 a[32:47], a[216:219], v[152:155], a[32:47]
v_mov_b32 v22, 0
v_mov_b32 v23, 0
v_and_b32 v16, 3, v1
v_mul_u32_u24 v16, 4160, v16
v_lshrrev_b32 v17, 2, v1
v_min_u32 v17, 3, v17
v_mfma_f32_32x32x16_bf16 a[48:63], a[220:223], v[152:155], a[48:63]
v_lshl_add_u32 v16, v17, 4, v16
v_add_u32 v16, s36, v16
ds_write_b128 v16, v[20:23]
v_and_b32 v17, 31, v1
v_lshlrev_b32 v17, 4, v17
v_add_u32 v17, s43, v17
v_mfma_f32_32x32x16_bf16 a[0:15], a[224:227], v[176:179], a[0:15]
ds_write_b128 v17, v[20:23] offset:4096
v_alignbit_b32 v24, v49, v48, 16
v_alignbit_b32 v25, v50, v49, 16
v_alignbit_b32 v26, v51, v50, 16
v_alignbit_b32 v27, v52, v51, 16
v_alignbit_b32 v28, v53, v52, 16
v_mfma_f32_32x32x16_bf16 a[16:31], a[228:231], v[176:179], a[16:31]
ds_write_b128 v6, v[50:53] offset:64
ds_write_b128 v6, v[24:27] offset:4208
v_mov_b32 v16, v49
v_mov_b32 v17, v50
v_mov_b32 v18, v51
v_mov_b32 v19, v52
v_mfma_f32_32x32x16_bf16 a[32:47], a[232:235], v[176:179], a[32:47]
ds_write_b128 v6, v[16:19] offset:8368
v_mov_b32 v16, v25
v_mov_b32 v17, v26
v_mov_b32 v18, v27
v_mov_b32 v19, v28
ds_write_b128 v6, v[16:19] offset:12528
v_mfma_f32_32x32x16_bf16 a[48:63], a[236:239], v[176:179], a[48:63]
v_alignbit_b32 v30, v55, v54, 16
v_alignbit_b32 v31, v56, v55, 16
v_alignbit_b32 v32, v57, v56, 16
v_alignbit_b32 v33, v58, v57, 16
v_alignbit_b32 v34, v59, v58, 16
ds_write_b128 v6, v[56:59] offset:1088
v_mfma_f32_32x32x16_bf16 a[0:15], a[240:243], v[184:187], a[0:15]
ds_write_b128 v6, v[30:33] offset:5232
v_mov_b32 v16, v55
v_mov_b32 v17, v56
v_mov_b32 v18, v57
v_mov_b32 v19, v58
ds_write_b128 v6, v[16:19] offset:9392
v_mfma_f32_32x32x16_bf16 a[16:31], a[244:247], v[184:187], a[16:31]
v_mov_b32 v16, v31
v_mov_b32 v17, v32
v_mov_b32 v18, v33
v_mov_b32 v19, v34
ds_write_b128 v6, v[16:19] offset:13552
v_alignbit_b32 v24, v61, v60, 16
v_mfma_f32_32x32x16_bf16 a[32:47], a[248:251], v[184:187], a[32:47]
v_alignbit_b32 v25, v62, v61, 16
v_alignbit_b32 v26, v63, v62, 16
v_alignbit_b32 v27, v64, v63, 16
v_alignbit_b32 v28, v65, v64, 16
ds_write_b128 v6, v[62:65] offset:2112
ds_write_b128 v6, v[24:27] offset:6256
v_mfma_f32_32x32x16_bf16 a[48:63], a[252:255], v[184:187], a[48:63]
v_mov_b32 v16, v61
v_mov_b32 v17, v62
v_mov_b32 v18, v63
v_mov_b32 v19, v64
ds_write_b128 v6, v[16:19] offset:10416
v_mov_b32 v16, v25
v_mov_b32 v17, v26
v_mov_b32 v18, v27
v_mov_b32 v19, v28
ds_write_b128 v6, v[16:19] offset:14576
v_alignbit_b32 v30, v67, v66, 16
v_alignbit_b32 v31, v68, v67, 16
v_alignbit_b32 v32, v69, v68, 16
v_alignbit_b32 v33, v70, v69, 16
v_alignbit_b32 v34, v71, v70, 16
ds_write_b128 v6, v[68:71] offset:3136
ds_write_b128 v6, v[30:33] offset:7280
v_mov_b32 v16, v67
v_mov_b32 v17, v68
v_mov_b32 v18, v69
v_mov_b32 v19, v70
ds_write_b128 v6, v[16:19] offset:11440
v_mov_b32 v16, v31
v_mov_b32 v17, v32
v_mov_b32 v18, v33
v_mov_b32 v19, v34
ds_write_b128 v6, v[16:19] offset:15600
v_lshlrev_b32 v16, 16, v74
v_cmp_eq_u32 vcc, 0, v75
s_nop 1
v_cndmask_b32 v44, 0, v74, vcc
v_cmp_eq_u32 vcc, 1, v75
s_nop 1
v_cndmask_b32 v44, v44, v16, vcc
v_cmp_eq_u32 vcc, 2, v75
s_nop 1
v_cndmask_b32 v45, 0, v74, vcc
v_cmp_eq_u32 vcc, 3, v75
s_nop 1
v_cndmask_b32 v45, v45, v16, vcc
v_cmp_eq_u32 vcc, 4, v75
s_nop 1
v_cndmask_b32 v46, 0, v74, vcc
v_cmp_eq_u32 vcc, 5, v75
s_nop 1
v_cndmask_b32 v46, v46, v16, vcc
v_cmp_eq_u32 vcc, 6, v75
s_nop 1
v_cndmask_b32 v47, 0, v74, vcc
v_cmp_eq_u32 vcc, 7, v75
s_nop 1
v_cndmask_b32 v47, v47, v16, vcc
v_add_f32 v2, v2, v3
v_mov_b32 v3, v2
s_nop 1
v_permlane32_swap_b32 v2, v3
v_add_f32 v2, v2, v3
v_rcp_f32 v2, v2
s_nop 7
v_accvgpr_read_b32 v240, a0
v_accvgpr_read_b32 v241, a1
v_accvgpr_read_b32 v242, a2
v_accvgpr_read_b32 v243, a3
v_accvgpr_read_b32 v244, a4
v_accvgpr_read_b32 v245, a5
v_accvgpr_read_b32 v246, a6
v_accvgpr_read_b32 v247, a7
v_mul_f32 v240, v240, v2
v_mul_f32 v241, v241, v2
v_mul_f32 v242, v242, v2
v_mul_f32 v243, v243, v2
v_mul_f32 v244, v244, v2
v_mul_f32 v245, v245, v2
v_mul_f32 v246, v246, v2
v_mul_f32 v247, v247, v2
v_cvt_pk_bf16_f32 v248, v240, v241
v_cvt_pk_bf16_f32 v249, v242, v243
v_cvt_pk_bf16_f32 v250, v244, v245
v_cvt_pk_bf16_f32 v251, v246, v247
buffer_store_dwordx4 v[248:251], v15, s[60:63], s100 offen offset:0 sc1
v_accvgpr_read_b32 v240, a8
v_accvgpr_read_b32 v241, a9
v_accvgpr_read_b32 v242, a10
v_accvgpr_read_b32 v243, a11
v_accvgpr_read_b32 v244, a12
v_accvgpr_read_b32 v245, a13
v_accvgpr_read_b32 v246, a14
v_accvgpr_read_b32 v247, a15
v_mul_f32 v240, v240, v2
v_mul_f32 v241, v241, v2
v_mul_f32 v242, v242, v2
v_mul_f32 v243, v243, v2
v_mul_f32 v244, v244, v2
v_mul_f32 v245, v245, v2
v_mul_f32 v246, v246, v2
v_mul_f32 v247, v247, v2
v_cvt_pk_bf16_f32 v252, v240, v241
v_cvt_pk_bf16_f32 v253, v242, v243
v_cvt_pk_bf16_f32 v254, v244, v245
v_cvt_pk_bf16_f32 v255, v246, v247
buffer_store_dwordx4 v[252:255], v15, s[60:63], s100 offen offset:512 sc1
v_accvgpr_read_b32 v240, a16
v_accvgpr_read_b32 v241, a17
v_accvgpr_read_b32 v242, a18
v_accvgpr_read_b32 v243, a19
v_accvgpr_read_b32 v244, a20
v_accvgpr_read_b32 v245, a21
v_accvgpr_read_b32 v246, a22
v_accvgpr_read_b32 v247, a23
v_mul_f32 v240, v240, v2
v_mul_f32 v241, v241, v2
v_mul_f32 v242, v242, v2
v_mul_f32 v243, v243, v2
v_mul_f32 v244, v244, v2
v_mul_f32 v245, v245, v2
v_mul_f32 v246, v246, v2
v_mul_f32 v247, v247, v2
v_cvt_pk_bf16_f32 v248, v240, v241
v_cvt_pk_bf16_f32 v249, v242, v243
v_cvt_pk_bf16_f32 v250, v244, v245
v_cvt_pk_bf16_f32 v251, v246, v247
buffer_store_dwordx4 v[248:251], v15, s[60:63], s100 offen offset:1024 sc1
v_accvgpr_read_b32 v240, a24
v_accvgpr_read_b32 v241, a25
v_accvgpr_read_b32 v242, a26
v_accvgpr_read_b32 v243, a27
v_accvgpr_read_b32 v244, a28
v_accvgpr_read_b32 v245, a29
v_accvgpr_read_b32 v246, a30
v_accvgpr_read_b32 v247, a31
v_mul_f32 v240, v240, v2
v_mul_f32 v241, v241, v2
v_mul_f32 v242, v242, v2
v_mul_f32 v243, v243, v2
v_mul_f32 v244, v244, v2
v_mul_f32 v245, v245, v2
v_mul_f32 v246, v246, v2
v_mul_f32 v247, v247, v2
v_cvt_pk_bf16_f32 v252, v240, v241
v_cvt_pk_bf16_f32 v253, v242, v243
v_cvt_pk_bf16_f32 v254, v244, v245
v_cvt_pk_bf16_f32 v255, v246, v247
buffer_store_dwordx4 v[252:255], v15, s[60:63], s100 offen offset:1536 sc1
v_accvgpr_read_b32 v240, a32
v_accvgpr_read_b32 v241, a33
v_accvgpr_read_b32 v242, a34
v_accvgpr_read_b32 v243, a35
v_accvgpr_read_b32 v244, a36
v_accvgpr_read_b32 v245, a37
v_accvgpr_read_b32 v246, a38
v_accvgpr_read_b32 v247, a39
v_mul_f32 v240, v240, v2
v_mul_f32 v241, v241, v2
v_mul_f32 v242, v242, v2
v_mul_f32 v243, v243, v2
v_mul_f32 v244, v244, v2
v_mul_f32 v245, v245, v2
v_mul_f32 v246, v246, v2
v_mul_f32 v247, v247, v2
v_cvt_pk_bf16_f32 v248, v240, v241
v_cvt_pk_bf16_f32 v249, v242, v243
v_cvt_pk_bf16_f32 v250, v244, v245
v_cvt_pk_bf16_f32 v251, v246, v247
buffer_store_dwordx4 v[248:251], v15, s[60:63], s100 offen offset:2048 sc1
v_accvgpr_read_b32 v240, a40
v_accvgpr_read_b32 v241, a41
v_accvgpr_read_b32 v242, a42
v_accvgpr_read_b32 v243, a43
v_accvgpr_read_b32 v244, a44
v_accvgpr_read_b32 v245, a45
v_accvgpr_read_b32 v246, a46
v_accvgpr_read_b32 v247, a47
v_mul_f32 v240, v240, v2
v_mul_f32 v241, v241, v2
v_mul_f32 v242, v242, v2
v_mul_f32 v243, v243, v2
v_mul_f32 v244, v244, v2
v_mul_f32 v245, v245, v2
v_mul_f32 v246, v246, v2
v_mul_f32 v247, v247, v2
v_cvt_pk_bf16_f32 v252, v240, v241
v_cvt_pk_bf16_f32 v253, v242, v243
v_cvt_pk_bf16_f32 v254, v244, v245
v_cvt_pk_bf16_f32 v255, v246, v247
buffer_store_dwordx4 v[252:255], v15, s[60:63], s100 offen offset:2560 sc1
v_accvgpr_read_b32 v240, a48
v_accvgpr_read_b32 v241, a49
v_accvgpr_read_b32 v242, a50
v_accvgpr_read_b32 v243, a51
v_accvgpr_read_b32 v244, a52
v_accvgpr_read_b32 v245, a53
v_accvgpr_read_b32 v246, a54
v_accvgpr_read_b32 v247, a55
v_mul_f32 v240, v240, v2
v_mul_f32 v241, v241, v2
v_mul_f32 v242, v242, v2
v_mul_f32 v243, v243, v2
v_mul_f32 v244, v244, v2
v_mul_f32 v245, v245, v2
v_mul_f32 v246, v246, v2
v_mul_f32 v247, v247, v2
v_cvt_pk_bf16_f32 v248, v240, v241
v_cvt_pk_bf16_f32 v249, v242, v243
v_cvt_pk_bf16_f32 v250, v244, v245
v_cvt_pk_bf16_f32 v251, v246, v247
buffer_store_dwordx4 v[248:251], v15, s[60:63], s100 offen offset:3072 sc1
v_accvgpr_read_b32 v240, a56
v_accvgpr_read_b32 v241, a57
v_accvgpr_read_b32 v242, a58
v_accvgpr_read_b32 v243, a59
v_accvgpr_read_b32 v244, a60
v_accvgpr_read_b32 v245, a61
v_accvgpr_read_b32 v246, a62
v_accvgpr_read_b32 v247, a63
v_mul_f32 v240, v240, v2
v_mul_f32 v241, v241, v2
v_mul_f32 v242, v242, v2
v_mul_f32 v243, v243, v2
v_mul_f32 v244, v244, v2
v_mul_f32 v245, v245, v2
v_mul_f32 v246, v246, v2
v_mul_f32 v247, v247, v2
v_cvt_pk_bf16_f32 v252, v240, v241
v_cvt_pk_bf16_f32 v253, v242, v243
v_cvt_pk_bf16_f32 v254, v244, v245
v_cvt_pk_bf16_f32 v255, v246, v247
buffer_store_dwordx4 v[252:255], v15, s[60:63], s100 offen offset:3584 sc1
s_waitcnt lgkmcnt(0)
ds_read_b128 a[160:163], v5 offset:3584
ds_read_b64 a[128:129], v4 offset:0
ds_read_b64 a[130:131], v4 offset:8
ds_read_b128 a[164:167], v5 offset:3072
ds_read_b64 a[132:133], v4 offset:512
ds_read_b64 a[134:135], v4 offset:520
ds_read_b128 a[168:171], v5 offset:2560
ds_read_b64 a[136:137], v4 offset:1024
ds_read_b64 a[138:139], v4 offset:1032
ds_read_b128 a[172:175], v5 offset:2048
ds_read_b64 a[140:141], v4 offset:1536
ds_read_b64 a[142:143], v4 offset:1544
ds_read_b128 a[176:179], v5 offset:1536
ds_read_b64 a[144:145], v4 offset:2048
ds_read_b64 a[146:147], v4 offset:2056
ds_read_b128 a[180:183], v5 offset:1024
ds_read_b64 a[148:149], v4 offset:2560
ds_read_b64 a[150:151], v4 offset:2568
ds_read_b128 a[184:187], v5 offset:512
ds_read_b64 a[152:153], v4 offset:3072
ds_read_b64 a[154:155], v4 offset:3080
ds_read_b128 a[188:191], v5 offset:0
ds_read_b64 a[156:157], v4 offset:3584
ds_read_b64 a[158:159], v4 offset:3592
v_lshlrev_b32 v255, 20, v1
s_lshl_b32 s36, s3, 26
v_add_u32 v255, s36, v255
s_waitcnt lgkmcnt(15)
v_mfma_f32_16x16x32_bf16 v[76:79], a[128:131], a[160:163], 0
ds_read_b128 a[224:227], v5 offset:3648
s_and_b32 s81, s2, 3
v_mfma_f32_16x16x32_bf16 v[80:83], a[128:131], a[164:167], 0
ds_read_b64 a[192:193], v4 offset:64
s_lshl_b32 s81, s81, 1
v_mfma_f32_16x16x32_bf16 v[84:87], a[128:131], a[168:171], 0
ds_read_b64 a[194:195], v4 offset:72
s_sub_u32 s74, 14, s81
s_waitcnt lgkmcnt(15)
v_mfma_f32_16x16x32_bf16 v[88:91], a[128:131], a[172:175], 0
ds_read_b128 a[228:231], v5 offset:3136
s_waitcnt lgkmcnt(15)
v_mfma_f32_16x16x32_bf16 v[92:95], a[128:131], a[176:179], 0
s_bitcmp1_b32 s2, 4
s_cselect_b32 s81, s74, s81
s_waitcnt lgkmcnt(12)
v_mfma_f32_16x16x32_bf16 v[96:99], a[128:131], a[180:183], 0
ds_read_b64 a[196:197], v4 offset:576
s_waitcnt lgkmcnt(10)
v_mfma_f32_16x16x32_bf16 v[100:103], a[128:131], a[184:187], 0
ds_read_b64 a[198:199], v4 offset:584
s_waitcnt lgkmcnt(8)
v_mfma_f32_16x16x32_bf16 v[104:107], a[128:131], a[188:191], 0
ds_read_b128 a[232:235], v5 offset:2624
s_bfe_u32 s74, s2, 0x10003
MV 76,v,44,a,160
ds_read_b64 a[200:201], v4 offset:1088
s_add_u32 s81, s81, s74
MV 80,v,44,a,164
MV 84,v,44,a,168
ds_read_b64 a[202:203], v4 offset:1096
s_bfe_u32 s82, s2, 0x10002
MV 88,v,44,a,172
ds_read_b128 a[236:239], v5 offset:2112
s_lshr_b32 s74, s2, 5
MV 92,v,44,a,176
ds_read_b64 a[204:205], v4 offset:1600
s_lshl_b32 s74, s74, 1
MV 96,v,44,a,180
ds_read_b64 a[206:207], v4 offset:1608
MV 100,v,44,a,184
s_add_u32 s82, s82, s74
MV 104,v,44,a,188
ds_read_b128 a[240:243], v5 offset:1600
s_mov_b32 s72, s81
MV 80,a,132,a,160
ds_read_b64 a[208:209], v4 offset:2112
MV 84,a,132,a,164
ds_read_b64 a[210:211], v4 offset:2120
s_mov_b32 s73, s82
MV 88,a,132,a,168
ds_read_b128 a[244:247], v5 offset:1088
s_lshl_b32 s74, s72, 2
MV 92,a,132,a,172
MV 96,a,132,a,176
ds_read_b64 a[212:213], v4 offset:2624
s_add_u32 s74, s74, s3
MV 100,a,132,a,180
ds_read_b64 a[214:215], v4 offset:2632
s_lshl_b32 s68, s74, 18
MV 104,a,132,a,184
ds_read_b128 a[248:251], v5 offset:576
s_and_b32 s80, s73, 1
MV 84,a,136,a,160
ds_read_b64 a[216:217], v4 offset:3136
MV 88,a,136,a,164
s_lshl_b32 s75, s80, 16
MV 92,a,136,a,168
ds_read_b64 a[218:219], v4 offset:3144
s_add_u32 s68, s68, s75
MV 96,a,136,a,172
ds_read_b128 a[252:255], v5 offset:64
MV 100,a,136,a,176
ds_read_b64 a[220:221], v4 offset:3648
s_lshl_b32 s69, s73, 19
MV 104,a,136,a,180
ds_read_b64 a[222:223], v4 offset:3656
s_lshl_b32 s75, s73, 7
MV 88,a,140,a,160
MV 92,a,140,a,164
s_lshl_b32 s70, s3, 12
MV 96,a,140,a,168
s_lshl_b32 s78, s74, 16
MV 100,a,140,a,172
s_add_u32 s78, s78, s75
MV 104,a,140,a,176
MV 92,a,144,a,160
s_lshl_b32 s79, s73, 18
MV 96,a,144,a,164
s_lshl_b32 s75, s74, 8
MV 100,a,144,a,168
MV 104,a,144,a,172
s_add_u32 s79, s79, s75
MV 96,a,148,a,160
v_lshlrev_b32 v236, 4, v1
MV 100,a,148,a,164
MV 104,a,148,a,168
v_add_u32 v237, 0x20000, v236
MV 100,a,152,a,160
v_add_u32 v238, s70, v236
MV 104,a,152,a,164
s_waitcnt lgkmcnt(15)
MV 104,a,156,a,160
s_waitcnt vmcnt(0)
s_barrier
v_mov_b32 v253, 1
s_lshl_b32 s36, s2, 2
buffer_store_dword v253, v255, s[8:11], s36 offen offset:2048 sc1
MV 76,a,192,a,224
ds_read_b128 a[160:163], v5 offset:3712
s_lshl_b32 s75, s80, 12
MV 80,a,192,a,228
ds_read_b64 a[128:129], v4 offset:128
v_add_u32 v244, s75, v236
MV 84,a,192,a,232
ds_read_b64 a[130:131], v4 offset:136
v_xor_b32 v245, 0x1000, v244
s_waitcnt lgkmcnt(15)
MV 88,a,192,a,236
ds_read_b128 a[164:167], v5 offset:3200
v_add_u32 v242, 66560, v244
s_waitcnt lgkmcnt(15)
MV 92,a,192,a,240
v_add_u32 v243, 66560, v245
s_waitcnt lgkmcnt(12)
MV 96,a,192,a,244
ds_read_b64 a[132:133], v4 offset:640
v_bfe_u32 v38, v1, 4, 1
s_waitcnt lgkmcnt(10)
MV 100,a,192,a,248
ds_read_b64 a[134:135], v4 offset:648
v_lshrrev_b32 v40, 5, v1
s_waitcnt lgkmcnt(8)
MV 104,a,192,a,252
ds_read_b128 a[168:171], v5 offset:2688
v_and_b32 v36, 15, v1
MV 80,a,196,a,224
ds_read_b64 a[136:137], v4 offset:1152
v_lshlrev_b32 v41, 5, v38
MV 84,a,196,a,228
v_lshl_add_u32 v41, v40, 4, v41
MV 88,a,196,a,232
ds_read_b64 a[138:139], v4 offset:1160
v_lshl_add_u32 v250, v36, 11, v41
MV 92,a,196,a,236
ds_read_b128 a[172:175], v5 offset:2176
v_lshlrev_b32 v41, 11, v41
MV 96,a,196,a,240
ds_read_b64 a[140:141], v4 offset:1664
v_lshl_add_u32 v251, v36, 3, v41
MV 100,a,196,a,244
ds_read_b64 a[142:143], v4 offset:1672
MV 104,a,196,a,248
s_add_u32 s44, s40, 33554432
s_addc_u32 s45, s41, 0
MV 84,a,200,a,224
ds_read_b128 a[176:179], v5 offset:1664
s_mov_b32 s46, 16777216
MV 88,a,200,a,228
ds_read_b64 a[144:145], v4 offset:2176
s_mov_b32 s47, 0x20000
MV 92,a,200,a,232
ds_read_b64 a[146:147], v4 offset:2184
MV 96,a,200,a,236
ds_read_b128 a[180:183], v5 offset:1152
MV 100,a,200,a,240
s_add_u32 s48, s40, 100663296
s_addc_u32 s49, s41, 0
MV 104,a,200,a,244
ds_read_b64 a[148:149], v4 offset:2688
s_mov_b32 s50, 8388608
MV 88,a,204,a,224
ds_read_b64 a[150:151], v4 offset:2696
s_mov_b32 s51, 0x20000
MV 92,a,204,a,228
ds_read_b128 a[184:187], v5 offset:640
MV 96,a,204,a,232
ds_read_b64 a[152:153], v4 offset:3200
MV 100,a,204,a,236
s_add_u32 s52, s40, 109051904
s_addc_u32 s53, s41, 0
MV 104,a,204,a,240
ds_read_b64 a[154:155], v4 offset:3208
s_mov_b32 s54, 4194304
MV 92,a,208,a,224
ds_read_b128 a[188:191], v5 offset:128
s_mov_b32 s55, 0x20000
MV 96,a,208,a,228
ds_read_b64 a[156:157], v4 offset:3712
MV 100,a,208,a,232
ds_read_b64 a[158:159], v4 offset:3720
MV 104,a,208,a,236
s_add_u32 s56, s40, 54525952
s_addc_u32 s57, s41, 0
MV 96,a,212,a,224
s_mov_b32 s58, 4194304
s_mov_b32 s59, 0x20000
MV 100,a,212,a,228
s_mov_b32 s60, s88
s_mov_b32 s61, s89
MV 104,a,212,a,232
s_mov_b32 s62, 4194304
MV 100,a,216,a,224
s_mov_b32 s63, 0x20000
MV 104,a,216,a,228
s_waitcnt lgkmcnt(15)
MV 104,a,220,a,224
MV 76,a,128,a,160
ds_read_b128 a[224:227], v5 offset:3776
s_sub_u32 s36, 15, s81
MV 80,a,128,a,164
ds_read_b64 a[192:193], v4 offset:192
s_min_u32 s36, s36, s81
MV 84,a,128,a,168
ds_read_b64 a[194:195], v4 offset:200
s_lshl_b32 s36, s36, 5
s_waitcnt lgkmcnt(15)
MV 88,a,128,a,172
ds_read_b128 a[228:231], v5 offset:3264
s_waitcnt lgkmcnt(15)
MV 92,a,128,a,176
s_lshl_b32 s37, s80, 2
s_waitcnt lgkmcnt(12)
MV 96,a,128,a,180
ds_read_b64 a[196:197], v4 offset:704
s_add_u32 s36, s36, s37
s_waitcnt lgkmcnt(10)
MV 100,a,128,a,184
ds_read_b64 a[198:199], v4 offset:712
s_add_u32 s36, s36, 256
s_waitcnt lgkmcnt(8)
MV 104,a,128,a,188
ds_read_b128 a[232:235], v5 offset:2752
MV 80,a,132,a,160
ds_read_b64 a[200:201], v4 offset:1216
v_and_b32 v254, 3, v1
MV 84,a,132,a,164
v_lshlrev_b32 v254, 3, v254
MV 88,a,132,a,168
ds_read_b64 a[202:203], v4 offset:1224
v_bfe_u32 v253, v1, 2, 2
MV 92,a,132,a,172
ds_read_b128 a[236:239], v5 offset:2240
MV 96,a,132,a,176
ds_read_b64 a[204:205], v4 offset:1728
v_add3_u32 v254, v254, v253, s36
MV 100,a,132,a,180
ds_read_b64 a[206:207], v4 offset:1736
s_lshr_b32 s36, s82, 1
MV 104,a,132,a,184
s_lshl_b32 s37, s80, 7
MV 84,a,136,a,160
ds_read_b128 a[240:243], v5 offset:1728
MV 88,a,136,a,164
ds_read_b64 a[208:209], v4 offset:2240
s_add_u32 s36, s36, s37
MV 92,a,136,a,168
ds_read_b64 a[210:211], v4 offset:2248
v_and_b32 v253, 15, v1
MV 96,a,136,a,172
ds_read_b128 a[244:247], v5 offset:1216
v_lshl_add_u32 v253, v253, 3, s36
MV 100,a,136,a,176
MV 104,a,136,a,180
ds_read_b64 a[212:213], v4 offset:2752
s_xor_b32 s36, s2, 4
MV 88,a,140,a,160
ds_read_b64 a[214:215], v4 offset:2760
v_mov_b32 v228, s36
MV 92,a,140,a,164
ds_read_b128 a[248:251], v5 offset:704
MV 96,a,140,a,168
ds_read_b64 a[216:217], v4 offset:3264
MV 100,a,140,a,172
v_cmp_lt_u32 vcc, 15, v1
s_nop 1
v_cndmask_b32 v254, v254, v228, vcc
MV 104,a,140,a,176
ds_read_b64 a[218:219], v4 offset:3272
MV 92,a,144,a,160
ds_read_b128 a[252:255], v5 offset:192
MV 96,a,144,a,164
ds_read_b64 a[220:221], v4 offset:3776
MV 100,a,144,a,168
ds_read_b64 a[222:223], v4 offset:3784
MV 104,a,144,a,172
v_cmp_lt_u32 vcc, 31, v1
s_nop 1
v_cndmask_b32 v254, v254, v253, vcc
MV 96,a,148,a,160
MV 100,a,148,a,164
MV 104,a,148,a,168
MV 100,a,152,a,160
v_lshlrev_b32 v254, 2, v254
MV 104,a,152,a,164
s_waitcnt lgkmcnt(15)
MV 104,a,156,a,160
MV 76,a,192,a,224
ds_read_b128 a[160:163], v5 offset:3840
MV 80,a,192,a,228
ds_read_b64 a[128:129], v4 offset:256
MV 84,a,192,a,232
ds_read_b64 a[130:131], v4 offset:264
s_waitcnt lgkmcnt(15)
MV 88,a,192,a,236
ds_read_b128 a[164:167], v5 offset:3328
s_waitcnt lgkmcnt(15)
MV 92,a,192,a,240
s_waitcnt lgkmcnt(12)
MV 96,a,192,a,244
ds_read_b64 a[132:133], v4 offset:768
s_waitcnt lgkmcnt(10)
MV 100,a,192,a,248
ds_read_b64 a[134:135], v4 offset:776
s_waitcnt lgkmcnt(8)
MV 104,a,192,a,252
ds_read_b128 a[168:171], v5 offset:2816
MV 80,a,196,a,224
ds_read_b64 a[136:137], v4 offset:1280
MV 84,a,196,a,228
MV 88,a,196,a,232
ds_read_b64 a[138:139], v4 offset:1288
MV 92,a,196,a,236
ds_read_b128 a[172:175], v5 offset:2304
MV 96,a,196,a,240
ds_read_b64 a[140:141], v4 offset:1792
MV 100,a,196,a,244
ds_read_b64 a[142:143], v4 offset:1800
MV 104,a,196,a,248
MV 84,a,200,a,224
ds_read_b128 a[176:179], v5 offset:1792
MV 88,a,200,a,228
ds_read_b64 a[144:145], v4 offset:2304
MV 92,a,200,a,232
ds_read_b64 a[146:147], v4 offset:2312
MV 96,a,200,a,236
ds_read_b128 a[180:183], v5 offset:1280
MV 100,a,200,a,240
MV 104,a,200,a,244
ds_read_b64 a[148:149], v4 offset:2816
MV 88,a,204,a,224
ds_read_b64 a[150:151], v4 offset:2824
MV 92,a,204,a,228
ds_read_b128 a[184:187], v5 offset:768
MV 96,a,204,a,232
ds_read_b64 a[152:153], v4 offset:3328
MV 100,a,204,a,236
MV 104,a,204,a,240
ds_read_b64 a[154:155], v4 offset:3336
MV 92,a,208,a,224
ds_read_b128 a[188:191], v5 offset:256
MV 96,a,208,a,228
ds_read_b64 a[156:157], v4 offset:3840
MV 100,a,208,a,232
ds_read_b64 a[158:159], v4 offset:3848
MV 104,a,208,a,236
MV 96,a,212,a,224
MV 100,a,212,a,228
MV 104,a,212,a,232
MV 100,a,216,a,224
MV 104,a,216,a,228
s_waitcnt lgkmcnt(15)
MV 104,a,220,a,224
MV 76,a,128,a,160
ds_read_b128 a[224:227], v5 offset:3904
MV 80,a,128,a,164
ds_read_b64 a[192:193], v4 offset:320
MV 84,a,128,a,168
ds_read_b64 a[194:195], v4 offset:328
s_waitcnt lgkmcnt(15)
MV 88,a,128,a,172
ds_read_b128 a[228:231], v5 offset:3392
s_waitcnt lgkmcnt(15)
MV 92,a,128,a,176
s_waitcnt lgkmcnt(12)
MV 96,a,128,a,180
ds_read_b64 a[196:197], v4 offset:832
s_waitcnt lgkmcnt(10)
MV 100,a,128,a,184
ds_read_b64 a[198:199], v4 offset:840
s_waitcnt lgkmcnt(8)
MV 104,a,128,a,188
ds_read_b128 a[232:235], v5 offset:2880
MV 80,a,132,a,160
ds_read_b64 a[200:201], v4 offset:1344
MV 84,a,132,a,164
MV 88,a,132,a,168
ds_read_b64 a[202:203], v4 offset:1352
MV 92,a,132,a,172
ds_read_b128 a[236:239], v5 offset:2368
MV 96,a,132,a,176
ds_read_b64 a[204:205], v4 offset:1856
MV 100,a,132,a,180
ds_read_b64 a[206:207], v4 offset:1864
MV 104,a,132,a,184
MV 84,a,136,a,160
ds_read_b128 a[240:243], v5 offset:1856
MV 88,a,136,a,164
ds_read_b64 a[208:209], v4 offset:2368
MV 92,a,136,a,168
ds_read_b64 a[210:211], v4 offset:2376
MV 96,a,136,a,172
ds_read_b128 a[244:247], v5 offset:1344
MV 100,a,136,a,176
MV 104,a,136,a,180
ds_read_b64 a[212:213], v4 offset:2880
MV 88,a,140,a,160
ds_read_b64 a[214:215], v4 offset:2888
MV 92,a,140,a,164
ds_read_b128 a[248:251], v5 offset:832
MV 96,a,140,a,168
ds_read_b64 a[216:217], v4 offset:3392
MV 100,a,140,a,172
MV 104,a,140,a,176
ds_read_b64 a[218:219], v4 offset:3400
MV 92,a,144,a,160
ds_read_b128 a[252:255], v5 offset:320
MV 96,a,144,a,164
ds_read_b64 a[220:221], v4 offset:3904
MV 100,a,144,a,168
ds_read_b64 a[222:223], v4 offset:3912
MV 104,a,144,a,172
MV 96,a,148,a,160
MV 100,a,148,a,164
MV 104,a,148,a,168
MV 100,a,152,a,160
MV 104,a,152,a,164
s_waitcnt lgkmcnt(15)
MV 104,a,156,a,160
MV 76,a,192,a,224
ds_read_b128 a[160:163], v5 offset:3968
MV 80,a,192,a,228
ds_read_b64 a[128:129], v4 offset:384
MV 84,a,192,a,232
ds_read_b64 a[130:131], v4 offset:392
s_waitcnt lgkmcnt(15)
MV 88,a,192,a,236
ds_read_b128 a[164:167], v5 offset:3456
s_waitcnt lgkmcnt(15)
MV 92,a,192,a,240
s_waitcnt lgkmcnt(12)
MV 96,a,192,a,244
ds_read_b64 a[132:133], v4 offset:896
s_waitcnt lgkmcnt(10)
MV 100,a,192,a,248
ds_read_b64 a[134:135], v4 offset:904
s_waitcnt lgkmcnt(8)
MV 104,a,192,a,252
ds_read_b128 a[168:171], v5 offset:2944
MV 80,a,196,a,224
ds_read_b64 a[136:137], v4 offset:1408
MV 84,a,196,a,228
MV 88,a,196,a,232
ds_read_b64 a[138:139], v4 offset:1416
MV 92,a,196,a,236
ds_read_b128 a[172:175], v5 offset:2432
MV 96,a,196,a,240
ds_read_b64 a[140:141], v4 offset:1920
MV 100,a,196,a,244
ds_read_b64 a[142:143], v4 offset:1928
MV 104,a,196,a,248
MV 84,a,200,a,224
ds_read_b128 a[176:179], v5 offset:1920
MV 88,a,200,a,228
ds_read_b64 a[144:145], v4 offset:2432
MV 92,a,200,a,232
ds_read_b64 a[146:147], v4 offset:2440
MV 96,a,200,a,236
ds_read_b128 a[180:183], v5 offset:1408
MV 100,a,200,a,240
MV 104,a,200,a,244
ds_read_b64 a[148:149], v4 offset:2944
MV 88,a,204,a,224
ds_read_b64 a[150:151], v4 offset:2952
MV 92,a,204,a,228
ds_read_b128 a[184:187], v5 offset:896
MV 96,a,204,a,232
ds_read_b64 a[152:153], v4 offset:3456
MV 100,a,204,a,236
MV 104,a,204,a,240
ds_read_b64 a[154:155], v4 offset:3464
MV 92,a,208,a,224
ds_read_b128 a[188:191], v5 offset:384
MV 96,a,208,a,228
ds_read_b64 a[156:157], v4 offset:3968
MV 100,a,208,a,232
ds_read_b64 a[158:159], v4 offset:3976
MV 104,a,208,a,236
MV 96,a,212,a,224
MV 100,a,212,a,228
MV 104,a,212,a,232
MV 100,a,216,a,224
MV 104,a,216,a,228
s_waitcnt lgkmcnt(15)
MV 104,a,220,a,224
MV 76,a,128,a,160
ds_read_b128 a[224:227], v5 offset:4032
MV 80,a,128,a,164
ds_read_b64 a[192:193], v4 offset:448
MV 84,a,128,a,168
ds_read_b64 a[194:195], v4 offset:456
s_waitcnt lgkmcnt(15)
MV 88,a,128,a,172
ds_read_b128 a[228:231], v5 offset:3520
s_waitcnt lgkmcnt(15)
MV 92,a,128,a,176
s_waitcnt lgkmcnt(12)
MV 96,a,128,a,180
ds_read_b64 a[196:197], v4 offset:960
s_waitcnt lgkmcnt(10)
MV 100,a,128,a,184
ds_read_b64 a[198:199], v4 offset:968
s_waitcnt lgkmcnt(8)
MV 104,a,128,a,188
ds_read_b128 a[232:235], v5 offset:3008
MV 80,a,132,a,160
ds_read_b64 a[200:201], v4 offset:1472
MV 84,a,132,a,164
MV 88,a,132,a,168
ds_read_b64 a[202:203], v4 offset:1480
MV 92,a,132,a,172
ds_read_b128 a[236:239], v5 offset:2496
MV 96,a,132,a,176
ds_read_b64 a[204:205], v4 offset:1984
MV 100,a,132,a,180
ds_read_b64 a[206:207], v4 offset:1992
MV 104,a,132,a,184
MV 84,a,136,a,160
ds_read_b128 a[240:243], v5 offset:1984
MV 88,a,136,a,164
ds_read_b64 a[208:209], v4 offset:2496
MV 92,a,136,a,168
ds_read_b64 a[210:211], v4 offset:2504
MV 96,a,136,a,172
ds_read_b128 a[244:247], v5 offset:1472
MV 100,a,136,a,176
MV 104,a,136,a,180
ds_read_b64 a[212:213], v4 offset:3008
MV 88,a,140,a,160
ds_read_b64 a[214:215], v4 offset:3016
MV 92,a,140,a,164
ds_read_b128 a[248:251], v5 offset:960
MV 96,a,140,a,168
ds_read_b64 a[216:217], v4 offset:3520
MV 100,a,140,a,172
MV 104,a,140,a,176
ds_read_b64 a[218:219], v4 offset:3528
MV 92,a,144,a,160
ds_read_b128 a[252:255], v5 offset:448
MV 96,a,144,a,164
ds_read_b64 a[220:221], v4 offset:4032
MV 100,a,144,a,168
ds_read_b64 a[222:223], v4 offset:4040
MV 104,a,144,a,172
MV 96,a,148,a,160
MV 100,a,148,a,164
MV 104,a,148,a,168
MV 100,a,152,a,160
MV 104,a,152,a,164
s_waitcnt lgkmcnt(15)
MV 104,a,156,a,160
buffer_load_dword v253, v254, s[8:11], 0 offen offset:1024 sc1
s_waitcnt vmcnt(0)
v_cmp_gt_u32 vcc, 1, v253
s_nop 4
s_cbranch_vccnz L_spin_f2
L_spin_f2_ret:
s_add_u32 m0, s70, 66560
s_nop 0
buffer_load_dwordx4 v238, s[48:51], s69 offen offset:0 sc1 lds
buffer_load_dwordx4 v238, s[48:51], s69 offen offset:1024 sc1 lds
buffer_load_dwordx4 v238, s[48:51], s69 offen offset:2048 sc1 lds
buffer_load_dwordx4 v238, s[48:51], s69 offen offset:3072 sc1 lds
s_add_u32 s69, s69, 16384
buffer_load_dwordx4 a[0:3], v236, s[44:47], s68 offen offset:0 sc1
buffer_load_dwordx4 a[4:7], v237, s[44:47], s68 offen offset:0 sc1
buffer_load_dwordx4 a[8:11], v236, s[44:47], s68 offen offset:1024 sc1
buffer_load_dwordx4 a[12:15], v237, s[44:47], s68 offen offset:1024 sc1
s_add_u32 s68, s68, 2048
MV 76,a,192,a,224
s_add_u32 m0, s70, 82944
s_nop 0
buffer_load_dwordx4 v238, s[48:51], s69 offen offset:0 sc1 lds
MV 80,a,192,a,228
buffer_load_dwordx4 v238, s[48:51], s69 offen offset:1024 sc1 lds
MV 84,a,192,a,232
buffer_load_dwordx4 v238, s[48:51], s69 offen offset:2048 sc1 lds
buffer_load_dwordx4 v238, s[48:51], s69 offen offset:3072 sc1 lds
s_waitcnt lgkmcnt(14)
MV 88,a,192,a,236
s_add_u32 s69, s69, 16384
s_waitcnt lgkmcnt(11)
MV 92,a,192,a,240
buffer_load_dwordx4 a[16:19], v236, s[44:47], s68 offen offset:0 sc1
s_waitcnt lgkmcnt(8)
MV 96,a,192,a,244
buffer_load_dwordx4 a[20:23], v237, s[44:47], s68 offen offset:0 sc1
buffer_load_dwordx4 a[24:27], v236, s[44:47], s68 offen offset:1024 sc1
s_waitcnt lgkmcnt(5)
MV 100,a,192,a,248
buffer_load_dwordx4 a[28:31], v237, s[44:47], s68 offen offset:1024 sc1
s_waitcnt lgkmcnt(2)
MV 104,a,192,a,252
s_add_u32 s68, s68, 2048
MV 80,a,196,a,224
s_add_u32 m0, s70, 99328
s_nop 0
buffer_load_dwordx4 v238, s[48:51], s69 offen offset:0 sc1 lds
MV 84,a,196,a,228
buffer_load_dwordx4 v238, s[48:51], s69 offen offset:1024 sc1 lds
MV 88,a,196,a,232
buffer_load_dwordx4 v238, s[48:51], s69 offen offset:2048 sc1 lds
buffer_load_dwordx4 v238, s[48:51], s69 offen offset:3072 sc1 lds
MV 92,a,196,a,236
s_add_u32 s69, s69, 16384
MV 96,a,196,a,240
buffer_load_dwordx4 a[32:35], v236, s[44:47], s68 offen offset:0 sc1
MV 100,a,196,a,244
buffer_load_dwordx4 a[36:39], v237, s[44:47], s68 offen offset:0 sc1
buffer_load_dwordx4 a[40:43], v236, s[44:47], s68 offen offset:1024 sc1
MV 104,a,196,a,248
buffer_load_dwordx4 a[44:47], v237, s[44:47], s68 offen offset:1024 sc1
MV 84,a,200,a,224
s_add_u32 s68, s68, 2048
MV 88,a,200,a,228
s_add_u32 m0, s70, 115712
s_nop 0
buffer_load_dwordx4 v238, s[48:51], s69 offen offset:0 sc1 lds
MV 92,a,200,a,232
buffer_load_dwordx4 v238, s[48:51], s69 offen offset:1024 sc1 lds
MV 96,a,200,a,236
buffer_load_dwordx4 v238, s[48:51], s69 offen offset:2048 sc1 lds
buffer_load_dwordx4 v238, s[48:51], s69 offen offset:3072 sc1 lds
MV 100,a,200,a,240
s_add_u32 s69, s69, 16384
MV 104,a,200,a,244
buffer_load_dwordx4 a[48:51], v236, s[44:47], s68 offen offset:0 sc1
MV 88,a,204,a,224
buffer_load_dwordx4 a[52:55], v237, s[44:47], s68 offen offset:0 sc1
buffer_load_dwordx4 a[56:59], v236, s[44:47], s68 offen offset:1024 sc1
MV 92,a,204,a,228
buffer_load_dwordx4 a[60:63], v237, s[44:47], s68 offen offset:1024 sc1
MV 96,a,204,a,232
s_add_u32 s68, s68, 2048
MV 100,a,204,a,236
buffer_load_dwordx4 a[64:67], v236, s[44:47], s68 offen offset:0 sc1
buffer_load_dwordx4 a[68:71], v237, s[44:47], s68 offen offset:0 sc1
MV 104,a,204,a,240
buffer_load_dwordx4 a[72:75], v236, s[44:47], s68 offen offset:1024 sc1
MV 92,a,208,a,224
buffer_load_dwordx4 a[76:79], v237, s[44:47], s68 offen offset:1024 sc1
s_add_u32 s68, s68, 2048
MV 96,a,208,a,228
buffer_load_dwordx4 a[80:83], v236, s[44:47], s68 offen offset:0 sc1
MV 100,a,208,a,232
buffer_load_dwordx4 a[84:87], v237, s[44:47], s68 offen offset:0 sc1
MV 104,a,208,a,236
buffer_load_dwordx4 a[88:91], v236, s[44:47], s68 offen offset:1024 sc1
buffer_load_dwordx4 a[92:95], v237, s[44:47], s68 offen offset:1024 sc1
MV 96,a,212,a,224
s_add_u32 s68, s68, 2048
MV 100,a,212,a,228
buffer_load_dwordx4 a[96:99], v236, s[44:47], s68 offen offset:0 sc1
MV 104,a,212,a,232
buffer_load_dwordx4 a[100:103], v237, s[44:47], s68 offen offset:0 sc1
buffer_load_dwordx4 a[104:107], v236, s[44:47], s68 offen offset:1024 sc1
MV 100,a,216,a,224
buffer_load_dwordx4 a[108:111], v237, s[44:47], s68 offen offset:1024 sc1
MV 104,a,216,a,228
s_add_u32 s68, s68, 2048
s_waitcnt lgkmcnt(0)
MV 104,a,220,a,224
s_waitcnt vmcnt(40) lgkmcnt(0)
s_barrier
ds_read_b128 a[128:131], v242 offset:0
ds_read_b128 a[132:135], v242 offset:1024
ds_read_b128 a[136:139], v242 offset:2048
ds_read_b128 a[140:143], v242 offset:3072
ds_read_b128 a[144:147], v243 offset:0
ds_read_b128 a[148:151], v243 offset:1024
ds_read_b128 a[152:155], v243 offset:2048
ds_read_b128 a[156:159], v243 offset:3072
s_add_u32 m0, s70, 0
s_nop 0
buffer_load_dwordx4 v238, s[48:51], s69 offen offset:0 sc1 lds
buffer_load_dwordx4 v238, s[48:51], s69 offen offset:1024 sc1 lds
buffer_load_dwordx4 v238, s[48:51], s69 offen offset:2048 sc1 lds
buffer_load_dwordx4 v238, s[48:51], s69 offen offset:3072 sc1 lds
s_add_u32 s69, s69, 16384
s_add_u32 m0, s70, 16384
s_nop 0
buffer_load_dwordx4 v238, s[48:51], s69 offen offset:0 sc1 lds
buffer_load_dwordx4 v238, s[48:51], s69 offen offset:1024 sc1 lds
buffer_load_dwordx4 v238, s[48:51], s69 offen offset:2048 sc1 lds
buffer_load_dwordx4 v238, s[48:51], s69 offen offset:3072 sc1 lds
s_add_u32 s69, s69, 16384
s_waitcnt vmcnt(47) lgkmcnt(7)
v_mfma_f32_16x16x32_bf16 v[124:127], a[128:131], a[0:3], 0
ds_read_b128 a[160:163], v242 offset:8192
v_cvt_pk_bf16_f32 v16, v76, v77
s_waitcnt vmcnt(46)
v_mfma_f32_16x16x32_bf16 v[128:131], a[128:131], a[4:7], 0
ds_read_b128 a[164:167], v242 offset:9216
s_add_u32 m0, s70, 32768
s_waitcnt lgkmcnt(8)
v_mfma_f32_16x16x32_bf16 v[132:135], a[132:135], a[0:3], 0
v_cvt_pk_bf16_f32 v17, v78, v79
v_mfma_f32_16x16x32_bf16 v[136:139], a[132:135], a[4:7], 0
ds_read_b128 a[168:171], v242 offset:10240
ds_write_b16 v7, v16 offset:0
s_waitcnt lgkmcnt(9)
v_mfma_f32_16x16x32_bf16 v[140:143], a[136:139], a[0:3], 0
ds_read_b128 a[172:175], v242 offset:11264
v_mfma_f32_16x16x32_bf16 v[144:147], a[136:139], a[4:7], 0
buffer_load_dwordx4 v238, s[48:51], s69 offen offset:0 sc1 lds
ds_write_b16_d16_hi v7, v16 offset:8
s_waitcnt lgkmcnt(10)
v_mfma_f32_16x16x32_bf16 v[148:151], a[140:143], a[0:3], 0
ds_read_b128 a[176:179], v243 offset:8192
v_mfma_f32_16x16x32_bf16 v[152:155], a[140:143], a[4:7], 0
ds_read_b128 a[180:183], v243 offset:9216
ds_write_b16 v7, v17 offset:16
s_waitcnt lgkmcnt(12)
v_mfma_f32_16x16x32_bf16 v[156:159], a[144:147], a[0:3], 0
ds_write_b16_d16_hi v7, v17 offset:24
v_mfma_f32_16x16x32_bf16 v[160:163], a[144:147], a[4:7], 0
ds_read_b128 a[184:187], v243 offset:10240
buffer_load_dwordx4 v238, s[48:51], s69 offen offset:1024 sc1 lds
s_waitcnt lgkmcnt(13)
v_mfma_f32_16x16x32_bf16 v[164:167], a[148:151], a[0:3], 0
ds_read_b128 a[188:191], v243 offset:11264
v_cvt_pk_bf16_f32 v18, v80, v81
v_mfma_f32_16x16x32_bf16 v[168:171], a[148:151], a[4:7], 0
s_waitcnt lgkmcnt(13)
v_mfma_f32_16x16x32_bf16 v[172:175], a[152:155], a[0:3], 0
v_cvt_pk_bf16_f32 v19, v82, v83
v_mfma_f32_16x16x32_bf16 v[176:179], a[152:155], a[4:7], 0
s_waitcnt lgkmcnt(12)
v_mfma_f32_16x16x32_bf16 v[180:183], a[156:159], a[0:3], 0
buffer_load_dwordx4 a[0:3], v236, s[44:47], s68 offen offset:0 sc1
ds_write_b16 v7, v18 offset:2176
v_mfma_f32_16x16x32_bf16 v[184:187], a[156:159], a[4:7], 0
buffer_load_dwordx4 a[4:7], v237, s[44:47], s68 offen offset:0 sc1
s_waitcnt vmcnt(44) lgkmcnt(0)
s_barrier
MV 124,a,160,a,8
ds_read_b128 a[128:131], v242 offset:16384
ds_write_b16_d16_hi v7, v18 offset:2184
MV 128,a,160,a,12
ds_read_b128 a[132:135], v242 offset:17408
buffer_load_dwordx4 v238, s[48:51], s69 offen offset:2048 sc1 lds
MV 132,a,164,a,8
ds_write_b16 v7, v19 offset:2192
MV 136,a,164,a,12
ds_read_b128 a[136:139], v242 offset:18432
ds_write_b16_d16_hi v7, v19 offset:2200
MV 140,a,168,a,8
ds_read_b128 a[140:143], v242 offset:19456
v_cvt_pk_bf16_f32 v16, v84, v85
MV 144,a,168,a,12
buffer_load_dwordx4 v238, s[48:51], s69 offen offset:3072 sc1 lds
MV 148,a,172,a,8
ds_read_b128 a[144:147], v243 offset:16384
v_cvt_pk_bf16_f32 v17, v86, v87
MV 152,a,172,a,12
ds_read_b128 a[148:151], v243 offset:17408
MV 156,a,176,a,8
ds_write_b16 v7, v16 offset:4352
MV 160,a,176,a,12
ds_read_b128 a[152:155], v243 offset:18432
s_add_u32 s69, s69, 16384
MV 164,a,180,a,8
ds_read_b128 a[156:159], v243 offset:19456
ds_write_b16_d16_hi v7, v16 offset:4360
MV 168,a,180,a,12
ds_write_b16 v7, v17 offset:4368
MV 172,a,184,a,8
ds_write_b16_d16_hi v7, v17 offset:4376
MV 176,a,184,a,12
MV 180,a,188,a,8
buffer_load_dwordx4 a[8:11], v236, s[44:47], s68 offen offset:1024 sc1
v_cvt_pk_bf16_f32 v18, v88, v89
MV 184,a,188,a,12
buffer_load_dwordx4 a[12:15], v237, s[44:47], s68 offen offset:1024 sc1
s_add_u32 s68, s68, 2048
s_waitcnt vmcnt(47) lgkmcnt(14)
MV 124,a,128,a,16
ds_read_b128 a[160:163], v242 offset:24576
v_cvt_pk_bf16_f32 v19, v90, v91
s_waitcnt vmcnt(46)
MV 128,a,128,a,20
ds_read_b128 a[164:167], v242 offset:25600
s_add_u32 m0, s70, 66560
s_waitcnt lgkmcnt(14)
MV 132,a,132,a,16
ds_write_b16 v7, v18 offset:6528
MV 136,a,132,a,20
ds_read_b128 a[168:171], v242 offset:26624
ds_write_b16_d16_hi v7, v18 offset:6536
s_waitcnt lgkmcnt(15)
MV 140,a,136,a,16
ds_read_b128 a[172:175], v242 offset:27648
MV 144,a,136,a,20
buffer_load_dwordx4 v238, s[48:51], s69 offen offset:0 sc1 lds
ds_write_b16 v7, v19 offset:6544
s_waitcnt lgkmcnt(15)
MV 148,a,140,a,16
ds_read_b128 a[176:179], v243 offset:24576
MV 152,a,140,a,20
ds_read_b128 a[180:183], v243 offset:25600
ds_write_b16_d16_hi v7, v19 offset:6552
s_waitcnt lgkmcnt(15)
MV 156,a,144,a,16
v_cvt_pk_bf16_f32 v16, v92, v93
MV 160,a,144,a,20
ds_read_b128 a[184:187], v243 offset:26624
buffer_load_dwordx4 v238, s[48:51], s69 offen offset:1024 sc1 lds
MV 164,a,148,a,16
ds_read_b128 a[188:191], v243 offset:27648
v_cvt_pk_bf16_f32 v17, v94, v95
MV 168,a,148,a,20
s_waitcnt lgkmcnt(15)
MV 172,a,152,a,16
ds_write_b16 v7, v16 offset:8704
MV 176,a,152,a,20
MV 180,a,156,a,16
buffer_load_dwordx4 a[16:19], v236, s[44:47], s68 offen offset:0 sc1
ds_write_b16_d16_hi v7, v16 offset:8712
MV 184,a,156,a,20
buffer_load_dwordx4 a[20:23], v237, s[44:47], s68 offen offset:0 sc1
s_waitcnt vmcnt(44) lgkmcnt(0)
s_barrier
MV 124,a,160,a,24
ds_read_b128 a[128:131], v242 offset:32768
ds_write_b16 v7, v17 offset:8720
MV 128,a,160,a,28
ds_read_b128 a[132:135], v242 offset:33792
buffer_load_dwordx4 v238, s[48:51], s69 offen offset:2048 sc1 lds
MV 132,a,164,a,24
ds_write_b16_d16_hi v7, v17 offset:8728
MV 136,a,164,a,28
ds_read_b128 a[136:139], v242 offset:34816
v_cvt_pk_bf16_f32 v18, v96, v97
MV 140,a,168,a,24
ds_read_b128 a[140:143], v242 offset:35840
v_cvt_pk_bf16_f32 v19, v98, v99
MV 144,a,168,a,28
buffer_load_dwordx4 v238, s[48:51], s69 offen offset:3072 sc1 lds
MV 148,a,172,a,24
ds_read_b128 a[144:147], v243 offset:32768
ds_write_b16 v7, v18 offset:10880
MV 152,a,172,a,28
ds_read_b128 a[148:151], v243 offset:33792
MV 156,a,176,a,24
ds_write_b16_d16_hi v7, v18 offset:10888
MV 160,a,176,a,28
ds_read_b128 a[152:155], v243 offset:34816
s_add_u32 s69, s69, 16384
MV 164,a,180,a,24
ds_read_b128 a[156:159], v243 offset:35840
ds_write_b16 v7, v19 offset:10896
MV 168,a,180,a,28
ds_write_b16_d16_hi v7, v19 offset:10904
MV 172,a,184,a,24
v_cvt_pk_bf16_f32 v16, v100, v101
MV 176,a,184,a,28
MV 180,a,188,a,24
buffer_load_dwordx4 a[24:27], v236, s[44:47], s68 offen offset:1024 sc1
v_cvt_pk_bf16_f32 v17, v102, v103
MV 184,a,188,a,28
buffer_load_dwordx4 a[28:31], v237, s[44:47], s68 offen offset:1024 sc1
s_add_u32 s68, s68, 2048
s_waitcnt vmcnt(47) lgkmcnt(13)
MV 124,a,128,a,32
ds_read_b128 a[160:163], v242 offset:40960
ds_write_b16 v7, v16 offset:13056
s_waitcnt vmcnt(46)
MV 128,a,128,a,36
ds_read_b128 a[164:167], v242 offset:41984
s_add_u32 m0, s70, 82944
s_waitcnt lgkmcnt(14)
MV 132,a,132,a,32
ds_write_b16_d16_hi v7, v16 offset:13064
MV 136,a,132,a,36
ds_read_b128 a[168:171], v242 offset:43008
ds_write_b16 v7, v17 offset:13072
s_waitcnt lgkmcnt(15)
MV 140,a,136,a,32
ds_read_b128 a[172:175], v242 offset:44032
ds_write_b16_d16_hi v7, v17 offset:13080
MV 144,a,136,a,36
buffer_load_dwordx4 v238, s[48:51], s69 offen offset:0 sc1 lds
s_waitcnt lgkmcnt(15)
MV 148,a,140,a,32
ds_read_b128 a[176:179], v243 offset:40960
v_cvt_pk_bf16_f32 v18, v104, v105
MV 152,a,140,a,36
ds_read_b128 a[180:183], v243 offset:41984
MV 156,a,144,a,32
v_cvt_pk_bf16_f32 v19, v106, v107
MV 160,a,144,a,36
ds_read_b128 a[184:187], v243 offset:43008
buffer_load_dwordx4 v238, s[48:51], s69 offen offset:1024 sc1 lds
s_waitcnt lgkmcnt(15)
MV 164,a,148,a,32
ds_read_b128 a[188:191], v243 offset:44032
ds_write_b16 v7, v18 offset:15232
MV 168,a,148,a,36
ds_write_b16_d16_hi v7, v18 offset:15240
s_waitcnt lgkmcnt(15)
MV 172,a,152,a,32
ds_write_b16 v7, v19 offset:15248
MV 176,a,152,a,36
MV 180,a,156,a,32
buffer_load_dwordx4 a[32:35], v236, s[44:47], s68 offen offset:0 sc1
ds_write_b16_d16_hi v7, v19 offset:15256
MV 184,a,156,a,36
buffer_load_dwordx4 a[36:39], v237, s[44:47], s68 offen offset:0 sc1
s_waitcnt vmcnt(44) lgkmcnt(0)
s_barrier
MV 124,a,160,a,40
ds_read_b128 a[128:131], v242 offset:49152
ds_read_b64 v[108:109], v8 offset:0
MV 128,a,160,a,44
ds_read_b128 a[132:135], v242 offset:50176
buffer_load_dwordx4 v238, s[48:51], s69 offen offset:2048 sc1 lds
MV 132,a,164,a,40
ds_read_b64 v[110:111], v8 offset:8
MV 136,a,164,a,44
ds_read_b128 a[136:139], v242 offset:51200
MV 140,a,168,a,40
ds_read_b128 a[140:143], v242 offset:52224
ds_read_b64 v[112:113], v8 offset:1088
MV 144,a,168,a,44
buffer_load_dwordx4 v238, s[48:51], s69 offen offset:3072 sc1 lds
MV 148,a,172,a,40
ds_read_b128 a[144:147], v243 offset:49152
ds_read_b64 v[114:115], v8 offset:1096
MV 152,a,172,a,44
ds_read_b128 a[148:151], v243 offset:50176
MV 156,a,176,a,40
ds_read_b64 v[116:117], v8 offset:2176
MV 160,a,176,a,44
ds_read_b128 a[152:155], v243 offset:51200
s_add_u32 s69, s69, 16384
MV 164,a,180,a,40
ds_read_b128 a[156:159], v243 offset:52224
ds_read_b64 v[118:119], v8 offset:2184
MV 168,a,180,a,44
MV 172,a,184,a,40
ds_read_b64 v[120:121], v8 offset:3264
MV 176,a,184,a,44
MV 180,a,188,a,40
buffer_load_dwordx4 a[40:43], v236, s[44:47], s68 offen offset:1024 sc1
ds_read_b64 v[122:123], v8 offset:3272
MV 184,a,188,a,44
buffer_load_dwordx4 a[44:47], v237, s[44:47], s68 offen offset:1024 sc1
s_add_u32 s68, s68, 2048
s_waitcnt vmcnt(47) lgkmcnt(15)
MV 124,a,128,a,48
ds_read_b128 a[160:163], v242 offset:57344
s_waitcnt lgkmcnt(13)
buffer_store_dwordx4 v[108:111], v9, s[24:27], 0 offen offset:0 sc1
s_waitcnt vmcnt(47)
MV 128,a,128,a,52
ds_read_b128 a[164:167], v242 offset:58368
s_add_u32 m0, s70, 99328
MV 132,a,132,a,48
MV 136,a,132,a,52
ds_read_b128 a[168:171], v242 offset:59392
s_waitcnt lgkmcnt(14)
MV 140,a,136,a,48
ds_read_b128 a[172:175], v242 offset:60416
MV 144,a,136,a,52
buffer_load_dwordx4 v238, s[48:51], s69 offen offset:0 sc1 lds
s_waitcnt lgkmcnt(14)
MV 148,a,140,a,48
ds_read_b128 a[176:179], v243 offset:57344
MV 152,a,140,a,52
ds_read_b128 a[180:183], v243 offset:58368
s_waitcnt lgkmcnt(14)
MV 156,a,144,a,48
s_waitcnt lgkmcnt(13)
buffer_store_dwordx4 v[112:115], v9, s[24:27], 0 offen offset:1024 sc1
MV 160,a,144,a,52
ds_read_b128 a[184:187], v243 offset:59392
buffer_load_dwordx4 v238, s[48:51], s69 offen offset:1024 sc1 lds
s_waitcnt lgkmcnt(13)
MV 164,a,148,a,48
ds_read_b128 a[188:191], v243 offset:60416
MV 168,a,148,a,52
s_waitcnt lgkmcnt(12)
MV 172,a,152,a,48
MV 176,a,152,a,52
s_waitcnt lgkmcnt(11)
MV 180,a,156,a,48
buffer_load_dwordx4 a[48:51], v236, s[44:47], s68 offen offset:0 sc1
MV 184,a,156,a,52
buffer_load_dwordx4 a[52:55], v237, s[44:47], s68 offen offset:0 sc1
s_waitcnt vmcnt(34) lgkmcnt(0)
s_barrier
MV 124,a,160,a,56
ds_read_b128 a[128:131], v244 offset:0
buffer_store_dwordx4 v[116:119], v9, s[24:27], 0 offen offset:2048 sc1
MV 128,a,160,a,60
ds_read_b128 a[132:135], v244 offset:1024
buffer_load_dwordx4 v238, s[48:51], s69 offen offset:2048 sc1 lds
MV 132,a,164,a,56
MV 136,a,164,a,60
ds_read_b128 a[136:139], v244 offset:2048
MV 140,a,168,a,56
ds_read_b128 a[140:143], v244 offset:3072
MV 144,a,168,a,60
buffer_load_dwordx4 v238, s[48:51], s69 offen offset:3072 sc1 lds
MV 148,a,172,a,56
ds_read_b128 a[144:147], v245 offset:0
MV 152,a,172,a,60
ds_read_b128 a[148:151], v245 offset:1024
MV 156,a,176,a,56
buffer_store_dwordx4 v[120:123], v9, s[24:27], 0 offen offset:3072 sc1
MV 160,a,176,a,60
ds_read_b128 a[152:155], v245 offset:2048
s_add_u32 s69, s69, 16384
MV 164,a,180,a,56
ds_read_b128 a[156:159], v245 offset:3072
MV 168,a,180,a,60
MV 172,a,184,a,56
MV 176,a,184,a,60
MV 180,a,188,a,56
buffer_load_dwordx4 a[56:59], v236, s[44:47], s68 offen offset:1024 sc1
MV 184,a,188,a,60
buffer_load_dwordx4 a[60:63], v237, s[44:47], s68 offen offset:1024 sc1
s_add_u32 s68, s68, 2048
s_waitcnt lgkmcnt(7)
MV 124,a,128,a,64
ds_read_b128 a[160:163], v244 offset:8192
MV 128,a,128,a,68
ds_read_b128 a[164:167], v244 offset:9216
s_add_u32 m0, s70, 115712
s_waitcnt lgkmcnt(8)
MV 132,a,132,a,64
MV 136,a,132,a,68
ds_read_b128 a[168:171], v244 offset:10240
s_waitcnt lgkmcnt(8)
MV 140,a,136,a,64
ds_read_b128 a[172:175], v244 offset:11264
MV 144,a,136,a,68
buffer_load_dwordx4 v238, s[48:51], s69 offen offset:0 sc1 lds
s_waitcnt lgkmcnt(8)
MV 148,a,140,a,64
ds_read_b128 a[176:179], v245 offset:8192
MV 152,a,140,a,68
ds_read_b128 a[180:183], v245 offset:9216
s_waitcnt lgkmcnt(9)
MV 156,a,144,a,64
MV 160,a,144,a,68
ds_read_b128 a[184:187], v245 offset:10240
buffer_load_dwordx4 v238, s[48:51], s69 offen offset:1024 sc1 lds
s_waitcnt lgkmcnt(9)
MV 164,a,148,a,64
ds_read_b128 a[188:191], v245 offset:11264
MV 168,a,148,a,68
s_waitcnt lgkmcnt(9)
MV 172,a,152,a,64
MV 176,a,152,a,68
s_waitcnt lgkmcnt(8)
MV 180,a,156,a,64
buffer_load_dwordx4 a[64:67], v236, s[44:47], s68 offen offset:0 sc1
MV 184,a,156,a,68
buffer_load_dwordx4 a[68:71], v237, s[44:47], s68 offen offset:0 sc1
s_waitcnt vmcnt(40) lgkmcnt(0)
s_barrier
MV 124,a,160,a,72
ds_read_b128 a[128:131], v244 offset:16384
MV 128,a,160,a,76
ds_read_b128 a[132:135], v244 offset:17408
buffer_load_dwordx4 v238, s[48:51], s69 offen offset:2048 sc1 lds
MV 132,a,164,a,72
MV 136,a,164,a,76
ds_read_b128 a[136:139], v244 offset:18432
MV 140,a,168,a,72
ds_read_b128 a[140:143], v244 offset:19456
MV 144,a,168,a,76
buffer_load_dwordx4 v238, s[48:51], s69 offen offset:3072 sc1 lds
MV 148,a,172,a,72
ds_read_b128 a[144:147], v245 offset:16384
MV 152,a,172,a,76
ds_read_b128 a[148:151], v245 offset:17408
MV 156,a,176,a,72
MV 160,a,176,a,76
ds_read_b128 a[152:155], v245 offset:18432
s_add_u32 s69, s69, 16384
MV 164,a,180,a,72
ds_read_b128 a[156:159], v245 offset:19456
MV 168,a,180,a,76
MV 172,a,184,a,72
MV 176,a,184,a,76
MV 180,a,188,a,72
buffer_load_dwordx4 a[72:75], v236, s[44:47], s68 offen offset:1024 sc1
MV 184,a,188,a,76
buffer_load_dwordx4 a[76:79], v237, s[44:47], s68 offen offset:1024 sc1
s_add_u32 s68, s68, 2048
s_waitcnt lgkmcnt(7)
MV 124,a,128,a,80
ds_read_b128 a[160:163], v244 offset:24576
MV 128,a,128,a,84
ds_read_b128 a[164:167], v244 offset:25600
s_add_u32 m0, s70, 0
s_waitcnt lgkmcnt(8)
MV 132,a,132,a,80
MV 136,a,132,a,84
ds_read_b128 a[168:171], v244 offset:26624
s_waitcnt lgkmcnt(8)
MV 140,a,136,a,80
ds_read_b128 a[172:175], v244 offset:27648
MV 144,a,136,a,84
buffer_load_dwordx4 v238, s[48:51], s69 offen offset:0 sc1 lds
s_waitcnt lgkmcnt(8)
MV 148,a,140,a,80
ds_read_b128 a[176:179], v245 offset:24576
MV 152,a,140,a,84
ds_read_b128 a[180:183], v245 offset:25600
s_waitcnt lgkmcnt(9)
MV 156,a,144,a,80
MV 160,a,144,a,84
ds_read_b128 a[184:187], v245 offset:26624
buffer_load_dwordx4 v238, s[48:51], s69 offen offset:1024 sc1 lds
s_waitcnt lgkmcnt(9)
MV 164,a,148,a,80
ds_read_b128 a[188:191], v245 offset:27648
MV 168,a,148,a,84
s_waitcnt lgkmcnt(9)
MV 172,a,152,a,80
MV 176,a,152,a,84
s_waitcnt lgkmcnt(8)
MV 180,a,156,a,80
buffer_load_dwordx4 a[80:83], v236, s[44:47], s68 offen offset:0 sc1
MV 184,a,156,a,84
buffer_load_dwordx4 a[84:87], v237, s[44:47], s68 offen offset:0 sc1
s_waitcnt vmcnt(42) lgkmcnt(0)
s_barrier
MV 124,a,160,a,88
ds_read_b128 a[128:131], v244 offset:32768
MV 128,a,160,a,92
ds_read_b128 a[132:135], v244 offset:33792
buffer_load_dwordx4 v238, s[48:51], s69 offen offset:2048 sc1 lds
MV 132,a,164,a,88
MV 136,a,164,a,92
ds_read_b128 a[136:139], v244 offset:34816
MV 140,a,168,a,88
ds_read_b128 a[140:143], v244 offset:35840
MV 144,a,168,a,92
buffer_load_dwordx4 v238, s[48:51], s69 offen offset:3072 sc1 lds
MV 148,a,172,a,88
ds_read_b128 a[144:147], v245 offset:32768
MV 152,a,172,a,92
ds_read_b128 a[148:151], v245 offset:33792
MV 156,a,176,a,88
MV 160,a,176,a,92
ds_read_b128 a[152:155], v245 offset:34816
s_add_u32 s69, s69, 16384
MV 164,a,180,a,88
ds_read_b128 a[156:159], v245 offset:35840
MV 168,a,180,a,92
MV 172,a,184,a,88
MV 176,a,184,a,92
MV 180,a,188,a,88
buffer_load_dwordx4 a[88:91], v236, s[44:47], s68 offen offset:1024 sc1
MV 184,a,188,a,92
buffer_load_dwordx4 a[92:95], v237, s[44:47], s68 offen offset:1024 sc1
s_add_u32 s68, s68, 2048
s_waitcnt lgkmcnt(7)
MV 124,a,128,a,96
ds_read_b128 a[160:163], v244 offset:40960
MV 128,a,128,a,100
ds_read_b128 a[164:167], v244 offset:41984
s_add_u32 m0, s70, 16384
s_waitcnt lgkmcnt(8)
MV 132,a,132,a,96
MV 136,a,132,a,100
ds_read_b128 a[168:171], v244 offset:43008
s_waitcnt lgkmcnt(8)
MV 140,a,136,a,96
ds_read_b128 a[172:175], v244 offset:44032
MV 144,a,136,a,100
buffer_load_dwordx4 v238, s[48:51], s69 offen offset:0 sc1 lds
s_waitcnt lgkmcnt(8)
MV 148,a,140,a,96
ds_read_b128 a[176:179], v245 offset:40960
MV 152,a,140,a,100
ds_read_b128 a[180:183], v245 offset:41984
s_waitcnt lgkmcnt(9)
MV 156,a,144,a,96
MV 160,a,144,a,100
ds_read_b128 a[184:187], v245 offset:43008
buffer_load_dwordx4 v238, s[48:51], s69 offen offset:1024 sc1 lds
s_waitcnt lgkmcnt(9)
MV 164,a,148,a,96
ds_read_b128 a[188:191], v245 offset:44032
MV 168,a,148,a,100
s_waitcnt lgkmcnt(9)
MV 172,a,152,a,96
MV 176,a,152,a,100
s_waitcnt lgkmcnt(8)
MV 180,a,156,a,96
buffer_load_dwordx4 a[96:99], v236, s[44:47], s68 offen offset:0 sc1
MV 184,a,156,a,100
buffer_load_dwordx4 a[100:103], v237, s[44:47], s68 offen offset:0 sc1
s_waitcnt vmcnt(42) lgkmcnt(0)
s_barrier
MV 124,a,160,a,104
ds_read_b128 a[128:131], v242 offset:0
MV 128,a,160,a,108
ds_read_b128 a[132:135], v242 offset:1024
buffer_load_dwordx4 v238, s[48:51], s69 offen offset:2048 sc1 lds
MV 132,a,164,a,104
MV 136,a,164,a,108
ds_read_b128 a[136:139], v242 offset:2048
MV 140,a,168,a,104
ds_read_b128 a[140:143], v242 offset:3072
MV 144,a,168,a,108
buffer_load_dwordx4 v238, s[48:51], s69 offen offset:3072 sc1 lds
MV 148,a,172,a,104
ds_read_b128 a[144:147], v243 offset:0
MV 152,a,172,a,108
ds_read_b128 a[148:151], v243 offset:1024
MV 156,a,176,a,104
MV 160,a,176,a,108
ds_read_b128 a[152:155], v243 offset:2048
s_add_u32 s69, s69, 16384
MV 164,a,180,a,104
ds_read_b128 a[156:159], v243 offset:3072
MV 168,a,180,a,108
MV 172,a,184,a,104
MV 176,a,184,a,108
MV 180,a,188,a,104
buffer_load_dwordx4 a[104:107], v236, s[44:47], s68 offen offset:1024 sc1
MV 184,a,188,a,108
buffer_load_dwordx4 a[108:111], v237, s[44:47], s68 offen offset:1024 sc1
s_add_u32 s68, s68, 2048
s_waitcnt lgkmcnt(7)
MV 124,a,128,a,0
ds_read_b128 a[160:163], v242 offset:8192
MV 128,a,128,a,4
ds_read_b128 a[164:167], v242 offset:9216
s_add_u32 m0, s70, 32768
s_waitcnt lgkmcnt(8)
MV 132,a,132,a,0
MV 136,a,132,a,4
ds_read_b128 a[168:171], v242 offset:10240
s_waitcnt lgkmcnt(8)
MV 140,a,136,a,0
ds_read_b128 a[172:175], v242 offset:11264
MV 144,a,136,a,4
buffer_load_dwordx4 v238, s[48:51], s69 offen offset:0 sc1 lds
s_waitcnt lgkmcnt(8)
MV 148,a,140,a,0
ds_read_b128 a[176:179], v243 offset:8192
MV 152,a,140,a,4
ds_read_b128 a[180:183], v243 offset:9216
s_waitcnt lgkmcnt(9)
MV 156,a,144,a,0
MV 160,a,144,a,4
ds_read_b128 a[184:187], v243 offset:10240
buffer_load_dwordx4 v238, s[48:51], s69 offen offset:1024 sc1 lds
s_waitcnt lgkmcnt(9)
MV 164,a,148,a,0
ds_read_b128 a[188:191], v243 offset:11264
MV 168,a,148,a,4
s_waitcnt lgkmcnt(9)
MV 172,a,152,a,0
MV 176,a,152,a,4
s_waitcnt lgkmcnt(8)
MV 180,a,156,a,0
buffer_load_dwordx4 a[0:3], v236, s[44:47], s68 offen offset:0 sc1
MV 184,a,156,a,4
buffer_load_dwordx4 a[4:7], v237, s[44:47], s68 offen offset:0 sc1
s_waitcnt vmcnt(42) lgkmcnt(0)
s_barrier
MV 124,a,160,a,8
ds_read_b128 a[128:131], v242 offset:16384
MV 128,a,160,a,12
ds_read_b128 a[132:135], v242 offset:17408
buffer_load_dwordx4 v238, s[48:51], s69 offen offset:2048 sc1 lds
MV 132,a,164,a,8
MV 136,a,164,a,12
ds_read_b128 a[136:139], v242 offset:18432
MV 140,a,168,a,8
ds_read_b128 a[140:143], v242 offset:19456
MV 144,a,168,a,12
buffer_load_dwordx4 v238, s[48:51], s69 offen offset:3072 sc1 lds
MV 148,a,172,a,8
ds_read_b128 a[144:147], v243 offset:16384
MV 152,a,172,a,12
ds_read_b128 a[148:151], v243 offset:17408
MV 156,a,176,a,8
MV 160,a,176,a,12
ds_read_b128 a[152:155], v243 offset:18432
s_add_u32 s69, s69, 16384
MV 164,a,180,a,8
ds_read_b128 a[156:159], v243 offset:19456
MV 168,a,180,a,12
MV 172,a,184,a,8
MV 176,a,184,a,12
MV 180,a,188,a,8
buffer_load_dwordx4 a[8:11], v236, s[44:47], s68 offen offset:1024 sc1
MV 184,a,188,a,12
buffer_load_dwordx4 a[12:15], v237, s[44:47], s68 offen offset:1024 sc1
s_add_u32 s68, s68, 2048
s_waitcnt lgkmcnt(7)
MV 124,a,128,a,16
ds_read_b128 a[160:163], v242 offset:24576
MV 128,a,128,a,20
ds_read_b128 a[164:167], v242 offset:25600
s_add_u32 m0, s70, 66560
s_waitcnt lgkmcnt(8)
MV 132,a,132,a,16
MV 136,a,132,a,20
ds_read_b128 a[168:171], v242 offset:26624
s_waitcnt lgkmcnt(8)
MV 140,a,136,a,16
ds_read_b128 a[172:175], v242 offset:27648
MV 144,a,136,a,20
buffer_load_dwordx4 v238, s[48:51], s69 offen offset:0 sc1 lds
s_waitcnt lgkmcnt(8)
MV 148,a,140,a,16
ds_read_b128 a[176:179], v243 offset:24576
MV 152,a,140,a,20
ds_read_b128 a[180:183], v243 offset:25600
s_waitcnt lgkmcnt(9)
MV 156,a,144,a,16
MV 160,a,144,a,20
ds_read_b128 a[184:187], v243 offset:26624
buffer_load_dwordx4 v238, s[48:51], s69 offen offset:1024 sc1 lds
s_waitcnt lgkmcnt(9)
MV 164,a,148,a,16
ds_read_b128 a[188:191], v243 offset:27648
MV 168,a,148,a,20
s_waitcnt lgkmcnt(9)
MV 172,a,152,a,16
MV 176,a,152,a,20
s_waitcnt lgkmcnt(8)
MV 180,a,156,a,16
buffer_load_dwordx4 a[16:19], v236, s[44:47], s68 offen offset:0 sc1
MV 184,a,156,a,20
buffer_load_dwordx4 a[20:23], v237, s[44:47], s68 offen offset:0 sc1
s_waitcnt vmcnt(39) lgkmcnt(0)
s_barrier
MV 124,a,160,a,24
ds_read_b128 a[128:131], v242 offset:32768
MV 128,a,160,a,28
ds_read_b128 a[132:135], v242 offset:33792
buffer_load_dwordx4 v238, s[48:51], s69 offen offset:2048 sc1 lds
MV 132,a,164,a,24
MV 136,a,164,a,28
ds_read_b128 a[136:139], v242 offset:34816
MV 140,a,168,a,24
ds_read_b128 a[140:143], v242 offset:35840
MV 144,a,168,a,28
buffer_load_dwordx4 v238, s[48:51], s69 offen offset:3072 sc1 lds
MV 148,a,172,a,24
ds_read_b128 a[144:147], v243 offset:32768
MV 152,a,172,a,28
ds_read_b128 a[148:151], v243 offset:33792
MV 156,a,176,a,24
MV 160,a,176,a,28
ds_read_b128 a[152:155], v243 offset:34816
s_add_u32 s69, s69, 16384
MV 164,a,180,a,24
ds_read_b128 a[156:159], v243 offset:35840
MV 168,a,180,a,28
MV 172,a,184,a,24
MV 176,a,184,a,28
MV 180,a,188,a,24
buffer_load_dwordx4 a[24:27], v236, s[44:47], s68 offen offset:1024 sc1
MV 184,a,188,a,28
buffer_load_dwordx4 a[28:31], v237, s[44:47], s68 offen offset:1024 sc1
s_add_u32 s68, s68, 2048
s_waitcnt lgkmcnt(7)
MV 124,a,128,a,32
ds_read_b128 a[160:163], v242 offset:40960
MV 128,a,128,a,36
ds_read_b128 a[164:167], v242 offset:41984
s_add_u32 m0, s70, 82944
s_waitcnt lgkmcnt(8)
MV 132,a,132,a,32
MV 136,a,132,a,36
ds_read_b128 a[168:171], v242 offset:43008
s_waitcnt lgkmcnt(8)
MV 140,a,136,a,32
ds_read_b128 a[172:175], v242 offset:44032
MV 144,a,136,a,36
buffer_load_dwordx4 v238, s[48:51], s69 offen offset:0 sc1 lds
s_waitcnt lgkmcnt(8)
MV 148,a,140,a,32
ds_read_b128 a[176:179], v243 offset:40960
MV 152,a,140,a,36
ds_read_b128 a[180:183], v243 offset:41984
s_waitcnt lgkmcnt(9)
MV 156,a,144,a,32
MV 160,a,144,a,36
ds_read_b128 a[184:187], v243 offset:43008
buffer_load_dwordx4 v238, s[48:51], s69 offen offset:1024 sc1 lds
s_waitcnt lgkmcnt(9)
MV 164,a,148,a,32
ds_read_b128 a[188:191], v243 offset:44032
MV 168,a,148,a,36
s_waitcnt lgkmcnt(9)
MV 172,a,152,a,32
MV 176,a,152,a,36
s_waitcnt lgkmcnt(8)
MV 180,a,156,a,32
buffer_load_dwordx4 a[32:35], v236, s[44:47], s68 offen offset:0 sc1
MV 184,a,156,a,36
buffer_load_dwordx4 a[36:39], v237, s[44:47], s68 offen offset:0 sc1
s_waitcnt vmcnt(38) lgkmcnt(0)
s_barrier
MV 124,a,160,a,40
ds_read_b128 a[128:131], v242 offset:49152
MV 128,a,160,a,44
ds_read_b128 a[132:135], v242 offset:50176
buffer_load_dwordx4 v238, s[48:51], s69 offen offset:2048 sc1 lds
MV 132,a,164,a,40
MV 136,a,164,a,44
ds_read_b128 a[136:139], v242 offset:51200
MV 140,a,168,a,40
ds_read_b128 a[140:143], v242 offset:52224
MV 144,a,168,a,44
buffer_load_dwordx4 v238, s[48:51], s69 offen offset:3072 sc1 lds
MV 148,a,172,a,40
ds_read_b128 a[144:147], v243 offset:49152
MV 152,a,172,a,44
ds_read_b128 a[148:151], v243 offset:50176
MV 156,a,176,a,40
MV 160,a,176,a,44
ds_read_b128 a[152:155], v243 offset:51200
s_add_u32 s69, s69, 16384
MV 164,a,180,a,40
ds_read_b128 a[156:159], v243 offset:52224
MV 168,a,180,a,44
MV 172,a,184,a,40
MV 176,a,184,a,44
MV 180,a,188,a,40
buffer_load_dwordx4 a[40:43], v236, s[44:47], s68 offen offset:1024 sc1
MV 184,a,188,a,44
buffer_load_dwordx4 a[44:47], v237, s[44:47], s68 offen offset:1024 sc1
s_add_u32 s68, s68, 2048
s_waitcnt lgkmcnt(7)
MV 124,a,128,a,48
ds_read_b128 a[160:163], v242 offset:57344
MV 128,a,128,a,52
ds_read_b128 a[164:167], v242 offset:58368
s_add_u32 m0, s70, 99328
s_waitcnt lgkmcnt(8)
MV 132,a,132,a,48
MV 136,a,132,a,52
ds_read_b128 a[168:171], v242 offset:59392
s_waitcnt lgkmcnt(8)
MV 140,a,136,a,48
ds_read_b128 a[172:175], v242 offset:60416
MV 144,a,136,a,52
buffer_load_dwordx4 v238, s[48:51], s69 offen offset:0 sc1 lds
s_waitcnt lgkmcnt(8)
MV 148,a,140,a,48
ds_read_b128 a[176:179], v243 offset:57344
MV 152,a,140,a,52
ds_read_b128 a[180:183], v243 offset:58368
s_waitcnt lgkmcnt(9)
MV 156,a,144,a,48
MV 160,a,144,a,52
ds_read_b128 a[184:187], v243 offset:59392
buffer_load_dwordx4 v238, s[48:51], s69 offen offset:1024 sc1 lds
s_waitcnt lgkmcnt(9)
MV 164,a,148,a,48
ds_read_b128 a[188:191], v243 offset:60416
MV 168,a,148,a,52
s_waitcnt lgkmcnt(9)
MV 172,a,152,a,48
MV 176,a,152,a,52
s_waitcnt lgkmcnt(8)
MV 180,a,156,a,48
buffer_load_dwordx4 a[48:51], v236, s[44:47], s68 offen offset:0 sc1
MV 184,a,156,a,52
buffer_load_dwordx4 a[52:55], v237, s[44:47], s68 offen offset:0 sc1
s_waitcnt vmcnt(38) lgkmcnt(0)
s_barrier
v_mov_b32 v253, 1
s_lshl_b32 s36, s2, 2
buffer_store_dword v253, v255, s[8:11], s36 offen offset:3072 sc1
MV 124,a,160,a,56
ds_read_b128 a[128:131], v244 offset:0
MV 128,a,160,a,60
ds_read_b128 a[132:135], v244 offset:1024
buffer_load_dwordx4 v238, s[48:51], s69 offen offset:2048 sc1 lds
MV 132,a,164,a,56
MV 136,a,164,a,60
ds_read_b128 a[136:139], v244 offset:2048
MV 140,a,168,a,56
ds_read_b128 a[140:143], v244 offset:3072
MV 144,a,168,a,60
buffer_load_dwordx4 v238, s[48:51], s69 offen offset:3072 sc1 lds
MV 148,a,172,a,56
ds_read_b128 a[144:147], v245 offset:0
MV 152,a,172,a,60
ds_read_b128 a[148:151], v245 offset:1024
MV 156,a,176,a,56
MV 160,a,176,a,60
ds_read_b128 a[152:155], v245 offset:2048
s_add_u32 s69, s69, 16384
MV 164,a,180,a,56
ds_read_b128 a[156:159], v245 offset:3072
MV 168,a,180,a,60
MV 172,a,184,a,56
MV 176,a,184,a,60
MV 180,a,188,a,56
buffer_load_dwordx4 a[56:59], v236, s[44:47], s68 offen offset:1024 sc1
MV 184,a,188,a,60
buffer_load_dwordx4 a[60:63], v237, s[44:47], s68 offen offset:1024 sc1
s_add_u32 s68, s68, 2048
s_waitcnt lgkmcnt(7)
MV 124,a,128,a,64
ds_read_b128 a[160:163], v244 offset:8192
MV 128,a,128,a,68
ds_read_b128 a[164:167], v244 offset:9216
s_add_u32 m0, s70, 115712
s_waitcnt lgkmcnt(8)
MV 132,a,132,a,64
MV 136,a,132,a,68
ds_read_b128 a[168:171], v244 offset:10240
s_waitcnt lgkmcnt(8)
MV 140,a,136,a,64
ds_read_b128 a[172:175], v244 offset:11264
MV 144,a,136,a,68
buffer_load_dwordx4 v238, s[48:51], s69 offen offset:0 sc1 lds
s_waitcnt lgkmcnt(8)
MV 148,a,140,a,64
ds_read_b128 a[176:179], v245 offset:8192
MV 152,a,140,a,68
ds_read_b128 a[180:183], v245 offset:9216
s_waitcnt lgkmcnt(9)
MV 156,a,144,a,64
MV 160,a,144,a,68
ds_read_b128 a[184:187], v245 offset:10240
buffer_load_dwordx4 v238, s[48:51], s69 offen offset:1024 sc1 lds
s_waitcnt lgkmcnt(9)
MV 164,a,148,a,64
ds_read_b128 a[188:191], v245 offset:11264
MV 168,a,148,a,68
s_waitcnt lgkmcnt(9)
MV 172,a,152,a,64
MV 176,a,152,a,68
s_waitcnt lgkmcnt(8)
MV 180,a,156,a,64
buffer_load_dwordx4 a[64:67], v236, s[44:47], s68 offen offset:0 sc1
MV 184,a,156,a,68
buffer_load_dwordx4 a[68:71], v237, s[44:47], s68 offen offset:0 sc1
s_waitcnt vmcnt(39) lgkmcnt(0)
s_barrier
MV 124,a,160,a,72
ds_read_b128 a[128:131], v244 offset:16384
MV 128,a,160,a,76
ds_read_b128 a[132:135], v244 offset:17408
buffer_load_dwordx4 v238, s[48:51], s69 offen offset:2048 sc1 lds
MV 132,a,164,a,72
MV 136,a,164,a,76
ds_read_b128 a[136:139], v244 offset:18432
MV 140,a,168,a,72
ds_read_b128 a[140:143], v244 offset:19456
MV 144,a,168,a,76
buffer_load_dwordx4 v238, s[48:51], s69 offen offset:3072 sc1 lds
MV 148,a,172,a,72
ds_read_b128 a[144:147], v245 offset:16384
MV 152,a,172,a,76
ds_read_b128 a[148:151], v245 offset:17408
MV 156,a,176,a,72
MV 160,a,176,a,76
ds_read_b128 a[152:155], v245 offset:18432
s_add_u32 s69, s69, 16384
MV 164,a,180,a,72
ds_read_b128 a[156:159], v245 offset:19456
MV 168,a,180,a,76
MV 172,a,184,a,72
MV 176,a,184,a,76
MV 180,a,188,a,72
buffer_load_dwordx4 a[72:75], v236, s[44:47], s68 offen offset:1024 sc1
MV 184,a,188,a,76
buffer_load_dwordx4 a[76:79], v237, s[44:47], s68 offen offset:1024 sc1
s_add_u32 s68, s68, 2048
s_waitcnt lgkmcnt(7)
MV 124,a,128,a,80
ds_read_b128 a[160:163], v244 offset:24576
v_and_b32 v254, 15, v1
MV 128,a,128,a,84
ds_read_b128 a[164:167], v244 offset:25600
s_add_u32 m0, s70, 0
s_waitcnt lgkmcnt(8)
MV 132,a,132,a,80
MV 136,a,132,a,84
ds_read_b128 a[168:171], v244 offset:26624
s_waitcnt lgkmcnt(8)
MV 140,a,136,a,80
ds_read_b128 a[172:175], v244 offset:27648
s_lshl_b32 s36, s82, 4
MV 144,a,136,a,84
buffer_load_dwordx4 v238, s[48:51], s69 offen offset:0 sc1 lds
s_waitcnt lgkmcnt(8)
MV 148,a,140,a,80
ds_read_b128 a[176:179], v245 offset:24576
MV 152,a,140,a,84
ds_read_b128 a[180:183], v245 offset:25600
s_waitcnt lgkmcnt(9)
MV 156,a,144,a,80
v_add_u32 v254, s36, v254
MV 160,a,144,a,84
ds_read_b128 a[184:187], v245 offset:26624
buffer_load_dwordx4 v238, s[48:51], s69 offen offset:1024 sc1 lds
s_waitcnt lgkmcnt(9)
MV 164,a,148,a,80
ds_read_b128 a[188:191], v245 offset:27648
MV 168,a,148,a,84
s_waitcnt lgkmcnt(9)
MV 172,a,152,a,80
v_lshlrev_b32 v254, 2, v254
MV 176,a,152,a,84
s_waitcnt lgkmcnt(8)
MV 180,a,156,a,80
buffer_load_dwordx4 a[80:83], v236, s[44:47], s68 offen offset:0 sc1
MV 184,a,156,a,84
buffer_load_dwordx4 a[84:87], v237, s[44:47], s68 offen offset:0 sc1
s_waitcnt vmcnt(39) lgkmcnt(0)
s_barrier
MV 124,a,160,a,88
ds_read_b128 a[128:131], v244 offset:32768
buffer_load_dword v253, v254, s[8:11], 0 offen offset:3072 sc1
MV 128,a,160,a,92
ds_read_b128 a[132:135], v244 offset:33792
buffer_load_dwordx4 v238, s[48:51], s69 offen offset:2048 sc1 lds
MV 132,a,164,a,88
MV 136,a,164,a,92
ds_read_b128 a[136:139], v244 offset:34816
MV 140,a,168,a,88
ds_read_b128 a[140:143], v244 offset:35840
MV 144,a,168,a,92
buffer_load_dwordx4 v238, s[48:51], s69 offen offset:3072 sc1 lds
MV 148,a,172,a,88
ds_read_b128 a[144:147], v245 offset:32768
MV 152,a,172,a,92
ds_read_b128 a[148:151], v245 offset:33792
MV 156,a,176,a,88
MV 160,a,176,a,92
ds_read_b128 a[152:155], v245 offset:34816
s_add_u32 s69, s69, 16384
MV 164,a,180,a,88
ds_read_b128 a[156:159], v245 offset:35840
MV 168,a,180,a,92
MV 172,a,184,a,88
MV 176,a,184,a,92
MV 180,a,188,a,88
buffer_load_dwordx4 a[88:91], v236, s[44:47], s68 offen offset:1024 sc1
MV 184,a,188,a,92
buffer_load_dwordx4 a[92:95], v237, s[44:47], s68 offen offset:1024 sc1
s_add_u32 s68, s68, 2048
s_waitcnt lgkmcnt(7)
MV 124,a,128,a,96
ds_read_b128 a[160:163], v244 offset:40960
MV 128,a,128,a,100
ds_read_b128 a[164:167], v244 offset:41984
s_add_u32 m0, s70, 16384
s_waitcnt lgkmcnt(8)
MV 132,a,132,a,96
MV 136,a,132,a,100
ds_read_b128 a[168:171], v244 offset:43008
s_waitcnt lgkmcnt(8)
MV 140,a,136,a,96
ds_read_b128 a[172:175], v244 offset:44032
MV 144,a,136,a,100
buffer_load_dwordx4 v238, s[48:51], s69 offen offset:0 sc1 lds
s_waitcnt lgkmcnt(8)
MV 148,a,140,a,96
ds_read_b128 a[176:179], v245 offset:40960
MV 152,a,140,a,100
ds_read_b128 a[180:183], v245 offset:41984
s_waitcnt lgkmcnt(9)
MV 156,a,144,a,96
MV 160,a,144,a,100
ds_read_b128 a[184:187], v245 offset:43008
buffer_load_dwordx4 v238, s[48:51], s69 offen offset:1024 sc1 lds
s_waitcnt lgkmcnt(9)
MV 164,a,148,a,96
ds_read_b128 a[188:191], v245 offset:44032
MV 168,a,148,a,100
s_waitcnt lgkmcnt(9)
MV 172,a,152,a,96
MV 176,a,152,a,100
s_waitcnt lgkmcnt(8)
MV 180,a,156,a,96
buffer_load_dwordx4 a[96:99], v236, s[44:47], s68 offen offset:0 sc1
MV 184,a,156,a,100
buffer_load_dwordx4 a[100:103], v237, s[44:47], s68 offen offset:0 sc1
s_waitcnt vmcnt(40) lgkmcnt(0)
s_barrier
MV 124,a,160,a,104
ds_read_b128 a[128:131], v242 offset:0
MV 128,a,160,a,108
ds_read_b128 a[132:135], v242 offset:1024
buffer_load_dwordx4 v238, s[48:51], s69 offen offset:2048 sc1 lds
MV 132,a,164,a,104
MV 136,a,164,a,108
ds_read_b128 a[136:139], v242 offset:2048
MV 140,a,168,a,104
ds_read_b128 a[140:143], v242 offset:3072
MV 144,a,168,a,108
buffer_load_dwordx4 v238, s[48:51], s69 offen offset:3072 sc1 lds
MV 148,a,172,a,104
ds_read_b128 a[144:147], v243 offset:0
MV 152,a,172,a,108
ds_read_b128 a[148:151], v243 offset:1024
MV 156,a,176,a,104
MV 160,a,176,a,108
ds_read_b128 a[152:155], v243 offset:2048
s_add_u32 s69, s69, 16384
MV 164,a,180,a,104
ds_read_b128 a[156:159], v243 offset:3072
MV 168,a,180,a,108
MV 172,a,184,a,104
MV 176,a,184,a,108
MV 180,a,188,a,104
buffer_load_dwordx4 a[104:107], v236, s[44:47], s68 offen offset:1024 sc1
MV 184,a,188,a,108
buffer_load_dwordx4 a[108:111], v237, s[44:47], s68 offen offset:1024 sc1
s_add_u32 s68, s68, 2048
s_waitcnt lgkmcnt(7)
MV 124,a,128,a,0
ds_read_b128 a[160:163], v242 offset:8192
MV 128,a,128,a,4
ds_read_b128 a[164:167], v242 offset:9216
s_add_u32 m0, s70, 32768
s_waitcnt lgkmcnt(8)
MV 132,a,132,a,0
MV 136,a,132,a,4
ds_read_b128 a[168:171], v242 offset:10240
s_waitcnt lgkmcnt(8)
MV 140,a,136,a,0
ds_read_b128 a[172:175], v242 offset:11264
MV 144,a,136,a,4
buffer_load_dwordx4 v238, s[48:51], s69 offen offset:0 sc1 lds
s_waitcnt lgkmcnt(8)
MV 148,a,140,a,0
ds_read_b128 a[176:179], v243 offset:8192
MV 152,a,140,a,4
ds_read_b128 a[180:183], v243 offset:9216
s_waitcnt lgkmcnt(9)
MV 156,a,144,a,0
MV 160,a,144,a,4
ds_read_b128 a[184:187], v243 offset:10240
buffer_load_dwordx4 v238, s[48:51], s69 offen offset:1024 sc1 lds
s_waitcnt lgkmcnt(9)
MV 164,a,148,a,0
ds_read_b128 a[188:191], v243 offset:11264
MV 168,a,148,a,4
s_waitcnt lgkmcnt(9)
MV 172,a,152,a,0
MV 176,a,152,a,4
s_waitcnt lgkmcnt(8)
MV 180,a,156,a,0
buffer_load_dwordx4 a[0:3], v236, s[44:47], s68 offen offset:0 sc1
MV 184,a,156,a,4
buffer_load_dwordx4 a[4:7], v237, s[44:47], s68 offen offset:0 sc1
s_waitcnt vmcnt(40) lgkmcnt(0)
s_barrier
MV 124,a,160,a,8
ds_read_b128 a[128:131], v242 offset:16384
MV 128,a,160,a,12
ds_read_b128 a[132:135], v242 offset:17408
buffer_load_dwordx4 v238, s[48:51], s69 offen offset:2048 sc1 lds
MV 132,a,164,a,8
MV 136,a,164,a,12
ds_read_b128 a[136:139], v242 offset:18432
MV 140,a,168,a,8
ds_read_b128 a[140:143], v242 offset:19456
MV 144,a,168,a,12
buffer_load_dwordx4 v238, s[48:51], s69 offen offset:3072 sc1 lds
MV 148,a,172,a,8
ds_read_b128 a[144:147], v243 offset:16384
MV 152,a,172,a,12
ds_read_b128 a[148:151], v243 offset:17408
MV 156,a,176,a,8
MV 160,a,176,a,12
ds_read_b128 a[152:155], v243 offset:18432
s_add_u32 s69, s69, 16384
MV 164,a,180,a,8
ds_read_b128 a[156:159], v243 offset:19456
MV 168,a,180,a,12
MV 172,a,184,a,8
MV 176,a,184,a,12
MV 180,a,188,a,8
buffer_load_dwordx4 a[8:11], v236, s[44:47], s68 offen offset:1024 sc1
MV 184,a,188,a,12
buffer_load_dwordx4 a[12:15], v237, s[44:47], s68 offen offset:1024 sc1
s_add_u32 s68, s68, 2048
s_waitcnt lgkmcnt(7)
MV 124,a,128,a,16
ds_read_b128 a[160:163], v242 offset:24576
MV 128,a,128,a,20
ds_read_b128 a[164:167], v242 offset:25600
s_add_u32 m0, s70, 66560
s_waitcnt lgkmcnt(8)
MV 132,a,132,a,16
MV 136,a,132,a,20
ds_read_b128 a[168:171], v242 offset:26624
s_waitcnt lgkmcnt(8)
MV 140,a,136,a,16
ds_read_b128 a[172:175], v242 offset:27648
MV 144,a,136,a,20
buffer_load_dwordx4 v238, s[48:51], s69 offen offset:0 sc1 lds
s_waitcnt lgkmcnt(8)
MV 148,a,140,a,16
ds_read_b128 a[176:179], v243 offset:24576
MV 152,a,140,a,20
ds_read_b128 a[180:183], v243 offset:25600
s_waitcnt lgkmcnt(9)
MV 156,a,144,a,16
MV 160,a,144,a,20
ds_read_b128 a[184:187], v243 offset:26624
buffer_load_dwordx4 v238, s[48:51], s69 offen offset:1024 sc1 lds
s_waitcnt lgkmcnt(9)
MV 164,a,148,a,16
ds_read_b128 a[188:191], v243 offset:27648
MV 168,a,148,a,20
s_waitcnt lgkmcnt(9)
MV 172,a,152,a,16
MV 176,a,152,a,20
s_waitcnt lgkmcnt(8)
MV 180,a,156,a,16
buffer_load_dwordx4 a[16:19], v236, s[44:47], s68 offen offset:0 sc1
MV 184,a,156,a,20
buffer_load_dwordx4 a[20:23], v237, s[44:47], s68 offen offset:0 sc1
s_waitcnt vmcnt(39) lgkmcnt(0)
s_barrier
MV 124,a,160,a,24
ds_read_b128 a[128:131], v242 offset:32768
MV 128,a,160,a,28
ds_read_b128 a[132:135], v242 offset:33792
buffer_load_dwordx4 v238, s[48:51], s69 offen offset:2048 sc1 lds
MV 132,a,164,a,24
MV 136,a,164,a,28
ds_read_b128 a[136:139], v242 offset:34816
MV 140,a,168,a,24
ds_read_b128 a[140:143], v242 offset:35840
MV 144,a,168,a,28
buffer_load_dwordx4 v238, s[48:51], s69 offen offset:3072 sc1 lds
MV 148,a,172,a,24
ds_read_b128 a[144:147], v243 offset:32768
MV 152,a,172,a,28
ds_read_b128 a[148:151], v243 offset:33792
MV 156,a,176,a,24
MV 160,a,176,a,28
ds_read_b128 a[152:155], v243 offset:34816
s_add_u32 s69, s69, 16384
MV 164,a,180,a,24
ds_read_b128 a[156:159], v243 offset:35840
MV 168,a,180,a,28
MV 172,a,184,a,24
MV 176,a,184,a,28
MV 180,a,188,a,24
buffer_load_dwordx4 a[24:27], v236, s[44:47], s68 offen offset:1024 sc1
MV 184,a,188,a,28
buffer_load_dwordx4 a[28:31], v237, s[44:47], s68 offen offset:1024 sc1
s_add_u32 s68, s68, 2048
s_waitcnt lgkmcnt(7)
MV 124,a,128,a,32
ds_read_b128 a[160:163], v242 offset:40960
MV 128,a,128,a,36
ds_read_b128 a[164:167], v242 offset:41984
s_add_u32 m0, s70, 82944
s_waitcnt lgkmcnt(8)
MV 132,a,132,a,32
MV 136,a,132,a,36
ds_read_b128 a[168:171], v242 offset:43008
s_waitcnt lgkmcnt(8)
MV 140,a,136,a,32
ds_read_b128 a[172:175], v242 offset:44032
MV 144,a,136,a,36
buffer_load_dwordx4 v238, s[48:51], s69 offen offset:0 sc1 lds
s_waitcnt lgkmcnt(8)
MV 148,a,140,a,32
ds_read_b128 a[176:179], v243 offset:40960
MV 152,a,140,a,36
ds_read_b128 a[180:183], v243 offset:41984
s_waitcnt lgkmcnt(9)
MV 156,a,144,a,32
MV 160,a,144,a,36
ds_read_b128 a[184:187], v243 offset:43008
buffer_load_dwordx4 v238, s[48:51], s69 offen offset:1024 sc1 lds
s_waitcnt lgkmcnt(9)
MV 164,a,148,a,32
ds_read_b128 a[188:191], v243 offset:44032
MV 168,a,148,a,36
s_waitcnt lgkmcnt(9)
MV 172,a,152,a,32
MV 176,a,152,a,36
s_waitcnt lgkmcnt(8)
MV 180,a,156,a,32
buffer_load_dwordx4 a[32:35], v236, s[44:47], s68 offen offset:0 sc1
MV 184,a,156,a,36
buffer_load_dwordx4 a[36:39], v237, s[44:47], s68 offen offset:0 sc1
s_waitcnt vmcnt(39) lgkmcnt(0)
s_barrier
MV 124,a,160,a,40
ds_read_b128 a[128:131], v242 offset:49152
MV 128,a,160,a,44
ds_read_b128 a[132:135], v242 offset:50176
buffer_load_dwordx4 v238, s[48:51], s69 offen offset:2048 sc1 lds
MV 132,a,164,a,40
MV 136,a,164,a,44
ds_read_b128 a[136:139], v242 offset:51200
MV 140,a,168,a,40
ds_read_b128 a[140:143], v242 offset:52224
MV 144,a,168,a,44
buffer_load_dwordx4 v238, s[48:51], s69 offen offset:3072 sc1 lds
MV 148,a,172,a,40
ds_read_b128 a[144:147], v243 offset:49152
MV 152,a,172,a,44
ds_read_b128 a[148:151], v243 offset:50176
MV 156,a,176,a,40
MV 160,a,176,a,44
ds_read_b128 a[152:155], v243 offset:51200
s_add_u32 s69, s69, 16384
MV 164,a,180,a,40
ds_read_b128 a[156:159], v243 offset:52224
MV 168,a,180,a,44
MV 172,a,184,a,40
MV 176,a,184,a,44
MV 180,a,188,a,40
buffer_load_dwordx4 a[40:43], v236, s[44:47], s68 offen offset:1024 sc1
MV 184,a,188,a,44
buffer_load_dwordx4 a[44:47], v237, s[44:47], s68 offen offset:1024 sc1
s_add_u32 s68, s68, 2048
s_waitcnt lgkmcnt(7)
MV 124,a,128,a,48
ds_read_b128 a[160:163], v242 offset:57344
MV 128,a,128,a,52
ds_read_b128 a[164:167], v242 offset:58368
s_add_u32 m0, s70, 99328
s_waitcnt lgkmcnt(8)
MV 132,a,132,a,48
MV 136,a,132,a,52
ds_read_b128 a[168:171], v242 offset:59392
s_waitcnt lgkmcnt(8)
MV 140,a,136,a,48
ds_read_b128 a[172:175], v242 offset:60416
MV 144,a,136,a,52
buffer_load_dwordx4 v238, s[48:51], s69 offen offset:0 sc1 lds
s_waitcnt lgkmcnt(8)
MV 148,a,140,a,48
ds_read_b128 a[176:179], v243 offset:57344
MV 152,a,140,a,52
ds_read_b128 a[180:183], v243 offset:58368
s_waitcnt lgkmcnt(9)
MV 156,a,144,a,48
MV 160,a,144,a,52
ds_read_b128 a[184:187], v243 offset:59392
buffer_load_dwordx4 v238, s[48:51], s69 offen offset:1024 sc1 lds
s_waitcnt lgkmcnt(9)
MV 164,a,148,a,48
ds_read_b128 a[188:191], v243 offset:60416
MV 168,a,148,a,52
s_waitcnt lgkmcnt(9)
MV 172,a,152,a,48
MV 176,a,152,a,52
s_waitcnt lgkmcnt(8)
MV 180,a,156,a,48
buffer_load_dwordx4 a[48:51], v236, s[44:47], s68 offen offset:0 sc1
MV 184,a,156,a,52
buffer_load_dwordx4 a[52:55], v237, s[44:47], s68 offen offset:0 sc1
s_waitcnt vmcnt(38) lgkmcnt(0)
s_barrier
MV 124,a,160,a,56
ds_read_b128 a[128:131], v244 offset:0
MV 128,a,160,a,60
ds_read_b128 a[132:135], v244 offset:1024
buffer_load_dwordx4 v238, s[48:51], s69 offen offset:2048 sc1 lds
MV 132,a,164,a,56
MV 136,a,164,a,60
ds_read_b128 a[136:139], v244 offset:2048
MV 140,a,168,a,56
ds_read_b128 a[140:143], v244 offset:3072
MV 144,a,168,a,60
buffer_load_dwordx4 v238, s[48:51], s69 offen offset:3072 sc1 lds
MV 148,a,172,a,56
ds_read_b128 a[144:147], v245 offset:0
MV 152,a,172,a,60
ds_read_b128 a[148:151], v245 offset:1024
MV 156,a,176,a,56
MV 160,a,176,a,60
ds_read_b128 a[152:155], v245 offset:2048
s_add_u32 s69, s69, 16384
MV 164,a,180,a,56
ds_read_b128 a[156:159], v245 offset:3072
MV 168,a,180,a,60
MV 172,a,184,a,56
MV 176,a,184,a,60
MV 180,a,188,a,56
buffer_load_dwordx4 a[56:59], v236, s[44:47], s68 offen offset:1024 sc1
MV 184,a,188,a,60
buffer_load_dwordx4 a[60:63], v237, s[44:47], s68 offen offset:1024 sc1
s_add_u32 s68, s68, 2048
s_waitcnt lgkmcnt(7)
MV 124,a,128,a,64
ds_read_b128 a[160:163], v244 offset:8192
MV 128,a,128,a,68
ds_read_b128 a[164:167], v244 offset:9216
s_add_u32 m0, s70, 115712
s_waitcnt lgkmcnt(8)
MV 132,a,132,a,64
MV 136,a,132,a,68
ds_read_b128 a[168:171], v244 offset:10240
s_waitcnt lgkmcnt(8)
MV 140,a,136,a,64
ds_read_b128 a[172:175], v244 offset:11264
MV 144,a,136,a,68
buffer_load_dwordx4 v238, s[48:51], s69 offen offset:0 sc1 lds
s_waitcnt lgkmcnt(8)
MV 148,a,140,a,64
ds_read_b128 a[176:179], v245 offset:8192
MV 152,a,140,a,68
ds_read_b128 a[180:183], v245 offset:9216
s_waitcnt lgkmcnt(9)
MV 156,a,144,a,64
MV 160,a,144,a,68
ds_read_b128 a[184:187], v245 offset:10240
buffer_load_dwordx4 v238, s[48:51], s69 offen offset:1024 sc1 lds
s_waitcnt lgkmcnt(9)
MV 164,a,148,a,64
ds_read_b128 a[188:191], v245 offset:11264
MV 168,a,148,a,68
s_waitcnt lgkmcnt(9)
MV 172,a,152,a,64
MV 176,a,152,a,68
s_waitcnt lgkmcnt(8)
MV 180,a,156,a,64
buffer_load_dwordx4 a[64:67], v236, s[44:47], s68 offen offset:0 sc1
MV 184,a,156,a,68
buffer_load_dwordx4 a[68:71], v237, s[44:47], s68 offen offset:0 sc1
s_waitcnt vmcnt(38) lgkmcnt(0)
s_barrier
MV 124,a,160,a,72
ds_read_b128 a[128:131], v244 offset:16384
MV 128,a,160,a,76
ds_read_b128 a[132:135], v244 offset:17408
buffer_load_dwordx4 v238, s[48:51], s69 offen offset:2048 sc1 lds
MV 132,a,164,a,72
MV 136,a,164,a,76
ds_read_b128 a[136:139], v244 offset:18432
MV 140,a,168,a,72
ds_read_b128 a[140:143], v244 offset:19456
MV 144,a,168,a,76
buffer_load_dwordx4 v238, s[48:51], s69 offen offset:3072 sc1 lds
MV 148,a,172,a,72
ds_read_b128 a[144:147], v245 offset:16384
MV 152,a,172,a,76
ds_read_b128 a[148:151], v245 offset:17408
MV 156,a,176,a,72
MV 160,a,176,a,76
ds_read_b128 a[152:155], v245 offset:18432
s_add_u32 s69, s69, 16384
MV 164,a,180,a,72
ds_read_b128 a[156:159], v245 offset:19456
MV 168,a,180,a,76
MV 172,a,184,a,72
MV 176,a,184,a,76
MV 180,a,188,a,72
buffer_load_dwordx4 a[72:75], v236, s[44:47], s68 offen offset:1024 sc1
MV 184,a,188,a,76
buffer_load_dwordx4 a[76:79], v237, s[44:47], s68 offen offset:1024 sc1
s_add_u32 s68, s68, 2048
s_waitcnt lgkmcnt(7)
MV 124,a,128,a,80
ds_read_b128 a[160:163], v244 offset:24576
MV 128,a,128,a,84
ds_read_b128 a[164:167], v244 offset:25600
s_add_u32 m0, s70, 0
s_waitcnt lgkmcnt(8)
MV 132,a,132,a,80
v_cmp_gt_u32 vcc, 1, v253
s_nop 4
s_cbranch_vccnz L_spin_f3
L_spin_f3_ret:
MV 136,a,132,a,84
ds_read_b128 a[168:171], v244 offset:26624
s_waitcnt lgkmcnt(8)
MV 140,a,136,a,80
ds_read_b128 a[172:175], v244 offset:27648
MV 144,a,136,a,84
buffer_load_dwordx4 v238, s[48:51], s69 offen offset:0 sc1 lds
s_waitcnt lgkmcnt(8)
MV 148,a,140,a,80
ds_read_b128 a[176:179], v245 offset:24576
MV 152,a,140,a,84
ds_read_b128 a[180:183], v245 offset:25600
s_waitcnt lgkmcnt(9)
MV 156,a,144,a,80
MV 160,a,144,a,84
ds_read_b128 a[184:187], v245 offset:26624
buffer_load_dwordx4 v238, s[48:51], s69 offen offset:1024 sc1 lds
s_waitcnt lgkmcnt(9)
MV 164,a,148,a,80
ds_read_b128 a[188:191], v245 offset:27648
MV 168,a,148,a,84
s_waitcnt lgkmcnt(9)
MV 172,a,152,a,80
s_add_u32 s72, s79, 0
MV 176,a,152,a,84
s_waitcnt lgkmcnt(8)
MV 180,a,156,a,80
buffer_load_dwordx4 a[80:83], v236, s[44:47], s68 offen offset:0 sc1
buffer_load_dwordx2 v[208:209], v251, s[56:59], s72 offen offset:0 sc1
MV 184,a,156,a,84
buffer_load_dwordx4 a[84:87], v237, s[44:47], s68 offen offset:0 sc1
s_waitcnt vmcnt(39) lgkmcnt(0)
s_barrier
MV 124,a,160,a,88
ds_read_b128 a[128:131], v244 offset:32768
s_add_u32 s72, s79, 16384
MV 128,a,160,a,92
ds_read_b128 a[132:135], v244 offset:33792
buffer_load_dwordx4 v238, s[48:51], s69 offen offset:2048 sc1 lds
MV 132,a,164,a,88
MV 136,a,164,a,92
ds_read_b128 a[136:139], v244 offset:34816
MV 140,a,168,a,88
ds_read_b128 a[140:143], v244 offset:35840
MV 144,a,168,a,92
buffer_load_dwordx4 v238, s[48:51], s69 offen offset:3072 sc1 lds
MV 148,a,172,a,88
ds_read_b128 a[144:147], v245 offset:32768
MV 152,a,172,a,92
ds_read_b128 a[148:151], v245 offset:33792
MV 156,a,176,a,88
buffer_load_dwordx2 v[210:211], v251, s[56:59], s72 offen offset:0 sc1
MV 160,a,176,a,92
ds_read_b128 a[152:155], v245 offset:34816
s_add_u32 s69, s69, 16384
MV 164,a,180,a,88
ds_read_b128 a[156:159], v245 offset:35840
MV 168,a,180,a,92
MV 172,a,184,a,88
MV 176,a,184,a,92
MV 180,a,188,a,88
buffer_load_dwordx4 a[88:91], v236, s[44:47], s68 offen offset:1024 sc1
MV 184,a,188,a,92
buffer_load_dwordx4 a[92:95], v237, s[44:47], s68 offen offset:1024 sc1
s_add_u32 s68, s68, 2048
s_waitcnt lgkmcnt(7)
MV 124,a,128,a,96
ds_read_b128 a[160:163], v244 offset:40960
s_add_u32 s72, s79, 131072
MV 128,a,128,a,100
ds_read_b128 a[164:167], v244 offset:41984
s_add_u32 m0, s70, 16384
s_waitcnt lgkmcnt(8)
MV 132,a,132,a,96
MV 136,a,132,a,100
ds_read_b128 a[168:171], v244 offset:43008
s_waitcnt lgkmcnt(8)
MV 140,a,136,a,96
ds_read_b128 a[172:175], v244 offset:44032
MV 144,a,136,a,100
buffer_load_dwordx4 v238, s[48:51], s69 offen offset:0 sc1 lds
s_waitcnt lgkmcnt(8)
MV 148,a,140,a,96
ds_read_b128 a[176:179], v245 offset:40960
MV 152,a,140,a,100
ds_read_b128 a[180:183], v245 offset:41984
s_waitcnt lgkmcnt(9)
MV 156,a,144,a,96
buffer_load_dwordx2 v[212:213], v251, s[56:59], s72 offen offset:0 sc1
MV 160,a,144,a,100
ds_read_b128 a[184:187], v245 offset:43008
buffer_load_dwordx4 v238, s[48:51], s69 offen offset:1024 sc1 lds
s_waitcnt lgkmcnt(9)
MV 164,a,148,a,96
ds_read_b128 a[188:191], v245 offset:44032
MV 168,a,148,a,100
s_waitcnt lgkmcnt(9)
MV 172,a,152,a,96
MV 176,a,152,a,100
s_waitcnt lgkmcnt(8)
MV 180,a,156,a,96
buffer_load_dwordx4 a[96:99], v236, s[44:47], s68 offen offset:0 sc1
MV 184,a,156,a,100
buffer_load_dwordx4 a[100:103], v237, s[44:47], s68 offen offset:0 sc1
s_waitcnt vmcnt(41) lgkmcnt(0)
s_barrier
MV 124,a,160,a,104
ds_read_b128 a[128:131], v242 offset:0
s_add_u32 s72, s79, 147456
MV 128,a,160,a,108
ds_read_b128 a[132:135], v242 offset:1024
buffer_load_dwordx4 v238, s[48:51], s69 offen offset:2048 sc1 lds
MV 132,a,164,a,104
MV 136,a,164,a,108
ds_read_b128 a[136:139], v242 offset:2048
MV 140,a,168,a,104
ds_read_b128 a[140:143], v242 offset:3072
MV 144,a,168,a,108
buffer_load_dwordx4 v238, s[48:51], s69 offen offset:3072 sc1 lds
MV 148,a,172,a,104
ds_read_b128 a[144:147], v243 offset:0
MV 152,a,172,a,108
ds_read_b128 a[148:151], v243 offset:1024
MV 156,a,176,a,104
buffer_load_dwordx2 v[214:215], v251, s[56:59], s72 offen offset:0 sc1
MV 160,a,176,a,108
ds_read_b128 a[152:155], v243 offset:2048
s_add_u32 s69, s69, 16384
MV 164,a,180,a,104
ds_read_b128 a[156:159], v243 offset:3072
MV 168,a,180,a,108
MV 172,a,184,a,104
MV 176,a,184,a,108
MV 180,a,188,a,104
buffer_load_dwordx4 a[104:107], v236, s[44:47], s68 offen offset:1024 sc1
MV 184,a,188,a,108
buffer_load_dwordx4 a[108:111], v237, s[44:47], s68 offen offset:1024 sc1
s_add_u32 s68, s68, 2048
s_waitcnt lgkmcnt(7)
MV 124,a,128,a,0
ds_read_b128 a[160:163], v242 offset:8192
s_add_u32 s72, s79, 0
MV 128,a,128,a,4
ds_read_b128 a[164:167], v242 offset:9216
s_add_u32 m0, s70, 32768
s_waitcnt lgkmcnt(8)
MV 132,a,132,a,0
MV 136,a,132,a,4
ds_read_b128 a[168:171], v242 offset:10240
s_waitcnt lgkmcnt(8)
MV 140,a,136,a,0
ds_read_b128 a[172:175], v242 offset:11264
MV 144,a,136,a,4
buffer_load_dwordx4 v238, s[48:51], s69 offen offset:0 sc1 lds
s_waitcnt lgkmcnt(8)
MV 148,a,140,a,0
ds_read_b128 a[176:179], v243 offset:8192
MV 152,a,140,a,4
ds_read_b128 a[180:183], v243 offset:9216
s_waitcnt lgkmcnt(9)
MV 156,a,144,a,0
buffer_load_dwordx2 v[216:217], v251, s[56:59], s72 offen offset:128 sc1
MV 160,a,144,a,4
ds_read_b128 a[184:187], v243 offset:10240
buffer_load_dwordx4 v238, s[48:51], s69 offen offset:1024 sc1 lds
s_waitcnt lgkmcnt(9)
MV 164,a,148,a,0
ds_read_b128 a[188:191], v243 offset:11264
MV 168,a,148,a,4
s_waitcnt lgkmcnt(9)
MV 172,a,152,a,0
MV 176,a,152,a,4
s_waitcnt lgkmcnt(8)
MV 180,a,156,a,0
buffer_load_dwordx4 a[0:3], v236, s[44:47], s68 offen offset:0 sc1
MV 184,a,156,a,4
buffer_load_dwordx4 a[4:7], v237, s[44:47], s68 offen offset:0 sc1
s_waitcnt vmcnt(43) lgkmcnt(0)
s_barrier
MV 124,a,160,a,8
ds_read_b128 a[128:131], v242 offset:16384
s_add_u32 s72, s79, 16384
MV 128,a,160,a,12
ds_read_b128 a[132:135], v242 offset:17408
buffer_load_dwordx4 v238, s[48:51], s69 offen offset:2048 sc1 lds
MV 132,a,164,a,8
MV 136,a,164,a,12
ds_read_b128 a[136:139], v242 offset:18432
MV 140,a,168,a,8
ds_read_b128 a[140:143], v242 offset:19456
MV 144,a,168,a,12
buffer_load_dwordx4 v238, s[48:51], s69 offen offset:3072 sc1 lds
MV 148,a,172,a,8
ds_read_b128 a[144:147], v243 offset:16384
MV 152,a,172,a,12
ds_read_b128 a[148:151], v243 offset:17408
MV 156,a,176,a,8
buffer_load_dwordx2 v[218:219], v251, s[56:59], s72 offen offset:128 sc1
MV 160,a,176,a,12
ds_read_b128 a[152:155], v243 offset:18432
s_add_u32 s69, s69, 16384
MV 164,a,180,a,8
ds_read_b128 a[156:159], v243 offset:19456
MV 168,a,180,a,12
MV 172,a,184,a,8
MV 176,a,184,a,12
MV 180,a,188,a,8
buffer_load_dwordx4 a[8:11], v236, s[44:47], s68 offen offset:1024 sc1
MV 184,a,188,a,12
buffer_load_dwordx4 a[12:15], v237, s[44:47], s68 offen offset:1024 sc1
s_add_u32 s68, s68, 2048
s_waitcnt lgkmcnt(7)
MV 124,a,128,a,16
ds_read_b128 a[160:163], v242 offset:24576
s_add_u32 s72, s79, 131072
MV 128,a,128,a,20
ds_read_b128 a[164:167], v242 offset:25600
s_add_u32 m0, s70, 66560
s_waitcnt lgkmcnt(8)
MV 132,a,132,a,16
MV 136,a,132,a,20
ds_read_b128 a[168:171], v242 offset:26624
s_waitcnt lgkmcnt(8)
MV 140,a,136,a,16
ds_read_b128 a[172:175], v242 offset:27648
MV 144,a,136,a,20
buffer_load_dwordx4 v238, s[48:51], s69 offen offset:0 sc1 lds
s_waitcnt lgkmcnt(8)
MV 148,a,140,a,16
ds_read_b128 a[176:179], v243 offset:24576
MV 152,a,140,a,20
ds_read_b128 a[180:183], v243 offset:25600
s_waitcnt lgkmcnt(9)
MV 156,a,144,a,16
buffer_load_dwordx2 v[220:221], v251, s[56:59], s72 offen offset:128 sc1
MV 160,a,144,a,20
ds_read_b128 a[184:187], v243 offset:26624
buffer_load_dwordx4 v238, s[48:51], s69 offen offset:1024 sc1 lds
s_waitcnt lgkmcnt(9)
MV 164,a,148,a,16
ds_read_b128 a[188:191], v243 offset:27648
MV 168,a,148,a,20
s_waitcnt lgkmcnt(9)
MV 172,a,152,a,16
MV 176,a,152,a,20
s_waitcnt lgkmcnt(8)
MV 180,a,156,a,16
buffer_load_dwordx4 a[16:19], v236, s[44:47], s68 offen offset:0 sc1
MV 184,a,156,a,20
buffer_load_dwordx4 a[20:23], v237, s[44:47], s68 offen offset:0 sc1
s_waitcnt vmcnt(45) lgkmcnt(0)
s_barrier
MV 124,a,160,a,24
ds_read_b128 a[128:131], v242 offset:32768
s_add_u32 s72, s79, 147456
MV 128,a,160,a,28
ds_read_b128 a[132:135], v242 offset:33792
buffer_load_dwordx4 v238, s[48:51], s69 offen offset:2048 sc1 lds
MV 132,a,164,a,24
MV 136,a,164,a,28
ds_read_b128 a[136:139], v242 offset:34816
MV 140,a,168,a,24
ds_read_b128 a[140:143], v242 offset:35840
MV 144,a,168,a,28
buffer_load_dwordx4 v238, s[48:51], s69 offen offset:3072 sc1 lds
MV 148,a,172,a,24
ds_read_b128 a[144:147], v243 offset:32768
MV 152,a,172,a,28
ds_read_b128 a[148:151], v243 offset:33792
MV 156,a,176,a,24
buffer_load_dwordx2 v[222:223], v251, s[56:59], s72 offen offset:128 sc1
MV 160,a,176,a,28
ds_read_b128 a[152:155], v243 offset:34816
s_add_u32 s69, s69, 16384
MV 164,a,180,a,24
ds_read_b128 a[156:159], v243 offset:35840
MV 168,a,180,a,28
MV 172,a,184,a,24
MV 176,a,184,a,28
MV 180,a,188,a,24
buffer_load_dwordx4 a[24:27], v236, s[44:47], s68 offen offset:1024 sc1
MV 184,a,188,a,28
buffer_load_dwordx4 a[28:31], v237, s[44:47], s68 offen offset:1024 sc1
s_add_u32 s68, s68, 2048
s_waitcnt lgkmcnt(7)
MV 124,a,128,a,32
ds_read_b128 a[160:163], v242 offset:40960
MV 128,a,128,a,36
ds_read_b128 a[164:167], v242 offset:41984
s_add_u32 m0, s70, 82944
s_waitcnt lgkmcnt(8)
MV 132,a,132,a,32
MV 136,a,132,a,36
ds_read_b128 a[168:171], v242 offset:43008
s_waitcnt lgkmcnt(8)
MV 140,a,136,a,32
ds_read_b128 a[172:175], v242 offset:44032
MV 144,a,136,a,36
buffer_load_dwordx4 v238, s[48:51], s69 offen offset:0 sc1 lds
s_waitcnt lgkmcnt(8)
MV 148,a,140,a,32
ds_read_b128 a[176:179], v243 offset:40960
MV 152,a,140,a,36
ds_read_b128 a[180:183], v243 offset:41984
s_waitcnt lgkmcnt(9)
MV 156,a,144,a,32
MV 160,a,144,a,36
ds_read_b128 a[184:187], v243 offset:43008
buffer_load_dwordx4 v238, s[48:51], s69 offen offset:1024 sc1 lds
s_waitcnt lgkmcnt(9)
MV 164,a,148,a,32
ds_read_b128 a[188:191], v243 offset:44032
MV 168,a,148,a,36
s_waitcnt lgkmcnt(9)
MV 172,a,152,a,32
MV 176,a,152,a,36
s_waitcnt lgkmcnt(8)
MV 180,a,156,a,32
buffer_load_dwordx4 a[32:35], v236, s[44:47], s68 offen offset:0 sc1
MV 184,a,156,a,36
buffer_load_dwordx4 a[36:39], v237, s[44:47], s68 offen offset:0 sc1
s_waitcnt vmcnt(46) lgkmcnt(0)
s_barrier
MV 124,a,160,a,40
ds_read_b128 a[128:131], v242 offset:49152
MV 128,a,160,a,44
ds_read_b128 a[132:135], v242 offset:50176
buffer_load_dwordx4 v238, s[48:51], s69 offen offset:2048 sc1 lds
MV 132,a,164,a,40
MV 136,a,164,a,44
ds_read_b128 a[136:139], v242 offset:51200
MV 140,a,168,a,40
ds_read_b128 a[140:143], v242 offset:52224
MV 144,a,168,a,44
buffer_load_dwordx4 v238, s[48:51], s69 offen offset:3072 sc1 lds
MV 148,a,172,a,40
ds_read_b128 a[144:147], v243 offset:49152
MV 152,a,172,a,44
ds_read_b128 a[148:151], v243 offset:50176
MV 156,a,176,a,40
MV 160,a,176,a,44
ds_read_b128 a[152:155], v243 offset:51200
s_add_u32 s69, s69, 16384
MV 164,a,180,a,40
ds_read_b128 a[156:159], v243 offset:52224
MV 168,a,180,a,44
MV 172,a,184,a,40
MV 176,a,184,a,44
MV 180,a,188,a,40
buffer_load_dwordx4 a[40:43], v236, s[44:47], s68 offen offset:1024 sc1
MV 184,a,188,a,44
buffer_load_dwordx4 a[44:47], v237, s[44:47], s68 offen offset:1024 sc1
s_add_u32 s68, s68, 2048
s_waitcnt lgkmcnt(7)
MV 124,a,128,a,48
ds_read_b128 a[160:163], v242 offset:57344
MV 128,a,128,a,52
ds_read_b128 a[164:167], v242 offset:58368
s_add_u32 m0, s70, 99328
s_waitcnt lgkmcnt(8)
MV 132,a,132,a,48
MV 136,a,132,a,52
ds_read_b128 a[168:171], v242 offset:59392
s_waitcnt lgkmcnt(8)
MV 140,a,136,a,48
ds_read_b128 a[172:175], v242 offset:60416
MV 144,a,136,a,52
buffer_load_dwordx4 v238, s[48:51], s69 offen offset:0 sc1 lds
s_waitcnt lgkmcnt(8)
MV 148,a,140,a,48
ds_read_b128 a[176:179], v243 offset:57344
MV 152,a,140,a,52
ds_read_b128 a[180:183], v243 offset:58368
s_waitcnt lgkmcnt(9)
MV 156,a,144,a,48
MV 160,a,144,a,52
ds_read_b128 a[184:187], v243 offset:59392
buffer_load_dwordx4 v238, s[48:51], s69 offen offset:1024 sc1 lds
s_waitcnt lgkmcnt(9)
MV 164,a,148,a,48
ds_read_b128 a[188:191], v243 offset:60416
MV 168,a,148,a,52
s_waitcnt lgkmcnt(9)
MV 172,a,152,a,48
MV 176,a,152,a,52
s_waitcnt lgkmcnt(8)
MV 180,a,156,a,48
buffer_load_dwordx4 a[48:51], v236, s[44:47], s68 offen offset:0 sc1
MV 184,a,156,a,52
buffer_load_dwordx4 a[52:55], v237, s[44:47], s68 offen offset:0 sc1
s_waitcnt vmcnt(45) lgkmcnt(0)
s_barrier
MV 124,a,160,a,56
ds_read_b128 a[128:131], v244 offset:0
MV 128,a,160,a,60
ds_read_b128 a[132:135], v244 offset:1024
buffer_load_dwordx4 v238, s[48:51], s69 offen offset:2048 sc1 lds
MV 132,a,164,a,56
MV 136,a,164,a,60
ds_read_b128 a[136:139], v244 offset:2048
MV 140,a,168,a,56
ds_read_b128 a[140:143], v244 offset:3072
MV 144,a,168,a,60
buffer_load_dwordx4 v238, s[48:51], s69 offen offset:3072 sc1 lds
MV 148,a,172,a,56
ds_read_b128 a[144:147], v245 offset:0
MV 152,a,172,a,60
ds_read_b128 a[148:151], v245 offset:1024
MV 156,a,176,a,56
MV 160,a,176,a,60
ds_read_b128 a[152:155], v245 offset:2048
s_add_u32 s69, s69, 16384
MV 164,a,180,a,56
ds_read_b128 a[156:159], v245 offset:3072
MV 168,a,180,a,60
MV 172,a,184,a,56
MV 176,a,184,a,60
MV 180,a,188,a,56
buffer_load_dwordx4 a[56:59], v236, s[44:47], s68 offen offset:1024 sc1
MV 184,a,188,a,60
buffer_load_dwordx4 a[60:63], v237, s[44:47], s68 offen offset:1024 sc1
s_add_u32 s68, s68, 2048
s_waitcnt lgkmcnt(7)
MV 124,a,128,a,64
ds_read_b128 a[160:163], v244 offset:8192
MV 128,a,128,a,68
ds_read_b128 a[164:167], v244 offset:9216
s_add_u32 m0, s70, 115712
s_waitcnt lgkmcnt(8)
MV 132,a,132,a,64
MV 136,a,132,a,68
ds_read_b128 a[168:171], v244 offset:10240
s_waitcnt lgkmcnt(8)
MV 140,a,136,a,64
ds_read_b128 a[172:175], v244 offset:11264
MV 144,a,136,a,68
buffer_load_dwordx4 v238, s[48:51], s69 offen offset:0 sc1 lds
s_waitcnt lgkmcnt(8)
MV 148,a,140,a,64
ds_read_b128 a[176:179], v245 offset:8192
MV 152,a,140,a,68
ds_read_b128 a[180:183], v245 offset:9216
s_waitcnt lgkmcnt(9)
MV 156,a,144,a,64
MV 160,a,144,a,68
ds_read_b128 a[184:187], v245 offset:10240
buffer_load_dwordx4 v238, s[48:51], s69 offen offset:1024 sc1 lds
s_waitcnt lgkmcnt(9)
MV 164,a,148,a,64
ds_read_b128 a[188:191], v245 offset:11264
MV 168,a,148,a,68
s_waitcnt lgkmcnt(9)
MV 172,a,152,a,64
MV 176,a,152,a,68
s_waitcnt lgkmcnt(8)
MV 180,a,156,a,64
MV 184,a,156,a,68
s_waitcnt vmcnt(41) lgkmcnt(0)
s_barrier
MV 124,a,160,a,72
ds_read_b128 a[128:131], v244 offset:16384
MV 128,a,160,a,76
ds_read_b128 a[132:135], v244 offset:17408
buffer_load_dwordx4 v238, s[48:51], s69 offen offset:2048 sc1 lds
MV 132,a,164,a,72
MV 136,a,164,a,76
ds_read_b128 a[136:139], v244 offset:18432
MV 140,a,168,a,72
ds_read_b128 a[140:143], v244 offset:19456
MV 144,a,168,a,76
buffer_load_dwordx4 v238, s[48:51], s69 offen offset:3072 sc1 lds
MV 148,a,172,a,72
ds_read_b128 a[144:147], v245 offset:16384
MV 152,a,172,a,76
ds_read_b128 a[148:151], v245 offset:17408
MV 156,a,176,a,72
MV 160,a,176,a,76
ds_read_b128 a[152:155], v245 offset:18432
s_add_u32 s69, s69, 16384
MV 164,a,180,a,72
ds_read_b128 a[156:159], v245 offset:19456
MV 168,a,180,a,76
MV 172,a,184,a,72
MV 176,a,184,a,76
MV 180,a,188,a,72
MV 184,a,188,a,76
s_waitcnt lgkmcnt(7)
MV 124,a,128,a,80
ds_read_b128 a[160:163], v244 offset:24576
MV 128,a,128,a,84
ds_read_b128 a[164:167], v244 offset:25600
s_waitcnt lgkmcnt(8)
MV 132,a,132,a,80
MV 136,a,132,a,84
ds_read_b128 a[168:171], v244 offset:26624
s_waitcnt lgkmcnt(8)
MV 140,a,136,a,80
ds_read_b128 a[172:175], v244 offset:27648
MV 144,a,136,a,84
s_waitcnt lgkmcnt(8)
MV 148,a,140,a,80
ds_read_b128 a[176:179], v245 offset:24576
MV 152,a,140,a,84
ds_read_b128 a[180:183], v245 offset:25600
s_waitcnt lgkmcnt(9)
MV 156,a,144,a,80
MV 160,a,144,a,84
ds_read_b128 a[184:187], v245 offset:26624
s_waitcnt lgkmcnt(9)
MV 164,a,148,a,80
ds_read_b128 a[188:191], v245 offset:27648
MV 168,a,148,a,84
s_waitcnt lgkmcnt(9)
MV 172,a,152,a,80
MV 176,a,152,a,84
s_waitcnt lgkmcnt(8)
MV 180,a,156,a,80
MV 184,a,156,a,84
s_waitcnt vmcnt(33) lgkmcnt(0)
s_barrier
MV 124,a,160,a,88
ds_read_b128 a[128:131], v244 offset:32768
MV 128,a,160,a,92
ds_read_b128 a[132:135], v244 offset:33792
MV 132,a,164,a,88
MV 136,a,164,a,92
ds_read_b128 a[136:139], v244 offset:34816
MV 140,a,168,a,88
ds_read_b128 a[140:143], v244 offset:35840
MV 144,a,168,a,92
MV 148,a,172,a,88
ds_read_b128 a[144:147], v245 offset:32768
MV 152,a,172,a,92
ds_read_b128 a[148:151], v245 offset:33792
MV 156,a,176,a,88
MV 160,a,176,a,92
ds_read_b128 a[152:155], v245 offset:34816
MV 164,a,180,a,88
ds_read_b128 a[156:159], v245 offset:35840
MV 168,a,180,a,92
MV 172,a,184,a,88
MV 176,a,184,a,92
MV 180,a,188,a,88
MV 184,a,188,a,92
s_waitcnt lgkmcnt(7)
MV 124,a,128,a,96
ds_read_b128 a[160:163], v244 offset:40960
v_sub_f32 v226, 1.0, v224
MV 128,a,128,a,100
ds_read_b128 a[164:167], v244 offset:41984
v_lshlrev_b32 v36, 16, v192
s_waitcnt lgkmcnt(8)
MV 132,a,132,a,96
v_lshlrev_b32 v228, 16, v208
MV 136,a,132,a,100
ds_read_b128 a[168:171], v244 offset:43008
v_and_b32 v37, 0xffff0000, v192
s_waitcnt lgkmcnt(8)
MV 140,a,136,a,96
ds_read_b128 a[172:175], v244 offset:44032
v_and_b32 v229, 0xffff0000, v208
MV 144,a,136,a,100
s_waitcnt lgkmcnt(8)
MV 148,a,140,a,96
ds_read_b128 a[176:179], v245 offset:40960
v_mul_f32 v36, v36, v228
MV 152,a,140,a,100
ds_read_b128 a[180:183], v245 offset:41984
v_mul_f32 v37, v37, v229
s_waitcnt lgkmcnt(9)
MV 156,a,144,a,96
v_mul_f32 v36, v36, v224
MV 160,a,144,a,100
ds_read_b128 a[184:187], v245 offset:43008
v_mul_f32 v37, v37, v224
s_waitcnt lgkmcnt(9)
MV 164,a,148,a,96
ds_read_b128 a[188:191], v245 offset:44032
MV 168,a,148,a,100
v_lshlrev_b32 v38, 16, v193
s_waitcnt lgkmcnt(9)
MV 172,a,152,a,96
v_lshlrev_b32 v228, 16, v209
MV 176,a,152,a,100
v_and_b32 v39, 0xffff0000, v193
s_waitcnt lgkmcnt(8)
MV 180,a,156,a,96
v_and_b32 v229, 0xffff0000, v209
MV 184,a,156,a,100
s_waitcnt vmcnt(23) lgkmcnt(0)
s_barrier
MV 124,a,160,a,104
ds_read_b128 a[128:131], v242 offset:0
v_mul_f32 v38, v38, v228
MV 128,a,160,a,108
ds_read_b128 a[132:135], v242 offset:1024
v_mul_f32 v39, v39, v229
MV 132,a,164,a,104
v_mul_f32 v38, v38, v224
MV 136,a,164,a,108
ds_read_b128 a[136:139], v242 offset:2048
v_mul_f32 v39, v39, v224
MV 140,a,168,a,104
ds_read_b128 a[140:143], v242 offset:3072
v_lshlrev_b32 v40, 16, v194
MV 144,a,168,a,108
MV 148,a,172,a,104
ds_read_b128 a[144:147], v243 offset:0
v_lshlrev_b32 v228, 16, v210
MV 152,a,172,a,108
ds_read_b128 a[148:151], v243 offset:1024
v_and_b32 v41, 0xffff0000, v194
MV 156,a,176,a,104
v_and_b32 v229, 0xffff0000, v210
MV 160,a,176,a,108
ds_read_b128 a[152:155], v243 offset:2048
v_mul_f32 v40, v40, v228
MV 164,a,180,a,104
ds_read_b128 a[156:159], v243 offset:3072
MV 168,a,180,a,108
v_mul_f32 v41, v41, v229
MV 172,a,184,a,104
v_mul_f32 v40, v40, v224
MV 176,a,184,a,108
v_mul_f32 v41, v41, v224
MV 180,a,188,a,104
v_lshlrev_b32 v42, 16, v195
MV 184,a,188,a,108
s_waitcnt lgkmcnt(7)
MV 124,a,128,a,0
ds_read_b128 a[160:163], v242 offset:8192
v_lshlrev_b32 v228, 16, v211
MV 128,a,128,a,4
ds_read_b128 a[164:167], v242 offset:9216
v_and_b32 v43, 0xffff0000, v195
s_waitcnt lgkmcnt(8)
MV 132,a,132,a,0
v_and_b32 v229, 0xffff0000, v211
MV 136,a,132,a,4
ds_read_b128 a[168:171], v242 offset:10240
v_mul_f32 v42, v42, v228
s_waitcnt lgkmcnt(8)
MV 140,a,136,a,0
ds_read_b128 a[172:175], v242 offset:11264
v_mul_f32 v43, v43, v229
MV 144,a,136,a,4
s_waitcnt lgkmcnt(8)
MV 148,a,140,a,0
ds_read_b128 a[176:179], v243 offset:8192
v_mul_f32 v42, v42, v224
MV 152,a,140,a,4
ds_read_b128 a[180:183], v243 offset:9216
v_mul_f32 v43, v43, v224
s_waitcnt lgkmcnt(9)
MV 156,a,144,a,0
v_lshlrev_b32 v44, 16, v196
MV 160,a,144,a,4
ds_read_b128 a[184:187], v243 offset:10240
v_lshlrev_b32 v228, 16, v212
s_waitcnt lgkmcnt(9)
MV 164,a,148,a,0
ds_read_b128 a[188:191], v243 offset:11264
MV 168,a,148,a,4
v_and_b32 v45, 0xffff0000, v196
s_waitcnt lgkmcnt(9)
MV 172,a,152,a,0
v_and_b32 v229, 0xffff0000, v212
MV 176,a,152,a,4
v_mul_f32 v44, v44, v228
s_waitcnt lgkmcnt(8)
MV 180,a,156,a,0
v_mul_f32 v45, v45, v229
MV 184,a,156,a,4
s_waitcnt vmcnt(14) lgkmcnt(0)
s_barrier
MV 124,a,160,a,8
ds_read_b128 a[128:131], v242 offset:16384
v_mul_f32 v44, v44, v224
MV 128,a,160,a,12
ds_read_b128 a[132:135], v242 offset:17408
v_mul_f32 v45, v45, v224
MV 132,a,164,a,8
v_lshlrev_b32 v46, 16, v197
MV 136,a,164,a,12
ds_read_b128 a[136:139], v242 offset:18432
v_lshlrev_b32 v228, 16, v213
MV 140,a,168,a,8
ds_read_b128 a[140:143], v242 offset:19456
v_and_b32 v47, 0xffff0000, v197
MV 144,a,168,a,12
MV 148,a,172,a,8
ds_read_b128 a[144:147], v243 offset:16384
v_and_b32 v229, 0xffff0000, v213
MV 152,a,172,a,12
ds_read_b128 a[148:151], v243 offset:17408
v_mul_f32 v46, v46, v228
MV 156,a,176,a,8
v_mul_f32 v47, v47, v229
MV 160,a,176,a,12
ds_read_b128 a[152:155], v243 offset:18432
v_mul_f32 v46, v46, v224
MV 164,a,180,a,8
ds_read_b128 a[156:159], v243 offset:19456
MV 168,a,180,a,12
v_mul_f32 v47, v47, v224
MV 172,a,184,a,8
v_lshlrev_b32 v48, 16, v198
MV 176,a,184,a,12
v_lshlrev_b32 v228, 16, v214
MV 180,a,188,a,8
v_and_b32 v49, 0xffff0000, v198
MV 184,a,188,a,12
s_waitcnt lgkmcnt(7)
MV 124,a,128,a,16
ds_read_b128 a[160:163], v242 offset:24576
v_and_b32 v229, 0xffff0000, v214
MV 128,a,128,a,20
ds_read_b128 a[164:167], v242 offset:25600
v_mul_f32 v48, v48, v228
s_waitcnt lgkmcnt(8)
MV 132,a,132,a,16
v_mul_f32 v49, v49, v229
MV 136,a,132,a,20
ds_read_b128 a[168:171], v242 offset:26624
v_mul_f32 v48, v48, v224
s_waitcnt lgkmcnt(8)
MV 140,a,136,a,16
ds_read_b128 a[172:175], v242 offset:27648
v_mul_f32 v49, v49, v224
MV 144,a,136,a,20
s_waitcnt lgkmcnt(8)
MV 148,a,140,a,16
ds_read_b128 a[176:179], v243 offset:24576
v_lshlrev_b32 v50, 16, v199
MV 152,a,140,a,20
ds_read_b128 a[180:183], v243 offset:25600
v_lshlrev_b32 v228, 16, v215
s_waitcnt lgkmcnt(9)
MV 156,a,144,a,16
v_and_b32 v51, 0xffff0000, v199
MV 160,a,144,a,20
ds_read_b128 a[184:187], v243 offset:26624
v_and_b32 v229, 0xffff0000, v215
s_waitcnt lgkmcnt(9)
MV 164,a,148,a,16
ds_read_b128 a[188:191], v243 offset:27648
MV 168,a,148,a,20
v_mul_f32 v50, v50, v228
s_waitcnt lgkmcnt(9)
MV 172,a,152,a,16
v_mul_f32 v51, v51, v229
MV 176,a,152,a,20
v_mul_f32 v50, v50, v224
s_waitcnt lgkmcnt(8)
MV 180,a,156,a,16
v_mul_f32 v51, v51, v224
MV 184,a,156,a,20
s_waitcnt vmcnt(6) lgkmcnt(0)
s_barrier
MV 124,a,160,a,24
ds_read_b128 a[128:131], v242 offset:32768
v_sub_f32 v227, 1.0, v225
MV 128,a,160,a,28
ds_read_b128 a[132:135], v242 offset:33792
v_lshlrev_b32 v52, 16, v200
MV 132,a,164,a,24
v_lshlrev_b32 v228, 16, v216
MV 136,a,164,a,28
ds_read_b128 a[136:139], v242 offset:34816
v_and_b32 v53, 0xffff0000, v200
MV 140,a,168,a,24
ds_read_b128 a[140:143], v242 offset:35840
v_and_b32 v229, 0xffff0000, v216
MV 144,a,168,a,28
MV 148,a,172,a,24
ds_read_b128 a[144:147], v243 offset:32768
v_mul_f32 v52, v52, v228
MV 152,a,172,a,28
ds_read_b128 a[148:151], v243 offset:33792
v_mul_f32 v53, v53, v229
MV 156,a,176,a,24
v_mul_f32 v52, v52, v225
MV 160,a,176,a,28
ds_read_b128 a[152:155], v243 offset:34816
v_mul_f32 v53, v53, v225
MV 164,a,180,a,24
ds_read_b128 a[156:159], v243 offset:35840
MV 168,a,180,a,28
v_lshlrev_b32 v54, 16, v201
MV 172,a,184,a,24
v_lshlrev_b32 v228, 16, v217
MV 176,a,184,a,28
v_and_b32 v55, 0xffff0000, v201
MV 180,a,188,a,24
v_and_b32 v229, 0xffff0000, v217
MV 184,a,188,a,28
s_waitcnt lgkmcnt(7)
MV 124,a,128,a,32
ds_read_b128 a[160:163], v242 offset:40960
v_mul_f32 v54, v54, v228
MV 128,a,128,a,36
ds_read_b128 a[164:167], v242 offset:41984
v_mul_f32 v55, v55, v229
s_waitcnt lgkmcnt(8)
MV 132,a,132,a,32
v_mul_f32 v54, v54, v225
MV 136,a,132,a,36
ds_read_b128 a[168:171], v242 offset:43008
v_mul_f32 v55, v55, v225
s_waitcnt lgkmcnt(8)
MV 140,a,136,a,32
ds_read_b128 a[172:175], v242 offset:44032
v_lshlrev_b32 v56, 16, v202
MV 144,a,136,a,36
s_waitcnt lgkmcnt(8)
MV 148,a,140,a,32
ds_read_b128 a[176:179], v243 offset:40960
v_lshlrev_b32 v228, 16, v218
MV 152,a,140,a,36
ds_read_b128 a[180:183], v243 offset:41984
v_and_b32 v57, 0xffff0000, v202
s_waitcnt lgkmcnt(9)
MV 156,a,144,a,32
v_and_b32 v229, 0xffff0000, v218
MV 160,a,144,a,36
ds_read_b128 a[184:187], v243 offset:43008
v_mul_f32 v56, v56, v228
s_waitcnt lgkmcnt(9)
MV 164,a,148,a,32
ds_read_b128 a[188:191], v243 offset:44032
MV 168,a,148,a,36
v_mul_f32 v57, v57, v229
s_waitcnt lgkmcnt(9)
MV 172,a,152,a,32
v_mul_f32 v56, v56, v225
MV 176,a,152,a,36
v_mul_f32 v57, v57, v225
s_waitcnt lgkmcnt(8)
MV 180,a,156,a,32
v_lshlrev_b32 v58, 16, v203
MV 184,a,156,a,36
s_waitcnt vmcnt(0) lgkmcnt(0)
s_barrier
MV 124,a,160,a,40
ds_read_b128 a[128:131], v242 offset:49152
v_lshlrev_b32 v228, 16, v219
MV 128,a,160,a,44
ds_read_b128 a[132:135], v242 offset:50176
v_and_b32 v59, 0xffff0000, v203
MV 132,a,164,a,40
v_and_b32 v229, 0xffff0000, v219
MV 136,a,164,a,44
ds_read_b128 a[136:139], v242 offset:51200
v_mul_f32 v58, v58, v228
MV 140,a,168,a,40
ds_read_b128 a[140:143], v242 offset:52224
v_mul_f32 v59, v59, v229
MV 144,a,168,a,44
MV 148,a,172,a,40
ds_read_b128 a[144:147], v243 offset:49152
v_mul_f32 v58, v58, v225
MV 152,a,172,a,44
ds_read_b128 a[148:151], v243 offset:50176
v_mul_f32 v59, v59, v225
MV 156,a,176,a,40
v_lshlrev_b32 v60, 16, v204
MV 160,a,176,a,44
ds_read_b128 a[152:155], v243 offset:51200
v_lshlrev_b32 v228, 16, v220
MV 164,a,180,a,40
ds_read_b128 a[156:159], v243 offset:52224
MV 168,a,180,a,44
v_and_b32 v61, 0xffff0000, v204
MV 172,a,184,a,40
v_and_b32 v229, 0xffff0000, v220
MV 176,a,184,a,44
v_mul_f32 v60, v60, v228
MV 180,a,188,a,40
v_mul_f32 v61, v61, v229
MV 184,a,188,a,44
s_waitcnt lgkmcnt(7)
MV 124,a,128,a,48
ds_read_b128 a[160:163], v242 offset:57344
v_mul_f32 v60, v60, v225
MV 128,a,128,a,52
ds_read_b128 a[164:167], v242 offset:58368
v_mul_f32 v61, v61, v225
s_waitcnt lgkmcnt(8)
MV 132,a,132,a,48
v_lshlrev_b32 v62, 16, v205
MV 136,a,132,a,52
ds_read_b128 a[168:171], v242 offset:59392
v_lshlrev_b32 v228, 16, v221
s_waitcnt lgkmcnt(8)
MV 140,a,136,a,48
ds_read_b128 a[172:175], v242 offset:60416
v_and_b32 v63, 0xffff0000, v205
MV 144,a,136,a,52
s_waitcnt lgkmcnt(8)
MV 148,a,140,a,48
ds_read_b128 a[176:179], v243 offset:57344
v_and_b32 v229, 0xffff0000, v221
MV 152,a,140,a,52
ds_read_b128 a[180:183], v243 offset:58368
v_mul_f32 v62, v62, v228
s_waitcnt lgkmcnt(9)
MV 156,a,144,a,48
v_mul_f32 v63, v63, v229
MV 160,a,144,a,52
ds_read_b128 a[184:187], v243 offset:59392
v_mul_f32 v62, v62, v225
s_waitcnt lgkmcnt(9)
MV 164,a,148,a,48
ds_read_b128 a[188:191], v243 offset:60416
MV 168,a,148,a,52
v_mul_f32 v63, v63, v225
s_waitcnt lgkmcnt(9)
MV 172,a,152,a,48
v_lshlrev_b32 v64, 16, v206
MV 176,a,152,a,52
v_lshlrev_b32 v228, 16, v222
s_waitcnt lgkmcnt(8)
MV 180,a,156,a,48
v_and_b32 v65, 0xffff0000, v206
MV 184,a,156,a,52
s_waitcnt lgkmcnt(3)
MV 156,a,176,a,56
v_and_b32 v229, 0xffff0000, v222
MV 160,a,176,a,60
v_mul_f32 v64, v64, v228
s_waitcnt lgkmcnt(2)
MV 164,a,180,a,56
v_mul_f32 v65, v65, v229
MV 168,a,180,a,60
v_mul_f32 v64, v64, v225
s_waitcnt lgkmcnt(1)
MV 172,a,184,a,56
v_mul_f32 v65, v65, v225
MV 176,a,184,a,60
s_waitcnt lgkmcnt(0)
MV 180,a,188,a,56
v_lshlrev_b32 v66, 16, v207
MV 184,a,188,a,60
v_lshlrev_b32 v228, 16, v223
MV 124,a,160,a,56
v_and_b32 v67, 0xffff0000, v207
MV 128,a,160,a,60
v_and_b32 v229, 0xffff0000, v223
MV 132,a,164,a,56
MV 136,a,164,a,60
v_mul_f32 v66, v66, v228
MV 140,a,168,a,56
v_mul_f32 v67, v67, v229
MV 144,a,168,a,60
v_mul_f32 v66, v66, v225
MV 148,a,172,a,56
v_mul_f32 v67, v67, v225
MV 152,a,172,a,60
s_xor_b32 s72, s2, 4
s_lshl_b32 s72, s72, 14
v_cvt_pk_bf16_f32 v156, v156, v157
v_cvt_pk_bf16_f32 v157, v158, v159
v_cvt_pk_bf16_f32 v158, v160, v161
v_cvt_pk_bf16_f32 v159, v162, v163
buffer_store_dwordx4 v[156:159], v238, s[52:55], s72 offen offset:0 sc1
v_cvt_pk_bf16_f32 v164, v164, v165
v_cvt_pk_bf16_f32 v165, v166, v167
v_cvt_pk_bf16_f32 v166, v168, v169
v_cvt_pk_bf16_f32 v167, v170, v171
buffer_store_dwordx4 v[164:167], v238, s[52:55], s72 offen offset:1024 sc1
v_cvt_pk_bf16_f32 v172, v172, v173
v_cvt_pk_bf16_f32 v173, v174, v175
v_cvt_pk_bf16_f32 v174, v176, v177
v_cvt_pk_bf16_f32 v175, v178, v179
buffer_store_dwordx4 v[172:175], v238, s[52:55], s72 offen offset:2048 sc1
v_cvt_pk_bf16_f32 v180, v180, v181
v_cvt_pk_bf16_f32 v181, v182, v183
v_cvt_pk_bf16_f32 v182, v184, v185
v_cvt_pk_bf16_f32 v183, v186, v187
buffer_store_dwordx4 v[180:183], v238, s[52:55], s72 offen offset:3072 sc1
s_lshl_b32 s72, s2, 14
s_mov_b32 s73, 400000
L_xb:
buffer_load_dwordx4 v[76:79], v238, s[52:55], s72 offen offset:0 sc1
buffer_load_dwordx4 v[80:83], v238, s[52:55], s72 offen offset:1024 sc1
buffer_load_dwordx4 v[84:87], v238, s[52:55], s72 offen offset:2048 sc1
buffer_load_dwordx4 v[88:91], v238, s[52:55], s72 offen offset:3072 sc1
s_sub_u32 s73, s73, 1
s_cbranch_scc1 L_xb_done
s_waitcnt vmcnt(3)
v_max3_u32 v228, v76, v77, v78
s_waitcnt vmcnt(2)
v_max3_u32 v228, v228, v79, v80
v_max3_u32 v228, v228, v81, v82
s_waitcnt vmcnt(1)
v_max3_u32 v228, v228, v83, v84
v_max3_u32 v228, v228, v85, v86
s_waitcnt vmcnt(0)
v_max3_u32 v228, v228, v87, v88
v_max3_u32 v228, v228, v89, v90
v_max_u32 v228, v228, v91
v_cmp_eq_u32 vcc, -1, v228
s_nop 4
s_cbranch_vccnz L_xb
L_xb_done:
s_waitcnt vmcnt(0)
v_lshlrev_b32 v92, 16, v76
v_and_b32 v93, 0xffff0000, v76
v_add_f32 v124, v124, v92
v_add_f32 v125, v125, v93
v_lshlrev_b32 v92, 16, v77
v_and_b32 v93, 0xffff0000, v77
v_add_f32 v126, v126, v92
v_add_f32 v127, v127, v93
v_lshlrev_b32 v92, 16, v78
v_and_b32 v93, 0xffff0000, v78
v_add_f32 v128, v128, v92
v_add_f32 v129, v129, v93
v_lshlrev_b32 v92, 16, v79
v_and_b32 v93, 0xffff0000, v79
v_add_f32 v130, v130, v92
v_add_f32 v131, v131, v93
v_lshlrev_b32 v92, 16, v80
v_and_b32 v93, 0xffff0000, v80
v_add_f32 v132, v132, v92
v_add_f32 v133, v133, v93
v_lshlrev_b32 v92, 16, v81
v_and_b32 v93, 0xffff0000, v81
v_add_f32 v134, v134, v92
v_add_f32 v135, v135, v93
v_lshlrev_b32 v92, 16, v82
v_and_b32 v93, 0xffff0000, v82
v_add_f32 v136, v136, v92
v_add_f32 v137, v137, v93
v_lshlrev_b32 v92, 16, v83
v_and_b32 v93, 0xffff0000, v83
v_add_f32 v138, v138, v92
v_add_f32 v139, v139, v93
v_lshlrev_b32 v92, 16, v84
v_and_b32 v93, 0xffff0000, v84
v_add_f32 v140, v140, v92
v_add_f32 v141, v141, v93
v_lshlrev_b32 v92, 16, v85
v_and_b32 v93, 0xffff0000, v85
v_add_f32 v142, v142, v92
v_add_f32 v143, v143, v93
v_lshlrev_b32 v92, 16, v86
v_and_b32 v93, 0xffff0000, v86
v_add_f32 v144, v144, v92
v_add_f32 v145, v145, v93
v_lshlrev_b32 v92, 16, v87
v_and_b32 v93, 0xffff0000, v87
v_add_f32 v146, v146, v92
v_add_f32 v147, v147, v93
v_lshlrev_b32 v92, 16, v88
v_and_b32 v93, 0xffff0000, v88
v_add_f32 v148, v148, v92
v_add_f32 v149, v149, v93
v_lshlrev_b32 v92, 16, v89
v_and_b32 v93, 0xffff0000, v89
v_add_f32 v150, v150, v92
v_add_f32 v151, v151, v93
v_lshlrev_b32 v92, 16, v90
v_and_b32 v93, 0xffff0000, v90
v_add_f32 v152, v152, v92
v_add_f32 v153, v153, v93
v_lshlrev_b32 v92, 16, v91
v_and_b32 v93, 0xffff0000, v91
v_add_f32 v154, v154, v92
v_add_f32 v155, v155, v93
v_permlane16_swap_b32 v124, v132
v_permlane16_swap_b32 v125, v133
v_permlane16_swap_b32 v126, v134
v_permlane16_swap_b32 v127, v135
v_permlane16_swap_b32 v140, v148
v_permlane16_swap_b32 v141, v149
v_permlane16_swap_b32 v142, v150
v_permlane16_swap_b32 v143, v151
v_permlane16_swap_b32 v128, v136
v_permlane16_swap_b32 v129, v137
v_permlane16_swap_b32 v130, v138
v_permlane16_swap_b32 v131, v139
v_permlane16_swap_b32 v144, v152
v_permlane16_swap_b32 v145, v153
v_permlane16_swap_b32 v146, v154
v_permlane16_swap_b32 v147, v155
s_add_u32 s72, s78, 0
v_fma_f32 v36, v124, v226, v36
v_fma_f32 v37, v125, v226, v37
v_fma_f32 v38, v126, v226, v38
v_fma_f32 v39, v127, v226, v39
v_fma_f32 v40, v132, v226, v40
v_fma_f32 v41, v133, v226, v41
v_fma_f32 v42, v134, v226, v42
v_fma_f32 v43, v135, v226, v43
v_cvt_pk_bf16_f32 v192, v36, v37
v_cvt_pk_bf16_f32 v193, v38, v39
v_cvt_pk_bf16_f32 v194, v40, v41
v_cvt_pk_bf16_f32 v195, v42, v43
buffer_store_dwordx4 v[192:195], v250, s[60:63], s72 offen offset:0
v_fma_f32 v44, v140, v226, v44
v_fma_f32 v45, v141, v226, v45
v_fma_f32 v46, v142, v226, v46
v_fma_f32 v47, v143, v226, v47
v_fma_f32 v48, v148, v226, v48
v_fma_f32 v49, v149, v226, v49
v_fma_f32 v50, v150, v226, v50
v_fma_f32 v51, v151, v226, v51
v_cvt_pk_bf16_f32 v196, v44, v45
v_cvt_pk_bf16_f32 v197, v46, v47
v_cvt_pk_bf16_f32 v198, v48, v49
v_cvt_pk_bf16_f32 v199, v50, v51
buffer_store_dwordx4 v[196:199], v250, s[60:63], s72 offen offset:64
s_add_u32 s72, s78, 32768
v_fma_f32 v52, v128, v227, v52
v_fma_f32 v53, v129, v227, v53
v_fma_f32 v54, v130, v227, v54
v_fma_f32 v55, v131, v227, v55
v_fma_f32 v56, v136, v227, v56
v_fma_f32 v57, v137, v227, v57
v_fma_f32 v58, v138, v227, v58
v_fma_f32 v59, v139, v227, v59
v_cvt_pk_bf16_f32 v200, v52, v53
v_cvt_pk_bf16_f32 v201, v54, v55
v_cvt_pk_bf16_f32 v202, v56, v57
v_cvt_pk_bf16_f32 v203, v58, v59
buffer_store_dwordx4 v[200:203], v250, s[60:63], s72 offen offset:0
v_fma_f32 v60, v144, v227, v60
v_fma_f32 v61, v145, v227, v61
v_fma_f32 v62, v146, v227, v62
v_fma_f32 v63, v147, v227, v63
v_fma_f32 v64, v152, v227, v64
v_fma_f32 v65, v153, v227, v65
v_fma_f32 v66, v154, v227, v66
v_fma_f32 v67, v155, v227, v67
v_cvt_pk_bf16_f32 v204, v60, v61
v_cvt_pk_bf16_f32 v205, v62, v63
v_cvt_pk_bf16_f32 v206, v64, v65
v_cvt_pk_bf16_f32 v207, v66, v67
buffer_store_dwordx4 v[204:207], v250, s[60:63], s72 offen offset:64
L_end:
s_endpgm
L_p3_pmask:
s_nop 7
v_add_u32 v246, 0, v13
v_cmp_gt_i32_e64 s[84:85], 0, v246
v_cmp_gt_i32_e64 s[86:87], 1, v246
v_cmp_gt_i32_e64 s[88:89], 2, v246
v_cmp_gt_i32_e64 s[90:91], 3, v246
v_cndmask_b32_e64 v96, v96, v14, s[84:85]
v_cndmask_b32_e64 v97, v97, v14, s[86:87]
v_cndmask_b32_e64 v98, v98, v14, s[88:89]
v_cndmask_b32_e64 v99, v99, v14, s[90:91]
v_cmp_gt_i32_e64 s[92:93], 16, v246
v_cmp_gt_i32_e64 s[94:95], 17, v246
v_cmp_gt_i32_e64 s[96:97], 18, v246
v_cmp_gt_i32_e64 s[98:99], 19, v246
v_cndmask_b32_e64 v100, v100, v14, s[92:93]
v_cndmask_b32_e64 v101, v101, v14, s[94:95]
v_cndmask_b32_e64 v102, v102, v14, s[96:97]
v_cndmask_b32_e64 v103, v103, v14, s[98:99]
v_cmp_gt_i32_e64 s[84:85], 8, v246
v_cmp_gt_i32_e64 s[86:87], 9, v246
v_cmp_gt_i32_e64 s[88:89], 10, v246
v_cmp_gt_i32_e64 s[90:91], 11, v246
v_cndmask_b32_e64 v104, v104, v14, s[84:85]
v_cndmask_b32_e64 v105, v105, v14, s[86:87]
v_cndmask_b32_e64 v106, v106, v14, s[88:89]
v_cndmask_b32_e64 v107, v107, v14, s[90:91]
v_cmp_gt_i32_e64 s[92:93], 24, v246
v_cmp_gt_i32_e64 s[94:95], 25, v246
v_cmp_gt_i32_e64 s[96:97], 26, v246
v_cmp_gt_i32_e64 s[98:99], 27, v246
v_cndmask_b32_e64 v108, v108, v14, s[92:93]
v_cndmask_b32_e64 v109, v109, v14, s[94:95]
v_cndmask_b32_e64 v110, v110, v14, s[96:97]
v_cndmask_b32_e64 v111, v111, v14, s[98:99]
v_add_u32 v247, -32, v13
v_cmp_gt_i32_e64 s[84:85], 0, v247
v_cmp_gt_i32_e64 s[86:87], 1, v247
v_cmp_gt_i32_e64 s[88:89], 2, v247
v_cmp_gt_i32_e64 s[90:91], 3, v247
v_cndmask_b32_e64 v128, v128, v14, s[84:85]
v_cndmask_b32_e64 v129, v129, v14, s[86:87]
v_cndmask_b32_e64 v130, v130, v14, s[88:89]
v_cndmask_b32_e64 v131, v131, v14, s[90:91]
v_cmp_gt_i32_e64 s[92:93], 16, v247
v_cmp_gt_i32_e64 s[94:95], 17, v247
v_cmp_gt_i32_e64 s[96:97], 18, v247
v_cmp_gt_i32_e64 s[98:99], 19, v247
v_cndmask_b32_e64 v132, v132, v14, s[92:93]
v_cndmask_b32_e64 v133, v133, v14, s[94:95]
v_cndmask_b32_e64 v134, v134, v14, s[96:97]
v_cndmask_b32_e64 v135, v135, v14, s[98:99]
v_cmp_gt_i32_e64 s[84:85], 8, v247
v_cmp_gt_i32_e64 s[86:87], 9, v247
v_cmp_gt_i32_e64 s[88:89], 10, v247
v_cmp_gt_i32_e64 s[90:91], 11, v247
v_cndmask_b32_e64 v136, v136, v14, s[84:85]
v_cndmask_b32_e64 v137, v137, v14, s[86:87]
v_cndmask_b32_e64 v138, v138, v14, s[88:89]
v_cndmask_b32_e64 v139, v139, v14, s[90:91]
v_cmp_gt_i32_e64 s[92:93], 24, v247
v_cmp_gt_i32_e64 s[94:95], 25, v247
v_cmp_gt_i32_e64 s[96:97], 26, v247
v_cmp_gt_i32_e64 s[98:99], 27, v247
v_cndmask_b32_e64 v140, v140, v14, s[92:93]
v_cndmask_b32_e64 v141, v141, v14, s[94:95]
v_cndmask_b32_e64 v142, v142, v14, s[96:97]
v_cndmask_b32_e64 v143, v143, v14, s[98:99]
s_branch L_p3_pmask_ret
L_p3_pfix:
v_sub_f32 v208, 0, v6
v_sub_f32 v209, 0, v6
v_sub_f32 v210, 0, v6
v_sub_f32 v211, 0, v6
v_sub_f32 v212, 0, v6
v_sub_f32 v213, 0, v6
v_sub_f32 v214, 0, v6
v_sub_f32 v215, 0, v6
v_sub_f32 v216, 0, v6
v_sub_f32 v217, 0, v6
v_sub_f32 v218, 0, v6
v_sub_f32 v219, 0, v6
v_sub_f32 v220, 0, v6
v_sub_f32 v221, 0, v6
v_sub_f32 v222, 0, v6
v_sub_f32 v223, 0, v6
v_sub_f32 v80, v80, v6
v_sub_f32 v81, v81, v6
v_sub_f32 v82, v82, v6
v_sub_f32 v83, v83, v6
v_sub_f32 v84, v84, v6
v_sub_f32 v85, v85, v6
v_sub_f32 v86, v86, v6
v_sub_f32 v87, v87, v6
v_sub_f32 v88, v88, v6
v_sub_f32 v89, v89, v6
v_sub_f32 v90, v90, v6
v_sub_f32 v91, v91, v6
v_sub_f32 v92, v92, v6
v_sub_f32 v93, v93, v6
v_sub_f32 v94, v94, v6
v_sub_f32 v95, v95, v6
v_sub_f32 v112, v112, v6
v_sub_f32 v113, v113, v6
v_sub_f32 v114, v114, v6
v_sub_f32 v115, v115, v6
v_sub_f32 v116, v116, v6
v_sub_f32 v117, v117, v6
v_sub_f32 v118, v118, v6
v_sub_f32 v119, v119, v6
v_sub_f32 v120, v120, v6
v_sub_f32 v121, v121, v6
v_sub_f32 v122, v122, v6
v_sub_f32 v123, v123, v6
v_sub_f32 v124, v124, v6
v_sub_f32 v125, v125, v6
v_sub_f32 v126, v126, v6
v_sub_f32 v127, v127, v6
v_sub_f32 v224, 0, v7
v_sub_f32 v225, 0, v7
v_sub_f32 v226, 0, v7
v_sub_f32 v227, 0, v7
v_sub_f32 v228, 0, v7
v_sub_f32 v229, 0, v7
v_sub_f32 v230, 0, v7
v_sub_f32 v231, 0, v7
v_sub_f32 v232, 0, v7
v_sub_f32 v233, 0, v7
v_sub_f32 v234, 0, v7
v_sub_f32 v235, 0, v7
v_sub_f32 v236, 0, v7
v_sub_f32 v237, 0, v7
v_sub_f32 v238, 0, v7
v_sub_f32 v239, 0, v7
v_sub_f32 v96, v96, v7
v_sub_f32 v97, v97, v7
v_sub_f32 v98, v98, v7
v_sub_f32 v99, v99, v7
v_sub_f32 v100, v100, v7
v_sub_f32 v101, v101, v7
v_sub_f32 v102, v102, v7
v_sub_f32 v103, v103, v7
v_sub_f32 v104, v104, v7
v_sub_f32 v105, v105, v7
v_sub_f32 v106, v106, v7
v_sub_f32 v107, v107, v7
v_sub_f32 v108, v108, v7
v_sub_f32 v109, v109, v7
v_sub_f32 v110, v110, v7
v_sub_f32 v111, v111, v7
v_sub_f32 v128, v128, v7
v_sub_f32 v129, v129, v7
v_sub_f32 v130, v130, v7
v_sub_f32 v131, v131, v7
v_sub_f32 v132, v132, v7
v_sub_f32 v133, v133, v7
v_sub_f32 v134, v134, v7
v_sub_f32 v135, v135, v7
v_sub_f32 v136, v136, v7
v_sub_f32 v137, v137, v7
v_sub_f32 v138, v138, v7
v_sub_f32 v139, v139, v7
v_sub_f32 v140, v140, v7
v_sub_f32 v141, v141, v7
v_sub_f32 v142, v142, v7
v_sub_f32 v143, v143, v7
s_branch L_p3_pfix_ret
L_p3_mxm_top:
s_waitcnt lgkmcnt(0)
v_xor_b32 v11, 0x8000, v11
v_mfma_f32_32x32x16_bf16 v[80:95], a[128:131], v[16:19], v[208:223]
s_add_u32 m0, s73, 16384
ds_read_b128 a[192:195], v11 offset:0
ds_read_b128 a[196:199], v11 offset:1024
v_exp_f32 v168, v168
v_mfma_f32_32x32x16_bf16 v[80:95], a[132:135], v[20:23], v[80:95]
ds_read_b128 a[200:203], v11 offset:2048
buffer_load_dwordx4 v12, s[56:59], s71 offen offset:0 sc1 lds
v_exp_f32 v169, v169
v_exp_f32 v170, v170
v_mfma_f32_32x32x16_bf16 v[80:95], a[136:139], v[24:27], v[80:95]
ds_read_b128 a[204:207], v11 offset:3072
ds_read_b128 a[208:211], v11 offset:4096
v_add_f32 v4, v4, v168
v_exp_f32 v171, v171
v_add_f32 v5, v5, v169
v_mfma_f32_32x32x16_bf16 v[80:95], a[140:143], v[28:31], v[80:95]
ds_read_b128 a[212:215], v11 offset:5120
buffer_load_dwordx4 v12, s[56:59], s71 offen offset:1024 sc1 lds
v_cvt_pk_bf16_f32 v168, v168, v169
v_exp_f32 v172, v172
v_add_f32 v4, v4, v170
v_mfma_f32_32x32x16_bf16 v[80:95], a[144:147], v[32:35], v[80:95]
ds_read_b128 a[216:219], v11 offset:6144
ds_read_b128 a[220:223], v11 offset:7168
v_exp_f32 v173, v173
v_add_f32 v5, v5, v171
v_cvt_pk_bf16_f32 v169, v170, v171
v_mfma_f32_32x32x16_bf16 v[80:95], a[148:151], v[36:39], v[80:95]
ds_read_b128 a[224:227], v11 offset:8192
v_exp_f32 v174, v174
v_add_f32 v4, v4, v172
v_exp_f32 v175, v175
v_mfma_f32_32x32x16_bf16 v[80:95], a[152:155], v[40:43], v[80:95]
ds_read_b128 a[228:231], v11 offset:9216
ds_read_b128 a[232:235], v11 offset:10240
buffer_load_dwordx4 v12, s[56:59], s71 offen offset:2048 sc1 lds
v_add_f32 v5, v5, v173
v_cvt_pk_bf16_f32 v170, v172, v173
v_mfma_f32_32x32x16_bf16 v[80:95], a[156:159], v[44:47], v[80:95]
ds_read_b128 a[236:239], v11 offset:11264
v_exp_f32 v176, v176
v_add_f32 v4, v4, v174
v_exp_f32 v177, v177
v_mfma_f32_32x32x16_bf16 v[112:127], a[160:163], v[16:19], v[208:223]
ds_read_b128 a[240:243], v11 offset:12288
ds_read_b128 a[244:247], v11 offset:13312
buffer_load_dwordx4 v12, s[56:59], s71 offen offset:3072 sc1 lds
v_add_f32 v5, v5, v175
v_cvt_pk_bf16_f32 v171, v174, v175
v_mfma_f32_32x32x16_bf16 v[112:127], a[164:167], v[20:23], v[112:127]
ds_read_b128 a[248:251], v11 offset:14336
v_exp_f32 v178, v178
v_add_f32 v2, v2, v176
v_exp_f32 v179, v179
v_mfma_f32_32x32x16_bf16 v[112:127], a[168:171], v[24:27], v[112:127]
ds_read_b128 a[252:255], v11 offset:15360
v_add_f32 v3, v3, v177
v_cvt_pk_bf16_f32 v176, v176, v177
v_exp_f32 v180, v180
v_add_f32 v2, v2, v178
v_mfma_f32_32x32x16_bf16 v[112:127], a[172:175], v[28:31], v[112:127]
s_add_u32 s71, s71, 16384
v_exp_f32 v181, v181
v_add_f32 v3, v3, v179
v_cvt_pk_bf16_f32 v177, v178, v179
v_add_u32 v246, 0, v13
v_mfma_f32_32x32x16_bf16 v[112:127], a[176:179], v[32:35], v[112:127]
v_exp_f32 v182, v182
v_add_f32 v2, v2, v180
v_exp_f32 v183, v183
v_add_f32 v3, v3, v181
v_mfma_f32_32x32x16_bf16 v[112:127], a[180:183], v[36:39], v[112:127]
s_xor_b32 s73, s73, 0x8000
v_cvt_pk_bf16_f32 v178, v180, v181
v_exp_f32 v184, v184
v_add_f32 v2, v2, v182
v_cmp_gt_i32_e64 s[84:85], 0, v246
v_mfma_f32_32x32x16_bf16 v[112:127], a[184:187], v[40:43], v[112:127]
v_exp_f32 v185, v185
v_add_f32 v3, v3, v183
v_cvt_pk_bf16_f32 v179, v182, v183
v_exp_f32 v186, v186
v_mfma_f32_32x32x16_bf16 v[112:127], a[188:191], v[44:47], v[112:127]
v_add_f32 v2, v2, v184
v_exp_f32 v187, v187
v_add_f32 v3, v3, v185
v_cvt_pk_bf16_f32 v184, v184, v185
v_exp_f32 v188, v188
v_add_f32 v2, v2, v186
v_exp_f32 v189, v189
v_add_f32 v3, v3, v187
v_cvt_pk_bf16_f32 v185, v186, v187
v_exp_f32 v190, v190
v_add_f32 v2, v2, v188
v_exp_f32 v191, v191
v_add_f32 v3, v3, v189
v_cvt_pk_bf16_f32 v186, v188, v189
v_exp_f32 v192, v192
v_add_f32 v2, v2, v190
v_exp_f32 v193, v193
v_add_f32 v3, v3, v191
v_cvt_pk_bf16_f32 v187, v190, v191
v_exp_f32 v194, v194
v_add_f32 v4, v4, v192
v_exp_f32 v195, v195
v_add_f32 v5, v5, v193
v_cvt_pk_bf16_f32 v192, v192, v193
v_exp_f32 v196, v196
v_add_f32 v4, v4, v194
v_exp_f32 v197, v197
v_add_f32 v5, v5, v195
v_cvt_pk_bf16_f32 v193, v194, v195
v_exp_f32 v198, v198
v_add_f32 v4, v4, v196
v_cmp_gt_i32_e64 s[86:87], 1, v246
v_cmp_gt_i32_e64 s[88:89], 2, v246
v_cmp_gt_i32_e64 s[90:91], 3, v246
v_cndmask_b32_e64 v80, v80, v14, s[84:85]
v_cndmask_b32_e64 v81, v81, v14, s[86:87]
v_exp_f32 v199, v199
v_add_f32 v5, v5, v197
v_cvt_pk_bf16_f32 v194, v196, v197
v_exp_f32 v200, v200
v_add_f32 v4, v4, v198
v_exp_f32 v201, v201
v_cndmask_b32_e64 v82, v82, v14, s[88:89]
v_cndmask_b32_e64 v83, v83, v14, s[90:91]
v_cmp_gt_i32_e64 s[92:93], 16, v246
v_cmp_gt_i32_e64 s[94:95], 17, v246
v_cmp_gt_i32_e64 s[96:97], 18, v246
v_cmp_gt_i32_e64 s[98:99], 19, v246
v_cndmask_b32_e64 v84, v84, v14, s[92:93]
v_add_f32 v5, v5, v199
v_cvt_pk_bf16_f32 v195, v198, v199
v_exp_f32 v202, v202
v_add_f32 v4, v4, v200
v_exp_f32 v203, v203
v_add_f32 v5, v5, v201
v_cvt_pk_bf16_f32 v200, v200, v201
v_cndmask_b32_e64 v85, v85, v14, s[94:95]
v_cndmask_b32_e64 v86, v86, v14, s[96:97]
v_cndmask_b32_e64 v87, v87, v14, s[98:99]
v_cmp_gt_i32_e64 s[84:85], 8, v246
v_cmp_gt_i32_e64 s[86:87], 9, v246
v_cmp_gt_i32_e64 s[88:89], 10, v246
v_exp_f32 v204, v204
v_add_f32 v4, v4, v202
v_exp_f32 v205, v205
v_add_f32 v5, v5, v203
v_cvt_pk_bf16_f32 v201, v202, v203
v_exp_f32 v206, v206
v_cmp_gt_i32_e64 s[90:91], 11, v246
v_cndmask_b32_e64 v88, v88, v14, s[84:85]
v_cndmask_b32_e64 v89, v89, v14, s[86:87]
v_cndmask_b32_e64 v90, v90, v14, s[88:89]
v_cndmask_b32_e64 v91, v91, v14, s[90:91]
v_cmp_gt_i32_e64 s[92:93], 24, v246
v_cmp_gt_i32_e64 s[94:95], 25, v246
v_add_f32 v4, v4, v204
v_exp_f32 v207, v207
v_add_f32 v5, v5, v205
v_cvt_pk_bf16_f32 v202, v204, v205
v_add_f32 v4, v4, v206
v_add_f32 v5, v5, v207
v_cvt_pk_bf16_f32 v203, v206, v207
v_cmp_gt_i32_e64 s[96:97], 26, v246
v_cmp_gt_i32_e64 s[98:99], 27, v246
v_cndmask_b32_e64 v92, v92, v14, s[92:93]
v_cndmask_b32_e64 v93, v93, v14, s[94:95]
v_cndmask_b32_e64 v94, v94, v14, s[96:97]
v_cndmask_b32_e64 v95, v95, v14, s[98:99]
s_waitcnt vmcnt(16) lgkmcnt(0)
v_mfma_f32_32x32x16_bf16 a[0:15], a[192:195], v[144:147], a[0:15]
s_barrier
v_xor_b32 v10, 0x8000, v10
v_mfma_f32_32x32x16_bf16 a[64:79], a[192:195], v[160:163], a[64:79]
ds_read_b128 a[128:131], v10 offset:0
v_max3_f32 v6, v80, v81, v82
v_max3_f32 v6, v6, v83, v84
v_max3_f32 v6, v6, v85, v86
v_max3_f32 v6, v6, v87, v88
v_max3_f32 v6, v6, v89, v90
v_mfma_f32_32x32x16_bf16 a[16:31], a[196:199], v[144:147], a[16:31]
ds_read_b128 a[132:135], v10 offset:1024
v_max3_f32 v6, v6, v91, v92
v_max3_f32 v6, v6, v93, v94
v_add_u32 v247, -32, v13
v_cmp_gt_i32_e64 s[84:85], 0, v247
v_cmp_gt_i32_e64 s[86:87], 1, v247
v_mfma_f32_32x32x16_bf16 a[80:95], a[196:199], v[160:163], a[80:95]
v_cmp_gt_i32_e64 s[88:89], 2, v247
v_cmp_gt_i32_e64 s[90:91], 3, v247
v_cndmask_b32_e64 v112, v112, v14, s[84:85]
v_cndmask_b32_e64 v113, v113, v14, s[86:87]
v_cndmask_b32_e64 v114, v114, v14, s[88:89]
v_mfma_f32_32x32x16_bf16 a[32:47], a[200:203], v[144:147], a[32:47]
ds_read_b128 a[136:139], v10 offset:2048
v_cndmask_b32_e64 v115, v115, v14, s[90:91]
v_cmp_gt_i32_e64 s[92:93], 16, v247
v_cmp_gt_i32_e64 s[94:95], 17, v247
v_cmp_gt_i32_e64 s[96:97], 18, v247
v_cmp_gt_i32_e64 s[98:99], 19, v247
v_mfma_f32_32x32x16_bf16 a[96:111], a[200:203], v[160:163], a[96:111]
v_cndmask_b32_e64 v116, v116, v14, s[92:93]
v_cndmask_b32_e64 v117, v117, v14, s[94:95]
v_cndmask_b32_e64 v118, v118, v14, s[96:97]
v_cndmask_b32_e64 v119, v119, v14, s[98:99]
v_cmp_gt_i32_e64 s[84:85], 8, v247
v_mfma_f32_32x32x16_bf16 a[48:63], a[204:207], v[144:147], a[48:63]
ds_read_b128 a[140:143], v10 offset:3072
v_cmp_gt_i32_e64 s[86:87], 9, v247
v_cmp_gt_i32_e64 s[88:89], 10, v247
v_cmp_gt_i32_e64 s[90:91], 11, v247
v_cndmask_b32_e64 v120, v120, v14, s[84:85]
v_cndmask_b32_e64 v121, v121, v14, s[86:87]
v_mfma_f32_32x32x16_bf16 a[112:127], a[204:207], v[160:163], a[112:127]
ds_read_b128 a[144:147], v10 offset:4096
v_cndmask_b32_e64 v122, v122, v14, s[88:89]
v_cndmask_b32_e64 v123, v123, v14, s[90:91]
v_cmp_gt_i32_e64 s[92:93], 24, v247
v_cmp_gt_i32_e64 s[94:95], 25, v247
v_cmp_gt_i32_e64 s[96:97], 26, v247
v_mfma_f32_32x32x16_bf16 a[0:15], a[208:211], v[152:155], a[0:15]
v_cmp_gt_i32_e64 s[98:99], 27, v247
v_cndmask_b32_e64 v124, v124, v14, s[92:93]
v_cndmask_b32_e64 v125, v125, v14, s[94:95]
v_cndmask_b32_e64 v126, v126, v14, s[96:97]
v_cndmask_b32_e64 v127, v127, v14, s[98:99]
v_mfma_f32_32x32x16_bf16 a[64:79], a[208:211], v[168:171], a[64:79]
ds_read_b128 a[148:151], v10 offset:5120
v_max3_f32 v6, v6, v95, v112
v_max3_f32 v6, v6, v113, v114
v_max3_f32 v6, v6, v115, v116
v_max3_f32 v6, v6, v117, v118
v_max3_f32 v6, v6, v119, v120
v_mfma_f32_32x32x16_bf16 a[16:31], a[212:215], v[152:155], a[16:31]
v_max3_f32 v6, v6, v121, v122
v_max3_f32 v6, v6, v123, v124
v_max3_f32 v6, v6, v125, v126
v_max_f32 v6, v6, v127
v_cmp_lt_f32 vcc, s79, v6
v_mfma_f32_32x32x16_bf16 a[80:95], a[212:215], v[168:171], a[80:95]
s_cbranch_vccnz L_p3_mxm_rare
s_add_u32 m0, s72, 16384
ds_read_b128 a[152:155], v10 offset:6144
v_exp_f32 v80, v80
v_bfe_u32 v248, v1, 2, 2
v_bfe_u32 v249, v1, 4, 1
v_mfma_f32_32x32x16_bf16 a[32:47], a[216:219], v[152:155], a[32:47]
ds_read_b128 a[156:159], v10 offset:7168
buffer_load_dwordx4 v12, s[52:55], s71 offen offset:0 sc1 lds
v_lshl_add_u32 v248, v249, 2, v248
v_lshrrev_b32 v249, 5, v1
v_lshl_add_u32 v249, v249, 4, v248
v_lshlrev_b32 v249, 8, v249
v_mfma_f32_32x32x16_bf16 a[96:111], a[216:219], v[168:171], a[96:111]
v_exp_f32 v81, v81
v_and_b32 v250, 3, v1
v_lshl_add_u32 v249, v250, 3, v249
s_lshl_b32 s36, s3, 13
s_add_u32 s36, s36, 131072
v_mfma_f32_32x32x16_bf16 a[48:63], a[220:223], v[152:155], a[48:63]
ds_read_b128 a[160:163], v10 offset:8192
v_exp_f32 v82, v82
v_add_u32 v249, s36, v249
v_xor_b32 v250, 0, v248
v_lshl_add_u32 v250, v250, 5, v249
v_mfma_f32_32x32x16_bf16 a[112:127], a[220:223], v[168:171], a[112:127]
v_add_f32 v2, v2, v80
v_exp_f32 v83, v83
TR 96,250,0
TR 98,250,2048
v_xor_b32 v250, 1, v248
v_mfma_f32_32x32x16_bf16 a[0:15], a[224:227], v[176:179], a[0:15]
ds_read_b128 a[164:167], v10 offset:9216
buffer_load_dwordx4 v12, s[52:55], s71 offen offset:1024 sc1 lds
v_lshl_add_u32 v250, v250, 5, v249
v_add_f32 v3, v3, v81
TR 100,250,0
TR 102,250,2048
v_mfma_f32_32x32x16_bf16 a[64:79], a[224:227], v[192:195], a[64:79]
ds_read_b128 a[168:171], v10 offset:10240
v_xor_b32 v250, 2, v248
v_lshl_add_u32 v250, v250, 5, v249
v_cvt_pk_bf16_f32 v80, v80, v81
v_exp_f32 v84, v84
v_mfma_f32_32x32x16_bf16 a[16:31], a[228:231], v[176:179], a[16:31]
TR 104,250,0
TR 106,250,2048
v_xor_b32 v250, 3, v248
v_lshl_add_u32 v250, v250, 5, v249
TR 108,250,0
v_add_f32 v2, v2, v82
v_mfma_f32_32x32x16_bf16 a[80:95], a[228:231], v[192:195], a[80:95]
ds_read_b128 a[172:175], v10 offset:11264
TR 110,250,2048
v_xor_b32 v250, 4, v248
v_lshl_add_u32 v250, v250, 5, v249
TR 128,250,0
TR 130,250,2048
v_mfma_f32_32x32x16_bf16 a[32:47], a[232:235], v[176:179], a[32:47]
buffer_load_dwordx4 v12, s[52:55], s71 offen offset:2048 sc1 lds
v_exp_f32 v85, v85
v_xor_b32 v250, 5, v248
v_lshl_add_u32 v250, v250, 5, v249
TR 132,250,0
v_mfma_f32_32x32x16_bf16 a[96:111], a[232:235], v[192:195], a[96:111]
ds_read_b128 a[176:179], v10 offset:12288
v_add_f32 v3, v3, v83
v_cvt_pk_bf16_f32 v81, v82, v83
TR 134,250,2048
v_xor_b32 v250, 6, v248
v_lshl_add_u32 v250, v250, 5, v249
v_mfma_f32_32x32x16_bf16 a[48:63], a[236:239], v[176:179], a[48:63]
ds_read_b128 a[180:183], v10 offset:13312
TR 136,250,0
v_exp_f32 v86, v86
TR 138,250,2048
v_xor_b32 v250, 7, v248
v_mfma_f32_32x32x16_bf16 a[112:127], a[236:239], v[192:195], a[112:127]
v_lshl_add_u32 v250, v250, 5, v249
TR 140,250,0
v_add_f32 v2, v2, v84
v_exp_f32 v87, v87
TR 142,250,2048
v_mfma_f32_32x32x16_bf16 a[0:15], a[240:243], v[184:187], a[0:15]
ds_read_b128 a[184:187], v10 offset:14336
buffer_load_dwordx4 v12, s[52:55], s71 offen offset:3072 sc1 lds
s_add_u32 s32, s40, 100663296
s_addc_u32 s33, s41, 0
s_mov_b32 s34, 8388608
s_mov_b32 s35, 0x20000
v_mfma_f32_32x32x16_bf16 a[64:79], a[240:243], v[200:203], a[64:79]
v_add_f32 v3, v3, v85
s_and_b32 s36, s2, 7
s_lshl_b32 s36, s36, 20
s_lshr_b32 s37, s2, 3
s_lshl_b32 s37, s37, 15
v_cvt_pk_bf16_f32 v82, v84, v85
v_mfma_f32_32x32x16_bf16 a[16:31], a[244:247], v[184:187], a[16:31]
ds_read_b128 a[188:191], v10 offset:15360
v_exp_f32 v88, v88
s_add_u32 s36, s36, s37
s_lshl_b32 s37, s3, 12
s_add_u32 s36, s36, s37
v_mfma_f32_32x32x16_bf16 a[80:95], a[244:247], v[200:203], a[80:95]
s_add_u32 s37, s36, 4096
v_add_f32 v2, v2, v86
s_waitcnt lgkmcnt(15)
buffer_store_dwordx4 v[96:99], v12, s[32:35], s36 offen offset:0 sc1
buffer_store_dwordx4 v[100:103], v12, s[32:35], s36 offen offset:1024 sc1
buffer_store_dwordx4 v[104:107], v12, s[32:35], s36 offen offset:2048 sc1
s_waitcnt lgkmcnt(12)
buffer_store_dwordx4 v[108:111], v12, s[32:35], s36 offen offset:3072 sc1
v_mfma_f32_32x32x16_bf16 a[32:47], a[248:251], v[184:187], a[32:47]
s_xor_b32 s72, s72, 0x8000
v_exp_f32 v89, v89
s_waitcnt lgkmcnt(10)
buffer_store_dwordx4 v[128:131], v12, s[32:35], s37 offen offset:0 sc1
s_waitcnt lgkmcnt(7)
buffer_store_dwordx4 v[132:135], v12, s[32:35], s37 offen offset:1024 sc1
s_waitcnt lgkmcnt(4)
buffer_store_dwordx4 v[136:139], v12, s[32:35], s37 offen offset:2048 sc1
v_mfma_f32_32x32x16_bf16 a[96:111], a[248:251], v[200:203], a[96:111]
s_waitcnt lgkmcnt(2)
buffer_store_dwordx4 v[140:143], v12, s[32:35], s37 offen offset:3072 sc1
v_add_f32 v3, v3, v87
v_cvt_pk_bf16_f32 v83, v86, v87
s_add_u32 s32, s40, 109051904
s_addc_u32 s33, s41, 0
s_mov_b32 s34, 4194304
v_mfma_f32_32x32x16_bf16 a[48:63], a[252:255], v[184:187], a[48:63]
s_mov_b32 s35, 0x20000
s_lshl_b32 s36, s2, 14
v_exp_f32 v90, v90
v_mov_b32 v252, -1
v_mov_b32 v253, -1
v_mfma_f32_32x32x16_bf16 a[112:127], a[252:255], v[200:203], a[112:127]
v_mov_b32 v254, -1
v_mov_b32 v255, -1
v_add_f32 v2, v2, v88
v_exp_f32 v91, v91
buffer_store_dwordx4 v[252:255], v12, s[32:35], s36 offen offset:0 sc1
buffer_store_dwordx4 v[252:255], v12, s[32:35], s36 offen offset:1024 sc1
buffer_store_dwordx4 v[252:255], v12, s[32:35], s36 offen offset:2048 sc1
buffer_store_dwordx4 v[252:255], v12, s[32:35], s36 offen offset:3072 sc1
v_add_f32 v3, v3, v89
v_lshlrev_b32 v72, 4, v1
v_add_u32 v73, -8, v72
v_mov_b32 v75, 0
buffer_load_ushort v74, v75, s[28:31], s42 offen
v_cvt_pk_bf16_f32 v88, v88, v89
v_add_f32 v2, v2, v90
buffer_load_dwordx2 v[48:49], v73, s[16:19], 0 offen
buffer_load_dwordx4 v[50:53], v72, s[16:19], 0 offen offset:0
buffer_load_dwordx2 v[54:55], v72, s[16:19], 0 offen offset:1016
buffer_load_dwordx4 v[56:59], v72, s[16:19], 0 offen offset:1024
v_add_f32 v3, v3, v91
v_cvt_pk_bf16_f32 v89, v90, v91
buffer_load_dwordx2 v[60:61], v72, s[16:19], 0 offen offset:2040
buffer_load_dwordx4 v[62:65], v72, s[16:19], 0 offen offset:2048
buffer_load_dwordx2 v[66:67], v72, s[16:19], 0 offen offset:3064
buffer_load_dwordx4 v[68:71], v72, s[16:19], 0 offen offset:3072
L_p3_mxm_end:
s_branch L_p3_eps
L_p3_d0_rare:
v_mov_b32 v240, v6
v_mov_b32 v241, v6
s_nop 1
v_permlane32_swap_b32 v240, v241
v_max_f32 v242, v240, v241
v_max_f32 v242, 0, v242
v_exp_f32 v8, -v242
v_sub_f32 v208, v208, v242
v_sub_f32 v209, v209, v242
v_sub_f32 v210, v210, v242
v_sub_f32 v211, v211, v242
v_sub_f32 v212, v212, v242
v_sub_f32 v213, v213, v242
v_sub_f32 v214, v214, v242
v_sub_f32 v215, v215, v242
v_sub_f32 v216, v216, v242
v_sub_f32 v217, v217, v242
v_sub_f32 v218, v218, v242
v_sub_f32 v219, v219, v242
v_sub_f32 v220, v220, v242
v_sub_f32 v221, v221, v242
v_sub_f32 v222, v222, v242
v_sub_f32 v223, v223, v242
v_mul_f32 v2, v2, v8
v_mul_f32 v3, v3, v8
v_sub_f32 v144, v144, v242
v_sub_f32 v145, v145, v242
v_sub_f32 v146, v146, v242
v_sub_f32 v147, v147, v242
v_sub_f32 v148, v148, v242
v_sub_f32 v149, v149, v242
v_sub_f32 v150, v150, v242
v_sub_f32 v151, v151, v242
v_sub_f32 v152, v152, v242
v_sub_f32 v153, v153, v242
v_sub_f32 v154, v154, v242
v_sub_f32 v155, v155, v242
v_sub_f32 v156, v156, v242
v_sub_f32 v157, v157, v242
v_sub_f32 v158, v158, v242
v_sub_f32 v159, v159, v242
v_sub_f32 v176, v176, v242
v_sub_f32 v177, v177, v242
v_sub_f32 v178, v178, v242
v_sub_f32 v179, v179, v242
v_sub_f32 v180, v180, v242
v_sub_f32 v181, v181, v242
v_sub_f32 v182, v182, v242
v_sub_f32 v183, v183, v242
v_sub_f32 v184, v184, v242
v_sub_f32 v185, v185, v242
v_sub_f32 v186, v186, v242
v_sub_f32 v187, v187, v242
v_sub_f32 v188, v188, v242
v_sub_f32 v189, v189, v242
v_sub_f32 v190, v190, v242
v_sub_f32 v191, v191, v242
v_mov_b32 v240, v7
v_mov_b32 v241, v7
s_nop 1
v_permlane32_swap_b32 v240, v241
v_max_f32 v242, v240, v241
v_max_f32 v242, 0, v242
v_exp_f32 v9, -v242
v_sub_f32 v224, v224, v242
v_sub_f32 v225, v225, v242
v_sub_f32 v226, v226, v242
v_sub_f32 v227, v227, v242
v_sub_f32 v228, v228, v242
v_sub_f32 v229, v229, v242
v_sub_f32 v230, v230, v242
v_sub_f32 v231, v231, v242
v_sub_f32 v232, v232, v242
v_sub_f32 v233, v233, v242
v_sub_f32 v234, v234, v242
v_sub_f32 v235, v235, v242
v_sub_f32 v236, v236, v242
v_sub_f32 v237, v237, v242
v_sub_f32 v238, v238, v242
v_sub_f32 v239, v239, v242
v_mul_f32 v4, v4, v9
v_mul_f32 v5, v5, v9
v_sub_f32 v160, v160, v242
v_sub_f32 v161, v161, v242
v_sub_f32 v162, v162, v242
v_sub_f32 v163, v163, v242
v_sub_f32 v164, v164, v242
v_sub_f32 v165, v165, v242
v_sub_f32 v166, v166, v242
v_sub_f32 v167, v167, v242
v_sub_f32 v168, v168, v242
v_sub_f32 v169, v169, v242
v_sub_f32 v170, v170, v242
v_sub_f32 v171, v171, v242
v_sub_f32 v172, v172, v242
v_sub_f32 v173, v173, v242
v_sub_f32 v174, v174, v242
v_sub_f32 v175, v175, v242
v_sub_f32 v192, v192, v242
v_sub_f32 v193, v193, v242
v_sub_f32 v194, v194, v242
v_sub_f32 v195, v195, v242
v_sub_f32 v196, v196, v242
v_sub_f32 v197, v197, v242
v_sub_f32 v198, v198, v242
v_sub_f32 v199, v199, v242
v_sub_f32 v200, v200, v242
v_sub_f32 v201, v201, v242
v_sub_f32 v202, v202, v242
v_sub_f32 v203, v203, v242
v_sub_f32 v204, v204, v242
v_sub_f32 v205, v205, v242
v_sub_f32 v206, v206, v242
v_sub_f32 v207, v207, v242
s_add_u32 m0, s72, 0
ds_read_b128 a[144:147], v10 offset:20480
v_exp_f32 v144, v144
v_exp_f32 v145, v145
v_mfma_f32_32x32x16_bf16 a[64:79], a[208:211], v[104:107], a[64:79]
ds_read_b128 a[148:151], v10 offset:21504
buffer_load_dwordx4 v12, s[52:55], s71 offen offset:0 sc1 lds
v_exp_f32 v146, v146
v_add_f32 v2, v2, v144
v_mfma_f32_32x32x16_bf16 a[16:31], a[212:215], v[88:91], a[16:31]
v_exp_f32 v147, v147
v_add_f32 v3, v3, v145
v_cvt_pk_bf16_f32 v144, v144, v145
v_mfma_f32_32x32x16_bf16 a[80:95], a[212:215], v[104:107], a[80:95]
ds_read_b128 a[152:155], v10 offset:22528
v_exp_f32 v148, v148
v_add_f32 v2, v2, v146
v_mfma_f32_32x32x16_bf16 a[32:47], a[216:219], v[88:91], a[32:47]
v_exp_f32 v149, v149
v_add_f32 v3, v3, v147
v_cvt_pk_bf16_f32 v145, v146, v147
v_mfma_f32_32x32x16_bf16 a[96:111], a[216:219], v[104:107], a[96:111]
ds_read_b128 a[156:159], v10 offset:23552
buffer_load_dwordx4 v12, s[52:55], s71 offen offset:1024 sc1 lds
v_exp_f32 v150, v150
v_add_f32 v2, v2, v148
v_mfma_f32_32x32x16_bf16 a[48:63], a[220:223], v[88:91], a[48:63]
ds_read_b128 a[160:163], v10 offset:24576
v_exp_f32 v151, v151
v_add_f32 v3, v3, v149
v_cvt_pk_bf16_f32 v146, v148, v149
v_mfma_f32_32x32x16_bf16 a[112:127], a[220:223], v[104:107], a[112:127]
v_exp_f32 v152, v152
v_add_f32 v2, v2, v150
v_mfma_f32_32x32x16_bf16 a[0:15], a[224:227], v[112:115], a[0:15]
ds_read_b128 a[164:167], v10 offset:25600
v_exp_f32 v153, v153
v_add_f32 v3, v3, v151
v_cvt_pk_bf16_f32 v147, v150, v151
v_mfma_f32_32x32x16_bf16 a[64:79], a[224:227], v[128:131], a[64:79]
v_exp_f32 v154, v154
v_add_f32 v2, v2, v152
v_mfma_f32_32x32x16_bf16 a[16:31], a[228:231], v[112:115], a[16:31]
ds_read_b128 a[168:171], v10 offset:26624
buffer_load_dwordx4 v12, s[52:55], s71 offen offset:2048 sc1 lds
v_exp_f32 v155, v155
v_add_f32 v3, v3, v153
v_cvt_pk_bf16_f32 v152, v152, v153
v_mfma_f32_32x32x16_bf16 a[80:95], a[228:231], v[128:131], a[80:95]
ds_read_b128 a[172:175], v10 offset:27648
v_exp_f32 v156, v156
v_add_f32 v2, v2, v154
v_mfma_f32_32x32x16_bf16 a[32:47], a[232:235], v[112:115], a[32:47]
v_exp_f32 v157, v157
v_add_f32 v3, v3, v155
v_cvt_pk_bf16_f32 v153, v154, v155
v_mfma_f32_32x32x16_bf16 a[96:111], a[232:235], v[128:131], a[96:111]
ds_read_b128 a[176:179], v10 offset:28672
v_exp_f32 v158, v158
v_add_f32 v2, v2, v156
v_mfma_f32_32x32x16_bf16 a[48:63], a[236:239], v[112:115], a[48:63]
buffer_load_dwordx4 v12, s[52:55], s71 offen offset:3072 sc1 lds
v_exp_f32 v159, v159
v_add_f32 v3, v3, v157
v_cvt_pk_bf16_f32 v154, v156, v157
v_mfma_f32_32x32x16_bf16 a[112:127], a[236:239], v[128:131], a[112:127]
ds_read_b128 a[180:183], v10 offset:29696
v_exp_f32 v160, v160
v_add_f32 v2, v2, v158
v_mfma_f32_32x32x16_bf16 a[0:15], a[240:243], v[120:123], a[0:15]
ds_read_b128 a[184:187], v10 offset:30720
v_exp_f32 v161, v161
v_add_f32 v3, v3, v159
v_cvt_pk_bf16_f32 v155, v158, v159
v_mfma_f32_32x32x16_bf16 a[64:79], a[240:243], v[136:139], a[64:79]
v_exp_f32 v162, v162
v_add_f32 v4, v4, v160
v_mfma_f32_32x32x16_bf16 a[16:31], a[244:247], v[120:123], a[16:31]
ds_read_b128 a[188:191], v10 offset:31744
v_exp_f32 v163, v163
v_add_f32 v5, v5, v161
v_cvt_pk_bf16_f32 v160, v160, v161
v_mfma_f32_32x32x16_bf16 a[80:95], a[244:247], v[136:139], a[80:95]
s_sub_u32 s74, s74, 1
v_exp_f32 v164, v164
v_add_f32 v4, v4, v162
v_mfma_f32_32x32x16_bf16 a[32:47], a[248:251], v[120:123], a[32:47]
v_exp_f32 v165, v165
v_add_f32 v5, v5, v163
v_cvt_pk_bf16_f32 v161, v162, v163
v_mfma_f32_32x32x16_bf16 a[96:111], a[248:251], v[136:139], a[96:111]
v_exp_f32 v166, v166
v_add_f32 v4, v4, v164
v_mfma_f32_32x32x16_bf16 a[48:63], a[252:255], v[120:123], a[48:63]
v_exp_f32 v167, v167
v_add_f32 v5, v5, v165
v_cvt_pk_bf16_f32 v162, v164, v165
v_mfma_f32_32x32x16_bf16 a[112:127], a[252:255], v[136:139], a[112:127]
v_add_f32 v4, v4, v166
v_add_f32 v5, v5, v167
v_cvt_pk_bf16_f32 v163, v166, v167
s_nop 15
v_accvgpr_read_b32 v240, a0
v_accvgpr_read_b32 v241, a1
v_accvgpr_read_b32 v242, a2
v_accvgpr_read_b32 v243, a3
v_accvgpr_read_b32 v244, a4
v_accvgpr_read_b32 v245, a5
v_accvgpr_read_b32 v246, a6
v_accvgpr_read_b32 v247, a7
v_mul_f32 v240, v240, v8
v_mul_f32 v241, v241, v8
v_mul_f32 v242, v242, v8
v_mul_f32 v243, v243, v8
v_mul_f32 v244, v244, v8
v_mul_f32 v245, v245, v8
v_mul_f32 v246, v246, v8
v_mul_f32 v247, v247, v8
v_accvgpr_write_b32 a0, v240
v_accvgpr_write_b32 a1, v241
v_accvgpr_write_b32 a2, v242
v_accvgpr_write_b32 a3, v243
v_accvgpr_write_b32 a4, v244
v_accvgpr_write_b32 a5, v245
v_accvgpr_write_b32 a6, v246
v_accvgpr_write_b32 a7, v247
v_accvgpr_read_b32 v240, a8
v_accvgpr_read_b32 v241, a9
v_accvgpr_read_b32 v242, a10
v_accvgpr_read_b32 v243, a11
v_accvgpr_read_b32 v244, a12
v_accvgpr_read_b32 v245, a13
v_accvgpr_read_b32 v246, a14
v_accvgpr_read_b32 v247, a15
v_mul_f32 v240, v240, v8
v_mul_f32 v241, v241, v8
v_mul_f32 v242, v242, v8
v_mul_f32 v243, v243, v8
v_mul_f32 v244, v244, v8
v_mul_f32 v245, v245, v8
v_mul_f32 v246, v246, v8
v_mul_f32 v247, v247, v8
v_accvgpr_write_b32 a8, v240
v_accvgpr_write_b32 a9, v241
v_accvgpr_write_b32 a10, v242
v_accvgpr_write_b32 a11, v243
v_accvgpr_write_b32 a12, v244
v_accvgpr_write_b32 a13, v245
v_accvgpr_write_b32 a14, v246
v_accvgpr_write_b32 a15, v247
v_accvgpr_read_b32 v240, a16
v_accvgpr_read_b32 v241, a17
v_accvgpr_read_b32 v242, a18
v_accvgpr_read_b32 v243, a19
v_accvgpr_read_b32 v244, a20
v_accvgpr_read_b32 v245, a21
v_accvgpr_read_b32 v246, a22
v_accvgpr_read_b32 v247, a23
v_mul_f32 v240, v240, v8
v_mul_f32 v241, v241, v8
v_mul_f32 v242, v242, v8
v_mul_f32 v243, v243, v8
v_mul_f32 v244, v244, v8
v_mul_f32 v245, v245, v8
v_mul_f32 v246, v246, v8
v_mul_f32 v247, v247, v8
v_accvgpr_write_b32 a16, v240
v_accvgpr_write_b32 a17, v241
v_accvgpr_write_b32 a18, v242
v_accvgpr_write_b32 a19, v243
v_accvgpr_write_b32 a20, v244
v_accvgpr_write_b32 a21, v245
v_accvgpr_write_b32 a22, v246
v_accvgpr_write_b32 a23, v247
v_accvgpr_read_b32 v240, a24
v_accvgpr_read_b32 v241, a25
v_accvgpr_read_b32 v242, a26
v_accvgpr_read_b32 v243, a27
v_accvgpr_read_b32 v244, a28
v_accvgpr_read_b32 v245, a29
v_accvgpr_read_b32 v246, a30
v_accvgpr_read_b32 v247, a31
v_mul_f32 v240, v240, v8
v_mul_f32 v241, v241, v8
v_mul_f32 v242, v242, v8
v_mul_f32 v243, v243, v8
v_mul_f32 v244, v244, v8
v_mul_f32 v245, v245, v8
v_mul_f32 v246, v246, v8
v_mul_f32 v247, v247, v8
v_accvgpr_write_b32 a24, v240
v_accvgpr_write_b32 a25, v241
v_accvgpr_write_b32 a26, v242
v_accvgpr_write_b32 a27, v243
v_accvgpr_write_b32 a28, v244
v_accvgpr_write_b32 a29, v245
v_accvgpr_write_b32 a30, v246
v_accvgpr_write_b32 a31, v247
v_accvgpr_read_b32 v240, a32
v_accvgpr_read_b32 v241, a33
v_accvgpr_read_b32 v242, a34
v_accvgpr_read_b32 v243, a35
v_accvgpr_read_b32 v244, a36
v_accvgpr_read_b32 v245, a37
v_accvgpr_read_b32 v246, a38
v_accvgpr_read_b32 v247, a39
v_mul_f32 v240, v240, v8
v_mul_f32 v241, v241, v8
v_mul_f32 v242, v242, v8
v_mul_f32 v243, v243, v8
v_mul_f32 v244, v244, v8
v_mul_f32 v245, v245, v8
v_mul_f32 v246, v246, v8
v_mul_f32 v247, v247, v8
v_accvgpr_write_b32 a32, v240
v_accvgpr_write_b32 a33, v241
v_accvgpr_write_b32 a34, v242
v_accvgpr_write_b32 a35, v243
v_accvgpr_write_b32 a36, v244
v_accvgpr_write_b32 a37, v245
v_accvgpr_write_b32 a38, v246
v_accvgpr_write_b32 a39, v247
v_accvgpr_read_b32 v240, a40
v_accvgpr_read_b32 v241, a41
v_accvgpr_read_b32 v242, a42
v_accvgpr_read_b32 v243, a43
v_accvgpr_read_b32 v244, a44
v_accvgpr_read_b32 v245, a45
v_accvgpr_read_b32 v246, a46
v_accvgpr_read_b32 v247, a47
v_mul_f32 v240, v240, v8
v_mul_f32 v241, v241, v8
v_mul_f32 v242, v242, v8
v_mul_f32 v243, v243, v8
v_mul_f32 v244, v244, v8
v_mul_f32 v245, v245, v8
v_mul_f32 v246, v246, v8
v_mul_f32 v247, v247, v8
v_accvgpr_write_b32 a40, v240
v_accvgpr_write_b32 a41, v241
v_accvgpr_write_b32 a42, v242
v_accvgpr_write_b32 a43, v243
v_accvgpr_write_b32 a44, v244
v_accvgpr_write_b32 a45, v245
v_accvgpr_write_b32 a46, v246
v_accvgpr_write_b32 a47, v247
v_accvgpr_read_b32 v240, a48
v_accvgpr_read_b32 v241, a49
v_accvgpr_read_b32 v242, a50
v_accvgpr_read_b32 v243, a51
v_accvgpr_read_b32 v244, a52
v_accvgpr_read_b32 v245, a53
v_accvgpr_read_b32 v246, a54
v_accvgpr_read_b32 v247, a55
v_mul_f32 v240, v240, v8
v_mul_f32 v241, v241, v8
v_mul_f32 v242, v242, v8
v_mul_f32 v243, v243, v8
v_mul_f32 v244, v244, v8
v_mul_f32 v245, v245, v8
v_mul_f32 v246, v246, v8
v_mul_f32 v247, v247, v8
v_accvgpr_write_b32 a48, v240
v_accvgpr_write_b32 a49, v241
v_accvgpr_write_b32 a50, v242
v_accvgpr_write_b32 a51, v243
v_accvgpr_write_b32 a52, v244
v_accvgpr_write_b32 a53, v245
v_accvgpr_write_b32 a54, v246
v_accvgpr_write_b32 a55, v247
v_accvgpr_read_b32 v240, a56
v_accvgpr_read_b32 v241, a57
v_accvgpr_read_b32 v242, a58
v_accvgpr_read_b32 v243, a59
v_accvgpr_read_b32 v244, a60
v_accvgpr_read_b32 v245, a61
v_accvgpr_read_b32 v246, a62
v_accvgpr_read_b32 v247, a63
v_mul_f32 v240, v240, v8
v_mul_f32 v241, v241, v8
v_mul_f32 v242, v242, v8
v_mul_f32 v243, v243, v8
v_mul_f32 v244, v244, v8
v_mul_f32 v245, v245, v8
v_mul_f32 v246, v246, v8
v_mul_f32 v247, v247, v8
v_accvgpr_write_b32 a56, v240
v_accvgpr_write_b32 a57, v241
v_accvgpr_write_b32 a58, v242
v_accvgpr_write_b32 a59, v243
v_accvgpr_write_b32 a60, v244
v_accvgpr_write_b32 a61, v245
v_accvgpr_write_b32 a62, v246
v_accvgpr_write_b32 a63, v247
v_accvgpr_read_b32 v240, a64
v_accvgpr_read_b32 v241, a65
v_accvgpr_read_b32 v242, a66
v_accvgpr_read_b32 v243, a67
v_accvgpr_read_b32 v244, a68
v_accvgpr_read_b32 v245, a69
v_accvgpr_read_b32 v246, a70
v_accvgpr_read_b32 v247, a71
v_mul_f32 v240, v240, v9
v_mul_f32 v241, v241, v9
v_mul_f32 v242, v242, v9
v_mul_f32 v243, v243, v9
v_mul_f32 v244, v244, v9
v_mul_f32 v245, v245, v9
v_mul_f32 v246, v246, v9
v_mul_f32 v247, v247, v9
v_accvgpr_write_b32 a64, v240
v_accvgpr_write_b32 a65, v241
v_accvgpr_write_b32 a66, v242
v_accvgpr_write_b32 a67, v243
v_accvgpr_write_b32 a68, v244
v_accvgpr_write_b32 a69, v245
v_accvgpr_write_b32 a70, v246
v_accvgpr_write_b32 a71, v247
v_accvgpr_read_b32 v240, a72
v_accvgpr_read_b32 v241, a73
v_accvgpr_read_b32 v242, a74
v_accvgpr_read_b32 v243, a75
v_accvgpr_read_b32 v244, a76
v_accvgpr_read_b32 v245, a77
v_accvgpr_read_b32 v246, a78
v_accvgpr_read_b32 v247, a79
v_mul_f32 v240, v240, v9
v_mul_f32 v241, v241, v9
v_mul_f32 v242, v242, v9
v_mul_f32 v243, v243, v9
v_mul_f32 v244, v244, v9
v_mul_f32 v245, v245, v9
v_mul_f32 v246, v246, v9
v_mul_f32 v247, v247, v9
v_accvgpr_write_b32 a72, v240
v_accvgpr_write_b32 a73, v241
v_accvgpr_write_b32 a74, v242
v_accvgpr_write_b32 a75, v243
v_accvgpr_write_b32 a76, v244
v_accvgpr_write_b32 a77, v245
v_accvgpr_write_b32 a78, v246
v_accvgpr_write_b32 a79, v247
v_accvgpr_read_b32 v240, a80
v_accvgpr_read_b32 v241, a81
v_accvgpr_read_b32 v242, a82
v_accvgpr_read_b32 v243, a83
v_accvgpr_read_b32 v244, a84
v_accvgpr_read_b32 v245, a85
v_accvgpr_read_b32 v246, a86
v_accvgpr_read_b32 v247, a87
v_mul_f32 v240, v240, v9
v_mul_f32 v241, v241, v9
v_mul_f32 v242, v242, v9
v_mul_f32 v243, v243, v9
v_mul_f32 v244, v244, v9
v_mul_f32 v245, v245, v9
v_mul_f32 v246, v246, v9
v_mul_f32 v247, v247, v9
v_accvgpr_write_b32 a80, v240
v_accvgpr_write_b32 a81, v241
v_accvgpr_write_b32 a82, v242
v_accvgpr_write_b32 a83, v243
v_accvgpr_write_b32 a84, v244
v_accvgpr_write_b32 a85, v245
v_accvgpr_write_b32 a86, v246
v_accvgpr_write_b32 a87, v247
v_accvgpr_read_b32 v240, a88
v_accvgpr_read_b32 v241, a89
v_accvgpr_read_b32 v242, a90
v_accvgpr_read_b32 v243, a91
v_accvgpr_read_b32 v244, a92
v_accvgpr_read_b32 v245, a93
v_accvgpr_read_b32 v246, a94
v_accvgpr_read_b32 v247, a95
v_mul_f32 v240, v240, v9
v_mul_f32 v241, v241, v9
v_mul_f32 v242, v242, v9
v_mul_f32 v243, v243, v9
v_mul_f32 v244, v244, v9
v_mul_f32 v245, v245, v9
v_mul_f32 v246, v246, v9
v_mul_f32 v247, v247, v9
v_accvgpr_write_b32 a88, v240
v_accvgpr_write_b32 a89, v241
v_accvgpr_write_b32 a90, v242
v_accvgpr_write_b32 a91, v243
v_accvgpr_write_b32 a92, v244
v_accvgpr_write_b32 a93, v245
v_accvgpr_write_b32 a94, v246
v_accvgpr_write_b32 a95, v247
v_accvgpr_read_b32 v240, a96
v_accvgpr_read_b32 v241, a97
v_accvgpr_read_b32 v242, a98
v_accvgpr_read_b32 v243, a99
v_accvgpr_read_b32 v244, a100
v_accvgpr_read_b32 v245, a101
v_accvgpr_read_b32 v246, a102
v_accvgpr_read_b32 v247, a103
v_mul_f32 v240, v240, v9
v_mul_f32 v241, v241, v9
v_mul_f32 v242, v242, v9
v_mul_f32 v243, v243, v9
v_mul_f32 v244, v244, v9
v_mul_f32 v245, v245, v9
v_mul_f32 v246, v246, v9
v_mul_f32 v247, v247, v9
v_accvgpr_write_b32 a96, v240
v_accvgpr_write_b32 a97, v241
v_accvgpr_write_b32 a98, v242
v_accvgpr_write_b32 a99, v243
v_accvgpr_write_b32 a100, v244
v_accvgpr_write_b32 a101, v245
v_accvgpr_write_b32 a102, v246
v_accvgpr_write_b32 a103, v247
v_accvgpr_read_b32 v240, a104
v_accvgpr_read_b32 v241, a105
v_accvgpr_read_b32 v242, a106
v_accvgpr_read_b32 v243, a107
v_accvgpr_read_b32 v244, a108
v_accvgpr_read_b32 v245, a109
v_accvgpr_read_b32 v246, a110
v_accvgpr_read_b32 v247, a111
v_mul_f32 v240, v240, v9
v_mul_f32 v241, v241, v9
v_mul_f32 v242, v242, v9
v_mul_f32 v243, v243, v9
v_mul_f32 v244, v244, v9
v_mul_f32 v245, v245, v9
v_mul_f32 v246, v246, v9
v_mul_f32 v247, v247, v9
v_accvgpr_write_b32 a104, v240
v_accvgpr_write_b32 a105, v241
v_accvgpr_write_b32 a106, v242
v_accvgpr_write_b32 a107, v243
v_accvgpr_write_b32 a108, v244
v_accvgpr_write_b32 a109, v245
v_accvgpr_write_b32 a110, v246
v_accvgpr_write_b32 a111, v247
v_accvgpr_read_b32 v240, a112
v_accvgpr_read_b32 v241, a113
v_accvgpr_read_b32 v242, a114
v_accvgpr_read_b32 v243, a115
v_accvgpr_read_b32 v244, a116
v_accvgpr_read_b32 v245, a117
v_accvgpr_read_b32 v246, a118
v_accvgpr_read_b32 v247, a119
v_mul_f32 v240, v240, v9
v_mul_f32 v241, v241, v9
v_mul_f32 v242, v242, v9
v_mul_f32 v243, v243, v9
v_mul_f32 v244, v244, v9
v_mul_f32 v245, v245, v9
v_mul_f32 v246, v246, v9
v_mul_f32 v247, v247, v9
v_accvgpr_write_b32 a112, v240
v_accvgpr_write_b32 a113, v241
v_accvgpr_write_b32 a114, v242
v_accvgpr_write_b32 a115, v243
v_accvgpr_write_b32 a116, v244
v_accvgpr_write_b32 a117, v245
v_accvgpr_write_b32 a118, v246
v_accvgpr_write_b32 a119, v247
v_accvgpr_read_b32 v240, a120
v_accvgpr_read_b32 v241, a121
v_accvgpr_read_b32 v242, a122
v_accvgpr_read_b32 v243, a123
v_accvgpr_read_b32 v244, a124
v_accvgpr_read_b32 v245, a125
v_accvgpr_read_b32 v246, a126
v_accvgpr_read_b32 v247, a127
v_mul_f32 v240, v240, v9
v_mul_f32 v241, v241, v9
v_mul_f32 v242, v242, v9
v_mul_f32 v243, v243, v9
v_mul_f32 v244, v244, v9
v_mul_f32 v245, v245, v9
v_mul_f32 v246, v246, v9
v_mul_f32 v247, v247, v9
v_accvgpr_write_b32 a120, v240
v_accvgpr_write_b32 a121, v241
v_accvgpr_write_b32 a122, v242
v_accvgpr_write_b32 a123, v243
v_accvgpr_write_b32 a124, v244
v_accvgpr_write_b32 a125, v245
v_accvgpr_write_b32 a126, v246
v_accvgpr_write_b32 a127, v247
s_nop 1
s_branch L_p3_d0_end
L_p3_d1_rare:
v_mov_b32 v240, v6
v_mov_b32 v241, v6
s_nop 1
v_permlane32_swap_b32 v240, v241
v_max_f32 v242, v240, v241
v_max_f32 v242, 0, v242
v_exp_f32 v8, -v242
v_sub_f32 v208, v208, v242
v_sub_f32 v209, v209, v242
v_sub_f32 v210, v210, v242
v_sub_f32 v211, v211, v242
v_sub_f32 v212, v212, v242
v_sub_f32 v213, v213, v242
v_sub_f32 v214, v214, v242
v_sub_f32 v215, v215, v242
v_sub_f32 v216, v216, v242
v_sub_f32 v217, v217, v242
v_sub_f32 v218, v218, v242
v_sub_f32 v219, v219, v242
v_sub_f32 v220, v220, v242
v_sub_f32 v221, v221, v242
v_sub_f32 v222, v222, v242
v_sub_f32 v223, v223, v242
v_mul_f32 v2, v2, v8
v_mul_f32 v3, v3, v8
v_sub_f32 v80, v80, v242
v_sub_f32 v81, v81, v242
v_sub_f32 v82, v82, v242
v_sub_f32 v83, v83, v242
v_sub_f32 v84, v84, v242
v_sub_f32 v85, v85, v242
v_sub_f32 v86, v86, v242
v_sub_f32 v87, v87, v242
v_sub_f32 v88, v88, v242
v_sub_f32 v89, v89, v242
v_sub_f32 v90, v90, v242
v_sub_f32 v91, v91, v242
v_sub_f32 v92, v92, v242
v_sub_f32 v93, v93, v242
v_sub_f32 v94, v94, v242
v_sub_f32 v95, v95, v242
v_sub_f32 v112, v112, v242
v_sub_f32 v113, v113, v242
v_sub_f32 v114, v114, v242
v_sub_f32 v115, v115, v242
v_sub_f32 v116, v116, v242
v_sub_f32 v117, v117, v242
v_sub_f32 v118, v118, v242
v_sub_f32 v119, v119, v242
v_sub_f32 v120, v120, v242
v_sub_f32 v121, v121, v242
v_sub_f32 v122, v122, v242
v_sub_f32 v123, v123, v242
v_sub_f32 v124, v124, v242
v_sub_f32 v125, v125, v242
v_sub_f32 v126, v126, v242
v_sub_f32 v127, v127, v242
v_mov_b32 v240, v7
v_mov_b32 v241, v7
s_nop 1
v_permlane32_swap_b32 v240, v241
v_max_f32 v242, v240, v241
v_max_f32 v242, 0, v242
v_exp_f32 v9, -v242
v_sub_f32 v224, v224, v242
v_sub_f32 v225, v225, v242
v_sub_f32 v226, v226, v242
v_sub_f32 v227, v227, v242
v_sub_f32 v228, v228, v242
v_sub_f32 v229, v229, v242
v_sub_f32 v230, v230, v242
v_sub_f32 v231, v231, v242
v_sub_f32 v232, v232, v242
v_sub_f32 v233, v233, v242
v_sub_f32 v234, v234, v242
v_sub_f32 v235, v235, v242
v_sub_f32 v236, v236, v242
v_sub_f32 v237, v237, v242
v_sub_f32 v238, v238, v242
v_sub_f32 v239, v239, v242
v_mul_f32 v4, v4, v9
v_mul_f32 v5, v5, v9
v_sub_f32 v96, v96, v242
v_sub_f32 v97, v97, v242
v_sub_f32 v98, v98, v242
v_sub_f32 v99, v99, v242
v_sub_f32 v100, v100, v242
v_sub_f32 v101, v101, v242
v_sub_f32 v102, v102, v242
v_sub_f32 v103, v103, v242
v_sub_f32 v104, v104, v242
v_sub_f32 v105, v105, v242
v_sub_f32 v106, v106, v242
v_sub_f32 v107, v107, v242
v_sub_f32 v108, v108, v242
v_sub_f32 v109, v109, v242
v_sub_f32 v110, v110, v242
v_sub_f32 v111, v111, v242
v_sub_f32 v128, v128, v242
v_sub_f32 v129, v129, v242
v_sub_f32 v130, v130, v242
v_sub_f32 v131, v131, v242
v_sub_f32 v132, v132, v242
v_sub_f32 v133, v133, v242
v_sub_f32 v134, v134, v242
v_sub_f32 v135, v135, v242
v_sub_f32 v136, v136, v242
v_sub_f32 v137, v137, v242
v_sub_f32 v138, v138, v242
v_sub_f32 v139, v139, v242
v_sub_f32 v140, v140, v242
v_sub_f32 v141, v141, v242
v_sub_f32 v142, v142, v242
v_sub_f32 v143, v143, v242
s_add_u32 m0, s72, 16384
ds_read_b128 a[144:147], v10 offset:4096
v_exp_f32 v80, v80
v_exp_f32 v81, v81
v_mfma_f32_32x32x16_bf16 a[64:79], a[208:211], v[168:171], a[64:79]
ds_read_b128 a[148:151], v10 offset:5120
buffer_load_dwordx4 v12, s[52:55], s71 offen offset:0 sc1 lds
v_exp_f32 v82, v82
v_add_f32 v2, v2, v80
v_mfma_f32_32x32x16_bf16 a[16:31], a[212:215], v[152:155], a[16:31]
v_exp_f32 v83, v83
v_add_f32 v3, v3, v81
v_cvt_pk_bf16_f32 v80, v80, v81
v_mfma_f32_32x32x16_bf16 a[80:95], a[212:215], v[168:171], a[80:95]
ds_read_b128 a[152:155], v10 offset:6144
v_exp_f32 v84, v84
v_add_f32 v2, v2, v82
v_mfma_f32_32x32x16_bf16 a[32:47], a[216:219], v[152:155], a[32:47]
v_exp_f32 v85, v85
v_add_f32 v3, v3, v83
v_cvt_pk_bf16_f32 v81, v82, v83
v_mfma_f32_32x32x16_bf16 a[96:111], a[216:219], v[168:171], a[96:111]
ds_read_b128 a[156:159], v10 offset:7168
buffer_load_dwordx4 v12, s[52:55], s71 offen offset:1024 sc1 lds
v_exp_f32 v86, v86
v_add_f32 v2, v2, v84
v_mfma_f32_32x32x16_bf16 a[48:63], a[220:223], v[152:155], a[48:63]
ds_read_b128 a[160:163], v10 offset:8192
v_exp_f32 v87, v87
v_add_f32 v3, v3, v85
v_cvt_pk_bf16_f32 v82, v84, v85
v_mfma_f32_32x32x16_bf16 a[112:127], a[220:223], v[168:171], a[112:127]
v_exp_f32 v88, v88
v_add_f32 v2, v2, v86
v_mfma_f32_32x32x16_bf16 a[0:15], a[224:227], v[176:179], a[0:15]
ds_read_b128 a[164:167], v10 offset:9216
v_exp_f32 v89, v89
v_add_f32 v3, v3, v87
v_cvt_pk_bf16_f32 v83, v86, v87
v_mfma_f32_32x32x16_bf16 a[64:79], a[224:227], v[192:195], a[64:79]
v_exp_f32 v90, v90
v_add_f32 v2, v2, v88
v_mfma_f32_32x32x16_bf16 a[16:31], a[228:231], v[176:179], a[16:31]
ds_read_b128 a[168:171], v10 offset:10240
buffer_load_dwordx4 v12, s[52:55], s71 offen offset:2048 sc1 lds
v_exp_f32 v91, v91
v_add_f32 v3, v3, v89
v_cvt_pk_bf16_f32 v88, v88, v89
v_mfma_f32_32x32x16_bf16 a[80:95], a[228:231], v[192:195], a[80:95]
ds_read_b128 a[172:175], v10 offset:11264
v_exp_f32 v92, v92
v_add_f32 v2, v2, v90
v_mfma_f32_32x32x16_bf16 a[32:47], a[232:235], v[176:179], a[32:47]
v_exp_f32 v93, v93
v_add_f32 v3, v3, v91
v_cvt_pk_bf16_f32 v89, v90, v91
v_mfma_f32_32x32x16_bf16 a[96:111], a[232:235], v[192:195], a[96:111]
ds_read_b128 a[176:179], v10 offset:12288
v_exp_f32 v94, v94
v_add_f32 v2, v2, v92
v_mfma_f32_32x32x16_bf16 a[48:63], a[236:239], v[176:179], a[48:63]
buffer_load_dwordx4 v12, s[52:55], s71 offen offset:3072 sc1 lds
v_exp_f32 v95, v95
v_add_f32 v3, v3, v93
v_cvt_pk_bf16_f32 v90, v92, v93
v_mfma_f32_32x32x16_bf16 a[112:127], a[236:239], v[192:195], a[112:127]
ds_read_b128 a[180:183], v10 offset:13312
v_exp_f32 v96, v96
v_add_f32 v2, v2, v94
v_mfma_f32_32x32x16_bf16 a[0:15], a[240:243], v[184:187], a[0:15]
ds_read_b128 a[184:187], v10 offset:14336
v_exp_f32 v97, v97
v_add_f32 v3, v3, v95
v_cvt_pk_bf16_f32 v91, v94, v95
v_mfma_f32_32x32x16_bf16 a[64:79], a[240:243], v[200:203], a[64:79]
v_exp_f32 v98, v98
v_add_f32 v4, v4, v96
v_mfma_f32_32x32x16_bf16 a[16:31], a[244:247], v[184:187], a[16:31]
ds_read_b128 a[188:191], v10 offset:15360
v_exp_f32 v99, v99
v_add_f32 v5, v5, v97
v_cvt_pk_bf16_f32 v96, v96, v97
v_mfma_f32_32x32x16_bf16 a[80:95], a[244:247], v[200:203], a[80:95]
s_xor_b32 s72, s72, 0x8000
v_exp_f32 v100, v100
v_add_f32 v4, v4, v98
v_mfma_f32_32x32x16_bf16 a[32:47], a[248:251], v[184:187], a[32:47]
v_exp_f32 v101, v101
v_add_f32 v5, v5, v99
v_cvt_pk_bf16_f32 v97, v98, v99
v_mfma_f32_32x32x16_bf16 a[96:111], a[248:251], v[200:203], a[96:111]
v_exp_f32 v102, v102
v_add_f32 v4, v4, v100
v_mfma_f32_32x32x16_bf16 a[48:63], a[252:255], v[184:187], a[48:63]
v_exp_f32 v103, v103
v_add_f32 v5, v5, v101
v_cvt_pk_bf16_f32 v98, v100, v101
v_mfma_f32_32x32x16_bf16 a[112:127], a[252:255], v[200:203], a[112:127]
v_add_f32 v4, v4, v102
v_add_f32 v5, v5, v103
v_cvt_pk_bf16_f32 v99, v102, v103
s_nop 15
v_accvgpr_read_b32 v240, a0
v_accvgpr_read_b32 v241, a1
v_accvgpr_read_b32 v242, a2
v_accvgpr_read_b32 v243, a3
v_accvgpr_read_b32 v244, a4
v_accvgpr_read_b32 v245, a5
v_accvgpr_read_b32 v246, a6
v_accvgpr_read_b32 v247, a7
v_mul_f32 v240, v240, v8
v_mul_f32 v241, v241, v8
v_mul_f32 v242, v242, v8
v_mul_f32 v243, v243, v8
v_mul_f32 v244, v244, v8
v_mul_f32 v245, v245, v8
v_mul_f32 v246, v246, v8
v_mul_f32 v247, v247, v8
v_accvgpr_write_b32 a0, v240
v_accvgpr_write_b32 a1, v241
v_accvgpr_write_b32 a2, v242
v_accvgpr_write_b32 a3, v243
v_accvgpr_write_b32 a4, v244
v_accvgpr_write_b32 a5, v245
v_accvgpr_write_b32 a6, v246
v_accvgpr_write_b32 a7, v247
v_accvgpr_read_b32 v240, a8
v_accvgpr_read_b32 v241, a9
v_accvgpr_read_b32 v242, a10
v_accvgpr_read_b32 v243, a11
v_accvgpr_read_b32 v244, a12
v_accvgpr_read_b32 v245, a13
v_accvgpr_read_b32 v246, a14
v_accvgpr_read_b32 v247, a15
v_mul_f32 v240, v240, v8
v_mul_f32 v241, v241, v8
v_mul_f32 v242, v242, v8
v_mul_f32 v243, v243, v8
v_mul_f32 v244, v244, v8
v_mul_f32 v245, v245, v8
v_mul_f32 v246, v246, v8
v_mul_f32 v247, v247, v8
v_accvgpr_write_b32 a8, v240
v_accvgpr_write_b32 a9, v241
v_accvgpr_write_b32 a10, v242
v_accvgpr_write_b32 a11, v243
v_accvgpr_write_b32 a12, v244
v_accvgpr_write_b32 a13, v245
v_accvgpr_write_b32 a14, v246
v_accvgpr_write_b32 a15, v247
v_accvgpr_read_b32 v240, a16
v_accvgpr_read_b32 v241, a17
v_accvgpr_read_b32 v242, a18
v_accvgpr_read_b32 v243, a19
v_accvgpr_read_b32 v244, a20
v_accvgpr_read_b32 v245, a21
v_accvgpr_read_b32 v246, a22
v_accvgpr_read_b32 v247, a23
v_mul_f32 v240, v240, v8
v_mul_f32 v241, v241, v8
v_mul_f32 v242, v242, v8
v_mul_f32 v243, v243, v8
v_mul_f32 v244, v244, v8
v_mul_f32 v245, v245, v8
v_mul_f32 v246, v246, v8
v_mul_f32 v247, v247, v8
v_accvgpr_write_b32 a16, v240
v_accvgpr_write_b32 a17, v241
v_accvgpr_write_b32 a18, v242
v_accvgpr_write_b32 a19, v243
v_accvgpr_write_b32 a20, v244
v_accvgpr_write_b32 a21, v245
v_accvgpr_write_b32 a22, v246
v_accvgpr_write_b32 a23, v247
v_accvgpr_read_b32 v240, a24
v_accvgpr_read_b32 v241, a25
v_accvgpr_read_b32 v242, a26
v_accvgpr_read_b32 v243, a27
v_accvgpr_read_b32 v244, a28
v_accvgpr_read_b32 v245, a29
v_accvgpr_read_b32 v246, a30
v_accvgpr_read_b32 v247, a31
v_mul_f32 v240, v240, v8
v_mul_f32 v241, v241, v8
v_mul_f32 v242, v242, v8
v_mul_f32 v243, v243, v8
v_mul_f32 v244, v244, v8
v_mul_f32 v245, v245, v8
v_mul_f32 v246, v246, v8
v_mul_f32 v247, v247, v8
v_accvgpr_write_b32 a24, v240
v_accvgpr_write_b32 a25, v241
v_accvgpr_write_b32 a26, v242
v_accvgpr_write_b32 a27, v243
v_accvgpr_write_b32 a28, v244
v_accvgpr_write_b32 a29, v245
v_accvgpr_write_b32 a30, v246
v_accvgpr_write_b32 a31, v247
v_accvgpr_read_b32 v240, a32
v_accvgpr_read_b32 v241, a33
v_accvgpr_read_b32 v242, a34
v_accvgpr_read_b32 v243, a35
v_accvgpr_read_b32 v244, a36
v_accvgpr_read_b32 v245, a37
v_accvgpr_read_b32 v246, a38
v_accvgpr_read_b32 v247, a39
v_mul_f32 v240, v240, v8
v_mul_f32 v241, v241, v8
v_mul_f32 v242, v242, v8
v_mul_f32 v243, v243, v8
v_mul_f32 v244, v244, v8
v_mul_f32 v245, v245, v8
v_mul_f32 v246, v246, v8
v_mul_f32 v247, v247, v8
v_accvgpr_write_b32 a32, v240
v_accvgpr_write_b32 a33, v241
v_accvgpr_write_b32 a34, v242
v_accvgpr_write_b32 a35, v243
v_accvgpr_write_b32 a36, v244
v_accvgpr_write_b32 a37, v245
v_accvgpr_write_b32 a38, v246
v_accvgpr_write_b32 a39, v247
v_accvgpr_read_b32 v240, a40
v_accvgpr_read_b32 v241, a41
v_accvgpr_read_b32 v242, a42
v_accvgpr_read_b32 v243, a43
v_accvgpr_read_b32 v244, a44
v_accvgpr_read_b32 v245, a45
v_accvgpr_read_b32 v246, a46
v_accvgpr_read_b32 v247, a47
v_mul_f32 v240, v240, v8
v_mul_f32 v241, v241, v8
v_mul_f32 v242, v242, v8
v_mul_f32 v243, v243, v8
v_mul_f32 v244, v244, v8
v_mul_f32 v245, v245, v8
v_mul_f32 v246, v246, v8
v_mul_f32 v247, v247, v8
v_accvgpr_write_b32 a40, v240
v_accvgpr_write_b32 a41, v241
v_accvgpr_write_b32 a42, v242
v_accvgpr_write_b32 a43, v243
v_accvgpr_write_b32 a44, v244
v_accvgpr_write_b32 a45, v245
v_accvgpr_write_b32 a46, v246
v_accvgpr_write_b32 a47, v247
v_accvgpr_read_b32 v240, a48
v_accvgpr_read_b32 v241, a49
v_accvgpr_read_b32 v242, a50
v_accvgpr_read_b32 v243, a51
v_accvgpr_read_b32 v244, a52
v_accvgpr_read_b32 v245, a53
v_accvgpr_read_b32 v246, a54
v_accvgpr_read_b32 v247, a55
v_mul_f32 v240, v240, v8
v_mul_f32 v241, v241, v8
v_mul_f32 v242, v242, v8
v_mul_f32 v243, v243, v8
v_mul_f32 v244, v244, v8
v_mul_f32 v245, v245, v8
v_mul_f32 v246, v246, v8
v_mul_f32 v247, v247, v8
v_accvgpr_write_b32 a48, v240
v_accvgpr_write_b32 a49, v241
v_accvgpr_write_b32 a50, v242
v_accvgpr_write_b32 a51, v243
v_accvgpr_write_b32 a52, v244
v_accvgpr_write_b32 a53, v245
v_accvgpr_write_b32 a54, v246
v_accvgpr_write_b32 a55, v247
v_accvgpr_read_b32 v240, a56
v_accvgpr_read_b32 v241, a57
v_accvgpr_read_b32 v242, a58
v_accvgpr_read_b32 v243, a59
v_accvgpr_read_b32 v244, a60
v_accvgpr_read_b32 v245, a61
v_accvgpr_read_b32 v246, a62
v_accvgpr_read_b32 v247, a63
v_mul_f32 v240, v240, v8
v_mul_f32 v241, v241, v8
v_mul_f32 v242, v242, v8
v_mul_f32 v243, v243, v8
v_mul_f32 v244, v244, v8
v_mul_f32 v245, v245, v8
v_mul_f32 v246, v246, v8
v_mul_f32 v247, v247, v8
v_accvgpr_write_b32 a56, v240
v_accvgpr_write_b32 a57, v241
v_accvgpr_write_b32 a58, v242
v_accvgpr_write_b32 a59, v243
v_accvgpr_write_b32 a60, v244
v_accvgpr_write_b32 a61, v245
v_accvgpr_write_b32 a62, v246
v_accvgpr_write_b32 a63, v247
v_accvgpr_read_b32 v240, a64
v_accvgpr_read_b32 v241, a65
v_accvgpr_read_b32 v242, a66
v_accvgpr_read_b32 v243, a67
v_accvgpr_read_b32 v244, a68
v_accvgpr_read_b32 v245, a69
v_accvgpr_read_b32 v246, a70
v_accvgpr_read_b32 v247, a71
v_mul_f32 v240, v240, v9
v_mul_f32 v241, v241, v9
v_mul_f32 v242, v242, v9
v_mul_f32 v243, v243, v9
v_mul_f32 v244, v244, v9
v_mul_f32 v245, v245, v9
v_mul_f32 v246, v246, v9
v_mul_f32 v247, v247, v9
v_accvgpr_write_b32 a64, v240
v_accvgpr_write_b32 a65, v241
v_accvgpr_write_b32 a66, v242
v_accvgpr_write_b32 a67, v243
v_accvgpr_write_b32 a68, v244
v_accvgpr_write_b32 a69, v245
v_accvgpr_write_b32 a70, v246
v_accvgpr_write_b32 a71, v247
v_accvgpr_read_b32 v240, a72
v_accvgpr_read_b32 v241, a73
v_accvgpr_read_b32 v242, a74
v_accvgpr_read_b32 v243, a75
v_accvgpr_read_b32 v244, a76
v_accvgpr_read_b32 v245, a77
v_accvgpr_read_b32 v246, a78
v_accvgpr_read_b32 v247, a79
v_mul_f32 v240, v240, v9
v_mul_f32 v241, v241, v9
v_mul_f32 v242, v242, v9
v_mul_f32 v243, v243, v9
v_mul_f32 v244, v244, v9
v_mul_f32 v245, v245, v9
v_mul_f32 v246, v246, v9
v_mul_f32 v247, v247, v9
v_accvgpr_write_b32 a72, v240
v_accvgpr_write_b32 a73, v241
v_accvgpr_write_b32 a74, v242
v_accvgpr_write_b32 a75, v243
v_accvgpr_write_b32 a76, v244
v_accvgpr_write_b32 a77, v245
v_accvgpr_write_b32 a78, v246
v_accvgpr_write_b32 a79, v247
v_accvgpr_read_b32 v240, a80
v_accvgpr_read_b32 v241, a81
v_accvgpr_read_b32 v242, a82
v_accvgpr_read_b32 v243, a83
v_accvgpr_read_b32 v244, a84
v_accvgpr_read_b32 v245, a85
v_accvgpr_read_b32 v246, a86
v_accvgpr_read_b32 v247, a87
v_mul_f32 v240, v240, v9
v_mul_f32 v241, v241, v9
v_mul_f32 v242, v242, v9
v_mul_f32 v243, v243, v9
v_mul_f32 v244, v244, v9
v_mul_f32 v245, v245, v9
v_mul_f32 v246, v246, v9
v_mul_f32 v247, v247, v9
v_accvgpr_write_b32 a80, v240
v_accvgpr_write_b32 a81, v241
v_accvgpr_write_b32 a82, v242
v_accvgpr_write_b32 a83, v243
v_accvgpr_write_b32 a84, v244
v_accvgpr_write_b32 a85, v245
v_accvgpr_write_b32 a86, v246
v_accvgpr_write_b32 a87, v247
v_accvgpr_read_b32 v240, a88
v_accvgpr_read_b32 v241, a89
v_accvgpr_read_b32 v242, a90
v_accvgpr_read_b32 v243, a91
v_accvgpr_read_b32 v244, a92
v_accvgpr_read_b32 v245, a93
v_accvgpr_read_b32 v246, a94
v_accvgpr_read_b32 v247, a95
v_mul_f32 v240, v240, v9
v_mul_f32 v241, v241, v9
v_mul_f32 v242, v242, v9
v_mul_f32 v243, v243, v9
v_mul_f32 v244, v244, v9
v_mul_f32 v245, v245, v9
v_mul_f32 v246, v246, v9
v_mul_f32 v247, v247, v9
v_accvgpr_write_b32 a88, v240
v_accvgpr_write_b32 a89, v241
v_accvgpr_write_b32 a90, v242
v_accvgpr_write_b32 a91, v243
v_accvgpr_write_b32 a92, v244
v_accvgpr_write_b32 a93, v245
v_accvgpr_write_b32 a94, v246
v_accvgpr_write_b32 a95, v247
v_accvgpr_read_b32 v240, a96
v_accvgpr_read_b32 v241, a97
v_accvgpr_read_b32 v242, a98
v_accvgpr_read_b32 v243, a99
v_accvgpr_read_b32 v244, a100
v_accvgpr_read_b32 v245, a101
v_accvgpr_read_b32 v246, a102
v_accvgpr_read_b32 v247, a103
v_mul_f32 v240, v240, v9
v_mul_f32 v241, v241, v9
v_mul_f32 v242, v242, v9
v_mul_f32 v243, v243, v9
v_mul_f32 v244, v244, v9
v_mul_f32 v245, v245, v9
v_mul_f32 v246, v246, v9
v_mul_f32 v247, v247, v9
v_accvgpr_write_b32 a96, v240
v_accvgpr_write_b32 a97, v241
v_accvgpr_write_b32 a98, v242
v_accvgpr_write_b32 a99, v243
v_accvgpr_write_b32 a100, v244
v_accvgpr_write_b32 a101, v245
v_accvgpr_write_b32 a102, v246
v_accvgpr_write_b32 a103, v247
v_accvgpr_read_b32 v240, a104
v_accvgpr_read_b32 v241, a105
v_accvgpr_read_b32 v242, a106
v_accvgpr_read_b32 v243, a107
v_accvgpr_read_b32 v244, a108
v_accvgpr_read_b32 v245, a109
v_accvgpr_read_b32 v246, a110
v_accvgpr_read_b32 v247, a111
v_mul_f32 v240, v240, v9
v_mul_f32 v241, v241, v9
v_mul_f32 v242, v242, v9
v_mul_f32 v243, v243, v9
v_mul_f32 v244, v244, v9
v_mul_f32 v245, v245, v9
v_mul_f32 v246, v246, v9
v_mul_f32 v247, v247, v9
v_accvgpr_write_b32 a104, v240
v_accvgpr_write_b32 a105, v241
v_accvgpr_write_b32 a106, v242
v_accvgpr_write_b32 a107, v243
v_accvgpr_write_b32 a108, v244
v_accvgpr_write_b32 a109, v245
v_accvgpr_write_b32 a110, v246
v_accvgpr_write_b32 a111, v247
v_accvgpr_read_b32 v240, a112
v_accvgpr_read_b32 v241, a113
v_accvgpr_read_b32 v242, a114
v_accvgpr_read_b32 v243, a115
v_accvgpr_read_b32 v244, a116
v_accvgpr_read_b32 v245, a117
v_accvgpr_read_b32 v246, a118
v_accvgpr_read_b32 v247, a119
v_mul_f32 v240, v240, v9
v_mul_f32 v241, v241, v9
v_mul_f32 v242, v242, v9
v_mul_f32 v243, v243, v9
v_mul_f32 v244, v244, v9
v_mul_f32 v245, v245, v9
v_mul_f32 v246, v246, v9
v_mul_f32 v247, v247, v9
v_accvgpr_write_b32 a112, v240
v_accvgpr_write_b32 a113, v241
v_accvgpr_write_b32 a114, v242
v_accvgpr_write_b32 a115, v243
v_accvgpr_write_b32 a116, v244
v_accvgpr_write_b32 a117, v245
v_accvgpr_write_b32 a118, v246
v_accvgpr_write_b32 a119, v247
v_accvgpr_read_b32 v240, a120
v_accvgpr_read_b32 v241, a121
v_accvgpr_read_b32 v242, a122
v_accvgpr_read_b32 v243, a123
v_accvgpr_read_b32 v244, a124
v_accvgpr_read_b32 v245, a125
v_accvgpr_read_b32 v246, a126
v_accvgpr_read_b32 v247, a127
v_mul_f32 v240, v240, v9
v_mul_f32 v241, v241, v9
v_mul_f32 v242, v242, v9
v_mul_f32 v243, v243, v9
v_mul_f32 v244, v244, v9
v_mul_f32 v245, v245, v9
v_mul_f32 v246, v246, v9
v_mul_f32 v247, v247, v9
v_accvgpr_write_b32 a120, v240
v_accvgpr_write_b32 a121, v241
v_accvgpr_write_b32 a122, v242
v_accvgpr_write_b32 a123, v243
v_accvgpr_write_b32 a124, v244
v_accvgpr_write_b32 a125, v245
v_accvgpr_write_b32 a126, v246
v_accvgpr_write_b32 a127, v247
s_nop 1
s_branch L_p3_d1_end
L_p3_d1m_rare:
v_mov_b32 v240, v6
v_mov_b32 v241, v6
s_nop 1
v_permlane32_swap_b32 v240, v241
v_max_f32 v242, v240, v241
v_max_f32 v242, 0, v242
v_exp_f32 v8, -v242
v_sub_f32 v208, v208, v242
v_sub_f32 v209, v209, v242
v_sub_f32 v210, v210, v242
v_sub_f32 v211, v211, v242
v_sub_f32 v212, v212, v242
v_sub_f32 v213, v213, v242
v_sub_f32 v214, v214, v242
v_sub_f32 v215, v215, v242
v_sub_f32 v216, v216, v242
v_sub_f32 v217, v217, v242
v_sub_f32 v218, v218, v242
v_sub_f32 v219, v219, v242
v_sub_f32 v220, v220, v242
v_sub_f32 v221, v221, v242
v_sub_f32 v222, v222, v242
v_sub_f32 v223, v223, v242
v_mul_f32 v2, v2, v8
v_mul_f32 v3, v3, v8
v_sub_f32 v80, v80, v242
v_sub_f32 v81, v81, v242
v_sub_f32 v82, v82, v242
v_sub_f32 v83, v83, v242
v_sub_f32 v84, v84, v242
v_sub_f32 v85, v85, v242
v_sub_f32 v86, v86, v242
v_sub_f32 v87, v87, v242
v_sub_f32 v88, v88, v242
v_sub_f32 v89, v89, v242
v_sub_f32 v90, v90, v242
v_sub_f32 v91, v91, v242
v_sub_f32 v92, v92, v242
v_sub_f32 v93, v93, v242
v_sub_f32 v94, v94, v242
v_sub_f32 v95, v95, v242
v_sub_f32 v112, v112, v242
v_sub_f32 v113, v113, v242
v_sub_f32 v114, v114, v242
v_sub_f32 v115, v115, v242
v_sub_f32 v116, v116, v242
v_sub_f32 v117, v117, v242
v_sub_f32 v118, v118, v242
v_sub_f32 v119, v119, v242
v_sub_f32 v120, v120, v242
v_sub_f32 v121, v121, v242
v_sub_f32 v122, v122, v242
v_sub_f32 v123, v123, v242
v_sub_f32 v124, v124, v242
v_sub_f32 v125, v125, v242
v_sub_f32 v126, v126, v242
v_sub_f32 v127, v127, v242
v_mov_b32 v240, v7
v_mov_b32 v241, v7
s_nop 1
v_permlane32_swap_b32 v240, v241
v_max_f32 v242, v240, v241
v_max_f32 v242, 0, v242
v_exp_f32 v9, -v242
v_sub_f32 v224, v224, v242
v_sub_f32 v225, v225, v242
v_sub_f32 v226, v226, v242
v_sub_f32 v227, v227, v242
v_sub_f32 v228, v228, v242
v_sub_f32 v229, v229, v242
v_sub_f32 v230, v230, v242
v_sub_f32 v231, v231, v242
v_sub_f32 v232, v232, v242
v_sub_f32 v233, v233, v242
v_sub_f32 v234, v234, v242
v_sub_f32 v235, v235, v242
v_sub_f32 v236, v236, v242
v_sub_f32 v237, v237, v242
v_sub_f32 v238, v238, v242
v_sub_f32 v239, v239, v242
v_mul_f32 v4, v4, v9
v_mul_f32 v5, v5, v9
v_sub_f32 v96, v96, v242
v_sub_f32 v97, v97, v242
v_sub_f32 v98, v98, v242
v_sub_f32 v99, v99, v242
v_sub_f32 v100, v100, v242
v_sub_f32 v101, v101, v242
v_sub_f32 v102, v102, v242
v_sub_f32 v103, v103, v242
v_sub_f32 v104, v104, v242
v_sub_f32 v105, v105, v242
v_sub_f32 v106, v106, v242
v_sub_f32 v107, v107, v242
v_sub_f32 v108, v108, v242
v_sub_f32 v109, v109, v242
v_sub_f32 v110, v110, v242
v_sub_f32 v111, v111, v242
v_sub_f32 v128, v128, v242
v_sub_f32 v129, v129, v242
v_sub_f32 v130, v130, v242
v_sub_f32 v131, v131, v242
v_sub_f32 v132, v132, v242
v_sub_f32 v133, v133, v242
v_sub_f32 v134, v134, v242
v_sub_f32 v135, v135, v242
v_sub_f32 v136, v136, v242
v_sub_f32 v137, v137, v242
v_sub_f32 v138, v138, v242
v_sub_f32 v139, v139, v242
v_sub_f32 v140, v140, v242
v_sub_f32 v141, v141, v242
v_sub_f32 v142, v142, v242
v_sub_f32 v143, v143, v242
s_add_u32 m0, s72, 16384
ds_read_b128 a[160:163], v10 offset:8192
v_exp_f32 v80, v80
v_exp_f32 v81, v81
v_mfma_f32_32x32x16_bf16 a[0:15], a[224:227], v[176:179], a[0:15]
ds_read_b128 a[164:167], v10 offset:9216
buffer_load_dwordx4 v12, s[52:55], s71 offen offset:0 sc1 lds
v_exp_f32 v82, v82
v_add_f32 v2, v2, v80
v_mfma_f32_32x32x16_bf16 a[64:79], a[224:227], v[192:195], a[64:79]
v_exp_f32 v83, v83
v_add_f32 v3, v3, v81
v_cvt_pk_bf16_f32 v80, v80, v81
v_exp_f32 v84, v84
v_mfma_f32_32x32x16_bf16 a[16:31], a[228:231], v[176:179], a[16:31]
ds_read_b128 a[168:171], v10 offset:10240
v_add_f32 v2, v2, v82
v_exp_f32 v85, v85
v_add_f32 v3, v3, v83
v_cvt_pk_bf16_f32 v81, v82, v83
v_mfma_f32_32x32x16_bf16 a[80:95], a[228:231], v[192:195], a[80:95]
ds_read_b128 a[172:175], v10 offset:11264
buffer_load_dwordx4 v12, s[52:55], s71 offen offset:1024 sc1 lds
v_exp_f32 v86, v86
v_add_f32 v2, v2, v84
v_mfma_f32_32x32x16_bf16 a[32:47], a[232:235], v[176:179], a[32:47]
v_exp_f32 v87, v87
v_add_f32 v3, v3, v85
v_cvt_pk_bf16_f32 v82, v84, v85
v_exp_f32 v88, v88
v_mfma_f32_32x32x16_bf16 a[96:111], a[232:235], v[192:195], a[96:111]
ds_read_b128 a[176:179], v10 offset:12288
v_add_f32 v2, v2, v86
v_exp_f32 v89, v89
v_add_f32 v3, v3, v87
v_cvt_pk_bf16_f32 v83, v86, v87
v_mfma_f32_32x32x16_bf16 a[48:63], a[236:239], v[176:179], a[48:63]
buffer_load_dwordx4 v12, s[52:55], s71 offen offset:2048 sc1 lds
v_exp_f32 v90, v90
v_add_f32 v2, v2, v88
v_exp_f32 v91, v91
v_mfma_f32_32x32x16_bf16 a[112:127], a[236:239], v[192:195], a[112:127]
ds_read_b128 a[180:183], v10 offset:13312
v_add_f32 v3, v3, v89
v_cvt_pk_bf16_f32 v88, v88, v89
v_exp_f32 v92, v92
v_add_f32 v2, v2, v90
v_mfma_f32_32x32x16_bf16 a[0:15], a[240:243], v[184:187], a[0:15]
ds_read_b128 a[184:187], v10 offset:14336
v_exp_f32 v93, v93
v_add_f32 v3, v3, v91
v_cvt_pk_bf16_f32 v89, v90, v91
v_mfma_f32_32x32x16_bf16 a[64:79], a[240:243], v[200:203], a[64:79]
buffer_load_dwordx4 v12, s[52:55], s71 offen offset:3072 sc1 lds
v_exp_f32 v94, v94
v_add_f32 v2, v2, v92
v_exp_f32 v95, v95
v_mfma_f32_32x32x16_bf16 a[16:31], a[244:247], v[184:187], a[16:31]
ds_read_b128 a[188:191], v10 offset:15360
v_add_f32 v3, v3, v93
v_cvt_pk_bf16_f32 v90, v92, v93
v_exp_f32 v96, v96
v_add_f32 v2, v2, v94
v_mfma_f32_32x32x16_bf16 a[80:95], a[244:247], v[200:203], a[80:95]
v_exp_f32 v97, v97
v_add_f32 v3, v3, v95
v_cvt_pk_bf16_f32 v91, v94, v95
v_exp_f32 v98, v98
v_mfma_f32_32x32x16_bf16 a[32:47], a[248:251], v[184:187], a[32:47]
s_xor_b32 s72, s72, 0x8000
v_add_f32 v4, v4, v96
v_exp_f32 v99, v99
v_add_f32 v5, v5, v97
v_cvt_pk_bf16_f32 v96, v96, v97
v_mfma_f32_32x32x16_bf16 a[96:111], a[248:251], v[200:203], a[96:111]
v_exp_f32 v100, v100
v_add_f32 v4, v4, v98
v_exp_f32 v101, v101
v_add_f32 v5, v5, v99
v_mfma_f32_32x32x16_bf16 a[48:63], a[252:255], v[184:187], a[48:63]
v_cvt_pk_bf16_f32 v97, v98, v99
v_exp_f32 v102, v102
v_add_f32 v4, v4, v100
v_exp_f32 v103, v103
v_mfma_f32_32x32x16_bf16 a[112:127], a[252:255], v[200:203], a[112:127]
v_add_f32 v5, v5, v101
v_cvt_pk_bf16_f32 v98, v100, v101
v_add_f32 v4, v4, v102
v_add_f32 v5, v5, v103
v_cvt_pk_bf16_f32 v99, v102, v103
s_nop 15
v_accvgpr_read_b32 v240, a0
v_accvgpr_read_b32 v241, a1
v_accvgpr_read_b32 v242, a2
v_accvgpr_read_b32 v243, a3
v_accvgpr_read_b32 v244, a4
v_accvgpr_read_b32 v245, a5
v_accvgpr_read_b32 v246, a6
v_accvgpr_read_b32 v247, a7
v_mul_f32 v240, v240, v8
v_mul_f32 v241, v241, v8
v_mul_f32 v242, v242, v8
v_mul_f32 v243, v243, v8
v_mul_f32 v244, v244, v8
v_mul_f32 v245, v245, v8
v_mul_f32 v246, v246, v8
v_mul_f32 v247, v247, v8
v_accvgpr_write_b32 a0, v240
v_accvgpr_write_b32 a1, v241
v_accvgpr_write_b32 a2, v242
v_accvgpr_write_b32 a3, v243
v_accvgpr_write_b32 a4, v244
v_accvgpr_write_b32 a5, v245
v_accvgpr_write_b32 a6, v246
v_accvgpr_write_b32 a7, v247
v_accvgpr_read_b32 v240, a8
v_accvgpr_read_b32 v241, a9
v_accvgpr_read_b32 v242, a10
v_accvgpr_read_b32 v243, a11
v_accvgpr_read_b32 v244, a12
v_accvgpr_read_b32 v245, a13
v_accvgpr_read_b32 v246, a14
v_accvgpr_read_b32 v247, a15
v_mul_f32 v240, v240, v8
v_mul_f32 v241, v241, v8
v_mul_f32 v242, v242, v8
v_mul_f32 v243, v243, v8
v_mul_f32 v244, v244, v8
v_mul_f32 v245, v245, v8
v_mul_f32 v246, v246, v8
v_mul_f32 v247, v247, v8
v_accvgpr_write_b32 a8, v240
v_accvgpr_write_b32 a9, v241
v_accvgpr_write_b32 a10, v242
v_accvgpr_write_b32 a11, v243
v_accvgpr_write_b32 a12, v244
v_accvgpr_write_b32 a13, v245
v_accvgpr_write_b32 a14, v246
v_accvgpr_write_b32 a15, v247
v_accvgpr_read_b32 v240, a16
v_accvgpr_read_b32 v241, a17
v_accvgpr_read_b32 v242, a18
v_accvgpr_read_b32 v243, a19
v_accvgpr_read_b32 v244, a20
v_accvgpr_read_b32 v245, a21
v_accvgpr_read_b32 v246, a22
v_accvgpr_read_b32 v247, a23
v_mul_f32 v240, v240, v8
v_mul_f32 v241, v241, v8
v_mul_f32 v242, v242, v8
v_mul_f32 v243, v243, v8
v_mul_f32 v244, v244, v8
v_mul_f32 v245, v245, v8
v_mul_f32 v246, v246, v8
v_mul_f32 v247, v247, v8
v_accvgpr_write_b32 a16, v240
v_accvgpr_write_b32 a17, v241
v_accvgpr_write_b32 a18, v242
v_accvgpr_write_b32 a19, v243
v_accvgpr_write_b32 a20, v244
v_accvgpr_write_b32 a21, v245
v_accvgpr_write_b32 a22, v246
v_accvgpr_write_b32 a23, v247
v_accvgpr_read_b32 v240, a24
v_accvgpr_read_b32 v241, a25
v_accvgpr_read_b32 v242, a26
v_accvgpr_read_b32 v243, a27
v_accvgpr_read_b32 v244, a28
v_accvgpr_read_b32 v245, a29
v_accvgpr_read_b32 v246, a30
v_accvgpr_read_b32 v247, a31
v_mul_f32 v240, v240, v8
v_mul_f32 v241, v241, v8
v_mul_f32 v242, v242, v8
v_mul_f32 v243, v243, v8
v_mul_f32 v244, v244, v8
v_mul_f32 v245, v245, v8
v_mul_f32 v246, v246, v8
v_mul_f32 v247, v247, v8
v_accvgpr_write_b32 a24, v240
v_accvgpr_write_b32 a25, v241
v_accvgpr_write_b32 a26, v242
v_accvgpr_write_b32 a27, v243
v_accvgpr_write_b32 a28, v244
v_accvgpr_write_b32 a29, v245
v_accvgpr_write_b32 a30, v246
v_accvgpr_write_b32 a31, v247
v_accvgpr_read_b32 v240, a32
v_accvgpr_read_b32 v241, a33
v_accvgpr_read_b32 v242, a34
v_accvgpr_read_b32 v243, a35
v_accvgpr_read_b32 v244, a36
v_accvgpr_read_b32 v245, a37
v_accvgpr_read_b32 v246, a38
v_accvgpr_read_b32 v247, a39
v_mul_f32 v240, v240, v8
v_mul_f32 v241, v241, v8
v_mul_f32 v242, v242, v8
v_mul_f32 v243, v243, v8
v_mul_f32 v244, v244, v8
v_mul_f32 v245, v245, v8
v_mul_f32 v246, v246, v8
v_mul_f32 v247, v247, v8
v_accvgpr_write_b32 a32, v240
v_accvgpr_write_b32 a33, v241
v_accvgpr_write_b32 a34, v242
v_accvgpr_write_b32 a35, v243
v_accvgpr_write_b32 a36, v244
v_accvgpr_write_b32 a37, v245
v_accvgpr_write_b32 a38, v246
v_accvgpr_write_b32 a39, v247
v_accvgpr_read_b32 v240, a40
v_accvgpr_read_b32 v241, a41
v_accvgpr_read_b32 v242, a42
v_accvgpr_read_b32 v243, a43
v_accvgpr_read_b32 v244, a44
v_accvgpr_read_b32 v245, a45
v_accvgpr_read_b32 v246, a46
v_accvgpr_read_b32 v247, a47
v_mul_f32 v240, v240, v8
v_mul_f32 v241, v241, v8
v_mul_f32 v242, v242, v8
v_mul_f32 v243, v243, v8
v_mul_f32 v244, v244, v8
v_mul_f32 v245, v245, v8
v_mul_f32 v246, v246, v8
v_mul_f32 v247, v247, v8
v_accvgpr_write_b32 a40, v240
v_accvgpr_write_b32 a41, v241
v_accvgpr_write_b32 a42, v242
v_accvgpr_write_b32 a43, v243
v_accvgpr_write_b32 a44, v244
v_accvgpr_write_b32 a45, v245
v_accvgpr_write_b32 a46, v246
v_accvgpr_write_b32 a47, v247
v_accvgpr_read_b32 v240, a48
v_accvgpr_read_b32 v241, a49
v_accvgpr_read_b32 v242, a50
v_accvgpr_read_b32 v243, a51
v_accvgpr_read_b32 v244, a52
v_accvgpr_read_b32 v245, a53
v_accvgpr_read_b32 v246, a54
v_accvgpr_read_b32 v247, a55
v_mul_f32 v240, v240, v8
v_mul_f32 v241, v241, v8
v_mul_f32 v242, v242, v8
v_mul_f32 v243, v243, v8
v_mul_f32 v244, v244, v8
v_mul_f32 v245, v245, v8
v_mul_f32 v246, v246, v8
v_mul_f32 v247, v247, v8
v_accvgpr_write_b32 a48, v240
v_accvgpr_write_b32 a49, v241
v_accvgpr_write_b32 a50, v242
v_accvgpr_write_b32 a51, v243
v_accvgpr_write_b32 a52, v244
v_accvgpr_write_b32 a53, v245
v_accvgpr_write_b32 a54, v246
v_accvgpr_write_b32 a55, v247
v_accvgpr_read_b32 v240, a56
v_accvgpr_read_b32 v241, a57
v_accvgpr_read_b32 v242, a58
v_accvgpr_read_b32 v243, a59
v_accvgpr_read_b32 v244, a60
v_accvgpr_read_b32 v245, a61
v_accvgpr_read_b32 v246, a62
v_accvgpr_read_b32 v247, a63
v_mul_f32 v240, v240, v8
v_mul_f32 v241, v241, v8
v_mul_f32 v242, v242, v8
v_mul_f32 v243, v243, v8
v_mul_f32 v244, v244, v8
v_mul_f32 v245, v245, v8
v_mul_f32 v246, v246, v8
v_mul_f32 v247, v247, v8
v_accvgpr_write_b32 a56, v240
v_accvgpr_write_b32 a57, v241
v_accvgpr_write_b32 a58, v242
v_accvgpr_write_b32 a59, v243
v_accvgpr_write_b32 a60, v244
v_accvgpr_write_b32 a61, v245
v_accvgpr_write_b32 a62, v246
v_accvgpr_write_b32 a63, v247
v_accvgpr_read_b32 v240, a64
v_accvgpr_read_b32 v241, a65
v_accvgpr_read_b32 v242, a66
v_accvgpr_read_b32 v243, a67
v_accvgpr_read_b32 v244, a68
v_accvgpr_read_b32 v245, a69
v_accvgpr_read_b32 v246, a70
v_accvgpr_read_b32 v247, a71
v_mul_f32 v240, v240, v9
v_mul_f32 v241, v241, v9
v_mul_f32 v242, v242, v9
v_mul_f32 v243, v243, v9
v_mul_f32 v244, v244, v9
v_mul_f32 v245, v245, v9
v_mul_f32 v246, v246, v9
v_mul_f32 v247, v247, v9
v_accvgpr_write_b32 a64, v240
v_accvgpr_write_b32 a65, v241
v_accvgpr_write_b32 a66, v242
v_accvgpr_write_b32 a67, v243
v_accvgpr_write_b32 a68, v244
v_accvgpr_write_b32 a69, v245
v_accvgpr_write_b32 a70, v246
v_accvgpr_write_b32 a71, v247
v_accvgpr_read_b32 v240, a72
v_accvgpr_read_b32 v241, a73
v_accvgpr_read_b32 v242, a74
v_accvgpr_read_b32 v243, a75
v_accvgpr_read_b32 v244, a76
v_accvgpr_read_b32 v245, a77
v_accvgpr_read_b32 v246, a78
v_accvgpr_read_b32 v247, a79
v_mul_f32 v240, v240, v9
v_mul_f32 v241, v241, v9
v_mul_f32 v242, v242, v9
v_mul_f32 v243, v243, v9
v_mul_f32 v244, v244, v9
v_mul_f32 v245, v245, v9
v_mul_f32 v246, v246, v9
v_mul_f32 v247, v247, v9
v_accvgpr_write_b32 a72, v240
v_accvgpr_write_b32 a73, v241
v_accvgpr_write_b32 a74, v242
v_accvgpr_write_b32 a75, v243
v_accvgpr_write_b32 a76, v244
v_accvgpr_write_b32 a77, v245
v_accvgpr_write_b32 a78, v246
v_accvgpr_write_b32 a79, v247
v_accvgpr_read_b32 v240, a80
v_accvgpr_read_b32 v241, a81
v_accvgpr_read_b32 v242, a82
v_accvgpr_read_b32 v243, a83
v_accvgpr_read_b32 v244, a84
v_accvgpr_read_b32 v245, a85
v_accvgpr_read_b32 v246, a86
v_accvgpr_read_b32 v247, a87
v_mul_f32 v240, v240, v9
v_mul_f32 v241, v241, v9
v_mul_f32 v242, v242, v9
v_mul_f32 v243, v243, v9
v_mul_f32 v244, v244, v9
v_mul_f32 v245, v245, v9
v_mul_f32 v246, v246, v9
v_mul_f32 v247, v247, v9
v_accvgpr_write_b32 a80, v240
v_accvgpr_write_b32 a81, v241
v_accvgpr_write_b32 a82, v242
v_accvgpr_write_b32 a83, v243
v_accvgpr_write_b32 a84, v244
v_accvgpr_write_b32 a85, v245
v_accvgpr_write_b32 a86, v246
v_accvgpr_write_b32 a87, v247
v_accvgpr_read_b32 v240, a88
v_accvgpr_read_b32 v241, a89
v_accvgpr_read_b32 v242, a90
v_accvgpr_read_b32 v243, a91
v_accvgpr_read_b32 v244, a92
v_accvgpr_read_b32 v245, a93
v_accvgpr_read_b32 v246, a94
v_accvgpr_read_b32 v247, a95
v_mul_f32 v240, v240, v9
v_mul_f32 v241, v241, v9
v_mul_f32 v242, v242, v9
v_mul_f32 v243, v243, v9
v_mul_f32 v244, v244, v9
v_mul_f32 v245, v245, v9
v_mul_f32 v246, v246, v9
v_mul_f32 v247, v247, v9
v_accvgpr_write_b32 a88, v240
v_accvgpr_write_b32 a89, v241
v_accvgpr_write_b32 a90, v242
v_accvgpr_write_b32 a91, v243
v_accvgpr_write_b32 a92, v244
v_accvgpr_write_b32 a93, v245
v_accvgpr_write_b32 a94, v246
v_accvgpr_write_b32 a95, v247
v_accvgpr_read_b32 v240, a96
v_accvgpr_read_b32 v241, a97
v_accvgpr_read_b32 v242, a98
v_accvgpr_read_b32 v243, a99
v_accvgpr_read_b32 v244, a100
v_accvgpr_read_b32 v245, a101
v_accvgpr_read_b32 v246, a102
v_accvgpr_read_b32 v247, a103
v_mul_f32 v240, v240, v9
v_mul_f32 v241, v241, v9
v_mul_f32 v242, v242, v9
v_mul_f32 v243, v243, v9
v_mul_f32 v244, v244, v9
v_mul_f32 v245, v245, v9
v_mul_f32 v246, v246, v9
v_mul_f32 v247, v247, v9
v_accvgpr_write_b32 a96, v240
v_accvgpr_write_b32 a97, v241
v_accvgpr_write_b32 a98, v242
v_accvgpr_write_b32 a99, v243
v_accvgpr_write_b32 a100, v244
v_accvgpr_write_b32 a101, v245
v_accvgpr_write_b32 a102, v246
v_accvgpr_write_b32 a103, v247
v_accvgpr_read_b32 v240, a104
v_accvgpr_read_b32 v241, a105
v_accvgpr_read_b32 v242, a106
v_accvgpr_read_b32 v243, a107
v_accvgpr_read_b32 v244, a108
v_accvgpr_read_b32 v245, a109
v_accvgpr_read_b32 v246, a110
v_accvgpr_read_b32 v247, a111
v_mul_f32 v240, v240, v9
v_mul_f32 v241, v241, v9
v_mul_f32 v242, v242, v9
v_mul_f32 v243, v243, v9
v_mul_f32 v244, v244, v9
v_mul_f32 v245, v245, v9
v_mul_f32 v246, v246, v9
v_mul_f32 v247, v247, v9
v_accvgpr_write_b32 a104, v240
v_accvgpr_write_b32 a105, v241
v_accvgpr_write_b32 a106, v242
v_accvgpr_write_b32 a107, v243
v_accvgpr_write_b32 a108, v244
v_accvgpr_write_b32 a109, v245
v_accvgpr_write_b32 a110, v246
v_accvgpr_write_b32 a111, v247
v_accvgpr_read_b32 v240, a112
v_accvgpr_read_b32 v241, a113
v_accvgpr_read_b32 v242, a114
v_accvgpr_read_b32 v243, a115
v_accvgpr_read_b32 v244, a116
v_accvgpr_read_b32 v245, a117
v_accvgpr_read_b32 v246, a118
v_accvgpr_read_b32 v247, a119
v_mul_f32 v240, v240, v9
v_mul_f32 v241, v241, v9
v_mul_f32 v242, v242, v9
v_mul_f32 v243, v243, v9
v_mul_f32 v244, v244, v9
v_mul_f32 v245, v245, v9
v_mul_f32 v246, v246, v9
v_mul_f32 v247, v247, v9
v_accvgpr_write_b32 a112, v240
v_accvgpr_write_b32 a113, v241
v_accvgpr_write_b32 a114, v242
v_accvgpr_write_b32 a115, v243
v_accvgpr_write_b32 a116, v244
v_accvgpr_write_b32 a117, v245
v_accvgpr_write_b32 a118, v246
v_accvgpr_write_b32 a119, v247
v_accvgpr_read_b32 v240, a120
v_accvgpr_read_b32 v241, a121
v_accvgpr_read_b32 v242, a122
v_accvgpr_read_b32 v243, a123
v_accvgpr_read_b32 v244, a124
v_accvgpr_read_b32 v245, a125
v_accvgpr_read_b32 v246, a126
v_accvgpr_read_b32 v247, a127
v_mul_f32 v240, v240, v9
v_mul_f32 v241, v241, v9
v_mul_f32 v242, v242, v9
v_mul_f32 v243, v243, v9
v_mul_f32 v244, v244, v9
v_mul_f32 v245, v245, v9
v_mul_f32 v246, v246, v9
v_mul_f32 v247, v247, v9
v_accvgpr_write_b32 a120, v240
v_accvgpr_write_b32 a121, v241
v_accvgpr_write_b32 a122, v242
v_accvgpr_write_b32 a123, v243
v_accvgpr_write_b32 a124, v244
v_accvgpr_write_b32 a125, v245
v_accvgpr_write_b32 a126, v246
v_accvgpr_write_b32 a127, v247
s_nop 1
s_branch L_p3_d1m_end
L_p3_d0m_rare:
v_mov_b32 v240, v6
v_mov_b32 v241, v6
s_nop 1
v_permlane32_swap_b32 v240, v241
v_max_f32 v242, v240, v241
v_max_f32 v242, 0, v242
v_exp_f32 v8, -v242
v_sub_f32 v208, v208, v242
v_sub_f32 v209, v209, v242
v_sub_f32 v210, v210, v242
v_sub_f32 v211, v211, v242
v_sub_f32 v212, v212, v242
v_sub_f32 v213, v213, v242
v_sub_f32 v214, v214, v242
v_sub_f32 v215, v215, v242
v_sub_f32 v216, v216, v242
v_sub_f32 v217, v217, v242
v_sub_f32 v218, v218, v242
v_sub_f32 v219, v219, v242
v_sub_f32 v220, v220, v242
v_sub_f32 v221, v221, v242
v_sub_f32 v222, v222, v242
v_sub_f32 v223, v223, v242
v_mul_f32 v2, v2, v8
v_mul_f32 v3, v3, v8
v_sub_f32 v144, v144, v242
v_sub_f32 v145, v145, v242
v_sub_f32 v146, v146, v242
v_sub_f32 v147, v147, v242
v_sub_f32 v148, v148, v242
v_sub_f32 v149, v149, v242
v_sub_f32 v150, v150, v242
v_sub_f32 v151, v151, v242
v_sub_f32 v152, v152, v242
v_sub_f32 v153, v153, v242
v_sub_f32 v154, v154, v242
v_sub_f32 v155, v155, v242
v_sub_f32 v156, v156, v242
v_sub_f32 v157, v157, v242
v_sub_f32 v158, v158, v242
v_sub_f32 v159, v159, v242
v_sub_f32 v176, v176, v242
v_sub_f32 v177, v177, v242
v_sub_f32 v178, v178, v242
v_sub_f32 v179, v179, v242
v_sub_f32 v180, v180, v242
v_sub_f32 v181, v181, v242
v_sub_f32 v182, v182, v242
v_sub_f32 v183, v183, v242
v_sub_f32 v184, v184, v242
v_sub_f32 v185, v185, v242
v_sub_f32 v186, v186, v242
v_sub_f32 v187, v187, v242
v_sub_f32 v188, v188, v242
v_sub_f32 v189, v189, v242
v_sub_f32 v190, v190, v242
v_sub_f32 v191, v191, v242
v_mov_b32 v240, v7
v_mov_b32 v241, v7
s_nop 1
v_permlane32_swap_b32 v240, v241
v_max_f32 v242, v240, v241
v_max_f32 v242, 0, v242
v_exp_f32 v9, -v242
v_sub_f32 v224, v224, v242
v_sub_f32 v225, v225, v242
v_sub_f32 v226, v226, v242
v_sub_f32 v227, v227, v242
v_sub_f32 v228, v228, v242
v_sub_f32 v229, v229, v242
v_sub_f32 v230, v230, v242
v_sub_f32 v231, v231, v242
v_sub_f32 v232, v232, v242
v_sub_f32 v233, v233, v242
v_sub_f32 v234, v234, v242
v_sub_f32 v235, v235, v242
v_sub_f32 v236, v236, v242
v_sub_f32 v237, v237, v242
v_sub_f32 v238, v238, v242
v_sub_f32 v239, v239, v242
v_mul_f32 v4, v4, v9
v_mul_f32 v5, v5, v9
v_sub_f32 v160, v160, v242
v_sub_f32 v161, v161, v242
v_sub_f32 v162, v162, v242
v_sub_f32 v163, v163, v242
v_sub_f32 v164, v164, v242
v_sub_f32 v165, v165, v242
v_sub_f32 v166, v166, v242
v_sub_f32 v167, v167, v242
v_sub_f32 v168, v168, v242
v_sub_f32 v169, v169, v242
v_sub_f32 v170, v170, v242
v_sub_f32 v171, v171, v242
v_sub_f32 v172, v172, v242
v_sub_f32 v173, v173, v242
v_sub_f32 v174, v174, v242
v_sub_f32 v175, v175, v242
v_sub_f32 v192, v192, v242
v_sub_f32 v193, v193, v242
v_sub_f32 v194, v194, v242
v_sub_f32 v195, v195, v242
v_sub_f32 v196, v196, v242
v_sub_f32 v197, v197, v242
v_sub_f32 v198, v198, v242
v_sub_f32 v199, v199, v242
v_sub_f32 v200, v200, v242
v_sub_f32 v201, v201, v242
v_sub_f32 v202, v202, v242
v_sub_f32 v203, v203, v242
v_sub_f32 v204, v204, v242
v_sub_f32 v205, v205, v242
v_sub_f32 v206, v206, v242
v_sub_f32 v207, v207, v242
s_add_u32 m0, s72, 0
ds_read_b128 a[160:163], v10 offset:24576
v_exp_f32 v144, v144
v_exp_f32 v145, v145
v_mfma_f32_32x32x16_bf16 a[0:15], a[224:227], v[112:115], a[0:15]
ds_read_b128 a[164:167], v10 offset:25600
buffer_load_dwordx4 v12, s[52:55], s71 offen offset:0 sc1 lds
v_exp_f32 v146, v146
v_add_f32 v2, v2, v144
v_mfma_f32_32x32x16_bf16 a[64:79], a[224:227], v[128:131], a[64:79]
v_exp_f32 v147, v147
v_add_f32 v3, v3, v145
v_cvt_pk_bf16_f32 v144, v144, v145
v_exp_f32 v148, v148
v_mfma_f32_32x32x16_bf16 a[16:31], a[228:231], v[112:115], a[16:31]
ds_read_b128 a[168:171], v10 offset:26624
v_add_f32 v2, v2, v146
v_exp_f32 v149, v149
v_add_f32 v3, v3, v147
v_cvt_pk_bf16_f32 v145, v146, v147
v_mfma_f32_32x32x16_bf16 a[80:95], a[228:231], v[128:131], a[80:95]
ds_read_b128 a[172:175], v10 offset:27648
buffer_load_dwordx4 v12, s[52:55], s71 offen offset:1024 sc1 lds
v_exp_f32 v150, v150
v_add_f32 v2, v2, v148
v_mfma_f32_32x32x16_bf16 a[32:47], a[232:235], v[112:115], a[32:47]
v_exp_f32 v151, v151
v_add_f32 v3, v3, v149
v_cvt_pk_bf16_f32 v146, v148, v149
v_exp_f32 v152, v152
v_mfma_f32_32x32x16_bf16 a[96:111], a[232:235], v[128:131], a[96:111]
ds_read_b128 a[176:179], v10 offset:28672
v_add_f32 v2, v2, v150
v_exp_f32 v153, v153
v_add_f32 v3, v3, v151
v_cvt_pk_bf16_f32 v147, v150, v151
v_mfma_f32_32x32x16_bf16 a[48:63], a[236:239], v[112:115], a[48:63]
buffer_load_dwordx4 v12, s[52:55], s71 offen offset:2048 sc1 lds
v_exp_f32 v154, v154
v_add_f32 v2, v2, v152
v_exp_f32 v155, v155
v_mfma_f32_32x32x16_bf16 a[112:127], a[236:239], v[128:131], a[112:127]
ds_read_b128 a[180:183], v10 offset:29696
v_add_f32 v3, v3, v153
v_cvt_pk_bf16_f32 v152, v152, v153
v_exp_f32 v156, v156
v_add_f32 v2, v2, v154
v_mfma_f32_32x32x16_bf16 a[0:15], a[240:243], v[120:123], a[0:15]
ds_read_b128 a[184:187], v10 offset:30720
v_exp_f32 v157, v157
v_add_f32 v3, v3, v155
v_cvt_pk_bf16_f32 v153, v154, v155
v_mfma_f32_32x32x16_bf16 a[64:79], a[240:243], v[136:139], a[64:79]
buffer_load_dwordx4 v12, s[52:55], s71 offen offset:3072 sc1 lds
v_exp_f32 v158, v158
v_add_f32 v2, v2, v156
v_exp_f32 v159, v159
v_mfma_f32_32x32x16_bf16 a[16:31], a[244:247], v[120:123], a[16:31]
ds_read_b128 a[188:191], v10 offset:31744
v_add_f32 v3, v3, v157
v_cvt_pk_bf16_f32 v154, v156, v157
v_exp_f32 v160, v160
v_add_f32 v2, v2, v158
v_mfma_f32_32x32x16_bf16 a[80:95], a[244:247], v[136:139], a[80:95]
v_exp_f32 v161, v161
v_add_f32 v3, v3, v159
v_cvt_pk_bf16_f32 v155, v158, v159
v_exp_f32 v162, v162
v_mfma_f32_32x32x16_bf16 a[32:47], a[248:251], v[120:123], a[32:47]
s_cmp_eq_u32 s70, 7
v_add_f32 v4, v4, v160
v_exp_f32 v163, v163
v_add_f32 v5, v5, v161
v_cvt_pk_bf16_f32 v160, v160, v161
v_mfma_f32_32x32x16_bf16 a[96:111], a[248:251], v[136:139], a[96:111]
v_exp_f32 v164, v164
v_add_f32 v4, v4, v162
v_exp_f32 v165, v165
v_add_f32 v5, v5, v163
v_mfma_f32_32x32x16_bf16 a[48:63], a[252:255], v[120:123], a[48:63]
v_cvt_pk_bf16_f32 v161, v162, v163
v_exp_f32 v166, v166
v_add_f32 v4, v4, v164
v_exp_f32 v167, v167
v_mfma_f32_32x32x16_bf16 a[112:127], a[252:255], v[136:139], a[112:127]
v_add_f32 v5, v5, v165
v_cvt_pk_bf16_f32 v162, v164, v165
v_add_f32 v4, v4, v166
v_add_f32 v5, v5, v167
v_cvt_pk_bf16_f32 v163, v166, v167
s_nop 15
v_accvgpr_read_b32 v240, a0
v_accvgpr_read_b32 v241, a1
v_accvgpr_read_b32 v242, a2
v_accvgpr_read_b32 v243, a3
v_accvgpr_read_b32 v244, a4
v_accvgpr_read_b32 v245, a5
v_accvgpr_read_b32 v246, a6
v_accvgpr_read_b32 v247, a7
v_mul_f32 v240, v240, v8
v_mul_f32 v241, v241, v8
v_mul_f32 v242, v242, v8
v_mul_f32 v243, v243, v8
v_mul_f32 v244, v244, v8
v_mul_f32 v245, v245, v8
v_mul_f32 v246, v246, v8
v_mul_f32 v247, v247, v8
v_accvgpr_write_b32 a0, v240
v_accvgpr_write_b32 a1, v241
v_accvgpr_write_b32 a2, v242
v_accvgpr_write_b32 a3, v243
v_accvgpr_write_b32 a4, v244
v_accvgpr_write_b32 a5, v245
v_accvgpr_write_b32 a6, v246
v_accvgpr_write_b32 a7, v247
v_accvgpr_read_b32 v240, a8
v_accvgpr_read_b32 v241, a9
v_accvgpr_read_b32 v242, a10
v_accvgpr_read_b32 v243, a11
v_accvgpr_read_b32 v244, a12
v_accvgpr_read_b32 v245, a13
v_accvgpr_read_b32 v246, a14
v_accvgpr_read_b32 v247, a15
v_mul_f32 v240, v240, v8
v_mul_f32 v241, v241, v8
v_mul_f32 v242, v242, v8
v_mul_f32 v243, v243, v8
v_mul_f32 v244, v244, v8
v_mul_f32 v245, v245, v8
v_mul_f32 v246, v246, v8
v_mul_f32 v247, v247, v8
v_accvgpr_write_b32 a8, v240
v_accvgpr_write_b32 a9, v241
v_accvgpr_write_b32 a10, v242
v_accvgpr_write_b32 a11, v243
v_accvgpr_write_b32 a12, v244
v_accvgpr_write_b32 a13, v245
v_accvgpr_write_b32 a14, v246
v_accvgpr_write_b32 a15, v247
v_accvgpr_read_b32 v240, a16
v_accvgpr_read_b32 v241, a17
v_accvgpr_read_b32 v242, a18
v_accvgpr_read_b32 v243, a19
v_accvgpr_read_b32 v244, a20
v_accvgpr_read_b32 v245, a21
v_accvgpr_read_b32 v246, a22
v_accvgpr_read_b32 v247, a23
v_mul_f32 v240, v240, v8
v_mul_f32 v241, v241, v8
v_mul_f32 v242, v242, v8
v_mul_f32 v243, v243, v8
v_mul_f32 v244, v244, v8
v_mul_f32 v245, v245, v8
v_mul_f32 v246, v246, v8
v_mul_f32 v247, v247, v8
v_accvgpr_write_b32 a16, v240
v_accvgpr_write_b32 a17, v241
v_accvgpr_write_b32 a18, v242
v_accvgpr_write_b32 a19, v243
v_accvgpr_write_b32 a20, v244
v_accvgpr_write_b32 a21, v245
v_accvgpr_write_b32 a22, v246
v_accvgpr_write_b32 a23, v247
v_accvgpr_read_b32 v240, a24
v_accvgpr_read_b32 v241, a25
v_accvgpr_read_b32 v242, a26
v_accvgpr_read_b32 v243, a27
v_accvgpr_read_b32 v244, a28
v_accvgpr_read_b32 v245, a29
v_accvgpr_read_b32 v246, a30
v_accvgpr_read_b32 v247, a31
v_mul_f32 v240, v240, v8
v_mul_f32 v241, v241, v8
v_mul_f32 v242, v242, v8
v_mul_f32 v243, v243, v8
v_mul_f32 v244, v244, v8
v_mul_f32 v245, v245, v8
v_mul_f32 v246, v246, v8
v_mul_f32 v247, v247, v8
v_accvgpr_write_b32 a24, v240
v_accvgpr_write_b32 a25, v241
v_accvgpr_write_b32 a26, v242
v_accvgpr_write_b32 a27, v243
v_accvgpr_write_b32 a28, v244
v_accvgpr_write_b32 a29, v245
v_accvgpr_write_b32 a30, v246
v_accvgpr_write_b32 a31, v247
v_accvgpr_read_b32 v240, a32
v_accvgpr_read_b32 v241, a33
v_accvgpr_read_b32 v242, a34
v_accvgpr_read_b32 v243, a35
v_accvgpr_read_b32 v244, a36
v_accvgpr_read_b32 v245, a37
v_accvgpr_read_b32 v246, a38
v_accvgpr_read_b32 v247, a39
v_mul_f32 v240, v240, v8
v_mul_f32 v241, v241, v8
v_mul_f32 v242, v242, v8
v_mul_f32 v243, v243, v8
v_mul_f32 v244, v244, v8
v_mul_f32 v245, v245, v8
v_mul_f32 v246, v246, v8
v_mul_f32 v247, v247, v8
v_accvgpr_write_b32 a32, v240
v_accvgpr_write_b32 a33, v241
v_accvgpr_write_b32 a34, v242
v_accvgpr_write_b32 a35, v243
v_accvgpr_write_b32 a36, v244
v_accvgpr_write_b32 a37, v245
v_accvgpr_write_b32 a38, v246
v_accvgpr_write_b32 a39, v247
v_accvgpr_read_b32 v240, a40
v_accvgpr_read_b32 v241, a41
v_accvgpr_read_b32 v242, a42
v_accvgpr_read_b32 v243, a43
v_accvgpr_read_b32 v244, a44
v_accvgpr_read_b32 v245, a45
v_accvgpr_read_b32 v246, a46
v_accvgpr_read_b32 v247, a47
v_mul_f32 v240, v240, v8
v_mul_f32 v241, v241, v8
v_mul_f32 v242, v242, v8
v_mul_f32 v243, v243, v8
v_mul_f32 v244, v244, v8
v_mul_f32 v245, v245, v8
v_mul_f32 v246, v246, v8
v_mul_f32 v247, v247, v8
v_accvgpr_write_b32 a40, v240
v_accvgpr_write_b32 a41, v241
v_accvgpr_write_b32 a42, v242
v_accvgpr_write_b32 a43, v243
v_accvgpr_write_b32 a44, v244
v_accvgpr_write_b32 a45, v245
v_accvgpr_write_b32 a46, v246
v_accvgpr_write_b32 a47, v247
v_accvgpr_read_b32 v240, a48
v_accvgpr_read_b32 v241, a49
v_accvgpr_read_b32 v242, a50
v_accvgpr_read_b32 v243, a51
v_accvgpr_read_b32 v244, a52
v_accvgpr_read_b32 v245, a53
v_accvgpr_read_b32 v246, a54
v_accvgpr_read_b32 v247, a55
v_mul_f32 v240, v240, v8
v_mul_f32 v241, v241, v8
v_mul_f32 v242, v242, v8
v_mul_f32 v243, v243, v8
v_mul_f32 v244, v244, v8
v_mul_f32 v245, v245, v8
v_mul_f32 v246, v246, v8
v_mul_f32 v247, v247, v8
v_accvgpr_write_b32 a48, v240
v_accvgpr_write_b32 a49, v241
v_accvgpr_write_b32 a50, v242
v_accvgpr_write_b32 a51, v243
v_accvgpr_write_b32 a52, v244
v_accvgpr_write_b32 a53, v245
v_accvgpr_write_b32 a54, v246
v_accvgpr_write_b32 a55, v247
v_accvgpr_read_b32 v240, a56
v_accvgpr_read_b32 v241, a57
v_accvgpr_read_b32 v242, a58
v_accvgpr_read_b32 v243, a59
v_accvgpr_read_b32 v244, a60
v_accvgpr_read_b32 v245, a61
v_accvgpr_read_b32 v246, a62
v_accvgpr_read_b32 v247, a63
v_mul_f32 v240, v240, v8
v_mul_f32 v241, v241, v8
v_mul_f32 v242, v242, v8
v_mul_f32 v243, v243, v8
v_mul_f32 v244, v244, v8
v_mul_f32 v245, v245, v8
v_mul_f32 v246, v246, v8
v_mul_f32 v247, v247, v8
v_accvgpr_write_b32 a56, v240
v_accvgpr_write_b32 a57, v241
v_accvgpr_write_b32 a58, v242
v_accvgpr_write_b32 a59, v243
v_accvgpr_write_b32 a60, v244
v_accvgpr_write_b32 a61, v245
v_accvgpr_write_b32 a62, v246
v_accvgpr_write_b32 a63, v247
v_accvgpr_read_b32 v240, a64
v_accvgpr_read_b32 v241, a65
v_accvgpr_read_b32 v242, a66
v_accvgpr_read_b32 v243, a67
v_accvgpr_read_b32 v244, a68
v_accvgpr_read_b32 v245, a69
v_accvgpr_read_b32 v246, a70
v_accvgpr_read_b32 v247, a71
v_mul_f32 v240, v240, v9
v_mul_f32 v241, v241, v9
v_mul_f32 v242, v242, v9
v_mul_f32 v243, v243, v9
v_mul_f32 v244, v244, v9
v_mul_f32 v245, v245, v9
v_mul_f32 v246, v246, v9
v_mul_f32 v247, v247, v9
v_accvgpr_write_b32 a64, v240
v_accvgpr_write_b32 a65, v241
v_accvgpr_write_b32 a66, v242
v_accvgpr_write_b32 a67, v243
v_accvgpr_write_b32 a68, v244
v_accvgpr_write_b32 a69, v245
v_accvgpr_write_b32 a70, v246
v_accvgpr_write_b32 a71, v247
v_accvgpr_read_b32 v240, a72
v_accvgpr_read_b32 v241, a73
v_accvgpr_read_b32 v242, a74
v_accvgpr_read_b32 v243, a75
v_accvgpr_read_b32 v244, a76
v_accvgpr_read_b32 v245, a77
v_accvgpr_read_b32 v246, a78
v_accvgpr_read_b32 v247, a79
v_mul_f32 v240, v240, v9
v_mul_f32 v241, v241, v9
v_mul_f32 v242, v242, v9
v_mul_f32 v243, v243, v9
v_mul_f32 v244, v244, v9
v_mul_f32 v245, v245, v9
v_mul_f32 v246, v246, v9
v_mul_f32 v247, v247, v9
v_accvgpr_write_b32 a72, v240
v_accvgpr_write_b32 a73, v241
v_accvgpr_write_b32 a74, v242
v_accvgpr_write_b32 a75, v243
v_accvgpr_write_b32 a76, v244
v_accvgpr_write_b32 a77, v245
v_accvgpr_write_b32 a78, v246
v_accvgpr_write_b32 a79, v247
v_accvgpr_read_b32 v240, a80
v_accvgpr_read_b32 v241, a81
v_accvgpr_read_b32 v242, a82
v_accvgpr_read_b32 v243, a83
v_accvgpr_read_b32 v244, a84
v_accvgpr_read_b32 v245, a85
v_accvgpr_read_b32 v246, a86
v_accvgpr_read_b32 v247, a87
v_mul_f32 v240, v240, v9
v_mul_f32 v241, v241, v9
v_mul_f32 v242, v242, v9
v_mul_f32 v243, v243, v9
v_mul_f32 v244, v244, v9
v_mul_f32 v245, v245, v9
v_mul_f32 v246, v246, v9
v_mul_f32 v247, v247, v9
v_accvgpr_write_b32 a80, v240
v_accvgpr_write_b32 a81, v241
v_accvgpr_write_b32 a82, v242
v_accvgpr_write_b32 a83, v243
v_accvgpr_write_b32 a84, v244
v_accvgpr_write_b32 a85, v245
v_accvgpr_write_b32 a86, v246
v_accvgpr_write_b32 a87, v247
v_accvgpr_read_b32 v240, a88
v_accvgpr_read_b32 v241, a89
v_accvgpr_read_b32 v242, a90
v_accvgpr_read_b32 v243, a91
v_accvgpr_read_b32 v244, a92
v_accvgpr_read_b32 v245, a93
v_accvgpr_read_b32 v246, a94
v_accvgpr_read_b32 v247, a95
v_mul_f32 v240, v240, v9
v_mul_f32 v241, v241, v9
v_mul_f32 v242, v242, v9
v_mul_f32 v243, v243, v9
v_mul_f32 v244, v244, v9
v_mul_f32 v245, v245, v9
v_mul_f32 v246, v246, v9
v_mul_f32 v247, v247, v9
v_accvgpr_write_b32 a88, v240
v_accvgpr_write_b32 a89, v241
v_accvgpr_write_b32 a90, v242
v_accvgpr_write_b32 a91, v243
v_accvgpr_write_b32 a92, v244
v_accvgpr_write_b32 a93, v245
v_accvgpr_write_b32 a94, v246
v_accvgpr_write_b32 a95, v247
v_accvgpr_read_b32 v240, a96
v_accvgpr_read_b32 v241, a97
v_accvgpr_read_b32 v242, a98
v_accvgpr_read_b32 v243, a99
v_accvgpr_read_b32 v244, a100
v_accvgpr_read_b32 v245, a101
v_accvgpr_read_b32 v246, a102
v_accvgpr_read_b32 v247, a103
v_mul_f32 v240, v240, v9
v_mul_f32 v241, v241, v9
v_mul_f32 v242, v242, v9
v_mul_f32 v243, v243, v9
v_mul_f32 v244, v244, v9
v_mul_f32 v245, v245, v9
v_mul_f32 v246, v246, v9
v_mul_f32 v247, v247, v9
v_accvgpr_write_b32 a96, v240
v_accvgpr_write_b32 a97, v241
v_accvgpr_write_b32 a98, v242
v_accvgpr_write_b32 a99, v243
v_accvgpr_write_b32 a100, v244
v_accvgpr_write_b32 a101, v245
v_accvgpr_write_b32 a102, v246
v_accvgpr_write_b32 a103, v247
v_accvgpr_read_b32 v240, a104
v_accvgpr_read_b32 v241, a105
v_accvgpr_read_b32 v242, a106
v_accvgpr_read_b32 v243, a107
v_accvgpr_read_b32 v244, a108
v_accvgpr_read_b32 v245, a109
v_accvgpr_read_b32 v246, a110
v_accvgpr_read_b32 v247, a111
v_mul_f32 v240, v240, v9
v_mul_f32 v241, v241, v9
v_mul_f32 v242, v242, v9
v_mul_f32 v243, v243, v9
v_mul_f32 v244, v244, v9
v_mul_f32 v245, v245, v9
v_mul_f32 v246, v246, v9
v_mul_f32 v247, v247, v9
v_accvgpr_write_b32 a104, v240
v_accvgpr_write_b32 a105, v241
v_accvgpr_write_b32 a106, v242
v_accvgpr_write_b32 a107, v243
v_accvgpr_write_b32 a108, v244
v_accvgpr_write_b32 a109, v245
v_accvgpr_write_b32 a110, v246
v_accvgpr_write_b32 a111, v247
v_accvgpr_read_b32 v240, a112
v_accvgpr_read_b32 v241, a113
v_accvgpr_read_b32 v242, a114
v_accvgpr_read_b32 v243, a115
v_accvgpr_read_b32 v244, a116
v_accvgpr_read_b32 v245, a117
v_accvgpr_read_b32 v246, a118
v_accvgpr_read_b32 v247, a119
v_mul_f32 v240, v240, v9
v_mul_f32 v241, v241, v9
v_mul_f32 v242, v242, v9
v_mul_f32 v243, v243, v9
v_mul_f32 v244, v244, v9
v_mul_f32 v245, v245, v9
v_mul_f32 v246, v246, v9
v_mul_f32 v247, v247, v9
v_accvgpr_write_b32 a112, v240
v_accvgpr_write_b32 a113, v241
v_accvgpr_write_b32 a114, v242
v_accvgpr_write_b32 a115, v243
v_accvgpr_write_b32 a116, v244
v_accvgpr_write_b32 a117, v245
v_accvgpr_write_b32 a118, v246
v_accvgpr_write_b32 a119, v247
v_accvgpr_read_b32 v240, a120
v_accvgpr_read_b32 v241, a121
v_accvgpr_read_b32 v242, a122
v_accvgpr_read_b32 v243, a123
v_accvgpr_read_b32 v244, a124
v_accvgpr_read_b32 v245, a125
v_accvgpr_read_b32 v246, a126
v_accvgpr_read_b32 v247, a127
v_mul_f32 v240, v240, v9
v_mul_f32 v241, v241, v9
v_mul_f32 v242, v242, v9
v_mul_f32 v243, v243, v9
v_mul_f32 v244, v244, v9
v_mul_f32 v245, v245, v9
v_mul_f32 v246, v246, v9
v_mul_f32 v247, v247, v9
v_accvgpr_write_b32 a120, v240
v_accvgpr_write_b32 a121, v241
v_accvgpr_write_b32 a122, v242
v_accvgpr_write_b32 a123, v243
v_accvgpr_write_b32 a124, v244
v_accvgpr_write_b32 a125, v245
v_accvgpr_write_b32 a126, v246
v_accvgpr_write_b32 a127, v247
s_nop 1
s_branch L_p3_d0m_end
L_p3_mx_rare:
v_mov_b32 v240, v6
v_mov_b32 v241, v6
s_nop 1
v_permlane32_swap_b32 v240, v241
v_max_f32 v242, v240, v241
v_max_f32 v242, 0, v242
v_exp_f32 v8, -v242
v_sub_f32 v208, v208, v242
v_sub_f32 v209, v209, v242
v_sub_f32 v210, v210, v242
v_sub_f32 v211, v211, v242
v_sub_f32 v212, v212, v242
v_sub_f32 v213, v213, v242
v_sub_f32 v214, v214, v242
v_sub_f32 v215, v215, v242
v_sub_f32 v216, v216, v242
v_sub_f32 v217, v217, v242
v_sub_f32 v218, v218, v242
v_sub_f32 v219, v219, v242
v_sub_f32 v220, v220, v242
v_sub_f32 v221, v221, v242
v_sub_f32 v222, v222, v242
v_sub_f32 v223, v223, v242
v_mul_f32 v2, v2, v8
v_mul_f32 v3, v3, v8
v_sub_f32 v80, v80, v242
v_sub_f32 v81, v81, v242
v_sub_f32 v82, v82, v242
v_sub_f32 v83, v83, v242
v_sub_f32 v84, v84, v242
v_sub_f32 v85, v85, v242
v_sub_f32 v86, v86, v242
v_sub_f32 v87, v87, v242
v_sub_f32 v88, v88, v242
v_sub_f32 v89, v89, v242
v_sub_f32 v90, v90, v242
v_sub_f32 v91, v91, v242
v_sub_f32 v92, v92, v242
v_sub_f32 v93, v93, v242
v_sub_f32 v94, v94, v242
v_sub_f32 v95, v95, v242
v_sub_f32 v112, v112, v242
v_sub_f32 v113, v113, v242
v_sub_f32 v114, v114, v242
v_sub_f32 v115, v115, v242
v_sub_f32 v116, v116, v242
v_sub_f32 v117, v117, v242
v_sub_f32 v118, v118, v242
v_sub_f32 v119, v119, v242
v_sub_f32 v120, v120, v242
v_sub_f32 v121, v121, v242
v_sub_f32 v122, v122, v242
v_sub_f32 v123, v123, v242
v_sub_f32 v124, v124, v242
v_sub_f32 v125, v125, v242
v_sub_f32 v126, v126, v242
v_sub_f32 v127, v127, v242
s_add_u32 m0, s72, 16384
ds_read_b128 a[136:139], v10 offset:2048
v_exp_f32 v80, v80
v_bfe_u32 v248, v1, 2, 2
v_bfe_u32 v249, v1, 4, 1
v_mfma_f32_32x32x16_bf16 a[48:63], a[204:207], v[144:147], a[48:63]
ds_read_b128 a[140:143], v10 offset:3072
buffer_load_dwordx4 v12, s[52:55], s71 offen offset:0 sc1 lds
v_lshl_add_u32 v248, v249, 2, v248
v_lshrrev_b32 v249, 5, v1
v_exp_f32 v81, v81
v_mfma_f32_32x32x16_bf16 a[112:127], a[204:207], v[160:163], a[112:127]
v_lshl_add_u32 v249, v249, 4, v248
v_lshlrev_b32 v249, 8, v249
v_and_b32 v250, 3, v1
v_exp_f32 v82, v82
v_lshl_add_u32 v249, v250, 3, v249
v_mfma_f32_32x32x16_bf16 a[0:15], a[208:211], v[152:155], a[0:15]
ds_read_b128 a[144:147], v10 offset:4096
s_lshl_b32 s36, s3, 13
s_add_u32 s36, s36, 131072
v_add_f32 v2, v2, v80
v_add_u32 v249, s36, v249
v_xor_b32 v250, 0, v248
v_mfma_f32_32x32x16_bf16 a[64:79], a[208:211], v[168:171], a[64:79]
ds_read_b128 a[148:151], v10 offset:5120
v_lshl_add_u32 v250, v250, 5, v249
TR 96,250,0
v_exp_f32 v83, v83
TR 98,250,2048
v_mfma_f32_32x32x16_bf16 a[16:31], a[212:215], v[152:155], a[16:31]
v_xor_b32 v250, 1, v248
v_lshl_add_u32 v250, v250, 5, v249
v_add_f32 v3, v3, v81
TR 100,250,0
TR 102,250,2048
v_xor_b32 v250, 2, v248
v_mfma_f32_32x32x16_bf16 a[80:95], a[212:215], v[168:171], a[80:95]
ds_read_b128 a[152:155], v10 offset:6144
buffer_load_dwordx4 v12, s[52:55], s71 offen offset:1024 sc1 lds
v_cvt_pk_bf16_f32 v80, v80, v81
v_lshl_add_u32 v250, v250, 5, v249
TR 104,250,0
TR 106,250,2048
v_mfma_f32_32x32x16_bf16 a[32:47], a[216:219], v[152:155], a[32:47]
v_exp_f32 v84, v84
v_xor_b32 v250, 3, v248
v_lshl_add_u32 v250, v250, 5, v249
TR 108,250,0
TR 110,250,2048
v_mfma_f32_32x32x16_bf16 a[96:111], a[216:219], v[168:171], a[96:111]
ds_read_b128 a[156:159], v10 offset:7168
v_add_f32 v2, v2, v82
v_xor_b32 v250, 4, v248
v_lshl_add_u32 v250, v250, 5, v249
TR 128,250,0
v_mfma_f32_32x32x16_bf16 a[48:63], a[220:223], v[152:155], a[48:63]
ds_read_b128 a[160:163], v10 offset:8192
v_exp_f32 v85, v85
TR 130,250,2048
v_xor_b32 v250, 5, v248
v_lshl_add_u32 v250, v250, 5, v249
v_mfma_f32_32x32x16_bf16 a[112:127], a[220:223], v[168:171], a[112:127]
v_add_f32 v3, v3, v83
v_cvt_pk_bf16_f32 v81, v82, v83
TR 132,250,0
TR 134,250,2048
v_xor_b32 v250, 6, v248
v_mfma_f32_32x32x16_bf16 a[0:15], a[224:227], v[176:179], a[0:15]
ds_read_b128 a[164:167], v10 offset:9216
buffer_load_dwordx4 v12, s[52:55], s71 offen offset:2048 sc1 lds
v_exp_f32 v86, v86
v_lshl_add_u32 v250, v250, 5, v249
TR 136,250,0
v_mfma_f32_32x32x16_bf16 a[64:79], a[224:227], v[192:195], a[64:79]
TR 138,250,2048
v_xor_b32 v250, 7, v248
v_add_f32 v2, v2, v84
v_lshl_add_u32 v250, v250, 5, v249
TR 140,250,0
TR 142,250,2048
v_mfma_f32_32x32x16_bf16 a[16:31], a[228:231], v[176:179], a[16:31]
ds_read_b128 a[168:171], v10 offset:10240
v_exp_f32 v87, v87
s_add_u32 s32, s40, 100663296
s_addc_u32 s33, s41, 0
s_mov_b32 s34, 8388608
v_mfma_f32_32x32x16_bf16 a[80:95], a[228:231], v[192:195], a[80:95]
ds_read_b128 a[172:175], v10 offset:11264
v_add_f32 v3, v3, v85
s_mov_b32 s35, 0x20000
s_and_b32 s36, s2, 7
s_lshl_b32 s36, s36, 20
v_mfma_f32_32x32x16_bf16 a[32:47], a[232:235], v[176:179], a[32:47]
v_cvt_pk_bf16_f32 v82, v84, v85
s_lshr_b32 s37, s2, 3
s_lshl_b32 s37, s37, 15
s_add_u32 s36, s36, s37
s_lshl_b32 s37, s3, 12
v_mfma_f32_32x32x16_bf16 a[96:111], a[232:235], v[192:195], a[96:111]
ds_read_b128 a[176:179], v10 offset:12288
buffer_load_dwordx4 v12, s[52:55], s71 offen offset:3072 sc1 lds
v_exp_f32 v88, v88
s_add_u32 s36, s36, s37
s_add_u32 s37, s36, 4096
v_mfma_f32_32x32x16_bf16 a[48:63], a[236:239], v[176:179], a[48:63]
s_waitcnt lgkmcnt(15)
buffer_store_dwordx4 v[96:99], v12, s[32:35], s36 offen offset:0 sc1
v_add_f32 v2, v2, v86
buffer_store_dwordx4 v[100:103], v12, s[32:35], s36 offen offset:1024 sc1
buffer_store_dwordx4 v[104:107], v12, s[32:35], s36 offen offset:2048 sc1
s_waitcnt lgkmcnt(14)
buffer_store_dwordx4 v[108:111], v12, s[32:35], s36 offen offset:3072 sc1
v_mfma_f32_32x32x16_bf16 a[112:127], a[236:239], v[192:195], a[112:127]
ds_read_b128 a[180:183], v10 offset:13312
v_exp_f32 v89, v89
s_waitcnt lgkmcnt(11)
buffer_store_dwordx4 v[128:131], v12, s[32:35], s37 offen offset:0 sc1
s_waitcnt lgkmcnt(9)
buffer_store_dwordx4 v[132:135], v12, s[32:35], s37 offen offset:1024 sc1
s_waitcnt lgkmcnt(6)
buffer_store_dwordx4 v[136:139], v12, s[32:35], s37 offen offset:2048 sc1
v_mfma_f32_32x32x16_bf16 a[0:15], a[240:243], v[184:187], a[0:15]
ds_read_b128 a[184:187], v10 offset:14336
v_add_f32 v3, v3, v87
v_cvt_pk_bf16_f32 v83, v86, v87
s_waitcnt lgkmcnt(5)
buffer_store_dwordx4 v[140:143], v12, s[32:35], s37 offen offset:3072 sc1
s_add_u32 s32, s40, 109051904
s_addc_u32 s33, s41, 0
v_mfma_f32_32x32x16_bf16 a[64:79], a[240:243], v[200:203], a[64:79]
s_mov_b32 s34, 4194304
v_exp_f32 v90, v90
s_mov_b32 s35, 0x20000
s_lshl_b32 s36, s2, 14
v_mov_b32 v252, -1
v_mfma_f32_32x32x16_bf16 a[16:31], a[244:247], v[184:187], a[16:31]
ds_read_b128 a[188:191], v10 offset:15360
s_xor_b32 s72, s72, 0x8000
v_add_f32 v2, v2, v88
v_mov_b32 v253, -1
v_mov_b32 v254, -1
v_mov_b32 v255, -1
v_mfma_f32_32x32x16_bf16 a[80:95], a[244:247], v[200:203], a[80:95]
v_exp_f32 v91, v91
buffer_store_dwordx4 v[252:255], v12, s[32:35], s36 offen offset:0 sc1
buffer_store_dwordx4 v[252:255], v12, s[32:35], s36 offen offset:1024 sc1
buffer_store_dwordx4 v[252:255], v12, s[32:35], s36 offen offset:2048 sc1
v_mfma_f32_32x32x16_bf16 a[32:47], a[248:251], v[184:187], a[32:47]
v_add_f32 v3, v3, v89
buffer_store_dwordx4 v[252:255], v12, s[32:35], s36 offen offset:3072 sc1
v_lshlrev_b32 v72, 4, v1
v_add_u32 v73, -8, v72
v_mov_b32 v75, 0
v_mfma_f32_32x32x16_bf16 a[96:111], a[248:251], v[200:203], a[96:111]
v_cvt_pk_bf16_f32 v88, v88, v89
buffer_load_ushort v74, v75, s[28:31], s42 offen
buffer_load_dwordx2 v[48:49], v73, s[16:19], 0 offen
buffer_load_dwordx4 v[50:53], v72, s[16:19], 0 offen offset:0
v_mfma_f32_32x32x16_bf16 a[48:63], a[252:255], v[184:187], a[48:63]
v_add_f32 v2, v2, v90
v_add_f32 v3, v3, v91
buffer_load_dwordx2 v[54:55], v72, s[16:19], 0 offen offset:1016
buffer_load_dwordx4 v[56:59], v72, s[16:19], 0 offen offset:1024
buffer_load_dwordx2 v[60:61], v72, s[16:19], 0 offen offset:2040
v_mfma_f32_32x32x16_bf16 a[112:127], a[252:255], v[200:203], a[112:127]
v_cvt_pk_bf16_f32 v89, v90, v91
buffer_load_dwordx4 v[62:65], v72, s[16:19], 0 offen offset:2048
buffer_load_dwordx2 v[66:67], v72, s[16:19], 0 offen offset:3064
buffer_load_dwordx4 v[68:71], v72, s[16:19], 0 offen offset:3072
s_nop 15
v_accvgpr_read_b32 v240, a0
v_accvgpr_read_b32 v241, a1
v_accvgpr_read_b32 v242, a2
v_accvgpr_read_b32 v243, a3
v_accvgpr_read_b32 v244, a4
v_accvgpr_read_b32 v245, a5
v_accvgpr_read_b32 v246, a6
v_accvgpr_read_b32 v247, a7
v_mul_f32 v240, v240, v8
v_mul_f32 v241, v241, v8
v_mul_f32 v242, v242, v8
v_mul_f32 v243, v243, v8
v_mul_f32 v244, v244, v8
v_mul_f32 v245, v245, v8
v_mul_f32 v246, v246, v8
v_mul_f32 v247, v247, v8
v_accvgpr_write_b32 a0, v240
v_accvgpr_write_b32 a1, v241
v_accvgpr_write_b32 a2, v242
v_accvgpr_write_b32 a3, v243
v_accvgpr_write_b32 a4, v244
v_accvgpr_write_b32 a5, v245
v_accvgpr_write_b32 a6, v246
v_accvgpr_write_b32 a7, v247
v_accvgpr_read_b32 v240, a8
v_accvgpr_read_b32 v241, a9
v_accvgpr_read_b32 v242, a10
v_accvgpr_read_b32 v243, a11
v_accvgpr_read_b32 v244, a12
v_accvgpr_read_b32 v245, a13
v_accvgpr_read_b32 v246, a14
v_accvgpr_read_b32 v247, a15
v_mul_f32 v240, v240, v8
v_mul_f32 v241, v241, v8
v_mul_f32 v242, v242, v8
v_mul_f32 v243, v243, v8
v_mul_f32 v244, v244, v8
v_mul_f32 v245, v245, v8
v_mul_f32 v246, v246, v8
v_mul_f32 v247, v247, v8
v_accvgpr_write_b32 a8, v240
v_accvgpr_write_b32 a9, v241
v_accvgpr_write_b32 a10, v242
v_accvgpr_write_b32 a11, v243
v_accvgpr_write_b32 a12, v244
v_accvgpr_write_b32 a13, v245
v_accvgpr_write_b32 a14, v246
v_accvgpr_write_b32 a15, v247
v_accvgpr_read_b32 v240, a16
v_accvgpr_read_b32 v241, a17
v_accvgpr_read_b32 v242, a18
v_accvgpr_read_b32 v243, a19
v_accvgpr_read_b32 v244, a20
v_accvgpr_read_b32 v245, a21
v_accvgpr_read_b32 v246, a22
v_accvgpr_read_b32 v247, a23
v_mul_f32 v240, v240, v8
v_mul_f32 v241, v241, v8
v_mul_f32 v242, v242, v8
v_mul_f32 v243, v243, v8
v_mul_f32 v244, v244, v8
v_mul_f32 v245, v245, v8
v_mul_f32 v246, v246, v8
v_mul_f32 v247, v247, v8
v_accvgpr_write_b32 a16, v240
v_accvgpr_write_b32 a17, v241
v_accvgpr_write_b32 a18, v242
v_accvgpr_write_b32 a19, v243
v_accvgpr_write_b32 a20, v244
v_accvgpr_write_b32 a21, v245
v_accvgpr_write_b32 a22, v246
v_accvgpr_write_b32 a23, v247
v_accvgpr_read_b32 v240, a24
v_accvgpr_read_b32 v241, a25
v_accvgpr_read_b32 v242, a26
v_accvgpr_read_b32 v243, a27
v_accvgpr_read_b32 v244, a28
v_accvgpr_read_b32 v245, a29
v_accvgpr_read_b32 v246, a30
v_accvgpr_read_b32 v247, a31
v_mul_f32 v240, v240, v8
v_mul_f32 v241, v241, v8
v_mul_f32 v242, v242, v8
v_mul_f32 v243, v243, v8
v_mul_f32 v244, v244, v8
v_mul_f32 v245, v245, v8
v_mul_f32 v246, v246, v8
v_mul_f32 v247, v247, v8
v_accvgpr_write_b32 a24, v240
v_accvgpr_write_b32 a25, v241
v_accvgpr_write_b32 a26, v242
v_accvgpr_write_b32 a27, v243
v_accvgpr_write_b32 a28, v244
v_accvgpr_write_b32 a29, v245
v_accvgpr_write_b32 a30, v246
v_accvgpr_write_b32 a31, v247
v_accvgpr_read_b32 v240, a32
v_accvgpr_read_b32 v241, a33
v_accvgpr_read_b32 v242, a34
v_accvgpr_read_b32 v243, a35
v_accvgpr_read_b32 v244, a36
v_accvgpr_read_b32 v245, a37
v_accvgpr_read_b32 v246, a38
v_accvgpr_read_b32 v247, a39
v_mul_f32 v240, v240, v8
v_mul_f32 v241, v241, v8
v_mul_f32 v242, v242, v8
v_mul_f32 v243, v243, v8
v_mul_f32 v244, v244, v8
v_mul_f32 v245, v245, v8
v_mul_f32 v246, v246, v8
v_mul_f32 v247, v247, v8
v_accvgpr_write_b32 a32, v240
v_accvgpr_write_b32 a33, v241
v_accvgpr_write_b32 a34, v242
v_accvgpr_write_b32 a35, v243
v_accvgpr_write_b32 a36, v244
v_accvgpr_write_b32 a37, v245
v_accvgpr_write_b32 a38, v246
v_accvgpr_write_b32 a39, v247
v_accvgpr_read_b32 v240, a40
v_accvgpr_read_b32 v241, a41
v_accvgpr_read_b32 v242, a42
v_accvgpr_read_b32 v243, a43
v_accvgpr_read_b32 v244, a44
v_accvgpr_read_b32 v245, a45
v_accvgpr_read_b32 v246, a46
v_accvgpr_read_b32 v247, a47
v_mul_f32 v240, v240, v8
v_mul_f32 v241, v241, v8
v_mul_f32 v242, v242, v8
v_mul_f32 v243, v243, v8
v_mul_f32 v244, v244, v8
v_mul_f32 v245, v245, v8
v_mul_f32 v246, v246, v8
v_mul_f32 v247, v247, v8
v_accvgpr_write_b32 a40, v240
v_accvgpr_write_b32 a41, v241
v_accvgpr_write_b32 a42, v242
v_accvgpr_write_b32 a43, v243
v_accvgpr_write_b32 a44, v244
v_accvgpr_write_b32 a45, v245
v_accvgpr_write_b32 a46, v246
v_accvgpr_write_b32 a47, v247
v_accvgpr_read_b32 v240, a48
v_accvgpr_read_b32 v241, a49
v_accvgpr_read_b32 v242, a50
v_accvgpr_read_b32 v243, a51
v_accvgpr_read_b32 v244, a52
v_accvgpr_read_b32 v245, a53
v_accvgpr_read_b32 v246, a54
v_accvgpr_read_b32 v247, a55
v_mul_f32 v240, v240, v8
v_mul_f32 v241, v241, v8
v_mul_f32 v242, v242, v8
v_mul_f32 v243, v243, v8
v_mul_f32 v244, v244, v8
v_mul_f32 v245, v245, v8
v_mul_f32 v246, v246, v8
v_mul_f32 v247, v247, v8
v_accvgpr_write_b32 a48, v240
v_accvgpr_write_b32 a49, v241
v_accvgpr_write_b32 a50, v242
v_accvgpr_write_b32 a51, v243
v_accvgpr_write_b32 a52, v244
v_accvgpr_write_b32 a53, v245
v_accvgpr_write_b32 a54, v246
v_accvgpr_write_b32 a55, v247
v_accvgpr_read_b32 v240, a56
v_accvgpr_read_b32 v241, a57
v_accvgpr_read_b32 v242, a58
v_accvgpr_read_b32 v243, a59
v_accvgpr_read_b32 v244, a60
v_accvgpr_read_b32 v245, a61
v_accvgpr_read_b32 v246, a62
v_accvgpr_read_b32 v247, a63
v_mul_f32 v240, v240, v8
v_mul_f32 v241, v241, v8
v_mul_f32 v242, v242, v8
v_mul_f32 v243, v243, v8
v_mul_f32 v244, v244, v8
v_mul_f32 v245, v245, v8
v_mul_f32 v246, v246, v8
v_mul_f32 v247, v247, v8
v_accvgpr_write_b32 a56, v240
v_accvgpr_write_b32 a57, v241
v_accvgpr_write_b32 a58, v242
v_accvgpr_write_b32 a59, v243
v_accvgpr_write_b32 a60, v244
v_accvgpr_write_b32 a61, v245
v_accvgpr_write_b32 a62, v246
v_accvgpr_write_b32 a63, v247
s_nop 1
s_branch L_p3_mx_end
L_p3_mxm_rare:
v_mov_b32 v240, v6
v_mov_b32 v241, v6
s_nop 1
v_permlane32_swap_b32 v240, v241
v_max_f32 v242, v240, v241
v_max_f32 v242, 0, v242
v_exp_f32 v8, -v242
v_sub_f32 v208, v208, v242
v_sub_f32 v209, v209, v242
v_sub_f32 v210, v210, v242
v_sub_f32 v211, v211, v242
v_sub_f32 v212, v212, v242
v_sub_f32 v213, v213, v242
v_sub_f32 v214, v214, v242
v_sub_f32 v215, v215, v242
v_sub_f32 v216, v216, v242
v_sub_f32 v217, v217, v242
v_sub_f32 v218, v218, v242
v_sub_f32 v219, v219, v242
v_sub_f32 v220, v220, v242
v_sub_f32 v221, v221, v242
v_sub_f32 v222, v222, v242
v_sub_f32 v223, v223, v242
v_mul_f32 v2, v2, v8
v_mul_f32 v3, v3, v8
v_sub_f32 v80, v80, v242
v_sub_f32 v81, v81, v242
v_sub_f32 v82, v82, v242
v_sub_f32 v83, v83, v242
v_sub_f32 v84, v84, v242
v_sub_f32 v85, v85, v242
v_sub_f32 v86, v86, v242
v_sub_f32 v87, v87, v242
v_sub_f32 v88, v88, v242
v_sub_f32 v89, v89, v242
v_sub_f32 v90, v90, v242
v_sub_f32 v91, v91, v242
v_sub_f32 v92, v92, v242
v_sub_f32 v93, v93, v242
v_sub_f32 v94, v94, v242
v_sub_f32 v95, v95, v242
v_sub_f32 v112, v112, v242
v_sub_f32 v113, v113, v242
v_sub_f32 v114, v114, v242
v_sub_f32 v115, v115, v242
v_sub_f32 v116, v116, v242
v_sub_f32 v117, v117, v242
v_sub_f32 v118, v118, v242
v_sub_f32 v119, v119, v242
v_sub_f32 v120, v120, v242
v_sub_f32 v121, v121, v242
v_sub_f32 v122, v122, v242
v_sub_f32 v123, v123, v242
v_sub_f32 v124, v124, v242
v_sub_f32 v125, v125, v242
v_sub_f32 v126, v126, v242
v_sub_f32 v127, v127, v242
s_add_u32 m0, s72, 16384
ds_read_b128 a[152:155], v10 offset:6144
v_exp_f32 v80, v80
v_bfe_u32 v248, v1, 2, 2
v_bfe_u32 v249, v1, 4, 1
v_mfma_f32_32x32x16_bf16 a[32:47], a[216:219], v[152:155], a[32:47]
ds_read_b128 a[156:159], v10 offset:7168
buffer_load_dwordx4 v12, s[52:55], s71 offen offset:0 sc1 lds
v_lshl_add_u32 v248, v249, 2, v248
v_lshrrev_b32 v249, 5, v1
v_lshl_add_u32 v249, v249, 4, v248
v_lshlrev_b32 v249, 8, v249
v_mfma_f32_32x32x16_bf16 a[96:111], a[216:219], v[168:171], a[96:111]
v_exp_f32 v81, v81
v_and_b32 v250, 3, v1
v_lshl_add_u32 v249, v250, 3, v249
s_lshl_b32 s36, s3, 13
s_add_u32 s36, s36, 131072
v_mfma_f32_32x32x16_bf16 a[48:63], a[220:223], v[152:155], a[48:63]
ds_read_b128 a[160:163], v10 offset:8192
v_exp_f32 v82, v82
v_add_u32 v249, s36, v249
v_xor_b32 v250, 0, v248
v_lshl_add_u32 v250, v250, 5, v249
v_mfma_f32_32x32x16_bf16 a[112:127], a[220:223], v[168:171], a[112:127]
v_add_f32 v2, v2, v80
v_exp_f32 v83, v83
TR 96,250,0
TR 98,250,2048
v_xor_b32 v250, 1, v248
v_mfma_f32_32x32x16_bf16 a[0:15], a[224:227], v[176:179], a[0:15]
ds_read_b128 a[164:167], v10 offset:9216
buffer_load_dwordx4 v12, s[52:55], s71 offen offset:1024 sc1 lds
v_lshl_add_u32 v250, v250, 5, v249
v_add_f32 v3, v3, v81
TR 100,250,0
TR 102,250,2048
v_mfma_f32_32x32x16_bf16 a[64:79], a[224:227], v[192:195], a[64:79]
ds_read_b128 a[168:171], v10 offset:10240
v_xor_b32 v250, 2, v248
v_lshl_add_u32 v250, v250, 5, v249
v_cvt_pk_bf16_f32 v80, v80, v81
v_exp_f32 v84, v84
v_mfma_f32_32x32x16_bf16 a[16:31], a[228:231], v[176:179], a[16:31]
TR 104,250,0
TR 106,250,2048
v_xor_b32 v250, 3, v248
v_lshl_add_u32 v250, v250, 5, v249
TR 108,250,0
v_add_f32 v2, v2, v82
v_mfma_f32_32x32x16_bf16 a[80:95], a[228:231], v[192:195], a[80:95]
ds_read_b128 a[172:175], v10 offset:11264
TR 110,250,2048
v_xor_b32 v250, 4, v248
v_lshl_add_u32 v250, v250, 5, v249
TR 128,250,0
TR 130,250,2048
v_mfma_f32_32x32x16_bf16 a[32:47], a[232:235], v[176:179], a[32:47]
buffer_load_dwordx4 v12, s[52:55], s71 offen offset:2048 sc1 lds
v_exp_f32 v85, v85
v_xor_b32 v250, 5, v248
v_lshl_add_u32 v250, v250, 5, v249
TR 132,250,0
v_mfma_f32_32x32x16_bf16 a[96:111], a[232:235], v[192:195], a[96:111]
ds_read_b128 a[176:179], v10 offset:12288
v_add_f32 v3, v3, v83
v_cvt_pk_bf16_f32 v81, v82, v83
TR 134,250,2048
v_xor_b32 v250, 6, v248
v_lshl_add_u32 v250, v250, 5, v249
v_mfma_f32_32x32x16_bf16 a[48:63], a[236:239], v[176:179], a[48:63]
ds_read_b128 a[180:183], v10 offset:13312
TR 136,250,0
v_exp_f32 v86, v86
TR 138,250,2048
v_xor_b32 v250, 7, v248
v_mfma_f32_32x32x16_bf16 a[112:127], a[236:239], v[192:195], a[112:127]
v_lshl_add_u32 v250, v250, 5, v249
TR 140,250,0
v_add_f32 v2, v2, v84
v_exp_f32 v87, v87
TR 142,250,2048
v_mfma_f32_32x32x16_bf16 a[0:15], a[240:243], v[184:187], a[0:15]
ds_read_b128 a[184:187], v10 offset:14336
buffer_load_dwordx4 v12, s[52:55], s71 offen offset:3072 sc1 lds
s_add_u32 s32, s40, 100663296
s_addc_u32 s33, s41, 0
s_mov_b32 s34, 8388608
s_mov_b32 s35, 0x20000
v_mfma_f32_32x32x16_bf16 a[64:79], a[240:243], v[200:203], a[64:79]
v_add_f32 v3, v3, v85
s_and_b32 s36, s2, 7
s_lshl_b32 s36, s36, 20
s_lshr_b32 s37, s2, 3
s_lshl_b32 s37, s37, 15
v_cvt_pk_bf16_f32 v82, v84, v85
v_mfma_f32_32x32x16_bf16 a[16:31], a[244:247], v[184:187], a[16:31]
ds_read_b128 a[188:191], v10 offset:15360
v_exp_f32 v88, v88
s_add_u32 s36, s36, s37
s_lshl_b32 s37, s3, 12
s_add_u32 s36, s36, s37
v_mfma_f32_32x32x16_bf16 a[80:95], a[244:247], v[200:203], a[80:95]
s_add_u32 s37, s36, 4096
v_add_f32 v2, v2, v86
s_waitcnt lgkmcnt(15)
buffer_store_dwordx4 v[96:99], v12, s[32:35], s36 offen offset:0 sc1
buffer_store_dwordx4 v[100:103], v12, s[32:35], s36 offen offset:1024 sc1
buffer_store_dwordx4 v[104:107], v12, s[32:35], s36 offen offset:2048 sc1
s_waitcnt lgkmcnt(12)
buffer_store_dwordx4 v[108:111], v12, s[32:35], s36 offen offset:3072 sc1
v_mfma_f32_32x32x16_bf16 a[32:47], a[248:251], v[184:187], a[32:47]
s_xor_b32 s72, s72, 0x8000
v_exp_f32 v89, v89
s_waitcnt lgkmcnt(10)
buffer_store_dwordx4 v[128:131], v12, s[32:35], s37 offen offset:0 sc1
s_waitcnt lgkmcnt(7)
buffer_store_dwordx4 v[132:135], v12, s[32:35], s37 offen offset:1024 sc1
s_waitcnt lgkmcnt(4)
buffer_store_dwordx4 v[136:139], v12, s[32:35], s37 offen offset:2048 sc1
v_mfma_f32_32x32x16_bf16 a[96:111], a[248:251], v[200:203], a[96:111]
s_waitcnt lgkmcnt(2)
buffer_store_dwordx4 v[140:143], v12, s[32:35], s37 offen offset:3072 sc1
v_add_f32 v3, v3, v87
v_cvt_pk_bf16_f32 v83, v86, v87
s_add_u32 s32, s40, 109051904
s_addc_u32 s33, s41, 0
s_mov_b32 s34, 4194304
v_mfma_f32_32x32x16_bf16 a[48:63], a[252:255], v[184:187], a[48:63]
s_mov_b32 s35, 0x20000
s_lshl_b32 s36, s2, 14
v_exp_f32 v90, v90
v_mov_b32 v252, -1
v_mov_b32 v253, -1
v_mfma_f32_32x32x16_bf16 a[112:127], a[252:255], v[200:203], a[112:127]
v_mov_b32 v254, -1
v_mov_b32 v255, -1
v_add_f32 v2, v2, v88
v_exp_f32 v91, v91
buffer_store_dwordx4 v[252:255], v12, s[32:35], s36 offen offset:0 sc1
buffer_store_dwordx4 v[252:255], v12, s[32:35], s36 offen offset:1024 sc1
buffer_store_dwordx4 v[252:255], v12, s[32:35], s36 offen offset:2048 sc1
buffer_store_dwordx4 v[252:255], v12, s[32:35], s36 offen offset:3072 sc1
v_add_f32 v3, v3, v89
v_lshlrev_b32 v72, 4, v1
v_add_u32 v73, -8, v72
v_mov_b32 v75, 0
buffer_load_ushort v74, v75, s[28:31], s42 offen
v_cvt_pk_bf16_f32 v88, v88, v89
v_add_f32 v2, v2, v90
buffer_load_dwordx2 v[48:49], v73, s[16:19], 0 offen
buffer_load_dwordx4 v[50:53], v72, s[16:19], 0 offen offset:0
buffer_load_dwordx2 v[54:55], v72, s[16:19], 0 offen offset:1016
buffer_load_dwordx4 v[56:59], v72, s[16:19], 0 offen offset:1024
v_add_f32 v3, v3, v91
v_cvt_pk_bf16_f32 v89, v90, v91
buffer_load_dwordx2 v[60:61], v72, s[16:19], 0 offen offset:2040
buffer_load_dwordx4 v[62:65], v72, s[16:19], 0 offen offset:2048
buffer_load_dwordx2 v[66:67], v72, s[16:19], 0 offen offset:3064
buffer_load_dwordx4 v[68:71], v72, s[16:19], 0 offen offset:3072
s_nop 15
v_accvgpr_read_b32 v240, a0
v_accvgpr_read_b32 v241, a1
v_accvgpr_read_b32 v242, a2
v_accvgpr_read_b32 v243, a3
v_accvgpr_read_b32 v244, a4
v_accvgpr_read_b32 v245, a5
v_accvgpr_read_b32 v246, a6
v_accvgpr_read_b32 v247, a7
v_mul_f32 v240, v240, v8
v_mul_f32 v241, v241, v8
v_mul_f32 v242, v242, v8
v_mul_f32 v243, v243, v8
v_mul_f32 v244, v244, v8
v_mul_f32 v245, v245, v8
v_mul_f32 v246, v246, v8
v_mul_f32 v247, v247, v8
v_accvgpr_write_b32 a0, v240
v_accvgpr_write_b32 a1, v241
v_accvgpr_write_b32 a2, v242
v_accvgpr_write_b32 a3, v243
v_accvgpr_write_b32 a4, v244
v_accvgpr_write_b32 a5, v245
v_accvgpr_write_b32 a6, v246
v_accvgpr_write_b32 a7, v247
v_accvgpr_read_b32 v240, a8
v_accvgpr_read_b32 v241, a9
v_accvgpr_read_b32 v242, a10
v_accvgpr_read_b32 v243, a11
v_accvgpr_read_b32 v244, a12
v_accvgpr_read_b32 v245, a13
v_accvgpr_read_b32 v246, a14
v_accvgpr_read_b32 v247, a15
v_mul_f32 v240, v240, v8
v_mul_f32 v241, v241, v8
v_mul_f32 v242, v242, v8
v_mul_f32 v243, v243, v8
v_mul_f32 v244, v244, v8
v_mul_f32 v245, v245, v8
v_mul_f32 v246, v246, v8
v_mul_f32 v247, v247, v8
v_accvgpr_write_b32 a8, v240
v_accvgpr_write_b32 a9, v241
v_accvgpr_write_b32 a10, v242
v_accvgpr_write_b32 a11, v243
v_accvgpr_write_b32 a12, v244
v_accvgpr_write_b32 a13, v245
v_accvgpr_write_b32 a14, v246
v_accvgpr_write_b32 a15, v247
v_accvgpr_read_b32 v240, a16
v_accvgpr_read_b32 v241, a17
v_accvgpr_read_b32 v242, a18
v_accvgpr_read_b32 v243, a19
v_accvgpr_read_b32 v244, a20
v_accvgpr_read_b32 v245, a21
v_accvgpr_read_b32 v246, a22
v_accvgpr_read_b32 v247, a23
v_mul_f32 v240, v240, v8
v_mul_f32 v241, v241, v8
v_mul_f32 v242, v242, v8
v_mul_f32 v243, v243, v8
v_mul_f32 v244, v244, v8
v_mul_f32 v245, v245, v8
v_mul_f32 v246, v246, v8
v_mul_f32 v247, v247, v8
v_accvgpr_write_b32 a16, v240
v_accvgpr_write_b32 a17, v241
v_accvgpr_write_b32 a18, v242
v_accvgpr_write_b32 a19, v243
v_accvgpr_write_b32 a20, v244
v_accvgpr_write_b32 a21, v245
v_accvgpr_write_b32 a22, v246
v_accvgpr_write_b32 a23, v247
v_accvgpr_read_b32 v240, a24
v_accvgpr_read_b32 v241, a25
v_accvgpr_read_b32 v242, a26
v_accvgpr_read_b32 v243, a27
v_accvgpr_read_b32 v244, a28
v_accvgpr_read_b32 v245, a29
v_accvgpr_read_b32 v246, a30
v_accvgpr_read_b32 v247, a31
v_mul_f32 v240, v240, v8
v_mul_f32 v241, v241, v8
v_mul_f32 v242, v242, v8
v_mul_f32 v243, v243, v8
v_mul_f32 v244, v244, v8
v_mul_f32 v245, v245, v8
v_mul_f32 v246, v246, v8
v_mul_f32 v247, v247, v8
v_accvgpr_write_b32 a24, v240
v_accvgpr_write_b32 a25, v241
v_accvgpr_write_b32 a26, v242
v_accvgpr_write_b32 a27, v243
v_accvgpr_write_b32 a28, v244
v_accvgpr_write_b32 a29, v245
v_accvgpr_write_b32 a30, v246
v_accvgpr_write_b32 a31, v247
v_accvgpr_read_b32 v240, a32
v_accvgpr_read_b32 v241, a33
v_accvgpr_read_b32 v242, a34
v_accvgpr_read_b32 v243, a35
v_accvgpr_read_b32 v244, a36
v_accvgpr_read_b32 v245, a37
v_accvgpr_read_b32 v246, a38
v_accvgpr_read_b32 v247, a39
v_mul_f32 v240, v240, v8
v_mul_f32 v241, v241, v8
v_mul_f32 v242, v242, v8
v_mul_f32 v243, v243, v8
v_mul_f32 v244, v244, v8
v_mul_f32 v245, v245, v8
v_mul_f32 v246, v246, v8
v_mul_f32 v247, v247, v8
v_accvgpr_write_b32 a32, v240
v_accvgpr_write_b32 a33, v241
v_accvgpr_write_b32 a34, v242
v_accvgpr_write_b32 a35, v243
v_accvgpr_write_b32 a36, v244
v_accvgpr_write_b32 a37, v245
v_accvgpr_write_b32 a38, v246
v_accvgpr_write_b32 a39, v247
v_accvgpr_read_b32 v240, a40
v_accvgpr_read_b32 v241, a41
v_accvgpr_read_b32 v242, a42
v_accvgpr_read_b32 v243, a43
v_accvgpr_read_b32 v244, a44
v_accvgpr_read_b32 v245, a45
v_accvgpr_read_b32 v246, a46
v_accvgpr_read_b32 v247, a47
v_mul_f32 v240, v240, v8
v_mul_f32 v241, v241, v8
v_mul_f32 v242, v242, v8
v_mul_f32 v243, v243, v8
v_mul_f32 v244, v244, v8
v_mul_f32 v245, v245, v8
v_mul_f32 v246, v246, v8
v_mul_f32 v247, v247, v8
v_accvgpr_write_b32 a40, v240
v_accvgpr_write_b32 a41, v241
v_accvgpr_write_b32 a42, v242
v_accvgpr_write_b32 a43, v243
v_accvgpr_write_b32 a44, v244
v_accvgpr_write_b32 a45, v245
v_accvgpr_write_b32 a46, v246
v_accvgpr_write_b32 a47, v247
v_accvgpr_read_b32 v240, a48
v_accvgpr_read_b32 v241, a49
v_accvgpr_read_b32 v242, a50
v_accvgpr_read_b32 v243, a51
v_accvgpr_read_b32 v244, a52
v_accvgpr_read_b32 v245, a53
v_accvgpr_read_b32 v246, a54
v_accvgpr_read_b32 v247, a55
v_mul_f32 v240, v240, v8
v_mul_f32 v241, v241, v8
v_mul_f32 v242, v242, v8
v_mul_f32 v243, v243, v8
v_mul_f32 v244, v244, v8
v_mul_f32 v245, v245, v8
v_mul_f32 v246, v246, v8
v_mul_f32 v247, v247, v8
v_accvgpr_write_b32 a48, v240
v_accvgpr_write_b32 a49, v241
v_accvgpr_write_b32 a50, v242
v_accvgpr_write_b32 a51, v243
v_accvgpr_write_b32 a52, v244
v_accvgpr_write_b32 a53, v245
v_accvgpr_write_b32 a54, v246
v_accvgpr_write_b32 a55, v247
v_accvgpr_read_b32 v240, a56
v_accvgpr_read_b32 v241, a57
v_accvgpr_read_b32 v242, a58
v_accvgpr_read_b32 v243, a59
v_accvgpr_read_b32 v244, a60
v_accvgpr_read_b32 v245, a61
v_accvgpr_read_b32 v246, a62
v_accvgpr_read_b32 v247, a63
v_mul_f32 v240, v240, v8
v_mul_f32 v241, v241, v8
v_mul_f32 v242, v242, v8
v_mul_f32 v243, v243, v8
v_mul_f32 v244, v244, v8
v_mul_f32 v245, v245, v8
v_mul_f32 v246, v246, v8
v_mul_f32 v247, v247, v8
v_accvgpr_write_b32 a56, v240
v_accvgpr_write_b32 a57, v241
v_accvgpr_write_b32 a58, v242
v_accvgpr_write_b32 a59, v243
v_accvgpr_write_b32 a60, v244
v_accvgpr_write_b32 a61, v245
v_accvgpr_write_b32 a62, v246
v_accvgpr_write_b32 a63, v247
s_nop 1
s_branch L_p3_mxm_end
L_p3_s0_rare:
v_mov_b32 v240, v6
v_mov_b32 v241, v6
s_nop 1
v_permlane32_swap_b32 v240, v241
v_max_f32 v242, v240, v241
v_max_f32 v242, 0, v242
v_exp_f32 v8, -v242
v_sub_f32 v208, v208, v242
v_sub_f32 v209, v209, v242
v_sub_f32 v210, v210, v242
v_sub_f32 v211, v211, v242
v_sub_f32 v212, v212, v242
v_sub_f32 v213, v213, v242
v_sub_f32 v214, v214, v242
v_sub_f32 v215, v215, v242
v_sub_f32 v216, v216, v242
v_sub_f32 v217, v217, v242
v_sub_f32 v218, v218, v242
v_sub_f32 v219, v219, v242
v_sub_f32 v220, v220, v242
v_sub_f32 v221, v221, v242
v_sub_f32 v222, v222, v242
v_sub_f32 v223, v223, v242
v_mul_f32 v2, v2, v8
v_mul_f32 v3, v3, v8
v_sub_f32 v144, v144, v242
v_sub_f32 v145, v145, v242
v_sub_f32 v146, v146, v242
v_sub_f32 v147, v147, v242
v_sub_f32 v148, v148, v242
v_sub_f32 v149, v149, v242
v_sub_f32 v150, v150, v242
v_sub_f32 v151, v151, v242
v_sub_f32 v152, v152, v242
v_sub_f32 v153, v153, v242
v_sub_f32 v154, v154, v242
v_sub_f32 v155, v155, v242
v_sub_f32 v156, v156, v242
v_sub_f32 v157, v157, v242
v_sub_f32 v158, v158, v242
v_sub_f32 v159, v159, v242
v_sub_f32 v176, v176, v242
v_sub_f32 v177, v177, v242
v_sub_f32 v178, v178, v242
v_sub_f32 v179, v179, v242
v_sub_f32 v180, v180, v242
v_sub_f32 v181, v181, v242
v_sub_f32 v182, v182, v242
v_sub_f32 v183, v183, v242
v_sub_f32 v184, v184, v242
v_sub_f32 v185, v185, v242
v_sub_f32 v186, v186, v242
v_sub_f32 v187, v187, v242
v_sub_f32 v188, v188, v242
v_sub_f32 v189, v189, v242
v_sub_f32 v190, v190, v242
v_sub_f32 v191, v191, v242
s_add_u32 m0, s72, 0
ds_read_b128 a[152:155], v10 offset:22528
ds_read_b128 a[156:159], v10 offset:23552
v_exp_f32 v144, v144
v_mfma_f32_32x32x16_bf16 a[32:47], a[216:219], v[88:91], a[32:47]
ds_read_b128 a[160:163], v10 offset:24576
buffer_load_dwordx4 v12, s[52:55], s71 offen offset:0 sc1 lds
v_exp_f32 v145, v145
v_exp_f32 v146, v146
v_mfma_f32_32x32x16_bf16 a[48:63], a[220:223], v[88:91], a[48:63]
ds_read_b128 a[164:167], v10 offset:25600
ds_read_b128 a[168:171], v10 offset:26624
v_add_f32 v2, v2, v144
v_exp_f32 v147, v147
v_add_f32 v3, v3, v145
v_mfma_f32_32x32x16_bf16 a[0:15], a[224:227], v[112:115], a[0:15]
ds_read_b128 a[172:175], v10 offset:27648
buffer_load_dwordx4 v12, s[52:55], s71 offen offset:1024 sc1 lds
v_cvt_pk_bf16_f32 v144, v144, v145
v_exp_f32 v148, v148
v_add_f32 v2, v2, v146
v_mfma_f32_32x32x16_bf16 a[16:31], a[228:231], v[112:115], a[16:31]
ds_read_b128 a[176:179], v10 offset:28672
ds_read_b128 a[180:183], v10 offset:29696
v_exp_f32 v149, v149
v_add_f32 v3, v3, v147
v_cvt_pk_bf16_f32 v145, v146, v147
v_mfma_f32_32x32x16_bf16 a[32:47], a[232:235], v[112:115], a[32:47]
ds_read_b128 a[184:187], v10 offset:30720
buffer_load_dwordx4 v12, s[52:55], s71 offen offset:2048 sc1 lds
v_exp_f32 v150, v150
v_add_f32 v2, v2, v148
v_mfma_f32_32x32x16_bf16 a[48:63], a[236:239], v[112:115], a[48:63]
ds_read_b128 a[188:191], v10 offset:31744
v_exp_f32 v151, v151
v_add_f32 v3, v3, v149
v_cvt_pk_bf16_f32 v146, v148, v149
v_mfma_f32_32x32x16_bf16 a[0:15], a[240:243], v[120:123], a[0:15]
buffer_load_dwordx4 v12, s[52:55], s71 offen offset:3072 sc1 lds
v_exp_f32 v152, v152
v_add_f32 v2, v2, v150
v_exp_f32 v153, v153
v_mfma_f32_32x32x16_bf16 a[16:31], a[244:247], v[120:123], a[16:31]
v_add_f32 v3, v3, v151
v_cvt_pk_bf16_f32 v147, v150, v151
v_exp_f32 v154, v154
v_add_f32 v2, v2, v152
v_mfma_f32_32x32x16_bf16 a[32:47], a[248:251], v[120:123], a[32:47]
s_sub_u32 s74, s74, 1
v_exp_f32 v155, v155
v_add_f32 v3, v3, v153
v_cvt_pk_bf16_f32 v152, v152, v153
v_mfma_f32_32x32x16_bf16 a[48:63], a[252:255], v[120:123], a[48:63]
v_add_f32 v2, v2, v154
v_add_f32 v3, v3, v155
v_cvt_pk_bf16_f32 v153, v154, v155
s_nop 15
v_accvgpr_read_b32 v240, a0
v_accvgpr_read_b32 v241, a1
v_accvgpr_read_b32 v242, a2
v_accvgpr_read_b32 v243, a3
v_accvgpr_read_b32 v244, a4
v_accvgpr_read_b32 v245, a5
v_accvgpr_read_b32 v246, a6
v_accvgpr_read_b32 v247, a7
v_mul_f32 v240, v240, v8
v_mul_f32 v241, v241, v8
v_mul_f32 v242, v242, v8
v_mul_f32 v243, v243, v8
v_mul_f32 v244, v244, v8
v_mul_f32 v245, v245, v8
v_mul_f32 v246, v246, v8
v_mul_f32 v247, v247, v8
v_accvgpr_write_b32 a0, v240
v_accvgpr_write_b32 a1, v241
v_accvgpr_write_b32 a2, v242
v_accvgpr_write_b32 a3, v243
v_accvgpr_write_b32 a4, v244
v_accvgpr_write_b32 a5, v245
v_accvgpr_write_b32 a6, v246
v_accvgpr_write_b32 a7, v247
v_accvgpr_read_b32 v240, a8
v_accvgpr_read_b32 v241, a9
v_accvgpr_read_b32 v242, a10
v_accvgpr_read_b32 v243, a11
v_accvgpr_read_b32 v244, a12
v_accvgpr_read_b32 v245, a13
v_accvgpr_read_b32 v246, a14
v_accvgpr_read_b32 v247, a15
v_mul_f32 v240, v240, v8
v_mul_f32 v241, v241, v8
v_mul_f32 v242, v242, v8
v_mul_f32 v243, v243, v8
v_mul_f32 v244, v244, v8
v_mul_f32 v245, v245, v8
v_mul_f32 v246, v246, v8
v_mul_f32 v247, v247, v8
v_accvgpr_write_b32 a8, v240
v_accvgpr_write_b32 a9, v241
v_accvgpr_write_b32 a10, v242
v_accvgpr_write_b32 a11, v243
v_accvgpr_write_b32 a12, v244
v_accvgpr_write_b32 a13, v245
v_accvgpr_write_b32 a14, v246
v_accvgpr_write_b32 a15, v247
v_accvgpr_read_b32 v240, a16
v_accvgpr_read_b32 v241, a17
v_accvgpr_read_b32 v242, a18
v_accvgpr_read_b32 v243, a19
v_accvgpr_read_b32 v244, a20
v_accvgpr_read_b32 v245, a21
v_accvgpr_read_b32 v246, a22
v_accvgpr_read_b32 v247, a23
v_mul_f32 v240, v240, v8
v_mul_f32 v241, v241, v8
v_mul_f32 v242, v242, v8
v_mul_f32 v243, v243, v8
v_mul_f32 v244, v244, v8
v_mul_f32 v245, v245, v8
v_mul_f32 v246, v246, v8
v_mul_f32 v247, v247, v8
v_accvgpr_write_b32 a16, v240
v_accvgpr_write_b32 a17, v241
v_accvgpr_write_b32 a18, v242
v_accvgpr_write_b32 a19, v243
v_accvgpr_write_b32 a20, v244
v_accvgpr_write_b32 a21, v245
v_accvgpr_write_b32 a22, v246
v_accvgpr_write_b32 a23, v247
v_accvgpr_read_b32 v240, a24
v_accvgpr_read_b32 v241, a25
v_accvgpr_read_b32 v242, a26
v_accvgpr_read_b32 v243, a27
v_accvgpr_read_b32 v244, a28
v_accvgpr_read_b32 v245, a29
v_accvgpr_read_b32 v246, a30
v_accvgpr_read_b32 v247, a31
v_mul_f32 v240, v240, v8
v_mul_f32 v241, v241, v8
v_mul_f32 v242, v242, v8
v_mul_f32 v243, v243, v8
v_mul_f32 v244, v244, v8
v_mul_f32 v245, v245, v8
v_mul_f32 v246, v246, v8
v_mul_f32 v247, v247, v8
v_accvgpr_write_b32 a24, v240
v_accvgpr_write_b32 a25, v241
v_accvgpr_write_b32 a26, v242
v_accvgpr_write_b32 a27, v243
v_accvgpr_write_b32 a28, v244
v_accvgpr_write_b32 a29, v245
v_accvgpr_write_b32 a30, v246
v_accvgpr_write_b32 a31, v247
v_accvgpr_read_b32 v240, a32
v_accvgpr_read_b32 v241, a33
v_accvgpr_read_b32 v242, a34
v_accvgpr_read_b32 v243, a35
v_accvgpr_read_b32 v244, a36
v_accvgpr_read_b32 v245, a37
v_accvgpr_read_b32 v246, a38
v_accvgpr_read_b32 v247, a39
v_mul_f32 v240, v240, v8
v_mul_f32 v241, v241, v8
v_mul_f32 v242, v242, v8
v_mul_f32 v243, v243, v8
v_mul_f32 v244, v244, v8
v_mul_f32 v245, v245, v8
v_mul_f32 v246, v246, v8
v_mul_f32 v247, v247, v8
v_accvgpr_write_b32 a32, v240
v_accvgpr_write_b32 a33, v241
v_accvgpr_write_b32 a34, v242
v_accvgpr_write_b32 a35, v243
v_accvgpr_write_b32 a36, v244
v_accvgpr_write_b32 a37, v245
v_accvgpr_write_b32 a38, v246
v_accvgpr_write_b32 a39, v247
v_accvgpr_read_b32 v240, a40
v_accvgpr_read_b32 v241, a41
v_accvgpr_read_b32 v242, a42
v_accvgpr_read_b32 v243, a43
v_accvgpr_read_b32 v244, a44
v_accvgpr_read_b32 v245, a45
v_accvgpr_read_b32 v246, a46
v_accvgpr_read_b32 v247, a47
v_mul_f32 v240, v240, v8
v_mul_f32 v241, v241, v8
v_mul_f32 v242, v242, v8
v_mul_f32 v243, v243, v8
v_mul_f32 v244, v244, v8
v_mul_f32 v245, v245, v8
v_mul_f32 v246, v246, v8
v_mul_f32 v247, v247, v8
v_accvgpr_write_b32 a40, v240
v_accvgpr_write_b32 a41, v241
v_accvgpr_write_b32 a42, v242
v_accvgpr_write_b32 a43, v243
v_accvgpr_write_b32 a44, v244
v_accvgpr_write_b32 a45, v245
v_accvgpr_write_b32 a46, v246
v_accvgpr_write_b32 a47, v247
v_accvgpr_read_b32 v240, a48
v_accvgpr_read_b32 v241, a49
v_accvgpr_read_b32 v242, a50
v_accvgpr_read_b32 v243, a51
v_accvgpr_read_b32 v244, a52
v_accvgpr_read_b32 v245, a53
v_accvgpr_read_b32 v246, a54
v_accvgpr_read_b32 v247, a55
v_mul_f32 v240, v240, v8
v_mul_f32 v241, v241, v8
v_mul_f32 v242, v242, v8
v_mul_f32 v243, v243, v8
v_mul_f32 v244, v244, v8
v_mul_f32 v245, v245, v8
v_mul_f32 v246, v246, v8
v_mul_f32 v247, v247, v8
v_accvgpr_write_b32 a48, v240
v_accvgpr_write_b32 a49, v241
v_accvgpr_write_b32 a50, v242
v_accvgpr_write_b32 a51, v243
v_accvgpr_write_b32 a52, v244
v_accvgpr_write_b32 a53, v245
v_accvgpr_write_b32 a54, v246
v_accvgpr_write_b32 a55, v247
v_accvgpr_read_b32 v240, a56
v_accvgpr_read_b32 v241, a57
v_accvgpr_read_b32 v242, a58
v_accvgpr_read_b32 v243, a59
v_accvgpr_read_b32 v244, a60
v_accvgpr_read_b32 v245, a61
v_accvgpr_read_b32 v246, a62
v_accvgpr_read_b32 v247, a63
v_mul_f32 v240, v240, v8
v_mul_f32 v241, v241, v8
v_mul_f32 v242, v242, v8
v_mul_f32 v243, v243, v8
v_mul_f32 v244, v244, v8
v_mul_f32 v245, v245, v8
v_mul_f32 v246, v246, v8
v_mul_f32 v247, v247, v8
v_accvgpr_write_b32 a56, v240
v_accvgpr_write_b32 a57, v241
v_accvgpr_write_b32 a58, v242
v_accvgpr_write_b32 a59, v243
v_accvgpr_write_b32 a60, v244
v_accvgpr_write_b32 a61, v245
v_accvgpr_write_b32 a62, v246
v_accvgpr_write_b32 a63, v247
s_nop 1
s_branch L_p3_s0_end
L_p3_s1_rare:
v_mov_b32 v240, v6
v_mov_b32 v241, v6
s_nop 1
v_permlane32_swap_b32 v240, v241
v_max_f32 v242, v240, v241
v_max_f32 v242, 0, v242
v_exp_f32 v8, -v242
v_sub_f32 v208, v208, v242
v_sub_f32 v209, v209, v242
v_sub_f32 v210, v210, v242
v_sub_f32 v211, v211, v242
v_sub_f32 v212, v212, v242
v_sub_f32 v213, v213, v242
v_sub_f32 v214, v214, v242
v_sub_f32 v215, v215, v242
v_sub_f32 v216, v216, v242
v_sub_f32 v217, v217, v242
v_sub_f32 v218, v218, v242
v_sub_f32 v219, v219, v242
v_sub_f32 v220, v220, v242
v_sub_f32 v221, v221, v242
v_sub_f32 v222, v222, v242
v_sub_f32 v223, v223, v242
v_mul_f32 v2, v2, v8
v_mul_f32 v3, v3, v8
v_sub_f32 v80, v80, v242
v_sub_f32 v81, v81, v242
v_sub_f32 v82, v82, v242
v_sub_f32 v83, v83, v242
v_sub_f32 v84, v84, v242
v_sub_f32 v85, v85, v242
v_sub_f32 v86, v86, v242
v_sub_f32 v87, v87, v242
v_sub_f32 v88, v88, v242
v_sub_f32 v89, v89, v242
v_sub_f32 v90, v90, v242
v_sub_f32 v91, v91, v242
v_sub_f32 v92, v92, v242
v_sub_f32 v93, v93, v242
v_sub_f32 v94, v94, v242
v_sub_f32 v95, v95, v242
v_sub_f32 v112, v112, v242
v_sub_f32 v113, v113, v242
v_sub_f32 v114, v114, v242
v_sub_f32 v115, v115, v242
v_sub_f32 v116, v116, v242
v_sub_f32 v117, v117, v242
v_sub_f32 v118, v118, v242
v_sub_f32 v119, v119, v242
v_sub_f32 v120, v120, v242
v_sub_f32 v121, v121, v242
v_sub_f32 v122, v122, v242
v_sub_f32 v123, v123, v242
v_sub_f32 v124, v124, v242
v_sub_f32 v125, v125, v242
v_sub_f32 v126, v126, v242
v_sub_f32 v127, v127, v242
s_add_u32 m0, s72, 16384
ds_read_b128 a[152:155], v10 offset:6144
ds_read_b128 a[156:159], v10 offset:7168
v_exp_f32 v80, v80
v_mfma_f32_32x32x16_bf16 a[32:47], a[216:219], v[152:155], a[32:47]
ds_read_b128 a[160:163], v10 offset:8192
buffer_load_dwordx4 v12, s[52:55], s71 offen offset:0 sc1 lds
v_exp_f32 v81, v81
v_exp_f32 v82, v82
v_mfma_f32_32x32x16_bf16 a[48:63], a[220:223], v[152:155], a[48:63]
ds_read_b128 a[164:167], v10 offset:9216
ds_read_b128 a[168:171], v10 offset:10240
buffer_load_dwordx4 v12, s[52:55], s71 offen offset:1024 sc1 lds
v_add_f32 v2, v2, v80
v_exp_f32 v83, v83
v_mfma_f32_32x32x16_bf16 a[0:15], a[224:227], v[176:179], a[0:15]
ds_read_b128 a[172:175], v10 offset:11264
v_add_f32 v3, v3, v81
v_cvt_pk_bf16_f32 v80, v80, v81
v_exp_f32 v84, v84
v_add_f32 v2, v2, v82
v_mfma_f32_32x32x16_bf16 a[16:31], a[228:231], v[176:179], a[16:31]
ds_read_b128 a[176:179], v10 offset:12288
ds_read_b128 a[180:183], v10 offset:13312
buffer_load_dwordx4 v12, s[52:55], s71 offen offset:2048 sc1 lds
v_exp_f32 v85, v85
v_add_f32 v3, v3, v83
v_mfma_f32_32x32x16_bf16 a[32:47], a[232:235], v[176:179], a[32:47]
ds_read_b128 a[184:187], v10 offset:14336
v_cvt_pk_bf16_f32 v81, v82, v83
v_exp_f32 v86, v86
v_add_f32 v2, v2, v84
v_mfma_f32_32x32x16_bf16 a[48:63], a[236:239], v[176:179], a[48:63]
ds_read_b128 a[188:191], v10 offset:15360
buffer_load_dwordx4 v12, s[52:55], s71 offen offset:3072 sc1 lds
v_exp_f32 v87, v87
v_add_f32 v3, v3, v85
v_cvt_pk_bf16_f32 v82, v84, v85
v_mfma_f32_32x32x16_bf16 a[0:15], a[240:243], v[184:187], a[0:15]
s_xor_b32 s72, s72, 0x8000
v_exp_f32 v88, v88
v_add_f32 v2, v2, v86
v_exp_f32 v89, v89
v_mfma_f32_32x32x16_bf16 a[16:31], a[244:247], v[184:187], a[16:31]
v_add_f32 v3, v3, v87
v_cvt_pk_bf16_f32 v83, v86, v87
v_exp_f32 v90, v90
v_add_f32 v2, v2, v88
v_mfma_f32_32x32x16_bf16 a[32:47], a[248:251], v[184:187], a[32:47]
buffer_store_dword v77, v76, s[8:11], s37 offen offset:1024 sc1
v_exp_f32 v91, v91
v_add_f32 v3, v3, v89
v_cvt_pk_bf16_f32 v88, v88, v89
v_mfma_f32_32x32x16_bf16 a[48:63], a[252:255], v[184:187], a[48:63]
v_add_f32 v2, v2, v90
v_add_f32 v3, v3, v91
v_cvt_pk_bf16_f32 v89, v90, v91
s_nop 15
v_accvgpr_read_b32 v240, a0
v_accvgpr_read_b32 v241, a1
v_accvgpr_read_b32 v242, a2
v_accvgpr_read_b32 v243, a3
v_accvgpr_read_b32 v244, a4
v_accvgpr_read_b32 v245, a5
v_accvgpr_read_b32 v246, a6
v_accvgpr_read_b32 v247, a7
v_mul_f32 v240, v240, v8
v_mul_f32 v241, v241, v8
v_mul_f32 v242, v242, v8
v_mul_f32 v243, v243, v8
v_mul_f32 v244, v244, v8
v_mul_f32 v245, v245, v8
v_mul_f32 v246, v246, v8
v_mul_f32 v247, v247, v8
v_accvgpr_write_b32 a0, v240
v_accvgpr_write_b32 a1, v241
v_accvgpr_write_b32 a2, v242
v_accvgpr_write_b32 a3, v243
v_accvgpr_write_b32 a4, v244
v_accvgpr_write_b32 a5, v245
v_accvgpr_write_b32 a6, v246
v_accvgpr_write_b32 a7, v247
v_accvgpr_read_b32 v240, a8
v_accvgpr_read_b32 v241, a9
v_accvgpr_read_b32 v242, a10
v_accvgpr_read_b32 v243, a11
v_accvgpr_read_b32 v244, a12
v_accvgpr_read_b32 v245, a13
v_accvgpr_read_b32 v246, a14
v_accvgpr_read_b32 v247, a15
v_mul_f32 v240, v240, v8
v_mul_f32 v241, v241, v8
v_mul_f32 v242, v242, v8
v_mul_f32 v243, v243, v8
v_mul_f32 v244, v244, v8
v_mul_f32 v245, v245, v8
v_mul_f32 v246, v246, v8
v_mul_f32 v247, v247, v8
v_accvgpr_write_b32 a8, v240
v_accvgpr_write_b32 a9, v241
v_accvgpr_write_b32 a10, v242
v_accvgpr_write_b32 a11, v243
v_accvgpr_write_b32 a12, v244
v_accvgpr_write_b32 a13, v245
v_accvgpr_write_b32 a14, v246
v_accvgpr_write_b32 a15, v247
v_accvgpr_read_b32 v240, a16
v_accvgpr_read_b32 v241, a17
v_accvgpr_read_b32 v242, a18
v_accvgpr_read_b32 v243, a19
v_accvgpr_read_b32 v244, a20
v_accvgpr_read_b32 v245, a21
v_accvgpr_read_b32 v246, a22
v_accvgpr_read_b32 v247, a23
v_mul_f32 v240, v240, v8
v_mul_f32 v241, v241, v8
v_mul_f32 v242, v242, v8
v_mul_f32 v243, v243, v8
v_mul_f32 v244, v244, v8
v_mul_f32 v245, v245, v8
v_mul_f32 v246, v246, v8
v_mul_f32 v247, v247, v8
v_accvgpr_write_b32 a16, v240
v_accvgpr_write_b32 a17, v241
v_accvgpr_write_b32 a18, v242
v_accvgpr_write_b32 a19, v243
v_accvgpr_write_b32 a20, v244
v_accvgpr_write_b32 a21, v245
v_accvgpr_write_b32 a22, v246
v_accvgpr_write_b32 a23, v247
v_accvgpr_read_b32 v240, a24
v_accvgpr_read_b32 v241, a25
v_accvgpr_read_b32 v242, a26
v_accvgpr_read_b32 v243, a27
v_accvgpr_read_b32 v244, a28
v_accvgpr_read_b32 v245, a29
v_accvgpr_read_b32 v246, a30
v_accvgpr_read_b32 v247, a31
v_mul_f32 v240, v240, v8
v_mul_f32 v241, v241, v8
v_mul_f32 v242, v242, v8
v_mul_f32 v243, v243, v8
v_mul_f32 v244, v244, v8
v_mul_f32 v245, v245, v8
v_mul_f32 v246, v246, v8
v_mul_f32 v247, v247, v8
v_accvgpr_write_b32 a24, v240
v_accvgpr_write_b32 a25, v241
v_accvgpr_write_b32 a26, v242
v_accvgpr_write_b32 a27, v243
v_accvgpr_write_b32 a28, v244
v_accvgpr_write_b32 a29, v245
v_accvgpr_write_b32 a30, v246
v_accvgpr_write_b32 a31, v247
v_accvgpr_read_b32 v240, a32
v_accvgpr_read_b32 v241, a33
v_accvgpr_read_b32 v242, a34
v_accvgpr_read_b32 v243, a35
v_accvgpr_read_b32 v244, a36
v_accvgpr_read_b32 v245, a37
v_accvgpr_read_b32 v246, a38
v_accvgpr_read_b32 v247, a39
v_mul_f32 v240, v240, v8
v_mul_f32 v241, v241, v8
v_mul_f32 v242, v242, v8
v_mul_f32 v243, v243, v8
v_mul_f32 v244, v244, v8
v_mul_f32 v245, v245, v8
v_mul_f32 v246, v246, v8
v_mul_f32 v247, v247, v8
v_accvgpr_write_b32 a32, v240
v_accvgpr_write_b32 a33, v241
v_accvgpr_write_b32 a34, v242
v_accvgpr_write_b32 a35, v243
v_accvgpr_write_b32 a36, v244
v_accvgpr_write_b32 a37, v245
v_accvgpr_write_b32 a38, v246
v_accvgpr_write_b32 a39, v247
v_accvgpr_read_b32 v240, a40
v_accvgpr_read_b32 v241, a41
v_accvgpr_read_b32 v242, a42
v_accvgpr_read_b32 v243, a43
v_accvgpr_read_b32 v244, a44
v_accvgpr_read_b32 v245, a45
v_accvgpr_read_b32 v246, a46
v_accvgpr_read_b32 v247, a47
v_mul_f32 v240, v240, v8
v_mul_f32 v241, v241, v8
v_mul_f32 v242, v242, v8
v_mul_f32 v243, v243, v8
v_mul_f32 v244, v244, v8
v_mul_f32 v245, v245, v8
v_mul_f32 v246, v246, v8
v_mul_f32 v247, v247, v8
v_accvgpr_write_b32 a40, v240
v_accvgpr_write_b32 a41, v241
v_accvgpr_write_b32 a42, v242
v_accvgpr_write_b32 a43, v243
v_accvgpr_write_b32 a44, v244
v_accvgpr_write_b32 a45, v245
v_accvgpr_write_b32 a46, v246
v_accvgpr_write_b32 a47, v247
v_accvgpr_read_b32 v240, a48
v_accvgpr_read_b32 v241, a49
v_accvgpr_read_b32 v242, a50
v_accvgpr_read_b32 v243, a51
v_accvgpr_read_b32 v244, a52
v_accvgpr_read_b32 v245, a53
v_accvgpr_read_b32 v246, a54
v_accvgpr_read_b32 v247, a55
v_mul_f32 v240, v240, v8
v_mul_f32 v241, v241, v8
v_mul_f32 v242, v242, v8
v_mul_f32 v243, v243, v8
v_mul_f32 v244, v244, v8
v_mul_f32 v245, v245, v8
v_mul_f32 v246, v246, v8
v_mul_f32 v247, v247, v8
v_accvgpr_write_b32 a48, v240
v_accvgpr_write_b32 a49, v241
v_accvgpr_write_b32 a50, v242
v_accvgpr_write_b32 a51, v243
v_accvgpr_write_b32 a52, v244
v_accvgpr_write_b32 a53, v245
v_accvgpr_write_b32 a54, v246
v_accvgpr_write_b32 a55, v247
v_accvgpr_read_b32 v240, a56
v_accvgpr_read_b32 v241, a57
v_accvgpr_read_b32 v242, a58
v_accvgpr_read_b32 v243, a59
v_accvgpr_read_b32 v244, a60
v_accvgpr_read_b32 v245, a61
v_accvgpr_read_b32 v246, a62
v_accvgpr_read_b32 v247, a63
v_mul_f32 v240, v240, v8
v_mul_f32 v241, v241, v8
v_mul_f32 v242, v242, v8
v_mul_f32 v243, v243, v8
v_mul_f32 v244, v244, v8
v_mul_f32 v245, v245, v8
v_mul_f32 v246, v246, v8
v_mul_f32 v247, v247, v8
v_accvgpr_write_b32 a56, v240
v_accvgpr_write_b32 a57, v241
v_accvgpr_write_b32 a58, v242
v_accvgpr_write_b32 a59, v243
v_accvgpr_write_b32 a60, v244
v_accvgpr_write_b32 a61, v245
v_accvgpr_write_b32 a62, v246
v_accvgpr_write_b32 a63, v247
s_nop 1
s_branch L_p3_s1_end
L_p3_s1m_rare:
v_mov_b32 v240, v6
v_mov_b32 v241, v6
s_nop 1
v_permlane32_swap_b32 v240, v241
v_max_f32 v242, v240, v241
v_max_f32 v242, 0, v242
v_exp_f32 v8, -v242
v_sub_f32 v208, v208, v242
v_sub_f32 v209, v209, v242
v_sub_f32 v210, v210, v242
v_sub_f32 v211, v211, v242
v_sub_f32 v212, v212, v242
v_sub_f32 v213, v213, v242
v_sub_f32 v214, v214, v242
v_sub_f32 v215, v215, v242
v_sub_f32 v216, v216, v242
v_sub_f32 v217, v217, v242
v_sub_f32 v218, v218, v242
v_sub_f32 v219, v219, v242
v_sub_f32 v220, v220, v242
v_sub_f32 v221, v221, v242
v_sub_f32 v222, v222, v242
v_sub_f32 v223, v223, v242
v_mul_f32 v2, v2, v8
v_mul_f32 v3, v3, v8
v_sub_f32 v80, v80, v242
v_sub_f32 v81, v81, v242
v_sub_f32 v82, v82, v242
v_sub_f32 v83, v83, v242
v_sub_f32 v84, v84, v242
v_sub_f32 v85, v85, v242
v_sub_f32 v86, v86, v242
v_sub_f32 v87, v87, v242
v_sub_f32 v88, v88, v242
v_sub_f32 v89, v89, v242
v_sub_f32 v90, v90, v242
v_sub_f32 v91, v91, v242
v_sub_f32 v92, v92, v242
v_sub_f32 v93, v93, v242
v_sub_f32 v94, v94, v242
v_sub_f32 v95, v95, v242
v_sub_f32 v112, v112, v242
v_sub_f32 v113, v113, v242
v_sub_f32 v114, v114, v242
v_sub_f32 v115, v115, v242
v_sub_f32 v116, v116, v242
v_sub_f32 v117, v117, v242
v_sub_f32 v118, v118, v242
v_sub_f32 v119, v119, v242
v_sub_f32 v120, v120, v242
v_sub_f32 v121, v121, v242
v_sub_f32 v122, v122, v242
v_sub_f32 v123, v123, v242
v_sub_f32 v124, v124, v242
v_sub_f32 v125, v125, v242
v_sub_f32 v126, v126, v242
v_sub_f32 v127, v127, v242
s_add_u32 m0, s72, 16384
v_exp_f32 v80, v80
v_exp_f32 v81, v81
v_mfma_f32_32x32x16_bf16 a[0:15], a[240:243], v[184:187], a[0:15]
buffer_load_dwordx4 v12, s[52:55], s71 offen offset:0 sc1 lds
buffer_load_dwordx4 v12, s[52:55], s71 offen offset:1024 sc1 lds
v_exp_f32 v82, v82
v_add_f32 v2, v2, v80
v_mfma_f32_32x32x16_bf16 a[16:31], a[244:247], v[184:187], a[16:31]
buffer_load_dwordx4 v12, s[52:55], s71 offen offset:2048 sc1 lds
v_exp_f32 v83, v83
v_add_f32 v3, v3, v81
v_cvt_pk_bf16_f32 v80, v80, v81
v_mfma_f32_32x32x16_bf16 a[32:47], a[248:251], v[184:187], a[32:47]
buffer_load_dwordx4 v12, s[52:55], s71 offen offset:3072 sc1 lds
v_exp_f32 v84, v84
v_add_f32 v2, v2, v82
v_exp_f32 v85, v85
v_mfma_f32_32x32x16_bf16 a[48:63], a[252:255], v[184:187], a[48:63]
s_xor_b32 s72, s72, 0x8000
v_add_f32 v3, v3, v83
v_cvt_pk_bf16_f32 v81, v82, v83
v_exp_f32 v86, v86
v_add_f32 v2, v2, v84
v_exp_f32 v87, v87
v_add_f32 v3, v3, v85
v_cvt_pk_bf16_f32 v82, v84, v85
v_exp_f32 v88, v88
v_add_f32 v2, v2, v86
v_exp_f32 v89, v89
v_add_f32 v3, v3, v87
v_cvt_pk_bf16_f32 v83, v86, v87
v_exp_f32 v90, v90
v_add_f32 v2, v2, v88
v_exp_f32 v91, v91
v_add_f32 v3, v3, v89
v_cvt_pk_bf16_f32 v88, v88, v89
v_add_f32 v2, v2, v90
v_add_f32 v3, v3, v91
v_cvt_pk_bf16_f32 v89, v90, v91
s_nop 15
v_accvgpr_read_b32 v240, a0
v_accvgpr_read_b32 v241, a1
v_accvgpr_read_b32 v242, a2
v_accvgpr_read_b32 v243, a3
v_accvgpr_read_b32 v244, a4
v_accvgpr_read_b32 v245, a5
v_accvgpr_read_b32 v246, a6
v_accvgpr_read_b32 v247, a7
v_mul_f32 v240, v240, v8
v_mul_f32 v241, v241, v8
v_mul_f32 v242, v242, v8
v_mul_f32 v243, v243, v8
v_mul_f32 v244, v244, v8
v_mul_f32 v245, v245, v8
v_mul_f32 v246, v246, v8
v_mul_f32 v247, v247, v8
v_accvgpr_write_b32 a0, v240
v_accvgpr_write_b32 a1, v241
v_accvgpr_write_b32 a2, v242
v_accvgpr_write_b32 a3, v243
v_accvgpr_write_b32 a4, v244
v_accvgpr_write_b32 a5, v245
v_accvgpr_write_b32 a6, v246
v_accvgpr_write_b32 a7, v247
v_accvgpr_read_b32 v240, a8
v_accvgpr_read_b32 v241, a9
v_accvgpr_read_b32 v242, a10
v_accvgpr_read_b32 v243, a11
v_accvgpr_read_b32 v244, a12
v_accvgpr_read_b32 v245, a13
v_accvgpr_read_b32 v246, a14
v_accvgpr_read_b32 v247, a15
v_mul_f32 v240, v240, v8
v_mul_f32 v241, v241, v8
v_mul_f32 v242, v242, v8
v_mul_f32 v243, v243, v8
v_mul_f32 v244, v244, v8
v_mul_f32 v245, v245, v8
v_mul_f32 v246, v246, v8
v_mul_f32 v247, v247, v8
v_accvgpr_write_b32 a8, v240
v_accvgpr_write_b32 a9, v241
v_accvgpr_write_b32 a10, v242
v_accvgpr_write_b32 a11, v243
v_accvgpr_write_b32 a12, v244
v_accvgpr_write_b32 a13, v245
v_accvgpr_write_b32 a14, v246
v_accvgpr_write_b32 a15, v247
v_accvgpr_read_b32 v240, a16
v_accvgpr_read_b32 v241, a17
v_accvgpr_read_b32 v242, a18
v_accvgpr_read_b32 v243, a19
v_accvgpr_read_b32 v244, a20
v_accvgpr_read_b32 v245, a21
v_accvgpr_read_b32 v246, a22
v_accvgpr_read_b32 v247, a23
v_mul_f32 v240, v240, v8
v_mul_f32 v241, v241, v8
v_mul_f32 v242, v242, v8
v_mul_f32 v243, v243, v8
v_mul_f32 v244, v244, v8
v_mul_f32 v245, v245, v8
v_mul_f32 v246, v246, v8
v_mul_f32 v247, v247, v8
v_accvgpr_write_b32 a16, v240
v_accvgpr_write_b32 a17, v241
v_accvgpr_write_b32 a18, v242
v_accvgpr_write_b32 a19, v243
v_accvgpr_write_b32 a20, v244
v_accvgpr_write_b32 a21, v245
v_accvgpr_write_b32 a22, v246
v_accvgpr_write_b32 a23, v247
v_accvgpr_read_b32 v240, a24
v_accvgpr_read_b32 v241, a25
v_accvgpr_read_b32 v242, a26
v_accvgpr_read_b32 v243, a27
v_accvgpr_read_b32 v244, a28
v_accvgpr_read_b32 v245, a29
v_accvgpr_read_b32 v246, a30
v_accvgpr_read_b32 v247, a31
v_mul_f32 v240, v240, v8
v_mul_f32 v241, v241, v8
v_mul_f32 v242, v242, v8
v_mul_f32 v243, v243, v8
v_mul_f32 v244, v244, v8
v_mul_f32 v245, v245, v8
v_mul_f32 v246, v246, v8
v_mul_f32 v247, v247, v8
v_accvgpr_write_b32 a24, v240
v_accvgpr_write_b32 a25, v241
v_accvgpr_write_b32 a26, v242
v_accvgpr_write_b32 a27, v243
v_accvgpr_write_b32 a28, v244
v_accvgpr_write_b32 a29, v245
v_accvgpr_write_b32 a30, v246
v_accvgpr_write_b32 a31, v247
v_accvgpr_read_b32 v240, a32
v_accvgpr_read_b32 v241, a33
v_accvgpr_read_b32 v242, a34
v_accvgpr_read_b32 v243, a35
v_accvgpr_read_b32 v244, a36
v_accvgpr_read_b32 v245, a37
v_accvgpr_read_b32 v246, a38
v_accvgpr_read_b32 v247, a39
v_mul_f32 v240, v240, v8
v_mul_f32 v241, v241, v8
v_mul_f32 v242, v242, v8
v_mul_f32 v243, v243, v8
v_mul_f32 v244, v244, v8
v_mul_f32 v245, v245, v8
v_mul_f32 v246, v246, v8
v_mul_f32 v247, v247, v8
v_accvgpr_write_b32 a32, v240
v_accvgpr_write_b32 a33, v241
v_accvgpr_write_b32 a34, v242
v_accvgpr_write_b32 a35, v243
v_accvgpr_write_b32 a36, v244
v_accvgpr_write_b32 a37, v245
v_accvgpr_write_b32 a38, v246
v_accvgpr_write_b32 a39, v247
v_accvgpr_read_b32 v240, a40
v_accvgpr_read_b32 v241, a41
v_accvgpr_read_b32 v242, a42
v_accvgpr_read_b32 v243, a43
v_accvgpr_read_b32 v244, a44
v_accvgpr_read_b32 v245, a45
v_accvgpr_read_b32 v246, a46
v_accvgpr_read_b32 v247, a47
v_mul_f32 v240, v240, v8
v_mul_f32 v241, v241, v8
v_mul_f32 v242, v242, v8
v_mul_f32 v243, v243, v8
v_mul_f32 v244, v244, v8
v_mul_f32 v245, v245, v8
v_mul_f32 v246, v246, v8
v_mul_f32 v247, v247, v8
v_accvgpr_write_b32 a40, v240
v_accvgpr_write_b32 a41, v241
v_accvgpr_write_b32 a42, v242
v_accvgpr_write_b32 a43, v243
v_accvgpr_write_b32 a44, v244
v_accvgpr_write_b32 a45, v245
v_accvgpr_write_b32 a46, v246
v_accvgpr_write_b32 a47, v247
v_accvgpr_read_b32 v240, a48
v_accvgpr_read_b32 v241, a49
v_accvgpr_read_b32 v242, a50
v_accvgpr_read_b32 v243, a51
v_accvgpr_read_b32 v244, a52
v_accvgpr_read_b32 v245, a53
v_accvgpr_read_b32 v246, a54
v_accvgpr_read_b32 v247, a55
v_mul_f32 v240, v240, v8
v_mul_f32 v241, v241, v8
v_mul_f32 v242, v242, v8
v_mul_f32 v243, v243, v8
v_mul_f32 v244, v244, v8
v_mul_f32 v245, v245, v8
v_mul_f32 v246, v246, v8
v_mul_f32 v247, v247, v8
v_accvgpr_write_b32 a48, v240
v_accvgpr_write_b32 a49, v241
v_accvgpr_write_b32 a50, v242
v_accvgpr_write_b32 a51, v243
v_accvgpr_write_b32 a52, v244
v_accvgpr_write_b32 a53, v245
v_accvgpr_write_b32 a54, v246
v_accvgpr_write_b32 a55, v247
v_accvgpr_read_b32 v240, a56
v_accvgpr_read_b32 v241, a57
v_accvgpr_read_b32 v242, a58
v_accvgpr_read_b32 v243, a59
v_accvgpr_read_b32 v244, a60
v_accvgpr_read_b32 v245, a61
v_accvgpr_read_b32 v246, a62
v_accvgpr_read_b32 v247, a63
v_mul_f32 v240, v240, v8
v_mul_f32 v241, v241, v8
v_mul_f32 v242, v242, v8
v_mul_f32 v243, v243, v8
v_mul_f32 v244, v244, v8
v_mul_f32 v245, v245, v8
v_mul_f32 v246, v246, v8
v_mul_f32 v247, v247, v8
v_accvgpr_write_b32 a56, v240
v_accvgpr_write_b32 a57, v241
v_accvgpr_write_b32 a58, v242
v_accvgpr_write_b32 a59, v243
v_accvgpr_write_b32 a60, v244
v_accvgpr_write_b32 a61, v245
v_accvgpr_write_b32 a62, v246
v_accvgpr_write_b32 a63, v247
s_nop 1
s_branch L_p3_s1m_end
L_p3_s0m_rare:
v_mov_b32 v240, v6
v_mov_b32 v241, v6
s_nop 1
v_permlane32_swap_b32 v240, v241
v_max_f32 v242, v240, v241
v_max_f32 v242, 0, v242
v_exp_f32 v8, -v242
v_sub_f32 v208, v208, v242
v_sub_f32 v209, v209, v242
v_sub_f32 v210, v210, v242
v_sub_f32 v211, v211, v242
v_sub_f32 v212, v212, v242
v_sub_f32 v213, v213, v242
v_sub_f32 v214, v214, v242
v_sub_f32 v215, v215, v242
v_sub_f32 v216, v216, v242
v_sub_f32 v217, v217, v242
v_sub_f32 v218, v218, v242
v_sub_f32 v219, v219, v242
v_sub_f32 v220, v220, v242
v_sub_f32 v221, v221, v242
v_sub_f32 v222, v222, v242
v_sub_f32 v223, v223, v242
v_mul_f32 v2, v2, v8
v_mul_f32 v3, v3, v8
v_sub_f32 v144, v144, v242
v_sub_f32 v145, v145, v242
v_sub_f32 v146, v146, v242
v_sub_f32 v147, v147, v242
v_sub_f32 v148, v148, v242
v_sub_f32 v149, v149, v242
v_sub_f32 v150, v150, v242
v_sub_f32 v151, v151, v242
v_sub_f32 v152, v152, v242
v_sub_f32 v153, v153, v242
v_sub_f32 v154, v154, v242
v_sub_f32 v155, v155, v242
v_sub_f32 v156, v156, v242
v_sub_f32 v157, v157, v242
v_sub_f32 v158, v158, v242
v_sub_f32 v159, v159, v242
v_sub_f32 v176, v176, v242
v_sub_f32 v177, v177, v242
v_sub_f32 v178, v178, v242
v_sub_f32 v179, v179, v242
v_sub_f32 v180, v180, v242
v_sub_f32 v181, v181, v242
v_sub_f32 v182, v182, v242
v_sub_f32 v183, v183, v242
v_sub_f32 v184, v184, v242
v_sub_f32 v185, v185, v242
v_sub_f32 v186, v186, v242
v_sub_f32 v187, v187, v242
v_sub_f32 v188, v188, v242
v_sub_f32 v189, v189, v242
v_sub_f32 v190, v190, v242
v_sub_f32 v191, v191, v242
s_add_u32 m0, s72, 0
v_exp_f32 v144, v144
v_exp_f32 v145, v145
v_mfma_f32_32x32x16_bf16 a[0:15], a[240:243], v[120:123], a[0:15]
buffer_load_dwordx4 v12, s[52:55], s71 offen offset:0 sc1 lds
buffer_load_dwordx4 v12, s[52:55], s71 offen offset:1024 sc1 lds
buffer_load_dwordx4 v12, s[52:55], s71 offen offset:2048 sc1 lds
v_exp_f32 v146, v146
v_add_f32 v2, v2, v144
v_mfma_f32_32x32x16_bf16 a[16:31], a[244:247], v[120:123], a[16:31]
buffer_load_dwordx4 v12, s[52:55], s71 offen offset:3072 sc1 lds
v_lshlrev_b32 v245, 4, v1
s_mov_b32 m0, s43
v_exp_f32 v147, v147
v_add_f32 v3, v3, v145
v_mfma_f32_32x32x16_bf16 a[32:47], a[248:251], v[120:123], a[32:47]
s_nop 0
buffer_load_dwordx4 v245, s[20:23], 0 offen offset:0 sc1 lds
buffer_load_dwordx4 v245, s[20:23], 0 offen offset:1024 sc1 lds
v_cvt_pk_bf16_f32 v144, v144, v145
v_exp_f32 v148, v148
v_mfma_f32_32x32x16_bf16 a[48:63], a[252:255], v[120:123], a[48:63]
buffer_load_dwordx4 v245, s[20:23], 0 offen offset:2048 sc1 lds
buffer_load_dwordx4 v245, s[20:23], 0 offen offset:3072 sc1 lds
v_add_f32 v2, v2, v146
v_exp_f32 v149, v149
v_add_f32 v3, v3, v147
v_cvt_pk_bf16_f32 v145, v146, v147
v_exp_f32 v150, v150
v_add_f32 v2, v2, v148
v_exp_f32 v151, v151
v_add_f32 v3, v3, v149
v_cvt_pk_bf16_f32 v146, v148, v149
v_exp_f32 v152, v152
v_add_f32 v2, v2, v150
v_exp_f32 v153, v153
v_add_f32 v3, v3, v151
v_cvt_pk_bf16_f32 v147, v150, v151
v_exp_f32 v154, v154
v_add_f32 v2, v2, v152
v_exp_f32 v155, v155
v_add_f32 v3, v3, v153
v_cvt_pk_bf16_f32 v152, v152, v153
v_add_f32 v2, v2, v154
v_add_f32 v3, v3, v155
v_cvt_pk_bf16_f32 v153, v154, v155
s_nop 15
v_accvgpr_read_b32 v240, a0
v_accvgpr_read_b32 v241, a1
v_accvgpr_read_b32 v242, a2
v_accvgpr_read_b32 v243, a3
v_accvgpr_read_b32 v244, a4
v_accvgpr_read_b32 v245, a5
v_accvgpr_read_b32 v246, a6
v_accvgpr_read_b32 v247, a7
v_mul_f32 v240, v240, v8
v_mul_f32 v241, v241, v8
v_mul_f32 v242, v242, v8
v_mul_f32 v243, v243, v8
v_mul_f32 v244, v244, v8
v_mul_f32 v245, v245, v8
v_mul_f32 v246, v246, v8
v_mul_f32 v247, v247, v8
v_accvgpr_write_b32 a0, v240
v_accvgpr_write_b32 a1, v241
v_accvgpr_write_b32 a2, v242
v_accvgpr_write_b32 a3, v243
v_accvgpr_write_b32 a4, v244
v_accvgpr_write_b32 a5, v245
v_accvgpr_write_b32 a6, v246
v_accvgpr_write_b32 a7, v247
v_accvgpr_read_b32 v240, a8
v_accvgpr_read_b32 v241, a9
v_accvgpr_read_b32 v242, a10
v_accvgpr_read_b32 v243, a11
v_accvgpr_read_b32 v244, a12
v_accvgpr_read_b32 v245, a13
v_accvgpr_read_b32 v246, a14
v_accvgpr_read_b32 v247, a15
v_mul_f32 v240, v240, v8
v_mul_f32 v241, v241, v8
v_mul_f32 v242, v242, v8
v_mul_f32 v243, v243, v8
v_mul_f32 v244, v244, v8
v_mul_f32 v245, v245, v8
v_mul_f32 v246, v246, v8
v_mul_f32 v247, v247, v8
v_accvgpr_write_b32 a8, v240
v_accvgpr_write_b32 a9, v241
v_accvgpr_write_b32 a10, v242
v_accvgpr_write_b32 a11, v243
v_accvgpr_write_b32 a12, v244
v_accvgpr_write_b32 a13, v245
v_accvgpr_write_b32 a14, v246
v_accvgpr_write_b32 a15, v247
v_accvgpr_read_b32 v240, a16
v_accvgpr_read_b32 v241, a17
v_accvgpr_read_b32 v242, a18
v_accvgpr_read_b32 v243, a19
v_accvgpr_read_b32 v244, a20
v_accvgpr_read_b32 v245, a21
v_accvgpr_read_b32 v246, a22
v_accvgpr_read_b32 v247, a23
v_mul_f32 v240, v240, v8
v_mul_f32 v241, v241, v8
v_mul_f32 v242, v242, v8
v_mul_f32 v243, v243, v8
v_mul_f32 v244, v244, v8
v_mul_f32 v245, v245, v8
v_mul_f32 v246, v246, v8
v_mul_f32 v247, v247, v8
v_accvgpr_write_b32 a16, v240
v_accvgpr_write_b32 a17, v241
v_accvgpr_write_b32 a18, v242
v_accvgpr_write_b32 a19, v243
v_accvgpr_write_b32 a20, v244
v_accvgpr_write_b32 a21, v245
v_accvgpr_write_b32 a22, v246
v_accvgpr_write_b32 a23, v247
v_accvgpr_read_b32 v240, a24
v_accvgpr_read_b32 v241, a25
v_accvgpr_read_b32 v242, a26
v_accvgpr_read_b32 v243, a27
v_accvgpr_read_b32 v244, a28
v_accvgpr_read_b32 v245, a29
v_accvgpr_read_b32 v246, a30
v_accvgpr_read_b32 v247, a31
v_mul_f32 v240, v240, v8
v_mul_f32 v241, v241, v8
v_mul_f32 v242, v242, v8
v_mul_f32 v243, v243, v8
v_mul_f32 v244, v244, v8
v_mul_f32 v245, v245, v8
v_mul_f32 v246, v246, v8
v_mul_f32 v247, v247, v8
v_accvgpr_write_b32 a24, v240
v_accvgpr_write_b32 a25, v241
v_accvgpr_write_b32 a26, v242
v_accvgpr_write_b32 a27, v243
v_accvgpr_write_b32 a28, v244
v_accvgpr_write_b32 a29, v245
v_accvgpr_write_b32 a30, v246
v_accvgpr_write_b32 a31, v247
v_accvgpr_read_b32 v240, a32
v_accvgpr_read_b32 v241, a33
v_accvgpr_read_b32 v242, a34
v_accvgpr_read_b32 v243, a35
v_accvgpr_read_b32 v244, a36
v_accvgpr_read_b32 v245, a37
v_accvgpr_read_b32 v246, a38
v_accvgpr_read_b32 v247, a39
v_mul_f32 v240, v240, v8
v_mul_f32 v241, v241, v8
v_mul_f32 v242, v242, v8
v_mul_f32 v243, v243, v8
v_mul_f32 v244, v244, v8
v_mul_f32 v245, v245, v8
v_mul_f32 v246, v246, v8
v_mul_f32 v247, v247, v8
v_accvgpr_write_b32 a32, v240
v_accvgpr_write_b32 a33, v241
v_accvgpr_write_b32 a34, v242
v_accvgpr_write_b32 a35, v243
v_accvgpr_write_b32 a36, v244
v_accvgpr_write_b32 a37, v245
v_accvgpr_write_b32 a38, v246
v_accvgpr_write_b32 a39, v247
v_accvgpr_read_b32 v240, a40
v_accvgpr_read_b32 v241, a41
v_accvgpr_read_b32 v242, a42
v_accvgpr_read_b32 v243, a43
v_accvgpr_read_b32 v244, a44
v_accvgpr_read_b32 v245, a45
v_accvgpr_read_b32 v246, a46
v_accvgpr_read_b32 v247, a47
v_mul_f32 v240, v240, v8
v_mul_f32 v241, v241, v8
v_mul_f32 v242, v242, v8
v_mul_f32 v243, v243, v8
v_mul_f32 v244, v244, v8
v_mul_f32 v245, v245, v8
v_mul_f32 v246, v246, v8
v_mul_f32 v247, v247, v8
v_accvgpr_write_b32 a40, v240
v_accvgpr_write_b32 a41, v241
v_accvgpr_write_b32 a42, v242
v_accvgpr_write_b32 a43, v243
v_accvgpr_write_b32 a44, v244
v_accvgpr_write_b32 a45, v245
v_accvgpr_write_b32 a46, v246
v_accvgpr_write_b32 a47, v247
v_accvgpr_read_b32 v240, a48
v_accvgpr_read_b32 v241, a49
v_accvgpr_read_b32 v242, a50
v_accvgpr_read_b32 v243, a51
v_accvgpr_read_b32 v244, a52
v_accvgpr_read_b32 v245, a53
v_accvgpr_read_b32 v246, a54
v_accvgpr_read_b32 v247, a55
v_mul_f32 v240, v240, v8
v_mul_f32 v241, v241, v8
v_mul_f32 v242, v242, v8
v_mul_f32 v243, v243, v8
v_mul_f32 v244, v244, v8
v_mul_f32 v245, v245, v8
v_mul_f32 v246, v246, v8
v_mul_f32 v247, v247, v8
v_accvgpr_write_b32 a48, v240
v_accvgpr_write_b32 a49, v241
v_accvgpr_write_b32 a50, v242
v_accvgpr_write_b32 a51, v243
v_accvgpr_write_b32 a52, v244
v_accvgpr_write_b32 a53, v245
v_accvgpr_write_b32 a54, v246
v_accvgpr_write_b32 a55, v247
v_accvgpr_read_b32 v240, a56
v_accvgpr_read_b32 v241, a57
v_accvgpr_read_b32 v242, a58
v_accvgpr_read_b32 v243, a59
v_accvgpr_read_b32 v244, a60
v_accvgpr_read_b32 v245, a61
v_accvgpr_read_b32 v246, a62
v_accvgpr_read_b32 v247, a63
v_mul_f32 v240, v240, v8
v_mul_f32 v241, v241, v8
v_mul_f32 v242, v242, v8
v_mul_f32 v243, v243, v8
v_mul_f32 v244, v244, v8
v_mul_f32 v245, v245, v8
v_mul_f32 v246, v246, v8
v_mul_f32 v247, v247, v8
v_accvgpr_write_b32 a56, v240
v_accvgpr_write_b32 a57, v241
v_accvgpr_write_b32 a58, v242
v_accvgpr_write_b32 a59, v243
v_accvgpr_write_b32 a60, v244
v_accvgpr_write_b32 a61, v245
v_accvgpr_write_b32 a62, v246
v_accvgpr_write_b32 a63, v247
s_nop 1
s_branch L_p3_s0m_end
L_spin_go:
s_mov_b32 s36, 400000
L_spin_go_l:
s_sleep 1
buffer_load_dword v254, off, s[12:15], 0 sc1
s_waitcnt vmcnt(0)
v_cmp_gt_u32 vcc, 1, v254
s_nop 4
s_cbranch_vccz L_spin_go_ret
s_sub_u32 s36, s36, 1
s_cmp_lg_u32 s36, 0
s_cbranch_scc1 L_spin_go_l
s_branch L_spin_go_ret
L_spin_f1:
s_mov_b32 s36, 400000
L_spin_f1_l:
s_sleep 1
buffer_load_dword v237, v233, s[8:11], 0 offen offset:0 sc1
s_waitcnt vmcnt(0)
v_cmp_gt_u32 vcc, 1, v237
s_nop 4
s_cbranch_vccz L_spin_f1_ret
s_sub_u32 s36, s36, 1
s_cmp_lg_u32 s36, 0
s_cbranch_scc1 L_spin_f1_l
s_branch L_spin_f1_ret
L_spin_f2:
s_mov_b32 s36, 400000
L_spin_f2_l:
s_sleep 1
buffer_load_dword v253, v254, s[8:11], 0 offen offset:1024 sc1
s_waitcnt vmcnt(0)
v_cmp_gt_u32 vcc, 1, v253
s_nop 4
s_cbranch_vccz L_spin_f2_ret
s_sub_u32 s36, s36, 1
s_cmp_lg_u32 s36, 0
s_cbranch_scc1 L_spin_f2_l
s_branch L_spin_f2_ret
L_spin_f3:
s_mov_b32 s36, 400000
L_spin_f3_l:
s_sleep 1
buffer_load_dword v253, v254, s[8:11], 0 offen offset:3072 sc1
s_waitcnt vmcnt(0)
v_cmp_gt_u32 vcc, 1, v253
s_nop 4
s_cbranch_vccz L_spin_f3_ret
s_sub_u32 s36, s36, 1
s_cmp_lg_u32 s36, 0
s_cbranch_scc1 L_spin_f3_l
s_branch L_spin_f3_ret
L_code_end:
s_endpgm
.section .rodata,"a"
.p2align 6
.amdhsa_kernel gated_mix__ssm_conv_h3__compressed_kv_cla__prompt_kernel
  .amdhsa_next_free_vgpr 512
  .amdhsa_next_free_sgpr 102
  .amdhsa_accum_offset 256
  .amdhsa_group_segment_fixed_size 0
  .amdhsa_kernarg_size 128
  .amdhsa_user_sgpr_count 2
  .amdhsa_user_sgpr_kernarg_segment_ptr 1
  .amdhsa_system_sgpr_workgroup_id_x 1
  .amdhsa_float_denorm_mode_32 3
.end_amdhsa_kernel
.text
```

```asm
; @launch grid=(256,1,1) block=(256,1,1) lds=163840
.amdgcn_target "amdgcn-amd-amdhsa--gfx950"
.text
.macro MA d,x,a,y,b
v_mfma_f32_16x16x32_bf16 a[\d:\d+3], \x[\a:\a+3], \y[\b:\b+3], a[\d:\d+3]
.endm
.macro MV d,x,a,y,b
v_mfma_f32_16x16x32_bf16 v[\d:\d+3], \x[\a:\a+3], \y[\b:\b+3], v[\d:\d+3]
.endm
.macro TR d,a,o
ds_read_b64_tr_b16 v[\d:\d+1], v\a offset:\o
.endm
.globl gated_mix__ssm_conv_h3__compressed_kv_cla__prompt_kernel
.p2align 8
.type gated_mix__ssm_conv_h3__compressed_kv_cla__prompt_kernel,@function
gated_mix__ssm_conv_h3__compressed_kv_cla__prompt_kernel:
s_cmp_ge_u32 s2, 256
s_cbranch_scc1 L_end
s_load_dwordx2 s[88:89], s[0:1], 56
s_load_dwordx4 s[92:95], s[0:1], 72
s_load_dwordx2 s[40:41], s[0:1], 120
s_load_dwordx2 s[96:97], s[0:1], 112
s_load_dwordx2 s[32:33], s[0:1], 0
s_load_dwordx2 s[34:35], s[0:1], 64
v_lshrrev_b32 v2, 6, v0
v_and_b32 v1, 63, v0
v_lshlrev_b32 v3, 4, v0
v_readfirstlane_b32 s3, v2
s_and_b32 s36, s2, 7
s_lshr_b32 s37, s2, 3
s_and_b32 s38, s37, 7
s_lshr_b32 s37, s37, 3
s_lshr_b32 s42, s37, 1
s_and_b32 s37, s37, 1
s_lshl_b32 s36, s36, 1
s_add_u32 s36, s36, s37
s_lshl_b32 s24, s38, 18
s_lshl_b32 s39, s3, 16
s_add_u32 s24, s24, s39
s_lshl_b32 s25, s3, 17
s_lshl_b32 s39, s36, 9
s_add_u32 s25, s25, s39
s_and_b32 s20, s2, 7
s_lshl_b32 s21, s20, 19
s_lshl_b32 s20, s20, 7
s_lshl_b32 s22, s3, 13
s_add_u32 s23, s22, 98304
v_lshrrev_b32 v204, 3, v1
v_lshlrev_b32 v204, 10, v204
v_lshrrev_b32 v205, 4, v1
v_and_b32 v206, 7, v1
v_xor_b32 v206, v206, v205
v_lshl_add_u32 v204, v206, 4, v204
v_xor_b32 v207, 64, v204
v_add_u32 v176, 0, v204
v_add_u32 v177, 7168, v207
v_add_u32 v178, 14336, v204
v_add_u32 v179, 21504, v207
v_add_u32 v180, 32768, v204
v_add_u32 v181, 39936, v207
v_add_u32 v182, 47104, v204
v_add_u32 v183, 54272, v207
v_lshrrev_b32 v204, 5, v1
v_and_b32 v206, 31, v1
v_lshlrev_b32 v207, 1, v204
v_xor_b32 v206, v206, v207
v_lshlrev_b32 v204, 13, v204
v_xor_b32 v207, 0, v206
v_lshl_add_u32 v207, v207, 4, v204
v_add_u32 v184, 0, v207
v_xor_b32 v207, 4, v206
v_lshl_add_u32 v207, v207, 4, v204
v_add_u32 v185, 15360, v207
v_xor_b32 v207, 0, v206
v_lshl_add_u32 v207, v207, 4, v204
v_add_u32 v186, 30720, v207
v_xor_b32 v207, 4, v206
v_lshl_add_u32 v207, v207, 4, v204
v_add_u32 v187, 46080, v207
v_xor_b32 v207, 8, v206
v_lshl_add_u32 v207, v207, 4, v204
v_add_u32 v188, 65536, v207
v_xor_b32 v207, 12, v206
v_lshl_add_u32 v207, v207, 4, v204
v_add_u32 v189, 80896, v207
v_xor_b32 v207, 8, v206
v_lshl_add_u32 v207, v207, 4, v204
v_add_u32 v190, 96256, v207
v_xor_b32 v207, 12, v206
v_lshl_add_u32 v207, v207, 4, v204
v_add_u32 v191, 111616, v207
s_waitcnt lgkmcnt(0)
s_add_u32 s8, s88, s24
s_addc_u32 s9, s89, 0
s_mov_b32 s10, 65536
s_mov_b32 s11, 0x20000
s_cmp_eq_u32 s42, 0
s_cselect_b32 s12, s92, s94
s_cselect_b32 s13, s93, s95
s_add_u32 s12, s12, s25
s_addc_u32 s13, s13, 0
s_sub_u32 s14, 4194304, s25
s_mov_b32 s15, 0x20000
s_add_u32 s4, s40, 59768832
s_addc_u32 s5, s41, 0
s_mov_b32 s6, 4096
s_mov_b32 s7, 0x20000
s_lshl_b32 s43, s2, 20
v_add_u32 v3, s43, v3
v_mov_b32 v4, 0
v_mov_b32 v5, 0
v_mov_b32 v6, 0
v_mov_b32 v7, 0
buffer_store_dwordx4 v[4:7], v3, s[4:7], 0 offen sc1
s_add_u32 m0, s23, 0
s_nop 0
buffer_load_dwordx4 v184, s[12:15], s21 offen offset:0 lds
buffer_load_dwordx4 v185, s[12:15], s21 offen offset:1024 lds
buffer_load_dwordx4 v186, s[12:15], s21 offen offset:2048 lds
buffer_load_dwordx4 v187, s[12:15], s21 offen offset:3072 lds
s_add_u32 m0, s23, 4096
s_nop 0
buffer_load_dwordx4 v188, s[12:15], s21 offen offset:0 lds
buffer_load_dwordx4 v189, s[12:15], s21 offen offset:1024 lds
buffer_load_dwordx4 v190, s[12:15], s21 offen offset:2048 lds
buffer_load_dwordx4 v191, s[12:15], s21 offen offset:3072 lds
s_add_u32 s21, s21, 524288
s_and_b32 s21, s21, 4194303
s_add_u32 m0, s22, 0
s_nop 0
buffer_load_dwordx4 v176, s[8:11], s20 offen offset:0 lds
buffer_load_dwordx4 v177, s[8:11], s20 offen offset:1024 lds
buffer_load_dwordx4 v178, s[8:11], s20 offen offset:2048 lds
buffer_load_dwordx4 v179, s[8:11], s20 offen offset:3072 lds
s_add_u32 m0, s22, 4096
s_nop 0
buffer_load_dwordx4 v180, s[8:11], s20 offen offset:0 lds
buffer_load_dwordx4 v181, s[8:11], s20 offen offset:1024 lds
buffer_load_dwordx4 v182, s[8:11], s20 offen offset:2048 lds
buffer_load_dwordx4 v183, s[8:11], s20 offen offset:3072 lds
s_add_u32 s20, s20, 128
s_and_b32 s20, s20, 1023
v_and_b32 v204, 15, v1
v_lshrrev_b32 v206, 1, v204
v_xor_b32 v206, v206, v205
v_lshlrev_b32 v206, 4, v206
v_lshl_add_u32 v206, v204, 7, v206
s_and_b32 s39, s3, 1
s_lshl_b32 s39, s39, 14
v_add_u32 v192, s39, v206
v_xor_b32 v193, 64, v192
v_add_u32 v194, 0x10000, v192
v_add_u32 v195, 0x10000, v193
v_bfe_u32 v204, v1, 2, 2
v_and_b32 v206, 1, v205
v_lshl_or_b32 v206, v206, 2, v204
v_lshl_add_u32 v204, v205, 3, v204
v_lshlrev_b32 v204, 9, v204
v_and_b32 v207, 3, v1
v_lshl_add_u32 v204, v207, 3, v204
s_lshr_b32 s39, s3, 1
s_lshl_b32 s39, s39, 8
s_add_u32 s39, s39, 98304
v_add_u32 v204, s39, v204
v_xor_b32 v207, 0, v206
v_lshl_add_u32 v196, v207, 5, v204
v_xor_b32 v207, 1, v206
v_lshl_add_u32 v197, v207, 5, v204
v_xor_b32 v207, 2, v206
v_lshl_add_u32 v198, v207, 5, v204
v_xor_b32 v207, 3, v206
v_lshl_add_u32 v199, v207, 5, v204
v_xor_b32 v207, 4, v206
v_lshl_add_u32 v200, v207, 5, v204
v_xor_b32 v207, 5, v206
v_lshl_add_u32 v201, v207, 5, v204
v_xor_b32 v207, 6, v206
v_lshl_add_u32 v202, v207, 5, v204
v_xor_b32 v207, 7, v206
v_lshl_add_u32 v203, v207, 5, v204
s_lshl_b32 s36, s36, 1
s_lshr_b32 s39, s3, 1
s_add_u32 s36, s36, s39
s_lshl_b32 s24, s36, 19
s_lshl_b32 s38, s38, 16
s_add_u32 s24, s24, s38
s_and_b32 s39, s3, 1
s_lshl_b32 s39, s39, 15
s_add_u32 s24, s24, s39
s_lshl_b32 s36, s42, 24
s_add_u32 s16, s40, s36
s_addc_u32 s17, s41, 0
s_mov_b32 s18, 16777216
s_mov_b32 s19, 0x20000
s_mov_b32 s98, 256
s_mov_b32 s99, 0x20000
v_lshlrev_b32 v3, 16, v3
v_mov_b32 v4, 1
s_cmp_lg_u32 s2, 0
s_cselect_b32 s43, 0x10000000, 0
v_or_b32 v3, s43, v3
s_waitcnt vmcnt(0)
s_barrier
buffer_store_dword v4, v3, s[96:99], 0 offen sc1
ds_read_b128 v[80:83], v192 offset:0
ds_read_b128 v[84:87], v192 offset:2048
ds_read_b128 v[88:91], v192 offset:4096
ds_read_b128 v[92:95], v192 offset:6144
ds_read_b128 v[96:99], v192 offset:8192
ds_read_b128 v[100:103], v192 offset:10240
ds_read_b128 v[104:107], v192 offset:12288
ds_read_b128 v[108:111], v192 offset:14336
TR 144,196,0
TR 146,196,2048
TR 148,197,0
TR 150,197,2048
TR 152,198,0
TR 154,198,2048
TR 156,199,0
TR 158,199,2048
TR 160,200,0
TR 162,200,2048
TR 164,201,0
TR 166,201,2048
TR 168,202,0
TR 170,202,2048
TR 172,203,0
TR 174,203,2048
s_cmp_eq_u32 s42, 0
s_cbranch_scc0 L_p1_V
s_waitcnt lgkmcnt(14)
v_mfma_f32_16x16x32_bf16 a[0:3], v[144:147], v[80:83], 0
s_add_u32 m0, s23, 32768
s_add_u32 s25, s24, 128
v_mfma_f32_16x16x32_bf16 a[8:11], v[144:147], v[84:87], 0
ds_read_b128 v[112:115], v193 offset:0
v_mfma_f32_16x16x32_bf16 a[64:67], v[144:147], v[88:91], 0
buffer_load_dwordx4 v184, s[12:15], s21 offen offset:0 lds
s_add_u32 s26, s24, 2048
v_mfma_f32_16x16x32_bf16 a[72:75], v[144:147], v[92:95], 0
v_mfma_f32_16x16x32_bf16 a[128:131], v[144:147], v[96:99], 0
v_mfma_f32_16x16x32_bf16 a[136:139], v[144:147], v[100:103], 0
buffer_load_dwordx4 v185, s[12:15], s21 offen offset:1024 lds
s_add_u32 s27, s24, 2176
v_mfma_f32_16x16x32_bf16 a[192:195], v[144:147], v[104:107], 0
v_mfma_f32_16x16x32_bf16 a[200:203], v[144:147], v[108:111], 0
TR 144,196,16384
TR 146,196,18432
s_waitcnt lgkmcnt(15)
v_mfma_f32_16x16x32_bf16 a[4:7], v[148:151], v[80:83], 0
ds_read_b128 v[116:119], v193 offset:2048
buffer_load_dwordx4 v186, s[12:15], s21 offen offset:2048 lds
v_mfma_f32_16x16x32_bf16 a[12:15], v[148:151], v[84:87], 0
s_add_u32 s28, s24, 4096
v_mfma_f32_16x16x32_bf16 a[68:71], v[148:151], v[88:91], 0
buffer_load_dwordx4 v187, s[12:15], s21 offen offset:3072 lds
v_mfma_f32_16x16x32_bf16 a[76:79], v[148:151], v[92:95], 0
s_add_u32 s29, s24, 4224
v_mfma_f32_16x16x32_bf16 a[132:135], v[148:151], v[96:99], 0
s_add_u32 m0, s23, 36864
v_mfma_f32_16x16x32_bf16 a[140:143], v[148:151], v[100:103], 0
ds_read_b128 v[120:123], v193 offset:4096
v_mfma_f32_16x16x32_bf16 a[196:199], v[148:151], v[104:107], 0
s_add_u32 s30, s24, 6144
v_mfma_f32_16x16x32_bf16 a[204:207], v[148:151], v[108:111], 0
TR 148,197,16384
TR 150,197,18432
s_waitcnt lgkmcnt(15)
v_mfma_f32_16x16x32_bf16 a[16:19], v[152:155], v[80:83], 0
buffer_load_dwordx4 v188, s[12:15], s21 offen offset:0 lds
s_add_u32 s31, s24, 6272
v_mfma_f32_16x16x32_bf16 a[24:27], v[152:155], v[84:87], 0
v_mfma_f32_16x16x32_bf16 a[80:83], v[152:155], v[88:91], 0
buffer_load_dwordx4 v189, s[12:15], s21 offen offset:1024 lds
v_mfma_f32_16x16x32_bf16 a[88:91], v[152:155], v[92:95], 0
v_lshlrev_b32 v8, 7, v1
v_mfma_f32_16x16x32_bf16 a[144:147], v[152:155], v[96:99], 0
ds_read_b128 v[124:127], v193 offset:6144
buffer_load_dwordx4 v190, s[12:15], s21 offen offset:2048 lds
v_mfma_f32_16x16x32_bf16 a[152:155], v[152:155], v[100:103], 0
v_mfma_f32_16x16x32_bf16 a[208:211], v[152:155], v[104:107], 0
s_getpc_b64 s[4:5]
L_pcK:
v_mfma_f32_16x16x32_bf16 a[216:219], v[152:155], v[108:111], 0
TR 152,198,16384
TR 154,198,18432
v_mfma_f32_16x16x32_bf16 a[20:23], v[156:159], v[80:83], 0
buffer_load_dwordx4 v191, s[12:15], s21 offen offset:3072 lds
v_mfma_f32_16x16x32_bf16 a[28:31], v[156:159], v[84:87], 0
s_add_u32 s21, s21, 524288
s_lshr_b32 s98, s2, 3
v_mfma_f32_16x16x32_bf16 a[84:87], v[156:159], v[88:91], 0
ds_read_b128 v[128:131], v193 offset:8192
v_mfma_f32_16x16x32_bf16 a[92:95], v[156:159], v[92:95], 0
v_mfma_f32_16x16x32_bf16 a[148:151], v[156:159], v[96:99], 0
s_and_b32 s21, s21, 4194303
s_lshl_b32 s98, s98, 2
v_mfma_f32_16x16x32_bf16 a[156:159], v[156:159], v[100:103], 0
v_mfma_f32_16x16x32_bf16 a[212:215], v[156:159], v[104:107], 0
v_mfma_f32_16x16x32_bf16 a[220:223], v[156:159], v[108:111], 0
TR 156,199,16384
TR 158,199,18432
s_waitcnt lgkmcnt(15)
v_mfma_f32_16x16x32_bf16 a[32:35], v[160:163], v[80:83], 0
ds_read_b128 v[132:135], v193 offset:10240
s_add_u32 m0, s22, 32768
v_mfma_f32_16x16x32_bf16 a[40:43], v[160:163], v[84:87], 0
buffer_load_dwordx4 v176, s[8:11], s20 offen offset:0 lds
s_add_u32 s98, s98, s3
v_mfma_f32_16x16x32_bf16 a[96:99], v[160:163], v[88:91], 0
s_lshl_b32 s98, s98, 10
v_mfma_f32_16x16x32_bf16 a[104:107], v[160:163], v[92:95], 0
v_mfma_f32_16x16x32_bf16 a[160:163], v[160:163], v[96:99], 0
buffer_load_dwordx4 v177, s[8:11], s20 offen offset:1024 lds
v_and_b32 v9, 0x380, v8
v_mfma_f32_16x16x32_bf16 a[168:171], v[160:163], v[100:103], 0
v_mfma_f32_16x16x32_bf16 a[224:227], v[160:163], v[104:107], 0
buffer_load_dwordx4 v178, s[8:11], s20 offen offset:2048 lds
v_mfma_f32_16x16x32_bf16 a[232:235], v[160:163], v[108:111], 0
TR 160,200,16384
TR 162,200,18432
v_mfma_f32_16x16x32_bf16 a[36:39], v[164:167], v[80:83], 0
ds_read_b128 v[136:139], v193 offset:12288
v_add_u32 v9, s98, v9
v_mfma_f32_16x16x32_bf16 a[44:47], v[164:167], v[84:87], 0
buffer_load_dwordx4 v179, s[8:11], s20 offen offset:3072 lds
v_mfma_f32_16x16x32_bf16 a[100:103], v[164:167], v[88:91], 0
v_min_u32 v9, L_code_end - L_pcK - 4, v9
v_mfma_f32_16x16x32_bf16 a[108:111], v[164:167], v[92:95], 0
s_add_u32 m0, s22, 36864
v_mfma_f32_16x16x32_bf16 a[164:167], v[164:167], v[96:99], 0
v_mfma_f32_16x16x32_bf16 a[172:175], v[164:167], v[100:103], 0
ds_read_b128 v[140:143], v193 offset:14336
v_mov_b32 v11, s5
v_mfma_f32_16x16x32_bf16 a[228:231], v[164:167], v[104:107], 0
buffer_load_dwordx4 v180, s[8:11], s20 offen offset:0 lds
v_mfma_f32_16x16x32_bf16 a[236:239], v[164:167], v[108:111], 0
TR 164,201,16384
TR 166,201,18432
v_mfma_f32_16x16x32_bf16 a[48:51], v[168:171], v[80:83], 0
v_add_co_u32 v10, vcc, s4, v9
s_nop 1
v_addc_co_u32 v11, vcc, 0, v11, vcc
v_mfma_f32_16x16x32_bf16 a[56:59], v[168:171], v[84:87], 0
buffer_load_dwordx4 v181, s[8:11], s20 offen offset:1024 lds
v_mfma_f32_16x16x32_bf16 a[112:115], v[168:171], v[88:91], 0
v_mfma_f32_16x16x32_bf16 a[120:123], v[168:171], v[92:95], 0
buffer_load_dwordx4 v182, s[8:11], s20 offen offset:2048 lds
v_mfma_f32_16x16x32_bf16 a[176:179], v[168:171], v[96:99], 0
v_mfma_f32_16x16x32_bf16 a[184:187], v[168:171], v[100:103], 0
v_mfma_f32_16x16x32_bf16 a[240:243], v[168:171], v[104:107], 0
buffer_load_dwordx4 v183, s[8:11], s20 offen offset:3072 lds
v_mfma_f32_16x16x32_bf16 a[248:251], v[168:171], v[108:111], 0
TR 168,202,16384
TR 170,202,18432
s_waitcnt lgkmcnt(15)
v_mfma_f32_16x16x32_bf16 a[52:55], v[172:175], v[80:83], 0
s_add_u32 s20, s20, 128
v_mfma_f32_16x16x32_bf16 a[60:63], v[172:175], v[84:87], 0
v_mfma_f32_16x16x32_bf16 a[116:119], v[172:175], v[88:91], 0
v_mfma_f32_16x16x32_bf16 a[124:127], v[172:175], v[92:95], 0
s_and_b32 s20, s20, 1023
global_load_dword v79, v[10:11], off
v_mfma_f32_16x16x32_bf16 a[180:183], v[172:175], v[96:99], 0
v_mfma_f32_16x16x32_bf16 a[188:191], v[172:175], v[100:103], 0
v_mfma_f32_16x16x32_bf16 a[244:247], v[172:175], v[104:107], 0
v_mfma_f32_16x16x32_bf16 a[252:255], v[172:175], v[108:111], 0
TR 172,203,16384
TR 174,203,18432
s_waitcnt lgkmcnt(2)
MA 0,v,144,v,112
s_add_u32 m0, s22, 65536
MA 8,v,144,v,116
MA 64,v,144,v,120
MA 72,v,144,v,124
buffer_load_dwordx4 v176, s[8:11], s20 offen offset:0 lds
MA 128,v,144,v,128
MA 136,v,144,v,132
MA 192,v,144,v,136
MA 200,v,144,v,140
buffer_load_dwordx4 v177, s[8:11], s20 offen offset:1024 lds
MA 4,v,148,v,112
MA 12,v,148,v,116
MA 68,v,148,v,120
buffer_load_dwordx4 v178, s[8:11], s20 offen offset:2048 lds
MA 76,v,148,v,124
MA 132,v,148,v,128
MA 140,v,148,v,132
MA 196,v,148,v,136
buffer_load_dwordx4 v179, s[8:11], s20 offen offset:3072 lds
MA 204,v,148,v,140
MA 16,v,152,v,112
MA 24,v,152,v,116
s_add_u32 m0, s22, 69632
MA 80,v,152,v,120
MA 88,v,152,v,124
MA 144,v,152,v,128
MA 152,v,152,v,132
buffer_load_dwordx4 v180, s[8:11], s20 offen offset:0 lds
MA 208,v,152,v,136
MA 216,v,152,v,140
MA 20,v,156,v,112
MA 28,v,156,v,116
buffer_load_dwordx4 v181, s[8:11], s20 offen offset:1024 lds
MA 84,v,156,v,120
MA 92,v,156,v,124
MA 148,v,156,v,128
buffer_load_dwordx4 v182, s[8:11], s20 offen offset:2048 lds
MA 156,v,156,v,132
MA 212,v,156,v,136
MA 220,v,156,v,140
MA 32,v,160,v,112
buffer_load_dwordx4 v183, s[8:11], s20 offen offset:3072 lds
MA 40,v,160,v,116
MA 96,v,160,v,120
MA 104,v,160,v,124
s_add_u32 s20, s20, 128
MA 160,v,160,v,128
MA 168,v,160,v,132
MA 224,v,160,v,136
MA 232,v,160,v,140
s_and_b32 s20, s20, 1023
MA 36,v,164,v,112
MA 44,v,164,v,116
MA 100,v,164,v,120
MA 108,v,164,v,124
MA 164,v,164,v,128
s_waitcnt vmcnt(9) lgkmcnt(0)
s_barrier
MA 172,v,164,v,132
TR 144,196,32768
TR 146,196,34816
MA 228,v,164,v,136
ds_read_b128 v[80:83], v192 offset:32768
s_add_u32 m0, s23, 0
MA 236,v,164,v,140
TR 148,197,32768
TR 150,197,34816
MA 48,v,168,v,112
ds_read_b128 v[84:87], v192 offset:34816
ds_read_b128 v[88:91], v192 offset:36864
MA 56,v,168,v,116
TR 152,198,32768
TR 154,198,34816
MA 112,v,168,v,120
ds_read_b128 v[92:95], v192 offset:38912
ds_read_b128 v[96:99], v192 offset:40960
MA 120,v,168,v,124
TR 156,199,32768
TR 158,199,34816
MA 176,v,168,v,128
ds_read_b128 v[100:103], v192 offset:43008
ds_read_b128 v[104:107], v192 offset:45056
MA 184,v,168,v,132
TR 160,200,32768
TR 162,200,34816
MA 240,v,168,v,136
ds_read_b128 v[108:111], v192 offset:47104
buffer_load_dwordx4 v184, s[12:15], s21 offen offset:0 lds
MA 248,v,168,v,140
TR 164,201,32768
TR 166,201,34816
MA 52,v,172,v,112
buffer_load_dwordx4 v185, s[12:15], s21 offen offset:1024 lds
buffer_load_dwordx4 v186, s[12:15], s21 offen offset:2048 lds
MA 60,v,172,v,116
TR 168,202,32768
TR 170,202,34816
MA 116,v,172,v,120
buffer_load_dwordx4 v187, s[12:15], s21 offen offset:3072 lds
s_add_u32 m0, s23, 4096
MA 124,v,172,v,124
buffer_load_dwordx4 v188, s[12:15], s21 offen offset:0 lds
buffer_load_dwordx4 v189, s[12:15], s21 offen offset:1024 lds
MA 180,v,172,v,128
buffer_load_dwordx4 v190, s[12:15], s21 offen offset:2048 lds
buffer_load_dwordx4 v191, s[12:15], s21 offen offset:3072 lds
MA 188,v,172,v,132
s_add_u32 s21, s21, 524288
s_and_b32 s21, s21, 4194303
MA 244,v,172,v,136
s_load_dwordx2 s[84:85], s[0:1], 8
s_load_dwordx2 s[88:89], s[0:1], 16
MA 252,v,172,v,140
TR 172,203,32768
TR 174,203,34816
s_load_dwordx2 s[92:93], s[0:1], 0
s_load_dwordx2 s[96:97], s[0:1], 24
s_load_dwordx2 s[76:77], s[0:1], 96
s_waitcnt lgkmcnt(2)
MA 0,v,144,v,80
s_add_u32 m0, s22, 0
MA 8,v,144,v,84
ds_read_b128 v[112:115], v193 offset:32768
MA 64,v,144,v,88
s_mov_b32 s4, s34
s_mov_b32 s5, s35
MA 72,v,144,v,92
MA 128,v,144,v,96
MA 136,v,144,v,100
buffer_load_dwordx4 v176, s[8:11], s20 offen offset:0 lds
MA 192,v,144,v,104
MA 200,v,144,v,108
TR 144,196,49152
TR 146,196,51200
MA 4,v,148,v,80
ds_read_b128 v[116:119], v193 offset:34816
MA 12,v,148,v,84
s_mov_b32 s6, 8388608
s_mov_b32 s7, 0x20000
MA 68,v,148,v,88
buffer_load_dwordx4 v177, s[8:11], s20 offen offset:1024 lds
MA 76,v,148,v,92
MA 132,v,148,v,96
MA 140,v,148,v,100
ds_read_b128 v[120:123], v193 offset:36864
MA 196,v,148,v,104
MA 204,v,148,v,108
TR 148,197,49152
TR 150,197,51200
MA 16,v,152,v,80
buffer_load_dwordx4 v178, s[8:11], s20 offen offset:2048 lds
s_lshr_b32 s43, s2, 3
MA 24,v,152,v,84
MA 80,v,152,v,88
MA 88,v,152,v,92
s_lshl_b32 s43, s43, 2
MA 144,v,152,v,96
ds_read_b128 v[124:127], v193 offset:38912
buffer_load_dwordx4 v179, s[8:11], s20 offen offset:3072 lds
MA 152,v,152,v,100
MA 208,v,152,v,104
MA 216,v,152,v,108
TR 152,198,49152
TR 154,198,51200
MA 20,v,156,v,80
s_add_u32 s43, s43, s3
MA 28,v,156,v,84
s_add_u32 m0, s22, 4096
MA 84,v,156,v,88
ds_read_b128 v[128:131], v193 offset:40960
MA 92,v,156,v,92
s_lshl_b32 s43, s43, 16
MA 148,v,156,v,96
MA 156,v,156,v,100
MA 212,v,156,v,104
MA 220,v,156,v,108
TR 156,199,49152
TR 158,199,51200
MA 32,v,160,v,80
ds_read_b128 v[132:135], v193 offset:43008
buffer_load_dwordx4 v180, s[8:11], s20 offen offset:0 lds
MA 40,v,160,v,84
s_and_b32 s37, s2, 7
MA 96,v,160,v,88
s_lshl_b32 s37, s37, 10
MA 104,v,160,v,92
MA 160,v,160,v,96
buffer_load_dwordx4 v181, s[8:11], s20 offen offset:1024 lds
MA 168,v,160,v,100
MA 224,v,160,v,104
s_add_u32 s43, s43, s37
MA 232,v,160,v,108
TR 160,200,49152
TR 162,200,51200
MA 36,v,164,v,80
ds_read_b128 v[136:139], v193 offset:45056
MA 44,v,164,v,84
buffer_load_dwordx4 v182, s[8:11], s20 offen offset:2048 lds
MA 100,v,164,v,88
v_lshrrev_b32 v78, 3, v1
MA 108,v,164,v,92
MA 164,v,164,v,96
MA 172,v,164,v,100
ds_read_b128 v[140:143], v193 offset:47104
MA 228,v,164,v,104
buffer_load_dwordx4 v183, s[8:11], s20 offen offset:3072 lds
s_waitcnt vmcnt(24)
v_and_b32 v79, 7, v1
MA 236,v,164,v,108
TR 164,201,49152
TR 166,201,51200
MA 48,v,168,v,80
MA 56,v,168,v,84
MA 112,v,168,v,88
v_lshlrev_b32 v79, 7, v79
MA 120,v,168,v,92
s_add_u32 s20, s20, 128
MA 176,v,168,v,96
MA 184,v,168,v,100
MA 240,v,168,v,104
v_lshl_add_u32 v78, v78, 13, v79
MA 248,v,168,v,108
TR 168,202,49152
TR 170,202,51200
s_waitcnt lgkmcnt(15)
MA 52,v,172,v,80
s_and_b32 s20, s20, 1023
MA 60,v,172,v,84
MA 116,v,172,v,88
v_add_u32 v78, s43, v78
MA 124,v,172,v,92
MA 180,v,172,v,96
MA 188,v,172,v,100
MA 244,v,172,v,104
MA 252,v,172,v,108
TR 172,203,49152
TR 174,203,51200
s_waitcnt lgkmcnt(2)
MA 0,v,144,v,112
MA 8,v,144,v,116
MA 64,v,144,v,120
MA 72,v,144,v,124
MA 128,v,144,v,128
MA 136,v,144,v,132
MA 192,v,144,v,136
MA 200,v,144,v,140
MA 4,v,148,v,112
MA 12,v,148,v,116
s_waitcnt vmcnt(8) lgkmcnt(0)
s_barrier
MA 68,v,148,v,120
TR 144,196,0
TR 146,196,2048
MA 76,v,148,v,124
ds_read_b128 v[80:83], v194 offset:0
s_add_u32 m0, s23, 32768
MA 132,v,148,v,128
s_mov_b32 s86, 4194304
s_mov_b32 s87, 0x20000
MA 140,v,148,v,132
s_mov_b32 s90, 4194304
s_mov_b32 s91, 0x20000
MA 196,v,148,v,136
buffer_load_dwordx4 v184, s[12:15], s21 offen offset:0 lds
MA 204,v,148,v,140
TR 148,197,0
TR 150,197,2048
MA 16,v,152,v,112
ds_read_b128 v[84:87], v194 offset:2048
s_mov_b32 s94, 4194304
MA 24,v,152,v,116
s_mov_b32 s95, 0x20000
s_mov_b32 s98, 8192
MA 80,v,152,v,120
buffer_load_dwordx4 v185, s[12:15], s21 offen offset:1024 lds
s_mov_b32 s99, 0x20000
MA 88,v,152,v,124
MA 144,v,152,v,128
s_mov_b32 s78, 2048
MA 152,v,152,v,132
ds_read_b128 v[88:91], v194 offset:4096
s_mov_b32 s79, 0x20000
MA 208,v,152,v,136
s_and_b32 s36, s2, 15
MA 216,v,152,v,140
TR 152,198,0
TR 154,198,2048
MA 20,v,156,v,112
buffer_load_dwordx4 v186, s[12:15], s21 offen offset:2048 lds
s_lshl_b32 s36, s36, 1
MA 28,v,156,v,116
s_lshr_b32 s37, s3, 1
MA 84,v,156,v,120
ds_read_b128 v[92:95], v194 offset:6144
s_add_u32 s36, s36, s37
MA 92,v,156,v,124
buffer_load_dwordx4 v187, s[12:15], s21 offen offset:3072 lds
s_lshl_b32 s36, s36, 3
MA 148,v,156,v,128
MA 156,v,156,v,132
v_and_b32 v252, 7, v1
MA 212,v,156,v,136
v_add_u32 v252, s36, v252
MA 220,v,156,v,140
TR 156,199,0
TR 158,199,2048
MA 32,v,160,v,112
ds_read_b128 v[96:99], v194 offset:8192
s_add_u32 m0, s23, 36864
MA 40,v,160,v,116
s_lshr_b32 s36, s2, 4
s_lshl_b32 s36, s36, 1
MA 96,v,160,v,120
s_and_b32 s37, s3, 1
MA 104,v,160,v,124
s_add_u32 s36, s36, s37
MA 160,v,160,v,128
ds_read_b128 v[100:103], v194 offset:10240
buffer_load_dwordx4 v188, s[12:15], s21 offen offset:0 lds
MA 168,v,160,v,132
s_lshl_b32 s36, s36, 3
v_lshrrev_b32 v253, 3, v1
MA 224,v,160,v,136
MA 232,v,160,v,140
TR 160,200,0
TR 162,200,2048
MA 36,v,164,v,112
buffer_load_dwordx4 v189, s[12:15], s21 offen offset:1024 lds
v_add_u32 v253, s36, v253
MA 44,v,164,v,116
ds_read_b128 v[104:107], v194 offset:12288
v_lshlrev_b32 v254, 14, v253
MA 100,v,164,v,120
v_lshl_add_u32 v254, v252, 3, v254
v_add_u32 v229, -6144, v254
MA 108,v,164,v,124
MA 164,v,164,v,128
buffer_load_dwordx4 v190, s[12:15], s21 offen offset:2048 lds
v_lshlrev_b32 v62, 5, v252
MA 172,v,164,v,132
v_lshlrev_b32 v254, 4, v253
MA 228,v,164,v,136
ds_read_b128 v[108:111], v194 offset:14336
v_sub_u32 v254, 4080, v254
MA 236,v,164,v,140
TR 164,201,0
TR 166,201,2048
MA 48,v,168,v,112
v_lshl_add_u32 v10, v252, 14, v254
MA 56,v,168,v,116
buffer_load_dwordx4 v191, s[12:15], s21 offen offset:3072 lds
v_and_b32 v252, 31, v1
MA 112,v,168,v,120
v_lshlrev_b32 v64, 4, v252
MA 120,v,168,v,124
s_lshl_b32 s36, s2, 2
MA 176,v,168,v,128
MA 184,v,168,v,132
s_add_u32 s21, s21, 524288
s_add_u32 s36, s36, s3
MA 240,v,168,v,136
s_lshl_b32 s36, s36, 1
MA 248,v,168,v,140
TR 168,202,0
TR 170,202,2048
MA 52,v,172,v,112
v_lshrrev_b32 v253, 5, v1
v_add_u32 v253, s36, v253
MA 60,v,172,v,116
s_and_b32 s21, s21, 4194303
MA 116,v,172,v,120
v_lshl_add_u32 v63, v253, 11, v64
MA 124,v,172,v,124
v_lshlrev_b32 v253, 2, v253
MA 180,v,172,v,128
v_lshl_add_u32 v11, v252, 20, v253
MA 188,v,172,v,132
MA 244,v,172,v,136
MA 252,v,172,v,140
TR 172,203,0
TR 174,203,2048
s_waitcnt lgkmcnt(2)
MA 0,v,144,v,80
s_add_u32 m0, s22, 32768
buffer_load_dwordx4 v[230:233], v63, s[92:95], 0 offen offset:0
MA 8,v,144,v,84
ds_read_b128 v[112:115], v195 offset:0
MA 64,v,144,v,88
MA 72,v,144,v,92
MA 128,v,144,v,96
buffer_load_dwordx4 v[2:5], v64, s[76:79], 0 offen offset:0
MA 136,v,144,v,100
buffer_load_dwordx4 v176, s[8:11], s20 offen offset:0 lds
MA 192,v,144,v,104
MA 200,v,144,v,108
TR 144,196,16384
TR 146,196,18432
MA 4,v,148,v,80
ds_read_b128 v[116:119], v195 offset:2048
MA 12,v,148,v,84
buffer_load_dwordx4 v[234:237], v63, s[92:95], 0 offen offset:512
MA 68,v,148,v,88
buffer_load_dwordx4 v177, s[8:11], s20 offen offset:1024 lds
MA 76,v,148,v,92
MA 132,v,148,v,96
MA 140,v,148,v,100
ds_read_b128 v[120:123], v195 offset:4096
MA 196,v,148,v,104
buffer_load_dwordx4 v[6:9], v64, s[76:79], 0 offen offset:512
MA 204,v,148,v,108
TR 148,197,16384
TR 150,197,18432
MA 16,v,152,v,80
buffer_load_dwordx4 v178, s[8:11], s20 offen offset:2048 lds
MA 24,v,152,v,84
MA 80,v,152,v,88
MA 88,v,152,v,92
buffer_load_dwordx4 v[238:241], v63, s[92:95], 0 offen offset:1024
MA 144,v,152,v,96
ds_read_b128 v[124:127], v195 offset:6144
buffer_load_dwordx4 v179, s[8:11], s20 offen offset:3072 lds
MA 152,v,152,v,100
MA 208,v,152,v,104
MA 216,v,152,v,108
TR 152,198,16384
TR 154,198,18432
MA 20,v,156,v,80
buffer_load_dwordx4 v[12:15], v64, s[76:79], 0 offen offset:1024
MA 28,v,156,v,84
s_add_u32 m0, s22, 36864
MA 84,v,156,v,88
ds_read_b128 v[128:131], v195 offset:8192
MA 92,v,156,v,92
MA 148,v,156,v,96
buffer_load_dwordx4 v[242:245], v63, s[92:95], 0 offen offset:1536
MA 156,v,156,v,100
MA 212,v,156,v,104
MA 220,v,156,v,108
TR 156,199,16384
TR 158,199,18432
MA 32,v,160,v,80
ds_read_b128 v[132:135], v195 offset:10240
buffer_load_dwordx4 v180, s[8:11], s20 offen offset:0 lds
MA 40,v,160,v,84
buffer_load_dwordx4 v[246:249], v64, s[76:79], 0 offen offset:1536
MA 96,v,160,v,88
MA 104,v,160,v,92
MA 160,v,160,v,96
buffer_load_dwordx4 v181, s[8:11], s20 offen offset:1024 lds
MA 168,v,160,v,100
MA 224,v,160,v,104
buffer_load_dwordx4 v[54:57], v62, s[96:99], 0 offen offset:0
MA 232,v,160,v,108
TR 160,200,16384
TR 162,200,18432
MA 36,v,164,v,80
ds_read_b128 v[136:139], v195 offset:12288
MA 44,v,164,v,84
buffer_load_dwordx4 v182, s[8:11], s20 offen offset:2048 lds
MA 100,v,164,v,88
buffer_load_dwordx4 v[58:61], v62, s[96:99], 0 offen offset:16
MA 108,v,164,v,92
MA 164,v,164,v,96
MA 172,v,164,v,100
ds_read_b128 v[140:143], v195 offset:14336
MA 228,v,164,v,104
buffer_load_dwordx4 v183, s[8:11], s20 offen offset:3072 lds
MA 236,v,164,v,108
TR 164,201,16384
TR 166,201,18432
MA 48,v,168,v,80
v_add_u32 v252, 0, v229
MA 56,v,168,v,84
MA 112,v,168,v,88
MA 120,v,168,v,92
s_add_u32 s20, s20, 128
MA 176,v,168,v,96
buffer_load_dwordx2 v[16:17], v252, s[84:87], 0 offen
MA 184,v,168,v,100
MA 240,v,168,v,104
MA 248,v,168,v,108
TR 168,202,16384
TR 170,202,18432
s_waitcnt lgkmcnt(15)
MA 52,v,172,v,80
s_and_b32 s20, s20, 1023
MA 60,v,172,v,84
v_add_u32 v253, 2048, v229
MA 116,v,172,v,88
MA 124,v,172,v,92
MA 180,v,172,v,96
MA 188,v,172,v,100
MA 244,v,172,v,104
MA 252,v,172,v,108
TR 172,203,16384
TR 174,203,18432
s_waitcnt lgkmcnt(2)
MA 0,v,144,v,112
MA 8,v,144,v,116
MA 64,v,144,v,120
MA 72,v,144,v,124
MA 128,v,144,v,128
MA 136,v,144,v,132
MA 192,v,144,v,136
MA 200,v,144,v,140
MA 4,v,148,v,112
MA 12,v,148,v,116
s_waitcnt vmcnt(19) lgkmcnt(0)
s_barrier
MA 68,v,148,v,120
TR 144,196,32768
TR 146,196,34816
MA 76,v,148,v,124
ds_read_b128 v[80:83], v192 offset:0
s_add_u32 m0, s23, 0
MA 132,v,148,v,128
s_and_b32 s80, s2, 7
s_lshr_b32 s81, s2, 3
MA 140,v,148,v,132
s_and_b32 s69, s81, 3
s_lshl_b32 s80, s80, 2
MA 196,v,148,v,136
buffer_load_dwordx4 v184, s[12:15], s21 offen offset:0 lds
s_add_u32 s69, s69, s80
MA 204,v,148,v,140
TR 148,197,32768
TR 150,197,34816
MA 16,v,152,v,112
ds_read_b128 v[84:87], v192 offset:2048
s_lshr_b32 s70, s81, 2
MA 24,v,152,v,116
s_lshl_b32 s80, s3, 16
s_lshl_b32 s65, s70, 18
MA 80,v,152,v,120
buffer_load_dwordx4 v185, s[12:15], s21 offen offset:1024 lds
s_sub_u32 s64, 3932160, s65
MA 88,v,152,v,124
s_add_u32 s65, s65, s80
s_add_u32 s64, s64, s80
MA 144,v,152,v,128
s_lshl_b32 s81, s69, 12
MA 152,v,152,v,132
ds_read_b128 v[88:91], v192 offset:4096
s_lshl_b32 s100, s64, 2
MA 208,v,152,v,136
s_add_u32 s100, s100, s81
MA 216,v,152,v,140
TR 152,198,32768
TR 154,198,34816
MA 20,v,156,v,112
buffer_load_dwordx4 v186, s[12:15], s21 offen offset:2048 lds
s_lshl_b32 s101, s65, 2
MA 28,v,156,v,116
s_add_u32 s101, s101, s81
s_lshl_b32 s66, s3, 17
MA 84,v,156,v,120
ds_read_b128 v[92:95], v192 offset:6144
s_lshl_b32 s81, s69, 8
MA 92,v,156,v,124
buffer_load_dwordx4 v187, s[12:15], s21 offen offset:3072 lds
s_add_u32 s66, s66, s81
MA 148,v,156,v,128
s_and_b32 s74, s2, 7
MA 156,v,156,v,132
s_lshl_b32 s74, s74, 8
MA 212,v,156,v,136
s_mov_b32 s82, s66
MA 220,v,156,v,140
TR 156,199,32768
TR 158,199,34816
MA 32,v,160,v,112
ds_read_b128 v[96:99], v192 offset:8192
s_add_u32 m0, s23, 4096
MA 40,v,160,v,116
s_lshl_b32 s66, s74, 12
s_lshl_b32 s67, s3, 13
MA 96,v,160,v,120
s_lshl_b32 s68, s3, 12
s_lshl_b32 s76, s70, 1
MA 104,v,160,v,124
s_sub_u32 s77, 32, s76
MA 160,v,160,v,128
ds_read_b128 v[100:103], v192 offset:10240
buffer_load_dwordx4 v188, s[12:15], s21 offen offset:0 lds
MA 168,v,160,v,132
s_add_u32 s76, s76, 2
s_mov_b32 s79, 0x41000000
MA 224,v,160,v,136
v_lshrrev_b32 v66, 3, v1
MA 232,v,160,v,140
TR 160,200,32768
TR 162,200,34816
MA 36,v,164,v,112
buffer_load_dwordx4 v189, s[12:15], s21 offen offset:1024 lds
v_lshlrev_b32 v66, 11, v66
MA 44,v,164,v,116
ds_read_b128 v[104:107], v192 offset:12288
v_lshrrev_b32 v67, 4, v1
MA 100,v,164,v,120
v_and_b32 v68, 7, v1
v_xor_b32 v68, v68, v67
MA 108,v,164,v,124
v_lshl_add_u32 v66, v68, 4, v66
MA 164,v,164,v,128
buffer_load_dwordx4 v190, s[12:15], s21 offen offset:2048 lds
v_xor_b32 v69, 64, v66
MA 172,v,164,v,132
v_add_u32 v208, 0, v66
MA 228,v,164,v,136
ds_read_b128 v[108:111], v192 offset:14336
v_add_u32 v209, 15360, v69
MA 236,v,164,v,140
TR 164,201,32768
TR 166,201,34816
MA 48,v,168,v,112
v_add_u32 v210, 30720, v66
v_add_u32 v211, 46080, v69
MA 56,v,168,v,116
buffer_load_dwordx4 v191, s[12:15], s21 offen offset:3072 lds
v_and_b32 v68, 15, v1
MA 112,v,168,v,120
v_lshlrev_b32 v69, 1, v67
MA 120,v,168,v,124
v_xor_b32 v68, v68, v69
MA 176,v,168,v,128
v_lshlrev_b32 v66, 13, v67
MA 184,v,168,v,132
s_add_u32 s21, s21, 524288
v_xor_b32 v69, 0, v68
MA 240,v,168,v,136
v_lshl_add_u32 v69, v69, 4, v66
MA 248,v,168,v,140
TR 168,202,32768
TR 170,202,34816
MA 52,v,172,v,112
v_add_u32 v212, 0, v69
v_xor_b32 v69, 0, v68
MA 60,v,172,v,116
s_and_b32 s21, s21, 4194303
v_lshl_add_u32 v69, v69, 4, v66
MA 116,v,172,v,120
v_add_u32 v213, 31744, v69
MA 124,v,172,v,124
v_xor_b32 v69, 8, v68
MA 180,v,172,v,128
v_lshl_add_u32 v69, v69, 4, v66
MA 188,v,172,v,132
v_add_u32 v214, 63488, v69
MA 244,v,172,v,136
MA 252,v,172,v,140
TR 172,203,32768
TR 174,203,34816
s_waitcnt lgkmcnt(2)
MA 0,v,144,v,80
s_add_u32 m0, s22, 65536
buffer_load_dwordx2 v[18:19], v253, s[84:87], 0 offen
MA 8,v,144,v,84
ds_read_b128 v[112:115], v193 offset:0
MA 64,v,144,v,88
MA 72,v,144,v,92
MA 128,v,144,v,96
v_add_u32 v254, 4096, v229
MA 136,v,144,v,100
buffer_load_dwordx4 v176, s[8:11], s20 offen offset:0 lds
MA 192,v,144,v,104
MA 200,v,144,v,108
TR 144,196,49152
TR 146,196,51200
MA 4,v,148,v,80
ds_read_b128 v[116:119], v193 offset:2048
MA 12,v,148,v,84
buffer_load_dwordx2 v[20:21], v254, s[84:87], 0 offen
MA 68,v,148,v,88
buffer_load_dwordx4 v177, s[8:11], s20 offen offset:1024 lds
MA 76,v,148,v,92
MA 132,v,148,v,96
MA 140,v,148,v,100
ds_read_b128 v[120:123], v193 offset:4096
MA 196,v,148,v,104
v_add_u32 v255, 6144, v229
MA 204,v,148,v,108
TR 148,197,49152
TR 150,197,51200
MA 16,v,152,v,80
buffer_load_dwordx4 v178, s[8:11], s20 offen offset:2048 lds
MA 24,v,152,v,84
MA 80,v,152,v,88
MA 88,v,152,v,92
buffer_load_dwordx2 v[22:23], v255, s[84:87], 0 offen
MA 144,v,152,v,96
ds_read_b128 v[124:127], v193 offset:6144
buffer_load_dwordx4 v179, s[8:11], s20 offen offset:3072 lds
MA 152,v,152,v,100
MA 208,v,152,v,104
MA 216,v,152,v,108
TR 152,198,49152
TR 154,198,51200
MA 20,v,156,v,80
buffer_load_dwordx2 v[38:39], v255, s[88:91], 0 offen
MA 28,v,156,v,84
s_add_u32 m0, s22, 69632
MA 84,v,156,v,88
ds_read_b128 v[128:131], v193 offset:8192
MA 92,v,156,v,92
MA 148,v,156,v,96
v_add_u32 v252, 8192, v229
MA 156,v,156,v,100
MA 212,v,156,v,104
MA 220,v,156,v,108
TR 156,199,49152
TR 158,199,51200
MA 32,v,160,v,80
ds_read_b128 v[132:135], v193 offset:10240
buffer_load_dwordx4 v180, s[8:11], s20 offen offset:0 lds
MA 40,v,160,v,84
buffer_load_dwordx2 v[24:25], v252, s[84:87], 0 offen
MA 96,v,160,v,88
MA 104,v,160,v,92
MA 160,v,160,v,96
buffer_load_dwordx4 v181, s[8:11], s20 offen offset:1024 lds
MA 168,v,160,v,100
MA 224,v,160,v,104
buffer_load_dwordx2 v[40:41], v252, s[88:91], 0 offen
MA 232,v,160,v,108
TR 160,200,49152
TR 162,200,51200
MA 36,v,164,v,80
ds_read_b128 v[136:139], v193 offset:12288
MA 44,v,164,v,84
buffer_load_dwordx4 v182, s[8:11], s20 offen offset:2048 lds
MA 100,v,164,v,88
v_add_u32 v253, 10240, v229
MA 108,v,164,v,92
MA 164,v,164,v,96
MA 172,v,164,v,100
ds_read_b128 v[140:143], v193 offset:14336
MA 228,v,164,v,104
buffer_load_dwordx4 v183, s[8:11], s20 offen offset:3072 lds
MA 236,v,164,v,108
TR 164,201,49152
TR 166,201,51200
MA 48,v,168,v,80
buffer_load_dwordx2 v[26:27], v253, s[84:87], 0 offen
MA 56,v,168,v,84
MA 112,v,168,v,88
MA 120,v,168,v,92
s_add_u32 s20, s20, 128
MA 176,v,168,v,96
buffer_load_dwordx2 v[42:43], v253, s[88:91], 0 offen
MA 184,v,168,v,100
MA 240,v,168,v,104
MA 248,v,168,v,108
TR 168,202,49152
TR 170,202,51200
s_waitcnt lgkmcnt(15)
MA 52,v,172,v,80
s_and_b32 s20, s20, 1023
MA 60,v,172,v,84
v_add_u32 v254, 12288, v229
MA 116,v,172,v,88
MA 124,v,172,v,92
MA 180,v,172,v,96
MA 188,v,172,v,100
MA 244,v,172,v,104
MA 252,v,172,v,108
TR 172,203,49152
TR 174,203,51200
s_waitcnt lgkmcnt(2)
MA 0,v,144,v,112
MA 8,v,144,v,116
MA 64,v,144,v,120
MA 72,v,144,v,124
MA 128,v,144,v,128
MA 136,v,144,v,132
MA 192,v,144,v,136
MA 200,v,144,v,140
MA 4,v,148,v,112
MA 12,v,148,v,116
s_waitcnt vmcnt(16) lgkmcnt(0)
s_barrier
MA 68,v,148,v,120
TR 144,196,0
TR 146,196,2048
MA 76,v,148,v,124
ds_read_b128 v[80:83], v192 offset:32768
s_add_u32 m0, s23, 32768
MA 132,v,148,v,128
v_xor_b32 v69, 8, v68
v_lshl_add_u32 v69, v69, 4, v66
MA 140,v,148,v,132
v_add_u32 v215, 95232, v69
v_and_b32 v66, 15, v1
MA 196,v,148,v,136
buffer_load_dwordx4 v184, s[12:15], s21 offen offset:0 lds
v_lshrrev_b32 v68, 1, v66
MA 204,v,148,v,140
TR 148,197,0
TR 150,197,2048
MA 16,v,152,v,112
ds_read_b128 v[84:87], v192 offset:34816
v_xor_b32 v68, v68, v67
MA 24,v,152,v,116
v_lshlrev_b32 v68, 4, v68
v_lshl_add_u32 v68, v66, 7, v68
MA 80,v,152,v,120
buffer_load_dwordx4 v185, s[12:15], s21 offen offset:1024 lds
v_add_u32 v224, s67, v68
MA 88,v,152,v,124
v_xor_b32 v225, 64, v224
v_add_u32 v226, 0x10000, v224
MA 144,v,152,v,128
v_add_u32 v227, 0x10000, v225
v_bfe_u32 v66, v1, 2, 2
MA 152,v,152,v,132
ds_read_b128 v[88:91], v192 offset:36864
v_and_b32 v68, 1, v67
MA 208,v,152,v,136
v_lshl_or_b32 v68, v68, 2, v66
MA 216,v,152,v,140
TR 152,198,0
TR 154,198,2048
MA 20,v,156,v,112
buffer_load_dwordx4 v186, s[12:15], s21 offen offset:2048 lds
v_lshl_add_u32 v66, v67, 3, v66
MA 28,v,156,v,116
v_lshlrev_b32 v66, 8, v66
v_and_b32 v69, 3, v1
MA 84,v,156,v,120
ds_read_b128 v[92:95], v192 offset:38912
v_lshl_add_u32 v66, v69, 3, v66
MA 92,v,156,v,124
buffer_load_dwordx4 v187, s[12:15], s21 offen offset:3072 lds
v_add_u32 v66, 98304, v66
MA 148,v,156,v,128
v_xor_b32 v69, 0, v68
v_lshl_add_u32 v216, v69, 5, v66
MA 156,v,156,v,132
v_xor_b32 v69, 1, v68
MA 212,v,156,v,136
v_lshl_add_u32 v217, v69, 5, v66
MA 220,v,156,v,140
TR 156,199,0
TR 158,199,2048
MA 32,v,160,v,112
ds_read_b128 v[96:99], v192 offset:40960
s_add_u32 m0, s23, 36864
MA 40,v,160,v,116
v_xor_b32 v69, 2, v68
v_lshl_add_u32 v218, v69, 5, v66
MA 96,v,160,v,120
v_xor_b32 v69, 3, v68
v_lshl_add_u32 v219, v69, 5, v66
MA 104,v,160,v,124
v_xor_b32 v69, 4, v68
v_lshl_add_u32 v220, v69, 5, v66
MA 160,v,160,v,128
ds_read_b128 v[100:103], v192 offset:43008
buffer_load_dwordx4 v188, s[12:15], s21 offen offset:0 lds
MA 168,v,160,v,132
v_xor_b32 v69, 5, v68
v_lshl_add_u32 v221, v69, 5, v66
MA 224,v,160,v,136
v_xor_b32 v69, 6, v68
MA 232,v,160,v,140
TR 160,200,0
TR 162,200,2048
MA 36,v,164,v,112
buffer_load_dwordx4 v189, s[12:15], s21 offen offset:1024 lds
v_lshl_add_u32 v222, v69, 5, v66
MA 44,v,164,v,116
ds_read_b128 v[104:107], v192 offset:45056
v_xor_b32 v69, 7, v68
MA 100,v,164,v,120
v_lshl_add_u32 v223, v69, 5, v66
s_mov_b32 s44, s32
MA 108,v,164,v,124
s_mov_b32 s45, s33
s_mov_b32 s46, 4194304
MA 164,v,164,v,128
buffer_load_dwordx4 v190, s[12:15], s21 offen offset:2048 lds
s_mov_b32 s47, 0x20000
MA 172,v,164,v,132
s_add_u32 s48, s34, s82
s_addc_u32 s49, s35, 0
MA 228,v,164,v,136
ds_read_b128 v[108:111], v192 offset:47104
MA 236,v,164,v,140
TR 164,201,0
TR 166,201,2048
MA 48,v,168,v,112
s_sub_u32 s50, 8388608, s82
s_mov_b32 s51, 0x20000
MA 56,v,168,v,116
buffer_load_dwordx4 v191, s[12:15], s21 offen offset:3072 lds
MA 112,v,168,v,120
s_add_u32 s60, s40, 33554432
s_addc_u32 s61, s41, 0
MA 120,v,168,v,124
s_mov_b32 s62, 16777216
s_mov_b32 s63, 0x20000
MA 176,v,168,v,128
s_lshl_b32 s80, s69, 19
MA 184,v,168,v,132
s_add_u32 s21, s21, 524288
MA 240,v,168,v,136
s_add_u32 s52, s40, s80
s_addc_u32 s53, s41, 0
MA 248,v,168,v,140
TR 168,202,0
TR 170,202,2048
MA 52,v,172,v,112
s_lshl_b32 s54, s77, 14
s_mov_b32 s55, 0x20000
MA 60,v,172,v,116
s_and_b32 s21, s21, 4194303
s_add_u32 s80, s80, 16760832
MA 116,v,172,v,120
s_add_u32 s56, s40, s80
s_addc_u32 s57, s41, 0
MA 124,v,172,v,124
s_add_u32 s58, s54, 16384
MA 180,v,172,v,128
s_mov_b32 s59, 0x20000
MA 188,v,172,v,132
s_load_dwordx2 s[38:39], s[0:1], 112
MA 244,v,172,v,136
MA 252,v,172,v,140
TR 172,203,0
TR 174,203,2048
s_waitcnt lgkmcnt(2)
MA 0,v,144,v,80
s_add_u32 m0, s22, 0
buffer_load_dwordx2 v[28:29], v254, s[84:87], 0 offen
MA 8,v,144,v,84
ds_read_b128 v[112:115], v193 offset:32768
MA 64,v,144,v,88
MA 72,v,144,v,92
MA 128,v,144,v,96
buffer_load_dwordx2 v[44:45], v254, s[88:91], 0 offen
MA 136,v,144,v,100
buffer_load_dwordx4 v176, s[8:11], s20 offen offset:0 lds
MA 192,v,144,v,104
MA 200,v,144,v,108
TR 144,196,16384
TR 146,196,18432
MA 4,v,148,v,80
ds_read_b128 v[116:119], v193 offset:34816
v_add_u32 v255, 14336, v229
MA 12,v,148,v,84
MA 68,v,148,v,88
buffer_load_dwordx4 v177, s[8:11], s20 offen offset:1024 lds
MA 76,v,148,v,92
MA 132,v,148,v,96
MA 140,v,148,v,100
ds_read_b128 v[120:123], v193 offset:36864
buffer_load_dwordx2 v[30:31], v255, s[84:87], 0 offen
MA 196,v,148,v,104
MA 204,v,148,v,108
TR 148,197,16384
TR 150,197,18432
MA 16,v,152,v,80
buffer_load_dwordx4 v178, s[8:11], s20 offen offset:2048 lds
MA 24,v,152,v,84
buffer_load_dwordx2 v[46:47], v255, s[88:91], 0 offen
MA 80,v,152,v,88
MA 88,v,152,v,92
MA 144,v,152,v,96
ds_read_b128 v[124:127], v193 offset:38912
buffer_load_dwordx4 v179, s[8:11], s20 offen offset:3072 lds
MA 152,v,152,v,100
MA 208,v,152,v,104
v_add_u32 v252, 16384, v229
MA 216,v,152,v,108
TR 152,198,16384
TR 154,198,18432
MA 20,v,156,v,80
MA 28,v,156,v,84
s_add_u32 m0, s22, 4096
MA 84,v,156,v,88
ds_read_b128 v[128:131], v193 offset:40960
buffer_load_dwordx2 v[32:33], v252, s[84:87], 0 offen
MA 92,v,156,v,92
MA 148,v,156,v,96
MA 156,v,156,v,100
MA 212,v,156,v,104
MA 220,v,156,v,108
TR 156,199,16384
TR 158,199,18432
MA 32,v,160,v,80
ds_read_b128 v[132:135], v193 offset:43008
buffer_load_dwordx4 v180, s[8:11], s20 offen offset:0 lds
MA 40,v,160,v,84
buffer_load_dwordx2 v[48:49], v252, s[88:91], 0 offen
MA 96,v,160,v,88
MA 104,v,160,v,92
v_add_u32 v253, 18432, v229
MA 160,v,160,v,96
buffer_load_dwordx4 v181, s[8:11], s20 offen offset:1024 lds
MA 168,v,160,v,100
MA 224,v,160,v,104
MA 232,v,160,v,108
TR 160,200,16384
TR 162,200,18432
MA 36,v,164,v,80
ds_read_b128 v[136:139], v193 offset:45056
buffer_load_dwordx2 v[34:35], v253, s[84:87], 0 offen
MA 44,v,164,v,84
buffer_load_dwordx4 v182, s[8:11], s20 offen offset:2048 lds
MA 100,v,164,v,88
MA 108,v,164,v,92
MA 164,v,164,v,96
buffer_load_dwordx2 v[50:51], v253, s[88:91], 0 offen
MA 172,v,164,v,100
ds_read_b128 v[140:143], v193 offset:47104
MA 228,v,164,v,104
buffer_load_dwordx4 v183, s[8:11], s20 offen offset:3072 lds
MA 236,v,164,v,108
TR 164,201,16384
TR 166,201,18432
MA 48,v,168,v,80
v_add_u32 v254, 20480, v229
MA 56,v,168,v,84
MA 112,v,168,v,88
MA 120,v,168,v,92
s_add_u32 s20, s20, 128
MA 176,v,168,v,96
MA 184,v,168,v,100
buffer_load_dwordx2 v[36:37], v254, s[84:87], 0 offen
MA 240,v,168,v,104
MA 248,v,168,v,108
TR 168,202,16384
TR 170,202,18432
s_waitcnt lgkmcnt(15)
MA 52,v,172,v,80
s_and_b32 s20, s20, 1023
MA 60,v,172,v,84
buffer_load_dwordx2 v[52:53], v254, s[88:91], 0 offen
MA 116,v,172,v,88
MA 124,v,172,v,92
MA 180,v,172,v,96
MA 188,v,172,v,100
MA 244,v,172,v,104
MA 252,v,172,v,108
TR 172,203,16384
TR 174,203,18432
s_waitcnt lgkmcnt(2)
MA 0,v,144,v,112
MA 8,v,144,v,116
MA 64,v,144,v,120
MA 72,v,144,v,124
MA 128,v,144,v,128
MA 136,v,144,v,132
MA 192,v,144,v,136
MA 200,v,144,v,140
MA 4,v,148,v,112
MA 12,v,148,v,116
s_waitcnt vmcnt(18) lgkmcnt(0)
s_barrier
MA 68,v,148,v,120
TR 144,196,32768
TR 146,196,34816
MA 76,v,148,v,124
ds_read_b128 v[80:83], v194 offset:0
s_add_u32 m0, s23, 0
MA 132,v,148,v,128
MA 140,v,148,v,132
MA 196,v,148,v,136
buffer_load_dwordx4 v184, s[12:15], s21 offen offset:0 lds
MA 204,v,148,v,140
TR 148,197,32768
TR 150,197,34816
MA 16,v,152,v,112
ds_read_b128 v[84:87], v194 offset:2048
MA 24,v,152,v,116
MA 80,v,152,v,120
buffer_load_dwordx4 v185, s[12:15], s21 offen offset:1024 lds
MA 88,v,152,v,124
MA 144,v,152,v,128
MA 152,v,152,v,132
ds_read_b128 v[88:91], v194 offset:4096
MA 208,v,152,v,136
MA 216,v,152,v,140
TR 152,198,32768
TR 154,198,34816
MA 20,v,156,v,112
buffer_load_dwordx4 v186, s[12:15], s21 offen offset:2048 lds
MA 28,v,156,v,116
MA 84,v,156,v,120
ds_read_b128 v[92:95], v194 offset:6144
MA 92,v,156,v,124
buffer_load_dwordx4 v187, s[12:15], s21 offen offset:3072 lds
MA 148,v,156,v,128
MA 156,v,156,v,132
MA 212,v,156,v,136
MA 220,v,156,v,140
TR 156,199,32768
TR 158,199,34816
MA 32,v,160,v,112
ds_read_b128 v[96:99], v194 offset:8192
s_add_u32 m0, s23, 4096
MA 40,v,160,v,116
MA 96,v,160,v,120
MA 104,v,160,v,124
MA 160,v,160,v,128
ds_read_b128 v[100:103], v194 offset:10240
buffer_load_dwordx4 v188, s[12:15], s21 offen offset:0 lds
MA 168,v,160,v,132
MA 224,v,160,v,136
MA 232,v,160,v,140
TR 160,200,32768
TR 162,200,34816
MA 36,v,164,v,112
buffer_load_dwordx4 v189, s[12:15], s21 offen offset:1024 lds
MA 44,v,164,v,116
ds_read_b128 v[104:107], v194 offset:12288
MA 100,v,164,v,120
MA 108,v,164,v,124
MA 164,v,164,v,128
buffer_load_dwordx4 v190, s[12:15], s21 offen offset:2048 lds
MA 172,v,164,v,132
MA 228,v,164,v,136
ds_read_b128 v[108:111], v194 offset:14336
MA 236,v,164,v,140
TR 164,201,32768
TR 166,201,34816
MA 48,v,168,v,112
MA 56,v,168,v,116
buffer_load_dwordx4 v191, s[12:15], s21 offen offset:3072 lds
MA 112,v,168,v,120
MA 120,v,168,v,124
MA 176,v,168,v,128
MA 184,v,168,v,132
s_add_u32 s21, s21, 524288
MA 240,v,168,v,136
MA 248,v,168,v,140
TR 168,202,32768
TR 170,202,34816
MA 52,v,172,v,112
MA 60,v,172,v,116
s_and_b32 s21, s21, 4194303
MA 116,v,172,v,120
MA 124,v,172,v,124
MA 180,v,172,v,128
MA 188,v,172,v,132
MA 244,v,172,v,136
MA 252,v,172,v,140
TR 172,203,32768
TR 174,203,34816
s_waitcnt lgkmcnt(2)
MA 0,v,144,v,80
s_add_u32 m0, s22, 32768
MA 8,v,144,v,84
ds_read_b128 v[112:115], v195 offset:0
MA 64,v,144,v,88
MA 72,v,144,v,92
MA 128,v,144,v,96
MA 136,v,144,v,100
buffer_load_dwordx4 v176, s[8:11], s20 offen offset:0 lds
MA 192,v,144,v,104
MA 200,v,144,v,108
TR 144,196,49152
TR 146,196,51200
MA 4,v,148,v,80
ds_read_b128 v[116:119], v195 offset:2048
MA 12,v,148,v,84
MA 68,v,148,v,88
buffer_load_dwordx4 v177, s[8:11], s20 offen offset:1024 lds
MA 76,v,148,v,92
MA 132,v,148,v,96
MA 140,v,148,v,100
ds_read_b128 v[120:123], v195 offset:4096
MA 196,v,148,v,104
MA 204,v,148,v,108
TR 148,197,49152
TR 150,197,51200
MA 16,v,152,v,80
buffer_load_dwordx4 v178, s[8:11], s20 offen offset:2048 lds
MA 24,v,152,v,84
MA 80,v,152,v,88
MA 88,v,152,v,92
MA 144,v,152,v,96
ds_read_b128 v[124:127], v195 offset:6144
buffer_load_dwordx4 v179, s[8:11], s20 offen offset:3072 lds
MA 152,v,152,v,100
MA 208,v,152,v,104
MA 216,v,152,v,108
TR 152,198,49152
TR 154,198,51200
MA 20,v,156,v,80
MA 28,v,156,v,84
s_add_u32 m0, s22, 36864
MA 84,v,156,v,88
ds_read_b128 v[128:131], v195 offset:8192
MA 92,v,156,v,92
MA 148,v,156,v,96
MA 156,v,156,v,100
MA 212,v,156,v,104
MA 220,v,156,v,108
TR 156,199,49152
TR 158,199,51200
MA 32,v,160,v,80
ds_read_b128 v[132:135], v195 offset:10240
buffer_load_dwordx4 v180, s[8:11], s20 offen offset:0 lds
MA 40,v,160,v,84
MA 96,v,160,v,88
MA 104,v,160,v,92
MA 160,v,160,v,96
buffer_load_dwordx4 v181, s[8:11], s20 offen offset:1024 lds
MA 168,v,160,v,100
MA 224,v,160,v,104
MA 232,v,160,v,108
TR 160,200,49152
TR 162,200,51200
MA 36,v,164,v,80
ds_read_b128 v[136:139], v195 offset:12288
MA 44,v,164,v,84
buffer_load_dwordx4 v182, s[8:11], s20 offen offset:2048 lds
MA 100,v,164,v,88
MA 108,v,164,v,92
MA 164,v,164,v,96
MA 172,v,164,v,100
ds_read_b128 v[140:143], v195 offset:14336
MA 228,v,164,v,104
buffer_load_dwordx4 v183, s[8:11], s20 offen offset:3072 lds
MA 236,v,164,v,108
TR 164,201,49152
TR 166,201,51200
MA 48,v,168,v,80
MA 56,v,168,v,84
MA 112,v,168,v,88
MA 120,v,168,v,92
s_add_u32 s20, s20, 128
MA 176,v,168,v,96
MA 184,v,168,v,100
MA 240,v,168,v,104
MA 248,v,168,v,108
TR 168,202,49152
TR 170,202,51200
s_waitcnt lgkmcnt(15)
MA 52,v,172,v,80
s_and_b32 s20, s20, 1023
MA 60,v,172,v,84
MA 116,v,172,v,88
MA 124,v,172,v,92
MA 180,v,172,v,96
MA 188,v,172,v,100
MA 244,v,172,v,104
MA 252,v,172,v,108
TR 172,203,49152
TR 174,203,51200
s_waitcnt lgkmcnt(2)
MA 0,v,144,v,112
MA 8,v,144,v,116
MA 64,v,144,v,120
MA 72,v,144,v,124
MA 128,v,144,v,128
MA 136,v,144,v,132
MA 192,v,144,v,136
MA 200,v,144,v,140
MA 4,v,148,v,112
MA 12,v,148,v,116
s_waitcnt vmcnt(8) lgkmcnt(0)
s_barrier
MA 68,v,148,v,120
TR 144,196,0
TR 146,196,2048
MA 76,v,148,v,124
ds_read_b128 v[80:83], v192 offset:0
s_add_u32 m0, s23, 32768
MA 132,v,148,v,128
buffer_load_dword v79, v78, s[4:7], 0 offen
MA 140,v,148,v,132
s_add_u32 s84, s40, 50331648
s_addc_u32 s85, s41, 0
MA 196,v,148,v,136
buffer_load_dwordx4 v184, s[12:15], s21 offen offset:0 lds
s_mov_b32 s86, 4194304
MA 204,v,148,v,140
TR 148,197,0
TR 150,197,2048
MA 16,v,152,v,112
ds_read_b128 v[84:87], v192 offset:2048
s_mov_b32 s87, 0x20000
MA 24,v,152,v,116
s_add_u32 s88, s40, 58720256
s_addc_u32 s89, s41, 0
MA 80,v,152,v,120
buffer_load_dwordx4 v185, s[12:15], s21 offen offset:1024 lds
s_mov_b32 s90, 8192
MA 88,v,152,v,124
s_mov_b32 s91, 0x20000
v_mov_b32 v252, 0
MA 144,v,152,v,128
v_mov_b32 v253, 0
v_dot2_f32_bf16 v252, v230, v2, v252
MA 152,v,152,v,132
ds_read_b128 v[88:91], v192 offset:4096
v_dot2_f32_bf16 v253, v231, v3, v253
MA 208,v,152,v,136
v_dot2_f32_bf16 v252, v232, v4, v252
v_dot2_f32_bf16 v253, v233, v5, v253
MA 216,v,152,v,140
TR 152,198,0
TR 154,198,2048
MA 20,v,156,v,112
buffer_load_dwordx4 v186, s[12:15], s21 offen offset:2048 lds
v_dot2_f32_bf16 v252, v234, v6, v252
MA 28,v,156,v,116
v_dot2_f32_bf16 v253, v235, v7, v253
v_dot2_f32_bf16 v252, v236, v8, v252
MA 84,v,156,v,120
ds_read_b128 v[92:95], v192 offset:6144
v_dot2_f32_bf16 v253, v237, v9, v253
MA 92,v,156,v,124
buffer_load_dwordx4 v187, s[12:15], s21 offen offset:3072 lds
v_dot2_f32_bf16 v252, v238, v12, v252
MA 148,v,156,v,128
v_dot2_f32_bf16 v253, v239, v13, v253
v_dot2_f32_bf16 v252, v240, v14, v252
MA 156,v,156,v,132
v_dot2_f32_bf16 v253, v241, v15, v253
v_dot2_f32_bf16 v252, v242, v246, v252
MA 212,v,156,v,136
v_dot2_f32_bf16 v253, v243, v247, v253
v_dot2_f32_bf16 v252, v244, v248, v252
MA 220,v,156,v,140
TR 156,199,0
TR 158,199,2048
MA 32,v,160,v,112
ds_read_b128 v[96:99], v192 offset:8192
s_add_u32 m0, s23, 36864
MA 40,v,160,v,116
v_dot2_f32_bf16 v253, v245, v249, v253
MA 96,v,160,v,120
s_nop 2
v_add_f32 v252, v252, v253
MA 104,v,160,v,124
s_nop 0
v_add_f32_dpp v252, v252, v252 row_ror:8 row_mask:0xf bank_mask:0xf
s_nop 1
v_add_f32_dpp v252, v252, v252 row_ror:4 row_mask:0xf bank_mask:0xf
MA 160,v,160,v,128
ds_read_b128 v[100:103], v192 offset:10240
buffer_load_dwordx4 v188, s[12:15], s21 offen offset:0 lds
MA 168,v,160,v,132
v_add_f32_dpp v252, v252, v252 row_ror:2 row_mask:0xf bank_mask:0xf
s_nop 1
v_add_f32_dpp v252, v252, v252 row_ror:1 row_mask:0xf bank_mask:0xf
MA 224,v,160,v,136
v_mov_b32 v253, v252
s_nop 1
v_permlane16_swap_b32 v252, v253
MA 232,v,160,v,140
TR 160,200,0
TR 162,200,2048
MA 36,v,164,v,112
buffer_load_dwordx4 v189, s[12:15], s21 offen offset:1024 lds
v_add_f32 v252, v252, v253
MA 44,v,164,v,116
ds_read_b128 v[104:107], v192 offset:12288
v_mul_f32 v252, 0xbfb8aa3b, v252
MA 100,v,164,v,120
v_exp_f32 v252, v252
MA 108,v,164,v,124
v_add_f32 v252, 1.0, v252
MA 164,v,164,v,128
buffer_load_dwordx4 v190, s[12:15], s21 offen offset:2048 lds
MA 172,v,164,v,132
v_rcp_f32 v252, v252
MA 228,v,164,v,136
ds_read_b128 v[108:111], v192 offset:14336
MA 236,v,164,v,140
TR 164,201,0
TR 166,201,2048
MA 48,v,168,v,112
s_nop 0
buffer_store_dword v252, v11, s[88:91], 0 offen sc1
MA 56,v,168,v,116
buffer_load_dwordx4 v191, s[12:15], s21 offen offset:3072 lds
v_lshlrev_b32 v2, 16, v54
MA 112,v,168,v,120
v_and_b32 v3, 0xffff0000, v54
v_lshlrev_b32 v4, 16, v55
MA 120,v,168,v,124
v_and_b32 v5, 0xffff0000, v55
v_lshlrev_b32 v6, 16, v56
MA 176,v,168,v,128
v_and_b32 v7, 0xffff0000, v56
v_lshlrev_b32 v8, 16, v57
MA 184,v,168,v,132
s_add_u32 s21, s21, 524288
v_and_b32 v9, 0xffff0000, v57
MA 240,v,168,v,136
v_lshlrev_b32 v230, 16, v16
v_and_b32 v231, 0xffff0000, v16
MA 248,v,168,v,140
TR 168,202,0
TR 170,202,2048
MA 52,v,172,v,112
v_lshlrev_b32 v232, 16, v18
v_and_b32 v233, 0xffff0000, v18
MA 60,v,172,v,116
s_and_b32 s21, s21, 4194303
v_lshlrev_b32 v234, 16, v20
MA 116,v,172,v,120
v_and_b32 v235, 0xffff0000, v20
v_lshlrev_b32 v236, 16, v22
MA 124,v,172,v,124
v_and_b32 v237, 0xffff0000, v22
v_lshlrev_b32 v238, 16, v24
MA 180,v,172,v,128
v_and_b32 v239, 0xffff0000, v24
v_lshlrev_b32 v240, 16, v26
MA 188,v,172,v,132
v_and_b32 v241, 0xffff0000, v26
v_lshlrev_b32 v242, 16, v28
MA 244,v,172,v,136
v_and_b32 v243, 0xffff0000, v28
v_lshlrev_b32 v244, 16, v30
MA 252,v,172,v,140
TR 172,203,0
TR 174,203,2048
v_and_b32 v245, 0xffff0000, v30
v_lshlrev_b32 v246, 16, v32
v_and_b32 v247, 0xffff0000, v32
v_lshlrev_b32 v248, 16, v34
v_and_b32 v249, 0xffff0000, v34
v_lshlrev_b32 v250, 16, v36
v_and_b32 v251, 0xffff0000, v36
v_lshlrev_b32 v254, 16, v38
v_and_b32 v255, 0xffff0000, v38
v_mul_f32 v62, v236, v2
v_mul_f32 v70, v237, v6
v_fmac_f32 v62, v234, v3
v_fmac_f32 v70, v235, v7
v_fmac_f32 v62, v232, v4
v_fmac_f32 v70, v233, v8
v_fmac_f32 v62, v230, v5
v_fmac_f32 v70, v231, v9
v_mul_f32 v62, v62, v254
s_waitcnt lgkmcnt(2)
MA 0,v,144,v,80
s_add_u32 s75, s64, s74
v_mul_f32 v70, v70, v255
MA 8,v,144,v,84
ds_read_b128 v[112:115], v193 offset:0
v_lshlrev_b32 v254, 16, v40
MA 64,v,144,v,88
v_and_b32 v255, 0xffff0000, v40
v_mul_f32 v63, v238, v2
MA 72,v,144,v,92
v_mul_f32 v71, v239, v6
v_fmac_f32 v63, v236, v3
MA 128,v,144,v,96
s_add_u32 m0, s67, 65536
v_fmac_f32 v71, v237, v7
MA 136,v,144,v,100
v_fmac_f32 v63, v234, v4
MA 192,v,144,v,104
v_fmac_f32 v71, v235, v8
MA 200,v,144,v,108
TR 144,196,16384
TR 146,196,18432
MA 4,v,148,v,80
ds_read_b128 v[116:119], v193 offset:2048
buffer_load_dwordx4 v208, s[44:47], s75 offen offset:0 lds
MA 12,v,148,v,84
v_fmac_f32 v63, v232, v5
v_fmac_f32 v71, v233, v9
MA 68,v,148,v,88
v_mul_f32 v63, v63, v254
v_mul_f32 v71, v71, v255
MA 76,v,148,v,92
v_lshlrev_b32 v254, 16, v42
v_and_b32 v255, 0xffff0000, v42
MA 132,v,148,v,96
v_mul_f32 v64, v240, v2
v_mul_f32 v72, v241, v6
MA 140,v,148,v,100
ds_read_b128 v[120:123], v193 offset:4096
buffer_load_dwordx4 v209, s[44:47], s75 offen offset:1024 lds
MA 196,v,148,v,104
v_fmac_f32 v64, v238, v3
v_fmac_f32 v72, v239, v7
MA 204,v,148,v,108
TR 148,197,16384
TR 150,197,18432
MA 16,v,152,v,80
v_fmac_f32 v64, v236, v4
v_fmac_f32 v72, v237, v8
MA 24,v,152,v,84
buffer_load_dwordx4 v210, s[44:47], s75 offen offset:2048 lds
v_fmac_f32 v64, v234, v5
MA 80,v,152,v,88
v_fmac_f32 v72, v235, v9
v_mul_f32 v64, v64, v254
MA 88,v,152,v,92
v_mul_f32 v72, v72, v255
v_lshlrev_b32 v254, 16, v44
MA 144,v,152,v,96
ds_read_b128 v[124:127], v193 offset:6144
v_and_b32 v255, 0xffff0000, v44
MA 152,v,152,v,100
v_mul_f32 v65, v242, v2
MA 208,v,152,v,104
buffer_load_dwordx4 v211, s[44:47], s75 offen offset:3072 lds
v_mul_f32 v73, v243, v6
MA 216,v,152,v,108
TR 152,198,16384
TR 154,198,18432
MA 20,v,156,v,80
v_fmac_f32 v65, v240, v3
v_fmac_f32 v73, v241, v7
MA 28,v,156,v,84
v_fmac_f32 v65, v238, v4
v_fmac_f32 v73, v239, v8
MA 84,v,156,v,88
ds_read_b128 v[128:131], v193 offset:8192
s_add_u32 s75, s65, s74
MA 92,v,156,v,92
v_fmac_f32 v65, v236, v5
v_fmac_f32 v73, v237, v9
MA 148,v,156,v,96
v_mul_f32 v65, v65, v254
v_mul_f32 v73, v73, v255
MA 156,v,156,v,100
v_lshlrev_b32 v254, 16, v46
MA 212,v,156,v,104
v_and_b32 v255, 0xffff0000, v46
MA 220,v,156,v,108
TR 156,199,16384
TR 158,199,18432
MA 32,v,160,v,80
ds_read_b128 v[132:135], v193 offset:10240
s_add_u32 m0, s67, 69632
MA 40,v,160,v,84
v_mul_f32 v66, v244, v2
v_mul_f32 v74, v245, v6
MA 96,v,160,v,88
v_fmac_f32 v66, v242, v3
v_fmac_f32 v74, v243, v7
MA 104,v,160,v,92
buffer_load_dwordx4 v208, s[44:47], s75 offen offset:0 lds
v_fmac_f32 v66, v240, v4
MA 160,v,160,v,96
v_fmac_f32 v74, v241, v8
v_fmac_f32 v66, v238, v5
MA 168,v,160,v,100
v_fmac_f32 v74, v239, v9
v_mul_f32 v66, v66, v254
MA 224,v,160,v,104
v_mul_f32 v74, v74, v255
v_lshlrev_b32 v254, 16, v48
MA 232,v,160,v,108
TR 160,200,16384
TR 162,200,18432
MA 36,v,164,v,80
ds_read_b128 v[136:139], v193 offset:12288
buffer_load_dwordx4 v209, s[44:47], s75 offen offset:1024 lds
MA 44,v,164,v,84
v_and_b32 v255, 0xffff0000, v48
v_mul_f32 v67, v246, v2
MA 100,v,164,v,88
v_mul_f32 v75, v247, v6
v_fmac_f32 v67, v244, v3
MA 108,v,164,v,92
v_fmac_f32 v75, v245, v7
v_fmac_f32 v67, v242, v4
MA 164,v,164,v,96
buffer_load_dwordx4 v210, s[44:47], s75 offen offset:2048 lds
v_fmac_f32 v75, v243, v8
MA 172,v,164,v,100
ds_read_b128 v[140:143], v193 offset:14336
v_fmac_f32 v67, v240, v5
MA 228,v,164,v,104
v_fmac_f32 v75, v241, v9
v_mul_f32 v67, v67, v254
MA 236,v,164,v,108
TR 164,201,16384
TR 166,201,18432
MA 48,v,168,v,80
buffer_load_dwordx4 v211, s[44:47], s75 offen offset:3072 lds
v_mul_f32 v75, v75, v255
MA 56,v,168,v,84
v_lshlrev_b32 v254, 16, v50
v_and_b32 v255, 0xffff0000, v50
MA 112,v,168,v,88
v_mul_f32 v68, v248, v2
v_mul_f32 v76, v249, v6
MA 120,v,168,v,92
v_fmac_f32 v68, v246, v3
MA 176,v,168,v,96
v_fmac_f32 v76, v247, v7
MA 184,v,168,v,100
s_add_u32 s74, s74, 128
v_fmac_f32 v68, v244, v4
MA 240,v,168,v,104
v_fmac_f32 v76, v245, v8
v_fmac_f32 v68, v242, v5
MA 248,v,168,v,108
TR 168,202,16384
TR 170,202,18432
s_waitcnt lgkmcnt(15)
MA 52,v,172,v,80
v_fmac_f32 v76, v243, v9
v_mul_f32 v68, v68, v254
MA 60,v,172,v,84
s_and_b32 s74, s74, 2047
v_mul_f32 v76, v76, v255
MA 116,v,172,v,88
v_lshlrev_b32 v254, 16, v52
v_and_b32 v255, 0xffff0000, v52
MA 124,v,172,v,92
v_mul_f32 v69, v250, v2
MA 180,v,172,v,96
v_mul_f32 v77, v251, v6
MA 188,v,172,v,100
v_fmac_f32 v69, v248, v3
MA 244,v,172,v,104
MA 252,v,172,v,108
TR 172,203,16384
TR 174,203,18432
s_waitcnt lgkmcnt(2)
MA 0,v,144,v,112
MA 8,v,144,v,116
MA 64,v,144,v,120
MA 72,v,144,v,124
MA 128,v,144,v,128
MA 136,v,144,v,132
MA 192,v,144,v,136
MA 200,v,144,v,140
MA 4,v,148,v,112
MA 12,v,148,v,116
s_waitcnt vmcnt(8) lgkmcnt(0)
s_barrier
MA 68,v,148,v,120
TR 144,196,32768
TR 146,196,34816
MA 76,v,148,v,124
ds_read_b128 v[80:83], v192 offset:32768
s_add_u32 m0, s68, 98304
MA 132,v,148,v,128
v_fmac_f32 v77, v249, v7
v_fmac_f32 v69, v246, v4
MA 140,v,148,v,132
buffer_load_dwordx4 v212, s[48:51], s66 offen offset:0 lds
v_fmac_f32 v77, v247, v8
MA 196,v,148,v,136
v_fmac_f32 v69, v244, v5
v_fmac_f32 v77, v245, v9
MA 204,v,148,v,140
TR 148,197,32768
TR 150,197,34816
MA 16,v,152,v,112
ds_read_b128 v[84:87], v192 offset:34816
v_mul_f32 v69, v69, v254
MA 24,v,152,v,116
buffer_load_dwordx4 v213, s[48:51], s66 offen offset:1024 lds
v_mul_f32 v77, v77, v255
MA 80,v,152,v,120
v_cvt_pk_bf16_f32 v12, v69, v68
v_cvt_pk_bf16_f32 v13, v67, v66
MA 88,v,152,v,124
v_cvt_pk_bf16_f32 v14, v65, v64
v_cvt_pk_bf16_f32 v15, v63, v62
MA 144,v,152,v,128
s_mov_b32 s36, 0
buffer_store_dwordx4 v[12:15], v10, s[84:87], s36 offen sc1
MA 152,v,152,v,132
ds_read_b128 v[88:91], v192 offset:36864
buffer_load_dwordx4 v214, s[48:51], s66 offen offset:2048 lds
MA 208,v,152,v,136
v_cvt_pk_bf16_f32 v54, v77, v76
v_cvt_pk_bf16_f32 v55, v75, v74
MA 216,v,152,v,140
TR 152,198,32768
TR 154,198,34816
MA 20,v,156,v,112
buffer_load_dwordx4 v215, s[48:51], s66 offen offset:3072 lds
v_cvt_pk_bf16_f32 v56, v73, v72
MA 28,v,156,v,116
v_cvt_pk_bf16_f32 v57, v71, v70
s_mov_b32 s36, 4096
MA 84,v,156,v,120
ds_read_b128 v[92:95], v192 offset:38912
buffer_store_dwordx4 v[54:57], v10, s[84:87], s36 offen sc1
MA 92,v,156,v,124
v_lshlrev_b32 v2, 16, v58
v_and_b32 v3, 0xffff0000, v58
MA 148,v,156,v,128
s_add_u32 s66, s66, 524288
v_lshlrev_b32 v4, 16, v59
MA 156,v,156,v,132
v_and_b32 v5, 0xffff0000, v59
v_lshlrev_b32 v6, 16, v60
MA 212,v,156,v,136
v_and_b32 v7, 0xffff0000, v60
v_lshlrev_b32 v8, 16, v61
MA 220,v,156,v,140
TR 156,199,32768
TR 158,199,34816
MA 32,v,160,v,112
ds_read_b128 v[96:99], v192 offset:40960
s_and_b32 s66, s66, 8388607
MA 40,v,160,v,116
v_and_b32 v9, 0xffff0000, v61
v_lshlrev_b32 v230, 16, v17
MA 96,v,160,v,120
v_and_b32 v231, 0xffff0000, v17
v_lshlrev_b32 v232, 16, v19
MA 104,v,160,v,124
v_and_b32 v233, 0xffff0000, v19
v_lshlrev_b32 v234, 16, v21
MA 160,v,160,v,128
ds_read_b128 v[100:103], v192 offset:43008
s_add_u32 m0, s68, 114688
MA 168,v,160,v,132
v_and_b32 v235, 0xffff0000, v21
v_lshlrev_b32 v236, 16, v23
MA 224,v,160,v,136
v_and_b32 v237, 0xffff0000, v23
v_lshlrev_b32 v238, 16, v25
MA 232,v,160,v,140
TR 160,200,32768
TR 162,200,34816
MA 36,v,164,v,112
buffer_load_dwordx4 v212, s[48:51], s66 offen offset:0 lds
v_and_b32 v239, 0xffff0000, v25
MA 44,v,164,v,116
ds_read_b128 v[104:107], v192 offset:45056
v_lshlrev_b32 v240, 16, v27
MA 100,v,164,v,120
v_and_b32 v241, 0xffff0000, v27
v_lshlrev_b32 v242, 16, v29
MA 108,v,164,v,124
buffer_load_dwordx4 v213, s[48:51], s66 offen offset:1024 lds
v_and_b32 v243, 0xffff0000, v29
MA 164,v,164,v,128
v_lshlrev_b32 v244, 16, v31
v_and_b32 v245, 0xffff0000, v31
MA 172,v,164,v,132
v_lshlrev_b32 v246, 16, v33
v_and_b32 v247, 0xffff0000, v33
MA 228,v,164,v,136
ds_read_b128 v[108:111], v192 offset:47104
v_lshlrev_b32 v248, 16, v35
MA 236,v,164,v,140
TR 164,201,32768
TR 166,201,34816
MA 48,v,168,v,112
buffer_load_dwordx4 v214, s[48:51], s66 offen offset:2048 lds
v_and_b32 v249, 0xffff0000, v35
MA 56,v,168,v,116
v_lshlrev_b32 v250, 16, v37
v_and_b32 v251, 0xffff0000, v37
MA 112,v,168,v,120
buffer_load_dwordx4 v215, s[48:51], s66 offen offset:3072 lds
v_lshlrev_b32 v254, 16, v39
MA 120,v,168,v,124
v_and_b32 v255, 0xffff0000, v39
v_mul_f32 v62, v236, v2
MA 176,v,168,v,128
v_mul_f32 v70, v237, v6
v_fmac_f32 v62, v234, v3
MA 184,v,168,v,132
v_fmac_f32 v70, v235, v7
v_fmac_f32 v62, v232, v4
MA 240,v,168,v,136
s_add_u32 s66, s66, 524288
v_fmac_f32 v70, v233, v8
MA 248,v,168,v,140
TR 168,202,32768
TR 170,202,34816
MA 52,v,172,v,112
v_fmac_f32 v62, v230, v5
v_fmac_f32 v70, v231, v9
MA 60,v,172,v,116
v_mul_f32 v62, v62, v254
v_mul_f32 v70, v70, v255
MA 116,v,172,v,120
s_and_b32 s66, s66, 8388607
v_lshlrev_b32 v254, 16, v41
MA 124,v,172,v,124
v_and_b32 v255, 0xffff0000, v41
v_mul_f32 v63, v238, v2
MA 180,v,172,v,128
v_mul_f32 v71, v239, v6
v_fmac_f32 v63, v236, v3
MA 188,v,172,v,132
v_fmac_f32 v71, v237, v7
v_fmac_f32 v63, v234, v4
MA 244,v,172,v,136
v_fmac_f32 v71, v235, v8
v_fmac_f32 v63, v232, v5
MA 252,v,172,v,140
TR 172,203,32768
TR 174,203,34816
v_fmac_f32 v71, v233, v9
v_mul_f32 v63, v63, v254
v_mul_f32 v71, v71, v255
v_lshlrev_b32 v254, 16, v43
v_and_b32 v255, 0xffff0000, v43
v_mul_f32 v64, v240, v2
v_mul_f32 v72, v241, v6
v_fmac_f32 v64, v238, v3
s_waitcnt lgkmcnt(2)
MA 0,v,144,v,80
s_add_u32 s75, s64, s74
v_fmac_f32 v72, v239, v7
MA 8,v,144,v,84
ds_read_b128 v[112:115], v193 offset:32768
v_fmac_f32 v64, v236, v4
MA 64,v,144,v,88
v_fmac_f32 v72, v237, v8
v_fmac_f32 v64, v234, v5
MA 72,v,144,v,92
v_fmac_f32 v72, v235, v9
v_mul_f32 v64, v64, v254
MA 128,v,144,v,96
s_add_u32 m0, s67, 0
v_mul_f32 v72, v72, v255
MA 136,v,144,v,100
v_lshlrev_b32 v254, 16, v45
v_and_b32 v255, 0xffff0000, v45
MA 192,v,144,v,104
v_mul_f32 v65, v242, v2
MA 200,v,144,v,108
TR 144,196,49152
TR 146,196,51200
MA 4,v,148,v,80
ds_read_b128 v[116:119], v193 offset:34816
buffer_load_dwordx4 v208, s[44:47], s75 offen offset:0 lds
MA 12,v,148,v,84
v_mul_f32 v73, v243, v6
v_fmac_f32 v65, v240, v3
MA 68,v,148,v,88
v_fmac_f32 v73, v241, v7
v_fmac_f32 v65, v238, v4
MA 76,v,148,v,92
v_fmac_f32 v73, v239, v8
v_fmac_f32 v65, v236, v5
MA 132,v,148,v,96
v_fmac_f32 v73, v237, v9
v_mul_f32 v65, v65, v254
MA 140,v,148,v,100
ds_read_b128 v[120:123], v193 offset:36864
buffer_load_dwordx4 v209, s[44:47], s75 offen offset:1024 lds
MA 196,v,148,v,104
v_mul_f32 v73, v73, v255
v_lshlrev_b32 v254, 16, v47
MA 204,v,148,v,108
TR 148,197,49152
TR 150,197,51200
MA 16,v,152,v,80
v_and_b32 v255, 0xffff0000, v47
v_mul_f32 v66, v244, v2
MA 24,v,152,v,84
buffer_load_dwordx4 v210, s[44:47], s75 offen offset:2048 lds
v_mul_f32 v74, v245, v6
MA 80,v,152,v,88
v_fmac_f32 v66, v242, v3
v_fmac_f32 v74, v243, v7
MA 88,v,152,v,92
v_fmac_f32 v66, v240, v4
v_fmac_f32 v74, v241, v8
MA 144,v,152,v,96
ds_read_b128 v[124:127], v193 offset:38912
v_fmac_f32 v66, v238, v5
MA 152,v,152,v,100
v_fmac_f32 v74, v239, v9
v_mul_f32 v66, v66, v254
MA 208,v,152,v,104
buffer_load_dwordx4 v211, s[44:47], s75 offen offset:3072 lds
v_mul_f32 v74, v74, v255
MA 216,v,152,v,108
TR 152,198,49152
TR 154,198,51200
MA 20,v,156,v,80
v_lshlrev_b32 v254, 16, v49
v_and_b32 v255, 0xffff0000, v49
MA 28,v,156,v,84
v_mul_f32 v67, v246, v2
v_mul_f32 v75, v247, v6
MA 84,v,156,v,88
ds_read_b128 v[128:131], v193 offset:40960
s_add_u32 s75, s65, s74
MA 92,v,156,v,92
v_fmac_f32 v67, v244, v3
v_fmac_f32 v75, v245, v7
MA 148,v,156,v,96
v_fmac_f32 v67, v242, v4
v_fmac_f32 v75, v243, v8
MA 156,v,156,v,100
v_fmac_f32 v67, v240, v5
v_fmac_f32 v75, v241, v9
MA 212,v,156,v,104
v_mul_f32 v67, v67, v254
v_mul_f32 v75, v75, v255
MA 220,v,156,v,108
TR 156,199,49152
TR 158,199,51200
MA 32,v,160,v,80
ds_read_b128 v[132:135], v193 offset:43008
s_add_u32 m0, s67, 4096
MA 40,v,160,v,84
v_lshlrev_b32 v254, 16, v51
v_and_b32 v255, 0xffff0000, v51
MA 96,v,160,v,88
v_mul_f32 v68, v248, v2
v_mul_f32 v76, v249, v6
MA 104,v,160,v,92
buffer_load_dwordx4 v208, s[44:47], s75 offen offset:0 lds
v_fmac_f32 v68, v246, v3
MA 160,v,160,v,96
v_fmac_f32 v76, v247, v7
v_fmac_f32 v68, v244, v4
MA 168,v,160,v,100
v_fmac_f32 v76, v245, v8
v_fmac_f32 v68, v242, v5
MA 224,v,160,v,104
v_fmac_f32 v76, v243, v9
v_mul_f32 v68, v68, v254
MA 232,v,160,v,108
TR 160,200,49152
TR 162,200,51200
MA 36,v,164,v,80
ds_read_b128 v[136:139], v193 offset:45056
buffer_load_dwordx4 v209, s[44:47], s75 offen offset:1024 lds
MA 44,v,164,v,84
v_mul_f32 v76, v76, v255
v_lshlrev_b32 v254, 16, v53
MA 100,v,164,v,88
v_and_b32 v255, 0xffff0000, v53
v_mul_f32 v69, v250, v2
MA 108,v,164,v,92
v_mul_f32 v77, v251, v6
v_fmac_f32 v69, v248, v3
MA 164,v,164,v,96
buffer_load_dwordx4 v210, s[44:47], s75 offen offset:2048 lds
v_fmac_f32 v77, v249, v7
MA 172,v,164,v,100
ds_read_b128 v[140:143], v193 offset:47104
v_fmac_f32 v69, v246, v4
MA 228,v,164,v,104
v_fmac_f32 v77, v247, v8
v_fmac_f32 v69, v244, v5
MA 236,v,164,v,108
TR 164,201,49152
TR 166,201,51200
MA 48,v,168,v,80
buffer_load_dwordx4 v211, s[44:47], s75 offen offset:3072 lds
v_fmac_f32 v77, v245, v9
MA 56,v,168,v,84
v_mul_f32 v69, v69, v254
v_mul_f32 v77, v77, v255
MA 112,v,168,v,88
v_cvt_pk_bf16_f32 v230, v69, v68
v_cvt_pk_bf16_f32 v231, v67, v66
MA 120,v,168,v,92
v_cvt_pk_bf16_f32 v232, v65, v64
v_cvt_pk_bf16_f32 v233, v63, v62
MA 176,v,168,v,96
s_mov_b32 s36, 8192
buffer_store_dwordx4 v[230:233], v10, s[84:87], s36 offen sc1
MA 184,v,168,v,100
s_add_u32 s74, s74, 128
v_cvt_pk_bf16_f32 v234, v77, v76
MA 240,v,168,v,104
v_cvt_pk_bf16_f32 v235, v75, v74
v_cvt_pk_bf16_f32 v236, v73, v72
MA 248,v,168,v,108
TR 168,202,49152
TR 170,202,51200
s_waitcnt lgkmcnt(15)
MA 52,v,172,v,80
v_cvt_pk_bf16_f32 v237, v71, v70
s_mov_b32 s36, 12288
MA 60,v,172,v,84
s_and_b32 s74, s74, 2047
buffer_store_dwordx4 v[234:237], v10, s[84:87], s36 offen sc1
MA 116,v,172,v,88
v_bfe_u32 v230, v1, 4, 1
v_lshlrev_b32 v230, 10, v230
MA 124,v,172,v,92
v_bfe_u32 v231, v1, 3, 1
v_lshl_add_u32 v230, v231, 8, v230
MA 180,v,172,v,96
v_and_b32 v231, 7, v1
v_lshl_add_u32 v230, v231, 4, v230
MA 188,v,172,v,100
v_lshrrev_b32 v231, 5, v1
v_lshl_add_u32 v228, v231, 9, v230
MA 244,v,172,v,104
MA 252,v,172,v,108
TR 172,203,49152
TR 174,203,51200
s_waitcnt lgkmcnt(2)
MA 0,v,144,v,112
MA 8,v,144,v,116
MA 64,v,144,v,120
MA 72,v,144,v,124
MA 128,v,144,v,128
MA 136,v,144,v,132
MA 192,v,144,v,136
MA 200,v,144,v,140
MA 4,v,148,v,112
MA 12,v,148,v,116
s_waitcnt vmcnt(15) lgkmcnt(0)
s_barrier
MA 68,v,148,v,120
ds_read_b128 v[48:51], v226 offset:0
s_add_u32 m0, s68, 131072
MA 76,v,148,v,124
MA 132,v,148,v,128
ds_read_b128 v[52:55], v226 offset:2048
buffer_load_dwordx4 v212, s[48:51], s66 offen offset:0 lds
MA 140,v,148,v,132
MA 196,v,148,v,136
ds_read_b128 v[56:59], v226 offset:4096
buffer_load_dwordx4 v213, s[48:51], s66 offen offset:1024 lds
MA 204,v,148,v,140
MA 16,v,152,v,112
ds_read_b128 v[60:63], v226 offset:6144
MA 24,v,152,v,116
buffer_load_dwordx4 v214, s[48:51], s66 offen offset:2048 lds
MA 80,v,152,v,120
TR 16,216,0
MA 88,v,152,v,124
buffer_load_dwordx4 v215, s[48:51], s66 offen offset:3072 lds
MA 144,v,152,v,128
TR 18,216,1024
MA 152,v,152,v,132
MA 208,v,152,v,136
TR 20,217,0
s_add_u32 s66, s66, 524288
MA 216,v,152,v,140
MA 20,v,156,v,112
TR 22,217,1024
s_and_b32 s66, s66, 8388607
MA 28,v,156,v,116
MA 84,v,156,v,120
TR 24,218,0
MA 92,v,156,v,124
s_add_u32 s75, s64, s74
MA 148,v,156,v,128
TR 26,218,1024
MA 156,v,156,v,132
s_add_u32 m0, s67, 32768
MA 212,v,156,v,136
TR 28,219,0
MA 220,v,156,v,140
MA 32,v,160,v,112
TR 30,219,1024
buffer_load_dwordx4 v208, s[44:47], s75 offen offset:0 lds
MA 40,v,160,v,116
MA 96,v,160,v,120
TR 32,220,0
buffer_load_dwordx4 v209, s[44:47], s75 offen offset:1024 lds
MA 104,v,160,v,124
MA 160,v,160,v,128
TR 34,220,1024
MA 168,v,160,v,132
buffer_load_dwordx4 v210, s[44:47], s75 offen offset:2048 lds
MA 224,v,160,v,136
TR 36,221,0
MA 232,v,160,v,140
buffer_load_dwordx4 v211, s[44:47], s75 offen offset:3072 lds
MA 36,v,164,v,112
TR 38,221,1024
MA 44,v,164,v,116
MA 100,v,164,v,120
TR 40,222,0
s_add_u32 s75, s65, s74
MA 108,v,164,v,124
MA 164,v,164,v,128
TR 42,222,1024
s_add_u32 m0, s67, 36864
MA 172,v,164,v,132
MA 228,v,164,v,136
TR 44,223,0
MA 236,v,164,v,140
buffer_load_dwordx4 v208, s[44:47], s75 offen offset:0 lds
MA 48,v,168,v,112
TR 46,223,1024
MA 56,v,168,v,116
buffer_load_dwordx4 v209, s[44:47], s75 offen offset:1024 lds
MA 112,v,168,v,120
MA 120,v,168,v,124
MA 176,v,168,v,128
buffer_load_dwordx4 v210, s[44:47], s75 offen offset:2048 lds
MA 184,v,168,v,132
MA 240,v,168,v,136
buffer_load_dwordx4 v211, s[44:47], s75 offen offset:3072 lds
MA 248,v,168,v,140
MA 52,v,172,v,112
MA 60,v,172,v,116
s_add_u32 s74, s74, 128
MA 116,v,172,v,120
MA 124,v,172,v,124
s_and_b32 s74, s74, 2047
MA 180,v,172,v,128
MA 188,v,172,v,132
MA 244,v,172,v,136
MA 252,v,172,v,140
s_branch L_p2
L_p1_V:
s_waitcnt lgkmcnt(14)
v_mfma_f32_16x16x32_bf16 a[0:3], v[80:83], v[144:147], 0
s_add_u32 m0, s23, 32768
s_add_u32 s25, s24, 256
v_mfma_f32_16x16x32_bf16 a[4:7], v[84:87], v[144:147], 0
ds_read_b128 v[112:115], v193 offset:0
v_mfma_f32_16x16x32_bf16 a[64:67], v[88:91], v[144:147], 0
buffer_load_dwordx4 v184, s[12:15], s21 offen offset:0 lds
s_add_u32 s26, s24, 1024
v_mfma_f32_16x16x32_bf16 a[68:71], v[92:95], v[144:147], 0
v_mfma_f32_16x16x32_bf16 a[128:131], v[96:99], v[144:147], 0
v_mfma_f32_16x16x32_bf16 a[132:135], v[100:103], v[144:147], 0
buffer_load_dwordx4 v185, s[12:15], s21 offen offset:1024 lds
s_add_u32 s27, s24, 1280
v_mfma_f32_16x16x32_bf16 a[192:195], v[104:107], v[144:147], 0
v_mfma_f32_16x16x32_bf16 a[196:199], v[108:111], v[144:147], 0
TR 144,196,16384
TR 146,196,18432
s_waitcnt lgkmcnt(15)
v_mfma_f32_16x16x32_bf16 a[8:11], v[80:83], v[148:151], 0
ds_read_b128 v[116:119], v193 offset:2048
buffer_load_dwordx4 v186, s[12:15], s21 offen offset:2048 lds
v_mfma_f32_16x16x32_bf16 a[12:15], v[84:87], v[148:151], 0
s_add_u32 s28, s24, 2048
v_mfma_f32_16x16x32_bf16 a[72:75], v[88:91], v[148:151], 0
buffer_load_dwordx4 v187, s[12:15], s21 offen offset:3072 lds
v_mfma_f32_16x16x32_bf16 a[76:79], v[92:95], v[148:151], 0
s_add_u32 s29, s24, 2304
v_mfma_f32_16x16x32_bf16 a[136:139], v[96:99], v[148:151], 0
s_add_u32 m0, s23, 36864
v_mfma_f32_16x16x32_bf16 a[140:143], v[100:103], v[148:151], 0
ds_read_b128 v[120:123], v193 offset:4096
v_mfma_f32_16x16x32_bf16 a[200:203], v[104:107], v[148:151], 0
s_add_u32 s30, s24, 3072
v_mfma_f32_16x16x32_bf16 a[204:207], v[108:111], v[148:151], 0
TR 148,197,16384
TR 150,197,18432
s_waitcnt lgkmcnt(15)
v_mfma_f32_16x16x32_bf16 a[16:19], v[80:83], v[152:155], 0
buffer_load_dwordx4 v188, s[12:15], s21 offen offset:0 lds
s_add_u32 s31, s24, 3328
v_mfma_f32_16x16x32_bf16 a[20:23], v[84:87], v[152:155], 0
v_mfma_f32_16x16x32_bf16 a[80:83], v[88:91], v[152:155], 0
buffer_load_dwordx4 v189, s[12:15], s21 offen offset:1024 lds
v_mfma_f32_16x16x32_bf16 a[84:87], v[92:95], v[152:155], 0
v_lshlrev_b32 v8, 7, v1
v_mfma_f32_16x16x32_bf16 a[144:147], v[96:99], v[152:155], 0
ds_read_b128 v[124:127], v193 offset:6144
buffer_load_dwordx4 v190, s[12:15], s21 offen offset:2048 lds
v_mfma_f32_16x16x32_bf16 a[148:151], v[100:103], v[152:155], 0
v_mfma_f32_16x16x32_bf16 a[208:211], v[104:107], v[152:155], 0
s_getpc_b64 s[4:5]
L_pcV:
v_mfma_f32_16x16x32_bf16 a[212:215], v[108:111], v[152:155], 0
TR 152,198,16384
TR 154,198,18432
v_mfma_f32_16x16x32_bf16 a[24:27], v[80:83], v[156:159], 0
buffer_load_dwordx4 v191, s[12:15], s21 offen offset:3072 lds
v_mfma_f32_16x16x32_bf16 a[28:31], v[84:87], v[156:159], 0
s_add_u32 s21, s21, 524288
s_lshr_b32 s98, s2, 3
v_mfma_f32_16x16x32_bf16 a[88:91], v[88:91], v[156:159], 0
ds_read_b128 v[128:131], v193 offset:8192
v_mfma_f32_16x16x32_bf16 a[92:95], v[92:95], v[156:159], 0
v_mfma_f32_16x16x32_bf16 a[152:155], v[96:99], v[156:159], 0
s_and_b32 s21, s21, 4194303
s_lshl_b32 s98, s98, 2
v_mfma_f32_16x16x32_bf16 a[156:159], v[100:103], v[156:159], 0
v_mfma_f32_16x16x32_bf16 a[216:219], v[104:107], v[156:159], 0
v_mfma_f32_16x16x32_bf16 a[220:223], v[108:111], v[156:159], 0
TR 156,199,16384
TR 158,199,18432
s_waitcnt lgkmcnt(15)
v_mfma_f32_16x16x32_bf16 a[32:35], v[80:83], v[160:163], 0
ds_read_b128 v[132:135], v193 offset:10240
s_add_u32 m0, s22, 32768
v_mfma_f32_16x16x32_bf16 a[36:39], v[84:87], v[160:163], 0
buffer_load_dwordx4 v176, s[8:11], s20 offen offset:0 lds
s_add_u32 s98, s98, s3
v_mfma_f32_16x16x32_bf16 a[96:99], v[88:91], v[160:163], 0
s_lshl_b32 s98, s98, 10
v_mfma_f32_16x16x32_bf16 a[100:103], v[92:95], v[160:163], 0
v_mfma_f32_16x16x32_bf16 a[160:163], v[96:99], v[160:163], 0
buffer_load_dwordx4 v177, s[8:11], s20 offen offset:1024 lds
v_and_b32 v9, 0x380, v8
v_mfma_f32_16x16x32_bf16 a[164:167], v[100:103], v[160:163], 0
v_mfma_f32_16x16x32_bf16 a[224:227], v[104:107], v[160:163], 0
buffer_load_dwordx4 v178, s[8:11], s20 offen offset:2048 lds
v_mfma_f32_16x16x32_bf16 a[228:231], v[108:111], v[160:163], 0
TR 160,200,16384
TR 162,200,18432
v_mfma_f32_16x16x32_bf16 a[40:43], v[80:83], v[164:167], 0
ds_read_b128 v[136:139], v193 offset:12288
v_add_u32 v9, s98, v9
v_mfma_f32_16x16x32_bf16 a[44:47], v[84:87], v[164:167], 0
buffer_load_dwordx4 v179, s[8:11], s20 offen offset:3072 lds
v_mfma_f32_16x16x32_bf16 a[104:107], v[88:91], v[164:167], 0
v_min_u32 v9, L_code_end - L_pcV - 4, v9
v_mfma_f32_16x16x32_bf16 a[108:111], v[92:95], v[164:167], 0
s_add_u32 m0, s22, 36864
v_mfma_f32_16x16x32_bf16 a[168:171], v[96:99], v[164:167], 0
v_mfma_f32_16x16x32_bf16 a[172:175], v[100:103], v[164:167], 0
ds_read_b128 v[140:143], v193 offset:14336
v_mov_b32 v11, s5
v_mfma_f32_16x16x32_bf16 a[232:235], v[104:107], v[164:167], 0
buffer_load_dwordx4 v180, s[8:11], s20 offen offset:0 lds
v_mfma_f32_16x16x32_bf16 a[236:239], v[108:111], v[164:167], 0
TR 164,201,16384
TR 166,201,18432
v_mfma_f32_16x16x32_bf16 a[48:51], v[80:83], v[168:171], 0
v_add_co_u32 v10, vcc, s4, v9
s_nop 1
v_addc_co_u32 v11, vcc, 0, v11, vcc
v_mfma_f32_16x16x32_bf16 a[52:55], v[84:87], v[168:171], 0
buffer_load_dwordx4 v181, s[8:11], s20 offen offset:1024 lds
v_mfma_f32_16x16x32_bf16 a[112:115], v[88:91], v[168:171], 0
v_mfma_f32_16x16x32_bf16 a[116:119], v[92:95], v[168:171], 0
buffer_load_dwordx4 v182, s[8:11], s20 offen offset:2048 lds
v_mfma_f32_16x16x32_bf16 a[176:179], v[96:99], v[168:171], 0
v_mfma_f32_16x16x32_bf16 a[180:183], v[100:103], v[168:171], 0
v_mfma_f32_16x16x32_bf16 a[240:243], v[104:107], v[168:171], 0
buffer_load_dwordx4 v183, s[8:11], s20 offen offset:3072 lds
v_mfma_f32_16x16x32_bf16 a[244:247], v[108:111], v[168:171], 0
TR 168,202,16384
TR 170,202,18432
s_waitcnt lgkmcnt(15)
v_mfma_f32_16x16x32_bf16 a[56:59], v[80:83], v[172:175], 0
s_add_u32 s20, s20, 128
v_mfma_f32_16x16x32_bf16 a[60:63], v[84:87], v[172:175], 0
v_mfma_f32_16x16x32_bf16 a[120:123], v[88:91], v[172:175], 0
v_mfma_f32_16x16x32_bf16 a[124:127], v[92:95], v[172:175], 0
s_and_b32 s20, s20, 1023
global_load_dword v79, v[10:11], off
v_mfma_f32_16x16x32_bf16 a[184:187], v[96:99], v[172:175], 0
v_mfma_f32_16x16x32_bf16 a[188:191], v[100:103], v[172:175], 0
v_mfma_f32_16x16x32_bf16 a[248:251], v[104:107], v[172:175], 0
v_mfma_f32_16x16x32_bf16 a[252:255], v[108:111], v[172:175], 0
TR 172,203,16384
TR 174,203,18432
s_waitcnt lgkmcnt(2)
MA 0,v,112,v,144
s_add_u32 m0, s22, 65536
MA 4,v,116,v,144
MA 64,v,120,v,144
MA 68,v,124,v,144
buffer_load_dwordx4 v176, s[8:11], s20 offen offset:0 lds
MA 128,v,128,v,144
MA 132,v,132,v,144
MA 192,v,136,v,144
MA 196,v,140,v,144
buffer_load_dwordx4 v177, s[8:11], s20 offen offset:1024 lds
MA 8,v,112,v,148
MA 12,v,116,v,148
MA 72,v,120,v,148
buffer_load_dwordx4 v178, s[8:11], s20 offen offset:2048 lds
MA 76,v,124,v,148
MA 136,v,128,v,148
MA 140,v,132,v,148
MA 200,v,136,v,148
buffer_load_dwordx4 v179, s[8:11], s20 offen offset:3072 lds
MA 204,v,140,v,148
MA 16,v,112,v,152
MA 20,v,116,v,152
s_add_u32 m0, s22, 69632
MA 80,v,120,v,152
MA 84,v,124,v,152
MA 144,v,128,v,152
MA 148,v,132,v,152
buffer_load_dwordx4 v180, s[8:11], s20 offen offset:0 lds
MA 208,v,136,v,152
MA 212,v,140,v,152
MA 24,v,112,v,156
MA 28,v,116,v,156
buffer_load_dwordx4 v181, s[8:11], s20 offen offset:1024 lds
MA 88,v,120,v,156
MA 92,v,124,v,156
MA 152,v,128,v,156
buffer_load_dwordx4 v182, s[8:11], s20 offen offset:2048 lds
MA 156,v,132,v,156
MA 216,v,136,v,156
MA 220,v,140,v,156
MA 32,v,112,v,160
buffer_load_dwordx4 v183, s[8:11], s20 offen offset:3072 lds
MA 36,v,116,v,160
MA 96,v,120,v,160
MA 100,v,124,v,160
s_add_u32 s20, s20, 128
MA 160,v,128,v,160
MA 164,v,132,v,160
MA 224,v,136,v,160
MA 228,v,140,v,160
s_and_b32 s20, s20, 1023
MA 40,v,112,v,164
MA 44,v,116,v,164
MA 104,v,120,v,164
MA 108,v,124,v,164
MA 168,v,128,v,164
s_waitcnt vmcnt(9) lgkmcnt(0)
s_barrier
MA 172,v,132,v,164
TR 144,196,32768
TR 146,196,34816
MA 232,v,136,v,164
ds_read_b128 v[80:83], v192 offset:32768
s_add_u32 m0, s23, 0
MA 236,v,140,v,164
TR 148,197,32768
TR 150,197,34816
MA 48,v,112,v,168
ds_read_b128 v[84:87], v192 offset:34816
ds_read_b128 v[88:91], v192 offset:36864
MA 52,v,116,v,168
TR 152,198,32768
TR 154,198,34816
MA 112,v,120,v,168
ds_read_b128 v[92:95], v192 offset:38912
ds_read_b128 v[96:99], v192 offset:40960
MA 116,v,124,v,168
TR 156,199,32768
TR 158,199,34816
MA 176,v,128,v,168
ds_read_b128 v[100:103], v192 offset:43008
ds_read_b128 v[104:107], v192 offset:45056
MA 180,v,132,v,168
TR 160,200,32768
TR 162,200,34816
MA 240,v,136,v,168
ds_read_b128 v[108:111], v192 offset:47104
buffer_load_dwordx4 v184, s[12:15], s21 offen offset:0 lds
MA 244,v,140,v,168
TR 164,201,32768
TR 166,201,34816
MA 56,v,112,v,172
buffer_load_dwordx4 v185, s[12:15], s21 offen offset:1024 lds
buffer_load_dwordx4 v186, s[12:15], s21 offen offset:2048 lds
MA 60,v,116,v,172
TR 168,202,32768
TR 170,202,34816
MA 120,v,120,v,172
buffer_load_dwordx4 v187, s[12:15], s21 offen offset:3072 lds
s_add_u32 m0, s23, 4096
MA 124,v,124,v,172
buffer_load_dwordx4 v188, s[12:15], s21 offen offset:0 lds
buffer_load_dwordx4 v189, s[12:15], s21 offen offset:1024 lds
MA 184,v,128,v,172
buffer_load_dwordx4 v190, s[12:15], s21 offen offset:2048 lds
buffer_load_dwordx4 v191, s[12:15], s21 offen offset:3072 lds
MA 188,v,132,v,172
s_add_u32 s21, s21, 524288
s_and_b32 s21, s21, 4194303
MA 248,v,136,v,172
s_load_dwordx2 s[84:85], s[0:1], 8
s_load_dwordx2 s[88:89], s[0:1], 16
MA 252,v,140,v,172
TR 172,203,32768
TR 174,203,34816
s_load_dwordx2 s[92:93], s[0:1], 0
s_load_dwordx2 s[96:97], s[0:1], 24
s_load_dwordx2 s[76:77], s[0:1], 96
s_waitcnt lgkmcnt(2)
MA 0,v,80,v,144
s_add_u32 m0, s22, 0
MA 4,v,84,v,144
ds_read_b128 v[112:115], v193 offset:32768
MA 64,v,88,v,144
s_mov_b32 s4, s34
s_mov_b32 s5, s35
MA 68,v,92,v,144
MA 128,v,96,v,144
MA 132,v,100,v,144
buffer_load_dwordx4 v176, s[8:11], s20 offen offset:0 lds
MA 192,v,104,v,144
MA 196,v,108,v,144
TR 144,196,49152
TR 146,196,51200
MA 8,v,80,v,148
ds_read_b128 v[116:119], v193 offset:34816
MA 12,v,84,v,148
s_mov_b32 s6, 8388608
s_mov_b32 s7, 0x20000
MA 72,v,88,v,148
buffer_load_dwordx4 v177, s[8:11], s20 offen offset:1024 lds
MA 76,v,92,v,148
MA 136,v,96,v,148
MA 140,v,100,v,148
ds_read_b128 v[120:123], v193 offset:36864
MA 200,v,104,v,148
MA 204,v,108,v,148
TR 148,197,49152
TR 150,197,51200
MA 16,v,80,v,152
buffer_load_dwordx4 v178, s[8:11], s20 offen offset:2048 lds
s_lshr_b32 s43, s2, 3
MA 20,v,84,v,152
MA 80,v,88,v,152
MA 84,v,92,v,152
s_lshl_b32 s43, s43, 2
MA 144,v,96,v,152
ds_read_b128 v[124:127], v193 offset:38912
buffer_load_dwordx4 v179, s[8:11], s20 offen offset:3072 lds
MA 148,v,100,v,152
MA 208,v,104,v,152
MA 212,v,108,v,152
TR 152,198,49152
TR 154,198,51200
MA 24,v,80,v,156
s_add_u32 s43, s43, s3
MA 28,v,84,v,156
s_add_u32 m0, s22, 4096
MA 88,v,88,v,156
ds_read_b128 v[128:131], v193 offset:40960
MA 92,v,92,v,156
s_lshl_b32 s43, s43, 16
MA 152,v,96,v,156
MA 156,v,100,v,156
MA 216,v,104,v,156
MA 220,v,108,v,156
TR 156,199,49152
TR 158,199,51200
MA 32,v,80,v,160
ds_read_b128 v[132:135], v193 offset:43008
buffer_load_dwordx4 v180, s[8:11], s20 offen offset:0 lds
MA 36,v,84,v,160
s_and_b32 s37, s2, 7
MA 96,v,88,v,160
s_lshl_b32 s37, s37, 10
MA 100,v,92,v,160
MA 160,v,96,v,160
buffer_load_dwordx4 v181, s[8:11], s20 offen offset:1024 lds
MA 164,v,100,v,160
MA 224,v,104,v,160
s_add_u32 s43, s43, s37
MA 228,v,108,v,160
TR 160,200,49152
TR 162,200,51200
MA 40,v,80,v,164
ds_read_b128 v[136:139], v193 offset:45056
MA 44,v,84,v,164
buffer_load_dwordx4 v182, s[8:11], s20 offen offset:2048 lds
MA 104,v,88,v,164
v_lshrrev_b32 v78, 3, v1
MA 108,v,92,v,164
MA 168,v,96,v,164
MA 172,v,100,v,164
ds_read_b128 v[140:143], v193 offset:47104
MA 232,v,104,v,164
buffer_load_dwordx4 v183, s[8:11], s20 offen offset:3072 lds
s_waitcnt vmcnt(24)
v_and_b32 v79, 7, v1
MA 236,v,108,v,164
TR 164,201,49152
TR 166,201,51200
MA 48,v,80,v,168
MA 52,v,84,v,168
MA 112,v,88,v,168
v_lshlrev_b32 v79, 7, v79
MA 116,v,92,v,168
s_add_u32 s20, s20, 128
MA 176,v,96,v,168
MA 180,v,100,v,168
MA 240,v,104,v,168
v_lshl_add_u32 v78, v78, 13, v79
MA 244,v,108,v,168
TR 168,202,49152
TR 170,202,51200
s_waitcnt lgkmcnt(15)
MA 56,v,80,v,172
s_and_b32 s20, s20, 1023
MA 60,v,84,v,172
MA 120,v,88,v,172
v_add_u32 v78, s43, v78
MA 124,v,92,v,172
MA 184,v,96,v,172
MA 188,v,100,v,172
MA 248,v,104,v,172
MA 252,v,108,v,172
TR 172,203,49152
TR 174,203,51200
s_waitcnt lgkmcnt(2)
MA 0,v,112,v,144
MA 4,v,116,v,144
MA 64,v,120,v,144
MA 68,v,124,v,144
MA 128,v,128,v,144
MA 132,v,132,v,144
MA 192,v,136,v,144
MA 196,v,140,v,144
MA 8,v,112,v,148
MA 12,v,116,v,148
s_waitcnt vmcnt(8) lgkmcnt(0)
s_barrier
MA 72,v,120,v,148
TR 144,196,0
TR 146,196,2048
MA 76,v,124,v,148
ds_read_b128 v[80:83], v194 offset:0
s_add_u32 m0, s23, 32768
MA 136,v,128,v,148
s_mov_b32 s86, 4194304
s_mov_b32 s87, 0x20000
MA 140,v,132,v,148
s_mov_b32 s90, 4194304
s_mov_b32 s91, 0x20000
MA 200,v,136,v,148
buffer_load_dwordx4 v184, s[12:15], s21 offen offset:0 lds
MA 204,v,140,v,148
TR 148,197,0
TR 150,197,2048
MA 16,v,112,v,152
ds_read_b128 v[84:87], v194 offset:2048
s_mov_b32 s94, 4194304
MA 20,v,116,v,152
s_mov_b32 s95, 0x20000
s_mov_b32 s98, 8192
MA 80,v,120,v,152
buffer_load_dwordx4 v185, s[12:15], s21 offen offset:1024 lds
s_mov_b32 s99, 0x20000
MA 84,v,124,v,152
MA 144,v,128,v,152
s_mov_b32 s78, 2048
MA 148,v,132,v,152
ds_read_b128 v[88:91], v194 offset:4096
s_mov_b32 s79, 0x20000
MA 208,v,136,v,152
s_and_b32 s36, s2, 15
MA 212,v,140,v,152
TR 152,198,0
TR 154,198,2048
MA 24,v,112,v,156
buffer_load_dwordx4 v186, s[12:15], s21 offen offset:2048 lds
s_lshl_b32 s36, s36, 1
MA 28,v,116,v,156
s_lshr_b32 s37, s3, 1
MA 88,v,120,v,156
ds_read_b128 v[92:95], v194 offset:6144
s_add_u32 s36, s36, s37
MA 92,v,124,v,156
buffer_load_dwordx4 v187, s[12:15], s21 offen offset:3072 lds
s_lshl_b32 s36, s36, 3
MA 152,v,128,v,156
MA 156,v,132,v,156
v_and_b32 v252, 7, v1
MA 216,v,136,v,156
v_add_u32 v252, s36, v252
MA 220,v,140,v,156
TR 156,199,0
TR 158,199,2048
MA 32,v,112,v,160
ds_read_b128 v[96:99], v194 offset:8192
s_add_u32 m0, s23, 36864
MA 36,v,116,v,160
s_lshr_b32 s36, s2, 4
s_lshl_b32 s36, s36, 1
MA 96,v,120,v,160
s_and_b32 s37, s3, 1
MA 100,v,124,v,160
s_add_u32 s36, s36, s37
MA 160,v,128,v,160
ds_read_b128 v[100:103], v194 offset:10240
buffer_load_dwordx4 v188, s[12:15], s21 offen offset:0 lds
MA 164,v,132,v,160
s_lshl_b32 s36, s36, 3
v_lshrrev_b32 v253, 3, v1
MA 224,v,136,v,160
MA 228,v,140,v,160
TR 160,200,0
TR 162,200,2048
MA 40,v,112,v,164
buffer_load_dwordx4 v189, s[12:15], s21 offen offset:1024 lds
v_add_u32 v253, s36, v253
MA 44,v,116,v,164
ds_read_b128 v[104:107], v194 offset:12288
v_lshlrev_b32 v254, 14, v253
MA 104,v,120,v,164
v_lshl_add_u32 v254, v252, 3, v254
v_add_u32 v229, -6144, v254
MA 108,v,124,v,164
MA 168,v,128,v,164
buffer_load_dwordx4 v190, s[12:15], s21 offen offset:2048 lds
v_lshlrev_b32 v62, 5, v252
MA 172,v,132,v,164
v_lshlrev_b32 v254, 4, v253
MA 232,v,136,v,164
ds_read_b128 v[108:111], v194 offset:14336
v_sub_u32 v254, 4080, v254
MA 236,v,140,v,164
TR 164,201,0
TR 166,201,2048
MA 48,v,112,v,168
v_lshl_add_u32 v10, v252, 14, v254
MA 52,v,116,v,168
buffer_load_dwordx4 v191, s[12:15], s21 offen offset:3072 lds
v_and_b32 v252, 31, v1
MA 112,v,120,v,168
v_lshlrev_b32 v64, 4, v252
MA 116,v,124,v,168
s_lshl_b32 s36, s2, 2
MA 176,v,128,v,168
MA 180,v,132,v,168
s_add_u32 s21, s21, 524288
s_add_u32 s36, s36, s3
MA 240,v,136,v,168
s_lshl_b32 s36, s36, 1
MA 244,v,140,v,168
TR 168,202,0
TR 170,202,2048
MA 56,v,112,v,172
v_lshrrev_b32 v253, 5, v1
v_add_u32 v253, s36, v253
MA 60,v,116,v,172
s_and_b32 s21, s21, 4194303
MA 120,v,120,v,172
v_lshl_add_u32 v63, v253, 11, v64
MA 124,v,124,v,172
v_lshlrev_b32 v253, 2, v253
MA 184,v,128,v,172
v_lshl_add_u32 v11, v252, 20, v253
MA 188,v,132,v,172
MA 248,v,136,v,172
MA 252,v,140,v,172
TR 172,203,0
TR 174,203,2048
s_waitcnt lgkmcnt(2)
MA 0,v,80,v,144
s_add_u32 m0, s22, 32768
buffer_load_dwordx4 v[230:233], v63, s[92:95], 0 offen offset:0
MA 4,v,84,v,144
ds_read_b128 v[112:115], v195 offset:0
MA 64,v,88,v,144
MA 68,v,92,v,144
MA 128,v,96,v,144
buffer_load_dwordx4 v[2:5], v64, s[76:79], 0 offen offset:0
MA 132,v,100,v,144
buffer_load_dwordx4 v176, s[8:11], s20 offen offset:0 lds
MA 192,v,104,v,144
MA 196,v,108,v,144
TR 144,196,16384
TR 146,196,18432
MA 8,v,80,v,148
ds_read_b128 v[116:119], v195 offset:2048
MA 12,v,84,v,148
buffer_load_dwordx4 v[234:237], v63, s[92:95], 0 offen offset:512
MA 72,v,88,v,148
buffer_load_dwordx4 v177, s[8:11], s20 offen offset:1024 lds
MA 76,v,92,v,148
MA 136,v,96,v,148
MA 140,v,100,v,148
ds_read_b128 v[120:123], v195 offset:4096
MA 200,v,104,v,148
buffer_load_dwordx4 v[6:9], v64, s[76:79], 0 offen offset:512
MA 204,v,108,v,148
TR 148,197,16384
TR 150,197,18432
MA 16,v,80,v,152
buffer_load_dwordx4 v178, s[8:11], s20 offen offset:2048 lds
MA 20,v,84,v,152
MA 80,v,88,v,152
MA 84,v,92,v,152
buffer_load_dwordx4 v[238:241], v63, s[92:95], 0 offen offset:1024
MA 144,v,96,v,152
ds_read_b128 v[124:127], v195 offset:6144
buffer_load_dwordx4 v179, s[8:11], s20 offen offset:3072 lds
MA 148,v,100,v,152
MA 208,v,104,v,152
MA 212,v,108,v,152
TR 152,198,16384
TR 154,198,18432
MA 24,v,80,v,156
buffer_load_dwordx4 v[12:15], v64, s[76:79], 0 offen offset:1024
MA 28,v,84,v,156
s_add_u32 m0, s22, 36864
MA 88,v,88,v,156
ds_read_b128 v[128:131], v195 offset:8192
MA 92,v,92,v,156
MA 152,v,96,v,156
buffer_load_dwordx4 v[242:245], v63, s[92:95], 0 offen offset:1536
MA 156,v,100,v,156
MA 216,v,104,v,156
MA 220,v,108,v,156
TR 156,199,16384
TR 158,199,18432
MA 32,v,80,v,160
ds_read_b128 v[132:135], v195 offset:10240
buffer_load_dwordx4 v180, s[8:11], s20 offen offset:0 lds
MA 36,v,84,v,160
buffer_load_dwordx4 v[246:249], v64, s[76:79], 0 offen offset:1536
MA 96,v,88,v,160
MA 100,v,92,v,160
MA 160,v,96,v,160
buffer_load_dwordx4 v181, s[8:11], s20 offen offset:1024 lds
MA 164,v,100,v,160
MA 224,v,104,v,160
buffer_load_dwordx4 v[54:57], v62, s[96:99], 0 offen offset:0
MA 228,v,108,v,160
TR 160,200,16384
TR 162,200,18432
MA 40,v,80,v,164
ds_read_b128 v[136:139], v195 offset:12288
MA 44,v,84,v,164
buffer_load_dwordx4 v182, s[8:11], s20 offen offset:2048 lds
MA 104,v,88,v,164
buffer_load_dwordx4 v[58:61], v62, s[96:99], 0 offen offset:16
MA 108,v,92,v,164
MA 168,v,96,v,164
MA 172,v,100,v,164
ds_read_b128 v[140:143], v195 offset:14336
MA 232,v,104,v,164
buffer_load_dwordx4 v183, s[8:11], s20 offen offset:3072 lds
MA 236,v,108,v,164
TR 164,201,16384
TR 166,201,18432
MA 48,v,80,v,168
v_add_u32 v252, 0, v229
MA 52,v,84,v,168
MA 112,v,88,v,168
MA 116,v,92,v,168
s_add_u32 s20, s20, 128
MA 176,v,96,v,168
buffer_load_dwordx2 v[16:17], v252, s[84:87], 0 offen
MA 180,v,100,v,168
MA 240,v,104,v,168
MA 244,v,108,v,168
TR 168,202,16384
TR 170,202,18432
s_waitcnt lgkmcnt(15)
MA 56,v,80,v,172
s_and_b32 s20, s20, 1023
MA 60,v,84,v,172
v_add_u32 v253, 2048, v229
MA 120,v,88,v,172
MA 124,v,92,v,172
MA 184,v,96,v,172
MA 188,v,100,v,172
MA 248,v,104,v,172
MA 252,v,108,v,172
TR 172,203,16384
TR 174,203,18432
s_waitcnt lgkmcnt(2)
MA 0,v,112,v,144
MA 4,v,116,v,144
MA 64,v,120,v,144
MA 68,v,124,v,144
MA 128,v,128,v,144
MA 132,v,132,v,144
MA 192,v,136,v,144
MA 196,v,140,v,144
MA 8,v,112,v,148
MA 12,v,116,v,148
s_waitcnt vmcnt(19) lgkmcnt(0)
s_barrier
MA 72,v,120,v,148
TR 144,196,32768
TR 146,196,34816
MA 76,v,124,v,148
ds_read_b128 v[80:83], v192 offset:0
s_add_u32 m0, s23, 0
MA 136,v,128,v,148
s_and_b32 s80, s2, 7
s_lshr_b32 s81, s2, 3
MA 140,v,132,v,148
s_and_b32 s69, s81, 3
s_lshl_b32 s80, s80, 2
MA 200,v,136,v,148
buffer_load_dwordx4 v184, s[12:15], s21 offen offset:0 lds
s_add_u32 s69, s69, s80
MA 204,v,140,v,148
TR 148,197,32768
TR 150,197,34816
MA 16,v,112,v,152
ds_read_b128 v[84:87], v192 offset:2048
s_lshr_b32 s70, s81, 2
MA 20,v,116,v,152
s_lshl_b32 s80, s3, 16
s_lshl_b32 s65, s70, 18
MA 80,v,120,v,152
buffer_load_dwordx4 v185, s[12:15], s21 offen offset:1024 lds
s_sub_u32 s64, 3932160, s65
MA 84,v,124,v,152
s_add_u32 s65, s65, s80
s_add_u32 s64, s64, s80
MA 144,v,128,v,152
s_lshl_b32 s81, s69, 12
MA 148,v,132,v,152
ds_read_b128 v[88:91], v192 offset:4096
s_lshl_b32 s100, s64, 2
MA 208,v,136,v,152
s_add_u32 s100, s100, s81
MA 212,v,140,v,152
TR 152,198,32768
TR 154,198,34816
MA 24,v,112,v,156
buffer_load_dwordx4 v186, s[12:15], s21 offen offset:2048 lds
s_lshl_b32 s101, s65, 2
MA 28,v,116,v,156
s_add_u32 s101, s101, s81
s_lshl_b32 s66, s3, 17
MA 88,v,120,v,156
ds_read_b128 v[92:95], v192 offset:6144
s_lshl_b32 s81, s69, 8
MA 92,v,124,v,156
buffer_load_dwordx4 v187, s[12:15], s21 offen offset:3072 lds
s_add_u32 s66, s66, s81
MA 152,v,128,v,156
s_and_b32 s74, s2, 7
MA 156,v,132,v,156
s_lshl_b32 s74, s74, 8
MA 216,v,136,v,156
s_mov_b32 s82, s66
MA 220,v,140,v,156
TR 156,199,32768
TR 158,199,34816
MA 32,v,112,v,160
ds_read_b128 v[96:99], v192 offset:8192
s_add_u32 m0, s23, 4096
MA 36,v,116,v,160
s_lshl_b32 s66, s74, 12
s_lshl_b32 s67, s3, 13
MA 96,v,120,v,160
s_lshl_b32 s68, s3, 12
s_lshl_b32 s76, s70, 1
MA 100,v,124,v,160
s_sub_u32 s77, 32, s76
MA 160,v,128,v,160
ds_read_b128 v[100:103], v192 offset:10240
buffer_load_dwordx4 v188, s[12:15], s21 offen offset:0 lds
MA 164,v,132,v,160
s_add_u32 s76, s76, 2
s_mov_b32 s79, 0x41000000
MA 224,v,136,v,160
v_lshrrev_b32 v66, 3, v1
MA 228,v,140,v,160
TR 160,200,32768
TR 162,200,34816
MA 40,v,112,v,164
buffer_load_dwordx4 v189, s[12:15], s21 offen offset:1024 lds
v_lshlrev_b32 v66, 11, v66
MA 44,v,116,v,164
ds_read_b128 v[104:107], v192 offset:12288
v_lshrrev_b32 v67, 4, v1
MA 104,v,120,v,164
v_and_b32 v68, 7, v1
v_xor_b32 v68, v68, v67
MA 108,v,124,v,164
v_lshl_add_u32 v66, v68, 4, v66
MA 168,v,128,v,164
buffer_load_dwordx4 v190, s[12:15], s21 offen offset:2048 lds
v_xor_b32 v69, 64, v66
MA 172,v,132,v,164
v_add_u32 v208, 0, v66
MA 232,v,136,v,164
ds_read_b128 v[108:111], v192 offset:14336
v_add_u32 v209, 15360, v69
MA 236,v,140,v,164
TR 164,201,32768
TR 166,201,34816
MA 48,v,112,v,168
v_add_u32 v210, 30720, v66
v_add_u32 v211, 46080, v69
MA 52,v,116,v,168
buffer_load_dwordx4 v191, s[12:15], s21 offen offset:3072 lds
v_and_b32 v68, 15, v1
MA 112,v,120,v,168
v_lshlrev_b32 v69, 1, v67
MA 116,v,124,v,168
v_xor_b32 v68, v68, v69
MA 176,v,128,v,168
v_lshlrev_b32 v66, 13, v67
MA 180,v,132,v,168
s_add_u32 s21, s21, 524288
v_xor_b32 v69, 0, v68
MA 240,v,136,v,168
v_lshl_add_u32 v69, v69, 4, v66
MA 244,v,140,v,168
TR 168,202,32768
TR 170,202,34816
MA 56,v,112,v,172
v_add_u32 v212, 0, v69
v_xor_b32 v69, 0, v68
MA 60,v,116,v,172
s_and_b32 s21, s21, 4194303
v_lshl_add_u32 v69, v69, 4, v66
MA 120,v,120,v,172
v_add_u32 v213, 31744, v69
MA 124,v,124,v,172
v_xor_b32 v69, 8, v68
MA 184,v,128,v,172
v_lshl_add_u32 v69, v69, 4, v66
MA 188,v,132,v,172
v_add_u32 v214, 63488, v69
MA 248,v,136,v,172
MA 252,v,140,v,172
TR 172,203,32768
TR 174,203,34816
s_waitcnt lgkmcnt(2)
MA 0,v,80,v,144
s_add_u32 m0, s22, 65536
buffer_load_dwordx2 v[18:19], v253, s[84:87], 0 offen
MA 4,v,84,v,144
ds_read_b128 v[112:115], v193 offset:0
MA 64,v,88,v,144
MA 68,v,92,v,144
MA 128,v,96,v,144
v_add_u32 v254, 4096, v229
MA 132,v,100,v,144
buffer_load_dwordx4 v176, s[8:11], s20 offen offset:0 lds
MA 192,v,104,v,144
MA 196,v,108,v,144
TR 144,196,49152
TR 146,196,51200
MA 8,v,80,v,148
ds_read_b128 v[116:119], v193 offset:2048
MA 12,v,84,v,148
buffer_load_dwordx2 v[20:21], v254, s[84:87], 0 offen
MA 72,v,88,v,148
buffer_load_dwordx4 v177, s[8:11], s20 offen offset:1024 lds
MA 76,v,92,v,148
MA 136,v,96,v,148
MA 140,v,100,v,148
ds_read_b128 v[120:123], v193 offset:4096
MA 200,v,104,v,148
v_add_u32 v255, 6144, v229
MA 204,v,108,v,148
TR 148,197,49152
TR 150,197,51200
MA 16,v,80,v,152
buffer_load_dwordx4 v178, s[8:11], s20 offen offset:2048 lds
MA 20,v,84,v,152
MA 80,v,88,v,152
MA 84,v,92,v,152
buffer_load_dwordx2 v[22:23], v255, s[84:87], 0 offen
MA 144,v,96,v,152
ds_read_b128 v[124:127], v193 offset:6144
buffer_load_dwordx4 v179, s[8:11], s20 offen offset:3072 lds
MA 148,v,100,v,152
MA 208,v,104,v,152
MA 212,v,108,v,152
TR 152,198,49152
TR 154,198,51200
MA 24,v,80,v,156
buffer_load_dwordx2 v[38:39], v255, s[88:91], 0 offen
MA 28,v,84,v,156
s_add_u32 m0, s22, 69632
MA 88,v,88,v,156
ds_read_b128 v[128:131], v193 offset:8192
MA 92,v,92,v,156
MA 152,v,96,v,156
v_add_u32 v252, 8192, v229
MA 156,v,100,v,156
MA 216,v,104,v,156
MA 220,v,108,v,156
TR 156,199,49152
TR 158,199,51200
MA 32,v,80,v,160
ds_read_b128 v[132:135], v193 offset:10240
buffer_load_dwordx4 v180, s[8:11], s20 offen offset:0 lds
MA 36,v,84,v,160
buffer_load_dwordx2 v[24:25], v252, s[84:87], 0 offen
MA 96,v,88,v,160
MA 100,v,92,v,160
MA 160,v,96,v,160
buffer_load_dwordx4 v181, s[8:11], s20 offen offset:1024 lds
MA 164,v,100,v,160
MA 224,v,104,v,160
buffer_load_dwordx2 v[40:41], v252, s[88:91], 0 offen
MA 228,v,108,v,160
TR 160,200,49152
TR 162,200,51200
MA 40,v,80,v,164
ds_read_b128 v[136:139], v193 offset:12288
MA 44,v,84,v,164
buffer_load_dwordx4 v182, s[8:11], s20 offen offset:2048 lds
MA 104,v,88,v,164
v_add_u32 v253, 10240, v229
MA 108,v,92,v,164
MA 168,v,96,v,164
MA 172,v,100,v,164
ds_read_b128 v[140:143], v193 offset:14336
MA 232,v,104,v,164
buffer_load_dwordx4 v183, s[8:11], s20 offen offset:3072 lds
MA 236,v,108,v,164
TR 164,201,49152
TR 166,201,51200
MA 48,v,80,v,168
buffer_load_dwordx2 v[26:27], v253, s[84:87], 0 offen
MA 52,v,84,v,168
MA 112,v,88,v,168
MA 116,v,92,v,168
s_add_u32 s20, s20, 128
MA 176,v,96,v,168
buffer_load_dwordx2 v[42:43], v253, s[88:91], 0 offen
MA 180,v,100,v,168
MA 240,v,104,v,168
MA 244,v,108,v,168
TR 168,202,49152
TR 170,202,51200
s_waitcnt lgkmcnt(15)
MA 56,v,80,v,172
s_and_b32 s20, s20, 1023
MA 60,v,84,v,172
v_add_u32 v254, 12288, v229
MA 120,v,88,v,172
MA 124,v,92,v,172
MA 184,v,96,v,172
MA 188,v,100,v,172
MA 248,v,104,v,172
MA 252,v,108,v,172
TR 172,203,49152
TR 174,203,51200
s_waitcnt lgkmcnt(2)
MA 0,v,112,v,144
MA 4,v,116,v,144
MA 64,v,120,v,144
MA 68,v,124,v,144
MA 128,v,128,v,144
MA 132,v,132,v,144
MA 192,v,136,v,144
MA 196,v,140,v,144
MA 8,v,112,v,148
MA 12,v,116,v,148
s_waitcnt vmcnt(16) lgkmcnt(0)
s_barrier
MA 72,v,120,v,148
TR 144,196,0
TR 146,196,2048
MA 76,v,124,v,148
ds_read_b128 v[80:83], v192 offset:32768
s_add_u32 m0, s23, 32768
MA 136,v,128,v,148
v_xor_b32 v69, 8, v68
v_lshl_add_u32 v69, v69, 4, v66
MA 140,v,132,v,148
v_add_u32 v215, 95232, v69
v_and_b32 v66, 15, v1
MA 200,v,136,v,148
buffer_load_dwordx4 v184, s[12:15], s21 offen offset:0 lds
v_lshrrev_b32 v68, 1, v66
MA 204,v,140,v,148
TR 148,197,0
TR 150,197,2048
MA 16,v,112,v,152
ds_read_b128 v[84:87], v192 offset:34816
v_xor_b32 v68, v68, v67
MA 20,v,116,v,152
v_lshlrev_b32 v68, 4, v68
v_lshl_add_u32 v68, v66, 7, v68
MA 80,v,120,v,152
buffer_load_dwordx4 v185, s[12:15], s21 offen offset:1024 lds
v_add_u32 v224, s67, v68
MA 84,v,124,v,152
v_xor_b32 v225, 64, v224
v_add_u32 v226, 0x10000, v224
MA 144,v,128,v,152
v_add_u32 v227, 0x10000, v225
v_bfe_u32 v66, v1, 2, 2
MA 148,v,132,v,152
ds_read_b128 v[88:91], v192 offset:36864
v_and_b32 v68, 1, v67
MA 208,v,136,v,152
v_lshl_or_b32 v68, v68, 2, v66
MA 212,v,140,v,152
TR 152,198,0
TR 154,198,2048
MA 24,v,112,v,156
buffer_load_dwordx4 v186, s[12:15], s21 offen offset:2048 lds
v_lshl_add_u32 v66, v67, 3, v66
MA 28,v,116,v,156
v_lshlrev_b32 v66, 8, v66
v_and_b32 v69, 3, v1
MA 88,v,120,v,156
ds_read_b128 v[92:95], v192 offset:38912
v_lshl_add_u32 v66, v69, 3, v66
MA 92,v,124,v,156
buffer_load_dwordx4 v187, s[12:15], s21 offen offset:3072 lds
v_add_u32 v66, 98304, v66
MA 152,v,128,v,156
v_xor_b32 v69, 0, v68
v_lshl_add_u32 v216, v69, 5, v66
MA 156,v,132,v,156
v_xor_b32 v69, 1, v68
MA 216,v,136,v,156
v_lshl_add_u32 v217, v69, 5, v66
MA 220,v,140,v,156
TR 156,199,0
TR 158,199,2048
MA 32,v,112,v,160
ds_read_b128 v[96:99], v192 offset:40960
s_add_u32 m0, s23, 36864
MA 36,v,116,v,160
v_xor_b32 v69, 2, v68
v_lshl_add_u32 v218, v69, 5, v66
MA 96,v,120,v,160
v_xor_b32 v69, 3, v68
v_lshl_add_u32 v219, v69, 5, v66
MA 100,v,124,v,160
v_xor_b32 v69, 4, v68
v_lshl_add_u32 v220, v69, 5, v66
MA 160,v,128,v,160
ds_read_b128 v[100:103], v192 offset:43008
buffer_load_dwordx4 v188, s[12:15], s21 offen offset:0 lds
MA 164,v,132,v,160
v_xor_b32 v69, 5, v68
v_lshl_add_u32 v221, v69, 5, v66
MA 224,v,136,v,160
v_xor_b32 v69, 6, v68
MA 228,v,140,v,160
TR 160,200,0
TR 162,200,2048
MA 40,v,112,v,164
buffer_load_dwordx4 v189, s[12:15], s21 offen offset:1024 lds
v_lshl_add_u32 v222, v69, 5, v66
MA 44,v,116,v,164
ds_read_b128 v[104:107], v192 offset:45056
v_xor_b32 v69, 7, v68
MA 104,v,120,v,164
v_lshl_add_u32 v223, v69, 5, v66
s_mov_b32 s44, s32
MA 108,v,124,v,164
s_mov_b32 s45, s33
s_mov_b32 s46, 4194304
MA 168,v,128,v,164
buffer_load_dwordx4 v190, s[12:15], s21 offen offset:2048 lds
s_mov_b32 s47, 0x20000
MA 172,v,132,v,164
s_add_u32 s48, s34, s82
s_addc_u32 s49, s35, 0
MA 232,v,136,v,164
ds_read_b128 v[108:111], v192 offset:47104
MA 236,v,140,v,164
TR 164,201,0
TR 166,201,2048
MA 48,v,112,v,168
s_sub_u32 s50, 8388608, s82
s_mov_b32 s51, 0x20000
MA 52,v,116,v,168
buffer_load_dwordx4 v191, s[12:15], s21 offen offset:3072 lds
MA 112,v,120,v,168
s_add_u32 s60, s40, 33554432
s_addc_u32 s61, s41, 0
MA 116,v,124,v,168
s_mov_b32 s62, 16777216
s_mov_b32 s63, 0x20000
MA 176,v,128,v,168
s_lshl_b32 s80, s69, 19
MA 180,v,132,v,168
s_add_u32 s21, s21, 524288
MA 240,v,136,v,168
s_add_u32 s52, s40, s80
s_addc_u32 s53, s41, 0
MA 244,v,140,v,168
TR 168,202,0
TR 170,202,2048
MA 56,v,112,v,172
s_lshl_b32 s54, s77, 14
s_mov_b32 s55, 0x20000
MA 60,v,116,v,172
s_and_b32 s21, s21, 4194303
s_add_u32 s80, s80, 16760832
MA 120,v,120,v,172
s_add_u32 s56, s40, s80
s_addc_u32 s57, s41, 0
MA 124,v,124,v,172
s_add_u32 s58, s54, 16384
MA 184,v,128,v,172
s_mov_b32 s59, 0x20000
MA 188,v,132,v,172
s_load_dwordx2 s[38:39], s[0:1], 112
MA 248,v,136,v,172
MA 252,v,140,v,172
TR 172,203,0
TR 174,203,2048
s_waitcnt lgkmcnt(2)
MA 0,v,80,v,144
s_add_u32 m0, s22, 0
buffer_load_dwordx2 v[28:29], v254, s[84:87], 0 offen
MA 4,v,84,v,144
ds_read_b128 v[112:115], v193 offset:32768
MA 64,v,88,v,144
MA 68,v,92,v,144
MA 128,v,96,v,144
buffer_load_dwordx2 v[44:45], v254, s[88:91], 0 offen
MA 132,v,100,v,144
buffer_load_dwordx4 v176, s[8:11], s20 offen offset:0 lds
MA 192,v,104,v,144
MA 196,v,108,v,144
TR 144,196,16384
TR 146,196,18432
MA 8,v,80,v,148
ds_read_b128 v[116:119], v193 offset:34816
v_add_u32 v255, 14336, v229
MA 12,v,84,v,148
MA 72,v,88,v,148
buffer_load_dwordx4 v177, s[8:11], s20 offen offset:1024 lds
MA 76,v,92,v,148
MA 136,v,96,v,148
MA 140,v,100,v,148
ds_read_b128 v[120:123], v193 offset:36864
buffer_load_dwordx2 v[30:31], v255, s[84:87], 0 offen
MA 200,v,104,v,148
MA 204,v,108,v,148
TR 148,197,16384
TR 150,197,18432
MA 16,v,80,v,152
buffer_load_dwordx4 v178, s[8:11], s20 offen offset:2048 lds
MA 20,v,84,v,152
buffer_load_dwordx2 v[46:47], v255, s[88:91], 0 offen
MA 80,v,88,v,152
MA 84,v,92,v,152
MA 144,v,96,v,152
ds_read_b128 v[124:127], v193 offset:38912
buffer_load_dwordx4 v179, s[8:11], s20 offen offset:3072 lds
MA 148,v,100,v,152
MA 208,v,104,v,152
v_add_u32 v252, 16384, v229
MA 212,v,108,v,152
TR 152,198,16384
TR 154,198,18432
MA 24,v,80,v,156
MA 28,v,84,v,156
s_add_u32 m0, s22, 4096
MA 88,v,88,v,156
ds_read_b128 v[128:131], v193 offset:40960
buffer_load_dwordx2 v[32:33], v252, s[84:87], 0 offen
MA 92,v,92,v,156
MA 152,v,96,v,156
MA 156,v,100,v,156
MA 216,v,104,v,156
MA 220,v,108,v,156
TR 156,199,16384
TR 158,199,18432
MA 32,v,80,v,160
ds_read_b128 v[132:135], v193 offset:43008
buffer_load_dwordx4 v180, s[8:11], s20 offen offset:0 lds
MA 36,v,84,v,160
buffer_load_dwordx2 v[48:49], v252, s[88:91], 0 offen
MA 96,v,88,v,160
MA 100,v,92,v,160
v_add_u32 v253, 18432, v229
MA 160,v,96,v,160
buffer_load_dwordx4 v181, s[8:11], s20 offen offset:1024 lds
MA 164,v,100,v,160
MA 224,v,104,v,160
MA 228,v,108,v,160
TR 160,200,16384
TR 162,200,18432
MA 40,v,80,v,164
ds_read_b128 v[136:139], v193 offset:45056
buffer_load_dwordx2 v[34:35], v253, s[84:87], 0 offen
MA 44,v,84,v,164
buffer_load_dwordx4 v182, s[8:11], s20 offen offset:2048 lds
MA 104,v,88,v,164
MA 108,v,92,v,164
MA 168,v,96,v,164
buffer_load_dwordx2 v[50:51], v253, s[88:91], 0 offen
MA 172,v,100,v,164
ds_read_b128 v[140:143], v193 offset:47104
MA 232,v,104,v,164
buffer_load_dwordx4 v183, s[8:11], s20 offen offset:3072 lds
MA 236,v,108,v,164
TR 164,201,16384
TR 166,201,18432
MA 48,v,80,v,168
v_add_u32 v254, 20480, v229
MA 52,v,84,v,168
MA 112,v,88,v,168
MA 116,v,92,v,168
s_add_u32 s20, s20, 128
MA 176,v,96,v,168
MA 180,v,100,v,168
buffer_load_dwordx2 v[36:37], v254, s[84:87], 0 offen
MA 240,v,104,v,168
MA 244,v,108,v,168
TR 168,202,16384
TR 170,202,18432
s_waitcnt lgkmcnt(15)
MA 56,v,80,v,172
s_and_b32 s20, s20, 1023
MA 60,v,84,v,172
buffer_load_dwordx2 v[52:53], v254, s[88:91], 0 offen
MA 120,v,88,v,172
MA 124,v,92,v,172
MA 184,v,96,v,172
MA 188,v,100,v,172
MA 248,v,104,v,172
MA 252,v,108,v,172
TR 172,203,16384
TR 174,203,18432
s_waitcnt lgkmcnt(2)
MA 0,v,112,v,144
MA 4,v,116,v,144
MA 64,v,120,v,144
MA 68,v,124,v,144
MA 128,v,128,v,144
MA 132,v,132,v,144
MA 192,v,136,v,144
MA 196,v,140,v,144
MA 8,v,112,v,148
MA 12,v,116,v,148
s_waitcnt vmcnt(18) lgkmcnt(0)
s_barrier
MA 72,v,120,v,148
TR 144,196,32768
TR 146,196,34816
MA 76,v,124,v,148
ds_read_b128 v[80:83], v194 offset:0
s_add_u32 m0, s23, 0
MA 136,v,128,v,148
MA 140,v,132,v,148
MA 200,v,136,v,148
buffer_load_dwordx4 v184, s[12:15], s21 offen offset:0 lds
MA 204,v,140,v,148
TR 148,197,32768
TR 150,197,34816
MA 16,v,112,v,152
ds_read_b128 v[84:87], v194 offset:2048
MA 20,v,116,v,152
MA 80,v,120,v,152
buffer_load_dwordx4 v185, s[12:15], s21 offen offset:1024 lds
MA 84,v,124,v,152
MA 144,v,128,v,152
MA 148,v,132,v,152
ds_read_b128 v[88:91], v194 offset:4096
MA 208,v,136,v,152
MA 212,v,140,v,152
TR 152,198,32768
TR 154,198,34816
MA 24,v,112,v,156
buffer_load_dwordx4 v186, s[12:15], s21 offen offset:2048 lds
MA 28,v,116,v,156
MA 88,v,120,v,156
ds_read_b128 v[92:95], v194 offset:6144
MA 92,v,124,v,156
buffer_load_dwordx4 v187, s[12:15], s21 offen offset:3072 lds
MA 152,v,128,v,156
MA 156,v,132,v,156
MA 216,v,136,v,156
MA 220,v,140,v,156
TR 156,199,32768
TR 158,199,34816
MA 32,v,112,v,160
ds_read_b128 v[96:99], v194 offset:8192
s_add_u32 m0, s23, 4096
MA 36,v,116,v,160
MA 96,v,120,v,160
MA 100,v,124,v,160
MA 160,v,128,v,160
ds_read_b128 v[100:103], v194 offset:10240
buffer_load_dwordx4 v188, s[12:15], s21 offen offset:0 lds
MA 164,v,132,v,160
MA 224,v,136,v,160
MA 228,v,140,v,160
TR 160,200,32768
TR 162,200,34816
MA 40,v,112,v,164
buffer_load_dwordx4 v189, s[12:15], s21 offen offset:1024 lds
MA 44,v,116,v,164
ds_read_b128 v[104:107], v194 offset:12288
MA 104,v,120,v,164
MA 108,v,124,v,164
MA 168,v,128,v,164
buffer_load_dwordx4 v190, s[12:15], s21 offen offset:2048 lds
MA 172,v,132,v,164
MA 232,v,136,v,164
ds_read_b128 v[108:111], v194 offset:14336
MA 236,v,140,v,164
TR 164,201,32768
TR 166,201,34816
MA 48,v,112,v,168
MA 52,v,116,v,168
buffer_load_dwordx4 v191, s[12:15], s21 offen offset:3072 lds
MA 112,v,120,v,168
MA 116,v,124,v,168
MA 176,v,128,v,168
MA 180,v,132,v,168
s_add_u32 s21, s21, 524288
MA 240,v,136,v,168
MA 244,v,140,v,168
TR 168,202,32768
TR 170,202,34816
MA 56,v,112,v,172
MA 60,v,116,v,172
s_and_b32 s21, s21, 4194303
MA 120,v,120,v,172
MA 124,v,124,v,172
MA 184,v,128,v,172
MA 188,v,132,v,172
MA 248,v,136,v,172
MA 252,v,140,v,172
TR 172,203,32768
TR 174,203,34816
s_waitcnt lgkmcnt(2)
MA 0,v,80,v,144
s_add_u32 m0, s22, 32768
MA 4,v,84,v,144
ds_read_b128 v[112:115], v195 offset:0
MA 64,v,88,v,144
MA 68,v,92,v,144
MA 128,v,96,v,144
MA 132,v,100,v,144
buffer_load_dwordx4 v176, s[8:11], s20 offen offset:0 lds
MA 192,v,104,v,144
MA 196,v,108,v,144
TR 144,196,49152
TR 146,196,51200
MA 8,v,80,v,148
ds_read_b128 v[116:119], v195 offset:2048
MA 12,v,84,v,148
MA 72,v,88,v,148
buffer_load_dwordx4 v177, s[8:11], s20 offen offset:1024 lds
MA 76,v,92,v,148
MA 136,v,96,v,148
MA 140,v,100,v,148
ds_read_b128 v[120:123], v195 offset:4096
MA 200,v,104,v,148
MA 204,v,108,v,148
TR 148,197,49152
TR 150,197,51200
MA 16,v,80,v,152
buffer_load_dwordx4 v178, s[8:11], s20 offen offset:2048 lds
MA 20,v,84,v,152
MA 80,v,88,v,152
MA 84,v,92,v,152
MA 144,v,96,v,152
ds_read_b128 v[124:127], v195 offset:6144
buffer_load_dwordx4 v179, s[8:11], s20 offen offset:3072 lds
MA 148,v,100,v,152
MA 208,v,104,v,152
MA 212,v,108,v,152
TR 152,198,49152
TR 154,198,51200
MA 24,v,80,v,156
MA 28,v,84,v,156
s_add_u32 m0, s22, 36864
MA 88,v,88,v,156
ds_read_b128 v[128:131], v195 offset:8192
MA 92,v,92,v,156
MA 152,v,96,v,156
MA 156,v,100,v,156
MA 216,v,104,v,156
MA 220,v,108,v,156
TR 156,199,49152
TR 158,199,51200
MA 32,v,80,v,160
ds_read_b128 v[132:135], v195 offset:10240
buffer_load_dwordx4 v180, s[8:11], s20 offen offset:0 lds
MA 36,v,84,v,160
MA 96,v,88,v,160
MA 100,v,92,v,160
MA 160,v,96,v,160
buffer_load_dwordx4 v181, s[8:11], s20 offen offset:1024 lds
MA 164,v,100,v,160
MA 224,v,104,v,160
MA 228,v,108,v,160
TR 160,200,49152
TR 162,200,51200
MA 40,v,80,v,164
ds_read_b128 v[136:139], v195 offset:12288
MA 44,v,84,v,164
buffer_load_dwordx4 v182, s[8:11], s20 offen offset:2048 lds
MA 104,v,88,v,164
MA 108,v,92,v,164
MA 168,v,96,v,164
MA 172,v,100,v,164
ds_read_b128 v[140:143], v195 offset:14336
MA 232,v,104,v,164
buffer_load_dwordx4 v183, s[8:11], s20 offen offset:3072 lds
MA 236,v,108,v,164
TR 164,201,49152
TR 166,201,51200
MA 48,v,80,v,168
MA 52,v,84,v,168
MA 112,v,88,v,168
MA 116,v,92,v,168
s_add_u32 s20, s20, 128
MA 176,v,96,v,168
MA 180,v,100,v,168
MA 240,v,104,v,168
MA 244,v,108,v,168
TR 168,202,49152
TR 170,202,51200
s_waitcnt lgkmcnt(15)
MA 56,v,80,v,172
s_and_b32 s20, s20, 1023
MA 60,v,84,v,172
MA 120,v,88,v,172
MA 124,v,92,v,172
MA 184,v,96,v,172
MA 188,v,100,v,172
MA 248,v,104,v,172
MA 252,v,108,v,172
TR 172,203,49152
TR 174,203,51200
s_waitcnt lgkmcnt(2)
MA 0,v,112,v,144
MA 4,v,116,v,144
MA 64,v,120,v,144
MA 68,v,124,v,144
MA 128,v,128,v,144
MA 132,v,132,v,144
MA 192,v,136,v,144
MA 196,v,140,v,144
MA 8,v,112,v,148
MA 12,v,116,v,148
s_waitcnt vmcnt(8) lgkmcnt(0)
s_barrier
MA 72,v,120,v,148
TR 144,196,0
TR 146,196,2048
MA 76,v,124,v,148
ds_read_b128 v[80:83], v192 offset:0
s_add_u32 m0, s23, 32768
MA 136,v,128,v,148
buffer_load_dword v79, v78, s[4:7], 0 offen
MA 140,v,132,v,148
s_add_u32 s84, s40, 50331648
s_addc_u32 s85, s41, 0
MA 200,v,136,v,148
buffer_load_dwordx4 v184, s[12:15], s21 offen offset:0 lds
s_mov_b32 s86, 4194304
MA 204,v,140,v,148
TR 148,197,0
TR 150,197,2048
MA 16,v,112,v,152
ds_read_b128 v[84:87], v192 offset:2048
s_mov_b32 s87, 0x20000
MA 20,v,116,v,152
s_add_u32 s88, s40, 58720256
s_addc_u32 s89, s41, 0
MA 80,v,120,v,152
buffer_load_dwordx4 v185, s[12:15], s21 offen offset:1024 lds
s_mov_b32 s90, 8192
MA 84,v,124,v,152
s_mov_b32 s91, 0x20000
v_mov_b32 v252, 0
MA 144,v,128,v,152
v_mov_b32 v253, 0
v_dot2_f32_bf16 v252, v230, v2, v252
MA 148,v,132,v,152
ds_read_b128 v[88:91], v192 offset:4096
v_dot2_f32_bf16 v253, v231, v3, v253
MA 208,v,136,v,152
v_dot2_f32_bf16 v252, v232, v4, v252
v_dot2_f32_bf16 v253, v233, v5, v253
MA 212,v,140,v,152
TR 152,198,0
TR 154,198,2048
MA 24,v,112,v,156
buffer_load_dwordx4 v186, s[12:15], s21 offen offset:2048 lds
v_dot2_f32_bf16 v252, v234, v6, v252
MA 28,v,116,v,156
v_dot2_f32_bf16 v253, v235, v7, v253
v_dot2_f32_bf16 v252, v236, v8, v252
MA 88,v,120,v,156
ds_read_b128 v[92:95], v192 offset:6144
v_dot2_f32_bf16 v253, v237, v9, v253
MA 92,v,124,v,156
buffer_load_dwordx4 v187, s[12:15], s21 offen offset:3072 lds
v_dot2_f32_bf16 v252, v238, v12, v252
MA 152,v,128,v,156
v_dot2_f32_bf16 v253, v239, v13, v253
v_dot2_f32_bf16 v252, v240, v14, v252
MA 156,v,132,v,156
v_dot2_f32_bf16 v253, v241, v15, v253
v_dot2_f32_bf16 v252, v242, v246, v252
MA 216,v,136,v,156
v_dot2_f32_bf16 v253, v243, v247, v253
v_dot2_f32_bf16 v252, v244, v248, v252
MA 220,v,140,v,156
TR 156,199,0
TR 158,199,2048
MA 32,v,112,v,160
ds_read_b128 v[96:99], v192 offset:8192
s_add_u32 m0, s23, 36864
MA 36,v,116,v,160
v_dot2_f32_bf16 v253, v245, v249, v253
MA 96,v,120,v,160
s_nop 2
v_add_f32 v252, v252, v253
MA 100,v,124,v,160
s_nop 0
v_add_f32_dpp v252, v252, v252 row_ror:8 row_mask:0xf bank_mask:0xf
s_nop 1
v_add_f32_dpp v252, v252, v252 row_ror:4 row_mask:0xf bank_mask:0xf
MA 160,v,128,v,160
ds_read_b128 v[100:103], v192 offset:10240
buffer_load_dwordx4 v188, s[12:15], s21 offen offset:0 lds
MA 164,v,132,v,160
v_add_f32_dpp v252, v252, v252 row_ror:2 row_mask:0xf bank_mask:0xf
s_nop 1
v_add_f32_dpp v252, v252, v252 row_ror:1 row_mask:0xf bank_mask:0xf
MA 224,v,136,v,160
v_mov_b32 v253, v252
s_nop 1
v_permlane16_swap_b32 v252, v253
MA 228,v,140,v,160
TR 160,200,0
TR 162,200,2048
MA 40,v,112,v,164
buffer_load_dwordx4 v189, s[12:15], s21 offen offset:1024 lds
v_add_f32 v252, v252, v253
MA 44,v,116,v,164
ds_read_b128 v[104:107], v192 offset:12288
v_mul_f32 v252, 0xbfb8aa3b, v252
MA 104,v,120,v,164
v_exp_f32 v252, v252
MA 108,v,124,v,164
v_add_f32 v252, 1.0, v252
MA 168,v,128,v,164
buffer_load_dwordx4 v190, s[12:15], s21 offen offset:2048 lds
MA 172,v,132,v,164
v_rcp_f32 v252, v252
MA 232,v,136,v,164
ds_read_b128 v[108:111], v192 offset:14336
MA 236,v,140,v,164
TR 164,201,0
TR 166,201,2048
MA 48,v,112,v,168
s_nop 0
buffer_store_dword v252, v11, s[88:91], 0 offen sc1
MA 52,v,116,v,168
buffer_load_dwordx4 v191, s[12:15], s21 offen offset:3072 lds
v_lshlrev_b32 v2, 16, v54
MA 112,v,120,v,168
v_and_b32 v3, 0xffff0000, v54
v_lshlrev_b32 v4, 16, v55
MA 116,v,124,v,168
v_and_b32 v5, 0xffff0000, v55
v_lshlrev_b32 v6, 16, v56
MA 176,v,128,v,168
v_and_b32 v7, 0xffff0000, v56
v_lshlrev_b32 v8, 16, v57
MA 180,v,132,v,168
s_add_u32 s21, s21, 524288
v_and_b32 v9, 0xffff0000, v57
MA 240,v,136,v,168
v_lshlrev_b32 v230, 16, v16
v_and_b32 v231, 0xffff0000, v16
MA 244,v,140,v,168
TR 168,202,0
TR 170,202,2048
MA 56,v,112,v,172
v_lshlrev_b32 v232, 16, v18
v_and_b32 v233, 0xffff0000, v18
MA 60,v,116,v,172
s_and_b32 s21, s21, 4194303
v_lshlrev_b32 v234, 16, v20
MA 120,v,120,v,172
v_and_b32 v235, 0xffff0000, v20
v_lshlrev_b32 v236, 16, v22
MA 124,v,124,v,172
v_and_b32 v237, 0xffff0000, v22
v_lshlrev_b32 v238, 16, v24
MA 184,v,128,v,172
v_and_b32 v239, 0xffff0000, v24
v_lshlrev_b32 v240, 16, v26
MA 188,v,132,v,172
v_and_b32 v241, 0xffff0000, v26
v_lshlrev_b32 v242, 16, v28
MA 248,v,136,v,172
v_and_b32 v243, 0xffff0000, v28
v_lshlrev_b32 v244, 16, v30
MA 252,v,140,v,172
TR 172,203,0
TR 174,203,2048
v_and_b32 v245, 0xffff0000, v30
v_lshlrev_b32 v246, 16, v32
v_and_b32 v247, 0xffff0000, v32
v_lshlrev_b32 v248, 16, v34
v_and_b32 v249, 0xffff0000, v34
v_lshlrev_b32 v250, 16, v36
v_and_b32 v251, 0xffff0000, v36
v_lshlrev_b32 v254, 16, v38
v_and_b32 v255, 0xffff0000, v38
v_mul_f32 v62, v236, v2
v_mul_f32 v70, v237, v6
v_fmac_f32 v62, v234, v3
v_fmac_f32 v70, v235, v7
v_fmac_f32 v62, v232, v4
v_fmac_f32 v70, v233, v8
v_fmac_f32 v62, v230, v5
v_fmac_f32 v70, v231, v9
v_mul_f32 v62, v62, v254
s_waitcnt lgkmcnt(2)
MA 0,v,80,v,144
s_add_u32 s75, s64, s74
v_mul_f32 v70, v70, v255
MA 4,v,84,v,144
ds_read_b128 v[112:115], v193 offset:0
v_lshlrev_b32 v254, 16, v40
MA 64,v,88,v,144
v_and_b32 v255, 0xffff0000, v40
v_mul_f32 v63, v238, v2
MA 68,v,92,v,144
v_mul_f32 v71, v239, v6
v_fmac_f32 v63, v236, v3
MA 128,v,96,v,144
s_add_u32 m0, s67, 65536
v_fmac_f32 v71, v237, v7
MA 132,v,100,v,144
v_fmac_f32 v63, v234, v4
MA 192,v,104,v,144
v_fmac_f32 v71, v235, v8
MA 196,v,108,v,144
TR 144,196,16384
TR 146,196,18432
MA 8,v,80,v,148
ds_read_b128 v[116:119], v193 offset:2048
buffer_load_dwordx4 v208, s[44:47], s75 offen offset:0 lds
MA 12,v,84,v,148
v_fmac_f32 v63, v232, v5
v_fmac_f32 v71, v233, v9
MA 72,v,88,v,148
v_mul_f32 v63, v63, v254
v_mul_f32 v71, v71, v255
MA 76,v,92,v,148
v_lshlrev_b32 v254, 16, v42
v_and_b32 v255, 0xffff0000, v42
MA 136,v,96,v,148
v_mul_f32 v64, v240, v2
v_mul_f32 v72, v241, v6
MA 140,v,100,v,148
ds_read_b128 v[120:123], v193 offset:4096
buffer_load_dwordx4 v209, s[44:47], s75 offen offset:1024 lds
MA 200,v,104,v,148
v_fmac_f32 v64, v238, v3
v_fmac_f32 v72, v239, v7
MA 204,v,108,v,148
TR 148,197,16384
TR 150,197,18432
MA 16,v,80,v,152
v_fmac_f32 v64, v236, v4
v_fmac_f32 v72, v237, v8
MA 20,v,84,v,152
buffer_load_dwordx4 v210, s[44:47], s75 offen offset:2048 lds
v_fmac_f32 v64, v234, v5
MA 80,v,88,v,152
v_fmac_f32 v72, v235, v9
v_mul_f32 v64, v64, v254
MA 84,v,92,v,152
v_mul_f32 v72, v72, v255
v_lshlrev_b32 v254, 16, v44
MA 144,v,96,v,152
ds_read_b128 v[124:127], v193 offset:6144
v_and_b32 v255, 0xffff0000, v44
MA 148,v,100,v,152
v_mul_f32 v65, v242, v2
MA 208,v,104,v,152
buffer_load_dwordx4 v211, s[44:47], s75 offen offset:3072 lds
v_mul_f32 v73, v243, v6
MA 212,v,108,v,152
TR 152,198,16384
TR 154,198,18432
MA 24,v,80,v,156
v_fmac_f32 v65, v240, v3
v_fmac_f32 v73, v241, v7
MA 28,v,84,v,156
v_fmac_f32 v65, v238, v4
v_fmac_f32 v73, v239, v8
MA 88,v,88,v,156
ds_read_b128 v[128:131], v193 offset:8192
s_add_u32 s75, s65, s74
MA 92,v,92,v,156
v_fmac_f32 v65, v236, v5
v_fmac_f32 v73, v237, v9
MA 152,v,96,v,156
v_mul_f32 v65, v65, v254
v_mul_f32 v73, v73, v255
MA 156,v,100,v,156
v_lshlrev_b32 v254, 16, v46
MA 216,v,104,v,156
v_and_b32 v255, 0xffff0000, v46
MA 220,v,108,v,156
TR 156,199,16384
TR 158,199,18432
MA 32,v,80,v,160
ds_read_b128 v[132:135], v193 offset:10240
s_add_u32 m0, s67, 69632
MA 36,v,84,v,160
v_mul_f32 v66, v244, v2
v_mul_f32 v74, v245, v6
MA 96,v,88,v,160
v_fmac_f32 v66, v242, v3
v_fmac_f32 v74, v243, v7
MA 100,v,92,v,160
buffer_load_dwordx4 v208, s[44:47], s75 offen offset:0 lds
v_fmac_f32 v66, v240, v4
MA 160,v,96,v,160
v_fmac_f32 v74, v241, v8
v_fmac_f32 v66, v238, v5
MA 164,v,100,v,160
v_fmac_f32 v74, v239, v9
v_mul_f32 v66, v66, v254
MA 224,v,104,v,160
v_mul_f32 v74, v74, v255
v_lshlrev_b32 v254, 16, v48
MA 228,v,108,v,160
TR 160,200,16384
TR 162,200,18432
MA 40,v,80,v,164
ds_read_b128 v[136:139], v193 offset:12288
buffer_load_dwordx4 v209, s[44:47], s75 offen offset:1024 lds
MA 44,v,84,v,164
v_and_b32 v255, 0xffff0000, v48
v_mul_f32 v67, v246, v2
MA 104,v,88,v,164
v_mul_f32 v75, v247, v6
v_fmac_f32 v67, v244, v3
MA 108,v,92,v,164
v_fmac_f32 v75, v245, v7
v_fmac_f32 v67, v242, v4
MA 168,v,96,v,164
buffer_load_dwordx4 v210, s[44:47], s75 offen offset:2048 lds
v_fmac_f32 v75, v243, v8
MA 172,v,100,v,164
ds_read_b128 v[140:143], v193 offset:14336
v_fmac_f32 v67, v240, v5
MA 232,v,104,v,164
v_fmac_f32 v75, v241, v9
v_mul_f32 v67, v67, v254
MA 236,v,108,v,164
TR 164,201,16384
TR 166,201,18432
MA 48,v,80,v,168
buffer_load_dwordx4 v211, s[44:47], s75 offen offset:3072 lds
v_mul_f32 v75, v75, v255
MA 52,v,84,v,168
v_lshlrev_b32 v254, 16, v50
v_and_b32 v255, 0xffff0000, v50
MA 112,v,88,v,168
v_mul_f32 v68, v248, v2
v_mul_f32 v76, v249, v6
MA 116,v,92,v,168
v_fmac_f32 v68, v246, v3
MA 176,v,96,v,168
v_fmac_f32 v76, v247, v7
MA 180,v,100,v,168
s_add_u32 s74, s74, 128
v_fmac_f32 v68, v244, v4
MA 240,v,104,v,168
v_fmac_f32 v76, v245, v8
v_fmac_f32 v68, v242, v5
MA 244,v,108,v,168
TR 168,202,16384
TR 170,202,18432
s_waitcnt lgkmcnt(15)
MA 56,v,80,v,172
v_fmac_f32 v76, v243, v9
v_mul_f32 v68, v68, v254
MA 60,v,84,v,172
s_and_b32 s74, s74, 2047
v_mul_f32 v76, v76, v255
MA 120,v,88,v,172
v_lshlrev_b32 v254, 16, v52
v_and_b32 v255, 0xffff0000, v52
MA 124,v,92,v,172
v_mul_f32 v69, v250, v2
MA 184,v,96,v,172
v_mul_f32 v77, v251, v6
MA 188,v,100,v,172
v_fmac_f32 v69, v248, v3
MA 248,v,104,v,172
MA 252,v,108,v,172
TR 172,203,16384
TR 174,203,18432
s_waitcnt lgkmcnt(2)
MA 0,v,112,v,144
MA 4,v,116,v,144
MA 64,v,120,v,144
MA 68,v,124,v,144
MA 128,v,128,v,144
MA 132,v,132,v,144
MA 192,v,136,v,144
MA 196,v,140,v,144
MA 8,v,112,v,148
MA 12,v,116,v,148
s_waitcnt vmcnt(8) lgkmcnt(0)
s_barrier
MA 72,v,120,v,148
TR 144,196,32768
TR 146,196,34816
MA 76,v,124,v,148
ds_read_b128 v[80:83], v192 offset:32768
s_add_u32 m0, s68, 98304
MA 136,v,128,v,148
v_fmac_f32 v77, v249, v7
v_fmac_f32 v69, v246, v4
MA 140,v,132,v,148
buffer_load_dwordx4 v212, s[48:51], s66 offen offset:0 lds
v_fmac_f32 v77, v247, v8
MA 200,v,136,v,148
v_fmac_f32 v69, v244, v5
v_fmac_f32 v77, v245, v9
MA 204,v,140,v,148
TR 148,197,32768
TR 150,197,34816
MA 16,v,112,v,152
ds_read_b128 v[84:87], v192 offset:34816
v_mul_f32 v69, v69, v254
MA 20,v,116,v,152
buffer_load_dwordx4 v213, s[48:51], s66 offen offset:1024 lds
v_mul_f32 v77, v77, v255
MA 80,v,120,v,152
v_cvt_pk_bf16_f32 v12, v69, v68
v_cvt_pk_bf16_f32 v13, v67, v66
MA 84,v,124,v,152
v_cvt_pk_bf16_f32 v14, v65, v64
v_cvt_pk_bf16_f32 v15, v63, v62
MA 144,v,128,v,152
s_mov_b32 s36, 0
buffer_store_dwordx4 v[12:15], v10, s[84:87], s36 offen sc1
MA 148,v,132,v,152
ds_read_b128 v[88:91], v192 offset:36864
buffer_load_dwordx4 v214, s[48:51], s66 offen offset:2048 lds
MA 208,v,136,v,152
v_cvt_pk_bf16_f32 v54, v77, v76
v_cvt_pk_bf16_f32 v55, v75, v74
MA 212,v,140,v,152
TR 152,198,32768
TR 154,198,34816
MA 24,v,112,v,156
buffer_load_dwordx4 v215, s[48:51], s66 offen offset:3072 lds
v_cvt_pk_bf16_f32 v56, v73, v72
MA 28,v,116,v,156
v_cvt_pk_bf16_f32 v57, v71, v70
s_mov_b32 s36, 4096
MA 88,v,120,v,156
ds_read_b128 v[92:95], v192 offset:38912
buffer_store_dwordx4 v[54:57], v10, s[84:87], s36 offen sc1
MA 92,v,124,v,156
v_lshlrev_b32 v2, 16, v58
v_and_b32 v3, 0xffff0000, v58
MA 152,v,128,v,156
s_add_u32 s66, s66, 524288
v_lshlrev_b32 v4, 16, v59
MA 156,v,132,v,156
v_and_b32 v5, 0xffff0000, v59
v_lshlrev_b32 v6, 16, v60
MA 216,v,136,v,156
v_and_b32 v7, 0xffff0000, v60
v_lshlrev_b32 v8, 16, v61
MA 220,v,140,v,156
TR 156,199,32768
TR 158,199,34816
MA 32,v,112,v,160
ds_read_b128 v[96:99], v192 offset:40960
s_and_b32 s66, s66, 8388607
MA 36,v,116,v,160
v_and_b32 v9, 0xffff0000, v61
v_lshlrev_b32 v230, 16, v17
MA 96,v,120,v,160
v_and_b32 v231, 0xffff0000, v17
v_lshlrev_b32 v232, 16, v19
MA 100,v,124,v,160
v_and_b32 v233, 0xffff0000, v19
v_lshlrev_b32 v234, 16, v21
MA 160,v,128,v,160
ds_read_b128 v[100:103], v192 offset:43008
s_add_u32 m0, s68, 114688
MA 164,v,132,v,160
v_and_b32 v235, 0xffff0000, v21
v_lshlrev_b32 v236, 16, v23
MA 224,v,136,v,160
v_and_b32 v237, 0xffff0000, v23
v_lshlrev_b32 v238, 16, v25
MA 228,v,140,v,160
TR 160,200,32768
TR 162,200,34816
MA 40,v,112,v,164
buffer_load_dwordx4 v212, s[48:51], s66 offen offset:0 lds
v_and_b32 v239, 0xffff0000, v25
MA 44,v,116,v,164
ds_read_b128 v[104:107], v192 offset:45056
v_lshlrev_b32 v240, 16, v27
MA 104,v,120,v,164
v_and_b32 v241, 0xffff0000, v27
v_lshlrev_b32 v242, 16, v29
MA 108,v,124,v,164
buffer_load_dwordx4 v213, s[48:51], s66 offen offset:1024 lds
v_and_b32 v243, 0xffff0000, v29
MA 168,v,128,v,164
v_lshlrev_b32 v244, 16, v31
v_and_b32 v245, 0xffff0000, v31
MA 172,v,132,v,164
v_lshlrev_b32 v246, 16, v33
v_and_b32 v247, 0xffff0000, v33
MA 232,v,136,v,164
ds_read_b128 v[108:111], v192 offset:47104
v_lshlrev_b32 v248, 16, v35
MA 236,v,140,v,164
TR 164,201,32768
TR 166,201,34816
MA 48,v,112,v,168
buffer_load_dwordx4 v214, s[48:51], s66 offen offset:2048 lds
v_and_b32 v249, 0xffff0000, v35
MA 52,v,116,v,168
v_lshlrev_b32 v250, 16, v37
v_and_b32 v251, 0xffff0000, v37
MA 112,v,120,v,168
buffer_load_dwordx4 v215, s[48:51], s66 offen offset:3072 lds
v_lshlrev_b32 v254, 16, v39
MA 116,v,124,v,168
v_and_b32 v255, 0xffff0000, v39
v_mul_f32 v62, v236, v2
MA 176,v,128,v,168
v_mul_f32 v70, v237, v6
v_fmac_f32 v62, v234, v3
MA 180,v,132,v,168
v_fmac_f32 v70, v235, v7
v_fmac_f32 v62, v232, v4
MA 240,v,136,v,168
s_add_u32 s66, s66, 524288
v_fmac_f32 v70, v233, v8
MA 244,v,140,v,168
TR 168,202,32768
TR 170,202,34816
MA 56,v,112,v,172
v_fmac_f32 v62, v230, v5
v_fmac_f32 v70, v231, v9
MA 60,v,116,v,172
v_mul_f32 v62, v62, v254
v_mul_f32 v70, v70, v255
MA 120,v,120,v,172
s_and_b32 s66, s66, 8388607
v_lshlrev_b32 v254, 16, v41
MA 124,v,124,v,172
v_and_b32 v255, 0xffff0000, v41
v_mul_f32 v63, v238, v2
MA 184,v,128,v,172
v_mul_f32 v71, v239, v6
v_fmac_f32 v63, v236, v3
MA 188,v,132,v,172
v_fmac_f32 v71, v237, v7
v_fmac_f32 v63, v234, v4
MA 248,v,136,v,172
v_fmac_f32 v71, v235, v8
v_fmac_f32 v63, v232, v5
MA 252,v,140,v,172
TR 172,203,32768
TR 174,203,34816
v_fmac_f32 v71, v233, v9
v_mul_f32 v63, v63, v254
v_mul_f32 v71, v71, v255
v_lshlrev_b32 v254, 16, v43
v_and_b32 v255, 0xffff0000, v43
v_mul_f32 v64, v240, v2
v_mul_f32 v72, v241, v6
v_fmac_f32 v64, v238, v3
s_waitcnt lgkmcnt(2)
MA 0,v,80,v,144
s_add_u32 s75, s64, s74
v_fmac_f32 v72, v239, v7
MA 4,v,84,v,144
ds_read_b128 v[112:115], v193 offset:32768
v_fmac_f32 v64, v236, v4
MA 64,v,88,v,144
v_fmac_f32 v72, v237, v8
v_fmac_f32 v64, v234, v5
MA 68,v,92,v,144
v_fmac_f32 v72, v235, v9
v_mul_f32 v64, v64, v254
MA 128,v,96,v,144
s_add_u32 m0, s67, 0
v_mul_f32 v72, v72, v255
MA 132,v,100,v,144
v_lshlrev_b32 v254, 16, v45
v_and_b32 v255, 0xffff0000, v45
MA 192,v,104,v,144
v_mul_f32 v65, v242, v2
MA 196,v,108,v,144
TR 144,196,49152
TR 146,196,51200
MA 8,v,80,v,148
ds_read_b128 v[116:119], v193 offset:34816
buffer_load_dwordx4 v208, s[44:47], s75 offen offset:0 lds
MA 12,v,84,v,148
v_mul_f32 v73, v243, v6
v_fmac_f32 v65, v240, v3
MA 72,v,88,v,148
v_fmac_f32 v73, v241, v7
v_fmac_f32 v65, v238, v4
MA 76,v,92,v,148
v_fmac_f32 v73, v239, v8
v_fmac_f32 v65, v236, v5
MA 136,v,96,v,148
v_fmac_f32 v73, v237, v9
v_mul_f32 v65, v65, v254
MA 140,v,100,v,148
ds_read_b128 v[120:123], v193 offset:36864
buffer_load_dwordx4 v209, s[44:47], s75 offen offset:1024 lds
MA 200,v,104,v,148
v_mul_f32 v73, v73, v255
v_lshlrev_b32 v254, 16, v47
MA 204,v,108,v,148
TR 148,197,49152
TR 150,197,51200
MA 16,v,80,v,152
v_and_b32 v255, 0xffff0000, v47
v_mul_f32 v66, v244, v2
MA 20,v,84,v,152
buffer_load_dwordx4 v210, s[44:47], s75 offen offset:2048 lds
v_mul_f32 v74, v245, v6
MA 80,v,88,v,152
v_fmac_f32 v66, v242, v3
v_fmac_f32 v74, v243, v7
MA 84,v,92,v,152
v_fmac_f32 v66, v240, v4
v_fmac_f32 v74, v241, v8
MA 144,v,96,v,152
ds_read_b128 v[124:127], v193 offset:38912
v_fmac_f32 v66, v238, v5
MA 148,v,100,v,152
v_fmac_f32 v74, v239, v9
v_mul_f32 v66, v66, v254
MA 208,v,104,v,152
buffer_load_dwordx4 v211, s[44:47], s75 offen offset:3072 lds
v_mul_f32 v74, v74, v255
MA 212,v,108,v,152
TR 152,198,49152
TR 154,198,51200
MA 24,v,80,v,156
v_lshlrev_b32 v254, 16, v49
v_and_b32 v255, 0xffff0000, v49
MA 28,v,84,v,156
v_mul_f32 v67, v246, v2
v_mul_f32 v75, v247, v6
MA 88,v,88,v,156
ds_read_b128 v[128:131], v193 offset:40960
s_add_u32 s75, s65, s74
MA 92,v,92,v,156
v_fmac_f32 v67, v244, v3
v_fmac_f32 v75, v245, v7
MA 152,v,96,v,156
v_fmac_f32 v67, v242, v4
v_fmac_f32 v75, v243, v8
MA 156,v,100,v,156
v_fmac_f32 v67, v240, v5
v_fmac_f32 v75, v241, v9
MA 216,v,104,v,156
v_mul_f32 v67, v67, v254
v_mul_f32 v75, v75, v255
MA 220,v,108,v,156
TR 156,199,49152
TR 158,199,51200
MA 32,v,80,v,160
ds_read_b128 v[132:135], v193 offset:43008
s_add_u32 m0, s67, 4096
MA 36,v,84,v,160
v_lshlrev_b32 v254, 16, v51
v_and_b32 v255, 0xffff0000, v51
MA 96,v,88,v,160
v_mul_f32 v68, v248, v2
v_mul_f32 v76, v249, v6
MA 100,v,92,v,160
buffer_load_dwordx4 v208, s[44:47], s75 offen offset:0 lds
v_fmac_f32 v68, v246, v3
MA 160,v,96,v,160
v_fmac_f32 v76, v247, v7
v_fmac_f32 v68, v244, v4
MA 164,v,100,v,160
v_fmac_f32 v76, v245, v8
v_fmac_f32 v68, v242, v5
MA 224,v,104,v,160
v_fmac_f32 v76, v243, v9
v_mul_f32 v68, v68, v254
MA 228,v,108,v,160
TR 160,200,49152
TR 162,200,51200
MA 40,v,80,v,164
ds_read_b128 v[136:139], v193 offset:45056
buffer_load_dwordx4 v209, s[44:47], s75 offen offset:1024 lds
MA 44,v,84,v,164
v_mul_f32 v76, v76, v255
v_lshlrev_b32 v254, 16, v53
MA 104,v,88,v,164
v_and_b32 v255, 0xffff0000, v53
v_mul_f32 v69, v250, v2
MA 108,v,92,v,164
v_mul_f32 v77, v251, v6
v_fmac_f32 v69, v248, v3
MA 168,v,96,v,164
buffer_load_dwordx4 v210, s[44:47], s75 offen offset:2048 lds
v_fmac_f32 v77, v249, v7
MA 172,v,100,v,164
ds_read_b128 v[140:143], v193 offset:47104
v_fmac_f32 v69, v246, v4
MA 232,v,104,v,164
v_fmac_f32 v77, v247, v8
v_fmac_f32 v69, v244, v5
MA 236,v,108,v,164
TR 164,201,49152
TR 166,201,51200
MA 48,v,80,v,168
buffer_load_dwordx4 v211, s[44:47], s75 offen offset:3072 lds
v_fmac_f32 v77, v245, v9
MA 52,v,84,v,168
v_mul_f32 v69, v69, v254
v_mul_f32 v77, v77, v255
MA 112,v,88,v,168
v_cvt_pk_bf16_f32 v230, v69, v68
v_cvt_pk_bf16_f32 v231, v67, v66
MA 116,v,92,v,168
v_cvt_pk_bf16_f32 v232, v65, v64
v_cvt_pk_bf16_f32 v233, v63, v62
MA 176,v,96,v,168
s_mov_b32 s36, 8192
buffer_store_dwordx4 v[230:233], v10, s[84:87], s36 offen sc1
MA 180,v,100,v,168
s_add_u32 s74, s74, 128
v_cvt_pk_bf16_f32 v234, v77, v76
MA 240,v,104,v,168
v_cvt_pk_bf16_f32 v235, v75, v74
v_cvt_pk_bf16_f32 v236, v73, v72
MA 244,v,108,v,168
TR 168,202,49152
TR 170,202,51200
s_waitcnt lgkmcnt(15)
MA 56,v,80,v,172
v_cvt_pk_bf16_f32 v237, v71, v70
s_mov_b32 s36, 12288
MA 60,v,84,v,172
s_and_b32 s74, s74, 2047
buffer_store_dwordx4 v[234:237], v10, s[84:87], s36 offen sc1
MA 120,v,88,v,172
v_lshrrev_b32 v230, 5, v1
v_lshlrev_b32 v230, 12, v230
MA 124,v,92,v,172
v_and_b32 v231, 15, v1
v_lshl_add_u32 v230, v231, 4, v230
MA 184,v,96,v,172
v_bfe_u32 v231, v1, 4, 1
MA 188,v,100,v,172
v_lshl_add_u32 v228, v231, 9, v230
MA 248,v,104,v,172
MA 252,v,108,v,172
TR 172,203,49152
TR 174,203,51200
s_waitcnt lgkmcnt(2)
MA 0,v,112,v,144
MA 4,v,116,v,144
MA 64,v,120,v,144
MA 68,v,124,v,144
MA 128,v,128,v,144
MA 132,v,132,v,144
MA 192,v,136,v,144
MA 196,v,140,v,144
MA 8,v,112,v,148
MA 12,v,116,v,148
s_waitcnt vmcnt(15) lgkmcnt(0)
s_barrier
MA 72,v,120,v,148
ds_read_b128 v[48:51], v226 offset:0
s_add_u32 m0, s68, 131072
MA 76,v,124,v,148
MA 136,v,128,v,148
ds_read_b128 v[52:55], v226 offset:2048
buffer_load_dwordx4 v212, s[48:51], s66 offen offset:0 lds
MA 140,v,132,v,148
MA 200,v,136,v,148
ds_read_b128 v[56:59], v226 offset:4096
buffer_load_dwordx4 v213, s[48:51], s66 offen offset:1024 lds
MA 204,v,140,v,148
MA 16,v,112,v,152
ds_read_b128 v[60:63], v226 offset:6144
MA 20,v,116,v,152
buffer_load_dwordx4 v214, s[48:51], s66 offen offset:2048 lds
MA 80,v,120,v,152
TR 16,216,0
MA 84,v,124,v,152
buffer_load_dwordx4 v215, s[48:51], s66 offen offset:3072 lds
MA 144,v,128,v,152
TR 18,216,1024
MA 148,v,132,v,152
MA 208,v,136,v,152
TR 20,217,0
s_add_u32 s66, s66, 524288
MA 212,v,140,v,152
MA 24,v,112,v,156
TR 22,217,1024
s_and_b32 s66, s66, 8388607
MA 28,v,116,v,156
MA 88,v,120,v,156
TR 24,218,0
MA 92,v,124,v,156
s_add_u32 s75, s64, s74
MA 152,v,128,v,156
TR 26,218,1024
MA 156,v,132,v,156
s_add_u32 m0, s67, 32768
MA 216,v,136,v,156
TR 28,219,0
MA 220,v,140,v,156
MA 32,v,112,v,160
TR 30,219,1024
buffer_load_dwordx4 v208, s[44:47], s75 offen offset:0 lds
MA 36,v,116,v,160
MA 96,v,120,v,160
TR 32,220,0
buffer_load_dwordx4 v209, s[44:47], s75 offen offset:1024 lds
MA 100,v,124,v,160
MA 160,v,128,v,160
TR 34,220,1024
MA 164,v,132,v,160
buffer_load_dwordx4 v210, s[44:47], s75 offen offset:2048 lds
MA 224,v,136,v,160
TR 36,221,0
MA 228,v,140,v,160
buffer_load_dwordx4 v211, s[44:47], s75 offen offset:3072 lds
MA 40,v,112,v,164
TR 38,221,1024
MA 44,v,116,v,164
MA 104,v,120,v,164
TR 40,222,0
s_add_u32 s75, s65, s74
MA 108,v,124,v,164
MA 168,v,128,v,164
TR 42,222,1024
s_add_u32 m0, s67, 36864
MA 172,v,132,v,164
MA 232,v,136,v,164
TR 44,223,0
MA 236,v,140,v,164
buffer_load_dwordx4 v208, s[44:47], s75 offen offset:0 lds
MA 48,v,112,v,168
TR 46,223,1024
MA 52,v,116,v,168
buffer_load_dwordx4 v209, s[44:47], s75 offen offset:1024 lds
MA 112,v,120,v,168
MA 116,v,124,v,168
MA 176,v,128,v,168
buffer_load_dwordx4 v210, s[44:47], s75 offen offset:2048 lds
MA 180,v,132,v,168
MA 240,v,136,v,168
buffer_load_dwordx4 v211, s[44:47], s75 offen offset:3072 lds
MA 244,v,140,v,168
MA 56,v,112,v,172
MA 60,v,116,v,172
s_add_u32 s74, s74, 128
MA 120,v,120,v,172
MA 124,v,124,v,172
s_and_b32 s74, s74, 2047
MA 184,v,128,v,172
MA 188,v,132,v,172
MA 248,v,136,v,172
MA 252,v,140,v,172
L_p2:
s_waitcnt lgkmcnt(4)
v_mfma_f32_16x16x32_bf16 v[80:83], v[16:19], v[48:51], 0
s_add_u32 s8, s40, 59768832
s_addc_u32 s9, s41, 0
v_mfma_f32_16x16x32_bf16 v[84:87], v[16:19], v[52:55], 0
ds_read_b128 v[64:67], v227 offset:0
v_mfma_f32_16x16x32_bf16 v[88:91], v[16:19], v[56:59], 0
s_mov_b32 s10, 4096
v_mfma_f32_16x16x32_bf16 v[92:95], v[16:19], v[60:63], 0
TR 16,216,8192
TR 18,216,9216
v_mfma_f32_16x16x32_bf16 v[96:99], v[20:23], v[48:51], 0
s_mov_b32 s11, 0x20000
s_mov_b32 s12, s38
v_mfma_f32_16x16x32_bf16 v[100:103], v[20:23], v[52:55], 0
s_mov_b32 s13, s39
v_mfma_f32_16x16x32_bf16 v[104:107], v[20:23], v[56:59], 0
ds_read_b128 v[68:71], v227 offset:2048
s_mov_b32 s14, 256
v_mfma_f32_16x16x32_bf16 v[108:111], v[20:23], v[60:63], 0
TR 20,217,8192
TR 22,217,9216
v_mfma_f32_16x16x32_bf16 v[112:115], v[24:27], v[48:51], 0
s_mov_b32 s15, 0x20000
v_accvgpr_read_b32 v234, a0
v_mfma_f32_16x16x32_bf16 v[116:119], v[24:27], v[52:55], 0
v_accvgpr_read_b32 v235, a1
v_mfma_f32_16x16x32_bf16 v[120:123], v[24:27], v[56:59], 0
v_accvgpr_read_b32 v236, a2
v_mfma_f32_16x16x32_bf16 v[124:127], v[24:27], v[60:63], 0
TR 24,218,8192
TR 26,218,9216
v_mfma_f32_16x16x32_bf16 v[128:131], v[28:31], v[48:51], 0
ds_read_b128 v[72:75], v227 offset:4096
v_accvgpr_read_b32 v237, a3
v_mfma_f32_16x16x32_bf16 v[132:135], v[28:31], v[52:55], 0
v_accvgpr_read_b32 v238, a4
v_accvgpr_read_b32 v239, a5
v_mfma_f32_16x16x32_bf16 v[136:139], v[28:31], v[56:59], 0
v_accvgpr_read_b32 v240, a6
v_mfma_f32_16x16x32_bf16 v[140:143], v[28:31], v[60:63], 0
TR 28,219,8192
TR 30,219,9216
v_mfma_f32_16x16x32_bf16 v[144:147], v[32:35], v[48:51], 0
v_accvgpr_read_b32 v241, a7
v_cvt_pk_bf16_f32 v230, v234, v235
v_mfma_f32_16x16x32_bf16 v[148:151], v[32:35], v[52:55], 0
v_cvt_pk_bf16_f32 v231, v236, v237
v_mfma_f32_16x16x32_bf16 v[152:155], v[32:35], v[56:59], 0
ds_read_b128 v[76:79], v227 offset:6144
v_cvt_pk_bf16_f32 v232, v238, v239
v_mfma_f32_16x16x32_bf16 v[156:159], v[32:35], v[60:63], 0
TR 32,220,8192
TR 34,220,9216
v_mfma_f32_16x16x32_bf16 v[160:163], v[36:39], v[48:51], 0
v_cvt_pk_bf16_f32 v233, v240, v241
buffer_store_dwordx4 v[230:233], v228, s[16:19], s24 offen sc1
v_mfma_f32_16x16x32_bf16 v[164:167], v[36:39], v[52:55], 0
v_accvgpr_read_b32 v246, a8
v_mfma_f32_16x16x32_bf16 v[168:171], v[36:39], v[56:59], 0
v_accvgpr_read_b32 v247, a9
v_mfma_f32_16x16x32_bf16 v[172:175], v[36:39], v[60:63], 0
TR 36,221,8192
TR 38,221,9216
s_waitcnt lgkmcnt(15)
v_mfma_f32_16x16x32_bf16 v[176:179], v[40:43], v[48:51], 0
v_accvgpr_read_b32 v248, a10
v_accvgpr_read_b32 v249, a11
v_mfma_f32_16x16x32_bf16 v[180:183], v[40:43], v[52:55], 0
v_accvgpr_read_b32 v250, a12
v_mfma_f32_16x16x32_bf16 v[184:187], v[40:43], v[56:59], 0
v_accvgpr_read_b32 v251, a13
v_mfma_f32_16x16x32_bf16 v[188:191], v[40:43], v[60:63], 0
TR 40,222,8192
TR 42,222,9216
v_mfma_f32_16x16x32_bf16 v[192:195], v[44:47], v[48:51], 0
v_accvgpr_read_b32 v252, a14
v_accvgpr_read_b32 v253, a15
v_mfma_f32_16x16x32_bf16 v[196:199], v[44:47], v[52:55], 0
v_cvt_pk_bf16_f32 v242, v246, v247
v_mfma_f32_16x16x32_bf16 v[200:203], v[44:47], v[56:59], 0
v_mfma_f32_16x16x32_bf16 v[204:207], v[44:47], v[60:63], 0
TR 44,223,8192
TR 46,223,9216
s_waitcnt lgkmcnt(4)
MV 80,v,16,v,64
v_cvt_pk_bf16_f32 v243, v248, v249
MV 84,v,16,v,68
v_cvt_pk_bf16_f32 v244, v250, v251
MV 88,v,16,v,72
v_cvt_pk_bf16_f32 v245, v252, v253
MV 92,v,16,v,76
MV 96,v,20,v,64
buffer_store_dwordx4 v[242:245], v228, s[16:19], s25 offen sc1
MV 100,v,20,v,68
v_accvgpr_read_b32 v234, a16
MV 104,v,20,v,72
v_accvgpr_read_b32 v235, a17
MV 108,v,20,v,76
s_waitcnt vmcnt(16) lgkmcnt(0)
s_barrier
MV 112,v,24,v,64
TR 16,216,16384
TR 18,216,17408
MV 116,v,24,v,68
ds_read_b128 v[48:51], v224 offset:0
s_add_u32 m0, s68, 98304
MV 120,v,24,v,72
TR 20,217,16384
TR 22,217,17408
MV 124,v,24,v,76
buffer_load_dwordx4 v212, s[48:51], s66 offen offset:0 lds
v_accvgpr_read_b32 v236, a18
MV 128,v,28,v,64
TR 24,218,16384
TR 26,218,17408
MV 132,v,28,v,68
ds_read_b128 v[52:55], v224 offset:2048
buffer_load_dwordx4 v213, s[48:51], s66 offen offset:1024 lds
MV 136,v,28,v,72
buffer_load_dwordx4 v214, s[48:51], s66 offen offset:2048 lds
v_accvgpr_read_b32 v237, a19
MV 140,v,28,v,76
TR 28,219,16384
TR 30,219,17408
MV 144,v,32,v,64
ds_read_b128 v[56:59], v224 offset:4096
v_accvgpr_read_b32 v238, a20
MV 148,v,32,v,68
buffer_load_dwordx4 v215, s[48:51], s66 offen offset:3072 lds
v_accvgpr_read_b32 v239, a21
MV 152,v,32,v,72
v_accvgpr_read_b32 v240, a22
v_accvgpr_read_b32 v241, a23
MV 156,v,32,v,76
TR 32,220,16384
TR 34,220,17408
MV 160,v,36,v,64
ds_read_b128 v[60:63], v224 offset:6144
s_add_u32 s66, s66, 524288
MV 164,v,36,v,68
s_and_b32 s66, s66, 8388607
v_cvt_pk_bf16_f32 v230, v234, v235
MV 168,v,36,v,72
v_cvt_pk_bf16_f32 v231, v236, v237
v_cvt_pk_bf16_f32 v232, v238, v239
MV 172,v,36,v,76
TR 36,221,16384
TR 38,221,17408
MV 176,v,40,v,64
s_add_u32 s75, s64, s74
v_cvt_pk_bf16_f32 v233, v240, v241
MV 180,v,40,v,68
buffer_store_dwordx4 v[230:233], v228, s[16:19], s26 offen sc1
v_accvgpr_read_b32 v246, a24
MV 184,v,40,v,72
s_add_u32 m0, s67, 65536
v_accvgpr_read_b32 v247, a25
MV 188,v,40,v,76
TR 40,222,16384
TR 42,222,17408
MV 192,v,44,v,64
buffer_load_dwordx4 v208, s[44:47], s75 offen offset:0 lds
v_accvgpr_read_b32 v248, a26
MV 196,v,44,v,68
v_accvgpr_read_b32 v249, a27
v_accvgpr_read_b32 v250, a28
MV 200,v,44,v,72
MV 204,v,44,v,76
TR 44,223,16384
TR 46,223,17408
s_waitcnt lgkmcnt(4)
MV 80,v,16,v,48
buffer_load_dwordx4 v209, s[44:47], s75 offen offset:1024 lds
v_accvgpr_read_b32 v251, a29
MV 84,v,16,v,52
ds_read_b128 v[64:67], v225 offset:0
v_accvgpr_read_b32 v252, a30
MV 88,v,16,v,56
buffer_load_dwordx4 v210, s[44:47], s75 offen offset:2048 lds
v_accvgpr_read_b32 v253, a31
MV 92,v,16,v,60
TR 16,216,24576
TR 18,216,25600
MV 96,v,20,v,48
v_cvt_pk_bf16_f32 v242, v246, v247
MV 100,v,20,v,52
buffer_load_dwordx4 v211, s[44:47], s75 offen offset:3072 lds
v_cvt_pk_bf16_f32 v243, v248, v249
MV 104,v,20,v,56
ds_read_b128 v[68:71], v225 offset:2048
v_cvt_pk_bf16_f32 v244, v250, v251
MV 108,v,20,v,60
TR 20,217,24576
TR 22,217,25600
MV 112,v,24,v,48
s_add_u32 s75, s65, s74
v_cvt_pk_bf16_f32 v245, v252, v253
MV 116,v,24,v,52
buffer_store_dwordx4 v[242:245], v228, s[16:19], s27 offen sc1
MV 120,v,24,v,56
v_accvgpr_read_b32 v234, a32
MV 124,v,24,v,60
TR 24,218,24576
TR 26,218,25600
MV 128,v,28,v,48
ds_read_b128 v[72:75], v225 offset:4096
s_add_u32 m0, s67, 69632
MV 132,v,28,v,52
v_accvgpr_read_b32 v235, a33
v_accvgpr_read_b32 v236, a34
MV 136,v,28,v,56
buffer_load_dwordx4 v208, s[44:47], s75 offen offset:0 lds
MV 140,v,28,v,60
TR 28,219,24576
TR 30,219,25600
MV 144,v,32,v,48
buffer_load_dwordx4 v209, s[44:47], s75 offen offset:1024 lds
v_accvgpr_read_b32 v237, a35
MV 148,v,32,v,52
v_accvgpr_read_b32 v238, a36
v_accvgpr_read_b32 v239, a37
MV 152,v,32,v,56
ds_read_b128 v[76:79], v225 offset:6144
MV 156,v,32,v,60
TR 32,220,24576
TR 34,220,25600
MV 160,v,36,v,48
buffer_load_dwordx4 v210, s[44:47], s75 offen offset:2048 lds
v_accvgpr_read_b32 v240, a38
MV 164,v,36,v,52
v_accvgpr_read_b32 v241, a39
v_cvt_pk_bf16_f32 v230, v234, v235
MV 168,v,36,v,56
buffer_load_dwordx4 v211, s[44:47], s75 offen offset:3072 lds
MV 172,v,36,v,60
TR 36,221,24576
TR 38,221,25600
s_waitcnt lgkmcnt(15)
MV 176,v,40,v,48
v_cvt_pk_bf16_f32 v231, v236, v237
v_cvt_pk_bf16_f32 v232, v238, v239
MV 180,v,40,v,52
s_add_u32 s74, s74, 128
v_cvt_pk_bf16_f32 v233, v240, v241
MV 184,v,40,v,56
MV 188,v,40,v,60
TR 40,222,24576
TR 42,222,25600
MV 192,v,44,v,48
s_and_b32 s74, s74, 2047
buffer_store_dwordx4 v[230:233], v228, s[16:19], s28 offen sc1
MV 196,v,44,v,52
v_accvgpr_read_b32 v246, a40
MV 200,v,44,v,56
MV 204,v,44,v,60
TR 44,223,24576
TR 46,223,25600
s_waitcnt lgkmcnt(4)
MV 80,v,16,v,64
v_accvgpr_read_b32 v247, a41
MV 84,v,16,v,68
v_accvgpr_read_b32 v248, a42
MV 88,v,16,v,72
v_accvgpr_read_b32 v249, a43
MV 92,v,16,v,76
MV 96,v,20,v,64
v_accvgpr_read_b32 v250, a44
MV 100,v,20,v,68
v_accvgpr_read_b32 v251, a45
MV 104,v,20,v,72
v_accvgpr_read_b32 v252, a46
MV 108,v,20,v,76
s_waitcnt vmcnt(17) lgkmcnt(0)
s_barrier
MV 112,v,24,v,64
TR 16,216,32768
TR 18,216,33792
MV 116,v,24,v,68
ds_read_b128 v[48:51], v224 offset:32768
s_add_u32 m0, s68, 114688
MV 120,v,24,v,72
TR 20,217,32768
TR 22,217,33792
MV 124,v,24,v,76
buffer_load_dwordx4 v212, s[48:51], s66 offen offset:0 lds
v_accvgpr_read_b32 v253, a47
MV 128,v,28,v,64
TR 24,218,32768
TR 26,218,33792
MV 132,v,28,v,68
ds_read_b128 v[52:55], v224 offset:34816
buffer_load_dwordx4 v213, s[48:51], s66 offen offset:1024 lds
MV 136,v,28,v,72
buffer_load_dwordx4 v214, s[48:51], s66 offen offset:2048 lds
v_cvt_pk_bf16_f32 v242, v246, v247
MV 140,v,28,v,76
TR 28,219,32768
TR 30,219,33792
MV 144,v,32,v,64
ds_read_b128 v[56:59], v224 offset:36864
v_cvt_pk_bf16_f32 v243, v248, v249
MV 148,v,32,v,68
buffer_load_dwordx4 v215, s[48:51], s66 offen offset:3072 lds
v_cvt_pk_bf16_f32 v244, v250, v251
MV 152,v,32,v,72
v_cvt_pk_bf16_f32 v245, v252, v253
buffer_store_dwordx4 v[242:245], v228, s[16:19], s29 offen sc1
MV 156,v,32,v,76
TR 32,220,32768
TR 34,220,33792
MV 160,v,36,v,64
ds_read_b128 v[60:63], v224 offset:38912
s_add_u32 s66, s66, 524288
MV 164,v,36,v,68
s_and_b32 s66, s66, 8388607
v_accvgpr_read_b32 v234, a48
MV 168,v,36,v,72
v_accvgpr_read_b32 v235, a49
v_accvgpr_read_b32 v236, a50
MV 172,v,36,v,76
TR 36,221,32768
TR 38,221,33792
MV 176,v,40,v,64
s_add_u32 s75, s64, s74
v_accvgpr_read_b32 v237, a51
MV 180,v,40,v,68
v_accvgpr_read_b32 v238, a52
v_accvgpr_read_b32 v239, a53
MV 184,v,40,v,72
s_add_u32 m0, s67, 0
v_accvgpr_read_b32 v240, a54
MV 188,v,40,v,76
TR 40,222,32768
TR 42,222,33792
MV 192,v,44,v,64
buffer_load_dwordx4 v208, s[44:47], s75 offen offset:0 lds
v_accvgpr_read_b32 v241, a55
MV 196,v,44,v,68
v_cvt_pk_bf16_f32 v230, v234, v235
v_cvt_pk_bf16_f32 v231, v236, v237
MV 200,v,44,v,72
MV 204,v,44,v,76
TR 44,223,32768
TR 46,223,33792
s_waitcnt lgkmcnt(4)
MV 80,v,16,v,48
buffer_load_dwordx4 v209, s[44:47], s75 offen offset:1024 lds
v_cvt_pk_bf16_f32 v232, v238, v239
MV 84,v,16,v,52
ds_read_b128 v[64:67], v225 offset:32768
v_cvt_pk_bf16_f32 v233, v240, v241
MV 88,v,16,v,56
buffer_load_dwordx4 v210, s[44:47], s75 offen offset:2048 lds
buffer_store_dwordx4 v[230:233], v228, s[16:19], s30 offen sc1
MV 92,v,16,v,60
TR 16,216,40960
TR 18,216,41984
MV 96,v,20,v,48
v_accvgpr_read_b32 v246, a56
MV 100,v,20,v,52
buffer_load_dwordx4 v211, s[44:47], s75 offen offset:3072 lds
v_accvgpr_read_b32 v247, a57
MV 104,v,20,v,56
ds_read_b128 v[68:71], v225 offset:34816
v_accvgpr_read_b32 v248, a58
MV 108,v,20,v,60
TR 20,217,40960
TR 22,217,41984
MV 112,v,24,v,48
s_add_u32 s75, s65, s74
v_accvgpr_read_b32 v249, a59
MV 116,v,24,v,52
v_accvgpr_read_b32 v250, a60
MV 120,v,24,v,56
v_accvgpr_read_b32 v251, a61
MV 124,v,24,v,60
TR 24,218,40960
TR 26,218,41984
MV 128,v,28,v,48
ds_read_b128 v[72:75], v225 offset:36864
s_add_u32 m0, s67, 4096
MV 132,v,28,v,52
v_accvgpr_read_b32 v252, a62
v_accvgpr_read_b32 v253, a63
MV 136,v,28,v,56
buffer_load_dwordx4 v208, s[44:47], s75 offen offset:0 lds
MV 140,v,28,v,60
TR 28,219,40960
TR 30,219,41984
MV 144,v,32,v,48
buffer_load_dwordx4 v209, s[44:47], s75 offen offset:1024 lds
v_cvt_pk_bf16_f32 v242, v246, v247
MV 148,v,32,v,52
v_cvt_pk_bf16_f32 v243, v248, v249
v_cvt_pk_bf16_f32 v244, v250, v251
MV 152,v,32,v,56
ds_read_b128 v[76:79], v225 offset:38912
MV 156,v,32,v,60
TR 32,220,40960
TR 34,220,41984
MV 160,v,36,v,48
buffer_load_dwordx4 v210, s[44:47], s75 offen offset:2048 lds
v_cvt_pk_bf16_f32 v245, v252, v253
MV 164,v,36,v,52
buffer_store_dwordx4 v[242:245], v228, s[16:19], s31 offen sc1
v_accvgpr_read_b32 v234, a64
MV 168,v,36,v,56
buffer_load_dwordx4 v211, s[44:47], s75 offen offset:3072 lds
MV 172,v,36,v,60
TR 36,221,40960
TR 38,221,41984
s_waitcnt lgkmcnt(15)
MV 176,v,40,v,48
v_accvgpr_read_b32 v235, a65
v_accvgpr_read_b32 v236, a66
MV 180,v,40,v,52
s_add_u32 s74, s74, 128
v_accvgpr_read_b32 v237, a67
MV 184,v,40,v,56
MV 188,v,40,v,60
TR 40,222,40960
TR 42,222,41984
MV 192,v,44,v,48
s_and_b32 s74, s74, 2047
v_accvgpr_read_b32 v238, a68
MV 196,v,44,v,52
v_accvgpr_read_b32 v239, a69
MV 200,v,44,v,56
MV 204,v,44,v,60
TR 44,223,40960
TR 46,223,41984
s_waitcnt lgkmcnt(4)
MV 80,v,16,v,64
v_accvgpr_read_b32 v240, a70
MV 84,v,16,v,68
v_accvgpr_read_b32 v241, a71
MV 88,v,16,v,72
v_cvt_pk_bf16_f32 v230, v234, v235
MV 92,v,16,v,76
MV 96,v,20,v,64
v_cvt_pk_bf16_f32 v231, v236, v237
MV 100,v,20,v,68
v_cvt_pk_bf16_f32 v232, v238, v239
MV 104,v,20,v,72
v_cvt_pk_bf16_f32 v233, v240, v241
MV 108,v,20,v,76
s_waitcnt vmcnt(16) lgkmcnt(0)
s_barrier
MV 112,v,24,v,64
TR 16,216,0
TR 18,216,1024
MV 116,v,24,v,68
ds_read_b128 v[48:51], v226 offset:0
s_add_u32 m0, s68, 131072
MV 120,v,24,v,72
TR 20,217,0
TR 22,217,1024
MV 124,v,24,v,76
buffer_load_dwordx4 v212, s[48:51], s66 offen offset:0 lds
s_add_u32 s36, s24, 8192
MV 128,v,28,v,64
TR 24,218,0
TR 26,218,1024
MV 132,v,28,v,68
ds_read_b128 v[52:55], v226 offset:2048
buffer_load_dwordx4 v213, s[48:51], s66 offen offset:1024 lds
MV 136,v,28,v,72
buffer_load_dwordx4 v214, s[48:51], s66 offen offset:2048 lds
buffer_store_dwordx4 v[230:233], v228, s[16:19], s36 offen sc1
MV 140,v,28,v,76
TR 28,219,0
TR 30,219,1024
MV 144,v,32,v,64
ds_read_b128 v[56:59], v226 offset:4096
v_accvgpr_read_b32 v246, a72
MV 148,v,32,v,68
buffer_load_dwordx4 v215, s[48:51], s66 offen offset:3072 lds
v_accvgpr_read_b32 v247, a73
MV 152,v,32,v,72
v_accvgpr_read_b32 v248, a74
v_accvgpr_read_b32 v249, a75
MV 156,v,32,v,76
TR 32,220,0
TR 34,220,1024
MV 160,v,36,v,64
ds_read_b128 v[60:63], v226 offset:6144
s_add_u32 s66, s66, 524288
MV 164,v,36,v,68
s_and_b32 s66, s66, 8388607
v_accvgpr_read_b32 v250, a76
MV 168,v,36,v,72
v_accvgpr_read_b32 v251, a77
v_accvgpr_read_b32 v252, a78
MV 172,v,36,v,76
TR 36,221,0
TR 38,221,1024
MV 176,v,40,v,64
s_add_u32 s75, s64, s74
v_accvgpr_read_b32 v253, a79
MV 180,v,40,v,68
v_cvt_pk_bf16_f32 v242, v246, v247
v_cvt_pk_bf16_f32 v243, v248, v249
MV 184,v,40,v,72
s_add_u32 m0, s67, 32768
v_cvt_pk_bf16_f32 v244, v250, v251
MV 188,v,40,v,76
TR 40,222,0
TR 42,222,1024
MV 192,v,44,v,64
buffer_load_dwordx4 v208, s[44:47], s75 offen offset:0 lds
v_cvt_pk_bf16_f32 v245, v252, v253
MV 196,v,44,v,68
s_add_u32 s36, s25, 8192
buffer_store_dwordx4 v[242:245], v228, s[16:19], s36 offen sc1
MV 200,v,44,v,72
MV 204,v,44,v,76
TR 44,223,0
TR 46,223,1024
s_waitcnt lgkmcnt(4)
MV 80,v,16,v,48
buffer_load_dwordx4 v209, s[44:47], s75 offen offset:1024 lds
v_accvgpr_read_b32 v234, a80
MV 84,v,16,v,52
ds_read_b128 v[64:67], v227 offset:0
v_accvgpr_read_b32 v235, a81
MV 88,v,16,v,56
buffer_load_dwordx4 v210, s[44:47], s75 offen offset:2048 lds
v_accvgpr_read_b32 v236, a82
MV 92,v,16,v,60
TR 16,216,8192
TR 18,216,9216
MV 96,v,20,v,48
v_accvgpr_read_b32 v237, a83
MV 100,v,20,v,52
buffer_load_dwordx4 v211, s[44:47], s75 offen offset:3072 lds
v_accvgpr_read_b32 v238, a84
MV 104,v,20,v,56
ds_read_b128 v[68:71], v227 offset:2048
v_accvgpr_read_b32 v239, a85
MV 108,v,20,v,60
TR 20,217,8192
TR 22,217,9216
MV 112,v,24,v,48
s_add_u32 s75, s65, s74
v_accvgpr_read_b32 v240, a86
MV 116,v,24,v,52
v_accvgpr_read_b32 v241, a87
MV 120,v,24,v,56
v_cvt_pk_bf16_f32 v230, v234, v235
MV 124,v,24,v,60
TR 24,218,8192
TR 26,218,9216
MV 128,v,28,v,48
ds_read_b128 v[72:75], v227 offset:4096
s_add_u32 m0, s67, 36864
MV 132,v,28,v,52
v_cvt_pk_bf16_f32 v231, v236, v237
v_cvt_pk_bf16_f32 v232, v238, v239
MV 136,v,28,v,56
buffer_load_dwordx4 v208, s[44:47], s75 offen offset:0 lds
MV 140,v,28,v,60
TR 28,219,8192
TR 30,219,9216
MV 144,v,32,v,48
buffer_load_dwordx4 v209, s[44:47], s75 offen offset:1024 lds
v_cvt_pk_bf16_f32 v233, v240, v241
MV 148,v,32,v,52
s_add_u32 s36, s26, 8192
buffer_store_dwordx4 v[230:233], v228, s[16:19], s36 offen sc1
MV 152,v,32,v,56
ds_read_b128 v[76:79], v227 offset:6144
MV 156,v,32,v,60
TR 32,220,8192
TR 34,220,9216
MV 160,v,36,v,48
buffer_load_dwordx4 v210, s[44:47], s75 offen offset:2048 lds
v_accvgpr_read_b32 v246, a88
MV 164,v,36,v,52
v_accvgpr_read_b32 v247, a89
v_accvgpr_read_b32 v248, a90
MV 168,v,36,v,56
buffer_load_dwordx4 v211, s[44:47], s75 offen offset:3072 lds
MV 172,v,36,v,60
TR 36,221,8192
TR 38,221,9216
s_waitcnt lgkmcnt(15)
MV 176,v,40,v,48
v_accvgpr_read_b32 v249, a91
v_accvgpr_read_b32 v250, a92
MV 180,v,40,v,52
s_add_u32 s74, s74, 128
v_accvgpr_read_b32 v251, a93
MV 184,v,40,v,56
MV 188,v,40,v,60
TR 40,222,8192
TR 42,222,9216
MV 192,v,44,v,48
s_and_b32 s74, s74, 2047
v_accvgpr_read_b32 v252, a94
MV 196,v,44,v,52
v_accvgpr_read_b32 v253, a95
MV 200,v,44,v,56
MV 204,v,44,v,60
TR 44,223,8192
TR 46,223,9216
s_waitcnt lgkmcnt(4)
MV 80,v,16,v,64
v_cvt_pk_bf16_f32 v242, v246, v247
MV 84,v,16,v,68
v_cvt_pk_bf16_f32 v243, v248, v249
MV 88,v,16,v,72
v_cvt_pk_bf16_f32 v244, v250, v251
MV 92,v,16,v,76
MV 96,v,20,v,64
v_cvt_pk_bf16_f32 v245, v252, v253
MV 100,v,20,v,68
s_add_u32 s36, s27, 8192
MV 104,v,20,v,72
buffer_store_dwordx4 v[242:245], v228, s[16:19], s36 offen sc1
MV 108,v,20,v,76
s_waitcnt vmcnt(16) lgkmcnt(0)
s_barrier
MV 112,v,24,v,64
TR 16,216,16384
TR 18,216,17408
MV 116,v,24,v,68
ds_read_b128 v[48:51], v224 offset:0
s_add_u32 m0, s68, 98304
MV 120,v,24,v,72
TR 20,217,16384
TR 22,217,17408
MV 124,v,24,v,76
buffer_load_dwordx4 v212, s[48:51], s66 offen offset:0 lds
v_accvgpr_read_b32 v234, a96
MV 128,v,28,v,64
TR 24,218,16384
TR 26,218,17408
MV 132,v,28,v,68
ds_read_b128 v[52:55], v224 offset:2048
buffer_load_dwordx4 v213, s[48:51], s66 offen offset:1024 lds
MV 136,v,28,v,72
buffer_load_dwordx4 v214, s[48:51], s66 offen offset:2048 lds
v_accvgpr_read_b32 v235, a97
MV 140,v,28,v,76
TR 28,219,16384
TR 30,219,17408
MV 144,v,32,v,64
ds_read_b128 v[56:59], v224 offset:4096
v_accvgpr_read_b32 v236, a98
MV 148,v,32,v,68
buffer_load_dwordx4 v215, s[48:51], s66 offen offset:3072 lds
v_accvgpr_read_b32 v237, a99
MV 152,v,32,v,72
v_accvgpr_read_b32 v238, a100
v_accvgpr_read_b32 v239, a101
MV 156,v,32,v,76
TR 32,220,16384
TR 34,220,17408
MV 160,v,36,v,64
ds_read_b128 v[60:63], v224 offset:6144
s_add_u32 s66, s66, 524288
MV 164,v,36,v,68
s_and_b32 s66, s66, 8388607
v_accvgpr_read_b32 v240, a102
MV 168,v,36,v,72
v_accvgpr_read_b32 v241, a103
v_cvt_pk_bf16_f32 v230, v234, v235
MV 172,v,36,v,76
TR 36,221,16384
TR 38,221,17408
MV 176,v,40,v,64
s_add_u32 s75, s64, s74
v_cvt_pk_bf16_f32 v231, v236, v237
MV 180,v,40,v,68
v_cvt_pk_bf16_f32 v232, v238, v239
v_cvt_pk_bf16_f32 v233, v240, v241
MV 184,v,40,v,72
s_add_u32 m0, s67, 65536
s_add_u32 s36, s28, 8192
MV 188,v,40,v,76
TR 40,222,16384
TR 42,222,17408
MV 192,v,44,v,64
buffer_load_dwordx4 v208, s[44:47], s75 offen offset:0 lds
buffer_store_dwordx4 v[230:233], v228, s[16:19], s36 offen sc1
MV 196,v,44,v,68
v_accvgpr_read_b32 v246, a104
v_accvgpr_read_b32 v247, a105
MV 200,v,44,v,72
MV 204,v,44,v,76
TR 44,223,16384
TR 46,223,17408
s_waitcnt lgkmcnt(4)
MV 80,v,16,v,48
buffer_load_dwordx4 v209, s[44:47], s75 offen offset:1024 lds
v_accvgpr_read_b32 v248, a106
MV 84,v,16,v,52
ds_read_b128 v[64:67], v225 offset:0
v_accvgpr_read_b32 v249, a107
MV 88,v,16,v,56
buffer_load_dwordx4 v210, s[44:47], s75 offen offset:2048 lds
v_accvgpr_read_b32 v250, a108
MV 92,v,16,v,60
TR 16,216,24576
TR 18,216,25600
MV 96,v,20,v,48
v_accvgpr_read_b32 v251, a109
MV 100,v,20,v,52
buffer_load_dwordx4 v211, s[44:47], s75 offen offset:3072 lds
v_accvgpr_read_b32 v252, a110
MV 104,v,20,v,56
ds_read_b128 v[68:71], v225 offset:2048
v_accvgpr_read_b32 v253, a111
MV 108,v,20,v,60
TR 20,217,24576
TR 22,217,25600
MV 112,v,24,v,48
s_add_u32 s75, s65, s74
v_cvt_pk_bf16_f32 v242, v246, v247
MV 116,v,24,v,52
v_cvt_pk_bf16_f32 v243, v248, v249
MV 120,v,24,v,56
v_cvt_pk_bf16_f32 v244, v250, v251
MV 124,v,24,v,60
TR 24,218,24576
TR 26,218,25600
MV 128,v,28,v,48
ds_read_b128 v[72:75], v225 offset:4096
s_add_u32 m0, s67, 69632
MV 132,v,28,v,52
v_cvt_pk_bf16_f32 v245, v252, v253
s_add_u32 s36, s29, 8192
MV 136,v,28,v,56
buffer_load_dwordx4 v208, s[44:47], s75 offen offset:0 lds
MV 140,v,28,v,60
TR 28,219,24576
TR 30,219,25600
MV 144,v,32,v,48
buffer_load_dwordx4 v209, s[44:47], s75 offen offset:1024 lds
buffer_store_dwordx4 v[242:245], v228, s[16:19], s36 offen sc1
MV 148,v,32,v,52
v_accvgpr_read_b32 v234, a112
v_accvgpr_read_b32 v235, a113
MV 152,v,32,v,56
ds_read_b128 v[76:79], v225 offset:6144
MV 156,v,32,v,60
TR 32,220,24576
TR 34,220,25600
MV 160,v,36,v,48
buffer_load_dwordx4 v210, s[44:47], s75 offen offset:2048 lds
v_accvgpr_read_b32 v236, a114
MV 164,v,36,v,52
v_accvgpr_read_b32 v237, a115
v_accvgpr_read_b32 v238, a116
MV 168,v,36,v,56
buffer_load_dwordx4 v211, s[44:47], s75 offen offset:3072 lds
MV 172,v,36,v,60
TR 36,221,24576
TR 38,221,25600
s_waitcnt lgkmcnt(15)
MV 176,v,40,v,48
v_accvgpr_read_b32 v239, a117
v_accvgpr_read_b32 v240, a118
MV 180,v,40,v,52
s_add_u32 s74, s74, 128
v_accvgpr_read_b32 v241, a119
MV 184,v,40,v,56
MV 188,v,40,v,60
TR 40,222,24576
TR 42,222,25600
MV 192,v,44,v,48
s_and_b32 s74, s74, 2047
v_cvt_pk_bf16_f32 v230, v234, v235
MV 196,v,44,v,52
v_cvt_pk_bf16_f32 v231, v236, v237
MV 200,v,44,v,56
MV 204,v,44,v,60
TR 44,223,24576
TR 46,223,25600
s_waitcnt lgkmcnt(4)
MV 80,v,16,v,64
v_cvt_pk_bf16_f32 v232, v238, v239
MV 84,v,16,v,68
v_cvt_pk_bf16_f32 v233, v240, v241
MV 88,v,16,v,72
s_add_u32 s36, s30, 8192
MV 92,v,16,v,76
MV 96,v,20,v,64
buffer_store_dwordx4 v[230:233], v228, s[16:19], s36 offen sc1
MV 100,v,20,v,68
v_accvgpr_read_b32 v246, a120
MV 104,v,20,v,72
v_accvgpr_read_b32 v247, a121
MV 108,v,20,v,76
s_waitcnt vmcnt(16) lgkmcnt(0)
s_barrier
MV 112,v,24,v,64
TR 16,216,32768
TR 18,216,33792
MV 116,v,24,v,68
ds_read_b128 v[48:51], v224 offset:32768
s_add_u32 m0, s68, 114688
MV 120,v,24,v,72
TR 20,217,32768
TR 22,217,33792
MV 124,v,24,v,76
buffer_load_dwordx4 v212, s[48:51], s66 offen offset:0 lds
v_accvgpr_read_b32 v248, a122
MV 128,v,28,v,64
TR 24,218,32768
TR 26,218,33792
MV 132,v,28,v,68
ds_read_b128 v[52:55], v224 offset:34816
buffer_load_dwordx4 v213, s[48:51], s66 offen offset:1024 lds
MV 136,v,28,v,72
buffer_load_dwordx4 v214, s[48:51], s66 offen offset:2048 lds
v_accvgpr_read_b32 v249, a123
MV 140,v,28,v,76
TR 28,219,32768
TR 30,219,33792
MV 144,v,32,v,64
ds_read_b128 v[56:59], v224 offset:36864
v_accvgpr_read_b32 v250, a124
MV 148,v,32,v,68
buffer_load_dwordx4 v215, s[48:51], s66 offen offset:3072 lds
v_accvgpr_read_b32 v251, a125
MV 152,v,32,v,72
v_accvgpr_read_b32 v252, a126
v_accvgpr_read_b32 v253, a127
MV 156,v,32,v,76
TR 32,220,32768
TR 34,220,33792
MV 160,v,36,v,64
ds_read_b128 v[60:63], v224 offset:38912
s_add_u32 s66, s66, 524288
MV 164,v,36,v,68
s_and_b32 s66, s66, 8388607
v_cvt_pk_bf16_f32 v242, v246, v247
MV 168,v,36,v,72
v_cvt_pk_bf16_f32 v243, v248, v249
v_cvt_pk_bf16_f32 v244, v250, v251
MV 172,v,36,v,76
TR 36,221,32768
TR 38,221,33792
MV 176,v,40,v,64
s_add_u32 s75, s64, s74
v_cvt_pk_bf16_f32 v245, v252, v253
MV 180,v,40,v,68
s_add_u32 s36, s31, 8192
buffer_store_dwordx4 v[242:245], v228, s[16:19], s36 offen sc1
MV 184,v,40,v,72
s_add_u32 m0, s67, 0
v_accvgpr_read_b32 v234, a128
MV 188,v,40,v,76
TR 40,222,32768
TR 42,222,33792
MV 192,v,44,v,64
buffer_load_dwordx4 v208, s[44:47], s75 offen offset:0 lds
v_accvgpr_read_b32 v235, a129
MV 196,v,44,v,68
v_accvgpr_read_b32 v236, a130
v_accvgpr_read_b32 v237, a131
MV 200,v,44,v,72
MV 204,v,44,v,76
TR 44,223,32768
TR 46,223,33792
s_waitcnt lgkmcnt(4)
MV 80,v,16,v,48
buffer_load_dwordx4 v209, s[44:47], s75 offen offset:1024 lds
v_accvgpr_read_b32 v238, a132
MV 84,v,16,v,52
ds_read_b128 v[64:67], v225 offset:32768
v_accvgpr_read_b32 v239, a133
MV 88,v,16,v,56
buffer_load_dwordx4 v210, s[44:47], s75 offen offset:2048 lds
v_accvgpr_read_b32 v240, a134
MV 92,v,16,v,60
TR 16,216,40960
TR 18,216,41984
MV 96,v,20,v,48
v_accvgpr_read_b32 v241, a135
MV 100,v,20,v,52
buffer_load_dwordx4 v211, s[44:47], s75 offen offset:3072 lds
v_cvt_pk_bf16_f32 v230, v234, v235
MV 104,v,20,v,56
ds_read_b128 v[68:71], v225 offset:34816
v_cvt_pk_bf16_f32 v231, v236, v237
MV 108,v,20,v,60
TR 20,217,40960
TR 22,217,41984
MV 112,v,24,v,48
s_add_u32 s75, s65, s74
v_cvt_pk_bf16_f32 v232, v238, v239
MV 116,v,24,v,52
v_cvt_pk_bf16_f32 v233, v240, v241
MV 120,v,24,v,56
s_add_u32 s36, s24, 16384
MV 124,v,24,v,60
TR 24,218,40960
TR 26,218,41984
MV 128,v,28,v,48
ds_read_b128 v[72:75], v225 offset:36864
s_add_u32 m0, s67, 4096
MV 132,v,28,v,52
buffer_store_dwordx4 v[230:233], v228, s[16:19], s36 offen sc1
v_accvgpr_read_b32 v246, a136
MV 136,v,28,v,56
buffer_load_dwordx4 v208, s[44:47], s75 offen offset:0 lds
MV 140,v,28,v,60
TR 28,219,40960
TR 30,219,41984
MV 144,v,32,v,48
buffer_load_dwordx4 v209, s[44:47], s75 offen offset:1024 lds
v_accvgpr_read_b32 v247, a137
MV 148,v,32,v,52
v_accvgpr_read_b32 v248, a138
v_accvgpr_read_b32 v249, a139
MV 152,v,32,v,56
ds_read_b128 v[76:79], v225 offset:38912
MV 156,v,32,v,60
TR 32,220,40960
TR 34,220,41984
MV 160,v,36,v,48
buffer_load_dwordx4 v210, s[44:47], s75 offen offset:2048 lds
v_accvgpr_read_b32 v250, a140
MV 164,v,36,v,52
v_accvgpr_read_b32 v251, a141
v_accvgpr_read_b32 v252, a142
MV 168,v,36,v,56
buffer_load_dwordx4 v211, s[44:47], s75 offen offset:3072 lds
MV 172,v,36,v,60
TR 36,221,40960
TR 38,221,41984
s_waitcnt lgkmcnt(15)
MV 176,v,40,v,48
v_accvgpr_read_b32 v253, a143
v_cvt_pk_bf16_f32 v242, v246, v247
MV 180,v,40,v,52
s_add_u32 s74, s74, 128
v_cvt_pk_bf16_f32 v243, v248, v249
MV 184,v,40,v,56
MV 188,v,40,v,60
TR 40,222,40960
TR 42,222,41984
MV 192,v,44,v,48
s_and_b32 s74, s74, 2047
v_cvt_pk_bf16_f32 v244, v250, v251
MV 196,v,44,v,52
v_cvt_pk_bf16_f32 v245, v252, v253
MV 200,v,44,v,56
MV 204,v,44,v,60
TR 44,223,40960
TR 46,223,41984
s_waitcnt lgkmcnt(4)
MV 80,v,16,v,64
s_add_u32 s36, s25, 16384
MV 84,v,16,v,68
buffer_store_dwordx4 v[242:245], v228, s[16:19], s36 offen sc1
MV 88,v,16,v,72
v_accvgpr_read_b32 v234, a144
MV 92,v,16,v,76
MV 96,v,20,v,64
v_accvgpr_read_b32 v235, a145
MV 100,v,20,v,68
v_accvgpr_read_b32 v236, a146
MV 104,v,20,v,72
v_accvgpr_read_b32 v237, a147
MV 108,v,20,v,76
s_waitcnt vmcnt(16) lgkmcnt(0)
s_barrier
MV 112,v,24,v,64
TR 16,216,0
TR 18,216,1024
MV 116,v,24,v,68
ds_read_b128 v[48:51], v226 offset:0
s_add_u32 m0, s68, 131072
MV 120,v,24,v,72
TR 20,217,0
TR 22,217,1024
MV 124,v,24,v,76
buffer_load_dwordx4 v212, s[48:51], s66 offen offset:0 lds
v_accvgpr_read_b32 v238, a148
MV 128,v,28,v,64
TR 24,218,0
TR 26,218,1024
MV 132,v,28,v,68
ds_read_b128 v[52:55], v226 offset:2048
buffer_load_dwordx4 v213, s[48:51], s66 offen offset:1024 lds
MV 136,v,28,v,72
buffer_load_dwordx4 v214, s[48:51], s66 offen offset:2048 lds
v_accvgpr_read_b32 v239, a149
MV 140,v,28,v,76
TR 28,219,0
TR 30,219,1024
MV 144,v,32,v,64
ds_read_b128 v[56:59], v226 offset:4096
v_accvgpr_read_b32 v240, a150
MV 148,v,32,v,68
buffer_load_dwordx4 v215, s[48:51], s66 offen offset:3072 lds
v_accvgpr_read_b32 v241, a151
MV 152,v,32,v,72
v_cvt_pk_bf16_f32 v230, v234, v235
v_cvt_pk_bf16_f32 v231, v236, v237
MV 156,v,32,v,76
TR 32,220,0
TR 34,220,1024
MV 160,v,36,v,64
ds_read_b128 v[60:63], v226 offset:6144
s_add_u32 s66, s66, 524288
MV 164,v,36,v,68
s_and_b32 s66, s66, 8388607
v_cvt_pk_bf16_f32 v232, v238, v239
MV 168,v,36,v,72
v_cvt_pk_bf16_f32 v233, v240, v241
s_add_u32 s36, s26, 16384
MV 172,v,36,v,76
TR 36,221,0
TR 38,221,1024
MV 176,v,40,v,64
s_add_u32 s75, s64, s74
buffer_store_dwordx4 v[230:233], v228, s[16:19], s36 offen sc1
MV 180,v,40,v,68
v_accvgpr_read_b32 v246, a152
v_accvgpr_read_b32 v247, a153
MV 184,v,40,v,72
s_add_u32 m0, s67, 32768
v_accvgpr_read_b32 v248, a154
MV 188,v,40,v,76
TR 40,222,0
TR 42,222,1024
MV 192,v,44,v,64
buffer_load_dwordx4 v208, s[44:47], s75 offen offset:0 lds
v_accvgpr_read_b32 v249, a155
MV 196,v,44,v,68
v_accvgpr_read_b32 v250, a156
v_accvgpr_read_b32 v251, a157
MV 200,v,44,v,72
MV 204,v,44,v,76
TR 44,223,0
TR 46,223,1024
s_waitcnt lgkmcnt(4)
MV 80,v,16,v,48
buffer_load_dwordx4 v209, s[44:47], s75 offen offset:1024 lds
v_accvgpr_read_b32 v252, a158
MV 84,v,16,v,52
ds_read_b128 v[64:67], v227 offset:0
v_accvgpr_read_b32 v253, a159
MV 88,v,16,v,56
buffer_load_dwordx4 v210, s[44:47], s75 offen offset:2048 lds
v_cvt_pk_bf16_f32 v242, v246, v247
MV 92,v,16,v,60
TR 16,216,8192
TR 18,216,9216
MV 96,v,20,v,48
v_cvt_pk_bf16_f32 v243, v248, v249
MV 100,v,20,v,52
buffer_load_dwordx4 v211, s[44:47], s75 offen offset:3072 lds
v_cvt_pk_bf16_f32 v244, v250, v251
MV 104,v,20,v,56
ds_read_b128 v[68:71], v227 offset:2048
v_cvt_pk_bf16_f32 v245, v252, v253
MV 108,v,20,v,60
TR 20,217,8192
TR 22,217,9216
MV 112,v,24,v,48
s_add_u32 s75, s65, s74
s_add_u32 s36, s27, 16384
MV 116,v,24,v,52
buffer_store_dwordx4 v[242:245], v228, s[16:19], s36 offen sc1
MV 120,v,24,v,56
v_accvgpr_read_b32 v234, a160
MV 124,v,24,v,60
TR 24,218,8192
TR 26,218,9216
MV 128,v,28,v,48
ds_read_b128 v[72:75], v227 offset:4096
s_add_u32 m0, s67, 36864
MV 132,v,28,v,52
v_accvgpr_read_b32 v235, a161
v_accvgpr_read_b32 v236, a162
MV 136,v,28,v,56
buffer_load_dwordx4 v208, s[44:47], s75 offen offset:0 lds
MV 140,v,28,v,60
TR 28,219,8192
TR 30,219,9216
MV 144,v,32,v,48
buffer_load_dwordx4 v209, s[44:47], s75 offen offset:1024 lds
v_accvgpr_read_b32 v237, a163
MV 148,v,32,v,52
v_accvgpr_read_b32 v238, a164
v_accvgpr_read_b32 v239, a165
MV 152,v,32,v,56
ds_read_b128 v[76:79], v227 offset:6144
MV 156,v,32,v,60
TR 32,220,8192
TR 34,220,9216
MV 160,v,36,v,48
buffer_load_dwordx4 v210, s[44:47], s75 offen offset:2048 lds
v_accvgpr_read_b32 v240, a166
MV 164,v,36,v,52
v_accvgpr_read_b32 v241, a167
v_cvt_pk_bf16_f32 v230, v234, v235
MV 168,v,36,v,56
buffer_load_dwordx4 v211, s[44:47], s75 offen offset:3072 lds
MV 172,v,36,v,60
TR 36,221,8192
TR 38,221,9216
s_waitcnt lgkmcnt(15)
MV 176,v,40,v,48
v_cvt_pk_bf16_f32 v231, v236, v237
v_cvt_pk_bf16_f32 v232, v238, v239
MV 180,v,40,v,52
s_add_u32 s74, s74, 128
v_cvt_pk_bf16_f32 v233, v240, v241
MV 184,v,40,v,56
MV 188,v,40,v,60
TR 40,222,8192
TR 42,222,9216
MV 192,v,44,v,48
s_and_b32 s74, s74, 2047
s_add_u32 s36, s28, 16384
MV 196,v,44,v,52
buffer_store_dwordx4 v[230:233], v228, s[16:19], s36 offen sc1
MV 200,v,44,v,56
MV 204,v,44,v,60
TR 44,223,8192
TR 46,223,9216
s_waitcnt lgkmcnt(4)
MV 80,v,16,v,64
v_accvgpr_read_b32 v246, a168
MV 84,v,16,v,68
v_accvgpr_read_b32 v247, a169
MV 88,v,16,v,72
v_accvgpr_read_b32 v248, a170
MV 92,v,16,v,76
MV 96,v,20,v,64
v_accvgpr_read_b32 v249, a171
MV 100,v,20,v,68
v_accvgpr_read_b32 v250, a172
MV 104,v,20,v,72
v_accvgpr_read_b32 v251, a173
MV 108,v,20,v,76
s_waitcnt vmcnt(16) lgkmcnt(0)
s_barrier
MV 112,v,24,v,64
TR 16,216,16384
TR 18,216,17408
MV 116,v,24,v,68
ds_read_b128 v[48:51], v224 offset:0
s_add_u32 m0, s68, 98304
MV 120,v,24,v,72
TR 20,217,16384
TR 22,217,17408
MV 124,v,24,v,76
buffer_load_dwordx4 v212, s[48:51], s66 offen offset:0 lds
v_accvgpr_read_b32 v252, a174
MV 128,v,28,v,64
TR 24,218,16384
TR 26,218,17408
MV 132,v,28,v,68
ds_read_b128 v[52:55], v224 offset:2048
buffer_load_dwordx4 v213, s[48:51], s66 offen offset:1024 lds
MV 136,v,28,v,72
buffer_load_dwordx4 v214, s[48:51], s66 offen offset:2048 lds
v_accvgpr_read_b32 v253, a175
MV 140,v,28,v,76
TR 28,219,16384
TR 30,219,17408
MV 144,v,32,v,64
ds_read_b128 v[56:59], v224 offset:4096
v_cvt_pk_bf16_f32 v242, v246, v247
MV 148,v,32,v,68
buffer_load_dwordx4 v215, s[48:51], s66 offen offset:3072 lds
v_cvt_pk_bf16_f32 v243, v248, v249
MV 152,v,32,v,72
v_cvt_pk_bf16_f32 v244, v250, v251
v_cvt_pk_bf16_f32 v245, v252, v253
MV 156,v,32,v,76
TR 32,220,16384
TR 34,220,17408
MV 160,v,36,v,64
ds_read_b128 v[60:63], v224 offset:6144
s_add_u32 s66, s66, 524288
MV 164,v,36,v,68
s_and_b32 s66, s66, 8388607
s_add_u32 s36, s29, 16384
MV 168,v,36,v,72
buffer_store_dwordx4 v[242:245], v228, s[16:19], s36 offen sc1
v_accvgpr_read_b32 v234, a176
MV 172,v,36,v,76
TR 36,221,16384
TR 38,221,17408
MV 176,v,40,v,64
s_add_u32 s75, s64, s74
v_accvgpr_read_b32 v235, a177
MV 180,v,40,v,68
v_accvgpr_read_b32 v236, a178
v_accvgpr_read_b32 v237, a179
MV 184,v,40,v,72
s_add_u32 m0, s67, 65536
v_accvgpr_read_b32 v238, a180
MV 188,v,40,v,76
TR 40,222,16384
TR 42,222,17408
MV 192,v,44,v,64
buffer_load_dwordx4 v208, s[44:47], s75 offen offset:0 lds
v_accvgpr_read_b32 v239, a181
MV 196,v,44,v,68
v_accvgpr_read_b32 v240, a182
v_accvgpr_read_b32 v241, a183
MV 200,v,44,v,72
MV 204,v,44,v,76
TR 44,223,16384
TR 46,223,17408
s_waitcnt lgkmcnt(4)
MV 80,v,16,v,48
buffer_load_dwordx4 v209, s[44:47], s75 offen offset:1024 lds
v_cvt_pk_bf16_f32 v230, v234, v235
MV 84,v,16,v,52
ds_read_b128 v[64:67], v225 offset:0
v_cvt_pk_bf16_f32 v231, v236, v237
MV 88,v,16,v,56
buffer_load_dwordx4 v210, s[44:47], s75 offen offset:2048 lds
v_cvt_pk_bf16_f32 v232, v238, v239
MV 92,v,16,v,60
TR 16,216,24576
TR 18,216,25600
MV 96,v,20,v,48
v_cvt_pk_bf16_f32 v233, v240, v241
MV 100,v,20,v,52
buffer_load_dwordx4 v211, s[44:47], s75 offen offset:3072 lds
s_add_u32 s36, s30, 16384
MV 104,v,20,v,56
ds_read_b128 v[68:71], v225 offset:2048
buffer_store_dwordx4 v[230:233], v228, s[16:19], s36 offen sc1
MV 108,v,20,v,60
TR 20,217,24576
TR 22,217,25600
MV 112,v,24,v,48
s_add_u32 s75, s65, s74
v_accvgpr_read_b32 v246, a184
MV 116,v,24,v,52
v_accvgpr_read_b32 v247, a185
MV 120,v,24,v,56
v_accvgpr_read_b32 v248, a186
MV 124,v,24,v,60
TR 24,218,24576
TR 26,218,25600
MV 128,v,28,v,48
ds_read_b128 v[72:75], v225 offset:4096
s_add_u32 m0, s67, 69632
MV 132,v,28,v,52
v_accvgpr_read_b32 v249, a187
v_accvgpr_read_b32 v250, a188
MV 136,v,28,v,56
buffer_load_dwordx4 v208, s[44:47], s75 offen offset:0 lds
v_accvgpr_read_b32 v251, a189
MV 140,v,28,v,60
TR 28,219,24576
TR 30,219,25600
MV 144,v,32,v,48
buffer_load_dwordx4 v209, s[44:47], s75 offen offset:1024 lds
v_accvgpr_read_b32 v252, a190
MV 148,v,32,v,52
v_accvgpr_read_b32 v253, a191
MV 152,v,32,v,56
ds_read_b128 v[76:79], v225 offset:6144
v_cvt_pk_bf16_f32 v242, v246, v247
MV 156,v,32,v,60
TR 32,220,24576
TR 34,220,25600
MV 160,v,36,v,48
buffer_load_dwordx4 v210, s[44:47], s75 offen offset:2048 lds
v_cvt_pk_bf16_f32 v243, v248, v249
MV 164,v,36,v,52
v_cvt_pk_bf16_f32 v244, v250, v251
MV 168,v,36,v,56
buffer_load_dwordx4 v211, s[44:47], s75 offen offset:3072 lds
v_cvt_pk_bf16_f32 v245, v252, v253
MV 172,v,36,v,60
TR 36,221,24576
TR 38,221,25600
s_waitcnt lgkmcnt(15)
MV 176,v,40,v,48
s_add_u32 s36, s31, 16384
buffer_store_dwordx4 v[242:245], v228, s[16:19], s36 offen sc1
MV 180,v,40,v,52
s_add_u32 s74, s74, 128
MV 184,v,40,v,56
v_accvgpr_read_b32 v234, a192
MV 188,v,40,v,60
TR 40,222,24576
TR 42,222,25600
MV 192,v,44,v,48
s_and_b32 s74, s74, 2047
v_accvgpr_read_b32 v235, a193
MV 196,v,44,v,52
buffer_load_dword v254, off, s[12:15], 0 sc1
MV 200,v,44,v,56
MV 204,v,44,v,60
TR 44,223,24576
TR 46,223,25600
s_waitcnt lgkmcnt(4)
MV 80,v,16,v,64
v_accvgpr_read_b32 v236, a194
MV 84,v,16,v,68
v_accvgpr_read_b32 v237, a195
MV 88,v,16,v,72
v_accvgpr_read_b32 v238, a196
MV 92,v,16,v,76
MV 96,v,20,v,64
v_accvgpr_read_b32 v239, a197
MV 100,v,20,v,68
v_accvgpr_read_b32 v240, a198
MV 104,v,20,v,72
v_accvgpr_read_b32 v241, a199
MV 108,v,20,v,76
s_waitcnt vmcnt(17) lgkmcnt(0)
s_barrier
MV 112,v,24,v,64
TR 16,216,32768
TR 18,216,33792
MV 116,v,24,v,68
ds_read_b128 v[48:51], v224 offset:32768
s_add_u32 m0, s68, 114688
MV 120,v,24,v,72
TR 20,217,32768
TR 22,217,33792
MV 124,v,24,v,76
buffer_load_dwordx4 v212, s[48:51], s66 offen offset:0 lds
v_cvt_pk_bf16_f32 v230, v234, v235
MV 128,v,28,v,64
TR 24,218,32768
TR 26,218,33792
MV 132,v,28,v,68
ds_read_b128 v[52:55], v224 offset:34816
buffer_load_dwordx4 v213, s[48:51], s66 offen offset:1024 lds
MV 136,v,28,v,72
buffer_load_dwordx4 v214, s[48:51], s66 offen offset:2048 lds
v_cvt_pk_bf16_f32 v231, v236, v237
MV 140,v,28,v,76
TR 28,219,32768
TR 30,219,33792
MV 144,v,32,v,64
ds_read_b128 v[56:59], v224 offset:36864
v_cvt_pk_bf16_f32 v232, v238, v239
MV 148,v,32,v,68
buffer_load_dwordx4 v215, s[48:51], s66 offen offset:3072 lds
v_cvt_pk_bf16_f32 v233, v240, v241
MV 152,v,32,v,72
s_add_u32 s36, s24, 24576
buffer_store_dwordx4 v[230:233], v228, s[16:19], s36 offen sc1
MV 156,v,32,v,76
TR 32,220,32768
TR 34,220,33792
MV 160,v,36,v,64
ds_read_b128 v[60:63], v224 offset:38912
s_add_u32 s66, s66, 524288
MV 164,v,36,v,68
s_and_b32 s66, s66, 8388607
v_accvgpr_read_b32 v246, a200
MV 168,v,36,v,72
v_accvgpr_read_b32 v247, a201
v_accvgpr_read_b32 v248, a202
MV 172,v,36,v,76
TR 36,221,32768
TR 38,221,33792
MV 176,v,40,v,64
s_add_u32 s75, s64, s74
v_accvgpr_read_b32 v249, a203
MV 180,v,40,v,68
v_accvgpr_read_b32 v250, a204
v_accvgpr_read_b32 v251, a205
MV 184,v,40,v,72
s_add_u32 m0, s67, 0
v_accvgpr_read_b32 v252, a206
MV 188,v,40,v,76
TR 40,222,32768
TR 42,222,33792
MV 192,v,44,v,64
buffer_load_dwordx4 v208, s[44:47], s75 offen offset:0 lds
v_accvgpr_read_b32 v253, a207
MV 196,v,44,v,68
v_cvt_pk_bf16_f32 v242, v246, v247
v_cvt_pk_bf16_f32 v243, v248, v249
MV 200,v,44,v,72
MV 204,v,44,v,76
TR 44,223,32768
TR 46,223,33792
s_waitcnt lgkmcnt(4)
MV 80,v,16,v,48
buffer_load_dwordx4 v209, s[44:47], s75 offen offset:1024 lds
v_cvt_pk_bf16_f32 v244, v250, v251
MV 84,v,16,v,52
ds_read_b128 v[64:67], v225 offset:32768
v_cvt_pk_bf16_f32 v245, v252, v253
MV 88,v,16,v,56
buffer_load_dwordx4 v210, s[44:47], s75 offen offset:2048 lds
s_add_u32 s36, s25, 24576
MV 92,v,16,v,60
TR 16,216,40960
TR 18,216,41984
MV 96,v,20,v,48
buffer_store_dwordx4 v[242:245], v228, s[16:19], s36 offen sc1
MV 100,v,20,v,52
buffer_load_dwordx4 v211, s[44:47], s75 offen offset:3072 lds
v_accvgpr_read_b32 v234, a208
MV 104,v,20,v,56
ds_read_b128 v[68:71], v225 offset:34816
v_accvgpr_read_b32 v235, a209
MV 108,v,20,v,60
TR 20,217,40960
TR 22,217,41984
MV 112,v,24,v,48
s_add_u32 s75, s65, s74
v_accvgpr_read_b32 v236, a210
MV 116,v,24,v,52
v_accvgpr_read_b32 v237, a211
MV 120,v,24,v,56
v_accvgpr_read_b32 v238, a212
MV 124,v,24,v,60
TR 24,218,40960
TR 26,218,41984
MV 128,v,28,v,48
ds_read_b128 v[72:75], v225 offset:36864
s_add_u32 m0, s67, 4096
MV 132,v,28,v,52
v_accvgpr_read_b32 v239, a213
v_accvgpr_read_b32 v240, a214
MV 136,v,28,v,56
buffer_load_dwordx4 v208, s[44:47], s75 offen offset:0 lds
MV 140,v,28,v,60
TR 28,219,40960
TR 30,219,41984
MV 144,v,32,v,48
buffer_load_dwordx4 v209, s[44:47], s75 offen offset:1024 lds
v_accvgpr_read_b32 v241, a215
MV 148,v,32,v,52
v_cvt_pk_bf16_f32 v230, v234, v235
v_cvt_pk_bf16_f32 v231, v236, v237
MV 152,v,32,v,56
ds_read_b128 v[76:79], v225 offset:38912
MV 156,v,32,v,60
TR 32,220,40960
TR 34,220,41984
MV 160,v,36,v,48
buffer_load_dwordx4 v210, s[44:47], s75 offen offset:2048 lds
v_cvt_pk_bf16_f32 v232, v238, v239
MV 164,v,36,v,52
v_cvt_pk_bf16_f32 v233, v240, v241
s_add_u32 s36, s26, 24576
MV 168,v,36,v,56
buffer_load_dwordx4 v211, s[44:47], s75 offen offset:3072 lds
MV 172,v,36,v,60
TR 36,221,40960
TR 38,221,41984
s_waitcnt lgkmcnt(15)
MV 176,v,40,v,48
buffer_store_dwordx4 v[230:233], v228, s[16:19], s36 offen sc1
v_accvgpr_read_b32 v246, a216
MV 180,v,40,v,52
s_add_u32 s74, s74, 128
v_accvgpr_read_b32 v247, a217
MV 184,v,40,v,56
MV 188,v,40,v,60
TR 40,222,40960
TR 42,222,41984
MV 192,v,44,v,48
s_and_b32 s74, s74, 2047
v_accvgpr_read_b32 v248, a218
MV 196,v,44,v,52
v_accvgpr_read_b32 v249, a219
MV 200,v,44,v,56
MV 204,v,44,v,60
TR 44,223,40960
TR 46,223,41984
s_waitcnt lgkmcnt(4)
MV 80,v,16,v,64
v_accvgpr_read_b32 v250, a220
MV 84,v,16,v,68
v_accvgpr_read_b32 v251, a221
MV 88,v,16,v,72
v_accvgpr_read_b32 v252, a222
MV 92,v,16,v,76
MV 96,v,20,v,64
v_accvgpr_read_b32 v253, a223
MV 100,v,20,v,68
v_cvt_pk_bf16_f32 v242, v246, v247
MV 104,v,20,v,72
v_cvt_pk_bf16_f32 v243, v248, v249
MV 108,v,20,v,76
s_waitcnt vmcnt(17) lgkmcnt(0)
s_barrier
MV 112,v,24,v,64
TR 16,216,0
TR 18,216,1024
MV 116,v,24,v,68
ds_read_b128 v[48:51], v226 offset:0
s_add_u32 m0, s68, 131072
MV 120,v,24,v,72
TR 20,217,0
TR 22,217,1024
MV 124,v,24,v,76
buffer_load_dwordx4 v212, s[48:51], s66 offen offset:0 lds
v_cvt_pk_bf16_f32 v244, v250, v251
MV 128,v,28,v,64
TR 24,218,0
TR 26,218,1024
MV 132,v,28,v,68
ds_read_b128 v[52:55], v226 offset:2048
buffer_load_dwordx4 v213, s[48:51], s66 offen offset:1024 lds
MV 136,v,28,v,72
buffer_load_dwordx4 v214, s[48:51], s66 offen offset:2048 lds
v_cvt_pk_bf16_f32 v245, v252, v253
MV 140,v,28,v,76
TR 28,219,0
TR 30,219,1024
MV 144,v,32,v,64
ds_read_b128 v[56:59], v226 offset:4096
s_add_u32 s36, s27, 24576
MV 148,v,32,v,68
buffer_load_dwordx4 v215, s[48:51], s66 offen offset:3072 lds
buffer_store_dwordx4 v[242:245], v228, s[16:19], s36 offen sc1
MV 152,v,32,v,72
v_accvgpr_read_b32 v234, a224
v_accvgpr_read_b32 v235, a225
MV 156,v,32,v,76
TR 32,220,0
TR 34,220,1024
MV 160,v,36,v,64
ds_read_b128 v[60:63], v226 offset:6144
s_add_u32 s66, s66, 524288
MV 164,v,36,v,68
s_and_b32 s66, s66, 8388607
v_accvgpr_read_b32 v236, a226
MV 168,v,36,v,72
v_accvgpr_read_b32 v237, a227
v_accvgpr_read_b32 v238, a228
MV 172,v,36,v,76
TR 36,221,0
TR 38,221,1024
MV 176,v,40,v,64
s_add_u32 s75, s64, s74
v_accvgpr_read_b32 v239, a229
MV 180,v,40,v,68
v_accvgpr_read_b32 v240, a230
v_accvgpr_read_b32 v241, a231
MV 184,v,40,v,72
s_add_u32 m0, s67, 32768
v_cvt_pk_bf16_f32 v230, v234, v235
MV 188,v,40,v,76
TR 40,222,0
TR 42,222,1024
MV 192,v,44,v,64
buffer_load_dwordx4 v208, s[44:47], s75 offen offset:0 lds
v_cvt_pk_bf16_f32 v231, v236, v237
MV 196,v,44,v,68
v_cvt_pk_bf16_f32 v232, v238, v239
v_cvt_pk_bf16_f32 v233, v240, v241
MV 200,v,44,v,72
MV 204,v,44,v,76
TR 44,223,0
TR 46,223,1024
s_waitcnt lgkmcnt(4)
MV 80,v,16,v,48
buffer_load_dwordx4 v209, s[44:47], s75 offen offset:1024 lds
s_add_u32 s36, s28, 24576
MV 84,v,16,v,52
ds_read_b128 v[64:67], v227 offset:0
buffer_store_dwordx4 v[230:233], v228, s[16:19], s36 offen sc1
MV 88,v,16,v,56
buffer_load_dwordx4 v210, s[44:47], s75 offen offset:2048 lds
v_accvgpr_read_b32 v246, a232
MV 92,v,16,v,60
TR 16,216,8192
TR 18,216,9216
MV 96,v,20,v,48
v_accvgpr_read_b32 v247, a233
MV 100,v,20,v,52
buffer_load_dwordx4 v211, s[44:47], s75 offen offset:3072 lds
v_accvgpr_read_b32 v248, a234
MV 104,v,20,v,56
ds_read_b128 v[68:71], v227 offset:2048
v_accvgpr_read_b32 v249, a235
MV 108,v,20,v,60
TR 20,217,8192
TR 22,217,9216
MV 112,v,24,v,48
s_add_u32 s75, s65, s74
v_accvgpr_read_b32 v250, a236
MV 116,v,24,v,52
v_accvgpr_read_b32 v251, a237
MV 120,v,24,v,56
v_accvgpr_read_b32 v252, a238
MV 124,v,24,v,60
TR 24,218,8192
TR 26,218,9216
MV 128,v,28,v,48
ds_read_b128 v[72:75], v227 offset:4096
s_add_u32 m0, s67, 36864
MV 132,v,28,v,52
v_accvgpr_read_b32 v253, a239
v_cvt_pk_bf16_f32 v242, v246, v247
MV 136,v,28,v,56
buffer_load_dwordx4 v208, s[44:47], s75 offen offset:0 lds
MV 140,v,28,v,60
TR 28,219,8192
TR 30,219,9216
MV 144,v,32,v,48
buffer_load_dwordx4 v209, s[44:47], s75 offen offset:1024 lds
v_cvt_pk_bf16_f32 v243, v248, v249
MV 148,v,32,v,52
v_cvt_pk_bf16_f32 v244, v250, v251
v_cvt_pk_bf16_f32 v245, v252, v253
MV 152,v,32,v,56
ds_read_b128 v[76:79], v227 offset:6144
MV 156,v,32,v,60
TR 32,220,8192
TR 34,220,9216
MV 160,v,36,v,48
buffer_load_dwordx4 v210, s[44:47], s75 offen offset:2048 lds
s_add_u32 s36, s29, 24576
MV 164,v,36,v,52
buffer_store_dwordx4 v[242:245], v228, s[16:19], s36 offen sc1
v_accvgpr_read_b32 v234, a240
MV 168,v,36,v,56
buffer_load_dwordx4 v211, s[44:47], s75 offen offset:3072 lds
MV 172,v,36,v,60
TR 36,221,8192
TR 38,221,9216
s_waitcnt lgkmcnt(15)
MV 176,v,40,v,48
v_accvgpr_read_b32 v235, a241
v_accvgpr_read_b32 v236, a242
MV 180,v,40,v,52
s_add_u32 s74, s74, 128
v_accvgpr_read_b32 v237, a243
MV 184,v,40,v,56
MV 188,v,40,v,60
TR 40,222,8192
TR 42,222,9216
MV 192,v,44,v,48
s_and_b32 s74, s74, 2047
v_accvgpr_read_b32 v238, a244
MV 196,v,44,v,52
v_accvgpr_read_b32 v239, a245
MV 200,v,44,v,56
MV 204,v,44,v,60
TR 44,223,8192
TR 46,223,9216
s_waitcnt lgkmcnt(4)
MV 80,v,16,v,64
v_accvgpr_read_b32 v240, a246
MV 84,v,16,v,68
v_accvgpr_read_b32 v241, a247
MV 88,v,16,v,72
v_cvt_pk_bf16_f32 v230, v234, v235
MV 92,v,16,v,76
MV 96,v,20,v,64
v_cvt_pk_bf16_f32 v231, v236, v237
MV 100,v,20,v,68
v_cvt_pk_bf16_f32 v232, v238, v239
MV 104,v,20,v,72
v_cvt_pk_bf16_f32 v233, v240, v241
MV 108,v,20,v,76
s_waitcnt vmcnt(16) lgkmcnt(0)
s_barrier
MV 112,v,24,v,64
TR 16,216,16384
TR 18,216,17408
MV 116,v,24,v,68
ds_read_b128 v[48:51], v224 offset:0
s_add_u32 m0, s68, 98304
MV 120,v,24,v,72
TR 20,217,16384
TR 22,217,17408
MV 124,v,24,v,76
buffer_load_dwordx4 v212, s[48:51], s66 offen offset:0 lds
s_add_u32 s36, s30, 24576
MV 128,v,28,v,64
TR 24,218,16384
TR 26,218,17408
MV 132,v,28,v,68
ds_read_b128 v[52:55], v224 offset:2048
buffer_load_dwordx4 v213, s[48:51], s66 offen offset:1024 lds
MV 136,v,28,v,72
buffer_load_dwordx4 v214, s[48:51], s66 offen offset:2048 lds
buffer_store_dwordx4 v[230:233], v228, s[16:19], s36 offen sc1
MV 140,v,28,v,76
TR 28,219,16384
TR 30,219,17408
MV 144,v,32,v,64
ds_read_b128 v[56:59], v224 offset:4096
v_accvgpr_read_b32 v246, a248
MV 148,v,32,v,68
buffer_load_dwordx4 v215, s[48:51], s66 offen offset:3072 lds
v_accvgpr_read_b32 v247, a249
MV 152,v,32,v,72
v_accvgpr_read_b32 v248, a250
v_accvgpr_read_b32 v249, a251
MV 156,v,32,v,76
TR 32,220,16384
TR 34,220,17408
MV 160,v,36,v,64
ds_read_b128 v[60:63], v224 offset:6144
s_add_u32 s66, s66, 524288
MV 164,v,36,v,68
s_and_b32 s66, s66, 8388607
v_accvgpr_read_b32 v250, a252
MV 168,v,36,v,72
v_accvgpr_read_b32 v251, a253
v_accvgpr_read_b32 v252, a254
MV 172,v,36,v,76
TR 36,221,16384
TR 38,221,17408
MV 176,v,40,v,64
s_add_u32 s75, s64, s74
v_accvgpr_read_b32 v253, a255
MV 180,v,40,v,68
v_cvt_pk_bf16_f32 v242, v246, v247
v_cvt_pk_bf16_f32 v243, v248, v249
MV 184,v,40,v,72
s_add_u32 m0, s67, 65536
v_cvt_pk_bf16_f32 v244, v250, v251
MV 188,v,40,v,76
TR 40,222,16384
TR 42,222,17408
MV 192,v,44,v,64
buffer_load_dwordx4 v208, s[44:47], s75 offen offset:0 lds
v_cvt_pk_bf16_f32 v245, v252, v253
MV 196,v,44,v,68
s_add_u32 s36, s31, 24576
buffer_store_dwordx4 v[242:245], v228, s[16:19], s36 offen sc1
MV 200,v,44,v,72
MV 204,v,44,v,76
TR 44,223,16384
TR 46,223,17408
s_waitcnt lgkmcnt(4)
MV 80,v,16,v,48
buffer_load_dwordx4 v209, s[44:47], s75 offen offset:1024 lds
v_lshlrev_b32 v255, 20, v1
MV 84,v,16,v,52
ds_read_b128 v[64:67], v225 offset:0
MV 88,v,16,v,56
buffer_load_dwordx4 v210, s[44:47], s75 offen offset:2048 lds
MV 92,v,16,v,60
TR 16,216,24576
TR 18,216,25600
MV 96,v,20,v,48
MV 100,v,20,v,52
buffer_load_dwordx4 v211, s[44:47], s75 offen offset:3072 lds
MV 104,v,20,v,56
ds_read_b128 v[68:71], v225 offset:2048
MV 108,v,20,v,60
TR 20,217,24576
TR 22,217,25600
MV 112,v,24,v,48
s_add_u32 s75, s65, s74
MV 116,v,24,v,52
MV 120,v,24,v,56
s_lshl_b32 s36, s3, 26
MV 124,v,24,v,60
TR 24,218,24576
TR 26,218,25600
MV 128,v,28,v,48
ds_read_b128 v[72:75], v225 offset:4096
s_add_u32 m0, s67, 69632
MV 132,v,28,v,52
MV 136,v,28,v,56
buffer_load_dwordx4 v208, s[44:47], s75 offen offset:0 lds
MV 140,v,28,v,60
TR 28,219,24576
TR 30,219,25600
MV 144,v,32,v,48
buffer_load_dwordx4 v209, s[44:47], s75 offen offset:1024 lds
MV 148,v,32,v,52
MV 152,v,32,v,56
ds_read_b128 v[76:79], v225 offset:6144
MV 156,v,32,v,60
TR 32,220,24576
TR 34,220,25600
MV 160,v,36,v,48
buffer_load_dwordx4 v210, s[44:47], s75 offen offset:2048 lds
v_add_u32 v255, s36, v255
MV 164,v,36,v,52
MV 168,v,36,v,56
buffer_load_dwordx4 v211, s[44:47], s75 offen offset:3072 lds
MV 172,v,36,v,60
TR 36,221,24576
TR 38,221,25600
s_waitcnt lgkmcnt(15)
MV 176,v,40,v,48
MV 180,v,40,v,52
s_add_u32 s74, s74, 128
MV 184,v,40,v,56
MV 188,v,40,v,60
TR 40,222,24576
TR 42,222,25600
MV 192,v,44,v,48
s_and_b32 s74, s74, 2047
MV 196,v,44,v,52
MV 200,v,44,v,56
MV 204,v,44,v,60
TR 44,223,24576
TR 46,223,25600
s_waitcnt lgkmcnt(4)
MV 80,v,16,v,64
v_lshlrev_b32 v230, 4, v1
MV 84,v,16,v,68
s_lshl_b32 s80, s3, 12
MV 88,v,16,v,72
MV 92,v,16,v,76
v_add_u32 v12, s80, v230
MV 96,v,20,v,64
v_add_u32 v10, 0x8000, v230
MV 100,v,20,v,68
MV 104,v,20,v,72
v_add_u32 v11, 0x10000, v230
MV 108,v,20,v,76
s_waitcnt vmcnt(14) lgkmcnt(0)
s_barrier
MV 112,v,24,v,64
TR 16,216,32768
TR 18,216,33792
MV 116,v,24,v,68
ds_read_b128 v[48:51], v224 offset:32768
s_add_u32 m0, s68, 114688
MV 120,v,24,v,72
TR 20,217,32768
TR 22,217,33792
MV 124,v,24,v,76
buffer_load_dwordx4 v212, s[48:51], s66 offen offset:0 lds
s_add_u32 s72, s80, 0x8000
MV 128,v,28,v,64
TR 24,218,32768
TR 26,218,33792
MV 132,v,28,v,68
ds_read_b128 v[52:55], v224 offset:34816
buffer_load_dwordx4 v213, s[48:51], s66 offen offset:1024 lds
MV 136,v,28,v,72
buffer_load_dwordx4 v214, s[48:51], s66 offen offset:2048 lds
s_add_u32 s73, s80, 0x10000
MV 140,v,28,v,76
TR 28,219,32768
TR 30,219,33792
MV 144,v,32,v,64
ds_read_b128 v[56:59], v224 offset:36864
v_and_b32 v230, 31, v1
MV 148,v,32,v,68
buffer_load_dwordx4 v215, s[48:51], s66 offen offset:3072 lds
v_lshrrev_b32 v232, 5, v1
MV 152,v,32,v,72
v_lshlrev_b32 v233, 2, v232
v_sub_u32 v13, v230, v233
MV 156,v,32,v,76
TR 32,220,32768
TR 34,220,33792
MV 160,v,36,v,64
ds_read_b128 v[60:63], v224 offset:38912
s_add_u32 s66, s66, 524288
MV 164,v,36,v,68
s_and_b32 s66, s66, 8388607
s_lshl_b32 s81, s3, 5
MV 168,v,36,v,72
v_add_u32 v13, s81, v13
v_mov_b32 v14, 0xff800000
MV 172,v,36,v,76
TR 36,221,32768
TR 38,221,33792
MV 176,v,40,v,64
s_add_u32 s75, s64, s74
v_and_b32 v230, 15, v1
MV 180,v,40,v,68
v_lshl_add_u32 v230, v232, 4, v230
v_lshlrev_b32 v230, 4, v230
MV 184,v,40,v,72
s_add_u32 m0, s67, 0
v_bfe_u32 v233, v1, 4, 1
MV 188,v,40,v,76
TR 40,222,32768
TR 42,222,33792
MV 192,v,44,v,64
buffer_load_dwordx4 v208, s[44:47], s75 offen offset:0 lds
v_lshl_add_u32 v15, v233, 17, v230
MV 196,v,44,v,68
MV 200,v,44,v,72
MV 204,v,44,v,76
TR 44,223,32768
TR 46,223,33792
s_waitcnt lgkmcnt(4)
MV 80,v,16,v,48
buffer_load_dwordx4 v209, s[44:47], s75 offen offset:1024 lds
v_accvgpr_write_b32 a0, 0
MV 84,v,16,v,52
ds_read_b128 v[64:67], v225 offset:32768
v_accvgpr_write_b32 a1, 0
MV 88,v,16,v,56
buffer_load_dwordx4 v210, s[44:47], s75 offen offset:2048 lds
MV 92,v,16,v,60
TR 16,216,40960
TR 18,216,41984
MV 96,v,20,v,48
v_accvgpr_write_b32 a2, 0
MV 100,v,20,v,52
buffer_load_dwordx4 v211, s[44:47], s75 offen offset:3072 lds
v_accvgpr_write_b32 a3, 0
MV 104,v,20,v,56
ds_read_b128 v[68:71], v225 offset:34816
MV 108,v,20,v,60
TR 20,217,40960
TR 22,217,41984
MV 112,v,24,v,48
s_add_u32 s75, s65, s74
v_accvgpr_write_b32 a4, 0
MV 116,v,24,v,52
v_accvgpr_write_b32 a5, 0
MV 120,v,24,v,56
MV 124,v,24,v,60
TR 24,218,40960
TR 26,218,41984
MV 128,v,28,v,48
ds_read_b128 v[72:75], v225 offset:36864
s_add_u32 m0, s67, 4096
MV 132,v,28,v,52
v_accvgpr_write_b32 a6, 0
v_accvgpr_write_b32 a7, 0
MV 136,v,28,v,56
buffer_load_dwordx4 v208, s[44:47], s75 offen offset:0 lds
MV 140,v,28,v,60
TR 28,219,40960
TR 30,219,41984
MV 144,v,32,v,48
buffer_load_dwordx4 v209, s[44:47], s75 offen offset:1024 lds
v_accvgpr_write_b32 a8, 0
MV 148,v,32,v,52
v_accvgpr_write_b32 a9, 0
MV 152,v,32,v,56
ds_read_b128 v[76:79], v225 offset:38912
v_accvgpr_write_b32 a10, 0
MV 156,v,32,v,60
TR 32,220,40960
TR 34,220,41984
MV 160,v,36,v,48
buffer_load_dwordx4 v210, s[44:47], s75 offen offset:2048 lds
v_accvgpr_write_b32 a11, 0
MV 164,v,36,v,52
MV 168,v,36,v,56
buffer_load_dwordx4 v211, s[44:47], s75 offen offset:3072 lds
v_accvgpr_write_b32 a12, 0
MV 172,v,36,v,60
TR 36,221,40960
TR 38,221,41984
s_waitcnt lgkmcnt(15)
MV 176,v,40,v,48
v_accvgpr_write_b32 a13, 0
MV 180,v,40,v,52
s_add_u32 s74, s74, 128
MV 184,v,40,v,56
v_accvgpr_write_b32 a14, 0
MV 188,v,40,v,60
TR 40,222,40960
TR 42,222,41984
MV 192,v,44,v,48
s_and_b32 s74, s74, 2047
v_accvgpr_write_b32 a15, 0
MV 196,v,44,v,52
MV 200,v,44,v,56
MV 204,v,44,v,60
TR 44,223,40960
TR 46,223,41984
s_waitcnt lgkmcnt(4)
MV 80,v,16,v,64
v_accvgpr_write_b32 a16, 0
MV 84,v,16,v,68
v_accvgpr_write_b32 a17, 0
MV 88,v,16,v,72
MV 92,v,16,v,76
v_accvgpr_write_b32 a18, 0
MV 96,v,20,v,64
MV 100,v,20,v,68
v_accvgpr_write_b32 a19, 0
MV 104,v,20,v,72
MV 108,v,20,v,76
s_waitcnt vmcnt(12) lgkmcnt(0)
s_barrier
MV 112,v,24,v,64
v_cmp_gt_u32 vcc, 1, v254
s_nop 4
s_cbranch_vccnz L_spin_go
L_spin_go_ret:
v_mov_b32 v254, 1
s_lshl_b32 s36, s2, 2
buffer_store_dword v254, v255, s[8:11], s36 offen offset:0 sc1
s_load_dwordx4 s[32:35], s[0:1], 32
MV 116,v,24,v,68
TR 16,216,0
TR 18,216,1024
MV 120,v,24,v,72
TR 20,217,0
TR 22,217,1024
MV 124,v,24,v,76
ds_read_b128 v[48:51], v226 offset:0
s_add_u32 m0, s68, 131072
MV 128,v,28,v,64
TR 24,218,0
TR 26,218,1024
MV 132,v,28,v,68
ds_read_b128 v[52:55], v226 offset:2048
buffer_load_dwordx4 v212, s[48:51], s66 offen offset:0 lds
MV 136,v,28,v,72
buffer_load_dwordx4 v213, s[48:51], s66 offen offset:1024 lds
buffer_load_dwordx4 v214, s[48:51], s66 offen offset:2048 lds
MV 140,v,28,v,76
TR 28,219,0
TR 30,219,1024
MV 144,v,32,v,64
ds_read_b128 v[56:59], v226 offset:4096
v_accvgpr_write_b32 a20, 0
MV 148,v,32,v,68
buffer_load_dwordx4 v215, s[48:51], s66 offen offset:3072 lds
v_accvgpr_write_b32 a21, 0
MV 152,v,32,v,72
v_accvgpr_write_b32 a22, 0
v_accvgpr_write_b32 a23, 0
MV 156,v,32,v,76
TR 32,220,0
TR 34,220,1024
MV 160,v,36,v,64
ds_read_b128 v[60:63], v226 offset:6144
s_add_u32 s66, s66, 524288
MV 164,v,36,v,68
s_and_b32 s66, s66, 8388607
v_accvgpr_write_b32 a24, 0
MV 168,v,36,v,72
v_accvgpr_write_b32 a25, 0
v_accvgpr_write_b32 a26, 0
MV 172,v,36,v,76
TR 36,221,0
TR 38,221,1024
MV 176,v,40,v,64
s_add_u32 s75, s64, s74
v_accvgpr_write_b32 a27, 0
MV 180,v,40,v,68
v_accvgpr_write_b32 a28, 0
v_accvgpr_write_b32 a29, 0
MV 184,v,40,v,72
s_add_u32 m0, s67, 32768
v_accvgpr_write_b32 a30, 0
MV 188,v,40,v,76
TR 40,222,0
TR 42,222,1024
MV 192,v,44,v,64
buffer_load_dwordx4 v208, s[44:47], s75 offen offset:0 lds
v_accvgpr_write_b32 a31, 0
MV 196,v,44,v,68
MV 200,v,44,v,72
MV 204,v,44,v,76
TR 44,223,0
TR 46,223,1024
s_waitcnt lgkmcnt(4)
MV 80,v,16,v,48
buffer_load_dwordx4 v209, s[44:47], s75 offen offset:1024 lds
v_accvgpr_write_b32 a32, 0
MV 84,v,16,v,52
ds_read_b128 v[64:67], v227 offset:0
v_accvgpr_write_b32 a33, 0
MV 88,v,16,v,56
buffer_load_dwordx4 v210, s[44:47], s75 offen offset:2048 lds
v_accvgpr_write_b32 a34, 0
MV 92,v,16,v,60
TR 16,216,8192
TR 18,216,9216
MV 96,v,20,v,48
v_accvgpr_write_b32 a35, 0
v_accvgpr_write_b32 a36, 0
MV 100,v,20,v,52
buffer_load_dwordx4 v211, s[44:47], s75 offen offset:3072 lds
v_accvgpr_write_b32 a37, 0
MV 104,v,20,v,56
ds_read_b128 v[68:71], v227 offset:2048
v_accvgpr_write_b32 a38, 0
MV 108,v,20,v,60
TR 20,217,8192
TR 22,217,9216
MV 112,v,24,v,48
s_add_u32 s75, s65, s74
v_accvgpr_write_b32 a39, 0
MV 116,v,24,v,52
v_accvgpr_write_b32 a40, 0
v_accvgpr_write_b32 a41, 0
MV 120,v,24,v,56
v_accvgpr_write_b32 a42, 0
v_accvgpr_write_b32 a43, 0
MV 124,v,24,v,60
TR 24,218,8192
TR 26,218,9216
MV 128,v,28,v,48
ds_read_b128 v[72:75], v227 offset:4096
s_add_u32 m0, s67, 36864
MV 132,v,28,v,52
v_accvgpr_write_b32 a44, 0
v_accvgpr_write_b32 a45, 0
MV 136,v,28,v,56
buffer_load_dwordx4 v208, s[44:47], s75 offen offset:0 lds
v_accvgpr_write_b32 a46, 0
MV 140,v,28,v,60
TR 28,219,8192
TR 30,219,9216
MV 144,v,32,v,48
buffer_load_dwordx4 v209, s[44:47], s75 offen offset:1024 lds
v_accvgpr_write_b32 a47, 0
MV 148,v,32,v,52
s_and_b32 s36, s2, 3
s_lshl_b32 s36, s36, 1
MV 152,v,32,v,56
ds_read_b128 v[76:79], v227 offset:6144
s_sub_u32 s43, 14, s36
MV 156,v,32,v,60
TR 32,220,8192
TR 34,220,9216
MV 160,v,36,v,48
buffer_load_dwordx4 v210, s[44:47], s75 offen offset:2048 lds
MV 164,v,36,v,52
s_bitcmp1_b32 s2, 4
s_cselect_b32 s36, s43, s36
MV 168,v,36,v,56
buffer_load_dwordx4 v211, s[44:47], s75 offen offset:3072 lds
s_bfe_u32 s43, s2, 0x10003
MV 172,v,36,v,60
TR 36,221,8192
TR 38,221,9216
s_waitcnt lgkmcnt(15)
MV 176,v,40,v,48
s_add_u32 s36, s36, s43
s_bfe_u32 s37, s2, 0x10002
MV 180,v,40,v,52
s_add_u32 s74, s74, 128
s_lshr_b32 s43, s2, 5
MV 184,v,40,v,56
s_lshl_b32 s43, s43, 1
s_add_u32 s37, s37, s43
MV 188,v,40,v,60
TR 40,222,8192
TR 42,222,9216
MV 192,v,44,v,48
s_and_b32 s74, s74, 2047
v_and_b32 v230, 15, v1
MV 196,v,44,v,52
s_lshl_b32 s36, s36, 4
v_add_u32 v231, s36, v230
MV 200,v,44,v,56
s_lshr_b32 s36, s2, 4
v_lshl_add_u32 v232, v230, 4, s36
MV 204,v,44,v,60
TR 44,223,8192
TR 46,223,9216
v_and_b32 v233, 7, v1
v_bfe_u32 v234, v1, 3, 1
v_lshlrev_b32 v233, 3, v233
v_lshl_add_u32 v233, v234, 7, v233
s_bfe_u32 s36, s2, 0x10004
s_lshl_b32 s36, s36, 6
s_and_b32 s37, s2, 7
s_add_u32 s36, s36, s37
v_add_u32 v233, s36, v233
v_lshrrev_b32 v234, 4, v1
v_cmp_eq_u32 vcc, 1, v234
s_nop 1
v_cndmask_b32 v233, v233, v232, vcc
v_cmp_eq_u32 vcc, 2, v234
s_nop 1
v_cndmask_b32 v233, v233, v231, vcc
v_lshlrev_b32 v233, 2, v233
s_waitcnt lgkmcnt(4)
MV 80,v,16,v,64
v_accvgpr_write_b32 a48, 0
MV 84,v,16,v,68
v_accvgpr_write_b32 a49, 0
MV 88,v,16,v,72
MV 92,v,16,v,76
v_accvgpr_write_b32 a50, 0
MV 96,v,20,v,64
MV 100,v,20,v,68
v_accvgpr_write_b32 a51, 0
MV 104,v,20,v,72
MV 108,v,20,v,76
s_waitcnt vmcnt(13) lgkmcnt(0)
s_barrier
MV 112,v,24,v,64
TR 16,216,16384
TR 18,216,17408
MV 116,v,24,v,68
ds_read_b128 v[48:51], v224 offset:0
s_add_u32 m0, s68, 98304
MV 120,v,24,v,72
TR 20,217,16384
TR 22,217,17408
MV 124,v,24,v,76
buffer_load_dwordx4 v212, s[48:51], s66 offen offset:0 lds
v_accvgpr_write_b32 a52, 0
MV 128,v,28,v,64
TR 24,218,16384
TR 26,218,17408
MV 132,v,28,v,68
ds_read_b128 v[52:55], v224 offset:2048
buffer_load_dwordx4 v213, s[48:51], s66 offen offset:1024 lds
MV 136,v,28,v,72
buffer_load_dwordx4 v214, s[48:51], s66 offen offset:2048 lds
v_accvgpr_write_b32 a53, 0
MV 140,v,28,v,76
TR 28,219,16384
TR 30,219,17408
MV 144,v,32,v,64
ds_read_b128 v[56:59], v224 offset:4096
v_accvgpr_write_b32 a54, 0
MV 148,v,32,v,68
buffer_load_dwordx4 v215, s[48:51], s66 offen offset:3072 lds
v_accvgpr_write_b32 a55, 0
MV 152,v,32,v,72
v_accvgpr_write_b32 a56, 0
v_accvgpr_write_b32 a57, 0
MV 156,v,32,v,76
TR 32,220,16384
TR 34,220,17408
MV 160,v,36,v,64
ds_read_b128 v[60:63], v224 offset:6144
s_add_u32 s66, s66, 524288
MV 164,v,36,v,68
s_and_b32 s66, s66, 8388607
v_accvgpr_write_b32 a58, 0
MV 168,v,36,v,72
v_accvgpr_write_b32 a59, 0
v_accvgpr_write_b32 a60, 0
MV 172,v,36,v,76
TR 36,221,16384
TR 38,221,17408
MV 176,v,40,v,64
s_add_u32 s75, s64, s74
v_accvgpr_write_b32 a61, 0
MV 180,v,40,v,68
MV 184,v,40,v,72
s_add_u32 m0, s67, 65536
v_accvgpr_write_b32 a62, 0
MV 188,v,40,v,76
TR 40,222,16384
TR 42,222,17408
MV 192,v,44,v,64
buffer_load_dwordx4 v208, s[44:47], s75 offen offset:0 lds
v_accvgpr_write_b32 a63, 0
MV 196,v,44,v,68
MV 200,v,44,v,72
MV 204,v,44,v,76
TR 44,223,16384
TR 46,223,17408
s_waitcnt lgkmcnt(4)
MV 80,v,16,v,48
buffer_load_dwordx4 v209, s[44:47], s75 offen offset:1024 lds
v_accvgpr_write_b32 a64, 0
MV 84,v,16,v,52
ds_read_b128 v[64:67], v225 offset:0
v_accvgpr_write_b32 a65, 0
MV 88,v,16,v,56
buffer_load_dwordx4 v210, s[44:47], s75 offen offset:2048 lds
v_accvgpr_write_b32 a66, 0
MV 92,v,16,v,60
TR 16,216,24576
TR 18,216,25600
MV 96,v,20,v,48
v_accvgpr_write_b32 a67, 0
v_accvgpr_write_b32 a68, 0
MV 100,v,20,v,52
buffer_load_dwordx4 v211, s[44:47], s75 offen offset:3072 lds
v_accvgpr_write_b32 a69, 0
MV 104,v,20,v,56
ds_read_b128 v[68:71], v225 offset:2048
v_accvgpr_write_b32 a70, 0
MV 108,v,20,v,60
TR 20,217,24576
TR 22,217,25600
MV 112,v,24,v,48
s_add_u32 s75, s65, s74
v_accvgpr_write_b32 a71, 0
MV 116,v,24,v,52
v_accvgpr_write_b32 a72, 0
v_accvgpr_write_b32 a73, 0
MV 120,v,24,v,56
v_accvgpr_write_b32 a74, 0
v_accvgpr_write_b32 a75, 0
MV 124,v,24,v,60
TR 24,218,24576
TR 26,218,25600
MV 128,v,28,v,48
ds_read_b128 v[72:75], v225 offset:4096
s_add_u32 m0, s67, 69632
MV 132,v,28,v,52
v_accvgpr_write_b32 a76, 0
v_accvgpr_write_b32 a77, 0
MV 136,v,28,v,56
buffer_load_dwordx4 v208, s[44:47], s75 offen offset:0 lds
v_accvgpr_write_b32 a78, 0
MV 140,v,28,v,60
TR 28,219,24576
TR 30,219,25600
MV 144,v,32,v,48
buffer_load_dwordx4 v209, s[44:47], s75 offen offset:1024 lds
v_accvgpr_write_b32 a79, 0
MV 148,v,32,v,52
s_lshl_b32 s36, s2, 2
s_add_u32 s36, s36, s3
MV 152,v,32,v,56
ds_read_b128 v[76:79], v225 offset:6144
s_lshl_b32 s42, s36, 1
MV 156,v,32,v,60
TR 32,220,24576
TR 34,220,25600
MV 160,v,36,v,48
buffer_load_dwordx4 v210, s[44:47], s75 offen offset:2048 lds
s_lshl_b32 s37, s36, 12
MV 164,v,36,v,52
s_add_u32 s16, s32, s37
s_addc_u32 s17, s33, 0
MV 168,v,36,v,56
buffer_load_dwordx4 v211, s[44:47], s75 offen offset:3072 lds
s_mov_b32 s18, 4096
MV 172,v,36,v,60
TR 36,221,24576
TR 38,221,25600
s_waitcnt lgkmcnt(15)
MV 176,v,40,v,48
s_mov_b32 s19, 0x20000
s_add_u32 s37, s37, 50331648
MV 180,v,40,v,52
s_add_u32 s74, s74, 128
MV 184,v,40,v,56
s_add_u32 s20, s40, s37
s_addc_u32 s21, s41, 0
MV 188,v,40,v,60
TR 40,222,24576
TR 42,222,25600
MV 192,v,44,v,48
s_and_b32 s74, s74, 2047
s_mov_b32 s22, 4096
MV 196,v,44,v,52
s_mov_b32 s23, 0x20000
s_lshl_b32 s37, s2, 14
MV 200,v,44,v,56
s_add_u32 s37, s37, 54525952
MV 204,v,44,v,60
TR 44,223,24576
TR 46,223,25600
s_add_u32 s24, s40, s37
s_addc_u32 s25, s41, 0
s_mov_b32 s26, 16384
s_mov_b32 s27, 0x20000
s_mov_b32 s28, s34
s_mov_b32 s29, s35
s_mov_b32 s30, 2048
s_mov_b32 s31, 0x20000
s_mul_i32 s43, s3, 4608
s_add_u32 s43, s43, 132096
s_waitcnt lgkmcnt(4)
MV 80,v,16,v,64
v_accvgpr_write_b32 a80, 0
MV 84,v,16,v,68
v_accvgpr_write_b32 a81, 0
MV 88,v,16,v,72
MV 92,v,16,v,76
v_accvgpr_write_b32 a82, 0
MV 96,v,20,v,64
MV 100,v,20,v,68
v_accvgpr_write_b32 a83, 0
MV 104,v,20,v,72
MV 108,v,20,v,76
s_waitcnt vmcnt(12) lgkmcnt(0)
s_barrier
MV 112,v,24,v,64
s_load_dwordx2 s[32:33], s[0:1], 88
TR 16,216,32768
MV 116,v,24,v,68
TR 18,216,33792
ds_read_b128 v[48:51], v224 offset:32768
MV 120,v,24,v,72
TR 20,217,32768
TR 22,217,33792
MV 124,v,24,v,76
v_accvgpr_write_b32 a84, 0
v_accvgpr_write_b32 a85, 0
MV 128,v,28,v,64
TR 24,218,32768
TR 26,218,33792
MV 132,v,28,v,68
ds_read_b128 v[52:55], v224 offset:34816
v_accvgpr_write_b32 a86, 0
MV 136,v,28,v,72
v_accvgpr_write_b32 a87, 0
MV 140,v,28,v,76
TR 28,219,32768
TR 30,219,33792
MV 144,v,32,v,64
ds_read_b128 v[56:59], v224 offset:36864
v_accvgpr_write_b32 a88, 0
MV 148,v,32,v,68
v_accvgpr_write_b32 a89, 0
MV 152,v,32,v,72
v_accvgpr_write_b32 a90, 0
MV 156,v,32,v,76
TR 32,220,32768
TR 34,220,33792
MV 160,v,36,v,64
ds_read_b128 v[60:63], v224 offset:38912
v_accvgpr_write_b32 a91, 0
MV 164,v,36,v,68
MV 168,v,36,v,72
v_accvgpr_write_b32 a92, 0
MV 172,v,36,v,76
TR 36,221,32768
TR 38,221,33792
MV 176,v,40,v,64
v_accvgpr_write_b32 a93, 0
MV 180,v,40,v,68
MV 184,v,40,v,72
v_accvgpr_write_b32 a94, 0
MV 188,v,40,v,76
TR 40,222,32768
TR 42,222,33792
MV 192,v,44,v,64
v_accvgpr_write_b32 a95, 0
MV 196,v,44,v,68
MV 200,v,44,v,72
MV 204,v,44,v,76
TR 44,223,32768
TR 46,223,33792
s_waitcnt lgkmcnt(4)
MV 80,v,16,v,48
v_accvgpr_write_b32 a96, 0
MV 84,v,16,v,52
ds_read_b128 v[64:67], v225 offset:32768
v_accvgpr_write_b32 a97, 0
MV 88,v,16,v,56
MV 92,v,16,v,60
TR 16,216,40960
TR 18,216,41984
MV 96,v,20,v,48
v_accvgpr_write_b32 a98, 0
MV 100,v,20,v,52
v_accvgpr_write_b32 a99, 0
MV 104,v,20,v,56
ds_read_b128 v[68:71], v225 offset:34816
MV 108,v,20,v,60
TR 20,217,40960
TR 22,217,41984
MV 112,v,24,v,48
v_accvgpr_write_b32 a100, 0
MV 116,v,24,v,52
v_accvgpr_write_b32 a101, 0
MV 120,v,24,v,56
MV 124,v,24,v,60
TR 24,218,40960
TR 26,218,41984
MV 128,v,28,v,48
ds_read_b128 v[72:75], v225 offset:36864
v_accvgpr_write_b32 a102, 0
MV 132,v,28,v,52
v_accvgpr_write_b32 a103, 0
MV 136,v,28,v,56
MV 140,v,28,v,60
TR 28,219,40960
TR 30,219,41984
MV 144,v,32,v,48
v_accvgpr_write_b32 a104, 0
v_accvgpr_write_b32 a105, 0
MV 148,v,32,v,52
MV 152,v,32,v,56
ds_read_b128 v[76:79], v225 offset:38912
v_accvgpr_write_b32 a106, 0
MV 156,v,32,v,60
TR 32,220,40960
TR 34,220,41984
MV 160,v,36,v,48
v_accvgpr_write_b32 a107, 0
MV 164,v,36,v,52
MV 168,v,36,v,56
v_accvgpr_write_b32 a108, 0
MV 172,v,36,v,60
TR 36,221,40960
TR 38,221,41984
s_waitcnt lgkmcnt(15)
MV 176,v,40,v,48
v_accvgpr_write_b32 a109, 0
MV 180,v,40,v,52
MV 184,v,40,v,56
v_accvgpr_write_b32 a110, 0
MV 188,v,40,v,60
TR 40,222,40960
TR 42,222,41984
MV 192,v,44,v,48
v_accvgpr_write_b32 a111, 0
MV 196,v,44,v,52
MV 200,v,44,v,56
MV 204,v,44,v,60
TR 44,223,40960
TR 46,223,41984
s_waitcnt lgkmcnt(4)
MV 80,v,16,v,64
v_accvgpr_write_b32 a112, 0
MV 84,v,16,v,68
v_accvgpr_write_b32 a113, 0
MV 88,v,16,v,72
MV 92,v,16,v,76
v_accvgpr_write_b32 a114, 0
MV 96,v,20,v,64
MV 100,v,20,v,68
v_accvgpr_write_b32 a115, 0
MV 104,v,20,v,72
MV 108,v,20,v,76
s_waitcnt vmcnt(0) lgkmcnt(0)
s_barrier
MV 112,v,24,v,64
TR 16,216,0
TR 18,216,1024
MV 116,v,24,v,68
ds_read_b128 v[48:51], v226 offset:0
v_accvgpr_write_b32 a116, 0
MV 120,v,24,v,72
TR 20,217,0
TR 22,217,1024
MV 124,v,24,v,76
v_accvgpr_write_b32 a117, 0
v_accvgpr_write_b32 a118, 0
MV 128,v,28,v,64
TR 24,218,0
TR 26,218,1024
MV 132,v,28,v,68
ds_read_b128 v[52:55], v226 offset:2048
v_accvgpr_write_b32 a119, 0
MV 136,v,28,v,72
MV 140,v,28,v,76
TR 28,219,0
TR 30,219,1024
MV 144,v,32,v,64
ds_read_b128 v[56:59], v226 offset:4096
v_accvgpr_write_b32 a120, 0
MV 148,v,32,v,68
v_accvgpr_write_b32 a121, 0
MV 152,v,32,v,72
v_accvgpr_write_b32 a122, 0
MV 156,v,32,v,76
TR 32,220,0
TR 34,220,1024
MV 160,v,36,v,64
ds_read_b128 v[60:63], v226 offset:6144
v_accvgpr_write_b32 a123, 0
MV 164,v,36,v,68
MV 168,v,36,v,72
v_accvgpr_write_b32 a124, 0
MV 172,v,36,v,76
TR 36,221,0
TR 38,221,1024
MV 176,v,40,v,64
v_accvgpr_write_b32 a125, 0
MV 180,v,40,v,68
MV 184,v,40,v,72
v_accvgpr_write_b32 a126, 0
MV 188,v,40,v,76
TR 40,222,0
TR 42,222,1024
MV 192,v,44,v,64
v_accvgpr_write_b32 a127, 0
MV 196,v,44,v,68
MV 200,v,44,v,72
MV 204,v,44,v,76
TR 44,223,0
TR 46,223,1024
s_waitcnt lgkmcnt(4)
MV 80,v,16,v,48
buffer_load_dword v237, v233, s[8:11], 0 offen offset:0 sc1
MV 84,v,16,v,52
ds_read_b128 v[64:67], v227 offset:0
MV 88,v,16,v,56
s_lshr_b32 s36, s2, 3
MV 92,v,16,v,60
TR 16,216,8192
TR 18,216,9216
MV 96,v,20,v,48
MV 100,v,20,v,52
s_lshl_b32 s36, s36, 18
MV 104,v,20,v,56
ds_read_b128 v[68:71], v227 offset:2048
MV 108,v,20,v,60
TR 20,217,8192
TR 22,217,9216
MV 112,v,24,v,48
s_and_b32 s37, s2, 7
MV 116,v,24,v,52
MV 120,v,24,v,56
s_lshl_b32 s37, s37, 8
MV 124,v,24,v,60
TR 24,218,8192
TR 26,218,9216
MV 128,v,28,v,48
ds_read_b128 v[72:75], v227 offset:4096
s_add_u32 s36, s36, s37
MV 132,v,28,v,52
MV 136,v,28,v,56
MV 140,v,28,v,60
TR 28,219,8192
TR 30,219,9216
MV 144,v,32,v,48
s_lshl_b32 s37, s3, 16
MV 148,v,32,v,52
s_add_u32 s36, s36, s37
MV 152,v,32,v,56
ds_read_b128 v[76:79], v227 offset:6144
MV 156,v,32,v,60
TR 32,220,8192
TR 34,220,9216
MV 160,v,36,v,48
s_add_u32 s32, s32, s36
s_addc_u32 s33, s33, 0
MV 164,v,36,v,52
MV 168,v,36,v,56
MV 172,v,36,v,60
TR 36,221,8192
TR 38,221,9216
s_waitcnt lgkmcnt(15)
MV 176,v,40,v,48
MV 180,v,40,v,52
s_mov_b32 s34, 65536
MV 184,v,40,v,56
MV 188,v,40,v,60
TR 40,222,8192
TR 42,222,9216
MV 192,v,44,v,48
s_mov_b32 s35, 0x20000
MV 196,v,44,v,52
MV 200,v,44,v,56
MV 204,v,44,v,60
TR 44,223,8192
TR 46,223,9216
s_waitcnt lgkmcnt(4)
MV 80,v,16,v,64
MV 84,v,16,v,68
MV 88,v,16,v,72
MV 92,v,16,v,76
MV 96,v,20,v,64
MV 100,v,20,v,68
MV 104,v,20,v,72
MV 108,v,20,v,76
MV 112,v,24,v,64
MV 116,v,24,v,68
MV 120,v,24,v,72
MV 124,v,24,v,76
MV 128,v,28,v,64
MV 132,v,28,v,68
MV 136,v,28,v,72
MV 140,v,28,v,76
MV 144,v,32,v,64
MV 148,v,32,v,68
MV 152,v,32,v,72
MV 156,v,32,v,76
MV 160,v,36,v,64
MV 164,v,36,v,68
MV 168,v,36,v,72
MV 172,v,36,v,76
s_waitcnt lgkmcnt(2)
MV 176,v,40,v,64
MV 180,v,40,v,68
MV 184,v,40,v,72
MV 188,v,40,v,76
s_waitcnt lgkmcnt(0)
MV 192,v,44,v,64
MV 196,v,44,v,68
MV 200,v,44,v,72
MV 204,v,44,v,76
s_waitcnt vmcnt(0)
v_cmp_gt_u32 vcc, 1, v237
s_nop 4
s_cbranch_vccnz L_spin_f1
L_spin_f1_ret:
s_waitcnt lgkmcnt(0)
s_barrier
s_add_u32 m0, s68, 16384
s_mov_b32 s80, 0
buffer_load_dwordx4 v12, s[52:55], s80 offen offset:0 sc1 lds
buffer_load_dwordx4 v12, s[52:55], s80 offen offset:1024 sc1 lds
buffer_load_dwordx4 v12, s[52:55], s80 offen offset:2048 sc1 lds
buffer_load_dwordx4 v12, s[52:55], s80 offen offset:3072 sc1 lds
s_add_u32 m0, s68, 32768
s_mov_b32 s80, 16384
buffer_load_dwordx4 v12, s[52:55], s80 offen offset:0 sc1 lds
buffer_load_dwordx4 v12, s[52:55], s80 offen offset:1024 sc1 lds
buffer_load_dwordx4 v12, s[52:55], s80 offen offset:2048 sc1 lds
buffer_load_dwordx4 v12, s[52:55], s80 offen offset:3072 sc1 lds
s_mov_b32 s82, 0x3e0293ee
s_mov_b32 s83, 0x3e0293ee
v_pk_mul_f32 v[80:81], v[80:81], s[82:83]
v_pk_mul_f32 v[82:83], v[82:83], s[82:83]
v_pk_mul_f32 v[84:85], v[84:85], s[82:83]
v_pk_mul_f32 v[86:87], v[86:87], s[82:83]
v_pk_mul_f32 v[88:89], v[88:89], s[82:83]
v_pk_mul_f32 v[90:91], v[90:91], s[82:83]
v_pk_mul_f32 v[92:93], v[92:93], s[82:83]
v_pk_mul_f32 v[94:95], v[94:95], s[82:83]
v_pk_mul_f32 v[96:97], v[96:97], s[82:83]
s_add_u32 m0, s68, 81920
v_pk_mul_f32 v[98:99], v[98:99], s[82:83]
v_pk_mul_f32 v[100:101], v[100:101], s[82:83]
v_pk_mul_f32 v[102:103], v[102:103], s[82:83]
v_pk_mul_f32 v[104:105], v[104:105], s[82:83]
v_pk_mul_f32 v[106:107], v[106:107], s[82:83]
v_pk_mul_f32 v[108:109], v[108:109], s[82:83]
v_pk_mul_f32 v[110:111], v[110:111], s[82:83]
v_cvt_pk_bf16_f32 v16, v80, v81
v_cvt_pk_bf16_f32 v17, v82, v83
v_cvt_pk_bf16_f32 v18, v96, v97
v_cvt_pk_bf16_f32 v19, v98, v99
s_mov_b32 s80, 16384
v_cvt_pk_bf16_f32 v20, v84, v85
v_cvt_pk_bf16_f32 v21, v86, v87
v_cvt_pk_bf16_f32 v22, v100, v101
v_cvt_pk_bf16_f32 v23, v102, v103
v_cvt_pk_bf16_f32 v48, v88, v89
v_cvt_pk_bf16_f32 v49, v90, v91
v_cvt_pk_bf16_f32 v50, v104, v105
v_cvt_pk_bf16_f32 v51, v106, v107
v_cvt_pk_bf16_f32 v52, v92, v93
v_cvt_pk_bf16_f32 v53, v94, v95
v_cvt_pk_bf16_f32 v54, v108, v109
buffer_load_dwordx4 v12, s[56:59], s80 offen offset:0 sc1 lds
v_cvt_pk_bf16_f32 v55, v110, v111
v_permlane16_swap_b32 v16, v20
v_permlane16_swap_b32 v17, v21
v_permlane16_swap_b32 v18, v22
v_permlane16_swap_b32 v19, v23
v_permlane16_swap_b32 v48, v52
v_permlane16_swap_b32 v49, v53
v_permlane16_swap_b32 v50, v54
v_permlane16_swap_b32 v51, v55
v_pk_mul_f32 v[112:113], v[112:113], s[82:83]
v_pk_mul_f32 v[114:115], v[114:115], s[82:83]
buffer_load_dwordx4 v12, s[56:59], s80 offen offset:1024 sc1 lds
v_pk_mul_f32 v[116:117], v[116:117], s[82:83]
v_pk_mul_f32 v[118:119], v[118:119], s[82:83]
v_pk_mul_f32 v[120:121], v[120:121], s[82:83]
v_pk_mul_f32 v[122:123], v[122:123], s[82:83]
v_pk_mul_f32 v[124:125], v[124:125], s[82:83]
v_pk_mul_f32 v[126:127], v[126:127], s[82:83]
v_pk_mul_f32 v[128:129], v[128:129], s[82:83]
v_pk_mul_f32 v[130:131], v[130:131], s[82:83]
v_pk_mul_f32 v[132:133], v[132:133], s[82:83]
v_pk_mul_f32 v[134:135], v[134:135], s[82:83]
v_pk_mul_f32 v[136:137], v[136:137], s[82:83]
buffer_load_dwordx4 v12, s[56:59], s80 offen offset:2048 sc1 lds
v_pk_mul_f32 v[138:139], v[138:139], s[82:83]
v_pk_mul_f32 v[140:141], v[140:141], s[82:83]
v_pk_mul_f32 v[142:143], v[142:143], s[82:83]
v_cvt_pk_bf16_f32 v24, v112, v113
v_cvt_pk_bf16_f32 v25, v114, v115
v_cvt_pk_bf16_f32 v26, v128, v129
v_cvt_pk_bf16_f32 v27, v130, v131
v_cvt_pk_bf16_f32 v28, v116, v117
v_cvt_pk_bf16_f32 v29, v118, v119
v_cvt_pk_bf16_f32 v30, v132, v133
v_cvt_pk_bf16_f32 v31, v134, v135
buffer_load_dwordx4 v12, s[56:59], s80 offen offset:3072 sc1 lds
v_cvt_pk_bf16_f32 v56, v120, v121
v_cvt_pk_bf16_f32 v57, v122, v123
v_cvt_pk_bf16_f32 v58, v136, v137
v_cvt_pk_bf16_f32 v59, v138, v139
v_cvt_pk_bf16_f32 v60, v124, v125
v_cvt_pk_bf16_f32 v61, v126, v127
v_cvt_pk_bf16_f32 v62, v140, v141
v_cvt_pk_bf16_f32 v63, v142, v143
v_permlane16_swap_b32 v24, v28
v_permlane16_swap_b32 v25, v29
v_permlane16_swap_b32 v26, v30
s_add_u32 m0, s68, 49152
v_permlane16_swap_b32 v27, v31
v_permlane16_swap_b32 v56, v60
v_permlane16_swap_b32 v57, v61
v_permlane16_swap_b32 v58, v62
v_permlane16_swap_b32 v59, v63
v_pk_mul_f32 v[144:145], v[144:145], s[82:83]
v_pk_mul_f32 v[146:147], v[146:147], s[82:83]
v_pk_mul_f32 v[148:149], v[148:149], s[82:83]
v_pk_mul_f32 v[150:151], v[150:151], s[82:83]
v_pk_mul_f32 v[152:153], v[152:153], s[82:83]
v_pk_mul_f32 v[154:155], v[154:155], s[82:83]
s_mov_b32 s80, 32768
v_pk_mul_f32 v[156:157], v[156:157], s[82:83]
v_pk_mul_f32 v[158:159], v[158:159], s[82:83]
v_pk_mul_f32 v[160:161], v[160:161], s[82:83]
v_pk_mul_f32 v[162:163], v[162:163], s[82:83]
v_pk_mul_f32 v[164:165], v[164:165], s[82:83]
v_pk_mul_f32 v[166:167], v[166:167], s[82:83]
v_pk_mul_f32 v[168:169], v[168:169], s[82:83]
v_pk_mul_f32 v[170:171], v[170:171], s[82:83]
v_pk_mul_f32 v[172:173], v[172:173], s[82:83]
v_pk_mul_f32 v[174:175], v[174:175], s[82:83]
v_cvt_pk_bf16_f32 v32, v144, v145
buffer_load_dwordx4 v12, s[52:55], s80 offen offset:0 sc1 lds
v_cvt_pk_bf16_f32 v33, v146, v147
v_cvt_pk_bf16_f32 v34, v160, v161
v_cvt_pk_bf16_f32 v35, v162, v163
v_cvt_pk_bf16_f32 v36, v148, v149
v_cvt_pk_bf16_f32 v37, v150, v151
v_cvt_pk_bf16_f32 v38, v164, v165
v_cvt_pk_bf16_f32 v39, v166, v167
v_cvt_pk_bf16_f32 v64, v152, v153
v_cvt_pk_bf16_f32 v65, v154, v155
v_cvt_pk_bf16_f32 v66, v168, v169
v_cvt_pk_bf16_f32 v67, v170, v171
buffer_load_dwordx4 v12, s[52:55], s80 offen offset:1024 sc1 lds
v_cvt_pk_bf16_f32 v68, v156, v157
v_cvt_pk_bf16_f32 v69, v158, v159
v_cvt_pk_bf16_f32 v70, v172, v173
v_cvt_pk_bf16_f32 v71, v174, v175
v_permlane16_swap_b32 v32, v36
v_permlane16_swap_b32 v33, v37
v_permlane16_swap_b32 v34, v38
v_permlane16_swap_b32 v35, v39
v_permlane16_swap_b32 v64, v68
v_permlane16_swap_b32 v65, v69
v_permlane16_swap_b32 v66, v70
buffer_load_dwordx4 v12, s[52:55], s80 offen offset:2048 sc1 lds
v_permlane16_swap_b32 v67, v71
v_pk_mul_f32 v[176:177], v[176:177], s[82:83]
v_pk_mul_f32 v[178:179], v[178:179], s[82:83]
v_pk_mul_f32 v[180:181], v[180:181], s[82:83]
v_pk_mul_f32 v[182:183], v[182:183], s[82:83]
v_pk_mul_f32 v[184:185], v[184:185], s[82:83]
v_pk_mul_f32 v[186:187], v[186:187], s[82:83]
v_pk_mul_f32 v[188:189], v[188:189], s[82:83]
v_pk_mul_f32 v[190:191], v[190:191], s[82:83]
v_pk_mul_f32 v[192:193], v[192:193], s[82:83]
v_pk_mul_f32 v[194:195], v[194:195], s[82:83]
buffer_load_dwordx4 v12, s[52:55], s80 offen offset:3072 sc1 lds
v_pk_mul_f32 v[196:197], v[196:197], s[82:83]
v_pk_mul_f32 v[198:199], v[198:199], s[82:83]
v_pk_mul_f32 v[200:201], v[200:201], s[82:83]
v_pk_mul_f32 v[202:203], v[202:203], s[82:83]
v_pk_mul_f32 v[204:205], v[204:205], s[82:83]
v_pk_mul_f32 v[206:207], v[206:207], s[82:83]
v_cvt_pk_bf16_f32 v40, v176, v177
v_cvt_pk_bf16_f32 v41, v178, v179
v_cvt_pk_bf16_f32 v42, v192, v193
v_cvt_pk_bf16_f32 v43, v194, v195
v_cvt_pk_bf16_f32 v44, v180, v181
s_add_u32 m0, s68, 98304
v_cvt_pk_bf16_f32 v45, v182, v183
v_cvt_pk_bf16_f32 v46, v196, v197
v_cvt_pk_bf16_f32 v47, v198, v199
v_cvt_pk_bf16_f32 v72, v184, v185
v_cvt_pk_bf16_f32 v73, v186, v187
v_cvt_pk_bf16_f32 v74, v200, v201
v_cvt_pk_bf16_f32 v75, v202, v203
v_cvt_pk_bf16_f32 v76, v188, v189
v_cvt_pk_bf16_f32 v77, v190, v191
v_cvt_pk_bf16_f32 v78, v204, v205
v_cvt_pk_bf16_f32 v79, v206, v207
s_mov_b32 s80, 32768
v_permlane16_swap_b32 v40, v44
v_permlane16_swap_b32 v41, v45
v_permlane16_swap_b32 v42, v46
v_permlane16_swap_b32 v43, v47
v_permlane16_swap_b32 v72, v76
v_permlane16_swap_b32 v73, v77
v_permlane16_swap_b32 v74, v78
v_permlane16_swap_b32 v75, v79
v_mov_b32 v208, 0
v_mov_b32 v209, 0
v_mov_b32 v210, 0
buffer_load_dwordx4 v12, s[56:59], s80 offen offset:0 sc1 lds
v_mov_b32 v211, 0
v_mov_b32 v212, 0
v_mov_b32 v213, 0
v_mov_b32 v214, 0
v_mov_b32 v215, 0
v_mov_b32 v216, 0
v_mov_b32 v217, 0
v_mov_b32 v218, 0
v_mov_b32 v219, 0
v_mov_b32 v220, 0
v_mov_b32 v221, 0
buffer_load_dwordx4 v12, s[56:59], s80 offen offset:1024 sc1 lds
v_mov_b32 v222, 0
v_mov_b32 v223, 0
v_mov_b32 v224, 0
v_mov_b32 v225, 0
v_mov_b32 v226, 0
v_mov_b32 v227, 0
v_mov_b32 v228, 0
v_mov_b32 v229, 0
v_mov_b32 v230, 0
v_mov_b32 v231, 0
v_mov_b32 v232, 0
buffer_load_dwordx4 v12, s[56:59], s80 offen offset:2048 sc1 lds
v_mov_b32 v233, 0
v_mov_b32 v234, 0
v_mov_b32 v235, 0
v_mov_b32 v236, 0
v_mov_b32 v237, 0
v_mov_b32 v238, 0
v_mov_b32 v239, 0
v_mov_b32 v2, 0
v_mov_b32 v3, 0
v_mov_b32 v4, 0
v_mov_b32 v5, 0
v_xor_b32 v244, 0x8000, v10
buffer_load_dwordx4 v12, s[56:59], s80 offen offset:3072 sc1 lds
s_waitcnt vmcnt(16)
s_barrier
ds_read_b128 a[128:131], v244 offset:16384
ds_read_b128 a[132:135], v244 offset:17408
ds_read_b128 a[136:139], v244 offset:18432
ds_read_b128 a[140:143], v244 offset:19456
ds_read_b128 a[144:147], v244 offset:20480
ds_read_b128 a[148:151], v244 offset:21504
ds_read_b128 a[152:155], v244 offset:22528
ds_read_b128 a[156:159], v244 offset:23552
ds_read_b128 a[160:163], v244 offset:24576
ds_read_b128 a[164:167], v244 offset:25600
ds_read_b128 a[168:171], v244 offset:26624
ds_read_b128 a[172:175], v244 offset:27648
ds_read_b128 a[176:179], v244 offset:28672
ds_read_b128 a[180:183], v244 offset:29696
ds_read_b128 a[184:187], v244 offset:30720
ds_read_b128 a[188:191], v244 offset:31744
s_waitcnt lgkmcnt(15)
v_mfma_f32_32x32x16_bf16 v[80:95], a[128:131], v[16:19], 0
s_add_u32 m0, s68, 0
v_mfma_f32_32x32x16_bf16 v[96:111], a[128:131], v[48:51], 0
s_mov_b32 s80, 49152
s_waitcnt lgkmcnt(14)
v_mfma_f32_32x32x16_bf16 v[80:95], a[132:135], v[20:23], v[80:95]
buffer_load_dwordx4 v12, s[52:55], s80 offen offset:0 sc1 lds
v_mfma_f32_32x32x16_bf16 v[96:111], a[132:135], v[52:55], v[96:111]
buffer_load_dwordx4 v12, s[52:55], s80 offen offset:1024 sc1 lds
s_waitcnt lgkmcnt(13)
v_mfma_f32_32x32x16_bf16 v[80:95], a[136:139], v[24:27], v[80:95]
buffer_load_dwordx4 v12, s[52:55], s80 offen offset:2048 sc1 lds
v_mfma_f32_32x32x16_bf16 v[96:111], a[136:139], v[56:59], v[96:111]
buffer_load_dwordx4 v12, s[52:55], s80 offen offset:3072 sc1 lds
s_waitcnt lgkmcnt(12)
v_mfma_f32_32x32x16_bf16 v[80:95], a[140:143], v[28:31], v[80:95]
s_add_u32 m0, s68, 114688
v_mfma_f32_32x32x16_bf16 v[96:111], a[140:143], v[60:63], v[96:111]
s_mov_b32 s80, 49152
s_waitcnt lgkmcnt(11)
v_mfma_f32_32x32x16_bf16 v[80:95], a[144:147], v[32:35], v[80:95]
buffer_load_dwordx4 v12, s[56:59], s80 offen offset:0 sc1 lds
v_mfma_f32_32x32x16_bf16 v[96:111], a[144:147], v[64:67], v[96:111]
buffer_load_dwordx4 v12, s[56:59], s80 offen offset:1024 sc1 lds
s_waitcnt lgkmcnt(10)
v_mfma_f32_32x32x16_bf16 v[80:95], a[148:151], v[36:39], v[80:95]
buffer_load_dwordx4 v12, s[56:59], s80 offen offset:2048 sc1 lds
v_mfma_f32_32x32x16_bf16 v[96:111], a[148:151], v[68:71], v[96:111]
buffer_load_dwordx4 v12, s[56:59], s80 offen offset:3072 sc1 lds
s_waitcnt lgkmcnt(9)
v_mfma_f32_32x32x16_bf16 v[80:95], a[152:155], v[40:43], v[80:95]
v_mfma_f32_32x32x16_bf16 v[96:111], a[152:155], v[72:75], v[96:111]
s_waitcnt vmcnt(16) lgkmcnt(0)
s_barrier
v_mfma_f32_32x32x16_bf16 v[80:95], a[156:159], v[44:47], v[80:95]
ds_read_b128 a[128:131], v10 offset:0
ds_read_b128 a[132:135], v10 offset:1024
s_add_u32 m0, s68, 16384
s_mov_b32 s80, 65536
v_mfma_f32_32x32x16_bf16 v[96:111], a[156:159], v[76:79], v[96:111]
ds_read_b128 a[136:139], v10 offset:2048
ds_read_b128 a[140:143], v10 offset:3072
buffer_load_dwordx4 v12, s[52:55], s80 offen offset:0 sc1 lds
buffer_load_dwordx4 v12, s[52:55], s80 offen offset:1024 sc1 lds
v_mfma_f32_32x32x16_bf16 v[112:127], a[160:163], v[16:19], 0
ds_read_b128 a[144:147], v10 offset:4096
ds_read_b128 a[148:151], v10 offset:5120
buffer_load_dwordx4 v12, s[52:55], s80 offen offset:2048 sc1 lds
buffer_load_dwordx4 v12, s[52:55], s80 offen offset:3072 sc1 lds
v_mfma_f32_32x32x16_bf16 v[128:143], a[160:163], v[48:51], 0
ds_read_b128 a[152:155], v10 offset:6144
ds_read_b128 a[156:159], v10 offset:7168
s_mov_b32 s71, 65536
v_lshrrev_b32 v245, 4, v1
v_mfma_f32_32x32x16_bf16 v[112:127], a[164:167], v[20:23], v[112:127]
ds_read_b128 a[160:163], v10 offset:8192
v_and_b32 v246, 15, v1
v_lshlrev_b32 v247, 1, v245
v_mfma_f32_32x32x16_bf16 v[128:143], a[164:167], v[52:55], v[128:143]
ds_read_b128 a[164:167], v10 offset:9216
v_xor_b32 v246, v246, v247
v_lshlrev_b32 v245, 11, v245
v_mfma_f32_32x32x16_bf16 v[112:127], a[168:171], v[24:27], v[112:127]
v_lshl_add_u32 v245, v246, 4, v245
v_xor_b32 v246, 128, v245
v_mfma_f32_32x32x16_bf16 v[128:143], a[168:171], v[56:59], v[128:143]
ds_read_b128 a[168:171], v10 offset:10240
s_lshl_b32 s36, s3, 13
s_add_u32 m0, s36, 131072
v_mfma_f32_32x32x16_bf16 v[112:127], a[172:175], v[28:31], v[112:127]
s_mov_b32 s37, 0
buffer_load_dwordx4 v245, s[32:35], s37 offen offset:0 lds
v_mfma_f32_32x32x16_bf16 v[128:143], a[172:175], v[60:63], v[128:143]
ds_read_b128 a[172:175], v10 offset:11264
s_mov_b32 s37, 7168
buffer_load_dwordx4 v246, s[32:35], s37 offen offset:1024 lds
v_mfma_f32_32x32x16_bf16 v[112:127], a[176:179], v[32:35], v[112:127]
s_mov_b32 s37, 14336
buffer_load_dwordx4 v245, s[32:35], s37 offen offset:2048 lds
v_mfma_f32_32x32x16_bf16 v[128:143], a[176:179], v[64:67], v[128:143]
ds_read_b128 a[176:179], v10 offset:12288
s_mov_b32 s37, 21504
buffer_load_dwordx4 v246, s[32:35], s37 offen offset:3072 lds
v_mfma_f32_32x32x16_bf16 v[112:127], a[180:183], v[36:39], v[112:127]
s_add_u32 m0, s36, 135168
s_mov_b32 s37, 32768
v_mfma_f32_32x32x16_bf16 v[128:143], a[180:183], v[68:71], v[128:143]
ds_read_b128 a[180:183], v10 offset:13312
buffer_load_dwordx4 v245, s[32:35], s37 offen offset:0 lds
s_mov_b32 s37, 39936
v_mfma_f32_32x32x16_bf16 v[112:127], a[184:187], v[40:43], v[112:127]
buffer_load_dwordx4 v246, s[32:35], s37 offen offset:1024 lds
s_mov_b32 s37, 47104
v_mfma_f32_32x32x16_bf16 v[128:143], a[184:187], v[72:75], v[128:143]
ds_read_b128 a[184:187], v10 offset:14336
buffer_load_dwordx4 v245, s[32:35], s37 offen offset:2048 lds
s_mov_b32 s37, 54272
v_mfma_f32_32x32x16_bf16 v[112:127], a[188:191], v[44:47], v[112:127]
buffer_load_dwordx4 v246, s[32:35], s37 offen offset:3072 lds
v_mfma_f32_32x32x16_bf16 v[128:143], a[188:191], v[76:79], v[128:143]
ds_read_b128 a[188:191], v10 offset:15360
s_cmp_eq_u32 s70, 0
s_cbranch_scc1 L_p3_pmask
L_p3_pmask_ret:
v_max3_f32 v6, v80, v81, v82
v_max3_f32 v7, v96, v97, v98
v_max3_f32 v6, v6, v83, v84
v_max3_f32 v7, v7, v99, v100
v_max3_f32 v6, v6, v85, v86
v_max3_f32 v7, v7, v101, v102
v_max3_f32 v6, v6, v87, v88
v_max3_f32 v7, v7, v103, v104
v_max3_f32 v6, v6, v89, v90
v_max3_f32 v7, v7, v105, v106
v_max3_f32 v6, v6, v91, v92
v_max3_f32 v7, v7, v107, v108
v_max3_f32 v6, v6, v93, v94
v_max3_f32 v7, v7, v109, v110
v_max3_f32 v6, v6, v95, v112
v_max3_f32 v7, v7, v111, v128
v_max3_f32 v6, v6, v113, v114
v_max3_f32 v7, v7, v129, v130
v_max3_f32 v6, v6, v115, v116
v_max3_f32 v7, v7, v131, v132
v_max3_f32 v6, v6, v117, v118
v_max3_f32 v7, v7, v133, v134
v_max3_f32 v6, v6, v119, v120
v_max3_f32 v7, v7, v135, v136
v_max3_f32 v6, v6, v121, v122
v_max3_f32 v7, v7, v137, v138
v_max3_f32 v6, v6, v123, v124
v_max3_f32 v7, v7, v139, v140
v_max3_f32 v6, v6, v125, v126
v_max3_f32 v7, v7, v141, v142
v_max_f32 v6, v6, v127
v_max_f32 v7, v7, v143
v_mov_b32 v240, v6
v_mov_b32 v241, v7
s_nop 0
v_permlane32_swap_b32 v6, v240
v_permlane32_swap_b32 v7, v241
v_max_f32 v6, v6, v240
v_max_f32 v7, v7, v241
v_max_f32 v240, abs(v6), abs(v7)
v_cmp_nge_f32 vcc, s79, v240
s_nop 4
s_cbranch_vccnz L_p3_pfix
L_p3_pfix_ret:
v_exp_f32 v80, v80
v_exp_f32 v81, v81
v_exp_f32 v82, v82
v_add_f32 v2, v2, v80
v_exp_f32 v83, v83
v_add_f32 v3, v3, v81
v_cvt_pk_bf16_f32 v80, v80, v81
v_exp_f32 v84, v84
v_add_f32 v2, v2, v82
v_exp_f32 v85, v85
v_add_f32 v3, v3, v83
v_cvt_pk_bf16_f32 v81, v82, v83
v_exp_f32 v86, v86
v_add_f32 v2, v2, v84
v_exp_f32 v87, v87
v_add_f32 v3, v3, v85
v_cvt_pk_bf16_f32 v82, v84, v85
v_exp_f32 v88, v88
v_add_f32 v2, v2, v86
v_exp_f32 v89, v89
v_add_f32 v3, v3, v87
v_cvt_pk_bf16_f32 v83, v86, v87
v_exp_f32 v90, v90
v_add_f32 v2, v2, v88
v_exp_f32 v91, v91
v_add_f32 v3, v3, v89
v_cvt_pk_bf16_f32 v88, v88, v89
v_exp_f32 v92, v92
v_add_f32 v2, v2, v90
v_exp_f32 v93, v93
v_add_f32 v3, v3, v91
v_cvt_pk_bf16_f32 v89, v90, v91
v_exp_f32 v94, v94
v_add_f32 v2, v2, v92
v_exp_f32 v95, v95
v_add_f32 v3, v3, v93
v_cvt_pk_bf16_f32 v90, v92, v93
v_exp_f32 v96, v96
v_add_f32 v2, v2, v94
v_exp_f32 v97, v97
v_add_f32 v3, v3, v95
v_cvt_pk_bf16_f32 v91, v94, v95
v_exp_f32 v98, v98
v_add_f32 v4, v4, v96
v_exp_f32 v99, v99
v_add_f32 v5, v5, v97
v_cvt_pk_bf16_f32 v96, v96, v97
v_exp_f32 v100, v100
v_add_f32 v4, v4, v98
v_exp_f32 v101, v101
v_add_f32 v5, v5, v99
v_cvt_pk_bf16_f32 v97, v98, v99
v_exp_f32 v102, v102
v_add_f32 v4, v4, v100
v_exp_f32 v103, v103
v_add_f32 v5, v5, v101
v_cvt_pk_bf16_f32 v98, v100, v101
v_add_f32 v4, v4, v102
v_add_f32 v5, v5, v103
v_cvt_pk_bf16_f32 v99, v102, v103
s_sub_u32 s74, s70, 1
s_cbranch_scc1 L_p3_d0m_top
.p2align 5
L_p3_d0_top:
s_waitcnt lgkmcnt(0)
v_mfma_f32_32x32x16_bf16 v[144:159], a[128:131], v[16:19], v[208:223]
s_add_u32 m0, s73, 0
ds_read_b128 a[192:195], v11 offset:16384
v_exp_f32 v104, v104
v_exp_f32 v105, v105
v_mfma_f32_32x32x16_bf16 v[160:175], a[128:131], v[48:51], v[224:239]
ds_read_b128 a[196:199], v11 offset:17408
buffer_load_dwordx4 v12, s[56:59], s71 offen offset:0 sc1 lds
v_exp_f32 v106, v106
v_add_f32 v4, v4, v104
v_mfma_f32_32x32x16_bf16 v[144:159], a[132:135], v[20:23], v[144:159]
ds_read_b128 a[200:203], v11 offset:18432
v_exp_f32 v107, v107
v_add_f32 v5, v5, v105
v_cvt_pk_bf16_f32 v104, v104, v105
v_mfma_f32_32x32x16_bf16 v[160:175], a[132:135], v[52:55], v[160:175]
v_exp_f32 v108, v108
v_add_f32 v4, v4, v106
v_exp_f32 v109, v109
v_add_f32 v5, v5, v107
v_mfma_f32_32x32x16_bf16 v[144:159], a[136:139], v[24:27], v[144:159]
ds_read_b128 a[204:207], v11 offset:19456
v_cvt_pk_bf16_f32 v105, v106, v107
v_exp_f32 v110, v110
v_add_f32 v4, v4, v108
v_mfma_f32_32x32x16_bf16 v[160:175], a[136:139], v[56:59], v[160:175]
ds_read_b128 a[208:211], v11 offset:20480
v_exp_f32 v111, v111
v_add_f32 v5, v5, v109
v_cvt_pk_bf16_f32 v106, v108, v109
v_mfma_f32_32x32x16_bf16 v[144:159], a[140:143], v[28:31], v[144:159]
ds_read_b128 a[212:215], v11 offset:21504
v_exp_f32 v112, v112
v_add_f32 v4, v4, v110
v_exp_f32 v113, v113
v_mfma_f32_32x32x16_bf16 v[160:175], a[140:143], v[60:63], v[160:175]
buffer_load_dwordx4 v12, s[56:59], s71 offen offset:1024 sc1 lds
v_add_f32 v5, v5, v111
v_cvt_pk_bf16_f32 v107, v110, v111
v_exp_f32 v114, v114
v_add_f32 v2, v2, v112
v_mfma_f32_32x32x16_bf16 v[144:159], a[144:147], v[32:35], v[144:159]
ds_read_b128 a[216:219], v11 offset:22528
v_exp_f32 v115, v115
v_add_f32 v3, v3, v113
v_cvt_pk_bf16_f32 v112, v112, v113
v_mfma_f32_32x32x16_bf16 v[160:175], a[144:147], v[64:67], v[160:175]
ds_read_b128 a[220:223], v11 offset:23552
v_exp_f32 v116, v116
v_add_f32 v2, v2, v114
v_exp_f32 v117, v117
v_mfma_f32_32x32x16_bf16 v[144:159], a[148:151], v[36:39], v[144:159]
v_add_f32 v3, v3, v115
v_cvt_pk_bf16_f32 v113, v114, v115
v_exp_f32 v118, v118
v_add_f32 v2, v2, v116
v_mfma_f32_32x32x16_bf16 v[160:175], a[148:151], v[68:71], v[160:175]
ds_read_b128 a[224:227], v11 offset:24576
v_exp_f32 v119, v119
v_add_f32 v3, v3, v117
v_cvt_pk_bf16_f32 v114, v116, v117
v_mfma_f32_32x32x16_bf16 v[144:159], a[152:155], v[40:43], v[144:159]
ds_read_b128 a[228:231], v11 offset:25600
v_exp_f32 v120, v120
v_add_f32 v2, v2, v118
v_exp_f32 v121, v121
v_mfma_f32_32x32x16_bf16 v[160:175], a[152:155], v[72:75], v[160:175]
ds_read_b128 a[232:235], v11 offset:26624
buffer_load_dwordx4 v12, s[56:59], s71 offen offset:2048 sc1 lds
v_add_f32 v3, v3, v119
v_cvt_pk_bf16_f32 v115, v118, v119
v_exp_f32 v122, v122
v_mfma_f32_32x32x16_bf16 v[144:159], a[156:159], v[44:47], v[144:159]
v_add_f32 v2, v2, v120
v_exp_f32 v123, v123
v_add_f32 v3, v3, v121
v_mfma_f32_32x32x16_bf16 v[160:175], a[156:159], v[76:79], v[160:175]
ds_read_b128 a[236:239], v11 offset:27648
v_cvt_pk_bf16_f32 v120, v120, v121
v_exp_f32 v124, v124
v_add_f32 v2, v2, v122
v_mfma_f32_32x32x16_bf16 v[176:191], a[160:163], v[16:19], v[208:223]
ds_read_b128 a[240:243], v11 offset:28672
v_exp_f32 v125, v125
v_add_f32 v3, v3, v123
v_cvt_pk_bf16_f32 v121, v122, v123
v_mfma_f32_32x32x16_bf16 v[192:207], a[160:163], v[48:51], v[224:239]
ds_read_b128 a[244:247], v11 offset:29696
v_exp_f32 v126, v126
v_add_f32 v2, v2, v124
v_exp_f32 v127, v127
v_mfma_f32_32x32x16_bf16 v[176:191], a[164:167], v[20:23], v[176:191]
v_add_f32 v3, v3, v125
v_cvt_pk_bf16_f32 v122, v124, v125
v_exp_f32 v128, v128
v_add_f32 v2, v2, v126
v_mfma_f32_32x32x16_bf16 v[192:207], a[164:167], v[52:55], v[192:207]
ds_read_b128 a[248:251], v11 offset:30720
buffer_load_dwordx4 v12, s[56:59], s71 offen offset:3072 sc1 lds
v_exp_f32 v129, v129
v_add_f32 v3, v3, v127
v_cvt_pk_bf16_f32 v123, v126, v127
v_mfma_f32_32x32x16_bf16 v[176:191], a[168:171], v[24:27], v[176:191]
ds_read_b128 a[252:255], v11 offset:31744
v_exp_f32 v130, v130
v_add_f32 v4, v4, v128
v_exp_f32 v131, v131
v_mfma_f32_32x32x16_bf16 v[192:207], a[168:171], v[56:59], v[192:207]
v_add_f32 v5, v5, v129
v_cvt_pk_bf16_f32 v128, v128, v129
v_exp_f32 v132, v132
v_mfma_f32_32x32x16_bf16 v[176:191], a[172:175], v[28:31], v[176:191]
v_add_f32 v4, v4, v130
v_exp_f32 v133, v133
v_add_f32 v5, v5, v131
v_mfma_f32_32x32x16_bf16 v[192:207], a[172:175], v[60:63], v[192:207]
v_cvt_pk_bf16_f32 v129, v130, v131
v_exp_f32 v134, v134
v_add_f32 v4, v4, v132
v_mfma_f32_32x32x16_bf16 v[176:191], a[176:179], v[32:35], v[176:191]
v_exp_f32 v135, v135
v_add_f32 v5, v5, v133
v_cvt_pk_bf16_f32 v130, v132, v133
v_exp_f32 v136, v136
v_mfma_f32_32x32x16_bf16 v[192:207], a[176:179], v[64:67], v[192:207]
s_add_u32 s71, s71, 16384
v_add_f32 v4, v4, v134
v_exp_f32 v137, v137
v_mfma_f32_32x32x16_bf16 v[176:191], a[180:183], v[36:39], v[176:191]
v_add_f32 v5, v5, v135
v_cvt_pk_bf16_f32 v131, v134, v135
v_exp_f32 v138, v138
v_add_f32 v4, v4, v136
v_mfma_f32_32x32x16_bf16 v[192:207], a[180:183], v[68:71], v[192:207]
v_exp_f32 v139, v139
v_add_f32 v5, v5, v137
v_cvt_pk_bf16_f32 v136, v136, v137
v_mfma_f32_32x32x16_bf16 v[176:191], a[184:187], v[40:43], v[176:191]
v_exp_f32 v140, v140
v_add_f32 v4, v4, v138
v_exp_f32 v141, v141
v_mfma_f32_32x32x16_bf16 v[192:207], a[184:187], v[72:75], v[192:207]
v_add_f32 v5, v5, v139
v_cvt_pk_bf16_f32 v137, v138, v139
v_exp_f32 v142, v142
v_mfma_f32_32x32x16_bf16 v[176:191], a[188:191], v[44:47], v[176:191]
v_add_f32 v4, v4, v140
v_exp_f32 v143, v143
v_add_f32 v5, v5, v141
v_mfma_f32_32x32x16_bf16 v[192:207], a[188:191], v[76:79], v[192:207]
v_cvt_pk_bf16_f32 v138, v140, v141
v_add_f32 v4, v4, v142
v_add_f32 v5, v5, v143
v_cvt_pk_bf16_f32 v139, v142, v143
s_waitcnt vmcnt(16) lgkmcnt(0)
v_mfma_f32_32x32x16_bf16 a[0:15], a[192:195], v[80:83], a[0:15]
s_barrier
v_mfma_f32_32x32x16_bf16 a[64:79], a[192:195], v[96:99], a[64:79]
ds_read_b128 a[128:131], v10 offset:16384
v_max3_f32 v6, v144, v145, v146
v_max3_f32 v7, v160, v161, v162
v_max3_f32 v6, v6, v147, v148
v_max3_f32 v7, v7, v163, v164
v_max3_f32 v6, v6, v149, v150
v_mfma_f32_32x32x16_bf16 a[16:31], a[196:199], v[80:83], a[16:31]
ds_read_b128 a[132:135], v10 offset:17408
v_max3_f32 v7, v7, v165, v166
v_max3_f32 v6, v6, v151, v152
v_max3_f32 v7, v7, v167, v168
v_max3_f32 v6, v6, v153, v154
v_max3_f32 v7, v7, v169, v170
v_mfma_f32_32x32x16_bf16 a[80:95], a[196:199], v[96:99], a[80:95]
v_max3_f32 v6, v6, v155, v156
v_max3_f32 v7, v7, v171, v172
v_max3_f32 v6, v6, v157, v158
v_max3_f32 v7, v7, v173, v174
v_max3_f32 v6, v6, v159, v176
v_mfma_f32_32x32x16_bf16 a[32:47], a[200:203], v[80:83], a[32:47]
ds_read_b128 a[136:139], v10 offset:18432
v_max3_f32 v7, v7, v175, v192
v_max3_f32 v6, v6, v177, v178
v_max3_f32 v7, v7, v193, v194
v_max3_f32 v6, v6, v179, v180
v_max3_f32 v7, v7, v195, v196
v_mfma_f32_32x32x16_bf16 a[96:111], a[200:203], v[96:99], a[96:111]
v_max3_f32 v6, v6, v181, v182
v_max3_f32 v7, v7, v197, v198
v_max3_f32 v6, v6, v183, v184
v_max3_f32 v7, v7, v199, v200
v_max3_f32 v6, v6, v185, v186
v_mfma_f32_32x32x16_bf16 a[48:63], a[204:207], v[80:83], a[48:63]
ds_read_b128 a[140:143], v10 offset:19456
v_max3_f32 v7, v7, v201, v202
v_max3_f32 v6, v6, v187, v188
v_max3_f32 v7, v7, v203, v204
v_max3_f32 v6, v6, v189, v190
v_max3_f32 v7, v7, v205, v206
v_mfma_f32_32x32x16_bf16 a[112:127], a[204:207], v[96:99], a[112:127]
v_max_f32 v6, v6, v191
v_max_f32 v7, v7, v207
v_max_f32 v240, v6, v7
v_cmp_lt_f32 vcc, s79, v240
v_mfma_f32_32x32x16_bf16 a[0:15], a[208:211], v[88:91], a[0:15]
s_cbranch_vccnz L_p3_d0_rare
s_add_u32 m0, s72, 0
ds_read_b128 a[144:147], v10 offset:20480
v_exp_f32 v144, v144
v_exp_f32 v145, v145
v_mfma_f32_32x32x16_bf16 a[64:79], a[208:211], v[104:107], a[64:79]
ds_read_b128 a[148:151], v10 offset:21504
buffer_load_dwordx4 v12, s[52:55], s71 offen offset:0 sc1 lds
v_exp_f32 v146, v146
v_add_f32 v2, v2, v144
v_mfma_f32_32x32x16_bf16 a[16:31], a[212:215], v[88:91], a[16:31]
v_exp_f32 v147, v147
v_add_f32 v3, v3, v145
v_cvt_pk_bf16_f32 v144, v144, v145
v_mfma_f32_32x32x16_bf16 a[80:95], a[212:215], v[104:107], a[80:95]
ds_read_b128 a[152:155], v10 offset:22528
v_exp_f32 v148, v148
v_add_f32 v2, v2, v146
v_mfma_f32_32x32x16_bf16 a[32:47], a[216:219], v[88:91], a[32:47]
v_exp_f32 v149, v149
v_add_f32 v3, v3, v147
v_cvt_pk_bf16_f32 v145, v146, v147
v_mfma_f32_32x32x16_bf16 a[96:111], a[216:219], v[104:107], a[96:111]
ds_read_b128 a[156:159], v10 offset:23552
buffer_load_dwordx4 v12, s[52:55], s71 offen offset:1024 sc1 lds
v_exp_f32 v150, v150
v_add_f32 v2, v2, v148
v_mfma_f32_32x32x16_bf16 a[48:63], a[220:223], v[88:91], a[48:63]
ds_read_b128 a[160:163], v10 offset:24576
v_exp_f32 v151, v151
v_add_f32 v3, v3, v149
v_cvt_pk_bf16_f32 v146, v148, v149
v_mfma_f32_32x32x16_bf16 a[112:127], a[220:223], v[104:107], a[112:127]
v_exp_f32 v152, v152
v_add_f32 v2, v2, v150
v_mfma_f32_32x32x16_bf16 a[0:15], a[224:227], v[112:115], a[0:15]
ds_read_b128 a[164:167], v10 offset:25600
v_exp_f32 v153, v153
v_add_f32 v3, v3, v151
v_cvt_pk_bf16_f32 v147, v150, v151
v_mfma_f32_32x32x16_bf16 a[64:79], a[224:227], v[128:131], a[64:79]
v_exp_f32 v154, v154
v_add_f32 v2, v2, v152
v_mfma_f32_32x32x16_bf16 a[16:31], a[228:231], v[112:115], a[16:31]
ds_read_b128 a[168:171], v10 offset:26624
buffer_load_dwordx4 v12, s[52:55], s71 offen offset:2048 sc1 lds
v_exp_f32 v155, v155
v_add_f32 v3, v3, v153
v_cvt_pk_bf16_f32 v152, v152, v153
v_mfma_f32_32x32x16_bf16 a[80:95], a[228:231], v[128:131], a[80:95]
ds_read_b128 a[172:175], v10 offset:27648
v_exp_f32 v156, v156
v_add_f32 v2, v2, v154
v_mfma_f32_32x32x16_bf16 a[32:47], a[232:235], v[112:115], a[32:47]
v_exp_f32 v157, v157
v_add_f32 v3, v3, v155
v_cvt_pk_bf16_f32 v153, v154, v155
v_mfma_f32_32x32x16_bf16 a[96:111], a[232:235], v[128:131], a[96:111]
ds_read_b128 a[176:179], v10 offset:28672
v_exp_f32 v158, v158
v_add_f32 v2, v2, v156
v_mfma_f32_32x32x16_bf16 a[48:63], a[236:239], v[112:115], a[48:63]
buffer_load_dwordx4 v12, s[52:55], s71 offen offset:3072 sc1 lds
v_exp_f32 v159, v159
v_add_f32 v3, v3, v157
v_cvt_pk_bf16_f32 v154, v156, v157
v_mfma_f32_32x32x16_bf16 a[112:127], a[236:239], v[128:131], a[112:127]
ds_read_b128 a[180:183], v10 offset:29696
v_exp_f32 v160, v160
v_add_f32 v2, v2, v158
v_mfma_f32_32x32x16_bf16 a[0:15], a[240:243], v[120:123], a[0:15]
ds_read_b128 a[184:187], v10 offset:30720
v_exp_f32 v161, v161
v_add_f32 v3, v3, v159
v_cvt_pk_bf16_f32 v155, v158, v159
v_mfma_f32_32x32x16_bf16 a[64:79], a[240:243], v[136:139], a[64:79]
v_exp_f32 v162, v162
v_add_f32 v4, v4, v160
v_mfma_f32_32x32x16_bf16 a[16:31], a[244:247], v[120:123], a[16:31]
ds_read_b128 a[188:191], v10 offset:31744
v_exp_f32 v163, v163
v_add_f32 v5, v5, v161
v_cvt_pk_bf16_f32 v160, v160, v161
v_mfma_f32_32x32x16_bf16 a[80:95], a[244:247], v[136:139], a[80:95]
s_sub_u32 s74, s74, 1
v_exp_f32 v164, v164
v_add_f32 v4, v4, v162
v_mfma_f32_32x32x16_bf16 a[32:47], a[248:251], v[120:123], a[32:47]
v_exp_f32 v165, v165
v_add_f32 v5, v5, v163
v_cvt_pk_bf16_f32 v161, v162, v163
v_mfma_f32_32x32x16_bf16 a[96:111], a[248:251], v[136:139], a[96:111]
v_exp_f32 v166, v166
v_add_f32 v4, v4, v164
v_mfma_f32_32x32x16_bf16 a[48:63], a[252:255], v[120:123], a[48:63]
v_exp_f32 v167, v167
v_add_f32 v5, v5, v165
v_cvt_pk_bf16_f32 v162, v164, v165
v_mfma_f32_32x32x16_bf16 a[112:127], a[252:255], v[136:139], a[112:127]
v_add_f32 v4, v4, v166
v_add_f32 v5, v5, v167
v_cvt_pk_bf16_f32 v163, v166, v167
L_p3_d0_end:
s_cbranch_scc1 L_p3_d1m_top
s_waitcnt lgkmcnt(0)
v_xor_b32 v11, 0x8000, v11
v_mfma_f32_32x32x16_bf16 v[80:95], a[128:131], v[16:19], v[208:223]
s_add_u32 m0, s73, 16384
ds_read_b128 a[192:195], v11 offset:0
v_exp_f32 v168, v168
v_exp_f32 v169, v169
v_mfma_f32_32x32x16_bf16 v[96:111], a[128:131], v[48:51], v[224:239]
ds_read_b128 a[196:199], v11 offset:1024
buffer_load_dwordx4 v12, s[56:59], s71 offen offset:0 sc1 lds
v_exp_f32 v170, v170
v_add_f32 v4, v4, v168
v_mfma_f32_32x32x16_bf16 v[80:95], a[132:135], v[20:23], v[80:95]
ds_read_b128 a[200:203], v11 offset:2048
v_exp_f32 v171, v171
v_add_f32 v5, v5, v169
v_cvt_pk_bf16_f32 v168, v168, v169
v_mfma_f32_32x32x16_bf16 v[96:111], a[132:135], v[52:55], v[96:111]
v_exp_f32 v172, v172
v_add_f32 v4, v4, v170
v_exp_f32 v173, v173
v_add_f32 v5, v5, v171
v_mfma_f32_32x32x16_bf16 v[80:95], a[136:139], v[24:27], v[80:95]
ds_read_b128 a[204:207], v11 offset:3072
v_cvt_pk_bf16_f32 v169, v170, v171
v_exp_f32 v174, v174
v_add_f32 v4, v4, v172
v_mfma_f32_32x32x16_bf16 v[96:111], a[136:139], v[56:59], v[96:111]
ds_read_b128 a[208:211], v11 offset:4096
v_exp_f32 v175, v175
v_add_f32 v5, v5, v173
v_cvt_pk_bf16_f32 v170, v172, v173
v_mfma_f32_32x32x16_bf16 v[80:95], a[140:143], v[28:31], v[80:95]
ds_read_b128 a[212:215], v11 offset:5120
buffer_load_dwordx4 v12, s[56:59], s71 offen offset:1024 sc1 lds
v_exp_f32 v176, v176
v_add_f32 v4, v4, v174
v_mfma_f32_32x32x16_bf16 v[96:111], a[140:143], v[60:63], v[96:111]
v_exp_f32 v177, v177
v_add_f32 v5, v5, v175
v_cvt_pk_bf16_f32 v171, v174, v175
v_exp_f32 v178, v178
v_mfma_f32_32x32x16_bf16 v[80:95], a[144:147], v[32:35], v[80:95]
ds_read_b128 a[216:219], v11 offset:6144
v_add_f32 v2, v2, v176
v_exp_f32 v179, v179
v_add_f32 v3, v3, v177
v_cvt_pk_bf16_f32 v176, v176, v177
v_mfma_f32_32x32x16_bf16 v[96:111], a[144:147], v[64:67], v[96:111]
ds_read_b128 a[220:223], v11 offset:7168
v_exp_f32 v180, v180
v_add_f32 v2, v2, v178
v_exp_f32 v181, v181
v_mfma_f32_32x32x16_bf16 v[80:95], a[148:151], v[36:39], v[80:95]
v_add_f32 v3, v3, v179
v_cvt_pk_bf16_f32 v177, v178, v179
v_exp_f32 v182, v182
v_add_f32 v2, v2, v180
v_mfma_f32_32x32x16_bf16 v[96:111], a[148:151], v[68:71], v[96:111]
ds_read_b128 a[224:227], v11 offset:8192
buffer_load_dwordx4 v12, s[56:59], s71 offen offset:2048 sc1 lds
v_exp_f32 v183, v183
v_add_f32 v3, v3, v181
v_cvt_pk_bf16_f32 v178, v180, v181
v_mfma_f32_32x32x16_bf16 v[80:95], a[152:155], v[40:43], v[80:95]
ds_read_b128 a[228:231], v11 offset:9216
v_exp_f32 v184, v184
v_add_f32 v2, v2, v182
v_exp_f32 v185, v185
v_mfma_f32_32x32x16_bf16 v[96:111], a[152:155], v[72:75], v[96:111]
ds_read_b128 a[232:235], v11 offset:10240
v_add_f32 v3, v3, v183
v_cvt_pk_bf16_f32 v179, v182, v183
v_exp_f32 v186, v186
v_mfma_f32_32x32x16_bf16 v[80:95], a[156:159], v[44:47], v[80:95]
v_add_f32 v2, v2, v184
v_exp_f32 v187, v187
v_add_f32 v3, v3, v185
v_mfma_f32_32x32x16_bf16 v[96:111], a[156:159], v[76:79], v[96:111]
ds_read_b128 a[236:239], v11 offset:11264
v_cvt_pk_bf16_f32 v184, v184, v185
v_exp_f32 v188, v188
v_add_f32 v2, v2, v186
v_mfma_f32_32x32x16_bf16 v[112:127], a[160:163], v[16:19], v[208:223]
ds_read_b128 a[240:243], v11 offset:12288
buffer_load_dwordx4 v12, s[56:59], s71 offen offset:3072 sc1 lds
v_exp_f32 v189, v189
v_add_f32 v3, v3, v187
v_cvt_pk_bf16_f32 v185, v186, v187
v_mfma_f32_32x32x16_bf16 v[128:143], a[160:163], v[48:51], v[224:239]
ds_read_b128 a[244:247], v11 offset:13312
v_exp_f32 v190, v190
v_add_f32 v2, v2, v188
v_exp_f32 v191, v191
v_mfma_f32_32x32x16_bf16 v[112:127], a[164:167], v[20:23], v[112:127]
v_add_f32 v3, v3, v189
v_cvt_pk_bf16_f32 v186, v188, v189
v_exp_f32 v192, v192
v_add_f32 v2, v2, v190
v_mfma_f32_32x32x16_bf16 v[128:143], a[164:167], v[52:55], v[128:143]
ds_read_b128 a[248:251], v11 offset:14336
v_exp_f32 v193, v193
v_add_f32 v3, v3, v191
v_cvt_pk_bf16_f32 v187, v190, v191
v_mfma_f32_32x32x16_bf16 v[112:127], a[168:171], v[24:27], v[112:127]
ds_read_b128 a[252:255], v11 offset:15360
v_exp_f32 v194, v194
v_add_f32 v4, v4, v192
v_exp_f32 v195, v195
v_mfma_f32_32x32x16_bf16 v[128:143], a[168:171], v[56:59], v[128:143]
s_add_u32 s71, s71, 16384
v_add_f32 v5, v5, v193
v_cvt_pk_bf16_f32 v192, v192, v193
v_exp_f32 v196, v196
v_mfma_f32_32x32x16_bf16 v[112:127], a[172:175], v[28:31], v[112:127]
v_add_f32 v4, v4, v194
v_exp_f32 v197, v197
v_add_f32 v5, v5, v195
v_mfma_f32_32x32x16_bf16 v[128:143], a[172:175], v[60:63], v[128:143]
v_cvt_pk_bf16_f32 v193, v194, v195
v_exp_f32 v198, v198
v_add_f32 v4, v4, v196
v_mfma_f32_32x32x16_bf16 v[112:127], a[176:179], v[32:35], v[112:127]
v_exp_f32 v199, v199
v_add_f32 v5, v5, v197
v_cvt_pk_bf16_f32 v194, v196, v197
v_exp_f32 v200, v200
v_mfma_f32_32x32x16_bf16 v[128:143], a[176:179], v[64:67], v[128:143]
v_add_f32 v4, v4, v198
v_exp_f32 v201, v201
v_mfma_f32_32x32x16_bf16 v[112:127], a[180:183], v[36:39], v[112:127]
s_xor_b32 s73, s73, 0x8000
v_add_f32 v5, v5, v199
v_cvt_pk_bf16_f32 v195, v198, v199
v_exp_f32 v202, v202
v_add_f32 v4, v4, v200
v_mfma_f32_32x32x16_bf16 v[128:143], a[180:183], v[68:71], v[128:143]
v_exp_f32 v203, v203
v_add_f32 v5, v5, v201
v_cvt_pk_bf16_f32 v200, v200, v201
v_mfma_f32_32x32x16_bf16 v[112:127], a[184:187], v[40:43], v[112:127]
v_exp_f32 v204, v204
v_add_f32 v4, v4, v202
v_exp_f32 v205, v205
v_mfma_f32_32x32x16_bf16 v[128:143], a[184:187], v[72:75], v[128:143]
v_add_f32 v5, v5, v203
v_cvt_pk_bf16_f32 v201, v202, v203
v_exp_f32 v206, v206
v_mfma_f32_32x32x16_bf16 v[112:127], a[188:191], v[44:47], v[112:127]
v_add_f32 v4, v4, v204
v_exp_f32 v207, v207
v_add_f32 v5, v5, v205
v_mfma_f32_32x32x16_bf16 v[128:143], a[188:191], v[76:79], v[128:143]
v_cvt_pk_bf16_f32 v202, v204, v205
v_add_f32 v4, v4, v206
v_add_f32 v5, v5, v207
v_cvt_pk_bf16_f32 v203, v206, v207
s_waitcnt vmcnt(16) lgkmcnt(0)
v_mfma_f32_32x32x16_bf16 a[0:15], a[192:195], v[144:147], a[0:15]
s_barrier
v_xor_b32 v10, 0x8000, v10
v_mfma_f32_32x32x16_bf16 a[64:79], a[192:195], v[160:163], a[64:79]
ds_read_b128 a[128:131], v10 offset:0
v_max3_f32 v6, v80, v81, v82
v_max3_f32 v7, v96, v97, v98
v_max3_f32 v6, v6, v83, v84
v_max3_f32 v7, v7, v99, v100
v_max3_f32 v6, v6, v85, v86
v_mfma_f32_32x32x16_bf16 a[16:31], a[196:199], v[144:147], a[16:31]
ds_read_b128 a[132:135], v10 offset:1024
v_max3_f32 v7, v7, v101, v102
v_max3_f32 v6, v6, v87, v88
v_max3_f32 v7, v7, v103, v104
v_max3_f32 v6, v6, v89, v90
v_max3_f32 v7, v7, v105, v106
v_mfma_f32_32x32x16_bf16 a[80:95], a[196:199], v[160:163], a[80:95]
v_max3_f32 v6, v6, v91, v92
v_max3_f32 v7, v7, v107, v108
v_max3_f32 v6, v6, v93, v94
v_max3_f32 v7, v7, v109, v110
v_max3_f32 v6, v6, v95, v112
v_mfma_f32_32x32x16_bf16 a[32:47], a[200:203], v[144:147], a[32:47]
ds_read_b128 a[136:139], v10 offset:2048
v_max3_f32 v7, v7, v111, v128
v_max3_f32 v6, v6, v113, v114
v_max3_f32 v7, v7, v129, v130
v_max3_f32 v6, v6, v115, v116
v_max3_f32 v7, v7, v131, v132
v_mfma_f32_32x32x16_bf16 a[96:111], a[200:203], v[160:163], a[96:111]
v_max3_f32 v6, v6, v117, v118
v_max3_f32 v7, v7, v133, v134
v_max3_f32 v6, v6, v119, v120
v_max3_f32 v7, v7, v135, v136
v_max3_f32 v6, v6, v121, v122
v_mfma_f32_32x32x16_bf16 a[48:63], a[204:207], v[144:147], a[48:63]
ds_read_b128 a[140:143], v10 offset:3072
v_max3_f32 v7, v7, v137, v138
v_max3_f32 v6, v6, v123, v124
v_max3_f32 v7, v7, v139, v140
v_max3_f32 v6, v6, v125, v126
v_max3_f32 v7, v7, v141, v142
v_mfma_f32_32x32x16_bf16 a[112:127], a[204:207], v[160:163], a[112:127]
v_max_f32 v6, v6, v127
v_max_f32 v7, v7, v143
v_max_f32 v240, v6, v7
v_cmp_lt_f32 vcc, s79, v240
v_mfma_f32_32x32x16_bf16 a[0:15], a[208:211], v[152:155], a[0:15]
s_cbranch_vccnz L_p3_d1_rare
s_add_u32 m0, s72, 16384
ds_read_b128 a[144:147], v10 offset:4096
v_exp_f32 v80, v80
v_exp_f32 v81, v81
v_mfma_f32_32x32x16_bf16 a[64:79], a[208:211], v[168:171], a[64:79]
ds_read_b128 a[148:151], v10 offset:5120
buffer_load_dwordx4 v12, s[52:55], s71 offen offset:0 sc1 lds
v_exp_f32 v82, v82
v_add_f32 v2, v2, v80
v_mfma_f32_32x32x16_bf16 a[16:31], a[212:215], v[152:155], a[16:31]
v_exp_f32 v83, v83
v_add_f32 v3, v3, v81
v_cvt_pk_bf16_f32 v80, v80, v81
v_mfma_f32_32x32x16_bf16 a[80:95], a[212:215], v[168:171], a[80:95]
ds_read_b128 a[152:155], v10 offset:6144
v_exp_f32 v84, v84
v_add_f32 v2, v2, v82
v_mfma_f32_32x32x16_bf16 a[32:47], a[216:219], v[152:155], a[32:47]
v_exp_f32 v85, v85
v_add_f32 v3, v3, v83
v_cvt_pk_bf16_f32 v81, v82, v83
v_mfma_f32_32x32x16_bf16 a[96:111], a[216:219], v[168:171], a[96:111]
ds_read_b128 a[156:159], v10 offset:7168
buffer_load_dwordx4 v12, s[52:55], s71 offen offset:1024 sc1 lds
v_exp_f32 v86, v86
v_add_f32 v2, v2, v84
v_mfma_f32_32x32x16_bf16 a[48:63], a[220:223], v[152:155], a[48:63]
ds_read_b128 a[160:163], v10 offset:8192
v_exp_f32 v87, v87
v_add_f32 v3, v3, v85
v_cvt_pk_bf16_f32 v82, v84, v85
v_mfma_f32_32x32x16_bf16 a[112:127], a[220:223], v[168:171], a[112:127]
v_exp_f32 v88, v88
v_add_f32 v2, v2, v86
v_mfma_f32_32x32x16_bf16 a[0:15], a[224:227], v[176:179], a[0:15]
ds_read_b128 a[164:167], v10 offset:9216
v_exp_f32 v89, v89
v_add_f32 v3, v3, v87
v_cvt_pk_bf16_f32 v83, v86, v87
v_mfma_f32_32x32x16_bf16 a[64:79], a[224:227], v[192:195], a[64:79]
v_exp_f32 v90, v90
v_add_f32 v2, v2, v88
v_mfma_f32_32x32x16_bf16 a[16:31], a[228:231], v[176:179], a[16:31]
ds_read_b128 a[168:171], v10 offset:10240
buffer_load_dwordx4 v12, s[52:55], s71 offen offset:2048 sc1 lds
v_exp_f32 v91, v91
v_add_f32 v3, v3, v89
v_cvt_pk_bf16_f32 v88, v88, v89
v_mfma_f32_32x32x16_bf16 a[80:95], a[228:231], v[192:195], a[80:95]
ds_read_b128 a[172:175], v10 offset:11264
v_exp_f32 v92, v92
v_add_f32 v2, v2, v90
v_mfma_f32_32x32x16_bf16 a[32:47], a[232:235], v[176:179], a[32:47]
v_exp_f32 v93, v93
v_add_f32 v3, v3, v91
v_cvt_pk_bf16_f32 v89, v90, v91
v_mfma_f32_32x32x16_bf16 a[96:111], a[232:235], v[192:195], a[96:111]
ds_read_b128 a[176:179], v10 offset:12288
v_exp_f32 v94, v94
v_add_f32 v2, v2, v92
v_mfma_f32_32x32x16_bf16 a[48:63], a[236:239], v[176:179], a[48:63]
buffer_load_dwordx4 v12, s[52:55], s71 offen offset:3072 sc1 lds
v_exp_f32 v95, v95
v_add_f32 v3, v3, v93
v_cvt_pk_bf16_f32 v90, v92, v93
v_mfma_f32_32x32x16_bf16 a[112:127], a[236:239], v[192:195], a[112:127]
ds_read_b128 a[180:183], v10 offset:13312
v_exp_f32 v96, v96
v_add_f32 v2, v2, v94
v_mfma_f32_32x32x16_bf16 a[0:15], a[240:243], v[184:187], a[0:15]
ds_read_b128 a[184:187], v10 offset:14336
v_exp_f32 v97, v97
v_add_f32 v3, v3, v95
v_cvt_pk_bf16_f32 v91, v94, v95
v_mfma_f32_32x32x16_bf16 a[64:79], a[240:243], v[200:203], a[64:79]
v_exp_f32 v98, v98
v_add_f32 v4, v4, v96
v_mfma_f32_32x32x16_bf16 a[16:31], a[244:247], v[184:187], a[16:31]
ds_read_b128 a[188:191], v10 offset:15360
v_exp_f32 v99, v99
v_add_f32 v5, v5, v97
v_cvt_pk_bf16_f32 v96, v96, v97
v_mfma_f32_32x32x16_bf16 a[80:95], a[244:247], v[200:203], a[80:95]
s_xor_b32 s72, s72, 0x8000
v_exp_f32 v100, v100
v_add_f32 v4, v4, v98
v_mfma_f32_32x32x16_bf16 a[32:47], a[248:251], v[184:187], a[32:47]
v_exp_f32 v101, v101
v_add_f32 v5, v5, v99
v_cvt_pk_bf16_f32 v97, v98, v99
v_mfma_f32_32x32x16_bf16 a[96:111], a[248:251], v[200:203], a[96:111]
v_exp_f32 v102, v102
v_add_f32 v4, v4, v100
v_mfma_f32_32x32x16_bf16 a[48:63], a[252:255], v[184:187], a[48:63]
v_exp_f32 v103, v103
v_add_f32 v5, v5, v101
v_cvt_pk_bf16_f32 v98, v100, v101
v_mfma_f32_32x32x16_bf16 a[112:127], a[252:255], v[200:203], a[112:127]
v_add_f32 v4, v4, v102
v_add_f32 v5, v5, v103
v_cvt_pk_bf16_f32 v99, v102, v103
L_p3_d1_end:
s_branch L_p3_d0_top
L_p3_d1m_top:
s_waitcnt lgkmcnt(0)
v_xor_b32 v11, 0x8000, v11
v_mfma_f32_32x32x16_bf16 v[80:95], a[128:131], v[16:19], v[208:223]
s_add_u32 m0, s73, 16384
ds_read_b128 a[192:195], v11 offset:0
v_exp_f32 v168, v168
v_exp_f32 v169, v169
v_mfma_f32_32x32x16_bf16 v[96:111], a[128:131], v[48:51], v[224:239]
ds_read_b128 a[196:199], v11 offset:1024
buffer_load_dwordx4 v12, s[56:59], s71 offen offset:0 sc1 lds
v_exp_f32 v170, v170
v_add_f32 v4, v4, v168
v_mfma_f32_32x32x16_bf16 v[80:95], a[132:135], v[20:23], v[80:95]
ds_read_b128 a[200:203], v11 offset:2048
v_exp_f32 v171, v171
v_add_f32 v5, v5, v169
v_cvt_pk_bf16_f32 v168, v168, v169
v_mfma_f32_32x32x16_bf16 v[96:111], a[132:135], v[52:55], v[96:111]
v_exp_f32 v172, v172
v_add_f32 v4, v4, v170
v_exp_f32 v173, v173
v_add_f32 v5, v5, v171
v_mfma_f32_32x32x16_bf16 v[80:95], a[136:139], v[24:27], v[80:95]
ds_read_b128 a[204:207], v11 offset:3072
v_cvt_pk_bf16_f32 v169, v170, v171
v_exp_f32 v174, v174
v_add_f32 v4, v4, v172
v_mfma_f32_32x32x16_bf16 v[96:111], a[136:139], v[56:59], v[96:111]
ds_read_b128 a[208:211], v11 offset:4096
v_exp_f32 v175, v175
v_add_f32 v5, v5, v173
v_cvt_pk_bf16_f32 v170, v172, v173
v_mfma_f32_32x32x16_bf16 v[80:95], a[140:143], v[28:31], v[80:95]
ds_read_b128 a[212:215], v11 offset:5120
buffer_load_dwordx4 v12, s[56:59], s71 offen offset:1024 sc1 lds
v_exp_f32 v176, v176
v_add_f32 v4, v4, v174
v_mfma_f32_32x32x16_bf16 v[96:111], a[140:143], v[60:63], v[96:111]
v_exp_f32 v177, v177
v_add_f32 v5, v5, v175
v_cvt_pk_bf16_f32 v171, v174, v175
v_exp_f32 v178, v178
v_mfma_f32_32x32x16_bf16 v[80:95], a[144:147], v[32:35], v[80:95]
ds_read_b128 a[216:219], v11 offset:6144
v_add_f32 v2, v2, v176
v_exp_f32 v179, v179
v_add_f32 v3, v3, v177
v_cvt_pk_bf16_f32 v176, v176, v177
v_mfma_f32_32x32x16_bf16 v[96:111], a[144:147], v[64:67], v[96:111]
ds_read_b128 a[220:223], v11 offset:7168
v_exp_f32 v180, v180
v_add_f32 v2, v2, v178
v_exp_f32 v181, v181
v_mfma_f32_32x32x16_bf16 v[80:95], a[148:151], v[36:39], v[80:95]
v_add_f32 v3, v3, v179
v_cvt_pk_bf16_f32 v177, v178, v179
v_exp_f32 v182, v182
v_add_f32 v2, v2, v180
v_mfma_f32_32x32x16_bf16 v[96:111], a[148:151], v[68:71], v[96:111]
ds_read_b128 a[224:227], v11 offset:8192
buffer_load_dwordx4 v12, s[56:59], s71 offen offset:2048 sc1 lds
v_exp_f32 v183, v183
v_add_f32 v3, v3, v181
v_cvt_pk_bf16_f32 v178, v180, v181
v_mfma_f32_32x32x16_bf16 v[80:95], a[152:155], v[40:43], v[80:95]
ds_read_b128 a[228:231], v11 offset:9216
v_exp_f32 v184, v184
v_add_f32 v2, v2, v182
v_exp_f32 v185, v185
v_mfma_f32_32x32x16_bf16 v[96:111], a[152:155], v[72:75], v[96:111]
ds_read_b128 a[232:235], v11 offset:10240
v_add_f32 v3, v3, v183
v_cvt_pk_bf16_f32 v179, v182, v183
v_exp_f32 v186, v186
v_mfma_f32_32x32x16_bf16 v[80:95], a[156:159], v[44:47], v[80:95]
v_add_f32 v2, v2, v184
v_exp_f32 v187, v187
v_add_f32 v3, v3, v185
v_mfma_f32_32x32x16_bf16 v[96:111], a[156:159], v[76:79], v[96:111]
ds_read_b128 a[236:239], v11 offset:11264
v_cvt_pk_bf16_f32 v184, v184, v185
v_exp_f32 v188, v188
v_add_f32 v2, v2, v186
v_mfma_f32_32x32x16_bf16 v[112:127], a[160:163], v[16:19], v[208:223]
ds_read_b128 a[240:243], v11 offset:12288
buffer_load_dwordx4 v12, s[56:59], s71 offen offset:3072 sc1 lds
v_exp_f32 v189, v189
v_add_f32 v3, v3, v187
v_cvt_pk_bf16_f32 v185, v186, v187
v_mfma_f32_32x32x16_bf16 v[128:143], a[160:163], v[48:51], v[224:239]
ds_read_b128 a[244:247], v11 offset:13312
v_exp_f32 v190, v190
v_add_f32 v2, v2, v188
v_exp_f32 v191, v191
v_mfma_f32_32x32x16_bf16 v[112:127], a[164:167], v[20:23], v[112:127]
v_add_f32 v3, v3, v189
v_cvt_pk_bf16_f32 v186, v188, v189
v_exp_f32 v192, v192
v_add_f32 v2, v2, v190
v_mfma_f32_32x32x16_bf16 v[128:143], a[164:167], v[52:55], v[128:143]
ds_read_b128 a[248:251], v11 offset:14336
v_exp_f32 v193, v193
v_add_f32 v3, v3, v191
v_cvt_pk_bf16_f32 v187, v190, v191
v_add_u32 v246, 0, v13
v_mfma_f32_32x32x16_bf16 v[112:127], a[168:171], v[24:27], v[112:127]
ds_read_b128 a[252:255], v11 offset:15360
v_cmp_gt_i32_e64 s[84:85], 0, v246
v_cmp_gt_i32_e64 s[86:87], 1, v246
v_exp_f32 v194, v194
v_add_f32 v4, v4, v192
v_mfma_f32_32x32x16_bf16 v[128:143], a[168:171], v[56:59], v[128:143]
s_add_u32 s71, s71, 16384
v_exp_f32 v195, v195
v_cmp_gt_i32_e64 s[88:89], 2, v246
v_cmp_gt_i32_e64 s[90:91], 3, v246
v_cndmask_b32_e64 v96, v96, v14, s[84:85]
v_mfma_f32_32x32x16_bf16 v[112:127], a[172:175], v[28:31], v[112:127]
v_add_f32 v5, v5, v193
v_cvt_pk_bf16_f32 v192, v192, v193
v_exp_f32 v196, v196
v_cndmask_b32_e64 v97, v97, v14, s[86:87]
v_cndmask_b32_e64 v98, v98, v14, s[88:89]
v_mfma_f32_32x32x16_bf16 v[128:143], a[172:175], v[60:63], v[128:143]
v_add_f32 v4, v4, v194
v_exp_f32 v197, v197
v_add_f32 v5, v5, v195
v_cndmask_b32_e64 v99, v99, v14, s[90:91]
v_cmp_gt_i32_e64 s[92:93], 16, v246
v_mfma_f32_32x32x16_bf16 v[112:127], a[176:179], v[32:35], v[112:127]
v_cmp_gt_i32_e64 s[94:95], 17, v246
v_cvt_pk_bf16_f32 v193, v194, v195
v_exp_f32 v198, v198
v_add_f32 v4, v4, v196
v_cmp_gt_i32_e64 s[96:97], 18, v246
v_mfma_f32_32x32x16_bf16 v[128:143], a[176:179], v[64:67], v[128:143]
v_cmp_gt_i32_e64 s[98:99], 19, v246
v_exp_f32 v199, v199
v_add_f32 v5, v5, v197
v_cvt_pk_bf16_f32 v194, v196, v197
v_cndmask_b32_e64 v100, v100, v14, s[92:93]
v_mfma_f32_32x32x16_bf16 v[112:127], a[180:183], v[36:39], v[112:127]
s_xor_b32 s73, s73, 0x8000
v_exp_f32 v200, v200
v_cndmask_b32_e64 v101, v101, v14, s[94:95]
v_cndmask_b32_e64 v102, v102, v14, s[96:97]
v_add_f32 v4, v4, v198
v_mfma_f32_32x32x16_bf16 v[128:143], a[180:183], v[68:71], v[128:143]
v_exp_f32 v201, v201
v_cndmask_b32_e64 v103, v103, v14, s[98:99]
v_cmp_gt_i32_e64 s[84:85], 8, v246
v_add_f32 v5, v5, v199
v_cvt_pk_bf16_f32 v195, v198, v199
v_mfma_f32_32x32x16_bf16 v[112:127], a[184:187], v[40:43], v[112:127]
v_exp_f32 v202, v202
v_add_f32 v4, v4, v200
v_cmp_gt_i32_e64 s[86:87], 9, v246
v_cmp_gt_i32_e64 s[88:89], 10, v246
v_cmp_gt_i32_e64 s[90:91], 11, v246
v_mfma_f32_32x32x16_bf16 v[128:143], a[184:187], v[72:75], v[128:143]
v_exp_f32 v203, v203
v_add_f32 v5, v5, v201
v_cvt_pk_bf16_f32 v200, v200, v201
v_cndmask_b32_e64 v104, v104, v14, s[84:85]
v_cndmask_b32_e64 v105, v105, v14, s[86:87]
v_mfma_f32_32x32x16_bf16 v[112:127], a[188:191], v[44:47], v[112:127]
v_exp_f32 v204, v204
v_add_f32 v4, v4, v202
v_exp_f32 v205, v205
v_cndmask_b32_e64 v106, v106, v14, s[88:89]
v_mfma_f32_32x32x16_bf16 v[128:143], a[188:191], v[76:79], v[128:143]
v_cndmask_b32_e64 v107, v107, v14, s[90:91]
v_cmp_gt_i32_e64 s[92:93], 24, v246
v_add_f32 v5, v5, v203
v_cvt_pk_bf16_f32 v201, v202, v203
v_exp_f32 v206, v206
v_cmp_gt_i32_e64 s[94:95], 25, v246
v_cmp_gt_i32_e64 s[96:97], 26, v246
v_add_f32 v4, v4, v204
v_exp_f32 v207, v207
v_add_f32 v5, v5, v205
v_cmp_gt_i32_e64 s[98:99], 27, v246
v_cndmask_b32_e64 v108, v108, v14, s[92:93]
v_cndmask_b32_e64 v109, v109, v14, s[94:95]
v_cvt_pk_bf16_f32 v202, v204, v205
v_add_f32 v4, v4, v206
v_add_f32 v5, v5, v207
v_cvt_pk_bf16_f32 v203, v206, v207
v_cndmask_b32_e64 v110, v110, v14, s[96:97]
v_cndmask_b32_e64 v111, v111, v14, s[98:99]
s_waitcnt vmcnt(16) lgkmcnt(0)
v_mfma_f32_32x32x16_bf16 a[0:15], a[192:195], v[144:147], a[0:15]
s_barrier
v_xor_b32 v10, 0x8000, v10
v_mfma_f32_32x32x16_bf16 a[64:79], a[192:195], v[160:163], a[64:79]
ds_read_b128 a[128:131], v10 offset:0
v_max3_f32 v6, v80, v81, v82
v_max3_f32 v7, v96, v97, v98
v_max3_f32 v6, v6, v83, v84
v_max3_f32 v7, v7, v99, v100
v_max3_f32 v6, v6, v85, v86
v_mfma_f32_32x32x16_bf16 a[16:31], a[196:199], v[144:147], a[16:31]
ds_read_b128 a[132:135], v10 offset:1024
v_max3_f32 v7, v7, v101, v102
v_max3_f32 v6, v6, v87, v88
v_max3_f32 v7, v7, v103, v104
v_max3_f32 v6, v6, v89, v90
v_max3_f32 v7, v7, v105, v106
v_mfma_f32_32x32x16_bf16 a[80:95], a[196:199], v[160:163], a[80:95]
v_max3_f32 v6, v6, v91, v92
v_max3_f32 v7, v7, v107, v108
v_max3_f32 v6, v6, v93, v94
v_max3_f32 v7, v7, v109, v110
v_add_u32 v247, -32, v13
v_mfma_f32_32x32x16_bf16 a[32:47], a[200:203], v[144:147], a[32:47]
ds_read_b128 a[136:139], v10 offset:2048
v_cmp_gt_i32_e64 s[84:85], 0, v247
v_cmp_gt_i32_e64 s[86:87], 1, v247
v_cmp_gt_i32_e64 s[88:89], 2, v247
v_cmp_gt_i32_e64 s[90:91], 3, v247
v_cndmask_b32_e64 v128, v128, v14, s[84:85]
v_mfma_f32_32x32x16_bf16 a[96:111], a[200:203], v[160:163], a[96:111]
v_cndmask_b32_e64 v129, v129, v14, s[86:87]
v_cndmask_b32_e64 v130, v130, v14, s[88:89]
v_cndmask_b32_e64 v131, v131, v14, s[90:91]
v_cmp_gt_i32_e64 s[92:93], 16, v247
v_mfma_f32_32x32x16_bf16 a[48:63], a[204:207], v[144:147], a[48:63]
ds_read_b128 a[140:143], v10 offset:3072
v_cmp_gt_i32_e64 s[94:95], 17, v247
v_cmp_gt_i32_e64 s[96:97], 18, v247
v_cmp_gt_i32_e64 s[98:99], 19, v247
v_cndmask_b32_e64 v132, v132, v14, s[92:93]
v_cndmask_b32_e64 v133, v133, v14, s[94:95]
v_mfma_f32_32x32x16_bf16 a[112:127], a[204:207], v[160:163], a[112:127]
v_cndmask_b32_e64 v134, v134, v14, s[96:97]
v_cndmask_b32_e64 v135, v135, v14, s[98:99]
v_cmp_gt_i32_e64 s[84:85], 8, v247
v_cmp_gt_i32_e64 s[86:87], 9, v247
v_cmp_gt_i32_e64 s[88:89], 10, v247
v_mfma_f32_32x32x16_bf16 a[0:15], a[208:211], v[152:155], a[0:15]
ds_read_b128 a[144:147], v10 offset:4096
v_cmp_gt_i32_e64 s[90:91], 11, v247
v_cndmask_b32_e64 v136, v136, v14, s[84:85]
v_cndmask_b32_e64 v137, v137, v14, s[86:87]
v_cndmask_b32_e64 v138, v138, v14, s[88:89]
v_cndmask_b32_e64 v139, v139, v14, s[90:91]
v_mfma_f32_32x32x16_bf16 a[64:79], a[208:211], v[168:171], a[64:79]
ds_read_b128 a[148:151], v10 offset:5120
v_cmp_gt_i32_e64 s[92:93], 24, v247
v_cmp_gt_i32_e64 s[94:95], 25, v247
v_cmp_gt_i32_e64 s[96:97], 26, v247
v_cmp_gt_i32_e64 s[98:99], 27, v247
v_cndmask_b32_e64 v140, v140, v14, s[92:93]
v_mfma_f32_32x32x16_bf16 a[16:31], a[212:215], v[152:155], a[16:31]
v_cndmask_b32_e64 v141, v141, v14, s[94:95]
v_cndmask_b32_e64 v142, v142, v14, s[96:97]
v_cndmask_b32_e64 v143, v143, v14, s[98:99]
v_max3_f32 v6, v6, v95, v112
v_mfma_f32_32x32x16_bf16 a[80:95], a[212:215], v[168:171], a[80:95]
ds_read_b128 a[152:155], v10 offset:6144
v_max3_f32 v7, v7, v111, v128
v_max3_f32 v6, v6, v113, v114
v_max3_f32 v7, v7, v129, v130
v_max3_f32 v6, v6, v115, v116
v_max3_f32 v7, v7, v131, v132
v_mfma_f32_32x32x16_bf16 a[32:47], a[216:219], v[152:155], a[32:47]
v_max3_f32 v6, v6, v117, v118
v_max3_f32 v7, v7, v133, v134
v_max3_f32 v6, v6, v119, v120
v_max3_f32 v7, v7, v135, v136
v_max3_f32 v6, v6, v121, v122
v_mfma_f32_32x32x16_bf16 a[96:111], a[216:219], v[168:171], a[96:111]
ds_read_b128 a[156:159], v10 offset:7168
v_max3_f32 v7, v7, v137, v138
v_max3_f32 v6, v6, v123, v124
v_max3_f32 v7, v7, v139, v140
v_max3_f32 v6, v6, v125, v126
v_max3_f32 v7, v7, v141, v142
v_mfma_f32_32x32x16_bf16 a[48:63], a[220:223], v[152:155], a[48:63]
v_max_f32 v6, v6, v127
v_max_f32 v7, v7, v143
v_max_f32 v240, v6, v7
v_cmp_lt_f32 vcc, s79, v240
v_mfma_f32_32x32x16_bf16 a[112:127], a[220:223], v[168:171], a[112:127]
s_cbranch_vccnz L_p3_d1m_rare
s_add_u32 m0, s72, 16384
ds_read_b128 a[160:163], v10 offset:8192
v_exp_f32 v80, v80
v_exp_f32 v81, v81
v_mfma_f32_32x32x16_bf16 a[0:15], a[224:227], v[176:179], a[0:15]
ds_read_b128 a[164:167], v10 offset:9216
buffer_load_dwordx4 v12, s[52:55], s71 offen offset:0 sc1 lds
v_exp_f32 v82, v82
v_add_f32 v2, v2, v80
v_mfma_f32_32x32x16_bf16 a[64:79], a[224:227], v[192:195], a[64:79]
v_exp_f32 v83, v83
v_add_f32 v3, v3, v81
v_cvt_pk_bf16_f32 v80, v80, v81
v_exp_f32 v84, v84
v_mfma_f32_32x32x16_bf16 a[16:31], a[228:231], v[176:179], a[16:31]
ds_read_b128 a[168:171], v10 offset:10240
v_add_f32 v2, v2, v82
v_exp_f32 v85, v85
v_add_f32 v3, v3, v83
v_cvt_pk_bf16_f32 v81, v82, v83
v_mfma_f32_32x32x16_bf16 a[80:95], a[228:231], v[192:195], a[80:95]
ds_read_b128 a[172:175], v10 offset:11264
buffer_load_dwordx4 v12, s[52:55], s71 offen offset:1024 sc1 lds
v_exp_f32 v86, v86
v_add_f32 v2, v2, v84
v_mfma_f32_32x32x16_bf16 a[32:47], a[232:235], v[176:179], a[32:47]
v_exp_f32 v87, v87
v_add_f32 v3, v3, v85
v_cvt_pk_bf16_f32 v82, v84, v85
v_exp_f32 v88, v88
v_mfma_f32_32x32x16_bf16 a[96:111], a[232:235], v[192:195], a[96:111]
ds_read_b128 a[176:179], v10 offset:12288
v_add_f32 v2, v2, v86
v_exp_f32 v89, v89
v_add_f32 v3, v3, v87
v_cvt_pk_bf16_f32 v83, v86, v87
v_mfma_f32_32x32x16_bf16 a[48:63], a[236:239], v[176:179], a[48:63]
buffer_load_dwordx4 v12, s[52:55], s71 offen offset:2048 sc1 lds
v_exp_f32 v90, v90
v_add_f32 v2, v2, v88
v_exp_f32 v91, v91
v_mfma_f32_32x32x16_bf16 a[112:127], a[236:239], v[192:195], a[112:127]
ds_read_b128 a[180:183], v10 offset:13312
v_add_f32 v3, v3, v89
v_cvt_pk_bf16_f32 v88, v88, v89
v_exp_f32 v92, v92
v_add_f32 v2, v2, v90
v_mfma_f32_32x32x16_bf16 a[0:15], a[240:243], v[184:187], a[0:15]
ds_read_b128 a[184:187], v10 offset:14336
v_exp_f32 v93, v93
v_add_f32 v3, v3, v91
v_cvt_pk_bf16_f32 v89, v90, v91
v_mfma_f32_32x32x16_bf16 a[64:79], a[240:243], v[200:203], a[64:79]
buffer_load_dwordx4 v12, s[52:55], s71 offen offset:3072 sc1 lds
v_exp_f32 v94, v94
v_add_f32 v2, v2, v92
v_exp_f32 v95, v95
v_mfma_f32_32x32x16_bf16 a[16:31], a[244:247], v[184:187], a[16:31]
ds_read_b128 a[188:191], v10 offset:15360
v_add_f32 v3, v3, v93
v_cvt_pk_bf16_f32 v90, v92, v93
v_exp_f32 v96, v96
v_add_f32 v2, v2, v94
v_mfma_f32_32x32x16_bf16 a[80:95], a[244:247], v[200:203], a[80:95]
v_exp_f32 v97, v97
v_add_f32 v3, v3, v95
v_cvt_pk_bf16_f32 v91, v94, v95
v_exp_f32 v98, v98
v_mfma_f32_32x32x16_bf16 a[32:47], a[248:251], v[184:187], a[32:47]
s_xor_b32 s72, s72, 0x8000
v_add_f32 v4, v4, v96
v_exp_f32 v99, v99
v_add_f32 v5, v5, v97
v_cvt_pk_bf16_f32 v96, v96, v97
v_mfma_f32_32x32x16_bf16 a[96:111], a[248:251], v[200:203], a[96:111]
v_exp_f32 v100, v100
v_add_f32 v4, v4, v98
v_exp_f32 v101, v101
v_add_f32 v5, v5, v99
v_mfma_f32_32x32x16_bf16 a[48:63], a[252:255], v[184:187], a[48:63]
v_cvt_pk_bf16_f32 v97, v98, v99
v_exp_f32 v102, v102
v_add_f32 v4, v4, v100
v_exp_f32 v103, v103
v_mfma_f32_32x32x16_bf16 a[112:127], a[252:255], v[200:203], a[112:127]
v_add_f32 v5, v5, v101
v_cvt_pk_bf16_f32 v98, v100, v101
v_add_f32 v4, v4, v102
v_add_f32 v5, v5, v103
v_cvt_pk_bf16_f32 v99, v102, v103
L_p3_d1m_end:
L_p3_d0m_top:
s_waitcnt lgkmcnt(0)
v_mfma_f32_32x32x16_bf16 v[144:159], a[128:131], v[16:19], v[208:223]
s_add_u32 m0, s73, 0
ds_read_b128 a[192:195], v11 offset:16384
v_exp_f32 v104, v104
v_exp_f32 v105, v105
v_mfma_f32_32x32x16_bf16 v[160:175], a[128:131], v[48:51], v[224:239]
ds_read_b128 a[196:199], v11 offset:17408
buffer_load_dwordx4 v12, s[56:59], s71 offen offset:0 sc1 lds
v_exp_f32 v106, v106
v_add_f32 v4, v4, v104
v_mfma_f32_32x32x16_bf16 v[144:159], a[132:135], v[20:23], v[144:159]
ds_read_b128 a[200:203], v11 offset:18432
v_exp_f32 v107, v107
v_add_f32 v5, v5, v105
v_cvt_pk_bf16_f32 v104, v104, v105
v_mfma_f32_32x32x16_bf16 v[160:175], a[132:135], v[52:55], v[160:175]
v_exp_f32 v108, v108
v_add_f32 v4, v4, v106
v_exp_f32 v109, v109
v_add_f32 v5, v5, v107
v_mfma_f32_32x32x16_bf16 v[144:159], a[136:139], v[24:27], v[144:159]
ds_read_b128 a[204:207], v11 offset:19456
v_cvt_pk_bf16_f32 v105, v106, v107
v_exp_f32 v110, v110
v_add_f32 v4, v4, v108
v_mfma_f32_32x32x16_bf16 v[160:175], a[136:139], v[56:59], v[160:175]
ds_read_b128 a[208:211], v11 offset:20480
v_exp_f32 v111, v111
v_add_f32 v5, v5, v109
v_cvt_pk_bf16_f32 v106, v108, v109
v_mfma_f32_32x32x16_bf16 v[144:159], a[140:143], v[28:31], v[144:159]
ds_read_b128 a[212:215], v11 offset:21504
v_exp_f32 v112, v112
v_add_f32 v4, v4, v110
v_exp_f32 v113, v113
v_mfma_f32_32x32x16_bf16 v[160:175], a[140:143], v[60:63], v[160:175]
buffer_load_dwordx4 v12, s[56:59], s71 offen offset:1024 sc1 lds
v_add_f32 v5, v5, v111
v_cvt_pk_bf16_f32 v107, v110, v111
v_exp_f32 v114, v114
v_add_f32 v2, v2, v112
v_mfma_f32_32x32x16_bf16 v[144:159], a[144:147], v[32:35], v[144:159]
ds_read_b128 a[216:219], v11 offset:22528
v_exp_f32 v115, v115
v_add_f32 v3, v3, v113
v_cvt_pk_bf16_f32 v112, v112, v113
v_mfma_f32_32x32x16_bf16 v[160:175], a[144:147], v[64:67], v[160:175]
ds_read_b128 a[220:223], v11 offset:23552
v_exp_f32 v116, v116
v_add_f32 v2, v2, v114
v_exp_f32 v117, v117
v_mfma_f32_32x32x16_bf16 v[144:159], a[148:151], v[36:39], v[144:159]
v_add_f32 v3, v3, v115
v_cvt_pk_bf16_f32 v113, v114, v115
v_exp_f32 v118, v118
v_add_f32 v2, v2, v116
v_mfma_f32_32x32x16_bf16 v[160:175], a[148:151], v[68:71], v[160:175]
ds_read_b128 a[224:227], v11 offset:24576
v_exp_f32 v119, v119
v_add_f32 v3, v3, v117
v_cvt_pk_bf16_f32 v114, v116, v117
v_mfma_f32_32x32x16_bf16 v[144:159], a[152:155], v[40:43], v[144:159]
ds_read_b128 a[228:231], v11 offset:25600
v_exp_f32 v120, v120
v_add_f32 v2, v2, v118
v_exp_f32 v121, v121
v_mfma_f32_32x32x16_bf16 v[160:175], a[152:155], v[72:75], v[160:175]
ds_read_b128 a[232:235], v11 offset:26624
buffer_load_dwordx4 v12, s[56:59], s71 offen offset:2048 sc1 lds
v_add_f32 v3, v3, v119
v_cvt_pk_bf16_f32 v115, v118, v119
v_exp_f32 v122, v122
v_mfma_f32_32x32x16_bf16 v[144:159], a[156:159], v[44:47], v[144:159]
v_add_f32 v2, v2, v120
v_exp_f32 v123, v123
v_add_f32 v3, v3, v121
v_mfma_f32_32x32x16_bf16 v[160:175], a[156:159], v[76:79], v[160:175]
ds_read_b128 a[236:239], v11 offset:27648
v_cvt_pk_bf16_f32 v120, v120, v121
v_exp_f32 v124, v124
v_add_f32 v2, v2, v122
v_mfma_f32_32x32x16_bf16 v[176:191], a[160:163], v[16:19], v[208:223]
ds_read_b128 a[240:243], v11 offset:28672
v_exp_f32 v125, v125
v_add_f32 v3, v3, v123
v_cvt_pk_bf16_f32 v121, v122, v123
v_mfma_f32_32x32x16_bf16 v[192:207], a[160:163], v[48:51], v[224:239]
ds_read_b128 a[244:247], v11 offset:29696
v_exp_f32 v126, v126
v_add_f32 v2, v2, v124
v_exp_f32 v127, v127
v_mfma_f32_32x32x16_bf16 v[176:191], a[164:167], v[20:23], v[176:191]
v_add_f32 v3, v3, v125
v_cvt_pk_bf16_f32 v122, v124, v125
v_exp_f32 v128, v128
v_add_f32 v2, v2, v126
v_mfma_f32_32x32x16_bf16 v[192:207], a[164:167], v[52:55], v[192:207]
ds_read_b128 a[248:251], v11 offset:30720
buffer_load_dwordx4 v12, s[56:59], s71 offen offset:3072 sc1 lds
v_exp_f32 v129, v129
v_add_f32 v3, v3, v127
v_cvt_pk_bf16_f32 v123, v126, v127
v_mfma_f32_32x32x16_bf16 v[176:191], a[168:171], v[24:27], v[176:191]
ds_read_b128 a[252:255], v11 offset:31744
v_add_u32 v246, -64, v13
v_cmp_gt_i32_e64 s[84:85], 0, v246
v_cmp_gt_i32_e64 s[86:87], 1, v246
v_exp_f32 v130, v130
v_mfma_f32_32x32x16_bf16 v[192:207], a[168:171], v[56:59], v[192:207]
v_add_f32 v4, v4, v128
v_exp_f32 v131, v131
v_cmp_gt_i32_e64 s[88:89], 2, v246
v_cmp_gt_i32_e64 s[90:91], 3, v246
v_cndmask_b32_e64 v160, v160, v14, s[84:85]
v_mfma_f32_32x32x16_bf16 v[176:191], a[172:175], v[28:31], v[176:191]
v_add_f32 v5, v5, v129
v_cvt_pk_bf16_f32 v128, v128, v129
v_exp_f32 v132, v132
v_cndmask_b32_e64 v161, v161, v14, s[86:87]
v_cndmask_b32_e64 v162, v162, v14, s[88:89]
v_mfma_f32_32x32x16_bf16 v[192:207], a[172:175], v[60:63], v[192:207]
v_add_f32 v4, v4, v130
v_exp_f32 v133, v133
v_add_f32 v5, v5, v131
v_cndmask_b32_e64 v163, v163, v14, s[90:91]
v_cmp_gt_i32_e64 s[92:93], 16, v246
v_mfma_f32_32x32x16_bf16 v[176:191], a[176:179], v[32:35], v[176:191]
v_cmp_gt_i32_e64 s[94:95], 17, v246
v_cvt_pk_bf16_f32 v129, v130, v131
v_exp_f32 v134, v134
v_add_f32 v4, v4, v132
v_cmp_gt_i32_e64 s[96:97], 18, v246
v_mfma_f32_32x32x16_bf16 v[192:207], a[176:179], v[64:67], v[192:207]
s_add_u32 s71, s71, 16384
v_cmp_gt_i32_e64 s[98:99], 19, v246
v_exp_f32 v135, v135
v_add_f32 v5, v5, v133
v_cvt_pk_bf16_f32 v130, v132, v133
v_mfma_f32_32x32x16_bf16 v[176:191], a[180:183], v[36:39], v[176:191]
v_exp_f32 v136, v136
v_cndmask_b32_e64 v164, v164, v14, s[92:93]
v_cndmask_b32_e64 v165, v165, v14, s[94:95]
v_cndmask_b32_e64 v166, v166, v14, s[96:97]
v_add_f32 v4, v4, v134
v_mfma_f32_32x32x16_bf16 v[192:207], a[180:183], v[68:71], v[192:207]
v_exp_f32 v137, v137
v_cndmask_b32_e64 v167, v167, v14, s[98:99]
v_cmp_gt_i32_e64 s[84:85], 8, v246
v_add_f32 v5, v5, v135
v_cvt_pk_bf16_f32 v131, v134, v135
v_mfma_f32_32x32x16_bf16 v[176:191], a[184:187], v[40:43], v[176:191]
v_exp_f32 v138, v138
v_add_f32 v4, v4, v136
v_cmp_gt_i32_e64 s[86:87], 9, v246
v_cmp_gt_i32_e64 s[88:89], 10, v246
v_cmp_gt_i32_e64 s[90:91], 11, v246
v_mfma_f32_32x32x16_bf16 v[192:207], a[184:187], v[72:75], v[192:207]
v_exp_f32 v139, v139
v_add_f32 v5, v5, v137
v_cvt_pk_bf16_f32 v136, v136, v137
v_cndmask_b32_e64 v168, v168, v14, s[84:85]
v_cndmask_b32_e64 v169, v169, v14, s[86:87]
v_mfma_f32_32x32x16_bf16 v[176:191], a[188:191], v[44:47], v[176:191]
v_exp_f32 v140, v140
v_add_f32 v4, v4, v138
v_exp_f32 v141, v141
v_cndmask_b32_e64 v170, v170, v14, s[88:89]
v_mfma_f32_32x32x16_bf16 v[192:207], a[188:191], v[76:79], v[192:207]
v_cndmask_b32_e64 v171, v171, v14, s[90:91]
v_cmp_gt_i32_e64 s[92:93], 24, v246
v_add_f32 v5, v5, v139
v_cvt_pk_bf16_f32 v137, v138, v139
v_exp_f32 v142, v142
v_cmp_gt_i32_e64 s[94:95], 25, v246
v_cmp_gt_i32_e64 s[96:97], 26, v246
v_add_f32 v4, v4, v140
v_exp_f32 v143, v143
v_add_f32 v5, v5, v141
v_cmp_gt_i32_e64 s[98:99], 27, v246
v_cndmask_b32_e64 v172, v172, v14, s[92:93]
v_cndmask_b32_e64 v173, v173, v14, s[94:95]
v_cvt_pk_bf16_f32 v138, v140, v141
v_add_f32 v4, v4, v142
v_add_f32 v5, v5, v143
v_cvt_pk_bf16_f32 v139, v142, v143
v_cndmask_b32_e64 v174, v174, v14, s[96:97]
v_cndmask_b32_e64 v175, v175, v14, s[98:99]
s_waitcnt vmcnt(16) lgkmcnt(0)
v_mfma_f32_32x32x16_bf16 a[0:15], a[192:195], v[80:83], a[0:15]
s_barrier
v_mfma_f32_32x32x16_bf16 a[64:79], a[192:195], v[96:99], a[64:79]
ds_read_b128 a[128:131], v10 offset:16384
v_max3_f32 v6, v144, v145, v146
v_max3_f32 v7, v160, v161, v162
v_max3_f32 v6, v6, v147, v148
v_max3_f32 v7, v7, v163, v164
v_max3_f32 v6, v6, v149, v150
v_mfma_f32_32x32x16_bf16 a[16:31], a[196:199], v[80:83], a[16:31]
ds_read_b128 a[132:135], v10 offset:17408
v_max3_f32 v7, v7, v165, v166
v_max3_f32 v6, v6, v151, v152
v_max3_f32 v7, v7, v167, v168
v_max3_f32 v6, v6, v153, v154
v_max3_f32 v7, v7, v169, v170
v_mfma_f32_32x32x16_bf16 a[80:95], a[196:199], v[96:99], a[80:95]
v_max3_f32 v6, v6, v155, v156
v_max3_f32 v7, v7, v171, v172
v_max3_f32 v6, v6, v157, v158
v_max3_f32 v7, v7, v173, v174
v_add_u32 v247, -96, v13
v_mfma_f32_32x32x16_bf16 a[32:47], a[200:203], v[80:83], a[32:47]
ds_read_b128 a[136:139], v10 offset:18432
v_cmp_gt_i32_e64 s[84:85], 0, v247
v_cmp_gt_i32_e64 s[86:87], 1, v247
v_cmp_gt_i32_e64 s[88:89], 2, v247
v_cmp_gt_i32_e64 s[90:91], 3, v247
v_cndmask_b32_e64 v192, v192, v14, s[84:85]
v_mfma_f32_32x32x16_bf16 a[96:111], a[200:203], v[96:99], a[96:111]
v_cndmask_b32_e64 v193, v193, v14, s[86:87]
v_cndmask_b32_e64 v194, v194, v14, s[88:89]
v_cndmask_b32_e64 v195, v195, v14, s[90:91]
v_cmp_gt_i32_e64 s[92:93], 16, v247
v_mfma_f32_32x32x16_bf16 a[48:63], a[204:207], v[80:83], a[48:63]
ds_read_b128 a[140:143], v10 offset:19456
v_cmp_gt_i32_e64 s[94:95], 17, v247
v_cmp_gt_i32_e64 s[96:97], 18, v247
v_cmp_gt_i32_e64 s[98:99], 19, v247
v_cndmask_b32_e64 v196, v196, v14, s[92:93]
v_cndmask_b32_e64 v197, v197, v14, s[94:95]
v_mfma_f32_32x32x16_bf16 a[112:127], a[204:207], v[96:99], a[112:127]
v_cndmask_b32_e64 v198, v198, v14, s[96:97]
v_cndmask_b32_e64 v199, v199, v14, s[98:99]
v_cmp_gt_i32_e64 s[84:85], 8, v247
v_cmp_gt_i32_e64 s[86:87], 9, v247
v_cmp_gt_i32_e64 s[88:89], 10, v247
v_mfma_f32_32x32x16_bf16 a[0:15], a[208:211], v[88:91], a[0:15]
ds_read_b128 a[144:147], v10 offset:20480
v_cmp_gt_i32_e64 s[90:91], 11, v247
v_cndmask_b32_e64 v200, v200, v14, s[84:85]
v_cndmask_b32_e64 v201, v201, v14, s[86:87]
v_cndmask_b32_e64 v202, v202, v14, s[88:89]
v_cndmask_b32_e64 v203, v203, v14, s[90:91]
v_mfma_f32_32x32x16_bf16 a[64:79], a[208:211], v[104:107], a[64:79]
ds_read_b128 a[148:151], v10 offset:21504
v_cmp_gt_i32_e64 s[92:93], 24, v247
v_cmp_gt_i32_e64 s[94:95], 25, v247
v_cmp_gt_i32_e64 s[96:97], 26, v247
v_cmp_gt_i32_e64 s[98:99], 27, v247
v_cndmask_b32_e64 v204, v204, v14, s[92:93]
v_mfma_f32_32x32x16_bf16 a[16:31], a[212:215], v[88:91], a[16:31]
v_cndmask_b32_e64 v205, v205, v14, s[94:95]
v_cndmask_b32_e64 v206, v206, v14, s[96:97]
v_cndmask_b32_e64 v207, v207, v14, s[98:99]
v_max3_f32 v6, v6, v159, v176
v_mfma_f32_32x32x16_bf16 a[80:95], a[212:215], v[104:107], a[80:95]
ds_read_b128 a[152:155], v10 offset:22528
v_max3_f32 v7, v7, v175, v192
v_max3_f32 v6, v6, v177, v178
v_max3_f32 v7, v7, v193, v194
v_max3_f32 v6, v6, v179, v180
v_max3_f32 v7, v7, v195, v196
v_mfma_f32_32x32x16_bf16 a[32:47], a[216:219], v[88:91], a[32:47]
v_max3_f32 v6, v6, v181, v182
v_max3_f32 v7, v7, v197, v198
v_max3_f32 v6, v6, v183, v184
v_max3_f32 v7, v7, v199, v200
v_max3_f32 v6, v6, v185, v186
v_mfma_f32_32x32x16_bf16 a[96:111], a[216:219], v[104:107], a[96:111]
ds_read_b128 a[156:159], v10 offset:23552
v_max3_f32 v7, v7, v201, v202
v_max3_f32 v6, v6, v187, v188
v_max3_f32 v7, v7, v203, v204
v_max3_f32 v6, v6, v189, v190
v_max3_f32 v7, v7, v205, v206
v_mfma_f32_32x32x16_bf16 a[48:63], a[220:223], v[88:91], a[48:63]
v_max_f32 v6, v6, v191
v_max_f32 v7, v7, v207
v_max_f32 v240, v6, v7
v_cmp_lt_f32 vcc, s79, v240
v_mfma_f32_32x32x16_bf16 a[112:127], a[220:223], v[104:107], a[112:127]
s_cbranch_vccnz L_p3_d0m_rare
s_add_u32 m0, s72, 0
ds_read_b128 a[160:163], v10 offset:24576
v_exp_f32 v144, v144
v_exp_f32 v145, v145
v_mfma_f32_32x32x16_bf16 a[0:15], a[224:227], v[112:115], a[0:15]
ds_read_b128 a[164:167], v10 offset:25600
buffer_load_dwordx4 v12, s[52:55], s71 offen offset:0 sc1 lds
v_exp_f32 v146, v146
v_add_f32 v2, v2, v144
v_mfma_f32_32x32x16_bf16 a[64:79], a[224:227], v[128:131], a[64:79]
v_exp_f32 v147, v147
v_add_f32 v3, v3, v145
v_cvt_pk_bf16_f32 v144, v144, v145
v_exp_f32 v148, v148
v_mfma_f32_32x32x16_bf16 a[16:31], a[228:231], v[112:115], a[16:31]
ds_read_b128 a[168:171], v10 offset:26624
v_add_f32 v2, v2, v146
v_exp_f32 v149, v149
v_add_f32 v3, v3, v147
v_cvt_pk_bf16_f32 v145, v146, v147
v_mfma_f32_32x32x16_bf16 a[80:95], a[228:231], v[128:131], a[80:95]
ds_read_b128 a[172:175], v10 offset:27648
buffer_load_dwordx4 v12, s[52:55], s71 offen offset:1024 sc1 lds
v_exp_f32 v150, v150
v_add_f32 v2, v2, v148
v_mfma_f32_32x32x16_bf16 a[32:47], a[232:235], v[112:115], a[32:47]
v_exp_f32 v151, v151
v_add_f32 v3, v3, v149
v_cvt_pk_bf16_f32 v146, v148, v149
v_exp_f32 v152, v152
v_mfma_f32_32x32x16_bf16 a[96:111], a[232:235], v[128:131], a[96:111]
ds_read_b128 a[176:179], v10 offset:28672
v_add_f32 v2, v2, v150
v_exp_f32 v153, v153
v_add_f32 v3, v3, v151
v_cvt_pk_bf16_f32 v147, v150, v151
v_mfma_f32_32x32x16_bf16 a[48:63], a[236:239], v[112:115], a[48:63]
buffer_load_dwordx4 v12, s[52:55], s71 offen offset:2048 sc1 lds
v_exp_f32 v154, v154
v_add_f32 v2, v2, v152
v_exp_f32 v155, v155
v_mfma_f32_32x32x16_bf16 a[112:127], a[236:239], v[128:131], a[112:127]
ds_read_b128 a[180:183], v10 offset:29696
v_add_f32 v3, v3, v153
v_cvt_pk_bf16_f32 v152, v152, v153
v_exp_f32 v156, v156
v_add_f32 v2, v2, v154
v_mfma_f32_32x32x16_bf16 a[0:15], a[240:243], v[120:123], a[0:15]
ds_read_b128 a[184:187], v10 offset:30720
v_exp_f32 v157, v157
v_add_f32 v3, v3, v155
v_cvt_pk_bf16_f32 v153, v154, v155
v_mfma_f32_32x32x16_bf16 a[64:79], a[240:243], v[136:139], a[64:79]
buffer_load_dwordx4 v12, s[52:55], s71 offen offset:3072 sc1 lds
v_exp_f32 v158, v158
v_add_f32 v2, v2, v156
v_exp_f32 v159, v159
v_mfma_f32_32x32x16_bf16 a[16:31], a[244:247], v[120:123], a[16:31]
ds_read_b128 a[188:191], v10 offset:31744
v_add_f32 v3, v3, v157
v_cvt_pk_bf16_f32 v154, v156, v157
v_exp_f32 v160, v160
v_add_f32 v2, v2, v158
v_mfma_f32_32x32x16_bf16 a[80:95], a[244:247], v[136:139], a[80:95]
v_exp_f32 v161, v161
v_add_f32 v3, v3, v159
v_cvt_pk_bf16_f32 v155, v158, v159
v_exp_f32 v162, v162
v_mfma_f32_32x32x16_bf16 a[32:47], a[248:251], v[120:123], a[32:47]
s_cmp_eq_u32 s70, 7
v_add_f32 v4, v4, v160
v_exp_f32 v163, v163
v_add_f32 v5, v5, v161
v_cvt_pk_bf16_f32 v160, v160, v161
v_mfma_f32_32x32x16_bf16 a[96:111], a[248:251], v[136:139], a[96:111]
v_exp_f32 v164, v164
v_add_f32 v4, v4, v162
v_exp_f32 v165, v165
v_add_f32 v5, v5, v163
v_mfma_f32_32x32x16_bf16 a[48:63], a[252:255], v[120:123], a[48:63]
v_cvt_pk_bf16_f32 v161, v162, v163
v_exp_f32 v166, v166
v_add_f32 v4, v4, v164
v_exp_f32 v167, v167
v_mfma_f32_32x32x16_bf16 a[112:127], a[252:255], v[136:139], a[112:127]
v_add_f32 v5, v5, v165
v_cvt_pk_bf16_f32 v162, v164, v165
v_add_f32 v4, v4, v166
v_add_f32 v5, v5, v167
v_cvt_pk_bf16_f32 v163, v166, v167
L_p3_d0m_end:
s_cbranch_scc1 L_p3_mxm_top
s_waitcnt lgkmcnt(0)
v_xor_b32 v11, 0x8000, v11
v_mfma_f32_32x32x16_bf16 v[80:95], a[128:131], v[16:19], v[208:223]
s_add_u32 m0, s73, 16384
ds_read_b128 a[192:195], v11 offset:0
ds_read_b128 a[196:199], v11 offset:1024
v_exp_f32 v168, v168
v_mfma_f32_32x32x16_bf16 v[80:95], a[132:135], v[20:23], v[80:95]
ds_read_b128 a[200:203], v11 offset:2048
buffer_load_dwordx4 v12, s[56:59], s71 offen offset:0 sc1 lds
v_exp_f32 v169, v169
v_exp_f32 v170, v170
v_mfma_f32_32x32x16_bf16 v[80:95], a[136:139], v[24:27], v[80:95]
ds_read_b128 a[204:207], v11 offset:3072
ds_read_b128 a[208:211], v11 offset:4096
v_add_f32 v4, v4, v168
v_exp_f32 v171, v171
v_add_f32 v5, v5, v169
v_mfma_f32_32x32x16_bf16 v[80:95], a[140:143], v[28:31], v[80:95]
ds_read_b128 a[212:215], v11 offset:5120
buffer_load_dwordx4 v12, s[56:59], s71 offen offset:1024 sc1 lds
v_cvt_pk_bf16_f32 v168, v168, v169
v_exp_f32 v172, v172
v_add_f32 v4, v4, v170
v_mfma_f32_32x32x16_bf16 v[80:95], a[144:147], v[32:35], v[80:95]
ds_read_b128 a[216:219], v11 offset:6144
ds_read_b128 a[220:223], v11 offset:7168
v_exp_f32 v173, v173
v_add_f32 v5, v5, v171
v_cvt_pk_bf16_f32 v169, v170, v171
v_mfma_f32_32x32x16_bf16 v[80:95], a[148:151], v[36:39], v[80:95]
ds_read_b128 a[224:227], v11 offset:8192
v_exp_f32 v174, v174
v_add_f32 v4, v4, v172
v_exp_f32 v175, v175
v_mfma_f32_32x32x16_bf16 v[80:95], a[152:155], v[40:43], v[80:95]
ds_read_b128 a[228:231], v11 offset:9216
ds_read_b128 a[232:235], v11 offset:10240
buffer_load_dwordx4 v12, s[56:59], s71 offen offset:2048 sc1 lds
v_add_f32 v5, v5, v173
v_cvt_pk_bf16_f32 v170, v172, v173
v_mfma_f32_32x32x16_bf16 v[80:95], a[156:159], v[44:47], v[80:95]
ds_read_b128 a[236:239], v11 offset:11264
v_exp_f32 v176, v176
v_add_f32 v4, v4, v174
v_exp_f32 v177, v177
v_mfma_f32_32x32x16_bf16 v[112:127], a[160:163], v[16:19], v[208:223]
ds_read_b128 a[240:243], v11 offset:12288
ds_read_b128 a[244:247], v11 offset:13312
buffer_load_dwordx4 v12, s[56:59], s71 offen offset:3072 sc1 lds
v_add_f32 v5, v5, v175
v_cvt_pk_bf16_f32 v171, v174, v175
v_mfma_f32_32x32x16_bf16 v[112:127], a[164:167], v[20:23], v[112:127]
ds_read_b128 a[248:251], v11 offset:14336
v_exp_f32 v178, v178
v_add_f32 v2, v2, v176
v_exp_f32 v179, v179
v_mfma_f32_32x32x16_bf16 v[112:127], a[168:171], v[24:27], v[112:127]
ds_read_b128 a[252:255], v11 offset:15360
v_add_f32 v3, v3, v177
v_cvt_pk_bf16_f32 v176, v176, v177
v_exp_f32 v180, v180
v_add_f32 v2, v2, v178
v_mfma_f32_32x32x16_bf16 v[112:127], a[172:175], v[28:31], v[112:127]
s_add_u32 s71, s71, 16384
v_exp_f32 v181, v181
v_add_f32 v3, v3, v179
v_cvt_pk_bf16_f32 v177, v178, v179
v_mfma_f32_32x32x16_bf16 v[112:127], a[176:179], v[32:35], v[112:127]
v_exp_f32 v182, v182
v_add_f32 v2, v2, v180
v_exp_f32 v183, v183
v_add_f32 v3, v3, v181
v_mfma_f32_32x32x16_bf16 v[112:127], a[180:183], v[36:39], v[112:127]
s_xor_b32 s73, s73, 0x8000
v_cvt_pk_bf16_f32 v178, v180, v181
v_exp_f32 v184, v184
v_add_f32 v2, v2, v182
v_mfma_f32_32x32x16_bf16 v[112:127], a[184:187], v[40:43], v[112:127]
v_exp_f32 v185, v185
v_add_f32 v3, v3, v183
v_cvt_pk_bf16_f32 v179, v182, v183
v_exp_f32 v186, v186
v_mfma_f32_32x32x16_bf16 v[112:127], a[188:191], v[44:47], v[112:127]
v_add_f32 v2, v2, v184
v_exp_f32 v187, v187
v_add_f32 v3, v3, v185
v_cvt_pk_bf16_f32 v184, v184, v185
v_exp_f32 v188, v188
v_add_f32 v2, v2, v186
v_exp_f32 v189, v189
v_add_f32 v3, v3, v187
v_cvt_pk_bf16_f32 v185, v186, v187
v_exp_f32 v190, v190
v_add_f32 v2, v2, v188
v_exp_f32 v191, v191
v_add_f32 v3, v3, v189
v_cvt_pk_bf16_f32 v186, v188, v189
v_exp_f32 v192, v192
v_add_f32 v2, v2, v190
v_exp_f32 v193, v193
v_add_f32 v3, v3, v191
v_cvt_pk_bf16_f32 v187, v190, v191
v_exp_f32 v194, v194
v_add_f32 v4, v4, v192
v_exp_f32 v195, v195
v_add_f32 v5, v5, v193
v_cvt_pk_bf16_f32 v192, v192, v193
v_exp_f32 v196, v196
v_add_f32 v4, v4, v194
v_exp_f32 v197, v197
v_add_f32 v5, v5, v195
v_cvt_pk_bf16_f32 v193, v194, v195
v_exp_f32 v198, v198
v_add_f32 v4, v4, v196
v_exp_f32 v199, v199
v_add_f32 v5, v5, v197
v_cvt_pk_bf16_f32 v194, v196, v197
v_exp_f32 v200, v200
v_add_f32 v4, v4, v198
v_exp_f32 v201, v201
v_add_f32 v5, v5, v199
v_cvt_pk_bf16_f32 v195, v198, v199
v_exp_f32 v202, v202
v_add_f32 v4, v4, v200
v_exp_f32 v203, v203
v_add_f32 v5, v5, v201
v_cvt_pk_bf16_f32 v200, v200, v201
v_exp_f32 v204, v204
v_add_f32 v4, v4, v202
v_exp_f32 v205, v205
v_add_f32 v5, v5, v203
v_cvt_pk_bf16_f32 v201, v202, v203
v_exp_f32 v206, v206
v_add_f32 v4, v4, v204
v_exp_f32 v207, v207
v_add_f32 v5, v5, v205
v_cvt_pk_bf16_f32 v202, v204, v205
v_add_f32 v4, v4, v206
v_add_f32 v5, v5, v207
v_cvt_pk_bf16_f32 v203, v206, v207
s_waitcnt vmcnt(16) lgkmcnt(0)
v_mfma_f32_32x32x16_bf16 a[0:15], a[192:195], v[144:147], a[0:15]
s_barrier
v_xor_b32 v10, 0x8000, v10
v_mfma_f32_32x32x16_bf16 a[64:79], a[192:195], v[160:163], a[64:79]
ds_read_b128 a[128:131], v10 offset:0
v_max3_f32 v6, v80, v81, v82
v_max3_f32 v6, v6, v83, v84
v_max3_f32 v6, v6, v85, v86
v_max3_f32 v6, v6, v87, v88
v_max3_f32 v6, v6, v89, v90
v_mfma_f32_32x32x16_bf16 a[16:31], a[196:199], v[144:147], a[16:31]
v_max3_f32 v6, v6, v91, v92
v_max3_f32 v6, v6, v93, v94
v_max3_f32 v6, v6, v95, v112
v_max3_f32 v6, v6, v113, v114
v_mfma_f32_32x32x16_bf16 a[80:95], a[196:199], v[160:163], a[80:95]
ds_read_b128 a[132:135], v10 offset:1024
v_max3_f32 v6, v6, v115, v116
v_max3_f32 v6, v6, v117, v118
v_max3_f32 v6, v6, v119, v120
v_max3_f32 v6, v6, v121, v122
v_mfma_f32_32x32x16_bf16 a[32:47], a[200:203], v[144:147], a[32:47]
v_max3_f32 v6, v6, v123, v124
v_max3_f32 v6, v6, v125, v126
v_max_f32 v6, v6, v127
v_cmp_lt_f32 vcc, s79, v6
v_mfma_f32_32x32x16_bf16 a[96:111], a[200:203], v[160:163], a[96:111]
s_cbranch_vccnz L_p3_mx_rare
s_add_u32 m0, s72, 16384
ds_read_b128 a[136:139], v10 offset:2048
v_exp_f32 v80, v80
v_bfe_u32 v248, v1, 2, 2
v_bfe_u32 v249, v1, 4, 1
v_mfma_f32_32x32x16_bf16 a[48:63], a[204:207], v[144:147], a[48:63]
ds_read_b128 a[140:143], v10 offset:3072
buffer_load_dwordx4 v12, s[52:55], s71 offen offset:0 sc1 lds
v_lshl_add_u32 v248, v249, 2, v248
v_lshrrev_b32 v249, 5, v1
v_exp_f32 v81, v81
v_mfma_f32_32x32x16_bf16 a[112:127], a[204:207], v[160:163], a[112:127]
v_lshl_add_u32 v249, v249, 4, v248
v_lshlrev_b32 v249, 8, v249
v_and_b32 v250, 3, v1
v_exp_f32 v82, v82
v_lshl_add_u32 v249, v250, 3, v249
v_mfma_f32_32x32x16_bf16 a[0:15], a[208:211], v[152:155], a[0:15]
ds_read_b128 a[144:147], v10 offset:4096
s_lshl_b32 s36, s3, 13
s_add_u32 s36, s36, 131072
v_add_f32 v2, v2, v80
v_add_u32 v249, s36, v249
s_waitcnt vmcnt(13)
v_mfma_f32_32x32x16_bf16 a[64:79], a[208:211], v[168:171], a[64:79]
ds_read_b128 a[148:151], v10 offset:5120
v_xor_b32 v250, 0, v248
v_lshl_add_u32 v250, v250, 5, v249
v_exp_f32 v83, v83
TR 96,250,0
v_mfma_f32_32x32x16_bf16 a[16:31], a[212:215], v[152:155], a[16:31]
TR 98,250,2048
v_xor_b32 v250, 1, v248
v_add_f32 v3, v3, v81
v_lshl_add_u32 v250, v250, 5, v249
TR 100,250,0
TR 102,250,2048
v_mfma_f32_32x32x16_bf16 a[80:95], a[212:215], v[168:171], a[80:95]
ds_read_b128 a[152:155], v10 offset:6144
buffer_load_dwordx4 v12, s[52:55], s71 offen offset:1024 sc1 lds
v_cvt_pk_bf16_f32 v80, v80, v81
v_xor_b32 v250, 2, v248
v_lshl_add_u32 v250, v250, 5, v249
TR 104,250,0
v_mfma_f32_32x32x16_bf16 a[32:47], a[216:219], v[152:155], a[32:47]
TR 106,250,2048
v_exp_f32 v84, v84
v_xor_b32 v250, 3, v248
v_lshl_add_u32 v250, v250, 5, v249
TR 108,250,0
v_mfma_f32_32x32x16_bf16 a[96:111], a[216:219], v[168:171], a[96:111]
ds_read_b128 a[156:159], v10 offset:7168
v_add_f32 v2, v2, v82
TR 110,250,2048
v_xor_b32 v250, 4, v248
v_lshl_add_u32 v250, v250, 5, v249
v_mfma_f32_32x32x16_bf16 a[48:63], a[220:223], v[152:155], a[48:63]
ds_read_b128 a[160:163], v10 offset:8192
v_exp_f32 v85, v85
TR 128,250,0
TR 130,250,2048
v_xor_b32 v250, 5, v248
v_mfma_f32_32x32x16_bf16 a[112:127], a[220:223], v[168:171], a[112:127]
v_add_f32 v3, v3, v83
v_cvt_pk_bf16_f32 v81, v82, v83
v_lshl_add_u32 v250, v250, 5, v249
TR 132,250,0
TR 134,250,2048
v_xor_b32 v250, 6, v248
v_mfma_f32_32x32x16_bf16 a[0:15], a[224:227], v[176:179], a[0:15]
ds_read_b128 a[164:167], v10 offset:9216
buffer_load_dwordx4 v12, s[52:55], s71 offen offset:2048 sc1 lds
v_exp_f32 v86, v86
v_lshl_add_u32 v250, v250, 5, v249
TR 136,250,0
v_mfma_f32_32x32x16_bf16 a[64:79], a[224:227], v[192:195], a[64:79]
TR 138,250,2048
v_add_f32 v2, v2, v84
v_xor_b32 v250, 7, v248
v_lshl_add_u32 v250, v250, 5, v249
TR 140,250,0
v_mfma_f32_32x32x16_bf16 a[16:31], a[228:231], v[176:179], a[16:31]
ds_read_b128 a[168:171], v10 offset:10240
v_exp_f32 v87, v87
TR 142,250,2048
s_add_u32 s32, s40, 100663296
s_addc_u32 s33, s41, 0
v_mfma_f32_32x32x16_bf16 a[80:95], a[228:231], v[192:195], a[80:95]
ds_read_b128 a[172:175], v10 offset:11264
s_mov_b32 s34, 8388608
v_add_f32 v3, v3, v85
s_mov_b32 s35, 0x20000
s_and_b32 s36, s2, 7
s_lshl_b32 s36, s36, 20
v_mfma_f32_32x32x16_bf16 a[32:47], a[232:235], v[176:179], a[32:47]
v_cvt_pk_bf16_f32 v82, v84, v85
s_lshr_b32 s37, s2, 3
s_lshl_b32 s37, s37, 15
s_add_u32 s36, s36, s37
v_mfma_f32_32x32x16_bf16 a[96:111], a[232:235], v[192:195], a[96:111]
ds_read_b128 a[176:179], v10 offset:12288
buffer_load_dwordx4 v12, s[52:55], s71 offen offset:3072 sc1 lds
v_exp_f32 v88, v88
s_lshl_b32 s37, s3, 12
s_add_u32 s36, s36, s37
v_mfma_f32_32x32x16_bf16 a[48:63], a[236:239], v[176:179], a[48:63]
s_add_u32 s37, s36, 4096
s_waitcnt lgkmcnt(15)
buffer_store_dwordx4 v[96:99], v12, s[32:35], s36 offen offset:0 sc1
v_add_f32 v2, v2, v86
buffer_store_dwordx4 v[100:103], v12, s[32:35], s36 offen offset:1024 sc1
buffer_store_dwordx4 v[104:107], v12, s[32:35], s36 offen offset:2048 sc1
s_waitcnt lgkmcnt(13)
buffer_store_dwordx4 v[108:111], v12, s[32:35], s36 offen offset:3072 sc1
v_mfma_f32_32x32x16_bf16 a[112:127], a[236:239], v[192:195], a[112:127]
ds_read_b128 a[180:183], v10 offset:13312
v_exp_f32 v89, v89
s_waitcnt lgkmcnt(11)
buffer_store_dwordx4 v[128:131], v12, s[32:35], s37 offen offset:0 sc1
s_waitcnt lgkmcnt(9)
buffer_store_dwordx4 v[132:135], v12, s[32:35], s37 offen offset:1024 sc1
s_waitcnt lgkmcnt(6)
buffer_store_dwordx4 v[136:139], v12, s[32:35], s37 offen offset:2048 sc1
v_mfma_f32_32x32x16_bf16 a[0:15], a[240:243], v[184:187], a[0:15]
ds_read_b128 a[184:187], v10 offset:14336
v_add_f32 v3, v3, v87
v_cvt_pk_bf16_f32 v83, v86, v87
s_waitcnt lgkmcnt(4)
buffer_store_dwordx4 v[140:143], v12, s[32:35], s37 offen offset:3072 sc1
s_add_u32 s32, s40, 109051904
s_addc_u32 s33, s41, 0
v_mfma_f32_32x32x16_bf16 a[64:79], a[240:243], v[200:203], a[64:79]
v_exp_f32 v90, v90
s_mov_b32 s34, 4194304
s_mov_b32 s35, 0x20000
s_lshl_b32 s36, s2, 14
v_mov_b32 v252, -1
v_mfma_f32_32x32x16_bf16 a[16:31], a[244:247], v[184:187], a[16:31]
ds_read_b128 a[188:191], v10 offset:15360
s_xor_b32 s72, s72, 0x8000
v_add_f32 v2, v2, v88
v_mov_b32 v253, -1
v_mov_b32 v254, -1
v_mov_b32 v255, -1
v_mfma_f32_32x32x16_bf16 a[80:95], a[244:247], v[200:203], a[80:95]
v_exp_f32 v91, v91
buffer_store_dwordx4 v[252:255], v12, s[32:35], s36 offen offset:0 sc1
buffer_store_dwordx4 v[252:255], v12, s[32:35], s36 offen offset:1024 sc1
buffer_store_dwordx4 v[252:255], v12, s[32:35], s36 offen offset:2048 sc1
v_mfma_f32_32x32x16_bf16 a[32:47], a[248:251], v[184:187], a[32:47]
v_add_f32 v3, v3, v89
buffer_store_dwordx4 v[252:255], v12, s[32:35], s36 offen offset:3072 sc1
v_lshlrev_b32 v72, 4, v1
v_add_u32 v73, -8, v72
v_mov_b32 v75, 0
v_mfma_f32_32x32x16_bf16 a[96:111], a[248:251], v[200:203], a[96:111]
v_cvt_pk_bf16_f32 v88, v88, v89
buffer_load_ushort v74, v75, s[28:31], s42 offen
buffer_load_dwordx2 v[48:49], v73, s[16:19], 0 offen
buffer_load_dwordx4 v[50:53], v72, s[16:19], 0 offen offset:0
v_mfma_f32_32x32x16_bf16 a[48:63], a[252:255], v[184:187], a[48:63]
v_add_f32 v2, v2, v90
v_add_f32 v3, v3, v91
buffer_load_dwordx2 v[54:55], v72, s[16:19], 0 offen offset:1016
buffer_load_dwordx4 v[56:59], v72, s[16:19], 0 offen offset:1024
buffer_load_dwordx2 v[60:61], v72, s[16:19], 0 offen offset:2040
v_mfma_f32_32x32x16_bf16 a[112:127], a[252:255], v[200:203], a[112:127]
v_cvt_pk_bf16_f32 v89, v90, v91
buffer_load_dwordx4 v[62:65], v72, s[16:19], 0 offen offset:2048
buffer_load_dwordx2 v[66:67], v72, s[16:19], 0 offen offset:3064
buffer_load_dwordx4 v[68:71], v72, s[16:19], 0 offen offset:3072
L_p3_mx_end:
L_p3_eps:
v_add_f32 v4, v4, v5
v_mov_b32 v5, v4
s_nop 1
v_permlane32_swap_b32 v4, v5
v_add_f32 v4, v4, v5
v_rcp_f32 v4, v4
s_nop 7
v_accvgpr_read_b32 v240, a64
v_accvgpr_read_b32 v241, a65
v_accvgpr_read_b32 v242, a66
v_accvgpr_read_b32 v243, a67
v_accvgpr_read_b32 v244, a68
v_accvgpr_read_b32 v245, a69
v_accvgpr_read_b32 v246, a70
v_accvgpr_read_b32 v247, a71
v_mul_f32 v240, v240, v4
v_mul_f32 v241, v241, v4
v_mul_f32 v242, v242, v4
v_mul_f32 v243, v243, v4
v_mul_f32 v244, v244, v4
v_mul_f32 v245, v245, v4
v_mul_f32 v246, v246, v4
v_mul_f32 v247, v247, v4
v_cvt_pk_bf16_f32 v248, v240, v241
v_cvt_pk_bf16_f32 v249, v242, v243
v_cvt_pk_bf16_f32 v250, v244, v245
v_cvt_pk_bf16_f32 v251, v246, v247
buffer_store_dwordx4 v[248:251], v15, s[60:63], s101 offen offset:0 sc1
v_accvgpr_read_b32 v240, a72
v_accvgpr_read_b32 v241, a73
v_accvgpr_read_b32 v242, a74
v_accvgpr_read_b32 v243, a75
v_accvgpr_read_b32 v244, a76
v_accvgpr_read_b32 v245, a77
v_accvgpr_read_b32 v246, a78
v_accvgpr_read_b32 v247, a79
v_mul_f32 v240, v240, v4
v_mul_f32 v241, v241, v4
v_mul_f32 v242, v242, v4
v_mul_f32 v243, v243, v4
v_mul_f32 v244, v244, v4
v_mul_f32 v245, v245, v4
v_mul_f32 v246, v246, v4
v_mul_f32 v247, v247, v4
v_cvt_pk_bf16_f32 v252, v240, v241
v_cvt_pk_bf16_f32 v253, v242, v243
v_cvt_pk_bf16_f32 v254, v244, v245
v_cvt_pk_bf16_f32 v255, v246, v247
buffer_store_dwordx4 v[252:255], v15, s[60:63], s101 offen offset:512 sc1
v_accvgpr_read_b32 v240, a80
v_accvgpr_read_b32 v241, a81
v_accvgpr_read_b32 v242, a82
v_accvgpr_read_b32 v243, a83
v_accvgpr_read_b32 v244, a84
v_accvgpr_read_b32 v245, a85
v_accvgpr_read_b32 v246, a86
v_accvgpr_read_b32 v247, a87
v_mul_f32 v240, v240, v4
v_mul_f32 v241, v241, v4
v_mul_f32 v242, v242, v4
v_mul_f32 v243, v243, v4
v_mul_f32 v244, v244, v4
v_mul_f32 v245, v245, v4
v_mul_f32 v246, v246, v4
v_mul_f32 v247, v247, v4
v_cvt_pk_bf16_f32 v248, v240, v241
v_cvt_pk_bf16_f32 v249, v242, v243
v_cvt_pk_bf16_f32 v250, v244, v245
v_cvt_pk_bf16_f32 v251, v246, v247
buffer_store_dwordx4 v[248:251], v15, s[60:63], s101 offen offset:1024 sc1
v_accvgpr_read_b32 v240, a88
v_accvgpr_read_b32 v241, a89
v_accvgpr_read_b32 v242, a90
v_accvgpr_read_b32 v243, a91
v_accvgpr_read_b32 v244, a92
v_accvgpr_read_b32 v245, a93
v_accvgpr_read_b32 v246, a94
v_accvgpr_read_b32 v247, a95
v_mul_f32 v240, v240, v4
v_mul_f32 v241, v241, v4
v_mul_f32 v242, v242, v4
v_mul_f32 v243, v243, v4
v_mul_f32 v244, v244, v4
v_mul_f32 v245, v245, v4
v_mul_f32 v246, v246, v4
v_mul_f32 v247, v247, v4
v_cvt_pk_bf16_f32 v252, v240, v241
v_cvt_pk_bf16_f32 v253, v242, v243
v_cvt_pk_bf16_f32 v254, v244, v245
v_cvt_pk_bf16_f32 v255, v246, v247
buffer_store_dwordx4 v[252:255], v15, s[60:63], s101 offen offset:1536 sc1
v_accvgpr_read_b32 v240, a96
v_accvgpr_read_b32 v241, a97
v_accvgpr_read_b32 v242, a98
v_accvgpr_read_b32 v243, a99
v_accvgpr_read_b32 v244, a100
v_accvgpr_read_b32 v245, a101
v_accvgpr_read_b32 v246, a102
v_accvgpr_read_b32 v247, a103
v_mul_f32 v240, v240, v4
v_mul_f32 v241, v241, v4
v_mul_f32 v242, v242, v4
v_mul_f32 v243, v243, v4
v_mul_f32 v244, v244, v4
v_mul_f32 v245, v245, v4
v_mul_f32 v246, v246, v4
v_mul_f32 v247, v247, v4
v_cvt_pk_bf16_f32 v248, v240, v241
v_cvt_pk_bf16_f32 v249, v242, v243
v_cvt_pk_bf16_f32 v250, v244, v245
v_cvt_pk_bf16_f32 v251, v246, v247
buffer_store_dwordx4 v[248:251], v15, s[60:63], s101 offen offset:2048 sc1
v_accvgpr_read_b32 v240, a104
v_accvgpr_read_b32 v241, a105
v_accvgpr_read_b32 v242, a106
v_accvgpr_read_b32 v243, a107
v_accvgpr_read_b32 v244, a108
v_accvgpr_read_b32 v245, a109
v_accvgpr_read_b32 v246, a110
v_accvgpr_read_b32 v247, a111
v_mul_f32 v240, v240, v4
v_mul_f32 v241, v241, v4
v_mul_f32 v242, v242, v4
v_mul_f32 v243, v243, v4
v_mul_f32 v244, v244, v4
v_mul_f32 v245, v245, v4
v_mul_f32 v246, v246, v4
v_mul_f32 v247, v247, v4
v_cvt_pk_bf16_f32 v252, v240, v241
v_cvt_pk_bf16_f32 v253, v242, v243
v_cvt_pk_bf16_f32 v254, v244, v245
v_cvt_pk_bf16_f32 v255, v246, v247
buffer_store_dwordx4 v[252:255], v15, s[60:63], s101 offen offset:2560 sc1
v_accvgpr_read_b32 v240, a112
v_accvgpr_read_b32 v241, a113
v_accvgpr_read_b32 v242, a114
v_accvgpr_read_b32 v243, a115
v_accvgpr_read_b32 v244, a116
v_accvgpr_read_b32 v245, a117
v_accvgpr_read_b32 v246, a118
v_accvgpr_read_b32 v247, a119
v_mul_f32 v240, v240, v4
v_mul_f32 v241, v241, v4
v_mul_f32 v242, v242, v4
v_mul_f32 v243, v243, v4
v_mul_f32 v244, v244, v4
v_mul_f32 v245, v245, v4
v_mul_f32 v246, v246, v4
v_mul_f32 v247, v247, v4
v_cvt_pk_bf16_f32 v248, v240, v241
v_cvt_pk_bf16_f32 v249, v242, v243
v_cvt_pk_bf16_f32 v250, v244, v245
v_cvt_pk_bf16_f32 v251, v246, v247
buffer_store_dwordx4 v[248:251], v15, s[60:63], s101 offen offset:3072 sc1
v_accvgpr_read_b32 v240, a120
v_accvgpr_read_b32 v241, a121
v_accvgpr_read_b32 v242, a122
v_accvgpr_read_b32 v243, a123
v_accvgpr_read_b32 v244, a124
v_accvgpr_read_b32 v245, a125
v_accvgpr_read_b32 v246, a126
v_accvgpr_read_b32 v247, a127
v_mul_f32 v240, v240, v4
v_mul_f32 v241, v241, v4
v_mul_f32 v242, v242, v4
v_mul_f32 v243, v243, v4
v_mul_f32 v244, v244, v4
v_mul_f32 v245, v245, v4
v_mul_f32 v246, v246, v4
v_mul_f32 v247, v247, v4
v_cvt_pk_bf16_f32 v252, v240, v241
v_cvt_pk_bf16_f32 v253, v242, v243
v_cvt_pk_bf16_f32 v254, v244, v245
v_cvt_pk_bf16_f32 v255, v246, v247
buffer_store_dwordx4 v[252:255], v15, s[60:63], s101 offen offset:3584 sc1
s_and_b32 s36, s2, 3
s_lshl_b32 s36, s36, 1
s_sub_u32 s32, 14, s36
s_bitcmp1_b32 s2, 4
s_cselect_b32 s36, s32, s36
s_bfe_u32 s32, s2, 0x10003
s_add_u32 s36, s36, s32
s_bfe_u32 s37, s2, 0x10002
s_lshr_b32 s32, s2, 5
s_lshl_b32 s32, s32, 1
s_add_u32 s37, s37, s32
s_lshl_b32 s36, s36, 2
s_add_u32 s36, s36, s3
s_lshl_b32 s37, s37, 7
s_lshl_b32 s32, s36, 16
s_add_u32 s37, s37, s32
s_lshl_b32 s36, s36, 7
v_and_b32 v240, 15, v1
v_bfe_u32 v241, v1, 4, 1
v_lshlrev_b32 v241, 5, v241
v_lshrrev_b32 v242, 5, v1
v_lshl_add_u32 v241, v242, 4, v241
v_lshl_add_u32 v241, v240, 11, v241
v_lshlrev_b32 v240, 2, v240
s_add_u32 s32, s40, 58720256
s_addc_u32 s33, s41, 0
s_mov_b32 s34, 8192
s_mov_b32 s35, 0x20000
buffer_load_dwordx4 v[192:195], v241, s[44:47], s37 offen offset:0
buffer_load_dwordx4 v[196:199], v241, s[44:47], s37 offen offset:64
buffer_load_dword v224, v240, s[32:35], s36 offen offset:0 sc1
s_add_u32 s37, s37, 32768
buffer_load_dwordx4 v[200:203], v241, s[44:47], s37 offen offset:0
buffer_load_dwordx4 v[204:207], v241, s[44:47], s37 offen offset:64
buffer_load_dword v225, v240, s[32:35], s36 offen offset:64 sc1
v_lshlrev_b32 v76, 20, v1
s_lshl_b32 s36, s3, 26
v_add_u32 v76, s36, v76
v_mov_b32 v77, 1
s_lshl_b32 s37, s2, 2
s_lshl_b32 s74, s70, 1
s_sub_u32 s74, 13, s74
s_cbranch_scc1 L_p3_s0m_top
.p2align 5
L_p3_s0_top:
s_waitcnt lgkmcnt(0)
v_mfma_f32_32x32x16_bf16 v[144:159], a[128:131], v[16:19], v[208:223]
s_add_u32 m0, s73, 0
ds_read_b128 a[192:195], v11 offset:16384
ds_read_b128 a[196:199], v11 offset:17408
v_exp_f32 v92, v92
v_mfma_f32_32x32x16_bf16 v[144:159], a[132:135], v[20:23], v[144:159]
ds_read_b128 a[200:203], v11 offset:18432
buffer_load_dwordx4 v12, s[56:59], s71 offen offset:0 sc1 lds
v_exp_f32 v93, v93
v_exp_f32 v94, v94
v_mfma_f32_32x32x16_bf16 v[144:159], a[136:139], v[24:27], v[144:159]
ds_read_b128 a[204:207], v11 offset:19456
ds_read_b128 a[208:211], v11 offset:20480
v_add_f32 v2, v2, v92
v_exp_f32 v95, v95
v_add_f32 v3, v3, v93
v_mfma_f32_32x32x16_bf16 v[144:159], a[140:143], v[28:31], v[144:159]
ds_read_b128 a[212:215], v11 offset:21504
v_cvt_pk_bf16_f32 v90, v92, v93
v_exp_f32 v112, v112
v_add_f32 v2, v2, v94
v_mfma_f32_32x32x16_bf16 v[144:159], a[144:147], v[32:35], v[144:159]
ds_read_b128 a[216:219], v11 offset:22528
ds_read_b128 a[220:223], v11 offset:23552
buffer_load_dwordx4 v12, s[56:59], s71 offen offset:1024 sc1 lds
v_exp_f32 v113, v113
v_add_f32 v3, v3, v95
v_mfma_f32_32x32x16_bf16 v[144:159], a[148:151], v[36:39], v[144:159]
ds_read_b128 a[224:227], v11 offset:24576
v_cvt_pk_bf16_f32 v91, v94, v95
v_exp_f32 v114, v114
v_add_f32 v2, v2, v112
v_mfma_f32_32x32x16_bf16 v[144:159], a[152:155], v[40:43], v[144:159]
ds_read_b128 a[228:231], v11 offset:25600
ds_read_b128 a[232:235], v11 offset:26624
v_exp_f32 v115, v115
v_add_f32 v3, v3, v113
v_cvt_pk_bf16_f32 v112, v112, v113
v_mfma_f32_32x32x16_bf16 v[144:159], a[156:159], v[44:47], v[144:159]
ds_read_b128 a[236:239], v11 offset:27648
buffer_load_dwordx4 v12, s[56:59], s71 offen offset:2048 sc1 lds
v_exp_f32 v116, v116
v_add_f32 v2, v2, v114
v_mfma_f32_32x32x16_bf16 v[176:191], a[160:163], v[16:19], v[208:223]
ds_read_b128 a[240:243], v11 offset:28672
ds_read_b128 a[244:247], v11 offset:29696
v_exp_f32 v117, v117
v_add_f32 v3, v3, v115
v_cvt_pk_bf16_f32 v113, v114, v115
v_mfma_f32_32x32x16_bf16 v[176:191], a[164:167], v[20:23], v[176:191]
ds_read_b128 a[248:251], v11 offset:30720
v_exp_f32 v118, v118
v_add_f32 v2, v2, v116
v_exp_f32 v119, v119
v_mfma_f32_32x32x16_bf16 v[176:191], a[168:171], v[24:27], v[176:191]
ds_read_b128 a[252:255], v11 offset:31744
buffer_load_dwordx4 v12, s[56:59], s71 offen offset:3072 sc1 lds
v_add_f32 v3, v3, v117
v_cvt_pk_bf16_f32 v114, v116, v117
v_exp_f32 v120, v120
v_mfma_f32_32x32x16_bf16 v[176:191], a[172:175], v[28:31], v[176:191]
v_add_f32 v2, v2, v118
v_exp_f32 v121, v121
v_add_f32 v3, v3, v119
v_cvt_pk_bf16_f32 v115, v118, v119
v_mfma_f32_32x32x16_bf16 v[176:191], a[176:179], v[32:35], v[176:191]
v_exp_f32 v122, v122
v_add_f32 v2, v2, v120
v_exp_f32 v123, v123
v_add_f32 v3, v3, v121
v_mfma_f32_32x32x16_bf16 v[176:191], a[180:183], v[36:39], v[176:191]
s_add_u32 s71, s71, 16384
v_cvt_pk_bf16_f32 v120, v120, v121
v_exp_f32 v124, v124
v_add_f32 v2, v2, v122
v_mfma_f32_32x32x16_bf16 v[176:191], a[184:187], v[40:43], v[176:191]
v_exp_f32 v125, v125
v_add_f32 v3, v3, v123
v_cvt_pk_bf16_f32 v121, v122, v123
v_exp_f32 v126, v126
v_mfma_f32_32x32x16_bf16 v[176:191], a[188:191], v[44:47], v[176:191]
v_add_f32 v2, v2, v124
v_exp_f32 v127, v127
v_add_f32 v3, v3, v125
v_cvt_pk_bf16_f32 v122, v124, v125
v_add_f32 v2, v2, v126
v_add_f32 v3, v3, v127
v_cvt_pk_bf16_f32 v123, v126, v127
s_waitcnt vmcnt(16) lgkmcnt(0)
v_mfma_f32_32x32x16_bf16 a[0:15], a[192:195], v[80:83], a[0:15]
s_barrier
v_mfma_f32_32x32x16_bf16 a[16:31], a[196:199], v[80:83], a[16:31]
ds_read_b128 a[128:131], v10 offset:16384
ds_read_b128 a[132:135], v10 offset:17408
v_max3_f32 v6, v144, v145, v146
v_max3_f32 v6, v6, v147, v148
v_max3_f32 v6, v6, v149, v150
v_max3_f32 v6, v6, v151, v152
v_mfma_f32_32x32x16_bf16 a[32:47], a[200:203], v[80:83], a[32:47]
ds_read_b128 a[136:139], v10 offset:18432
v_max3_f32 v6, v6, v153, v154
v_max3_f32 v6, v6, v155, v156
v_max3_f32 v6, v6, v157, v158
v_max3_f32 v6, v6, v159, v176
v_max3_f32 v6, v6, v177, v178
v_mfma_f32_32x32x16_bf16 a[48:63], a[204:207], v[80:83], a[48:63]
ds_read_b128 a[140:143], v10 offset:19456
ds_read_b128 a[144:147], v10 offset:20480
v_max3_f32 v6, v6, v179, v180
v_max3_f32 v6, v6, v181, v182
v_max3_f32 v6, v6, v183, v184
v_max3_f32 v6, v6, v185, v186
v_mfma_f32_32x32x16_bf16 a[0:15], a[208:211], v[88:91], a[0:15]
ds_read_b128 a[148:151], v10 offset:21504
v_max3_f32 v6, v6, v187, v188
v_max3_f32 v6, v6, v189, v190
v_max_f32 v6, v6, v191
v_cmp_lt_f32 vcc, s79, v6
v_mfma_f32_32x32x16_bf16 a[16:31], a[212:215], v[88:91], a[16:31]
s_cbranch_vccnz L_p3_s0_rare
s_add_u32 m0, s72, 0
ds_read_b128 a[152:155], v10 offset:22528
ds_read_b128 a[156:159], v10 offset:23552
v_exp_f32 v144, v144
v_mfma_f32_32x32x16_bf16 a[32:47], a[216:219], v[88:91], a[32:47]
ds_read_b128 a[160:163], v10 offset:24576
buffer_load_dwordx4 v12, s[52:55], s71 offen offset:0 sc1 lds
v_exp_f32 v145, v145
v_exp_f32 v146, v146
v_mfma_f32_32x32x16_bf16 a[48:63], a[220:223], v[88:91], a[48:63]
ds_read_b128 a[164:167], v10 offset:25600
ds_read_b128 a[168:171], v10 offset:26624
v_add_f32 v2, v2, v144
v_exp_f32 v147, v147
v_add_f32 v3, v3, v145
v_mfma_f32_32x32x16_bf16 a[0:15], a[224:227], v[112:115], a[0:15]
ds_read_b128 a[172:175], v10 offset:27648
buffer_load_dwordx4 v12, s[52:55], s71 offen offset:1024 sc1 lds
v_cvt_pk_bf16_f32 v144, v144, v145
v_exp_f32 v148, v148
v_add_f32 v2, v2, v146
v_mfma_f32_32x32x16_bf16 a[16:31], a[228:231], v[112:115], a[16:31]
ds_read_b128 a[176:179], v10 offset:28672
ds_read_b128 a[180:183], v10 offset:29696
v_exp_f32 v149, v149
v_add_f32 v3, v3, v147
v_cvt_pk_bf16_f32 v145, v146, v147
v_mfma_f32_32x32x16_bf16 a[32:47], a[232:235], v[112:115], a[32:47]
ds_read_b128 a[184:187], v10 offset:30720
buffer_load_dwordx4 v12, s[52:55], s71 offen offset:2048 sc1 lds
v_exp_f32 v150, v150
v_add_f32 v2, v2, v148
v_mfma_f32_32x32x16_bf16 a[48:63], a[236:239], v[112:115], a[48:63]
ds_read_b128 a[188:191], v10 offset:31744
v_exp_f32 v151, v151
v_add_f32 v3, v3, v149
v_cvt_pk_bf16_f32 v146, v148, v149
v_mfma_f32_32x32x16_bf16 a[0:15], a[240:243], v[120:123], a[0:15]
buffer_load_dwordx4 v12, s[52:55], s71 offen offset:3072 sc1 lds
v_exp_f32 v152, v152
v_add_f32 v2, v2, v150
v_exp_f32 v153, v153
v_mfma_f32_32x32x16_bf16 a[16:31], a[244:247], v[120:123], a[16:31]
v_add_f32 v3, v3, v151
v_cvt_pk_bf16_f32 v147, v150, v151
v_exp_f32 v154, v154
v_add_f32 v2, v2, v152
v_mfma_f32_32x32x16_bf16 a[32:47], a[248:251], v[120:123], a[32:47]
s_sub_u32 s74, s74, 1
v_exp_f32 v155, v155
v_add_f32 v3, v3, v153
v_cvt_pk_bf16_f32 v152, v152, v153
v_mfma_f32_32x32x16_bf16 a[48:63], a[252:255], v[120:123], a[48:63]
v_add_f32 v2, v2, v154
v_add_f32 v3, v3, v155
v_cvt_pk_bf16_f32 v153, v154, v155
L_p3_s0_end:
s_cbranch_scc1 L_p3_s1m_top
s_waitcnt lgkmcnt(0)
v_xor_b32 v11, 0x8000, v11
v_mfma_f32_32x32x16_bf16 v[80:95], a[128:131], v[16:19], v[208:223]
s_add_u32 m0, s73, 16384
ds_read_b128 a[192:195], v11 offset:0
ds_read_b128 a[196:199], v11 offset:1024
v_exp_f32 v156, v156
v_mfma_f32_32x32x16_bf16 v[80:95], a[132:135], v[20:23], v[80:95]
ds_read_b128 a[200:203], v11 offset:2048
buffer_load_dwordx4 v12, s[56:59], s71 offen offset:0 sc1 lds
v_exp_f32 v157, v157
v_exp_f32 v158, v158
v_mfma_f32_32x32x16_bf16 v[80:95], a[136:139], v[24:27], v[80:95]
ds_read_b128 a[204:207], v11 offset:3072
ds_read_b128 a[208:211], v11 offset:4096
v_add_f32 v2, v2, v156
v_exp_f32 v159, v159
v_add_f32 v3, v3, v157
v_mfma_f32_32x32x16_bf16 v[80:95], a[140:143], v[28:31], v[80:95]
ds_read_b128 a[212:215], v11 offset:5120
buffer_load_dwordx4 v12, s[56:59], s71 offen offset:1024 sc1 lds
v_cvt_pk_bf16_f32 v154, v156, v157
v_exp_f32 v176, v176
v_add_f32 v2, v2, v158
v_mfma_f32_32x32x16_bf16 v[80:95], a[144:147], v[32:35], v[80:95]
ds_read_b128 a[216:219], v11 offset:6144
ds_read_b128 a[220:223], v11 offset:7168
v_exp_f32 v177, v177
v_add_f32 v3, v3, v159
v_cvt_pk_bf16_f32 v155, v158, v159
v_mfma_f32_32x32x16_bf16 v[80:95], a[148:151], v[36:39], v[80:95]
ds_read_b128 a[224:227], v11 offset:8192
v_exp_f32 v178, v178
v_add_f32 v2, v2, v176
v_exp_f32 v179, v179
v_mfma_f32_32x32x16_bf16 v[80:95], a[152:155], v[40:43], v[80:95]
ds_read_b128 a[228:231], v11 offset:9216
ds_read_b128 a[232:235], v11 offset:10240
buffer_load_dwordx4 v12, s[56:59], s71 offen offset:2048 sc1 lds
v_add_f32 v3, v3, v177
v_cvt_pk_bf16_f32 v176, v176, v177
v_mfma_f32_32x32x16_bf16 v[80:95], a[156:159], v[44:47], v[80:95]
ds_read_b128 a[236:239], v11 offset:11264
v_exp_f32 v180, v180
v_add_f32 v2, v2, v178
v_exp_f32 v181, v181
v_mfma_f32_32x32x16_bf16 v[112:127], a[160:163], v[16:19], v[208:223]
ds_read_b128 a[240:243], v11 offset:12288
ds_read_b128 a[244:247], v11 offset:13312
buffer_load_dwordx4 v12, s[56:59], s71 offen offset:3072 sc1 lds
v_add_f32 v3, v3, v179
v_cvt_pk_bf16_f32 v177, v178, v179
v_mfma_f32_32x32x16_bf16 v[112:127], a[164:167], v[20:23], v[112:127]
ds_read_b128 a[248:251], v11 offset:14336
v_exp_f32 v182, v182
v_add_f32 v2, v2, v180
v_exp_f32 v183, v183
v_mfma_f32_32x32x16_bf16 v[112:127], a[168:171], v[24:27], v[112:127]
ds_read_b128 a[252:255], v11 offset:15360
v_add_f32 v3, v3, v181
v_cvt_pk_bf16_f32 v178, v180, v181
v_exp_f32 v184, v184
v_add_f32 v2, v2, v182
v_mfma_f32_32x32x16_bf16 v[112:127], a[172:175], v[28:31], v[112:127]
s_add_u32 s71, s71, 16384
v_exp_f32 v185, v185
v_add_f32 v3, v3, v183
v_cvt_pk_bf16_f32 v179, v182, v183
v_mfma_f32_32x32x16_bf16 v[112:127], a[176:179], v[32:35], v[112:127]
v_exp_f32 v186, v186
v_add_f32 v2, v2, v184
v_exp_f32 v187, v187
v_add_f32 v3, v3, v185
v_mfma_f32_32x32x16_bf16 v[112:127], a[180:183], v[36:39], v[112:127]
s_xor_b32 s73, s73, 0x8000
v_cvt_pk_bf16_f32 v184, v184, v185
v_exp_f32 v188, v188
v_add_f32 v2, v2, v186
v_mfma_f32_32x32x16_bf16 v[112:127], a[184:187], v[40:43], v[112:127]
v_exp_f32 v189, v189
v_add_f32 v3, v3, v187
v_cvt_pk_bf16_f32 v185, v186, v187
v_exp_f32 v190, v190
v_mfma_f32_32x32x16_bf16 v[112:127], a[188:191], v[44:47], v[112:127]
v_add_f32 v2, v2, v188
v_exp_f32 v191, v191
v_add_f32 v3, v3, v189
v_cvt_pk_bf16_f32 v186, v188, v189
v_add_f32 v2, v2, v190
v_add_f32 v3, v3, v191
v_cvt_pk_bf16_f32 v187, v190, v191
s_waitcnt vmcnt(16) lgkmcnt(0)
v_mfma_f32_32x32x16_bf16 a[0:15], a[192:195], v[144:147], a[0:15]
s_barrier
v_xor_b32 v10, 0x8000, v10
v_mfma_f32_32x32x16_bf16 a[16:31], a[196:199], v[144:147], a[16:31]
ds_read_b128 a[128:131], v10 offset:0
ds_read_b128 a[132:135], v10 offset:1024
v_max3_f32 v6, v80, v81, v82
v_max3_f32 v6, v6, v83, v84
v_max3_f32 v6, v6, v85, v86
v_max3_f32 v6, v6, v87, v88
v_mfma_f32_32x32x16_bf16 a[32:47], a[200:203], v[144:147], a[32:47]
ds_read_b128 a[136:139], v10 offset:2048
v_max3_f32 v6, v6, v89, v90
v_max3_f32 v6, v6, v91, v92
v_max3_f32 v6, v6, v93, v94
v_max3_f32 v6, v6, v95, v112
v_max3_f32 v6, v6, v113, v114
v_mfma_f32_32x32x16_bf16 a[48:63], a[204:207], v[144:147], a[48:63]
ds_read_b128 a[140:143], v10 offset:3072
ds_read_b128 a[144:147], v10 offset:4096
v_max3_f32 v6, v6, v115, v116
v_max3_f32 v6, v6, v117, v118
v_max3_f32 v6, v6, v119, v120
v_max3_f32 v6, v6, v121, v122
v_mfma_f32_32x32x16_bf16 a[0:15], a[208:211], v[152:155], a[0:15]
ds_read_b128 a[148:151], v10 offset:5120
v_max3_f32 v6, v6, v123, v124
v_max3_f32 v6, v6, v125, v126
v_max_f32 v6, v6, v127
v_cmp_lt_f32 vcc, s79, v6
v_mfma_f32_32x32x16_bf16 a[16:31], a[212:215], v[152:155], a[16:31]
s_cbranch_vccnz L_p3_s1_rare
s_add_u32 m0, s72, 16384
ds_read_b128 a[152:155], v10 offset:6144
ds_read_b128 a[156:159], v10 offset:7168
v_exp_f32 v80, v80
v_mfma_f32_32x32x16_bf16 a[32:47], a[216:219], v[152:155], a[32:47]
ds_read_b128 a[160:163], v10 offset:8192
buffer_load_dwordx4 v12, s[52:55], s71 offen offset:0 sc1 lds
v_exp_f32 v81, v81
v_exp_f32 v82, v82
v_mfma_f32_32x32x16_bf16 a[48:63], a[220:223], v[152:155], a[48:63]
ds_read_b128 a[164:167], v10 offset:9216
ds_read_b128 a[168:171], v10 offset:10240
buffer_load_dwordx4 v12, s[52:55], s71 offen offset:1024 sc1 lds
v_add_f32 v2, v2, v80
v_exp_f32 v83, v83
v_mfma_f32_32x32x16_bf16 a[0:15], a[224:227], v[176:179], a[0:15]
ds_read_b128 a[172:175], v10 offset:11264
v_add_f32 v3, v3, v81
v_cvt_pk_bf16_f32 v80, v80, v81
v_exp_f32 v84, v84
v_add_f32 v2, v2, v82
v_mfma_f32_32x32x16_bf16 a[16:31], a[228:231], v[176:179], a[16:31]
ds_read_b128 a[176:179], v10 offset:12288
ds_read_b128 a[180:183], v10 offset:13312
buffer_load_dwordx4 v12, s[52:55], s71 offen offset:2048 sc1 lds
v_exp_f32 v85, v85
v_add_f32 v3, v3, v83
v_mfma_f32_32x32x16_bf16 a[32:47], a[232:235], v[176:179], a[32:47]
ds_read_b128 a[184:187], v10 offset:14336
v_cvt_pk_bf16_f32 v81, v82, v83
v_exp_f32 v86, v86
v_add_f32 v2, v2, v84
v_mfma_f32_32x32x16_bf16 a[48:63], a[236:239], v[176:179], a[48:63]
ds_read_b128 a[188:191], v10 offset:15360
buffer_load_dwordx4 v12, s[52:55], s71 offen offset:3072 sc1 lds
v_exp_f32 v87, v87
v_add_f32 v3, v3, v85
v_cvt_pk_bf16_f32 v82, v84, v85
v_mfma_f32_32x32x16_bf16 a[0:15], a[240:243], v[184:187], a[0:15]
s_xor_b32 s72, s72, 0x8000
v_exp_f32 v88, v88
v_add_f32 v2, v2, v86
v_exp_f32 v89, v89
v_mfma_f32_32x32x16_bf16 a[16:31], a[244:247], v[184:187], a[16:31]
v_add_f32 v3, v3, v87
v_cvt_pk_bf16_f32 v83, v86, v87
v_exp_f32 v90, v90
v_add_f32 v2, v2, v88
v_mfma_f32_32x32x16_bf16 a[32:47], a[248:251], v[184:187], a[32:47]
buffer_store_dword v77, v76, s[8:11], s37 offen offset:1024 sc1
v_exp_f32 v91, v91
v_add_f32 v3, v3, v89
v_cvt_pk_bf16_f32 v88, v88, v89
v_mfma_f32_32x32x16_bf16 a[48:63], a[252:255], v[184:187], a[48:63]
v_add_f32 v2, v2, v90
v_add_f32 v3, v3, v91
v_cvt_pk_bf16_f32 v89, v90, v91
L_p3_s1_end:
s_branch L_p3_s0_top
L_p3_s1m_top:
s_waitcnt lgkmcnt(0)
v_xor_b32 v11, 0x8000, v11
v_mfma_f32_32x32x16_bf16 v[80:95], a[128:131], v[16:19], v[208:223]
s_add_u32 m0, s73, 16384
ds_read_b128 a[192:195], v11 offset:0
ds_read_b128 a[196:199], v11 offset:1024
v_exp_f32 v156, v156
v_mfma_f32_32x32x16_bf16 v[80:95], a[132:135], v[20:23], v[80:95]
ds_read_b128 a[200:203], v11 offset:2048
buffer_load_dwordx4 v12, s[56:59], s71 offen offset:0 sc1 lds
v_exp_f32 v157, v157
v_exp_f32 v158, v158
v_mfma_f32_32x32x16_bf16 v[80:95], a[136:139], v[24:27], v[80:95]
ds_read_b128 a[204:207], v11 offset:3072
ds_read_b128 a[208:211], v11 offset:4096
v_add_f32 v2, v2, v156
v_exp_f32 v159, v159
v_add_f32 v3, v3, v157
v_mfma_f32_32x32x16_bf16 v[80:95], a[140:143], v[28:31], v[80:95]
ds_read_b128 a[212:215], v11 offset:5120
buffer_load_dwordx4 v12, s[56:59], s71 offen offset:1024 sc1 lds
v_cvt_pk_bf16_f32 v154, v156, v157
v_exp_f32 v176, v176
v_add_f32 v2, v2, v158
v_mfma_f32_32x32x16_bf16 v[80:95], a[144:147], v[32:35], v[80:95]
ds_read_b128 a[216:219], v11 offset:6144
ds_read_b128 a[220:223], v11 offset:7168
v_exp_f32 v177, v177
v_add_f32 v3, v3, v159
v_cvt_pk_bf16_f32 v155, v158, v159
v_mfma_f32_32x32x16_bf16 v[80:95], a[148:151], v[36:39], v[80:95]
ds_read_b128 a[224:227], v11 offset:8192
v_exp_f32 v178, v178
v_add_f32 v2, v2, v176
v_exp_f32 v179, v179
v_mfma_f32_32x32x16_bf16 v[80:95], a[152:155], v[40:43], v[80:95]
ds_read_b128 a[228:231], v11 offset:9216
ds_read_b128 a[232:235], v11 offset:10240
buffer_load_dwordx4 v12, s[56:59], s71 offen offset:2048 sc1 lds
v_add_f32 v3, v3, v177
v_cvt_pk_bf16_f32 v176, v176, v177
v_mfma_f32_32x32x16_bf16 v[80:95], a[156:159], v[44:47], v[80:95]
ds_read_b128 a[236:239], v11 offset:11264
v_exp_f32 v180, v180
v_add_f32 v2, v2, v178
v_exp_f32 v181, v181
v_mfma_f32_32x32x16_bf16 v[112:127], a[160:163], v[16:19], v[208:223]
ds_read_b128 a[240:243], v11 offset:12288
ds_read_b128 a[244:247], v11 offset:13312
buffer_load_dwordx4 v12, s[56:59], s71 offen offset:3072 sc1 lds
v_add_f32 v3, v3, v179
v_cvt_pk_bf16_f32 v177, v178, v179
v_mfma_f32_32x32x16_bf16 v[112:127], a[164:167], v[20:23], v[112:127]
ds_read_b128 a[248:251], v11 offset:14336
v_exp_f32 v182, v182
v_add_f32 v2, v2, v180
v_exp_f32 v183, v183
v_mfma_f32_32x32x16_bf16 v[112:127], a[168:171], v[24:27], v[112:127]
ds_read_b128 a[252:255], v11 offset:15360
v_add_f32 v3, v3, v181
v_cvt_pk_bf16_f32 v178, v180, v181
v_exp_f32 v184, v184
v_add_f32 v2, v2, v182
v_mfma_f32_32x32x16_bf16 v[112:127], a[172:175], v[28:31], v[112:127]
s_add_u32 s71, s71, 16384
v_exp_f32 v185, v185
v_add_f32 v3, v3, v183
v_cvt_pk_bf16_f32 v179, v182, v183
v_add_u32 v246, 0, v13
v_mfma_f32_32x32x16_bf16 v[112:127], a[176:179], v[32:35], v[112:127]
v_exp_f32 v186, v186
v_add_f32 v2, v2, v184
v_exp_f32 v187, v187
v_add_f32 v3, v3, v185
v_mfma_f32_32x32x16_bf16 v[112:127], a[180:183], v[36:39], v[112:127]
s_xor_b32 s73, s73, 0x8000
v_cvt_pk_bf16_f32 v184, v184, v185
v_cmp_gt_i32_e64 s[84:85], 0, v246
v_cmp_gt_i32_e64 s[86:87], 1, v246
v_cmp_gt_i32_e64 s[88:89], 2, v246
v_cmp_gt_i32_e64 s[90:91], 3, v246
v_mfma_f32_32x32x16_bf16 v[112:127], a[184:187], v[40:43], v[112:127]
v_cndmask_b32_e64 v80, v80, v14, s[84:85]
v_cndmask_b32_e64 v81, v81, v14, s[86:87]
v_exp_f32 v188, v188
v_add_f32 v2, v2, v186
v_cndmask_b32_e64 v82, v82, v14, s[88:89]
v_mfma_f32_32x32x16_bf16 v[112:127], a[188:191], v[44:47], v[112:127]
v_exp_f32 v189, v189
v_cndmask_b32_e64 v83, v83, v14, s[90:91]
v_cmp_gt_i32_e64 s[92:93], 16, v246
v_cmp_gt_i32_e64 s[94:95], 17, v246
v_cmp_gt_i32_e64 s[96:97], 18, v246
v_cmp_gt_i32_e64 s[98:99], 19, v246
v_cndmask_b32_e64 v84, v84, v14, s[92:93]
v_add_f32 v3, v3, v187
v_cvt_pk_bf16_f32 v185, v186, v187
v_exp_f32 v190, v190
v_cndmask_b32_e64 v85, v85, v14, s[94:95]
v_cndmask_b32_e64 v86, v86, v14, s[96:97]
v_cndmask_b32_e64 v87, v87, v14, s[98:99]
v_cmp_gt_i32_e64 s[84:85], 8, v246
v_cmp_gt_i32_e64 s[86:87], 9, v246
v_cmp_gt_i32_e64 s[88:89], 10, v246
v_add_f32 v2, v2, v188
v_exp_f32 v191, v191
v_add_f32 v3, v3, v189
v_cmp_gt_i32_e64 s[90:91], 11, v246
v_cndmask_b32_e64 v88, v88, v14, s[84:85]
v_cndmask_b32_e64 v89, v89, v14, s[86:87]
v_cndmask_b32_e64 v90, v90, v14, s[88:89]
v_cndmask_b32_e64 v91, v91, v14, s[90:91]
v_cmp_gt_i32_e64 s[92:93], 24, v246
v_cmp_gt_i32_e64 s[94:95], 25, v246
v_cvt_pk_bf16_f32 v186, v188, v189
v_add_f32 v2, v2, v190
v_add_f32 v3, v3, v191
v_cvt_pk_bf16_f32 v187, v190, v191
v_cmp_gt_i32_e64 s[96:97], 26, v246
v_cmp_gt_i32_e64 s[98:99], 27, v246
v_cndmask_b32_e64 v92, v92, v14, s[92:93]
v_cndmask_b32_e64 v93, v93, v14, s[94:95]
v_cndmask_b32_e64 v94, v94, v14, s[96:97]
v_cndmask_b32_e64 v95, v95, v14, s[98:99]
s_waitcnt vmcnt(16) lgkmcnt(0)
v_mfma_f32_32x32x16_bf16 a[0:15], a[192:195], v[144:147], a[0:15]
s_barrier
v_xor_b32 v10, 0x8000, v10
v_mfma_f32_32x32x16_bf16 a[16:31], a[196:199], v[144:147], a[16:31]
ds_read_b128 a[128:131], v10 offset:0
ds_read_b128 a[132:135], v10 offset:1024
v_max3_f32 v6, v80, v81, v82
v_max3_f32 v6, v6, v83, v84
v_max3_f32 v6, v6, v85, v86
v_max3_f32 v6, v6, v87, v88
v_mfma_f32_32x32x16_bf16 a[32:47], a[200:203], v[144:147], a[32:47]
ds_read_b128 a[136:139], v10 offset:2048
ds_read_b128 a[140:143], v10 offset:3072
v_max3_f32 v6, v6, v89, v90
v_max3_f32 v6, v6, v91, v92
v_max3_f32 v6, v6, v93, v94
v_add_u32 v247, -32, v13
v_mfma_f32_32x32x16_bf16 a[48:63], a[204:207], v[144:147], a[48:63]
ds_read_b128 a[144:147], v10 offset:4096
v_cmp_gt_i32_e64 s[84:85], 0, v247
v_cmp_gt_i32_e64 s[86:87], 1, v247
v_cmp_gt_i32_e64 s[88:89], 2, v247
v_cmp_gt_i32_e64 s[90:91], 3, v247
v_cndmask_b32_e64 v112, v112, v14, s[84:85]
v_mfma_f32_32x32x16_bf16 a[0:15], a[208:211], v[152:155], a[0:15]
ds_read_b128 a[148:151], v10 offset:5120
ds_read_b128 a[152:155], v10 offset:6144
v_cndmask_b32_e64 v113, v113, v14, s[86:87]
v_cndmask_b32_e64 v114, v114, v14, s[88:89]
v_cndmask_b32_e64 v115, v115, v14, s[90:91]
v_cmp_gt_i32_e64 s[92:93], 16, v247
v_mfma_f32_32x32x16_bf16 a[16:31], a[212:215], v[152:155], a[16:31]
ds_read_b128 a[156:159], v10 offset:7168
v_cmp_gt_i32_e64 s[94:95], 17, v247
v_cmp_gt_i32_e64 s[96:97], 18, v247
v_cmp_gt_i32_e64 s[98:99], 19, v247
v_cndmask_b32_e64 v116, v116, v14, s[92:93]
v_cndmask_b32_e64 v117, v117, v14, s[94:95]
v_mfma_f32_32x32x16_bf16 a[32:47], a[216:219], v[152:155], a[32:47]
ds_read_b128 a[160:163], v10 offset:8192
ds_read_b128 a[164:167], v10 offset:9216
v_cndmask_b32_e64 v118, v118, v14, s[96:97]
v_cndmask_b32_e64 v119, v119, v14, s[98:99]
v_cmp_gt_i32_e64 s[84:85], 8, v247
v_cmp_gt_i32_e64 s[86:87], 9, v247
v_mfma_f32_32x32x16_bf16 a[48:63], a[220:223], v[152:155], a[48:63]
ds_read_b128 a[168:171], v10 offset:10240
ds_read_b128 a[172:175], v10 offset:11264
v_cmp_gt_i32_e64 s[88:89], 10, v247
v_cmp_gt_i32_e64 s[90:91], 11, v247
v_cndmask_b32_e64 v120, v120, v14, s[84:85]
v_cndmask_b32_e64 v121, v121, v14, s[86:87]
v_mfma_f32_32x32x16_bf16 a[0:15], a[224:227], v[176:179], a[0:15]
ds_read_b128 a[176:179], v10 offset:12288
v_cndmask_b32_e64 v122, v122, v14, s[88:89]
v_cndmask_b32_e64 v123, v123, v14, s[90:91]
v_cmp_gt_i32_e64 s[92:93], 24, v247
v_cmp_gt_i32_e64 s[94:95], 25, v247
v_cmp_gt_i32_e64 s[96:97], 26, v247
v_mfma_f32_32x32x16_bf16 a[16:31], a[228:231], v[176:179], a[16:31]
ds_read_b128 a[180:183], v10 offset:13312
ds_read_b128 a[184:187], v10 offset:14336
v_cmp_gt_i32_e64 s[98:99], 27, v247
v_cndmask_b32_e64 v124, v124, v14, s[92:93]
v_cndmask_b32_e64 v125, v125, v14, s[94:95]
v_cndmask_b32_e64 v126, v126, v14, s[96:97]
v_mfma_f32_32x32x16_bf16 a[32:47], a[232:235], v[176:179], a[32:47]
ds_read_b128 a[188:191], v10 offset:15360
v_cndmask_b32_e64 v127, v127, v14, s[98:99]
v_max3_f32 v6, v6, v95, v112
v_max3_f32 v6, v6, v113, v114
v_max3_f32 v6, v6, v115, v116
v_max3_f32 v6, v6, v117, v118
v_max3_f32 v6, v6, v119, v120
v_max3_f32 v6, v6, v121, v122
v_max3_f32 v6, v6, v123, v124
v_max3_f32 v6, v6, v125, v126
v_max_f32 v6, v6, v127
v_cmp_lt_f32 vcc, s79, v6
v_mfma_f32_32x32x16_bf16 a[48:63], a[236:239], v[176:179], a[48:63]
s_cbranch_vccnz L_p3_s1m_rare
s_add_u32 m0, s72, 16384
v_exp_f32 v80, v80
v_exp_f32 v81, v81
v_mfma_f32_32x32x16_bf16 a[0:15], a[240:243], v[184:187], a[0:15]
buffer_load_dwordx4 v12, s[52:55], s71 offen offset:0 sc1 lds
buffer_load_dwordx4 v12, s[52:55], s71 offen offset:1024 sc1 lds
v_exp_f32 v82, v82
v_add_f32 v2, v2, v80
v_mfma_f32_32x32x16_bf16 a[16:31], a[244:247], v[184:187], a[16:31]
buffer_load_dwordx4 v12, s[52:55], s71 offen offset:2048 sc1 lds
v_exp_f32 v83, v83
v_add_f32 v3, v3, v81
v_cvt_pk_bf16_f32 v80, v80, v81
v_mfma_f32_32x32x16_bf16 a[32:47], a[248:251], v[184:187], a[32:47]
buffer_load_dwordx4 v12, s[52:55], s71 offen offset:3072 sc1 lds
v_exp_f32 v84, v84
v_add_f32 v2, v2, v82
v_exp_f32 v85, v85
v_mfma_f32_32x32x16_bf16 a[48:63], a[252:255], v[184:187], a[48:63]
s_xor_b32 s72, s72, 0x8000
v_add_f32 v3, v3, v83
v_cvt_pk_bf16_f32 v81, v82, v83
v_exp_f32 v86, v86
v_add_f32 v2, v2, v84
v_exp_f32 v87, v87
v_add_f32 v3, v3, v85
v_cvt_pk_bf16_f32 v82, v84, v85
v_exp_f32 v88, v88
v_add_f32 v2, v2, v86
v_exp_f32 v89, v89
v_add_f32 v3, v3, v87
v_cvt_pk_bf16_f32 v83, v86, v87
v_exp_f32 v90, v90
v_add_f32 v2, v2, v88
v_exp_f32 v91, v91
v_add_f32 v3, v3, v89
v_cvt_pk_bf16_f32 v88, v88, v89
v_add_f32 v2, v2, v90
v_add_f32 v3, v3, v91
v_cvt_pk_bf16_f32 v89, v90, v91
L_p3_s1m_end:
L_p3_s0m_top:
s_waitcnt lgkmcnt(0)
v_mfma_f32_32x32x16_bf16 v[144:159], a[128:131], v[16:19], v[208:223]
s_add_u32 m0, s73, 0
ds_read_b128 a[192:195], v11 offset:16384
ds_read_b128 a[196:199], v11 offset:17408
v_exp_f32 v92, v92
v_mfma_f32_32x32x16_bf16 v[144:159], a[132:135], v[20:23], v[144:159]
ds_read_b128 a[200:203], v11 offset:18432
buffer_load_dwordx4 v12, s[56:59], s71 offen offset:0 sc1 lds
v_exp_f32 v93, v93
v_exp_f32 v94, v94
v_mfma_f32_32x32x16_bf16 v[144:159], a[136:139], v[24:27], v[144:159]
ds_read_b128 a[204:207], v11 offset:19456
ds_read_b128 a[208:211], v11 offset:20480
v_add_f32 v2, v2, v92
v_exp_f32 v95, v95
v_add_f32 v3, v3, v93
v_mfma_f32_32x32x16_bf16 v[144:159], a[140:143], v[28:31], v[144:159]
ds_read_b128 a[212:215], v11 offset:21504
v_cvt_pk_bf16_f32 v90, v92, v93
v_exp_f32 v112, v112
v_add_f32 v2, v2, v94
v_mfma_f32_32x32x16_bf16 v[144:159], a[144:147], v[32:35], v[144:159]
ds_read_b128 a[216:219], v11 offset:22528
ds_read_b128 a[220:223], v11 offset:23552
buffer_load_dwordx4 v12, s[56:59], s71 offen offset:1024 sc1 lds
v_exp_f32 v113, v113
v_add_f32 v3, v3, v95
v_mfma_f32_32x32x16_bf16 v[144:159], a[148:151], v[36:39], v[144:159]
ds_read_b128 a[224:227], v11 offset:24576
v_cvt_pk_bf16_f32 v91, v94, v95
v_exp_f32 v114, v114
v_add_f32 v2, v2, v112
v_mfma_f32_32x32x16_bf16 v[144:159], a[152:155], v[40:43], v[144:159]
ds_read_b128 a[228:231], v11 offset:25600
ds_read_b128 a[232:235], v11 offset:26624
v_exp_f32 v115, v115
v_add_f32 v3, v3, v113
v_cvt_pk_bf16_f32 v112, v112, v113
v_mfma_f32_32x32x16_bf16 v[144:159], a[156:159], v[44:47], v[144:159]
ds_read_b128 a[236:239], v11 offset:27648
buffer_load_dwordx4 v12, s[56:59], s71 offen offset:2048 sc1 lds
v_exp_f32 v116, v116
v_add_f32 v2, v2, v114
v_mfma_f32_32x32x16_bf16 v[176:191], a[160:163], v[16:19], v[208:223]
ds_read_b128 a[240:243], v11 offset:28672
ds_read_b128 a[244:247], v11 offset:29696
v_exp_f32 v117, v117
v_add_f32 v3, v3, v115
v_cvt_pk_bf16_f32 v113, v114, v115
v_mfma_f32_32x32x16_bf16 v[176:191], a[164:167], v[20:23], v[176:191]
ds_read_b128 a[248:251], v11 offset:30720
v_exp_f32 v118, v118
v_add_f32 v2, v2, v116
v_exp_f32 v119, v119
v_mfma_f32_32x32x16_bf16 v[176:191], a[168:171], v[24:27], v[176:191]
ds_read_b128 a[252:255], v11 offset:31744
buffer_load_dwordx4 v12, s[56:59], s71 offen offset:3072 sc1 lds
v_add_f32 v3, v3, v117
v_cvt_pk_bf16_f32 v114, v116, v117
v_exp_f32 v120, v120
v_mfma_f32_32x32x16_bf16 v[176:191], a[172:175], v[28:31], v[176:191]
v_add_f32 v2, v2, v118
v_exp_f32 v121, v121
v_add_f32 v3, v3, v119
v_cvt_pk_bf16_f32 v115, v118, v119
v_add_u32 v246, -64, v13
v_mfma_f32_32x32x16_bf16 v[176:191], a[176:179], v[32:35], v[176:191]
v_exp_f32 v122, v122
v_add_f32 v2, v2, v120
v_exp_f32 v123, v123
v_add_f32 v3, v3, v121
v_mfma_f32_32x32x16_bf16 v[176:191], a[180:183], v[36:39], v[176:191]
s_add_u32 s71, s71, 16384
v_cvt_pk_bf16_f32 v120, v120, v121
v_cmp_gt_i32_e64 s[84:85], 0, v246
v_cmp_gt_i32_e64 s[86:87], 1, v246
v_cmp_gt_i32_e64 s[88:89], 2, v246
v_cmp_gt_i32_e64 s[90:91], 3, v246
v_mfma_f32_32x32x16_bf16 v[176:191], a[184:187], v[40:43], v[176:191]
v_cndmask_b32_e64 v144, v144, v14, s[84:85]
v_cndmask_b32_e64 v145, v145, v14, s[86:87]
v_exp_f32 v124, v124
v_add_f32 v2, v2, v122
v_cndmask_b32_e64 v146, v146, v14, s[88:89]
v_mfma_f32_32x32x16_bf16 v[176:191], a[188:191], v[44:47], v[176:191]
v_exp_f32 v125, v125
v_cndmask_b32_e64 v147, v147, v14, s[90:91]
v_cmp_gt_i32_e64 s[92:93], 16, v246
v_cmp_gt_i32_e64 s[94:95], 17, v246
v_cmp_gt_i32_e64 s[96:97], 18, v246
v_cmp_gt_i32_e64 s[98:99], 19, v246
v_cndmask_b32_e64 v148, v148, v14, s[92:93]
v_add_f32 v3, v3, v123
v_cvt_pk_bf16_f32 v121, v122, v123
v_exp_f32 v126, v126
v_cndmask_b32_e64 v149, v149, v14, s[94:95]
v_cndmask_b32_e64 v150, v150, v14, s[96:97]
v_cndmask_b32_e64 v151, v151, v14, s[98:99]
v_cmp_gt_i32_e64 s[84:85], 8, v246
v_cmp_gt_i32_e64 s[86:87], 9, v246
v_cmp_gt_i32_e64 s[88:89], 10, v246
v_add_f32 v2, v2, v124
v_exp_f32 v127, v127
v_add_f32 v3, v3, v125
v_cmp_gt_i32_e64 s[90:91], 11, v246
v_cndmask_b32_e64 v152, v152, v14, s[84:85]
v_cndmask_b32_e64 v153, v153, v14, s[86:87]
v_cndmask_b32_e64 v154, v154, v14, s[88:89]
v_cndmask_b32_e64 v155, v155, v14, s[90:91]
v_cmp_gt_i32_e64 s[92:93], 24, v246
v_cmp_gt_i32_e64 s[94:95], 25, v246
v_cvt_pk_bf16_f32 v122, v124, v125
v_add_f32 v2, v2, v126
v_add_f32 v3, v3, v127
v_cvt_pk_bf16_f32 v123, v126, v127
v_cmp_gt_i32_e64 s[96:97], 26, v246
v_cmp_gt_i32_e64 s[98:99], 27, v246
v_cndmask_b32_e64 v156, v156, v14, s[92:93]
v_cndmask_b32_e64 v157, v157, v14, s[94:95]
v_cndmask_b32_e64 v158, v158, v14, s[96:97]
v_cndmask_b32_e64 v159, v159, v14, s[98:99]
s_waitcnt vmcnt(16) lgkmcnt(0)
v_mfma_f32_32x32x16_bf16 a[0:15], a[192:195], v[80:83], a[0:15]
s_barrier
v_mfma_f32_32x32x16_bf16 a[16:31], a[196:199], v[80:83], a[16:31]
ds_read_b128 a[128:131], v10 offset:16384
ds_read_b128 a[132:135], v10 offset:17408
v_max3_f32 v6, v144, v145, v146
v_max3_f32 v6, v6, v147, v148
v_max3_f32 v6, v6, v149, v150
v_max3_f32 v6, v6, v151, v152
v_mfma_f32_32x32x16_bf16 a[32:47], a[200:203], v[80:83], a[32:47]
ds_read_b128 a[136:139], v10 offset:18432
ds_read_b128 a[140:143], v10 offset:19456
v_max3_f32 v6, v6, v153, v154
v_max3_f32 v6, v6, v155, v156
v_max3_f32 v6, v6, v157, v158
v_add_u32 v247, -96, v13
v_mfma_f32_32x32x16_bf16 a[48:63], a[204:207], v[80:83], a[48:63]
ds_read_b128 a[144:147], v10 offset:20480
v_cmp_gt_i32_e64 s[84:85], 0, v247
v_cmp_gt_i32_e64 s[86:87], 1, v247
v_cmp_gt_i32_e64 s[88:89], 2, v247
v_cmp_gt_i32_e64 s[90:91], 3, v247
v_cndmask_b32_e64 v176, v176, v14, s[84:85]
v_mfma_f32_32x32x16_bf16 a[0:15], a[208:211], v[88:91], a[0:15]
ds_read_b128 a[148:151], v10 offset:21504
ds_read_b128 a[152:155], v10 offset:22528
v_cndmask_b32_e64 v177, v177, v14, s[86:87]
v_cndmask_b32_e64 v178, v178, v14, s[88:89]
v_cndmask_b32_e64 v179, v179, v14, s[90:91]
v_cmp_gt_i32_e64 s[92:93], 16, v247
v_mfma_f32_32x32x16_bf16 a[16:31], a[212:215], v[88:91], a[16:31]
ds_read_b128 a[156:159], v10 offset:23552
v_cmp_gt_i32_e64 s[94:95], 17, v247
v_cmp_gt_i32_e64 s[96:97], 18, v247
v_cmp_gt_i32_e64 s[98:99], 19, v247
v_cndmask_b32_e64 v180, v180, v14, s[92:93]
v_cndmask_b32_e64 v181, v181, v14, s[94:95]
v_mfma_f32_32x32x16_bf16 a[32:47], a[216:219], v[88:91], a[32:47]
ds_read_b128 a[160:163], v10 offset:24576
ds_read_b128 a[164:167], v10 offset:25600
v_cndmask_b32_e64 v182, v182, v14, s[96:97]
v_cndmask_b32_e64 v183, v183, v14, s[98:99]
v_cmp_gt_i32_e64 s[84:85], 8, v247
v_cmp_gt_i32_e64 s[86:87], 9, v247
v_mfma_f32_32x32x16_bf16 a[48:63], a[220:223], v[88:91], a[48:63]
ds_read_b128 a[168:171], v10 offset:26624
ds_read_b128 a[172:175], v10 offset:27648
v_cmp_gt_i32_e64 s[88:89], 10, v247
v_cmp_gt_i32_e64 s[90:91], 11, v247
v_cndmask_b32_e64 v184, v184, v14, s[84:85]
v_cndmask_b32_e64 v185, v185, v14, s[86:87]
v_mfma_f32_32x32x16_bf16 a[0:15], a[224:227], v[112:115], a[0:15]
ds_read_b128 a[176:179], v10 offset:28672
v_cndmask_b32_e64 v186, v186, v14, s[88:89]
v_cndmask_b32_e64 v187, v187, v14, s[90:91]
v_cmp_gt_i32_e64 s[92:93], 24, v247
v_cmp_gt_i32_e64 s[94:95], 25, v247
v_cmp_gt_i32_e64 s[96:97], 26, v247
v_mfma_f32_32x32x16_bf16 a[16:31], a[228:231], v[112:115], a[16:31]
ds_read_b128 a[180:183], v10 offset:29696
ds_read_b128 a[184:187], v10 offset:30720
v_cmp_gt_i32_e64 s[98:99], 27, v247
v_cndmask_b32_e64 v188, v188, v14, s[92:93]
v_cndmask_b32_e64 v189, v189, v14, s[94:95]
v_cndmask_b32_e64 v190, v190, v14, s[96:97]
v_mfma_f32_32x32x16_bf16 a[32:47], a[232:235], v[112:115], a[32:47]
ds_read_b128 a[188:191], v10 offset:31744
v_cndmask_b32_e64 v191, v191, v14, s[98:99]
v_max3_f32 v6, v6, v159, v176
v_max3_f32 v6, v6, v177, v178
v_max3_f32 v6, v6, v179, v180
v_max3_f32 v6, v6, v181, v182
v_max3_f32 v6, v6, v183, v184
v_max3_f32 v6, v6, v185, v186
v_max3_f32 v6, v6, v187, v188
v_max3_f32 v6, v6, v189, v190
v_max_f32 v6, v6, v191
v_cmp_lt_f32 vcc, s79, v6
v_mfma_f32_32x32x16_bf16 a[48:63], a[236:239], v[112:115], a[48:63]
s_cbranch_vccnz L_p3_s0m_rare
s_add_u32 m0, s72, 0
v_exp_f32 v144, v144
v_exp_f32 v145, v145
v_mfma_f32_32x32x16_bf16 a[0:15], a[240:243], v[120:123], a[0:15]
buffer_load_dwordx4 v12, s[52:55], s71 offen offset:0 sc1 lds
buffer_load_dwordx4 v12, s[52:55], s71 offen offset:1024 sc1 lds
buffer_load_dwordx4 v12, s[52:55], s71 offen offset:2048 sc1 lds
v_exp_f32 v146, v146
v_add_f32 v2, v2, v144
v_mfma_f32_32x32x16_bf16 a[16:31], a[244:247], v[120:123], a[16:31]
buffer_load_dwordx4 v12, s[52:55], s71 offen offset:3072 sc1 lds
v_lshlrev_b32 v245, 4, v1
s_mov_b32 m0, s43
v_exp_f32 v147, v147
v_add_f32 v3, v3, v145
v_mfma_f32_32x32x16_bf16 a[32:47], a[248:251], v[120:123], a[32:47]
s_nop 0
buffer_load_dwordx4 v245, s[20:23], 0 offen offset:0 sc1 lds
buffer_load_dwordx4 v245, s[20:23], 0 offen offset:1024 sc1 lds
v_cvt_pk_bf16_f32 v144, v144, v145
v_exp_f32 v148, v148
v_mfma_f32_32x32x16_bf16 a[48:63], a[252:255], v[120:123], a[48:63]
buffer_load_dwordx4 v245, s[20:23], 0 offen offset:2048 sc1 lds
buffer_load_dwordx4 v245, s[20:23], 0 offen offset:3072 sc1 lds
v_add_f32 v2, v2, v146
v_exp_f32 v149, v149
v_add_f32 v3, v3, v147
v_cvt_pk_bf16_f32 v145, v146, v147
v_exp_f32 v150, v150
v_add_f32 v2, v2, v148
v_exp_f32 v151, v151
v_add_f32 v3, v3, v149
v_cvt_pk_bf16_f32 v146, v148, v149
v_exp_f32 v152, v152
v_add_f32 v2, v2, v150
v_exp_f32 v153, v153
v_add_f32 v3, v3, v151
v_cvt_pk_bf16_f32 v147, v150, v151
v_exp_f32 v154, v154
v_add_f32 v2, v2, v152
v_exp_f32 v155, v155
v_add_f32 v3, v3, v153
v_cvt_pk_bf16_f32 v152, v152, v153
v_add_f32 v2, v2, v154
v_add_f32 v3, v3, v155
v_cvt_pk_bf16_f32 v153, v154, v155
L_p3_s0m_end:
s_load_dwordx2 s[88:89], s[0:1], 104
s_waitcnt lgkmcnt(0)
v_xor_b32 v11, 0x8000, v11
ds_read_b128 a[192:195], v11 offset:0
ds_read_b128 a[196:199], v11 offset:1024
ds_read_b128 a[200:203], v11 offset:2048
ds_read_b128 a[204:207], v11 offset:3072
ds_read_b128 a[208:211], v11 offset:4096
ds_read_b128 a[212:215], v11 offset:5120
ds_read_b128 a[216:219], v11 offset:6144
ds_read_b128 a[220:223], v11 offset:7168
ds_read_b128 a[224:227], v11 offset:8192
ds_read_b128 a[228:231], v11 offset:9216
ds_read_b128 a[232:235], v11 offset:10240
ds_read_b128 a[236:239], v11 offset:11264
ds_read_b128 a[240:243], v11 offset:12288
ds_read_b128 a[244:247], v11 offset:13312
ds_read_b128 a[248:251], v11 offset:14336
ds_read_b128 a[252:255], v11 offset:15360
v_exp_f32 v156, v156
v_exp_f32 v157, v157
v_exp_f32 v158, v158
v_add_f32 v2, v2, v156
v_exp_f32 v159, v159
v_add_f32 v3, v3, v157
v_cvt_pk_bf16_f32 v154, v156, v157
v_exp_f32 v176, v176
v_add_f32 v2, v2, v158
v_exp_f32 v177, v177
v_add_f32 v3, v3, v159
v_cvt_pk_bf16_f32 v155, v158, v159
v_exp_f32 v178, v178
v_add_f32 v2, v2, v176
v_exp_f32 v179, v179
v_add_f32 v3, v3, v177
v_cvt_pk_bf16_f32 v176, v176, v177
v_exp_f32 v180, v180
v_add_f32 v2, v2, v178
v_exp_f32 v181, v181
v_add_f32 v3, v3, v179
v_cvt_pk_bf16_f32 v177, v178, v179
v_exp_f32 v182, v182
v_add_f32 v2, v2, v180
v_exp_f32 v183, v183
v_add_f32 v3, v3, v181
v_cvt_pk_bf16_f32 v178, v180, v181
v_exp_f32 v184, v184
v_add_f32 v2, v2, v182
v_exp_f32 v185, v185
v_add_f32 v3, v3, v183
v_cvt_pk_bf16_f32 v179, v182, v183
v_exp_f32 v186, v186
v_add_f32 v2, v2, v184
v_exp_f32 v187, v187
v_add_f32 v3, v3, v185
v_cvt_pk_bf16_f32 v184, v184, v185
v_exp_f32 v188, v188
v_add_f32 v2, v2, v186
v_exp_f32 v189, v189
v_add_f32 v3, v3, v187
v_cvt_pk_bf16_f32 v185, v186, v187
v_exp_f32 v190, v190
v_add_f32 v2, v2, v188
v_exp_f32 v191, v191
v_add_f32 v3, v3, v189
v_cvt_pk_bf16_f32 v186, v188, v189
v_add_f32 v2, v2, v190
v_add_f32 v3, v3, v191
v_cvt_pk_bf16_f32 v187, v190, v191
s_waitcnt vmcnt(0) lgkmcnt(0)
s_barrier
buffer_store_dword v77, v76, s[8:11], s37 offen offset:1024 sc1
v_mfma_f32_32x32x16_bf16 a[0:15], a[192:195], v[144:147], a[0:15]
s_mul_i32 s36, s3, 16640
v_and_b32 v16, 15, v1
v_lshrrev_b32 v17, 4, v1
v_add_u32 v18, 13, v16
v_and_b32 v19, 3, v18
v_cmp_eq_u32 vcc, 0, v19
v_mfma_f32_32x32x16_bf16 a[16:31], a[196:199], v[144:147], a[16:31]
v_lshrrev_b32 v18, 2, v18
v_mul_u32_u24 v19, 4160, v19
v_cndmask_b32 v19, v19, 8, vcc
v_lshl_add_u32 v19, v18, 3, v19
v_lshl_add_u32 v19, v17, 4, v19
v_add_u32 v4, s36, v19
v_mfma_f32_32x32x16_bf16 a[32:47], a[200:203], v[144:147], a[32:47]
v_add_u32 v6, s36, v72
v_lshlrev_b32 v18, 5, v16
v_lshlrev_b32 v19, 4, v17
v_sub_u32 v19, v19, v18
s_add_u32 s37, s43, 480
v_add_u32 v5, s37, v19
v_mfma_f32_32x32x16_bf16 a[48:63], a[204:207], v[144:147], a[48:63]
v_mul_u32_u24 v18, 136, v16
v_lshl_add_u32 v18, v17, 5, v18
s_lshl_b32 s37, s3, 1
s_add_u32 s37, s37, 49152
v_add_u32 v7, s37, v18
v_lshrrev_b32 v18, 3, v1
v_mfma_f32_32x32x16_bf16 a[0:15], a[208:211], v[152:155], a[0:15]
v_mul_u32_u24 v18, 136, v18
v_and_b32 v19, 7, v1
v_lshl_add_u32 v18, v19, 4, v18
s_mul_i32 s37, s3, 4352
s_add_u32 s37, s37, 49152
v_add_u32 v8, s37, v18
v_mfma_f32_32x32x16_bf16 a[16:31], a[212:215], v[152:155], a[16:31]
s_lshl_b32 s37, s3, 12
v_add_u32 v9, s37, v72
v_lshl_add_u32 v18, v17, 3, v16
v_sub_u32 v75, 15, v18
v_mov_b32 v20, 0
v_mov_b32 v21, 0
v_mfma_f32_32x32x16_bf16 a[32:47], a[216:219], v[152:155], a[32:47]
v_mov_b32 v22, 0
v_mov_b32 v23, 0
v_and_b32 v16, 3, v1
v_mul_u32_u24 v16, 4160, v16
v_lshrrev_b32 v17, 2, v1
v_min_u32 v17, 3, v17
v_mfma_f32_32x32x16_bf16 a[48:63], a[220:223], v[152:155], a[48:63]
v_lshl_add_u32 v16, v17, 4, v16
v_add_u32 v16, s36, v16
ds_write_b128 v16, v[20:23]
v_and_b32 v17, 31, v1
v_lshlrev_b32 v17, 4, v17
v_add_u32 v17, s43, v17
v_mfma_f32_32x32x16_bf16 a[0:15], a[224:227], v[176:179], a[0:15]
ds_write_b128 v17, v[20:23] offset:4096
v_alignbit_b32 v24, v49, v48, 16
v_alignbit_b32 v25, v50, v49, 16
v_alignbit_b32 v26, v51, v50, 16
v_alignbit_b32 v27, v52, v51, 16
v_alignbit_b32 v28, v53, v52, 16
v_mfma_f32_32x32x16_bf16 a[16:31], a[228:231], v[176:179], a[16:31]
ds_write_b128 v6, v[50:53] offset:64
ds_write_b128 v6, v[24:27] offset:4208
v_mov_b32 v16, v49
v_mov_b32 v17, v50
v_mov_b32 v18, v51
v_mov_b32 v19, v52
v_mfma_f32_32x32x16_bf16 a[32:47], a[232:235], v[176:179], a[32:47]
ds_write_b128 v6, v[16:19] offset:8368
v_mov_b32 v16, v25
v_mov_b32 v17, v26
v_mov_b32 v18, v27
v_mov_b32 v19, v28
ds_write_b128 v6, v[16:19] offset:12528
v_mfma_f32_32x32x16_bf16 a[48:63], a[236:239], v[176:179], a[48:63]
v_alignbit_b32 v30, v55, v54, 16
v_alignbit_b32 v31, v56, v55, 16
v_alignbit_b32 v32, v57, v56, 16
v_alignbit_b32 v33, v58, v57, 16
v_alignbit_b32 v34, v59, v58, 16
ds_write_b128 v6, v[56:59] offset:1088
v_mfma_f32_32x32x16_bf16 a[0:15], a[240:243], v[184:187], a[0:15]
ds_write_b128 v6, v[30:33] offset:5232
v_mov_b32 v16, v55
v_mov_b32 v17, v56
v_mov_b32 v18, v57
v_mov_b32 v19, v58
ds_write_b128 v6, v[16:19] offset:9392
v_mfma_f32_32x32x16_bf16 a[16:31], a[244:247], v[184:187], a[16:31]
v_mov_b32 v16, v31
v_mov_b32 v17, v32
v_mov_b32 v18, v33
v_mov_b32 v19, v34
ds_write_b128 v6, v[16:19] offset:13552
v_alignbit_b32 v24, v61, v60, 16
v_mfma_f32_32x32x16_bf16 a[32:47], a[248:251], v[184:187], a[32:47]
v_alignbit_b32 v25, v62, v61, 16
v_alignbit_b32 v26, v63, v62, 16
v_alignbit_b32 v27, v64, v63, 16
v_alignbit_b32 v28, v65, v64, 16
ds_write_b128 v6, v[62:65] offset:2112
ds_write_b128 v6, v[24:27] offset:6256
v_mfma_f32_32x32x16_bf16 a[48:63], a[252:255], v[184:187], a[48:63]
v_mov_b32 v16, v61
v_mov_b32 v17, v62
v_mov_b32 v18, v63
v_mov_b32 v19, v64
ds_write_b128 v6, v[16:19] offset:10416
v_mov_b32 v16, v25
v_mov_b32 v17, v26
v_mov_b32 v18, v27
v_mov_b32 v19, v28
ds_write_b128 v6, v[16:19] offset:14576
v_alignbit_b32 v30, v67, v66, 16
v_alignbit_b32 v31, v68, v67, 16
v_alignbit_b32 v32, v69, v68, 16
v_alignbit_b32 v33, v70, v69, 16
v_alignbit_b32 v34, v71, v70, 16
ds_write_b128 v6, v[68:71] offset:3136
ds_write_b128 v6, v[30:33] offset:7280
v_mov_b32 v16, v67
v_mov_b32 v17, v68
v_mov_b32 v18, v69
v_mov_b32 v19, v70
ds_write_b128 v6, v[16:19] offset:11440
v_mov_b32 v16, v31
v_mov_b32 v17, v32
v_mov_b32 v18, v33
v_mov_b32 v19, v34
ds_write_b128 v6, v[16:19] offset:15600
v_lshlrev_b32 v16, 16, v74
v_cmp_eq_u32 vcc, 0, v75
s_nop 1
v_cndmask_b32 v44, 0, v74, vcc
v_cmp_eq_u32 vcc, 1, v75
s_nop 1
v_cndmask_b32 v44, v44, v16, vcc
v_cmp_eq_u32 vcc, 2, v75
s_nop 1
v_cndmask_b32 v45, 0, v74, vcc
v_cmp_eq_u32 vcc, 3, v75
s_nop 1
v_cndmask_b32 v45, v45, v16, vcc
v_cmp_eq_u32 vcc, 4, v75
s_nop 1
v_cndmask_b32 v46, 0, v74, vcc
v_cmp_eq_u32 vcc, 5, v75
s_nop 1
v_cndmask_b32 v46, v46, v16, vcc
v_cmp_eq_u32 vcc, 6, v75
s_nop 1
v_cndmask_b32 v47, 0, v74, vcc
v_cmp_eq_u32 vcc, 7, v75
s_nop 1
v_cndmask_b32 v47, v47, v16, vcc
v_add_f32 v2, v2, v3
v_mov_b32 v3, v2
s_nop 1
v_permlane32_swap_b32 v2, v3
v_add_f32 v2, v2, v3
v_rcp_f32 v2, v2
s_nop 7
v_accvgpr_read_b32 v240, a0
v_accvgpr_read_b32 v241, a1
v_accvgpr_read_b32 v242, a2
v_accvgpr_read_b32 v243, a3
v_accvgpr_read_b32 v244, a4
v_accvgpr_read_b32 v245, a5
v_accvgpr_read_b32 v246, a6
v_accvgpr_read_b32 v247, a7
v_mul_f32 v240, v240, v2
v_mul_f32 v241, v241, v2
v_mul_f32 v242, v242, v2
v_mul_f32 v243, v243, v2
v_mul_f32 v244, v244, v2
v_mul_f32 v245, v245, v2
v_mul_f32 v246, v246, v2
v_mul_f32 v247, v247, v2
v_cvt_pk_bf16_f32 v248, v240, v241
v_cvt_pk_bf16_f32 v249, v242, v243
v_cvt_pk_bf16_f32 v250, v244, v245
v_cvt_pk_bf16_f32 v251, v246, v247
buffer_store_dwordx4 v[248:251], v15, s[60:63], s100 offen offset:0 sc1
v_accvgpr_read_b32 v240, a8
v_accvgpr_read_b32 v241, a9
v_accvgpr_read_b32 v242, a10
v_accvgpr_read_b32 v243, a11
v_accvgpr_read_b32 v244, a12
v_accvgpr_read_b32 v245, a13
v_accvgpr_read_b32 v246, a14
v_accvgpr_read_b32 v247, a15
v_mul_f32 v240, v240, v2
v_mul_f32 v241, v241, v2
v_mul_f32 v242, v242, v2
v_mul_f32 v243, v243, v2
v_mul_f32 v244, v244, v2
v_mul_f32 v245, v245, v2
v_mul_f32 v246, v246, v2
v_mul_f32 v247, v247, v2
v_cvt_pk_bf16_f32 v252, v240, v241
v_cvt_pk_bf16_f32 v253, v242, v243
v_cvt_pk_bf16_f32 v254, v244, v245
v_cvt_pk_bf16_f32 v255, v246, v247
buffer_store_dwordx4 v[252:255], v15, s[60:63], s100 offen offset:512 sc1
v_accvgpr_read_b32 v240, a16
v_accvgpr_read_b32 v241, a17
v_accvgpr_read_b32 v242, a18
v_accvgpr_read_b32 v243, a19
v_accvgpr_read_b32 v244, a20
v_accvgpr_read_b32 v245, a21
v_accvgpr_read_b32 v246, a22
v_accvgpr_read_b32 v247, a23
v_mul_f32 v240, v240, v2
v_mul_f32 v241, v241, v2
v_mul_f32 v242, v242, v2
v_mul_f32 v243, v243, v2
v_mul_f32 v244, v244, v2
v_mul_f32 v245, v245, v2
v_mul_f32 v246, v246, v2
v_mul_f32 v247, v247, v2
v_cvt_pk_bf16_f32 v248, v240, v241
v_cvt_pk_bf16_f32 v249, v242, v243
v_cvt_pk_bf16_f32 v250, v244, v245
v_cvt_pk_bf16_f32 v251, v246, v247
buffer_store_dwordx4 v[248:251], v15, s[60:63], s100 offen offset:1024 sc1
v_accvgpr_read_b32 v240, a24
v_accvgpr_read_b32 v241, a25
v_accvgpr_read_b32 v242, a26
v_accvgpr_read_b32 v243, a27
v_accvgpr_read_b32 v244, a28
v_accvgpr_read_b32 v245, a29
v_accvgpr_read_b32 v246, a30
v_accvgpr_read_b32 v247, a31
v_mul_f32 v240, v240, v2
v_mul_f32 v241, v241, v2
v_mul_f32 v242, v242, v2
v_mul_f32 v243, v243, v2
v_mul_f32 v244, v244, v2
v_mul_f32 v245, v245, v2
v_mul_f32 v246, v246, v2
v_mul_f32 v247, v247, v2
v_cvt_pk_bf16_f32 v252, v240, v241
v_cvt_pk_bf16_f32 v253, v242, v243
v_cvt_pk_bf16_f32 v254, v244, v245
v_cvt_pk_bf16_f32 v255, v246, v247
buffer_store_dwordx4 v[252:255], v15, s[60:63], s100 offen offset:1536 sc1
v_accvgpr_read_b32 v240, a32
v_accvgpr_read_b32 v241, a33
v_accvgpr_read_b32 v242, a34
v_accvgpr_read_b32 v243, a35
v_accvgpr_read_b32 v244, a36
v_accvgpr_read_b32 v245, a37
v_accvgpr_read_b32 v246, a38
v_accvgpr_read_b32 v247, a39
v_mul_f32 v240, v240, v2
v_mul_f32 v241, v241, v2
v_mul_f32 v242, v242, v2
v_mul_f32 v243, v243, v2
v_mul_f32 v244, v244, v2
v_mul_f32 v245, v245, v2
v_mul_f32 v246, v246, v2
v_mul_f32 v247, v247, v2
v_cvt_pk_bf16_f32 v248, v240, v241
v_cvt_pk_bf16_f32 v249, v242, v243
v_cvt_pk_bf16_f32 v250, v244, v245
v_cvt_pk_bf16_f32 v251, v246, v247
buffer_store_dwordx4 v[248:251], v15, s[60:63], s100 offen offset:2048 sc1
v_accvgpr_read_b32 v240, a40
v_accvgpr_read_b32 v241, a41
v_accvgpr_read_b32 v242, a42
v_accvgpr_read_b32 v243, a43
v_accvgpr_read_b32 v244, a44
v_accvgpr_read_b32 v245, a45
v_accvgpr_read_b32 v246, a46
v_accvgpr_read_b32 v247, a47
v_mul_f32 v240, v240, v2
v_mul_f32 v241, v241, v2
v_mul_f32 v242, v242, v2
v_mul_f32 v243, v243, v2
v_mul_f32 v244, v244, v2
v_mul_f32 v245, v245, v2
v_mul_f32 v246, v246, v2
v_mul_f32 v247, v247, v2
v_cvt_pk_bf16_f32 v252, v240, v241
v_cvt_pk_bf16_f32 v253, v242, v243
v_cvt_pk_bf16_f32 v254, v244, v245
v_cvt_pk_bf16_f32 v255, v246, v247
buffer_store_dwordx4 v[252:255], v15, s[60:63], s100 offen offset:2560 sc1
v_accvgpr_read_b32 v240, a48
v_accvgpr_read_b32 v241, a49
v_accvgpr_read_b32 v242, a50
v_accvgpr_read_b32 v243, a51
v_accvgpr_read_b32 v244, a52
v_accvgpr_read_b32 v245, a53
v_accvgpr_read_b32 v246, a54
v_accvgpr_read_b32 v247, a55
v_mul_f32 v240, v240, v2
v_mul_f32 v241, v241, v2
v_mul_f32 v242, v242, v2
v_mul_f32 v243, v243, v2
v_mul_f32 v244, v244, v2
v_mul_f32 v245, v245, v2
v_mul_f32 v246, v246, v2
v_mul_f32 v247, v247, v2
v_cvt_pk_bf16_f32 v248, v240, v241
v_cvt_pk_bf16_f32 v249, v242, v243
v_cvt_pk_bf16_f32 v250, v244, v245
v_cvt_pk_bf16_f32 v251, v246, v247
buffer_store_dwordx4 v[248:251], v15, s[60:63], s100 offen offset:3072 sc1
v_accvgpr_read_b32 v240, a56
v_accvgpr_read_b32 v241, a57
v_accvgpr_read_b32 v242, a58
v_accvgpr_read_b32 v243, a59
v_accvgpr_read_b32 v244, a60
v_accvgpr_read_b32 v245, a61
v_accvgpr_read_b32 v246, a62
v_accvgpr_read_b32 v247, a63
v_mul_f32 v240, v240, v2
v_mul_f32 v241, v241, v2
v_mul_f32 v242, v242, v2
v_mul_f32 v243, v243, v2
v_mul_f32 v244, v244, v2
v_mul_f32 v245, v245, v2
v_mul_f32 v246, v246, v2
v_mul_f32 v247, v247, v2
v_cvt_pk_bf16_f32 v252, v240, v241
v_cvt_pk_bf16_f32 v253, v242, v243
v_cvt_pk_bf16_f32 v254, v244, v245
v_cvt_pk_bf16_f32 v255, v246, v247
buffer_store_dwordx4 v[252:255], v15, s[60:63], s100 offen offset:3584 sc1
s_waitcnt lgkmcnt(0)
ds_read_b128 a[160:163], v5 offset:3584
ds_read_b64 a[128:129], v4 offset:0
ds_read_b64 a[130:131], v4 offset:8
ds_read_b128 a[164:167], v5 offset:3072
ds_read_b64 a[132:133], v4 offset:512
ds_read_b64 a[134:135], v4 offset:520
ds_read_b128 a[168:171], v5 offset:2560
ds_read_b64 a[136:137], v4 offset:1024
ds_read_b64 a[138:139], v4 offset:1032
ds_read_b128 a[172:175], v5 offset:2048
ds_read_b64 a[140:141], v4 offset:1536
ds_read_b64 a[142:143], v4 offset:1544
ds_read_b128 a[176:179], v5 offset:1536
ds_read_b64 a[144:145], v4 offset:2048
ds_read_b64 a[146:147], v4 offset:2056
ds_read_b128 a[180:183], v5 offset:1024
ds_read_b64 a[148:149], v4 offset:2560
ds_read_b64 a[150:151], v4 offset:2568
ds_read_b128 a[184:187], v5 offset:512
ds_read_b64 a[152:153], v4 offset:3072
ds_read_b64 a[154:155], v4 offset:3080
ds_read_b128 a[188:191], v5 offset:0
ds_read_b64 a[156:157], v4 offset:3584
ds_read_b64 a[158:159], v4 offset:3592
v_lshlrev_b32 v255, 20, v1
s_lshl_b32 s36, s3, 26
v_add_u32 v255, s36, v255
s_waitcnt lgkmcnt(15)
v_mfma_f32_16x16x32_bf16 v[76:79], a[128:131], a[160:163], 0
ds_read_b128 a[224:227], v5 offset:3648
s_and_b32 s81, s2, 3
v_mfma_f32_16x16x32_bf16 v[80:83], a[128:131], a[164:167], 0
ds_read_b64 a[192:193], v4 offset:64
s_lshl_b32 s81, s81, 1
v_mfma_f32_16x16x32_bf16 v[84:87], a[128:131], a[168:171], 0
ds_read_b64 a[194:195], v4 offset:72
s_sub_u32 s74, 14, s81
s_waitcnt lgkmcnt(15)
v_mfma_f32_16x16x32_bf16 v[88:91], a[128:131], a[172:175], 0
ds_read_b128 a[228:231], v5 offset:3136
s_waitcnt lgkmcnt(15)
v_mfma_f32_16x16x32_bf16 v[92:95], a[128:131], a[176:179], 0
s_bitcmp1_b32 s2, 4
s_cselect_b32 s81, s74, s81
s_waitcnt lgkmcnt(12)
v_mfma_f32_16x16x32_bf16 v[96:99], a[128:131], a[180:183], 0
ds_read_b64 a[196:197], v4 offset:576
s_waitcnt lgkmcnt(10)
v_mfma_f32_16x16x32_bf16 v[100:103], a[128:131], a[184:187], 0
ds_read_b64 a[198:199], v4 offset:584
s_waitcnt lgkmcnt(8)
v_mfma_f32_16x16x32_bf16 v[104:107], a[128:131], a[188:191], 0
ds_read_b128 a[232:235], v5 offset:2624
s_bfe_u32 s74, s2, 0x10003
MV 76,v,44,a,160
ds_read_b64 a[200:201], v4 offset:1088
s_add_u32 s81, s81, s74
MV 80,v,44,a,164
MV 84,v,44,a,168
ds_read_b64 a[202:203], v4 offset:1096
s_bfe_u32 s82, s2, 0x10002
MV 88,v,44,a,172
ds_read_b128 a[236:239], v5 offset:2112
s_lshr_b32 s74, s2, 5
MV 92,v,44,a,176
ds_read_b64 a[204:205], v4 offset:1600
s_lshl_b32 s74, s74, 1
MV 96,v,44,a,180
ds_read_b64 a[206:207], v4 offset:1608
MV 100,v,44,a,184
s_add_u32 s82, s82, s74
MV 104,v,44,a,188
ds_read_b128 a[240:243], v5 offset:1600
s_mov_b32 s72, s81
MV 80,a,132,a,160
ds_read_b64 a[208:209], v4 offset:2112
MV 84,a,132,a,164
ds_read_b64 a[210:211], v4 offset:2120
s_mov_b32 s73, s82
MV 88,a,132,a,168
ds_read_b128 a[244:247], v5 offset:1088
s_lshl_b32 s74, s72, 2
MV 92,a,132,a,172
MV 96,a,132,a,176
ds_read_b64 a[212:213], v4 offset:2624
s_add_u32 s74, s74, s3
MV 100,a,132,a,180
ds_read_b64 a[214:215], v4 offset:2632
s_lshl_b32 s68, s74, 18
MV 104,a,132,a,184
ds_read_b128 a[248:251], v5 offset:576
s_and_b32 s80, s73, 1
MV 84,a,136,a,160
ds_read_b64 a[216:217], v4 offset:3136
MV 88,a,136,a,164
s_lshl_b32 s75, s80, 16
MV 92,a,136,a,168
ds_read_b64 a[218:219], v4 offset:3144
s_add_u32 s68, s68, s75
MV 96,a,136,a,172
ds_read_b128 a[252:255], v5 offset:64
MV 100,a,136,a,176
ds_read_b64 a[220:221], v4 offset:3648
s_lshl_b32 s69, s73, 19
MV 104,a,136,a,180
ds_read_b64 a[222:223], v4 offset:3656
s_lshl_b32 s75, s73, 7
MV 88,a,140,a,160
MV 92,a,140,a,164
s_lshl_b32 s70, s3, 12
MV 96,a,140,a,168
s_lshl_b32 s78, s74, 16
MV 100,a,140,a,172
s_add_u32 s78, s78, s75
MV 104,a,140,a,176
MV 92,a,144,a,160
s_lshl_b32 s79, s73, 18
MV 96,a,144,a,164
s_lshl_b32 s75, s74, 8
MV 100,a,144,a,168
MV 104,a,144,a,172
s_add_u32 s79, s79, s75
MV 96,a,148,a,160
v_lshlrev_b32 v236, 4, v1
MV 100,a,148,a,164
MV 104,a,148,a,168
v_add_u32 v237, 0x20000, v236
MV 100,a,152,a,160
v_add_u32 v238, s70, v236
MV 104,a,152,a,164
s_waitcnt lgkmcnt(15)
MV 104,a,156,a,160
s_waitcnt vmcnt(0)
s_barrier
v_mov_b32 v253, 1
s_lshl_b32 s36, s2, 2
buffer_store_dword v253, v255, s[8:11], s36 offen offset:2048 sc1
MV 76,a,192,a,224
ds_read_b128 a[160:163], v5 offset:3712
s_lshl_b32 s75, s80, 12
MV 80,a,192,a,228
ds_read_b64 a[128:129], v4 offset:128
v_add_u32 v244, s75, v236
MV 84,a,192,a,232
ds_read_b64 a[130:131], v4 offset:136
v_xor_b32 v245, 0x1000, v244
s_waitcnt lgkmcnt(15)
MV 88,a,192,a,236
ds_read_b128 a[164:167], v5 offset:3200
v_add_u32 v242, 66560, v244
s_waitcnt lgkmcnt(15)
MV 92,a,192,a,240
v_add_u32 v243, 66560, v245
s_waitcnt lgkmcnt(12)
MV 96,a,192,a,244
ds_read_b64 a[132:133], v4 offset:640
v_bfe_u32 v38, v1, 4, 1
s_waitcnt lgkmcnt(10)
MV 100,a,192,a,248
ds_read_b64 a[134:135], v4 offset:648
v_lshrrev_b32 v40, 5, v1
s_waitcnt lgkmcnt(8)
MV 104,a,192,a,252
ds_read_b128 a[168:171], v5 offset:2688
v_and_b32 v36, 15, v1
MV 80,a,196,a,224
ds_read_b64 a[136:137], v4 offset:1152
v_lshlrev_b32 v41, 5, v38
MV 84,a,196,a,228
v_lshl_add_u32 v41, v40, 4, v41
MV 88,a,196,a,232
ds_read_b64 a[138:139], v4 offset:1160
v_lshl_add_u32 v250, v36, 11, v41
MV 92,a,196,a,236
ds_read_b128 a[172:175], v5 offset:2176
v_lshlrev_b32 v41, 11, v41
MV 96,a,196,a,240
ds_read_b64 a[140:141], v4 offset:1664
v_lshl_add_u32 v251, v36, 3, v41
MV 100,a,196,a,244
ds_read_b64 a[142:143], v4 offset:1672
MV 104,a,196,a,248
s_add_u32 s44, s40, 33554432
s_addc_u32 s45, s41, 0
MV 84,a,200,a,224
ds_read_b128 a[176:179], v5 offset:1664
s_mov_b32 s46, 16777216
MV 88,a,200,a,228
ds_read_b64 a[144:145], v4 offset:2176
s_mov_b32 s47, 0x20000
MV 92,a,200,a,232
ds_read_b64 a[146:147], v4 offset:2184
MV 96,a,200,a,236
ds_read_b128 a[180:183], v5 offset:1152
MV 100,a,200,a,240
s_add_u32 s48, s40, 100663296
s_addc_u32 s49, s41, 0
MV 104,a,200,a,244
ds_read_b64 a[148:149], v4 offset:2688
s_mov_b32 s50, 8388608
MV 88,a,204,a,224
ds_read_b64 a[150:151], v4 offset:2696
s_mov_b32 s51, 0x20000
MV 92,a,204,a,228
ds_read_b128 a[184:187], v5 offset:640
MV 96,a,204,a,232
ds_read_b64 a[152:153], v4 offset:3200
MV 100,a,204,a,236
s_add_u32 s52, s40, 109051904
s_addc_u32 s53, s41, 0
MV 104,a,204,a,240
ds_read_b64 a[154:155], v4 offset:3208
s_mov_b32 s54, 4194304
MV 92,a,208,a,224
ds_read_b128 a[188:191], v5 offset:128
s_mov_b32 s55, 0x20000
MV 96,a,208,a,228
ds_read_b64 a[156:157], v4 offset:3712
MV 100,a,208,a,232
ds_read_b64 a[158:159], v4 offset:3720
MV 104,a,208,a,236
s_add_u32 s56, s40, 54525952
s_addc_u32 s57, s41, 0
MV 96,a,212,a,224
s_mov_b32 s58, 4194304
s_mov_b32 s59, 0x20000
MV 100,a,212,a,228
s_mov_b32 s60, s88
s_mov_b32 s61, s89
MV 104,a,212,a,232
s_mov_b32 s62, 4194304
MV 100,a,216,a,224
s_mov_b32 s63, 0x20000
MV 104,a,216,a,228
s_waitcnt lgkmcnt(15)
MV 104,a,220,a,224
MV 76,a,128,a,160
ds_read_b128 a[224:227], v5 offset:3776
s_sub_u32 s36, 15, s81
MV 80,a,128,a,164
ds_read_b64 a[192:193], v4 offset:192
s_min_u32 s36, s36, s81
MV 84,a,128,a,168
ds_read_b64 a[194:195], v4 offset:200
s_lshl_b32 s36, s36, 5
s_waitcnt lgkmcnt(15)
MV 88,a,128,a,172
ds_read_b128 a[228:231], v5 offset:3264
s_waitcnt lgkmcnt(15)
MV 92,a,128,a,176
s_lshl_b32 s37, s80, 2
s_waitcnt lgkmcnt(12)
MV 96,a,128,a,180
ds_read_b64 a[196:197], v4 offset:704
s_add_u32 s36, s36, s37
s_waitcnt lgkmcnt(10)
MV 100,a,128,a,184
ds_read_b64 a[198:199], v4 offset:712
s_add_u32 s36, s36, 256
s_waitcnt lgkmcnt(8)
MV 104,a,128,a,188
ds_read_b128 a[232:235], v5 offset:2752
MV 80,a,132,a,160
ds_read_b64 a[200:201], v4 offset:1216
v_and_b32 v254, 3, v1
MV 84,a,132,a,164
v_lshlrev_b32 v254, 3, v254
MV 88,a,132,a,168
ds_read_b64 a[202:203], v4 offset:1224
v_bfe_u32 v253, v1, 2, 2
MV 92,a,132,a,172
ds_read_b128 a[236:239], v5 offset:2240
MV 96,a,132,a,176
ds_read_b64 a[204:205], v4 offset:1728
v_add3_u32 v254, v254, v253, s36
MV 100,a,132,a,180
ds_read_b64 a[206:207], v4 offset:1736
s_lshr_b32 s36, s82, 1
MV 104,a,132,a,184
s_lshl_b32 s37, s80, 7
MV 84,a,136,a,160
ds_read_b128 a[240:243], v5 offset:1728
MV 88,a,136,a,164
ds_read_b64 a[208:209], v4 offset:2240
s_add_u32 s36, s36, s37
MV 92,a,136,a,168
ds_read_b64 a[210:211], v4 offset:2248
v_and_b32 v253, 15, v1
MV 96,a,136,a,172
ds_read_b128 a[244:247], v5 offset:1216
v_lshl_add_u32 v253, v253, 3, s36
MV 100,a,136,a,176
MV 104,a,136,a,180
ds_read_b64 a[212:213], v4 offset:2752
s_xor_b32 s36, s2, 4
MV 88,a,140,a,160
ds_read_b64 a[214:215], v4 offset:2760
v_mov_b32 v228, s36
MV 92,a,140,a,164
ds_read_b128 a[248:251], v5 offset:704
MV 96,a,140,a,168
ds_read_b64 a[216:217], v4 offset:3264
MV 100,a,140,a,172
v_cmp_lt_u32 vcc, 15, v1
s_nop 1
v_cndmask_b32 v254, v254, v228, vcc
MV 104,a,140,a,176
ds_read_b64 a[218:219], v4 offset:3272
MV 92,a,144,a,160
ds_read_b128 a[252:255], v5 offset:192
MV 96,a,144,a,164
ds_read_b64 a[220:221], v4 offset:3776
MV 100,a,144,a,168
ds_read_b64 a[222:223], v4 offset:3784
MV 104,a,144,a,172
v_cmp_lt_u32 vcc, 31, v1
s_nop 1
v_cndmask_b32 v254, v254, v253, vcc
MV 96,a,148,a,160
MV 100,a,148,a,164
MV 104,a,148,a,168
MV 100,a,152,a,160
v_lshlrev_b32 v254, 2, v254
MV 104,a,152,a,164
s_waitcnt lgkmcnt(15)
MV 104,a,156,a,160
MV 76,a,192,a,224
ds_read_b128 a[160:163], v5 offset:3840
MV 80,a,192,a,228
ds_read_b64 a[128:129], v4 offset:256
MV 84,a,192,a,232
ds_read_b64 a[130:131], v4 offset:264
s_waitcnt lgkmcnt(15)
MV 88,a,192,a,236
ds_read_b128 a[164:167], v5 offset:3328
s_waitcnt lgkmcnt(15)
MV 92,a,192,a,240
s_waitcnt lgkmcnt(12)
MV 96,a,192,a,244
ds_read_b64 a[132:133], v4 offset:768
s_waitcnt lgkmcnt(10)
MV 100,a,192,a,248
ds_read_b64 a[134:135], v4 offset:776
s_waitcnt lgkmcnt(8)
MV 104,a,192,a,252
ds_read_b128 a[168:171], v5 offset:2816
MV 80,a,196,a,224
ds_read_b64 a[136:137], v4 offset:1280
MV 84,a,196,a,228
MV 88,a,196,a,232
ds_read_b64 a[138:139], v4 offset:1288
MV 92,a,196,a,236
ds_read_b128 a[172:175], v5 offset:2304
MV 96,a,196,a,240
ds_read_b64 a[140:141], v4 offset:1792
MV 100,a,196,a,244
ds_read_b64 a[142:143], v4 offset:1800
MV 104,a,196,a,248
MV 84,a,200,a,224
ds_read_b128 a[176:179], v5 offset:1792
MV 88,a,200,a,228
ds_read_b64 a[144:145], v4 offset:2304
MV 92,a,200,a,232
ds_read_b64 a[146:147], v4 offset:2312
MV 96,a,200,a,236
ds_read_b128 a[180:183], v5 offset:1280
MV 100,a,200,a,240
MV 104,a,200,a,244
ds_read_b64 a[148:149], v4 offset:2816
MV 88,a,204,a,224
ds_read_b64 a[150:151], v4 offset:2824
MV 92,a,204,a,228
ds_read_b128 a[184:187], v5 offset:768
MV 96,a,204,a,232
ds_read_b64 a[152:153], v4 offset:3328
MV 100,a,204,a,236
MV 104,a,204,a,240
ds_read_b64 a[154:155], v4 offset:3336
MV 92,a,208,a,224
ds_read_b128 a[188:191], v5 offset:256
MV 96,a,208,a,228
ds_read_b64 a[156:157], v4 offset:3840
MV 100,a,208,a,232
ds_read_b64 a[158:159], v4 offset:3848
MV 104,a,208,a,236
MV 96,a,212,a,224
MV 100,a,212,a,228
MV 104,a,212,a,232
MV 100,a,216,a,224
MV 104,a,216,a,228
s_waitcnt lgkmcnt(15)
MV 104,a,220,a,224
MV 76,a,128,a,160
ds_read_b128 a[224:227], v5 offset:3904
MV 80,a,128,a,164
ds_read_b64 a[192:193], v4 offset:320
MV 84,a,128,a,168
ds_read_b64 a[194:195], v4 offset:328
s_waitcnt lgkmcnt(15)
MV 88,a,128,a,172
ds_read_b128 a[228:231], v5 offset:3392
s_waitcnt lgkmcnt(15)
MV 92,a,128,a,176
s_waitcnt lgkmcnt(12)
MV 96,a,128,a,180
ds_read_b64 a[196:197], v4 offset:832
s_waitcnt lgkmcnt(10)
MV 100,a,128,a,184
ds_read_b64 a[198:199], v4 offset:840
s_waitcnt lgkmcnt(8)
MV 104,a,128,a,188
ds_read_b128 a[232:235], v5 offset:2880
MV 80,a,132,a,160
ds_read_b64 a[200:201], v4 offset:1344
MV 84,a,132,a,164
MV 88,a,132,a,168
ds_read_b64 a[202:203], v4 offset:1352
MV 92,a,132,a,172
ds_read_b128 a[236:239], v5 offset:2368
MV 96,a,132,a,176
ds_read_b64 a[204:205], v4 offset:1856
MV 100,a,132,a,180
ds_read_b64 a[206:207], v4 offset:1864
MV 104,a,132,a,184
MV 84,a,136,a,160
ds_read_b128 a[240:243], v5 offset:1856
MV 88,a,136,a,164
ds_read_b64 a[208:209], v4 offset:2368
MV 92,a,136,a,168
ds_read_b64 a[210:211], v4 offset:2376
MV 96,a,136,a,172
ds_read_b128 a[244:247], v5 offset:1344
MV 100,a,136,a,176
MV 104,a,136,a,180
ds_read_b64 a[212:213], v4 offset:2880
MV 88,a,140,a,160
ds_read_b64 a[214:215], v4 offset:2888
MV 92,a,140,a,164
ds_read_b128 a[248:251], v5 offset:832
MV 96,a,140,a,168
ds_read_b64 a[216:217], v4 offset:3392
MV 100,a,140,a,172
MV 104,a,140,a,176
ds_read_b64 a[218:219], v4 offset:3400
MV 92,a,144,a,160
ds_read_b128 a[252:255], v5 offset:320
MV 96,a,144,a,164
ds_read_b64 a[220:221], v4 offset:3904
MV 100,a,144,a,168
ds_read_b64 a[222:223], v4 offset:3912
MV 104,a,144,a,172
MV 96,a,148,a,160
MV 100,a,148,a,164
MV 104,a,148,a,168
MV 100,a,152,a,160
MV 104,a,152,a,164
s_waitcnt lgkmcnt(15)
MV 104,a,156,a,160
MV 76,a,192,a,224
ds_read_b128 a[160:163], v5 offset:3968
MV 80,a,192,a,228
ds_read_b64 a[128:129], v4 offset:384
MV 84,a,192,a,232
ds_read_b64 a[130:131], v4 offset:392
s_waitcnt lgkmcnt(15)
MV 88,a,192,a,236
ds_read_b128 a[164:167], v5 offset:3456
s_waitcnt lgkmcnt(15)
MV 92,a,192,a,240
s_waitcnt lgkmcnt(12)
MV 96,a,192,a,244
ds_read_b64 a[132:133], v4 offset:896
s_waitcnt lgkmcnt(10)
MV 100,a,192,a,248
ds_read_b64 a[134:135], v4 offset:904
s_waitcnt lgkmcnt(8)
MV 104,a,192,a,252
ds_read_b128 a[168:171], v5 offset:2944
MV 80,a,196,a,224
ds_read_b64 a[136:137], v4 offset:1408
MV 84,a,196,a,228
MV 88,a,196,a,232
ds_read_b64 a[138:139], v4 offset:1416
MV 92,a,196,a,236
ds_read_b128 a[172:175], v5 offset:2432
MV 96,a,196,a,240
ds_read_b64 a[140:141], v4 offset:1920
MV 100,a,196,a,244
ds_read_b64 a[142:143], v4 offset:1928
MV 104,a,196,a,248
MV 84,a,200,a,224
ds_read_b128 a[176:179], v5 offset:1920
MV 88,a,200,a,228
ds_read_b64 a[144:145], v4 offset:2432
MV 92,a,200,a,232
ds_read_b64 a[146:147], v4 offset:2440
MV 96,a,200,a,236
ds_read_b128 a[180:183], v5 offset:1408
MV 100,a,200,a,240
MV 104,a,200,a,244
ds_read_b64 a[148:149], v4 offset:2944
MV 88,a,204,a,224
ds_read_b64 a[150:151], v4 offset:2952
MV 92,a,204,a,228
ds_read_b128 a[184:187], v5 offset:896
MV 96,a,204,a,232
ds_read_b64 a[152:153], v4 offset:3456
MV 100,a,204,a,236
MV 104,a,204,a,240
ds_read_b64 a[154:155], v4 offset:3464
MV 92,a,208,a,224
ds_read_b128 a[188:191], v5 offset:384
MV 96,a,208,a,228
ds_read_b64 a[156:157], v4 offset:3968
MV 100,a,208,a,232
ds_read_b64 a[158:159], v4 offset:3976
MV 104,a,208,a,236
MV 96,a,212,a,224
MV 100,a,212,a,228
MV 104,a,212,a,232
MV 100,a,216,a,224
MV 104,a,216,a,228
s_waitcnt lgkmcnt(15)
MV 104,a,220,a,224
MV 76,a,128,a,160
ds_read_b128 a[224:227], v5 offset:4032
MV 80,a,128,a,164
ds_read_b64 a[192:193], v4 offset:448
MV 84,a,128,a,168
ds_read_b64 a[194:195], v4 offset:456
s_waitcnt lgkmcnt(15)
MV 88,a,128,a,172
ds_read_b128 a[228:231], v5 offset:3520
s_waitcnt lgkmcnt(15)
MV 92,a,128,a,176
s_waitcnt lgkmcnt(12)
MV 96,a,128,a,180
ds_read_b64 a[196:197], v4 offset:960
s_waitcnt lgkmcnt(10)
MV 100,a,128,a,184
ds_read_b64 a[198:199], v4 offset:968
s_waitcnt lgkmcnt(8)
MV 104,a,128,a,188
ds_read_b128 a[232:235], v5 offset:3008
MV 80,a,132,a,160
ds_read_b64 a[200:201], v4 offset:1472
MV 84,a,132,a,164
MV 88,a,132,a,168
ds_read_b64 a[202:203], v4 offset:1480
MV 92,a,132,a,172
ds_read_b128 a[236:239], v5 offset:2496
MV 96,a,132,a,176
ds_read_b64 a[204:205], v4 offset:1984
MV 100,a,132,a,180
ds_read_b64 a[206:207], v4 offset:1992
MV 104,a,132,a,184
MV 84,a,136,a,160
ds_read_b128 a[240:243], v5 offset:1984
MV 88,a,136,a,164
ds_read_b64 a[208:209], v4 offset:2496
MV 92,a,136,a,168
ds_read_b64 a[210:211], v4 offset:2504
MV 96,a,136,a,172
ds_read_b128 a[244:247], v5 offset:1472
MV 100,a,136,a,176
MV 104,a,136,a,180
ds_read_b64 a[212:213], v4 offset:3008
MV 88,a,140,a,160
ds_read_b64 a[214:215], v4 offset:3016
MV 92,a,140,a,164
ds_read_b128 a[248:251], v5 offset:960
MV 96,a,140,a,168
ds_read_b64 a[216:217], v4 offset:3520
MV 100,a,140,a,172
MV 104,a,140,a,176
ds_read_b64 a[218:219], v4 offset:3528
MV 92,a,144,a,160
ds_read_b128 a[252:255], v5 offset:448
MV 96,a,144,a,164
ds_read_b64 a[220:221], v4 offset:4032
MV 100,a,144,a,168
ds_read_b64 a[222:223], v4 offset:4040
MV 104,a,144,a,172
MV 96,a,148,a,160
MV 100,a,148,a,164
MV 104,a,148,a,168
MV 100,a,152,a,160
MV 104,a,152,a,164
s_waitcnt lgkmcnt(15)
MV 104,a,156,a,160
buffer_load_dword v253, v254, s[8:11], 0 offen offset:1024 sc1
s_waitcnt vmcnt(0)
v_cmp_gt_u32 vcc, 1, v253
s_nop 4
s_cbranch_vccnz L_spin_f2
L_spin_f2_ret:
s_add_u32 m0, s70, 66560
s_nop 0
buffer_load_dwordx4 v238, s[48:51], s69 offen offset:0 sc1 lds
buffer_load_dwordx4 v238, s[48:51], s69 offen offset:1024 sc1 lds
buffer_load_dwordx4 v238, s[48:51], s69 offen offset:2048 sc1 lds
buffer_load_dwordx4 v238, s[48:51], s69 offen offset:3072 sc1 lds
s_add_u32 s69, s69, 16384
buffer_load_dwordx4 a[0:3], v236, s[44:47], s68 offen offset:0 sc1
buffer_load_dwordx4 a[4:7], v237, s[44:47], s68 offen offset:0 sc1
buffer_load_dwordx4 a[8:11], v236, s[44:47], s68 offen offset:1024 sc1
buffer_load_dwordx4 a[12:15], v237, s[44:47], s68 offen offset:1024 sc1
s_add_u32 s68, s68, 2048
MV 76,a,192,a,224
s_add_u32 m0, s70, 82944
MV 80,a,192,a,228
MV 84,a,192,a,232
s_waitcnt lgkmcnt(14)
MV 88,a,192,a,236
buffer_load_dwordx4 v238, s[48:51], s69 offen offset:0 sc1 lds
s_waitcnt lgkmcnt(11)
MV 92,a,192,a,240
s_waitcnt lgkmcnt(8)
MV 96,a,192,a,244
s_waitcnt lgkmcnt(5)
MV 100,a,192,a,248
buffer_load_dwordx4 v238, s[48:51], s69 offen offset:1024 sc1 lds
s_waitcnt lgkmcnt(2)
MV 104,a,192,a,252
MV 80,a,196,a,224
MV 84,a,196,a,228
buffer_load_dwordx4 v238, s[48:51], s69 offen offset:2048 sc1 lds
MV 88,a,196,a,232
MV 92,a,196,a,236
MV 96,a,196,a,240
buffer_load_dwordx4 v238, s[48:51], s69 offen offset:3072 sc1 lds
MV 100,a,196,a,244
MV 104,a,196,a,248
MV 84,a,200,a,224
s_add_u32 s69, s69, 16384
MV 88,a,200,a,228
MV 92,a,200,a,232
MV 96,a,200,a,236
MV 100,a,200,a,240
buffer_load_dwordx4 a[16:19], v236, s[44:47], s68 offen offset:0 sc1
MV 104,a,200,a,244
MV 88,a,204,a,224
MV 92,a,204,a,228
buffer_load_dwordx4 a[20:23], v237, s[44:47], s68 offen offset:0 sc1
MV 96,a,204,a,232
MV 100,a,204,a,236
MV 104,a,204,a,240
buffer_load_dwordx4 a[24:27], v236, s[44:47], s68 offen offset:1024 sc1
MV 92,a,208,a,224
MV 96,a,208,a,228
MV 100,a,208,a,232
buffer_load_dwordx4 a[28:31], v237, s[44:47], s68 offen offset:1024 sc1
MV 104,a,208,a,236
MV 96,a,212,a,224
MV 100,a,212,a,228
s_add_u32 s68, s68, 2048
MV 104,a,212,a,232
MV 100,a,216,a,224
MV 104,a,216,a,228
s_waitcnt lgkmcnt(0)
MV 104,a,220,a,224
s_waitcnt vmcnt(12) lgkmcnt(0)
s_barrier
ds_read_b128 a[128:131], v242 offset:0
ds_read_b128 a[132:135], v242 offset:1024
ds_read_b128 a[136:139], v242 offset:2048
ds_read_b128 a[140:143], v242 offset:3072
ds_read_b128 a[144:147], v243 offset:0
ds_read_b128 a[148:151], v243 offset:1024
ds_read_b128 a[152:155], v243 offset:2048
ds_read_b128 a[156:159], v243 offset:3072
s_waitcnt vmcnt(11) lgkmcnt(7)
v_mfma_f32_16x16x32_bf16 v[124:127], a[128:131], a[0:3], 0
s_add_u32 m0, s70, 99328
s_nop 0
buffer_load_dwordx4 v238, s[48:51], s69 offen offset:0 sc1 lds
s_waitcnt vmcnt(11)
v_mfma_f32_16x16x32_bf16 v[128:131], a[128:131], a[4:7], 0
buffer_load_dwordx4 v238, s[48:51], s69 offen offset:1024 sc1 lds
ds_read_b128 a[160:163], v242 offset:8192
s_waitcnt lgkmcnt(7)
v_mfma_f32_16x16x32_bf16 v[132:135], a[132:135], a[0:3], 0
buffer_load_dwordx4 v238, s[48:51], s69 offen offset:2048 sc1 lds
buffer_load_dwordx4 v238, s[48:51], s69 offen offset:3072 sc1 lds
v_mfma_f32_16x16x32_bf16 v[136:139], a[132:135], a[4:7], 0
s_add_u32 s69, s69, 16384
ds_read_b128 a[164:167], v242 offset:9216
s_waitcnt lgkmcnt(7)
v_mfma_f32_16x16x32_bf16 v[140:143], a[136:139], a[0:3], 0
buffer_load_dwordx4 a[32:35], v236, s[44:47], s68 offen offset:0 sc1
ds_read_b128 a[168:171], v242 offset:10240
v_mfma_f32_16x16x32_bf16 v[144:147], a[136:139], a[4:7], 0
buffer_load_dwordx4 a[36:39], v237, s[44:47], s68 offen offset:0 sc1
buffer_load_dwordx4 a[40:43], v236, s[44:47], s68 offen offset:1024 sc1
s_waitcnt lgkmcnt(7)
v_mfma_f32_16x16x32_bf16 v[148:151], a[140:143], a[0:3], 0
buffer_load_dwordx4 a[44:47], v237, s[44:47], s68 offen offset:1024 sc1
ds_read_b128 a[172:175], v242 offset:11264
v_mfma_f32_16x16x32_bf16 v[152:155], a[140:143], a[4:7], 0
s_add_u32 s68, s68, 2048
ds_read_b128 a[176:179], v243 offset:8192
s_waitcnt lgkmcnt(8)
v_mfma_f32_16x16x32_bf16 v[156:159], a[144:147], a[0:3], 0
buffer_load_dwordx4 a[48:51], v236, s[44:47], s68 offen offset:0 sc1
buffer_load_dwordx4 a[52:55], v237, s[44:47], s68 offen offset:0 sc1
v_mfma_f32_16x16x32_bf16 v[160:163], a[144:147], a[4:7], 0
buffer_load_dwordx4 a[56:59], v236, s[44:47], s68 offen offset:1024 sc1
ds_read_b128 a[180:183], v243 offset:9216
s_waitcnt lgkmcnt(8)
v_mfma_f32_16x16x32_bf16 v[164:167], a[148:151], a[0:3], 0
buffer_load_dwordx4 a[60:63], v237, s[44:47], s68 offen offset:1024 sc1
ds_read_b128 a[184:187], v243 offset:10240
v_mfma_f32_16x16x32_bf16 v[168:171], a[148:151], a[4:7], 0
s_add_u32 s68, s68, 2048
s_add_u32 m0, s70, 115712
s_waitcnt lgkmcnt(8)
v_mfma_f32_16x16x32_bf16 v[172:175], a[152:155], a[0:3], 0
buffer_load_dwordx4 v238, s[48:51], s69 offen offset:0 sc1 lds
ds_read_b128 a[188:191], v243 offset:11264
v_mfma_f32_16x16x32_bf16 v[176:179], a[152:155], a[4:7], 0
buffer_load_dwordx4 v238, s[48:51], s69 offen offset:1024 sc1 lds
v_cvt_pk_bf16_f32 v16, v76, v77
s_waitcnt lgkmcnt(8)
v_mfma_f32_16x16x32_bf16 v[180:183], a[156:159], a[0:3], 0
buffer_load_dwordx4 a[0:3], v236, s[44:47], s68 offen offset:0 sc1
v_cvt_pk_bf16_f32 v17, v78, v79
v_mfma_f32_16x16x32_bf16 v[184:187], a[156:159], a[4:7], 0
buffer_load_dwordx4 a[4:7], v237, s[44:47], s68 offen offset:0 sc1
ds_write_b16 v7, v16 offset:0
ds_write_b16_d16_hi v7, v16 offset:8
ds_write_b16 v7, v17 offset:16
ds_write_b16_d16_hi v7, v17 offset:24
v_cvt_pk_bf16_f32 v18, v80, v81
v_cvt_pk_bf16_f32 v19, v82, v83
ds_write_b16 v7, v18 offset:2176
s_waitcnt vmcnt(20) lgkmcnt(0)
s_barrier
MV 124,a,160,a,8
ds_read_b128 a[128:131], v242 offset:16384
ds_write_b16_d16_hi v7, v18 offset:2184
MV 128,a,160,a,12
ds_read_b128 a[132:135], v242 offset:17408
buffer_load_dwordx4 v238, s[48:51], s69 offen offset:2048 sc1 lds
MV 132,a,164,a,8
ds_write_b16 v7, v19 offset:2192
MV 136,a,164,a,12
ds_read_b128 a[136:139], v242 offset:18432
ds_write_b16_d16_hi v7, v19 offset:2200
MV 140,a,168,a,8
ds_read_b128 a[140:143], v242 offset:19456
v_cvt_pk_bf16_f32 v16, v84, v85
MV 144,a,168,a,12
buffer_load_dwordx4 v238, s[48:51], s69 offen offset:3072 sc1 lds
MV 148,a,172,a,8
ds_read_b128 a[144:147], v243 offset:16384
v_cvt_pk_bf16_f32 v17, v86, v87
MV 152,a,172,a,12
ds_read_b128 a[148:151], v243 offset:17408
MV 156,a,176,a,8
ds_write_b16 v7, v16 offset:4352
MV 160,a,176,a,12
ds_read_b128 a[152:155], v243 offset:18432
s_add_u32 s69, s69, 16384
MV 164,a,180,a,8
ds_read_b128 a[156:159], v243 offset:19456
ds_write_b16_d16_hi v7, v16 offset:4360
MV 168,a,180,a,12
ds_write_b16 v7, v17 offset:4368
MV 172,a,184,a,8
ds_write_b16_d16_hi v7, v17 offset:4376
MV 176,a,184,a,12
MV 180,a,188,a,8
buffer_load_dwordx4 a[8:11], v236, s[44:47], s68 offen offset:1024 sc1
v_cvt_pk_bf16_f32 v18, v88, v89
MV 184,a,188,a,12
buffer_load_dwordx4 a[12:15], v237, s[44:47], s68 offen offset:1024 sc1
s_add_u32 s68, s68, 2048
s_waitcnt vmcnt(23) lgkmcnt(14)
MV 124,a,128,a,16
ds_read_b128 a[160:163], v242 offset:24576
v_cvt_pk_bf16_f32 v19, v90, v91
s_waitcnt vmcnt(22)
MV 128,a,128,a,20
ds_read_b128 a[164:167], v242 offset:25600
s_add_u32 m0, s70, 66560
s_waitcnt lgkmcnt(14)
MV 132,a,132,a,16
ds_write_b16 v7, v18 offset:6528
MV 136,a,132,a,20
ds_read_b128 a[168:171], v242 offset:26624
ds_write_b16_d16_hi v7, v18 offset:6536
s_waitcnt lgkmcnt(15)
MV 140,a,136,a,16
ds_read_b128 a[172:175], v242 offset:27648
MV 144,a,136,a,20
buffer_load_dwordx4 v238, s[48:51], s69 offen offset:0 sc1 lds
ds_write_b16 v7, v19 offset:6544
s_waitcnt lgkmcnt(15)
MV 148,a,140,a,16
ds_read_b128 a[176:179], v243 offset:24576
MV 152,a,140,a,20
ds_read_b128 a[180:183], v243 offset:25600
ds_write_b16_d16_hi v7, v19 offset:6552
s_waitcnt lgkmcnt(15)
MV 156,a,144,a,16
v_cvt_pk_bf16_f32 v16, v92, v93
MV 160,a,144,a,20
ds_read_b128 a[184:187], v243 offset:26624
buffer_load_dwordx4 v238, s[48:51], s69 offen offset:1024 sc1 lds
MV 164,a,148,a,16
ds_read_b128 a[188:191], v243 offset:27648
v_cvt_pk_bf16_f32 v17, v94, v95
MV 168,a,148,a,20
s_waitcnt lgkmcnt(15)
MV 172,a,152,a,16
ds_write_b16 v7, v16 offset:8704
MV 176,a,152,a,20
MV 180,a,156,a,16
buffer_load_dwordx4 a[16:19], v236, s[44:47], s68 offen offset:0 sc1
ds_write_b16_d16_hi v7, v16 offset:8712
MV 184,a,156,a,20
buffer_load_dwordx4 a[20:23], v237, s[44:47], s68 offen offset:0 sc1
s_waitcnt vmcnt(20) lgkmcnt(0)
s_barrier
MV 124,a,160,a,24
ds_read_b128 a[128:131], v242 offset:32768
ds_write_b16 v7, v17 offset:8720
MV 128,a,160,a,28
ds_read_b128 a[132:135], v242 offset:33792
buffer_load_dwordx4 v238, s[48:51], s69 offen offset:2048 sc1 lds
MV 132,a,164,a,24
ds_write_b16_d16_hi v7, v17 offset:8728
MV 136,a,164,a,28
ds_read_b128 a[136:139], v242 offset:34816
v_cvt_pk_bf16_f32 v18, v96, v97
MV 140,a,168,a,24
ds_read_b128 a[140:143], v242 offset:35840
v_cvt_pk_bf16_f32 v19, v98, v99
MV 144,a,168,a,28
buffer_load_dwordx4 v238, s[48:51], s69 offen offset:3072 sc1 lds
MV 148,a,172,a,24
ds_read_b128 a[144:147], v243 offset:32768
ds_write_b16 v7, v18 offset:10880
MV 152,a,172,a,28
ds_read_b128 a[148:151], v243 offset:33792
MV 156,a,176,a,24
ds_write_b16_d16_hi v7, v18 offset:10888
MV 160,a,176,a,28
ds_read_b128 a[152:155], v243 offset:34816
s_add_u32 s69, s69, 16384
MV 164,a,180,a,24
ds_read_b128 a[156:159], v243 offset:35840
ds_write_b16 v7, v19 offset:10896
MV 168,a,180,a,28
ds_write_b16_d16_hi v7, v19 offset:10904
MV 172,a,184,a,24
v_cvt_pk_bf16_f32 v16, v100, v101
MV 176,a,184,a,28
MV 180,a,188,a,24
buffer_load_dwordx4 a[24:27], v236, s[44:47], s68 offen offset:1024 sc1
v_cvt_pk_bf16_f32 v17, v102, v103
MV 184,a,188,a,28
buffer_load_dwordx4 a[28:31], v237, s[44:47], s68 offen offset:1024 sc1
s_add_u32 s68, s68, 2048
s_waitcnt vmcnt(23) lgkmcnt(13)
MV 124,a,128,a,32
ds_read_b128 a[160:163], v242 offset:40960
ds_write_b16 v7, v16 offset:13056
s_waitcnt vmcnt(22)
MV 128,a,128,a,36
ds_read_b128 a[164:167], v242 offset:41984
s_add_u32 m0, s70, 82944
s_waitcnt lgkmcnt(14)
MV 132,a,132,a,32
ds_write_b16_d16_hi v7, v16 offset:13064
MV 136,a,132,a,36
ds_read_b128 a[168:171], v242 offset:43008
ds_write_b16 v7, v17 offset:13072
s_waitcnt lgkmcnt(15)
MV 140,a,136,a,32
ds_read_b128 a[172:175], v242 offset:44032
ds_write_b16_d16_hi v7, v17 offset:13080
MV 144,a,136,a,36
buffer_load_dwordx4 v238, s[48:51], s69 offen offset:0 sc1 lds
s_waitcnt lgkmcnt(15)
MV 148,a,140,a,32
ds_read_b128 a[176:179], v243 offset:40960
v_cvt_pk_bf16_f32 v18, v104, v105
MV 152,a,140,a,36
ds_read_b128 a[180:183], v243 offset:41984
MV 156,a,144,a,32
v_cvt_pk_bf16_f32 v19, v106, v107
MV 160,a,144,a,36
ds_read_b128 a[184:187], v243 offset:43008
buffer_load_dwordx4 v238, s[48:51], s69 offen offset:1024 sc1 lds
s_waitcnt lgkmcnt(15)
MV 164,a,148,a,32
ds_read_b128 a[188:191], v243 offset:44032
ds_write_b16 v7, v18 offset:15232
MV 168,a,148,a,36
ds_write_b16_d16_hi v7, v18 offset:15240
s_waitcnt lgkmcnt(15)
MV 172,a,152,a,32
ds_write_b16 v7, v19 offset:15248
MV 176,a,152,a,36
MV 180,a,156,a,32
buffer_load_dwordx4 a[32:35], v236, s[44:47], s68 offen offset:0 sc1
ds_write_b16_d16_hi v7, v19 offset:15256
MV 184,a,156,a,36
buffer_load_dwordx4 a[36:39], v237, s[44:47], s68 offen offset:0 sc1
s_waitcnt vmcnt(14) lgkmcnt(0)
s_barrier
MV 124,a,160,a,40
ds_read_b128 a[128:131], v242 offset:49152
ds_read_b64 v[108:109], v8 offset:0
MV 128,a,160,a,44
ds_read_b128 a[132:135], v242 offset:50176
buffer_load_dwordx4 v238, s[48:51], s69 offen offset:2048 sc1 lds
MV 132,a,164,a,40
ds_read_b64 v[110:111], v8 offset:8
MV 136,a,164,a,44
ds_read_b128 a[136:139], v242 offset:51200
MV 140,a,168,a,40
ds_read_b128 a[140:143], v242 offset:52224
ds_read_b64 v[112:113], v8 offset:1088
MV 144,a,168,a,44
buffer_load_dwordx4 v238, s[48:51], s69 offen offset:3072 sc1 lds
MV 148,a,172,a,40
ds_read_b128 a[144:147], v243 offset:49152
ds_read_b64 v[114:115], v8 offset:1096
MV 152,a,172,a,44
ds_read_b128 a[148:151], v243 offset:50176
MV 156,a,176,a,40
ds_read_b64 v[116:117], v8 offset:2176
MV 160,a,176,a,44
ds_read_b128 a[152:155], v243 offset:51200
s_add_u32 s69, s69, 16384
MV 164,a,180,a,40
ds_read_b128 a[156:159], v243 offset:52224
ds_read_b64 v[118:119], v8 offset:2184
MV 168,a,180,a,44
MV 172,a,184,a,40
ds_read_b64 v[120:121], v8 offset:3264
MV 176,a,184,a,44
MV 180,a,188,a,40
buffer_load_dwordx4 a[40:43], v236, s[44:47], s68 offen offset:1024 sc1
ds_read_b64 v[122:123], v8 offset:3272
MV 184,a,188,a,44
buffer_load_dwordx4 a[44:47], v237, s[44:47], s68 offen offset:1024 sc1
s_add_u32 s68, s68, 2048
s_waitcnt lgkmcnt(15)
MV 124,a,128,a,48
ds_read_b128 a[160:163], v242 offset:57344
s_waitcnt lgkmcnt(13)
buffer_store_dwordx4 v[108:111], v9, s[24:27], 0 offen offset:0 sc1
MV 128,a,128,a,52
ds_read_b128 a[164:167], v242 offset:58368
s_add_u32 m0, s70, 99328
MV 132,a,132,a,48
MV 136,a,132,a,52
ds_read_b128 a[168:171], v242 offset:59392
s_waitcnt lgkmcnt(14)
MV 140,a,136,a,48
ds_read_b128 a[172:175], v242 offset:60416
MV 144,a,136,a,52
buffer_load_dwordx4 v238, s[48:51], s69 offen offset:0 sc1 lds
s_waitcnt lgkmcnt(14)
MV 148,a,140,a,48
ds_read_b128 a[176:179], v243 offset:57344
MV 152,a,140,a,52
ds_read_b128 a[180:183], v243 offset:58368
s_waitcnt lgkmcnt(14)
MV 156,a,144,a,48
s_waitcnt lgkmcnt(13)
buffer_store_dwordx4 v[112:115], v9, s[24:27], 0 offen offset:1024 sc1
MV 160,a,144,a,52
ds_read_b128 a[184:187], v243 offset:59392
buffer_load_dwordx4 v238, s[48:51], s69 offen offset:1024 sc1 lds
s_waitcnt lgkmcnt(13)
MV 164,a,148,a,48
ds_read_b128 a[188:191], v243 offset:60416
MV 168,a,148,a,52
s_waitcnt lgkmcnt(12)
MV 172,a,152,a,48
MV 176,a,152,a,52
s_waitcnt lgkmcnt(11)
MV 180,a,156,a,48
buffer_load_dwordx4 a[48:51], v236, s[44:47], s68 offen offset:0 sc1
MV 184,a,156,a,52
buffer_load_dwordx4 a[52:55], v237, s[44:47], s68 offen offset:0 sc1
s_waitcnt vmcnt(16) lgkmcnt(0)
s_barrier
MV 124,a,160,a,56
ds_read_b128 a[128:131], v242 offset:0
buffer_store_dwordx4 v[116:119], v9, s[24:27], 0 offen offset:2048 sc1
MV 128,a,160,a,60
ds_read_b128 a[132:135], v242 offset:1024
buffer_load_dwordx4 v238, s[48:51], s69 offen offset:2048 sc1 lds
MV 132,a,164,a,56
MV 136,a,164,a,60
ds_read_b128 a[136:139], v242 offset:2048
MV 140,a,168,a,56
ds_read_b128 a[140:143], v242 offset:3072
MV 144,a,168,a,60
buffer_load_dwordx4 v238, s[48:51], s69 offen offset:3072 sc1 lds
MV 148,a,172,a,56
ds_read_b128 a[144:147], v243 offset:0
MV 152,a,172,a,60
ds_read_b128 a[148:151], v243 offset:1024
MV 156,a,176,a,56
buffer_store_dwordx4 v[120:123], v9, s[24:27], 0 offen offset:3072 sc1
MV 160,a,176,a,60
ds_read_b128 a[152:155], v243 offset:2048
s_add_u32 s69, s69, 16384
MV 164,a,180,a,56
ds_read_b128 a[156:159], v243 offset:3072
MV 168,a,180,a,60
MV 172,a,184,a,56
MV 176,a,184,a,60
MV 180,a,188,a,56
buffer_load_dwordx4 a[56:59], v236, s[44:47], s68 offen offset:1024 sc1
MV 184,a,188,a,60
buffer_load_dwordx4 a[60:63], v237, s[44:47], s68 offen offset:1024 sc1
s_add_u32 s68, s68, 2048
s_waitcnt lgkmcnt(7)
MV 124,a,128,a,0
ds_read_b128 a[160:163], v242 offset:8192
MV 128,a,128,a,4
ds_read_b128 a[164:167], v242 offset:9216
s_add_u32 m0, s70, 115712
s_waitcnt lgkmcnt(8)
MV 132,a,132,a,0
MV 136,a,132,a,4
ds_read_b128 a[168:171], v242 offset:10240
s_waitcnt lgkmcnt(8)
MV 140,a,136,a,0
ds_read_b128 a[172:175], v242 offset:11264
MV 144,a,136,a,4
buffer_load_dwordx4 v238, s[48:51], s69 offen offset:0 sc1 lds
s_waitcnt lgkmcnt(8)
MV 148,a,140,a,0
ds_read_b128 a[176:179], v243 offset:8192
MV 152,a,140,a,4
ds_read_b128 a[180:183], v243 offset:9216
s_waitcnt lgkmcnt(9)
MV 156,a,144,a,0
MV 160,a,144,a,4
ds_read_b128 a[184:187], v243 offset:10240
buffer_load_dwordx4 v238, s[48:51], s69 offen offset:1024 sc1 lds
s_waitcnt lgkmcnt(9)
MV 164,a,148,a,0
ds_read_b128 a[188:191], v243 offset:11264
MV 168,a,148,a,4
s_waitcnt lgkmcnt(9)
MV 172,a,152,a,0
MV 176,a,152,a,4
s_waitcnt lgkmcnt(8)
MV 180,a,156,a,0
buffer_load_dwordx4 a[0:3], v236, s[44:47], s68 offen offset:0 sc1
MV 184,a,156,a,4
buffer_load_dwordx4 a[4:7], v237, s[44:47], s68 offen offset:0 sc1
s_waitcnt vmcnt(18) lgkmcnt(0)
s_barrier
MV 124,a,160,a,8
ds_read_b128 a[128:131], v242 offset:16384
MV 128,a,160,a,12
ds_read_b128 a[132:135], v242 offset:17408
buffer_load_dwordx4 v238, s[48:51], s69 offen offset:2048 sc1 lds
MV 132,a,164,a,8
MV 136,a,164,a,12
ds_read_b128 a[136:139], v242 offset:18432
MV 140,a,168,a,8
ds_read_b128 a[140:143], v242 offset:19456
MV 144,a,168,a,12
buffer_load_dwordx4 v238, s[48:51], s69 offen offset:3072 sc1 lds
MV 148,a,172,a,8
ds_read_b128 a[144:147], v243 offset:16384
MV 152,a,172,a,12
ds_read_b128 a[148:151], v243 offset:17408
MV 156,a,176,a,8
MV 160,a,176,a,12
ds_read_b128 a[152:155], v243 offset:18432
s_add_u32 s69, s69, 16384
MV 164,a,180,a,8
ds_read_b128 a[156:159], v243 offset:19456
MV 168,a,180,a,12
MV 172,a,184,a,8
MV 176,a,184,a,12
MV 180,a,188,a,8
buffer_load_dwordx4 a[8:11], v236, s[44:47], s68 offen offset:1024 sc1
MV 184,a,188,a,12
buffer_load_dwordx4 a[12:15], v237, s[44:47], s68 offen offset:1024 sc1
s_add_u32 s68, s68, 2048
s_waitcnt lgkmcnt(7)
MV 124,a,128,a,16
ds_read_b128 a[160:163], v242 offset:24576
MV 128,a,128,a,20
ds_read_b128 a[164:167], v242 offset:25600
s_add_u32 m0, s70, 66560
s_waitcnt lgkmcnt(8)
MV 132,a,132,a,16
MV 136,a,132,a,20
ds_read_b128 a[168:171], v242 offset:26624
s_waitcnt lgkmcnt(8)
MV 140,a,136,a,16
ds_read_b128 a[172:175], v242 offset:27648
MV 144,a,136,a,20
buffer_load_dwordx4 v238, s[48:51], s69 offen offset:0 sc1 lds
s_waitcnt lgkmcnt(8)
MV 148,a,140,a,16
ds_read_b128 a[176:179], v243 offset:24576
MV 152,a,140,a,20
ds_read_b128 a[180:183], v243 offset:25600
s_waitcnt lgkmcnt(9)
MV 156,a,144,a,16
MV 160,a,144,a,20
ds_read_b128 a[184:187], v243 offset:26624
buffer_load_dwordx4 v238, s[48:51], s69 offen offset:1024 sc1 lds
s_waitcnt lgkmcnt(9)
MV 164,a,148,a,16
ds_read_b128 a[188:191], v243 offset:27648
MV 168,a,148,a,20
s_waitcnt lgkmcnt(9)
MV 172,a,152,a,16
MV 176,a,152,a,20
s_waitcnt lgkmcnt(8)
MV 180,a,156,a,16
buffer_load_dwordx4 a[16:19], v236, s[44:47], s68 offen offset:0 sc1
MV 184,a,156,a,20
buffer_load_dwordx4 a[20:23], v237, s[44:47], s68 offen offset:0 sc1
s_waitcnt vmcnt(15) lgkmcnt(0)
s_barrier
MV 124,a,160,a,24
ds_read_b128 a[128:131], v242 offset:32768
MV 128,a,160,a,28
ds_read_b128 a[132:135], v242 offset:33792
buffer_load_dwordx4 v238, s[48:51], s69 offen offset:2048 sc1 lds
MV 132,a,164,a,24
MV 136,a,164,a,28
ds_read_b128 a[136:139], v242 offset:34816
MV 140,a,168,a,24
ds_read_b128 a[140:143], v242 offset:35840
MV 144,a,168,a,28
buffer_load_dwordx4 v238, s[48:51], s69 offen offset:3072 sc1 lds
MV 148,a,172,a,24
ds_read_b128 a[144:147], v243 offset:32768
MV 152,a,172,a,28
ds_read_b128 a[148:151], v243 offset:33792
MV 156,a,176,a,24
MV 160,a,176,a,28
ds_read_b128 a[152:155], v243 offset:34816
s_add_u32 s69, s69, 16384
MV 164,a,180,a,24
ds_read_b128 a[156:159], v243 offset:35840
MV 168,a,180,a,28
MV 172,a,184,a,24
MV 176,a,184,a,28
MV 180,a,188,a,24
buffer_load_dwordx4 a[24:27], v236, s[44:47], s68 offen offset:1024 sc1
MV 184,a,188,a,28
buffer_load_dwordx4 a[28:31], v237, s[44:47], s68 offen offset:1024 sc1
s_add_u32 s68, s68, 2048
s_waitcnt lgkmcnt(7)
MV 124,a,128,a,32
ds_read_b128 a[160:163], v242 offset:40960
MV 128,a,128,a,36
ds_read_b128 a[164:167], v242 offset:41984
s_add_u32 m0, s70, 82944
s_waitcnt lgkmcnt(8)
MV 132,a,132,a,32
MV 136,a,132,a,36
ds_read_b128 a[168:171], v242 offset:43008
s_waitcnt lgkmcnt(8)
MV 140,a,136,a,32
ds_read_b128 a[172:175], v242 offset:44032
MV 144,a,136,a,36
buffer_load_dwordx4 v238, s[48:51], s69 offen offset:0 sc1 lds
s_waitcnt lgkmcnt(8)
MV 148,a,140,a,32
ds_read_b128 a[176:179], v243 offset:40960
MV 152,a,140,a,36
ds_read_b128 a[180:183], v243 offset:41984
s_waitcnt lgkmcnt(9)
MV 156,a,144,a,32
MV 160,a,144,a,36
ds_read_b128 a[184:187], v243 offset:43008
buffer_load_dwordx4 v238, s[48:51], s69 offen offset:1024 sc1 lds
s_waitcnt lgkmcnt(9)
MV 164,a,148,a,32
ds_read_b128 a[188:191], v243 offset:44032
MV 168,a,148,a,36
s_waitcnt lgkmcnt(9)
MV 172,a,152,a,32
MV 176,a,152,a,36
s_waitcnt lgkmcnt(8)
MV 180,a,156,a,32
buffer_load_dwordx4 a[32:35], v236, s[44:47], s68 offen offset:0 sc1
MV 184,a,156,a,36
buffer_load_dwordx4 a[36:39], v237, s[44:47], s68 offen offset:0 sc1
s_waitcnt vmcnt(14) lgkmcnt(0)
s_barrier
MV 124,a,160,a,40
ds_read_b128 a[128:131], v242 offset:49152
MV 128,a,160,a,44
ds_read_b128 a[132:135], v242 offset:50176
buffer_load_dwordx4 v238, s[48:51], s69 offen offset:2048 sc1 lds
MV 132,a,164,a,40
MV 136,a,164,a,44
ds_read_b128 a[136:139], v242 offset:51200
MV 140,a,168,a,40
ds_read_b128 a[140:143], v242 offset:52224
MV 144,a,168,a,44
buffer_load_dwordx4 v238, s[48:51], s69 offen offset:3072 sc1 lds
MV 148,a,172,a,40
ds_read_b128 a[144:147], v243 offset:49152
MV 152,a,172,a,44
ds_read_b128 a[148:151], v243 offset:50176
MV 156,a,176,a,40
MV 160,a,176,a,44
ds_read_b128 a[152:155], v243 offset:51200
s_add_u32 s69, s69, 16384
MV 164,a,180,a,40
ds_read_b128 a[156:159], v243 offset:52224
MV 168,a,180,a,44
MV 172,a,184,a,40
MV 176,a,184,a,44
MV 180,a,188,a,40
buffer_load_dwordx4 a[40:43], v236, s[44:47], s68 offen offset:1024 sc1
MV 184,a,188,a,44
buffer_load_dwordx4 a[44:47], v237, s[44:47], s68 offen offset:1024 sc1
s_add_u32 s68, s68, 2048
s_waitcnt lgkmcnt(7)
MV 124,a,128,a,48
ds_read_b128 a[160:163], v242 offset:57344
MV 128,a,128,a,52
ds_read_b128 a[164:167], v242 offset:58368
s_add_u32 m0, s70, 99328
s_waitcnt lgkmcnt(8)
MV 132,a,132,a,48
MV 136,a,132,a,52
ds_read_b128 a[168:171], v242 offset:59392
s_waitcnt lgkmcnt(8)
MV 140,a,136,a,48
ds_read_b128 a[172:175], v242 offset:60416
MV 144,a,136,a,52
buffer_load_dwordx4 v238, s[48:51], s69 offen offset:0 sc1 lds
s_waitcnt lgkmcnt(8)
MV 148,a,140,a,48
ds_read_b128 a[176:179], v243 offset:57344
MV 152,a,140,a,52
ds_read_b128 a[180:183], v243 offset:58368
s_waitcnt lgkmcnt(9)
MV 156,a,144,a,48
MV 160,a,144,a,52
ds_read_b128 a[184:187], v243 offset:59392
buffer_load_dwordx4 v238, s[48:51], s69 offen offset:1024 sc1 lds
s_waitcnt lgkmcnt(9)
MV 164,a,148,a,48
ds_read_b128 a[188:191], v243 offset:60416
MV 168,a,148,a,52
s_waitcnt lgkmcnt(9)
MV 172,a,152,a,48
MV 176,a,152,a,52
s_waitcnt lgkmcnt(8)
MV 180,a,156,a,48
buffer_load_dwordx4 a[48:51], v236, s[44:47], s68 offen offset:0 sc1
MV 184,a,156,a,52
buffer_load_dwordx4 a[52:55], v237, s[44:47], s68 offen offset:0 sc1
s_waitcnt vmcnt(14) lgkmcnt(0)
s_barrier
MV 124,a,160,a,56
ds_read_b128 a[128:131], v242 offset:0
MV 128,a,160,a,60
ds_read_b128 a[132:135], v242 offset:1024
buffer_load_dwordx4 v238, s[48:51], s69 offen offset:2048 sc1 lds
MV 132,a,164,a,56
MV 136,a,164,a,60
ds_read_b128 a[136:139], v242 offset:2048
MV 140,a,168,a,56
ds_read_b128 a[140:143], v242 offset:3072
MV 144,a,168,a,60
buffer_load_dwordx4 v238, s[48:51], s69 offen offset:3072 sc1 lds
MV 148,a,172,a,56
ds_read_b128 a[144:147], v243 offset:0
MV 152,a,172,a,60
ds_read_b128 a[148:151], v243 offset:1024
MV 156,a,176,a,56
MV 160,a,176,a,60
ds_read_b128 a[152:155], v243 offset:2048
s_add_u32 s69, s69, 16384
MV 164,a,180,a,56
ds_read_b128 a[156:159], v243 offset:3072
MV 168,a,180,a,60
MV 172,a,184,a,56
MV 176,a,184,a,60
MV 180,a,188,a,56
buffer_load_dwordx4 a[56:59], v236, s[44:47], s68 offen offset:1024 sc1
MV 184,a,188,a,60
buffer_load_dwordx4 a[60:63], v237, s[44:47], s68 offen offset:1024 sc1
s_add_u32 s68, s68, 2048
s_waitcnt lgkmcnt(7)
MV 124,a,128,a,0
ds_read_b128 a[160:163], v242 offset:8192
MV 128,a,128,a,4
ds_read_b128 a[164:167], v242 offset:9216
s_add_u32 m0, s70, 115712
s_waitcnt lgkmcnt(8)
MV 132,a,132,a,0
MV 136,a,132,a,4
ds_read_b128 a[168:171], v242 offset:10240
s_waitcnt lgkmcnt(8)
MV 140,a,136,a,0
ds_read_b128 a[172:175], v242 offset:11264
MV 144,a,136,a,4
buffer_load_dwordx4 v238, s[48:51], s69 offen offset:0 sc1 lds
s_waitcnt lgkmcnt(8)
MV 148,a,140,a,0
ds_read_b128 a[176:179], v243 offset:8192
MV 152,a,140,a,4
ds_read_b128 a[180:183], v243 offset:9216
s_waitcnt lgkmcnt(9)
MV 156,a,144,a,0
MV 160,a,144,a,4
ds_read_b128 a[184:187], v243 offset:10240
buffer_load_dwordx4 v238, s[48:51], s69 offen offset:1024 sc1 lds
s_waitcnt lgkmcnt(9)
MV 164,a,148,a,0
ds_read_b128 a[188:191], v243 offset:11264
MV 168,a,148,a,4
s_waitcnt lgkmcnt(9)
MV 172,a,152,a,0
MV 176,a,152,a,4
s_waitcnt lgkmcnt(8)
MV 180,a,156,a,0
buffer_load_dwordx4 a[0:3], v236, s[44:47], s68 offen offset:0 sc1
MV 184,a,156,a,4
buffer_load_dwordx4 a[4:7], v237, s[44:47], s68 offen offset:0 sc1
s_waitcnt vmcnt(14) lgkmcnt(0)
s_barrier
MV 124,a,160,a,8
ds_read_b128 a[128:131], v242 offset:16384
MV 128,a,160,a,12
ds_read_b128 a[132:135], v242 offset:17408
buffer_load_dwordx4 v238, s[48:51], s69 offen offset:2048 sc1 lds
MV 132,a,164,a,8
MV 136,a,164,a,12
ds_read_b128 a[136:139], v242 offset:18432
MV 140,a,168,a,8
ds_read_b128 a[140:143], v242 offset:19456
MV 144,a,168,a,12
buffer_load_dwordx4 v238, s[48:51], s69 offen offset:3072 sc1 lds
MV 148,a,172,a,8
ds_read_b128 a[144:147], v243 offset:16384
MV 152,a,172,a,12
ds_read_b128 a[148:151], v243 offset:17408
MV 156,a,176,a,8
MV 160,a,176,a,12
ds_read_b128 a[152:155], v243 offset:18432
s_add_u32 s69, s69, 16384
MV 164,a,180,a,8
ds_read_b128 a[156:159], v243 offset:19456
MV 168,a,180,a,12
MV 172,a,184,a,8
MV 176,a,184,a,12
MV 180,a,188,a,8
buffer_load_dwordx4 a[8:11], v236, s[44:47], s68 offen offset:1024 sc1
MV 184,a,188,a,12
buffer_load_dwordx4 a[12:15], v237, s[44:47], s68 offen offset:1024 sc1
s_add_u32 s68, s68, 2048
s_waitcnt lgkmcnt(7)
MV 124,a,128,a,16
ds_read_b128 a[160:163], v242 offset:24576
MV 128,a,128,a,20
ds_read_b128 a[164:167], v242 offset:25600
s_add_u32 m0, s70, 66560
s_waitcnt lgkmcnt(8)
MV 132,a,132,a,16
MV 136,a,132,a,20
ds_read_b128 a[168:171], v242 offset:26624
s_waitcnt lgkmcnt(8)
MV 140,a,136,a,16
ds_read_b128 a[172:175], v242 offset:27648
MV 144,a,136,a,20
buffer_load_dwordx4 v238, s[48:51], s69 offen offset:0 sc1 lds
s_waitcnt lgkmcnt(8)
MV 148,a,140,a,16
ds_read_b128 a[176:179], v243 offset:24576
MV 152,a,140,a,20
ds_read_b128 a[180:183], v243 offset:25600
s_waitcnt lgkmcnt(9)
MV 156,a,144,a,16
MV 160,a,144,a,20
ds_read_b128 a[184:187], v243 offset:26624
buffer_load_dwordx4 v238, s[48:51], s69 offen offset:1024 sc1 lds
s_waitcnt lgkmcnt(9)
MV 164,a,148,a,16
ds_read_b128 a[188:191], v243 offset:27648
MV 168,a,148,a,20
s_waitcnt lgkmcnt(9)
MV 172,a,152,a,16
MV 176,a,152,a,20
s_waitcnt lgkmcnt(8)
MV 180,a,156,a,16
buffer_load_dwordx4 a[16:19], v236, s[44:47], s68 offen offset:0 sc1
MV 184,a,156,a,20
buffer_load_dwordx4 a[20:23], v237, s[44:47], s68 offen offset:0 sc1
s_waitcnt vmcnt(14) lgkmcnt(0)
s_barrier
MV 124,a,160,a,24
ds_read_b128 a[128:131], v242 offset:32768
MV 128,a,160,a,28
ds_read_b128 a[132:135], v242 offset:33792
buffer_load_dwordx4 v238, s[48:51], s69 offen offset:2048 sc1 lds
MV 132,a,164,a,24
MV 136,a,164,a,28
ds_read_b128 a[136:139], v242 offset:34816
MV 140,a,168,a,24
ds_read_b128 a[140:143], v242 offset:35840
MV 144,a,168,a,28
buffer_load_dwordx4 v238, s[48:51], s69 offen offset:3072 sc1 lds
MV 148,a,172,a,24
ds_read_b128 a[144:147], v243 offset:32768
MV 152,a,172,a,28
ds_read_b128 a[148:151], v243 offset:33792
MV 156,a,176,a,24
MV 160,a,176,a,28
ds_read_b128 a[152:155], v243 offset:34816
s_add_u32 s69, s69, 16384
MV 164,a,180,a,24
ds_read_b128 a[156:159], v243 offset:35840
MV 168,a,180,a,28
MV 172,a,184,a,24
MV 176,a,184,a,28
MV 180,a,188,a,24
buffer_load_dwordx4 a[24:27], v236, s[44:47], s68 offen offset:1024 sc1
MV 184,a,188,a,28
buffer_load_dwordx4 a[28:31], v237, s[44:47], s68 offen offset:1024 sc1
s_add_u32 s68, s68, 2048
s_waitcnt lgkmcnt(7)
MV 124,a,128,a,32
ds_read_b128 a[160:163], v242 offset:40960
MV 128,a,128,a,36
ds_read_b128 a[164:167], v242 offset:41984
s_add_u32 m0, s70, 82944
s_waitcnt lgkmcnt(8)
MV 132,a,132,a,32
MV 136,a,132,a,36
ds_read_b128 a[168:171], v242 offset:43008
s_waitcnt lgkmcnt(8)
MV 140,a,136,a,32
ds_read_b128 a[172:175], v242 offset:44032
MV 144,a,136,a,36
buffer_load_dwordx4 v238, s[48:51], s69 offen offset:0 sc1 lds
s_waitcnt lgkmcnt(8)
MV 148,a,140,a,32
ds_read_b128 a[176:179], v243 offset:40960
MV 152,a,140,a,36
ds_read_b128 a[180:183], v243 offset:41984
s_waitcnt lgkmcnt(9)
MV 156,a,144,a,32
MV 160,a,144,a,36
ds_read_b128 a[184:187], v243 offset:43008
buffer_load_dwordx4 v238, s[48:51], s69 offen offset:1024 sc1 lds
s_waitcnt lgkmcnt(9)
MV 164,a,148,a,32
ds_read_b128 a[188:191], v243 offset:44032
MV 168,a,148,a,36
s_waitcnt lgkmcnt(9)
MV 172,a,152,a,32
MV 176,a,152,a,36
s_waitcnt lgkmcnt(8)
MV 180,a,156,a,32
buffer_load_dwordx4 a[32:35], v236, s[44:47], s68 offen offset:0 sc1
MV 184,a,156,a,36
buffer_load_dwordx4 a[36:39], v237, s[44:47], s68 offen offset:0 sc1
s_waitcnt vmcnt(14) lgkmcnt(0)
s_barrier
v_mov_b32 v253, 1
s_lshl_b32 s36, s2, 2
buffer_store_dword v253, v255, s[8:11], s36 offen offset:3072 sc1
MV 124,a,160,a,40
ds_read_b128 a[128:131], v242 offset:49152
MV 128,a,160,a,44
ds_read_b128 a[132:135], v242 offset:50176
buffer_load_dwordx4 v238, s[48:51], s69 offen offset:2048 sc1 lds
MV 132,a,164,a,40
MV 136,a,164,a,44
ds_read_b128 a[136:139], v242 offset:51200
MV 140,a,168,a,40
ds_read_b128 a[140:143], v242 offset:52224
MV 144,a,168,a,44
buffer_load_dwordx4 v238, s[48:51], s69 offen offset:3072 sc1 lds
MV 148,a,172,a,40
ds_read_b128 a[144:147], v243 offset:49152
MV 152,a,172,a,44
ds_read_b128 a[148:151], v243 offset:50176
MV 156,a,176,a,40
MV 160,a,176,a,44
ds_read_b128 a[152:155], v243 offset:51200
s_add_u32 s69, s69, 16384
MV 164,a,180,a,40
ds_read_b128 a[156:159], v243 offset:52224
MV 168,a,180,a,44
MV 172,a,184,a,40
MV 176,a,184,a,44
MV 180,a,188,a,40
buffer_load_dwordx4 a[40:43], v236, s[44:47], s68 offen offset:1024 sc1
MV 184,a,188,a,44
buffer_load_dwordx4 a[44:47], v237, s[44:47], s68 offen offset:1024 sc1
s_add_u32 s68, s68, 2048
s_waitcnt lgkmcnt(7)
MV 124,a,128,a,48
ds_read_b128 a[160:163], v242 offset:57344
MV 128,a,128,a,52
ds_read_b128 a[164:167], v242 offset:58368
s_add_u32 m0, s70, 99328
s_waitcnt lgkmcnt(8)
MV 132,a,132,a,48
MV 136,a,132,a,52
ds_read_b128 a[168:171], v242 offset:59392
s_waitcnt lgkmcnt(8)
MV 140,a,136,a,48
ds_read_b128 a[172:175], v242 offset:60416
MV 144,a,136,a,52
buffer_load_dwordx4 v238, s[48:51], s69 offen offset:0 sc1 lds
s_waitcnt lgkmcnt(8)
MV 148,a,140,a,48
ds_read_b128 a[176:179], v243 offset:57344
MV 152,a,140,a,52
ds_read_b128 a[180:183], v243 offset:58368
s_waitcnt lgkmcnt(9)
MV 156,a,144,a,48
MV 160,a,144,a,52
ds_read_b128 a[184:187], v243 offset:59392
buffer_load_dwordx4 v238, s[48:51], s69 offen offset:1024 sc1 lds
s_waitcnt lgkmcnt(9)
MV 164,a,148,a,48
ds_read_b128 a[188:191], v243 offset:60416
MV 168,a,148,a,52
s_waitcnt lgkmcnt(9)
MV 172,a,152,a,48
MV 176,a,152,a,52
s_waitcnt lgkmcnt(8)
MV 180,a,156,a,48
buffer_load_dwordx4 a[48:51], v236, s[44:47], s68 offen offset:0 sc1
MV 184,a,156,a,52
buffer_load_dwordx4 a[52:55], v237, s[44:47], s68 offen offset:0 sc1
s_waitcnt vmcnt(15) lgkmcnt(0)
s_barrier
MV 124,a,160,a,56
ds_read_b128 a[128:131], v242 offset:0
MV 128,a,160,a,60
ds_read_b128 a[132:135], v242 offset:1024
buffer_load_dwordx4 v238, s[48:51], s69 offen offset:2048 sc1 lds
MV 132,a,164,a,56
MV 136,a,164,a,60
ds_read_b128 a[136:139], v242 offset:2048
MV 140,a,168,a,56
ds_read_b128 a[140:143], v242 offset:3072
MV 144,a,168,a,60
buffer_load_dwordx4 v238, s[48:51], s69 offen offset:3072 sc1 lds
MV 148,a,172,a,56
ds_read_b128 a[144:147], v243 offset:0
MV 152,a,172,a,60
ds_read_b128 a[148:151], v243 offset:1024
MV 156,a,176,a,56
MV 160,a,176,a,60
ds_read_b128 a[152:155], v243 offset:2048
s_add_u32 s69, s69, 16384
MV 164,a,180,a,56
ds_read_b128 a[156:159], v243 offset:3072
MV 168,a,180,a,60
MV 172,a,184,a,56
MV 176,a,184,a,60
MV 180,a,188,a,56
buffer_load_dwordx4 a[56:59], v236, s[44:47], s68 offen offset:1024 sc1
MV 184,a,188,a,60
buffer_load_dwordx4 a[60:63], v237, s[44:47], s68 offen offset:1024 sc1
s_add_u32 s68, s68, 2048
s_waitcnt lgkmcnt(7)
MV 124,a,128,a,0
ds_read_b128 a[160:163], v242 offset:8192
MV 128,a,128,a,4
ds_read_b128 a[164:167], v242 offset:9216
s_add_u32 m0, s70, 115712
s_waitcnt lgkmcnt(8)
MV 132,a,132,a,0
MV 136,a,132,a,4
ds_read_b128 a[168:171], v242 offset:10240
s_waitcnt lgkmcnt(8)
MV 140,a,136,a,0
ds_read_b128 a[172:175], v242 offset:11264
MV 144,a,136,a,4
buffer_load_dwordx4 v238, s[48:51], s69 offen offset:0 sc1 lds
s_waitcnt lgkmcnt(8)
MV 148,a,140,a,0
ds_read_b128 a[176:179], v243 offset:8192
MV 152,a,140,a,4
ds_read_b128 a[180:183], v243 offset:9216
s_waitcnt lgkmcnt(9)
MV 156,a,144,a,0
MV 160,a,144,a,4
ds_read_b128 a[184:187], v243 offset:10240
buffer_load_dwordx4 v238, s[48:51], s69 offen offset:1024 sc1 lds
s_waitcnt lgkmcnt(9)
MV 164,a,148,a,0
ds_read_b128 a[188:191], v243 offset:11264
MV 168,a,148,a,4
s_waitcnt lgkmcnt(9)
MV 172,a,152,a,0
MV 176,a,152,a,4
s_waitcnt lgkmcnt(8)
MV 180,a,156,a,0
buffer_load_dwordx4 a[0:3], v236, s[44:47], s68 offen offset:0 sc1
MV 184,a,156,a,4
buffer_load_dwordx4 a[4:7], v237, s[44:47], s68 offen offset:0 sc1
s_waitcnt vmcnt(14) lgkmcnt(0)
s_barrier
MV 124,a,160,a,8
ds_read_b128 a[128:131], v242 offset:16384
MV 128,a,160,a,12
ds_read_b128 a[132:135], v242 offset:17408
buffer_load_dwordx4 v238, s[48:51], s69 offen offset:2048 sc1 lds
MV 132,a,164,a,8
MV 136,a,164,a,12
ds_read_b128 a[136:139], v242 offset:18432
MV 140,a,168,a,8
ds_read_b128 a[140:143], v242 offset:19456
MV 144,a,168,a,12
buffer_load_dwordx4 v238, s[48:51], s69 offen offset:3072 sc1 lds
MV 148,a,172,a,8
ds_read_b128 a[144:147], v243 offset:16384
MV 152,a,172,a,12
ds_read_b128 a[148:151], v243 offset:17408
MV 156,a,176,a,8
MV 160,a,176,a,12
ds_read_b128 a[152:155], v243 offset:18432
s_add_u32 s69, s69, 16384
MV 164,a,180,a,8
ds_read_b128 a[156:159], v243 offset:19456
MV 168,a,180,a,12
MV 172,a,184,a,8
MV 176,a,184,a,12
MV 180,a,188,a,8
buffer_load_dwordx4 a[8:11], v236, s[44:47], s68 offen offset:1024 sc1
MV 184,a,188,a,12
buffer_load_dwordx4 a[12:15], v237, s[44:47], s68 offen offset:1024 sc1
s_add_u32 s68, s68, 2048
s_waitcnt lgkmcnt(7)
MV 124,a,128,a,16
ds_read_b128 a[160:163], v242 offset:24576
MV 128,a,128,a,20
ds_read_b128 a[164:167], v242 offset:25600
s_add_u32 m0, s70, 66560
s_waitcnt lgkmcnt(8)
MV 132,a,132,a,16
MV 136,a,132,a,20
ds_read_b128 a[168:171], v242 offset:26624
s_waitcnt lgkmcnt(8)
MV 140,a,136,a,16
ds_read_b128 a[172:175], v242 offset:27648
MV 144,a,136,a,20
buffer_load_dwordx4 v238, s[48:51], s69 offen offset:0 sc1 lds
s_waitcnt lgkmcnt(8)
MV 148,a,140,a,16
ds_read_b128 a[176:179], v243 offset:24576
MV 152,a,140,a,20
ds_read_b128 a[180:183], v243 offset:25600
s_waitcnt lgkmcnt(9)
MV 156,a,144,a,16
MV 160,a,144,a,20
ds_read_b128 a[184:187], v243 offset:26624
buffer_load_dwordx4 v238, s[48:51], s69 offen offset:1024 sc1 lds
s_waitcnt lgkmcnt(9)
MV 164,a,148,a,16
ds_read_b128 a[188:191], v243 offset:27648
MV 168,a,148,a,20
s_waitcnt lgkmcnt(9)
MV 172,a,152,a,16
MV 176,a,152,a,20
s_waitcnt lgkmcnt(8)
MV 180,a,156,a,16
buffer_load_dwordx4 a[16:19], v236, s[44:47], s68 offen offset:0 sc1
MV 184,a,156,a,20
buffer_load_dwordx4 a[20:23], v237, s[44:47], s68 offen offset:0 sc1
s_waitcnt vmcnt(14) lgkmcnt(0)
s_barrier
MV 124,a,160,a,24
ds_read_b128 a[128:131], v242 offset:32768
MV 128,a,160,a,28
ds_read_b128 a[132:135], v242 offset:33792
buffer_load_dwordx4 v238, s[48:51], s69 offen offset:2048 sc1 lds
MV 132,a,164,a,24
MV 136,a,164,a,28
ds_read_b128 a[136:139], v242 offset:34816
MV 140,a,168,a,24
ds_read_b128 a[140:143], v242 offset:35840
MV 144,a,168,a,28
buffer_load_dwordx4 v238, s[48:51], s69 offen offset:3072 sc1 lds
MV 148,a,172,a,24
ds_read_b128 a[144:147], v243 offset:32768
MV 152,a,172,a,28
ds_read_b128 a[148:151], v243 offset:33792
MV 156,a,176,a,24
MV 160,a,176,a,28
ds_read_b128 a[152:155], v243 offset:34816
s_add_u32 s69, s69, 16384
MV 164,a,180,a,24
ds_read_b128 a[156:159], v243 offset:35840
MV 168,a,180,a,28
MV 172,a,184,a,24
MV 176,a,184,a,28
MV 180,a,188,a,24
buffer_load_dwordx4 a[24:27], v236, s[44:47], s68 offen offset:1024 sc1
MV 184,a,188,a,28
buffer_load_dwordx4 a[28:31], v237, s[44:47], s68 offen offset:1024 sc1
s_add_u32 s68, s68, 2048
s_waitcnt lgkmcnt(7)
MV 124,a,128,a,32
ds_read_b128 a[160:163], v242 offset:40960
MV 128,a,128,a,36
ds_read_b128 a[164:167], v242 offset:41984
s_add_u32 m0, s70, 82944
s_waitcnt lgkmcnt(8)
MV 132,a,132,a,32
MV 136,a,132,a,36
ds_read_b128 a[168:171], v242 offset:43008
s_waitcnt lgkmcnt(8)
MV 140,a,136,a,32
ds_read_b128 a[172:175], v242 offset:44032
MV 144,a,136,a,36
buffer_load_dwordx4 v238, s[48:51], s69 offen offset:0 sc1 lds
s_waitcnt lgkmcnt(8)
MV 148,a,140,a,32
ds_read_b128 a[176:179], v243 offset:40960
MV 152,a,140,a,36
ds_read_b128 a[180:183], v243 offset:41984
s_waitcnt lgkmcnt(9)
MV 156,a,144,a,32
MV 160,a,144,a,36
ds_read_b128 a[184:187], v243 offset:43008
buffer_load_dwordx4 v238, s[48:51], s69 offen offset:1024 sc1 lds
s_waitcnt lgkmcnt(9)
MV 164,a,148,a,32
ds_read_b128 a[188:191], v243 offset:44032
MV 168,a,148,a,36
s_waitcnt lgkmcnt(9)
MV 172,a,152,a,32
MV 176,a,152,a,36
s_waitcnt lgkmcnt(8)
MV 180,a,156,a,32
buffer_load_dwordx4 a[32:35], v236, s[44:47], s68 offen offset:0 sc1
MV 184,a,156,a,36
buffer_load_dwordx4 a[36:39], v237, s[44:47], s68 offen offset:0 sc1
s_waitcnt vmcnt(14) lgkmcnt(0)
s_barrier
MV 124,a,160,a,40
ds_read_b128 a[128:131], v242 offset:49152
MV 128,a,160,a,44
ds_read_b128 a[132:135], v242 offset:50176
buffer_load_dwordx4 v238, s[48:51], s69 offen offset:2048 sc1 lds
MV 132,a,164,a,40
MV 136,a,164,a,44
ds_read_b128 a[136:139], v242 offset:51200
MV 140,a,168,a,40
ds_read_b128 a[140:143], v242 offset:52224
MV 144,a,168,a,44
buffer_load_dwordx4 v238, s[48:51], s69 offen offset:3072 sc1 lds
MV 148,a,172,a,40
ds_read_b128 a[144:147], v243 offset:49152
MV 152,a,172,a,44
ds_read_b128 a[148:151], v243 offset:50176
MV 156,a,176,a,40
MV 160,a,176,a,44
ds_read_b128 a[152:155], v243 offset:51200
s_add_u32 s69, s69, 16384
MV 164,a,180,a,40
ds_read_b128 a[156:159], v243 offset:52224
MV 168,a,180,a,44
MV 172,a,184,a,40
MV 176,a,184,a,44
MV 180,a,188,a,40
buffer_load_dwordx4 a[40:43], v236, s[44:47], s68 offen offset:1024 sc1
MV 184,a,188,a,44
buffer_load_dwordx4 a[44:47], v237, s[44:47], s68 offen offset:1024 sc1
s_add_u32 s68, s68, 2048
s_waitcnt lgkmcnt(7)
MV 124,a,128,a,48
ds_read_b128 a[160:163], v242 offset:57344
MV 128,a,128,a,52
ds_read_b128 a[164:167], v242 offset:58368
s_add_u32 m0, s70, 99328
s_waitcnt lgkmcnt(8)
MV 132,a,132,a,48
MV 136,a,132,a,52
ds_read_b128 a[168:171], v242 offset:59392
s_waitcnt lgkmcnt(8)
MV 140,a,136,a,48
ds_read_b128 a[172:175], v242 offset:60416
MV 144,a,136,a,52
buffer_load_dwordx4 v238, s[48:51], s69 offen offset:0 sc1 lds
s_waitcnt lgkmcnt(8)
MV 148,a,140,a,48
ds_read_b128 a[176:179], v243 offset:57344
MV 152,a,140,a,52
ds_read_b128 a[180:183], v243 offset:58368
s_waitcnt lgkmcnt(9)
MV 156,a,144,a,48
MV 160,a,144,a,52
ds_read_b128 a[184:187], v243 offset:59392
buffer_load_dwordx4 v238, s[48:51], s69 offen offset:1024 sc1 lds
s_waitcnt lgkmcnt(9)
MV 164,a,148,a,48
ds_read_b128 a[188:191], v243 offset:60416
MV 168,a,148,a,52
s_waitcnt lgkmcnt(9)
MV 172,a,152,a,48
MV 176,a,152,a,52
s_waitcnt lgkmcnt(8)
MV 180,a,156,a,48
buffer_load_dwordx4 a[48:51], v236, s[44:47], s68 offen offset:0 sc1
MV 184,a,156,a,52
buffer_load_dwordx4 a[52:55], v237, s[44:47], s68 offen offset:0 sc1
s_waitcnt vmcnt(14) lgkmcnt(0)
s_barrier
MV 124,a,160,a,56
ds_read_b128 a[128:131], v242 offset:0
MV 128,a,160,a,60
ds_read_b128 a[132:135], v242 offset:1024
buffer_load_dwordx4 v238, s[48:51], s69 offen offset:2048 sc1 lds
MV 132,a,164,a,56
MV 136,a,164,a,60
ds_read_b128 a[136:139], v242 offset:2048
MV 140,a,168,a,56
ds_read_b128 a[140:143], v242 offset:3072
MV 144,a,168,a,60
buffer_load_dwordx4 v238, s[48:51], s69 offen offset:3072 sc1 lds
MV 148,a,172,a,56
ds_read_b128 a[144:147], v243 offset:0
MV 152,a,172,a,60
ds_read_b128 a[148:151], v243 offset:1024
MV 156,a,176,a,56
MV 160,a,176,a,60
ds_read_b128 a[152:155], v243 offset:2048
s_add_u32 s69, s69, 16384
MV 164,a,180,a,56
ds_read_b128 a[156:159], v243 offset:3072
MV 168,a,180,a,60
MV 172,a,184,a,56
MV 176,a,184,a,60
MV 180,a,188,a,56
buffer_load_dwordx4 a[56:59], v236, s[44:47], s68 offen offset:1024 sc1
MV 184,a,188,a,60
buffer_load_dwordx4 a[60:63], v237, s[44:47], s68 offen offset:1024 sc1
s_add_u32 s68, s68, 2048
s_waitcnt lgkmcnt(7)
MV 124,a,128,a,0
ds_read_b128 a[160:163], v242 offset:8192
MV 128,a,128,a,4
ds_read_b128 a[164:167], v242 offset:9216
s_add_u32 m0, s70, 115712
s_waitcnt lgkmcnt(8)
MV 132,a,132,a,0
MV 136,a,132,a,4
ds_read_b128 a[168:171], v242 offset:10240
s_waitcnt lgkmcnt(8)
MV 140,a,136,a,0
ds_read_b128 a[172:175], v242 offset:11264
MV 144,a,136,a,4
buffer_load_dwordx4 v238, s[48:51], s69 offen offset:0 sc1 lds
s_waitcnt lgkmcnt(8)
MV 148,a,140,a,0
ds_read_b128 a[176:179], v243 offset:8192
MV 152,a,140,a,4
ds_read_b128 a[180:183], v243 offset:9216
s_waitcnt lgkmcnt(9)
MV 156,a,144,a,0
MV 160,a,144,a,4
ds_read_b128 a[184:187], v243 offset:10240
buffer_load_dwordx4 v238, s[48:51], s69 offen offset:1024 sc1 lds
s_waitcnt lgkmcnt(9)
MV 164,a,148,a,0
ds_read_b128 a[188:191], v243 offset:11264
MV 168,a,148,a,4
s_waitcnt lgkmcnt(9)
MV 172,a,152,a,0
MV 176,a,152,a,4
s_waitcnt lgkmcnt(8)
MV 180,a,156,a,0
buffer_load_dwordx4 a[0:3], v236, s[44:47], s68 offen offset:0 sc1
MV 184,a,156,a,4
buffer_load_dwordx4 a[4:7], v237, s[44:47], s68 offen offset:0 sc1
s_waitcnt vmcnt(14) lgkmcnt(0)
s_barrier
MV 124,a,160,a,8
ds_read_b128 a[128:131], v242 offset:16384
MV 128,a,160,a,12
ds_read_b128 a[132:135], v242 offset:17408
buffer_load_dwordx4 v238, s[48:51], s69 offen offset:2048 sc1 lds
MV 132,a,164,a,8
MV 136,a,164,a,12
ds_read_b128 a[136:139], v242 offset:18432
MV 140,a,168,a,8
ds_read_b128 a[140:143], v242 offset:19456
MV 144,a,168,a,12
buffer_load_dwordx4 v238, s[48:51], s69 offen offset:3072 sc1 lds
MV 148,a,172,a,8
ds_read_b128 a[144:147], v243 offset:16384
MV 152,a,172,a,12
ds_read_b128 a[148:151], v243 offset:17408
MV 156,a,176,a,8
MV 160,a,176,a,12
ds_read_b128 a[152:155], v243 offset:18432
s_add_u32 s69, s69, 16384
MV 164,a,180,a,8
ds_read_b128 a[156:159], v243 offset:19456
MV 168,a,180,a,12
MV 172,a,184,a,8
MV 176,a,184,a,12
MV 180,a,188,a,8
buffer_load_dwordx4 a[8:11], v236, s[44:47], s68 offen offset:1024 sc1
MV 184,a,188,a,12
buffer_load_dwordx4 a[12:15], v237, s[44:47], s68 offen offset:1024 sc1
s_add_u32 s68, s68, 2048
s_waitcnt lgkmcnt(7)
MV 124,a,128,a,16
ds_read_b128 a[160:163], v242 offset:24576
MV 128,a,128,a,20
ds_read_b128 a[164:167], v242 offset:25600
s_add_u32 m0, s70, 66560
s_waitcnt lgkmcnt(8)
MV 132,a,132,a,16
MV 136,a,132,a,20
ds_read_b128 a[168:171], v242 offset:26624
s_waitcnt lgkmcnt(8)
MV 140,a,136,a,16
ds_read_b128 a[172:175], v242 offset:27648
MV 144,a,136,a,20
buffer_load_dwordx4 v238, s[48:51], s69 offen offset:0 sc1 lds
s_waitcnt lgkmcnt(8)
MV 148,a,140,a,16
ds_read_b128 a[176:179], v243 offset:24576
MV 152,a,140,a,20
ds_read_b128 a[180:183], v243 offset:25600
s_waitcnt lgkmcnt(9)
MV 156,a,144,a,16
MV 160,a,144,a,20
ds_read_b128 a[184:187], v243 offset:26624
buffer_load_dwordx4 v238, s[48:51], s69 offen offset:1024 sc1 lds
s_waitcnt lgkmcnt(9)
MV 164,a,148,a,16
ds_read_b128 a[188:191], v243 offset:27648
MV 168,a,148,a,20
s_waitcnt lgkmcnt(9)
MV 172,a,152,a,16
MV 176,a,152,a,20
s_waitcnt lgkmcnt(8)
MV 180,a,156,a,16
buffer_load_dwordx4 a[16:19], v236, s[44:47], s68 offen offset:0 sc1
MV 184,a,156,a,20
buffer_load_dwordx4 a[20:23], v237, s[44:47], s68 offen offset:0 sc1
s_waitcnt vmcnt(14) lgkmcnt(0)
s_barrier
MV 124,a,160,a,24
ds_read_b128 a[128:131], v242 offset:32768
MV 128,a,160,a,28
ds_read_b128 a[132:135], v242 offset:33792
buffer_load_dwordx4 v238, s[48:51], s69 offen offset:2048 sc1 lds
MV 132,a,164,a,24
MV 136,a,164,a,28
ds_read_b128 a[136:139], v242 offset:34816
MV 140,a,168,a,24
ds_read_b128 a[140:143], v242 offset:35840
MV 144,a,168,a,28
buffer_load_dwordx4 v238, s[48:51], s69 offen offset:3072 sc1 lds
MV 148,a,172,a,24
ds_read_b128 a[144:147], v243 offset:32768
MV 152,a,172,a,28
ds_read_b128 a[148:151], v243 offset:33792
MV 156,a,176,a,24
MV 160,a,176,a,28
ds_read_b128 a[152:155], v243 offset:34816
s_add_u32 s69, s69, 16384
MV 164,a,180,a,24
ds_read_b128 a[156:159], v243 offset:35840
MV 168,a,180,a,28
MV 172,a,184,a,24
MV 176,a,184,a,28
MV 180,a,188,a,24
buffer_load_dwordx4 a[24:27], v236, s[44:47], s68 offen offset:1024 sc1
MV 184,a,188,a,28
buffer_load_dwordx4 a[28:31], v237, s[44:47], s68 offen offset:1024 sc1
s_add_u32 s68, s68, 2048
s_waitcnt lgkmcnt(7)
MV 124,a,128,a,32
ds_read_b128 a[160:163], v242 offset:40960
v_and_b32 v254, 15, v1
MV 128,a,128,a,36
ds_read_b128 a[164:167], v242 offset:41984
s_add_u32 m0, s70, 82944
s_waitcnt lgkmcnt(8)
MV 132,a,132,a,32
MV 136,a,132,a,36
ds_read_b128 a[168:171], v242 offset:43008
s_waitcnt lgkmcnt(8)
MV 140,a,136,a,32
ds_read_b128 a[172:175], v242 offset:44032
s_lshl_b32 s36, s82, 4
MV 144,a,136,a,36
buffer_load_dwordx4 v238, s[48:51], s69 offen offset:0 sc1 lds
s_waitcnt lgkmcnt(8)
MV 148,a,140,a,32
ds_read_b128 a[176:179], v243 offset:40960
MV 152,a,140,a,36
ds_read_b128 a[180:183], v243 offset:41984
s_waitcnt lgkmcnt(9)
MV 156,a,144,a,32
v_add_u32 v254, s36, v254
MV 160,a,144,a,36
ds_read_b128 a[184:187], v243 offset:43008
buffer_load_dwordx4 v238, s[48:51], s69 offen offset:1024 sc1 lds
s_waitcnt lgkmcnt(9)
MV 164,a,148,a,32
ds_read_b128 a[188:191], v243 offset:44032
MV 168,a,148,a,36
s_waitcnt lgkmcnt(9)
MV 172,a,152,a,32
v_lshlrev_b32 v254, 2, v254
MV 176,a,152,a,36
s_waitcnt lgkmcnt(8)
MV 180,a,156,a,32
buffer_load_dwordx4 a[32:35], v236, s[44:47], s68 offen offset:0 sc1
MV 184,a,156,a,36
buffer_load_dwordx4 a[36:39], v237, s[44:47], s68 offen offset:0 sc1
s_waitcnt vmcnt(14) lgkmcnt(0)
s_barrier
MV 124,a,160,a,40
ds_read_b128 a[128:131], v242 offset:49152
buffer_load_dword v253, v254, s[8:11], 0 offen offset:3072 sc1
MV 128,a,160,a,44
ds_read_b128 a[132:135], v242 offset:50176
buffer_load_dwordx4 v238, s[48:51], s69 offen offset:2048 sc1 lds
MV 132,a,164,a,40
MV 136,a,164,a,44
ds_read_b128 a[136:139], v242 offset:51200
MV 140,a,168,a,40
ds_read_b128 a[140:143], v242 offset:52224
MV 144,a,168,a,44
buffer_load_dwordx4 v238, s[48:51], s69 offen offset:3072 sc1 lds
MV 148,a,172,a,40
ds_read_b128 a[144:147], v243 offset:49152
MV 152,a,172,a,44
ds_read_b128 a[148:151], v243 offset:50176
MV 156,a,176,a,40
MV 160,a,176,a,44
ds_read_b128 a[152:155], v243 offset:51200
s_add_u32 s69, s69, 16384
MV 164,a,180,a,40
ds_read_b128 a[156:159], v243 offset:52224
MV 168,a,180,a,44
MV 172,a,184,a,40
MV 176,a,184,a,44
MV 180,a,188,a,40
buffer_load_dwordx4 a[40:43], v236, s[44:47], s68 offen offset:1024 sc1
MV 184,a,188,a,44
buffer_load_dwordx4 a[44:47], v237, s[44:47], s68 offen offset:1024 sc1
s_add_u32 s68, s68, 2048
s_waitcnt lgkmcnt(7)
MV 124,a,128,a,48
ds_read_b128 a[160:163], v242 offset:57344
MV 128,a,128,a,52
ds_read_b128 a[164:167], v242 offset:58368
s_add_u32 m0, s70, 99328
s_waitcnt lgkmcnt(8)
MV 132,a,132,a,48
MV 136,a,132,a,52
ds_read_b128 a[168:171], v242 offset:59392
s_waitcnt lgkmcnt(8)
MV 140,a,136,a,48
ds_read_b128 a[172:175], v242 offset:60416
MV 144,a,136,a,52
buffer_load_dwordx4 v238, s[48:51], s69 offen offset:0 sc1 lds
s_waitcnt lgkmcnt(8)
MV 148,a,140,a,48
ds_read_b128 a[176:179], v243 offset:57344
MV 152,a,140,a,52
ds_read_b128 a[180:183], v243 offset:58368
s_waitcnt lgkmcnt(9)
MV 156,a,144,a,48
MV 160,a,144,a,52
ds_read_b128 a[184:187], v243 offset:59392
buffer_load_dwordx4 v238, s[48:51], s69 offen offset:1024 sc1 lds
s_waitcnt lgkmcnt(9)
MV 164,a,148,a,48
ds_read_b128 a[188:191], v243 offset:60416
MV 168,a,148,a,52
s_waitcnt lgkmcnt(9)
MV 172,a,152,a,48
MV 176,a,152,a,52
s_waitcnt lgkmcnt(8)
MV 180,a,156,a,48
buffer_load_dwordx4 a[48:51], v236, s[44:47], s68 offen offset:0 sc1
MV 184,a,156,a,52
buffer_load_dwordx4 a[52:55], v237, s[44:47], s68 offen offset:0 sc1
s_waitcnt vmcnt(15) lgkmcnt(0)
s_barrier
MV 124,a,160,a,56
ds_read_b128 a[128:131], v242 offset:0
MV 128,a,160,a,60
ds_read_b128 a[132:135], v242 offset:1024
buffer_load_dwordx4 v238, s[48:51], s69 offen offset:2048 sc1 lds
MV 132,a,164,a,56
MV 136,a,164,a,60
ds_read_b128 a[136:139], v242 offset:2048
MV 140,a,168,a,56
ds_read_b128 a[140:143], v242 offset:3072
MV 144,a,168,a,60
buffer_load_dwordx4 v238, s[48:51], s69 offen offset:3072 sc1 lds
MV 148,a,172,a,56
ds_read_b128 a[144:147], v243 offset:0
MV 152,a,172,a,60
ds_read_b128 a[148:151], v243 offset:1024
MV 156,a,176,a,56
MV 160,a,176,a,60
ds_read_b128 a[152:155], v243 offset:2048
s_add_u32 s69, s69, 16384
MV 164,a,180,a,56
ds_read_b128 a[156:159], v243 offset:3072
MV 168,a,180,a,60
MV 172,a,184,a,56
MV 176,a,184,a,60
MV 180,a,188,a,56
buffer_load_dwordx4 a[56:59], v236, s[44:47], s68 offen offset:1024 sc1
MV 184,a,188,a,60
buffer_load_dwordx4 a[60:63], v237, s[44:47], s68 offen offset:1024 sc1
s_add_u32 s68, s68, 2048
s_waitcnt lgkmcnt(7)
MV 124,a,128,a,0
ds_read_b128 a[160:163], v242 offset:8192
MV 128,a,128,a,4
ds_read_b128 a[164:167], v242 offset:9216
s_add_u32 m0, s70, 115712
s_waitcnt lgkmcnt(8)
MV 132,a,132,a,0
MV 136,a,132,a,4
ds_read_b128 a[168:171], v242 offset:10240
s_waitcnt lgkmcnt(8)
MV 140,a,136,a,0
ds_read_b128 a[172:175], v242 offset:11264
MV 144,a,136,a,4
buffer_load_dwordx4 v238, s[48:51], s69 offen offset:0 sc1 lds
s_waitcnt lgkmcnt(8)
MV 148,a,140,a,0
ds_read_b128 a[176:179], v243 offset:8192
MV 152,a,140,a,4
ds_read_b128 a[180:183], v243 offset:9216
s_waitcnt lgkmcnt(9)
MV 156,a,144,a,0
MV 160,a,144,a,4
ds_read_b128 a[184:187], v243 offset:10240
buffer_load_dwordx4 v238, s[48:51], s69 offen offset:1024 sc1 lds
s_waitcnt lgkmcnt(9)
MV 164,a,148,a,0
ds_read_b128 a[188:191], v243 offset:11264
MV 168,a,148,a,4
s_waitcnt lgkmcnt(9)
MV 172,a,152,a,0
MV 176,a,152,a,4
s_waitcnt lgkmcnt(8)
MV 180,a,156,a,0
buffer_load_dwordx4 a[0:3], v236, s[44:47], s68 offen offset:0 sc1
MV 184,a,156,a,4
buffer_load_dwordx4 a[4:7], v237, s[44:47], s68 offen offset:0 sc1
s_waitcnt vmcnt(14) lgkmcnt(0)
s_barrier
MV 124,a,160,a,8
ds_read_b128 a[128:131], v242 offset:16384
MV 128,a,160,a,12
ds_read_b128 a[132:135], v242 offset:17408
buffer_load_dwordx4 v238, s[48:51], s69 offen offset:2048 sc1 lds
MV 132,a,164,a,8
MV 136,a,164,a,12
ds_read_b128 a[136:139], v242 offset:18432
MV 140,a,168,a,8
ds_read_b128 a[140:143], v242 offset:19456
MV 144,a,168,a,12
buffer_load_dwordx4 v238, s[48:51], s69 offen offset:3072 sc1 lds
MV 148,a,172,a,8
ds_read_b128 a[144:147], v243 offset:16384
MV 152,a,172,a,12
ds_read_b128 a[148:151], v243 offset:17408
MV 156,a,176,a,8
MV 160,a,176,a,12
ds_read_b128 a[152:155], v243 offset:18432
s_add_u32 s69, s69, 16384
MV 164,a,180,a,8
ds_read_b128 a[156:159], v243 offset:19456
MV 168,a,180,a,12
MV 172,a,184,a,8
MV 176,a,184,a,12
MV 180,a,188,a,8
buffer_load_dwordx4 a[8:11], v236, s[44:47], s68 offen offset:1024 sc1
MV 184,a,188,a,12
buffer_load_dwordx4 a[12:15], v237, s[44:47], s68 offen offset:1024 sc1
s_add_u32 s68, s68, 2048
s_waitcnt lgkmcnt(7)
MV 124,a,128,a,16
ds_read_b128 a[160:163], v242 offset:24576
MV 128,a,128,a,20
ds_read_b128 a[164:167], v242 offset:25600
s_add_u32 m0, s70, 66560
s_waitcnt lgkmcnt(8)
MV 132,a,132,a,16
MV 136,a,132,a,20
ds_read_b128 a[168:171], v242 offset:26624
s_waitcnt lgkmcnt(8)
MV 140,a,136,a,16
ds_read_b128 a[172:175], v242 offset:27648
MV 144,a,136,a,20
buffer_load_dwordx4 v238, s[48:51], s69 offen offset:0 sc1 lds
s_waitcnt lgkmcnt(8)
MV 148,a,140,a,16
ds_read_b128 a[176:179], v243 offset:24576
MV 152,a,140,a,20
ds_read_b128 a[180:183], v243 offset:25600
s_waitcnt lgkmcnt(9)
MV 156,a,144,a,16
MV 160,a,144,a,20
ds_read_b128 a[184:187], v243 offset:26624
buffer_load_dwordx4 v238, s[48:51], s69 offen offset:1024 sc1 lds
s_waitcnt lgkmcnt(9)
MV 164,a,148,a,16
ds_read_b128 a[188:191], v243 offset:27648
MV 168,a,148,a,20
s_waitcnt lgkmcnt(9)
MV 172,a,152,a,16
MV 176,a,152,a,20
s_waitcnt lgkmcnt(8)
MV 180,a,156,a,16
buffer_load_dwordx4 a[16:19], v236, s[44:47], s68 offen offset:0 sc1
MV 184,a,156,a,20
buffer_load_dwordx4 a[20:23], v237, s[44:47], s68 offen offset:0 sc1
s_waitcnt vmcnt(14) lgkmcnt(0)
s_barrier
MV 124,a,160,a,24
ds_read_b128 a[128:131], v242 offset:32768
MV 128,a,160,a,28
ds_read_b128 a[132:135], v242 offset:33792
buffer_load_dwordx4 v238, s[48:51], s69 offen offset:2048 sc1 lds
MV 132,a,164,a,24
MV 136,a,164,a,28
ds_read_b128 a[136:139], v242 offset:34816
MV 140,a,168,a,24
ds_read_b128 a[140:143], v242 offset:35840
MV 144,a,168,a,28
buffer_load_dwordx4 v238, s[48:51], s69 offen offset:3072 sc1 lds
MV 148,a,172,a,24
ds_read_b128 a[144:147], v243 offset:32768
MV 152,a,172,a,28
ds_read_b128 a[148:151], v243 offset:33792
MV 156,a,176,a,24
MV 160,a,176,a,28
ds_read_b128 a[152:155], v243 offset:34816
s_add_u32 s69, s69, 16384
MV 164,a,180,a,24
ds_read_b128 a[156:159], v243 offset:35840
MV 168,a,180,a,28
MV 172,a,184,a,24
MV 176,a,184,a,28
MV 180,a,188,a,24
buffer_load_dwordx4 a[24:27], v236, s[44:47], s68 offen offset:1024 sc1
MV 184,a,188,a,28
buffer_load_dwordx4 a[28:31], v237, s[44:47], s68 offen offset:1024 sc1
s_add_u32 s68, s68, 2048
s_waitcnt lgkmcnt(7)
MV 124,a,128,a,32
ds_read_b128 a[160:163], v242 offset:40960
MV 128,a,128,a,36
ds_read_b128 a[164:167], v242 offset:41984
s_add_u32 m0, s70, 82944
s_waitcnt lgkmcnt(8)
MV 132,a,132,a,32
MV 136,a,132,a,36
ds_read_b128 a[168:171], v242 offset:43008
s_waitcnt lgkmcnt(8)
MV 140,a,136,a,32
ds_read_b128 a[172:175], v242 offset:44032
MV 144,a,136,a,36
buffer_load_dwordx4 v238, s[48:51], s69 offen offset:0 sc1 lds
s_waitcnt lgkmcnt(8)
MV 148,a,140,a,32
ds_read_b128 a[176:179], v243 offset:40960
MV 152,a,140,a,36
ds_read_b128 a[180:183], v243 offset:41984
s_waitcnt lgkmcnt(9)
MV 156,a,144,a,32
MV 160,a,144,a,36
ds_read_b128 a[184:187], v243 offset:43008
buffer_load_dwordx4 v238, s[48:51], s69 offen offset:1024 sc1 lds
s_waitcnt lgkmcnt(9)
MV 164,a,148,a,32
ds_read_b128 a[188:191], v243 offset:44032
MV 168,a,148,a,36
s_waitcnt lgkmcnt(9)
MV 172,a,152,a,32
MV 176,a,152,a,36
s_waitcnt lgkmcnt(8)
MV 180,a,156,a,32
buffer_load_dwordx4 a[32:35], v236, s[44:47], s68 offen offset:0 sc1
MV 184,a,156,a,36
buffer_load_dwordx4 a[36:39], v237, s[44:47], s68 offen offset:0 sc1
s_waitcnt vmcnt(14) lgkmcnt(0)
s_barrier
MV 124,a,160,a,40
ds_read_b128 a[128:131], v242 offset:49152
MV 128,a,160,a,44
ds_read_b128 a[132:135], v242 offset:50176
buffer_load_dwordx4 v238, s[48:51], s69 offen offset:2048 sc1 lds
MV 132,a,164,a,40
MV 136,a,164,a,44
ds_read_b128 a[136:139], v242 offset:51200
MV 140,a,168,a,40
ds_read_b128 a[140:143], v242 offset:52224
MV 144,a,168,a,44
buffer_load_dwordx4 v238, s[48:51], s69 offen offset:3072 sc1 lds
MV 148,a,172,a,40
ds_read_b128 a[144:147], v243 offset:49152
MV 152,a,172,a,44
ds_read_b128 a[148:151], v243 offset:50176
MV 156,a,176,a,40
MV 160,a,176,a,44
ds_read_b128 a[152:155], v243 offset:51200
s_add_u32 s69, s69, 16384
MV 164,a,180,a,40
ds_read_b128 a[156:159], v243 offset:52224
MV 168,a,180,a,44
MV 172,a,184,a,40
MV 176,a,184,a,44
MV 180,a,188,a,40
buffer_load_dwordx4 a[40:43], v236, s[44:47], s68 offen offset:1024 sc1
MV 184,a,188,a,44
buffer_load_dwordx4 a[44:47], v237, s[44:47], s68 offen offset:1024 sc1
s_add_u32 s68, s68, 2048
s_waitcnt lgkmcnt(7)
MV 124,a,128,a,48
ds_read_b128 a[160:163], v242 offset:57344
MV 128,a,128,a,52
ds_read_b128 a[164:167], v242 offset:58368
s_add_u32 m0, s70, 99328
s_waitcnt lgkmcnt(8)
MV 132,a,132,a,48
MV 136,a,132,a,52
ds_read_b128 a[168:171], v242 offset:59392
s_waitcnt lgkmcnt(8)
MV 140,a,136,a,48
ds_read_b128 a[172:175], v242 offset:60416
MV 144,a,136,a,52
buffer_load_dwordx4 v238, s[48:51], s69 offen offset:0 sc1 lds
s_waitcnt lgkmcnt(8)
MV 148,a,140,a,48
ds_read_b128 a[176:179], v243 offset:57344
MV 152,a,140,a,52
ds_read_b128 a[180:183], v243 offset:58368
s_waitcnt lgkmcnt(9)
MV 156,a,144,a,48
MV 160,a,144,a,52
ds_read_b128 a[184:187], v243 offset:59392
buffer_load_dwordx4 v238, s[48:51], s69 offen offset:1024 sc1 lds
s_waitcnt lgkmcnt(9)
MV 164,a,148,a,48
ds_read_b128 a[188:191], v243 offset:60416
MV 168,a,148,a,52
s_waitcnt lgkmcnt(9)
MV 172,a,152,a,48
MV 176,a,152,a,52
s_waitcnt lgkmcnt(8)
MV 180,a,156,a,48
buffer_load_dwordx4 a[48:51], v236, s[44:47], s68 offen offset:0 sc1
MV 184,a,156,a,52
buffer_load_dwordx4 a[52:55], v237, s[44:47], s68 offen offset:0 sc1
s_waitcnt vmcnt(14) lgkmcnt(0)
s_barrier
MV 124,a,160,a,56
ds_read_b128 a[128:131], v242 offset:0
MV 128,a,160,a,60
ds_read_b128 a[132:135], v242 offset:1024
buffer_load_dwordx4 v238, s[48:51], s69 offen offset:2048 sc1 lds
MV 132,a,164,a,56
MV 136,a,164,a,60
ds_read_b128 a[136:139], v242 offset:2048
MV 140,a,168,a,56
ds_read_b128 a[140:143], v242 offset:3072
MV 144,a,168,a,60
buffer_load_dwordx4 v238, s[48:51], s69 offen offset:3072 sc1 lds
MV 148,a,172,a,56
ds_read_b128 a[144:147], v243 offset:0
MV 152,a,172,a,60
ds_read_b128 a[148:151], v243 offset:1024
MV 156,a,176,a,56
MV 160,a,176,a,60
ds_read_b128 a[152:155], v243 offset:2048
s_add_u32 s69, s69, 16384
MV 164,a,180,a,56
ds_read_b128 a[156:159], v243 offset:3072
MV 168,a,180,a,60
MV 172,a,184,a,56
MV 176,a,184,a,60
MV 180,a,188,a,56
buffer_load_dwordx4 a[56:59], v236, s[44:47], s68 offen offset:1024 sc1
MV 184,a,188,a,60
buffer_load_dwordx4 a[60:63], v237, s[44:47], s68 offen offset:1024 sc1
s_add_u32 s68, s68, 2048
s_waitcnt lgkmcnt(7)
MV 124,a,128,a,0
ds_read_b128 a[160:163], v242 offset:8192
MV 128,a,128,a,4
ds_read_b128 a[164:167], v242 offset:9216
s_add_u32 m0, s70, 115712
s_waitcnt lgkmcnt(8)
MV 132,a,132,a,0
MV 136,a,132,a,4
ds_read_b128 a[168:171], v242 offset:10240
s_waitcnt lgkmcnt(8)
MV 140,a,136,a,0
ds_read_b128 a[172:175], v242 offset:11264
MV 144,a,136,a,4
buffer_load_dwordx4 v238, s[48:51], s69 offen offset:0 sc1 lds
s_waitcnt lgkmcnt(8)
MV 148,a,140,a,0
ds_read_b128 a[176:179], v243 offset:8192
MV 152,a,140,a,4
ds_read_b128 a[180:183], v243 offset:9216
s_waitcnt lgkmcnt(9)
MV 156,a,144,a,0
MV 160,a,144,a,4
ds_read_b128 a[184:187], v243 offset:10240
buffer_load_dwordx4 v238, s[48:51], s69 offen offset:1024 sc1 lds
s_waitcnt lgkmcnt(9)
MV 164,a,148,a,0
ds_read_b128 a[188:191], v243 offset:11264
MV 168,a,148,a,4
s_waitcnt lgkmcnt(9)
MV 172,a,152,a,0
MV 176,a,152,a,4
s_waitcnt lgkmcnt(8)
MV 180,a,156,a,0
buffer_load_dwordx4 a[0:3], v236, s[44:47], s68 offen offset:0 sc1
MV 184,a,156,a,4
buffer_load_dwordx4 a[4:7], v237, s[44:47], s68 offen offset:0 sc1
s_waitcnt vmcnt(14) lgkmcnt(0)
s_barrier
MV 124,a,160,a,8
ds_read_b128 a[128:131], v242 offset:16384
MV 128,a,160,a,12
ds_read_b128 a[132:135], v242 offset:17408
buffer_load_dwordx4 v238, s[48:51], s69 offen offset:2048 sc1 lds
MV 132,a,164,a,8
MV 136,a,164,a,12
ds_read_b128 a[136:139], v242 offset:18432
MV 140,a,168,a,8
ds_read_b128 a[140:143], v242 offset:19456
MV 144,a,168,a,12
buffer_load_dwordx4 v238, s[48:51], s69 offen offset:3072 sc1 lds
MV 148,a,172,a,8
ds_read_b128 a[144:147], v243 offset:16384
MV 152,a,172,a,12
ds_read_b128 a[148:151], v243 offset:17408
MV 156,a,176,a,8
MV 160,a,176,a,12
ds_read_b128 a[152:155], v243 offset:18432
s_add_u32 s69, s69, 16384
MV 164,a,180,a,8
ds_read_b128 a[156:159], v243 offset:19456
MV 168,a,180,a,12
MV 172,a,184,a,8
MV 176,a,184,a,12
MV 180,a,188,a,8
buffer_load_dwordx4 a[8:11], v236, s[44:47], s68 offen offset:1024 sc1
MV 184,a,188,a,12
buffer_load_dwordx4 a[12:15], v237, s[44:47], s68 offen offset:1024 sc1
s_add_u32 s68, s68, 2048
s_waitcnt lgkmcnt(7)
MV 124,a,128,a,16
ds_read_b128 a[160:163], v242 offset:24576
MV 128,a,128,a,20
ds_read_b128 a[164:167], v242 offset:25600
s_add_u32 m0, s70, 66560
s_waitcnt lgkmcnt(8)
MV 132,a,132,a,16
v_cmp_gt_u32 vcc, 1, v253
s_nop 4
s_cbranch_vccnz L_spin_f3
L_spin_f3_ret:
MV 136,a,132,a,20
ds_read_b128 a[168:171], v242 offset:26624
s_waitcnt lgkmcnt(8)
MV 140,a,136,a,16
ds_read_b128 a[172:175], v242 offset:27648
MV 144,a,136,a,20
buffer_load_dwordx4 v238, s[48:51], s69 offen offset:0 sc1 lds
s_waitcnt lgkmcnt(8)
MV 148,a,140,a,16
ds_read_b128 a[176:179], v243 offset:24576
MV 152,a,140,a,20
ds_read_b128 a[180:183], v243 offset:25600
s_waitcnt lgkmcnt(9)
MV 156,a,144,a,16
MV 160,a,144,a,20
ds_read_b128 a[184:187], v243 offset:26624
buffer_load_dwordx4 v238, s[48:51], s69 offen offset:1024 sc1 lds
s_waitcnt lgkmcnt(9)
MV 164,a,148,a,16
ds_read_b128 a[188:191], v243 offset:27648
MV 168,a,148,a,20
s_waitcnt lgkmcnt(9)
MV 172,a,152,a,16
s_add_u32 s72, s79, 0
MV 176,a,152,a,20
s_waitcnt lgkmcnt(8)
MV 180,a,156,a,16
buffer_load_dwordx4 a[16:19], v236, s[44:47], s68 offen offset:0 sc1
buffer_load_dwordx2 v[208:209], v251, s[56:59], s72 offen offset:0 sc1
MV 184,a,156,a,20
buffer_load_dwordx4 a[20:23], v237, s[44:47], s68 offen offset:0 sc1
s_waitcnt vmcnt(15) lgkmcnt(0)
s_barrier
MV 124,a,160,a,24
ds_read_b128 a[128:131], v242 offset:32768
s_add_u32 s72, s79, 16384
MV 128,a,160,a,28
ds_read_b128 a[132:135], v242 offset:33792
buffer_load_dwordx4 v238, s[48:51], s69 offen offset:2048 sc1 lds
MV 132,a,164,a,24
MV 136,a,164,a,28
ds_read_b128 a[136:139], v242 offset:34816
MV 140,a,168,a,24
ds_read_b128 a[140:143], v242 offset:35840
MV 144,a,168,a,28
buffer_load_dwordx4 v238, s[48:51], s69 offen offset:3072 sc1 lds
MV 148,a,172,a,24
ds_read_b128 a[144:147], v243 offset:32768
MV 152,a,172,a,28
ds_read_b128 a[148:151], v243 offset:33792
MV 156,a,176,a,24
buffer_load_dwordx2 v[210:211], v251, s[56:59], s72 offen offset:0 sc1
MV 160,a,176,a,28
ds_read_b128 a[152:155], v243 offset:34816
s_add_u32 s69, s69, 16384
MV 164,a,180,a,24
ds_read_b128 a[156:159], v243 offset:35840
MV 168,a,180,a,28
MV 172,a,184,a,24
MV 176,a,184,a,28
MV 180,a,188,a,24
buffer_load_dwordx4 a[24:27], v236, s[44:47], s68 offen offset:1024 sc1
MV 184,a,188,a,28
buffer_load_dwordx4 a[28:31], v237, s[44:47], s68 offen offset:1024 sc1
s_add_u32 s68, s68, 2048
s_waitcnt lgkmcnt(7)
MV 124,a,128,a,32
ds_read_b128 a[160:163], v242 offset:40960
s_add_u32 s72, s79, 131072
MV 128,a,128,a,36
ds_read_b128 a[164:167], v242 offset:41984
s_add_u32 m0, s70, 82944
s_waitcnt lgkmcnt(8)
MV 132,a,132,a,32
MV 136,a,132,a,36
ds_read_b128 a[168:171], v242 offset:43008
s_waitcnt lgkmcnt(8)
MV 140,a,136,a,32
ds_read_b128 a[172:175], v242 offset:44032
MV 144,a,136,a,36
buffer_load_dwordx4 v238, s[48:51], s69 offen offset:0 sc1 lds
s_waitcnt lgkmcnt(8)
MV 148,a,140,a,32
ds_read_b128 a[176:179], v243 offset:40960
MV 152,a,140,a,36
ds_read_b128 a[180:183], v243 offset:41984
s_waitcnt lgkmcnt(9)
MV 156,a,144,a,32
buffer_load_dwordx2 v[212:213], v251, s[56:59], s72 offen offset:0 sc1
MV 160,a,144,a,36
ds_read_b128 a[184:187], v243 offset:43008
buffer_load_dwordx4 v238, s[48:51], s69 offen offset:1024 sc1 lds
s_waitcnt lgkmcnt(9)
MV 164,a,148,a,32
ds_read_b128 a[188:191], v243 offset:44032
MV 168,a,148,a,36
s_waitcnt lgkmcnt(9)
MV 172,a,152,a,32
MV 176,a,152,a,36
s_waitcnt lgkmcnt(8)
MV 180,a,156,a,32
buffer_load_dwordx4 a[32:35], v236, s[44:47], s68 offen offset:0 sc1
MV 184,a,156,a,36
buffer_load_dwordx4 a[36:39], v237, s[44:47], s68 offen offset:0 sc1
s_waitcnt vmcnt(17) lgkmcnt(0)
s_barrier
MV 124,a,160,a,40
ds_read_b128 a[128:131], v242 offset:49152
s_add_u32 s72, s79, 147456
MV 128,a,160,a,44
ds_read_b128 a[132:135], v242 offset:50176
buffer_load_dwordx4 v238, s[48:51], s69 offen offset:2048 sc1 lds
MV 132,a,164,a,40
MV 136,a,164,a,44
ds_read_b128 a[136:139], v242 offset:51200
MV 140,a,168,a,40
ds_read_b128 a[140:143], v242 offset:52224
MV 144,a,168,a,44
buffer_load_dwordx4 v238, s[48:51], s69 offen offset:3072 sc1 lds
MV 148,a,172,a,40
ds_read_b128 a[144:147], v243 offset:49152
MV 152,a,172,a,44
ds_read_b128 a[148:151], v243 offset:50176
MV 156,a,176,a,40
buffer_load_dwordx2 v[214:215], v251, s[56:59], s72 offen offset:0 sc1
MV 160,a,176,a,44
ds_read_b128 a[152:155], v243 offset:51200
s_add_u32 s69, s69, 16384
MV 164,a,180,a,40
ds_read_b128 a[156:159], v243 offset:52224
MV 168,a,180,a,44
MV 172,a,184,a,40
MV 176,a,184,a,44
MV 180,a,188,a,40
buffer_load_dwordx4 a[40:43], v236, s[44:47], s68 offen offset:1024 sc1
MV 184,a,188,a,44
buffer_load_dwordx4 a[44:47], v237, s[44:47], s68 offen offset:1024 sc1
s_add_u32 s68, s68, 2048
s_waitcnt lgkmcnt(7)
MV 124,a,128,a,48
ds_read_b128 a[160:163], v242 offset:57344
s_add_u32 s72, s79, 0
MV 128,a,128,a,52
ds_read_b128 a[164:167], v242 offset:58368
s_add_u32 m0, s70, 99328
s_waitcnt lgkmcnt(8)
MV 132,a,132,a,48
MV 136,a,132,a,52
ds_read_b128 a[168:171], v242 offset:59392
s_waitcnt lgkmcnt(8)
MV 140,a,136,a,48
ds_read_b128 a[172:175], v242 offset:60416
MV 144,a,136,a,52
buffer_load_dwordx4 v238, s[48:51], s69 offen offset:0 sc1 lds
s_waitcnt lgkmcnt(8)
MV 148,a,140,a,48
ds_read_b128 a[176:179], v243 offset:57344
MV 152,a,140,a,52
ds_read_b128 a[180:183], v243 offset:58368
s_waitcnt lgkmcnt(9)
MV 156,a,144,a,48
buffer_load_dwordx2 v[216:217], v251, s[56:59], s72 offen offset:128 sc1
MV 160,a,144,a,52
ds_read_b128 a[184:187], v243 offset:59392
buffer_load_dwordx4 v238, s[48:51], s69 offen offset:1024 sc1 lds
s_waitcnt lgkmcnt(9)
MV 164,a,148,a,48
ds_read_b128 a[188:191], v243 offset:60416
MV 168,a,148,a,52
s_waitcnt lgkmcnt(9)
MV 172,a,152,a,48
MV 176,a,152,a,52
s_waitcnt lgkmcnt(8)
MV 180,a,156,a,48
buffer_load_dwordx4 a[48:51], v236, s[44:47], s68 offen offset:0 sc1
MV 184,a,156,a,52
buffer_load_dwordx4 a[52:55], v237, s[44:47], s68 offen offset:0 sc1
s_waitcnt vmcnt(18) lgkmcnt(0)
s_barrier
MV 124,a,160,a,56
ds_read_b128 a[128:131], v242 offset:0
s_add_u32 s72, s79, 16384
MV 128,a,160,a,60
ds_read_b128 a[132:135], v242 offset:1024
buffer_load_dwordx4 v238, s[48:51], s69 offen offset:2048 sc1 lds
MV 132,a,164,a,56
MV 136,a,164,a,60
ds_read_b128 a[136:139], v242 offset:2048
MV 140,a,168,a,56
ds_read_b128 a[140:143], v242 offset:3072
MV 144,a,168,a,60
buffer_load_dwordx4 v238, s[48:51], s69 offen offset:3072 sc1 lds
MV 148,a,172,a,56
ds_read_b128 a[144:147], v243 offset:0
MV 152,a,172,a,60
ds_read_b128 a[148:151], v243 offset:1024
MV 156,a,176,a,56
buffer_load_dwordx2 v[218:219], v251, s[56:59], s72 offen offset:128 sc1
MV 160,a,176,a,60
ds_read_b128 a[152:155], v243 offset:2048
s_add_u32 s69, s69, 16384
MV 164,a,180,a,56
ds_read_b128 a[156:159], v243 offset:3072
MV 168,a,180,a,60
MV 172,a,184,a,56
MV 176,a,184,a,60
MV 180,a,188,a,56
buffer_load_dwordx4 a[56:59], v236, s[44:47], s68 offen offset:1024 sc1
MV 184,a,188,a,60
buffer_load_dwordx4 a[60:63], v237, s[44:47], s68 offen offset:1024 sc1
s_add_u32 s68, s68, 2048
s_waitcnt lgkmcnt(7)
MV 124,a,128,a,0
ds_read_b128 a[160:163], v242 offset:8192
s_add_u32 s72, s79, 131072
MV 128,a,128,a,4
ds_read_b128 a[164:167], v242 offset:9216
s_add_u32 m0, s70, 115712
s_waitcnt lgkmcnt(8)
MV 132,a,132,a,0
MV 136,a,132,a,4
ds_read_b128 a[168:171], v242 offset:10240
s_waitcnt lgkmcnt(8)
MV 140,a,136,a,0
ds_read_b128 a[172:175], v242 offset:11264
MV 144,a,136,a,4
buffer_load_dwordx4 v238, s[48:51], s69 offen offset:0 sc1 lds
s_waitcnt lgkmcnt(8)
MV 148,a,140,a,0
ds_read_b128 a[176:179], v243 offset:8192
MV 152,a,140,a,4
ds_read_b128 a[180:183], v243 offset:9216
s_waitcnt lgkmcnt(9)
MV 156,a,144,a,0
buffer_load_dwordx2 v[220:221], v251, s[56:59], s72 offen offset:128 sc1
MV 160,a,144,a,4
ds_read_b128 a[184:187], v243 offset:10240
buffer_load_dwordx4 v238, s[48:51], s69 offen offset:1024 sc1 lds
s_waitcnt lgkmcnt(9)
MV 164,a,148,a,0
ds_read_b128 a[188:191], v243 offset:11264
MV 168,a,148,a,4
s_waitcnt lgkmcnt(9)
MV 172,a,152,a,0
MV 176,a,152,a,4
s_waitcnt lgkmcnt(8)
MV 180,a,156,a,0
MV 184,a,156,a,4
s_waitcnt vmcnt(16) lgkmcnt(0)
s_barrier
MV 124,a,160,a,8
ds_read_b128 a[128:131], v242 offset:16384
s_add_u32 s72, s79, 147456
MV 128,a,160,a,12
ds_read_b128 a[132:135], v242 offset:17408
buffer_load_dwordx4 v238, s[48:51], s69 offen offset:2048 sc1 lds
MV 132,a,164,a,8
MV 136,a,164,a,12
ds_read_b128 a[136:139], v242 offset:18432
MV 140,a,168,a,8
ds_read_b128 a[140:143], v242 offset:19456
MV 144,a,168,a,12
buffer_load_dwordx4 v238, s[48:51], s69 offen offset:3072 sc1 lds
MV 148,a,172,a,8
ds_read_b128 a[144:147], v243 offset:16384
MV 152,a,172,a,12
ds_read_b128 a[148:151], v243 offset:17408
MV 156,a,176,a,8
buffer_load_dwordx2 v[222:223], v251, s[56:59], s72 offen offset:128 sc1
MV 160,a,176,a,12
ds_read_b128 a[152:155], v243 offset:18432
s_add_u32 s69, s69, 16384
MV 164,a,180,a,8
ds_read_b128 a[156:159], v243 offset:19456
MV 168,a,180,a,12
MV 172,a,184,a,8
MV 176,a,184,a,12
MV 180,a,188,a,8
MV 184,a,188,a,12
s_waitcnt lgkmcnt(7)
MV 124,a,128,a,16
ds_read_b128 a[160:163], v242 offset:24576
MV 128,a,128,a,20
ds_read_b128 a[164:167], v242 offset:25600
s_waitcnt lgkmcnt(8)
MV 132,a,132,a,16
MV 136,a,132,a,20
ds_read_b128 a[168:171], v242 offset:26624
s_waitcnt lgkmcnt(8)
MV 140,a,136,a,16
ds_read_b128 a[172:175], v242 offset:27648
MV 144,a,136,a,20
s_waitcnt lgkmcnt(8)
MV 148,a,140,a,16
ds_read_b128 a[176:179], v243 offset:24576
MV 152,a,140,a,20
ds_read_b128 a[180:183], v243 offset:25600
s_waitcnt lgkmcnt(9)
MV 156,a,144,a,16
MV 160,a,144,a,20
ds_read_b128 a[184:187], v243 offset:26624
s_waitcnt lgkmcnt(9)
MV 164,a,148,a,16
ds_read_b128 a[188:191], v243 offset:27648
MV 168,a,148,a,20
s_waitcnt lgkmcnt(9)
MV 172,a,152,a,16
MV 176,a,152,a,20
s_waitcnt lgkmcnt(8)
MV 180,a,156,a,16
MV 184,a,156,a,20
s_waitcnt vmcnt(9) lgkmcnt(0)
s_barrier
MV 124,a,160,a,24
ds_read_b128 a[128:131], v242 offset:32768
MV 128,a,160,a,28
ds_read_b128 a[132:135], v242 offset:33792
MV 132,a,164,a,24
MV 136,a,164,a,28
ds_read_b128 a[136:139], v242 offset:34816
MV 140,a,168,a,24
ds_read_b128 a[140:143], v242 offset:35840
MV 144,a,168,a,28
MV 148,a,172,a,24
ds_read_b128 a[144:147], v243 offset:32768
MV 152,a,172,a,28
ds_read_b128 a[148:151], v243 offset:33792
MV 156,a,176,a,24
MV 160,a,176,a,28
ds_read_b128 a[152:155], v243 offset:34816
MV 164,a,180,a,24
ds_read_b128 a[156:159], v243 offset:35840
MV 168,a,180,a,28
MV 172,a,184,a,24
MV 176,a,184,a,28
MV 180,a,188,a,24
MV 184,a,188,a,28
s_waitcnt lgkmcnt(7)
MV 124,a,128,a,32
ds_read_b128 a[160:163], v242 offset:40960
MV 128,a,128,a,36
ds_read_b128 a[164:167], v242 offset:41984
s_waitcnt lgkmcnt(8)
MV 132,a,132,a,32
MV 136,a,132,a,36
ds_read_b128 a[168:171], v242 offset:43008
s_waitcnt lgkmcnt(8)
MV 140,a,136,a,32
ds_read_b128 a[172:175], v242 offset:44032
MV 144,a,136,a,36
s_waitcnt lgkmcnt(8)
MV 148,a,140,a,32
ds_read_b128 a[176:179], v243 offset:40960
MV 152,a,140,a,36
ds_read_b128 a[180:183], v243 offset:41984
s_waitcnt lgkmcnt(9)
MV 156,a,144,a,32
MV 160,a,144,a,36
ds_read_b128 a[184:187], v243 offset:43008
s_waitcnt lgkmcnt(9)
MV 164,a,148,a,32
ds_read_b128 a[188:191], v243 offset:44032
MV 168,a,148,a,36
s_waitcnt lgkmcnt(9)
MV 172,a,152,a,32
MV 176,a,152,a,36
s_waitcnt lgkmcnt(8)
MV 180,a,156,a,32
MV 184,a,156,a,36
s_waitcnt vmcnt(1) lgkmcnt(0)
s_barrier
MV 124,a,160,a,40
ds_read_b128 a[128:131], v242 offset:49152
MV 128,a,160,a,44
ds_read_b128 a[132:135], v242 offset:50176
MV 132,a,164,a,40
MV 136,a,164,a,44
ds_read_b128 a[136:139], v242 offset:51200
MV 140,a,168,a,40
ds_read_b128 a[140:143], v242 offset:52224
MV 144,a,168,a,44
MV 148,a,172,a,40
ds_read_b128 a[144:147], v243 offset:49152
MV 152,a,172,a,44
ds_read_b128 a[148:151], v243 offset:50176
MV 156,a,176,a,40
MV 160,a,176,a,44
ds_read_b128 a[152:155], v243 offset:51200
MV 164,a,180,a,40
ds_read_b128 a[156:159], v243 offset:52224
MV 168,a,180,a,44
MV 172,a,184,a,40
MV 176,a,184,a,44
MV 180,a,188,a,40
MV 184,a,188,a,44
s_waitcnt lgkmcnt(7)
MV 124,a,128,a,48
ds_read_b128 a[160:163], v242 offset:57344
MV 128,a,128,a,52
ds_read_b128 a[164:167], v242 offset:58368
s_waitcnt lgkmcnt(8)
MV 132,a,132,a,48
MV 136,a,132,a,52
ds_read_b128 a[168:171], v242 offset:59392
s_waitcnt lgkmcnt(8)
MV 140,a,136,a,48
ds_read_b128 a[172:175], v242 offset:60416
MV 144,a,136,a,52
s_waitcnt lgkmcnt(8)
MV 148,a,140,a,48
ds_read_b128 a[176:179], v243 offset:57344
MV 152,a,140,a,52
ds_read_b128 a[180:183], v243 offset:58368
s_waitcnt lgkmcnt(9)
MV 156,a,144,a,48
MV 160,a,144,a,52
ds_read_b128 a[184:187], v243 offset:59392
s_waitcnt lgkmcnt(9)
MV 164,a,148,a,48
ds_read_b128 a[188:191], v243 offset:60416
MV 168,a,148,a,52
s_waitcnt lgkmcnt(9)
MV 172,a,152,a,48
MV 176,a,152,a,52
s_waitcnt lgkmcnt(8)
MV 180,a,156,a,48
MV 184,a,156,a,52
s_waitcnt lgkmcnt(3)
MV 156,a,176,a,56
MV 160,a,176,a,60
s_waitcnt lgkmcnt(2)
MV 164,a,180,a,56
MV 168,a,180,a,60
s_waitcnt lgkmcnt(1)
MV 172,a,184,a,56
MV 176,a,184,a,60
s_waitcnt lgkmcnt(0)
MV 180,a,188,a,56
MV 184,a,188,a,60
MV 124,a,160,a,56
MV 128,a,160,a,60
MV 132,a,164,a,56
MV 136,a,164,a,60
MV 140,a,168,a,56
MV 144,a,168,a,60
MV 148,a,172,a,56
MV 152,a,172,a,60
s_xor_b32 s72, s2, 4
s_lshl_b32 s72, s72, 14
v_cvt_pk_bf16_f32 v156, v156, v157
v_cvt_pk_bf16_f32 v157, v158, v159
v_cvt_pk_bf16_f32 v158, v160, v161
v_cvt_pk_bf16_f32 v159, v162, v163
buffer_store_dwordx4 v[156:159], v238, s[52:55], s72 offen offset:0 sc1
v_cvt_pk_bf16_f32 v164, v164, v165
v_cvt_pk_bf16_f32 v165, v166, v167
v_cvt_pk_bf16_f32 v166, v168, v169
v_cvt_pk_bf16_f32 v167, v170, v171
buffer_store_dwordx4 v[164:167], v238, s[52:55], s72 offen offset:1024 sc1
v_cvt_pk_bf16_f32 v172, v172, v173
v_cvt_pk_bf16_f32 v173, v174, v175
v_cvt_pk_bf16_f32 v174, v176, v177
v_cvt_pk_bf16_f32 v175, v178, v179
buffer_store_dwordx4 v[172:175], v238, s[52:55], s72 offen offset:2048 sc1
v_cvt_pk_bf16_f32 v180, v180, v181
v_cvt_pk_bf16_f32 v181, v182, v183
v_cvt_pk_bf16_f32 v182, v184, v185
v_cvt_pk_bf16_f32 v183, v186, v187
buffer_store_dwordx4 v[180:183], v238, s[52:55], s72 offen offset:3072 sc1
v_sub_f32 v226, 1.0, v224
v_lshlrev_b32 v36, 16, v192
v_lshlrev_b32 v228, 16, v208
v_and_b32 v37, 0xffff0000, v192
v_and_b32 v229, 0xffff0000, v208
v_mul_f32 v36, v36, v228
v_mul_f32 v37, v37, v229
v_mul_f32 v36, v36, v224
v_mul_f32 v37, v37, v224
v_lshlrev_b32 v38, 16, v193
v_lshlrev_b32 v228, 16, v209
v_and_b32 v39, 0xffff0000, v193
v_and_b32 v229, 0xffff0000, v209
v_mul_f32 v38, v38, v228
v_mul_f32 v39, v39, v229
v_mul_f32 v38, v38, v224
v_mul_f32 v39, v39, v224
v_lshlrev_b32 v40, 16, v194
v_lshlrev_b32 v228, 16, v210
v_and_b32 v41, 0xffff0000, v194
v_and_b32 v229, 0xffff0000, v210
v_mul_f32 v40, v40, v228
v_mul_f32 v41, v41, v229
v_mul_f32 v40, v40, v224
v_mul_f32 v41, v41, v224
v_lshlrev_b32 v42, 16, v195
v_lshlrev_b32 v228, 16, v211
v_and_b32 v43, 0xffff0000, v195
v_and_b32 v229, 0xffff0000, v211
v_mul_f32 v42, v42, v228
v_mul_f32 v43, v43, v229
v_mul_f32 v42, v42, v224
v_mul_f32 v43, v43, v224
v_lshlrev_b32 v44, 16, v196
v_lshlrev_b32 v228, 16, v212
v_and_b32 v45, 0xffff0000, v196
v_and_b32 v229, 0xffff0000, v212
v_mul_f32 v44, v44, v228
v_mul_f32 v45, v45, v229
v_mul_f32 v44, v44, v224
v_mul_f32 v45, v45, v224
v_lshlrev_b32 v46, 16, v197
v_lshlrev_b32 v228, 16, v213
v_and_b32 v47, 0xffff0000, v197
v_and_b32 v229, 0xffff0000, v213
v_mul_f32 v46, v46, v228
v_mul_f32 v47, v47, v229
v_mul_f32 v46, v46, v224
v_mul_f32 v47, v47, v224
v_lshlrev_b32 v48, 16, v198
v_lshlrev_b32 v228, 16, v214
v_and_b32 v49, 0xffff0000, v198
v_and_b32 v229, 0xffff0000, v214
v_mul_f32 v48, v48, v228
v_mul_f32 v49, v49, v229
v_mul_f32 v48, v48, v224
v_mul_f32 v49, v49, v224
v_lshlrev_b32 v50, 16, v199
v_lshlrev_b32 v228, 16, v215
v_and_b32 v51, 0xffff0000, v199
v_and_b32 v229, 0xffff0000, v215
v_mul_f32 v50, v50, v228
v_mul_f32 v51, v51, v229
v_mul_f32 v50, v50, v224
v_mul_f32 v51, v51, v224
v_sub_f32 v227, 1.0, v225
v_lshlrev_b32 v52, 16, v200
v_lshlrev_b32 v228, 16, v216
v_and_b32 v53, 0xffff0000, v200
v_and_b32 v229, 0xffff0000, v216
v_mul_f32 v52, v52, v228
v_mul_f32 v53, v53, v229
v_mul_f32 v52, v52, v225
v_mul_f32 v53, v53, v225
v_lshlrev_b32 v54, 16, v201
v_lshlrev_b32 v228, 16, v217
v_and_b32 v55, 0xffff0000, v201
v_and_b32 v229, 0xffff0000, v217
v_mul_f32 v54, v54, v228
v_mul_f32 v55, v55, v229
v_mul_f32 v54, v54, v225
v_mul_f32 v55, v55, v225
v_lshlrev_b32 v56, 16, v202
v_lshlrev_b32 v228, 16, v218
v_and_b32 v57, 0xffff0000, v202
v_and_b32 v229, 0xffff0000, v218
v_mul_f32 v56, v56, v228
v_mul_f32 v57, v57, v229
v_mul_f32 v56, v56, v225
v_mul_f32 v57, v57, v225
v_lshlrev_b32 v58, 16, v203
v_lshlrev_b32 v228, 16, v219
v_and_b32 v59, 0xffff0000, v203
v_and_b32 v229, 0xffff0000, v219
v_mul_f32 v58, v58, v228
v_mul_f32 v59, v59, v229
v_mul_f32 v58, v58, v225
v_mul_f32 v59, v59, v225
v_lshlrev_b32 v60, 16, v204
v_lshlrev_b32 v228, 16, v220
v_and_b32 v61, 0xffff0000, v204
v_and_b32 v229, 0xffff0000, v220
v_mul_f32 v60, v60, v228
v_mul_f32 v61, v61, v229
v_mul_f32 v60, v60, v225
v_mul_f32 v61, v61, v225
v_lshlrev_b32 v62, 16, v205
v_lshlrev_b32 v228, 16, v221
v_and_b32 v63, 0xffff0000, v205
v_and_b32 v229, 0xffff0000, v221
v_mul_f32 v62, v62, v228
v_mul_f32 v63, v63, v229
v_mul_f32 v62, v62, v225
v_mul_f32 v63, v63, v225
v_lshlrev_b32 v64, 16, v206
s_waitcnt vmcnt(4)
v_lshlrev_b32 v228, 16, v222
v_and_b32 v65, 0xffff0000, v206
v_and_b32 v229, 0xffff0000, v222
v_mul_f32 v64, v64, v228
v_mul_f32 v65, v65, v229
v_mul_f32 v64, v64, v225
v_mul_f32 v65, v65, v225
v_lshlrev_b32 v66, 16, v207
v_lshlrev_b32 v228, 16, v223
v_and_b32 v67, 0xffff0000, v207
v_and_b32 v229, 0xffff0000, v223
v_mul_f32 v66, v66, v228
v_mul_f32 v67, v67, v229
v_mul_f32 v66, v66, v225
v_mul_f32 v67, v67, v225
s_lshl_b32 s72, s2, 14
s_mov_b32 s73, 400000
L_xb:
buffer_load_dwordx4 v[76:79], v238, s[52:55], s72 offen offset:0 sc1
buffer_load_dwordx4 v[80:83], v238, s[52:55], s72 offen offset:1024 sc1
buffer_load_dwordx4 v[84:87], v238, s[52:55], s72 offen offset:2048 sc1
buffer_load_dwordx4 v[88:91], v238, s[52:55], s72 offen offset:3072 sc1
s_sub_u32 s73, s73, 1
s_cbranch_scc1 L_xb_done
s_waitcnt vmcnt(3)
v_max3_u32 v228, v76, v77, v78
s_waitcnt vmcnt(2)
v_max3_u32 v228, v228, v79, v80
v_max3_u32 v228, v228, v81, v82
s_waitcnt vmcnt(1)
v_max3_u32 v228, v228, v83, v84
v_max3_u32 v228, v228, v85, v86
s_waitcnt vmcnt(0)
v_max3_u32 v228, v228, v87, v88
v_max3_u32 v228, v228, v89, v90
v_max_u32 v228, v228, v91
v_cmp_eq_u32 vcc, -1, v228
s_nop 4
s_cbranch_vccnz L_xb
L_xb_done:
s_waitcnt vmcnt(0)
v_lshlrev_b32 v92, 16, v76
v_and_b32 v93, 0xffff0000, v76
v_add_f32 v124, v124, v92
v_add_f32 v125, v125, v93
v_lshlrev_b32 v92, 16, v77
v_and_b32 v93, 0xffff0000, v77
v_add_f32 v126, v126, v92
v_add_f32 v127, v127, v93
v_lshlrev_b32 v92, 16, v78
v_and_b32 v93, 0xffff0000, v78
v_add_f32 v128, v128, v92
v_add_f32 v129, v129, v93
v_lshlrev_b32 v92, 16, v79
v_and_b32 v93, 0xffff0000, v79
v_add_f32 v130, v130, v92
v_add_f32 v131, v131, v93
v_lshlrev_b32 v92, 16, v80
v_and_b32 v93, 0xffff0000, v80
v_add_f32 v132, v132, v92
v_add_f32 v133, v133, v93
v_lshlrev_b32 v92, 16, v81
v_and_b32 v93, 0xffff0000, v81
v_add_f32 v134, v134, v92
v_add_f32 v135, v135, v93
v_lshlrev_b32 v92, 16, v82
v_and_b32 v93, 0xffff0000, v82
v_add_f32 v136, v136, v92
v_add_f32 v137, v137, v93
v_lshlrev_b32 v92, 16, v83
v_and_b32 v93, 0xffff0000, v83
v_add_f32 v138, v138, v92
v_add_f32 v139, v139, v93
v_lshlrev_b32 v92, 16, v84
v_and_b32 v93, 0xffff0000, v84
v_add_f32 v140, v140, v92
v_add_f32 v141, v141, v93
v_lshlrev_b32 v92, 16, v85
v_and_b32 v93, 0xffff0000, v85
v_add_f32 v142, v142, v92
v_add_f32 v143, v143, v93
v_lshlrev_b32 v92, 16, v86
v_and_b32 v93, 0xffff0000, v86
v_add_f32 v144, v144, v92
v_add_f32 v145, v145, v93
v_lshlrev_b32 v92, 16, v87
v_and_b32 v93, 0xffff0000, v87
v_add_f32 v146, v146, v92
v_add_f32 v147, v147, v93
v_lshlrev_b32 v92, 16, v88
v_and_b32 v93, 0xffff0000, v88
v_add_f32 v148, v148, v92
v_add_f32 v149, v149, v93
v_lshlrev_b32 v92, 16, v89
v_and_b32 v93, 0xffff0000, v89
v_add_f32 v150, v150, v92
v_add_f32 v151, v151, v93
v_lshlrev_b32 v92, 16, v90
v_and_b32 v93, 0xffff0000, v90
v_add_f32 v152, v152, v92
v_add_f32 v153, v153, v93
v_lshlrev_b32 v92, 16, v91
v_and_b32 v93, 0xffff0000, v91
v_add_f32 v154, v154, v92
v_add_f32 v155, v155, v93
v_permlane16_swap_b32 v124, v132
v_permlane16_swap_b32 v125, v133
v_permlane16_swap_b32 v126, v134
v_permlane16_swap_b32 v127, v135
v_permlane16_swap_b32 v140, v148
v_permlane16_swap_b32 v141, v149
v_permlane16_swap_b32 v142, v150
v_permlane16_swap_b32 v143, v151
v_permlane16_swap_b32 v128, v136
v_permlane16_swap_b32 v129, v137
v_permlane16_swap_b32 v130, v138
v_permlane16_swap_b32 v131, v139
v_permlane16_swap_b32 v144, v152
v_permlane16_swap_b32 v145, v153
v_permlane16_swap_b32 v146, v154
v_permlane16_swap_b32 v147, v155
s_add_u32 s72, s78, 0
v_fma_f32 v36, v124, v226, v36
v_fma_f32 v37, v125, v226, v37
v_fma_f32 v38, v126, v226, v38
v_fma_f32 v39, v127, v226, v39
v_fma_f32 v40, v132, v226, v40
v_fma_f32 v41, v133, v226, v41
v_fma_f32 v42, v134, v226, v42
v_fma_f32 v43, v135, v226, v43
v_cvt_pk_bf16_f32 v192, v36, v37
v_cvt_pk_bf16_f32 v193, v38, v39
v_cvt_pk_bf16_f32 v194, v40, v41
v_cvt_pk_bf16_f32 v195, v42, v43
buffer_store_dwordx4 v[192:195], v250, s[60:63], s72 offen offset:0
v_fma_f32 v44, v140, v226, v44
v_fma_f32 v45, v141, v226, v45
v_fma_f32 v46, v142, v226, v46
v_fma_f32 v47, v143, v226, v47
v_fma_f32 v48, v148, v226, v48
v_fma_f32 v49, v149, v226, v49
v_fma_f32 v50, v150, v226, v50
v_fma_f32 v51, v151, v226, v51
v_cvt_pk_bf16_f32 v196, v44, v45
v_cvt_pk_bf16_f32 v197, v46, v47
v_cvt_pk_bf16_f32 v198, v48, v49
v_cvt_pk_bf16_f32 v199, v50, v51
buffer_store_dwordx4 v[196:199], v250, s[60:63], s72 offen offset:64
s_add_u32 s72, s78, 32768
v_fma_f32 v52, v128, v227, v52
v_fma_f32 v53, v129, v227, v53
v_fma_f32 v54, v130, v227, v54
v_fma_f32 v55, v131, v227, v55
v_fma_f32 v56, v136, v227, v56
v_fma_f32 v57, v137, v227, v57
v_fma_f32 v58, v138, v227, v58
v_fma_f32 v59, v139, v227, v59
v_cvt_pk_bf16_f32 v200, v52, v53
v_cvt_pk_bf16_f32 v201, v54, v55
v_cvt_pk_bf16_f32 v202, v56, v57
v_cvt_pk_bf16_f32 v203, v58, v59
buffer_store_dwordx4 v[200:203], v250, s[60:63], s72 offen offset:0
v_fma_f32 v60, v144, v227, v60
v_fma_f32 v61, v145, v227, v61
v_fma_f32 v62, v146, v227, v62
v_fma_f32 v63, v147, v227, v63
v_fma_f32 v64, v152, v227, v64
v_fma_f32 v65, v153, v227, v65
v_fma_f32 v66, v154, v227, v66
v_fma_f32 v67, v155, v227, v67
v_cvt_pk_bf16_f32 v204, v60, v61
v_cvt_pk_bf16_f32 v205, v62, v63
v_cvt_pk_bf16_f32 v206, v64, v65
v_cvt_pk_bf16_f32 v207, v66, v67
buffer_store_dwordx4 v[204:207], v250, s[60:63], s72 offen offset:64
L_end:
s_endpgm
L_p3_pmask:
s_nop 7
v_add_u32 v246, 0, v13
v_cmp_gt_i32_e64 s[84:85], 0, v246
v_cmp_gt_i32_e64 s[86:87], 1, v246
v_cmp_gt_i32_e64 s[88:89], 2, v246
v_cmp_gt_i32_e64 s[90:91], 3, v246
v_cndmask_b32_e64 v96, v96, v14, s[84:85]
v_cndmask_b32_e64 v97, v97, v14, s[86:87]
v_cndmask_b32_e64 v98, v98, v14, s[88:89]
v_cndmask_b32_e64 v99, v99, v14, s[90:91]
v_cmp_gt_i32_e64 s[92:93], 16, v246
v_cmp_gt_i32_e64 s[94:95], 17, v246
v_cmp_gt_i32_e64 s[96:97], 18, v246
v_cmp_gt_i32_e64 s[98:99], 19, v246
v_cndmask_b32_e64 v100, v100, v14, s[92:93]
v_cndmask_b32_e64 v101, v101, v14, s[94:95]
v_cndmask_b32_e64 v102, v102, v14, s[96:97]
v_cndmask_b32_e64 v103, v103, v14, s[98:99]
v_cmp_gt_i32_e64 s[84:85], 8, v246
v_cmp_gt_i32_e64 s[86:87], 9, v246
v_cmp_gt_i32_e64 s[88:89], 10, v246
v_cmp_gt_i32_e64 s[90:91], 11, v246
v_cndmask_b32_e64 v104, v104, v14, s[84:85]
v_cndmask_b32_e64 v105, v105, v14, s[86:87]
v_cndmask_b32_e64 v106, v106, v14, s[88:89]
v_cndmask_b32_e64 v107, v107, v14, s[90:91]
v_cmp_gt_i32_e64 s[92:93], 24, v246
v_cmp_gt_i32_e64 s[94:95], 25, v246
v_cmp_gt_i32_e64 s[96:97], 26, v246
v_cmp_gt_i32_e64 s[98:99], 27, v246
v_cndmask_b32_e64 v108, v108, v14, s[92:93]
v_cndmask_b32_e64 v109, v109, v14, s[94:95]
v_cndmask_b32_e64 v110, v110, v14, s[96:97]
v_cndmask_b32_e64 v111, v111, v14, s[98:99]
v_add_u32 v247, -32, v13
v_cmp_gt_i32_e64 s[84:85], 0, v247
v_cmp_gt_i32_e64 s[86:87], 1, v247
v_cmp_gt_i32_e64 s[88:89], 2, v247
v_cmp_gt_i32_e64 s[90:91], 3, v247
v_cndmask_b32_e64 v128, v128, v14, s[84:85]
v_cndmask_b32_e64 v129, v129, v14, s[86:87]
v_cndmask_b32_e64 v130, v130, v14, s[88:89]
v_cndmask_b32_e64 v131, v131, v14, s[90:91]
v_cmp_gt_i32_e64 s[92:93], 16, v247
v_cmp_gt_i32_e64 s[94:95], 17, v247
v_cmp_gt_i32_e64 s[96:97], 18, v247
v_cmp_gt_i32_e64 s[98:99], 19, v247
v_cndmask_b32_e64 v132, v132, v14, s[92:93]
v_cndmask_b32_e64 v133, v133, v14, s[94:95]
v_cndmask_b32_e64 v134, v134, v14, s[96:97]
v_cndmask_b32_e64 v135, v135, v14, s[98:99]
v_cmp_gt_i32_e64 s[84:85], 8, v247
v_cmp_gt_i32_e64 s[86:87], 9, v247
v_cmp_gt_i32_e64 s[88:89], 10, v247
v_cmp_gt_i32_e64 s[90:91], 11, v247
v_cndmask_b32_e64 v136, v136, v14, s[84:85]
v_cndmask_b32_e64 v137, v137, v14, s[86:87]
v_cndmask_b32_e64 v138, v138, v14, s[88:89]
v_cndmask_b32_e64 v139, v139, v14, s[90:91]
v_cmp_gt_i32_e64 s[92:93], 24, v247
v_cmp_gt_i32_e64 s[94:95], 25, v247
v_cmp_gt_i32_e64 s[96:97], 26, v247
v_cmp_gt_i32_e64 s[98:99], 27, v247
v_cndmask_b32_e64 v140, v140, v14, s[92:93]
v_cndmask_b32_e64 v141, v141, v14, s[94:95]
v_cndmask_b32_e64 v142, v142, v14, s[96:97]
v_cndmask_b32_e64 v143, v143, v14, s[98:99]
s_branch L_p3_pmask_ret
L_p3_pfix:
v_sub_f32 v208, 0, v6
v_sub_f32 v209, 0, v6
v_sub_f32 v210, 0, v6
v_sub_f32 v211, 0, v6
v_sub_f32 v212, 0, v6
v_sub_f32 v213, 0, v6
v_sub_f32 v214, 0, v6
v_sub_f32 v215, 0, v6
v_sub_f32 v216, 0, v6
v_sub_f32 v217, 0, v6
v_sub_f32 v218, 0, v6
v_sub_f32 v219, 0, v6
v_sub_f32 v220, 0, v6
v_sub_f32 v221, 0, v6
v_sub_f32 v222, 0, v6
v_sub_f32 v223, 0, v6
v_sub_f32 v80, v80, v6
v_sub_f32 v81, v81, v6
v_sub_f32 v82, v82, v6
v_sub_f32 v83, v83, v6
v_sub_f32 v84, v84, v6
v_sub_f32 v85, v85, v6
v_sub_f32 v86, v86, v6
v_sub_f32 v87, v87, v6
v_sub_f32 v88, v88, v6
v_sub_f32 v89, v89, v6
v_sub_f32 v90, v90, v6
v_sub_f32 v91, v91, v6
v_sub_f32 v92, v92, v6
v_sub_f32 v93, v93, v6
v_sub_f32 v94, v94, v6
v_sub_f32 v95, v95, v6
v_sub_f32 v112, v112, v6
v_sub_f32 v113, v113, v6
v_sub_f32 v114, v114, v6
v_sub_f32 v115, v115, v6
v_sub_f32 v116, v116, v6
v_sub_f32 v117, v117, v6
v_sub_f32 v118, v118, v6
v_sub_f32 v119, v119, v6
v_sub_f32 v120, v120, v6
v_sub_f32 v121, v121, v6
v_sub_f32 v122, v122, v6
v_sub_f32 v123, v123, v6
v_sub_f32 v124, v124, v6
v_sub_f32 v125, v125, v6
v_sub_f32 v126, v126, v6
v_sub_f32 v127, v127, v6
v_sub_f32 v224, 0, v7
v_sub_f32 v225, 0, v7
v_sub_f32 v226, 0, v7
v_sub_f32 v227, 0, v7
v_sub_f32 v228, 0, v7
v_sub_f32 v229, 0, v7
v_sub_f32 v230, 0, v7
v_sub_f32 v231, 0, v7
v_sub_f32 v232, 0, v7
v_sub_f32 v233, 0, v7
v_sub_f32 v234, 0, v7
v_sub_f32 v235, 0, v7
v_sub_f32 v236, 0, v7
v_sub_f32 v237, 0, v7
v_sub_f32 v238, 0, v7
v_sub_f32 v239, 0, v7
v_sub_f32 v96, v96, v7
v_sub_f32 v97, v97, v7
v_sub_f32 v98, v98, v7
v_sub_f32 v99, v99, v7
v_sub_f32 v100, v100, v7
v_sub_f32 v101, v101, v7
v_sub_f32 v102, v102, v7
v_sub_f32 v103, v103, v7
v_sub_f32 v104, v104, v7
v_sub_f32 v105, v105, v7
v_sub_f32 v106, v106, v7
v_sub_f32 v107, v107, v7
v_sub_f32 v108, v108, v7
v_sub_f32 v109, v109, v7
v_sub_f32 v110, v110, v7
v_sub_f32 v111, v111, v7
v_sub_f32 v128, v128, v7
v_sub_f32 v129, v129, v7
v_sub_f32 v130, v130, v7
v_sub_f32 v131, v131, v7
v_sub_f32 v132, v132, v7
v_sub_f32 v133, v133, v7
v_sub_f32 v134, v134, v7
v_sub_f32 v135, v135, v7
v_sub_f32 v136, v136, v7
v_sub_f32 v137, v137, v7
v_sub_f32 v138, v138, v7
v_sub_f32 v139, v139, v7
v_sub_f32 v140, v140, v7
v_sub_f32 v141, v141, v7
v_sub_f32 v142, v142, v7
v_sub_f32 v143, v143, v7
s_branch L_p3_pfix_ret
L_p3_mxm_top:
s_waitcnt lgkmcnt(0)
v_xor_b32 v11, 0x8000, v11
v_mfma_f32_32x32x16_bf16 v[80:95], a[128:131], v[16:19], v[208:223]
s_add_u32 m0, s73, 16384
ds_read_b128 a[192:195], v11 offset:0
ds_read_b128 a[196:199], v11 offset:1024
v_exp_f32 v168, v168
v_mfma_f32_32x32x16_bf16 v[80:95], a[132:135], v[20:23], v[80:95]
ds_read_b128 a[200:203], v11 offset:2048
buffer_load_dwordx4 v12, s[56:59], s71 offen offset:0 sc1 lds
v_exp_f32 v169, v169
v_exp_f32 v170, v170
v_mfma_f32_32x32x16_bf16 v[80:95], a[136:139], v[24:27], v[80:95]
ds_read_b128 a[204:207], v11 offset:3072
ds_read_b128 a[208:211], v11 offset:4096
v_add_f32 v4, v4, v168
v_exp_f32 v171, v171
v_add_f32 v5, v5, v169
v_mfma_f32_32x32x16_bf16 v[80:95], a[140:143], v[28:31], v[80:95]
ds_read_b128 a[212:215], v11 offset:5120
buffer_load_dwordx4 v12, s[56:59], s71 offen offset:1024 sc1 lds
v_cvt_pk_bf16_f32 v168, v168, v169
v_exp_f32 v172, v172
v_add_f32 v4, v4, v170
v_mfma_f32_32x32x16_bf16 v[80:95], a[144:147], v[32:35], v[80:95]
ds_read_b128 a[216:219], v11 offset:6144
ds_read_b128 a[220:223], v11 offset:7168
v_exp_f32 v173, v173
v_add_f32 v5, v5, v171
v_cvt_pk_bf16_f32 v169, v170, v171
v_mfma_f32_32x32x16_bf16 v[80:95], a[148:151], v[36:39], v[80:95]
ds_read_b128 a[224:227], v11 offset:8192
v_exp_f32 v174, v174
v_add_f32 v4, v4, v172
v_exp_f32 v175, v175
v_mfma_f32_32x32x16_bf16 v[80:95], a[152:155], v[40:43], v[80:95]
ds_read_b128 a[228:231], v11 offset:9216
ds_read_b128 a[232:235], v11 offset:10240
buffer_load_dwordx4 v12, s[56:59], s71 offen offset:2048 sc1 lds
v_add_f32 v5, v5, v173
v_cvt_pk_bf16_f32 v170, v172, v173
v_mfma_f32_32x32x16_bf16 v[80:95], a[156:159], v[44:47], v[80:95]
ds_read_b128 a[236:239], v11 offset:11264
v_exp_f32 v176, v176
v_add_f32 v4, v4, v174
v_exp_f32 v177, v177
v_mfma_f32_32x32x16_bf16 v[112:127], a[160:163], v[16:19], v[208:223]
ds_read_b128 a[240:243], v11 offset:12288
ds_read_b128 a[244:247], v11 offset:13312
buffer_load_dwordx4 v12, s[56:59], s71 offen offset:3072 sc1 lds
v_add_f32 v5, v5, v175
v_cvt_pk_bf16_f32 v171, v174, v175
v_mfma_f32_32x32x16_bf16 v[112:127], a[164:167], v[20:23], v[112:127]
ds_read_b128 a[248:251], v11 offset:14336
v_exp_f32 v178, v178
v_add_f32 v2, v2, v176
v_exp_f32 v179, v179
v_mfma_f32_32x32x16_bf16 v[112:127], a[168:171], v[24:27], v[112:127]
ds_read_b128 a[252:255], v11 offset:15360
v_add_f32 v3, v3, v177
v_cvt_pk_bf16_f32 v176, v176, v177
v_exp_f32 v180, v180
v_add_f32 v2, v2, v178
v_mfma_f32_32x32x16_bf16 v[112:127], a[172:175], v[28:31], v[112:127]
s_add_u32 s71, s71, 16384
v_exp_f32 v181, v181
v_add_f32 v3, v3, v179
v_cvt_pk_bf16_f32 v177, v178, v179
v_add_u32 v246, 0, v13
v_mfma_f32_32x32x16_bf16 v[112:127], a[176:179], v[32:35], v[112:127]
v_exp_f32 v182, v182
v_add_f32 v2, v2, v180
v_exp_f32 v183, v183
v_add_f32 v3, v3, v181
v_mfma_f32_32x32x16_bf16 v[112:127], a[180:183], v[36:39], v[112:127]
s_xor_b32 s73, s73, 0x8000
v_cvt_pk_bf16_f32 v178, v180, v181
v_exp_f32 v184, v184
v_add_f32 v2, v2, v182
v_cmp_gt_i32_e64 s[84:85], 0, v246
v_mfma_f32_32x32x16_bf16 v[112:127], a[184:187], v[40:43], v[112:127]
v_exp_f32 v185, v185
v_add_f32 v3, v3, v183
v_cvt_pk_bf16_f32 v179, v182, v183
v_exp_f32 v186, v186
v_mfma_f32_32x32x16_bf16 v[112:127], a[188:191], v[44:47], v[112:127]
v_add_f32 v2, v2, v184
v_exp_f32 v187, v187
v_add_f32 v3, v3, v185
v_cvt_pk_bf16_f32 v184, v184, v185
v_exp_f32 v188, v188
v_add_f32 v2, v2, v186
v_exp_f32 v189, v189
v_add_f32 v3, v3, v187
v_cvt_pk_bf16_f32 v185, v186, v187
v_exp_f32 v190, v190
v_add_f32 v2, v2, v188
v_exp_f32 v191, v191
v_add_f32 v3, v3, v189
v_cvt_pk_bf16_f32 v186, v188, v189
v_exp_f32 v192, v192
v_add_f32 v2, v2, v190
v_exp_f32 v193, v193
v_add_f32 v3, v3, v191
v_cvt_pk_bf16_f32 v187, v190, v191
v_exp_f32 v194, v194
v_add_f32 v4, v4, v192
v_exp_f32 v195, v195
v_add_f32 v5, v5, v193
v_cvt_pk_bf16_f32 v192, v192, v193
v_exp_f32 v196, v196
v_add_f32 v4, v4, v194
v_exp_f32 v197, v197
v_add_f32 v5, v5, v195
v_cvt_pk_bf16_f32 v193, v194, v195
v_exp_f32 v198, v198
v_add_f32 v4, v4, v196
v_cmp_gt_i32_e64 s[86:87], 1, v246
v_cmp_gt_i32_e64 s[88:89], 2, v246
v_cmp_gt_i32_e64 s[90:91], 3, v246
v_cndmask_b32_e64 v80, v80, v14, s[84:85]
v_cndmask_b32_e64 v81, v81, v14, s[86:87]
v_exp_f32 v199, v199
v_add_f32 v5, v5, v197
v_cvt_pk_bf16_f32 v194, v196, v197
v_exp_f32 v200, v200
v_add_f32 v4, v4, v198
v_exp_f32 v201, v201
v_cndmask_b32_e64 v82, v82, v14, s[88:89]
v_cndmask_b32_e64 v83, v83, v14, s[90:91]
v_cmp_gt_i32_e64 s[92:93], 16, v246
v_cmp_gt_i32_e64 s[94:95], 17, v246
v_cmp_gt_i32_e64 s[96:97], 18, v246
v_cmp_gt_i32_e64 s[98:99], 19, v246
v_cndmask_b32_e64 v84, v84, v14, s[92:93]
v_add_f32 v5, v5, v199
v_cvt_pk_bf16_f32 v195, v198, v199
v_exp_f32 v202, v202
v_add_f32 v4, v4, v200
v_exp_f32 v203, v203
v_add_f32 v5, v5, v201
v_cvt_pk_bf16_f32 v200, v200, v201
v_cndmask_b32_e64 v85, v85, v14, s[94:95]
v_cndmask_b32_e64 v86, v86, v14, s[96:97]
v_cndmask_b32_e64 v87, v87, v14, s[98:99]
v_cmp_gt_i32_e64 s[84:85], 8, v246
v_cmp_gt_i32_e64 s[86:87], 9, v246
v_cmp_gt_i32_e64 s[88:89], 10, v246
v_exp_f32 v204, v204
v_add_f32 v4, v4, v202
v_exp_f32 v205, v205
v_add_f32 v5, v5, v203
v_cvt_pk_bf16_f32 v201, v202, v203
v_exp_f32 v206, v206
v_cmp_gt_i32_e64 s[90:91], 11, v246
v_cndmask_b32_e64 v88, v88, v14, s[84:85]
v_cndmask_b32_e64 v89, v89, v14, s[86:87]
v_cndmask_b32_e64 v90, v90, v14, s[88:89]
v_cndmask_b32_e64 v91, v91, v14, s[90:91]
v_cmp_gt_i32_e64 s[92:93], 24, v246
v_cmp_gt_i32_e64 s[94:95], 25, v246
v_add_f32 v4, v4, v204
v_exp_f32 v207, v207
v_add_f32 v5, v5, v205
v_cvt_pk_bf16_f32 v202, v204, v205
v_add_f32 v4, v4, v206
v_add_f32 v5, v5, v207
v_cvt_pk_bf16_f32 v203, v206, v207
v_cmp_gt_i32_e64 s[96:97], 26, v246
v_cmp_gt_i32_e64 s[98:99], 27, v246
v_cndmask_b32_e64 v92, v92, v14, s[92:93]
v_cndmask_b32_e64 v93, v93, v14, s[94:95]
v_cndmask_b32_e64 v94, v94, v14, s[96:97]
v_cndmask_b32_e64 v95, v95, v14, s[98:99]
s_waitcnt vmcnt(16) lgkmcnt(0)
v_mfma_f32_32x32x16_bf16 a[0:15], a[192:195], v[144:147], a[0:15]
s_barrier
v_xor_b32 v10, 0x8000, v10
v_mfma_f32_32x32x16_bf16 a[64:79], a[192:195], v[160:163], a[64:79]
ds_read_b128 a[128:131], v10 offset:0
v_max3_f32 v6, v80, v81, v82
v_max3_f32 v6, v6, v83, v84
v_max3_f32 v6, v6, v85, v86
v_max3_f32 v6, v6, v87, v88
v_max3_f32 v6, v6, v89, v90
v_mfma_f32_32x32x16_bf16 a[16:31], a[196:199], v[144:147], a[16:31]
ds_read_b128 a[132:135], v10 offset:1024
v_max3_f32 v6, v6, v91, v92
v_max3_f32 v6, v6, v93, v94
v_add_u32 v247, -32, v13
v_cmp_gt_i32_e64 s[84:85], 0, v247
v_cmp_gt_i32_e64 s[86:87], 1, v247
v_mfma_f32_32x32x16_bf16 a[80:95], a[196:199], v[160:163], a[80:95]
v_cmp_gt_i32_e64 s[88:89], 2, v247
v_cmp_gt_i32_e64 s[90:91], 3, v247
v_cndmask_b32_e64 v112, v112, v14, s[84:85]
v_cndmask_b32_e64 v113, v113, v14, s[86:87]
v_cndmask_b32_e64 v114, v114, v14, s[88:89]
v_mfma_f32_32x32x16_bf16 a[32:47], a[200:203], v[144:147], a[32:47]
ds_read_b128 a[136:139], v10 offset:2048
v_cndmask_b32_e64 v115, v115, v14, s[90:91]
v_cmp_gt_i32_e64 s[92:93], 16, v247
v_cmp_gt_i32_e64 s[94:95], 17, v247
v_cmp_gt_i32_e64 s[96:97], 18, v247
v_cmp_gt_i32_e64 s[98:99], 19, v247
v_mfma_f32_32x32x16_bf16 a[96:111], a[200:203], v[160:163], a[96:111]
v_cndmask_b32_e64 v116, v116, v14, s[92:93]
v_cndmask_b32_e64 v117, v117, v14, s[94:95]
v_cndmask_b32_e64 v118, v118, v14, s[96:97]
v_cndmask_b32_e64 v119, v119, v14, s[98:99]
v_cmp_gt_i32_e64 s[84:85], 8, v247
v_mfma_f32_32x32x16_bf16 a[48:63], a[204:207], v[144:147], a[48:63]
ds_read_b128 a[140:143], v10 offset:3072
v_cmp_gt_i32_e64 s[86:87], 9, v247
v_cmp_gt_i32_e64 s[88:89], 10, v247
v_cmp_gt_i32_e64 s[90:91], 11, v247
v_cndmask_b32_e64 v120, v120, v14, s[84:85]
v_cndmask_b32_e64 v121, v121, v14, s[86:87]
v_mfma_f32_32x32x16_bf16 a[112:127], a[204:207], v[160:163], a[112:127]
ds_read_b128 a[144:147], v10 offset:4096
v_cndmask_b32_e64 v122, v122, v14, s[88:89]
v_cndmask_b32_e64 v123, v123, v14, s[90:91]
v_cmp_gt_i32_e64 s[92:93], 24, v247
v_cmp_gt_i32_e64 s[94:95], 25, v247
v_cmp_gt_i32_e64 s[96:97], 26, v247
v_mfma_f32_32x32x16_bf16 a[0:15], a[208:211], v[152:155], a[0:15]
v_cmp_gt_i32_e64 s[98:99], 27, v247
v_cndmask_b32_e64 v124, v124, v14, s[92:93]
v_cndmask_b32_e64 v125, v125, v14, s[94:95]
v_cndmask_b32_e64 v126, v126, v14, s[96:97]
v_cndmask_b32_e64 v127, v127, v14, s[98:99]
v_mfma_f32_32x32x16_bf16 a[64:79], a[208:211], v[168:171], a[64:79]
ds_read_b128 a[148:151], v10 offset:5120
v_max3_f32 v6, v6, v95, v112
v_max3_f32 v6, v6, v113, v114
v_max3_f32 v6, v6, v115, v116
v_max3_f32 v6, v6, v117, v118
v_max3_f32 v6, v6, v119, v120
v_mfma_f32_32x32x16_bf16 a[16:31], a[212:215], v[152:155], a[16:31]
v_max3_f32 v6, v6, v121, v122
v_max3_f32 v6, v6, v123, v124
v_max3_f32 v6, v6, v125, v126
v_max_f32 v6, v6, v127
v_cmp_lt_f32 vcc, s79, v6
v_mfma_f32_32x32x16_bf16 a[80:95], a[212:215], v[168:171], a[80:95]
s_cbranch_vccnz L_p3_mxm_rare
s_add_u32 m0, s72, 16384
ds_read_b128 a[152:155], v10 offset:6144
v_exp_f32 v80, v80
v_bfe_u32 v248, v1, 2, 2
v_bfe_u32 v249, v1, 4, 1
v_mfma_f32_32x32x16_bf16 a[32:47], a[216:219], v[152:155], a[32:47]
ds_read_b128 a[156:159], v10 offset:7168
buffer_load_dwordx4 v12, s[52:55], s71 offen offset:0 sc1 lds
v_lshl_add_u32 v248, v249, 2, v248
v_lshrrev_b32 v249, 5, v1
v_lshl_add_u32 v249, v249, 4, v248
v_lshlrev_b32 v249, 8, v249
v_mfma_f32_32x32x16_bf16 a[96:111], a[216:219], v[168:171], a[96:111]
v_exp_f32 v81, v81
v_and_b32 v250, 3, v1
v_lshl_add_u32 v249, v250, 3, v249
s_lshl_b32 s36, s3, 13
s_add_u32 s36, s36, 131072
v_mfma_f32_32x32x16_bf16 a[48:63], a[220:223], v[152:155], a[48:63]
ds_read_b128 a[160:163], v10 offset:8192
v_exp_f32 v82, v82
v_add_u32 v249, s36, v249
s_nop 0
v_xor_b32 v250, 0, v248
v_mfma_f32_32x32x16_bf16 a[112:127], a[220:223], v[168:171], a[112:127]
v_add_f32 v2, v2, v80
v_exp_f32 v83, v83
v_lshl_add_u32 v250, v250, 5, v249
TR 96,250,0
TR 98,250,2048
v_mfma_f32_32x32x16_bf16 a[0:15], a[224:227], v[176:179], a[0:15]
ds_read_b128 a[164:167], v10 offset:9216
buffer_load_dwordx4 v12, s[52:55], s71 offen offset:1024 sc1 lds
v_xor_b32 v250, 1, v248
v_add_f32 v3, v3, v81
v_lshl_add_u32 v250, v250, 5, v249
TR 100,250,0
v_mfma_f32_32x32x16_bf16 a[64:79], a[224:227], v[192:195], a[64:79]
ds_read_b128 a[168:171], v10 offset:10240
TR 102,250,2048
v_xor_b32 v250, 2, v248
v_lshl_add_u32 v250, v250, 5, v249
v_cvt_pk_bf16_f32 v80, v80, v81
TR 104,250,0
v_mfma_f32_32x32x16_bf16 a[16:31], a[228:231], v[176:179], a[16:31]
v_exp_f32 v84, v84
TR 106,250,2048
v_xor_b32 v250, 3, v248
v_lshl_add_u32 v250, v250, 5, v249
v_add_f32 v2, v2, v82
v_mfma_f32_32x32x16_bf16 a[80:95], a[228:231], v[192:195], a[80:95]
ds_read_b128 a[172:175], v10 offset:11264
TR 108,250,0
TR 110,250,2048
v_xor_b32 v250, 4, v248
v_lshl_add_u32 v250, v250, 5, v249
TR 128,250,0
v_mfma_f32_32x32x16_bf16 a[32:47], a[232:235], v[176:179], a[32:47]
buffer_load_dwordx4 v12, s[52:55], s71 offen offset:2048 sc1 lds
v_exp_f32 v85, v85
TR 130,250,2048
v_xor_b32 v250, 5, v248
v_lshl_add_u32 v250, v250, 5, v249
v_mfma_f32_32x32x16_bf16 a[96:111], a[232:235], v[192:195], a[96:111]
ds_read_b128 a[176:179], v10 offset:12288
v_add_f32 v3, v3, v83
v_cvt_pk_bf16_f32 v81, v82, v83
TR 132,250,0
TR 134,250,2048
v_xor_b32 v250, 6, v248
v_mfma_f32_32x32x16_bf16 a[48:63], a[236:239], v[176:179], a[48:63]
ds_read_b128 a[180:183], v10 offset:13312
v_lshl_add_u32 v250, v250, 5, v249
TR 136,250,0
v_exp_f32 v86, v86
TR 138,250,2048
v_mfma_f32_32x32x16_bf16 a[112:127], a[236:239], v[192:195], a[112:127]
v_xor_b32 v250, 7, v248
v_lshl_add_u32 v250, v250, 5, v249
TR 140,250,0
v_add_f32 v2, v2, v84
v_exp_f32 v87, v87
v_mfma_f32_32x32x16_bf16 a[0:15], a[240:243], v[184:187], a[0:15]
ds_read_b128 a[184:187], v10 offset:14336
buffer_load_dwordx4 v12, s[52:55], s71 offen offset:3072 sc1 lds
TR 142,250,2048
s_add_u32 s32, s40, 100663296
s_addc_u32 s33, s41, 0
s_mov_b32 s34, 8388608
v_mfma_f32_32x32x16_bf16 a[64:79], a[240:243], v[200:203], a[64:79]
v_add_f32 v3, v3, v85
s_mov_b32 s35, 0x20000
s_and_b32 s36, s2, 7
s_lshl_b32 s36, s36, 20
s_lshr_b32 s37, s2, 3
v_cvt_pk_bf16_f32 v82, v84, v85
v_mfma_f32_32x32x16_bf16 a[16:31], a[244:247], v[184:187], a[16:31]
ds_read_b128 a[188:191], v10 offset:15360
v_exp_f32 v88, v88
s_lshl_b32 s37, s37, 15
s_add_u32 s36, s36, s37
s_lshl_b32 s37, s3, 12
v_mfma_f32_32x32x16_bf16 a[80:95], a[244:247], v[200:203], a[80:95]
s_add_u32 s36, s36, s37
s_add_u32 s37, s36, 4096
v_add_f32 v2, v2, v86
s_waitcnt lgkmcnt(15)
buffer_store_dwordx4 v[96:99], v12, s[32:35], s36 offen offset:0 sc1
buffer_store_dwordx4 v[100:103], v12, s[32:35], s36 offen offset:1024 sc1
buffer_store_dwordx4 v[104:107], v12, s[32:35], s36 offen offset:2048 sc1
v_mfma_f32_32x32x16_bf16 a[32:47], a[248:251], v[184:187], a[32:47]
s_xor_b32 s72, s72, 0x8000
s_waitcnt lgkmcnt(12)
buffer_store_dwordx4 v[108:111], v12, s[32:35], s36 offen offset:3072 sc1
v_exp_f32 v89, v89
s_waitcnt lgkmcnt(10)
buffer_store_dwordx4 v[128:131], v12, s[32:35], s37 offen offset:0 sc1
s_waitcnt lgkmcnt(7)
buffer_store_dwordx4 v[132:135], v12, s[32:35], s37 offen offset:1024 sc1
v_mfma_f32_32x32x16_bf16 a[96:111], a[248:251], v[200:203], a[96:111]
s_waitcnt lgkmcnt(4)
buffer_store_dwordx4 v[136:139], v12, s[32:35], s37 offen offset:2048 sc1
s_waitcnt lgkmcnt(1)
buffer_store_dwordx4 v[140:143], v12, s[32:35], s37 offen offset:3072 sc1
v_add_f32 v3, v3, v87
v_cvt_pk_bf16_f32 v83, v86, v87
s_add_u32 s32, s40, 109051904
s_addc_u32 s33, s41, 0
v_mfma_f32_32x32x16_bf16 a[48:63], a[252:255], v[184:187], a[48:63]
s_mov_b32 s34, 4194304
s_mov_b32 s35, 0x20000
v_exp_f32 v90, v90
s_lshl_b32 s36, s2, 14
v_mov_b32 v252, -1
v_mfma_f32_32x32x16_bf16 a[112:127], a[252:255], v[200:203], a[112:127]
v_mov_b32 v253, -1
v_mov_b32 v254, -1
v_mov_b32 v255, -1
v_add_f32 v2, v2, v88
v_exp_f32 v91, v91
buffer_store_dwordx4 v[252:255], v12, s[32:35], s36 offen offset:0 sc1
buffer_store_dwordx4 v[252:255], v12, s[32:35], s36 offen offset:1024 sc1
buffer_store_dwordx4 v[252:255], v12, s[32:35], s36 offen offset:2048 sc1
buffer_store_dwordx4 v[252:255], v12, s[32:35], s36 offen offset:3072 sc1
v_add_f32 v3, v3, v89
v_lshlrev_b32 v72, 4, v1
v_add_u32 v73, -8, v72
v_mov_b32 v75, 0
buffer_load_ushort v74, v75, s[28:31], s42 offen
v_cvt_pk_bf16_f32 v88, v88, v89
v_add_f32 v2, v2, v90
buffer_load_dwordx2 v[48:49], v73, s[16:19], 0 offen
buffer_load_dwordx4 v[50:53], v72, s[16:19], 0 offen offset:0
buffer_load_dwordx2 v[54:55], v72, s[16:19], 0 offen offset:1016
buffer_load_dwordx4 v[56:59], v72, s[16:19], 0 offen offset:1024
v_add_f32 v3, v3, v91
v_cvt_pk_bf16_f32 v89, v90, v91
buffer_load_dwordx2 v[60:61], v72, s[16:19], 0 offen offset:2040
buffer_load_dwordx4 v[62:65], v72, s[16:19], 0 offen offset:2048
buffer_load_dwordx2 v[66:67], v72, s[16:19], 0 offen offset:3064
buffer_load_dwordx4 v[68:71], v72, s[16:19], 0 offen offset:3072
L_p3_mxm_end:
s_branch L_p3_eps
L_p3_d0_rare:
v_mov_b32 v240, v6
v_mov_b32 v241, v6
s_nop 1
v_permlane32_swap_b32 v240, v241
v_max_f32 v242, v240, v241
v_max_f32 v242, 0, v242
v_exp_f32 v8, -v242
v_sub_f32 v208, v208, v242
v_sub_f32 v209, v209, v242
v_sub_f32 v210, v210, v242
v_sub_f32 v211, v211, v242
v_sub_f32 v212, v212, v242
v_sub_f32 v213, v213, v242
v_sub_f32 v214, v214, v242
v_sub_f32 v215, v215, v242
v_sub_f32 v216, v216, v242
v_sub_f32 v217, v217, v242
v_sub_f32 v218, v218, v242
v_sub_f32 v219, v219, v242
v_sub_f32 v220, v220, v242
v_sub_f32 v221, v221, v242
v_sub_f32 v222, v222, v242
v_sub_f32 v223, v223, v242
v_mul_f32 v2, v2, v8
v_mul_f32 v3, v3, v8
v_sub_f32 v144, v144, v242
v_sub_f32 v145, v145, v242
v_sub_f32 v146, v146, v242
v_sub_f32 v147, v147, v242
v_sub_f32 v148, v148, v242
v_sub_f32 v149, v149, v242
v_sub_f32 v150, v150, v242
v_sub_f32 v151, v151, v242
v_sub_f32 v152, v152, v242
v_sub_f32 v153, v153, v242
v_sub_f32 v154, v154, v242
v_sub_f32 v155, v155, v242
v_sub_f32 v156, v156, v242
v_sub_f32 v157, v157, v242
v_sub_f32 v158, v158, v242
v_sub_f32 v159, v159, v242
v_sub_f32 v176, v176, v242
v_sub_f32 v177, v177, v242
v_sub_f32 v178, v178, v242
v_sub_f32 v179, v179, v242
v_sub_f32 v180, v180, v242
v_sub_f32 v181, v181, v242
v_sub_f32 v182, v182, v242
v_sub_f32 v183, v183, v242
v_sub_f32 v184, v184, v242
v_sub_f32 v185, v185, v242
v_sub_f32 v186, v186, v242
v_sub_f32 v187, v187, v242
v_sub_f32 v188, v188, v242
v_sub_f32 v189, v189, v242
v_sub_f32 v190, v190, v242
v_sub_f32 v191, v191, v242
v_mov_b32 v240, v7
v_mov_b32 v241, v7
s_nop 1
v_permlane32_swap_b32 v240, v241
v_max_f32 v242, v240, v241
v_max_f32 v242, 0, v242
v_exp_f32 v9, -v242
v_sub_f32 v224, v224, v242
v_sub_f32 v225, v225, v242
v_sub_f32 v226, v226, v242
v_sub_f32 v227, v227, v242
v_sub_f32 v228, v228, v242
v_sub_f32 v229, v229, v242
v_sub_f32 v230, v230, v242
v_sub_f32 v231, v231, v242
v_sub_f32 v232, v232, v242
v_sub_f32 v233, v233, v242
v_sub_f32 v234, v234, v242
v_sub_f32 v235, v235, v242
v_sub_f32 v236, v236, v242
v_sub_f32 v237, v237, v242
v_sub_f32 v238, v238, v242
v_sub_f32 v239, v239, v242
v_mul_f32 v4, v4, v9
v_mul_f32 v5, v5, v9
v_sub_f32 v160, v160, v242
v_sub_f32 v161, v161, v242
v_sub_f32 v162, v162, v242
v_sub_f32 v163, v163, v242
v_sub_f32 v164, v164, v242
v_sub_f32 v165, v165, v242
v_sub_f32 v166, v166, v242
v_sub_f32 v167, v167, v242
v_sub_f32 v168, v168, v242
v_sub_f32 v169, v169, v242
v_sub_f32 v170, v170, v242
v_sub_f32 v171, v171, v242
v_sub_f32 v172, v172, v242
v_sub_f32 v173, v173, v242
v_sub_f32 v174, v174, v242
v_sub_f32 v175, v175, v242
v_sub_f32 v192, v192, v242
v_sub_f32 v193, v193, v242
v_sub_f32 v194, v194, v242
v_sub_f32 v195, v195, v242
v_sub_f32 v196, v196, v242
v_sub_f32 v197, v197, v242
v_sub_f32 v198, v198, v242
v_sub_f32 v199, v199, v242
v_sub_f32 v200, v200, v242
v_sub_f32 v201, v201, v242
v_sub_f32 v202, v202, v242
v_sub_f32 v203, v203, v242
v_sub_f32 v204, v204, v242
v_sub_f32 v205, v205, v242
v_sub_f32 v206, v206, v242
v_sub_f32 v207, v207, v242
s_add_u32 m0, s72, 0
ds_read_b128 a[144:147], v10 offset:20480
v_exp_f32 v144, v144
v_exp_f32 v145, v145
v_mfma_f32_32x32x16_bf16 a[64:79], a[208:211], v[104:107], a[64:79]
ds_read_b128 a[148:151], v10 offset:21504
buffer_load_dwordx4 v12, s[52:55], s71 offen offset:0 sc1 lds
v_exp_f32 v146, v146
v_add_f32 v2, v2, v144
v_mfma_f32_32x32x16_bf16 a[16:31], a[212:215], v[88:91], a[16:31]
v_exp_f32 v147, v147
v_add_f32 v3, v3, v145
v_cvt_pk_bf16_f32 v144, v144, v145
v_mfma_f32_32x32x16_bf16 a[80:95], a[212:215], v[104:107], a[80:95]
ds_read_b128 a[152:155], v10 offset:22528
v_exp_f32 v148, v148
v_add_f32 v2, v2, v146
v_mfma_f32_32x32x16_bf16 a[32:47], a[216:219], v[88:91], a[32:47]
v_exp_f32 v149, v149
v_add_f32 v3, v3, v147
v_cvt_pk_bf16_f32 v145, v146, v147
v_mfma_f32_32x32x16_bf16 a[96:111], a[216:219], v[104:107], a[96:111]
ds_read_b128 a[156:159], v10 offset:23552
buffer_load_dwordx4 v12, s[52:55], s71 offen offset:1024 sc1 lds
v_exp_f32 v150, v150
v_add_f32 v2, v2, v148
v_mfma_f32_32x32x16_bf16 a[48:63], a[220:223], v[88:91], a[48:63]
ds_read_b128 a[160:163], v10 offset:24576
v_exp_f32 v151, v151
v_add_f32 v3, v3, v149
v_cvt_pk_bf16_f32 v146, v148, v149
v_mfma_f32_32x32x16_bf16 a[112:127], a[220:223], v[104:107], a[112:127]
v_exp_f32 v152, v152
v_add_f32 v2, v2, v150
v_mfma_f32_32x32x16_bf16 a[0:15], a[224:227], v[112:115], a[0:15]
ds_read_b128 a[164:167], v10 offset:25600
v_exp_f32 v153, v153
v_add_f32 v3, v3, v151
v_cvt_pk_bf16_f32 v147, v150, v151
v_mfma_f32_32x32x16_bf16 a[64:79], a[224:227], v[128:131], a[64:79]
v_exp_f32 v154, v154
v_add_f32 v2, v2, v152
v_mfma_f32_32x32x16_bf16 a[16:31], a[228:231], v[112:115], a[16:31]
ds_read_b128 a[168:171], v10 offset:26624
buffer_load_dwordx4 v12, s[52:55], s71 offen offset:2048 sc1 lds
v_exp_f32 v155, v155
v_add_f32 v3, v3, v153
v_cvt_pk_bf16_f32 v152, v152, v153
v_mfma_f32_32x32x16_bf16 a[80:95], a[228:231], v[128:131], a[80:95]
ds_read_b128 a[172:175], v10 offset:27648
v_exp_f32 v156, v156
v_add_f32 v2, v2, v154
v_mfma_f32_32x32x16_bf16 a[32:47], a[232:235], v[112:115], a[32:47]
v_exp_f32 v157, v157
v_add_f32 v3, v3, v155
v_cvt_pk_bf16_f32 v153, v154, v155
v_mfma_f32_32x32x16_bf16 a[96:111], a[232:235], v[128:131], a[96:111]
ds_read_b128 a[176:179], v10 offset:28672
v_exp_f32 v158, v158
v_add_f32 v2, v2, v156
v_mfma_f32_32x32x16_bf16 a[48:63], a[236:239], v[112:115], a[48:63]
buffer_load_dwordx4 v12, s[52:55], s71 offen offset:3072 sc1 lds
v_exp_f32 v159, v159
v_add_f32 v3, v3, v157
v_cvt_pk_bf16_f32 v154, v156, v157
v_mfma_f32_32x32x16_bf16 a[112:127], a[236:239], v[128:131], a[112:127]
ds_read_b128 a[180:183], v10 offset:29696
v_exp_f32 v160, v160
v_add_f32 v2, v2, v158
v_mfma_f32_32x32x16_bf16 a[0:15], a[240:243], v[120:123], a[0:15]
ds_read_b128 a[184:187], v10 offset:30720
v_exp_f32 v161, v161
v_add_f32 v3, v3, v159
v_cvt_pk_bf16_f32 v155, v158, v159
v_mfma_f32_32x32x16_bf16 a[64:79], a[240:243], v[136:139], a[64:79]
v_exp_f32 v162, v162
v_add_f32 v4, v4, v160
v_mfma_f32_32x32x16_bf16 a[16:31], a[244:247], v[120:123], a[16:31]
ds_read_b128 a[188:191], v10 offset:31744
v_exp_f32 v163, v163
v_add_f32 v5, v5, v161
v_cvt_pk_bf16_f32 v160, v160, v161
v_mfma_f32_32x32x16_bf16 a[80:95], a[244:247], v[136:139], a[80:95]
s_sub_u32 s74, s74, 1
v_exp_f32 v164, v164
v_add_f32 v4, v4, v162
v_mfma_f32_32x32x16_bf16 a[32:47], a[248:251], v[120:123], a[32:47]
v_exp_f32 v165, v165
v_add_f32 v5, v5, v163
v_cvt_pk_bf16_f32 v161, v162, v163
v_mfma_f32_32x32x16_bf16 a[96:111], a[248:251], v[136:139], a[96:111]
v_exp_f32 v166, v166
v_add_f32 v4, v4, v164
v_mfma_f32_32x32x16_bf16 a[48:63], a[252:255], v[120:123], a[48:63]
v_exp_f32 v167, v167
v_add_f32 v5, v5, v165
v_cvt_pk_bf16_f32 v162, v164, v165
v_mfma_f32_32x32x16_bf16 a[112:127], a[252:255], v[136:139], a[112:127]
v_add_f32 v4, v4, v166
v_add_f32 v5, v5, v167
v_cvt_pk_bf16_f32 v163, v166, v167
s_nop 15
v_accvgpr_read_b32 v240, a0
v_accvgpr_read_b32 v241, a1
v_accvgpr_read_b32 v242, a2
v_accvgpr_read_b32 v243, a3
v_accvgpr_read_b32 v244, a4
v_accvgpr_read_b32 v245, a5
v_accvgpr_read_b32 v246, a6
v_accvgpr_read_b32 v247, a7
v_mul_f32 v240, v240, v8
v_mul_f32 v241, v241, v8
v_mul_f32 v242, v242, v8
v_mul_f32 v243, v243, v8
v_mul_f32 v244, v244, v8
v_mul_f32 v245, v245, v8
v_mul_f32 v246, v246, v8
v_mul_f32 v247, v247, v8
v_accvgpr_write_b32 a0, v240
v_accvgpr_write_b32 a1, v241
v_accvgpr_write_b32 a2, v242
v_accvgpr_write_b32 a3, v243
v_accvgpr_write_b32 a4, v244
v_accvgpr_write_b32 a5, v245
v_accvgpr_write_b32 a6, v246
v_accvgpr_write_b32 a7, v247
v_accvgpr_read_b32 v240, a8
v_accvgpr_read_b32 v241, a9
v_accvgpr_read_b32 v242, a10
v_accvgpr_read_b32 v243, a11
v_accvgpr_read_b32 v244, a12
v_accvgpr_read_b32 v245, a13
v_accvgpr_read_b32 v246, a14
v_accvgpr_read_b32 v247, a15
v_mul_f32 v240, v240, v8
v_mul_f32 v241, v241, v8
v_mul_f32 v242, v242, v8
v_mul_f32 v243, v243, v8
v_mul_f32 v244, v244, v8
v_mul_f32 v245, v245, v8
v_mul_f32 v246, v246, v8
v_mul_f32 v247, v247, v8
v_accvgpr_write_b32 a8, v240
v_accvgpr_write_b32 a9, v241
v_accvgpr_write_b32 a10, v242
v_accvgpr_write_b32 a11, v243
v_accvgpr_write_b32 a12, v244
v_accvgpr_write_b32 a13, v245
v_accvgpr_write_b32 a14, v246
v_accvgpr_write_b32 a15, v247
v_accvgpr_read_b32 v240, a16
v_accvgpr_read_b32 v241, a17
v_accvgpr_read_b32 v242, a18
v_accvgpr_read_b32 v243, a19
v_accvgpr_read_b32 v244, a20
v_accvgpr_read_b32 v245, a21
v_accvgpr_read_b32 v246, a22
v_accvgpr_read_b32 v247, a23
v_mul_f32 v240, v240, v8
v_mul_f32 v241, v241, v8
v_mul_f32 v242, v242, v8
v_mul_f32 v243, v243, v8
v_mul_f32 v244, v244, v8
v_mul_f32 v245, v245, v8
v_mul_f32 v246, v246, v8
v_mul_f32 v247, v247, v8
v_accvgpr_write_b32 a16, v240
v_accvgpr_write_b32 a17, v241
v_accvgpr_write_b32 a18, v242
v_accvgpr_write_b32 a19, v243
v_accvgpr_write_b32 a20, v244
v_accvgpr_write_b32 a21, v245
v_accvgpr_write_b32 a22, v246
v_accvgpr_write_b32 a23, v247
v_accvgpr_read_b32 v240, a24
v_accvgpr_read_b32 v241, a25
v_accvgpr_read_b32 v242, a26
v_accvgpr_read_b32 v243, a27
v_accvgpr_read_b32 v244, a28
v_accvgpr_read_b32 v245, a29
v_accvgpr_read_b32 v246, a30
v_accvgpr_read_b32 v247, a31
v_mul_f32 v240, v240, v8
v_mul_f32 v241, v241, v8
v_mul_f32 v242, v242, v8
v_mul_f32 v243, v243, v8
v_mul_f32 v244, v244, v8
v_mul_f32 v245, v245, v8
v_mul_f32 v246, v246, v8
v_mul_f32 v247, v247, v8
v_accvgpr_write_b32 a24, v240
v_accvgpr_write_b32 a25, v241
v_accvgpr_write_b32 a26, v242
v_accvgpr_write_b32 a27, v243
v_accvgpr_write_b32 a28, v244
v_accvgpr_write_b32 a29, v245
v_accvgpr_write_b32 a30, v246
v_accvgpr_write_b32 a31, v247
v_accvgpr_read_b32 v240, a32
v_accvgpr_read_b32 v241, a33
v_accvgpr_read_b32 v242, a34
v_accvgpr_read_b32 v243, a35
v_accvgpr_read_b32 v244, a36
v_accvgpr_read_b32 v245, a37
v_accvgpr_read_b32 v246, a38
v_accvgpr_read_b32 v247, a39
v_mul_f32 v240, v240, v8
v_mul_f32 v241, v241, v8
v_mul_f32 v242, v242, v8
v_mul_f32 v243, v243, v8
v_mul_f32 v244, v244, v8
v_mul_f32 v245, v245, v8
v_mul_f32 v246, v246, v8
v_mul_f32 v247, v247, v8
v_accvgpr_write_b32 a32, v240
v_accvgpr_write_b32 a33, v241
v_accvgpr_write_b32 a34, v242
v_accvgpr_write_b32 a35, v243
v_accvgpr_write_b32 a36, v244
v_accvgpr_write_b32 a37, v245
v_accvgpr_write_b32 a38, v246
v_accvgpr_write_b32 a39, v247
v_accvgpr_read_b32 v240, a40
v_accvgpr_read_b32 v241, a41
v_accvgpr_read_b32 v242, a42
v_accvgpr_read_b32 v243, a43
v_accvgpr_read_b32 v244, a44
v_accvgpr_read_b32 v245, a45
v_accvgpr_read_b32 v246, a46
v_accvgpr_read_b32 v247, a47
v_mul_f32 v240, v240, v8
v_mul_f32 v241, v241, v8
v_mul_f32 v242, v242, v8
v_mul_f32 v243, v243, v8
v_mul_f32 v244, v244, v8
v_mul_f32 v245, v245, v8
v_mul_f32 v246, v246, v8
v_mul_f32 v247, v247, v8
v_accvgpr_write_b32 a40, v240
v_accvgpr_write_b32 a41, v241
v_accvgpr_write_b32 a42, v242
v_accvgpr_write_b32 a43, v243
v_accvgpr_write_b32 a44, v244
v_accvgpr_write_b32 a45, v245
v_accvgpr_write_b32 a46, v246
v_accvgpr_write_b32 a47, v247
v_accvgpr_read_b32 v240, a48
v_accvgpr_read_b32 v241, a49
v_accvgpr_read_b32 v242, a50
v_accvgpr_read_b32 v243, a51
v_accvgpr_read_b32 v244, a52
v_accvgpr_read_b32 v245, a53
v_accvgpr_read_b32 v246, a54
v_accvgpr_read_b32 v247, a55
v_mul_f32 v240, v240, v8
v_mul_f32 v241, v241, v8
v_mul_f32 v242, v242, v8
v_mul_f32 v243, v243, v8
v_mul_f32 v244, v244, v8
v_mul_f32 v245, v245, v8
v_mul_f32 v246, v246, v8
v_mul_f32 v247, v247, v8
v_accvgpr_write_b32 a48, v240
v_accvgpr_write_b32 a49, v241
v_accvgpr_write_b32 a50, v242
v_accvgpr_write_b32 a51, v243
v_accvgpr_write_b32 a52, v244
v_accvgpr_write_b32 a53, v245
v_accvgpr_write_b32 a54, v246
v_accvgpr_write_b32 a55, v247
v_accvgpr_read_b32 v240, a56
v_accvgpr_read_b32 v241, a57
v_accvgpr_read_b32 v242, a58
v_accvgpr_read_b32 v243, a59
v_accvgpr_read_b32 v244, a60
v_accvgpr_read_b32 v245, a61
v_accvgpr_read_b32 v246, a62
v_accvgpr_read_b32 v247, a63
v_mul_f32 v240, v240, v8
v_mul_f32 v241, v241, v8
v_mul_f32 v242, v242, v8
v_mul_f32 v243, v243, v8
v_mul_f32 v244, v244, v8
v_mul_f32 v245, v245, v8
v_mul_f32 v246, v246, v8
v_mul_f32 v247, v247, v8
v_accvgpr_write_b32 a56, v240
v_accvgpr_write_b32 a57, v241
v_accvgpr_write_b32 a58, v242
v_accvgpr_write_b32 a59, v243
v_accvgpr_write_b32 a60, v244
v_accvgpr_write_b32 a61, v245
v_accvgpr_write_b32 a62, v246
v_accvgpr_write_b32 a63, v247
v_accvgpr_read_b32 v240, a64
v_accvgpr_read_b32 v241, a65
v_accvgpr_read_b32 v242, a66
v_accvgpr_read_b32 v243, a67
v_accvgpr_read_b32 v244, a68
v_accvgpr_read_b32 v245, a69
v_accvgpr_read_b32 v246, a70
v_accvgpr_read_b32 v247, a71
v_mul_f32 v240, v240, v9
v_mul_f32 v241, v241, v9
v_mul_f32 v242, v242, v9
v_mul_f32 v243, v243, v9
v_mul_f32 v244, v244, v9
v_mul_f32 v245, v245, v9
v_mul_f32 v246, v246, v9
v_mul_f32 v247, v247, v9
v_accvgpr_write_b32 a64, v240
v_accvgpr_write_b32 a65, v241
v_accvgpr_write_b32 a66, v242
v_accvgpr_write_b32 a67, v243
v_accvgpr_write_b32 a68, v244
v_accvgpr_write_b32 a69, v245
v_accvgpr_write_b32 a70, v246
v_accvgpr_write_b32 a71, v247
v_accvgpr_read_b32 v240, a72
v_accvgpr_read_b32 v241, a73
v_accvgpr_read_b32 v242, a74
v_accvgpr_read_b32 v243, a75
v_accvgpr_read_b32 v244, a76
v_accvgpr_read_b32 v245, a77
v_accvgpr_read_b32 v246, a78
v_accvgpr_read_b32 v247, a79
v_mul_f32 v240, v240, v9
v_mul_f32 v241, v241, v9
v_mul_f32 v242, v242, v9
v_mul_f32 v243, v243, v9
v_mul_f32 v244, v244, v9
v_mul_f32 v245, v245, v9
v_mul_f32 v246, v246, v9
v_mul_f32 v247, v247, v9
v_accvgpr_write_b32 a72, v240
v_accvgpr_write_b32 a73, v241
v_accvgpr_write_b32 a74, v242
v_accvgpr_write_b32 a75, v243
v_accvgpr_write_b32 a76, v244
v_accvgpr_write_b32 a77, v245
v_accvgpr_write_b32 a78, v246
v_accvgpr_write_b32 a79, v247
v_accvgpr_read_b32 v240, a80
v_accvgpr_read_b32 v241, a81
v_accvgpr_read_b32 v242, a82
v_accvgpr_read_b32 v243, a83
v_accvgpr_read_b32 v244, a84
v_accvgpr_read_b32 v245, a85
v_accvgpr_read_b32 v246, a86
v_accvgpr_read_b32 v247, a87
v_mul_f32 v240, v240, v9
v_mul_f32 v241, v241, v9
v_mul_f32 v242, v242, v9
v_mul_f32 v243, v243, v9
v_mul_f32 v244, v244, v9
v_mul_f32 v245, v245, v9
v_mul_f32 v246, v246, v9
v_mul_f32 v247, v247, v9
v_accvgpr_write_b32 a80, v240
v_accvgpr_write_b32 a81, v241
v_accvgpr_write_b32 a82, v242
v_accvgpr_write_b32 a83, v243
v_accvgpr_write_b32 a84, v244
v_accvgpr_write_b32 a85, v245
v_accvgpr_write_b32 a86, v246
v_accvgpr_write_b32 a87, v247
v_accvgpr_read_b32 v240, a88
v_accvgpr_read_b32 v241, a89
v_accvgpr_read_b32 v242, a90
v_accvgpr_read_b32 v243, a91
v_accvgpr_read_b32 v244, a92
v_accvgpr_read_b32 v245, a93
v_accvgpr_read_b32 v246, a94
v_accvgpr_read_b32 v247, a95
v_mul_f32 v240, v240, v9
v_mul_f32 v241, v241, v9
v_mul_f32 v242, v242, v9
v_mul_f32 v243, v243, v9
v_mul_f32 v244, v244, v9
v_mul_f32 v245, v245, v9
v_mul_f32 v246, v246, v9
v_mul_f32 v247, v247, v9
v_accvgpr_write_b32 a88, v240
v_accvgpr_write_b32 a89, v241
v_accvgpr_write_b32 a90, v242
v_accvgpr_write_b32 a91, v243
v_accvgpr_write_b32 a92, v244
v_accvgpr_write_b32 a93, v245
v_accvgpr_write_b32 a94, v246
v_accvgpr_write_b32 a95, v247
v_accvgpr_read_b32 v240, a96
v_accvgpr_read_b32 v241, a97
v_accvgpr_read_b32 v242, a98
v_accvgpr_read_b32 v243, a99
v_accvgpr_read_b32 v244, a100
v_accvgpr_read_b32 v245, a101
v_accvgpr_read_b32 v246, a102
v_accvgpr_read_b32 v247, a103
v_mul_f32 v240, v240, v9
v_mul_f32 v241, v241, v9
v_mul_f32 v242, v242, v9
v_mul_f32 v243, v243, v9
v_mul_f32 v244, v244, v9
v_mul_f32 v245, v245, v9
v_mul_f32 v246, v246, v9
v_mul_f32 v247, v247, v9
v_accvgpr_write_b32 a96, v240
v_accvgpr_write_b32 a97, v241
v_accvgpr_write_b32 a98, v242
v_accvgpr_write_b32 a99, v243
v_accvgpr_write_b32 a100, v244
v_accvgpr_write_b32 a101, v245
v_accvgpr_write_b32 a102, v246
v_accvgpr_write_b32 a103, v247
v_accvgpr_read_b32 v240, a104
v_accvgpr_read_b32 v241, a105
v_accvgpr_read_b32 v242, a106
v_accvgpr_read_b32 v243, a107
v_accvgpr_read_b32 v244, a108
v_accvgpr_read_b32 v245, a109
v_accvgpr_read_b32 v246, a110
v_accvgpr_read_b32 v247, a111
v_mul_f32 v240, v240, v9
v_mul_f32 v241, v241, v9
v_mul_f32 v242, v242, v9
v_mul_f32 v243, v243, v9
v_mul_f32 v244, v244, v9
v_mul_f32 v245, v245, v9
v_mul_f32 v246, v246, v9
v_mul_f32 v247, v247, v9
v_accvgpr_write_b32 a104, v240
v_accvgpr_write_b32 a105, v241
v_accvgpr_write_b32 a106, v242
v_accvgpr_write_b32 a107, v243
v_accvgpr_write_b32 a108, v244
v_accvgpr_write_b32 a109, v245
v_accvgpr_write_b32 a110, v246
v_accvgpr_write_b32 a111, v247
v_accvgpr_read_b32 v240, a112
v_accvgpr_read_b32 v241, a113
v_accvgpr_read_b32 v242, a114
v_accvgpr_read_b32 v243, a115
v_accvgpr_read_b32 v244, a116
v_accvgpr_read_b32 v245, a117
v_accvgpr_read_b32 v246, a118
v_accvgpr_read_b32 v247, a119
v_mul_f32 v240, v240, v9
v_mul_f32 v241, v241, v9
v_mul_f32 v242, v242, v9
v_mul_f32 v243, v243, v9
v_mul_f32 v244, v244, v9
v_mul_f32 v245, v245, v9
v_mul_f32 v246, v246, v9
v_mul_f32 v247, v247, v9
v_accvgpr_write_b32 a112, v240
v_accvgpr_write_b32 a113, v241
v_accvgpr_write_b32 a114, v242
v_accvgpr_write_b32 a115, v243
v_accvgpr_write_b32 a116, v244
v_accvgpr_write_b32 a117, v245
v_accvgpr_write_b32 a118, v246
v_accvgpr_write_b32 a119, v247
v_accvgpr_read_b32 v240, a120
v_accvgpr_read_b32 v241, a121
v_accvgpr_read_b32 v242, a122
v_accvgpr_read_b32 v243, a123
v_accvgpr_read_b32 v244, a124
v_accvgpr_read_b32 v245, a125
v_accvgpr_read_b32 v246, a126
v_accvgpr_read_b32 v247, a127
v_mul_f32 v240, v240, v9
v_mul_f32 v241, v241, v9
v_mul_f32 v242, v242, v9
v_mul_f32 v243, v243, v9
v_mul_f32 v244, v244, v9
v_mul_f32 v245, v245, v9
v_mul_f32 v246, v246, v9
v_mul_f32 v247, v247, v9
v_accvgpr_write_b32 a120, v240
v_accvgpr_write_b32 a121, v241
v_accvgpr_write_b32 a122, v242
v_accvgpr_write_b32 a123, v243
v_accvgpr_write_b32 a124, v244
v_accvgpr_write_b32 a125, v245
v_accvgpr_write_b32 a126, v246
v_accvgpr_write_b32 a127, v247
s_nop 1
s_branch L_p3_d0_end
L_p3_d1_rare:
v_mov_b32 v240, v6
v_mov_b32 v241, v6
s_nop 1
v_permlane32_swap_b32 v240, v241
v_max_f32 v242, v240, v241
v_max_f32 v242, 0, v242
v_exp_f32 v8, -v242
v_sub_f32 v208, v208, v242
v_sub_f32 v209, v209, v242
v_sub_f32 v210, v210, v242
v_sub_f32 v211, v211, v242
v_sub_f32 v212, v212, v242
v_sub_f32 v213, v213, v242
v_sub_f32 v214, v214, v242
v_sub_f32 v215, v215, v242
v_sub_f32 v216, v216, v242
v_sub_f32 v217, v217, v242
v_sub_f32 v218, v218, v242
v_sub_f32 v219, v219, v242
v_sub_f32 v220, v220, v242
v_sub_f32 v221, v221, v242
v_sub_f32 v222, v222, v242
v_sub_f32 v223, v223, v242
v_mul_f32 v2, v2, v8
v_mul_f32 v3, v3, v8
v_sub_f32 v80, v80, v242
v_sub_f32 v81, v81, v242
v_sub_f32 v82, v82, v242
v_sub_f32 v83, v83, v242
v_sub_f32 v84, v84, v242
v_sub_f32 v85, v85, v242
v_sub_f32 v86, v86, v242
v_sub_f32 v87, v87, v242
v_sub_f32 v88, v88, v242
v_sub_f32 v89, v89, v242
v_sub_f32 v90, v90, v242
v_sub_f32 v91, v91, v242
v_sub_f32 v92, v92, v242
v_sub_f32 v93, v93, v242
v_sub_f32 v94, v94, v242
v_sub_f32 v95, v95, v242
v_sub_f32 v112, v112, v242
v_sub_f32 v113, v113, v242
v_sub_f32 v114, v114, v242
v_sub_f32 v115, v115, v242
v_sub_f32 v116, v116, v242
v_sub_f32 v117, v117, v242
v_sub_f32 v118, v118, v242
v_sub_f32 v119, v119, v242
v_sub_f32 v120, v120, v242
v_sub_f32 v121, v121, v242
v_sub_f32 v122, v122, v242
v_sub_f32 v123, v123, v242
v_sub_f32 v124, v124, v242
v_sub_f32 v125, v125, v242
v_sub_f32 v126, v126, v242
v_sub_f32 v127, v127, v242
v_mov_b32 v240, v7
v_mov_b32 v241, v7
s_nop 1
v_permlane32_swap_b32 v240, v241
v_max_f32 v242, v240, v241
v_max_f32 v242, 0, v242
v_exp_f32 v9, -v242
v_sub_f32 v224, v224, v242
v_sub_f32 v225, v225, v242
v_sub_f32 v226, v226, v242
v_sub_f32 v227, v227, v242
v_sub_f32 v228, v228, v242
v_sub_f32 v229, v229, v242
v_sub_f32 v230, v230, v242
v_sub_f32 v231, v231, v242
v_sub_f32 v232, v232, v242
v_sub_f32 v233, v233, v242
v_sub_f32 v234, v234, v242
v_sub_f32 v235, v235, v242
v_sub_f32 v236, v236, v242
v_sub_f32 v237, v237, v242
v_sub_f32 v238, v238, v242
v_sub_f32 v239, v239, v242
v_mul_f32 v4, v4, v9
v_mul_f32 v5, v5, v9
v_sub_f32 v96, v96, v242
v_sub_f32 v97, v97, v242
v_sub_f32 v98, v98, v242
v_sub_f32 v99, v99, v242
v_sub_f32 v100, v100, v242
v_sub_f32 v101, v101, v242
v_sub_f32 v102, v102, v242
v_sub_f32 v103, v103, v242
v_sub_f32 v104, v104, v242
v_sub_f32 v105, v105, v242
v_sub_f32 v106, v106, v242
v_sub_f32 v107, v107, v242
v_sub_f32 v108, v108, v242
v_sub_f32 v109, v109, v242
v_sub_f32 v110, v110, v242
v_sub_f32 v111, v111, v242
v_sub_f32 v128, v128, v242
v_sub_f32 v129, v129, v242
v_sub_f32 v130, v130, v242
v_sub_f32 v131, v131, v242
v_sub_f32 v132, v132, v242
v_sub_f32 v133, v133, v242
v_sub_f32 v134, v134, v242
v_sub_f32 v135, v135, v242
v_sub_f32 v136, v136, v242
v_sub_f32 v137, v137, v242
v_sub_f32 v138, v138, v242
v_sub_f32 v139, v139, v242
v_sub_f32 v140, v140, v242
v_sub_f32 v141, v141, v242
v_sub_f32 v142, v142, v242
v_sub_f32 v143, v143, v242
s_add_u32 m0, s72, 16384
ds_read_b128 a[144:147], v10 offset:4096
v_exp_f32 v80, v80
v_exp_f32 v81, v81
v_mfma_f32_32x32x16_bf16 a[64:79], a[208:211], v[168:171], a[64:79]
ds_read_b128 a[148:151], v10 offset:5120
buffer_load_dwordx4 v12, s[52:55], s71 offen offset:0 sc1 lds
v_exp_f32 v82, v82
v_add_f32 v2, v2, v80
v_mfma_f32_32x32x16_bf16 a[16:31], a[212:215], v[152:155], a[16:31]
v_exp_f32 v83, v83
v_add_f32 v3, v3, v81
v_cvt_pk_bf16_f32 v80, v80, v81
v_mfma_f32_32x32x16_bf16 a[80:95], a[212:215], v[168:171], a[80:95]
ds_read_b128 a[152:155], v10 offset:6144
v_exp_f32 v84, v84
v_add_f32 v2, v2, v82
v_mfma_f32_32x32x16_bf16 a[32:47], a[216:219], v[152:155], a[32:47]
v_exp_f32 v85, v85
v_add_f32 v3, v3, v83
v_cvt_pk_bf16_f32 v81, v82, v83
v_mfma_f32_32x32x16_bf16 a[96:111], a[216:219], v[168:171], a[96:111]
ds_read_b128 a[156:159], v10 offset:7168
buffer_load_dwordx4 v12, s[52:55], s71 offen offset:1024 sc1 lds
v_exp_f32 v86, v86
v_add_f32 v2, v2, v84
v_mfma_f32_32x32x16_bf16 a[48:63], a[220:223], v[152:155], a[48:63]
ds_read_b128 a[160:163], v10 offset:8192
v_exp_f32 v87, v87
v_add_f32 v3, v3, v85
v_cvt_pk_bf16_f32 v82, v84, v85
v_mfma_f32_32x32x16_bf16 a[112:127], a[220:223], v[168:171], a[112:127]
v_exp_f32 v88, v88
v_add_f32 v2, v2, v86
v_mfma_f32_32x32x16_bf16 a[0:15], a[224:227], v[176:179], a[0:15]
ds_read_b128 a[164:167], v10 offset:9216
v_exp_f32 v89, v89
v_add_f32 v3, v3, v87
v_cvt_pk_bf16_f32 v83, v86, v87
v_mfma_f32_32x32x16_bf16 a[64:79], a[224:227], v[192:195], a[64:79]
v_exp_f32 v90, v90
v_add_f32 v2, v2, v88
v_mfma_f32_32x32x16_bf16 a[16:31], a[228:231], v[176:179], a[16:31]
ds_read_b128 a[168:171], v10 offset:10240
buffer_load_dwordx4 v12, s[52:55], s71 offen offset:2048 sc1 lds
v_exp_f32 v91, v91
v_add_f32 v3, v3, v89
v_cvt_pk_bf16_f32 v88, v88, v89
v_mfma_f32_32x32x16_bf16 a[80:95], a[228:231], v[192:195], a[80:95]
ds_read_b128 a[172:175], v10 offset:11264
v_exp_f32 v92, v92
v_add_f32 v2, v2, v90
v_mfma_f32_32x32x16_bf16 a[32:47], a[232:235], v[176:179], a[32:47]
v_exp_f32 v93, v93
v_add_f32 v3, v3, v91
v_cvt_pk_bf16_f32 v89, v90, v91
v_mfma_f32_32x32x16_bf16 a[96:111], a[232:235], v[192:195], a[96:111]
ds_read_b128 a[176:179], v10 offset:12288
v_exp_f32 v94, v94
v_add_f32 v2, v2, v92
v_mfma_f32_32x32x16_bf16 a[48:63], a[236:239], v[176:179], a[48:63]
buffer_load_dwordx4 v12, s[52:55], s71 offen offset:3072 sc1 lds
v_exp_f32 v95, v95
v_add_f32 v3, v3, v93
v_cvt_pk_bf16_f32 v90, v92, v93
v_mfma_f32_32x32x16_bf16 a[112:127], a[236:239], v[192:195], a[112:127]
ds_read_b128 a[180:183], v10 offset:13312
v_exp_f32 v96, v96
v_add_f32 v2, v2, v94
v_mfma_f32_32x32x16_bf16 a[0:15], a[240:243], v[184:187], a[0:15]
ds_read_b128 a[184:187], v10 offset:14336
v_exp_f32 v97, v97
v_add_f32 v3, v3, v95
v_cvt_pk_bf16_f32 v91, v94, v95
v_mfma_f32_32x32x16_bf16 a[64:79], a[240:243], v[200:203], a[64:79]
v_exp_f32 v98, v98
v_add_f32 v4, v4, v96
v_mfma_f32_32x32x16_bf16 a[16:31], a[244:247], v[184:187], a[16:31]
ds_read_b128 a[188:191], v10 offset:15360
v_exp_f32 v99, v99
v_add_f32 v5, v5, v97
v_cvt_pk_bf16_f32 v96, v96, v97
v_mfma_f32_32x32x16_bf16 a[80:95], a[244:247], v[200:203], a[80:95]
s_xor_b32 s72, s72, 0x8000
v_exp_f32 v100, v100
v_add_f32 v4, v4, v98
v_mfma_f32_32x32x16_bf16 a[32:47], a[248:251], v[184:187], a[32:47]
v_exp_f32 v101, v101
v_add_f32 v5, v5, v99
v_cvt_pk_bf16_f32 v97, v98, v99
v_mfma_f32_32x32x16_bf16 a[96:111], a[248:251], v[200:203], a[96:111]
v_exp_f32 v102, v102
v_add_f32 v4, v4, v100
v_mfma_f32_32x32x16_bf16 a[48:63], a[252:255], v[184:187], a[48:63]
v_exp_f32 v103, v103
v_add_f32 v5, v5, v101
v_cvt_pk_bf16_f32 v98, v100, v101
v_mfma_f32_32x32x16_bf16 a[112:127], a[252:255], v[200:203], a[112:127]
v_add_f32 v4, v4, v102
v_add_f32 v5, v5, v103
v_cvt_pk_bf16_f32 v99, v102, v103
s_nop 15
v_accvgpr_read_b32 v240, a0
v_accvgpr_read_b32 v241, a1
v_accvgpr_read_b32 v242, a2
v_accvgpr_read_b32 v243, a3
v_accvgpr_read_b32 v244, a4
v_accvgpr_read_b32 v245, a5
v_accvgpr_read_b32 v246, a6
v_accvgpr_read_b32 v247, a7
v_mul_f32 v240, v240, v8
v_mul_f32 v241, v241, v8
v_mul_f32 v242, v242, v8
v_mul_f32 v243, v243, v8
v_mul_f32 v244, v244, v8
v_mul_f32 v245, v245, v8
v_mul_f32 v246, v246, v8
v_mul_f32 v247, v247, v8
v_accvgpr_write_b32 a0, v240
v_accvgpr_write_b32 a1, v241
v_accvgpr_write_b32 a2, v242
v_accvgpr_write_b32 a3, v243
v_accvgpr_write_b32 a4, v244
v_accvgpr_write_b32 a5, v245
v_accvgpr_write_b32 a6, v246
v_accvgpr_write_b32 a7, v247
v_accvgpr_read_b32 v240, a8
v_accvgpr_read_b32 v241, a9
v_accvgpr_read_b32 v242, a10
v_accvgpr_read_b32 v243, a11
v_accvgpr_read_b32 v244, a12
v_accvgpr_read_b32 v245, a13
v_accvgpr_read_b32 v246, a14
v_accvgpr_read_b32 v247, a15
v_mul_f32 v240, v240, v8
v_mul_f32 v241, v241, v8
v_mul_f32 v242, v242, v8
v_mul_f32 v243, v243, v8
v_mul_f32 v244, v244, v8
v_mul_f32 v245, v245, v8
v_mul_f32 v246, v246, v8
v_mul_f32 v247, v247, v8
v_accvgpr_write_b32 a8, v240
v_accvgpr_write_b32 a9, v241
v_accvgpr_write_b32 a10, v242
v_accvgpr_write_b32 a11, v243
v_accvgpr_write_b32 a12, v244
v_accvgpr_write_b32 a13, v245
v_accvgpr_write_b32 a14, v246
v_accvgpr_write_b32 a15, v247
v_accvgpr_read_b32 v240, a16
v_accvgpr_read_b32 v241, a17
v_accvgpr_read_b32 v242, a18
v_accvgpr_read_b32 v243, a19
v_accvgpr_read_b32 v244, a20
v_accvgpr_read_b32 v245, a21
v_accvgpr_read_b32 v246, a22
v_accvgpr_read_b32 v247, a23
v_mul_f32 v240, v240, v8
v_mul_f32 v241, v241, v8
v_mul_f32 v242, v242, v8
v_mul_f32 v243, v243, v8
v_mul_f32 v244, v244, v8
v_mul_f32 v245, v245, v8
v_mul_f32 v246, v246, v8
v_mul_f32 v247, v247, v8
v_accvgpr_write_b32 a16, v240
v_accvgpr_write_b32 a17, v241
v_accvgpr_write_b32 a18, v242
v_accvgpr_write_b32 a19, v243
v_accvgpr_write_b32 a20, v244
v_accvgpr_write_b32 a21, v245
v_accvgpr_write_b32 a22, v246
v_accvgpr_write_b32 a23, v247
v_accvgpr_read_b32 v240, a24
v_accvgpr_read_b32 v241, a25
v_accvgpr_read_b32 v242, a26
v_accvgpr_read_b32 v243, a27
v_accvgpr_read_b32 v244, a28
v_accvgpr_read_b32 v245, a29
v_accvgpr_read_b32 v246, a30
v_accvgpr_read_b32 v247, a31
v_mul_f32 v240, v240, v8
v_mul_f32 v241, v241, v8
v_mul_f32 v242, v242, v8
v_mul_f32 v243, v243, v8
v_mul_f32 v244, v244, v8
v_mul_f32 v245, v245, v8
v_mul_f32 v246, v246, v8
v_mul_f32 v247, v247, v8
v_accvgpr_write_b32 a24, v240
v_accvgpr_write_b32 a25, v241
v_accvgpr_write_b32 a26, v242
v_accvgpr_write_b32 a27, v243
v_accvgpr_write_b32 a28, v244
v_accvgpr_write_b32 a29, v245
v_accvgpr_write_b32 a30, v246
v_accvgpr_write_b32 a31, v247
v_accvgpr_read_b32 v240, a32
v_accvgpr_read_b32 v241, a33
v_accvgpr_read_b32 v242, a34
v_accvgpr_read_b32 v243, a35
v_accvgpr_read_b32 v244, a36
v_accvgpr_read_b32 v245, a37
v_accvgpr_read_b32 v246, a38
v_accvgpr_read_b32 v247, a39
v_mul_f32 v240, v240, v8
v_mul_f32 v241, v241, v8
v_mul_f32 v242, v242, v8
v_mul_f32 v243, v243, v8
v_mul_f32 v244, v244, v8
v_mul_f32 v245, v245, v8
v_mul_f32 v246, v246, v8
v_mul_f32 v247, v247, v8
v_accvgpr_write_b32 a32, v240
v_accvgpr_write_b32 a33, v241
v_accvgpr_write_b32 a34, v242
v_accvgpr_write_b32 a35, v243
v_accvgpr_write_b32 a36, v244
v_accvgpr_write_b32 a37, v245
v_accvgpr_write_b32 a38, v246
v_accvgpr_write_b32 a39, v247
v_accvgpr_read_b32 v240, a40
v_accvgpr_read_b32 v241, a41
v_accvgpr_read_b32 v242, a42
v_accvgpr_read_b32 v243, a43
v_accvgpr_read_b32 v244, a44
v_accvgpr_read_b32 v245, a45
v_accvgpr_read_b32 v246, a46
v_accvgpr_read_b32 v247, a47
v_mul_f32 v240, v240, v8
v_mul_f32 v241, v241, v8
v_mul_f32 v242, v242, v8
v_mul_f32 v243, v243, v8
v_mul_f32 v244, v244, v8
v_mul_f32 v245, v245, v8
v_mul_f32 v246, v246, v8
v_mul_f32 v247, v247, v8
v_accvgpr_write_b32 a40, v240
v_accvgpr_write_b32 a41, v241
v_accvgpr_write_b32 a42, v242
v_accvgpr_write_b32 a43, v243
v_accvgpr_write_b32 a44, v244
v_accvgpr_write_b32 a45, v245
v_accvgpr_write_b32 a46, v246
v_accvgpr_write_b32 a47, v247
v_accvgpr_read_b32 v240, a48
v_accvgpr_read_b32 v241, a49
v_accvgpr_read_b32 v242, a50
v_accvgpr_read_b32 v243, a51
v_accvgpr_read_b32 v244, a52
v_accvgpr_read_b32 v245, a53
v_accvgpr_read_b32 v246, a54
v_accvgpr_read_b32 v247, a55
v_mul_f32 v240, v240, v8
v_mul_f32 v241, v241, v8
v_mul_f32 v242, v242, v8
v_mul_f32 v243, v243, v8
v_mul_f32 v244, v244, v8
v_mul_f32 v245, v245, v8
v_mul_f32 v246, v246, v8
v_mul_f32 v247, v247, v8
v_accvgpr_write_b32 a48, v240
v_accvgpr_write_b32 a49, v241
v_accvgpr_write_b32 a50, v242
v_accvgpr_write_b32 a51, v243
v_accvgpr_write_b32 a52, v244
v_accvgpr_write_b32 a53, v245
v_accvgpr_write_b32 a54, v246
v_accvgpr_write_b32 a55, v247
v_accvgpr_read_b32 v240, a56
v_accvgpr_read_b32 v241, a57
v_accvgpr_read_b32 v242, a58
v_accvgpr_read_b32 v243, a59
v_accvgpr_read_b32 v244, a60
v_accvgpr_read_b32 v245, a61
v_accvgpr_read_b32 v246, a62
v_accvgpr_read_b32 v247, a63
v_mul_f32 v240, v240, v8
v_mul_f32 v241, v241, v8
v_mul_f32 v242, v242, v8
v_mul_f32 v243, v243, v8
v_mul_f32 v244, v244, v8
v_mul_f32 v245, v245, v8
v_mul_f32 v246, v246, v8
v_mul_f32 v247, v247, v8
v_accvgpr_write_b32 a56, v240
v_accvgpr_write_b32 a57, v241
v_accvgpr_write_b32 a58, v242
v_accvgpr_write_b32 a59, v243
v_accvgpr_write_b32 a60, v244
v_accvgpr_write_b32 a61, v245
v_accvgpr_write_b32 a62, v246
v_accvgpr_write_b32 a63, v247
v_accvgpr_read_b32 v240, a64
v_accvgpr_read_b32 v241, a65
v_accvgpr_read_b32 v242, a66
v_accvgpr_read_b32 v243, a67
v_accvgpr_read_b32 v244, a68
v_accvgpr_read_b32 v245, a69
v_accvgpr_read_b32 v246, a70
v_accvgpr_read_b32 v247, a71
v_mul_f32 v240, v240, v9
v_mul_f32 v241, v241, v9
v_mul_f32 v242, v242, v9
v_mul_f32 v243, v243, v9
v_mul_f32 v244, v244, v9
v_mul_f32 v245, v245, v9
v_mul_f32 v246, v246, v9
v_mul_f32 v247, v247, v9
v_accvgpr_write_b32 a64, v240
v_accvgpr_write_b32 a65, v241
v_accvgpr_write_b32 a66, v242
v_accvgpr_write_b32 a67, v243
v_accvgpr_write_b32 a68, v244
v_accvgpr_write_b32 a69, v245
v_accvgpr_write_b32 a70, v246
v_accvgpr_write_b32 a71, v247
v_accvgpr_read_b32 v240, a72
v_accvgpr_read_b32 v241, a73
v_accvgpr_read_b32 v242, a74
v_accvgpr_read_b32 v243, a75
v_accvgpr_read_b32 v244, a76
v_accvgpr_read_b32 v245, a77
v_accvgpr_read_b32 v246, a78
v_accvgpr_read_b32 v247, a79
v_mul_f32 v240, v240, v9
v_mul_f32 v241, v241, v9
v_mul_f32 v242, v242, v9
v_mul_f32 v243, v243, v9
v_mul_f32 v244, v244, v9
v_mul_f32 v245, v245, v9
v_mul_f32 v246, v246, v9
v_mul_f32 v247, v247, v9
v_accvgpr_write_b32 a72, v240
v_accvgpr_write_b32 a73, v241
v_accvgpr_write_b32 a74, v242
v_accvgpr_write_b32 a75, v243
v_accvgpr_write_b32 a76, v244
v_accvgpr_write_b32 a77, v245
v_accvgpr_write_b32 a78, v246
v_accvgpr_write_b32 a79, v247
v_accvgpr_read_b32 v240, a80
v_accvgpr_read_b32 v241, a81
v_accvgpr_read_b32 v242, a82
v_accvgpr_read_b32 v243, a83
v_accvgpr_read_b32 v244, a84
v_accvgpr_read_b32 v245, a85
v_accvgpr_read_b32 v246, a86
v_accvgpr_read_b32 v247, a87
v_mul_f32 v240, v240, v9
v_mul_f32 v241, v241, v9
v_mul_f32 v242, v242, v9
v_mul_f32 v243, v243, v9
v_mul_f32 v244, v244, v9
v_mul_f32 v245, v245, v9
v_mul_f32 v246, v246, v9
v_mul_f32 v247, v247, v9
v_accvgpr_write_b32 a80, v240
v_accvgpr_write_b32 a81, v241
v_accvgpr_write_b32 a82, v242
v_accvgpr_write_b32 a83, v243
v_accvgpr_write_b32 a84, v244
v_accvgpr_write_b32 a85, v245
v_accvgpr_write_b32 a86, v246
v_accvgpr_write_b32 a87, v247
v_accvgpr_read_b32 v240, a88
v_accvgpr_read_b32 v241, a89
v_accvgpr_read_b32 v242, a90
v_accvgpr_read_b32 v243, a91
v_accvgpr_read_b32 v244, a92
v_accvgpr_read_b32 v245, a93
v_accvgpr_read_b32 v246, a94
v_accvgpr_read_b32 v247, a95
v_mul_f32 v240, v240, v9
v_mul_f32 v241, v241, v9
v_mul_f32 v242, v242, v9
v_mul_f32 v243, v243, v9
v_mul_f32 v244, v244, v9
v_mul_f32 v245, v245, v9
v_mul_f32 v246, v246, v9
v_mul_f32 v247, v247, v9
v_accvgpr_write_b32 a88, v240
v_accvgpr_write_b32 a89, v241
v_accvgpr_write_b32 a90, v242
v_accvgpr_write_b32 a91, v243
v_accvgpr_write_b32 a92, v244
v_accvgpr_write_b32 a93, v245
v_accvgpr_write_b32 a94, v246
v_accvgpr_write_b32 a95, v247
v_accvgpr_read_b32 v240, a96
v_accvgpr_read_b32 v241, a97
v_accvgpr_read_b32 v242, a98
v_accvgpr_read_b32 v243, a99
v_accvgpr_read_b32 v244, a100
v_accvgpr_read_b32 v245, a101
v_accvgpr_read_b32 v246, a102
v_accvgpr_read_b32 v247, a103
v_mul_f32 v240, v240, v9
v_mul_f32 v241, v241, v9
v_mul_f32 v242, v242, v9
v_mul_f32 v243, v243, v9
v_mul_f32 v244, v244, v9
v_mul_f32 v245, v245, v9
v_mul_f32 v246, v246, v9
v_mul_f32 v247, v247, v9
v_accvgpr_write_b32 a96, v240
v_accvgpr_write_b32 a97, v241
v_accvgpr_write_b32 a98, v242
v_accvgpr_write_b32 a99, v243
v_accvgpr_write_b32 a100, v244
v_accvgpr_write_b32 a101, v245
v_accvgpr_write_b32 a102, v246
v_accvgpr_write_b32 a103, v247
v_accvgpr_read_b32 v240, a104
v_accvgpr_read_b32 v241, a105
v_accvgpr_read_b32 v242, a106
v_accvgpr_read_b32 v243, a107
v_accvgpr_read_b32 v244, a108
v_accvgpr_read_b32 v245, a109
v_accvgpr_read_b32 v246, a110
v_accvgpr_read_b32 v247, a111
v_mul_f32 v240, v240, v9
v_mul_f32 v241, v241, v9
v_mul_f32 v242, v242, v9
v_mul_f32 v243, v243, v9
v_mul_f32 v244, v244, v9
v_mul_f32 v245, v245, v9
v_mul_f32 v246, v246, v9
v_mul_f32 v247, v247, v9
v_accvgpr_write_b32 a104, v240
v_accvgpr_write_b32 a105, v241
v_accvgpr_write_b32 a106, v242
v_accvgpr_write_b32 a107, v243
v_accvgpr_write_b32 a108, v244
v_accvgpr_write_b32 a109, v245
v_accvgpr_write_b32 a110, v246
v_accvgpr_write_b32 a111, v247
v_accvgpr_read_b32 v240, a112
v_accvgpr_read_b32 v241, a113
v_accvgpr_read_b32 v242, a114
v_accvgpr_read_b32 v243, a115
v_accvgpr_read_b32 v244, a116
v_accvgpr_read_b32 v245, a117
v_accvgpr_read_b32 v246, a118
v_accvgpr_read_b32 v247, a119
v_mul_f32 v240, v240, v9
v_mul_f32 v241, v241, v9
v_mul_f32 v242, v242, v9
v_mul_f32 v243, v243, v9
v_mul_f32 v244, v244, v9
v_mul_f32 v245, v245, v9
v_mul_f32 v246, v246, v9
v_mul_f32 v247, v247, v9
v_accvgpr_write_b32 a112, v240
v_accvgpr_write_b32 a113, v241
v_accvgpr_write_b32 a114, v242
v_accvgpr_write_b32 a115, v243
v_accvgpr_write_b32 a116, v244
v_accvgpr_write_b32 a117, v245
v_accvgpr_write_b32 a118, v246
v_accvgpr_write_b32 a119, v247
v_accvgpr_read_b32 v240, a120
v_accvgpr_read_b32 v241, a121
v_accvgpr_read_b32 v242, a122
v_accvgpr_read_b32 v243, a123
v_accvgpr_read_b32 v244, a124
v_accvgpr_read_b32 v245, a125
v_accvgpr_read_b32 v246, a126
v_accvgpr_read_b32 v247, a127
v_mul_f32 v240, v240, v9
v_mul_f32 v241, v241, v9
v_mul_f32 v242, v242, v9
v_mul_f32 v243, v243, v9
v_mul_f32 v244, v244, v9
v_mul_f32 v245, v245, v9
v_mul_f32 v246, v246, v9
v_mul_f32 v247, v247, v9
v_accvgpr_write_b32 a120, v240
v_accvgpr_write_b32 a121, v241
v_accvgpr_write_b32 a122, v242
v_accvgpr_write_b32 a123, v243
v_accvgpr_write_b32 a124, v244
v_accvgpr_write_b32 a125, v245
v_accvgpr_write_b32 a126, v246
v_accvgpr_write_b32 a127, v247
s_nop 1
s_branch L_p3_d1_end
L_p3_d1m_rare:
v_mov_b32 v240, v6
v_mov_b32 v241, v6
s_nop 1
v_permlane32_swap_b32 v240, v241
v_max_f32 v242, v240, v241
v_max_f32 v242, 0, v242
v_exp_f32 v8, -v242
v_sub_f32 v208, v208, v242
v_sub_f32 v209, v209, v242
v_sub_f32 v210, v210, v242
v_sub_f32 v211, v211, v242
v_sub_f32 v212, v212, v242
v_sub_f32 v213, v213, v242
v_sub_f32 v214, v214, v242
v_sub_f32 v215, v215, v242
v_sub_f32 v216, v216, v242
v_sub_f32 v217, v217, v242
v_sub_f32 v218, v218, v242
v_sub_f32 v219, v219, v242
v_sub_f32 v220, v220, v242
v_sub_f32 v221, v221, v242
v_sub_f32 v222, v222, v242
v_sub_f32 v223, v223, v242
v_mul_f32 v2, v2, v8
v_mul_f32 v3, v3, v8
v_sub_f32 v80, v80, v242
v_sub_f32 v81, v81, v242
v_sub_f32 v82, v82, v242
v_sub_f32 v83, v83, v242
v_sub_f32 v84, v84, v242
v_sub_f32 v85, v85, v242
v_sub_f32 v86, v86, v242
v_sub_f32 v87, v87, v242
v_sub_f32 v88, v88, v242
v_sub_f32 v89, v89, v242
v_sub_f32 v90, v90, v242
v_sub_f32 v91, v91, v242
v_sub_f32 v92, v92, v242
v_sub_f32 v93, v93, v242
v_sub_f32 v94, v94, v242
v_sub_f32 v95, v95, v242
v_sub_f32 v112, v112, v242
v_sub_f32 v113, v113, v242
v_sub_f32 v114, v114, v242
v_sub_f32 v115, v115, v242
v_sub_f32 v116, v116, v242
v_sub_f32 v117, v117, v242
v_sub_f32 v118, v118, v242
v_sub_f32 v119, v119, v242
v_sub_f32 v120, v120, v242
v_sub_f32 v121, v121, v242
v_sub_f32 v122, v122, v242
v_sub_f32 v123, v123, v242
v_sub_f32 v124, v124, v242
v_sub_f32 v125, v125, v242
v_sub_f32 v126, v126, v242
v_sub_f32 v127, v127, v242
v_mov_b32 v240, v7
v_mov_b32 v241, v7
s_nop 1
v_permlane32_swap_b32 v240, v241
v_max_f32 v242, v240, v241
v_max_f32 v242, 0, v242
v_exp_f32 v9, -v242
v_sub_f32 v224, v224, v242
v_sub_f32 v225, v225, v242
v_sub_f32 v226, v226, v242
v_sub_f32 v227, v227, v242
v_sub_f32 v228, v228, v242
v_sub_f32 v229, v229, v242
v_sub_f32 v230, v230, v242
v_sub_f32 v231, v231, v242
v_sub_f32 v232, v232, v242
v_sub_f32 v233, v233, v242
v_sub_f32 v234, v234, v242
v_sub_f32 v235, v235, v242
v_sub_f32 v236, v236, v242
v_sub_f32 v237, v237, v242
v_sub_f32 v238, v238, v242
v_sub_f32 v239, v239, v242
v_mul_f32 v4, v4, v9
v_mul_f32 v5, v5, v9
v_sub_f32 v96, v96, v242
v_sub_f32 v97, v97, v242
v_sub_f32 v98, v98, v242
v_sub_f32 v99, v99, v242
v_sub_f32 v100, v100, v242
v_sub_f32 v101, v101, v242
v_sub_f32 v102, v102, v242
v_sub_f32 v103, v103, v242
v_sub_f32 v104, v104, v242
v_sub_f32 v105, v105, v242
v_sub_f32 v106, v106, v242
v_sub_f32 v107, v107, v242
v_sub_f32 v108, v108, v242
v_sub_f32 v109, v109, v242
v_sub_f32 v110, v110, v242
v_sub_f32 v111, v111, v242
v_sub_f32 v128, v128, v242
v_sub_f32 v129, v129, v242
v_sub_f32 v130, v130, v242
v_sub_f32 v131, v131, v242
v_sub_f32 v132, v132, v242
v_sub_f32 v133, v133, v242
v_sub_f32 v134, v134, v242
v_sub_f32 v135, v135, v242
v_sub_f32 v136, v136, v242
v_sub_f32 v137, v137, v242
v_sub_f32 v138, v138, v242
v_sub_f32 v139, v139, v242
v_sub_f32 v140, v140, v242
v_sub_f32 v141, v141, v242
v_sub_f32 v142, v142, v242
v_sub_f32 v143, v143, v242
s_add_u32 m0, s72, 16384
ds_read_b128 a[160:163], v10 offset:8192
v_exp_f32 v80, v80
v_exp_f32 v81, v81
v_mfma_f32_32x32x16_bf16 a[0:15], a[224:227], v[176:179], a[0:15]
ds_read_b128 a[164:167], v10 offset:9216
buffer_load_dwordx4 v12, s[52:55], s71 offen offset:0 sc1 lds
v_exp_f32 v82, v82
v_add_f32 v2, v2, v80
v_mfma_f32_32x32x16_bf16 a[64:79], a[224:227], v[192:195], a[64:79]
v_exp_f32 v83, v83
v_add_f32 v3, v3, v81
v_cvt_pk_bf16_f32 v80, v80, v81
v_exp_f32 v84, v84
v_mfma_f32_32x32x16_bf16 a[16:31], a[228:231], v[176:179], a[16:31]
ds_read_b128 a[168:171], v10 offset:10240
v_add_f32 v2, v2, v82
v_exp_f32 v85, v85
v_add_f32 v3, v3, v83
v_cvt_pk_bf16_f32 v81, v82, v83
v_mfma_f32_32x32x16_bf16 a[80:95], a[228:231], v[192:195], a[80:95]
ds_read_b128 a[172:175], v10 offset:11264
buffer_load_dwordx4 v12, s[52:55], s71 offen offset:1024 sc1 lds
v_exp_f32 v86, v86
v_add_f32 v2, v2, v84
v_mfma_f32_32x32x16_bf16 a[32:47], a[232:235], v[176:179], a[32:47]
v_exp_f32 v87, v87
v_add_f32 v3, v3, v85
v_cvt_pk_bf16_f32 v82, v84, v85
v_exp_f32 v88, v88
v_mfma_f32_32x32x16_bf16 a[96:111], a[232:235], v[192:195], a[96:111]
ds_read_b128 a[176:179], v10 offset:12288
v_add_f32 v2, v2, v86
v_exp_f32 v89, v89
v_add_f32 v3, v3, v87
v_cvt_pk_bf16_f32 v83, v86, v87
v_mfma_f32_32x32x16_bf16 a[48:63], a[236:239], v[176:179], a[48:63]
buffer_load_dwordx4 v12, s[52:55], s71 offen offset:2048 sc1 lds
v_exp_f32 v90, v90
v_add_f32 v2, v2, v88
v_exp_f32 v91, v91
v_mfma_f32_32x32x16_bf16 a[112:127], a[236:239], v[192:195], a[112:127]
ds_read_b128 a[180:183], v10 offset:13312
v_add_f32 v3, v3, v89
v_cvt_pk_bf16_f32 v88, v88, v89
v_exp_f32 v92, v92
v_add_f32 v2, v2, v90
v_mfma_f32_32x32x16_bf16 a[0:15], a[240:243], v[184:187], a[0:15]
ds_read_b128 a[184:187], v10 offset:14336
v_exp_f32 v93, v93
v_add_f32 v3, v3, v91
v_cvt_pk_bf16_f32 v89, v90, v91
v_mfma_f32_32x32x16_bf16 a[64:79], a[240:243], v[200:203], a[64:79]
buffer_load_dwordx4 v12, s[52:55], s71 offen offset:3072 sc1 lds
v_exp_f32 v94, v94
v_add_f32 v2, v2, v92
v_exp_f32 v95, v95
v_mfma_f32_32x32x16_bf16 a[16:31], a[244:247], v[184:187], a[16:31]
ds_read_b128 a[188:191], v10 offset:15360
v_add_f32 v3, v3, v93
v_cvt_pk_bf16_f32 v90, v92, v93
v_exp_f32 v96, v96
v_add_f32 v2, v2, v94
v_mfma_f32_32x32x16_bf16 a[80:95], a[244:247], v[200:203], a[80:95]
v_exp_f32 v97, v97
v_add_f32 v3, v3, v95
v_cvt_pk_bf16_f32 v91, v94, v95
v_exp_f32 v98, v98
v_mfma_f32_32x32x16_bf16 a[32:47], a[248:251], v[184:187], a[32:47]
s_xor_b32 s72, s72, 0x8000
v_add_f32 v4, v4, v96
v_exp_f32 v99, v99
v_add_f32 v5, v5, v97
v_cvt_pk_bf16_f32 v96, v96, v97
v_mfma_f32_32x32x16_bf16 a[96:111], a[248:251], v[200:203], a[96:111]
v_exp_f32 v100, v100
v_add_f32 v4, v4, v98
v_exp_f32 v101, v101
v_add_f32 v5, v5, v99
v_mfma_f32_32x32x16_bf16 a[48:63], a[252:255], v[184:187], a[48:63]
v_cvt_pk_bf16_f32 v97, v98, v99
v_exp_f32 v102, v102
v_add_f32 v4, v4, v100
v_exp_f32 v103, v103
v_mfma_f32_32x32x16_bf16 a[112:127], a[252:255], v[200:203], a[112:127]
v_add_f32 v5, v5, v101
v_cvt_pk_bf16_f32 v98, v100, v101
v_add_f32 v4, v4, v102
v_add_f32 v5, v5, v103
v_cvt_pk_bf16_f32 v99, v102, v103
s_nop 15
v_accvgpr_read_b32 v240, a0
v_accvgpr_read_b32 v241, a1
v_accvgpr_read_b32 v242, a2
v_accvgpr_read_b32 v243, a3
v_accvgpr_read_b32 v244, a4
v_accvgpr_read_b32 v245, a5
v_accvgpr_read_b32 v246, a6
v_accvgpr_read_b32 v247, a7
v_mul_f32 v240, v240, v8
v_mul_f32 v241, v241, v8
v_mul_f32 v242, v242, v8
v_mul_f32 v243, v243, v8
v_mul_f32 v244, v244, v8
v_mul_f32 v245, v245, v8
v_mul_f32 v246, v246, v8
v_mul_f32 v247, v247, v8
v_accvgpr_write_b32 a0, v240
v_accvgpr_write_b32 a1, v241
v_accvgpr_write_b32 a2, v242
v_accvgpr_write_b32 a3, v243
v_accvgpr_write_b32 a4, v244
v_accvgpr_write_b32 a5, v245
v_accvgpr_write_b32 a6, v246
v_accvgpr_write_b32 a7, v247
v_accvgpr_read_b32 v240, a8
v_accvgpr_read_b32 v241, a9
v_accvgpr_read_b32 v242, a10
v_accvgpr_read_b32 v243, a11
v_accvgpr_read_b32 v244, a12
v_accvgpr_read_b32 v245, a13
v_accvgpr_read_b32 v246, a14
v_accvgpr_read_b32 v247, a15
v_mul_f32 v240, v240, v8
v_mul_f32 v241, v241, v8
v_mul_f32 v242, v242, v8
v_mul_f32 v243, v243, v8
v_mul_f32 v244, v244, v8
v_mul_f32 v245, v245, v8
v_mul_f32 v246, v246, v8
v_mul_f32 v247, v247, v8
v_accvgpr_write_b32 a8, v240
v_accvgpr_write_b32 a9, v241
v_accvgpr_write_b32 a10, v242
v_accvgpr_write_b32 a11, v243
v_accvgpr_write_b32 a12, v244
v_accvgpr_write_b32 a13, v245
v_accvgpr_write_b32 a14, v246
v_accvgpr_write_b32 a15, v247
v_accvgpr_read_b32 v240, a16
v_accvgpr_read_b32 v241, a17
v_accvgpr_read_b32 v242, a18
v_accvgpr_read_b32 v243, a19
v_accvgpr_read_b32 v244, a20
v_accvgpr_read_b32 v245, a21
v_accvgpr_read_b32 v246, a22
v_accvgpr_read_b32 v247, a23
v_mul_f32 v240, v240, v8
v_mul_f32 v241, v241, v8
v_mul_f32 v242, v242, v8
v_mul_f32 v243, v243, v8
v_mul_f32 v244, v244, v8
v_mul_f32 v245, v245, v8
v_mul_f32 v246, v246, v8
v_mul_f32 v247, v247, v8
v_accvgpr_write_b32 a16, v240
v_accvgpr_write_b32 a17, v241
v_accvgpr_write_b32 a18, v242
v_accvgpr_write_b32 a19, v243
v_accvgpr_write_b32 a20, v244
v_accvgpr_write_b32 a21, v245
v_accvgpr_write_b32 a22, v246
v_accvgpr_write_b32 a23, v247
v_accvgpr_read_b32 v240, a24
v_accvgpr_read_b32 v241, a25
v_accvgpr_read_b32 v242, a26
v_accvgpr_read_b32 v243, a27
v_accvgpr_read_b32 v244, a28
v_accvgpr_read_b32 v245, a29
v_accvgpr_read_b32 v246, a30
v_accvgpr_read_b32 v247, a31
v_mul_f32 v240, v240, v8
v_mul_f32 v241, v241, v8
v_mul_f32 v242, v242, v8
v_mul_f32 v243, v243, v8
v_mul_f32 v244, v244, v8
v_mul_f32 v245, v245, v8
v_mul_f32 v246, v246, v8
v_mul_f32 v247, v247, v8
v_accvgpr_write_b32 a24, v240
v_accvgpr_write_b32 a25, v241
v_accvgpr_write_b32 a26, v242
v_accvgpr_write_b32 a27, v243
v_accvgpr_write_b32 a28, v244
v_accvgpr_write_b32 a29, v245
v_accvgpr_write_b32 a30, v246
v_accvgpr_write_b32 a31, v247
v_accvgpr_read_b32 v240, a32
v_accvgpr_read_b32 v241, a33
v_accvgpr_read_b32 v242, a34
v_accvgpr_read_b32 v243, a35
v_accvgpr_read_b32 v244, a36
v_accvgpr_read_b32 v245, a37
v_accvgpr_read_b32 v246, a38
v_accvgpr_read_b32 v247, a39
v_mul_f32 v240, v240, v8
v_mul_f32 v241, v241, v8
v_mul_f32 v242, v242, v8
v_mul_f32 v243, v243, v8
v_mul_f32 v244, v244, v8
v_mul_f32 v245, v245, v8
v_mul_f32 v246, v246, v8
v_mul_f32 v247, v247, v8
v_accvgpr_write_b32 a32, v240
v_accvgpr_write_b32 a33, v241
v_accvgpr_write_b32 a34, v242
v_accvgpr_write_b32 a35, v243
v_accvgpr_write_b32 a36, v244
v_accvgpr_write_b32 a37, v245
v_accvgpr_write_b32 a38, v246
v_accvgpr_write_b32 a39, v247
v_accvgpr_read_b32 v240, a40
v_accvgpr_read_b32 v241, a41
v_accvgpr_read_b32 v242, a42
v_accvgpr_read_b32 v243, a43
v_accvgpr_read_b32 v244, a44
v_accvgpr_read_b32 v245, a45
v_accvgpr_read_b32 v246, a46
v_accvgpr_read_b32 v247, a47
v_mul_f32 v240, v240, v8
v_mul_f32 v241, v241, v8
v_mul_f32 v242, v242, v8
v_mul_f32 v243, v243, v8
v_mul_f32 v244, v244, v8
v_mul_f32 v245, v245, v8
v_mul_f32 v246, v246, v8
v_mul_f32 v247, v247, v8
v_accvgpr_write_b32 a40, v240
v_accvgpr_write_b32 a41, v241
v_accvgpr_write_b32 a42, v242
v_accvgpr_write_b32 a43, v243
v_accvgpr_write_b32 a44, v244
v_accvgpr_write_b32 a45, v245
v_accvgpr_write_b32 a46, v246
v_accvgpr_write_b32 a47, v247
v_accvgpr_read_b32 v240, a48
v_accvgpr_read_b32 v241, a49
v_accvgpr_read_b32 v242, a50
v_accvgpr_read_b32 v243, a51
v_accvgpr_read_b32 v244, a52
v_accvgpr_read_b32 v245, a53
v_accvgpr_read_b32 v246, a54
v_accvgpr_read_b32 v247, a55
v_mul_f32 v240, v240, v8
v_mul_f32 v241, v241, v8
v_mul_f32 v242, v242, v8
v_mul_f32 v243, v243, v8
v_mul_f32 v244, v244, v8
v_mul_f32 v245, v245, v8
v_mul_f32 v246, v246, v8
v_mul_f32 v247, v247, v8
v_accvgpr_write_b32 a48, v240
v_accvgpr_write_b32 a49, v241
v_accvgpr_write_b32 a50, v242
v_accvgpr_write_b32 a51, v243
v_accvgpr_write_b32 a52, v244
v_accvgpr_write_b32 a53, v245
v_accvgpr_write_b32 a54, v246
v_accvgpr_write_b32 a55, v247
v_accvgpr_read_b32 v240, a56
v_accvgpr_read_b32 v241, a57
v_accvgpr_read_b32 v242, a58
v_accvgpr_read_b32 v243, a59
v_accvgpr_read_b32 v244, a60
v_accvgpr_read_b32 v245, a61
v_accvgpr_read_b32 v246, a62
v_accvgpr_read_b32 v247, a63
v_mul_f32 v240, v240, v8
v_mul_f32 v241, v241, v8
v_mul_f32 v242, v242, v8
v_mul_f32 v243, v243, v8
v_mul_f32 v244, v244, v8
v_mul_f32 v245, v245, v8
v_mul_f32 v246, v246, v8
v_mul_f32 v247, v247, v8
v_accvgpr_write_b32 a56, v240
v_accvgpr_write_b32 a57, v241
v_accvgpr_write_b32 a58, v242
v_accvgpr_write_b32 a59, v243
v_accvgpr_write_b32 a60, v244
v_accvgpr_write_b32 a61, v245
v_accvgpr_write_b32 a62, v246
v_accvgpr_write_b32 a63, v247
v_accvgpr_read_b32 v240, a64
v_accvgpr_read_b32 v241, a65
v_accvgpr_read_b32 v242, a66
v_accvgpr_read_b32 v243, a67
v_accvgpr_read_b32 v244, a68
v_accvgpr_read_b32 v245, a69
v_accvgpr_read_b32 v246, a70
v_accvgpr_read_b32 v247, a71
v_mul_f32 v240, v240, v9
v_mul_f32 v241, v241, v9
v_mul_f32 v242, v242, v9
v_mul_f32 v243, v243, v9
v_mul_f32 v244, v244, v9
v_mul_f32 v245, v245, v9
v_mul_f32 v246, v246, v9
v_mul_f32 v247, v247, v9
v_accvgpr_write_b32 a64, v240
v_accvgpr_write_b32 a65, v241
v_accvgpr_write_b32 a66, v242
v_accvgpr_write_b32 a67, v243
v_accvgpr_write_b32 a68, v244
v_accvgpr_write_b32 a69, v245
v_accvgpr_write_b32 a70, v246
v_accvgpr_write_b32 a71, v247
v_accvgpr_read_b32 v240, a72
v_accvgpr_read_b32 v241, a73
v_accvgpr_read_b32 v242, a74
v_accvgpr_read_b32 v243, a75
v_accvgpr_read_b32 v244, a76
v_accvgpr_read_b32 v245, a77
v_accvgpr_read_b32 v246, a78
v_accvgpr_read_b32 v247, a79
v_mul_f32 v240, v240, v9
v_mul_f32 v241, v241, v9
v_mul_f32 v242, v242, v9
v_mul_f32 v243, v243, v9
v_mul_f32 v244, v244, v9
v_mul_f32 v245, v245, v9
v_mul_f32 v246, v246, v9
v_mul_f32 v247, v247, v9
v_accvgpr_write_b32 a72, v240
v_accvgpr_write_b32 a73, v241
v_accvgpr_write_b32 a74, v242
v_accvgpr_write_b32 a75, v243
v_accvgpr_write_b32 a76, v244
v_accvgpr_write_b32 a77, v245
v_accvgpr_write_b32 a78, v246
v_accvgpr_write_b32 a79, v247
v_accvgpr_read_b32 v240, a80
v_accvgpr_read_b32 v241, a81
v_accvgpr_read_b32 v242, a82
v_accvgpr_read_b32 v243, a83
v_accvgpr_read_b32 v244, a84
v_accvgpr_read_b32 v245, a85
v_accvgpr_read_b32 v246, a86
v_accvgpr_read_b32 v247, a87
v_mul_f32 v240, v240, v9
v_mul_f32 v241, v241, v9
v_mul_f32 v242, v242, v9
v_mul_f32 v243, v243, v9
v_mul_f32 v244, v244, v9
v_mul_f32 v245, v245, v9
v_mul_f32 v246, v246, v9
v_mul_f32 v247, v247, v9
v_accvgpr_write_b32 a80, v240
v_accvgpr_write_b32 a81, v241
v_accvgpr_write_b32 a82, v242
v_accvgpr_write_b32 a83, v243
v_accvgpr_write_b32 a84, v244
v_accvgpr_write_b32 a85, v245
v_accvgpr_write_b32 a86, v246
v_accvgpr_write_b32 a87, v247
v_accvgpr_read_b32 v240, a88
v_accvgpr_read_b32 v241, a89
v_accvgpr_read_b32 v242, a90
v_accvgpr_read_b32 v243, a91
v_accvgpr_read_b32 v244, a92
v_accvgpr_read_b32 v245, a93
v_accvgpr_read_b32 v246, a94
v_accvgpr_read_b32 v247, a95
v_mul_f32 v240, v240, v9
v_mul_f32 v241, v241, v9
v_mul_f32 v242, v242, v9
v_mul_f32 v243, v243, v9
v_mul_f32 v244, v244, v9
v_mul_f32 v245, v245, v9
v_mul_f32 v246, v246, v9
v_mul_f32 v247, v247, v9
v_accvgpr_write_b32 a88, v240
v_accvgpr_write_b32 a89, v241
v_accvgpr_write_b32 a90, v242
v_accvgpr_write_b32 a91, v243
v_accvgpr_write_b32 a92, v244
v_accvgpr_write_b32 a93, v245
v_accvgpr_write_b32 a94, v246
v_accvgpr_write_b32 a95, v247
v_accvgpr_read_b32 v240, a96
v_accvgpr_read_b32 v241, a97
v_accvgpr_read_b32 v242, a98
v_accvgpr_read_b32 v243, a99
v_accvgpr_read_b32 v244, a100
v_accvgpr_read_b32 v245, a101
v_accvgpr_read_b32 v246, a102
v_accvgpr_read_b32 v247, a103
v_mul_f32 v240, v240, v9
v_mul_f32 v241, v241, v9
v_mul_f32 v242, v242, v9
v_mul_f32 v243, v243, v9
v_mul_f32 v244, v244, v9
v_mul_f32 v245, v245, v9
v_mul_f32 v246, v246, v9
v_mul_f32 v247, v247, v9
v_accvgpr_write_b32 a96, v240
v_accvgpr_write_b32 a97, v241
v_accvgpr_write_b32 a98, v242
v_accvgpr_write_b32 a99, v243
v_accvgpr_write_b32 a100, v244
v_accvgpr_write_b32 a101, v245
v_accvgpr_write_b32 a102, v246
v_accvgpr_write_b32 a103, v247
v_accvgpr_read_b32 v240, a104
v_accvgpr_read_b32 v241, a105
v_accvgpr_read_b32 v242, a106
v_accvgpr_read_b32 v243, a107
v_accvgpr_read_b32 v244, a108
v_accvgpr_read_b32 v245, a109
v_accvgpr_read_b32 v246, a110
v_accvgpr_read_b32 v247, a111
v_mul_f32 v240, v240, v9
v_mul_f32 v241, v241, v9
v_mul_f32 v242, v242, v9
v_mul_f32 v243, v243, v9
v_mul_f32 v244, v244, v9
v_mul_f32 v245, v245, v9
v_mul_f32 v246, v246, v9
v_mul_f32 v247, v247, v9
v_accvgpr_write_b32 a104, v240
v_accvgpr_write_b32 a105, v241
v_accvgpr_write_b32 a106, v242
v_accvgpr_write_b32 a107, v243
v_accvgpr_write_b32 a108, v244
v_accvgpr_write_b32 a109, v245
v_accvgpr_write_b32 a110, v246
v_accvgpr_write_b32 a111, v247
v_accvgpr_read_b32 v240, a112
v_accvgpr_read_b32 v241, a113
v_accvgpr_read_b32 v242, a114
v_accvgpr_read_b32 v243, a115
v_accvgpr_read_b32 v244, a116
v_accvgpr_read_b32 v245, a117
v_accvgpr_read_b32 v246, a118
v_accvgpr_read_b32 v247, a119
v_mul_f32 v240, v240, v9
v_mul_f32 v241, v241, v9
v_mul_f32 v242, v242, v9
v_mul_f32 v243, v243, v9
v_mul_f32 v244, v244, v9
v_mul_f32 v245, v245, v9
v_mul_f32 v246, v246, v9
v_mul_f32 v247, v247, v9
v_accvgpr_write_b32 a112, v240
v_accvgpr_write_b32 a113, v241
v_accvgpr_write_b32 a114, v242
v_accvgpr_write_b32 a115, v243
v_accvgpr_write_b32 a116, v244
v_accvgpr_write_b32 a117, v245
v_accvgpr_write_b32 a118, v246
v_accvgpr_write_b32 a119, v247
v_accvgpr_read_b32 v240, a120
v_accvgpr_read_b32 v241, a121
v_accvgpr_read_b32 v242, a122
v_accvgpr_read_b32 v243, a123
v_accvgpr_read_b32 v244, a124
v_accvgpr_read_b32 v245, a125
v_accvgpr_read_b32 v246, a126
v_accvgpr_read_b32 v247, a127
v_mul_f32 v240, v240, v9
v_mul_f32 v241, v241, v9
v_mul_f32 v242, v242, v9
v_mul_f32 v243, v243, v9
v_mul_f32 v244, v244, v9
v_mul_f32 v245, v245, v9
v_mul_f32 v246, v246, v9
v_mul_f32 v247, v247, v9
v_accvgpr_write_b32 a120, v240
v_accvgpr_write_b32 a121, v241
v_accvgpr_write_b32 a122, v242
v_accvgpr_write_b32 a123, v243
v_accvgpr_write_b32 a124, v244
v_accvgpr_write_b32 a125, v245
v_accvgpr_write_b32 a126, v246
v_accvgpr_write_b32 a127, v247
s_nop 1
s_branch L_p3_d1m_end
L_p3_d0m_rare:
v_mov_b32 v240, v6
v_mov_b32 v241, v6
s_nop 1
v_permlane32_swap_b32 v240, v241
v_max_f32 v242, v240, v241
v_max_f32 v242, 0, v242
v_exp_f32 v8, -v242
v_sub_f32 v208, v208, v242
v_sub_f32 v209, v209, v242
v_sub_f32 v210, v210, v242
v_sub_f32 v211, v211, v242
v_sub_f32 v212, v212, v242
v_sub_f32 v213, v213, v242
v_sub_f32 v214, v214, v242
v_sub_f32 v215, v215, v242
v_sub_f32 v216, v216, v242
v_sub_f32 v217, v217, v242
v_sub_f32 v218, v218, v242
v_sub_f32 v219, v219, v242
v_sub_f32 v220, v220, v242
v_sub_f32 v221, v221, v242
v_sub_f32 v222, v222, v242
v_sub_f32 v223, v223, v242
v_mul_f32 v2, v2, v8
v_mul_f32 v3, v3, v8
v_sub_f32 v144, v144, v242
v_sub_f32 v145, v145, v242
v_sub_f32 v146, v146, v242
v_sub_f32 v147, v147, v242
v_sub_f32 v148, v148, v242
v_sub_f32 v149, v149, v242
v_sub_f32 v150, v150, v242
v_sub_f32 v151, v151, v242
v_sub_f32 v152, v152, v242
v_sub_f32 v153, v153, v242
v_sub_f32 v154, v154, v242
v_sub_f32 v155, v155, v242
v_sub_f32 v156, v156, v242
v_sub_f32 v157, v157, v242
v_sub_f32 v158, v158, v242
v_sub_f32 v159, v159, v242
v_sub_f32 v176, v176, v242
v_sub_f32 v177, v177, v242
v_sub_f32 v178, v178, v242
v_sub_f32 v179, v179, v242
v_sub_f32 v180, v180, v242
v_sub_f32 v181, v181, v242
v_sub_f32 v182, v182, v242
v_sub_f32 v183, v183, v242
v_sub_f32 v184, v184, v242
v_sub_f32 v185, v185, v242
v_sub_f32 v186, v186, v242
v_sub_f32 v187, v187, v242
v_sub_f32 v188, v188, v242
v_sub_f32 v189, v189, v242
v_sub_f32 v190, v190, v242
v_sub_f32 v191, v191, v242
v_mov_b32 v240, v7
v_mov_b32 v241, v7
s_nop 1
v_permlane32_swap_b32 v240, v241
v_max_f32 v242, v240, v241
v_max_f32 v242, 0, v242
v_exp_f32 v9, -v242
v_sub_f32 v224, v224, v242
v_sub_f32 v225, v225, v242
v_sub_f32 v226, v226, v242
v_sub_f32 v227, v227, v242
v_sub_f32 v228, v228, v242
v_sub_f32 v229, v229, v242
v_sub_f32 v230, v230, v242
v_sub_f32 v231, v231, v242
v_sub_f32 v232, v232, v242
v_sub_f32 v233, v233, v242
v_sub_f32 v234, v234, v242
v_sub_f32 v235, v235, v242
v_sub_f32 v236, v236, v242
v_sub_f32 v237, v237, v242
v_sub_f32 v238, v238, v242
v_sub_f32 v239, v239, v242
v_mul_f32 v4, v4, v9
v_mul_f32 v5, v5, v9
v_sub_f32 v160, v160, v242
v_sub_f32 v161, v161, v242
v_sub_f32 v162, v162, v242
v_sub_f32 v163, v163, v242
v_sub_f32 v164, v164, v242
v_sub_f32 v165, v165, v242
v_sub_f32 v166, v166, v242
v_sub_f32 v167, v167, v242
v_sub_f32 v168, v168, v242
v_sub_f32 v169, v169, v242
v_sub_f32 v170, v170, v242
v_sub_f32 v171, v171, v242
v_sub_f32 v172, v172, v242
v_sub_f32 v173, v173, v242
v_sub_f32 v174, v174, v242
v_sub_f32 v175, v175, v242
v_sub_f32 v192, v192, v242
v_sub_f32 v193, v193, v242
v_sub_f32 v194, v194, v242
v_sub_f32 v195, v195, v242
v_sub_f32 v196, v196, v242
v_sub_f32 v197, v197, v242
v_sub_f32 v198, v198, v242
v_sub_f32 v199, v199, v242
v_sub_f32 v200, v200, v242
v_sub_f32 v201, v201, v242
v_sub_f32 v202, v202, v242
v_sub_f32 v203, v203, v242
v_sub_f32 v204, v204, v242
v_sub_f32 v205, v205, v242
v_sub_f32 v206, v206, v242
v_sub_f32 v207, v207, v242
s_add_u32 m0, s72, 0
ds_read_b128 a[160:163], v10 offset:24576
v_exp_f32 v144, v144
v_exp_f32 v145, v145
v_mfma_f32_32x32x16_bf16 a[0:15], a[224:227], v[112:115], a[0:15]
ds_read_b128 a[164:167], v10 offset:25600
buffer_load_dwordx4 v12, s[52:55], s71 offen offset:0 sc1 lds
v_exp_f32 v146, v146
v_add_f32 v2, v2, v144
v_mfma_f32_32x32x16_bf16 a[64:79], a[224:227], v[128:131], a[64:79]
v_exp_f32 v147, v147
v_add_f32 v3, v3, v145
v_cvt_pk_bf16_f32 v144, v144, v145
v_exp_f32 v148, v148
v_mfma_f32_32x32x16_bf16 a[16:31], a[228:231], v[112:115], a[16:31]
ds_read_b128 a[168:171], v10 offset:26624
v_add_f32 v2, v2, v146
v_exp_f32 v149, v149
v_add_f32 v3, v3, v147
v_cvt_pk_bf16_f32 v145, v146, v147
v_mfma_f32_32x32x16_bf16 a[80:95], a[228:231], v[128:131], a[80:95]
ds_read_b128 a[172:175], v10 offset:27648
buffer_load_dwordx4 v12, s[52:55], s71 offen offset:1024 sc1 lds
v_exp_f32 v150, v150
v_add_f32 v2, v2, v148
v_mfma_f32_32x32x16_bf16 a[32:47], a[232:235], v[112:115], a[32:47]
v_exp_f32 v151, v151
v_add_f32 v3, v3, v149
v_cvt_pk_bf16_f32 v146, v148, v149
v_exp_f32 v152, v152
v_mfma_f32_32x32x16_bf16 a[96:111], a[232:235], v[128:131], a[96:111]
ds_read_b128 a[176:179], v10 offset:28672
v_add_f32 v2, v2, v150
v_exp_f32 v153, v153
v_add_f32 v3, v3, v151
v_cvt_pk_bf16_f32 v147, v150, v151
v_mfma_f32_32x32x16_bf16 a[48:63], a[236:239], v[112:115], a[48:63]
buffer_load_dwordx4 v12, s[52:55], s71 offen offset:2048 sc1 lds
v_exp_f32 v154, v154
v_add_f32 v2, v2, v152
v_exp_f32 v155, v155
v_mfma_f32_32x32x16_bf16 a[112:127], a[236:239], v[128:131], a[112:127]
ds_read_b128 a[180:183], v10 offset:29696
v_add_f32 v3, v3, v153
v_cvt_pk_bf16_f32 v152, v152, v153
v_exp_f32 v156, v156
v_add_f32 v2, v2, v154
v_mfma_f32_32x32x16_bf16 a[0:15], a[240:243], v[120:123], a[0:15]
ds_read_b128 a[184:187], v10 offset:30720
v_exp_f32 v157, v157
v_add_f32 v3, v3, v155
v_cvt_pk_bf16_f32 v153, v154, v155
v_mfma_f32_32x32x16_bf16 a[64:79], a[240:243], v[136:139], a[64:79]
buffer_load_dwordx4 v12, s[52:55], s71 offen offset:3072 sc1 lds
v_exp_f32 v158, v158
v_add_f32 v2, v2, v156
v_exp_f32 v159, v159
v_mfma_f32_32x32x16_bf16 a[16:31], a[244:247], v[120:123], a[16:31]
ds_read_b128 a[188:191], v10 offset:31744
v_add_f32 v3, v3, v157
v_cvt_pk_bf16_f32 v154, v156, v157
v_exp_f32 v160, v160
v_add_f32 v2, v2, v158
v_mfma_f32_32x32x16_bf16 a[80:95], a[244:247], v[136:139], a[80:95]
v_exp_f32 v161, v161
v_add_f32 v3, v3, v159
v_cvt_pk_bf16_f32 v155, v158, v159
v_exp_f32 v162, v162
v_mfma_f32_32x32x16_bf16 a[32:47], a[248:251], v[120:123], a[32:47]
s_cmp_eq_u32 s70, 7
v_add_f32 v4, v4, v160
v_exp_f32 v163, v163
v_add_f32 v5, v5, v161
v_cvt_pk_bf16_f32 v160, v160, v161
v_mfma_f32_32x32x16_bf16 a[96:111], a[248:251], v[136:139], a[96:111]
v_exp_f32 v164, v164
v_add_f32 v4, v4, v162
v_exp_f32 v165, v165
v_add_f32 v5, v5, v163
v_mfma_f32_32x32x16_bf16 a[48:63], a[252:255], v[120:123], a[48:63]
v_cvt_pk_bf16_f32 v161, v162, v163
v_exp_f32 v166, v166
v_add_f32 v4, v4, v164
v_exp_f32 v167, v167
v_mfma_f32_32x32x16_bf16 a[112:127], a[252:255], v[136:139], a[112:127]
v_add_f32 v5, v5, v165
v_cvt_pk_bf16_f32 v162, v164, v165
v_add_f32 v4, v4, v166
v_add_f32 v5, v5, v167
v_cvt_pk_bf16_f32 v163, v166, v167
s_nop 15
v_accvgpr_read_b32 v240, a0
v_accvgpr_read_b32 v241, a1
v_accvgpr_read_b32 v242, a2
v_accvgpr_read_b32 v243, a3
v_accvgpr_read_b32 v244, a4
v_accvgpr_read_b32 v245, a5
v_accvgpr_read_b32 v246, a6
v_accvgpr_read_b32 v247, a7
v_mul_f32 v240, v240, v8
v_mul_f32 v241, v241, v8
v_mul_f32 v242, v242, v8
v_mul_f32 v243, v243, v8
v_mul_f32 v244, v244, v8
v_mul_f32 v245, v245, v8
v_mul_f32 v246, v246, v8
v_mul_f32 v247, v247, v8
v_accvgpr_write_b32 a0, v240
v_accvgpr_write_b32 a1, v241
v_accvgpr_write_b32 a2, v242
v_accvgpr_write_b32 a3, v243
v_accvgpr_write_b32 a4, v244
v_accvgpr_write_b32 a5, v245
v_accvgpr_write_b32 a6, v246
v_accvgpr_write_b32 a7, v247
v_accvgpr_read_b32 v240, a8
v_accvgpr_read_b32 v241, a9
v_accvgpr_read_b32 v242, a10
v_accvgpr_read_b32 v243, a11
v_accvgpr_read_b32 v244, a12
v_accvgpr_read_b32 v245, a13
v_accvgpr_read_b32 v246, a14
v_accvgpr_read_b32 v247, a15
v_mul_f32 v240, v240, v8
v_mul_f32 v241, v241, v8
v_mul_f32 v242, v242, v8
v_mul_f32 v243, v243, v8
v_mul_f32 v244, v244, v8
v_mul_f32 v245, v245, v8
v_mul_f32 v246, v246, v8
v_mul_f32 v247, v247, v8
v_accvgpr_write_b32 a8, v240
v_accvgpr_write_b32 a9, v241
v_accvgpr_write_b32 a10, v242
v_accvgpr_write_b32 a11, v243
v_accvgpr_write_b32 a12, v244
v_accvgpr_write_b32 a13, v245
v_accvgpr_write_b32 a14, v246
v_accvgpr_write_b32 a15, v247
v_accvgpr_read_b32 v240, a16
v_accvgpr_read_b32 v241, a17
v_accvgpr_read_b32 v242, a18
v_accvgpr_read_b32 v243, a19
v_accvgpr_read_b32 v244, a20
v_accvgpr_read_b32 v245, a21
v_accvgpr_read_b32 v246, a22
v_accvgpr_read_b32 v247, a23
v_mul_f32 v240, v240, v8
v_mul_f32 v241, v241, v8
v_mul_f32 v242, v242, v8
v_mul_f32 v243, v243, v8
v_mul_f32 v244, v244, v8
v_mul_f32 v245, v245, v8
v_mul_f32 v246, v246, v8
v_mul_f32 v247, v247, v8
v_accvgpr_write_b32 a16, v240
v_accvgpr_write_b32 a17, v241
v_accvgpr_write_b32 a18, v242
v_accvgpr_write_b32 a19, v243
v_accvgpr_write_b32 a20, v244
v_accvgpr_write_b32 a21, v245
v_accvgpr_write_b32 a22, v246
v_accvgpr_write_b32 a23, v247
v_accvgpr_read_b32 v240, a24
v_accvgpr_read_b32 v241, a25
v_accvgpr_read_b32 v242, a26
v_accvgpr_read_b32 v243, a27
v_accvgpr_read_b32 v244, a28
v_accvgpr_read_b32 v245, a29
v_accvgpr_read_b32 v246, a30
v_accvgpr_read_b32 v247, a31
v_mul_f32 v240, v240, v8
v_mul_f32 v241, v241, v8
v_mul_f32 v242, v242, v8
v_mul_f32 v243, v243, v8
v_mul_f32 v244, v244, v8
v_mul_f32 v245, v245, v8
v_mul_f32 v246, v246, v8
v_mul_f32 v247, v247, v8
v_accvgpr_write_b32 a24, v240
v_accvgpr_write_b32 a25, v241
v_accvgpr_write_b32 a26, v242
v_accvgpr_write_b32 a27, v243
v_accvgpr_write_b32 a28, v244
v_accvgpr_write_b32 a29, v245
v_accvgpr_write_b32 a30, v246
v_accvgpr_write_b32 a31, v247
v_accvgpr_read_b32 v240, a32
v_accvgpr_read_b32 v241, a33
v_accvgpr_read_b32 v242, a34
v_accvgpr_read_b32 v243, a35
v_accvgpr_read_b32 v244, a36
v_accvgpr_read_b32 v245, a37
v_accvgpr_read_b32 v246, a38
v_accvgpr_read_b32 v247, a39
v_mul_f32 v240, v240, v8
v_mul_f32 v241, v241, v8
v_mul_f32 v242, v242, v8
v_mul_f32 v243, v243, v8
v_mul_f32 v244, v244, v8
v_mul_f32 v245, v245, v8
v_mul_f32 v246, v246, v8
v_mul_f32 v247, v247, v8
v_accvgpr_write_b32 a32, v240
v_accvgpr_write_b32 a33, v241
v_accvgpr_write_b32 a34, v242
v_accvgpr_write_b32 a35, v243
v_accvgpr_write_b32 a36, v244
v_accvgpr_write_b32 a37, v245
v_accvgpr_write_b32 a38, v246
v_accvgpr_write_b32 a39, v247
v_accvgpr_read_b32 v240, a40
v_accvgpr_read_b32 v241, a41
v_accvgpr_read_b32 v242, a42
v_accvgpr_read_b32 v243, a43
v_accvgpr_read_b32 v244, a44
v_accvgpr_read_b32 v245, a45
v_accvgpr_read_b32 v246, a46
v_accvgpr_read_b32 v247, a47
v_mul_f32 v240, v240, v8
v_mul_f32 v241, v241, v8
v_mul_f32 v242, v242, v8
v_mul_f32 v243, v243, v8
v_mul_f32 v244, v244, v8
v_mul_f32 v245, v245, v8
v_mul_f32 v246, v246, v8
v_mul_f32 v247, v247, v8
v_accvgpr_write_b32 a40, v240
v_accvgpr_write_b32 a41, v241
v_accvgpr_write_b32 a42, v242
v_accvgpr_write_b32 a43, v243
v_accvgpr_write_b32 a44, v244
v_accvgpr_write_b32 a45, v245
v_accvgpr_write_b32 a46, v246
v_accvgpr_write_b32 a47, v247
v_accvgpr_read_b32 v240, a48
v_accvgpr_read_b32 v241, a49
v_accvgpr_read_b32 v242, a50
v_accvgpr_read_b32 v243, a51
v_accvgpr_read_b32 v244, a52
v_accvgpr_read_b32 v245, a53
v_accvgpr_read_b32 v246, a54
v_accvgpr_read_b32 v247, a55
v_mul_f32 v240, v240, v8
v_mul_f32 v241, v241, v8
v_mul_f32 v242, v242, v8
v_mul_f32 v243, v243, v8
v_mul_f32 v244, v244, v8
v_mul_f32 v245, v245, v8
v_mul_f32 v246, v246, v8
v_mul_f32 v247, v247, v8
v_accvgpr_write_b32 a48, v240
v_accvgpr_write_b32 a49, v241
v_accvgpr_write_b32 a50, v242
v_accvgpr_write_b32 a51, v243
v_accvgpr_write_b32 a52, v244
v_accvgpr_write_b32 a53, v245
v_accvgpr_write_b32 a54, v246
v_accvgpr_write_b32 a55, v247
v_accvgpr_read_b32 v240, a56
v_accvgpr_read_b32 v241, a57
v_accvgpr_read_b32 v242, a58
v_accvgpr_read_b32 v243, a59
v_accvgpr_read_b32 v244, a60
v_accvgpr_read_b32 v245, a61
v_accvgpr_read_b32 v246, a62
v_accvgpr_read_b32 v247, a63
v_mul_f32 v240, v240, v8
v_mul_f32 v241, v241, v8
v_mul_f32 v242, v242, v8
v_mul_f32 v243, v243, v8
v_mul_f32 v244, v244, v8
v_mul_f32 v245, v245, v8
v_mul_f32 v246, v246, v8
v_mul_f32 v247, v247, v8
v_accvgpr_write_b32 a56, v240
v_accvgpr_write_b32 a57, v241
v_accvgpr_write_b32 a58, v242
v_accvgpr_write_b32 a59, v243
v_accvgpr_write_b32 a60, v244
v_accvgpr_write_b32 a61, v245
v_accvgpr_write_b32 a62, v246
v_accvgpr_write_b32 a63, v247
v_accvgpr_read_b32 v240, a64
v_accvgpr_read_b32 v241, a65
v_accvgpr_read_b32 v242, a66
v_accvgpr_read_b32 v243, a67
v_accvgpr_read_b32 v244, a68
v_accvgpr_read_b32 v245, a69
v_accvgpr_read_b32 v246, a70
v_accvgpr_read_b32 v247, a71
v_mul_f32 v240, v240, v9
v_mul_f32 v241, v241, v9
v_mul_f32 v242, v242, v9
v_mul_f32 v243, v243, v9
v_mul_f32 v244, v244, v9
v_mul_f32 v245, v245, v9
v_mul_f32 v246, v246, v9
v_mul_f32 v247, v247, v9
v_accvgpr_write_b32 a64, v240
v_accvgpr_write_b32 a65, v241
v_accvgpr_write_b32 a66, v242
v_accvgpr_write_b32 a67, v243
v_accvgpr_write_b32 a68, v244
v_accvgpr_write_b32 a69, v245
v_accvgpr_write_b32 a70, v246
v_accvgpr_write_b32 a71, v247
v_accvgpr_read_b32 v240, a72
v_accvgpr_read_b32 v241, a73
v_accvgpr_read_b32 v242, a74
v_accvgpr_read_b32 v243, a75
v_accvgpr_read_b32 v244, a76
v_accvgpr_read_b32 v245, a77
v_accvgpr_read_b32 v246, a78
v_accvgpr_read_b32 v247, a79
v_mul_f32 v240, v240, v9
v_mul_f32 v241, v241, v9
v_mul_f32 v242, v242, v9
v_mul_f32 v243, v243, v9
v_mul_f32 v244, v244, v9
v_mul_f32 v245, v245, v9
v_mul_f32 v246, v246, v9
v_mul_f32 v247, v247, v9
v_accvgpr_write_b32 a72, v240
v_accvgpr_write_b32 a73, v241
v_accvgpr_write_b32 a74, v242
v_accvgpr_write_b32 a75, v243
v_accvgpr_write_b32 a76, v244
v_accvgpr_write_b32 a77, v245
v_accvgpr_write_b32 a78, v246
v_accvgpr_write_b32 a79, v247
v_accvgpr_read_b32 v240, a80
v_accvgpr_read_b32 v241, a81
v_accvgpr_read_b32 v242, a82
v_accvgpr_read_b32 v243, a83
v_accvgpr_read_b32 v244, a84
v_accvgpr_read_b32 v245, a85
v_accvgpr_read_b32 v246, a86
v_accvgpr_read_b32 v247, a87
v_mul_f32 v240, v240, v9
v_mul_f32 v241, v241, v9
v_mul_f32 v242, v242, v9
v_mul_f32 v243, v243, v9
v_mul_f32 v244, v244, v9
v_mul_f32 v245, v245, v9
v_mul_f32 v246, v246, v9
v_mul_f32 v247, v247, v9
v_accvgpr_write_b32 a80, v240
v_accvgpr_write_b32 a81, v241
v_accvgpr_write_b32 a82, v242
v_accvgpr_write_b32 a83, v243
v_accvgpr_write_b32 a84, v244
v_accvgpr_write_b32 a85, v245
v_accvgpr_write_b32 a86, v246
v_accvgpr_write_b32 a87, v247
v_accvgpr_read_b32 v240, a88
v_accvgpr_read_b32 v241, a89
v_accvgpr_read_b32 v242, a90
v_accvgpr_read_b32 v243, a91
v_accvgpr_read_b32 v244, a92
v_accvgpr_read_b32 v245, a93
v_accvgpr_read_b32 v246, a94
v_accvgpr_read_b32 v247, a95
v_mul_f32 v240, v240, v9
v_mul_f32 v241, v241, v9
v_mul_f32 v242, v242, v9
v_mul_f32 v243, v243, v9
v_mul_f32 v244, v244, v9
v_mul_f32 v245, v245, v9
v_mul_f32 v246, v246, v9
v_mul_f32 v247, v247, v9
v_accvgpr_write_b32 a88, v240
v_accvgpr_write_b32 a89, v241
v_accvgpr_write_b32 a90, v242
v_accvgpr_write_b32 a91, v243
v_accvgpr_write_b32 a92, v244
v_accvgpr_write_b32 a93, v245
v_accvgpr_write_b32 a94, v246
v_accvgpr_write_b32 a95, v247
v_accvgpr_read_b32 v240, a96
v_accvgpr_read_b32 v241, a97
v_accvgpr_read_b32 v242, a98
v_accvgpr_read_b32 v243, a99
v_accvgpr_read_b32 v244, a100
v_accvgpr_read_b32 v245, a101
v_accvgpr_read_b32 v246, a102
v_accvgpr_read_b32 v247, a103
v_mul_f32 v240, v240, v9
v_mul_f32 v241, v241, v9
v_mul_f32 v242, v242, v9
v_mul_f32 v243, v243, v9
v_mul_f32 v244, v244, v9
v_mul_f32 v245, v245, v9
v_mul_f32 v246, v246, v9
v_mul_f32 v247, v247, v9
v_accvgpr_write_b32 a96, v240
v_accvgpr_write_b32 a97, v241
v_accvgpr_write_b32 a98, v242
v_accvgpr_write_b32 a99, v243
v_accvgpr_write_b32 a100, v244
v_accvgpr_write_b32 a101, v245
v_accvgpr_write_b32 a102, v246
v_accvgpr_write_b32 a103, v247
v_accvgpr_read_b32 v240, a104
v_accvgpr_read_b32 v241, a105
v_accvgpr_read_b32 v242, a106
v_accvgpr_read_b32 v243, a107
v_accvgpr_read_b32 v244, a108
v_accvgpr_read_b32 v245, a109
v_accvgpr_read_b32 v246, a110
v_accvgpr_read_b32 v247, a111
v_mul_f32 v240, v240, v9
v_mul_f32 v241, v241, v9
v_mul_f32 v242, v242, v9
v_mul_f32 v243, v243, v9
v_mul_f32 v244, v244, v9
v_mul_f32 v245, v245, v9
v_mul_f32 v246, v246, v9
v_mul_f32 v247, v247, v9
v_accvgpr_write_b32 a104, v240
v_accvgpr_write_b32 a105, v241
v_accvgpr_write_b32 a106, v242
v_accvgpr_write_b32 a107, v243
v_accvgpr_write_b32 a108, v244
v_accvgpr_write_b32 a109, v245
v_accvgpr_write_b32 a110, v246
v_accvgpr_write_b32 a111, v247
v_accvgpr_read_b32 v240, a112
v_accvgpr_read_b32 v241, a113
v_accvgpr_read_b32 v242, a114
v_accvgpr_read_b32 v243, a115
v_accvgpr_read_b32 v244, a116
v_accvgpr_read_b32 v245, a117
v_accvgpr_read_b32 v246, a118
v_accvgpr_read_b32 v247, a119
v_mul_f32 v240, v240, v9
v_mul_f32 v241, v241, v9
v_mul_f32 v242, v242, v9
v_mul_f32 v243, v243, v9
v_mul_f32 v244, v244, v9
v_mul_f32 v245, v245, v9
v_mul_f32 v246, v246, v9
v_mul_f32 v247, v247, v9
v_accvgpr_write_b32 a112, v240
v_accvgpr_write_b32 a113, v241
v_accvgpr_write_b32 a114, v242
v_accvgpr_write_b32 a115, v243
v_accvgpr_write_b32 a116, v244
v_accvgpr_write_b32 a117, v245
v_accvgpr_write_b32 a118, v246
v_accvgpr_write_b32 a119, v247
v_accvgpr_read_b32 v240, a120
v_accvgpr_read_b32 v241, a121
v_accvgpr_read_b32 v242, a122
v_accvgpr_read_b32 v243, a123
v_accvgpr_read_b32 v244, a124
v_accvgpr_read_b32 v245, a125
v_accvgpr_read_b32 v246, a126
v_accvgpr_read_b32 v247, a127
v_mul_f32 v240, v240, v9
v_mul_f32 v241, v241, v9
v_mul_f32 v242, v242, v9
v_mul_f32 v243, v243, v9
v_mul_f32 v244, v244, v9
v_mul_f32 v245, v245, v9
v_mul_f32 v246, v246, v9
v_mul_f32 v247, v247, v9
v_accvgpr_write_b32 a120, v240
v_accvgpr_write_b32 a121, v241
v_accvgpr_write_b32 a122, v242
v_accvgpr_write_b32 a123, v243
v_accvgpr_write_b32 a124, v244
v_accvgpr_write_b32 a125, v245
v_accvgpr_write_b32 a126, v246
v_accvgpr_write_b32 a127, v247
s_nop 1
s_branch L_p3_d0m_end
L_p3_mx_rare:
v_mov_b32 v240, v6
v_mov_b32 v241, v6
s_nop 1
v_permlane32_swap_b32 v240, v241
v_max_f32 v242, v240, v241
v_max_f32 v242, 0, v242
v_exp_f32 v8, -v242
v_sub_f32 v208, v208, v242
v_sub_f32 v209, v209, v242
v_sub_f32 v210, v210, v242
v_sub_f32 v211, v211, v242
v_sub_f32 v212, v212, v242
v_sub_f32 v213, v213, v242
v_sub_f32 v214, v214, v242
v_sub_f32 v215, v215, v242
v_sub_f32 v216, v216, v242
v_sub_f32 v217, v217, v242
v_sub_f32 v218, v218, v242
v_sub_f32 v219, v219, v242
v_sub_f32 v220, v220, v242
v_sub_f32 v221, v221, v242
v_sub_f32 v222, v222, v242
v_sub_f32 v223, v223, v242
v_mul_f32 v2, v2, v8
v_mul_f32 v3, v3, v8
v_sub_f32 v80, v80, v242
v_sub_f32 v81, v81, v242
v_sub_f32 v82, v82, v242
v_sub_f32 v83, v83, v242
v_sub_f32 v84, v84, v242
v_sub_f32 v85, v85, v242
v_sub_f32 v86, v86, v242
v_sub_f32 v87, v87, v242
v_sub_f32 v88, v88, v242
v_sub_f32 v89, v89, v242
v_sub_f32 v90, v90, v242
v_sub_f32 v91, v91, v242
v_sub_f32 v92, v92, v242
v_sub_f32 v93, v93, v242
v_sub_f32 v94, v94, v242
v_sub_f32 v95, v95, v242
v_sub_f32 v112, v112, v242
v_sub_f32 v113, v113, v242
v_sub_f32 v114, v114, v242
v_sub_f32 v115, v115, v242
v_sub_f32 v116, v116, v242
v_sub_f32 v117, v117, v242
v_sub_f32 v118, v118, v242
v_sub_f32 v119, v119, v242
v_sub_f32 v120, v120, v242
v_sub_f32 v121, v121, v242
v_sub_f32 v122, v122, v242
v_sub_f32 v123, v123, v242
v_sub_f32 v124, v124, v242
v_sub_f32 v125, v125, v242
v_sub_f32 v126, v126, v242
v_sub_f32 v127, v127, v242
s_add_u32 m0, s72, 16384
ds_read_b128 a[136:139], v10 offset:2048
v_exp_f32 v80, v80
v_bfe_u32 v248, v1, 2, 2
v_bfe_u32 v249, v1, 4, 1
v_mfma_f32_32x32x16_bf16 a[48:63], a[204:207], v[144:147], a[48:63]
ds_read_b128 a[140:143], v10 offset:3072
buffer_load_dwordx4 v12, s[52:55], s71 offen offset:0 sc1 lds
v_lshl_add_u32 v248, v249, 2, v248
v_lshrrev_b32 v249, 5, v1
v_exp_f32 v81, v81
v_mfma_f32_32x32x16_bf16 a[112:127], a[204:207], v[160:163], a[112:127]
v_lshl_add_u32 v249, v249, 4, v248
v_lshlrev_b32 v249, 8, v249
v_and_b32 v250, 3, v1
v_exp_f32 v82, v82
v_lshl_add_u32 v249, v250, 3, v249
v_mfma_f32_32x32x16_bf16 a[0:15], a[208:211], v[152:155], a[0:15]
ds_read_b128 a[144:147], v10 offset:4096
s_lshl_b32 s36, s3, 13
s_add_u32 s36, s36, 131072
v_add_f32 v2, v2, v80
v_add_u32 v249, s36, v249
s_waitcnt vmcnt(13)
v_mfma_f32_32x32x16_bf16 a[64:79], a[208:211], v[168:171], a[64:79]
ds_read_b128 a[148:151], v10 offset:5120
v_xor_b32 v250, 0, v248
v_lshl_add_u32 v250, v250, 5, v249
v_exp_f32 v83, v83
TR 96,250,0
v_mfma_f32_32x32x16_bf16 a[16:31], a[212:215], v[152:155], a[16:31]
TR 98,250,2048
v_xor_b32 v250, 1, v248
v_add_f32 v3, v3, v81
v_lshl_add_u32 v250, v250, 5, v249
TR 100,250,0
TR 102,250,2048
v_mfma_f32_32x32x16_bf16 a[80:95], a[212:215], v[168:171], a[80:95]
ds_read_b128 a[152:155], v10 offset:6144
buffer_load_dwordx4 v12, s[52:55], s71 offen offset:1024 sc1 lds
v_cvt_pk_bf16_f32 v80, v80, v81
v_xor_b32 v250, 2, v248
v_lshl_add_u32 v250, v250, 5, v249
TR 104,250,0
v_mfma_f32_32x32x16_bf16 a[32:47], a[216:219], v[152:155], a[32:47]
TR 106,250,2048
v_exp_f32 v84, v84
v_xor_b32 v250, 3, v248
v_lshl_add_u32 v250, v250, 5, v249
TR 108,250,0
v_mfma_f32_32x32x16_bf16 a[96:111], a[216:219], v[168:171], a[96:111]
ds_read_b128 a[156:159], v10 offset:7168
v_add_f32 v2, v2, v82
TR 110,250,2048
v_xor_b32 v250, 4, v248
v_lshl_add_u32 v250, v250, 5, v249
v_mfma_f32_32x32x16_bf16 a[48:63], a[220:223], v[152:155], a[48:63]
ds_read_b128 a[160:163], v10 offset:8192
v_exp_f32 v85, v85
TR 128,250,0
TR 130,250,2048
v_xor_b32 v250, 5, v248
v_mfma_f32_32x32x16_bf16 a[112:127], a[220:223], v[168:171], a[112:127]
v_add_f32 v3, v3, v83
v_cvt_pk_bf16_f32 v81, v82, v83
v_lshl_add_u32 v250, v250, 5, v249
TR 132,250,0
TR 134,250,2048
v_xor_b32 v250, 6, v248
v_mfma_f32_32x32x16_bf16 a[0:15], a[224:227], v[176:179], a[0:15]
ds_read_b128 a[164:167], v10 offset:9216
buffer_load_dwordx4 v12, s[52:55], s71 offen offset:2048 sc1 lds
v_exp_f32 v86, v86
v_lshl_add_u32 v250, v250, 5, v249
TR 136,250,0
v_mfma_f32_32x32x16_bf16 a[64:79], a[224:227], v[192:195], a[64:79]
TR 138,250,2048
v_add_f32 v2, v2, v84
v_xor_b32 v250, 7, v248
v_lshl_add_u32 v250, v250, 5, v249
TR 140,250,0
v_mfma_f32_32x32x16_bf16 a[16:31], a[228:231], v[176:179], a[16:31]
ds_read_b128 a[168:171], v10 offset:10240
v_exp_f32 v87, v87
TR 142,250,2048
s_add_u32 s32, s40, 100663296
s_addc_u32 s33, s41, 0
v_mfma_f32_32x32x16_bf16 a[80:95], a[228:231], v[192:195], a[80:95]
ds_read_b128 a[172:175], v10 offset:11264
s_mov_b32 s34, 8388608
v_add_f32 v3, v3, v85
s_mov_b32 s35, 0x20000
s_and_b32 s36, s2, 7
s_lshl_b32 s36, s36, 20
v_mfma_f32_32x32x16_bf16 a[32:47], a[232:235], v[176:179], a[32:47]
v_cvt_pk_bf16_f32 v82, v84, v85
s_lshr_b32 s37, s2, 3
s_lshl_b32 s37, s37, 15
s_add_u32 s36, s36, s37
v_mfma_f32_32x32x16_bf16 a[96:111], a[232:235], v[192:195], a[96:111]
ds_read_b128 a[176:179], v10 offset:12288
buffer_load_dwordx4 v12, s[52:55], s71 offen offset:3072 sc1 lds
v_exp_f32 v88, v88
s_lshl_b32 s37, s3, 12
s_add_u32 s36, s36, s37
v_mfma_f32_32x32x16_bf16 a[48:63], a[236:239], v[176:179], a[48:63]
s_add_u32 s37, s36, 4096
s_waitcnt lgkmcnt(15)
buffer_store_dwordx4 v[96:99], v12, s[32:35], s36 offen offset:0 sc1
v_add_f32 v2, v2, v86
buffer_store_dwordx4 v[100:103], v12, s[32:35], s36 offen offset:1024 sc1
buffer_store_dwordx4 v[104:107], v12, s[32:35], s36 offen offset:2048 sc1
s_waitcnt lgkmcnt(13)
buffer_store_dwordx4 v[108:111], v12, s[32:35], s36 offen offset:3072 sc1
v_mfma_f32_32x32x16_bf16 a[112:127], a[236:239], v[192:195], a[112:127]
ds_read_b128 a[180:183], v10 offset:13312
v_exp_f32 v89, v89
s_waitcnt lgkmcnt(11)
buffer_store_dwordx4 v[128:131], v12, s[32:35], s37 offen offset:0 sc1
s_waitcnt lgkmcnt(9)
buffer_store_dwordx4 v[132:135], v12, s[32:35], s37 offen offset:1024 sc1
s_waitcnt lgkmcnt(6)
buffer_store_dwordx4 v[136:139], v12, s[32:35], s37 offen offset:2048 sc1
v_mfma_f32_32x32x16_bf16 a[0:15], a[240:243], v[184:187], a[0:15]
ds_read_b128 a[184:187], v10 offset:14336
v_add_f32 v3, v3, v87
v_cvt_pk_bf16_f32 v83, v86, v87
s_waitcnt lgkmcnt(4)
buffer_store_dwordx4 v[140:143], v12, s[32:35], s37 offen offset:3072 sc1
s_add_u32 s32, s40, 109051904
s_addc_u32 s33, s41, 0
v_mfma_f32_32x32x16_bf16 a[64:79], a[240:243], v[200:203], a[64:79]
v_exp_f32 v90, v90
s_mov_b32 s34, 4194304
s_mov_b32 s35, 0x20000
s_lshl_b32 s36, s2, 14
v_mov_b32 v252, -1
v_mfma_f32_32x32x16_bf16 a[16:31], a[244:247], v[184:187], a[16:31]
ds_read_b128 a[188:191], v10 offset:15360
s_xor_b32 s72, s72, 0x8000
v_add_f32 v2, v2, v88
v_mov_b32 v253, -1
v_mov_b32 v254, -1
v_mov_b32 v255, -1
v_mfma_f32_32x32x16_bf16 a[80:95], a[244:247], v[200:203], a[80:95]
v_exp_f32 v91, v91
buffer_store_dwordx4 v[252:255], v12, s[32:35], s36 offen offset:0 sc1
buffer_store_dwordx4 v[252:255], v12, s[32:35], s36 offen offset:1024 sc1
buffer_store_dwordx4 v[252:255], v12, s[32:35], s36 offen offset:2048 sc1
v_mfma_f32_32x32x16_bf16 a[32:47], a[248:251], v[184:187], a[32:47]
v_add_f32 v3, v3, v89
buffer_store_dwordx4 v[252:255], v12, s[32:35], s36 offen offset:3072 sc1
v_lshlrev_b32 v72, 4, v1
v_add_u32 v73, -8, v72
v_mov_b32 v75, 0
v_mfma_f32_32x32x16_bf16 a[96:111], a[248:251], v[200:203], a[96:111]
v_cvt_pk_bf16_f32 v88, v88, v89
buffer_load_ushort v74, v75, s[28:31], s42 offen
buffer_load_dwordx2 v[48:49], v73, s[16:19], 0 offen
buffer_load_dwordx4 v[50:53], v72, s[16:19], 0 offen offset:0
v_mfma_f32_32x32x16_bf16 a[48:63], a[252:255], v[184:187], a[48:63]
v_add_f32 v2, v2, v90
v_add_f32 v3, v3, v91
buffer_load_dwordx2 v[54:55], v72, s[16:19], 0 offen offset:1016
buffer_load_dwordx4 v[56:59], v72, s[16:19], 0 offen offset:1024
buffer_load_dwordx2 v[60:61], v72, s[16:19], 0 offen offset:2040
v_mfma_f32_32x32x16_bf16 a[112:127], a[252:255], v[200:203], a[112:127]
v_cvt_pk_bf16_f32 v89, v90, v91
buffer_load_dwordx4 v[62:65], v72, s[16:19], 0 offen offset:2048
buffer_load_dwordx2 v[66:67], v72, s[16:19], 0 offen offset:3064
buffer_load_dwordx4 v[68:71], v72, s[16:19], 0 offen offset:3072
s_nop 15
v_accvgpr_read_b32 v240, a0
v_accvgpr_read_b32 v241, a1
v_accvgpr_read_b32 v242, a2
v_accvgpr_read_b32 v243, a3
v_accvgpr_read_b32 v244, a4
v_accvgpr_read_b32 v245, a5
v_accvgpr_read_b32 v246, a6
v_accvgpr_read_b32 v247, a7
v_mul_f32 v240, v240, v8
v_mul_f32 v241, v241, v8
v_mul_f32 v242, v242, v8
v_mul_f32 v243, v243, v8
v_mul_f32 v244, v244, v8
v_mul_f32 v245, v245, v8
v_mul_f32 v246, v246, v8
v_mul_f32 v247, v247, v8
v_accvgpr_write_b32 a0, v240
v_accvgpr_write_b32 a1, v241
v_accvgpr_write_b32 a2, v242
v_accvgpr_write_b32 a3, v243
v_accvgpr_write_b32 a4, v244
v_accvgpr_write_b32 a5, v245
v_accvgpr_write_b32 a6, v246
v_accvgpr_write_b32 a7, v247
v_accvgpr_read_b32 v240, a8
v_accvgpr_read_b32 v241, a9
v_accvgpr_read_b32 v242, a10
v_accvgpr_read_b32 v243, a11
v_accvgpr_read_b32 v244, a12
v_accvgpr_read_b32 v245, a13
v_accvgpr_read_b32 v246, a14
v_accvgpr_read_b32 v247, a15
v_mul_f32 v240, v240, v8
v_mul_f32 v241, v241, v8
v_mul_f32 v242, v242, v8
v_mul_f32 v243, v243, v8
v_mul_f32 v244, v244, v8
v_mul_f32 v245, v245, v8
v_mul_f32 v246, v246, v8
v_mul_f32 v247, v247, v8
v_accvgpr_write_b32 a8, v240
v_accvgpr_write_b32 a9, v241
v_accvgpr_write_b32 a10, v242
v_accvgpr_write_b32 a11, v243
v_accvgpr_write_b32 a12, v244
v_accvgpr_write_b32 a13, v245
v_accvgpr_write_b32 a14, v246
v_accvgpr_write_b32 a15, v247
v_accvgpr_read_b32 v240, a16
v_accvgpr_read_b32 v241, a17
v_accvgpr_read_b32 v242, a18
v_accvgpr_read_b32 v243, a19
v_accvgpr_read_b32 v244, a20
v_accvgpr_read_b32 v245, a21
v_accvgpr_read_b32 v246, a22
v_accvgpr_read_b32 v247, a23
v_mul_f32 v240, v240, v8
v_mul_f32 v241, v241, v8
v_mul_f32 v242, v242, v8
v_mul_f32 v243, v243, v8
v_mul_f32 v244, v244, v8
v_mul_f32 v245, v245, v8
v_mul_f32 v246, v246, v8
v_mul_f32 v247, v247, v8
v_accvgpr_write_b32 a16, v240
v_accvgpr_write_b32 a17, v241
v_accvgpr_write_b32 a18, v242
v_accvgpr_write_b32 a19, v243
v_accvgpr_write_b32 a20, v244
v_accvgpr_write_b32 a21, v245
v_accvgpr_write_b32 a22, v246
v_accvgpr_write_b32 a23, v247
v_accvgpr_read_b32 v240, a24
v_accvgpr_read_b32 v241, a25
v_accvgpr_read_b32 v242, a26
v_accvgpr_read_b32 v243, a27
v_accvgpr_read_b32 v244, a28
v_accvgpr_read_b32 v245, a29
v_accvgpr_read_b32 v246, a30
v_accvgpr_read_b32 v247, a31
v_mul_f32 v240, v240, v8
v_mul_f32 v241, v241, v8
v_mul_f32 v242, v242, v8
v_mul_f32 v243, v243, v8
v_mul_f32 v244, v244, v8
v_mul_f32 v245, v245, v8
v_mul_f32 v246, v246, v8
v_mul_f32 v247, v247, v8
v_accvgpr_write_b32 a24, v240
v_accvgpr_write_b32 a25, v241
v_accvgpr_write_b32 a26, v242
v_accvgpr_write_b32 a27, v243
v_accvgpr_write_b32 a28, v244
v_accvgpr_write_b32 a29, v245
v_accvgpr_write_b32 a30, v246
v_accvgpr_write_b32 a31, v247
v_accvgpr_read_b32 v240, a32
v_accvgpr_read_b32 v241, a33
v_accvgpr_read_b32 v242, a34
v_accvgpr_read_b32 v243, a35
v_accvgpr_read_b32 v244, a36
v_accvgpr_read_b32 v245, a37
v_accvgpr_read_b32 v246, a38
v_accvgpr_read_b32 v247, a39
v_mul_f32 v240, v240, v8
v_mul_f32 v241, v241, v8
v_mul_f32 v242, v242, v8
v_mul_f32 v243, v243, v8
v_mul_f32 v244, v244, v8
v_mul_f32 v245, v245, v8
v_mul_f32 v246, v246, v8
v_mul_f32 v247, v247, v8
v_accvgpr_write_b32 a32, v240
v_accvgpr_write_b32 a33, v241
v_accvgpr_write_b32 a34, v242
v_accvgpr_write_b32 a35, v243
v_accvgpr_write_b32 a36, v244
v_accvgpr_write_b32 a37, v245
v_accvgpr_write_b32 a38, v246
v_accvgpr_write_b32 a39, v247
v_accvgpr_read_b32 v240, a40
v_accvgpr_read_b32 v241, a41
v_accvgpr_read_b32 v242, a42
v_accvgpr_read_b32 v243, a43
v_accvgpr_read_b32 v244, a44
v_accvgpr_read_b32 v245, a45
v_accvgpr_read_b32 v246, a46
v_accvgpr_read_b32 v247, a47
v_mul_f32 v240, v240, v8
v_mul_f32 v241, v241, v8
v_mul_f32 v242, v242, v8
v_mul_f32 v243, v243, v8
v_mul_f32 v244, v244, v8
v_mul_f32 v245, v245, v8
v_mul_f32 v246, v246, v8
v_mul_f32 v247, v247, v8
v_accvgpr_write_b32 a40, v240
v_accvgpr_write_b32 a41, v241
v_accvgpr_write_b32 a42, v242
v_accvgpr_write_b32 a43, v243
v_accvgpr_write_b32 a44, v244
v_accvgpr_write_b32 a45, v245
v_accvgpr_write_b32 a46, v246
v_accvgpr_write_b32 a47, v247
v_accvgpr_read_b32 v240, a48
v_accvgpr_read_b32 v241, a49
v_accvgpr_read_b32 v242, a50
v_accvgpr_read_b32 v243, a51
v_accvgpr_read_b32 v244, a52
v_accvgpr_read_b32 v245, a53
v_accvgpr_read_b32 v246, a54
v_accvgpr_read_b32 v247, a55
v_mul_f32 v240, v240, v8
v_mul_f32 v241, v241, v8
v_mul_f32 v242, v242, v8
v_mul_f32 v243, v243, v8
v_mul_f32 v244, v244, v8
v_mul_f32 v245, v245, v8
v_mul_f32 v246, v246, v8
v_mul_f32 v247, v247, v8
v_accvgpr_write_b32 a48, v240
v_accvgpr_write_b32 a49, v241
v_accvgpr_write_b32 a50, v242
v_accvgpr_write_b32 a51, v243
v_accvgpr_write_b32 a52, v244
v_accvgpr_write_b32 a53, v245
v_accvgpr_write_b32 a54, v246
v_accvgpr_write_b32 a55, v247
v_accvgpr_read_b32 v240, a56
v_accvgpr_read_b32 v241, a57
v_accvgpr_read_b32 v242, a58
v_accvgpr_read_b32 v243, a59
v_accvgpr_read_b32 v244, a60
v_accvgpr_read_b32 v245, a61
v_accvgpr_read_b32 v246, a62
v_accvgpr_read_b32 v247, a63
v_mul_f32 v240, v240, v8
v_mul_f32 v241, v241, v8
v_mul_f32 v242, v242, v8
v_mul_f32 v243, v243, v8
v_mul_f32 v244, v244, v8
v_mul_f32 v245, v245, v8
v_mul_f32 v246, v246, v8
v_mul_f32 v247, v247, v8
v_accvgpr_write_b32 a56, v240
v_accvgpr_write_b32 a57, v241
v_accvgpr_write_b32 a58, v242
v_accvgpr_write_b32 a59, v243
v_accvgpr_write_b32 a60, v244
v_accvgpr_write_b32 a61, v245
v_accvgpr_write_b32 a62, v246
v_accvgpr_write_b32 a63, v247
s_nop 1
s_branch L_p3_mx_end
L_p3_mxm_rare:
v_mov_b32 v240, v6
v_mov_b32 v241, v6
s_nop 1
v_permlane32_swap_b32 v240, v241
v_max_f32 v242, v240, v241
v_max_f32 v242, 0, v242
v_exp_f32 v8, -v242
v_sub_f32 v208, v208, v242
v_sub_f32 v209, v209, v242
v_sub_f32 v210, v210, v242
v_sub_f32 v211, v211, v242
v_sub_f32 v212, v212, v242
v_sub_f32 v213, v213, v242
v_sub_f32 v214, v214, v242
v_sub_f32 v215, v215, v242
v_sub_f32 v216, v216, v242
v_sub_f32 v217, v217, v242
v_sub_f32 v218, v218, v242
v_sub_f32 v219, v219, v242
v_sub_f32 v220, v220, v242
v_sub_f32 v221, v221, v242
v_sub_f32 v222, v222, v242
v_sub_f32 v223, v223, v242
v_mul_f32 v2, v2, v8
v_mul_f32 v3, v3, v8
v_sub_f32 v80, v80, v242
v_sub_f32 v81, v81, v242
v_sub_f32 v82, v82, v242
v_sub_f32 v83, v83, v242
v_sub_f32 v84, v84, v242
v_sub_f32 v85, v85, v242
v_sub_f32 v86, v86, v242
v_sub_f32 v87, v87, v242
v_sub_f32 v88, v88, v242
v_sub_f32 v89, v89, v242
v_sub_f32 v90, v90, v242
v_sub_f32 v91, v91, v242
v_sub_f32 v92, v92, v242
v_sub_f32 v93, v93, v242
v_sub_f32 v94, v94, v242
v_sub_f32 v95, v95, v242
v_sub_f32 v112, v112, v242
v_sub_f32 v113, v113, v242
v_sub_f32 v114, v114, v242
v_sub_f32 v115, v115, v242
v_sub_f32 v116, v116, v242
v_sub_f32 v117, v117, v242
v_sub_f32 v118, v118, v242
v_sub_f32 v119, v119, v242
v_sub_f32 v120, v120, v242
v_sub_f32 v121, v121, v242
v_sub_f32 v122, v122, v242
v_sub_f32 v123, v123, v242
v_sub_f32 v124, v124, v242
v_sub_f32 v125, v125, v242
v_sub_f32 v126, v126, v242
v_sub_f32 v127, v127, v242
s_add_u32 m0, s72, 16384
ds_read_b128 a[152:155], v10 offset:6144
v_exp_f32 v80, v80
v_bfe_u32 v248, v1, 2, 2
v_bfe_u32 v249, v1, 4, 1
v_mfma_f32_32x32x16_bf16 a[32:47], a[216:219], v[152:155], a[32:47]
ds_read_b128 a[156:159], v10 offset:7168
buffer_load_dwordx4 v12, s[52:55], s71 offen offset:0 sc1 lds
v_lshl_add_u32 v248, v249, 2, v248
v_lshrrev_b32 v249, 5, v1
v_lshl_add_u32 v249, v249, 4, v248
v_lshlrev_b32 v249, 8, v249
v_mfma_f32_32x32x16_bf16 a[96:111], a[216:219], v[168:171], a[96:111]
v_exp_f32 v81, v81
v_and_b32 v250, 3, v1
v_lshl_add_u32 v249, v250, 3, v249
s_lshl_b32 s36, s3, 13
s_add_u32 s36, s36, 131072
v_mfma_f32_32x32x16_bf16 a[48:63], a[220:223], v[152:155], a[48:63]
ds_read_b128 a[160:163], v10 offset:8192
v_exp_f32 v82, v82
v_add_u32 v249, s36, v249
s_nop 0
v_xor_b32 v250, 0, v248
v_mfma_f32_32x32x16_bf16 a[112:127], a[220:223], v[168:171], a[112:127]
v_add_f32 v2, v2, v80
v_exp_f32 v83, v83
v_lshl_add_u32 v250, v250, 5, v249
TR 96,250,0
TR 98,250,2048
v_mfma_f32_32x32x16_bf16 a[0:15], a[224:227], v[176:179], a[0:15]
ds_read_b128 a[164:167], v10 offset:9216
buffer_load_dwordx4 v12, s[52:55], s71 offen offset:1024 sc1 lds
v_xor_b32 v250, 1, v248
v_add_f32 v3, v3, v81
v_lshl_add_u32 v250, v250, 5, v249
TR 100,250,0
v_mfma_f32_32x32x16_bf16 a[64:79], a[224:227], v[192:195], a[64:79]
ds_read_b128 a[168:171], v10 offset:10240
TR 102,250,2048
v_xor_b32 v250, 2, v248
v_lshl_add_u32 v250, v250, 5, v249
v_cvt_pk_bf16_f32 v80, v80, v81
TR 104,250,0
v_mfma_f32_32x32x16_bf16 a[16:31], a[228:231], v[176:179], a[16:31]
v_exp_f32 v84, v84
TR 106,250,2048
v_xor_b32 v250, 3, v248
v_lshl_add_u32 v250, v250, 5, v249
v_add_f32 v2, v2, v82
v_mfma_f32_32x32x16_bf16 a[80:95], a[228:231], v[192:195], a[80:95]
ds_read_b128 a[172:175], v10 offset:11264
TR 108,250,0
TR 110,250,2048
v_xor_b32 v250, 4, v248
v_lshl_add_u32 v250, v250, 5, v249
TR 128,250,0
v_mfma_f32_32x32x16_bf16 a[32:47], a[232:235], v[176:179], a[32:47]
buffer_load_dwordx4 v12, s[52:55], s71 offen offset:2048 sc1 lds
v_exp_f32 v85, v85
TR 130,250,2048
v_xor_b32 v250, 5, v248
v_lshl_add_u32 v250, v250, 5, v249
v_mfma_f32_32x32x16_bf16 a[96:111], a[232:235], v[192:195], a[96:111]
ds_read_b128 a[176:179], v10 offset:12288
v_add_f32 v3, v3, v83
v_cvt_pk_bf16_f32 v81, v82, v83
TR 132,250,0
TR 134,250,2048
v_xor_b32 v250, 6, v248
v_mfma_f32_32x32x16_bf16 a[48:63], a[236:239], v[176:179], a[48:63]
ds_read_b128 a[180:183], v10 offset:13312
v_lshl_add_u32 v250, v250, 5, v249
TR 136,250,0
v_exp_f32 v86, v86
TR 138,250,2048
v_mfma_f32_32x32x16_bf16 a[112:127], a[236:239], v[192:195], a[112:127]
v_xor_b32 v250, 7, v248
v_lshl_add_u32 v250, v250, 5, v249
TR 140,250,0
v_add_f32 v2, v2, v84
v_exp_f32 v87, v87
v_mfma_f32_32x32x16_bf16 a[0:15], a[240:243], v[184:187], a[0:15]
ds_read_b128 a[184:187], v10 offset:14336
buffer_load_dwordx4 v12, s[52:55], s71 offen offset:3072 sc1 lds
TR 142,250,2048
s_add_u32 s32, s40, 100663296
s_addc_u32 s33, s41, 0
s_mov_b32 s34, 8388608
v_mfma_f32_32x32x16_bf16 a[64:79], a[240:243], v[200:203], a[64:79]
v_add_f32 v3, v3, v85
s_mov_b32 s35, 0x20000
s_and_b32 s36, s2, 7
s_lshl_b32 s36, s36, 20
s_lshr_b32 s37, s2, 3
v_cvt_pk_bf16_f32 v82, v84, v85
v_mfma_f32_32x32x16_bf16 a[16:31], a[244:247], v[184:187], a[16:31]
ds_read_b128 a[188:191], v10 offset:15360
v_exp_f32 v88, v88
s_lshl_b32 s37, s37, 15
s_add_u32 s36, s36, s37
s_lshl_b32 s37, s3, 12
v_mfma_f32_32x32x16_bf16 a[80:95], a[244:247], v[200:203], a[80:95]
s_add_u32 s36, s36, s37
s_add_u32 s37, s36, 4096
v_add_f32 v2, v2, v86
s_waitcnt lgkmcnt(15)
buffer_store_dwordx4 v[96:99], v12, s[32:35], s36 offen offset:0 sc1
buffer_store_dwordx4 v[100:103], v12, s[32:35], s36 offen offset:1024 sc1
buffer_store_dwordx4 v[104:107], v12, s[32:35], s36 offen offset:2048 sc1
v_mfma_f32_32x32x16_bf16 a[32:47], a[248:251], v[184:187], a[32:47]
s_xor_b32 s72, s72, 0x8000
s_waitcnt lgkmcnt(12)
buffer_store_dwordx4 v[108:111], v12, s[32:35], s36 offen offset:3072 sc1
v_exp_f32 v89, v89
s_waitcnt lgkmcnt(10)
buffer_store_dwordx4 v[128:131], v12, s[32:35], s37 offen offset:0 sc1
s_waitcnt lgkmcnt(7)
buffer_store_dwordx4 v[132:135], v12, s[32:35], s37 offen offset:1024 sc1
v_mfma_f32_32x32x16_bf16 a[96:111], a[248:251], v[200:203], a[96:111]
s_waitcnt lgkmcnt(4)
buffer_store_dwordx4 v[136:139], v12, s[32:35], s37 offen offset:2048 sc1
s_waitcnt lgkmcnt(1)
buffer_store_dwordx4 v[140:143], v12, s[32:35], s37 offen offset:3072 sc1
v_add_f32 v3, v3, v87
v_cvt_pk_bf16_f32 v83, v86, v87
s_add_u32 s32, s40, 109051904
s_addc_u32 s33, s41, 0
v_mfma_f32_32x32x16_bf16 a[48:63], a[252:255], v[184:187], a[48:63]
s_mov_b32 s34, 4194304
s_mov_b32 s35, 0x20000
v_exp_f32 v90, v90
s_lshl_b32 s36, s2, 14
v_mov_b32 v252, -1
v_mfma_f32_32x32x16_bf16 a[112:127], a[252:255], v[200:203], a[112:127]
v_mov_b32 v253, -1
v_mov_b32 v254, -1
v_mov_b32 v255, -1
v_add_f32 v2, v2, v88
v_exp_f32 v91, v91
buffer_store_dwordx4 v[252:255], v12, s[32:35], s36 offen offset:0 sc1
buffer_store_dwordx4 v[252:255], v12, s[32:35], s36 offen offset:1024 sc1
buffer_store_dwordx4 v[252:255], v12, s[32:35], s36 offen offset:2048 sc1
buffer_store_dwordx4 v[252:255], v12, s[32:35], s36 offen offset:3072 sc1
v_add_f32 v3, v3, v89
v_lshlrev_b32 v72, 4, v1
v_add_u32 v73, -8, v72
v_mov_b32 v75, 0
buffer_load_ushort v74, v75, s[28:31], s42 offen
v_cvt_pk_bf16_f32 v88, v88, v89
v_add_f32 v2, v2, v90
buffer_load_dwordx2 v[48:49], v73, s[16:19], 0 offen
buffer_load_dwordx4 v[50:53], v72, s[16:19], 0 offen offset:0
buffer_load_dwordx2 v[54:55], v72, s[16:19], 0 offen offset:1016
buffer_load_dwordx4 v[56:59], v72, s[16:19], 0 offen offset:1024
v_add_f32 v3, v3, v91
v_cvt_pk_bf16_f32 v89, v90, v91
buffer_load_dwordx2 v[60:61], v72, s[16:19], 0 offen offset:2040
buffer_load_dwordx4 v[62:65], v72, s[16:19], 0 offen offset:2048
buffer_load_dwordx2 v[66:67], v72, s[16:19], 0 offen offset:3064
buffer_load_dwordx4 v[68:71], v72, s[16:19], 0 offen offset:3072
s_nop 15
v_accvgpr_read_b32 v240, a0
v_accvgpr_read_b32 v241, a1
v_accvgpr_read_b32 v242, a2
v_accvgpr_read_b32 v243, a3
v_accvgpr_read_b32 v244, a4
v_accvgpr_read_b32 v245, a5
v_accvgpr_read_b32 v246, a6
v_accvgpr_read_b32 v247, a7
v_mul_f32 v240, v240, v8
v_mul_f32 v241, v241, v8
v_mul_f32 v242, v242, v8
v_mul_f32 v243, v243, v8
v_mul_f32 v244, v244, v8
v_mul_f32 v245, v245, v8
v_mul_f32 v246, v246, v8
v_mul_f32 v247, v247, v8
v_accvgpr_write_b32 a0, v240
v_accvgpr_write_b32 a1, v241
v_accvgpr_write_b32 a2, v242
v_accvgpr_write_b32 a3, v243
v_accvgpr_write_b32 a4, v244
v_accvgpr_write_b32 a5, v245
v_accvgpr_write_b32 a6, v246
v_accvgpr_write_b32 a7, v247
v_accvgpr_read_b32 v240, a8
v_accvgpr_read_b32 v241, a9
v_accvgpr_read_b32 v242, a10
v_accvgpr_read_b32 v243, a11
v_accvgpr_read_b32 v244, a12
v_accvgpr_read_b32 v245, a13
v_accvgpr_read_b32 v246, a14
v_accvgpr_read_b32 v247, a15
v_mul_f32 v240, v240, v8
v_mul_f32 v241, v241, v8
v_mul_f32 v242, v242, v8
v_mul_f32 v243, v243, v8
v_mul_f32 v244, v244, v8
v_mul_f32 v245, v245, v8
v_mul_f32 v246, v246, v8
v_mul_f32 v247, v247, v8
v_accvgpr_write_b32 a8, v240
v_accvgpr_write_b32 a9, v241
v_accvgpr_write_b32 a10, v242
v_accvgpr_write_b32 a11, v243
v_accvgpr_write_b32 a12, v244
v_accvgpr_write_b32 a13, v245
v_accvgpr_write_b32 a14, v246
v_accvgpr_write_b32 a15, v247
v_accvgpr_read_b32 v240, a16
v_accvgpr_read_b32 v241, a17
v_accvgpr_read_b32 v242, a18
v_accvgpr_read_b32 v243, a19
v_accvgpr_read_b32 v244, a20
v_accvgpr_read_b32 v245, a21
v_accvgpr_read_b32 v246, a22
v_accvgpr_read_b32 v247, a23
v_mul_f32 v240, v240, v8
v_mul_f32 v241, v241, v8
v_mul_f32 v242, v242, v8
v_mul_f32 v243, v243, v8
v_mul_f32 v244, v244, v8
v_mul_f32 v245, v245, v8
v_mul_f32 v246, v246, v8
v_mul_f32 v247, v247, v8
v_accvgpr_write_b32 a16, v240
v_accvgpr_write_b32 a17, v241
v_accvgpr_write_b32 a18, v242
v_accvgpr_write_b32 a19, v243
v_accvgpr_write_b32 a20, v244
v_accvgpr_write_b32 a21, v245
v_accvgpr_write_b32 a22, v246
v_accvgpr_write_b32 a23, v247
v_accvgpr_read_b32 v240, a24
v_accvgpr_read_b32 v241, a25
v_accvgpr_read_b32 v242, a26
v_accvgpr_read_b32 v243, a27
v_accvgpr_read_b32 v244, a28
v_accvgpr_read_b32 v245, a29
v_accvgpr_read_b32 v246, a30
v_accvgpr_read_b32 v247, a31
v_mul_f32 v240, v240, v8
v_mul_f32 v241, v241, v8
v_mul_f32 v242, v242, v8
v_mul_f32 v243, v243, v8
v_mul_f32 v244, v244, v8
v_mul_f32 v245, v245, v8
v_mul_f32 v246, v246, v8
v_mul_f32 v247, v247, v8
v_accvgpr_write_b32 a24, v240
v_accvgpr_write_b32 a25, v241
v_accvgpr_write_b32 a26, v242
v_accvgpr_write_b32 a27, v243
v_accvgpr_write_b32 a28, v244
v_accvgpr_write_b32 a29, v245
v_accvgpr_write_b32 a30, v246
v_accvgpr_write_b32 a31, v247
v_accvgpr_read_b32 v240, a32
v_accvgpr_read_b32 v241, a33
v_accvgpr_read_b32 v242, a34
v_accvgpr_read_b32 v243, a35
v_accvgpr_read_b32 v244, a36
v_accvgpr_read_b32 v245, a37
v_accvgpr_read_b32 v246, a38
v_accvgpr_read_b32 v247, a39
v_mul_f32 v240, v240, v8
v_mul_f32 v241, v241, v8
v_mul_f32 v242, v242, v8
v_mul_f32 v243, v243, v8
v_mul_f32 v244, v244, v8
v_mul_f32 v245, v245, v8
v_mul_f32 v246, v246, v8
v_mul_f32 v247, v247, v8
v_accvgpr_write_b32 a32, v240
v_accvgpr_write_b32 a33, v241
v_accvgpr_write_b32 a34, v242
v_accvgpr_write_b32 a35, v243
v_accvgpr_write_b32 a36, v244
v_accvgpr_write_b32 a37, v245
v_accvgpr_write_b32 a38, v246
v_accvgpr_write_b32 a39, v247
v_accvgpr_read_b32 v240, a40
v_accvgpr_read_b32 v241, a41
v_accvgpr_read_b32 v242, a42
v_accvgpr_read_b32 v243, a43
v_accvgpr_read_b32 v244, a44
v_accvgpr_read_b32 v245, a45
v_accvgpr_read_b32 v246, a46
v_accvgpr_read_b32 v247, a47
v_mul_f32 v240, v240, v8
v_mul_f32 v241, v241, v8
v_mul_f32 v242, v242, v8
v_mul_f32 v243, v243, v8
v_mul_f32 v244, v244, v8
v_mul_f32 v245, v245, v8
v_mul_f32 v246, v246, v8
v_mul_f32 v247, v247, v8
v_accvgpr_write_b32 a40, v240
v_accvgpr_write_b32 a41, v241
v_accvgpr_write_b32 a42, v242
v_accvgpr_write_b32 a43, v243
v_accvgpr_write_b32 a44, v244
v_accvgpr_write_b32 a45, v245
v_accvgpr_write_b32 a46, v246
v_accvgpr_write_b32 a47, v247
v_accvgpr_read_b32 v240, a48
v_accvgpr_read_b32 v241, a49
v_accvgpr_read_b32 v242, a50
v_accvgpr_read_b32 v243, a51
v_accvgpr_read_b32 v244, a52
v_accvgpr_read_b32 v245, a53
v_accvgpr_read_b32 v246, a54
v_accvgpr_read_b32 v247, a55
v_mul_f32 v240, v240, v8
v_mul_f32 v241, v241, v8
v_mul_f32 v242, v242, v8
v_mul_f32 v243, v243, v8
v_mul_f32 v244, v244, v8
v_mul_f32 v245, v245, v8
v_mul_f32 v246, v246, v8
v_mul_f32 v247, v247, v8
v_accvgpr_write_b32 a48, v240
v_accvgpr_write_b32 a49, v241
v_accvgpr_write_b32 a50, v242
v_accvgpr_write_b32 a51, v243
v_accvgpr_write_b32 a52, v244
v_accvgpr_write_b32 a53, v245
v_accvgpr_write_b32 a54, v246
v_accvgpr_write_b32 a55, v247
v_accvgpr_read_b32 v240, a56
v_accvgpr_read_b32 v241, a57
v_accvgpr_read_b32 v242, a58
v_accvgpr_read_b32 v243, a59
v_accvgpr_read_b32 v244, a60
v_accvgpr_read_b32 v245, a61
v_accvgpr_read_b32 v246, a62
v_accvgpr_read_b32 v247, a63
v_mul_f32 v240, v240, v8
v_mul_f32 v241, v241, v8
v_mul_f32 v242, v242, v8
v_mul_f32 v243, v243, v8
v_mul_f32 v244, v244, v8
v_mul_f32 v245, v245, v8
v_mul_f32 v246, v246, v8
v_mul_f32 v247, v247, v8
v_accvgpr_write_b32 a56, v240
v_accvgpr_write_b32 a57, v241
v_accvgpr_write_b32 a58, v242
v_accvgpr_write_b32 a59, v243
v_accvgpr_write_b32 a60, v244
v_accvgpr_write_b32 a61, v245
v_accvgpr_write_b32 a62, v246
v_accvgpr_write_b32 a63, v247
s_nop 1
s_branch L_p3_mxm_end
L_p3_s0_rare:
v_mov_b32 v240, v6
v_mov_b32 v241, v6
s_nop 1
v_permlane32_swap_b32 v240, v241
v_max_f32 v242, v240, v241
v_max_f32 v242, 0, v242
v_exp_f32 v8, -v242
v_sub_f32 v208, v208, v242
v_sub_f32 v209, v209, v242
v_sub_f32 v210, v210, v242
v_sub_f32 v211, v211, v242
v_sub_f32 v212, v212, v242
v_sub_f32 v213, v213, v242
v_sub_f32 v214, v214, v242
v_sub_f32 v215, v215, v242
v_sub_f32 v216, v216, v242
v_sub_f32 v217, v217, v242
v_sub_f32 v218, v218, v242
v_sub_f32 v219, v219, v242
v_sub_f32 v220, v220, v242
v_sub_f32 v221, v221, v242
v_sub_f32 v222, v222, v242
v_sub_f32 v223, v223, v242
v_mul_f32 v2, v2, v8
v_mul_f32 v3, v3, v8
v_sub_f32 v144, v144, v242
v_sub_f32 v145, v145, v242
v_sub_f32 v146, v146, v242
v_sub_f32 v147, v147, v242
v_sub_f32 v148, v148, v242
v_sub_f32 v149, v149, v242
v_sub_f32 v150, v150, v242
v_sub_f32 v151, v151, v242
v_sub_f32 v152, v152, v242
v_sub_f32 v153, v153, v242
v_sub_f32 v154, v154, v242
v_sub_f32 v155, v155, v242
v_sub_f32 v156, v156, v242
v_sub_f32 v157, v157, v242
v_sub_f32 v158, v158, v242
v_sub_f32 v159, v159, v242
v_sub_f32 v176, v176, v242
v_sub_f32 v177, v177, v242
v_sub_f32 v178, v178, v242
v_sub_f32 v179, v179, v242
v_sub_f32 v180, v180, v242
v_sub_f32 v181, v181, v242
v_sub_f32 v182, v182, v242
v_sub_f32 v183, v183, v242
v_sub_f32 v184, v184, v242
v_sub_f32 v185, v185, v242
v_sub_f32 v186, v186, v242
v_sub_f32 v187, v187, v242
v_sub_f32 v188, v188, v242
v_sub_f32 v189, v189, v242
v_sub_f32 v190, v190, v242
v_sub_f32 v191, v191, v242
s_add_u32 m0, s72, 0
ds_read_b128 a[152:155], v10 offset:22528
ds_read_b128 a[156:159], v10 offset:23552
v_exp_f32 v144, v144
v_mfma_f32_32x32x16_bf16 a[32:47], a[216:219], v[88:91], a[32:47]
ds_read_b128 a[160:163], v10 offset:24576
buffer_load_dwordx4 v12, s[52:55], s71 offen offset:0 sc1 lds
v_exp_f32 v145, v145
v_exp_f32 v146, v146
v_mfma_f32_32x32x16_bf16 a[48:63], a[220:223], v[88:91], a[48:63]
ds_read_b128 a[164:167], v10 offset:25600
ds_read_b128 a[168:171], v10 offset:26624
v_add_f32 v2, v2, v144
v_exp_f32 v147, v147
v_add_f32 v3, v3, v145
v_mfma_f32_32x32x16_bf16 a[0:15], a[224:227], v[112:115], a[0:15]
ds_read_b128 a[172:175], v10 offset:27648
buffer_load_dwordx4 v12, s[52:55], s71 offen offset:1024 sc1 lds
v_cvt_pk_bf16_f32 v144, v144, v145
v_exp_f32 v148, v148
v_add_f32 v2, v2, v146
v_mfma_f32_32x32x16_bf16 a[16:31], a[228:231], v[112:115], a[16:31]
ds_read_b128 a[176:179], v10 offset:28672
ds_read_b128 a[180:183], v10 offset:29696
v_exp_f32 v149, v149
v_add_f32 v3, v3, v147
v_cvt_pk_bf16_f32 v145, v146, v147
v_mfma_f32_32x32x16_bf16 a[32:47], a[232:235], v[112:115], a[32:47]
ds_read_b128 a[184:187], v10 offset:30720
buffer_load_dwordx4 v12, s[52:55], s71 offen offset:2048 sc1 lds
v_exp_f32 v150, v150
v_add_f32 v2, v2, v148
v_mfma_f32_32x32x16_bf16 a[48:63], a[236:239], v[112:115], a[48:63]
ds_read_b128 a[188:191], v10 offset:31744
v_exp_f32 v151, v151
v_add_f32 v3, v3, v149
v_cvt_pk_bf16_f32 v146, v148, v149
v_mfma_f32_32x32x16_bf16 a[0:15], a[240:243], v[120:123], a[0:15]
buffer_load_dwordx4 v12, s[52:55], s71 offen offset:3072 sc1 lds
v_exp_f32 v152, v152
v_add_f32 v2, v2, v150
v_exp_f32 v153, v153
v_mfma_f32_32x32x16_bf16 a[16:31], a[244:247], v[120:123], a[16:31]
v_add_f32 v3, v3, v151
v_cvt_pk_bf16_f32 v147, v150, v151
v_exp_f32 v154, v154
v_add_f32 v2, v2, v152
v_mfma_f32_32x32x16_bf16 a[32:47], a[248:251], v[120:123], a[32:47]
s_sub_u32 s74, s74, 1
v_exp_f32 v155, v155
v_add_f32 v3, v3, v153
v_cvt_pk_bf16_f32 v152, v152, v153
v_mfma_f32_32x32x16_bf16 a[48:63], a[252:255], v[120:123], a[48:63]
v_add_f32 v2, v2, v154
v_add_f32 v3, v3, v155
v_cvt_pk_bf16_f32 v153, v154, v155
s_nop 15
v_accvgpr_read_b32 v240, a0
v_accvgpr_read_b32 v241, a1
v_accvgpr_read_b32 v242, a2
v_accvgpr_read_b32 v243, a3
v_accvgpr_read_b32 v244, a4
v_accvgpr_read_b32 v245, a5
v_accvgpr_read_b32 v246, a6
v_accvgpr_read_b32 v247, a7
v_mul_f32 v240, v240, v8
v_mul_f32 v241, v241, v8
v_mul_f32 v242, v242, v8
v_mul_f32 v243, v243, v8
v_mul_f32 v244, v244, v8
v_mul_f32 v245, v245, v8
v_mul_f32 v246, v246, v8
v_mul_f32 v247, v247, v8
v_accvgpr_write_b32 a0, v240
v_accvgpr_write_b32 a1, v241
v_accvgpr_write_b32 a2, v242
v_accvgpr_write_b32 a3, v243
v_accvgpr_write_b32 a4, v244
v_accvgpr_write_b32 a5, v245
v_accvgpr_write_b32 a6, v246
v_accvgpr_write_b32 a7, v247
v_accvgpr_read_b32 v240, a8
v_accvgpr_read_b32 v241, a9
v_accvgpr_read_b32 v242, a10
v_accvgpr_read_b32 v243, a11
v_accvgpr_read_b32 v244, a12
v_accvgpr_read_b32 v245, a13
v_accvgpr_read_b32 v246, a14
v_accvgpr_read_b32 v247, a15
v_mul_f32 v240, v240, v8
v_mul_f32 v241, v241, v8
v_mul_f32 v242, v242, v8
v_mul_f32 v243, v243, v8
v_mul_f32 v244, v244, v8
v_mul_f32 v245, v245, v8
v_mul_f32 v246, v246, v8
v_mul_f32 v247, v247, v8
v_accvgpr_write_b32 a8, v240
v_accvgpr_write_b32 a9, v241
v_accvgpr_write_b32 a10, v242
v_accvgpr_write_b32 a11, v243
v_accvgpr_write_b32 a12, v244
v_accvgpr_write_b32 a13, v245
v_accvgpr_write_b32 a14, v246
v_accvgpr_write_b32 a15, v247
v_accvgpr_read_b32 v240, a16
v_accvgpr_read_b32 v241, a17
v_accvgpr_read_b32 v242, a18
v_accvgpr_read_b32 v243, a19
v_accvgpr_read_b32 v244, a20
v_accvgpr_read_b32 v245, a21
v_accvgpr_read_b32 v246, a22
v_accvgpr_read_b32 v247, a23
v_mul_f32 v240, v240, v8
v_mul_f32 v241, v241, v8
v_mul_f32 v242, v242, v8
v_mul_f32 v243, v243, v8
v_mul_f32 v244, v244, v8
v_mul_f32 v245, v245, v8
v_mul_f32 v246, v246, v8
v_mul_f32 v247, v247, v8
v_accvgpr_write_b32 a16, v240
v_accvgpr_write_b32 a17, v241
v_accvgpr_write_b32 a18, v242
v_accvgpr_write_b32 a19, v243
v_accvgpr_write_b32 a20, v244
v_accvgpr_write_b32 a21, v245
v_accvgpr_write_b32 a22, v246
v_accvgpr_write_b32 a23, v247
v_accvgpr_read_b32 v240, a24
v_accvgpr_read_b32 v241, a25
v_accvgpr_read_b32 v242, a26
v_accvgpr_read_b32 v243, a27
v_accvgpr_read_b32 v244, a28
v_accvgpr_read_b32 v245, a29
v_accvgpr_read_b32 v246, a30
v_accvgpr_read_b32 v247, a31
v_mul_f32 v240, v240, v8
v_mul_f32 v241, v241, v8
v_mul_f32 v242, v242, v8
v_mul_f32 v243, v243, v8
v_mul_f32 v244, v244, v8
v_mul_f32 v245, v245, v8
v_mul_f32 v246, v246, v8
v_mul_f32 v247, v247, v8
v_accvgpr_write_b32 a24, v240
v_accvgpr_write_b32 a25, v241
v_accvgpr_write_b32 a26, v242
v_accvgpr_write_b32 a27, v243
v_accvgpr_write_b32 a28, v244
v_accvgpr_write_b32 a29, v245
v_accvgpr_write_b32 a30, v246
v_accvgpr_write_b32 a31, v247
v_accvgpr_read_b32 v240, a32
v_accvgpr_read_b32 v241, a33
v_accvgpr_read_b32 v242, a34
v_accvgpr_read_b32 v243, a35
v_accvgpr_read_b32 v244, a36
v_accvgpr_read_b32 v245, a37
v_accvgpr_read_b32 v246, a38
v_accvgpr_read_b32 v247, a39
v_mul_f32 v240, v240, v8
v_mul_f32 v241, v241, v8
v_mul_f32 v242, v242, v8
v_mul_f32 v243, v243, v8
v_mul_f32 v244, v244, v8
v_mul_f32 v245, v245, v8
v_mul_f32 v246, v246, v8
v_mul_f32 v247, v247, v8
v_accvgpr_write_b32 a32, v240
v_accvgpr_write_b32 a33, v241
v_accvgpr_write_b32 a34, v242
v_accvgpr_write_b32 a35, v243
v_accvgpr_write_b32 a36, v244
v_accvgpr_write_b32 a37, v245
v_accvgpr_write_b32 a38, v246
v_accvgpr_write_b32 a39, v247
v_accvgpr_read_b32 v240, a40
v_accvgpr_read_b32 v241, a41
v_accvgpr_read_b32 v242, a42
v_accvgpr_read_b32 v243, a43
v_accvgpr_read_b32 v244, a44
v_accvgpr_read_b32 v245, a45
v_accvgpr_read_b32 v246, a46
v_accvgpr_read_b32 v247, a47
v_mul_f32 v240, v240, v8
v_mul_f32 v241, v241, v8
v_mul_f32 v242, v242, v8
v_mul_f32 v243, v243, v8
v_mul_f32 v244, v244, v8
v_mul_f32 v245, v245, v8
v_mul_f32 v246, v246, v8
v_mul_f32 v247, v247, v8
v_accvgpr_write_b32 a40, v240
v_accvgpr_write_b32 a41, v241
v_accvgpr_write_b32 a42, v242
v_accvgpr_write_b32 a43, v243
v_accvgpr_write_b32 a44, v244
v_accvgpr_write_b32 a45, v245
v_accvgpr_write_b32 a46, v246
v_accvgpr_write_b32 a47, v247
v_accvgpr_read_b32 v240, a48
v_accvgpr_read_b32 v241, a49
v_accvgpr_read_b32 v242, a50
v_accvgpr_read_b32 v243, a51
v_accvgpr_read_b32 v244, a52
v_accvgpr_read_b32 v245, a53
v_accvgpr_read_b32 v246, a54
v_accvgpr_read_b32 v247, a55
v_mul_f32 v240, v240, v8
v_mul_f32 v241, v241, v8
v_mul_f32 v242, v242, v8
v_mul_f32 v243, v243, v8
v_mul_f32 v244, v244, v8
v_mul_f32 v245, v245, v8
v_mul_f32 v246, v246, v8
v_mul_f32 v247, v247, v8
v_accvgpr_write_b32 a48, v240
v_accvgpr_write_b32 a49, v241
v_accvgpr_write_b32 a50, v242
v_accvgpr_write_b32 a51, v243
v_accvgpr_write_b32 a52, v244
v_accvgpr_write_b32 a53, v245
v_accvgpr_write_b32 a54, v246
v_accvgpr_write_b32 a55, v247
v_accvgpr_read_b32 v240, a56
v_accvgpr_read_b32 v241, a57
v_accvgpr_read_b32 v242, a58
v_accvgpr_read_b32 v243, a59
v_accvgpr_read_b32 v244, a60
v_accvgpr_read_b32 v245, a61
v_accvgpr_read_b32 v246, a62
v_accvgpr_read_b32 v247, a63
v_mul_f32 v240, v240, v8
v_mul_f32 v241, v241, v8
v_mul_f32 v242, v242, v8
v_mul_f32 v243, v243, v8
v_mul_f32 v244, v244, v8
v_mul_f32 v245, v245, v8
v_mul_f32 v246, v246, v8
v_mul_f32 v247, v247, v8
v_accvgpr_write_b32 a56, v240
v_accvgpr_write_b32 a57, v241
v_accvgpr_write_b32 a58, v242
v_accvgpr_write_b32 a59, v243
v_accvgpr_write_b32 a60, v244
v_accvgpr_write_b32 a61, v245
v_accvgpr_write_b32 a62, v246
v_accvgpr_write_b32 a63, v247
s_nop 1
s_branch L_p3_s0_end
L_p3_s1_rare:
v_mov_b32 v240, v6
v_mov_b32 v241, v6
s_nop 1
v_permlane32_swap_b32 v240, v241
v_max_f32 v242, v240, v241
v_max_f32 v242, 0, v242
v_exp_f32 v8, -v242
v_sub_f32 v208, v208, v242
v_sub_f32 v209, v209, v242
v_sub_f32 v210, v210, v242
v_sub_f32 v211, v211, v242
v_sub_f32 v212, v212, v242
v_sub_f32 v213, v213, v242
v_sub_f32 v214, v214, v242
v_sub_f32 v215, v215, v242
v_sub_f32 v216, v216, v242
v_sub_f32 v217, v217, v242
v_sub_f32 v218, v218, v242
v_sub_f32 v219, v219, v242
v_sub_f32 v220, v220, v242
v_sub_f32 v221, v221, v242
v_sub_f32 v222, v222, v242
v_sub_f32 v223, v223, v242
v_mul_f32 v2, v2, v8
v_mul_f32 v3, v3, v8
v_sub_f32 v80, v80, v242
v_sub_f32 v81, v81, v242
v_sub_f32 v82, v82, v242
v_sub_f32 v83, v83, v242
v_sub_f32 v84, v84, v242
v_sub_f32 v85, v85, v242
v_sub_f32 v86, v86, v242
v_sub_f32 v87, v87, v242
v_sub_f32 v88, v88, v242
v_sub_f32 v89, v89, v242
v_sub_f32 v90, v90, v242
v_sub_f32 v91, v91, v242
v_sub_f32 v92, v92, v242
v_sub_f32 v93, v93, v242
v_sub_f32 v94, v94, v242
v_sub_f32 v95, v95, v242
v_sub_f32 v112, v112, v242
v_sub_f32 v113, v113, v242
v_sub_f32 v114, v114, v242
v_sub_f32 v115, v115, v242
v_sub_f32 v116, v116, v242
v_sub_f32 v117, v117, v242
v_sub_f32 v118, v118, v242
v_sub_f32 v119, v119, v242
v_sub_f32 v120, v120, v242
v_sub_f32 v121, v121, v242
v_sub_f32 v122, v122, v242
v_sub_f32 v123, v123, v242
v_sub_f32 v124, v124, v242
v_sub_f32 v125, v125, v242
v_sub_f32 v126, v126, v242
v_sub_f32 v127, v127, v242
s_add_u32 m0, s72, 16384
ds_read_b128 a[152:155], v10 offset:6144
ds_read_b128 a[156:159], v10 offset:7168
v_exp_f32 v80, v80
v_mfma_f32_32x32x16_bf16 a[32:47], a[216:219], v[152:155], a[32:47]
ds_read_b128 a[160:163], v10 offset:8192
buffer_load_dwordx4 v12, s[52:55], s71 offen offset:0 sc1 lds
v_exp_f32 v81, v81
v_exp_f32 v82, v82
v_mfma_f32_32x32x16_bf16 a[48:63], a[220:223], v[152:155], a[48:63]
ds_read_b128 a[164:167], v10 offset:9216
ds_read_b128 a[168:171], v10 offset:10240
buffer_load_dwordx4 v12, s[52:55], s71 offen offset:1024 sc1 lds
v_add_f32 v2, v2, v80
v_exp_f32 v83, v83
v_mfma_f32_32x32x16_bf16 a[0:15], a[224:227], v[176:179], a[0:15]
ds_read_b128 a[172:175], v10 offset:11264
v_add_f32 v3, v3, v81
v_cvt_pk_bf16_f32 v80, v80, v81
v_exp_f32 v84, v84
v_add_f32 v2, v2, v82
v_mfma_f32_32x32x16_bf16 a[16:31], a[228:231], v[176:179], a[16:31]
ds_read_b128 a[176:179], v10 offset:12288
ds_read_b128 a[180:183], v10 offset:13312
buffer_load_dwordx4 v12, s[52:55], s71 offen offset:2048 sc1 lds
v_exp_f32 v85, v85
v_add_f32 v3, v3, v83
v_mfma_f32_32x32x16_bf16 a[32:47], a[232:235], v[176:179], a[32:47]
ds_read_b128 a[184:187], v10 offset:14336
v_cvt_pk_bf16_f32 v81, v82, v83
v_exp_f32 v86, v86
v_add_f32 v2, v2, v84
v_mfma_f32_32x32x16_bf16 a[48:63], a[236:239], v[176:179], a[48:63]
ds_read_b128 a[188:191], v10 offset:15360
buffer_load_dwordx4 v12, s[52:55], s71 offen offset:3072 sc1 lds
v_exp_f32 v87, v87
v_add_f32 v3, v3, v85
v_cvt_pk_bf16_f32 v82, v84, v85
v_mfma_f32_32x32x16_bf16 a[0:15], a[240:243], v[184:187], a[0:15]
s_xor_b32 s72, s72, 0x8000
v_exp_f32 v88, v88
v_add_f32 v2, v2, v86
v_exp_f32 v89, v89
v_mfma_f32_32x32x16_bf16 a[16:31], a[244:247], v[184:187], a[16:31]
v_add_f32 v3, v3, v87
v_cvt_pk_bf16_f32 v83, v86, v87
v_exp_f32 v90, v90
v_add_f32 v2, v2, v88
v_mfma_f32_32x32x16_bf16 a[32:47], a[248:251], v[184:187], a[32:47]
buffer_store_dword v77, v76, s[8:11], s37 offen offset:1024 sc1
v_exp_f32 v91, v91
v_add_f32 v3, v3, v89
v_cvt_pk_bf16_f32 v88, v88, v89
v_mfma_f32_32x32x16_bf16 a[48:63], a[252:255], v[184:187], a[48:63]
v_add_f32 v2, v2, v90
v_add_f32 v3, v3, v91
v_cvt_pk_bf16_f32 v89, v90, v91
s_nop 15
v_accvgpr_read_b32 v240, a0
v_accvgpr_read_b32 v241, a1
v_accvgpr_read_b32 v242, a2
v_accvgpr_read_b32 v243, a3
v_accvgpr_read_b32 v244, a4
v_accvgpr_read_b32 v245, a5
v_accvgpr_read_b32 v246, a6
v_accvgpr_read_b32 v247, a7
v_mul_f32 v240, v240, v8
v_mul_f32 v241, v241, v8
v_mul_f32 v242, v242, v8
v_mul_f32 v243, v243, v8
v_mul_f32 v244, v244, v8
v_mul_f32 v245, v245, v8
v_mul_f32 v246, v246, v8
v_mul_f32 v247, v247, v8
v_accvgpr_write_b32 a0, v240
v_accvgpr_write_b32 a1, v241
v_accvgpr_write_b32 a2, v242
v_accvgpr_write_b32 a3, v243
v_accvgpr_write_b32 a4, v244
v_accvgpr_write_b32 a5, v245
v_accvgpr_write_b32 a6, v246
v_accvgpr_write_b32 a7, v247
v_accvgpr_read_b32 v240, a8
v_accvgpr_read_b32 v241, a9
v_accvgpr_read_b32 v242, a10
v_accvgpr_read_b32 v243, a11
v_accvgpr_read_b32 v244, a12
v_accvgpr_read_b32 v245, a13
v_accvgpr_read_b32 v246, a14
v_accvgpr_read_b32 v247, a15
v_mul_f32 v240, v240, v8
v_mul_f32 v241, v241, v8
v_mul_f32 v242, v242, v8
v_mul_f32 v243, v243, v8
v_mul_f32 v244, v244, v8
v_mul_f32 v245, v245, v8
v_mul_f32 v246, v246, v8
v_mul_f32 v247, v247, v8
v_accvgpr_write_b32 a8, v240
v_accvgpr_write_b32 a9, v241
v_accvgpr_write_b32 a10, v242
v_accvgpr_write_b32 a11, v243
v_accvgpr_write_b32 a12, v244
v_accvgpr_write_b32 a13, v245
v_accvgpr_write_b32 a14, v246
v_accvgpr_write_b32 a15, v247
v_accvgpr_read_b32 v240, a16
v_accvgpr_read_b32 v241, a17
v_accvgpr_read_b32 v242, a18
v_accvgpr_read_b32 v243, a19
v_accvgpr_read_b32 v244, a20
v_accvgpr_read_b32 v245, a21
v_accvgpr_read_b32 v246, a22
v_accvgpr_read_b32 v247, a23
v_mul_f32 v240, v240, v8
v_mul_f32 v241, v241, v8
v_mul_f32 v242, v242, v8
v_mul_f32 v243, v243, v8
v_mul_f32 v244, v244, v8
v_mul_f32 v245, v245, v8
v_mul_f32 v246, v246, v8
v_mul_f32 v247, v247, v8
v_accvgpr_write_b32 a16, v240
v_accvgpr_write_b32 a17, v241
v_accvgpr_write_b32 a18, v242
v_accvgpr_write_b32 a19, v243
v_accvgpr_write_b32 a20, v244
v_accvgpr_write_b32 a21, v245
v_accvgpr_write_b32 a22, v246
v_accvgpr_write_b32 a23, v247
v_accvgpr_read_b32 v240, a24
v_accvgpr_read_b32 v241, a25
v_accvgpr_read_b32 v242, a26
v_accvgpr_read_b32 v243, a27
v_accvgpr_read_b32 v244, a28
v_accvgpr_read_b32 v245, a29
v_accvgpr_read_b32 v246, a30
v_accvgpr_read_b32 v247, a31
v_mul_f32 v240, v240, v8
v_mul_f32 v241, v241, v8
v_mul_f32 v242, v242, v8
v_mul_f32 v243, v243, v8
v_mul_f32 v244, v244, v8
v_mul_f32 v245, v245, v8
v_mul_f32 v246, v246, v8
v_mul_f32 v247, v247, v8
v_accvgpr_write_b32 a24, v240
v_accvgpr_write_b32 a25, v241
v_accvgpr_write_b32 a26, v242
v_accvgpr_write_b32 a27, v243
v_accvgpr_write_b32 a28, v244
v_accvgpr_write_b32 a29, v245
v_accvgpr_write_b32 a30, v246
v_accvgpr_write_b32 a31, v247
v_accvgpr_read_b32 v240, a32
v_accvgpr_read_b32 v241, a33
v_accvgpr_read_b32 v242, a34
v_accvgpr_read_b32 v243, a35
v_accvgpr_read_b32 v244, a36
v_accvgpr_read_b32 v245, a37
v_accvgpr_read_b32 v246, a38
v_accvgpr_read_b32 v247, a39
v_mul_f32 v240, v240, v8
v_mul_f32 v241, v241, v8
v_mul_f32 v242, v242, v8
v_mul_f32 v243, v243, v8
v_mul_f32 v244, v244, v8
v_mul_f32 v245, v245, v8
v_mul_f32 v246, v246, v8
v_mul_f32 v247, v247, v8
v_accvgpr_write_b32 a32, v240
v_accvgpr_write_b32 a33, v241
v_accvgpr_write_b32 a34, v242
v_accvgpr_write_b32 a35, v243
v_accvgpr_write_b32 a36, v244
v_accvgpr_write_b32 a37, v245
v_accvgpr_write_b32 a38, v246
v_accvgpr_write_b32 a39, v247
v_accvgpr_read_b32 v240, a40
v_accvgpr_read_b32 v241, a41
v_accvgpr_read_b32 v242, a42
v_accvgpr_read_b32 v243, a43
v_accvgpr_read_b32 v244, a44
v_accvgpr_read_b32 v245, a45
v_accvgpr_read_b32 v246, a46
v_accvgpr_read_b32 v247, a47
v_mul_f32 v240, v240, v8
v_mul_f32 v241, v241, v8
v_mul_f32 v242, v242, v8
v_mul_f32 v243, v243, v8
v_mul_f32 v244, v244, v8
v_mul_f32 v245, v245, v8
v_mul_f32 v246, v246, v8
v_mul_f32 v247, v247, v8
v_accvgpr_write_b32 a40, v240
v_accvgpr_write_b32 a41, v241
v_accvgpr_write_b32 a42, v242
v_accvgpr_write_b32 a43, v243
v_accvgpr_write_b32 a44, v244
v_accvgpr_write_b32 a45, v245
v_accvgpr_write_b32 a46, v246
v_accvgpr_write_b32 a47, v247
v_accvgpr_read_b32 v240, a48
v_accvgpr_read_b32 v241, a49
v_accvgpr_read_b32 v242, a50
v_accvgpr_read_b32 v243, a51
v_accvgpr_read_b32 v244, a52
v_accvgpr_read_b32 v245, a53
v_accvgpr_read_b32 v246, a54
v_accvgpr_read_b32 v247, a55
v_mul_f32 v240, v240, v8
v_mul_f32 v241, v241, v8
v_mul_f32 v242, v242, v8
v_mul_f32 v243, v243, v8
v_mul_f32 v244, v244, v8
v_mul_f32 v245, v245, v8
v_mul_f32 v246, v246, v8
v_mul_f32 v247, v247, v8
v_accvgpr_write_b32 a48, v240
v_accvgpr_write_b32 a49, v241
v_accvgpr_write_b32 a50, v242
v_accvgpr_write_b32 a51, v243
v_accvgpr_write_b32 a52, v244
v_accvgpr_write_b32 a53, v245
v_accvgpr_write_b32 a54, v246
v_accvgpr_write_b32 a55, v247
v_accvgpr_read_b32 v240, a56
v_accvgpr_read_b32 v241, a57
v_accvgpr_read_b32 v242, a58
v_accvgpr_read_b32 v243, a59
v_accvgpr_read_b32 v244, a60
v_accvgpr_read_b32 v245, a61
v_accvgpr_read_b32 v246, a62
v_accvgpr_read_b32 v247, a63
v_mul_f32 v240, v240, v8
v_mul_f32 v241, v241, v8
v_mul_f32 v242, v242, v8
v_mul_f32 v243, v243, v8
v_mul_f32 v244, v244, v8
v_mul_f32 v245, v245, v8
v_mul_f32 v246, v246, v8
v_mul_f32 v247, v247, v8
v_accvgpr_write_b32 a56, v240
v_accvgpr_write_b32 a57, v241
v_accvgpr_write_b32 a58, v242
v_accvgpr_write_b32 a59, v243
v_accvgpr_write_b32 a60, v244
v_accvgpr_write_b32 a61, v245
v_accvgpr_write_b32 a62, v246
v_accvgpr_write_b32 a63, v247
s_nop 1
s_branch L_p3_s1_end
L_p3_s1m_rare:
v_mov_b32 v240, v6
v_mov_b32 v241, v6
s_nop 1
v_permlane32_swap_b32 v240, v241
v_max_f32 v242, v240, v241
v_max_f32 v242, 0, v242
v_exp_f32 v8, -v242
v_sub_f32 v208, v208, v242
v_sub_f32 v209, v209, v242
v_sub_f32 v210, v210, v242
v_sub_f32 v211, v211, v242
v_sub_f32 v212, v212, v242
v_sub_f32 v213, v213, v242
v_sub_f32 v214, v214, v242
v_sub_f32 v215, v215, v242
v_sub_f32 v216, v216, v242
v_sub_f32 v217, v217, v242
v_sub_f32 v218, v218, v242
v_sub_f32 v219, v219, v242
v_sub_f32 v220, v220, v242
v_sub_f32 v221, v221, v242
v_sub_f32 v222, v222, v242
v_sub_f32 v223, v223, v242
v_mul_f32 v2, v2, v8
v_mul_f32 v3, v3, v8
v_sub_f32 v80, v80, v242
v_sub_f32 v81, v81, v242
v_sub_f32 v82, v82, v242
v_sub_f32 v83, v83, v242
v_sub_f32 v84, v84, v242
v_sub_f32 v85, v85, v242
v_sub_f32 v86, v86, v242
v_sub_f32 v87, v87, v242
v_sub_f32 v88, v88, v242
v_sub_f32 v89, v89, v242
v_sub_f32 v90, v90, v242
v_sub_f32 v91, v91, v242
v_sub_f32 v92, v92, v242
v_sub_f32 v93, v93, v242
v_sub_f32 v94, v94, v242
v_sub_f32 v95, v95, v242
v_sub_f32 v112, v112, v242
v_sub_f32 v113, v113, v242
v_sub_f32 v114, v114, v242
v_sub_f32 v115, v115, v242
v_sub_f32 v116, v116, v242
v_sub_f32 v117, v117, v242
v_sub_f32 v118, v118, v242
v_sub_f32 v119, v119, v242
v_sub_f32 v120, v120, v242
v_sub_f32 v121, v121, v242
v_sub_f32 v122, v122, v242
v_sub_f32 v123, v123, v242
v_sub_f32 v124, v124, v242
v_sub_f32 v125, v125, v242
v_sub_f32 v126, v126, v242
v_sub_f32 v127, v127, v242
s_add_u32 m0, s72, 16384
v_exp_f32 v80, v80
v_exp_f32 v81, v81
v_mfma_f32_32x32x16_bf16 a[0:15], a[240:243], v[184:187], a[0:15]
buffer_load_dwordx4 v12, s[52:55], s71 offen offset:0 sc1 lds
buffer_load_dwordx4 v12, s[52:55], s71 offen offset:1024 sc1 lds
v_exp_f32 v82, v82
v_add_f32 v2, v2, v80
v_mfma_f32_32x32x16_bf16 a[16:31], a[244:247], v[184:187], a[16:31]
buffer_load_dwordx4 v12, s[52:55], s71 offen offset:2048 sc1 lds
v_exp_f32 v83, v83
v_add_f32 v3, v3, v81
v_cvt_pk_bf16_f32 v80, v80, v81
v_mfma_f32_32x32x16_bf16 a[32:47], a[248:251], v[184:187], a[32:47]
buffer_load_dwordx4 v12, s[52:55], s71 offen offset:3072 sc1 lds
v_exp_f32 v84, v84
v_add_f32 v2, v2, v82
v_exp_f32 v85, v85
v_mfma_f32_32x32x16_bf16 a[48:63], a[252:255], v[184:187], a[48:63]
s_xor_b32 s72, s72, 0x8000
v_add_f32 v3, v3, v83
v_cvt_pk_bf16_f32 v81, v82, v83
v_exp_f32 v86, v86
v_add_f32 v2, v2, v84
v_exp_f32 v87, v87
v_add_f32 v3, v3, v85
v_cvt_pk_bf16_f32 v82, v84, v85
v_exp_f32 v88, v88
v_add_f32 v2, v2, v86
v_exp_f32 v89, v89
v_add_f32 v3, v3, v87
v_cvt_pk_bf16_f32 v83, v86, v87
v_exp_f32 v90, v90
v_add_f32 v2, v2, v88
v_exp_f32 v91, v91
v_add_f32 v3, v3, v89
v_cvt_pk_bf16_f32 v88, v88, v89
v_add_f32 v2, v2, v90
v_add_f32 v3, v3, v91
v_cvt_pk_bf16_f32 v89, v90, v91
s_nop 15
v_accvgpr_read_b32 v240, a0
v_accvgpr_read_b32 v241, a1
v_accvgpr_read_b32 v242, a2
v_accvgpr_read_b32 v243, a3
v_accvgpr_read_b32 v244, a4
v_accvgpr_read_b32 v245, a5
v_accvgpr_read_b32 v246, a6
v_accvgpr_read_b32 v247, a7
v_mul_f32 v240, v240, v8
v_mul_f32 v241, v241, v8
v_mul_f32 v242, v242, v8
v_mul_f32 v243, v243, v8
v_mul_f32 v244, v244, v8
v_mul_f32 v245, v245, v8
v_mul_f32 v246, v246, v8
v_mul_f32 v247, v247, v8
v_accvgpr_write_b32 a0, v240
v_accvgpr_write_b32 a1, v241
v_accvgpr_write_b32 a2, v242
v_accvgpr_write_b32 a3, v243
v_accvgpr_write_b32 a4, v244
v_accvgpr_write_b32 a5, v245
v_accvgpr_write_b32 a6, v246
v_accvgpr_write_b32 a7, v247
v_accvgpr_read_b32 v240, a8
v_accvgpr_read_b32 v241, a9
v_accvgpr_read_b32 v242, a10
v_accvgpr_read_b32 v243, a11
v_accvgpr_read_b32 v244, a12
v_accvgpr_read_b32 v245, a13
v_accvgpr_read_b32 v246, a14
v_accvgpr_read_b32 v247, a15
v_mul_f32 v240, v240, v8
v_mul_f32 v241, v241, v8
v_mul_f32 v242, v242, v8
v_mul_f32 v243, v243, v8
v_mul_f32 v244, v244, v8
v_mul_f32 v245, v245, v8
v_mul_f32 v246, v246, v8
v_mul_f32 v247, v247, v8
v_accvgpr_write_b32 a8, v240
v_accvgpr_write_b32 a9, v241
v_accvgpr_write_b32 a10, v242
v_accvgpr_write_b32 a11, v243
v_accvgpr_write_b32 a12, v244
v_accvgpr_write_b32 a13, v245
v_accvgpr_write_b32 a14, v246
v_accvgpr_write_b32 a15, v247
v_accvgpr_read_b32 v240, a16
v_accvgpr_read_b32 v241, a17
v_accvgpr_read_b32 v242, a18
v_accvgpr_read_b32 v243, a19
v_accvgpr_read_b32 v244, a20
v_accvgpr_read_b32 v245, a21
v_accvgpr_read_b32 v246, a22
v_accvgpr_read_b32 v247, a23
v_mul_f32 v240, v240, v8
v_mul_f32 v241, v241, v8
v_mul_f32 v242, v242, v8
v_mul_f32 v243, v243, v8
v_mul_f32 v244, v244, v8
v_mul_f32 v245, v245, v8
v_mul_f32 v246, v246, v8
v_mul_f32 v247, v247, v8
v_accvgpr_write_b32 a16, v240
v_accvgpr_write_b32 a17, v241
v_accvgpr_write_b32 a18, v242
v_accvgpr_write_b32 a19, v243
v_accvgpr_write_b32 a20, v244
v_accvgpr_write_b32 a21, v245
v_accvgpr_write_b32 a22, v246
v_accvgpr_write_b32 a23, v247
v_accvgpr_read_b32 v240, a24
v_accvgpr_read_b32 v241, a25
v_accvgpr_read_b32 v242, a26
v_accvgpr_read_b32 v243, a27
v_accvgpr_read_b32 v244, a28
v_accvgpr_read_b32 v245, a29
v_accvgpr_read_b32 v246, a30
v_accvgpr_read_b32 v247, a31
v_mul_f32 v240, v240, v8
v_mul_f32 v241, v241, v8
v_mul_f32 v242, v242, v8
v_mul_f32 v243, v243, v8
v_mul_f32 v244, v244, v8
v_mul_f32 v245, v245, v8
v_mul_f32 v246, v246, v8
v_mul_f32 v247, v247, v8
v_accvgpr_write_b32 a24, v240
v_accvgpr_write_b32 a25, v241
v_accvgpr_write_b32 a26, v242
v_accvgpr_write_b32 a27, v243
v_accvgpr_write_b32 a28, v244
v_accvgpr_write_b32 a29, v245
v_accvgpr_write_b32 a30, v246
v_accvgpr_write_b32 a31, v247
v_accvgpr_read_b32 v240, a32
v_accvgpr_read_b32 v241, a33
v_accvgpr_read_b32 v242, a34
v_accvgpr_read_b32 v243, a35
v_accvgpr_read_b32 v244, a36
v_accvgpr_read_b32 v245, a37
v_accvgpr_read_b32 v246, a38
v_accvgpr_read_b32 v247, a39
v_mul_f32 v240, v240, v8
v_mul_f32 v241, v241, v8
v_mul_f32 v242, v242, v8
v_mul_f32 v243, v243, v8
v_mul_f32 v244, v244, v8
v_mul_f32 v245, v245, v8
v_mul_f32 v246, v246, v8
v_mul_f32 v247, v247, v8
v_accvgpr_write_b32 a32, v240
v_accvgpr_write_b32 a33, v241
v_accvgpr_write_b32 a34, v242
v_accvgpr_write_b32 a35, v243
v_accvgpr_write_b32 a36, v244
v_accvgpr_write_b32 a37, v245
v_accvgpr_write_b32 a38, v246
v_accvgpr_write_b32 a39, v247
v_accvgpr_read_b32 v240, a40
v_accvgpr_read_b32 v241, a41
v_accvgpr_read_b32 v242, a42
v_accvgpr_read_b32 v243, a43
v_accvgpr_read_b32 v244, a44
v_accvgpr_read_b32 v245, a45
v_accvgpr_read_b32 v246, a46
v_accvgpr_read_b32 v247, a47
v_mul_f32 v240, v240, v8
v_mul_f32 v241, v241, v8
v_mul_f32 v242, v242, v8
v_mul_f32 v243, v243, v8
v_mul_f32 v244, v244, v8
v_mul_f32 v245, v245, v8
v_mul_f32 v246, v246, v8
v_mul_f32 v247, v247, v8
v_accvgpr_write_b32 a40, v240
v_accvgpr_write_b32 a41, v241
v_accvgpr_write_b32 a42, v242
v_accvgpr_write_b32 a43, v243
v_accvgpr_write_b32 a44, v244
v_accvgpr_write_b32 a45, v245
v_accvgpr_write_b32 a46, v246
v_accvgpr_write_b32 a47, v247
v_accvgpr_read_b32 v240, a48
v_accvgpr_read_b32 v241, a49
v_accvgpr_read_b32 v242, a50
v_accvgpr_read_b32 v243, a51
v_accvgpr_read_b32 v244, a52
v_accvgpr_read_b32 v245, a53
v_accvgpr_read_b32 v246, a54
v_accvgpr_read_b32 v247, a55
v_mul_f32 v240, v240, v8
v_mul_f32 v241, v241, v8
v_mul_f32 v242, v242, v8
v_mul_f32 v243, v243, v8
v_mul_f32 v244, v244, v8
v_mul_f32 v245, v245, v8
v_mul_f32 v246, v246, v8
v_mul_f32 v247, v247, v8
v_accvgpr_write_b32 a48, v240
v_accvgpr_write_b32 a49, v241
v_accvgpr_write_b32 a50, v242
v_accvgpr_write_b32 a51, v243
v_accvgpr_write_b32 a52, v244
v_accvgpr_write_b32 a53, v245
v_accvgpr_write_b32 a54, v246
v_accvgpr_write_b32 a55, v247
v_accvgpr_read_b32 v240, a56
v_accvgpr_read_b32 v241, a57
v_accvgpr_read_b32 v242, a58
v_accvgpr_read_b32 v243, a59
v_accvgpr_read_b32 v244, a60
v_accvgpr_read_b32 v245, a61
v_accvgpr_read_b32 v246, a62
v_accvgpr_read_b32 v247, a63
v_mul_f32 v240, v240, v8
v_mul_f32 v241, v241, v8
v_mul_f32 v242, v242, v8
v_mul_f32 v243, v243, v8
v_mul_f32 v244, v244, v8
v_mul_f32 v245, v245, v8
v_mul_f32 v246, v246, v8
v_mul_f32 v247, v247, v8
v_accvgpr_write_b32 a56, v240
v_accvgpr_write_b32 a57, v241
v_accvgpr_write_b32 a58, v242
v_accvgpr_write_b32 a59, v243
v_accvgpr_write_b32 a60, v244
v_accvgpr_write_b32 a61, v245
v_accvgpr_write_b32 a62, v246
v_accvgpr_write_b32 a63, v247
s_nop 1
s_branch L_p3_s1m_end
L_p3_s0m_rare:
v_mov_b32 v240, v6
v_mov_b32 v241, v6
s_nop 1
v_permlane32_swap_b32 v240, v241
v_max_f32 v242, v240, v241
v_max_f32 v242, 0, v242
v_exp_f32 v8, -v242
v_sub_f32 v208, v208, v242
v_sub_f32 v209, v209, v242
v_sub_f32 v210, v210, v242
v_sub_f32 v211, v211, v242
v_sub_f32 v212, v212, v242
v_sub_f32 v213, v213, v242
v_sub_f32 v214, v214, v242
v_sub_f32 v215, v215, v242
v_sub_f32 v216, v216, v242
v_sub_f32 v217, v217, v242
v_sub_f32 v218, v218, v242
v_sub_f32 v219, v219, v242
v_sub_f32 v220, v220, v242
v_sub_f32 v221, v221, v242
v_sub_f32 v222, v222, v242
v_sub_f32 v223, v223, v242
v_mul_f32 v2, v2, v8
v_mul_f32 v3, v3, v8
v_sub_f32 v144, v144, v242
v_sub_f32 v145, v145, v242
v_sub_f32 v146, v146, v242
v_sub_f32 v147, v147, v242
v_sub_f32 v148, v148, v242
v_sub_f32 v149, v149, v242
v_sub_f32 v150, v150, v242
v_sub_f32 v151, v151, v242
v_sub_f32 v152, v152, v242
v_sub_f32 v153, v153, v242
v_sub_f32 v154, v154, v242
v_sub_f32 v155, v155, v242
v_sub_f32 v156, v156, v242
v_sub_f32 v157, v157, v242
v_sub_f32 v158, v158, v242
v_sub_f32 v159, v159, v242
v_sub_f32 v176, v176, v242
v_sub_f32 v177, v177, v242
v_sub_f32 v178, v178, v242
v_sub_f32 v179, v179, v242
v_sub_f32 v180, v180, v242
v_sub_f32 v181, v181, v242
v_sub_f32 v182, v182, v242
v_sub_f32 v183, v183, v242
v_sub_f32 v184, v184, v242
v_sub_f32 v185, v185, v242
v_sub_f32 v186, v186, v242
v_sub_f32 v187, v187, v242
v_sub_f32 v188, v188, v242
v_sub_f32 v189, v189, v242
v_sub_f32 v190, v190, v242
v_sub_f32 v191, v191, v242
s_add_u32 m0, s72, 0
v_exp_f32 v144, v144
v_exp_f32 v145, v145
v_mfma_f32_32x32x16_bf16 a[0:15], a[240:243], v[120:123], a[0:15]
buffer_load_dwordx4 v12, s[52:55], s71 offen offset:0 sc1 lds
buffer_load_dwordx4 v12, s[52:55], s71 offen offset:1024 sc1 lds
buffer_load_dwordx4 v12, s[52:55], s71 offen offset:2048 sc1 lds
v_exp_f32 v146, v146
v_add_f32 v2, v2, v144
v_mfma_f32_32x32x16_bf16 a[16:31], a[244:247], v[120:123], a[16:31]
buffer_load_dwordx4 v12, s[52:55], s71 offen offset:3072 sc1 lds
v_lshlrev_b32 v245, 4, v1
s_mov_b32 m0, s43
v_exp_f32 v147, v147
v_add_f32 v3, v3, v145
v_mfma_f32_32x32x16_bf16 a[32:47], a[248:251], v[120:123], a[32:47]
s_nop 0
buffer_load_dwordx4 v245, s[20:23], 0 offen offset:0 sc1 lds
buffer_load_dwordx4 v245, s[20:23], 0 offen offset:1024 sc1 lds
v_cvt_pk_bf16_f32 v144, v144, v145
v_exp_f32 v148, v148
v_mfma_f32_32x32x16_bf16 a[48:63], a[252:255], v[120:123], a[48:63]
buffer_load_dwordx4 v245, s[20:23], 0 offen offset:2048 sc1 lds
buffer_load_dwordx4 v245, s[20:23], 0 offen offset:3072 sc1 lds
v_add_f32 v2, v2, v146
v_exp_f32 v149, v149
v_add_f32 v3, v3, v147
v_cvt_pk_bf16_f32 v145, v146, v147
v_exp_f32 v150, v150
v_add_f32 v2, v2, v148
v_exp_f32 v151, v151
v_add_f32 v3, v3, v149
v_cvt_pk_bf16_f32 v146, v148, v149
v_exp_f32 v152, v152
v_add_f32 v2, v2, v150
v_exp_f32 v153, v153
v_add_f32 v3, v3, v151
v_cvt_pk_bf16_f32 v147, v150, v151
v_exp_f32 v154, v154
v_add_f32 v2, v2, v152
v_exp_f32 v155, v155
v_add_f32 v3, v3, v153
v_cvt_pk_bf16_f32 v152, v152, v153
v_add_f32 v2, v2, v154
v_add_f32 v3, v3, v155
v_cvt_pk_bf16_f32 v153, v154, v155
s_nop 15
v_accvgpr_read_b32 v240, a0
v_accvgpr_read_b32 v241, a1
v_accvgpr_read_b32 v242, a2
v_accvgpr_read_b32 v243, a3
v_accvgpr_read_b32 v244, a4
v_accvgpr_read_b32 v245, a5
v_accvgpr_read_b32 v246, a6
v_accvgpr_read_b32 v247, a7
v_mul_f32 v240, v240, v8
v_mul_f32 v241, v241, v8
v_mul_f32 v242, v242, v8
v_mul_f32 v243, v243, v8
v_mul_f32 v244, v244, v8
v_mul_f32 v245, v245, v8
v_mul_f32 v246, v246, v8
v_mul_f32 v247, v247, v8
v_accvgpr_write_b32 a0, v240
v_accvgpr_write_b32 a1, v241
v_accvgpr_write_b32 a2, v242
v_accvgpr_write_b32 a3, v243
v_accvgpr_write_b32 a4, v244
v_accvgpr_write_b32 a5, v245
v_accvgpr_write_b32 a6, v246
v_accvgpr_write_b32 a7, v247
v_accvgpr_read_b32 v240, a8
v_accvgpr_read_b32 v241, a9
v_accvgpr_read_b32 v242, a10
v_accvgpr_read_b32 v243, a11
v_accvgpr_read_b32 v244, a12
v_accvgpr_read_b32 v245, a13
v_accvgpr_read_b32 v246, a14
v_accvgpr_read_b32 v247, a15
v_mul_f32 v240, v240, v8
v_mul_f32 v241, v241, v8
v_mul_f32 v242, v242, v8
v_mul_f32 v243, v243, v8
v_mul_f32 v244, v244, v8
v_mul_f32 v245, v245, v8
v_mul_f32 v246, v246, v8
v_mul_f32 v247, v247, v8
v_accvgpr_write_b32 a8, v240
v_accvgpr_write_b32 a9, v241
v_accvgpr_write_b32 a10, v242
v_accvgpr_write_b32 a11, v243
v_accvgpr_write_b32 a12, v244
v_accvgpr_write_b32 a13, v245
v_accvgpr_write_b32 a14, v246
v_accvgpr_write_b32 a15, v247
v_accvgpr_read_b32 v240, a16
v_accvgpr_read_b32 v241, a17
v_accvgpr_read_b32 v242, a18
v_accvgpr_read_b32 v243, a19
v_accvgpr_read_b32 v244, a20
v_accvgpr_read_b32 v245, a21
v_accvgpr_read_b32 v246, a22
v_accvgpr_read_b32 v247, a23
v_mul_f32 v240, v240, v8
v_mul_f32 v241, v241, v8
v_mul_f32 v242, v242, v8
v_mul_f32 v243, v243, v8
v_mul_f32 v244, v244, v8
v_mul_f32 v245, v245, v8
v_mul_f32 v246, v246, v8
v_mul_f32 v247, v247, v8
v_accvgpr_write_b32 a16, v240
v_accvgpr_write_b32 a17, v241
v_accvgpr_write_b32 a18, v242
v_accvgpr_write_b32 a19, v243
v_accvgpr_write_b32 a20, v244
v_accvgpr_write_b32 a21, v245
v_accvgpr_write_b32 a22, v246
v_accvgpr_write_b32 a23, v247
v_accvgpr_read_b32 v240, a24
v_accvgpr_read_b32 v241, a25
v_accvgpr_read_b32 v242, a26
v_accvgpr_read_b32 v243, a27
v_accvgpr_read_b32 v244, a28
v_accvgpr_read_b32 v245, a29
v_accvgpr_read_b32 v246, a30
v_accvgpr_read_b32 v247, a31
v_mul_f32 v240, v240, v8
v_mul_f32 v241, v241, v8
v_mul_f32 v242, v242, v8
v_mul_f32 v243, v243, v8
v_mul_f32 v244, v244, v8
v_mul_f32 v245, v245, v8
v_mul_f32 v246, v246, v8
v_mul_f32 v247, v247, v8
v_accvgpr_write_b32 a24, v240
v_accvgpr_write_b32 a25, v241
v_accvgpr_write_b32 a26, v242
v_accvgpr_write_b32 a27, v243
v_accvgpr_write_b32 a28, v244
v_accvgpr_write_b32 a29, v245
v_accvgpr_write_b32 a30, v246
v_accvgpr_write_b32 a31, v247
v_accvgpr_read_b32 v240, a32
v_accvgpr_read_b32 v241, a33
v_accvgpr_read_b32 v242, a34
v_accvgpr_read_b32 v243, a35
v_accvgpr_read_b32 v244, a36
v_accvgpr_read_b32 v245, a37
v_accvgpr_read_b32 v246, a38
v_accvgpr_read_b32 v247, a39
v_mul_f32 v240, v240, v8
v_mul_f32 v241, v241, v8
v_mul_f32 v242, v242, v8
v_mul_f32 v243, v243, v8
v_mul_f32 v244, v244, v8
v_mul_f32 v245, v245, v8
v_mul_f32 v246, v246, v8
v_mul_f32 v247, v247, v8
v_accvgpr_write_b32 a32, v240
v_accvgpr_write_b32 a33, v241
v_accvgpr_write_b32 a34, v242
v_accvgpr_write_b32 a35, v243
v_accvgpr_write_b32 a36, v244
v_accvgpr_write_b32 a37, v245
v_accvgpr_write_b32 a38, v246
v_accvgpr_write_b32 a39, v247
v_accvgpr_read_b32 v240, a40
v_accvgpr_read_b32 v241, a41
v_accvgpr_read_b32 v242, a42
v_accvgpr_read_b32 v243, a43
v_accvgpr_read_b32 v244, a44
v_accvgpr_read_b32 v245, a45
v_accvgpr_read_b32 v246, a46
v_accvgpr_read_b32 v247, a47
v_mul_f32 v240, v240, v8
v_mul_f32 v241, v241, v8
v_mul_f32 v242, v242, v8
v_mul_f32 v243, v243, v8
v_mul_f32 v244, v244, v8
v_mul_f32 v245, v245, v8
v_mul_f32 v246, v246, v8
v_mul_f32 v247, v247, v8
v_accvgpr_write_b32 a40, v240
v_accvgpr_write_b32 a41, v241
v_accvgpr_write_b32 a42, v242
v_accvgpr_write_b32 a43, v243
v_accvgpr_write_b32 a44, v244
v_accvgpr_write_b32 a45, v245
v_accvgpr_write_b32 a46, v246
v_accvgpr_write_b32 a47, v247
v_accvgpr_read_b32 v240, a48
v_accvgpr_read_b32 v241, a49
v_accvgpr_read_b32 v242, a50
v_accvgpr_read_b32 v243, a51
v_accvgpr_read_b32 v244, a52
v_accvgpr_read_b32 v245, a53
v_accvgpr_read_b32 v246, a54
v_accvgpr_read_b32 v247, a55
v_mul_f32 v240, v240, v8
v_mul_f32 v241, v241, v8
v_mul_f32 v242, v242, v8
v_mul_f32 v243, v243, v8
v_mul_f32 v244, v244, v8
v_mul_f32 v245, v245, v8
v_mul_f32 v246, v246, v8
v_mul_f32 v247, v247, v8
v_accvgpr_write_b32 a48, v240
v_accvgpr_write_b32 a49, v241
v_accvgpr_write_b32 a50, v242
v_accvgpr_write_b32 a51, v243
v_accvgpr_write_b32 a52, v244
v_accvgpr_write_b32 a53, v245
v_accvgpr_write_b32 a54, v246
v_accvgpr_write_b32 a55, v247
v_accvgpr_read_b32 v240, a56
v_accvgpr_read_b32 v241, a57
v_accvgpr_read_b32 v242, a58
v_accvgpr_read_b32 v243, a59
v_accvgpr_read_b32 v244, a60
v_accvgpr_read_b32 v245, a61
v_accvgpr_read_b32 v246, a62
v_accvgpr_read_b32 v247, a63
v_mul_f32 v240, v240, v8
v_mul_f32 v241, v241, v8
v_mul_f32 v242, v242, v8
v_mul_f32 v243, v243, v8
v_mul_f32 v244, v244, v8
v_mul_f32 v245, v245, v8
v_mul_f32 v246, v246, v8
v_mul_f32 v247, v247, v8
v_accvgpr_write_b32 a56, v240
v_accvgpr_write_b32 a57, v241
v_accvgpr_write_b32 a58, v242
v_accvgpr_write_b32 a59, v243
v_accvgpr_write_b32 a60, v244
v_accvgpr_write_b32 a61, v245
v_accvgpr_write_b32 a62, v246
v_accvgpr_write_b32 a63, v247
s_nop 1
s_branch L_p3_s0m_end
L_spin_go:
s_mov_b32 s36, 400000
L_spin_go_l:
s_sleep 1
buffer_load_dword v254, off, s[12:15], 0 sc1
s_waitcnt vmcnt(0)
v_cmp_gt_u32 vcc, 1, v254
s_nop 4
s_cbranch_vccz L_spin_go_ret
s_sub_u32 s36, s36, 1
s_cmp_lg_u32 s36, 0
s_cbranch_scc1 L_spin_go_l
s_branch L_spin_go_ret
L_spin_f1:
s_mov_b32 s36, 400000
L_spin_f1_l:
s_sleep 1
buffer_load_dword v237, v233, s[8:11], 0 offen offset:0 sc1
s_waitcnt vmcnt(0)
v_cmp_gt_u32 vcc, 1, v237
s_nop 4
s_cbranch_vccz L_spin_f1_ret
s_sub_u32 s36, s36, 1
s_cmp_lg_u32 s36, 0
s_cbranch_scc1 L_spin_f1_l
s_branch L_spin_f1_ret
L_spin_f2:
s_mov_b32 s36, 400000
L_spin_f2_l:
s_sleep 1
buffer_load_dword v253, v254, s[8:11], 0 offen offset:1024 sc1
s_waitcnt vmcnt(0)
v_cmp_gt_u32 vcc, 1, v253
s_nop 4
s_cbranch_vccz L_spin_f2_ret
s_sub_u32 s36, s36, 1
s_cmp_lg_u32 s36, 0
s_cbranch_scc1 L_spin_f2_l
s_branch L_spin_f2_ret
L_spin_f3:
s_mov_b32 s36, 400000
L_spin_f3_l:
s_sleep 1
buffer_load_dword v253, v254, s[8:11], 0 offen offset:3072 sc1
s_waitcnt vmcnt(0)
v_cmp_gt_u32 vcc, 1, v253
s_nop 4
s_cbranch_vccz L_spin_f3_ret
s_sub_u32 s36, s36, 1
s_cmp_lg_u32 s36, 0
s_cbranch_scc1 L_spin_f3_l
s_branch L_spin_f3_ret
L_code_end:
s_endpgm
.section .rodata,"a"
.p2align 6
.amdhsa_kernel gated_mix__ssm_conv_h3__compressed_kv_cla__prompt_kernel
  .amdhsa_next_free_vgpr 512
  .amdhsa_next_free_sgpr 102
  .amdhsa_accum_offset 256
  .amdhsa_group_segment_fixed_size 0
  .amdhsa_kernarg_size 128
  .amdhsa_user_sgpr_count 2
  .amdhsa_user_sgpr_kernarg_segment_ptr 1
  .amdhsa_system_sgpr_workgroup_id_x 1
  .amdhsa_float_denorm_mode_32 3
.end_amdhsa_kernel
.text
```

```asm
; @launch grid=(256,1,1) block=(256,1,1) lds=163840
.amdgcn_target "amdgcn-amd-amdhsa--gfx950"
.text
.macro MA d,x,a,y,b
v_mfma_f32_16x16x32_bf16 a[\d:\d+3], \x[\a:\a+3], \y[\b:\b+3], a[\d:\d+3]
.endm
.macro MV d,x,a,y,b
v_mfma_f32_16x16x32_bf16 v[\d:\d+3], \x[\a:\a+3], \y[\b:\b+3], v[\d:\d+3]
.endm
.macro TR d,a,o
ds_read_b64_tr_b16 v[\d:\d+1], v\a offset:\o
.endm
.globl gated_mix__ssm_conv_h3__compressed_kv_cla__prompt_kernel
.p2align 8
.type gated_mix__ssm_conv_h3__compressed_kv_cla__prompt_kernel,@function
gated_mix__ssm_conv_h3__compressed_kv_cla__prompt_kernel:
s_cmp_ge_u32 s2, 256
s_cbranch_scc1 L_end
s_load_dwordx2 s[44:45], s[0:1], 56
s_load_dwordx4 s[48:51], s[0:1], 72
s_load_dwordx2 s[40:41], s[0:1], 120
s_load_dwordx2 s[52:53], s[0:1], 112
s_load_dwordx2 s[32:33], s[0:1], 0
s_load_dwordx2 s[34:35], s[0:1], 64
v_lshrrev_b32 v2, 6, v0
v_and_b32 v1, 63, v0
v_lshlrev_b32 v3, 4, v0
v_readfirstlane_b32 s3, v2
s_and_b32 s36, s2, 7
s_lshr_b32 s37, s2, 3
s_and_b32 s38, s37, 7
s_lshr_b32 s37, s37, 3
s_lshr_b32 s42, s37, 1
s_and_b32 s37, s37, 1
s_lshl_b32 s36, s36, 1
s_add_u32 s36, s36, s37
s_lshl_b32 s24, s38, 18
s_lshl_b32 s39, s3, 16
s_add_u32 s24, s24, s39
s_lshl_b32 s25, s3, 17
s_lshl_b32 s39, s36, 9
s_add_u32 s25, s25, s39
s_and_b32 s20, s2, 7
s_lshl_b32 s21, s20, 19
s_lshl_b32 s20, s20, 7
s_lshl_b32 s22, s3, 13
s_add_u32 s23, s22, 98304
v_lshrrev_b32 v204, 3, v1
v_lshlrev_b32 v204, 10, v204
v_lshrrev_b32 v205, 4, v1
v_and_b32 v206, 7, v1
v_xor_b32 v206, v206, v205
v_lshl_add_u32 v204, v206, 4, v204
v_xor_b32 v207, 64, v204
v_add_u32 v176, 0, v204
v_add_u32 v177, 7168, v207
v_add_u32 v178, 14336, v204
v_add_u32 v179, 21504, v207
v_add_u32 v180, 32768, v204
v_add_u32 v181, 39936, v207
v_add_u32 v182, 47104, v204
v_add_u32 v183, 54272, v207
v_lshrrev_b32 v204, 5, v1
v_and_b32 v206, 31, v1
v_lshlrev_b32 v207, 1, v204
v_xor_b32 v206, v206, v207
v_lshlrev_b32 v204, 13, v204
v_xor_b32 v207, 0, v206
v_lshl_add_u32 v207, v207, 4, v204
v_add_u32 v184, 0, v207
v_xor_b32 v207, 4, v206
v_lshl_add_u32 v207, v207, 4, v204
v_add_u32 v185, 15360, v207
v_xor_b32 v207, 0, v206
v_lshl_add_u32 v207, v207, 4, v204
v_add_u32 v186, 30720, v207
v_xor_b32 v207, 4, v206
v_lshl_add_u32 v207, v207, 4, v204
v_add_u32 v187, 46080, v207
v_xor_b32 v207, 8, v206
v_lshl_add_u32 v207, v207, 4, v204
v_add_u32 v188, 65536, v207
v_xor_b32 v207, 12, v206
v_lshl_add_u32 v207, v207, 4, v204
v_add_u32 v189, 80896, v207
v_xor_b32 v207, 8, v206
v_lshl_add_u32 v207, v207, 4, v204
v_add_u32 v190, 96256, v207
v_xor_b32 v207, 12, v206
v_lshl_add_u32 v207, v207, 4, v204
v_add_u32 v191, 111616, v207
s_waitcnt lgkmcnt(0)
s_add_u32 s8, s44, s24
s_addc_u32 s9, s45, 0
s_mov_b32 s10, 65536
s_mov_b32 s11, 0x20000
s_cmp_eq_u32 s42, 0
s_cselect_b32 s12, s48, s50
s_cselect_b32 s13, s49, s51
s_add_u32 s12, s12, s25
s_addc_u32 s13, s13, 0
s_sub_u32 s14, 4194304, s25
s_mov_b32 s15, 0x20000
s_add_u32 s4, s40, 59768832
s_addc_u32 s5, s41, 0
s_mov_b32 s6, 4096
s_mov_b32 s7, 0x20000
s_lshl_b32 s43, s2, 20
v_add_u32 v3, s43, v3
v_mov_b32 v4, 0
v_mov_b32 v5, 0
v_mov_b32 v6, 0
v_mov_b32 v7, 0
buffer_store_dwordx4 v[4:7], v3, s[4:7], 0 offen sc1
v_lshlrev_b32 v79, 16, v3
s_add_u32 m0, s23, 0
s_nop 0
buffer_load_dwordx4 v184, s[12:15], s21 offen offset:0 lds
buffer_load_dwordx4 v185, s[12:15], s21 offen offset:1024 lds
buffer_load_dwordx4 v186, s[12:15], s21 offen offset:2048 lds
buffer_load_dwordx4 v187, s[12:15], s21 offen offset:3072 lds
s_add_u32 m0, s23, 4096
s_nop 0
buffer_load_dwordx4 v188, s[12:15], s21 offen offset:0 lds
buffer_load_dwordx4 v189, s[12:15], s21 offen offset:1024 lds
buffer_load_dwordx4 v190, s[12:15], s21 offen offset:2048 lds
buffer_load_dwordx4 v191, s[12:15], s21 offen offset:3072 lds
s_add_u32 s21, s21, 524288
s_and_b32 s21, s21, 4194303
s_add_u32 m0, s22, 0
s_nop 0
buffer_load_dwordx4 v176, s[8:11], s20 offen offset:0 lds
buffer_load_dwordx4 v177, s[8:11], s20 offen offset:1024 lds
buffer_load_dwordx4 v178, s[8:11], s20 offen offset:2048 lds
buffer_load_dwordx4 v179, s[8:11], s20 offen offset:3072 lds
s_add_u32 m0, s22, 4096
s_nop 0
buffer_load_dwordx4 v180, s[8:11], s20 offen offset:0 lds
buffer_load_dwordx4 v181, s[8:11], s20 offen offset:1024 lds
buffer_load_dwordx4 v182, s[8:11], s20 offen offset:2048 lds
buffer_load_dwordx4 v183, s[8:11], s20 offen offset:3072 lds
s_add_u32 s20, s20, 128
s_and_b32 s20, s20, 1023
v_and_b32 v204, 15, v1
v_lshrrev_b32 v206, 1, v204
v_xor_b32 v206, v206, v205
v_lshlrev_b32 v206, 4, v206
v_lshl_add_u32 v206, v204, 7, v206
s_and_b32 s39, s3, 1
s_lshl_b32 s39, s39, 14
v_add_u32 v192, s39, v206
v_xor_b32 v193, 64, v192
v_add_u32 v194, 0x10000, v192
v_add_u32 v195, 0x10000, v193
v_bfe_u32 v204, v1, 2, 2
v_and_b32 v206, 1, v205
v_lshl_or_b32 v206, v206, 2, v204
v_lshl_add_u32 v204, v205, 3, v204
v_lshlrev_b32 v204, 9, v204
v_and_b32 v207, 3, v1
v_lshl_add_u32 v204, v207, 3, v204
s_lshr_b32 s39, s3, 1
s_lshl_b32 s39, s39, 8
s_add_u32 s39, s39, 98304
v_add_u32 v204, s39, v204
v_xor_b32 v207, 0, v206
v_lshl_add_u32 v196, v207, 5, v204
v_xor_b32 v207, 1, v206
v_lshl_add_u32 v197, v207, 5, v204
v_xor_b32 v207, 2, v206
v_lshl_add_u32 v198, v207, 5, v204
v_xor_b32 v207, 3, v206
v_lshl_add_u32 v199, v207, 5, v204
v_xor_b32 v207, 4, v206
v_lshl_add_u32 v200, v207, 5, v204
v_xor_b32 v207, 5, v206
v_lshl_add_u32 v201, v207, 5, v204
v_xor_b32 v207, 6, v206
v_lshl_add_u32 v202, v207, 5, v204
v_xor_b32 v207, 7, v206
v_lshl_add_u32 v203, v207, 5, v204
s_lshl_b32 s36, s36, 1
s_lshr_b32 s39, s3, 1
s_add_u32 s36, s36, s39
s_lshl_b32 s24, s36, 19
s_lshl_b32 s38, s38, 16
s_add_u32 s24, s24, s38
s_and_b32 s39, s3, 1
s_lshl_b32 s39, s39, 15
s_add_u32 s24, s24, s39
s_lshl_b32 s36, s42, 24
s_add_u32 s16, s40, s36
s_addc_u32 s17, s41, 0
s_mov_b32 s18, 16777216
s_mov_b32 s19, 0x20000
s_mov_b32 s54, 256
s_mov_b32 s55, 0x20000
v_mov_b32 v78, 1
s_cmp_lg_u32 s2, 0
s_cselect_b32 s43, 0x10000000, 0
v_or_b32 v79, s43, v79
s_waitcnt vmcnt(0)
s_barrier
buffer_store_dword v78, v79, s[52:55], 0 offen sc1
ds_read_b128 v[80:83], v192 offset:0
ds_read_b128 v[84:87], v192 offset:2048
ds_read_b128 v[88:91], v192 offset:4096
ds_read_b128 v[92:95], v192 offset:6144
ds_read_b128 v[96:99], v192 offset:8192
ds_read_b128 v[100:103], v192 offset:10240
ds_read_b128 v[104:107], v192 offset:12288
ds_read_b128 v[108:111], v192 offset:14336
TR 144,196,0
TR 146,196,2048
TR 148,197,0
TR 150,197,2048
TR 152,198,0
TR 154,198,2048
TR 156,199,0
TR 158,199,2048
TR 160,200,0
TR 162,200,2048
TR 164,201,0
TR 166,201,2048
TR 168,202,0
TR 170,202,2048
TR 172,203,0
TR 174,203,2048
s_cmp_eq_u32 s42, 0
s_cbranch_scc0 L_p1_V
s_waitcnt lgkmcnt(14)
v_mfma_f32_16x16x32_bf16 a[0:3], v[144:147], v[80:83], 0
s_add_u32 m0, s23, 32768
v_lshlrev_b32 v74, 7, v1
v_mfma_f32_16x16x32_bf16 a[32:35], v[144:147], v[84:87], 0
ds_read_b128 v[112:115], v193 offset:0
v_mfma_f32_16x16x32_bf16 a[64:67], v[144:147], v[88:91], 0
buffer_load_dwordx4 v184, s[12:15], s21 offen offset:0 lds
v_mfma_f32_16x16x32_bf16 a[96:99], v[144:147], v[92:95], 0
v_mfma_f32_16x16x32_bf16 a[128:131], v[144:147], v[96:99], 0
s_getpc_b64 s[4:5]
L_pcK:
v_mfma_f32_16x16x32_bf16 a[160:163], v[144:147], v[100:103], 0
buffer_load_dwordx4 v185, s[12:15], s21 offen offset:1024 lds
v_mfma_f32_16x16x32_bf16 a[192:195], v[144:147], v[104:107], 0
v_mfma_f32_16x16x32_bf16 a[224:227], v[144:147], v[108:111], 0
TR 144,196,16384
TR 146,196,18432
s_waitcnt lgkmcnt(15)
v_mfma_f32_16x16x32_bf16 a[4:7], v[148:151], v[80:83], 0
ds_read_b128 v[116:119], v193 offset:2048
buffer_load_dwordx4 v186, s[12:15], s21 offen offset:2048 lds
v_mfma_f32_16x16x32_bf16 a[36:39], v[148:151], v[84:87], 0
s_lshr_b32 s98, s2, 3
v_mfma_f32_16x16x32_bf16 a[68:71], v[148:151], v[88:91], 0
buffer_load_dwordx4 v187, s[12:15], s21 offen offset:3072 lds
v_mfma_f32_16x16x32_bf16 a[100:103], v[148:151], v[92:95], 0
v_mfma_f32_16x16x32_bf16 a[132:135], v[148:151], v[96:99], 0
s_add_u32 m0, s23, 36864
s_lshl_b32 s98, s98, 2
v_mfma_f32_16x16x32_bf16 a[164:167], v[148:151], v[100:103], 0
ds_read_b128 v[120:123], v193 offset:4096
v_mfma_f32_16x16x32_bf16 a[196:199], v[148:151], v[104:107], 0
v_mfma_f32_16x16x32_bf16 a[228:231], v[148:151], v[108:111], 0
TR 148,197,16384
TR 150,197,18432
s_waitcnt lgkmcnt(15)
v_mfma_f32_16x16x32_bf16 a[8:11], v[152:155], v[80:83], 0
buffer_load_dwordx4 v188, s[12:15], s21 offen offset:0 lds
s_add_u32 s98, s98, s3
v_mfma_f32_16x16x32_bf16 a[40:43], v[152:155], v[84:87], 0
v_mfma_f32_16x16x32_bf16 a[72:75], v[152:155], v[88:91], 0
buffer_load_dwordx4 v189, s[12:15], s21 offen offset:1024 lds
v_mfma_f32_16x16x32_bf16 a[104:107], v[152:155], v[92:95], 0
v_mfma_f32_16x16x32_bf16 a[136:139], v[152:155], v[96:99], 0
ds_read_b128 v[124:127], v193 offset:6144
buffer_load_dwordx4 v190, s[12:15], s21 offen offset:2048 lds
v_mfma_f32_16x16x32_bf16 a[168:171], v[152:155], v[100:103], 0
s_lshl_b32 s98, s98, 10
v_mfma_f32_16x16x32_bf16 a[200:203], v[152:155], v[104:107], 0
v_mfma_f32_16x16x32_bf16 a[232:235], v[152:155], v[108:111], 0
TR 152,198,16384
TR 154,198,18432
v_mfma_f32_16x16x32_bf16 a[12:15], v[156:159], v[80:83], 0
buffer_load_dwordx4 v191, s[12:15], s21 offen offset:3072 lds
v_and_b32 v75, 0x380, v74
v_mfma_f32_16x16x32_bf16 a[44:47], v[156:159], v[84:87], 0
s_add_u32 s21, s21, 524288
v_mfma_f32_16x16x32_bf16 a[76:79], v[156:159], v[88:91], 0
ds_read_b128 v[128:131], v193 offset:8192
v_mfma_f32_16x16x32_bf16 a[108:111], v[156:159], v[92:95], 0
v_mfma_f32_16x16x32_bf16 a[140:143], v[156:159], v[96:99], 0
s_and_b32 s21, s21, 4194303
v_add_u32 v75, s98, v75
v_mfma_f32_16x16x32_bf16 a[172:175], v[156:159], v[100:103], 0
v_mfma_f32_16x16x32_bf16 a[204:207], v[156:159], v[104:107], 0
v_mfma_f32_16x16x32_bf16 a[236:239], v[156:159], v[108:111], 0
TR 156,199,16384
TR 158,199,18432
s_waitcnt lgkmcnt(15)
v_mfma_f32_16x16x32_bf16 a[16:19], v[160:163], v[80:83], 0
ds_read_b128 v[132:135], v193 offset:10240
s_add_u32 m0, s22, 32768
v_mfma_f32_16x16x32_bf16 a[48:51], v[160:163], v[84:87], 0
buffer_load_dwordx4 v176, s[8:11], s20 offen offset:0 lds
v_min_u32 v75, L_code_end - L_pcK - 4, v75
v_mfma_f32_16x16x32_bf16 a[80:83], v[160:163], v[88:91], 0
v_mfma_f32_16x16x32_bf16 a[112:115], v[160:163], v[92:95], 0
v_mfma_f32_16x16x32_bf16 a[144:147], v[160:163], v[96:99], 0
buffer_load_dwordx4 v177, s[8:11], s20 offen offset:1024 lds
v_mfma_f32_16x16x32_bf16 a[176:179], v[160:163], v[100:103], 0
v_mov_b32 v77, s5
v_mfma_f32_16x16x32_bf16 a[208:211], v[160:163], v[104:107], 0
buffer_load_dwordx4 v178, s[8:11], s20 offen offset:2048 lds
v_mfma_f32_16x16x32_bf16 a[240:243], v[160:163], v[108:111], 0
TR 160,200,16384
TR 162,200,18432
v_mfma_f32_16x16x32_bf16 a[20:23], v[164:167], v[80:83], 0
ds_read_b128 v[136:139], v193 offset:12288
v_mfma_f32_16x16x32_bf16 a[52:55], v[164:167], v[84:87], 0
buffer_load_dwordx4 v179, s[8:11], s20 offen offset:3072 lds
v_mfma_f32_16x16x32_bf16 a[84:87], v[164:167], v[88:91], 0
v_add_co_u32 v76, vcc, s4, v75
s_nop 1
v_addc_co_u32 v77, vcc, 0, v77, vcc
v_mfma_f32_16x16x32_bf16 a[116:119], v[164:167], v[92:95], 0
s_add_u32 m0, s22, 36864
v_mfma_f32_16x16x32_bf16 a[148:151], v[164:167], v[96:99], 0
v_mfma_f32_16x16x32_bf16 a[180:183], v[164:167], v[100:103], 0
ds_read_b128 v[140:143], v193 offset:14336
v_mfma_f32_16x16x32_bf16 a[212:215], v[164:167], v[104:107], 0
buffer_load_dwordx4 v180, s[8:11], s20 offen offset:0 lds
v_mfma_f32_16x16x32_bf16 a[244:247], v[164:167], v[108:111], 0
TR 164,201,16384
TR 166,201,18432
v_mfma_f32_16x16x32_bf16 a[24:27], v[168:171], v[80:83], 0
v_mfma_f32_16x16x32_bf16 a[56:59], v[168:171], v[84:87], 0
buffer_load_dwordx4 v181, s[8:11], s20 offen offset:1024 lds
v_mfma_f32_16x16x32_bf16 a[88:91], v[168:171], v[88:91], 0
v_mfma_f32_16x16x32_bf16 a[120:123], v[168:171], v[92:95], 0
buffer_load_dwordx4 v182, s[8:11], s20 offen offset:2048 lds
v_mfma_f32_16x16x32_bf16 a[152:155], v[168:171], v[96:99], 0
v_mfma_f32_16x16x32_bf16 a[184:187], v[168:171], v[100:103], 0
v_mfma_f32_16x16x32_bf16 a[216:219], v[168:171], v[104:107], 0
buffer_load_dwordx4 v183, s[8:11], s20 offen offset:3072 lds
v_mfma_f32_16x16x32_bf16 a[248:251], v[168:171], v[108:111], 0
TR 168,202,16384
TR 170,202,18432
s_waitcnt lgkmcnt(15)
v_mfma_f32_16x16x32_bf16 a[28:31], v[172:175], v[80:83], 0
s_add_u32 s20, s20, 128
v_mfma_f32_16x16x32_bf16 a[60:63], v[172:175], v[84:87], 0
global_load_dword v79, v[76:77], off
v_mfma_f32_16x16x32_bf16 a[92:95], v[172:175], v[88:91], 0
v_mfma_f32_16x16x32_bf16 a[124:127], v[172:175], v[92:95], 0
s_and_b32 s20, s20, 1023
v_mfma_f32_16x16x32_bf16 a[156:159], v[172:175], v[96:99], 0
v_mfma_f32_16x16x32_bf16 a[188:191], v[172:175], v[100:103], 0
v_mfma_f32_16x16x32_bf16 a[220:223], v[172:175], v[104:107], 0
v_mfma_f32_16x16x32_bf16 a[252:255], v[172:175], v[108:111], 0
TR 172,203,16384
TR 174,203,18432
s_waitcnt lgkmcnt(2)
MA 0,v,144,v,112
s_add_u32 m0, s22, 65536
MA 32,v,144,v,116
MA 64,v,144,v,120
MA 96,v,144,v,124
buffer_load_dwordx4 v176, s[8:11], s20 offen offset:0 lds
MA 128,v,144,v,128
MA 160,v,144,v,132
MA 192,v,144,v,136
MA 224,v,144,v,140
buffer_load_dwordx4 v177, s[8:11], s20 offen offset:1024 lds
MA 4,v,148,v,112
MA 36,v,148,v,116
MA 68,v,148,v,120
buffer_load_dwordx4 v178, s[8:11], s20 offen offset:2048 lds
MA 100,v,148,v,124
MA 132,v,148,v,128
MA 164,v,148,v,132
MA 196,v,148,v,136
buffer_load_dwordx4 v179, s[8:11], s20 offen offset:3072 lds
MA 228,v,148,v,140
MA 8,v,152,v,112
MA 40,v,152,v,116
s_add_u32 m0, s22, 69632
MA 72,v,152,v,120
MA 104,v,152,v,124
MA 136,v,152,v,128
MA 168,v,152,v,132
buffer_load_dwordx4 v180, s[8:11], s20 offen offset:0 lds
MA 200,v,152,v,136
MA 232,v,152,v,140
MA 12,v,156,v,112
MA 44,v,156,v,116
buffer_load_dwordx4 v181, s[8:11], s20 offen offset:1024 lds
MA 76,v,156,v,120
MA 108,v,156,v,124
MA 140,v,156,v,128
buffer_load_dwordx4 v182, s[8:11], s20 offen offset:2048 lds
MA 172,v,156,v,132
MA 204,v,156,v,136
MA 236,v,156,v,140
MA 16,v,160,v,112
buffer_load_dwordx4 v183, s[8:11], s20 offen offset:3072 lds
MA 48,v,160,v,116
MA 80,v,160,v,120
MA 112,v,160,v,124
s_add_u32 s20, s20, 128
MA 144,v,160,v,128
MA 176,v,160,v,132
MA 208,v,160,v,136
MA 240,v,160,v,140
s_and_b32 s20, s20, 1023
MA 20,v,164,v,112
MA 52,v,164,v,116
MA 84,v,164,v,120
MA 116,v,164,v,124
MA 148,v,164,v,128
s_waitcnt vmcnt(9) lgkmcnt(0)
s_barrier
MA 180,v,164,v,132
TR 144,196,32768
TR 146,196,34816
MA 212,v,164,v,136
ds_read_b128 v[80:83], v192 offset:32768
s_add_u32 m0, s23, 0
MA 244,v,164,v,140
TR 148,197,32768
TR 150,197,34816
MA 24,v,168,v,112
ds_read_b128 v[84:87], v192 offset:34816
ds_read_b128 v[88:91], v192 offset:36864
MA 56,v,168,v,116
TR 152,198,32768
TR 154,198,34816
MA 88,v,168,v,120
ds_read_b128 v[92:95], v192 offset:38912
ds_read_b128 v[96:99], v192 offset:40960
MA 120,v,168,v,124
TR 156,199,32768
TR 158,199,34816
MA 152,v,168,v,128
ds_read_b128 v[100:103], v192 offset:43008
ds_read_b128 v[104:107], v192 offset:45056
MA 184,v,168,v,132
TR 160,200,32768
TR 162,200,34816
MA 216,v,168,v,136
ds_read_b128 v[108:111], v192 offset:47104
buffer_load_dwordx4 v184, s[12:15], s21 offen offset:0 lds
MA 248,v,168,v,140
TR 164,201,32768
TR 166,201,34816
MA 28,v,172,v,112
buffer_load_dwordx4 v185, s[12:15], s21 offen offset:1024 lds
buffer_load_dwordx4 v186, s[12:15], s21 offen offset:2048 lds
MA 60,v,172,v,116
TR 168,202,32768
TR 170,202,34816
MA 92,v,172,v,120
buffer_load_dwordx4 v187, s[12:15], s21 offen offset:3072 lds
s_add_u32 m0, s23, 4096
MA 124,v,172,v,124
buffer_load_dwordx4 v188, s[12:15], s21 offen offset:0 lds
buffer_load_dwordx4 v189, s[12:15], s21 offen offset:1024 lds
MA 156,v,172,v,128
buffer_load_dwordx4 v190, s[12:15], s21 offen offset:2048 lds
buffer_load_dwordx4 v191, s[12:15], s21 offen offset:3072 lds
MA 188,v,172,v,132
s_add_u32 s21, s21, 524288
s_and_b32 s21, s21, 4194303
MA 220,v,172,v,136
s_load_dwordx2 s[84:85], s[0:1], 8
s_load_dwordx2 s[88:89], s[0:1], 16
MA 252,v,172,v,140
TR 172,203,32768
TR 174,203,34816
s_load_dwordx2 s[92:93], s[0:1], 0
s_load_dwordx2 s[96:97], s[0:1], 24
s_load_dwordx2 s[76:77], s[0:1], 96
s_waitcnt lgkmcnt(2)
MA 0,v,144,v,80
s_add_u32 m0, s22, 0
MA 32,v,144,v,84
ds_read_b128 v[112:115], v193 offset:32768
MA 64,v,144,v,88
s_mov_b32 s4, s34
s_mov_b32 s5, s35
MA 96,v,144,v,92
MA 128,v,144,v,96
MA 160,v,144,v,100
buffer_load_dwordx4 v176, s[8:11], s20 offen offset:0 lds
MA 192,v,144,v,104
MA 224,v,144,v,108
TR 144,196,49152
TR 146,196,51200
MA 4,v,148,v,80
ds_read_b128 v[116:119], v193 offset:34816
MA 36,v,148,v,84
s_mov_b32 s6, 8388608
s_mov_b32 s7, 0x20000
MA 68,v,148,v,88
buffer_load_dwordx4 v177, s[8:11], s20 offen offset:1024 lds
MA 100,v,148,v,92
MA 132,v,148,v,96
MA 164,v,148,v,100
ds_read_b128 v[120:123], v193 offset:36864
MA 196,v,148,v,104
MA 228,v,148,v,108
TR 148,197,49152
TR 150,197,51200
MA 8,v,152,v,80
buffer_load_dwordx4 v178, s[8:11], s20 offen offset:2048 lds
s_lshr_b32 s43, s2, 3
MA 40,v,152,v,84
MA 72,v,152,v,88
MA 104,v,152,v,92
s_lshl_b32 s43, s43, 2
MA 136,v,152,v,96
ds_read_b128 v[124:127], v193 offset:38912
buffer_load_dwordx4 v179, s[8:11], s20 offen offset:3072 lds
MA 168,v,152,v,100
MA 200,v,152,v,104
MA 232,v,152,v,108
TR 152,198,49152
TR 154,198,51200
MA 12,v,156,v,80
s_add_u32 s43, s43, s3
MA 44,v,156,v,84
s_add_u32 m0, s22, 4096
MA 76,v,156,v,88
ds_read_b128 v[128:131], v193 offset:40960
MA 108,v,156,v,92
s_lshl_b32 s43, s43, 16
MA 140,v,156,v,96
MA 172,v,156,v,100
MA 204,v,156,v,104
MA 236,v,156,v,108
TR 156,199,49152
TR 158,199,51200
MA 16,v,160,v,80
ds_read_b128 v[132:135], v193 offset:43008
buffer_load_dwordx4 v180, s[8:11], s20 offen offset:0 lds
MA 48,v,160,v,84
s_and_b32 s37, s2, 7
MA 80,v,160,v,88
s_lshl_b32 s37, s37, 10
MA 112,v,160,v,92
MA 144,v,160,v,96
buffer_load_dwordx4 v181, s[8:11], s20 offen offset:1024 lds
MA 176,v,160,v,100
MA 208,v,160,v,104
s_add_u32 s43, s43, s37
MA 240,v,160,v,108
TR 160,200,49152
TR 162,200,51200
MA 20,v,164,v,80
ds_read_b128 v[136:139], v193 offset:45056
MA 52,v,164,v,84
buffer_load_dwordx4 v182, s[8:11], s20 offen offset:2048 lds
MA 84,v,164,v,88
v_lshrrev_b32 v78, 3, v1
MA 116,v,164,v,92
MA 148,v,164,v,96
MA 180,v,164,v,100
ds_read_b128 v[140:143], v193 offset:47104
MA 212,v,164,v,104
buffer_load_dwordx4 v183, s[8:11], s20 offen offset:3072 lds
s_waitcnt vmcnt(24)
v_and_b32 v79, 7, v1
MA 244,v,164,v,108
TR 164,201,49152
TR 166,201,51200
MA 24,v,168,v,80
MA 56,v,168,v,84
MA 88,v,168,v,88
v_lshlrev_b32 v79, 7, v79
MA 120,v,168,v,92
s_add_u32 s20, s20, 128
MA 152,v,168,v,96
MA 184,v,168,v,100
MA 216,v,168,v,104
v_lshl_add_u32 v78, v78, 13, v79
MA 248,v,168,v,108
TR 168,202,49152
TR 170,202,51200
s_waitcnt lgkmcnt(15)
MA 28,v,172,v,80
s_and_b32 s20, s20, 1023
MA 60,v,172,v,84
MA 92,v,172,v,88
v_add_u32 v78, s43, v78
MA 124,v,172,v,92
MA 156,v,172,v,96
MA 188,v,172,v,100
MA 220,v,172,v,104
MA 252,v,172,v,108
TR 172,203,49152
TR 174,203,51200
s_waitcnt lgkmcnt(2)
MA 0,v,144,v,112
MA 32,v,144,v,116
MA 64,v,144,v,120
MA 96,v,144,v,124
MA 128,v,144,v,128
MA 160,v,144,v,132
MA 192,v,144,v,136
MA 224,v,144,v,140
MA 4,v,148,v,112
MA 36,v,148,v,116
s_waitcnt vmcnt(8) lgkmcnt(0)
s_barrier
MA 68,v,148,v,120
TR 144,196,0
TR 146,196,2048
MA 100,v,148,v,124
ds_read_b128 v[80:83], v194 offset:0
s_add_u32 m0, s23, 32768
MA 132,v,148,v,128
s_mov_b32 s86, 4194304
s_mov_b32 s87, 0x20000
MA 164,v,148,v,132
s_mov_b32 s90, 4194304
s_mov_b32 s91, 0x20000
MA 196,v,148,v,136
buffer_load_dwordx4 v184, s[12:15], s21 offen offset:0 lds
MA 228,v,148,v,140
TR 148,197,0
TR 150,197,2048
MA 8,v,152,v,112
ds_read_b128 v[84:87], v194 offset:2048
s_mov_b32 s94, 4194304
MA 40,v,152,v,116
s_mov_b32 s95, 0x20000
s_mov_b32 s98, 8192
MA 72,v,152,v,120
buffer_load_dwordx4 v185, s[12:15], s21 offen offset:1024 lds
s_mov_b32 s99, 0x20000
MA 104,v,152,v,124
MA 136,v,152,v,128
s_mov_b32 s78, 2048
MA 168,v,152,v,132
ds_read_b128 v[88:91], v194 offset:4096
s_mov_b32 s79, 0x20000
MA 200,v,152,v,136
s_and_b32 s36, s2, 15
MA 232,v,152,v,140
TR 152,198,0
TR 154,198,2048
MA 12,v,156,v,112
buffer_load_dwordx4 v186, s[12:15], s21 offen offset:2048 lds
s_lshl_b32 s36, s36, 1
MA 44,v,156,v,116
s_lshr_b32 s37, s3, 1
MA 76,v,156,v,120
ds_read_b128 v[92:95], v194 offset:6144
s_add_u32 s36, s36, s37
MA 108,v,156,v,124
buffer_load_dwordx4 v187, s[12:15], s21 offen offset:3072 lds
s_lshl_b32 s36, s36, 3
MA 140,v,156,v,128
MA 172,v,156,v,132
v_and_b32 v252, 7, v1
MA 204,v,156,v,136
v_add_u32 v252, s36, v252
MA 236,v,156,v,140
TR 156,199,0
TR 158,199,2048
MA 16,v,160,v,112
ds_read_b128 v[96:99], v194 offset:8192
s_add_u32 m0, s23, 36864
MA 48,v,160,v,116
s_lshr_b32 s36, s2, 4
s_lshl_b32 s36, s36, 1
MA 80,v,160,v,120
s_and_b32 s37, s3, 1
MA 112,v,160,v,124
s_add_u32 s36, s36, s37
MA 144,v,160,v,128
ds_read_b128 v[100:103], v194 offset:10240
buffer_load_dwordx4 v188, s[12:15], s21 offen offset:0 lds
MA 176,v,160,v,132
s_lshl_b32 s36, s36, 3
v_lshrrev_b32 v253, 3, v1
MA 208,v,160,v,136
MA 240,v,160,v,140
TR 160,200,0
TR 162,200,2048
MA 20,v,164,v,112
buffer_load_dwordx4 v189, s[12:15], s21 offen offset:1024 lds
v_add_u32 v253, s36, v253
MA 52,v,164,v,116
ds_read_b128 v[104:107], v194 offset:12288
v_lshlrev_b32 v254, 14, v253
MA 84,v,164,v,120
v_lshl_add_u32 v254, v252, 3, v254
v_add_u32 v229, -6144, v254
MA 116,v,164,v,124
MA 148,v,164,v,128
buffer_load_dwordx4 v190, s[12:15], s21 offen offset:2048 lds
v_lshlrev_b32 v62, 5, v252
MA 180,v,164,v,132
v_lshlrev_b32 v254, 4, v253
MA 212,v,164,v,136
ds_read_b128 v[108:111], v194 offset:14336
v_sub_u32 v254, 4080, v254
MA 244,v,164,v,140
TR 164,201,0
TR 166,201,2048
MA 24,v,168,v,112
v_lshl_add_u32 v10, v252, 14, v254
MA 56,v,168,v,116
buffer_load_dwordx4 v191, s[12:15], s21 offen offset:3072 lds
v_and_b32 v252, 31, v1
MA 88,v,168,v,120
v_lshlrev_b32 v64, 4, v252
MA 120,v,168,v,124
s_lshl_b32 s36, s2, 2
MA 152,v,168,v,128
MA 184,v,168,v,132
s_add_u32 s21, s21, 524288
s_add_u32 s36, s36, s3
MA 216,v,168,v,136
s_lshl_b32 s36, s36, 1
MA 248,v,168,v,140
TR 168,202,0
TR 170,202,2048
MA 28,v,172,v,112
v_lshrrev_b32 v253, 5, v1
v_add_u32 v253, s36, v253
MA 60,v,172,v,116
s_and_b32 s21, s21, 4194303
MA 92,v,172,v,120
v_lshl_add_u32 v63, v253, 11, v64
MA 124,v,172,v,124
v_lshlrev_b32 v253, 2, v253
MA 156,v,172,v,128
v_lshl_add_u32 v11, v252, 20, v253
MA 188,v,172,v,132
MA 220,v,172,v,136
MA 252,v,172,v,140
TR 172,203,0
TR 174,203,2048
s_waitcnt lgkmcnt(2)
MA 0,v,144,v,80
s_add_u32 m0, s22, 32768
buffer_load_dwordx4 v[230:233], v63, s[92:95], 0 offen offset:0
MA 32,v,144,v,84
ds_read_b128 v[112:115], v195 offset:0
MA 64,v,144,v,88
MA 96,v,144,v,92
MA 128,v,144,v,96
buffer_load_dwordx4 v[2:5], v64, s[76:79], 0 offen offset:0
MA 160,v,144,v,100
buffer_load_dwordx4 v176, s[8:11], s20 offen offset:0 lds
MA 192,v,144,v,104
MA 224,v,144,v,108
TR 144,196,16384
TR 146,196,18432
MA 4,v,148,v,80
ds_read_b128 v[116:119], v195 offset:2048
MA 36,v,148,v,84
buffer_load_dwordx4 v[234:237], v63, s[92:95], 0 offen offset:512
MA 68,v,148,v,88
buffer_load_dwordx4 v177, s[8:11], s20 offen offset:1024 lds
MA 100,v,148,v,92
MA 132,v,148,v,96
MA 164,v,148,v,100
ds_read_b128 v[120:123], v195 offset:4096
MA 196,v,148,v,104
buffer_load_dwordx4 v[6:9], v64, s[76:79], 0 offen offset:512
MA 228,v,148,v,108
TR 148,197,16384
TR 150,197,18432
MA 8,v,152,v,80
buffer_load_dwordx4 v178, s[8:11], s20 offen offset:2048 lds
MA 40,v,152,v,84
MA 72,v,152,v,88
MA 104,v,152,v,92
buffer_load_dwordx4 v[238:241], v63, s[92:95], 0 offen offset:1024
MA 136,v,152,v,96
ds_read_b128 v[124:127], v195 offset:6144
buffer_load_dwordx4 v179, s[8:11], s20 offen offset:3072 lds
MA 168,v,152,v,100
MA 200,v,152,v,104
MA 232,v,152,v,108
TR 152,198,16384
TR 154,198,18432
MA 12,v,156,v,80
buffer_load_dwordx4 v[12:15], v64, s[76:79], 0 offen offset:1024
MA 44,v,156,v,84
s_add_u32 m0, s22, 36864
MA 76,v,156,v,88
ds_read_b128 v[128:131], v195 offset:8192
MA 108,v,156,v,92
MA 140,v,156,v,96
buffer_load_dwordx4 v[242:245], v63, s[92:95], 0 offen offset:1536
MA 172,v,156,v,100
MA 204,v,156,v,104
MA 236,v,156,v,108
TR 156,199,16384
TR 158,199,18432
MA 16,v,160,v,80
ds_read_b128 v[132:135], v195 offset:10240
buffer_load_dwordx4 v180, s[8:11], s20 offen offset:0 lds
MA 48,v,160,v,84
buffer_load_dwordx4 v[246:249], v64, s[76:79], 0 offen offset:1536
MA 80,v,160,v,88
MA 112,v,160,v,92
MA 144,v,160,v,96
buffer_load_dwordx4 v181, s[8:11], s20 offen offset:1024 lds
MA 176,v,160,v,100
MA 208,v,160,v,104
buffer_load_dwordx4 v[54:57], v62, s[96:99], 0 offen offset:0
MA 240,v,160,v,108
TR 160,200,16384
TR 162,200,18432
MA 20,v,164,v,80
ds_read_b128 v[136:139], v195 offset:12288
MA 52,v,164,v,84
buffer_load_dwordx4 v182, s[8:11], s20 offen offset:2048 lds
MA 84,v,164,v,88
buffer_load_dwordx4 v[58:61], v62, s[96:99], 0 offen offset:16
MA 116,v,164,v,92
MA 148,v,164,v,96
MA 180,v,164,v,100
ds_read_b128 v[140:143], v195 offset:14336
MA 212,v,164,v,104
buffer_load_dwordx4 v183, s[8:11], s20 offen offset:3072 lds
MA 244,v,164,v,108
TR 164,201,16384
TR 166,201,18432
MA 24,v,168,v,80
v_add_u32 v252, 0, v229
MA 56,v,168,v,84
MA 88,v,168,v,88
MA 120,v,168,v,92
s_add_u32 s20, s20, 128
MA 152,v,168,v,96
buffer_load_dwordx2 v[16:17], v252, s[84:87], 0 offen
MA 184,v,168,v,100
MA 216,v,168,v,104
MA 248,v,168,v,108
TR 168,202,16384
TR 170,202,18432
s_waitcnt lgkmcnt(15)
MA 28,v,172,v,80
s_and_b32 s20, s20, 1023
MA 60,v,172,v,84
v_add_u32 v253, 2048, v229
MA 92,v,172,v,88
MA 124,v,172,v,92
MA 156,v,172,v,96
MA 188,v,172,v,100
MA 220,v,172,v,104
MA 252,v,172,v,108
TR 172,203,16384
TR 174,203,18432
s_waitcnt lgkmcnt(2)
MA 0,v,144,v,112
MA 32,v,144,v,116
MA 64,v,144,v,120
MA 96,v,144,v,124
MA 128,v,144,v,128
MA 160,v,144,v,132
MA 192,v,144,v,136
MA 224,v,144,v,140
MA 4,v,148,v,112
MA 36,v,148,v,116
s_waitcnt vmcnt(19) lgkmcnt(0)
s_barrier
MA 68,v,148,v,120
TR 144,196,32768
TR 146,196,34816
MA 100,v,148,v,124
ds_read_b128 v[80:83], v192 offset:0
s_add_u32 m0, s23, 0
MA 132,v,148,v,128
s_and_b32 s80, s2, 7
s_lshr_b32 s81, s2, 3
MA 164,v,148,v,132
s_and_b32 s69, s81, 3
s_lshl_b32 s80, s80, 2
MA 196,v,148,v,136
buffer_load_dwordx4 v184, s[12:15], s21 offen offset:0 lds
s_add_u32 s69, s69, s80
MA 228,v,148,v,140
TR 148,197,32768
TR 150,197,34816
MA 8,v,152,v,112
ds_read_b128 v[84:87], v192 offset:2048
s_lshr_b32 s70, s81, 2
MA 40,v,152,v,116
s_lshl_b32 s80, s3, 16
s_lshl_b32 s65, s70, 18
MA 72,v,152,v,120
buffer_load_dwordx4 v185, s[12:15], s21 offen offset:1024 lds
s_sub_u32 s64, 3932160, s65
MA 104,v,152,v,124
s_add_u32 s65, s65, s80
MA 136,v,152,v,128
s_add_u32 s64, s64, s80
MA 168,v,152,v,132
ds_read_b128 v[88:91], v192 offset:4096
s_lshl_b32 s81, s69, 12
MA 200,v,152,v,136
s_lshl_b32 s100, s64, 2
MA 232,v,152,v,140
TR 152,198,32768
TR 154,198,34816
MA 12,v,156,v,112
buffer_load_dwordx4 v186, s[12:15], s21 offen offset:2048 lds
s_add_u32 s100, s100, s81
MA 44,v,156,v,116
s_lshl_b32 s101, s65, 2
s_add_u32 s101, s101, s81
MA 76,v,156,v,120
ds_read_b128 v[92:95], v192 offset:6144
s_lshl_b32 s66, s3, 17
MA 108,v,156,v,124
buffer_load_dwordx4 v187, s[12:15], s21 offen offset:3072 lds
s_lshl_b32 s81, s69, 8
MA 140,v,156,v,128
s_add_u32 s66, s66, s81
MA 172,v,156,v,132
s_and_b32 s74, s2, 7
MA 204,v,156,v,136
s_lshl_b32 s74, s74, 8
MA 236,v,156,v,140
TR 156,199,32768
TR 158,199,34816
MA 16,v,160,v,112
ds_read_b128 v[96:99], v192 offset:8192
s_add_u32 m0, s23, 4096
MA 48,v,160,v,116
s_mov_b32 s82, s66
s_lshl_b32 s66, s74, 12
MA 80,v,160,v,120
s_lshl_b32 s67, s3, 13
s_lshl_b32 s68, s3, 12
MA 112,v,160,v,124
s_lshl_b32 s77, s70, 1
MA 144,v,160,v,128
ds_read_b128 v[100:103], v192 offset:10240
buffer_load_dwordx4 v188, s[12:15], s21 offen offset:0 lds
MA 176,v,160,v,132
s_sub_u32 s77, 32, s77
v_lshrrev_b32 v66, 3, v1
MA 208,v,160,v,136
v_lshlrev_b32 v66, 11, v66
MA 240,v,160,v,140
TR 160,200,32768
TR 162,200,34816
MA 20,v,164,v,112
buffer_load_dwordx4 v189, s[12:15], s21 offen offset:1024 lds
v_lshrrev_b32 v67, 4, v1
MA 52,v,164,v,116
ds_read_b128 v[104:107], v192 offset:12288
v_and_b32 v68, 7, v1
MA 84,v,164,v,120
v_xor_b32 v68, v68, v67
v_lshl_add_u32 v66, v68, 4, v66
MA 116,v,164,v,124
v_xor_b32 v69, 64, v66
MA 148,v,164,v,128
buffer_load_dwordx4 v190, s[12:15], s21 offen offset:2048 lds
v_add_u32 v208, 0, v66
MA 180,v,164,v,132
v_add_u32 v209, 15360, v69
MA 212,v,164,v,136
ds_read_b128 v[108:111], v192 offset:14336
v_add_u32 v210, 30720, v66
MA 244,v,164,v,140
TR 164,201,32768
TR 166,201,34816
MA 24,v,168,v,112
v_add_u32 v211, 46080, v69
v_and_b32 v68, 15, v1
MA 56,v,168,v,116
buffer_load_dwordx4 v191, s[12:15], s21 offen offset:3072 lds
v_lshlrev_b32 v69, 1, v67
MA 88,v,168,v,120
v_xor_b32 v68, v68, v69
MA 120,v,168,v,124
v_lshlrev_b32 v66, 13, v67
MA 152,v,168,v,128
v_xor_b32 v69, 0, v68
MA 184,v,168,v,132
s_add_u32 s21, s21, 524288
v_lshl_add_u32 v69, v69, 4, v66
MA 216,v,168,v,136
v_add_u32 v212, 0, v69
MA 248,v,168,v,140
TR 168,202,32768
TR 170,202,34816
MA 28,v,172,v,112
v_xor_b32 v69, 0, v68
v_lshl_add_u32 v69, v69, 4, v66
MA 60,v,172,v,116
s_and_b32 s21, s21, 4194303
v_add_u32 v213, 31744, v69
MA 92,v,172,v,120
v_xor_b32 v69, 8, v68
MA 124,v,172,v,124
v_lshl_add_u32 v69, v69, 4, v66
MA 156,v,172,v,128
v_add_u32 v214, 63488, v69
MA 188,v,172,v,132
v_xor_b32 v69, 8, v68
MA 220,v,172,v,136
MA 252,v,172,v,140
TR 172,203,32768
TR 174,203,34816
s_waitcnt lgkmcnt(2)
MA 0,v,144,v,80
s_add_u32 m0, s22, 65536
buffer_load_dwordx2 v[18:19], v253, s[84:87], 0 offen
MA 32,v,144,v,84
ds_read_b128 v[112:115], v193 offset:0
MA 64,v,144,v,88
MA 96,v,144,v,92
MA 128,v,144,v,96
v_add_u32 v254, 4096, v229
MA 160,v,144,v,100
buffer_load_dwordx4 v176, s[8:11], s20 offen offset:0 lds
MA 192,v,144,v,104
MA 224,v,144,v,108
TR 144,196,49152
TR 146,196,51200
MA 4,v,148,v,80
ds_read_b128 v[116:119], v193 offset:2048
MA 36,v,148,v,84
buffer_load_dwordx2 v[20:21], v254, s[84:87], 0 offen
MA 68,v,148,v,88
buffer_load_dwordx4 v177, s[8:11], s20 offen offset:1024 lds
MA 100,v,148,v,92
MA 132,v,148,v,96
MA 164,v,148,v,100
ds_read_b128 v[120:123], v193 offset:4096
MA 196,v,148,v,104
v_add_u32 v255, 6144, v229
MA 228,v,148,v,108
TR 148,197,49152
TR 150,197,51200
MA 8,v,152,v,80
buffer_load_dwordx4 v178, s[8:11], s20 offen offset:2048 lds
MA 40,v,152,v,84
MA 72,v,152,v,88
MA 104,v,152,v,92
buffer_load_dwordx2 v[22:23], v255, s[84:87], 0 offen
MA 136,v,152,v,96
ds_read_b128 v[124:127], v193 offset:6144
buffer_load_dwordx4 v179, s[8:11], s20 offen offset:3072 lds
MA 168,v,152,v,100
MA 200,v,152,v,104
MA 232,v,152,v,108
TR 152,198,49152
TR 154,198,51200
MA 12,v,156,v,80
buffer_load_dwordx2 v[38:39], v255, s[88:91], 0 offen
MA 44,v,156,v,84
s_add_u32 m0, s22, 69632
MA 76,v,156,v,88
ds_read_b128 v[128:131], v193 offset:8192
MA 108,v,156,v,92
MA 140,v,156,v,96
v_add_u32 v252, 8192, v229
MA 172,v,156,v,100
MA 204,v,156,v,104
MA 236,v,156,v,108
TR 156,199,49152
TR 158,199,51200
MA 16,v,160,v,80
ds_read_b128 v[132:135], v193 offset:10240
buffer_load_dwordx4 v180, s[8:11], s20 offen offset:0 lds
MA 48,v,160,v,84
buffer_load_dwordx2 v[24:25], v252, s[84:87], 0 offen
MA 80,v,160,v,88
MA 112,v,160,v,92
MA 144,v,160,v,96
buffer_load_dwordx4 v181, s[8:11], s20 offen offset:1024 lds
MA 176,v,160,v,100
MA 208,v,160,v,104
buffer_load_dwordx2 v[40:41], v252, s[88:91], 0 offen
MA 240,v,160,v,108
TR 160,200,49152
TR 162,200,51200
MA 20,v,164,v,80
ds_read_b128 v[136:139], v193 offset:12288
MA 52,v,164,v,84
buffer_load_dwordx4 v182, s[8:11], s20 offen offset:2048 lds
MA 84,v,164,v,88
v_add_u32 v253, 10240, v229
MA 116,v,164,v,92
MA 148,v,164,v,96
MA 180,v,164,v,100
ds_read_b128 v[140:143], v193 offset:14336
MA 212,v,164,v,104
buffer_load_dwordx4 v183, s[8:11], s20 offen offset:3072 lds
MA 244,v,164,v,108
TR 164,201,49152
TR 166,201,51200
MA 24,v,168,v,80
buffer_load_dwordx2 v[26:27], v253, s[84:87], 0 offen
MA 56,v,168,v,84
MA 88,v,168,v,88
MA 120,v,168,v,92
s_add_u32 s20, s20, 128
MA 152,v,168,v,96
buffer_load_dwordx2 v[42:43], v253, s[88:91], 0 offen
MA 184,v,168,v,100
MA 216,v,168,v,104
MA 248,v,168,v,108
TR 168,202,49152
TR 170,202,51200
s_waitcnt lgkmcnt(15)
MA 28,v,172,v,80
s_and_b32 s20, s20, 1023
MA 60,v,172,v,84
v_add_u32 v254, 12288, v229
MA 92,v,172,v,88
MA 124,v,172,v,92
MA 156,v,172,v,96
MA 188,v,172,v,100
MA 220,v,172,v,104
MA 252,v,172,v,108
TR 172,203,49152
TR 174,203,51200
s_waitcnt lgkmcnt(2)
MA 0,v,144,v,112
MA 32,v,144,v,116
MA 64,v,144,v,120
MA 96,v,144,v,124
MA 128,v,144,v,128
MA 160,v,144,v,132
MA 192,v,144,v,136
MA 224,v,144,v,140
MA 4,v,148,v,112
MA 36,v,148,v,116
s_waitcnt vmcnt(16) lgkmcnt(0)
s_barrier
MA 68,v,148,v,120
TR 144,196,0
TR 146,196,2048
MA 100,v,148,v,124
ds_read_b128 v[80:83], v192 offset:32768
s_add_u32 m0, s23, 32768
MA 132,v,148,v,128
v_lshl_add_u32 v69, v69, 4, v66
v_add_u32 v215, 95232, v69
MA 164,v,148,v,132
v_and_b32 v66, 15, v1
v_lshrrev_b32 v68, 1, v66
MA 196,v,148,v,136
buffer_load_dwordx4 v184, s[12:15], s21 offen offset:0 lds
v_xor_b32 v68, v68, v67
MA 228,v,148,v,140
TR 148,197,0
TR 150,197,2048
MA 8,v,152,v,112
ds_read_b128 v[84:87], v192 offset:34816
v_lshlrev_b32 v68, 4, v68
MA 40,v,152,v,116
v_lshl_add_u32 v68, v66, 7, v68
v_add_u32 v224, s67, v68
MA 72,v,152,v,120
buffer_load_dwordx4 v185, s[12:15], s21 offen offset:1024 lds
v_xor_b32 v225, 64, v224
MA 104,v,152,v,124
v_add_u32 v226, 0x10000, v224
v_add_u32 v227, 0x10000, v225
MA 136,v,152,v,128
v_bfe_u32 v66, v1, 2, 2
v_and_b32 v68, 1, v67
MA 168,v,152,v,132
ds_read_b128 v[88:91], v192 offset:36864
v_lshl_or_b32 v68, v68, 2, v66
MA 200,v,152,v,136
v_lshl_add_u32 v66, v67, 3, v66
MA 232,v,152,v,140
TR 152,198,0
TR 154,198,2048
MA 12,v,156,v,112
buffer_load_dwordx4 v186, s[12:15], s21 offen offset:2048 lds
v_lshlrev_b32 v66, 8, v66
MA 44,v,156,v,116
v_and_b32 v69, 3, v1
v_lshl_add_u32 v66, v69, 3, v66
MA 76,v,156,v,120
ds_read_b128 v[92:95], v192 offset:38912
v_add_u32 v66, 98304, v66
MA 108,v,156,v,124
buffer_load_dwordx4 v187, s[12:15], s21 offen offset:3072 lds
v_xor_b32 v69, 0, v68
MA 140,v,156,v,128
v_lshl_add_u32 v216, v69, 5, v66
v_xor_b32 v69, 1, v68
MA 172,v,156,v,132
v_lshl_add_u32 v217, v69, 5, v66
MA 204,v,156,v,136
v_xor_b32 v69, 2, v68
MA 236,v,156,v,140
TR 156,199,0
TR 158,199,2048
MA 16,v,160,v,112
ds_read_b128 v[96:99], v192 offset:40960
s_add_u32 m0, s23, 36864
MA 48,v,160,v,116
v_lshl_add_u32 v218, v69, 5, v66
v_xor_b32 v69, 3, v68
MA 80,v,160,v,120
v_lshl_add_u32 v219, v69, 5, v66
v_xor_b32 v69, 4, v68
MA 112,v,160,v,124
v_lshl_add_u32 v220, v69, 5, v66
MA 144,v,160,v,128
ds_read_b128 v[100:103], v192 offset:43008
buffer_load_dwordx4 v188, s[12:15], s21 offen offset:0 lds
MA 176,v,160,v,132
v_xor_b32 v69, 5, v68
v_lshl_add_u32 v221, v69, 5, v66
MA 208,v,160,v,136
v_xor_b32 v69, 6, v68
v_lshl_add_u32 v222, v69, 5, v66
MA 240,v,160,v,140
TR 160,200,0
TR 162,200,2048
MA 20,v,164,v,112
buffer_load_dwordx4 v189, s[12:15], s21 offen offset:1024 lds
v_xor_b32 v69, 7, v68
MA 52,v,164,v,116
ds_read_b128 v[104:107], v192 offset:45056
v_lshl_add_u32 v223, v69, 5, v66
MA 84,v,164,v,120
s_mov_b32 s44, s32
s_mov_b32 s45, s33
MA 116,v,164,v,124
s_mov_b32 s46, 4194304
MA 148,v,164,v,128
buffer_load_dwordx4 v190, s[12:15], s21 offen offset:2048 lds
s_mov_b32 s47, 0x20000
MA 180,v,164,v,132
s_add_u32 s48, s34, s82
s_addc_u32 s49, s35, 0
MA 212,v,164,v,136
ds_read_b128 v[108:111], v192 offset:47104
s_sub_u32 s50, 8388608, s82
MA 244,v,164,v,140
TR 164,201,0
TR 166,201,2048
MA 24,v,168,v,112
s_mov_b32 s51, 0x20000
MA 56,v,168,v,116
buffer_load_dwordx4 v191, s[12:15], s21 offen offset:3072 lds
MA 88,v,168,v,120
s_add_u32 s60, s40, 33554432
s_addc_u32 s61, s41, 0
MA 120,v,168,v,124
s_mov_b32 s62, 16777216
s_mov_b32 s63, 0x20000
MA 152,v,168,v,128
s_lshl_b32 s80, s69, 19
MA 184,v,168,v,132
s_add_u32 s21, s21, 524288
MA 216,v,168,v,136
s_add_u32 s52, s40, s80
s_addc_u32 s53, s41, 0
MA 248,v,168,v,140
TR 168,202,0
TR 170,202,2048
MA 28,v,172,v,112
s_lshl_b32 s54, s77, 14
s_mov_b32 s55, 0x20000
MA 60,v,172,v,116
s_and_b32 s21, s21, 4194303
s_add_u32 s80, s80, 16760832
MA 92,v,172,v,120
s_add_u32 s56, s40, s80
s_addc_u32 s57, s41, 0
MA 124,v,172,v,124
s_add_u32 s58, s54, 16384
MA 156,v,172,v,128
s_mov_b32 s59, 0x20000
MA 188,v,172,v,132
s_load_dwordx2 s[38:39], s[0:1], 112
MA 220,v,172,v,136
MA 252,v,172,v,140
TR 172,203,0
TR 174,203,2048
s_waitcnt lgkmcnt(2)
MA 0,v,144,v,80
s_add_u32 m0, s22, 0
buffer_load_dwordx2 v[28:29], v254, s[84:87], 0 offen
MA 32,v,144,v,84
ds_read_b128 v[112:115], v193 offset:32768
MA 64,v,144,v,88
MA 96,v,144,v,92
MA 128,v,144,v,96
buffer_load_dwordx2 v[44:45], v254, s[88:91], 0 offen
MA 160,v,144,v,100
buffer_load_dwordx4 v176, s[8:11], s20 offen offset:0 lds
MA 192,v,144,v,104
MA 224,v,144,v,108
TR 144,196,16384
TR 146,196,18432
MA 4,v,148,v,80
ds_read_b128 v[116:119], v193 offset:34816
v_add_u32 v255, 14336, v229
MA 36,v,148,v,84
MA 68,v,148,v,88
buffer_load_dwordx4 v177, s[8:11], s20 offen offset:1024 lds
MA 100,v,148,v,92
MA 132,v,148,v,96
MA 164,v,148,v,100
ds_read_b128 v[120:123], v193 offset:36864
buffer_load_dwordx2 v[30:31], v255, s[84:87], 0 offen
MA 196,v,148,v,104
MA 228,v,148,v,108
TR 148,197,16384
TR 150,197,18432
MA 8,v,152,v,80
buffer_load_dwordx4 v178, s[8:11], s20 offen offset:2048 lds
MA 40,v,152,v,84
buffer_load_dwordx2 v[46:47], v255, s[88:91], 0 offen
MA 72,v,152,v,88
MA 104,v,152,v,92
MA 136,v,152,v,96
ds_read_b128 v[124:127], v193 offset:38912
buffer_load_dwordx4 v179, s[8:11], s20 offen offset:3072 lds
MA 168,v,152,v,100
MA 200,v,152,v,104
v_add_u32 v252, 16384, v229
MA 232,v,152,v,108
TR 152,198,16384
TR 154,198,18432
MA 12,v,156,v,80
MA 44,v,156,v,84
s_add_u32 m0, s22, 4096
MA 76,v,156,v,88
ds_read_b128 v[128:131], v193 offset:40960
buffer_load_dwordx2 v[32:33], v252, s[84:87], 0 offen
MA 108,v,156,v,92
MA 140,v,156,v,96
MA 172,v,156,v,100
MA 204,v,156,v,104
MA 236,v,156,v,108
TR 156,199,16384
TR 158,199,18432
MA 16,v,160,v,80
ds_read_b128 v[132:135], v193 offset:43008
buffer_load_dwordx4 v180, s[8:11], s20 offen offset:0 lds
MA 48,v,160,v,84
buffer_load_dwordx2 v[48:49], v252, s[88:91], 0 offen
MA 80,v,160,v,88
MA 112,v,160,v,92
v_add_u32 v253, 18432, v229
MA 144,v,160,v,96
buffer_load_dwordx4 v181, s[8:11], s20 offen offset:1024 lds
MA 176,v,160,v,100
MA 208,v,160,v,104
MA 240,v,160,v,108
TR 160,200,16384
TR 162,200,18432
MA 20,v,164,v,80
ds_read_b128 v[136:139], v193 offset:45056
buffer_load_dwordx2 v[34:35], v253, s[84:87], 0 offen
MA 52,v,164,v,84
buffer_load_dwordx4 v182, s[8:11], s20 offen offset:2048 lds
MA 84,v,164,v,88
MA 116,v,164,v,92
MA 148,v,164,v,96
buffer_load_dwordx2 v[50:51], v253, s[88:91], 0 offen
MA 180,v,164,v,100
ds_read_b128 v[140:143], v193 offset:47104
MA 212,v,164,v,104
buffer_load_dwordx4 v183, s[8:11], s20 offen offset:3072 lds
MA 244,v,164,v,108
TR 164,201,16384
TR 166,201,18432
MA 24,v,168,v,80
v_add_u32 v254, 20480, v229
MA 56,v,168,v,84
MA 88,v,168,v,88
MA 120,v,168,v,92
s_add_u32 s20, s20, 128
MA 152,v,168,v,96
MA 184,v,168,v,100
buffer_load_dwordx2 v[36:37], v254, s[84:87], 0 offen
MA 216,v,168,v,104
MA 248,v,168,v,108
TR 168,202,16384
TR 170,202,18432
s_waitcnt lgkmcnt(15)
MA 28,v,172,v,80
s_and_b32 s20, s20, 1023
MA 60,v,172,v,84
buffer_load_dwordx2 v[52:53], v254, s[88:91], 0 offen
MA 92,v,172,v,88
MA 124,v,172,v,92
MA 156,v,172,v,96
MA 188,v,172,v,100
MA 220,v,172,v,104
MA 252,v,172,v,108
TR 172,203,16384
TR 174,203,18432
s_waitcnt lgkmcnt(2)
MA 0,v,144,v,112
MA 32,v,144,v,116
MA 64,v,144,v,120
MA 96,v,144,v,124
MA 128,v,144,v,128
MA 160,v,144,v,132
MA 192,v,144,v,136
MA 224,v,144,v,140
MA 4,v,148,v,112
MA 36,v,148,v,116
s_waitcnt vmcnt(18) lgkmcnt(0)
s_barrier
MA 68,v,148,v,120
TR 144,196,32768
TR 146,196,34816
MA 100,v,148,v,124
ds_read_b128 v[80:83], v194 offset:0
s_add_u32 m0, s23, 0
MA 132,v,148,v,128
MA 164,v,148,v,132
MA 196,v,148,v,136
buffer_load_dwordx4 v184, s[12:15], s21 offen offset:0 lds
MA 228,v,148,v,140
TR 148,197,32768
TR 150,197,34816
MA 8,v,152,v,112
ds_read_b128 v[84:87], v194 offset:2048
MA 40,v,152,v,116
MA 72,v,152,v,120
buffer_load_dwordx4 v185, s[12:15], s21 offen offset:1024 lds
MA 104,v,152,v,124
MA 136,v,152,v,128
MA 168,v,152,v,132
ds_read_b128 v[88:91], v194 offset:4096
MA 200,v,152,v,136
MA 232,v,152,v,140
TR 152,198,32768
TR 154,198,34816
MA 12,v,156,v,112
buffer_load_dwordx4 v186, s[12:15], s21 offen offset:2048 lds
MA 44,v,156,v,116
MA 76,v,156,v,120
ds_read_b128 v[92:95], v194 offset:6144
MA 108,v,156,v,124
buffer_load_dwordx4 v187, s[12:15], s21 offen offset:3072 lds
MA 140,v,156,v,128
MA 172,v,156,v,132
MA 204,v,156,v,136
MA 236,v,156,v,140
TR 156,199,32768
TR 158,199,34816
MA 16,v,160,v,112
ds_read_b128 v[96:99], v194 offset:8192
s_add_u32 m0, s23, 4096
MA 48,v,160,v,116
MA 80,v,160,v,120
MA 112,v,160,v,124
MA 144,v,160,v,128
ds_read_b128 v[100:103], v194 offset:10240
buffer_load_dwordx4 v188, s[12:15], s21 offen offset:0 lds
MA 176,v,160,v,132
MA 208,v,160,v,136
MA 240,v,160,v,140
TR 160,200,32768
TR 162,200,34816
MA 20,v,164,v,112
buffer_load_dwordx4 v189, s[12:15], s21 offen offset:1024 lds
MA 52,v,164,v,116
ds_read_b128 v[104:107], v194 offset:12288
MA 84,v,164,v,120
MA 116,v,164,v,124
MA 148,v,164,v,128
buffer_load_dwordx4 v190, s[12:15], s21 offen offset:2048 lds
MA 180,v,164,v,132
MA 212,v,164,v,136
ds_read_b128 v[108:111], v194 offset:14336
MA 244,v,164,v,140
TR 164,201,32768
TR 166,201,34816
MA 24,v,168,v,112
MA 56,v,168,v,116
buffer_load_dwordx4 v191, s[12:15], s21 offen offset:3072 lds
MA 88,v,168,v,120
MA 120,v,168,v,124
MA 152,v,168,v,128
MA 184,v,168,v,132
s_add_u32 s21, s21, 524288
MA 216,v,168,v,136
MA 248,v,168,v,140
TR 168,202,32768
TR 170,202,34816
MA 28,v,172,v,112
MA 60,v,172,v,116
s_and_b32 s21, s21, 4194303
MA 92,v,172,v,120
MA 124,v,172,v,124
MA 156,v,172,v,128
MA 188,v,172,v,132
MA 220,v,172,v,136
MA 252,v,172,v,140
TR 172,203,32768
TR 174,203,34816
s_waitcnt lgkmcnt(2)
MA 0,v,144,v,80
s_add_u32 m0, s22, 32768
MA 32,v,144,v,84
ds_read_b128 v[112:115], v195 offset:0
MA 64,v,144,v,88
MA 96,v,144,v,92
MA 128,v,144,v,96
MA 160,v,144,v,100
buffer_load_dwordx4 v176, s[8:11], s20 offen offset:0 lds
MA 192,v,144,v,104
MA 224,v,144,v,108
TR 144,196,49152
TR 146,196,51200
MA 4,v,148,v,80
ds_read_b128 v[116:119], v195 offset:2048
MA 36,v,148,v,84
MA 68,v,148,v,88
buffer_load_dwordx4 v177, s[8:11], s20 offen offset:1024 lds
MA 100,v,148,v,92
MA 132,v,148,v,96
MA 164,v,148,v,100
ds_read_b128 v[120:123], v195 offset:4096
MA 196,v,148,v,104
MA 228,v,148,v,108
TR 148,197,49152
TR 150,197,51200
MA 8,v,152,v,80
buffer_load_dwordx4 v178, s[8:11], s20 offen offset:2048 lds
MA 40,v,152,v,84
MA 72,v,152,v,88
MA 104,v,152,v,92
MA 136,v,152,v,96
ds_read_b128 v[124:127], v195 offset:6144
buffer_load_dwordx4 v179, s[8:11], s20 offen offset:3072 lds
MA 168,v,152,v,100
MA 200,v,152,v,104
MA 232,v,152,v,108
TR 152,198,49152
TR 154,198,51200
MA 12,v,156,v,80
MA 44,v,156,v,84
s_add_u32 m0, s22, 36864
MA 76,v,156,v,88
ds_read_b128 v[128:131], v195 offset:8192
MA 108,v,156,v,92
MA 140,v,156,v,96
MA 172,v,156,v,100
MA 204,v,156,v,104
MA 236,v,156,v,108
TR 156,199,49152
TR 158,199,51200
MA 16,v,160,v,80
ds_read_b128 v[132:135], v195 offset:10240
buffer_load_dwordx4 v180, s[8:11], s20 offen offset:0 lds
MA 48,v,160,v,84
MA 80,v,160,v,88
MA 112,v,160,v,92
MA 144,v,160,v,96
buffer_load_dwordx4 v181, s[8:11], s20 offen offset:1024 lds
MA 176,v,160,v,100
MA 208,v,160,v,104
MA 240,v,160,v,108
TR 160,200,49152
TR 162,200,51200
MA 20,v,164,v,80
ds_read_b128 v[136:139], v195 offset:12288
MA 52,v,164,v,84
buffer_load_dwordx4 v182, s[8:11], s20 offen offset:2048 lds
MA 84,v,164,v,88
MA 116,v,164,v,92
MA 148,v,164,v,96
MA 180,v,164,v,100
ds_read_b128 v[140:143], v195 offset:14336
MA 212,v,164,v,104
buffer_load_dwordx4 v183, s[8:11], s20 offen offset:3072 lds
MA 244,v,164,v,108
TR 164,201,49152
TR 166,201,51200
MA 24,v,168,v,80
MA 56,v,168,v,84
MA 88,v,168,v,88
MA 120,v,168,v,92
s_add_u32 s20, s20, 128
MA 152,v,168,v,96
MA 184,v,168,v,100
MA 216,v,168,v,104
MA 248,v,168,v,108
TR 168,202,49152
TR 170,202,51200
s_waitcnt lgkmcnt(15)
MA 28,v,172,v,80
s_and_b32 s20, s20, 1023
MA 60,v,172,v,84
MA 92,v,172,v,88
MA 124,v,172,v,92
MA 156,v,172,v,96
MA 188,v,172,v,100
MA 220,v,172,v,104
MA 252,v,172,v,108
TR 172,203,49152
TR 174,203,51200
s_waitcnt lgkmcnt(2)
MA 0,v,144,v,112
MA 32,v,144,v,116
MA 64,v,144,v,120
MA 96,v,144,v,124
MA 128,v,144,v,128
MA 160,v,144,v,132
MA 192,v,144,v,136
MA 224,v,144,v,140
MA 4,v,148,v,112
MA 36,v,148,v,116
s_waitcnt vmcnt(8) lgkmcnt(0)
s_barrier
MA 68,v,148,v,120
TR 144,196,0
TR 146,196,2048
MA 100,v,148,v,124
ds_read_b128 v[80:83], v192 offset:0
s_add_u32 m0, s23, 32768
MA 132,v,148,v,128
buffer_load_dword v79, v78, s[4:7], 0 offen
MA 164,v,148,v,132
s_add_u32 s84, s40, 50331648
s_addc_u32 s85, s41, 0
MA 196,v,148,v,136
buffer_load_dwordx4 v184, s[12:15], s21 offen offset:0 lds
s_mov_b32 s86, 4194304
MA 228,v,148,v,140
TR 148,197,0
TR 150,197,2048
MA 8,v,152,v,112
ds_read_b128 v[84:87], v192 offset:2048
s_mov_b32 s87, 0x20000
MA 40,v,152,v,116
s_add_u32 s88, s40, 58720256
s_addc_u32 s89, s41, 0
MA 72,v,152,v,120
buffer_load_dwordx4 v185, s[12:15], s21 offen offset:1024 lds
s_mov_b32 s90, 8192
MA 104,v,152,v,124
s_mov_b32 s91, 0x20000
v_mov_b32 v252, 0
MA 136,v,152,v,128
v_mov_b32 v253, 0
v_dot2_f32_bf16 v252, v230, v2, v252
MA 168,v,152,v,132
ds_read_b128 v[88:91], v192 offset:4096
v_dot2_f32_bf16 v253, v231, v3, v253
MA 200,v,152,v,136
v_dot2_f32_bf16 v252, v232, v4, v252
v_dot2_f32_bf16 v253, v233, v5, v253
MA 232,v,152,v,140
TR 152,198,0
TR 154,198,2048
MA 12,v,156,v,112
buffer_load_dwordx4 v186, s[12:15], s21 offen offset:2048 lds
v_dot2_f32_bf16 v252, v234, v6, v252
MA 44,v,156,v,116
v_dot2_f32_bf16 v253, v235, v7, v253
v_dot2_f32_bf16 v252, v236, v8, v252
MA 76,v,156,v,120
ds_read_b128 v[92:95], v192 offset:6144
v_dot2_f32_bf16 v253, v237, v9, v253
MA 108,v,156,v,124
buffer_load_dwordx4 v187, s[12:15], s21 offen offset:3072 lds
v_dot2_f32_bf16 v252, v238, v12, v252
MA 140,v,156,v,128
v_dot2_f32_bf16 v253, v239, v13, v253
v_dot2_f32_bf16 v252, v240, v14, v252
MA 172,v,156,v,132
v_dot2_f32_bf16 v253, v241, v15, v253
v_dot2_f32_bf16 v252, v242, v246, v252
MA 204,v,156,v,136
v_dot2_f32_bf16 v253, v243, v247, v253
v_dot2_f32_bf16 v252, v244, v248, v252
MA 236,v,156,v,140
TR 156,199,0
TR 158,199,2048
MA 16,v,160,v,112
ds_read_b128 v[96:99], v192 offset:8192
s_add_u32 m0, s23, 36864
MA 48,v,160,v,116
v_dot2_f32_bf16 v253, v245, v249, v253
MA 80,v,160,v,120
s_nop 2
v_add_f32 v252, v252, v253
MA 112,v,160,v,124
s_nop 0
v_add_f32_dpp v252, v252, v252 row_ror:8 row_mask:0xf bank_mask:0xf
s_nop 1
v_add_f32_dpp v252, v252, v252 row_ror:4 row_mask:0xf bank_mask:0xf
MA 144,v,160,v,128
ds_read_b128 v[100:103], v192 offset:10240
buffer_load_dwordx4 v188, s[12:15], s21 offen offset:0 lds
MA 176,v,160,v,132
v_add_f32_dpp v252, v252, v252 row_ror:2 row_mask:0xf bank_mask:0xf
s_nop 1
v_add_f32_dpp v252, v252, v252 row_ror:1 row_mask:0xf bank_mask:0xf
MA 208,v,160,v,136
v_mov_b32 v253, v252
s_nop 1
v_permlane16_swap_b32 v252, v253
MA 240,v,160,v,140
TR 160,200,0
TR 162,200,2048
MA 20,v,164,v,112
buffer_load_dwordx4 v189, s[12:15], s21 offen offset:1024 lds
v_add_f32 v252, v252, v253
MA 52,v,164,v,116
ds_read_b128 v[104:107], v192 offset:12288
v_mul_f32 v252, 0xbfb8aa3b, v252
MA 84,v,164,v,120
v_exp_f32 v252, v252
MA 116,v,164,v,124
v_add_f32 v252, 1.0, v252
MA 148,v,164,v,128
buffer_load_dwordx4 v190, s[12:15], s21 offen offset:2048 lds
MA 180,v,164,v,132
v_rcp_f32 v252, v252
MA 212,v,164,v,136
ds_read_b128 v[108:111], v192 offset:14336
MA 244,v,164,v,140
TR 164,201,0
TR 166,201,2048
MA 24,v,168,v,112
s_nop 0
buffer_store_dword v252, v11, s[88:91], 0 offen sc1
MA 56,v,168,v,116
buffer_load_dwordx4 v191, s[12:15], s21 offen offset:3072 lds
v_lshlrev_b32 v2, 16, v54
MA 88,v,168,v,120
v_and_b32 v3, 0xffff0000, v54
v_lshlrev_b32 v4, 16, v55
MA 120,v,168,v,124
v_and_b32 v5, 0xffff0000, v55
v_lshlrev_b32 v6, 16, v56
MA 152,v,168,v,128
v_and_b32 v7, 0xffff0000, v56
v_lshlrev_b32 v8, 16, v57
MA 184,v,168,v,132
s_add_u32 s21, s21, 524288
v_and_b32 v9, 0xffff0000, v57
MA 216,v,168,v,136
v_lshlrev_b32 v230, 16, v16
v_and_b32 v231, 0xffff0000, v16
MA 248,v,168,v,140
TR 168,202,0
TR 170,202,2048
MA 28,v,172,v,112
v_lshlrev_b32 v232, 16, v18
v_and_b32 v233, 0xffff0000, v18
MA 60,v,172,v,116
s_and_b32 s21, s21, 4194303
v_lshlrev_b32 v234, 16, v20
MA 92,v,172,v,120
v_and_b32 v235, 0xffff0000, v20
v_lshlrev_b32 v236, 16, v22
MA 124,v,172,v,124
v_and_b32 v237, 0xffff0000, v22
v_lshlrev_b32 v238, 16, v24
MA 156,v,172,v,128
v_and_b32 v239, 0xffff0000, v24
v_lshlrev_b32 v240, 16, v26
MA 188,v,172,v,132
v_and_b32 v241, 0xffff0000, v26
v_lshlrev_b32 v242, 16, v28
MA 220,v,172,v,136
v_and_b32 v243, 0xffff0000, v28
v_lshlrev_b32 v244, 16, v30
MA 252,v,172,v,140
TR 172,203,0
TR 174,203,2048
v_and_b32 v245, 0xffff0000, v30
v_lshlrev_b32 v246, 16, v32
v_and_b32 v247, 0xffff0000, v32
v_lshlrev_b32 v248, 16, v34
v_and_b32 v249, 0xffff0000, v34
v_lshlrev_b32 v250, 16, v36
v_and_b32 v251, 0xffff0000, v36
v_lshlrev_b32 v254, 16, v38
v_and_b32 v255, 0xffff0000, v38
v_mul_f32 v62, v236, v2
v_mul_f32 v70, v237, v6
v_fmac_f32 v62, v234, v3
v_fmac_f32 v70, v235, v7
v_fmac_f32 v62, v232, v4
v_fmac_f32 v70, v233, v8
v_fmac_f32 v62, v230, v5
v_fmac_f32 v70, v231, v9
v_mul_f32 v62, v62, v254
s_waitcnt lgkmcnt(2)
MA 0,v,144,v,80
s_add_u32 s75, s64, s74
v_mul_f32 v70, v70, v255
MA 32,v,144,v,84
ds_read_b128 v[112:115], v193 offset:0
v_lshlrev_b32 v254, 16, v40
MA 64,v,144,v,88
v_and_b32 v255, 0xffff0000, v40
v_mul_f32 v63, v238, v2
MA 96,v,144,v,92
v_mul_f32 v71, v239, v6
v_fmac_f32 v63, v236, v3
MA 128,v,144,v,96
s_add_u32 m0, s67, 65536
v_fmac_f32 v71, v237, v7
MA 160,v,144,v,100
v_fmac_f32 v63, v234, v4
MA 192,v,144,v,104
v_fmac_f32 v71, v235, v8
MA 224,v,144,v,108
TR 144,196,16384
TR 146,196,18432
MA 4,v,148,v,80
ds_read_b128 v[116:119], v193 offset:2048
buffer_load_dwordx4 v208, s[44:47], s75 offen offset:0 lds
MA 36,v,148,v,84
v_fmac_f32 v63, v232, v5
v_fmac_f32 v71, v233, v9
MA 68,v,148,v,88
v_mul_f32 v63, v63, v254
v_mul_f32 v71, v71, v255
MA 100,v,148,v,92
v_lshlrev_b32 v254, 16, v42
v_and_b32 v255, 0xffff0000, v42
MA 132,v,148,v,96
v_mul_f32 v64, v240, v2
v_mul_f32 v72, v241, v6
MA 164,v,148,v,100
ds_read_b128 v[120:123], v193 offset:4096
buffer_load_dwordx4 v209, s[44:47], s75 offen offset:1024 lds
MA 196,v,148,v,104
v_fmac_f32 v64, v238, v3
v_fmac_f32 v72, v239, v7
MA 228,v,148,v,108
TR 148,197,16384
TR 150,197,18432
MA 8,v,152,v,80
v_fmac_f32 v64, v236, v4
v_fmac_f32 v72, v237, v8
MA 40,v,152,v,84
buffer_load_dwordx4 v210, s[44:47], s75 offen offset:2048 lds
v_fmac_f32 v64, v234, v5
MA 72,v,152,v,88
v_fmac_f32 v72, v235, v9
v_mul_f32 v64, v64, v254
MA 104,v,152,v,92
v_mul_f32 v72, v72, v255
v_lshlrev_b32 v254, 16, v44
MA 136,v,152,v,96
ds_read_b128 v[124:127], v193 offset:6144
v_and_b32 v255, 0xffff0000, v44
MA 168,v,152,v,100
v_mul_f32 v65, v242, v2
MA 200,v,152,v,104
buffer_load_dwordx4 v211, s[44:47], s75 offen offset:3072 lds
v_mul_f32 v73, v243, v6
MA 232,v,152,v,108
TR 152,198,16384
TR 154,198,18432
MA 12,v,156,v,80
v_fmac_f32 v65, v240, v3
v_fmac_f32 v73, v241, v7
MA 44,v,156,v,84
v_fmac_f32 v65, v238, v4
v_fmac_f32 v73, v239, v8
MA 76,v,156,v,88
ds_read_b128 v[128:131], v193 offset:8192
s_add_u32 s75, s65, s74
MA 108,v,156,v,92
v_fmac_f32 v65, v236, v5
v_fmac_f32 v73, v237, v9
MA 140,v,156,v,96
v_mul_f32 v65, v65, v254
v_mul_f32 v73, v73, v255
MA 172,v,156,v,100
v_lshlrev_b32 v254, 16, v46
MA 204,v,156,v,104
v_and_b32 v255, 0xffff0000, v46
MA 236,v,156,v,108
TR 156,199,16384
TR 158,199,18432
MA 16,v,160,v,80
ds_read_b128 v[132:135], v193 offset:10240
s_add_u32 m0, s67, 69632
MA 48,v,160,v,84
v_mul_f32 v66, v244, v2
v_mul_f32 v74, v245, v6
MA 80,v,160,v,88
v_fmac_f32 v66, v242, v3
v_fmac_f32 v74, v243, v7
MA 112,v,160,v,92
buffer_load_dwordx4 v208, s[44:47], s75 offen offset:0 lds
v_fmac_f32 v66, v240, v4
MA 144,v,160,v,96
v_fmac_f32 v74, v241, v8
v_fmac_f32 v66, v238, v5
MA 176,v,160,v,100
v_fmac_f32 v74, v239, v9
v_mul_f32 v66, v66, v254
MA 208,v,160,v,104
v_mul_f32 v74, v74, v255
v_lshlrev_b32 v254, 16, v48
MA 240,v,160,v,108
TR 160,200,16384
TR 162,200,18432
MA 20,v,164,v,80
ds_read_b128 v[136:139], v193 offset:12288
buffer_load_dwordx4 v209, s[44:47], s75 offen offset:1024 lds
MA 52,v,164,v,84
v_and_b32 v255, 0xffff0000, v48
v_mul_f32 v67, v246, v2
MA 84,v,164,v,88
v_mul_f32 v75, v247, v6
v_fmac_f32 v67, v244, v3
MA 116,v,164,v,92
v_fmac_f32 v75, v245, v7
v_fmac_f32 v67, v242, v4
MA 148,v,164,v,96
buffer_load_dwordx4 v210, s[44:47], s75 offen offset:2048 lds
v_fmac_f32 v75, v243, v8
MA 180,v,164,v,100
ds_read_b128 v[140:143], v193 offset:14336
v_fmac_f32 v67, v240, v5
MA 212,v,164,v,104
v_fmac_f32 v75, v241, v9
v_mul_f32 v67, v67, v254
MA 244,v,164,v,108
TR 164,201,16384
TR 166,201,18432
MA 24,v,168,v,80
buffer_load_dwordx4 v211, s[44:47], s75 offen offset:3072 lds
v_mul_f32 v75, v75, v255
MA 56,v,168,v,84
v_lshlrev_b32 v254, 16, v50
v_and_b32 v255, 0xffff0000, v50
MA 88,v,168,v,88
v_mul_f32 v68, v248, v2
v_mul_f32 v76, v249, v6
MA 120,v,168,v,92
v_fmac_f32 v68, v246, v3
MA 152,v,168,v,96
v_fmac_f32 v76, v247, v7
MA 184,v,168,v,100
s_add_u32 s74, s74, 128
v_fmac_f32 v68, v244, v4
MA 216,v,168,v,104
v_fmac_f32 v76, v245, v8
v_fmac_f32 v68, v242, v5
MA 248,v,168,v,108
TR 168,202,16384
TR 170,202,18432
s_waitcnt lgkmcnt(15)
MA 28,v,172,v,80
v_fmac_f32 v76, v243, v9
v_mul_f32 v68, v68, v254
MA 60,v,172,v,84
s_and_b32 s74, s74, 2047
v_mul_f32 v76, v76, v255
MA 92,v,172,v,88
v_lshlrev_b32 v254, 16, v52
v_and_b32 v255, 0xffff0000, v52
MA 124,v,172,v,92
v_mul_f32 v69, v250, v2
MA 156,v,172,v,96
v_mul_f32 v77, v251, v6
MA 188,v,172,v,100
v_fmac_f32 v69, v248, v3
MA 220,v,172,v,104
MA 252,v,172,v,108
TR 172,203,16384
TR 174,203,18432
s_waitcnt lgkmcnt(2)
MA 0,v,144,v,112
MA 32,v,144,v,116
MA 64,v,144,v,120
MA 96,v,144,v,124
MA 128,v,144,v,128
MA 160,v,144,v,132
MA 192,v,144,v,136
MA 224,v,144,v,140
MA 4,v,148,v,112
MA 36,v,148,v,116
s_waitcnt vmcnt(8) lgkmcnt(0)
s_barrier
MA 68,v,148,v,120
TR 144,196,32768
TR 146,196,34816
MA 100,v,148,v,124
ds_read_b128 v[80:83], v192 offset:32768
s_add_u32 m0, s68, 98304
MA 132,v,148,v,128
v_fmac_f32 v77, v249, v7
v_fmac_f32 v69, v246, v4
MA 164,v,148,v,132
buffer_load_dwordx4 v212, s[48:51], s66 offen offset:0 lds
v_fmac_f32 v77, v247, v8
MA 196,v,148,v,136
v_fmac_f32 v69, v244, v5
v_fmac_f32 v77, v245, v9
MA 228,v,148,v,140
TR 148,197,32768
TR 150,197,34816
MA 8,v,152,v,112
ds_read_b128 v[84:87], v192 offset:34816
v_mul_f32 v69, v69, v254
MA 40,v,152,v,116
buffer_load_dwordx4 v213, s[48:51], s66 offen offset:1024 lds
v_mul_f32 v77, v77, v255
MA 72,v,152,v,120
v_cvt_pk_bf16_f32 v12, v69, v68
v_cvt_pk_bf16_f32 v13, v67, v66
MA 104,v,152,v,124
v_cvt_pk_bf16_f32 v14, v65, v64
v_cvt_pk_bf16_f32 v15, v63, v62
MA 136,v,152,v,128
s_mov_b32 s36, 0
buffer_store_dwordx4 v[12:15], v10, s[84:87], s36 offen sc1
MA 168,v,152,v,132
ds_read_b128 v[88:91], v192 offset:36864
buffer_load_dwordx4 v214, s[48:51], s66 offen offset:2048 lds
MA 200,v,152,v,136
v_cvt_pk_bf16_f32 v54, v77, v76
v_cvt_pk_bf16_f32 v55, v75, v74
MA 232,v,152,v,140
TR 152,198,32768
TR 154,198,34816
MA 12,v,156,v,112
buffer_load_dwordx4 v215, s[48:51], s66 offen offset:3072 lds
v_cvt_pk_bf16_f32 v56, v73, v72
MA 44,v,156,v,116
v_cvt_pk_bf16_f32 v57, v71, v70
s_mov_b32 s36, 4096
MA 76,v,156,v,120
ds_read_b128 v[92:95], v192 offset:38912
buffer_store_dwordx4 v[54:57], v10, s[84:87], s36 offen sc1
MA 108,v,156,v,124
v_lshlrev_b32 v2, 16, v58
v_and_b32 v3, 0xffff0000, v58
MA 140,v,156,v,128
s_add_u32 s66, s66, 524288
v_lshlrev_b32 v4, 16, v59
MA 172,v,156,v,132
v_and_b32 v5, 0xffff0000, v59
v_lshlrev_b32 v6, 16, v60
MA 204,v,156,v,136
v_and_b32 v7, 0xffff0000, v60
v_lshlrev_b32 v8, 16, v61
MA 236,v,156,v,140
TR 156,199,32768
TR 158,199,34816
MA 16,v,160,v,112
ds_read_b128 v[96:99], v192 offset:40960
s_and_b32 s66, s66, 8388607
MA 48,v,160,v,116
v_and_b32 v9, 0xffff0000, v61
v_lshlrev_b32 v230, 16, v17
MA 80,v,160,v,120
v_and_b32 v231, 0xffff0000, v17
v_lshlrev_b32 v232, 16, v19
MA 112,v,160,v,124
v_and_b32 v233, 0xffff0000, v19
v_lshlrev_b32 v234, 16, v21
MA 144,v,160,v,128
ds_read_b128 v[100:103], v192 offset:43008
s_add_u32 m0, s68, 114688
MA 176,v,160,v,132
v_and_b32 v235, 0xffff0000, v21
v_lshlrev_b32 v236, 16, v23
MA 208,v,160,v,136
v_and_b32 v237, 0xffff0000, v23
v_lshlrev_b32 v238, 16, v25
MA 240,v,160,v,140
TR 160,200,32768
TR 162,200,34816
MA 20,v,164,v,112
buffer_load_dwordx4 v212, s[48:51], s66 offen offset:0 lds
v_and_b32 v239, 0xffff0000, v25
MA 52,v,164,v,116
ds_read_b128 v[104:107], v192 offset:45056
v_lshlrev_b32 v240, 16, v27
MA 84,v,164,v,120
v_and_b32 v241, 0xffff0000, v27
v_lshlrev_b32 v242, 16, v29
MA 116,v,164,v,124
buffer_load_dwordx4 v213, s[48:51], s66 offen offset:1024 lds
v_and_b32 v243, 0xffff0000, v29
MA 148,v,164,v,128
v_lshlrev_b32 v244, 16, v31
v_and_b32 v245, 0xffff0000, v31
MA 180,v,164,v,132
v_lshlrev_b32 v246, 16, v33
v_and_b32 v247, 0xffff0000, v33
MA 212,v,164,v,136
ds_read_b128 v[108:111], v192 offset:47104
v_lshlrev_b32 v248, 16, v35
MA 244,v,164,v,140
TR 164,201,32768
TR 166,201,34816
MA 24,v,168,v,112
buffer_load_dwordx4 v214, s[48:51], s66 offen offset:2048 lds
v_and_b32 v249, 0xffff0000, v35
MA 56,v,168,v,116
v_lshlrev_b32 v250, 16, v37
v_and_b32 v251, 0xffff0000, v37
MA 88,v,168,v,120
buffer_load_dwordx4 v215, s[48:51], s66 offen offset:3072 lds
v_lshlrev_b32 v254, 16, v39
MA 120,v,168,v,124
v_and_b32 v255, 0xffff0000, v39
v_mul_f32 v62, v236, v2
MA 152,v,168,v,128
v_mul_f32 v70, v237, v6
v_fmac_f32 v62, v234, v3
MA 184,v,168,v,132
v_fmac_f32 v70, v235, v7
v_fmac_f32 v62, v232, v4
MA 216,v,168,v,136
s_add_u32 s66, s66, 524288
v_fmac_f32 v70, v233, v8
MA 248,v,168,v,140
TR 168,202,32768
TR 170,202,34816
MA 28,v,172,v,112
v_fmac_f32 v62, v230, v5
v_fmac_f32 v70, v231, v9
MA 60,v,172,v,116
v_mul_f32 v62, v62, v254
v_mul_f32 v70, v70, v255
MA 92,v,172,v,120
s_and_b32 s66, s66, 8388607
v_lshlrev_b32 v254, 16, v41
MA 124,v,172,v,124
v_and_b32 v255, 0xffff0000, v41
v_mul_f32 v63, v238, v2
MA 156,v,172,v,128
v_mul_f32 v71, v239, v6
v_fmac_f32 v63, v236, v3
MA 188,v,172,v,132
v_fmac_f32 v71, v237, v7
v_fmac_f32 v63, v234, v4
MA 220,v,172,v,136
v_fmac_f32 v71, v235, v8
v_fmac_f32 v63, v232, v5
MA 252,v,172,v,140
TR 172,203,32768
TR 174,203,34816
v_fmac_f32 v71, v233, v9
v_mul_f32 v63, v63, v254
v_mul_f32 v71, v71, v255
v_lshlrev_b32 v254, 16, v43
v_and_b32 v255, 0xffff0000, v43
v_mul_f32 v64, v240, v2
v_mul_f32 v72, v241, v6
v_fmac_f32 v64, v238, v3
s_waitcnt lgkmcnt(2)
MA 0,v,144,v,80
s_add_u32 s75, s64, s74
v_fmac_f32 v72, v239, v7
MA 32,v,144,v,84
ds_read_b128 v[112:115], v193 offset:32768
v_fmac_f32 v64, v236, v4
MA 64,v,144,v,88
v_fmac_f32 v72, v237, v8
v_fmac_f32 v64, v234, v5
MA 96,v,144,v,92
v_fmac_f32 v72, v235, v9
v_mul_f32 v64, v64, v254
MA 128,v,144,v,96
s_add_u32 m0, s67, 0
v_mul_f32 v72, v72, v255
MA 160,v,144,v,100
v_lshlrev_b32 v254, 16, v45
MA 192,v,144,v,104
v_and_b32 v255, 0xffff0000, v45
v_mul_f32 v65, v242, v2
MA 224,v,144,v,108
TR 144,196,49152
TR 146,196,51200
MA 4,v,148,v,80
ds_read_b128 v[116:119], v193 offset:34816
buffer_load_dwordx4 v208, s[44:47], s75 offen offset:0 lds
MA 36,v,148,v,84
v_mul_f32 v73, v243, v6
v_fmac_f32 v65, v240, v3
MA 68,v,148,v,88
v_fmac_f32 v73, v241, v7
v_fmac_f32 v65, v238, v4
MA 100,v,148,v,92
v_fmac_f32 v73, v239, v8
v_fmac_f32 v65, v236, v5
MA 132,v,148,v,96
v_fmac_f32 v73, v237, v9
MA 164,v,148,v,100
ds_read_b128 v[120:123], v193 offset:36864
buffer_load_dwordx4 v209, s[44:47], s75 offen offset:1024 lds
MA 196,v,148,v,104
v_mul_f32 v65, v65, v254
v_mul_f32 v73, v73, v255
MA 228,v,148,v,108
TR 148,197,49152
TR 150,197,51200
MA 8,v,152,v,80
v_lshlrev_b32 v254, 16, v47
v_and_b32 v255, 0xffff0000, v47
MA 40,v,152,v,84
buffer_load_dwordx4 v210, s[44:47], s75 offen offset:2048 lds
v_mul_f32 v66, v244, v2
MA 72,v,152,v,88
v_mul_f32 v74, v245, v6
v_fmac_f32 v66, v242, v3
MA 104,v,152,v,92
v_fmac_f32 v74, v243, v7
v_fmac_f32 v66, v240, v4
MA 136,v,152,v,96
ds_read_b128 v[124:127], v193 offset:38912
v_fmac_f32 v74, v241, v8
MA 168,v,152,v,100
v_fmac_f32 v66, v238, v5
v_fmac_f32 v74, v239, v9
MA 200,v,152,v,104
buffer_load_dwordx4 v211, s[44:47], s75 offen offset:3072 lds
v_mul_f32 v66, v66, v254
MA 232,v,152,v,108
TR 152,198,49152
TR 154,198,51200
MA 12,v,156,v,80
v_mul_f32 v74, v74, v255
v_lshlrev_b32 v254, 16, v49
MA 44,v,156,v,84
v_and_b32 v255, 0xffff0000, v49
v_mul_f32 v67, v246, v2
MA 76,v,156,v,88
ds_read_b128 v[128:131], v193 offset:40960
s_add_u32 s75, s65, s74
MA 108,v,156,v,92
v_mul_f32 v75, v247, v6
v_fmac_f32 v67, v244, v3
MA 140,v,156,v,96
v_fmac_f32 v75, v245, v7
v_fmac_f32 v67, v242, v4
MA 172,v,156,v,100
v_fmac_f32 v75, v243, v8
MA 204,v,156,v,104
v_fmac_f32 v67, v240, v5
MA 236,v,156,v,108
TR 156,199,49152
TR 158,199,51200
MA 16,v,160,v,80
ds_read_b128 v[132:135], v193 offset:43008
s_add_u32 m0, s67, 4096
MA 48,v,160,v,84
v_fmac_f32 v75, v241, v9
v_mul_f32 v67, v67, v254
MA 80,v,160,v,88
v_mul_f32 v75, v75, v255
v_lshlrev_b32 v254, 16, v51
MA 112,v,160,v,92
buffer_load_dwordx4 v208, s[44:47], s75 offen offset:0 lds
v_and_b32 v255, 0xffff0000, v51
MA 144,v,160,v,96
v_mul_f32 v68, v248, v2
v_mul_f32 v76, v249, v6
MA 176,v,160,v,100
v_fmac_f32 v68, v246, v3
v_fmac_f32 v76, v247, v7
MA 208,v,160,v,104
v_fmac_f32 v68, v244, v4
v_fmac_f32 v76, v245, v8
MA 240,v,160,v,108
TR 160,200,49152
TR 162,200,51200
MA 20,v,164,v,80
ds_read_b128 v[136:139], v193 offset:45056
buffer_load_dwordx4 v209, s[44:47], s75 offen offset:1024 lds
MA 52,v,164,v,84
v_fmac_f32 v68, v242, v5
v_fmac_f32 v76, v243, v9
MA 84,v,164,v,88
v_mul_f32 v68, v68, v254
v_mul_f32 v76, v76, v255
MA 116,v,164,v,92
v_lshlrev_b32 v254, 16, v53
v_and_b32 v255, 0xffff0000, v53
MA 148,v,164,v,96
buffer_load_dwordx4 v210, s[44:47], s75 offen offset:2048 lds
v_mul_f32 v69, v250, v2
MA 180,v,164,v,100
ds_read_b128 v[140:143], v193 offset:47104
v_mul_f32 v77, v251, v6
MA 212,v,164,v,104
v_fmac_f32 v69, v248, v3
v_fmac_f32 v77, v249, v7
MA 244,v,164,v,108
TR 164,201,49152
TR 166,201,51200
MA 24,v,168,v,80
buffer_load_dwordx4 v211, s[44:47], s75 offen offset:3072 lds
v_fmac_f32 v69, v246, v4
MA 56,v,168,v,84
v_fmac_f32 v77, v247, v8
v_fmac_f32 v69, v244, v5
MA 88,v,168,v,88
v_fmac_f32 v77, v245, v9
v_mul_f32 v69, v69, v254
MA 120,v,168,v,92
v_mul_f32 v77, v77, v255
v_cvt_pk_bf16_f32 v230, v69, v68
MA 152,v,168,v,96
v_cvt_pk_bf16_f32 v231, v67, v66
MA 184,v,168,v,100
s_add_u32 s74, s74, 128
v_cvt_pk_bf16_f32 v232, v65, v64
MA 216,v,168,v,104
v_cvt_pk_bf16_f32 v233, v63, v62
MA 248,v,168,v,108
TR 168,202,49152
TR 170,202,51200
s_waitcnt lgkmcnt(15)
MA 28,v,172,v,80
s_mov_b32 s36, 8192
buffer_store_dwordx4 v[230:233], v10, s[84:87], s36 offen sc1
MA 60,v,172,v,84
s_and_b32 s74, s74, 2047
v_cvt_pk_bf16_f32 v234, v77, v76
MA 92,v,172,v,88
v_cvt_pk_bf16_f32 v235, v75, v74
v_cvt_pk_bf16_f32 v236, v73, v72
MA 124,v,172,v,92
v_cvt_pk_bf16_f32 v237, v71, v70
s_mov_b32 s36, 12288
MA 156,v,172,v,96
buffer_store_dwordx4 v[234:237], v10, s[84:87], s36 offen sc1
MA 188,v,172,v,100
v_lshlrev_b32 v228, 4, v1
MA 220,v,172,v,104
MA 252,v,172,v,108
TR 172,203,49152
TR 174,203,51200
s_waitcnt lgkmcnt(2)
MA 0,v,144,v,112
MA 32,v,144,v,116
MA 64,v,144,v,120
MA 96,v,144,v,124
MA 128,v,144,v,128
MA 160,v,144,v,132
MA 192,v,144,v,136
MA 224,v,144,v,140
MA 4,v,148,v,112
MA 36,v,148,v,116
s_waitcnt vmcnt(15) lgkmcnt(0)
s_barrier
MA 68,v,148,v,120
ds_read_b128 v[48:51], v226 offset:0
s_add_u32 m0, s68, 131072
MA 100,v,148,v,124
MA 132,v,148,v,128
ds_read_b128 v[52:55], v226 offset:2048
buffer_load_dwordx4 v212, s[48:51], s66 offen offset:0 lds
MA 164,v,148,v,132
MA 196,v,148,v,136
ds_read_b128 v[56:59], v226 offset:4096
buffer_load_dwordx4 v213, s[48:51], s66 offen offset:1024 lds
MA 228,v,148,v,140
MA 8,v,152,v,112
ds_read_b128 v[60:63], v226 offset:6144
MA 40,v,152,v,116
buffer_load_dwordx4 v214, s[48:51], s66 offen offset:2048 lds
MA 72,v,152,v,120
TR 16,216,0
MA 104,v,152,v,124
buffer_load_dwordx4 v215, s[48:51], s66 offen offset:3072 lds
MA 136,v,152,v,128
TR 18,216,1024
MA 168,v,152,v,132
MA 200,v,152,v,136
TR 20,217,0
s_add_u32 s66, s66, 524288
MA 232,v,152,v,140
MA 12,v,156,v,112
TR 22,217,1024
s_and_b32 s66, s66, 8388607
MA 44,v,156,v,116
MA 76,v,156,v,120
TR 24,218,0
MA 108,v,156,v,124
s_add_u32 s75, s64, s74
MA 140,v,156,v,128
TR 26,218,1024
MA 172,v,156,v,132
s_add_u32 m0, s67, 32768
MA 204,v,156,v,136
TR 28,219,0
MA 236,v,156,v,140
MA 16,v,160,v,112
TR 30,219,1024
buffer_load_dwordx4 v208, s[44:47], s75 offen offset:0 lds
MA 48,v,160,v,116
MA 80,v,160,v,120
TR 32,220,0
buffer_load_dwordx4 v209, s[44:47], s75 offen offset:1024 lds
MA 112,v,160,v,124
MA 144,v,160,v,128
TR 34,220,1024
MA 176,v,160,v,132
buffer_load_dwordx4 v210, s[44:47], s75 offen offset:2048 lds
MA 208,v,160,v,136
TR 36,221,0
MA 240,v,160,v,140
buffer_load_dwordx4 v211, s[44:47], s75 offen offset:3072 lds
MA 20,v,164,v,112
TR 38,221,1024
MA 52,v,164,v,116
MA 84,v,164,v,120
TR 40,222,0
s_add_u32 s75, s65, s74
MA 116,v,164,v,124
MA 148,v,164,v,128
TR 42,222,1024
s_add_u32 m0, s67, 36864
MA 180,v,164,v,132
MA 212,v,164,v,136
TR 44,223,0
MA 244,v,164,v,140
buffer_load_dwordx4 v208, s[44:47], s75 offen offset:0 lds
MA 24,v,168,v,112
TR 46,223,1024
MA 56,v,168,v,116
buffer_load_dwordx4 v209, s[44:47], s75 offen offset:1024 lds
MA 88,v,168,v,120
MA 120,v,168,v,124
MA 152,v,168,v,128
buffer_load_dwordx4 v210, s[44:47], s75 offen offset:2048 lds
MA 184,v,168,v,132
MA 216,v,168,v,136
buffer_load_dwordx4 v211, s[44:47], s75 offen offset:3072 lds
MA 248,v,168,v,140
MA 28,v,172,v,112
MA 60,v,172,v,116
s_add_u32 s74, s74, 128
MA 92,v,172,v,120
MA 124,v,172,v,124
s_and_b32 s74, s74, 2047
MA 156,v,172,v,128
MA 188,v,172,v,132
MA 220,v,172,v,136
MA 252,v,172,v,140
s_branch L_p2
L_p1_V:
s_waitcnt lgkmcnt(14)
v_mfma_f32_16x16x32_bf16 a[0:3], v[80:83], v[144:147], 0
s_add_u32 m0, s23, 32768
v_lshlrev_b32 v74, 7, v1
v_mfma_f32_16x16x32_bf16 a[4:7], v[84:87], v[144:147], 0
ds_read_b128 v[112:115], v193 offset:0
v_mfma_f32_16x16x32_bf16 a[64:67], v[88:91], v[144:147], 0
buffer_load_dwordx4 v184, s[12:15], s21 offen offset:0 lds
v_mfma_f32_16x16x32_bf16 a[68:71], v[92:95], v[144:147], 0
v_mfma_f32_16x16x32_bf16 a[128:131], v[96:99], v[144:147], 0
s_getpc_b64 s[4:5]
L_pcV:
v_mfma_f32_16x16x32_bf16 a[132:135], v[100:103], v[144:147], 0
buffer_load_dwordx4 v185, s[12:15], s21 offen offset:1024 lds
v_mfma_f32_16x16x32_bf16 a[192:195], v[104:107], v[144:147], 0
v_mfma_f32_16x16x32_bf16 a[196:199], v[108:111], v[144:147], 0
TR 144,196,16384
TR 146,196,18432
s_waitcnt lgkmcnt(15)
v_mfma_f32_16x16x32_bf16 a[8:11], v[80:83], v[148:151], 0
ds_read_b128 v[116:119], v193 offset:2048
buffer_load_dwordx4 v186, s[12:15], s21 offen offset:2048 lds
v_mfma_f32_16x16x32_bf16 a[12:15], v[84:87], v[148:151], 0
s_lshr_b32 s98, s2, 3
v_mfma_f32_16x16x32_bf16 a[72:75], v[88:91], v[148:151], 0
buffer_load_dwordx4 v187, s[12:15], s21 offen offset:3072 lds
v_mfma_f32_16x16x32_bf16 a[76:79], v[92:95], v[148:151], 0
v_mfma_f32_16x16x32_bf16 a[136:139], v[96:99], v[148:151], 0
s_add_u32 m0, s23, 36864
s_lshl_b32 s98, s98, 2
v_mfma_f32_16x16x32_bf16 a[140:143], v[100:103], v[148:151], 0
ds_read_b128 v[120:123], v193 offset:4096
v_mfma_f32_16x16x32_bf16 a[200:203], v[104:107], v[148:151], 0
v_mfma_f32_16x16x32_bf16 a[204:207], v[108:111], v[148:151], 0
TR 148,197,16384
TR 150,197,18432
s_waitcnt lgkmcnt(15)
v_mfma_f32_16x16x32_bf16 a[16:19], v[80:83], v[152:155], 0
buffer_load_dwordx4 v188, s[12:15], s21 offen offset:0 lds
s_add_u32 s98, s98, s3
v_mfma_f32_16x16x32_bf16 a[20:23], v[84:87], v[152:155], 0
v_mfma_f32_16x16x32_bf16 a[80:83], v[88:91], v[152:155], 0
buffer_load_dwordx4 v189, s[12:15], s21 offen offset:1024 lds
v_mfma_f32_16x16x32_bf16 a[84:87], v[92:95], v[152:155], 0
v_mfma_f32_16x16x32_bf16 a[144:147], v[96:99], v[152:155], 0
ds_read_b128 v[124:127], v193 offset:6144
buffer_load_dwordx4 v190, s[12:15], s21 offen offset:2048 lds
v_mfma_f32_16x16x32_bf16 a[148:151], v[100:103], v[152:155], 0
s_lshl_b32 s98, s98, 10
v_mfma_f32_16x16x32_bf16 a[208:211], v[104:107], v[152:155], 0
v_mfma_f32_16x16x32_bf16 a[212:215], v[108:111], v[152:155], 0
TR 152,198,16384
TR 154,198,18432
v_mfma_f32_16x16x32_bf16 a[24:27], v[80:83], v[156:159], 0
buffer_load_dwordx4 v191, s[12:15], s21 offen offset:3072 lds
v_and_b32 v75, 0x380, v74
v_mfma_f32_16x16x32_bf16 a[28:31], v[84:87], v[156:159], 0
s_add_u32 s21, s21, 524288
v_mfma_f32_16x16x32_bf16 a[88:91], v[88:91], v[156:159], 0
ds_read_b128 v[128:131], v193 offset:8192
v_mfma_f32_16x16x32_bf16 a[92:95], v[92:95], v[156:159], 0
v_mfma_f32_16x16x32_bf16 a[152:155], v[96:99], v[156:159], 0
s_and_b32 s21, s21, 4194303
v_add_u32 v75, s98, v75
v_mfma_f32_16x16x32_bf16 a[156:159], v[100:103], v[156:159], 0
v_mfma_f32_16x16x32_bf16 a[216:219], v[104:107], v[156:159], 0
v_mfma_f32_16x16x32_bf16 a[220:223], v[108:111], v[156:159], 0
TR 156,199,16384
TR 158,199,18432
s_waitcnt lgkmcnt(15)
v_mfma_f32_16x16x32_bf16 a[32:35], v[80:83], v[160:163], 0
ds_read_b128 v[132:135], v193 offset:10240
s_add_u32 m0, s22, 32768
v_mfma_f32_16x16x32_bf16 a[36:39], v[84:87], v[160:163], 0
buffer_load_dwordx4 v176, s[8:11], s20 offen offset:0 lds
v_min_u32 v75, L_code_end - L_pcV - 4, v75
v_mfma_f32_16x16x32_bf16 a[96:99], v[88:91], v[160:163], 0
v_mfma_f32_16x16x32_bf16 a[100:103], v[92:95], v[160:163], 0
v_mfma_f32_16x16x32_bf16 a[160:163], v[96:99], v[160:163], 0
buffer_load_dwordx4 v177, s[8:11], s20 offen offset:1024 lds
v_mfma_f32_16x16x32_bf16 a[164:167], v[100:103], v[160:163], 0
v_mov_b32 v77, s5
v_mfma_f32_16x16x32_bf16 a[224:227], v[104:107], v[160:163], 0
buffer_load_dwordx4 v178, s[8:11], s20 offen offset:2048 lds
v_mfma_f32_16x16x32_bf16 a[228:231], v[108:111], v[160:163], 0
TR 160,200,16384
TR 162,200,18432
v_mfma_f32_16x16x32_bf16 a[40:43], v[80:83], v[164:167], 0
ds_read_b128 v[136:139], v193 offset:12288
v_mfma_f32_16x16x32_bf16 a[44:47], v[84:87], v[164:167], 0
buffer_load_dwordx4 v179, s[8:11], s20 offen offset:3072 lds
v_mfma_f32_16x16x32_bf16 a[104:107], v[88:91], v[164:167], 0
v_add_co_u32 v76, vcc, s4, v75
s_nop 1
v_addc_co_u32 v77, vcc, 0, v77, vcc
v_mfma_f32_16x16x32_bf16 a[108:111], v[92:95], v[164:167], 0
s_add_u32 m0, s22, 36864
v_mfma_f32_16x16x32_bf16 a[168:171], v[96:99], v[164:167], 0
v_mfma_f32_16x16x32_bf16 a[172:175], v[100:103], v[164:167], 0
ds_read_b128 v[140:143], v193 offset:14336
v_mfma_f32_16x16x32_bf16 a[232:235], v[104:107], v[164:167], 0
buffer_load_dwordx4 v180, s[8:11], s20 offen offset:0 lds
v_mfma_f32_16x16x32_bf16 a[236:239], v[108:111], v[164:167], 0
TR 164,201,16384
TR 166,201,18432
v_mfma_f32_16x16x32_bf16 a[48:51], v[80:83], v[168:171], 0
v_mfma_f32_16x16x32_bf16 a[52:55], v[84:87], v[168:171], 0
buffer_load_dwordx4 v181, s[8:11], s20 offen offset:1024 lds
v_mfma_f32_16x16x32_bf16 a[112:115], v[88:91], v[168:171], 0
v_mfma_f32_16x16x32_bf16 a[116:119], v[92:95], v[168:171], 0
buffer_load_dwordx4 v182, s[8:11], s20 offen offset:2048 lds
v_mfma_f32_16x16x32_bf16 a[176:179], v[96:99], v[168:171], 0
v_mfma_f32_16x16x32_bf16 a[180:183], v[100:103], v[168:171], 0
v_mfma_f32_16x16x32_bf16 a[240:243], v[104:107], v[168:171], 0
buffer_load_dwordx4 v183, s[8:11], s20 offen offset:3072 lds
v_mfma_f32_16x16x32_bf16 a[244:247], v[108:111], v[168:171], 0
TR 168,202,16384
TR 170,202,18432
s_waitcnt lgkmcnt(15)
v_mfma_f32_16x16x32_bf16 a[56:59], v[80:83], v[172:175], 0
s_add_u32 s20, s20, 128
v_mfma_f32_16x16x32_bf16 a[60:63], v[84:87], v[172:175], 0
global_load_dword v79, v[76:77], off
v_mfma_f32_16x16x32_bf16 a[120:123], v[88:91], v[172:175], 0
v_mfma_f32_16x16x32_bf16 a[124:127], v[92:95], v[172:175], 0
s_and_b32 s20, s20, 1023
v_mfma_f32_16x16x32_bf16 a[184:187], v[96:99], v[172:175], 0
v_mfma_f32_16x16x32_bf16 a[188:191], v[100:103], v[172:175], 0
v_mfma_f32_16x16x32_bf16 a[248:251], v[104:107], v[172:175], 0
v_mfma_f32_16x16x32_bf16 a[252:255], v[108:111], v[172:175], 0
TR 172,203,16384
TR 174,203,18432
s_waitcnt lgkmcnt(2)
MA 0,v,112,v,144
s_add_u32 m0, s22, 65536
MA 4,v,116,v,144
MA 64,v,120,v,144
MA 68,v,124,v,144
buffer_load_dwordx4 v176, s[8:11], s20 offen offset:0 lds
MA 128,v,128,v,144
MA 132,v,132,v,144
MA 192,v,136,v,144
MA 196,v,140,v,144
buffer_load_dwordx4 v177, s[8:11], s20 offen offset:1024 lds
MA 8,v,112,v,148
MA 12,v,116,v,148
MA 72,v,120,v,148
buffer_load_dwordx4 v178, s[8:11], s20 offen offset:2048 lds
MA 76,v,124,v,148
MA 136,v,128,v,148
MA 140,v,132,v,148
MA 200,v,136,v,148
buffer_load_dwordx4 v179, s[8:11], s20 offen offset:3072 lds
MA 204,v,140,v,148
MA 16,v,112,v,152
MA 20,v,116,v,152
s_add_u32 m0, s22, 69632
MA 80,v,120,v,152
MA 84,v,124,v,152
MA 144,v,128,v,152
MA 148,v,132,v,152
buffer_load_dwordx4 v180, s[8:11], s20 offen offset:0 lds
MA 208,v,136,v,152
MA 212,v,140,v,152
MA 24,v,112,v,156
MA 28,v,116,v,156
buffer_load_dwordx4 v181, s[8:11], s20 offen offset:1024 lds
MA 88,v,120,v,156
MA 92,v,124,v,156
MA 152,v,128,v,156
buffer_load_dwordx4 v182, s[8:11], s20 offen offset:2048 lds
MA 156,v,132,v,156
MA 216,v,136,v,156
MA 220,v,140,v,156
MA 32,v,112,v,160
buffer_load_dwordx4 v183, s[8:11], s20 offen offset:3072 lds
MA 36,v,116,v,160
MA 96,v,120,v,160
MA 100,v,124,v,160
s_add_u32 s20, s20, 128
MA 160,v,128,v,160
MA 164,v,132,v,160
MA 224,v,136,v,160
MA 228,v,140,v,160
s_and_b32 s20, s20, 1023
MA 40,v,112,v,164
MA 44,v,116,v,164
MA 104,v,120,v,164
MA 108,v,124,v,164
MA 168,v,128,v,164
s_waitcnt vmcnt(9) lgkmcnt(0)
s_barrier
MA 172,v,132,v,164
TR 144,196,32768
TR 146,196,34816
MA 232,v,136,v,164
ds_read_b128 v[80:83], v192 offset:32768
s_add_u32 m0, s23, 0
MA 236,v,140,v,164
TR 148,197,32768
TR 150,197,34816
MA 48,v,112,v,168
ds_read_b128 v[84:87], v192 offset:34816
ds_read_b128 v[88:91], v192 offset:36864
MA 52,v,116,v,168
TR 152,198,32768
TR 154,198,34816
MA 112,v,120,v,168
ds_read_b128 v[92:95], v192 offset:38912
ds_read_b128 v[96:99], v192 offset:40960
MA 116,v,124,v,168
TR 156,199,32768
TR 158,199,34816
MA 176,v,128,v,168
ds_read_b128 v[100:103], v192 offset:43008
ds_read_b128 v[104:107], v192 offset:45056
MA 180,v,132,v,168
TR 160,200,32768
TR 162,200,34816
MA 240,v,136,v,168
ds_read_b128 v[108:111], v192 offset:47104
buffer_load_dwordx4 v184, s[12:15], s21 offen offset:0 lds
MA 244,v,140,v,168
TR 164,201,32768
TR 166,201,34816
MA 56,v,112,v,172
buffer_load_dwordx4 v185, s[12:15], s21 offen offset:1024 lds
buffer_load_dwordx4 v186, s[12:15], s21 offen offset:2048 lds
MA 60,v,116,v,172
TR 168,202,32768
TR 170,202,34816
MA 120,v,120,v,172
buffer_load_dwordx4 v187, s[12:15], s21 offen offset:3072 lds
s_add_u32 m0, s23, 4096
MA 124,v,124,v,172
buffer_load_dwordx4 v188, s[12:15], s21 offen offset:0 lds
buffer_load_dwordx4 v189, s[12:15], s21 offen offset:1024 lds
MA 184,v,128,v,172
buffer_load_dwordx4 v190, s[12:15], s21 offen offset:2048 lds
buffer_load_dwordx4 v191, s[12:15], s21 offen offset:3072 lds
MA 188,v,132,v,172
s_add_u32 s21, s21, 524288
s_and_b32 s21, s21, 4194303
MA 248,v,136,v,172
s_load_dwordx2 s[84:85], s[0:1], 8
s_load_dwordx2 s[88:89], s[0:1], 16
MA 252,v,140,v,172
TR 172,203,32768
TR 174,203,34816
s_load_dwordx2 s[92:93], s[0:1], 0
s_load_dwordx2 s[96:97], s[0:1], 24
s_load_dwordx2 s[76:77], s[0:1], 96
s_waitcnt lgkmcnt(2)
MA 0,v,80,v,144
s_add_u32 m0, s22, 0
MA 4,v,84,v,144
ds_read_b128 v[112:115], v193 offset:32768
MA 64,v,88,v,144
s_mov_b32 s4, s34
s_mov_b32 s5, s35
MA 68,v,92,v,144
MA 128,v,96,v,144
MA 132,v,100,v,144
buffer_load_dwordx4 v176, s[8:11], s20 offen offset:0 lds
MA 192,v,104,v,144
MA 196,v,108,v,144
TR 144,196,49152
TR 146,196,51200
MA 8,v,80,v,148
ds_read_b128 v[116:119], v193 offset:34816
MA 12,v,84,v,148
s_mov_b32 s6, 8388608
s_mov_b32 s7, 0x20000
MA 72,v,88,v,148
buffer_load_dwordx4 v177, s[8:11], s20 offen offset:1024 lds
MA 76,v,92,v,148
MA 136,v,96,v,148
MA 140,v,100,v,148
ds_read_b128 v[120:123], v193 offset:36864
MA 200,v,104,v,148
MA 204,v,108,v,148
TR 148,197,49152
TR 150,197,51200
MA 16,v,80,v,152
buffer_load_dwordx4 v178, s[8:11], s20 offen offset:2048 lds
s_lshr_b32 s43, s2, 3
MA 20,v,84,v,152
MA 80,v,88,v,152
MA 84,v,92,v,152
s_lshl_b32 s43, s43, 2
MA 144,v,96,v,152
ds_read_b128 v[124:127], v193 offset:38912
buffer_load_dwordx4 v179, s[8:11], s20 offen offset:3072 lds
MA 148,v,100,v,152
MA 208,v,104,v,152
MA 212,v,108,v,152
TR 152,198,49152
TR 154,198,51200
MA 24,v,80,v,156
s_add_u32 s43, s43, s3
MA 28,v,84,v,156
s_add_u32 m0, s22, 4096
MA 88,v,88,v,156
ds_read_b128 v[128:131], v193 offset:40960
MA 92,v,92,v,156
s_lshl_b32 s43, s43, 16
MA 152,v,96,v,156
MA 156,v,100,v,156
MA 216,v,104,v,156
MA 220,v,108,v,156
TR 156,199,49152
TR 158,199,51200
MA 32,v,80,v,160
ds_read_b128 v[132:135], v193 offset:43008
buffer_load_dwordx4 v180, s[8:11], s20 offen offset:0 lds
MA 36,v,84,v,160
s_and_b32 s37, s2, 7
MA 96,v,88,v,160
s_lshl_b32 s37, s37, 10
MA 100,v,92,v,160
MA 160,v,96,v,160
buffer_load_dwordx4 v181, s[8:11], s20 offen offset:1024 lds
MA 164,v,100,v,160
MA 224,v,104,v,160
s_add_u32 s43, s43, s37
MA 228,v,108,v,160
TR 160,200,49152
TR 162,200,51200
MA 40,v,80,v,164
ds_read_b128 v[136:139], v193 offset:45056
MA 44,v,84,v,164
buffer_load_dwordx4 v182, s[8:11], s20 offen offset:2048 lds
MA 104,v,88,v,164
v_lshrrev_b32 v78, 3, v1
MA 108,v,92,v,164
MA 168,v,96,v,164
MA 172,v,100,v,164
ds_read_b128 v[140:143], v193 offset:47104
MA 232,v,104,v,164
buffer_load_dwordx4 v183, s[8:11], s20 offen offset:3072 lds
s_waitcnt vmcnt(24)
v_and_b32 v79, 7, v1
MA 236,v,108,v,164
TR 164,201,49152
TR 166,201,51200
MA 48,v,80,v,168
MA 52,v,84,v,168
MA 112,v,88,v,168
v_lshlrev_b32 v79, 7, v79
MA 116,v,92,v,168
s_add_u32 s20, s20, 128
MA 176,v,96,v,168
MA 180,v,100,v,168
MA 240,v,104,v,168
v_lshl_add_u32 v78, v78, 13, v79
MA 244,v,108,v,168
TR 168,202,49152
TR 170,202,51200
s_waitcnt lgkmcnt(15)
MA 56,v,80,v,172
s_and_b32 s20, s20, 1023
MA 60,v,84,v,172
MA 120,v,88,v,172
v_add_u32 v78, s43, v78
MA 124,v,92,v,172
MA 184,v,96,v,172
MA 188,v,100,v,172
MA 248,v,104,v,172
MA 252,v,108,v,172
TR 172,203,49152
TR 174,203,51200
s_waitcnt lgkmcnt(2)
MA 0,v,112,v,144
MA 4,v,116,v,144
MA 64,v,120,v,144
MA 68,v,124,v,144
MA 128,v,128,v,144
MA 132,v,132,v,144
MA 192,v,136,v,144
MA 196,v,140,v,144
MA 8,v,112,v,148
MA 12,v,116,v,148
s_waitcnt vmcnt(8) lgkmcnt(0)
s_barrier
MA 72,v,120,v,148
TR 144,196,0
TR 146,196,2048
MA 76,v,124,v,148
ds_read_b128 v[80:83], v194 offset:0
s_add_u32 m0, s23, 32768
MA 136,v,128,v,148
s_mov_b32 s86, 4194304
s_mov_b32 s87, 0x20000
MA 140,v,132,v,148
s_mov_b32 s90, 4194304
s_mov_b32 s91, 0x20000
MA 200,v,136,v,148
buffer_load_dwordx4 v184, s[12:15], s21 offen offset:0 lds
MA 204,v,140,v,148
TR 148,197,0
TR 150,197,2048
MA 16,v,112,v,152
ds_read_b128 v[84:87], v194 offset:2048
s_mov_b32 s94, 4194304
MA 20,v,116,v,152
s_mov_b32 s95, 0x20000
s_mov_b32 s98, 8192
MA 80,v,120,v,152
buffer_load_dwordx4 v185, s[12:15], s21 offen offset:1024 lds
s_mov_b32 s99, 0x20000
MA 84,v,124,v,152
MA 144,v,128,v,152
s_mov_b32 s78, 2048
MA 148,v,132,v,152
ds_read_b128 v[88:91], v194 offset:4096
s_mov_b32 s79, 0x20000
MA 208,v,136,v,152
s_and_b32 s36, s2, 15
MA 212,v,140,v,152
TR 152,198,0
TR 154,198,2048
MA 24,v,112,v,156
buffer_load_dwordx4 v186, s[12:15], s21 offen offset:2048 lds
s_lshl_b32 s36, s36, 1
MA 28,v,116,v,156
s_lshr_b32 s37, s3, 1
MA 88,v,120,v,156
ds_read_b128 v[92:95], v194 offset:6144
s_add_u32 s36, s36, s37
MA 92,v,124,v,156
buffer_load_dwordx4 v187, s[12:15], s21 offen offset:3072 lds
s_lshl_b32 s36, s36, 3
MA 152,v,128,v,156
MA 156,v,132,v,156
v_and_b32 v252, 7, v1
MA 216,v,136,v,156
v_add_u32 v252, s36, v252
MA 220,v,140,v,156
TR 156,199,0
TR 158,199,2048
MA 32,v,112,v,160
ds_read_b128 v[96:99], v194 offset:8192
s_add_u32 m0, s23, 36864
MA 36,v,116,v,160
s_lshr_b32 s36, s2, 4
s_lshl_b32 s36, s36, 1
MA 96,v,120,v,160
s_and_b32 s37, s3, 1
MA 100,v,124,v,160
s_add_u32 s36, s36, s37
MA 160,v,128,v,160
ds_read_b128 v[100:103], v194 offset:10240
buffer_load_dwordx4 v188, s[12:15], s21 offen offset:0 lds
MA 164,v,132,v,160
s_lshl_b32 s36, s36, 3
v_lshrrev_b32 v253, 3, v1
MA 224,v,136,v,160
MA 228,v,140,v,160
TR 160,200,0
TR 162,200,2048
MA 40,v,112,v,164
buffer_load_dwordx4 v189, s[12:15], s21 offen offset:1024 lds
v_add_u32 v253, s36, v253
MA 44,v,116,v,164
ds_read_b128 v[104:107], v194 offset:12288
v_lshlrev_b32 v254, 14, v253
MA 104,v,120,v,164
v_lshl_add_u32 v254, v252, 3, v254
v_add_u32 v229, -6144, v254
MA 108,v,124,v,164
MA 168,v,128,v,164
buffer_load_dwordx4 v190, s[12:15], s21 offen offset:2048 lds
v_lshlrev_b32 v62, 5, v252
MA 172,v,132,v,164
v_lshlrev_b32 v254, 4, v253
MA 232,v,136,v,164
ds_read_b128 v[108:111], v194 offset:14336
v_sub_u32 v254, 4080, v254
MA 236,v,140,v,164
TR 164,201,0
TR 166,201,2048
MA 48,v,112,v,168
v_lshl_add_u32 v10, v252, 14, v254
MA 52,v,116,v,168
buffer_load_dwordx4 v191, s[12:15], s21 offen offset:3072 lds
v_and_b32 v252, 31, v1
MA 112,v,120,v,168
v_lshlrev_b32 v64, 4, v252
MA 116,v,124,v,168
s_lshl_b32 s36, s2, 2
MA 176,v,128,v,168
MA 180,v,132,v,168
s_add_u32 s21, s21, 524288
s_add_u32 s36, s36, s3
MA 240,v,136,v,168
s_lshl_b32 s36, s36, 1
MA 244,v,140,v,168
TR 168,202,0
TR 170,202,2048
MA 56,v,112,v,172
v_lshrrev_b32 v253, 5, v1
v_add_u32 v253, s36, v253
MA 60,v,116,v,172
s_and_b32 s21, s21, 4194303
MA 120,v,120,v,172
v_lshl_add_u32 v63, v253, 11, v64
MA 124,v,124,v,172
v_lshlrev_b32 v253, 2, v253
MA 184,v,128,v,172
v_lshl_add_u32 v11, v252, 20, v253
MA 188,v,132,v,172
MA 248,v,136,v,172
MA 252,v,140,v,172
TR 172,203,0
TR 174,203,2048
s_waitcnt lgkmcnt(2)
MA 0,v,80,v,144
s_add_u32 m0, s22, 32768
buffer_load_dwordx4 v[230:233], v63, s[92:95], 0 offen offset:0
MA 4,v,84,v,144
ds_read_b128 v[112:115], v195 offset:0
MA 64,v,88,v,144
MA 68,v,92,v,144
MA 128,v,96,v,144
buffer_load_dwordx4 v[2:5], v64, s[76:79], 0 offen offset:0
MA 132,v,100,v,144
buffer_load_dwordx4 v176, s[8:11], s20 offen offset:0 lds
MA 192,v,104,v,144
MA 196,v,108,v,144
TR 144,196,16384
TR 146,196,18432
MA 8,v,80,v,148
ds_read_b128 v[116:119], v195 offset:2048
MA 12,v,84,v,148
buffer_load_dwordx4 v[234:237], v63, s[92:95], 0 offen offset:512
MA 72,v,88,v,148
buffer_load_dwordx4 v177, s[8:11], s20 offen offset:1024 lds
MA 76,v,92,v,148
MA 136,v,96,v,148
MA 140,v,100,v,148
ds_read_b128 v[120:123], v195 offset:4096
MA 200,v,104,v,148
buffer_load_dwordx4 v[6:9], v64, s[76:79], 0 offen offset:512
MA 204,v,108,v,148
TR 148,197,16384
TR 150,197,18432
MA 16,v,80,v,152
buffer_load_dwordx4 v178, s[8:11], s20 offen offset:2048 lds
MA 20,v,84,v,152
MA 80,v,88,v,152
MA 84,v,92,v,152
buffer_load_dwordx4 v[238:241], v63, s[92:95], 0 offen offset:1024
MA 144,v,96,v,152
ds_read_b128 v[124:127], v195 offset:6144
buffer_load_dwordx4 v179, s[8:11], s20 offen offset:3072 lds
MA 148,v,100,v,152
MA 208,v,104,v,152
MA 212,v,108,v,152
TR 152,198,16384
TR 154,198,18432
MA 24,v,80,v,156
buffer_load_dwordx4 v[12:15], v64, s[76:79], 0 offen offset:1024
MA 28,v,84,v,156
s_add_u32 m0, s22, 36864
MA 88,v,88,v,156
ds_read_b128 v[128:131], v195 offset:8192
MA 92,v,92,v,156
MA 152,v,96,v,156
buffer_load_dwordx4 v[242:245], v63, s[92:95], 0 offen offset:1536
MA 156,v,100,v,156
MA 216,v,104,v,156
MA 220,v,108,v,156
TR 156,199,16384
TR 158,199,18432
MA 32,v,80,v,160
ds_read_b128 v[132:135], v195 offset:10240
buffer_load_dwordx4 v180, s[8:11], s20 offen offset:0 lds
MA 36,v,84,v,160
buffer_load_dwordx4 v[246:249], v64, s[76:79], 0 offen offset:1536
MA 96,v,88,v,160
MA 100,v,92,v,160
MA 160,v,96,v,160
buffer_load_dwordx4 v181, s[8:11], s20 offen offset:1024 lds
MA 164,v,100,v,160
MA 224,v,104,v,160
buffer_load_dwordx4 v[54:57], v62, s[96:99], 0 offen offset:0
MA 228,v,108,v,160
TR 160,200,16384
TR 162,200,18432
MA 40,v,80,v,164
ds_read_b128 v[136:139], v195 offset:12288
MA 44,v,84,v,164
buffer_load_dwordx4 v182, s[8:11], s20 offen offset:2048 lds
MA 104,v,88,v,164
buffer_load_dwordx4 v[58:61], v62, s[96:99], 0 offen offset:16
MA 108,v,92,v,164
MA 168,v,96,v,164
MA 172,v,100,v,164
ds_read_b128 v[140:143], v195 offset:14336
MA 232,v,104,v,164
buffer_load_dwordx4 v183, s[8:11], s20 offen offset:3072 lds
MA 236,v,108,v,164
TR 164,201,16384
TR 166,201,18432
MA 48,v,80,v,168
v_add_u32 v252, 0, v229
MA 52,v,84,v,168
MA 112,v,88,v,168
MA 116,v,92,v,168
s_add_u32 s20, s20, 128
MA 176,v,96,v,168
buffer_load_dwordx2 v[16:17], v252, s[84:87], 0 offen
MA 180,v,100,v,168
MA 240,v,104,v,168
MA 244,v,108,v,168
TR 168,202,16384
TR 170,202,18432
s_waitcnt lgkmcnt(15)
MA 56,v,80,v,172
s_and_b32 s20, s20, 1023
MA 60,v,84,v,172
v_add_u32 v253, 2048, v229
MA 120,v,88,v,172
MA 124,v,92,v,172
MA 184,v,96,v,172
MA 188,v,100,v,172
MA 248,v,104,v,172
MA 252,v,108,v,172
TR 172,203,16384
TR 174,203,18432
s_waitcnt lgkmcnt(2)
MA 0,v,112,v,144
MA 4,v,116,v,144
MA 64,v,120,v,144
MA 68,v,124,v,144
MA 128,v,128,v,144
MA 132,v,132,v,144
MA 192,v,136,v,144
MA 196,v,140,v,144
MA 8,v,112,v,148
MA 12,v,116,v,148
s_waitcnt vmcnt(19) lgkmcnt(0)
s_barrier
MA 72,v,120,v,148
TR 144,196,32768
TR 146,196,34816
MA 76,v,124,v,148
ds_read_b128 v[80:83], v192 offset:0
s_add_u32 m0, s23, 0
MA 136,v,128,v,148
s_and_b32 s80, s2, 7
s_lshr_b32 s81, s2, 3
MA 140,v,132,v,148
s_and_b32 s69, s81, 3
s_lshl_b32 s80, s80, 2
MA 200,v,136,v,148
buffer_load_dwordx4 v184, s[12:15], s21 offen offset:0 lds
s_add_u32 s69, s69, s80
MA 204,v,140,v,148
TR 148,197,32768
TR 150,197,34816
MA 16,v,112,v,152
ds_read_b128 v[84:87], v192 offset:2048
s_lshr_b32 s70, s81, 2
MA 20,v,116,v,152
s_lshl_b32 s80, s3, 16
s_lshl_b32 s65, s70, 18
MA 80,v,120,v,152
buffer_load_dwordx4 v185, s[12:15], s21 offen offset:1024 lds
s_sub_u32 s64, 3932160, s65
MA 84,v,124,v,152
s_add_u32 s65, s65, s80
MA 144,v,128,v,152
s_add_u32 s64, s64, s80
MA 148,v,132,v,152
ds_read_b128 v[88:91], v192 offset:4096
s_lshl_b32 s81, s69, 12
MA 208,v,136,v,152
s_lshl_b32 s100, s64, 2
MA 212,v,140,v,152
TR 152,198,32768
TR 154,198,34816
MA 24,v,112,v,156
buffer_load_dwordx4 v186, s[12:15], s21 offen offset:2048 lds
s_add_u32 s100, s100, s81
MA 28,v,116,v,156
s_lshl_b32 s101, s65, 2
s_add_u32 s101, s101, s81
MA 88,v,120,v,156
ds_read_b128 v[92:95], v192 offset:6144
s_lshl_b32 s66, s3, 17
MA 92,v,124,v,156
buffer_load_dwordx4 v187, s[12:15], s21 offen offset:3072 lds
s_lshl_b32 s81, s69, 8
MA 152,v,128,v,156
s_add_u32 s66, s66, s81
MA 156,v,132,v,156
s_and_b32 s74, s2, 7
MA 216,v,136,v,156
s_lshl_b32 s74, s74, 8
MA 220,v,140,v,156
TR 156,199,32768
TR 158,199,34816
MA 32,v,112,v,160
ds_read_b128 v[96:99], v192 offset:8192
s_add_u32 m0, s23, 4096
MA 36,v,116,v,160
s_mov_b32 s82, s66
s_lshl_b32 s66, s74, 12
MA 96,v,120,v,160
s_lshl_b32 s67, s3, 13
s_lshl_b32 s68, s3, 12
MA 100,v,124,v,160
s_lshl_b32 s77, s70, 1
MA 160,v,128,v,160
ds_read_b128 v[100:103], v192 offset:10240
buffer_load_dwordx4 v188, s[12:15], s21 offen offset:0 lds
MA 164,v,132,v,160
s_sub_u32 s77, 32, s77
v_lshrrev_b32 v66, 3, v1
MA 224,v,136,v,160
v_lshlrev_b32 v66, 11, v66
MA 228,v,140,v,160
TR 160,200,32768
TR 162,200,34816
MA 40,v,112,v,164
buffer_load_dwordx4 v189, s[12:15], s21 offen offset:1024 lds
v_lshrrev_b32 v67, 4, v1
MA 44,v,116,v,164
ds_read_b128 v[104:107], v192 offset:12288
v_and_b32 v68, 7, v1
MA 104,v,120,v,164
v_xor_b32 v68, v68, v67
v_lshl_add_u32 v66, v68, 4, v66
MA 108,v,124,v,164
v_xor_b32 v69, 64, v66
MA 168,v,128,v,164
buffer_load_dwordx4 v190, s[12:15], s21 offen offset:2048 lds
v_add_u32 v208, 0, v66
MA 172,v,132,v,164
v_add_u32 v209, 15360, v69
MA 232,v,136,v,164
ds_read_b128 v[108:111], v192 offset:14336
v_add_u32 v210, 30720, v66
MA 236,v,140,v,164
TR 164,201,32768
TR 166,201,34816
MA 48,v,112,v,168
v_add_u32 v211, 46080, v69
v_and_b32 v68, 15, v1
MA 52,v,116,v,168
buffer_load_dwordx4 v191, s[12:15], s21 offen offset:3072 lds
v_lshlrev_b32 v69, 1, v67
MA 112,v,120,v,168
v_xor_b32 v68, v68, v69
MA 116,v,124,v,168
v_lshlrev_b32 v66, 13, v67
MA 176,v,128,v,168
v_xor_b32 v69, 0, v68
MA 180,v,132,v,168
s_add_u32 s21, s21, 524288
v_lshl_add_u32 v69, v69, 4, v66
MA 240,v,136,v,168
v_add_u32 v212, 0, v69
MA 244,v,140,v,168
TR 168,202,32768
TR 170,202,34816
MA 56,v,112,v,172
v_xor_b32 v69, 0, v68
v_lshl_add_u32 v69, v69, 4, v66
MA 60,v,116,v,172
s_and_b32 s21, s21, 4194303
v_add_u32 v213, 31744, v69
MA 120,v,120,v,172
v_xor_b32 v69, 8, v68
MA 124,v,124,v,172
v_lshl_add_u32 v69, v69, 4, v66
MA 184,v,128,v,172
v_add_u32 v214, 63488, v69
MA 188,v,132,v,172
v_xor_b32 v69, 8, v68
MA 248,v,136,v,172
MA 252,v,140,v,172
TR 172,203,32768
TR 174,203,34816
s_waitcnt lgkmcnt(2)
MA 0,v,80,v,144
s_add_u32 m0, s22, 65536
buffer_load_dwordx2 v[18:19], v253, s[84:87], 0 offen
MA 4,v,84,v,144
ds_read_b128 v[112:115], v193 offset:0
MA 64,v,88,v,144
MA 68,v,92,v,144
MA 128,v,96,v,144
v_add_u32 v254, 4096, v229
MA 132,v,100,v,144
buffer_load_dwordx4 v176, s[8:11], s20 offen offset:0 lds
MA 192,v,104,v,144
MA 196,v,108,v,144
TR 144,196,49152
TR 146,196,51200
MA 8,v,80,v,148
ds_read_b128 v[116:119], v193 offset:2048
MA 12,v,84,v,148
buffer_load_dwordx2 v[20:21], v254, s[84:87], 0 offen
MA 72,v,88,v,148
buffer_load_dwordx4 v177, s[8:11], s20 offen offset:1024 lds
MA 76,v,92,v,148
MA 136,v,96,v,148
MA 140,v,100,v,148
ds_read_b128 v[120:123], v193 offset:4096
MA 200,v,104,v,148
v_add_u32 v255, 6144, v229
MA 204,v,108,v,148
TR 148,197,49152
TR 150,197,51200
MA 16,v,80,v,152
buffer_load_dwordx4 v178, s[8:11], s20 offen offset:2048 lds
MA 20,v,84,v,152
MA 80,v,88,v,152
MA 84,v,92,v,152
buffer_load_dwordx2 v[22:23], v255, s[84:87], 0 offen
MA 144,v,96,v,152
ds_read_b128 v[124:127], v193 offset:6144
buffer_load_dwordx4 v179, s[8:11], s20 offen offset:3072 lds
MA 148,v,100,v,152
MA 208,v,104,v,152
MA 212,v,108,v,152
TR 152,198,49152
TR 154,198,51200
MA 24,v,80,v,156
buffer_load_dwordx2 v[38:39], v255, s[88:91], 0 offen
MA 28,v,84,v,156
s_add_u32 m0, s22, 69632
MA 88,v,88,v,156
ds_read_b128 v[128:131], v193 offset:8192
MA 92,v,92,v,156
MA 152,v,96,v,156
v_add_u32 v252, 8192, v229
MA 156,v,100,v,156
MA 216,v,104,v,156
MA 220,v,108,v,156
TR 156,199,49152
TR 158,199,51200
MA 32,v,80,v,160
ds_read_b128 v[132:135], v193 offset:10240
buffer_load_dwordx4 v180, s[8:11], s20 offen offset:0 lds
MA 36,v,84,v,160
buffer_load_dwordx2 v[24:25], v252, s[84:87], 0 offen
MA 96,v,88,v,160
MA 100,v,92,v,160
MA 160,v,96,v,160
buffer_load_dwordx4 v181, s[8:11], s20 offen offset:1024 lds
MA 164,v,100,v,160
MA 224,v,104,v,160
buffer_load_dwordx2 v[40:41], v252, s[88:91], 0 offen
MA 228,v,108,v,160
TR 160,200,49152
TR 162,200,51200
MA 40,v,80,v,164
ds_read_b128 v[136:139], v193 offset:12288
MA 44,v,84,v,164
buffer_load_dwordx4 v182, s[8:11], s20 offen offset:2048 lds
MA 104,v,88,v,164
v_add_u32 v253, 10240, v229
MA 108,v,92,v,164
MA 168,v,96,v,164
MA 172,v,100,v,164
ds_read_b128 v[140:143], v193 offset:14336
MA 232,v,104,v,164
buffer_load_dwordx4 v183, s[8:11], s20 offen offset:3072 lds
MA 236,v,108,v,164
TR 164,201,49152
TR 166,201,51200
MA 48,v,80,v,168
buffer_load_dwordx2 v[26:27], v253, s[84:87], 0 offen
MA 52,v,84,v,168
MA 112,v,88,v,168
MA 116,v,92,v,168
s_add_u32 s20, s20, 128
MA 176,v,96,v,168
buffer_load_dwordx2 v[42:43], v253, s[88:91], 0 offen
MA 180,v,100,v,168
MA 240,v,104,v,168
MA 244,v,108,v,168
TR 168,202,49152
TR 170,202,51200
s_waitcnt lgkmcnt(15)
MA 56,v,80,v,172
s_and_b32 s20, s20, 1023
MA 60,v,84,v,172
v_add_u32 v254, 12288, v229
MA 120,v,88,v,172
MA 124,v,92,v,172
MA 184,v,96,v,172
MA 188,v,100,v,172
MA 248,v,104,v,172
MA 252,v,108,v,172
TR 172,203,49152
TR 174,203,51200
s_waitcnt lgkmcnt(2)
MA 0,v,112,v,144
MA 4,v,116,v,144
MA 64,v,120,v,144
MA 68,v,124,v,144
MA 128,v,128,v,144
MA 132,v,132,v,144
MA 192,v,136,v,144
MA 196,v,140,v,144
MA 8,v,112,v,148
MA 12,v,116,v,148
s_waitcnt vmcnt(16) lgkmcnt(0)
s_barrier
MA 72,v,120,v,148
TR 144,196,0
TR 146,196,2048
MA 76,v,124,v,148
ds_read_b128 v[80:83], v192 offset:32768
s_add_u32 m0, s23, 32768
MA 136,v,128,v,148
v_lshl_add_u32 v69, v69, 4, v66
v_add_u32 v215, 95232, v69
MA 140,v,132,v,148
v_and_b32 v66, 15, v1
v_lshrrev_b32 v68, 1, v66
MA 200,v,136,v,148
buffer_load_dwordx4 v184, s[12:15], s21 offen offset:0 lds
v_xor_b32 v68, v68, v67
MA 204,v,140,v,148
TR 148,197,0
TR 150,197,2048
MA 16,v,112,v,152
ds_read_b128 v[84:87], v192 offset:34816
v_lshlrev_b32 v68, 4, v68
MA 20,v,116,v,152
v_lshl_add_u32 v68, v66, 7, v68
v_add_u32 v224, s67, v68
MA 80,v,120,v,152
buffer_load_dwordx4 v185, s[12:15], s21 offen offset:1024 lds
v_xor_b32 v225, 64, v224
MA 84,v,124,v,152
v_add_u32 v226, 0x10000, v224
v_add_u32 v227, 0x10000, v225
MA 144,v,128,v,152
v_bfe_u32 v66, v1, 2, 2
v_and_b32 v68, 1, v67
MA 148,v,132,v,152
ds_read_b128 v[88:91], v192 offset:36864
v_lshl_or_b32 v68, v68, 2, v66
MA 208,v,136,v,152
v_lshl_add_u32 v66, v67, 3, v66
MA 212,v,140,v,152
TR 152,198,0
TR 154,198,2048
MA 24,v,112,v,156
buffer_load_dwordx4 v186, s[12:15], s21 offen offset:2048 lds
v_lshlrev_b32 v66, 8, v66
MA 28,v,116,v,156
v_and_b32 v69, 3, v1
v_lshl_add_u32 v66, v69, 3, v66
MA 88,v,120,v,156
ds_read_b128 v[92:95], v192 offset:38912
v_add_u32 v66, 98304, v66
MA 92,v,124,v,156
buffer_load_dwordx4 v187, s[12:15], s21 offen offset:3072 lds
v_xor_b32 v69, 0, v68
MA 152,v,128,v,156
v_lshl_add_u32 v216, v69, 5, v66
v_xor_b32 v69, 1, v68
MA 156,v,132,v,156
v_lshl_add_u32 v217, v69, 5, v66
MA 216,v,136,v,156
v_xor_b32 v69, 2, v68
MA 220,v,140,v,156
TR 156,199,0
TR 158,199,2048
MA 32,v,112,v,160
ds_read_b128 v[96:99], v192 offset:40960
s_add_u32 m0, s23, 36864
MA 36,v,116,v,160
v_lshl_add_u32 v218, v69, 5, v66
v_xor_b32 v69, 3, v68
MA 96,v,120,v,160
v_lshl_add_u32 v219, v69, 5, v66
v_xor_b32 v69, 4, v68
MA 100,v,124,v,160
v_lshl_add_u32 v220, v69, 5, v66
MA 160,v,128,v,160
ds_read_b128 v[100:103], v192 offset:43008
buffer_load_dwordx4 v188, s[12:15], s21 offen offset:0 lds
MA 164,v,132,v,160
v_xor_b32 v69, 5, v68
v_lshl_add_u32 v221, v69, 5, v66
MA 224,v,136,v,160
v_xor_b32 v69, 6, v68
v_lshl_add_u32 v222, v69, 5, v66
MA 228,v,140,v,160
TR 160,200,0
TR 162,200,2048
MA 40,v,112,v,164
buffer_load_dwordx4 v189, s[12:15], s21 offen offset:1024 lds
v_xor_b32 v69, 7, v68
MA 44,v,116,v,164
ds_read_b128 v[104:107], v192 offset:45056
v_lshl_add_u32 v223, v69, 5, v66
MA 104,v,120,v,164
s_mov_b32 s44, s32
s_mov_b32 s45, s33
MA 108,v,124,v,164
s_mov_b32 s46, 4194304
MA 168,v,128,v,164
buffer_load_dwordx4 v190, s[12:15], s21 offen offset:2048 lds
s_mov_b32 s47, 0x20000
MA 172,v,132,v,164
s_add_u32 s48, s34, s82
s_addc_u32 s49, s35, 0
MA 232,v,136,v,164
ds_read_b128 v[108:111], v192 offset:47104
s_sub_u32 s50, 8388608, s82
MA 236,v,140,v,164
TR 164,201,0
TR 166,201,2048
MA 48,v,112,v,168
s_mov_b32 s51, 0x20000
MA 52,v,116,v,168
buffer_load_dwordx4 v191, s[12:15], s21 offen offset:3072 lds
MA 112,v,120,v,168
s_add_u32 s60, s40, 33554432
s_addc_u32 s61, s41, 0
MA 116,v,124,v,168
s_mov_b32 s62, 16777216
s_mov_b32 s63, 0x20000
MA 176,v,128,v,168
s_lshl_b32 s80, s69, 19
MA 180,v,132,v,168
s_add_u32 s21, s21, 524288
MA 240,v,136,v,168
s_add_u32 s52, s40, s80
s_addc_u32 s53, s41, 0
MA 244,v,140,v,168
TR 168,202,0
TR 170,202,2048
MA 56,v,112,v,172
s_lshl_b32 s54, s77, 14
s_mov_b32 s55, 0x20000
MA 60,v,116,v,172
s_and_b32 s21, s21, 4194303
s_add_u32 s80, s80, 16760832
MA 120,v,120,v,172
s_add_u32 s56, s40, s80
s_addc_u32 s57, s41, 0
MA 124,v,124,v,172
s_add_u32 s58, s54, 16384
MA 184,v,128,v,172
s_mov_b32 s59, 0x20000
MA 188,v,132,v,172
s_load_dwordx2 s[38:39], s[0:1], 112
MA 248,v,136,v,172
MA 252,v,140,v,172
TR 172,203,0
TR 174,203,2048
s_waitcnt lgkmcnt(2)
MA 0,v,80,v,144
s_add_u32 m0, s22, 0
buffer_load_dwordx2 v[28:29], v254, s[84:87], 0 offen
MA 4,v,84,v,144
ds_read_b128 v[112:115], v193 offset:32768
MA 64,v,88,v,144
MA 68,v,92,v,144
MA 128,v,96,v,144
buffer_load_dwordx2 v[44:45], v254, s[88:91], 0 offen
MA 132,v,100,v,144
buffer_load_dwordx4 v176, s[8:11], s20 offen offset:0 lds
MA 192,v,104,v,144
MA 196,v,108,v,144
TR 144,196,16384
TR 146,196,18432
MA 8,v,80,v,148
ds_read_b128 v[116:119], v193 offset:34816
v_add_u32 v255, 14336, v229
MA 12,v,84,v,148
MA 72,v,88,v,148
buffer_load_dwordx4 v177, s[8:11], s20 offen offset:1024 lds
MA 76,v,92,v,148
MA 136,v,96,v,148
MA 140,v,100,v,148
ds_read_b128 v[120:123], v193 offset:36864
buffer_load_dwordx2 v[30:31], v255, s[84:87], 0 offen
MA 200,v,104,v,148
MA 204,v,108,v,148
TR 148,197,16384
TR 150,197,18432
MA 16,v,80,v,152
buffer_load_dwordx4 v178, s[8:11], s20 offen offset:2048 lds
MA 20,v,84,v,152
buffer_load_dwordx2 v[46:47], v255, s[88:91], 0 offen
MA 80,v,88,v,152
MA 84,v,92,v,152
MA 144,v,96,v,152
ds_read_b128 v[124:127], v193 offset:38912
buffer_load_dwordx4 v179, s[8:11], s20 offen offset:3072 lds
MA 148,v,100,v,152
MA 208,v,104,v,152
v_add_u32 v252, 16384, v229
MA 212,v,108,v,152
TR 152,198,16384
TR 154,198,18432
MA 24,v,80,v,156
MA 28,v,84,v,156
s_add_u32 m0, s22, 4096
MA 88,v,88,v,156
ds_read_b128 v[128:131], v193 offset:40960
buffer_load_dwordx2 v[32:33], v252, s[84:87], 0 offen
MA 92,v,92,v,156
MA 152,v,96,v,156
MA 156,v,100,v,156
MA 216,v,104,v,156
MA 220,v,108,v,156
TR 156,199,16384
TR 158,199,18432
MA 32,v,80,v,160
ds_read_b128 v[132:135], v193 offset:43008
buffer_load_dwordx4 v180, s[8:11], s20 offen offset:0 lds
MA 36,v,84,v,160
buffer_load_dwordx2 v[48:49], v252, s[88:91], 0 offen
MA 96,v,88,v,160
MA 100,v,92,v,160
v_add_u32 v253, 18432, v229
MA 160,v,96,v,160
buffer_load_dwordx4 v181, s[8:11], s20 offen offset:1024 lds
MA 164,v,100,v,160
MA 224,v,104,v,160
MA 228,v,108,v,160
TR 160,200,16384
TR 162,200,18432
MA 40,v,80,v,164
ds_read_b128 v[136:139], v193 offset:45056
buffer_load_dwordx2 v[34:35], v253, s[84:87], 0 offen
MA 44,v,84,v,164
buffer_load_dwordx4 v182, s[8:11], s20 offen offset:2048 lds
MA 104,v,88,v,164
MA 108,v,92,v,164
MA 168,v,96,v,164
buffer_load_dwordx2 v[50:51], v253, s[88:91], 0 offen
MA 172,v,100,v,164
ds_read_b128 v[140:143], v193 offset:47104
MA 232,v,104,v,164
buffer_load_dwordx4 v183, s[8:11], s20 offen offset:3072 lds
MA 236,v,108,v,164
TR 164,201,16384
TR 166,201,18432
MA 48,v,80,v,168
v_add_u32 v254, 20480, v229
MA 52,v,84,v,168
MA 112,v,88,v,168
MA 116,v,92,v,168
s_add_u32 s20, s20, 128
MA 176,v,96,v,168
MA 180,v,100,v,168
buffer_load_dwordx2 v[36:37], v254, s[84:87], 0 offen
MA 240,v,104,v,168
MA 244,v,108,v,168
TR 168,202,16384
TR 170,202,18432
s_waitcnt lgkmcnt(15)
MA 56,v,80,v,172
s_and_b32 s20, s20, 1023
MA 60,v,84,v,172
buffer_load_dwordx2 v[52:53], v254, s[88:91], 0 offen
MA 120,v,88,v,172
MA 124,v,92,v,172
MA 184,v,96,v,172
MA 188,v,100,v,172
MA 248,v,104,v,172
MA 252,v,108,v,172
TR 172,203,16384
TR 174,203,18432
s_waitcnt lgkmcnt(2)
MA 0,v,112,v,144
MA 4,v,116,v,144
MA 64,v,120,v,144
MA 68,v,124,v,144
MA 128,v,128,v,144
MA 132,v,132,v,144
MA 192,v,136,v,144
MA 196,v,140,v,144
MA 8,v,112,v,148
MA 12,v,116,v,148
s_waitcnt vmcnt(18) lgkmcnt(0)
s_barrier
MA 72,v,120,v,148
TR 144,196,32768
TR 146,196,34816
MA 76,v,124,v,148
ds_read_b128 v[80:83], v194 offset:0
s_add_u32 m0, s23, 0
MA 136,v,128,v,148
MA 140,v,132,v,148
MA 200,v,136,v,148
buffer_load_dwordx4 v184, s[12:15], s21 offen offset:0 lds
MA 204,v,140,v,148
TR 148,197,32768
TR 150,197,34816
MA 16,v,112,v,152
ds_read_b128 v[84:87], v194 offset:2048
MA 20,v,116,v,152
MA 80,v,120,v,152
buffer_load_dwordx4 v185, s[12:15], s21 offen offset:1024 lds
MA 84,v,124,v,152
MA 144,v,128,v,152
MA 148,v,132,v,152
ds_read_b128 v[88:91], v194 offset:4096
MA 208,v,136,v,152
MA 212,v,140,v,152
TR 152,198,32768
TR 154,198,34816
MA 24,v,112,v,156
buffer_load_dwordx4 v186, s[12:15], s21 offen offset:2048 lds
MA 28,v,116,v,156
MA 88,v,120,v,156
ds_read_b128 v[92:95], v194 offset:6144
MA 92,v,124,v,156
buffer_load_dwordx4 v187, s[12:15], s21 offen offset:3072 lds
MA 152,v,128,v,156
MA 156,v,132,v,156
MA 216,v,136,v,156
MA 220,v,140,v,156
TR 156,199,32768
TR 158,199,34816
MA 32,v,112,v,160
ds_read_b128 v[96:99], v194 offset:8192
s_add_u32 m0, s23, 4096
MA 36,v,116,v,160
MA 96,v,120,v,160
MA 100,v,124,v,160
MA 160,v,128,v,160
ds_read_b128 v[100:103], v194 offset:10240
buffer_load_dwordx4 v188, s[12:15], s21 offen offset:0 lds
MA 164,v,132,v,160
MA 224,v,136,v,160
MA 228,v,140,v,160
TR 160,200,32768
TR 162,200,34816
MA 40,v,112,v,164
buffer_load_dwordx4 v189, s[12:15], s21 offen offset:1024 lds
MA 44,v,116,v,164
ds_read_b128 v[104:107], v194 offset:12288
MA 104,v,120,v,164
MA 108,v,124,v,164
MA 168,v,128,v,164
buffer_load_dwordx4 v190, s[12:15], s21 offen offset:2048 lds
MA 172,v,132,v,164
MA 232,v,136,v,164
ds_read_b128 v[108:111], v194 offset:14336
MA 236,v,140,v,164
TR 164,201,32768
TR 166,201,34816
MA 48,v,112,v,168
MA 52,v,116,v,168
buffer_load_dwordx4 v191, s[12:15], s21 offen offset:3072 lds
MA 112,v,120,v,168
MA 116,v,124,v,168
MA 176,v,128,v,168
MA 180,v,132,v,168
s_add_u32 s21, s21, 524288
MA 240,v,136,v,168
MA 244,v,140,v,168
TR 168,202,32768
TR 170,202,34816
MA 56,v,112,v,172
MA 60,v,116,v,172
s_and_b32 s21, s21, 4194303
MA 120,v,120,v,172
MA 124,v,124,v,172
MA 184,v,128,v,172
MA 188,v,132,v,172
MA 248,v,136,v,172
MA 252,v,140,v,172
TR 172,203,32768
TR 174,203,34816
s_waitcnt lgkmcnt(2)
MA 0,v,80,v,144
s_add_u32 m0, s22, 32768
MA 4,v,84,v,144
ds_read_b128 v[112:115], v195 offset:0
MA 64,v,88,v,144
MA 68,v,92,v,144
MA 128,v,96,v,144
MA 132,v,100,v,144
buffer_load_dwordx4 v176, s[8:11], s20 offen offset:0 lds
MA 192,v,104,v,144
MA 196,v,108,v,144
TR 144,196,49152
TR 146,196,51200
MA 8,v,80,v,148
ds_read_b128 v[116:119], v195 offset:2048
MA 12,v,84,v,148
MA 72,v,88,v,148
buffer_load_dwordx4 v177, s[8:11], s20 offen offset:1024 lds
MA 76,v,92,v,148
MA 136,v,96,v,148
MA 140,v,100,v,148
ds_read_b128 v[120:123], v195 offset:4096
MA 200,v,104,v,148
MA 204,v,108,v,148
TR 148,197,49152
TR 150,197,51200
MA 16,v,80,v,152
buffer_load_dwordx4 v178, s[8:11], s20 offen offset:2048 lds
MA 20,v,84,v,152
MA 80,v,88,v,152
MA 84,v,92,v,152
MA 144,v,96,v,152
ds_read_b128 v[124:127], v195 offset:6144
buffer_load_dwordx4 v179, s[8:11], s20 offen offset:3072 lds
MA 148,v,100,v,152
MA 208,v,104,v,152
MA 212,v,108,v,152
TR 152,198,49152
TR 154,198,51200
MA 24,v,80,v,156
MA 28,v,84,v,156
s_add_u32 m0, s22, 36864
MA 88,v,88,v,156
ds_read_b128 v[128:131], v195 offset:8192
MA 92,v,92,v,156
MA 152,v,96,v,156
MA 156,v,100,v,156
MA 216,v,104,v,156
MA 220,v,108,v,156
TR 156,199,49152
TR 158,199,51200
MA 32,v,80,v,160
ds_read_b128 v[132:135], v195 offset:10240
buffer_load_dwordx4 v180, s[8:11], s20 offen offset:0 lds
MA 36,v,84,v,160
MA 96,v,88,v,160
MA 100,v,92,v,160
MA 160,v,96,v,160
buffer_load_dwordx4 v181, s[8:11], s20 offen offset:1024 lds
MA 164,v,100,v,160
MA 224,v,104,v,160
MA 228,v,108,v,160
TR 160,200,49152
TR 162,200,51200
MA 40,v,80,v,164
ds_read_b128 v[136:139], v195 offset:12288
MA 44,v,84,v,164
buffer_load_dwordx4 v182, s[8:11], s20 offen offset:2048 lds
MA 104,v,88,v,164
MA 108,v,92,v,164
MA 168,v,96,v,164
MA 172,v,100,v,164
ds_read_b128 v[140:143], v195 offset:14336
MA 232,v,104,v,164
buffer_load_dwordx4 v183, s[8:11], s20 offen offset:3072 lds
MA 236,v,108,v,164
TR 164,201,49152
TR 166,201,51200
MA 48,v,80,v,168
MA 52,v,84,v,168
MA 112,v,88,v,168
MA 116,v,92,v,168
s_add_u32 s20, s20, 128
MA 176,v,96,v,168
MA 180,v,100,v,168
MA 240,v,104,v,168
MA 244,v,108,v,168
TR 168,202,49152
TR 170,202,51200
s_waitcnt lgkmcnt(15)
MA 56,v,80,v,172
s_and_b32 s20, s20, 1023
MA 60,v,84,v,172
MA 120,v,88,v,172
MA 124,v,92,v,172
MA 184,v,96,v,172
MA 188,v,100,v,172
MA 248,v,104,v,172
MA 252,v,108,v,172
TR 172,203,49152
TR 174,203,51200
s_waitcnt lgkmcnt(2)
MA 0,v,112,v,144
MA 4,v,116,v,144
MA 64,v,120,v,144
MA 68,v,124,v,144
MA 128,v,128,v,144
MA 132,v,132,v,144
MA 192,v,136,v,144
MA 196,v,140,v,144
MA 8,v,112,v,148
MA 12,v,116,v,148
s_waitcnt vmcnt(8) lgkmcnt(0)
s_barrier
MA 72,v,120,v,148
TR 144,196,0
TR 146,196,2048
MA 76,v,124,v,148
ds_read_b128 v[80:83], v192 offset:0
s_add_u32 m0, s23, 32768
MA 136,v,128,v,148
buffer_load_dword v79, v78, s[4:7], 0 offen
MA 140,v,132,v,148
s_add_u32 s84, s40, 50331648
s_addc_u32 s85, s41, 0
MA 200,v,136,v,148
buffer_load_dwordx4 v184, s[12:15], s21 offen offset:0 lds
s_mov_b32 s86, 4194304
MA 204,v,140,v,148
TR 148,197,0
TR 150,197,2048
MA 16,v,112,v,152
ds_read_b128 v[84:87], v192 offset:2048
s_mov_b32 s87, 0x20000
MA 20,v,116,v,152
s_add_u32 s88, s40, 58720256
s_addc_u32 s89, s41, 0
MA 80,v,120,v,152
buffer_load_dwordx4 v185, s[12:15], s21 offen offset:1024 lds
s_mov_b32 s90, 8192
MA 84,v,124,v,152
s_mov_b32 s91, 0x20000
v_mov_b32 v252, 0
MA 144,v,128,v,152
v_mov_b32 v253, 0
v_dot2_f32_bf16 v252, v230, v2, v252
MA 148,v,132,v,152
ds_read_b128 v[88:91], v192 offset:4096
v_dot2_f32_bf16 v253, v231, v3, v253
MA 208,v,136,v,152
v_dot2_f32_bf16 v252, v232, v4, v252
v_dot2_f32_bf16 v253, v233, v5, v253
MA 212,v,140,v,152
TR 152,198,0
TR 154,198,2048
MA 24,v,112,v,156
buffer_load_dwordx4 v186, s[12:15], s21 offen offset:2048 lds
v_dot2_f32_bf16 v252, v234, v6, v252
MA 28,v,116,v,156
v_dot2_f32_bf16 v253, v235, v7, v253
v_dot2_f32_bf16 v252, v236, v8, v252
MA 88,v,120,v,156
ds_read_b128 v[92:95], v192 offset:6144
v_dot2_f32_bf16 v253, v237, v9, v253
MA 92,v,124,v,156
buffer_load_dwordx4 v187, s[12:15], s21 offen offset:3072 lds
v_dot2_f32_bf16 v252, v238, v12, v252
MA 152,v,128,v,156
v_dot2_f32_bf16 v253, v239, v13, v253
v_dot2_f32_bf16 v252, v240, v14, v252
MA 156,v,132,v,156
v_dot2_f32_bf16 v253, v241, v15, v253
v_dot2_f32_bf16 v252, v242, v246, v252
MA 216,v,136,v,156
v_dot2_f32_bf16 v253, v243, v247, v253
v_dot2_f32_bf16 v252, v244, v248, v252
MA 220,v,140,v,156
TR 156,199,0
TR 158,199,2048
MA 32,v,112,v,160
ds_read_b128 v[96:99], v192 offset:8192
s_add_u32 m0, s23, 36864
MA 36,v,116,v,160
v_dot2_f32_bf16 v253, v245, v249, v253
MA 96,v,120,v,160
s_nop 2
v_add_f32 v252, v252, v253
MA 100,v,124,v,160
s_nop 0
v_add_f32_dpp v252, v252, v252 row_ror:8 row_mask:0xf bank_mask:0xf
s_nop 1
v_add_f32_dpp v252, v252, v252 row_ror:4 row_mask:0xf bank_mask:0xf
MA 160,v,128,v,160
ds_read_b128 v[100:103], v192 offset:10240
buffer_load_dwordx4 v188, s[12:15], s21 offen offset:0 lds
MA 164,v,132,v,160
v_add_f32_dpp v252, v252, v252 row_ror:2 row_mask:0xf bank_mask:0xf
s_nop 1
v_add_f32_dpp v252, v252, v252 row_ror:1 row_mask:0xf bank_mask:0xf
MA 224,v,136,v,160
v_mov_b32 v253, v252
s_nop 1
v_permlane16_swap_b32 v252, v253
MA 228,v,140,v,160
TR 160,200,0
TR 162,200,2048
MA 40,v,112,v,164
buffer_load_dwordx4 v189, s[12:15], s21 offen offset:1024 lds
v_add_f32 v252, v252, v253
MA 44,v,116,v,164
ds_read_b128 v[104:107], v192 offset:12288
v_mul_f32 v252, 0xbfb8aa3b, v252
MA 104,v,120,v,164
v_exp_f32 v252, v252
MA 108,v,124,v,164
v_add_f32 v252, 1.0, v252
MA 168,v,128,v,164
buffer_load_dwordx4 v190, s[12:15], s21 offen offset:2048 lds
MA 172,v,132,v,164
v_rcp_f32 v252, v252
MA 232,v,136,v,164
ds_read_b128 v[108:111], v192 offset:14336
MA 236,v,140,v,164
TR 164,201,0
TR 166,201,2048
MA 48,v,112,v,168
s_nop 0
buffer_store_dword v252, v11, s[88:91], 0 offen sc1
MA 52,v,116,v,168
buffer_load_dwordx4 v191, s[12:15], s21 offen offset:3072 lds
v_lshlrev_b32 v2, 16, v54
MA 112,v,120,v,168
v_and_b32 v3, 0xffff0000, v54
v_lshlrev_b32 v4, 16, v55
MA 116,v,124,v,168
v_and_b32 v5, 0xffff0000, v55
v_lshlrev_b32 v6, 16, v56
MA 176,v,128,v,168
v_and_b32 v7, 0xffff0000, v56
v_lshlrev_b32 v8, 16, v57
MA 180,v,132,v,168
s_add_u32 s21, s21, 524288
v_and_b32 v9, 0xffff0000, v57
MA 240,v,136,v,168
v_lshlrev_b32 v230, 16, v16
v_and_b32 v231, 0xffff0000, v16
MA 244,v,140,v,168
TR 168,202,0
TR 170,202,2048
MA 56,v,112,v,172
v_lshlrev_b32 v232, 16, v18
v_and_b32 v233, 0xffff0000, v18
MA 60,v,116,v,172
s_and_b32 s21, s21, 4194303
v_lshlrev_b32 v234, 16, v20
MA 120,v,120,v,172
v_and_b32 v235, 0xffff0000, v20
v_lshlrev_b32 v236, 16, v22
MA 124,v,124,v,172
v_and_b32 v237, 0xffff0000, v22
v_lshlrev_b32 v238, 16, v24
MA 184,v,128,v,172
v_and_b32 v239, 0xffff0000, v24
v_lshlrev_b32 v240, 16, v26
MA 188,v,132,v,172
v_and_b32 v241, 0xffff0000, v26
v_lshlrev_b32 v242, 16, v28
MA 248,v,136,v,172
v_and_b32 v243, 0xffff0000, v28
v_lshlrev_b32 v244, 16, v30
MA 252,v,140,v,172
TR 172,203,0
TR 174,203,2048
v_and_b32 v245, 0xffff0000, v30
v_lshlrev_b32 v246, 16, v32
v_and_b32 v247, 0xffff0000, v32
v_lshlrev_b32 v248, 16, v34
v_and_b32 v249, 0xffff0000, v34
v_lshlrev_b32 v250, 16, v36
v_and_b32 v251, 0xffff0000, v36
v_lshlrev_b32 v254, 16, v38
v_and_b32 v255, 0xffff0000, v38
v_mul_f32 v62, v236, v2
v_mul_f32 v70, v237, v6
v_fmac_f32 v62, v234, v3
v_fmac_f32 v70, v235, v7
v_fmac_f32 v62, v232, v4
v_fmac_f32 v70, v233, v8
v_fmac_f32 v62, v230, v5
v_fmac_f32 v70, v231, v9
v_mul_f32 v62, v62, v254
s_waitcnt lgkmcnt(2)
MA 0,v,80,v,144
s_add_u32 s75, s64, s74
v_mul_f32 v70, v70, v255
MA 4,v,84,v,144
ds_read_b128 v[112:115], v193 offset:0
v_lshlrev_b32 v254, 16, v40
MA 64,v,88,v,144
v_and_b32 v255, 0xffff0000, v40
v_mul_f32 v63, v238, v2
MA 68,v,92,v,144
v_mul_f32 v71, v239, v6
v_fmac_f32 v63, v236, v3
MA 128,v,96,v,144
s_add_u32 m0, s67, 65536
v_fmac_f32 v71, v237, v7
MA 132,v,100,v,144
v_fmac_f32 v63, v234, v4
MA 192,v,104,v,144
v_fmac_f32 v71, v235, v8
MA 196,v,108,v,144
TR 144,196,16384
TR 146,196,18432
MA 8,v,80,v,148
ds_read_b128 v[116:119], v193 offset:2048
buffer_load_dwordx4 v208, s[44:47], s75 offen offset:0 lds
MA 12,v,84,v,148
v_fmac_f32 v63, v232, v5
v_fmac_f32 v71, v233, v9
MA 72,v,88,v,148
v_mul_f32 v63, v63, v254
v_mul_f32 v71, v71, v255
MA 76,v,92,v,148
v_lshlrev_b32 v254, 16, v42
v_and_b32 v255, 0xffff0000, v42
MA 136,v,96,v,148
v_mul_f32 v64, v240, v2
v_mul_f32 v72, v241, v6
MA 140,v,100,v,148
ds_read_b128 v[120:123], v193 offset:4096
buffer_load_dwordx4 v209, s[44:47], s75 offen offset:1024 lds
MA 200,v,104,v,148
v_fmac_f32 v64, v238, v3
v_fmac_f32 v72, v239, v7
MA 204,v,108,v,148
TR 148,197,16384
TR 150,197,18432
MA 16,v,80,v,152
v_fmac_f32 v64, v236, v4
v_fmac_f32 v72, v237, v8
MA 20,v,84,v,152
buffer_load_dwordx4 v210, s[44:47], s75 offen offset:2048 lds
v_fmac_f32 v64, v234, v5
MA 80,v,88,v,152
v_fmac_f32 v72, v235, v9
v_mul_f32 v64, v64, v254
MA 84,v,92,v,152
v_mul_f32 v72, v72, v255
v_lshlrev_b32 v254, 16, v44
MA 144,v,96,v,152
ds_read_b128 v[124:127], v193 offset:6144
v_and_b32 v255, 0xffff0000, v44
MA 148,v,100,v,152
v_mul_f32 v65, v242, v2
MA 208,v,104,v,152
buffer_load_dwordx4 v211, s[44:47], s75 offen offset:3072 lds
v_mul_f32 v73, v243, v6
MA 212,v,108,v,152
TR 152,198,16384
TR 154,198,18432
MA 24,v,80,v,156
v_fmac_f32 v65, v240, v3
v_fmac_f32 v73, v241, v7
MA 28,v,84,v,156
v_fmac_f32 v65, v238, v4
v_fmac_f32 v73, v239, v8
MA 88,v,88,v,156
ds_read_b128 v[128:131], v193 offset:8192
s_add_u32 s75, s65, s74
MA 92,v,92,v,156
v_fmac_f32 v65, v236, v5
v_fmac_f32 v73, v237, v9
MA 152,v,96,v,156
v_mul_f32 v65, v65, v254
v_mul_f32 v73, v73, v255
MA 156,v,100,v,156
v_lshlrev_b32 v254, 16, v46
MA 216,v,104,v,156
v_and_b32 v255, 0xffff0000, v46
MA 220,v,108,v,156
TR 156,199,16384
TR 158,199,18432
MA 32,v,80,v,160
ds_read_b128 v[132:135], v193 offset:10240
s_add_u32 m0, s67, 69632
MA 36,v,84,v,160
v_mul_f32 v66, v244, v2
v_mul_f32 v74, v245, v6
MA 96,v,88,v,160
v_fmac_f32 v66, v242, v3
v_fmac_f32 v74, v243, v7
MA 100,v,92,v,160
buffer_load_dwordx4 v208, s[44:47], s75 offen offset:0 lds
v_fmac_f32 v66, v240, v4
MA 160,v,96,v,160
v_fmac_f32 v74, v241, v8
v_fmac_f32 v66, v238, v5
MA 164,v,100,v,160
v_fmac_f32 v74, v239, v9
v_mul_f32 v66, v66, v254
MA 224,v,104,v,160
v_mul_f32 v74, v74, v255
v_lshlrev_b32 v254, 16, v48
MA 228,v,108,v,160
TR 160,200,16384
TR 162,200,18432
MA 40,v,80,v,164
ds_read_b128 v[136:139], v193 offset:12288
buffer_load_dwordx4 v209, s[44:47], s75 offen offset:1024 lds
MA 44,v,84,v,164
v_and_b32 v255, 0xffff0000, v48
v_mul_f32 v67, v246, v2
MA 104,v,88,v,164
v_mul_f32 v75, v247, v6
v_fmac_f32 v67, v244, v3
MA 108,v,92,v,164
v_fmac_f32 v75, v245, v7
v_fmac_f32 v67, v242, v4
MA 168,v,96,v,164
buffer_load_dwordx4 v210, s[44:47], s75 offen offset:2048 lds
v_fmac_f32 v75, v243, v8
MA 172,v,100,v,164
ds_read_b128 v[140:143], v193 offset:14336
v_fmac_f32 v67, v240, v5
MA 232,v,104,v,164
v_fmac_f32 v75, v241, v9
v_mul_f32 v67, v67, v254
MA 236,v,108,v,164
TR 164,201,16384
TR 166,201,18432
MA 48,v,80,v,168
buffer_load_dwordx4 v211, s[44:47], s75 offen offset:3072 lds
v_mul_f32 v75, v75, v255
MA 52,v,84,v,168
v_lshlrev_b32 v254, 16, v50
v_and_b32 v255, 0xffff0000, v50
MA 112,v,88,v,168
v_mul_f32 v68, v248, v2
v_mul_f32 v76, v249, v6
MA 116,v,92,v,168
v_fmac_f32 v68, v246, v3
MA 176,v,96,v,168
v_fmac_f32 v76, v247, v7
MA 180,v,100,v,168
s_add_u32 s74, s74, 128
v_fmac_f32 v68, v244, v4
MA 240,v,104,v,168
v_fmac_f32 v76, v245, v8
v_fmac_f32 v68, v242, v5
MA 244,v,108,v,168
TR 168,202,16384
TR 170,202,18432
s_waitcnt lgkmcnt(15)
MA 56,v,80,v,172
v_fmac_f32 v76, v243, v9
v_mul_f32 v68, v68, v254
MA 60,v,84,v,172
s_and_b32 s74, s74, 2047
v_mul_f32 v76, v76, v255
MA 120,v,88,v,172
v_lshlrev_b32 v254, 16, v52
v_and_b32 v255, 0xffff0000, v52
MA 124,v,92,v,172
v_mul_f32 v69, v250, v2
MA 184,v,96,v,172
v_mul_f32 v77, v251, v6
MA 188,v,100,v,172
v_fmac_f32 v69, v248, v3
MA 248,v,104,v,172
MA 252,v,108,v,172
TR 172,203,16384
TR 174,203,18432
s_waitcnt lgkmcnt(2)
MA 0,v,112,v,144
MA 4,v,116,v,144
MA 64,v,120,v,144
MA 68,v,124,v,144
MA 128,v,128,v,144
MA 132,v,132,v,144
MA 192,v,136,v,144
MA 196,v,140,v,144
MA 8,v,112,v,148
MA 12,v,116,v,148
s_waitcnt vmcnt(8) lgkmcnt(0)
s_barrier
MA 72,v,120,v,148
TR 144,196,32768
TR 146,196,34816
MA 76,v,124,v,148
ds_read_b128 v[80:83], v192 offset:32768
s_add_u32 m0, s68, 98304
MA 136,v,128,v,148
v_fmac_f32 v77, v249, v7
v_fmac_f32 v69, v246, v4
MA 140,v,132,v,148
buffer_load_dwordx4 v212, s[48:51], s66 offen offset:0 lds
v_fmac_f32 v77, v247, v8
MA 200,v,136,v,148
v_fmac_f32 v69, v244, v5
v_fmac_f32 v77, v245, v9
MA 204,v,140,v,148
TR 148,197,32768
TR 150,197,34816
MA 16,v,112,v,152
ds_read_b128 v[84:87], v192 offset:34816
v_mul_f32 v69, v69, v254
MA 20,v,116,v,152
buffer_load_dwordx4 v213, s[48:51], s66 offen offset:1024 lds
v_mul_f32 v77, v77, v255
MA 80,v,120,v,152
v_cvt_pk_bf16_f32 v12, v69, v68
v_cvt_pk_bf16_f32 v13, v67, v66
MA 84,v,124,v,152
v_cvt_pk_bf16_f32 v14, v65, v64
v_cvt_pk_bf16_f32 v15, v63, v62
MA 144,v,128,v,152
s_mov_b32 s36, 0
buffer_store_dwordx4 v[12:15], v10, s[84:87], s36 offen sc1
MA 148,v,132,v,152
ds_read_b128 v[88:91], v192 offset:36864
buffer_load_dwordx4 v214, s[48:51], s66 offen offset:2048 lds
MA 208,v,136,v,152
v_cvt_pk_bf16_f32 v54, v77, v76
v_cvt_pk_bf16_f32 v55, v75, v74
MA 212,v,140,v,152
TR 152,198,32768
TR 154,198,34816
MA 24,v,112,v,156
buffer_load_dwordx4 v215, s[48:51], s66 offen offset:3072 lds
v_cvt_pk_bf16_f32 v56, v73, v72
MA 28,v,116,v,156
v_cvt_pk_bf16_f32 v57, v71, v70
s_mov_b32 s36, 4096
MA 88,v,120,v,156
ds_read_b128 v[92:95], v192 offset:38912
buffer_store_dwordx4 v[54:57], v10, s[84:87], s36 offen sc1
MA 92,v,124,v,156
v_lshlrev_b32 v2, 16, v58
v_and_b32 v3, 0xffff0000, v58
MA 152,v,128,v,156
s_add_u32 s66, s66, 524288
v_lshlrev_b32 v4, 16, v59
MA 156,v,132,v,156
v_and_b32 v5, 0xffff0000, v59
v_lshlrev_b32 v6, 16, v60
MA 216,v,136,v,156
v_and_b32 v7, 0xffff0000, v60
v_lshlrev_b32 v8, 16, v61
MA 220,v,140,v,156
TR 156,199,32768
TR 158,199,34816
MA 32,v,112,v,160
ds_read_b128 v[96:99], v192 offset:40960
s_and_b32 s66, s66, 8388607
MA 36,v,116,v,160
v_and_b32 v9, 0xffff0000, v61
v_lshlrev_b32 v230, 16, v17
MA 96,v,120,v,160
v_and_b32 v231, 0xffff0000, v17
v_lshlrev_b32 v232, 16, v19
MA 100,v,124,v,160
v_and_b32 v233, 0xffff0000, v19
v_lshlrev_b32 v234, 16, v21
MA 160,v,128,v,160
ds_read_b128 v[100:103], v192 offset:43008
s_add_u32 m0, s68, 114688
MA 164,v,132,v,160
v_and_b32 v235, 0xffff0000, v21
v_lshlrev_b32 v236, 16, v23
MA 224,v,136,v,160
v_and_b32 v237, 0xffff0000, v23
v_lshlrev_b32 v238, 16, v25
MA 228,v,140,v,160
TR 160,200,32768
TR 162,200,34816
MA 40,v,112,v,164
buffer_load_dwordx4 v212, s[48:51], s66 offen offset:0 lds
v_and_b32 v239, 0xffff0000, v25
MA 44,v,116,v,164
ds_read_b128 v[104:107], v192 offset:45056
v_lshlrev_b32 v240, 16, v27
MA 104,v,120,v,164
v_and_b32 v241, 0xffff0000, v27
v_lshlrev_b32 v242, 16, v29
MA 108,v,124,v,164
buffer_load_dwordx4 v213, s[48:51], s66 offen offset:1024 lds
v_and_b32 v243, 0xffff0000, v29
MA 168,v,128,v,164
v_lshlrev_b32 v244, 16, v31
v_and_b32 v245, 0xffff0000, v31
MA 172,v,132,v,164
v_lshlrev_b32 v246, 16, v33
v_and_b32 v247, 0xffff0000, v33
MA 232,v,136,v,164
ds_read_b128 v[108:111], v192 offset:47104
v_lshlrev_b32 v248, 16, v35
MA 236,v,140,v,164
TR 164,201,32768
TR 166,201,34816
MA 48,v,112,v,168
buffer_load_dwordx4 v214, s[48:51], s66 offen offset:2048 lds
v_and_b32 v249, 0xffff0000, v35
MA 52,v,116,v,168
v_lshlrev_b32 v250, 16, v37
v_and_b32 v251, 0xffff0000, v37
MA 112,v,120,v,168
buffer_load_dwordx4 v215, s[48:51], s66 offen offset:3072 lds
v_lshlrev_b32 v254, 16, v39
MA 116,v,124,v,168
v_and_b32 v255, 0xffff0000, v39
v_mul_f32 v62, v236, v2
MA 176,v,128,v,168
v_mul_f32 v70, v237, v6
v_fmac_f32 v62, v234, v3
MA 180,v,132,v,168
v_fmac_f32 v70, v235, v7
v_fmac_f32 v62, v232, v4
MA 240,v,136,v,168
s_add_u32 s66, s66, 524288
v_fmac_f32 v70, v233, v8
MA 244,v,140,v,168
TR 168,202,32768
TR 170,202,34816
MA 56,v,112,v,172
v_fmac_f32 v62, v230, v5
v_fmac_f32 v70, v231, v9
MA 60,v,116,v,172
v_mul_f32 v62, v62, v254
v_mul_f32 v70, v70, v255
MA 120,v,120,v,172
s_and_b32 s66, s66, 8388607
v_lshlrev_b32 v254, 16, v41
MA 124,v,124,v,172
v_and_b32 v255, 0xffff0000, v41
v_mul_f32 v63, v238, v2
MA 184,v,128,v,172
v_mul_f32 v71, v239, v6
v_fmac_f32 v63, v236, v3
MA 188,v,132,v,172
v_fmac_f32 v71, v237, v7
v_fmac_f32 v63, v234, v4
MA 248,v,136,v,172
v_fmac_f32 v71, v235, v8
v_fmac_f32 v63, v232, v5
MA 252,v,140,v,172
TR 172,203,32768
TR 174,203,34816
v_fmac_f32 v71, v233, v9
v_mul_f32 v63, v63, v254
v_mul_f32 v71, v71, v255
v_lshlrev_b32 v254, 16, v43
v_and_b32 v255, 0xffff0000, v43
v_mul_f32 v64, v240, v2
v_mul_f32 v72, v241, v6
v_fmac_f32 v64, v238, v3
s_waitcnt lgkmcnt(2)
MA 0,v,80,v,144
s_add_u32 s75, s64, s74
v_fmac_f32 v72, v239, v7
MA 4,v,84,v,144
ds_read_b128 v[112:115], v193 offset:32768
v_fmac_f32 v64, v236, v4
MA 64,v,88,v,144
v_fmac_f32 v72, v237, v8
v_fmac_f32 v64, v234, v5
MA 68,v,92,v,144
v_fmac_f32 v72, v235, v9
v_mul_f32 v64, v64, v254
MA 128,v,96,v,144
s_add_u32 m0, s67, 0
v_mul_f32 v72, v72, v255
MA 132,v,100,v,144
v_lshlrev_b32 v254, 16, v45
MA 192,v,104,v,144
v_and_b32 v255, 0xffff0000, v45
v_mul_f32 v65, v242, v2
MA 196,v,108,v,144
TR 144,196,49152
TR 146,196,51200
MA 8,v,80,v,148
ds_read_b128 v[116:119], v193 offset:34816
buffer_load_dwordx4 v208, s[44:47], s75 offen offset:0 lds
MA 12,v,84,v,148
v_mul_f32 v73, v243, v6
v_fmac_f32 v65, v240, v3
MA 72,v,88,v,148
v_fmac_f32 v73, v241, v7
v_fmac_f32 v65, v238, v4
MA 76,v,92,v,148
v_fmac_f32 v73, v239, v8
v_fmac_f32 v65, v236, v5
MA 136,v,96,v,148
v_fmac_f32 v73, v237, v9
MA 140,v,100,v,148
ds_read_b128 v[120:123], v193 offset:36864
buffer_load_dwordx4 v209, s[44:47], s75 offen offset:1024 lds
MA 200,v,104,v,148
v_mul_f32 v65, v65, v254
v_mul_f32 v73, v73, v255
MA 204,v,108,v,148
TR 148,197,49152
TR 150,197,51200
MA 16,v,80,v,152
v_lshlrev_b32 v254, 16, v47
v_and_b32 v255, 0xffff0000, v47
MA 20,v,84,v,152
buffer_load_dwordx4 v210, s[44:47], s75 offen offset:2048 lds
v_mul_f32 v66, v244, v2
MA 80,v,88,v,152
v_mul_f32 v74, v245, v6
v_fmac_f32 v66, v242, v3
MA 84,v,92,v,152
v_fmac_f32 v74, v243, v7
v_fmac_f32 v66, v240, v4
MA 144,v,96,v,152
ds_read_b128 v[124:127], v193 offset:38912
v_fmac_f32 v74, v241, v8
MA 148,v,100,v,152
v_fmac_f32 v66, v238, v5
v_fmac_f32 v74, v239, v9
MA 208,v,104,v,152
buffer_load_dwordx4 v211, s[44:47], s75 offen offset:3072 lds
v_mul_f32 v66, v66, v254
MA 212,v,108,v,152
TR 152,198,49152
TR 154,198,51200
MA 24,v,80,v,156
v_mul_f32 v74, v74, v255
v_lshlrev_b32 v254, 16, v49
MA 28,v,84,v,156
v_and_b32 v255, 0xffff0000, v49
v_mul_f32 v67, v246, v2
MA 88,v,88,v,156
ds_read_b128 v[128:131], v193 offset:40960
s_add_u32 s75, s65, s74
MA 92,v,92,v,156
v_mul_f32 v75, v247, v6
v_fmac_f32 v67, v244, v3
MA 152,v,96,v,156
v_fmac_f32 v75, v245, v7
v_fmac_f32 v67, v242, v4
MA 156,v,100,v,156
v_fmac_f32 v75, v243, v8
MA 216,v,104,v,156
v_fmac_f32 v67, v240, v5
MA 220,v,108,v,156
TR 156,199,49152
TR 158,199,51200
MA 32,v,80,v,160
ds_read_b128 v[132:135], v193 offset:43008
s_add_u32 m0, s67, 4096
MA 36,v,84,v,160
v_fmac_f32 v75, v241, v9
v_mul_f32 v67, v67, v254
MA 96,v,88,v,160
v_mul_f32 v75, v75, v255
v_lshlrev_b32 v254, 16, v51
MA 100,v,92,v,160
buffer_load_dwordx4 v208, s[44:47], s75 offen offset:0 lds
v_and_b32 v255, 0xffff0000, v51
MA 160,v,96,v,160
v_mul_f32 v68, v248, v2
v_mul_f32 v76, v249, v6
MA 164,v,100,v,160
v_fmac_f32 v68, v246, v3
v_fmac_f32 v76, v247, v7
MA 224,v,104,v,160
v_fmac_f32 v68, v244, v4
v_fmac_f32 v76, v245, v8
MA 228,v,108,v,160
TR 160,200,49152
TR 162,200,51200
MA 40,v,80,v,164
ds_read_b128 v[136:139], v193 offset:45056
buffer_load_dwordx4 v209, s[44:47], s75 offen offset:1024 lds
MA 44,v,84,v,164
v_fmac_f32 v68, v242, v5
v_fmac_f32 v76, v243, v9
MA 104,v,88,v,164
v_mul_f32 v68, v68, v254
v_mul_f32 v76, v76, v255
MA 108,v,92,v,164
v_lshlrev_b32 v254, 16, v53
v_and_b32 v255, 0xffff0000, v53
MA 168,v,96,v,164
buffer_load_dwordx4 v210, s[44:47], s75 offen offset:2048 lds
v_mul_f32 v69, v250, v2
MA 172,v,100,v,164
ds_read_b128 v[140:143], v193 offset:47104
v_mul_f32 v77, v251, v6
MA 232,v,104,v,164
v_fmac_f32 v69, v248, v3
v_fmac_f32 v77, v249, v7
MA 236,v,108,v,164
TR 164,201,49152
TR 166,201,51200
MA 48,v,80,v,168
buffer_load_dwordx4 v211, s[44:47], s75 offen offset:3072 lds
v_fmac_f32 v69, v246, v4
MA 52,v,84,v,168
v_fmac_f32 v77, v247, v8
v_fmac_f32 v69, v244, v5
MA 112,v,88,v,168
v_fmac_f32 v77, v245, v9
v_mul_f32 v69, v69, v254
MA 116,v,92,v,168
v_mul_f32 v77, v77, v255
v_cvt_pk_bf16_f32 v230, v69, v68
MA 176,v,96,v,168
v_cvt_pk_bf16_f32 v231, v67, v66
MA 180,v,100,v,168
s_add_u32 s74, s74, 128
v_cvt_pk_bf16_f32 v232, v65, v64
MA 240,v,104,v,168
v_cvt_pk_bf16_f32 v233, v63, v62
MA 244,v,108,v,168
TR 168,202,49152
TR 170,202,51200
s_waitcnt lgkmcnt(15)
MA 56,v,80,v,172
s_mov_b32 s36, 8192
buffer_store_dwordx4 v[230:233], v10, s[84:87], s36 offen sc1
MA 60,v,84,v,172
s_and_b32 s74, s74, 2047
v_cvt_pk_bf16_f32 v234, v77, v76
MA 120,v,88,v,172
v_cvt_pk_bf16_f32 v235, v75, v74
v_cvt_pk_bf16_f32 v236, v73, v72
MA 124,v,92,v,172
v_cvt_pk_bf16_f32 v237, v71, v70
s_mov_b32 s36, 12288
MA 184,v,96,v,172
buffer_store_dwordx4 v[234:237], v10, s[84:87], s36 offen sc1
MA 188,v,100,v,172
v_lshlrev_b32 v228, 4, v1
MA 248,v,104,v,172
MA 252,v,108,v,172
TR 172,203,49152
TR 174,203,51200
s_waitcnt lgkmcnt(2)
MA 0,v,112,v,144
MA 4,v,116,v,144
MA 64,v,120,v,144
MA 68,v,124,v,144
MA 128,v,128,v,144
MA 132,v,132,v,144
MA 192,v,136,v,144
MA 196,v,140,v,144
MA 8,v,112,v,148
MA 12,v,116,v,148
s_waitcnt vmcnt(15) lgkmcnt(0)
s_barrier
MA 72,v,120,v,148
ds_read_b128 v[48:51], v226 offset:0
s_add_u32 m0, s68, 131072
MA 76,v,124,v,148
MA 136,v,128,v,148
ds_read_b128 v[52:55], v226 offset:2048
buffer_load_dwordx4 v212, s[48:51], s66 offen offset:0 lds
MA 140,v,132,v,148
MA 200,v,136,v,148
ds_read_b128 v[56:59], v226 offset:4096
buffer_load_dwordx4 v213, s[48:51], s66 offen offset:1024 lds
MA 204,v,140,v,148
MA 16,v,112,v,152
ds_read_b128 v[60:63], v226 offset:6144
MA 20,v,116,v,152
buffer_load_dwordx4 v214, s[48:51], s66 offen offset:2048 lds
MA 80,v,120,v,152
TR 16,216,0
MA 84,v,124,v,152
buffer_load_dwordx4 v215, s[48:51], s66 offen offset:3072 lds
MA 144,v,128,v,152
TR 18,216,1024
MA 148,v,132,v,152
MA 208,v,136,v,152
TR 20,217,0
s_add_u32 s66, s66, 524288
MA 212,v,140,v,152
MA 24,v,112,v,156
TR 22,217,1024
s_and_b32 s66, s66, 8388607
MA 28,v,116,v,156
MA 88,v,120,v,156
TR 24,218,0
MA 92,v,124,v,156
s_add_u32 s75, s64, s74
MA 152,v,128,v,156
TR 26,218,1024
MA 156,v,132,v,156
s_add_u32 m0, s67, 32768
MA 216,v,136,v,156
TR 28,219,0
MA 220,v,140,v,156
MA 32,v,112,v,160
TR 30,219,1024
buffer_load_dwordx4 v208, s[44:47], s75 offen offset:0 lds
MA 36,v,116,v,160
MA 96,v,120,v,160
TR 32,220,0
buffer_load_dwordx4 v209, s[44:47], s75 offen offset:1024 lds
MA 100,v,124,v,160
MA 160,v,128,v,160
TR 34,220,1024
MA 164,v,132,v,160
buffer_load_dwordx4 v210, s[44:47], s75 offen offset:2048 lds
MA 224,v,136,v,160
TR 36,221,0
MA 228,v,140,v,160
buffer_load_dwordx4 v211, s[44:47], s75 offen offset:3072 lds
MA 40,v,112,v,164
TR 38,221,1024
MA 44,v,116,v,164
MA 104,v,120,v,164
TR 40,222,0
s_add_u32 s75, s65, s74
MA 108,v,124,v,164
MA 168,v,128,v,164
TR 42,222,1024
s_add_u32 m0, s67, 36864
MA 172,v,132,v,164
MA 232,v,136,v,164
TR 44,223,0
MA 236,v,140,v,164
buffer_load_dwordx4 v208, s[44:47], s75 offen offset:0 lds
MA 48,v,112,v,168
TR 46,223,1024
MA 52,v,116,v,168
buffer_load_dwordx4 v209, s[44:47], s75 offen offset:1024 lds
MA 112,v,120,v,168
MA 116,v,124,v,168
MA 176,v,128,v,168
buffer_load_dwordx4 v210, s[44:47], s75 offen offset:2048 lds
MA 180,v,132,v,168
MA 240,v,136,v,168
buffer_load_dwordx4 v211, s[44:47], s75 offen offset:3072 lds
MA 244,v,140,v,168
MA 56,v,112,v,172
MA 60,v,116,v,172
s_add_u32 s74, s74, 128
MA 120,v,120,v,172
MA 124,v,124,v,172
s_and_b32 s74, s74, 2047
MA 184,v,128,v,172
MA 188,v,132,v,172
MA 248,v,136,v,172
MA 252,v,140,v,172
L_p2:
s_waitcnt lgkmcnt(4)
v_mfma_f32_16x16x32_bf16 v[80:83], v[16:19], v[48:51], 0
s_add_u32 s8, s40, 59768832
s_addc_u32 s9, s41, 0
v_mfma_f32_16x16x32_bf16 v[84:87], v[16:19], v[52:55], 0
ds_read_b128 v[64:67], v227 offset:0
v_mfma_f32_16x16x32_bf16 v[88:91], v[16:19], v[56:59], 0
s_mov_b32 s10, 4096
v_mfma_f32_16x16x32_bf16 v[92:95], v[16:19], v[60:63], 0
TR 16,216,8192
TR 18,216,9216
v_mfma_f32_16x16x32_bf16 v[96:99], v[20:23], v[48:51], 0
s_mov_b32 s11, 0x20000
s_mov_b32 s12, s38
v_mfma_f32_16x16x32_bf16 v[100:103], v[20:23], v[52:55], 0
s_mov_b32 s13, s39
v_mfma_f32_16x16x32_bf16 v[104:107], v[20:23], v[56:59], 0
ds_read_b128 v[68:71], v227 offset:2048
s_mov_b32 s14, 256
v_mfma_f32_16x16x32_bf16 v[108:111], v[20:23], v[60:63], 0
TR 20,217,8192
TR 22,217,9216
v_mfma_f32_16x16x32_bf16 v[112:115], v[24:27], v[48:51], 0
s_mov_b32 s15, 0x20000
v_accvgpr_read_b32 v234, a0
v_mfma_f32_16x16x32_bf16 v[116:119], v[24:27], v[52:55], 0
v_accvgpr_read_b32 v235, a1
v_mfma_f32_16x16x32_bf16 v[120:123], v[24:27], v[56:59], 0
v_accvgpr_read_b32 v236, a2
v_mfma_f32_16x16x32_bf16 v[124:127], v[24:27], v[60:63], 0
TR 24,218,8192
TR 26,218,9216
v_mfma_f32_16x16x32_bf16 v[128:131], v[28:31], v[48:51], 0
ds_read_b128 v[72:75], v227 offset:4096
v_accvgpr_read_b32 v237, a3
v_mfma_f32_16x16x32_bf16 v[132:135], v[28:31], v[52:55], 0
v_accvgpr_read_b32 v238, a4
v_accvgpr_read_b32 v239, a5
v_mfma_f32_16x16x32_bf16 v[136:139], v[28:31], v[56:59], 0
v_accvgpr_read_b32 v240, a6
v_mfma_f32_16x16x32_bf16 v[140:143], v[28:31], v[60:63], 0
TR 28,219,8192
TR 30,219,9216
v_mfma_f32_16x16x32_bf16 v[144:147], v[32:35], v[48:51], 0
v_accvgpr_read_b32 v241, a7
v_cvt_pk_bf16_f32 v230, v234, v235
v_mfma_f32_16x16x32_bf16 v[148:151], v[32:35], v[52:55], 0
v_cvt_pk_bf16_f32 v231, v236, v237
v_mfma_f32_16x16x32_bf16 v[152:155], v[32:35], v[56:59], 0
ds_read_b128 v[76:79], v227 offset:6144
v_cvt_pk_bf16_f32 v232, v238, v239
v_mfma_f32_16x16x32_bf16 v[156:159], v[32:35], v[60:63], 0
TR 32,220,8192
TR 34,220,9216
v_mfma_f32_16x16x32_bf16 v[160:163], v[36:39], v[48:51], 0
v_cvt_pk_bf16_f32 v233, v240, v241
buffer_store_dwordx4 v[230:233], v228, s[16:19], s24 offen offset:0 sc1
v_mfma_f32_16x16x32_bf16 v[164:167], v[36:39], v[52:55], 0
v_accvgpr_read_b32 v246, a8
v_mfma_f32_16x16x32_bf16 v[168:171], v[36:39], v[56:59], 0
v_accvgpr_read_b32 v247, a9
v_mfma_f32_16x16x32_bf16 v[172:175], v[36:39], v[60:63], 0
TR 36,221,8192
TR 38,221,9216
s_waitcnt lgkmcnt(15)
v_mfma_f32_16x16x32_bf16 v[176:179], v[40:43], v[48:51], 0
v_accvgpr_read_b32 v248, a10
v_accvgpr_read_b32 v249, a11
v_mfma_f32_16x16x32_bf16 v[180:183], v[40:43], v[52:55], 0
v_accvgpr_read_b32 v250, a12
v_mfma_f32_16x16x32_bf16 v[184:187], v[40:43], v[56:59], 0
v_accvgpr_read_b32 v251, a13
v_mfma_f32_16x16x32_bf16 v[188:191], v[40:43], v[60:63], 0
TR 40,222,8192
TR 42,222,9216
v_mfma_f32_16x16x32_bf16 v[192:195], v[44:47], v[48:51], 0
v_accvgpr_read_b32 v252, a14
v_accvgpr_read_b32 v253, a15
v_mfma_f32_16x16x32_bf16 v[196:199], v[44:47], v[52:55], 0
v_mfma_f32_16x16x32_bf16 v[200:203], v[44:47], v[56:59], 0
v_mfma_f32_16x16x32_bf16 v[204:207], v[44:47], v[60:63], 0
TR 44,223,8192
TR 46,223,9216
s_waitcnt lgkmcnt(4)
MV 80,v,16,v,64
v_cvt_pk_bf16_f32 v242, v246, v247
MV 84,v,16,v,68
v_cvt_pk_bf16_f32 v243, v248, v249
MV 88,v,16,v,72
v_cvt_pk_bf16_f32 v244, v250, v251
MV 92,v,16,v,76
MV 96,v,20,v,64
v_cvt_pk_bf16_f32 v245, v252, v253
MV 100,v,20,v,68
buffer_store_dwordx4 v[242:245], v228, s[16:19], s24 offen offset:1024 sc1
MV 104,v,20,v,72
MV 108,v,20,v,76
s_waitcnt vmcnt(16) lgkmcnt(0)
s_barrier
MV 112,v,24,v,64
TR 16,216,16384
TR 18,216,17408
MV 116,v,24,v,68
ds_read_b128 v[48:51], v224 offset:0
s_add_u32 m0, s68, 98304
MV 120,v,24,v,72
TR 20,217,16384
TR 22,217,17408
MV 124,v,24,v,76
buffer_load_dwordx4 v212, s[48:51], s66 offen offset:0 lds
v_accvgpr_read_b32 v234, a16
MV 128,v,28,v,64
TR 24,218,16384
TR 26,218,17408
MV 132,v,28,v,68
ds_read_b128 v[52:55], v224 offset:2048
buffer_load_dwordx4 v213, s[48:51], s66 offen offset:1024 lds
MV 136,v,28,v,72
buffer_load_dwordx4 v214, s[48:51], s66 offen offset:2048 lds
v_accvgpr_read_b32 v235, a17
MV 140,v,28,v,76
TR 28,219,16384
TR 30,219,17408
MV 144,v,32,v,64
ds_read_b128 v[56:59], v224 offset:4096
v_accvgpr_read_b32 v236, a18
MV 148,v,32,v,68
buffer_load_dwordx4 v215, s[48:51], s66 offen offset:3072 lds
v_accvgpr_read_b32 v237, a19
MV 152,v,32,v,72
v_accvgpr_read_b32 v238, a20
v_accvgpr_read_b32 v239, a21
MV 156,v,32,v,76
TR 32,220,16384
TR 34,220,17408
MV 160,v,36,v,64
ds_read_b128 v[60:63], v224 offset:6144
s_add_u32 s66, s66, 524288
MV 164,v,36,v,68
s_and_b32 s66, s66, 8388607
v_accvgpr_read_b32 v240, a22
MV 168,v,36,v,72
v_accvgpr_read_b32 v241, a23
v_cvt_pk_bf16_f32 v230, v234, v235
MV 172,v,36,v,76
TR 36,221,16384
TR 38,221,17408
MV 176,v,40,v,64
s_add_u32 s75, s64, s74
v_cvt_pk_bf16_f32 v231, v236, v237
MV 180,v,40,v,68
v_cvt_pk_bf16_f32 v232, v238, v239
v_cvt_pk_bf16_f32 v233, v240, v241
MV 184,v,40,v,72
s_add_u32 m0, s67, 65536
buffer_store_dwordx4 v[230:233], v228, s[16:19], s24 offen offset:2048 sc1
MV 188,v,40,v,76
TR 40,222,16384
TR 42,222,17408
MV 192,v,44,v,64
buffer_load_dwordx4 v208, s[44:47], s75 offen offset:0 lds
v_accvgpr_read_b32 v246, a24
MV 196,v,44,v,68
v_accvgpr_read_b32 v247, a25
v_accvgpr_read_b32 v248, a26
MV 200,v,44,v,72
MV 204,v,44,v,76
TR 44,223,16384
TR 46,223,17408
s_waitcnt lgkmcnt(4)
MV 80,v,16,v,48
buffer_load_dwordx4 v209, s[44:47], s75 offen offset:1024 lds
v_accvgpr_read_b32 v249, a27
MV 84,v,16,v,52
ds_read_b128 v[64:67], v225 offset:0
v_accvgpr_read_b32 v250, a28
MV 88,v,16,v,56
buffer_load_dwordx4 v210, s[44:47], s75 offen offset:2048 lds
v_accvgpr_read_b32 v251, a29
MV 92,v,16,v,60
TR 16,216,24576
TR 18,216,25600
MV 96,v,20,v,48
v_accvgpr_read_b32 v252, a30
MV 100,v,20,v,52
buffer_load_dwordx4 v211, s[44:47], s75 offen offset:3072 lds
v_accvgpr_read_b32 v253, a31
MV 104,v,20,v,56
ds_read_b128 v[68:71], v225 offset:2048
MV 108,v,20,v,60
TR 20,217,24576
TR 22,217,25600
MV 112,v,24,v,48
s_add_u32 s75, s65, s74
v_cvt_pk_bf16_f32 v242, v246, v247
MV 116,v,24,v,52
v_cvt_pk_bf16_f32 v243, v248, v249
MV 120,v,24,v,56
v_cvt_pk_bf16_f32 v244, v250, v251
MV 124,v,24,v,60
TR 24,218,24576
TR 26,218,25600
MV 128,v,28,v,48
ds_read_b128 v[72:75], v225 offset:4096
s_add_u32 m0, s67, 69632
MV 132,v,28,v,52
v_cvt_pk_bf16_f32 v245, v252, v253
buffer_store_dwordx4 v[242:245], v228, s[16:19], s24 offen offset:3072 sc1
MV 136,v,28,v,56
buffer_load_dwordx4 v208, s[44:47], s75 offen offset:0 lds
v_accvgpr_read_b32 v234, a32
MV 140,v,28,v,60
TR 28,219,24576
TR 30,219,25600
MV 144,v,32,v,48
buffer_load_dwordx4 v209, s[44:47], s75 offen offset:1024 lds
v_accvgpr_read_b32 v235, a33
MV 148,v,32,v,52
v_accvgpr_read_b32 v236, a34
MV 152,v,32,v,56
ds_read_b128 v[76:79], v225 offset:6144
v_accvgpr_read_b32 v237, a35
MV 156,v,32,v,60
TR 32,220,24576
TR 34,220,25600
MV 160,v,36,v,48
buffer_load_dwordx4 v210, s[44:47], s75 offen offset:2048 lds
v_accvgpr_read_b32 v238, a36
MV 164,v,36,v,52
v_accvgpr_read_b32 v239, a37
MV 168,v,36,v,56
buffer_load_dwordx4 v211, s[44:47], s75 offen offset:3072 lds
v_accvgpr_read_b32 v240, a38
MV 172,v,36,v,60
TR 36,221,24576
TR 38,221,25600
s_waitcnt lgkmcnt(15)
MV 176,v,40,v,48
v_accvgpr_read_b32 v241, a39
MV 180,v,40,v,52
s_add_u32 s74, s74, 128
v_cvt_pk_bf16_f32 v230, v234, v235
MV 184,v,40,v,56
MV 188,v,40,v,60
TR 40,222,24576
TR 42,222,25600
MV 192,v,44,v,48
s_and_b32 s74, s74, 2047
v_cvt_pk_bf16_f32 v231, v236, v237
MV 196,v,44,v,52
v_cvt_pk_bf16_f32 v232, v238, v239
MV 200,v,44,v,56
MV 204,v,44,v,60
TR 44,223,24576
TR 46,223,25600
s_waitcnt lgkmcnt(4)
MV 80,v,16,v,64
v_cvt_pk_bf16_f32 v233, v240, v241
MV 84,v,16,v,68
s_add_u32 s24, s24, 4096
MV 88,v,16,v,72
buffer_store_dwordx4 v[230:233], v228, s[16:19], s24 offen offset:0 sc1
MV 92,v,16,v,76
MV 96,v,20,v,64
v_accvgpr_read_b32 v246, a40
MV 100,v,20,v,68
v_accvgpr_read_b32 v247, a41
MV 104,v,20,v,72
MV 108,v,20,v,76
s_waitcnt vmcnt(17) lgkmcnt(0)
s_barrier
MV 112,v,24,v,64
TR 16,216,32768
TR 18,216,33792
MV 116,v,24,v,68
ds_read_b128 v[48:51], v224 offset:32768
s_add_u32 m0, s68, 114688
MV 120,v,24,v,72
TR 20,217,32768
TR 22,217,33792
MV 124,v,24,v,76
buffer_load_dwordx4 v212, s[48:51], s66 offen offset:0 lds
v_accvgpr_read_b32 v248, a42
MV 128,v,28,v,64
TR 24,218,32768
TR 26,218,33792
MV 132,v,28,v,68
ds_read_b128 v[52:55], v224 offset:34816
buffer_load_dwordx4 v213, s[48:51], s66 offen offset:1024 lds
MV 136,v,28,v,72
buffer_load_dwordx4 v214, s[48:51], s66 offen offset:2048 lds
v_accvgpr_read_b32 v249, a43
MV 140,v,28,v,76
TR 28,219,32768
TR 30,219,33792
MV 144,v,32,v,64
ds_read_b128 v[56:59], v224 offset:36864
v_accvgpr_read_b32 v250, a44
MV 148,v,32,v,68
buffer_load_dwordx4 v215, s[48:51], s66 offen offset:3072 lds
v_accvgpr_read_b32 v251, a45
MV 152,v,32,v,72
v_accvgpr_read_b32 v252, a46
v_accvgpr_read_b32 v253, a47
MV 156,v,32,v,76
TR 32,220,32768
TR 34,220,33792
MV 160,v,36,v,64
ds_read_b128 v[60:63], v224 offset:38912
s_add_u32 s66, s66, 524288
MV 164,v,36,v,68
s_and_b32 s66, s66, 8388607
v_cvt_pk_bf16_f32 v242, v246, v247
MV 168,v,36,v,72
v_cvt_pk_bf16_f32 v243, v248, v249
v_cvt_pk_bf16_f32 v244, v250, v251
MV 172,v,36,v,76
TR 36,221,32768
TR 38,221,33792
MV 176,v,40,v,64
s_add_u32 s75, s64, s74
v_cvt_pk_bf16_f32 v245, v252, v253
MV 180,v,40,v,68
buffer_store_dwordx4 v[242:245], v228, s[16:19], s24 offen offset:1024 sc1
v_accvgpr_read_b32 v234, a48
MV 184,v,40,v,72
s_add_u32 m0, s67, 0
v_accvgpr_read_b32 v235, a49
MV 188,v,40,v,76
TR 40,222,32768
TR 42,222,33792
MV 192,v,44,v,64
buffer_load_dwordx4 v208, s[44:47], s75 offen offset:0 lds
v_accvgpr_read_b32 v236, a50
MV 196,v,44,v,68
v_accvgpr_read_b32 v237, a51
v_accvgpr_read_b32 v238, a52
MV 200,v,44,v,72
MV 204,v,44,v,76
TR 44,223,32768
TR 46,223,33792
s_waitcnt lgkmcnt(4)
MV 80,v,16,v,48
buffer_load_dwordx4 v209, s[44:47], s75 offen offset:1024 lds
v_accvgpr_read_b32 v239, a53
MV 84,v,16,v,52
ds_read_b128 v[64:67], v225 offset:32768
v_accvgpr_read_b32 v240, a54
MV 88,v,16,v,56
buffer_load_dwordx4 v210, s[44:47], s75 offen offset:2048 lds
v_accvgpr_read_b32 v241, a55
MV 92,v,16,v,60
TR 16,216,40960
TR 18,216,41984
MV 96,v,20,v,48
v_cvt_pk_bf16_f32 v230, v234, v235
MV 100,v,20,v,52
buffer_load_dwordx4 v211, s[44:47], s75 offen offset:3072 lds
v_cvt_pk_bf16_f32 v231, v236, v237
MV 104,v,20,v,56
ds_read_b128 v[68:71], v225 offset:34816
MV 108,v,20,v,60
TR 20,217,40960
TR 22,217,41984
MV 112,v,24,v,48
s_add_u32 s75, s65, s74
v_cvt_pk_bf16_f32 v232, v238, v239
MV 116,v,24,v,52
v_cvt_pk_bf16_f32 v233, v240, v241
MV 120,v,24,v,56
buffer_store_dwordx4 v[230:233], v228, s[16:19], s24 offen offset:2048 sc1
MV 124,v,24,v,60
TR 24,218,40960
TR 26,218,41984
MV 128,v,28,v,48
ds_read_b128 v[72:75], v225 offset:36864
s_add_u32 m0, s67, 4096
MV 132,v,28,v,52
v_accvgpr_read_b32 v246, a56
v_accvgpr_read_b32 v247, a57
MV 136,v,28,v,56
buffer_load_dwordx4 v208, s[44:47], s75 offen offset:0 lds
v_accvgpr_read_b32 v248, a58
MV 140,v,28,v,60
TR 28,219,40960
TR 30,219,41984
MV 144,v,32,v,48
buffer_load_dwordx4 v209, s[44:47], s75 offen offset:1024 lds
v_accvgpr_read_b32 v249, a59
MV 148,v,32,v,52
v_accvgpr_read_b32 v250, a60
MV 152,v,32,v,56
ds_read_b128 v[76:79], v225 offset:38912
v_accvgpr_read_b32 v251, a61
MV 156,v,32,v,60
TR 32,220,40960
TR 34,220,41984
MV 160,v,36,v,48
buffer_load_dwordx4 v210, s[44:47], s75 offen offset:2048 lds
v_accvgpr_read_b32 v252, a62
MV 164,v,36,v,52
v_accvgpr_read_b32 v253, a63
MV 168,v,36,v,56
buffer_load_dwordx4 v211, s[44:47], s75 offen offset:3072 lds
v_cvt_pk_bf16_f32 v242, v246, v247
MV 172,v,36,v,60
TR 36,221,40960
TR 38,221,41984
s_waitcnt lgkmcnt(15)
MV 176,v,40,v,48
v_cvt_pk_bf16_f32 v243, v248, v249
MV 180,v,40,v,52
s_add_u32 s74, s74, 128
v_cvt_pk_bf16_f32 v244, v250, v251
MV 184,v,40,v,56
MV 188,v,40,v,60
TR 40,222,40960
TR 42,222,41984
MV 192,v,44,v,48
s_and_b32 s74, s74, 2047
v_cvt_pk_bf16_f32 v245, v252, v253
MV 196,v,44,v,52
buffer_store_dwordx4 v[242:245], v228, s[16:19], s24 offen offset:3072 sc1
MV 200,v,44,v,56
MV 204,v,44,v,60
TR 44,223,40960
TR 46,223,41984
s_waitcnt lgkmcnt(4)
MV 80,v,16,v,64
v_accvgpr_read_b32 v234, a64
MV 84,v,16,v,68
v_accvgpr_read_b32 v235, a65
MV 88,v,16,v,72
v_accvgpr_read_b32 v236, a66
MV 92,v,16,v,76
MV 96,v,20,v,64
v_accvgpr_read_b32 v237, a67
MV 100,v,20,v,68
v_accvgpr_read_b32 v238, a68
MV 104,v,20,v,72
MV 108,v,20,v,76
s_waitcnt vmcnt(16) lgkmcnt(0)
s_barrier
MV 112,v,24,v,64
TR 16,216,0
TR 18,216,1024
MV 116,v,24,v,68
ds_read_b128 v[48:51], v226 offset:0
s_add_u32 m0, s68, 131072
MV 120,v,24,v,72
TR 20,217,0
TR 22,217,1024
MV 124,v,24,v,76
buffer_load_dwordx4 v212, s[48:51], s66 offen offset:0 lds
v_accvgpr_read_b32 v239, a69
MV 128,v,28,v,64
TR 24,218,0
TR 26,218,1024
MV 132,v,28,v,68
ds_read_b128 v[52:55], v226 offset:2048
buffer_load_dwordx4 v213, s[48:51], s66 offen offset:1024 lds
MV 136,v,28,v,72
buffer_load_dwordx4 v214, s[48:51], s66 offen offset:2048 lds
v_accvgpr_read_b32 v240, a70
MV 140,v,28,v,76
TR 28,219,0
TR 30,219,1024
MV 144,v,32,v,64
ds_read_b128 v[56:59], v226 offset:4096
v_accvgpr_read_b32 v241, a71
MV 148,v,32,v,68
buffer_load_dwordx4 v215, s[48:51], s66 offen offset:3072 lds
v_cvt_pk_bf16_f32 v230, v234, v235
MV 152,v,32,v,72
v_cvt_pk_bf16_f32 v231, v236, v237
v_cvt_pk_bf16_f32 v232, v238, v239
MV 156,v,32,v,76
TR 32,220,0
TR 34,220,1024
MV 160,v,36,v,64
ds_read_b128 v[60:63], v226 offset:6144
s_add_u32 s66, s66, 524288
MV 164,v,36,v,68
s_and_b32 s66, s66, 8388607
v_cvt_pk_bf16_f32 v233, v240, v241
MV 168,v,36,v,72
s_add_u32 s24, s24, 4096
buffer_store_dwordx4 v[230:233], v228, s[16:19], s24 offen offset:0 sc1
MV 172,v,36,v,76
TR 36,221,0
TR 38,221,1024
MV 176,v,40,v,64
s_add_u32 s75, s64, s74
v_accvgpr_read_b32 v246, a72
MV 180,v,40,v,68
v_accvgpr_read_b32 v247, a73
v_accvgpr_read_b32 v248, a74
MV 184,v,40,v,72
s_add_u32 m0, s67, 32768
v_accvgpr_read_b32 v249, a75
MV 188,v,40,v,76
TR 40,222,0
TR 42,222,1024
MV 192,v,44,v,64
buffer_load_dwordx4 v208, s[44:47], s75 offen offset:0 lds
v_accvgpr_read_b32 v250, a76
MV 196,v,44,v,68
v_accvgpr_read_b32 v251, a77
v_accvgpr_read_b32 v252, a78
MV 200,v,44,v,72
MV 204,v,44,v,76
TR 44,223,0
TR 46,223,1024
s_waitcnt lgkmcnt(4)
MV 80,v,16,v,48
buffer_load_dwordx4 v209, s[44:47], s75 offen offset:1024 lds
v_accvgpr_read_b32 v253, a79
MV 84,v,16,v,52
ds_read_b128 v[64:67], v227 offset:0
v_cvt_pk_bf16_f32 v242, v246, v247
MV 88,v,16,v,56
buffer_load_dwordx4 v210, s[44:47], s75 offen offset:2048 lds
v_cvt_pk_bf16_f32 v243, v248, v249
MV 92,v,16,v,60
TR 16,216,8192
TR 18,216,9216
MV 96,v,20,v,48
v_cvt_pk_bf16_f32 v244, v250, v251
MV 100,v,20,v,52
buffer_load_dwordx4 v211, s[44:47], s75 offen offset:3072 lds
v_cvt_pk_bf16_f32 v245, v252, v253
MV 104,v,20,v,56
ds_read_b128 v[68:71], v227 offset:2048
buffer_store_dwordx4 v[242:245], v228, s[16:19], s24 offen offset:1024 sc1
MV 108,v,20,v,60
TR 20,217,8192
TR 22,217,9216
MV 112,v,24,v,48
s_add_u32 s75, s65, s74
v_accvgpr_read_b32 v234, a80
MV 116,v,24,v,52
v_accvgpr_read_b32 v235, a81
MV 120,v,24,v,56
v_accvgpr_read_b32 v236, a82
MV 124,v,24,v,60
TR 24,218,8192
TR 26,218,9216
MV 128,v,28,v,48
ds_read_b128 v[72:75], v227 offset:4096
s_add_u32 m0, s67, 36864
MV 132,v,28,v,52
v_accvgpr_read_b32 v237, a83
v_accvgpr_read_b32 v238, a84
MV 136,v,28,v,56
buffer_load_dwordx4 v208, s[44:47], s75 offen offset:0 lds
MV 140,v,28,v,60
TR 28,219,8192
TR 30,219,9216
MV 144,v,32,v,48
buffer_load_dwordx4 v209, s[44:47], s75 offen offset:1024 lds
v_accvgpr_read_b32 v239, a85
MV 148,v,32,v,52
v_accvgpr_read_b32 v240, a86
v_accvgpr_read_b32 v241, a87
MV 152,v,32,v,56
ds_read_b128 v[76:79], v227 offset:6144
MV 156,v,32,v,60
TR 32,220,8192
TR 34,220,9216
MV 160,v,36,v,48
buffer_load_dwordx4 v210, s[44:47], s75 offen offset:2048 lds
v_cvt_pk_bf16_f32 v230, v234, v235
MV 164,v,36,v,52
v_cvt_pk_bf16_f32 v231, v236, v237
v_cvt_pk_bf16_f32 v232, v238, v239
MV 168,v,36,v,56
buffer_load_dwordx4 v211, s[44:47], s75 offen offset:3072 lds
MV 172,v,36,v,60
TR 36,221,8192
TR 38,221,9216
s_waitcnt lgkmcnt(15)
MV 176,v,40,v,48
v_cvt_pk_bf16_f32 v233, v240, v241
buffer_store_dwordx4 v[230:233], v228, s[16:19], s24 offen offset:2048 sc1
MV 180,v,40,v,52
s_add_u32 s74, s74, 128
v_accvgpr_read_b32 v246, a88
MV 184,v,40,v,56
MV 188,v,40,v,60
TR 40,222,8192
TR 42,222,9216
MV 192,v,44,v,48
s_and_b32 s74, s74, 2047
v_accvgpr_read_b32 v247, a89
MV 196,v,44,v,52
v_accvgpr_read_b32 v248, a90
MV 200,v,44,v,56
MV 204,v,44,v,60
TR 44,223,8192
TR 46,223,9216
s_waitcnt lgkmcnt(4)
MV 80,v,16,v,64
v_accvgpr_read_b32 v249, a91
MV 84,v,16,v,68
v_accvgpr_read_b32 v250, a92
MV 88,v,16,v,72
v_accvgpr_read_b32 v251, a93
MV 92,v,16,v,76
MV 96,v,20,v,64
v_accvgpr_read_b32 v252, a94
MV 100,v,20,v,68
v_accvgpr_read_b32 v253, a95
MV 104,v,20,v,72
MV 108,v,20,v,76
s_waitcnt vmcnt(16) lgkmcnt(0)
s_barrier
MV 112,v,24,v,64
TR 16,216,16384
TR 18,216,17408
MV 116,v,24,v,68
ds_read_b128 v[48:51], v224 offset:0
s_add_u32 m0, s68, 98304
MV 120,v,24,v,72
TR 20,217,16384
TR 22,217,17408
MV 124,v,24,v,76
buffer_load_dwordx4 v212, s[48:51], s66 offen offset:0 lds
v_cvt_pk_bf16_f32 v242, v246, v247
MV 128,v,28,v,64
TR 24,218,16384
TR 26,218,17408
MV 132,v,28,v,68
ds_read_b128 v[52:55], v224 offset:2048
buffer_load_dwordx4 v213, s[48:51], s66 offen offset:1024 lds
MV 136,v,28,v,72
buffer_load_dwordx4 v214, s[48:51], s66 offen offset:2048 lds
v_cvt_pk_bf16_f32 v243, v248, v249
MV 140,v,28,v,76
TR 28,219,16384
TR 30,219,17408
MV 144,v,32,v,64
ds_read_b128 v[56:59], v224 offset:4096
v_cvt_pk_bf16_f32 v244, v250, v251
MV 148,v,32,v,68
buffer_load_dwordx4 v215, s[48:51], s66 offen offset:3072 lds
v_cvt_pk_bf16_f32 v245, v252, v253
MV 152,v,32,v,72
buffer_store_dwordx4 v[242:245], v228, s[16:19], s24 offen offset:3072 sc1
v_accvgpr_read_b32 v234, a96
MV 156,v,32,v,76
TR 32,220,16384
TR 34,220,17408
MV 160,v,36,v,64
ds_read_b128 v[60:63], v224 offset:6144
s_add_u32 s66, s66, 524288
MV 164,v,36,v,68
s_and_b32 s66, s66, 8388607
v_accvgpr_read_b32 v235, a97
MV 168,v,36,v,72
v_accvgpr_read_b32 v236, a98
v_accvgpr_read_b32 v237, a99
MV 172,v,36,v,76
TR 36,221,16384
TR 38,221,17408
MV 176,v,40,v,64
s_add_u32 s75, s64, s74
v_accvgpr_read_b32 v238, a100
MV 180,v,40,v,68
v_accvgpr_read_b32 v239, a101
v_accvgpr_read_b32 v240, a102
MV 184,v,40,v,72
s_add_u32 m0, s67, 65536
v_accvgpr_read_b32 v241, a103
MV 188,v,40,v,76
TR 40,222,16384
TR 42,222,17408
MV 192,v,44,v,64
buffer_load_dwordx4 v208, s[44:47], s75 offen offset:0 lds
v_cvt_pk_bf16_f32 v230, v234, v235
MV 196,v,44,v,68
v_cvt_pk_bf16_f32 v231, v236, v237
v_cvt_pk_bf16_f32 v232, v238, v239
MV 200,v,44,v,72
MV 204,v,44,v,76
TR 44,223,16384
TR 46,223,17408
s_waitcnt lgkmcnt(4)
MV 80,v,16,v,48
buffer_load_dwordx4 v209, s[44:47], s75 offen offset:1024 lds
v_cvt_pk_bf16_f32 v233, v240, v241
MV 84,v,16,v,52
ds_read_b128 v[64:67], v225 offset:0
s_add_u32 s24, s24, 4096
MV 88,v,16,v,56
buffer_load_dwordx4 v210, s[44:47], s75 offen offset:2048 lds
buffer_store_dwordx4 v[230:233], v228, s[16:19], s24 offen offset:0 sc1
MV 92,v,16,v,60
TR 16,216,24576
TR 18,216,25600
MV 96,v,20,v,48
v_accvgpr_read_b32 v246, a104
MV 100,v,20,v,52
buffer_load_dwordx4 v211, s[44:47], s75 offen offset:3072 lds
v_accvgpr_read_b32 v247, a105
MV 104,v,20,v,56
ds_read_b128 v[68:71], v225 offset:2048
MV 108,v,20,v,60
TR 20,217,24576
TR 22,217,25600
MV 112,v,24,v,48
s_add_u32 s75, s65, s74
v_accvgpr_read_b32 v248, a106
MV 116,v,24,v,52
v_accvgpr_read_b32 v249, a107
MV 120,v,24,v,56
v_accvgpr_read_b32 v250, a108
MV 124,v,24,v,60
TR 24,218,24576
TR 26,218,25600
MV 128,v,28,v,48
ds_read_b128 v[72:75], v225 offset:4096
s_add_u32 m0, s67, 69632
MV 132,v,28,v,52
v_accvgpr_read_b32 v251, a109
v_accvgpr_read_b32 v252, a110
MV 136,v,28,v,56
buffer_load_dwordx4 v208, s[44:47], s75 offen offset:0 lds
v_accvgpr_read_b32 v253, a111
MV 140,v,28,v,60
TR 28,219,24576
TR 30,219,25600
MV 144,v,32,v,48
buffer_load_dwordx4 v209, s[44:47], s75 offen offset:1024 lds
v_cvt_pk_bf16_f32 v242, v246, v247
MV 148,v,32,v,52
v_cvt_pk_bf16_f32 v243, v248, v249
MV 152,v,32,v,56
ds_read_b128 v[76:79], v225 offset:6144
v_cvt_pk_bf16_f32 v244, v250, v251
MV 156,v,32,v,60
TR 32,220,24576
TR 34,220,25600
MV 160,v,36,v,48
buffer_load_dwordx4 v210, s[44:47], s75 offen offset:2048 lds
v_cvt_pk_bf16_f32 v245, v252, v253
MV 164,v,36,v,52
buffer_store_dwordx4 v[242:245], v228, s[16:19], s24 offen offset:1024 sc1
MV 168,v,36,v,56
buffer_load_dwordx4 v211, s[44:47], s75 offen offset:3072 lds
v_accvgpr_read_b32 v234, a112
MV 172,v,36,v,60
TR 36,221,24576
TR 38,221,25600
s_waitcnt lgkmcnt(15)
MV 176,v,40,v,48
v_accvgpr_read_b32 v235, a113
MV 180,v,40,v,52
s_add_u32 s74, s74, 128
v_accvgpr_read_b32 v236, a114
MV 184,v,40,v,56
MV 188,v,40,v,60
TR 40,222,24576
TR 42,222,25600
MV 192,v,44,v,48
s_and_b32 s74, s74, 2047
v_accvgpr_read_b32 v237, a115
MV 196,v,44,v,52
v_accvgpr_read_b32 v238, a116
MV 200,v,44,v,56
MV 204,v,44,v,60
TR 44,223,24576
TR 46,223,25600
s_waitcnt lgkmcnt(4)
MV 80,v,16,v,64
v_accvgpr_read_b32 v239, a117
MV 84,v,16,v,68
v_accvgpr_read_b32 v240, a118
MV 88,v,16,v,72
v_accvgpr_read_b32 v241, a119
MV 92,v,16,v,76
MV 96,v,20,v,64
v_cvt_pk_bf16_f32 v230, v234, v235
MV 100,v,20,v,68
v_cvt_pk_bf16_f32 v231, v236, v237
MV 104,v,20,v,72
MV 108,v,20,v,76
s_waitcnt vmcnt(16) lgkmcnt(0)
s_barrier
MV 112,v,24,v,64
TR 16,216,32768
TR 18,216,33792
MV 116,v,24,v,68
ds_read_b128 v[48:51], v224 offset:32768
s_add_u32 m0, s68, 114688
MV 120,v,24,v,72
TR 20,217,32768
TR 22,217,33792
MV 124,v,24,v,76
buffer_load_dwordx4 v212, s[48:51], s66 offen offset:0 lds
v_cvt_pk_bf16_f32 v232, v238, v239
MV 128,v,28,v,64
TR 24,218,32768
TR 26,218,33792
MV 132,v,28,v,68
ds_read_b128 v[52:55], v224 offset:34816
buffer_load_dwordx4 v213, s[48:51], s66 offen offset:1024 lds
MV 136,v,28,v,72
buffer_load_dwordx4 v214, s[48:51], s66 offen offset:2048 lds
v_cvt_pk_bf16_f32 v233, v240, v241
MV 140,v,28,v,76
TR 28,219,32768
TR 30,219,33792
MV 144,v,32,v,64
ds_read_b128 v[56:59], v224 offset:36864
buffer_store_dwordx4 v[230:233], v228, s[16:19], s24 offen offset:2048 sc1
MV 148,v,32,v,68
buffer_load_dwordx4 v215, s[48:51], s66 offen offset:3072 lds
v_accvgpr_read_b32 v246, a120
MV 152,v,32,v,72
v_accvgpr_read_b32 v247, a121
v_accvgpr_read_b32 v248, a122
MV 156,v,32,v,76
TR 32,220,32768
TR 34,220,33792
MV 160,v,36,v,64
ds_read_b128 v[60:63], v224 offset:38912
s_add_u32 s66, s66, 524288
MV 164,v,36,v,68
s_and_b32 s66, s66, 8388607
v_accvgpr_read_b32 v249, a123
MV 168,v,36,v,72
v_accvgpr_read_b32 v250, a124
v_accvgpr_read_b32 v251, a125
MV 172,v,36,v,76
TR 36,221,32768
TR 38,221,33792
MV 176,v,40,v,64
s_add_u32 s75, s64, s74
v_accvgpr_read_b32 v252, a126
MV 180,v,40,v,68
v_accvgpr_read_b32 v253, a127
v_cvt_pk_bf16_f32 v242, v246, v247
MV 184,v,40,v,72
s_add_u32 m0, s67, 0
v_cvt_pk_bf16_f32 v243, v248, v249
MV 188,v,40,v,76
TR 40,222,32768
TR 42,222,33792
MV 192,v,44,v,64
buffer_load_dwordx4 v208, s[44:47], s75 offen offset:0 lds
v_cvt_pk_bf16_f32 v244, v250, v251
MV 196,v,44,v,68
v_cvt_pk_bf16_f32 v245, v252, v253
buffer_store_dwordx4 v[242:245], v228, s[16:19], s24 offen offset:3072 sc1
MV 200,v,44,v,72
MV 204,v,44,v,76
TR 44,223,32768
TR 46,223,33792
s_waitcnt lgkmcnt(4)
MV 80,v,16,v,48
buffer_load_dwordx4 v209, s[44:47], s75 offen offset:1024 lds
v_accvgpr_read_b32 v234, a128
MV 84,v,16,v,52
ds_read_b128 v[64:67], v225 offset:32768
v_accvgpr_read_b32 v235, a129
MV 88,v,16,v,56
buffer_load_dwordx4 v210, s[44:47], s75 offen offset:2048 lds
v_accvgpr_read_b32 v236, a130
MV 92,v,16,v,60
TR 16,216,40960
TR 18,216,41984
MV 96,v,20,v,48
v_accvgpr_read_b32 v237, a131
MV 100,v,20,v,52
buffer_load_dwordx4 v211, s[44:47], s75 offen offset:3072 lds
v_accvgpr_read_b32 v238, a132
MV 104,v,20,v,56
ds_read_b128 v[68:71], v225 offset:34816
MV 108,v,20,v,60
TR 20,217,40960
TR 22,217,41984
MV 112,v,24,v,48
s_add_u32 s75, s65, s74
v_accvgpr_read_b32 v239, a133
MV 116,v,24,v,52
v_accvgpr_read_b32 v240, a134
MV 120,v,24,v,56
v_accvgpr_read_b32 v241, a135
MV 124,v,24,v,60
TR 24,218,40960
TR 26,218,41984
MV 128,v,28,v,48
ds_read_b128 v[72:75], v225 offset:36864
s_add_u32 m0, s67, 4096
MV 132,v,28,v,52
v_cvt_pk_bf16_f32 v230, v234, v235
v_cvt_pk_bf16_f32 v231, v236, v237
MV 136,v,28,v,56
buffer_load_dwordx4 v208, s[44:47], s75 offen offset:0 lds
v_cvt_pk_bf16_f32 v232, v238, v239
MV 140,v,28,v,60
TR 28,219,40960
TR 30,219,41984
MV 144,v,32,v,48
buffer_load_dwordx4 v209, s[44:47], s75 offen offset:1024 lds
v_cvt_pk_bf16_f32 v233, v240, v241
MV 148,v,32,v,52
s_add_u32 s24, s24, 4096
MV 152,v,32,v,56
ds_read_b128 v[76:79], v225 offset:38912
buffer_store_dwordx4 v[230:233], v228, s[16:19], s24 offen offset:0 sc1
MV 156,v,32,v,60
TR 32,220,40960
TR 34,220,41984
MV 160,v,36,v,48
buffer_load_dwordx4 v210, s[44:47], s75 offen offset:2048 lds
v_accvgpr_read_b32 v246, a136
MV 164,v,36,v,52
v_accvgpr_read_b32 v247, a137
MV 168,v,36,v,56
buffer_load_dwordx4 v211, s[44:47], s75 offen offset:3072 lds
v_accvgpr_read_b32 v248, a138
MV 172,v,36,v,60
TR 36,221,40960
TR 38,221,41984
s_waitcnt lgkmcnt(15)
MV 176,v,40,v,48
v_accvgpr_read_b32 v249, a139
MV 180,v,40,v,52
s_add_u32 s74, s74, 128
v_accvgpr_read_b32 v250, a140
MV 184,v,40,v,56
MV 188,v,40,v,60
TR 40,222,40960
TR 42,222,41984
MV 192,v,44,v,48
s_and_b32 s74, s74, 2047
v_accvgpr_read_b32 v251, a141
MV 196,v,44,v,52
v_accvgpr_read_b32 v252, a142
MV 200,v,44,v,56
MV 204,v,44,v,60
TR 44,223,40960
TR 46,223,41984
s_waitcnt lgkmcnt(4)
MV 80,v,16,v,64
v_accvgpr_read_b32 v253, a143
MV 84,v,16,v,68
v_cvt_pk_bf16_f32 v242, v246, v247
MV 88,v,16,v,72
v_cvt_pk_bf16_f32 v243, v248, v249
MV 92,v,16,v,76
MV 96,v,20,v,64
v_cvt_pk_bf16_f32 v244, v250, v251
MV 100,v,20,v,68
v_cvt_pk_bf16_f32 v245, v252, v253
MV 104,v,20,v,72
MV 108,v,20,v,76
s_waitcnt vmcnt(15) lgkmcnt(0)
s_barrier
MV 112,v,24,v,64
TR 16,216,0
TR 18,216,1024
MV 116,v,24,v,68
ds_read_b128 v[48:51], v226 offset:0
s_add_u32 m0, s68, 131072
MV 120,v,24,v,72
TR 20,217,0
TR 22,217,1024
MV 124,v,24,v,76
buffer_load_dwordx4 v212, s[48:51], s66 offen offset:0 lds
buffer_store_dwordx4 v[242:245], v228, s[16:19], s24 offen offset:1024 sc1
MV 128,v,28,v,64
TR 24,218,0
TR 26,218,1024
MV 132,v,28,v,68
ds_read_b128 v[52:55], v226 offset:2048
buffer_load_dwordx4 v213, s[48:51], s66 offen offset:1024 lds
MV 136,v,28,v,72
buffer_load_dwordx4 v214, s[48:51], s66 offen offset:2048 lds
v_accvgpr_read_b32 v234, a144
MV 140,v,28,v,76
TR 28,219,0
TR 30,219,1024
MV 144,v,32,v,64
ds_read_b128 v[56:59], v226 offset:4096
v_accvgpr_read_b32 v235, a145
MV 148,v,32,v,68
buffer_load_dwordx4 v215, s[48:51], s66 offen offset:3072 lds
v_accvgpr_read_b32 v236, a146
MV 152,v,32,v,72
v_accvgpr_read_b32 v237, a147
v_accvgpr_read_b32 v238, a148
MV 156,v,32,v,76
TR 32,220,0
TR 34,220,1024
MV 160,v,36,v,64
ds_read_b128 v[60:63], v226 offset:6144
s_add_u32 s66, s66, 524288
MV 164,v,36,v,68
s_and_b32 s66, s66, 8388607
v_accvgpr_read_b32 v239, a149
MV 168,v,36,v,72
v_accvgpr_read_b32 v240, a150
v_accvgpr_read_b32 v241, a151
MV 172,v,36,v,76
TR 36,221,0
TR 38,221,1024
MV 176,v,40,v,64
s_add_u32 s75, s64, s74
v_cvt_pk_bf16_f32 v230, v234, v235
MV 180,v,40,v,68
v_cvt_pk_bf16_f32 v231, v236, v237
v_cvt_pk_bf16_f32 v232, v238, v239
MV 184,v,40,v,72
s_add_u32 m0, s67, 32768
v_cvt_pk_bf16_f32 v233, v240, v241
MV 188,v,40,v,76
TR 40,222,0
TR 42,222,1024
MV 192,v,44,v,64
buffer_load_dwordx4 v208, s[44:47], s75 offen offset:0 lds
buffer_store_dwordx4 v[230:233], v228, s[16:19], s24 offen offset:2048 sc1
MV 196,v,44,v,68
v_accvgpr_read_b32 v246, a152
v_accvgpr_read_b32 v247, a153
MV 200,v,44,v,72
MV 204,v,44,v,76
TR 44,223,0
TR 46,223,1024
s_waitcnt lgkmcnt(4)
MV 80,v,16,v,48
buffer_load_dwordx4 v209, s[44:47], s75 offen offset:1024 lds
v_accvgpr_read_b32 v248, a154
MV 84,v,16,v,52
ds_read_b128 v[64:67], v227 offset:0
v_accvgpr_read_b32 v249, a155
MV 88,v,16,v,56
buffer_load_dwordx4 v210, s[44:47], s75 offen offset:2048 lds
v_accvgpr_read_b32 v250, a156
MV 92,v,16,v,60
TR 16,216,8192
TR 18,216,9216
MV 96,v,20,v,48
v_accvgpr_read_b32 v251, a157
MV 100,v,20,v,52
buffer_load_dwordx4 v211, s[44:47], s75 offen offset:3072 lds
v_accvgpr_read_b32 v252, a158
MV 104,v,20,v,56
ds_read_b128 v[68:71], v227 offset:2048
MV 108,v,20,v,60
TR 20,217,8192
TR 22,217,9216
MV 112,v,24,v,48
s_add_u32 s75, s65, s74
v_accvgpr_read_b32 v253, a159
MV 116,v,24,v,52
v_cvt_pk_bf16_f32 v242, v246, v247
MV 120,v,24,v,56
v_cvt_pk_bf16_f32 v243, v248, v249
MV 124,v,24,v,60
TR 24,218,8192
TR 26,218,9216
MV 128,v,28,v,48
ds_read_b128 v[72:75], v227 offset:4096
s_add_u32 m0, s67, 36864
MV 132,v,28,v,52
v_cvt_pk_bf16_f32 v244, v250, v251
v_cvt_pk_bf16_f32 v245, v252, v253
MV 136,v,28,v,56
buffer_load_dwordx4 v208, s[44:47], s75 offen offset:0 lds
buffer_store_dwordx4 v[242:245], v228, s[16:19], s24 offen offset:3072 sc1
MV 140,v,28,v,60
TR 28,219,8192
TR 30,219,9216
MV 144,v,32,v,48
buffer_load_dwordx4 v209, s[44:47], s75 offen offset:1024 lds
v_accvgpr_read_b32 v234, a160
MV 148,v,32,v,52
v_accvgpr_read_b32 v235, a161
MV 152,v,32,v,56
ds_read_b128 v[76:79], v227 offset:6144
v_accvgpr_read_b32 v236, a162
MV 156,v,32,v,60
TR 32,220,8192
TR 34,220,9216
MV 160,v,36,v,48
buffer_load_dwordx4 v210, s[44:47], s75 offen offset:2048 lds
v_accvgpr_read_b32 v237, a163
MV 164,v,36,v,52
v_accvgpr_read_b32 v238, a164
MV 168,v,36,v,56
buffer_load_dwordx4 v211, s[44:47], s75 offen offset:3072 lds
v_accvgpr_read_b32 v239, a165
MV 172,v,36,v,60
TR 36,221,8192
TR 38,221,9216
s_waitcnt lgkmcnt(15)
MV 176,v,40,v,48
v_accvgpr_read_b32 v240, a166
MV 180,v,40,v,52
s_add_u32 s74, s74, 128
v_accvgpr_read_b32 v241, a167
MV 184,v,40,v,56
MV 188,v,40,v,60
TR 40,222,8192
TR 42,222,9216
MV 192,v,44,v,48
s_and_b32 s74, s74, 2047
v_cvt_pk_bf16_f32 v230, v234, v235
MV 196,v,44,v,52
v_cvt_pk_bf16_f32 v231, v236, v237
MV 200,v,44,v,56
MV 204,v,44,v,60
TR 44,223,8192
TR 46,223,9216
s_waitcnt lgkmcnt(4)
MV 80,v,16,v,64
v_cvt_pk_bf16_f32 v232, v238, v239
MV 84,v,16,v,68
v_cvt_pk_bf16_f32 v233, v240, v241
MV 88,v,16,v,72
s_add_u32 s24, s24, 4096
MV 92,v,16,v,76
MV 96,v,20,v,64
buffer_store_dwordx4 v[230:233], v228, s[16:19], s24 offen offset:0 sc1
MV 100,v,20,v,68
v_accvgpr_read_b32 v246, a168
MV 104,v,20,v,72
v_accvgpr_read_b32 v247, a169
MV 108,v,20,v,76
s_waitcnt vmcnt(16) lgkmcnt(0)
s_barrier
MV 112,v,24,v,64
TR 16,216,16384
TR 18,216,17408
MV 116,v,24,v,68
ds_read_b128 v[48:51], v224 offset:0
s_add_u32 m0, s68, 98304
MV 120,v,24,v,72
TR 20,217,16384
TR 22,217,17408
MV 124,v,24,v,76
buffer_load_dwordx4 v212, s[48:51], s66 offen offset:0 lds
v_accvgpr_read_b32 v248, a170
MV 128,v,28,v,64
TR 24,218,16384
TR 26,218,17408
MV 132,v,28,v,68
ds_read_b128 v[52:55], v224 offset:2048
buffer_load_dwordx4 v213, s[48:51], s66 offen offset:1024 lds
MV 136,v,28,v,72
buffer_load_dwordx4 v214, s[48:51], s66 offen offset:2048 lds
v_accvgpr_read_b32 v249, a171
MV 140,v,28,v,76
TR 28,219,16384
TR 30,219,17408
MV 144,v,32,v,64
ds_read_b128 v[56:59], v224 offset:4096
v_accvgpr_read_b32 v250, a172
MV 148,v,32,v,68
buffer_load_dwordx4 v215, s[48:51], s66 offen offset:3072 lds
v_accvgpr_read_b32 v251, a173
MV 152,v,32,v,72
v_accvgpr_read_b32 v252, a174
v_accvgpr_read_b32 v253, a175
MV 156,v,32,v,76
TR 32,220,16384
TR 34,220,17408
MV 160,v,36,v,64
ds_read_b128 v[60:63], v224 offset:6144
s_add_u32 s66, s66, 524288
MV 164,v,36,v,68
s_and_b32 s66, s66, 8388607
v_cvt_pk_bf16_f32 v242, v246, v247
MV 168,v,36,v,72
v_cvt_pk_bf16_f32 v243, v248, v249
v_cvt_pk_bf16_f32 v244, v250, v251
MV 172,v,36,v,76
TR 36,221,16384
TR 38,221,17408
MV 176,v,40,v,64
s_add_u32 s75, s64, s74
v_cvt_pk_bf16_f32 v245, v252, v253
MV 180,v,40,v,68
buffer_store_dwordx4 v[242:245], v228, s[16:19], s24 offen offset:1024 sc1
v_accvgpr_read_b32 v234, a176
MV 184,v,40,v,72
s_add_u32 m0, s67, 65536
v_accvgpr_read_b32 v235, a177
MV 188,v,40,v,76
TR 40,222,16384
TR 42,222,17408
MV 192,v,44,v,64
buffer_load_dwordx4 v208, s[44:47], s75 offen offset:0 lds
v_accvgpr_read_b32 v236, a178
MV 196,v,44,v,68
v_accvgpr_read_b32 v237, a179
v_accvgpr_read_b32 v238, a180
MV 200,v,44,v,72
MV 204,v,44,v,76
TR 44,223,16384
TR 46,223,17408
s_waitcnt lgkmcnt(4)
MV 80,v,16,v,48
buffer_load_dwordx4 v209, s[44:47], s75 offen offset:1024 lds
v_accvgpr_read_b32 v239, a181
MV 84,v,16,v,52
ds_read_b128 v[64:67], v225 offset:0
v_accvgpr_read_b32 v240, a182
MV 88,v,16,v,56
buffer_load_dwordx4 v210, s[44:47], s75 offen offset:2048 lds
v_accvgpr_read_b32 v241, a183
MV 92,v,16,v,60
TR 16,216,24576
TR 18,216,25600
MV 96,v,20,v,48
v_cvt_pk_bf16_f32 v230, v234, v235
MV 100,v,20,v,52
buffer_load_dwordx4 v211, s[44:47], s75 offen offset:3072 lds
v_cvt_pk_bf16_f32 v231, v236, v237
MV 104,v,20,v,56
ds_read_b128 v[68:71], v225 offset:2048
v_cvt_pk_bf16_f32 v232, v238, v239
MV 108,v,20,v,60
TR 20,217,24576
TR 22,217,25600
MV 112,v,24,v,48
s_add_u32 s75, s65, s74
v_cvt_pk_bf16_f32 v233, v240, v241
MV 116,v,24,v,52
buffer_store_dwordx4 v[230:233], v228, s[16:19], s24 offen offset:2048 sc1
MV 120,v,24,v,56
v_accvgpr_read_b32 v246, a184
MV 124,v,24,v,60
TR 24,218,24576
TR 26,218,25600
MV 128,v,28,v,48
ds_read_b128 v[72:75], v225 offset:4096
s_add_u32 m0, s67, 69632
MV 132,v,28,v,52
v_accvgpr_read_b32 v247, a185
v_accvgpr_read_b32 v248, a186
MV 136,v,28,v,56
buffer_load_dwordx4 v208, s[44:47], s75 offen offset:0 lds
MV 140,v,28,v,60
TR 28,219,24576
TR 30,219,25600
MV 144,v,32,v,48
buffer_load_dwordx4 v209, s[44:47], s75 offen offset:1024 lds
v_accvgpr_read_b32 v249, a187
MV 148,v,32,v,52
v_accvgpr_read_b32 v250, a188
v_accvgpr_read_b32 v251, a189
MV 152,v,32,v,56
ds_read_b128 v[76:79], v225 offset:6144
MV 156,v,32,v,60
TR 32,220,24576
TR 34,220,25600
MV 160,v,36,v,48
buffer_load_dwordx4 v210, s[44:47], s75 offen offset:2048 lds
v_accvgpr_read_b32 v252, a190
MV 164,v,36,v,52
v_accvgpr_read_b32 v253, a191
v_cvt_pk_bf16_f32 v242, v246, v247
MV 168,v,36,v,56
buffer_load_dwordx4 v211, s[44:47], s75 offen offset:3072 lds
MV 172,v,36,v,60
TR 36,221,24576
TR 38,221,25600
s_waitcnt lgkmcnt(15)
MV 176,v,40,v,48
v_cvt_pk_bf16_f32 v243, v248, v249
v_cvt_pk_bf16_f32 v244, v250, v251
MV 180,v,40,v,52
s_add_u32 s74, s74, 128
v_cvt_pk_bf16_f32 v245, v252, v253
MV 184,v,40,v,56
MV 188,v,40,v,60
TR 40,222,24576
TR 42,222,25600
MV 192,v,44,v,48
s_and_b32 s74, s74, 2047
buffer_store_dwordx4 v[242:245], v228, s[16:19], s24 offen offset:3072 sc1
MV 196,v,44,v,52
buffer_load_dword v254, off, s[12:15], 0 sc1
MV 200,v,44,v,56
MV 204,v,44,v,60
TR 44,223,24576
TR 46,223,25600
s_waitcnt lgkmcnt(4)
MV 80,v,16,v,64
v_accvgpr_read_b32 v234, a192
MV 84,v,16,v,68
v_accvgpr_read_b32 v235, a193
MV 88,v,16,v,72
v_accvgpr_read_b32 v236, a194
MV 92,v,16,v,76
MV 96,v,20,v,64
v_accvgpr_read_b32 v237, a195
MV 100,v,20,v,68
v_accvgpr_read_b32 v238, a196
MV 104,v,20,v,72
MV 108,v,20,v,76
s_waitcnt vmcnt(17) lgkmcnt(0)
s_barrier
MV 112,v,24,v,64
TR 16,216,32768
TR 18,216,33792
MV 116,v,24,v,68
ds_read_b128 v[48:51], v224 offset:32768
s_add_u32 m0, s68, 114688
MV 120,v,24,v,72
TR 20,217,32768
TR 22,217,33792
MV 124,v,24,v,76
buffer_load_dwordx4 v212, s[48:51], s66 offen offset:0 lds
v_accvgpr_read_b32 v239, a197
MV 128,v,28,v,64
TR 24,218,32768
TR 26,218,33792
MV 132,v,28,v,68
ds_read_b128 v[52:55], v224 offset:34816
buffer_load_dwordx4 v213, s[48:51], s66 offen offset:1024 lds
MV 136,v,28,v,72
buffer_load_dwordx4 v214, s[48:51], s66 offen offset:2048 lds
v_accvgpr_read_b32 v240, a198
MV 140,v,28,v,76
TR 28,219,32768
TR 30,219,33792
MV 144,v,32,v,64
ds_read_b128 v[56:59], v224 offset:36864
v_accvgpr_read_b32 v241, a199
MV 148,v,32,v,68
buffer_load_dwordx4 v215, s[48:51], s66 offen offset:3072 lds
v_cvt_pk_bf16_f32 v230, v234, v235
MV 152,v,32,v,72
v_cvt_pk_bf16_f32 v231, v236, v237
v_cvt_pk_bf16_f32 v232, v238, v239
MV 156,v,32,v,76
TR 32,220,32768
TR 34,220,33792
MV 160,v,36,v,64
ds_read_b128 v[60:63], v224 offset:38912
s_add_u32 s66, s66, 524288
MV 164,v,36,v,68
s_and_b32 s66, s66, 8388607
v_cvt_pk_bf16_f32 v233, v240, v241
MV 168,v,36,v,72
s_add_u32 s24, s24, 4096
buffer_store_dwordx4 v[230:233], v228, s[16:19], s24 offen offset:0 sc1
MV 172,v,36,v,76
TR 36,221,32768
TR 38,221,33792
MV 176,v,40,v,64
s_add_u32 s75, s64, s74
v_accvgpr_read_b32 v246, a200
MV 180,v,40,v,68
v_accvgpr_read_b32 v247, a201
v_accvgpr_read_b32 v248, a202
MV 184,v,40,v,72
s_add_u32 m0, s67, 0
v_accvgpr_read_b32 v249, a203
MV 188,v,40,v,76
TR 40,222,32768
TR 42,222,33792
MV 192,v,44,v,64
buffer_load_dwordx4 v208, s[44:47], s75 offen offset:0 lds
v_accvgpr_read_b32 v250, a204
MV 196,v,44,v,68
v_accvgpr_read_b32 v251, a205
v_accvgpr_read_b32 v252, a206
MV 200,v,44,v,72
MV 204,v,44,v,76
TR 44,223,32768
TR 46,223,33792
s_waitcnt lgkmcnt(4)
MV 80,v,16,v,48
buffer_load_dwordx4 v209, s[44:47], s75 offen offset:1024 lds
v_accvgpr_read_b32 v253, a207
MV 84,v,16,v,52
ds_read_b128 v[64:67], v225 offset:32768
v_cvt_pk_bf16_f32 v242, v246, v247
MV 88,v,16,v,56
buffer_load_dwordx4 v210, s[44:47], s75 offen offset:2048 lds
v_cvt_pk_bf16_f32 v243, v248, v249
MV 92,v,16,v,60
TR 16,216,40960
TR 18,216,41984
MV 96,v,20,v,48
v_cvt_pk_bf16_f32 v244, v250, v251
MV 100,v,20,v,52
buffer_load_dwordx4 v211, s[44:47], s75 offen offset:3072 lds
v_cvt_pk_bf16_f32 v245, v252, v253
MV 104,v,20,v,56
ds_read_b128 v[68:71], v225 offset:34816
MV 108,v,20,v,60
TR 20,217,40960
TR 22,217,41984
MV 112,v,24,v,48
s_add_u32 s75, s65, s74
buffer_store_dwordx4 v[242:245], v228, s[16:19], s24 offen offset:1024 sc1
MV 116,v,24,v,52
v_accvgpr_read_b32 v234, a208
MV 120,v,24,v,56
v_accvgpr_read_b32 v235, a209
MV 124,v,24,v,60
TR 24,218,40960
TR 26,218,41984
MV 128,v,28,v,48
ds_read_b128 v[72:75], v225 offset:36864
s_add_u32 m0, s67, 4096
MV 132,v,28,v,52
v_accvgpr_read_b32 v236, a210
v_accvgpr_read_b32 v237, a211
MV 136,v,28,v,56
buffer_load_dwordx4 v208, s[44:47], s75 offen offset:0 lds
v_accvgpr_read_b32 v238, a212
MV 140,v,28,v,60
TR 28,219,40960
TR 30,219,41984
MV 144,v,32,v,48
buffer_load_dwordx4 v209, s[44:47], s75 offen offset:1024 lds
v_accvgpr_read_b32 v239, a213
MV 148,v,32,v,52
v_accvgpr_read_b32 v240, a214
MV 152,v,32,v,56
ds_read_b128 v[76:79], v225 offset:38912
v_accvgpr_read_b32 v241, a215
MV 156,v,32,v,60
TR 32,220,40960
TR 34,220,41984
MV 160,v,36,v,48
buffer_load_dwordx4 v210, s[44:47], s75 offen offset:2048 lds
v_cvt_pk_bf16_f32 v230, v234, v235
MV 164,v,36,v,52
v_cvt_pk_bf16_f32 v231, v236, v237
MV 168,v,36,v,56
buffer_load_dwordx4 v211, s[44:47], s75 offen offset:3072 lds
v_cvt_pk_bf16_f32 v232, v238, v239
MV 172,v,36,v,60
TR 36,221,40960
TR 38,221,41984
s_waitcnt lgkmcnt(15)
MV 176,v,40,v,48
v_cvt_pk_bf16_f32 v233, v240, v241
MV 180,v,40,v,52
s_add_u32 s74, s74, 128
buffer_store_dwordx4 v[230:233], v228, s[16:19], s24 offen offset:2048 sc1
MV 184,v,40,v,56
MV 188,v,40,v,60
TR 40,222,40960
TR 42,222,41984
MV 192,v,44,v,48
s_and_b32 s74, s74, 2047
v_accvgpr_read_b32 v246, a216
MV 196,v,44,v,52
v_accvgpr_read_b32 v247, a217
MV 200,v,44,v,56
MV 204,v,44,v,60
TR 44,223,40960
TR 46,223,41984
s_waitcnt lgkmcnt(4)
MV 80,v,16,v,64
v_accvgpr_read_b32 v248, a218
MV 84,v,16,v,68
v_accvgpr_read_b32 v249, a219
MV 88,v,16,v,72
v_accvgpr_read_b32 v250, a220
MV 92,v,16,v,76
MV 96,v,20,v,64
v_accvgpr_read_b32 v251, a221
MV 100,v,20,v,68
v_accvgpr_read_b32 v252, a222
MV 104,v,20,v,72
MV 108,v,20,v,76
s_waitcnt vmcnt(17) lgkmcnt(0)
s_barrier
MV 112,v,24,v,64
TR 16,216,0
TR 18,216,1024
MV 116,v,24,v,68
ds_read_b128 v[48:51], v226 offset:0
s_add_u32 m0, s68, 131072
MV 120,v,24,v,72
TR 20,217,0
TR 22,217,1024
MV 124,v,24,v,76
buffer_load_dwordx4 v212, s[48:51], s66 offen offset:0 lds
v_accvgpr_read_b32 v253, a223
MV 128,v,28,v,64
TR 24,218,0
TR 26,218,1024
MV 132,v,28,v,68
ds_read_b128 v[52:55], v226 offset:2048
buffer_load_dwordx4 v213, s[48:51], s66 offen offset:1024 lds
MV 136,v,28,v,72
buffer_load_dwordx4 v214, s[48:51], s66 offen offset:2048 lds
v_cvt_pk_bf16_f32 v242, v246, v247
MV 140,v,28,v,76
TR 28,219,0
TR 30,219,1024
MV 144,v,32,v,64
ds_read_b128 v[56:59], v226 offset:4096
v_cvt_pk_bf16_f32 v243, v248, v249
MV 148,v,32,v,68
buffer_load_dwordx4 v215, s[48:51], s66 offen offset:3072 lds
v_cvt_pk_bf16_f32 v244, v250, v251
MV 152,v,32,v,72
v_cvt_pk_bf16_f32 v245, v252, v253
buffer_store_dwordx4 v[242:245], v228, s[16:19], s24 offen offset:3072 sc1
MV 156,v,32,v,76
TR 32,220,0
TR 34,220,1024
MV 160,v,36,v,64
ds_read_b128 v[60:63], v226 offset:6144
s_add_u32 s66, s66, 524288
MV 164,v,36,v,68
s_and_b32 s66, s66, 8388607
v_accvgpr_read_b32 v234, a224
MV 168,v,36,v,72
v_accvgpr_read_b32 v235, a225
v_accvgpr_read_b32 v236, a226
MV 172,v,36,v,76
TR 36,221,0
TR 38,221,1024
MV 176,v,40,v,64
s_add_u32 s75, s64, s74
v_accvgpr_read_b32 v237, a227
MV 180,v,40,v,68
v_accvgpr_read_b32 v238, a228
v_accvgpr_read_b32 v239, a229
MV 184,v,40,v,72
s_add_u32 m0, s67, 32768
v_accvgpr_read_b32 v240, a230
MV 188,v,40,v,76
TR 40,222,0
TR 42,222,1024
MV 192,v,44,v,64
buffer_load_dwordx4 v208, s[44:47], s75 offen offset:0 lds
v_accvgpr_read_b32 v241, a231
MV 196,v,44,v,68
v_cvt_pk_bf16_f32 v230, v234, v235
v_cvt_pk_bf16_f32 v231, v236, v237
MV 200,v,44,v,72
MV 204,v,44,v,76
TR 44,223,0
TR 46,223,1024
s_waitcnt lgkmcnt(4)
MV 80,v,16,v,48
buffer_load_dwordx4 v209, s[44:47], s75 offen offset:1024 lds
v_cvt_pk_bf16_f32 v232, v238, v239
MV 84,v,16,v,52
ds_read_b128 v[64:67], v227 offset:0
v_cvt_pk_bf16_f32 v233, v240, v241
MV 88,v,16,v,56
buffer_load_dwordx4 v210, s[44:47], s75 offen offset:2048 lds
s_add_u32 s24, s24, 4096
MV 92,v,16,v,60
TR 16,216,8192
TR 18,216,9216
MV 96,v,20,v,48
buffer_store_dwordx4 v[230:233], v228, s[16:19], s24 offen offset:0 sc1
MV 100,v,20,v,52
buffer_load_dwordx4 v211, s[44:47], s75 offen offset:3072 lds
v_accvgpr_read_b32 v246, a232
MV 104,v,20,v,56
ds_read_b128 v[68:71], v227 offset:2048
MV 108,v,20,v,60
TR 20,217,8192
TR 22,217,9216
MV 112,v,24,v,48
s_add_u32 s75, s65, s74
v_accvgpr_read_b32 v247, a233
MV 116,v,24,v,52
v_accvgpr_read_b32 v248, a234
MV 120,v,24,v,56
v_accvgpr_read_b32 v249, a235
MV 124,v,24,v,60
TR 24,218,8192
TR 26,218,9216
MV 128,v,28,v,48
ds_read_b128 v[72:75], v227 offset:4096
s_add_u32 m0, s67, 36864
MV 132,v,28,v,52
v_accvgpr_read_b32 v250, a236
v_accvgpr_read_b32 v251, a237
MV 136,v,28,v,56
buffer_load_dwordx4 v208, s[44:47], s75 offen offset:0 lds
v_accvgpr_read_b32 v252, a238
MV 140,v,28,v,60
TR 28,219,8192
TR 30,219,9216
MV 144,v,32,v,48
buffer_load_dwordx4 v209, s[44:47], s75 offen offset:1024 lds
v_accvgpr_read_b32 v253, a239
MV 148,v,32,v,52
v_cvt_pk_bf16_f32 v242, v246, v247
MV 152,v,32,v,56
ds_read_b128 v[76:79], v227 offset:6144
v_cvt_pk_bf16_f32 v243, v248, v249
MV 156,v,32,v,60
TR 32,220,8192
TR 34,220,9216
MV 160,v,36,v,48
buffer_load_dwordx4 v210, s[44:47], s75 offen offset:2048 lds
v_cvt_pk_bf16_f32 v244, v250, v251
MV 164,v,36,v,52
v_cvt_pk_bf16_f32 v245, v252, v253
MV 168,v,36,v,56
buffer_load_dwordx4 v211, s[44:47], s75 offen offset:3072 lds
buffer_store_dwordx4 v[242:245], v228, s[16:19], s24 offen offset:1024 sc1
MV 172,v,36,v,60
TR 36,221,8192
TR 38,221,9216
s_waitcnt lgkmcnt(15)
MV 176,v,40,v,48
v_accvgpr_read_b32 v234, a240
MV 180,v,40,v,52
s_add_u32 s74, s74, 128
v_accvgpr_read_b32 v235, a241
MV 184,v,40,v,56
MV 188,v,40,v,60
TR 40,222,8192
TR 42,222,9216
MV 192,v,44,v,48
s_and_b32 s74, s74, 2047
v_accvgpr_read_b32 v236, a242
MV 196,v,44,v,52
v_accvgpr_read_b32 v237, a243
MV 200,v,44,v,56
MV 204,v,44,v,60
TR 44,223,8192
TR 46,223,9216
s_waitcnt lgkmcnt(4)
MV 80,v,16,v,64
v_accvgpr_read_b32 v238, a244
MV 84,v,16,v,68
v_accvgpr_read_b32 v239, a245
MV 88,v,16,v,72
v_accvgpr_read_b32 v240, a246
MV 92,v,16,v,76
MV 96,v,20,v,64
v_accvgpr_read_b32 v241, a247
MV 100,v,20,v,68
v_cvt_pk_bf16_f32 v230, v234, v235
MV 104,v,20,v,72
v_cvt_pk_bf16_f32 v231, v236, v237
MV 108,v,20,v,76
s_waitcnt vmcnt(16) lgkmcnt(0)
s_barrier
MV 112,v,24,v,64
TR 16,216,16384
TR 18,216,17408
MV 116,v,24,v,68
ds_read_b128 v[48:51], v224 offset:0
s_add_u32 m0, s68, 98304
MV 120,v,24,v,72
TR 20,217,16384
TR 22,217,17408
MV 124,v,24,v,76
buffer_load_dwordx4 v212, s[48:51], s66 offen offset:0 lds
v_cvt_pk_bf16_f32 v232, v238, v239
MV 128,v,28,v,64
TR 24,218,16384
TR 26,218,17408
MV 132,v,28,v,68
ds_read_b128 v[52:55], v224 offset:2048
buffer_load_dwordx4 v213, s[48:51], s66 offen offset:1024 lds
MV 136,v,28,v,72
buffer_load_dwordx4 v214, s[48:51], s66 offen offset:2048 lds
v_cvt_pk_bf16_f32 v233, v240, v241
MV 140,v,28,v,76
TR 28,219,16384
TR 30,219,17408
MV 144,v,32,v,64
ds_read_b128 v[56:59], v224 offset:4096
buffer_store_dwordx4 v[230:233], v228, s[16:19], s24 offen offset:2048 sc1
MV 148,v,32,v,68
buffer_load_dwordx4 v215, s[48:51], s66 offen offset:3072 lds
v_accvgpr_read_b32 v246, a248
MV 152,v,32,v,72
v_accvgpr_read_b32 v247, a249
v_accvgpr_read_b32 v248, a250
MV 156,v,32,v,76
TR 32,220,16384
TR 34,220,17408
MV 160,v,36,v,64
ds_read_b128 v[60:63], v224 offset:6144
s_add_u32 s66, s66, 524288
MV 164,v,36,v,68
s_and_b32 s66, s66, 8388607
v_accvgpr_read_b32 v249, a251
MV 168,v,36,v,72
v_accvgpr_read_b32 v250, a252
v_accvgpr_read_b32 v251, a253
MV 172,v,36,v,76
TR 36,221,16384
TR 38,221,17408
MV 176,v,40,v,64
s_add_u32 s75, s64, s74
v_accvgpr_read_b32 v252, a254
MV 180,v,40,v,68
v_accvgpr_read_b32 v253, a255
v_cvt_pk_bf16_f32 v242, v246, v247
MV 184,v,40,v,72
s_add_u32 m0, s67, 65536
v_cvt_pk_bf16_f32 v243, v248, v249
MV 188,v,40,v,76
TR 40,222,16384
TR 42,222,17408
MV 192,v,44,v,64
buffer_load_dwordx4 v208, s[44:47], s75 offen offset:0 lds
v_cvt_pk_bf16_f32 v244, v250, v251
MV 196,v,44,v,68
v_cvt_pk_bf16_f32 v245, v252, v253
buffer_store_dwordx4 v[242:245], v228, s[16:19], s24 offen offset:3072 sc1
MV 200,v,44,v,72
MV 204,v,44,v,76
TR 44,223,16384
TR 46,223,17408
s_waitcnt lgkmcnt(4)
MV 80,v,16,v,48
buffer_load_dwordx4 v209, s[44:47], s75 offen offset:1024 lds
v_lshlrev_b32 v255, 20, v1
MV 84,v,16,v,52
ds_read_b128 v[64:67], v225 offset:0
MV 88,v,16,v,56
buffer_load_dwordx4 v210, s[44:47], s75 offen offset:2048 lds
MV 92,v,16,v,60
TR 16,216,24576
TR 18,216,25600
MV 96,v,20,v,48
MV 100,v,20,v,52
buffer_load_dwordx4 v211, s[44:47], s75 offen offset:3072 lds
MV 104,v,20,v,56
ds_read_b128 v[68:71], v225 offset:2048
MV 108,v,20,v,60
TR 20,217,24576
TR 22,217,25600
MV 112,v,24,v,48
s_add_u32 s75, s65, s74
MV 116,v,24,v,52
MV 120,v,24,v,56
s_lshl_b32 s36, s3, 26
MV 124,v,24,v,60
TR 24,218,24576
TR 26,218,25600
MV 128,v,28,v,48
ds_read_b128 v[72:75], v225 offset:4096
s_add_u32 m0, s67, 69632
MV 132,v,28,v,52
MV 136,v,28,v,56
buffer_load_dwordx4 v208, s[44:47], s75 offen offset:0 lds
MV 140,v,28,v,60
TR 28,219,24576
TR 30,219,25600
MV 144,v,32,v,48
buffer_load_dwordx4 v209, s[44:47], s75 offen offset:1024 lds
MV 148,v,32,v,52
MV 152,v,32,v,56
ds_read_b128 v[76:79], v225 offset:6144
MV 156,v,32,v,60
TR 32,220,24576
TR 34,220,25600
MV 160,v,36,v,48
buffer_load_dwordx4 v210, s[44:47], s75 offen offset:2048 lds
v_add_u32 v255, s36, v255
MV 164,v,36,v,52
MV 168,v,36,v,56
buffer_load_dwordx4 v211, s[44:47], s75 offen offset:3072 lds
MV 172,v,36,v,60
TR 36,221,24576
TR 38,221,25600
s_waitcnt lgkmcnt(15)
MV 176,v,40,v,48
MV 180,v,40,v,52
s_add_u32 s74, s74, 128
MV 184,v,40,v,56
MV 188,v,40,v,60
TR 40,222,24576
TR 42,222,25600
MV 192,v,44,v,48
s_and_b32 s74, s74, 2047
MV 196,v,44,v,52
MV 200,v,44,v,56
MV 204,v,44,v,60
TR 44,223,24576
TR 46,223,25600
s_waitcnt lgkmcnt(4)
MV 80,v,16,v,64
v_lshlrev_b32 v230, 4, v1
MV 84,v,16,v,68
MV 88,v,16,v,72
s_lshl_b32 s80, s3, 12
MV 92,v,16,v,76
MV 96,v,20,v,64
v_add_u32 v12, s80, v230
MV 100,v,20,v,68
MV 104,v,20,v,72
v_add_u32 v10, 0x8000, v230
MV 108,v,20,v,76
s_waitcnt vmcnt(15) lgkmcnt(0)
s_barrier
MV 112,v,24,v,64
TR 16,216,32768
TR 18,216,33792
MV 116,v,24,v,68
ds_read_b128 v[48:51], v224 offset:32768
s_add_u32 m0, s68, 114688
MV 120,v,24,v,72
TR 20,217,32768
TR 22,217,33792
MV 124,v,24,v,76
buffer_load_dwordx4 v212, s[48:51], s66 offen offset:0 lds
v_add_u32 v11, 0x10000, v230
MV 128,v,28,v,64
TR 24,218,32768
TR 26,218,33792
MV 132,v,28,v,68
ds_read_b128 v[52:55], v224 offset:34816
buffer_load_dwordx4 v213, s[48:51], s66 offen offset:1024 lds
MV 136,v,28,v,72
buffer_load_dwordx4 v214, s[48:51], s66 offen offset:2048 lds
s_add_u32 s72, s80, 0x8000
MV 140,v,28,v,76
TR 28,219,32768
TR 30,219,33792
MV 144,v,32,v,64
ds_read_b128 v[56:59], v224 offset:36864
s_add_u32 s73, s80, 0x10000
MV 148,v,32,v,68
buffer_load_dwordx4 v215, s[48:51], s66 offen offset:3072 lds
v_mov_b32 v15, v230
MV 152,v,32,v,72
v_and_b32 v230, 15, v1
v_lshrrev_b32 v232, 4, v1
MV 156,v,32,v,76
TR 32,220,32768
TR 34,220,33792
MV 160,v,36,v,64
ds_read_b128 v[60:63], v224 offset:38912
s_add_u32 s66, s66, 524288
MV 164,v,36,v,68
s_and_b32 s66, s66, 8388607
v_lshlrev_b32 v232, 2, v232
MV 168,v,36,v,72
v_sub_u32 v13, v230, v232
MV 172,v,36,v,76
TR 36,221,32768
TR 38,221,33792
MV 176,v,40,v,64
s_add_u32 s75, s64, s74
s_lshl_b32 s81, s3, 5
MV 180,v,40,v,68
MV 184,v,40,v,72
s_add_u32 m0, s67, 0
v_add_u32 v13, s81, v13
MV 188,v,40,v,76
TR 40,222,32768
TR 42,222,33792
MV 192,v,44,v,64
buffer_load_dwordx4 v208, s[44:47], s75 offen offset:0 lds
v_mov_b32 v14, 0xff800000
MV 196,v,44,v,68
MV 200,v,44,v,72
MV 204,v,44,v,76
TR 44,223,32768
TR 46,223,33792
s_waitcnt lgkmcnt(4)
MV 80,v,16,v,48
buffer_load_dwordx4 v209, s[44:47], s75 offen offset:1024 lds
v_accvgpr_write_b32 a0, 0
MV 84,v,16,v,52
ds_read_b128 v[64:67], v225 offset:32768
v_accvgpr_write_b32 a1, 0
MV 88,v,16,v,56
buffer_load_dwordx4 v210, s[44:47], s75 offen offset:2048 lds
MV 92,v,16,v,60
TR 16,216,40960
TR 18,216,41984
MV 96,v,20,v,48
v_accvgpr_write_b32 a2, 0
MV 100,v,20,v,52
buffer_load_dwordx4 v211, s[44:47], s75 offen offset:3072 lds
v_accvgpr_write_b32 a3, 0
MV 104,v,20,v,56
ds_read_b128 v[68:71], v225 offset:34816
MV 108,v,20,v,60
TR 20,217,40960
TR 22,217,41984
MV 112,v,24,v,48
s_add_u32 s75, s65, s74
v_accvgpr_write_b32 a4, 0
MV 116,v,24,v,52
v_accvgpr_write_b32 a5, 0
MV 120,v,24,v,56
MV 124,v,24,v,60
TR 24,218,40960
TR 26,218,41984
MV 128,v,28,v,48
ds_read_b128 v[72:75], v225 offset:36864
s_add_u32 m0, s67, 4096
MV 132,v,28,v,52
v_accvgpr_write_b32 a6, 0
v_accvgpr_write_b32 a7, 0
MV 136,v,28,v,56
buffer_load_dwordx4 v208, s[44:47], s75 offen offset:0 lds
MV 140,v,28,v,60
TR 28,219,40960
TR 30,219,41984
MV 144,v,32,v,48
buffer_load_dwordx4 v209, s[44:47], s75 offen offset:1024 lds
v_accvgpr_write_b32 a8, 0
MV 148,v,32,v,52
v_accvgpr_write_b32 a9, 0
MV 152,v,32,v,56
ds_read_b128 v[76:79], v225 offset:38912
v_accvgpr_write_b32 a10, 0
MV 156,v,32,v,60
TR 32,220,40960
TR 34,220,41984
MV 160,v,36,v,48
buffer_load_dwordx4 v210, s[44:47], s75 offen offset:2048 lds
v_accvgpr_write_b32 a11, 0
MV 164,v,36,v,52
MV 168,v,36,v,56
buffer_load_dwordx4 v211, s[44:47], s75 offen offset:3072 lds
v_accvgpr_write_b32 a12, 0
MV 172,v,36,v,60
TR 36,221,40960
TR 38,221,41984
s_waitcnt lgkmcnt(15)
MV 176,v,40,v,48
v_accvgpr_write_b32 a13, 0
MV 180,v,40,v,52
s_add_u32 s74, s74, 128
MV 184,v,40,v,56
v_accvgpr_write_b32 a14, 0
MV 188,v,40,v,60
TR 40,222,40960
TR 42,222,41984
MV 192,v,44,v,48
s_and_b32 s74, s74, 2047
v_accvgpr_write_b32 a15, 0
MV 196,v,44,v,52
MV 200,v,44,v,56
MV 204,v,44,v,60
TR 44,223,40960
TR 46,223,41984
s_waitcnt lgkmcnt(4)
MV 80,v,16,v,64
v_accvgpr_write_b32 a16, 0
MV 84,v,16,v,68
v_accvgpr_write_b32 a17, 0
MV 88,v,16,v,72
MV 92,v,16,v,76
v_accvgpr_write_b32 a18, 0
MV 96,v,20,v,64
MV 100,v,20,v,68
v_accvgpr_write_b32 a19, 0
MV 104,v,20,v,72
MV 108,v,20,v,76
s_waitcnt vmcnt(12) lgkmcnt(0)
s_barrier
MV 112,v,24,v,64
v_cmp_gt_u32 vcc, 1, v254
s_nop 4
s_cbranch_vccnz L_spin_go
L_spin_go_ret:
v_mov_b32 v254, 1
s_lshl_b32 s36, s2, 2
buffer_store_dword v254, v255, s[8:11], s36 offen offset:0 sc1
s_load_dwordx4 s[32:35], s[0:1], 32
MV 116,v,24,v,68
TR 16,216,0
TR 18,216,1024
MV 120,v,24,v,72
TR 20,217,0
TR 22,217,1024
MV 124,v,24,v,76
ds_read_b128 v[48:51], v226 offset:0
s_add_u32 m0, s68, 131072
MV 128,v,28,v,64
TR 24,218,0
TR 26,218,1024
MV 132,v,28,v,68
ds_read_b128 v[52:55], v226 offset:2048
buffer_load_dwordx4 v212, s[48:51], s66 offen offset:0 lds
MV 136,v,28,v,72
buffer_load_dwordx4 v213, s[48:51], s66 offen offset:1024 lds
buffer_load_dwordx4 v214, s[48:51], s66 offen offset:2048 lds
MV 140,v,28,v,76
TR 28,219,0
TR 30,219,1024
MV 144,v,32,v,64
ds_read_b128 v[56:59], v226 offset:4096
v_accvgpr_write_b32 a20, 0
MV 148,v,32,v,68
buffer_load_dwordx4 v215, s[48:51], s66 offen offset:3072 lds
v_accvgpr_write_b32 a21, 0
MV 152,v,32,v,72
v_accvgpr_write_b32 a22, 0
v_accvgpr_write_b32 a23, 0
MV 156,v,32,v,76
TR 32,220,0
TR 34,220,1024
MV 160,v,36,v,64
ds_read_b128 v[60:63], v226 offset:6144
s_add_u32 s66, s66, 524288
MV 164,v,36,v,68
s_and_b32 s66, s66, 8388607
v_accvgpr_write_b32 a24, 0
MV 168,v,36,v,72
v_accvgpr_write_b32 a25, 0
v_accvgpr_write_b32 a26, 0
MV 172,v,36,v,76
TR 36,221,0
TR 38,221,1024
MV 176,v,40,v,64
s_add_u32 s75, s64, s74
v_accvgpr_write_b32 a27, 0
MV 180,v,40,v,68
v_accvgpr_write_b32 a28, 0
v_accvgpr_write_b32 a29, 0
MV 184,v,40,v,72
s_add_u32 m0, s67, 32768
v_accvgpr_write_b32 a30, 0
MV 188,v,40,v,76
TR 40,222,0
TR 42,222,1024
MV 192,v,44,v,64
buffer_load_dwordx4 v208, s[44:47], s75 offen offset:0 lds
v_accvgpr_write_b32 a31, 0
MV 196,v,44,v,68
MV 200,v,44,v,72
MV 204,v,44,v,76
TR 44,223,0
TR 46,223,1024
s_waitcnt lgkmcnt(4)
MV 80,v,16,v,48
buffer_load_dwordx4 v209, s[44:47], s75 offen offset:1024 lds
v_accvgpr_write_b32 a32, 0
MV 84,v,16,v,52
ds_read_b128 v[64:67], v227 offset:0
v_accvgpr_write_b32 a33, 0
MV 88,v,16,v,56
buffer_load_dwordx4 v210, s[44:47], s75 offen offset:2048 lds
v_accvgpr_write_b32 a34, 0
MV 92,v,16,v,60
TR 16,216,8192
TR 18,216,9216
MV 96,v,20,v,48
v_accvgpr_write_b32 a35, 0
v_accvgpr_write_b32 a36, 0
MV 100,v,20,v,52
buffer_load_dwordx4 v211, s[44:47], s75 offen offset:3072 lds
v_accvgpr_write_b32 a37, 0
MV 104,v,20,v,56
ds_read_b128 v[68:71], v227 offset:2048
v_accvgpr_write_b32 a38, 0
MV 108,v,20,v,60
TR 20,217,8192
TR 22,217,9216
MV 112,v,24,v,48
s_add_u32 s75, s65, s74
v_accvgpr_write_b32 a39, 0
MV 116,v,24,v,52
v_accvgpr_write_b32 a40, 0
v_accvgpr_write_b32 a41, 0
MV 120,v,24,v,56
v_accvgpr_write_b32 a42, 0
v_accvgpr_write_b32 a43, 0
MV 124,v,24,v,60
TR 24,218,8192
TR 26,218,9216
MV 128,v,28,v,48
ds_read_b128 v[72:75], v227 offset:4096
s_add_u32 m0, s67, 36864
MV 132,v,28,v,52
v_accvgpr_write_b32 a44, 0
v_accvgpr_write_b32 a45, 0
MV 136,v,28,v,56
buffer_load_dwordx4 v208, s[44:47], s75 offen offset:0 lds
v_accvgpr_write_b32 a46, 0
MV 140,v,28,v,60
TR 28,219,8192
TR 30,219,9216
MV 144,v,32,v,48
buffer_load_dwordx4 v209, s[44:47], s75 offen offset:1024 lds
v_accvgpr_write_b32 a47, 0
MV 148,v,32,v,52
s_and_b32 s36, s2, 3
s_lshl_b32 s36, s36, 1
MV 152,v,32,v,56
ds_read_b128 v[76:79], v227 offset:6144
s_sub_u32 s43, 14, s36
MV 156,v,32,v,60
TR 32,220,8192
TR 34,220,9216
MV 160,v,36,v,48
buffer_load_dwordx4 v210, s[44:47], s75 offen offset:2048 lds
MV 164,v,36,v,52
s_bitcmp1_b32 s2, 4
s_cselect_b32 s36, s43, s36
MV 168,v,36,v,56
buffer_load_dwordx4 v211, s[44:47], s75 offen offset:3072 lds
s_bfe_u32 s43, s2, 0x10003
MV 172,v,36,v,60
TR 36,221,8192
TR 38,221,9216
s_waitcnt lgkmcnt(15)
MV 176,v,40,v,48
s_add_u32 s36, s36, s43
s_bfe_u32 s37, s2, 0x10002
MV 180,v,40,v,52
s_add_u32 s74, s74, 128
s_lshr_b32 s43, s2, 5
MV 184,v,40,v,56
s_lshl_b32 s43, s43, 1
s_add_u32 s37, s37, s43
MV 188,v,40,v,60
TR 40,222,8192
TR 42,222,9216
MV 192,v,44,v,48
s_and_b32 s74, s74, 2047
v_and_b32 v230, 15, v1
MV 196,v,44,v,52
s_lshl_b32 s36, s36, 4
v_add_u32 v231, s36, v230
MV 200,v,44,v,56
s_lshr_b32 s36, s2, 4
v_lshl_add_u32 v232, v230, 4, s36
MV 204,v,44,v,60
TR 44,223,8192
TR 46,223,9216
v_and_b32 v233, 7, v1
v_bfe_u32 v234, v1, 3, 1
v_lshlrev_b32 v233, 3, v233
v_lshl_add_u32 v233, v234, 7, v233
s_bfe_u32 s36, s2, 0x10004
s_lshl_b32 s36, s36, 6
s_and_b32 s37, s2, 7
s_add_u32 s36, s36, s37
v_add_u32 v233, s36, v233
v_lshrrev_b32 v234, 4, v1
v_cmp_eq_u32 vcc, 1, v234
s_nop 1
v_cndmask_b32 v233, v233, v232, vcc
v_cmp_eq_u32 vcc, 2, v234
s_nop 1
v_cndmask_b32 v233, v233, v231, vcc
v_lshlrev_b32 v233, 2, v233
s_waitcnt lgkmcnt(4)
MV 80,v,16,v,64
v_accvgpr_write_b32 a48, 0
MV 84,v,16,v,68
v_accvgpr_write_b32 a49, 0
MV 88,v,16,v,72
MV 92,v,16,v,76
v_accvgpr_write_b32 a50, 0
MV 96,v,20,v,64
MV 100,v,20,v,68
v_accvgpr_write_b32 a51, 0
MV 104,v,20,v,72
MV 108,v,20,v,76
s_waitcnt vmcnt(13) lgkmcnt(0)
s_barrier
MV 112,v,24,v,64
TR 16,216,16384
TR 18,216,17408
MV 116,v,24,v,68
ds_read_b128 v[48:51], v224 offset:0
s_add_u32 m0, s68, 98304
MV 120,v,24,v,72
TR 20,217,16384
TR 22,217,17408
MV 124,v,24,v,76
buffer_load_dwordx4 v212, s[48:51], s66 offen offset:0 lds
v_accvgpr_write_b32 a52, 0
MV 128,v,28,v,64
TR 24,218,16384
TR 26,218,17408
MV 132,v,28,v,68
ds_read_b128 v[52:55], v224 offset:2048
buffer_load_dwordx4 v213, s[48:51], s66 offen offset:1024 lds
MV 136,v,28,v,72
buffer_load_dwordx4 v214, s[48:51], s66 offen offset:2048 lds
v_accvgpr_write_b32 a53, 0
MV 140,v,28,v,76
TR 28,219,16384
TR 30,219,17408
MV 144,v,32,v,64
ds_read_b128 v[56:59], v224 offset:4096
v_accvgpr_write_b32 a54, 0
MV 148,v,32,v,68
buffer_load_dwordx4 v215, s[48:51], s66 offen offset:3072 lds
v_accvgpr_write_b32 a55, 0
MV 152,v,32,v,72
v_accvgpr_write_b32 a56, 0
v_accvgpr_write_b32 a57, 0
MV 156,v,32,v,76
TR 32,220,16384
TR 34,220,17408
MV 160,v,36,v,64
ds_read_b128 v[60:63], v224 offset:6144
s_add_u32 s66, s66, 524288
MV 164,v,36,v,68
s_and_b32 s66, s66, 8388607
v_accvgpr_write_b32 a58, 0
MV 168,v,36,v,72
v_accvgpr_write_b32 a59, 0
v_accvgpr_write_b32 a60, 0
MV 172,v,36,v,76
TR 36,221,16384
TR 38,221,17408
MV 176,v,40,v,64
s_add_u32 s75, s64, s74
v_accvgpr_write_b32 a61, 0
MV 180,v,40,v,68
MV 184,v,40,v,72
s_add_u32 m0, s67, 65536
v_accvgpr_write_b32 a62, 0
MV 188,v,40,v,76
TR 40,222,16384
TR 42,222,17408
MV 192,v,44,v,64
buffer_load_dwordx4 v208, s[44:47], s75 offen offset:0 lds
v_accvgpr_write_b32 a63, 0
MV 196,v,44,v,68
MV 200,v,44,v,72
MV 204,v,44,v,76
TR 44,223,16384
TR 46,223,17408
s_waitcnt lgkmcnt(4)
MV 80,v,16,v,48
buffer_load_dwordx4 v209, s[44:47], s75 offen offset:1024 lds
v_accvgpr_write_b32 a64, 0
MV 84,v,16,v,52
ds_read_b128 v[64:67], v225 offset:0
v_accvgpr_write_b32 a65, 0
MV 88,v,16,v,56
buffer_load_dwordx4 v210, s[44:47], s75 offen offset:2048 lds
v_accvgpr_write_b32 a66, 0
MV 92,v,16,v,60
TR 16,216,24576
TR 18,216,25600
MV 96,v,20,v,48
v_accvgpr_write_b32 a67, 0
v_accvgpr_write_b32 a68, 0
MV 100,v,20,v,52
buffer_load_dwordx4 v211, s[44:47], s75 offen offset:3072 lds
v_accvgpr_write_b32 a69, 0
MV 104,v,20,v,56
ds_read_b128 v[68:71], v225 offset:2048
v_accvgpr_write_b32 a70, 0
MV 108,v,20,v,60
TR 20,217,24576
TR 22,217,25600
MV 112,v,24,v,48
s_add_u32 s75, s65, s74
v_accvgpr_write_b32 a71, 0
MV 116,v,24,v,52
v_accvgpr_write_b32 a72, 0
v_accvgpr_write_b32 a73, 0
MV 120,v,24,v,56
v_accvgpr_write_b32 a74, 0
v_accvgpr_write_b32 a75, 0
MV 124,v,24,v,60
TR 24,218,24576
TR 26,218,25600
MV 128,v,28,v,48
ds_read_b128 v[72:75], v225 offset:4096
s_add_u32 m0, s67, 69632
MV 132,v,28,v,52
v_accvgpr_write_b32 a76, 0
v_accvgpr_write_b32 a77, 0
MV 136,v,28,v,56
buffer_load_dwordx4 v208, s[44:47], s75 offen offset:0 lds
v_accvgpr_write_b32 a78, 0
MV 140,v,28,v,60
TR 28,219,24576
TR 30,219,25600
MV 144,v,32,v,48
buffer_load_dwordx4 v209, s[44:47], s75 offen offset:1024 lds
v_accvgpr_write_b32 a79, 0
MV 148,v,32,v,52
s_lshl_b32 s36, s2, 2
s_add_u32 s36, s36, s3
MV 152,v,32,v,56
ds_read_b128 v[76:79], v225 offset:6144
s_lshl_b32 s42, s36, 1
MV 156,v,32,v,60
TR 32,220,24576
TR 34,220,25600
MV 160,v,36,v,48
buffer_load_dwordx4 v210, s[44:47], s75 offen offset:2048 lds
s_lshl_b32 s37, s36, 12
MV 164,v,36,v,52
s_add_u32 s16, s32, s37
s_addc_u32 s17, s33, 0
MV 168,v,36,v,56
buffer_load_dwordx4 v211, s[44:47], s75 offen offset:3072 lds
s_mov_b32 s18, 4096
MV 172,v,36,v,60
TR 36,221,24576
TR 38,221,25600
s_waitcnt lgkmcnt(15)
MV 176,v,40,v,48
s_mov_b32 s19, 0x20000
s_add_u32 s37, s37, 50331648
MV 180,v,40,v,52
s_add_u32 s74, s74, 128
MV 184,v,40,v,56
s_add_u32 s20, s40, s37
s_addc_u32 s21, s41, 0
MV 188,v,40,v,60
TR 40,222,24576
TR 42,222,25600
MV 192,v,44,v,48
s_and_b32 s74, s74, 2047
s_mov_b32 s22, 4096
MV 196,v,44,v,52
s_mov_b32 s23, 0x20000
s_lshl_b32 s37, s2, 14
MV 200,v,44,v,56
s_add_u32 s37, s37, 54525952
MV 204,v,44,v,60
TR 44,223,24576
TR 46,223,25600
s_add_u32 s24, s40, s37
s_addc_u32 s25, s41, 0
s_mov_b32 s26, 16384
s_mov_b32 s27, 0x20000
s_mov_b32 s28, s34
s_mov_b32 s29, s35
s_mov_b32 s30, 2048
s_mov_b32 s31, 0x20000
s_mul_i32 s43, s3, 4608
s_add_u32 s43, s43, 132096
s_waitcnt lgkmcnt(4)
MV 80,v,16,v,64
v_accvgpr_write_b32 a80, 0
MV 84,v,16,v,68
v_accvgpr_write_b32 a81, 0
MV 88,v,16,v,72
MV 92,v,16,v,76
v_accvgpr_write_b32 a82, 0
MV 96,v,20,v,64
MV 100,v,20,v,68
v_accvgpr_write_b32 a83, 0
MV 104,v,20,v,72
MV 108,v,20,v,76
s_waitcnt vmcnt(12) lgkmcnt(0)
s_barrier
MV 112,v,24,v,64
s_load_dwordx2 s[32:33], s[0:1], 88
TR 16,216,32768
MV 116,v,24,v,68
TR 18,216,33792
ds_read_b128 v[48:51], v224 offset:32768
MV 120,v,24,v,72
TR 20,217,32768
TR 22,217,33792
MV 124,v,24,v,76
v_accvgpr_write_b32 a84, 0
v_accvgpr_write_b32 a85, 0
MV 128,v,28,v,64
TR 24,218,32768
TR 26,218,33792
MV 132,v,28,v,68
ds_read_b128 v[52:55], v224 offset:34816
v_accvgpr_write_b32 a86, 0
MV 136,v,28,v,72
v_accvgpr_write_b32 a87, 0
MV 140,v,28,v,76
TR 28,219,32768
TR 30,219,33792
MV 144,v,32,v,64
ds_read_b128 v[56:59], v224 offset:36864
v_accvgpr_write_b32 a88, 0
MV 148,v,32,v,68
v_accvgpr_write_b32 a89, 0
MV 152,v,32,v,72
v_accvgpr_write_b32 a90, 0
MV 156,v,32,v,76
TR 32,220,32768
TR 34,220,33792
MV 160,v,36,v,64
ds_read_b128 v[60:63], v224 offset:38912
v_accvgpr_write_b32 a91, 0
MV 164,v,36,v,68
MV 168,v,36,v,72
v_accvgpr_write_b32 a92, 0
MV 172,v,36,v,76
TR 36,221,32768
TR 38,221,33792
MV 176,v,40,v,64
v_accvgpr_write_b32 a93, 0
MV 180,v,40,v,68
MV 184,v,40,v,72
v_accvgpr_write_b32 a94, 0
MV 188,v,40,v,76
TR 40,222,32768
TR 42,222,33792
MV 192,v,44,v,64
v_accvgpr_write_b32 a95, 0
MV 196,v,44,v,68
MV 200,v,44,v,72
MV 204,v,44,v,76
TR 44,223,32768
TR 46,223,33792
s_waitcnt lgkmcnt(4)
MV 80,v,16,v,48
v_accvgpr_write_b32 a96, 0
MV 84,v,16,v,52
ds_read_b128 v[64:67], v225 offset:32768
v_accvgpr_write_b32 a97, 0
MV 88,v,16,v,56
MV 92,v,16,v,60
TR 16,216,40960
TR 18,216,41984
MV 96,v,20,v,48
v_accvgpr_write_b32 a98, 0
MV 100,v,20,v,52
v_accvgpr_write_b32 a99, 0
MV 104,v,20,v,56
ds_read_b128 v[68:71], v225 offset:34816
MV 108,v,20,v,60
TR 20,217,40960
TR 22,217,41984
MV 112,v,24,v,48
v_accvgpr_write_b32 a100, 0
MV 116,v,24,v,52
v_accvgpr_write_b32 a101, 0
MV 120,v,24,v,56
MV 124,v,24,v,60
TR 24,218,40960
TR 26,218,41984
MV 128,v,28,v,48
ds_read_b128 v[72:75], v225 offset:36864
v_accvgpr_write_b32 a102, 0
MV 132,v,28,v,52
v_accvgpr_write_b32 a103, 0
MV 136,v,28,v,56
MV 140,v,28,v,60
TR 28,219,40960
TR 30,219,41984
MV 144,v,32,v,48
v_accvgpr_write_b32 a104, 0
v_accvgpr_write_b32 a105, 0
MV 148,v,32,v,52
MV 152,v,32,v,56
ds_read_b128 v[76:79], v225 offset:38912
v_accvgpr_write_b32 a106, 0
MV 156,v,32,v,60
TR 32,220,40960
TR 34,220,41984
MV 160,v,36,v,48
v_accvgpr_write_b32 a107, 0
MV 164,v,36,v,52
MV 168,v,36,v,56
v_accvgpr_write_b32 a108, 0
MV 172,v,36,v,60
TR 36,221,40960
TR 38,221,41984
s_waitcnt lgkmcnt(15)
MV 176,v,40,v,48
v_accvgpr_write_b32 a109, 0
MV 180,v,40,v,52
MV 184,v,40,v,56
v_accvgpr_write_b32 a110, 0
MV 188,v,40,v,60
TR 40,222,40960
TR 42,222,41984
MV 192,v,44,v,48
v_accvgpr_write_b32 a111, 0
MV 196,v,44,v,52
MV 200,v,44,v,56
MV 204,v,44,v,60
TR 44,223,40960
TR 46,223,41984
s_waitcnt lgkmcnt(4)
MV 80,v,16,v,64
v_accvgpr_write_b32 a112, 0
MV 84,v,16,v,68
v_accvgpr_write_b32 a113, 0
MV 88,v,16,v,72
MV 92,v,16,v,76
v_accvgpr_write_b32 a114, 0
MV 96,v,20,v,64
MV 100,v,20,v,68
v_accvgpr_write_b32 a115, 0
MV 104,v,20,v,72
MV 108,v,20,v,76
s_waitcnt vmcnt(0) lgkmcnt(0)
s_barrier
MV 112,v,24,v,64
TR 16,216,0
TR 18,216,1024
MV 116,v,24,v,68
ds_read_b128 v[48:51], v226 offset:0
v_accvgpr_write_b32 a116, 0
MV 120,v,24,v,72
TR 20,217,0
TR 22,217,1024
MV 124,v,24,v,76
v_accvgpr_write_b32 a117, 0
v_accvgpr_write_b32 a118, 0
MV 128,v,28,v,64
TR 24,218,0
TR 26,218,1024
MV 132,v,28,v,68
ds_read_b128 v[52:55], v226 offset:2048
v_accvgpr_write_b32 a119, 0
MV 136,v,28,v,72
MV 140,v,28,v,76
TR 28,219,0
TR 30,219,1024
MV 144,v,32,v,64
ds_read_b128 v[56:59], v226 offset:4096
v_accvgpr_write_b32 a120, 0
MV 148,v,32,v,68
v_accvgpr_write_b32 a121, 0
MV 152,v,32,v,72
v_accvgpr_write_b32 a122, 0
MV 156,v,32,v,76
TR 32,220,0
TR 34,220,1024
MV 160,v,36,v,64
ds_read_b128 v[60:63], v226 offset:6144
v_accvgpr_write_b32 a123, 0
MV 164,v,36,v,68
MV 168,v,36,v,72
v_accvgpr_write_b32 a124, 0
MV 172,v,36,v,76
TR 36,221,0
TR 38,221,1024
MV 176,v,40,v,64
v_accvgpr_write_b32 a125, 0
MV 180,v,40,v,68
MV 184,v,40,v,72
v_accvgpr_write_b32 a126, 0
MV 188,v,40,v,76
TR 40,222,0
TR 42,222,1024
MV 192,v,44,v,64
v_accvgpr_write_b32 a127, 0
MV 196,v,44,v,68
MV 200,v,44,v,72
MV 204,v,44,v,76
TR 44,223,0
TR 46,223,1024
s_waitcnt lgkmcnt(4)
MV 80,v,16,v,48
buffer_load_dword v237, v233, s[8:11], 0 offen offset:0 sc1
MV 84,v,16,v,52
ds_read_b128 v[64:67], v227 offset:0
MV 88,v,16,v,56
s_lshr_b32 s36, s2, 3
MV 92,v,16,v,60
TR 16,216,8192
TR 18,216,9216
MV 96,v,20,v,48
MV 100,v,20,v,52
s_lshl_b32 s36, s36, 18
MV 104,v,20,v,56
ds_read_b128 v[68:71], v227 offset:2048
MV 108,v,20,v,60
TR 20,217,8192
TR 22,217,9216
MV 112,v,24,v,48
s_and_b32 s37, s2, 7
MV 116,v,24,v,52
MV 120,v,24,v,56
s_lshl_b32 s37, s37, 8
MV 124,v,24,v,60
TR 24,218,8192
TR 26,218,9216
MV 128,v,28,v,48
ds_read_b128 v[72:75], v227 offset:4096
s_add_u32 s36, s36, s37
MV 132,v,28,v,52
MV 136,v,28,v,56
MV 140,v,28,v,60
TR 28,219,8192
TR 30,219,9216
MV 144,v,32,v,48
s_lshl_b32 s37, s3, 16
MV 148,v,32,v,52
s_add_u32 s36, s36, s37
MV 152,v,32,v,56
ds_read_b128 v[76:79], v227 offset:6144
MV 156,v,32,v,60
TR 32,220,8192
TR 34,220,9216
MV 160,v,36,v,48
s_add_u32 s32, s32, s36
s_addc_u32 s33, s33, 0
MV 164,v,36,v,52
MV 168,v,36,v,56
MV 172,v,36,v,60
TR 36,221,8192
TR 38,221,9216
s_waitcnt lgkmcnt(15)
MV 176,v,40,v,48
MV 180,v,40,v,52
s_mov_b32 s34, 65536
MV 184,v,40,v,56
MV 188,v,40,v,60
TR 40,222,8192
TR 42,222,9216
MV 192,v,44,v,48
s_mov_b32 s35, 0x20000
MV 196,v,44,v,52
MV 200,v,44,v,56
MV 204,v,44,v,60
TR 44,223,8192
TR 46,223,9216
s_waitcnt lgkmcnt(4)
MV 80,v,16,v,64
MV 84,v,16,v,68
MV 88,v,16,v,72
MV 92,v,16,v,76
MV 96,v,20,v,64
MV 100,v,20,v,68
MV 104,v,20,v,72
MV 108,v,20,v,76
MV 112,v,24,v,64
MV 116,v,24,v,68
MV 120,v,24,v,72
MV 124,v,24,v,76
MV 128,v,28,v,64
MV 132,v,28,v,68
MV 136,v,28,v,72
MV 140,v,28,v,76
MV 144,v,32,v,64
MV 148,v,32,v,68
MV 152,v,32,v,72
MV 156,v,32,v,76
MV 160,v,36,v,64
MV 164,v,36,v,68
MV 168,v,36,v,72
MV 172,v,36,v,76
s_waitcnt lgkmcnt(2)
MV 176,v,40,v,64
MV 180,v,40,v,68
MV 184,v,40,v,72
MV 188,v,40,v,76
s_waitcnt lgkmcnt(0)
MV 192,v,44,v,64
MV 196,v,44,v,68
MV 200,v,44,v,72
MV 204,v,44,v,76
s_waitcnt vmcnt(0)
v_cmp_gt_u32 vcc, 1, v237
s_nop 4
s_cbranch_vccnz L_spin_f1
L_spin_f1_ret:
s_waitcnt lgkmcnt(0)
s_barrier
s_add_u32 m0, s68, 16384
s_mov_b32 s80, 0
buffer_load_dwordx4 v12, s[52:55], s80 offen offset:0 sc1 lds
buffer_load_dwordx4 v12, s[52:55], s80 offen offset:1024 sc1 lds
buffer_load_dwordx4 v12, s[52:55], s80 offen offset:2048 sc1 lds
buffer_load_dwordx4 v12, s[52:55], s80 offen offset:3072 sc1 lds
s_add_u32 m0, s68, 32768
s_mov_b32 s80, 16384
buffer_load_dwordx4 v12, s[52:55], s80 offen offset:0 sc1 lds
buffer_load_dwordx4 v12, s[52:55], s80 offen offset:1024 sc1 lds
buffer_load_dwordx4 v12, s[52:55], s80 offen offset:2048 sc1 lds
buffer_load_dwordx4 v12, s[52:55], s80 offen offset:3072 sc1 lds
s_mov_b32 s82, 0x3e0293ee
s_mov_b32 s83, 0x3e0293ee
v_pk_mul_f32 v[80:81], v[80:81], s[82:83]
v_pk_mul_f32 v[82:83], v[82:83], s[82:83]
v_pk_mul_f32 v[84:85], v[84:85], s[82:83]
v_pk_mul_f32 v[86:87], v[86:87], s[82:83]
v_pk_mul_f32 v[88:89], v[88:89], s[82:83]
s_add_u32 m0, s68, 81920
v_pk_mul_f32 v[90:91], v[90:91], s[82:83]
v_pk_mul_f32 v[92:93], v[92:93], s[82:83]
v_pk_mul_f32 v[94:95], v[94:95], s[82:83]
v_pk_mul_f32 v[96:97], v[96:97], s[82:83]
v_pk_mul_f32 v[98:99], v[98:99], s[82:83]
v_pk_mul_f32 v[100:101], v[100:101], s[82:83]
v_pk_mul_f32 v[102:103], v[102:103], s[82:83]
v_pk_mul_f32 v[104:105], v[104:105], s[82:83]
s_mov_b32 s80, 16384
v_pk_mul_f32 v[106:107], v[106:107], s[82:83]
v_pk_mul_f32 v[108:109], v[108:109], s[82:83]
v_pk_mul_f32 v[110:111], v[110:111], s[82:83]
v_cvt_pk_bf16_f32 v16, v80, v81
v_cvt_pk_bf16_f32 v17, v82, v83
v_cvt_pk_bf16_f32 v18, v96, v97
v_cvt_pk_bf16_f32 v19, v98, v99
buffer_load_dwordx4 v12, s[56:59], s80 offen offset:0 sc1 lds
v_cvt_pk_bf16_f32 v32, v84, v85
v_cvt_pk_bf16_f32 v33, v86, v87
v_cvt_pk_bf16_f32 v34, v100, v101
v_cvt_pk_bf16_f32 v35, v102, v103
v_cvt_pk_bf16_f32 v48, v88, v89
v_cvt_pk_bf16_f32 v49, v90, v91
v_cvt_pk_bf16_f32 v50, v104, v105
v_cvt_pk_bf16_f32 v51, v106, v107
buffer_load_dwordx4 v12, s[56:59], s80 offen offset:1024 sc1 lds
v_cvt_pk_bf16_f32 v64, v92, v93
v_cvt_pk_bf16_f32 v65, v94, v95
v_cvt_pk_bf16_f32 v66, v108, v109
v_cvt_pk_bf16_f32 v67, v110, v111
v_pk_mul_f32 v[112:113], v[112:113], s[82:83]
v_pk_mul_f32 v[114:115], v[114:115], s[82:83]
v_pk_mul_f32 v[116:117], v[116:117], s[82:83]
buffer_load_dwordx4 v12, s[56:59], s80 offen offset:2048 sc1 lds
v_pk_mul_f32 v[118:119], v[118:119], s[82:83]
v_pk_mul_f32 v[120:121], v[120:121], s[82:83]
v_pk_mul_f32 v[122:123], v[122:123], s[82:83]
v_pk_mul_f32 v[124:125], v[124:125], s[82:83]
v_pk_mul_f32 v[126:127], v[126:127], s[82:83]
v_pk_mul_f32 v[128:129], v[128:129], s[82:83]
v_pk_mul_f32 v[130:131], v[130:131], s[82:83]
v_pk_mul_f32 v[132:133], v[132:133], s[82:83]
buffer_load_dwordx4 v12, s[56:59], s80 offen offset:3072 sc1 lds
v_pk_mul_f32 v[134:135], v[134:135], s[82:83]
v_pk_mul_f32 v[136:137], v[136:137], s[82:83]
v_pk_mul_f32 v[138:139], v[138:139], s[82:83]
v_pk_mul_f32 v[140:141], v[140:141], s[82:83]
v_pk_mul_f32 v[142:143], v[142:143], s[82:83]
v_cvt_pk_bf16_f32 v20, v112, v113
v_cvt_pk_bf16_f32 v21, v114, v115
s_add_u32 m0, s68, 49152
v_cvt_pk_bf16_f32 v22, v128, v129
v_cvt_pk_bf16_f32 v23, v130, v131
v_cvt_pk_bf16_f32 v36, v116, v117
v_cvt_pk_bf16_f32 v37, v118, v119
v_cvt_pk_bf16_f32 v38, v132, v133
v_cvt_pk_bf16_f32 v39, v134, v135
v_cvt_pk_bf16_f32 v52, v120, v121
v_cvt_pk_bf16_f32 v53, v122, v123
s_mov_b32 s80, 32768
v_cvt_pk_bf16_f32 v54, v136, v137
v_cvt_pk_bf16_f32 v55, v138, v139
v_cvt_pk_bf16_f32 v68, v124, v125
v_cvt_pk_bf16_f32 v69, v126, v127
v_cvt_pk_bf16_f32 v70, v140, v141
v_cvt_pk_bf16_f32 v71, v142, v143
v_pk_mul_f32 v[144:145], v[144:145], s[82:83]
buffer_load_dwordx4 v12, s[52:55], s80 offen offset:0 sc1 lds
v_pk_mul_f32 v[146:147], v[146:147], s[82:83]
v_pk_mul_f32 v[148:149], v[148:149], s[82:83]
v_pk_mul_f32 v[150:151], v[150:151], s[82:83]
v_pk_mul_f32 v[152:153], v[152:153], s[82:83]
v_pk_mul_f32 v[154:155], v[154:155], s[82:83]
v_pk_mul_f32 v[156:157], v[156:157], s[82:83]
v_pk_mul_f32 v[158:159], v[158:159], s[82:83]
v_pk_mul_f32 v[160:161], v[160:161], s[82:83]
buffer_load_dwordx4 v12, s[52:55], s80 offen offset:1024 sc1 lds
v_pk_mul_f32 v[162:163], v[162:163], s[82:83]
v_pk_mul_f32 v[164:165], v[164:165], s[82:83]
v_pk_mul_f32 v[166:167], v[166:167], s[82:83]
v_pk_mul_f32 v[168:169], v[168:169], s[82:83]
v_pk_mul_f32 v[170:171], v[170:171], s[82:83]
v_pk_mul_f32 v[172:173], v[172:173], s[82:83]
v_pk_mul_f32 v[174:175], v[174:175], s[82:83]
buffer_load_dwordx4 v12, s[52:55], s80 offen offset:2048 sc1 lds
v_cvt_pk_bf16_f32 v24, v144, v145
v_cvt_pk_bf16_f32 v25, v146, v147
v_cvt_pk_bf16_f32 v26, v160, v161
v_cvt_pk_bf16_f32 v27, v162, v163
v_cvt_pk_bf16_f32 v40, v148, v149
v_cvt_pk_bf16_f32 v41, v150, v151
v_cvt_pk_bf16_f32 v42, v164, v165
v_cvt_pk_bf16_f32 v43, v166, v167
buffer_load_dwordx4 v12, s[52:55], s80 offen offset:3072 sc1 lds
v_cvt_pk_bf16_f32 v56, v152, v153
v_cvt_pk_bf16_f32 v57, v154, v155
v_cvt_pk_bf16_f32 v58, v168, v169
v_cvt_pk_bf16_f32 v59, v170, v171
v_cvt_pk_bf16_f32 v72, v156, v157
v_cvt_pk_bf16_f32 v73, v158, v159
v_cvt_pk_bf16_f32 v74, v172, v173
s_add_u32 m0, s68, 98304
v_cvt_pk_bf16_f32 v75, v174, v175
v_pk_mul_f32 v[176:177], v[176:177], s[82:83]
v_pk_mul_f32 v[178:179], v[178:179], s[82:83]
v_pk_mul_f32 v[180:181], v[180:181], s[82:83]
v_pk_mul_f32 v[182:183], v[182:183], s[82:83]
v_pk_mul_f32 v[184:185], v[184:185], s[82:83]
v_pk_mul_f32 v[186:187], v[186:187], s[82:83]
v_pk_mul_f32 v[188:189], v[188:189], s[82:83]
s_mov_b32 s80, 32768
v_pk_mul_f32 v[190:191], v[190:191], s[82:83]
v_pk_mul_f32 v[192:193], v[192:193], s[82:83]
v_pk_mul_f32 v[194:195], v[194:195], s[82:83]
v_pk_mul_f32 v[196:197], v[196:197], s[82:83]
v_pk_mul_f32 v[198:199], v[198:199], s[82:83]
v_pk_mul_f32 v[200:201], v[200:201], s[82:83]
v_pk_mul_f32 v[202:203], v[202:203], s[82:83]
buffer_load_dwordx4 v12, s[56:59], s80 offen offset:0 sc1 lds
v_pk_mul_f32 v[204:205], v[204:205], s[82:83]
v_pk_mul_f32 v[206:207], v[206:207], s[82:83]
v_cvt_pk_bf16_f32 v28, v176, v177
v_cvt_pk_bf16_f32 v29, v178, v179
v_cvt_pk_bf16_f32 v30, v192, v193
v_cvt_pk_bf16_f32 v31, v194, v195
v_cvt_pk_bf16_f32 v44, v180, v181
v_cvt_pk_bf16_f32 v45, v182, v183
buffer_load_dwordx4 v12, s[56:59], s80 offen offset:1024 sc1 lds
v_cvt_pk_bf16_f32 v46, v196, v197
v_cvt_pk_bf16_f32 v47, v198, v199
v_cvt_pk_bf16_f32 v60, v184, v185
v_cvt_pk_bf16_f32 v61, v186, v187
v_cvt_pk_bf16_f32 v62, v200, v201
v_cvt_pk_bf16_f32 v63, v202, v203
v_cvt_pk_bf16_f32 v76, v188, v189
buffer_load_dwordx4 v12, s[56:59], s80 offen offset:2048 sc1 lds
v_cvt_pk_bf16_f32 v77, v190, v191
v_cvt_pk_bf16_f32 v78, v204, v205
v_cvt_pk_bf16_f32 v79, v206, v207
v_mov_b32 v2, 0
v_mov_b32 v3, 0
v_mov_b32 v4, 0
v_mov_b32 v5, 0
v_xor_b32 v244, 0x8000, v10
buffer_load_dwordx4 v12, s[56:59], s80 offen offset:3072 sc1 lds
s_waitcnt vmcnt(16)
s_barrier
ds_read_b128 a[128:131], v244 offset:16384
ds_read_b128 a[132:135], v244 offset:17408
ds_read_b128 a[136:139], v244 offset:18432
ds_read_b128 a[140:143], v244 offset:19456
ds_read_b128 a[144:147], v244 offset:20480
ds_read_b128 a[148:151], v244 offset:21504
ds_read_b128 a[152:155], v244 offset:22528
ds_read_b128 a[156:159], v244 offset:23552
ds_read_b128 a[160:163], v244 offset:24576
ds_read_b128 a[164:167], v244 offset:25600
ds_read_b128 a[168:171], v244 offset:26624
ds_read_b128 a[172:175], v244 offset:27648
ds_read_b128 a[176:179], v244 offset:28672
ds_read_b128 a[180:183], v244 offset:29696
ds_read_b128 a[184:187], v244 offset:30720
ds_read_b128 a[188:191], v244 offset:31744
s_waitcnt lgkmcnt(15)
v_mfma_f32_16x16x32_bf16 v[80:83], a[128:131], v[16:19], 0
s_add_u32 m0, s68, 0
v_mfma_f32_16x16x32_bf16 v[88:91], a[128:131], v[32:35], 0
s_mov_b32 s80, 49152
v_mfma_f32_16x16x32_bf16 v[96:99], a[128:131], v[48:51], 0
v_mfma_f32_16x16x32_bf16 v[104:107], a[128:131], v[64:67], 0
buffer_load_dwordx4 v12, s[52:55], s80 offen offset:0 sc1 lds
s_waitcnt lgkmcnt(14)
MV 80,a,132,v,20
MV 88,a,132,v,36
buffer_load_dwordx4 v12, s[52:55], s80 offen offset:1024 sc1 lds
MV 96,a,132,v,52
MV 104,a,132,v,68
buffer_load_dwordx4 v12, s[52:55], s80 offen offset:2048 sc1 lds
s_waitcnt lgkmcnt(13)
MV 80,a,136,v,24
MV 88,a,136,v,40
buffer_load_dwordx4 v12, s[52:55], s80 offen offset:3072 sc1 lds
MV 96,a,136,v,56
MV 104,a,136,v,72
s_add_u32 m0, s68, 114688
s_waitcnt lgkmcnt(12)
MV 80,a,140,v,28
s_mov_b32 s80, 49152
MV 88,a,140,v,44
MV 96,a,140,v,60
buffer_load_dwordx4 v12, s[56:59], s80 offen offset:0 sc1 lds
MV 104,a,140,v,76
s_waitcnt lgkmcnt(11)
v_mfma_f32_16x16x32_bf16 v[84:87], a[144:147], v[16:19], 0
buffer_load_dwordx4 v12, s[56:59], s80 offen offset:1024 sc1 lds
v_mfma_f32_16x16x32_bf16 v[92:95], a[144:147], v[32:35], 0
v_mfma_f32_16x16x32_bf16 v[100:103], a[144:147], v[48:51], 0
buffer_load_dwordx4 v12, s[56:59], s80 offen offset:2048 sc1 lds
v_mfma_f32_16x16x32_bf16 v[108:111], a[144:147], v[64:67], 0
s_waitcnt lgkmcnt(10)
MV 84,a,148,v,20
buffer_load_dwordx4 v12, s[56:59], s80 offen offset:3072 sc1 lds
MV 92,a,148,v,36
MV 100,a,148,v,52
MV 108,a,148,v,68
s_waitcnt lgkmcnt(9)
MV 84,a,152,v,24
s_waitcnt vmcnt(16) lgkmcnt(0)
s_barrier
MV 92,a,152,v,40
ds_read_b128 a[128:131], v10 offset:0
s_add_u32 m0, s68, 16384
MV 100,a,152,v,56
ds_read_b128 a[132:135], v10 offset:1024
s_mov_b32 s80, 65536
MV 108,a,152,v,72
ds_read_b128 a[136:139], v10 offset:2048
buffer_load_dwordx4 v12, s[52:55], s80 offen offset:0 sc1 lds
MV 84,a,156,v,28
ds_read_b128 a[140:143], v10 offset:3072
buffer_load_dwordx4 v12, s[52:55], s80 offen offset:1024 sc1 lds
MV 92,a,156,v,44
ds_read_b128 a[144:147], v10 offset:4096
buffer_load_dwordx4 v12, s[52:55], s80 offen offset:2048 sc1 lds
MV 100,a,156,v,60
ds_read_b128 a[148:151], v10 offset:5120
buffer_load_dwordx4 v12, s[52:55], s80 offen offset:3072 sc1 lds
MV 108,a,156,v,76
ds_read_b128 a[152:155], v10 offset:6144
s_mov_b32 s71, 65536
v_mfma_f32_16x16x32_bf16 v[112:115], a[160:163], v[16:19], 0
ds_read_b128 a[156:159], v10 offset:7168
v_mfma_f32_16x16x32_bf16 v[120:123], a[160:163], v[32:35], 0
v_lshrrev_b32 v245, 4, v1
v_mfma_f32_16x16x32_bf16 v[128:131], a[160:163], v[48:51], 0
v_and_b32 v246, 15, v1
v_mfma_f32_16x16x32_bf16 v[136:139], a[160:163], v[64:67], 0
ds_read_b128 a[160:163], v10 offset:8192
v_lshlrev_b32 v247, 1, v245
MV 112,a,164,v,20
v_xor_b32 v246, v246, v247
MV 120,a,164,v,36
v_lshlrev_b32 v245, 11, v245
MV 128,a,164,v,52
v_lshl_add_u32 v245, v246, 4, v245
MV 136,a,164,v,68
ds_read_b128 a[164:167], v10 offset:9216
v_xor_b32 v246, 128, v245
MV 112,a,168,v,24
MV 120,a,168,v,40
s_lshl_b32 s36, s3, 13
MV 128,a,168,v,56
s_add_u32 m0, s36, 131072
MV 136,a,168,v,72
ds_read_b128 a[168:171], v10 offset:10240
s_mov_b32 s37, 0
MV 112,a,172,v,28
buffer_load_dwordx4 v245, s[32:35], s37 offen offset:0 lds
MV 120,a,172,v,44
s_mov_b32 s37, 7168
MV 128,a,172,v,60
buffer_load_dwordx4 v246, s[32:35], s37 offen offset:1024 lds
MV 136,a,172,v,76
ds_read_b128 a[172:175], v10 offset:11264
v_mfma_f32_16x16x32_bf16 v[116:119], a[176:179], v[16:19], 0
s_mov_b32 s37, 14336
v_mfma_f32_16x16x32_bf16 v[124:127], a[176:179], v[32:35], 0
buffer_load_dwordx4 v245, s[32:35], s37 offen offset:2048 lds
v_mfma_f32_16x16x32_bf16 v[132:135], a[176:179], v[48:51], 0
s_mov_b32 s37, 21504
v_mfma_f32_16x16x32_bf16 v[140:143], a[176:179], v[64:67], 0
ds_read_b128 a[176:179], v10 offset:12288
buffer_load_dwordx4 v246, s[32:35], s37 offen offset:3072 lds
MV 116,a,180,v,20
s_add_u32 m0, s36, 135168
MV 124,a,180,v,36
s_mov_b32 s37, 32768
MV 132,a,180,v,52
buffer_load_dwordx4 v245, s[32:35], s37 offen offset:0 lds
MV 140,a,180,v,68
ds_read_b128 a[180:183], v10 offset:13312
MV 116,a,184,v,24
s_mov_b32 s37, 39936
MV 124,a,184,v,40
buffer_load_dwordx4 v246, s[32:35], s37 offen offset:1024 lds
MV 132,a,184,v,56
s_mov_b32 s37, 47104
MV 140,a,184,v,72
ds_read_b128 a[184:187], v10 offset:14336
buffer_load_dwordx4 v245, s[32:35], s37 offen offset:2048 lds
MV 116,a,188,v,28
s_mov_b32 s37, 54272
MV 124,a,188,v,44
buffer_load_dwordx4 v246, s[32:35], s37 offen offset:3072 lds
MV 132,a,188,v,60
MV 140,a,188,v,76
ds_read_b128 a[188:191], v10 offset:15360
s_cmp_eq_u32 s70, 0
s_cbranch_scc1 L_p3_pmask
L_p3_pmask_ret:
v_exp_f32 v80, v80
v_exp_f32 v81, v81
v_exp_f32 v82, v82
v_add_f32 v2, v2, v80
v_add_f32 v2, v2, v81
v_exp_f32 v83, v83
v_cvt_pk_bf16_f32 v80, v80, v81
v_exp_f32 v84, v84
v_add_f32 v2, v2, v82
v_add_f32 v2, v2, v83
v_exp_f32 v85, v85
v_cvt_pk_bf16_f32 v81, v82, v83
v_exp_f32 v86, v86
v_add_f32 v2, v2, v84
v_add_f32 v2, v2, v85
v_exp_f32 v87, v87
v_cvt_pk_bf16_f32 v82, v84, v85
v_exp_f32 v88, v88
v_add_f32 v2, v2, v86
v_add_f32 v2, v2, v87
v_exp_f32 v89, v89
v_cvt_pk_bf16_f32 v83, v86, v87
v_exp_f32 v90, v90
v_add_f32 v3, v3, v88
v_add_f32 v3, v3, v89
v_exp_f32 v91, v91
v_cvt_pk_bf16_f32 v88, v88, v89
v_exp_f32 v92, v92
v_add_f32 v3, v3, v90
v_add_f32 v3, v3, v91
v_exp_f32 v93, v93
v_cvt_pk_bf16_f32 v89, v90, v91
v_exp_f32 v94, v94
v_add_f32 v3, v3, v92
v_add_f32 v3, v3, v93
v_exp_f32 v95, v95
v_cvt_pk_bf16_f32 v90, v92, v93
v_exp_f32 v96, v96
v_add_f32 v3, v3, v94
v_add_f32 v3, v3, v95
v_exp_f32 v97, v97
v_cvt_pk_bf16_f32 v91, v94, v95
v_exp_f32 v98, v98
v_add_f32 v4, v4, v96
v_add_f32 v4, v4, v97
v_exp_f32 v99, v99
v_cvt_pk_bf16_f32 v96, v96, v97
v_exp_f32 v100, v100
v_add_f32 v4, v4, v98
v_add_f32 v4, v4, v99
v_exp_f32 v101, v101
v_cvt_pk_bf16_f32 v97, v98, v99
v_exp_f32 v102, v102
v_add_f32 v4, v4, v100
v_add_f32 v4, v4, v101
v_exp_f32 v103, v103
v_cvt_pk_bf16_f32 v98, v100, v101
v_exp_f32 v104, v104
v_add_f32 v4, v4, v102
v_add_f32 v4, v4, v103
v_exp_f32 v105, v105
v_cvt_pk_bf16_f32 v99, v102, v103
v_exp_f32 v106, v106
v_add_f32 v5, v5, v104
v_add_f32 v5, v5, v105
v_exp_f32 v107, v107
v_cvt_pk_bf16_f32 v104, v104, v105
v_exp_f32 v108, v108
v_add_f32 v5, v5, v106
v_add_f32 v5, v5, v107
v_exp_f32 v109, v109
v_cvt_pk_bf16_f32 v105, v106, v107
v_exp_f32 v110, v110
v_add_f32 v5, v5, v108
v_add_f32 v5, v5, v109
v_exp_f32 v111, v111
v_cvt_pk_bf16_f32 v106, v108, v109
v_add_f32 v5, v5, v110
v_add_f32 v5, v5, v111
v_cvt_pk_bf16_f32 v107, v110, v111
s_sub_u32 s74, s70, 1
s_cbranch_scc1 L_p3_d0m_top
.p2align 5
L_p3_d0_top:
s_waitcnt lgkmcnt(0)
v_mfma_f32_16x16x32_bf16 v[144:147], a[128:131], v[16:19], 0
s_add_u32 m0, s73, 0
ds_read_b128 a[192:195], v11 offset:16384
v_mfma_f32_16x16x32_bf16 v[152:155], a[128:131], v[32:35], 0
v_exp_f32 v112, v112
v_mfma_f32_16x16x32_bf16 v[160:163], a[128:131], v[48:51], 0
ds_read_b128 a[196:199], v11 offset:17408
buffer_load_dwordx4 v12, s[56:59], s71 offen offset:0 sc1 lds
v_mfma_f32_16x16x32_bf16 v[168:171], a[128:131], v[64:67], 0
v_exp_f32 v113, v113
MV 144,a,132,v,20
v_exp_f32 v114, v114
MV 152,a,132,v,36
v_add_f32 v2, v2, v112
v_add_f32 v2, v2, v113
MV 160,a,132,v,52
v_exp_f32 v115, v115
MV 168,a,132,v,68
ds_read_b128 a[200:203], v11 offset:18432
v_cvt_pk_bf16_f32 v112, v112, v113
MV 144,a,136,v,24
v_exp_f32 v116, v116
MV 152,a,136,v,40
v_add_f32 v2, v2, v114
v_add_f32 v2, v2, v115
MV 160,a,136,v,56
v_exp_f32 v117, v117
MV 168,a,136,v,72
ds_read_b128 a[204:207], v11 offset:19456
v_cvt_pk_bf16_f32 v113, v114, v115
MV 144,a,140,v,28
v_exp_f32 v118, v118
MV 152,a,140,v,44
ds_read_b128 a[208:211], v11 offset:20480
v_add_f32 v2, v2, v116
MV 160,a,140,v,60
buffer_load_dwordx4 v12, s[56:59], s71 offen offset:1024 sc1 lds
v_add_f32 v2, v2, v117
MV 168,a,140,v,76
v_exp_f32 v119, v119
v_mfma_f32_16x16x32_bf16 v[148:151], a[144:147], v[16:19], 0
ds_read_b128 a[212:215], v11 offset:21504
v_cvt_pk_bf16_f32 v114, v116, v117
v_mfma_f32_16x16x32_bf16 v[156:159], a[144:147], v[32:35], 0
v_exp_f32 v120, v120
v_mfma_f32_16x16x32_bf16 v[164:167], a[144:147], v[48:51], 0
v_add_f32 v2, v2, v118
v_add_f32 v2, v2, v119
v_mfma_f32_16x16x32_bf16 v[172:175], a[144:147], v[64:67], 0
v_exp_f32 v121, v121
MV 148,a,148,v,20
ds_read_b128 a[216:219], v11 offset:22528
v_cvt_pk_bf16_f32 v115, v118, v119
MV 156,a,148,v,36
v_exp_f32 v122, v122
MV 164,a,148,v,52
v_add_f32 v3, v3, v120
v_add_f32 v3, v3, v121
MV 172,a,148,v,68
v_exp_f32 v123, v123
MV 148,a,152,v,24
ds_read_b128 a[220:223], v11 offset:23552
v_cvt_pk_bf16_f32 v120, v120, v121
MV 156,a,152,v,40
v_exp_f32 v124, v124
MV 164,a,152,v,56
ds_read_b128 a[224:227], v11 offset:24576
v_add_f32 v3, v3, v122
MV 172,a,152,v,72
buffer_load_dwordx4 v12, s[56:59], s71 offen offset:2048 sc1 lds
v_add_f32 v3, v3, v123
MV 148,a,156,v,28
v_exp_f32 v125, v125
MV 156,a,156,v,44
ds_read_b128 a[228:231], v11 offset:25600
v_cvt_pk_bf16_f32 v121, v122, v123
MV 164,a,156,v,60
v_exp_f32 v126, v126
MV 172,a,156,v,76
v_add_f32 v3, v3, v124
v_add_f32 v3, v3, v125
v_mfma_f32_16x16x32_bf16 v[176:179], a[160:163], v[16:19], 0
v_exp_f32 v127, v127
v_mfma_f32_16x16x32_bf16 v[184:187], a[160:163], v[32:35], 0
ds_read_b128 a[232:235], v11 offset:26624
v_cvt_pk_bf16_f32 v122, v124, v125
v_mfma_f32_16x16x32_bf16 v[192:195], a[160:163], v[48:51], 0
v_exp_f32 v128, v128
v_mfma_f32_16x16x32_bf16 v[200:203], a[160:163], v[64:67], 0
v_add_f32 v3, v3, v126
v_add_f32 v3, v3, v127
MV 176,a,164,v,20
v_exp_f32 v129, v129
MV 184,a,164,v,36
ds_read_b128 a[236:239], v11 offset:27648
v_cvt_pk_bf16_f32 v123, v126, v127
MV 192,a,164,v,52
v_exp_f32 v130, v130
MV 200,a,164,v,68
ds_read_b128 a[240:243], v11 offset:28672
v_add_f32 v4, v4, v128
MV 176,a,168,v,24
buffer_load_dwordx4 v12, s[56:59], s71 offen offset:3072 sc1 lds
v_add_f32 v4, v4, v129
MV 184,a,168,v,40
v_exp_f32 v131, v131
MV 192,a,168,v,56
ds_read_b128 a[244:247], v11 offset:29696
v_cvt_pk_bf16_f32 v128, v128, v129
MV 200,a,168,v,72
v_exp_f32 v132, v132
MV 176,a,172,v,28
v_add_f32 v4, v4, v130
v_add_f32 v4, v4, v131
MV 184,a,172,v,44
v_exp_f32 v133, v133
MV 192,a,172,v,60
ds_read_b128 a[248:251], v11 offset:30720
v_cvt_pk_bf16_f32 v129, v130, v131
MV 200,a,172,v,76
v_exp_f32 v134, v134
v_mfma_f32_16x16x32_bf16 v[180:183], a[176:179], v[16:19], 0
v_add_f32 v4, v4, v132
v_add_f32 v4, v4, v133
v_mfma_f32_16x16x32_bf16 v[188:191], a[176:179], v[32:35], 0
v_exp_f32 v135, v135
v_mfma_f32_16x16x32_bf16 v[196:199], a[176:179], v[48:51], 0
ds_read_b128 a[252:255], v11 offset:31744
v_cvt_pk_bf16_f32 v130, v132, v133
v_mfma_f32_16x16x32_bf16 v[204:207], a[176:179], v[64:67], 0
v_exp_f32 v136, v136
MV 180,a,180,v,20
v_add_f32 v4, v4, v134
v_add_f32 v4, v4, v135
MV 188,a,180,v,36
v_exp_f32 v137, v137
MV 196,a,180,v,52
s_add_u32 s71, s71, 16384
v_cvt_pk_bf16_f32 v131, v134, v135
MV 204,a,180,v,68
v_exp_f32 v138, v138
MV 180,a,184,v,24
v_add_f32 v5, v5, v136
v_add_f32 v5, v5, v137
MV 188,a,184,v,40
v_exp_f32 v139, v139
MV 196,a,184,v,56
v_cvt_pk_bf16_f32 v136, v136, v137
MV 204,a,184,v,72
v_exp_f32 v140, v140
MV 180,a,188,v,28
v_add_f32 v5, v5, v138
v_add_f32 v5, v5, v139
MV 188,a,188,v,44
v_exp_f32 v141, v141
MV 196,a,188,v,60
v_cvt_pk_bf16_f32 v137, v138, v139
MV 204,a,188,v,76
v_exp_f32 v142, v142
v_add_f32 v5, v5, v140
v_add_f32 v5, v5, v141
v_exp_f32 v143, v143
v_cvt_pk_bf16_f32 v138, v140, v141
v_add_f32 v5, v5, v142
v_add_f32 v5, v5, v143
v_cvt_pk_bf16_f32 v139, v142, v143
s_waitcnt vmcnt(16) lgkmcnt(0)
MA 0,a,192,v,80
s_barrier
MA 32,a,192,v,88
s_add_u32 m0, s72, 0
ds_read_b128 a[128:131], v10 offset:16384
MA 64,a,192,v,96
v_exp_f32 v144, v144
MA 96,a,192,v,104
ds_read_b128 a[132:135], v10 offset:17408
buffer_load_dwordx4 v12, s[52:55], s71 offen offset:0 sc1 lds
MA 4,a,196,v,80
v_exp_f32 v145, v145
MA 36,a,196,v,88
v_exp_f32 v146, v146
MA 68,a,196,v,96
v_add_f32 v2, v2, v144
v_add_f32 v2, v2, v145
MA 100,a,196,v,104
v_exp_f32 v147, v147
MA 8,a,200,v,80
ds_read_b128 a[136:139], v10 offset:18432
v_cvt_pk_bf16_f32 v144, v144, v145
MA 40,a,200,v,88
v_exp_f32 v148, v148
MA 72,a,200,v,96
v_add_f32 v2, v2, v146
v_add_f32 v2, v2, v147
MA 104,a,200,v,104
ds_read_b128 a[140:143], v10 offset:19456
ds_read_b128 a[144:147], v10 offset:20480
MA 12,a,204,v,80
v_exp_f32 v149, v149
MA 44,a,204,v,88
buffer_load_dwordx4 v12, s[52:55], s71 offen offset:1024 sc1 lds
v_cvt_pk_bf16_f32 v145, v146, v147
MA 76,a,204,v,96
v_exp_f32 v150, v150
MA 108,a,204,v,104
v_add_f32 v2, v2, v148
v_add_f32 v2, v2, v149
MA 16,a,208,v,80
v_exp_f32 v151, v151
MA 48,a,208,v,88
ds_read_b128 a[148:151], v10 offset:21504
v_cvt_pk_bf16_f32 v146, v148, v149
MA 80,a,208,v,96
v_exp_f32 v152, v152
MA 112,a,208,v,104
v_add_f32 v2, v2, v150
v_add_f32 v2, v2, v151
MA 20,a,212,v,80
v_exp_f32 v153, v153
MA 52,a,212,v,88
ds_read_b128 a[152:155], v10 offset:22528
v_cvt_pk_bf16_f32 v147, v150, v151
MA 84,a,212,v,96
v_exp_f32 v154, v154
MA 116,a,212,v,104
v_add_f32 v3, v3, v152
v_add_f32 v3, v3, v153
MA 24,a,216,v,80
ds_read_b128 a[156:159], v10 offset:23552
ds_read_b128 a[160:163], v10 offset:24576
MA 56,a,216,v,88
v_exp_f32 v155, v155
MA 88,a,216,v,96
buffer_load_dwordx4 v12, s[52:55], s71 offen offset:2048 sc1 lds
v_cvt_pk_bf16_f32 v152, v152, v153
MA 120,a,216,v,104
v_exp_f32 v156, v156
MA 28,a,220,v,80
v_add_f32 v3, v3, v154
v_add_f32 v3, v3, v155
MA 60,a,220,v,88
v_exp_f32 v157, v157
MA 92,a,220,v,96
ds_read_b128 a[164:167], v10 offset:25600
v_cvt_pk_bf16_f32 v153, v154, v155
MA 124,a,220,v,104
v_exp_f32 v158, v158
MA 0,a,224,v,112
v_add_f32 v3, v3, v156
v_add_f32 v3, v3, v157
MA 32,a,224,v,120
v_exp_f32 v159, v159
MA 64,a,224,v,128
ds_read_b128 a[168:171], v10 offset:26624
v_cvt_pk_bf16_f32 v154, v156, v157
MA 96,a,224,v,136
v_exp_f32 v160, v160
MA 4,a,228,v,112
v_add_f32 v3, v3, v158
v_add_f32 v3, v3, v159
MA 36,a,228,v,120
ds_read_b128 a[172:175], v10 offset:27648
ds_read_b128 a[176:179], v10 offset:28672
MA 68,a,228,v,128
v_exp_f32 v161, v161
MA 100,a,228,v,136
ds_read_b128 a[180:183], v10 offset:29696
v_cvt_pk_bf16_f32 v155, v158, v159
MA 8,a,232,v,112
v_exp_f32 v162, v162
MA 40,a,232,v,120
v_add_f32 v4, v4, v160
v_add_f32 v4, v4, v161
MA 72,a,232,v,128
v_exp_f32 v163, v163
MA 104,a,232,v,136
buffer_load_dwordx4 v12, s[52:55], s71 offen offset:3072 sc1 lds
v_cvt_pk_bf16_f32 v160, v160, v161
MA 12,a,236,v,112
v_exp_f32 v164, v164
MA 44,a,236,v,120
v_add_f32 v4, v4, v162
v_add_f32 v4, v4, v163
MA 76,a,236,v,128
v_exp_f32 v165, v165
MA 108,a,236,v,136
ds_read_b128 a[184:187], v10 offset:30720
v_cvt_pk_bf16_f32 v161, v162, v163
MA 16,a,240,v,112
v_exp_f32 v166, v166
MA 48,a,240,v,120
v_add_f32 v4, v4, v164
v_add_f32 v4, v4, v165
MA 80,a,240,v,128
v_exp_f32 v167, v167
MA 112,a,240,v,136
ds_read_b128 a[188:191], v10 offset:31744
v_cvt_pk_bf16_f32 v162, v164, v165
MA 20,a,244,v,112
v_exp_f32 v168, v168
MA 52,a,244,v,120
v_add_f32 v4, v4, v166
v_add_f32 v4, v4, v167
MA 84,a,244,v,128
v_exp_f32 v169, v169
MA 116,a,244,v,136
s_sub_u32 s74, s74, 1
v_cvt_pk_bf16_f32 v163, v166, v167
MA 24,a,248,v,112
v_exp_f32 v170, v170
MA 56,a,248,v,120
v_add_f32 v5, v5, v168
v_add_f32 v5, v5, v169
MA 88,a,248,v,128
v_exp_f32 v171, v171
MA 120,a,248,v,136
v_cvt_pk_bf16_f32 v168, v168, v169
MA 28,a,252,v,112
v_exp_f32 v172, v172
MA 60,a,252,v,120
v_add_f32 v5, v5, v170
v_add_f32 v5, v5, v171
MA 92,a,252,v,128
v_exp_f32 v173, v173
MA 124,a,252,v,136
v_cvt_pk_bf16_f32 v169, v170, v171
v_exp_f32 v174, v174
v_add_f32 v5, v5, v172
v_add_f32 v5, v5, v173
v_exp_f32 v175, v175
v_cvt_pk_bf16_f32 v170, v172, v173
v_add_f32 v5, v5, v174
v_add_f32 v5, v5, v175
v_cvt_pk_bf16_f32 v171, v174, v175
s_cbranch_scc1 L_p3_d1m_top
s_waitcnt lgkmcnt(0)
v_xor_b32 v11, 0x8000, v11
v_mfma_f32_16x16x32_bf16 v[80:83], a[128:131], v[16:19], 0
s_add_u32 m0, s73, 16384
ds_read_b128 a[192:195], v11 offset:0
v_mfma_f32_16x16x32_bf16 v[88:91], a[128:131], v[32:35], 0
v_exp_f32 v176, v176
v_mfma_f32_16x16x32_bf16 v[96:99], a[128:131], v[48:51], 0
ds_read_b128 a[196:199], v11 offset:1024
buffer_load_dwordx4 v12, s[56:59], s71 offen offset:0 sc1 lds
v_mfma_f32_16x16x32_bf16 v[104:107], a[128:131], v[64:67], 0
v_exp_f32 v177, v177
MV 80,a,132,v,20
v_exp_f32 v178, v178
MV 88,a,132,v,36
v_add_f32 v2, v2, v176
v_add_f32 v2, v2, v177
MV 96,a,132,v,52
v_exp_f32 v179, v179
MV 104,a,132,v,68
ds_read_b128 a[200:203], v11 offset:2048
v_cvt_pk_bf16_f32 v176, v176, v177
MV 80,a,136,v,24
v_exp_f32 v180, v180
MV 88,a,136,v,40
v_add_f32 v2, v2, v178
v_add_f32 v2, v2, v179
MV 96,a,136,v,56
v_exp_f32 v181, v181
MV 104,a,136,v,72
ds_read_b128 a[204:207], v11 offset:3072
v_cvt_pk_bf16_f32 v177, v178, v179
MV 80,a,140,v,28
v_exp_f32 v182, v182
MV 88,a,140,v,44
buffer_load_dwordx4 v12, s[56:59], s71 offen offset:1024 sc1 lds
v_add_f32 v2, v2, v180
MV 96,a,140,v,60
ds_read_b128 a[208:211], v11 offset:4096
v_add_f32 v2, v2, v181
MV 104,a,140,v,76
v_exp_f32 v183, v183
v_mfma_f32_16x16x32_bf16 v[84:87], a[144:147], v[16:19], 0
ds_read_b128 a[212:215], v11 offset:5120
v_cvt_pk_bf16_f32 v178, v180, v181
v_mfma_f32_16x16x32_bf16 v[92:95], a[144:147], v[32:35], 0
v_exp_f32 v184, v184
v_mfma_f32_16x16x32_bf16 v[100:103], a[144:147], v[48:51], 0
v_add_f32 v2, v2, v182
v_add_f32 v2, v2, v183
v_mfma_f32_16x16x32_bf16 v[108:111], a[144:147], v[64:67], 0
v_exp_f32 v185, v185
MV 84,a,148,v,20
ds_read_b128 a[216:219], v11 offset:6144
v_cvt_pk_bf16_f32 v179, v182, v183
MV 92,a,148,v,36
v_exp_f32 v186, v186
MV 100,a,148,v,52
v_add_f32 v3, v3, v184
v_add_f32 v3, v3, v185
MV 108,a,148,v,68
v_exp_f32 v187, v187
MV 84,a,152,v,24
ds_read_b128 a[220:223], v11 offset:7168
v_cvt_pk_bf16_f32 v184, v184, v185
MV 92,a,152,v,40
ds_read_b128 a[224:227], v11 offset:8192
buffer_load_dwordx4 v12, s[56:59], s71 offen offset:2048 sc1 lds
MV 100,a,152,v,56
v_exp_f32 v188, v188
MV 108,a,152,v,72
v_add_f32 v3, v3, v186
v_add_f32 v3, v3, v187
MV 84,a,156,v,28
v_exp_f32 v189, v189
MV 92,a,156,v,44
ds_read_b128 a[228:231], v11 offset:9216
v_cvt_pk_bf16_f32 v185, v186, v187
MV 100,a,156,v,60
v_exp_f32 v190, v190
MV 108,a,156,v,76
v_add_f32 v3, v3, v188
v_add_f32 v3, v3, v189
v_mfma_f32_16x16x32_bf16 v[112:115], a[160:163], v[16:19], 0
v_exp_f32 v191, v191
v_mfma_f32_16x16x32_bf16 v[120:123], a[160:163], v[32:35], 0
ds_read_b128 a[232:235], v11 offset:10240
v_cvt_pk_bf16_f32 v186, v188, v189
v_mfma_f32_16x16x32_bf16 v[128:131], a[160:163], v[48:51], 0
v_exp_f32 v192, v192
v_mfma_f32_16x16x32_bf16 v[136:139], a[160:163], v[64:67], 0
buffer_load_dwordx4 v12, s[56:59], s71 offen offset:3072 sc1 lds
v_add_f32 v3, v3, v190
MV 112,a,164,v,20
ds_read_b128 a[236:239], v11 offset:11264
v_add_f32 v3, v3, v191
MV 120,a,164,v,36
v_exp_f32 v193, v193
MV 128,a,164,v,52
ds_read_b128 a[240:243], v11 offset:12288
v_cvt_pk_bf16_f32 v187, v190, v191
MV 136,a,164,v,68
v_exp_f32 v194, v194
MV 112,a,168,v,24
v_add_f32 v4, v4, v192
v_add_f32 v4, v4, v193
MV 120,a,168,v,40
v_exp_f32 v195, v195
MV 128,a,168,v,56
ds_read_b128 a[244:247], v11 offset:13312
v_cvt_pk_bf16_f32 v192, v192, v193
MV 136,a,168,v,72
v_exp_f32 v196, v196
MV 112,a,172,v,28
v_add_f32 v4, v4, v194
v_add_f32 v4, v4, v195
MV 120,a,172,v,44
v_exp_f32 v197, v197
MV 128,a,172,v,60
ds_read_b128 a[248:251], v11 offset:14336
v_cvt_pk_bf16_f32 v193, v194, v195
MV 136,a,172,v,76
v_exp_f32 v198, v198
v_mfma_f32_16x16x32_bf16 v[116:119], a[176:179], v[16:19], 0
s_add_u32 s71, s71, 16384
v_add_f32 v4, v4, v196
v_mfma_f32_16x16x32_bf16 v[124:127], a[176:179], v[32:35], 0
ds_read_b128 a[252:255], v11 offset:15360
v_add_f32 v4, v4, v197
v_mfma_f32_16x16x32_bf16 v[132:135], a[176:179], v[48:51], 0
v_exp_f32 v199, v199
v_mfma_f32_16x16x32_bf16 v[140:143], a[176:179], v[64:67], 0
s_xor_b32 s73, s73, 0x8000
v_cvt_pk_bf16_f32 v194, v196, v197
MV 116,a,180,v,20
v_exp_f32 v200, v200
MV 124,a,180,v,36
v_add_f32 v4, v4, v198
v_add_f32 v4, v4, v199
MV 132,a,180,v,52
v_exp_f32 v201, v201
MV 140,a,180,v,68
v_cvt_pk_bf16_f32 v195, v198, v199
MV 116,a,184,v,24
v_exp_f32 v202, v202
MV 124,a,184,v,40
v_add_f32 v5, v5, v200
v_add_f32 v5, v5, v201
MV 132,a,184,v,56
v_exp_f32 v203, v203
MV 140,a,184,v,72
v_cvt_pk_bf16_f32 v200, v200, v201
MV 116,a,188,v,28
v_exp_f32 v204, v204
MV 124,a,188,v,44
v_add_f32 v5, v5, v202
v_add_f32 v5, v5, v203
MV 132,a,188,v,60
v_exp_f32 v205, v205
MV 140,a,188,v,76
v_cvt_pk_bf16_f32 v201, v202, v203
v_exp_f32 v206, v206
v_add_f32 v5, v5, v204
v_add_f32 v5, v5, v205
v_exp_f32 v207, v207
v_cvt_pk_bf16_f32 v202, v204, v205
v_add_f32 v5, v5, v206
v_add_f32 v5, v5, v207
v_cvt_pk_bf16_f32 v203, v206, v207
s_waitcnt vmcnt(16) lgkmcnt(0)
MA 0,a,192,v,144
s_barrier
v_xor_b32 v10, 0x8000, v10
MA 32,a,192,v,152
s_add_u32 m0, s72, 16384
ds_read_b128 a[128:131], v10 offset:0
MA 64,a,192,v,160
v_exp_f32 v80, v80
MA 96,a,192,v,168
ds_read_b128 a[132:135], v10 offset:1024
buffer_load_dwordx4 v12, s[52:55], s71 offen offset:0 sc1 lds
MA 4,a,196,v,144
v_exp_f32 v81, v81
MA 36,a,196,v,152
v_exp_f32 v82, v82
MA 68,a,196,v,160
v_add_f32 v2, v2, v80
v_add_f32 v2, v2, v81
MA 100,a,196,v,168
v_exp_f32 v83, v83
MA 8,a,200,v,144
ds_read_b128 a[136:139], v10 offset:2048
v_cvt_pk_bf16_f32 v80, v80, v81
MA 40,a,200,v,152
v_exp_f32 v84, v84
MA 72,a,200,v,160
v_add_f32 v2, v2, v82
v_add_f32 v2, v2, v83
MA 104,a,200,v,168
ds_read_b128 a[140:143], v10 offset:3072
ds_read_b128 a[144:147], v10 offset:4096
MA 12,a,204,v,144
v_exp_f32 v85, v85
MA 44,a,204,v,152
buffer_load_dwordx4 v12, s[52:55], s71 offen offset:1024 sc1 lds
v_cvt_pk_bf16_f32 v81, v82, v83
MA 76,a,204,v,160
v_exp_f32 v86, v86
MA 108,a,204,v,168
v_add_f32 v2, v2, v84
v_add_f32 v2, v2, v85
MA 16,a,208,v,144
v_exp_f32 v87, v87
MA 48,a,208,v,152
ds_read_b128 a[148:151], v10 offset:5120
v_cvt_pk_bf16_f32 v82, v84, v85
MA 80,a,208,v,160
v_exp_f32 v88, v88
MA 112,a,208,v,168
v_add_f32 v2, v2, v86
v_add_f32 v2, v2, v87
MA 20,a,212,v,144
v_exp_f32 v89, v89
MA 52,a,212,v,152
ds_read_b128 a[152:155], v10 offset:6144
v_cvt_pk_bf16_f32 v83, v86, v87
MA 84,a,212,v,160
v_exp_f32 v90, v90
MA 116,a,212,v,168
v_add_f32 v3, v3, v88
v_add_f32 v3, v3, v89
MA 24,a,216,v,144
ds_read_b128 a[156:159], v10 offset:7168
ds_read_b128 a[160:163], v10 offset:8192
MA 56,a,216,v,152
v_exp_f32 v91, v91
MA 88,a,216,v,160
buffer_load_dwordx4 v12, s[52:55], s71 offen offset:2048 sc1 lds
v_cvt_pk_bf16_f32 v88, v88, v89
MA 120,a,216,v,168
v_exp_f32 v92, v92
MA 28,a,220,v,144
v_add_f32 v3, v3, v90
v_add_f32 v3, v3, v91
MA 60,a,220,v,152
v_exp_f32 v93, v93
MA 92,a,220,v,160
ds_read_b128 a[164:167], v10 offset:9216
v_cvt_pk_bf16_f32 v89, v90, v91
MA 124,a,220,v,168
v_exp_f32 v94, v94
MA 0,a,224,v,176
v_add_f32 v3, v3, v92
v_add_f32 v3, v3, v93
MA 32,a,224,v,184
v_exp_f32 v95, v95
MA 64,a,224,v,192
ds_read_b128 a[168:171], v10 offset:10240
v_cvt_pk_bf16_f32 v90, v92, v93
MA 96,a,224,v,200
v_exp_f32 v96, v96
MA 4,a,228,v,176
v_add_f32 v3, v3, v94
v_add_f32 v3, v3, v95
MA 36,a,228,v,184
ds_read_b128 a[172:175], v10 offset:11264
ds_read_b128 a[176:179], v10 offset:12288
MA 68,a,228,v,192
v_exp_f32 v97, v97
MA 100,a,228,v,200
ds_read_b128 a[180:183], v10 offset:13312
v_cvt_pk_bf16_f32 v91, v94, v95
MA 8,a,232,v,176
v_exp_f32 v98, v98
MA 40,a,232,v,184
v_add_f32 v4, v4, v96
v_add_f32 v4, v4, v97
MA 72,a,232,v,192
v_exp_f32 v99, v99
MA 104,a,232,v,200
buffer_load_dwordx4 v12, s[52:55], s71 offen offset:3072 sc1 lds
v_cvt_pk_bf16_f32 v96, v96, v97
MA 12,a,236,v,176
v_exp_f32 v100, v100
MA 44,a,236,v,184
v_add_f32 v4, v4, v98
v_add_f32 v4, v4, v99
MA 76,a,236,v,192
v_exp_f32 v101, v101
MA 108,a,236,v,200
ds_read_b128 a[184:187], v10 offset:14336
v_cvt_pk_bf16_f32 v97, v98, v99
MA 16,a,240,v,176
v_exp_f32 v102, v102
MA 48,a,240,v,184
v_add_f32 v4, v4, v100
v_add_f32 v4, v4, v101
MA 80,a,240,v,192
v_exp_f32 v103, v103
MA 112,a,240,v,200
ds_read_b128 a[188:191], v10 offset:15360
v_cvt_pk_bf16_f32 v98, v100, v101
MA 20,a,244,v,176
v_exp_f32 v104, v104
MA 52,a,244,v,184
v_add_f32 v4, v4, v102
v_add_f32 v4, v4, v103
MA 84,a,244,v,192
v_exp_f32 v105, v105
MA 116,a,244,v,200
s_xor_b32 s72, s72, 0x8000
v_cvt_pk_bf16_f32 v99, v102, v103
MA 24,a,248,v,176
v_exp_f32 v106, v106
MA 56,a,248,v,184
v_add_f32 v5, v5, v104
v_add_f32 v5, v5, v105
MA 88,a,248,v,192
v_exp_f32 v107, v107
MA 120,a,248,v,200
v_cvt_pk_bf16_f32 v104, v104, v105
MA 28,a,252,v,176
v_exp_f32 v108, v108
MA 60,a,252,v,184
v_add_f32 v5, v5, v106
v_add_f32 v5, v5, v107
MA 92,a,252,v,192
v_exp_f32 v109, v109
MA 124,a,252,v,200
v_cvt_pk_bf16_f32 v105, v106, v107
v_exp_f32 v110, v110
v_add_f32 v5, v5, v108
v_add_f32 v5, v5, v109
v_exp_f32 v111, v111
v_cvt_pk_bf16_f32 v106, v108, v109
v_add_f32 v5, v5, v110
v_add_f32 v5, v5, v111
v_cvt_pk_bf16_f32 v107, v110, v111
s_branch L_p3_d0_top
L_p3_d1m_top:
s_waitcnt lgkmcnt(0)
v_xor_b32 v11, 0x8000, v11
v_mfma_f32_16x16x32_bf16 v[80:83], a[128:131], v[16:19], 0
s_add_u32 m0, s73, 16384
ds_read_b128 a[192:195], v11 offset:0
v_mfma_f32_16x16x32_bf16 v[88:91], a[128:131], v[32:35], 0
v_exp_f32 v176, v176
v_mfma_f32_16x16x32_bf16 v[96:99], a[128:131], v[48:51], 0
ds_read_b128 a[196:199], v11 offset:1024
buffer_load_dwordx4 v12, s[56:59], s71 offen offset:0 sc1 lds
v_mfma_f32_16x16x32_bf16 v[104:107], a[128:131], v[64:67], 0
v_exp_f32 v177, v177
MV 80,a,132,v,20
v_exp_f32 v178, v178
MV 88,a,132,v,36
v_add_f32 v2, v2, v176
v_add_f32 v2, v2, v177
MV 96,a,132,v,52
v_exp_f32 v179, v179
MV 104,a,132,v,68
ds_read_b128 a[200:203], v11 offset:2048
v_cvt_pk_bf16_f32 v176, v176, v177
MV 80,a,136,v,24
v_exp_f32 v180, v180
MV 88,a,136,v,40
v_add_f32 v2, v2, v178
v_add_f32 v2, v2, v179
MV 96,a,136,v,56
v_exp_f32 v181, v181
MV 104,a,136,v,72
ds_read_b128 a[204:207], v11 offset:3072
v_cvt_pk_bf16_f32 v177, v178, v179
MV 80,a,140,v,28
v_exp_f32 v182, v182
MV 88,a,140,v,44
buffer_load_dwordx4 v12, s[56:59], s71 offen offset:1024 sc1 lds
v_add_f32 v2, v2, v180
MV 96,a,140,v,60
ds_read_b128 a[208:211], v11 offset:4096
v_add_f32 v2, v2, v181
MV 104,a,140,v,76
v_exp_f32 v183, v183
v_mfma_f32_16x16x32_bf16 v[84:87], a[144:147], v[16:19], 0
ds_read_b128 a[212:215], v11 offset:5120
v_cvt_pk_bf16_f32 v178, v180, v181
v_mfma_f32_16x16x32_bf16 v[92:95], a[144:147], v[32:35], 0
v_exp_f32 v184, v184
v_mfma_f32_16x16x32_bf16 v[100:103], a[144:147], v[48:51], 0
v_add_f32 v2, v2, v182
v_add_f32 v2, v2, v183
v_mfma_f32_16x16x32_bf16 v[108:111], a[144:147], v[64:67], 0
v_exp_f32 v185, v185
MV 84,a,148,v,20
ds_read_b128 a[216:219], v11 offset:6144
v_cvt_pk_bf16_f32 v179, v182, v183
MV 92,a,148,v,36
v_exp_f32 v186, v186
MV 100,a,148,v,52
v_add_f32 v3, v3, v184
v_add_f32 v3, v3, v185
MV 108,a,148,v,68
v_exp_f32 v187, v187
MV 84,a,152,v,24
ds_read_b128 a[220:223], v11 offset:7168
v_cvt_pk_bf16_f32 v184, v184, v185
MV 92,a,152,v,40
ds_read_b128 a[224:227], v11 offset:8192
buffer_load_dwordx4 v12, s[56:59], s71 offen offset:2048 sc1 lds
MV 100,a,152,v,56
v_exp_f32 v188, v188
MV 108,a,152,v,72
v_add_f32 v3, v3, v186
v_add_f32 v3, v3, v187
MV 84,a,156,v,28
v_exp_f32 v189, v189
MV 92,a,156,v,44
ds_read_b128 a[228:231], v11 offset:9216
v_cvt_pk_bf16_f32 v185, v186, v187
MV 100,a,156,v,60
v_exp_f32 v190, v190
MV 108,a,156,v,76
v_add_f32 v3, v3, v188
v_add_f32 v3, v3, v189
v_mfma_f32_16x16x32_bf16 v[112:115], a[160:163], v[16:19], 0
v_exp_f32 v191, v191
v_mfma_f32_16x16x32_bf16 v[120:123], a[160:163], v[32:35], 0
ds_read_b128 a[232:235], v11 offset:10240
v_cvt_pk_bf16_f32 v186, v188, v189
v_mfma_f32_16x16x32_bf16 v[128:131], a[160:163], v[48:51], 0
v_exp_f32 v192, v192
v_mfma_f32_16x16x32_bf16 v[136:139], a[160:163], v[64:67], 0
buffer_load_dwordx4 v12, s[56:59], s71 offen offset:3072 sc1 lds
v_add_f32 v3, v3, v190
MV 112,a,164,v,20
ds_read_b128 a[236:239], v11 offset:11264
v_add_f32 v3, v3, v191
MV 120,a,164,v,36
v_exp_f32 v193, v193
MV 128,a,164,v,52
ds_read_b128 a[240:243], v11 offset:12288
v_cvt_pk_bf16_f32 v187, v190, v191
MV 136,a,164,v,68
v_exp_f32 v194, v194
MV 112,a,168,v,24
v_add_f32 v4, v4, v192
v_add_f32 v4, v4, v193
MV 120,a,168,v,40
v_exp_f32 v195, v195
MV 128,a,168,v,56
v_cvt_pk_bf16_f32 v192, v192, v193
v_add_u32 v246, 0, v13
MV 136,a,168,v,72
ds_read_b128 a[244:247], v11 offset:13312
v_cmp_gt_i32_e64 s[84:85], 0, v246
MV 112,a,172,v,28
v_exp_f32 v196, v196
MV 120,a,172,v,44
v_add_f32 v4, v4, v194
v_cmp_gt_i32_e64 s[86:87], 1, v246
MV 128,a,172,v,60
v_add_f32 v4, v4, v195
v_cmp_gt_i32_e64 s[88:89], 2, v246
MV 136,a,172,v,76
v_cmp_gt_i32_e64 s[90:91], 3, v246
v_cndmask_b32_e64 v96, v96, v14, s[84:85]
v_mfma_f32_16x16x32_bf16 v[116:119], a[176:179], v[16:19], 0
v_exp_f32 v197, v197
v_mfma_f32_16x16x32_bf16 v[124:127], a[176:179], v[32:35], 0
ds_read_b128 a[248:251], v11 offset:14336
v_cvt_pk_bf16_f32 v193, v194, v195
v_mfma_f32_16x16x32_bf16 v[132:135], a[176:179], v[48:51], 0
s_add_u32 s71, s71, 16384
v_cndmask_b32_e64 v97, v97, v14, s[86:87]
v_mfma_f32_16x16x32_bf16 v[140:143], a[176:179], v[64:67], 0
v_exp_f32 v198, v198
MV 116,a,180,v,20
v_add_f32 v4, v4, v196
v_cndmask_b32_e64 v98, v98, v14, s[88:89]
MV 124,a,180,v,36
v_add_f32 v4, v4, v197
v_cndmask_b32_e64 v99, v99, v14, s[90:91]
MV 132,a,180,v,52
ds_read_b128 a[252:255], v11 offset:15360
v_add_u32 v247, 16, v13
MV 140,a,180,v,68
v_exp_f32 v199, v199
MV 116,a,184,v,24
v_cvt_pk_bf16_f32 v194, v196, v197
v_cmp_gt_i32_e64 s[92:93], 0, v247
MV 124,a,184,v,40
v_cmp_gt_i32_e64 s[94:95], 1, v247
v_cmp_gt_i32_e64 s[96:97], 2, v247
MV 132,a,184,v,56
v_exp_f32 v200, v200
MV 140,a,184,v,72
v_add_f32 v4, v4, v198
v_cmp_gt_i32_e64 s[98:99], 3, v247
MV 116,a,188,v,28
v_add_f32 v4, v4, v199
v_cndmask_b32_e64 v104, v104, v14, s[92:93]
MV 124,a,188,v,44
v_cndmask_b32_e64 v105, v105, v14, s[94:95]
v_cndmask_b32_e64 v106, v106, v14, s[96:97]
MV 132,a,188,v,60
v_exp_f32 v201, v201
MV 140,a,188,v,76
s_xor_b32 s73, s73, 0x8000
v_cvt_pk_bf16_f32 v195, v198, v199
v_exp_f32 v202, v202
v_cndmask_b32_e64 v107, v107, v14, s[98:99]
v_add_f32 v5, v5, v200
v_add_u32 v246, -16, v13
v_cmp_gt_i32_e64 s[84:85], 0, v246
v_add_f32 v5, v5, v201
v_exp_f32 v203, v203
v_cmp_gt_i32_e64 s[86:87], 1, v246
v_cvt_pk_bf16_f32 v200, v200, v201
v_cmp_gt_i32_e64 s[88:89], 2, v246
v_cmp_gt_i32_e64 s[90:91], 3, v246
v_exp_f32 v204, v204
v_cndmask_b32_e64 v100, v100, v14, s[84:85]
v_add_f32 v5, v5, v202
v_cndmask_b32_e64 v101, v101, v14, s[86:87]
v_add_f32 v5, v5, v203
v_exp_f32 v205, v205
v_cndmask_b32_e64 v102, v102, v14, s[88:89]
v_cndmask_b32_e64 v103, v103, v14, s[90:91]
v_cvt_pk_bf16_f32 v201, v202, v203
v_add_u32 v247, 0, v13
v_exp_f32 v206, v206
v_cmp_gt_i32_e64 s[92:93], 0, v247
v_cmp_gt_i32_e64 s[94:95], 1, v247
v_add_f32 v5, v5, v204
v_cmp_gt_i32_e64 s[96:97], 2, v247
v_add_f32 v5, v5, v205
v_exp_f32 v207, v207
v_cmp_gt_i32_e64 s[98:99], 3, v247
v_cvt_pk_bf16_f32 v202, v204, v205
v_cndmask_b32_e64 v108, v108, v14, s[92:93]
v_cndmask_b32_e64 v109, v109, v14, s[94:95]
v_add_f32 v5, v5, v206
v_add_f32 v5, v5, v207
v_cndmask_b32_e64 v110, v110, v14, s[96:97]
v_cvt_pk_bf16_f32 v203, v206, v207
v_cndmask_b32_e64 v111, v111, v14, s[98:99]
s_waitcnt vmcnt(16) lgkmcnt(0)
MA 0,a,192,v,144
s_barrier
v_xor_b32 v10, 0x8000, v10
MA 32,a,192,v,152
s_add_u32 m0, s72, 16384
ds_read_b128 a[128:131], v10 offset:0
MA 64,a,192,v,160
v_exp_f32 v80, v80
MA 96,a,192,v,168
ds_read_b128 a[132:135], v10 offset:1024
buffer_load_dwordx4 v12, s[52:55], s71 offen offset:0 sc1 lds
MA 4,a,196,v,144
v_exp_f32 v81, v81
MA 36,a,196,v,152
v_exp_f32 v82, v82
MA 68,a,196,v,160
v_add_f32 v2, v2, v80
v_add_f32 v2, v2, v81
MA 100,a,196,v,168
v_exp_f32 v83, v83
MA 8,a,200,v,144
ds_read_b128 a[136:139], v10 offset:2048
v_cvt_pk_bf16_f32 v80, v80, v81
MA 40,a,200,v,152
v_add_u32 v246, -32, v13
v_cmp_gt_i32_e64 s[84:85], 0, v246
MA 72,a,200,v,160
v_exp_f32 v84, v84
MA 104,a,200,v,168
v_add_f32 v2, v2, v82
v_add_f32 v2, v2, v83
MA 12,a,204,v,144
ds_read_b128 a[140:143], v10 offset:3072
v_cmp_gt_i32_e64 s[86:87], 1, v246
MA 44,a,204,v,152
v_exp_f32 v85, v85
MA 76,a,204,v,160
v_cvt_pk_bf16_f32 v81, v82, v83
v_cmp_gt_i32_e64 s[88:89], 2, v246
MA 108,a,204,v,168
v_exp_f32 v86, v86
MA 16,a,208,v,144
ds_read_b128 a[144:147], v10 offset:4096
v_add_f32 v2, v2, v84
MA 48,a,208,v,152
v_add_f32 v2, v2, v85
v_cmp_gt_i32_e64 s[90:91], 3, v246
MA 80,a,208,v,160
v_exp_f32 v87, v87
MA 112,a,208,v,168
buffer_load_dwordx4 v12, s[52:55], s71 offen offset:1024 sc1 lds
v_cvt_pk_bf16_f32 v82, v84, v85
MA 20,a,212,v,144
ds_read_b128 a[148:151], v10 offset:5120
v_cndmask_b32_e64 v128, v128, v14, s[84:85]
MA 52,a,212,v,152
v_cndmask_b32_e64 v129, v129, v14, s[86:87]
v_cndmask_b32_e64 v130, v130, v14, s[88:89]
MA 84,a,212,v,160
v_exp_f32 v88, v88
MA 116,a,212,v,168
v_add_f32 v2, v2, v86
v_add_f32 v2, v2, v87
MA 24,a,216,v,144
v_exp_f32 v89, v89
MA 56,a,216,v,152
ds_read_b128 a[152:155], v10 offset:6144
v_cvt_pk_bf16_f32 v83, v86, v87
MA 88,a,216,v,160
v_cndmask_b32_e64 v131, v131, v14, s[90:91]
v_add_u32 v247, -16, v13
MA 120,a,216,v,168
v_exp_f32 v90, v90
MA 28,a,220,v,144
v_add_f32 v3, v3, v88
v_add_f32 v3, v3, v89
MA 60,a,220,v,152
ds_read_b128 a[156:159], v10 offset:7168
v_cmp_gt_i32_e64 s[92:93], 0, v247
MA 92,a,220,v,160
v_exp_f32 v91, v91
MA 124,a,220,v,168
v_cvt_pk_bf16_f32 v88, v88, v89
v_cmp_gt_i32_e64 s[94:95], 1, v247
MA 0,a,224,v,176
v_exp_f32 v92, v92
MA 32,a,224,v,184
ds_read_b128 a[160:163], v10 offset:8192
v_add_f32 v3, v3, v90
MA 64,a,224,v,192
v_add_f32 v3, v3, v91
v_cmp_gt_i32_e64 s[96:97], 2, v247
MA 96,a,224,v,200
v_exp_f32 v93, v93
MA 4,a,228,v,176
buffer_load_dwordx4 v12, s[52:55], s71 offen offset:2048 sc1 lds
v_cvt_pk_bf16_f32 v89, v90, v91
MA 36,a,228,v,184
ds_read_b128 a[164:167], v10 offset:9216
v_cmp_gt_i32_e64 s[98:99], 3, v247
MA 68,a,228,v,192
v_exp_f32 v94, v94
MA 100,a,228,v,200
v_add_f32 v3, v3, v92
v_add_f32 v3, v3, v93
MA 8,a,232,v,176
ds_read_b128 a[168:171], v10 offset:10240
v_cndmask_b32_e64 v136, v136, v14, s[92:93]
MA 40,a,232,v,184
v_exp_f32 v95, v95
MA 72,a,232,v,192
v_cvt_pk_bf16_f32 v90, v92, v93
v_cndmask_b32_e64 v137, v137, v14, s[94:95]
MA 104,a,232,v,200
v_exp_f32 v96, v96
MA 12,a,236,v,176
v_add_f32 v3, v3, v94
v_cndmask_b32_e64 v138, v138, v14, s[96:97]
MA 44,a,236,v,184
ds_read_b128 a[172:175], v10 offset:11264
v_add_f32 v3, v3, v95
MA 76,a,236,v,192
v_cndmask_b32_e64 v139, v139, v14, s[98:99]
v_add_u32 v246, -48, v13
MA 108,a,236,v,200
v_exp_f32 v97, v97
MA 16,a,240,v,176
ds_read_b128 a[176:179], v10 offset:12288
v_cvt_pk_bf16_f32 v91, v94, v95
MA 48,a,240,v,184
v_exp_f32 v98, v98
MA 80,a,240,v,192
v_add_f32 v4, v4, v96
v_add_f32 v4, v4, v97
MA 112,a,240,v,200
v_cmp_gt_i32_e64 s[84:85], 0, v246
v_cmp_gt_i32_e64 s[86:87], 1, v246
MA 20,a,244,v,176
v_exp_f32 v99, v99
MA 52,a,244,v,184
ds_read_b128 a[180:183], v10 offset:13312
v_cvt_pk_bf16_f32 v96, v96, v97
MA 84,a,244,v,192
v_exp_f32 v100, v100
MA 116,a,244,v,200
buffer_load_dwordx4 v12, s[52:55], s71 offen offset:3072 sc1 lds
v_add_f32 v4, v4, v98
MA 24,a,248,v,176
v_add_f32 v4, v4, v99
v_cmp_gt_i32_e64 s[88:89], 2, v246
MA 56,a,248,v,184
v_exp_f32 v101, v101
MA 88,a,248,v,192
ds_read_b128 a[184:187], v10 offset:14336
v_cmp_gt_i32_e64 s[90:91], 3, v246
MA 120,a,248,v,200
v_cvt_pk_bf16_f32 v97, v98, v99
v_cndmask_b32_e64 v132, v132, v14, s[84:85]
MA 28,a,252,v,176
v_exp_f32 v102, v102
MA 60,a,252,v,184
v_add_f32 v4, v4, v100
v_add_f32 v4, v4, v101
MA 92,a,252,v,192
ds_read_b128 a[188:191], v10 offset:15360
v_cndmask_b32_e64 v133, v133, v14, s[86:87]
MA 124,a,252,v,200
s_xor_b32 s72, s72, 0x8000
v_exp_f32 v103, v103
v_cvt_pk_bf16_f32 v98, v100, v101
v_exp_f32 v104, v104
v_cndmask_b32_e64 v134, v134, v14, s[88:89]
v_add_f32 v4, v4, v102
v_cndmask_b32_e64 v135, v135, v14, s[90:91]
v_add_f32 v4, v4, v103
v_exp_f32 v105, v105
v_cvt_pk_bf16_f32 v99, v102, v103
v_add_u32 v247, -32, v13
v_exp_f32 v106, v106
v_add_f32 v5, v5, v104
v_cmp_gt_i32_e64 s[92:93], 0, v247
v_add_f32 v5, v5, v105
v_exp_f32 v107, v107
v_cmp_gt_i32_e64 s[94:95], 1, v247
v_cvt_pk_bf16_f32 v104, v104, v105
v_exp_f32 v108, v108
v_cmp_gt_i32_e64 s[96:97], 2, v247
v_add_f32 v5, v5, v106
v_cmp_gt_i32_e64 s[98:99], 3, v247
v_add_f32 v5, v5, v107
v_exp_f32 v109, v109
v_cvt_pk_bf16_f32 v105, v106, v107
v_cndmask_b32_e64 v140, v140, v14, s[92:93]
v_exp_f32 v110, v110
v_add_f32 v5, v5, v108
v_cndmask_b32_e64 v141, v141, v14, s[94:95]
v_add_f32 v5, v5, v109
v_exp_f32 v111, v111
v_cndmask_b32_e64 v142, v142, v14, s[96:97]
v_cvt_pk_bf16_f32 v106, v108, v109
v_add_f32 v5, v5, v110
v_add_f32 v5, v5, v111
v_cndmask_b32_e64 v143, v143, v14, s[98:99]
v_cvt_pk_bf16_f32 v107, v110, v111
L_p3_d0m_top:
s_waitcnt lgkmcnt(0)
v_mfma_f32_16x16x32_bf16 v[144:147], a[128:131], v[16:19], 0
s_add_u32 m0, s73, 0
ds_read_b128 a[192:195], v11 offset:16384
v_mfma_f32_16x16x32_bf16 v[152:155], a[128:131], v[32:35], 0
v_exp_f32 v112, v112
v_mfma_f32_16x16x32_bf16 v[160:163], a[128:131], v[48:51], 0
ds_read_b128 a[196:199], v11 offset:17408
buffer_load_dwordx4 v12, s[56:59], s71 offen offset:0 sc1 lds
v_mfma_f32_16x16x32_bf16 v[168:171], a[128:131], v[64:67], 0
v_exp_f32 v113, v113
MV 144,a,132,v,20
v_exp_f32 v114, v114
MV 152,a,132,v,36
v_add_f32 v2, v2, v112
v_add_f32 v2, v2, v113
MV 160,a,132,v,52
v_exp_f32 v115, v115
MV 168,a,132,v,68
ds_read_b128 a[200:203], v11 offset:18432
v_cvt_pk_bf16_f32 v112, v112, v113
MV 144,a,136,v,24
v_exp_f32 v116, v116
MV 152,a,136,v,40
v_add_f32 v2, v2, v114
v_add_f32 v2, v2, v115
MV 160,a,136,v,56
v_exp_f32 v117, v117
MV 168,a,136,v,72
ds_read_b128 a[204:207], v11 offset:19456
v_cvt_pk_bf16_f32 v113, v114, v115
MV 144,a,140,v,28
v_exp_f32 v118, v118
MV 152,a,140,v,44
ds_read_b128 a[208:211], v11 offset:20480
v_add_f32 v2, v2, v116
MV 160,a,140,v,60
buffer_load_dwordx4 v12, s[56:59], s71 offen offset:1024 sc1 lds
v_add_f32 v2, v2, v117
MV 168,a,140,v,76
v_exp_f32 v119, v119
v_mfma_f32_16x16x32_bf16 v[148:151], a[144:147], v[16:19], 0
ds_read_b128 a[212:215], v11 offset:21504
v_cvt_pk_bf16_f32 v114, v116, v117
v_mfma_f32_16x16x32_bf16 v[156:159], a[144:147], v[32:35], 0
v_exp_f32 v120, v120
v_mfma_f32_16x16x32_bf16 v[164:167], a[144:147], v[48:51], 0
v_add_f32 v2, v2, v118
v_add_f32 v2, v2, v119
v_mfma_f32_16x16x32_bf16 v[172:175], a[144:147], v[64:67], 0
v_exp_f32 v121, v121
MV 148,a,148,v,20
ds_read_b128 a[216:219], v11 offset:22528
v_cvt_pk_bf16_f32 v115, v118, v119
MV 156,a,148,v,36
v_exp_f32 v122, v122
MV 164,a,148,v,52
v_add_f32 v3, v3, v120
v_add_f32 v3, v3, v121
MV 172,a,148,v,68
v_exp_f32 v123, v123
MV 148,a,152,v,24
ds_read_b128 a[220:223], v11 offset:23552
v_cvt_pk_bf16_f32 v120, v120, v121
MV 156,a,152,v,40
v_exp_f32 v124, v124
MV 164,a,152,v,56
ds_read_b128 a[224:227], v11 offset:24576
v_add_f32 v3, v3, v122
MV 172,a,152,v,72
buffer_load_dwordx4 v12, s[56:59], s71 offen offset:2048 sc1 lds
v_add_f32 v3, v3, v123
MV 148,a,156,v,28
v_exp_f32 v125, v125
MV 156,a,156,v,44
ds_read_b128 a[228:231], v11 offset:25600
v_cvt_pk_bf16_f32 v121, v122, v123
MV 164,a,156,v,60
v_exp_f32 v126, v126
MV 172,a,156,v,76
v_add_f32 v3, v3, v124
v_add_f32 v3, v3, v125
v_mfma_f32_16x16x32_bf16 v[176:179], a[160:163], v[16:19], 0
v_exp_f32 v127, v127
v_mfma_f32_16x16x32_bf16 v[184:187], a[160:163], v[32:35], 0
ds_read_b128 a[232:235], v11 offset:26624
v_cvt_pk_bf16_f32 v122, v124, v125
v_mfma_f32_16x16x32_bf16 v[192:195], a[160:163], v[48:51], 0
v_exp_f32 v128, v128
v_mfma_f32_16x16x32_bf16 v[200:203], a[160:163], v[64:67], 0
v_add_f32 v3, v3, v126
v_add_f32 v3, v3, v127
MV 176,a,164,v,20
v_exp_f32 v129, v129
MV 184,a,164,v,36
ds_read_b128 a[236:239], v11 offset:27648
v_cvt_pk_bf16_f32 v123, v126, v127
MV 192,a,164,v,52
v_exp_f32 v130, v130
MV 200,a,164,v,68
ds_read_b128 a[240:243], v11 offset:28672
v_add_f32 v4, v4, v128
MV 176,a,168,v,24
buffer_load_dwordx4 v12, s[56:59], s71 offen offset:3072 sc1 lds
v_add_f32 v4, v4, v129
MV 184,a,168,v,40
v_exp_f32 v131, v131
MV 192,a,168,v,56
v_cvt_pk_bf16_f32 v128, v128, v129
v_add_u32 v246, -64, v13
MV 200,a,168,v,72
ds_read_b128 a[244:247], v11 offset:29696
v_cmp_gt_i32_e64 s[84:85], 0, v246
MV 176,a,172,v,28
v_exp_f32 v132, v132
MV 184,a,172,v,44
v_add_f32 v4, v4, v130
v_cmp_gt_i32_e64 s[86:87], 1, v246
MV 192,a,172,v,60
v_add_f32 v4, v4, v131
v_cmp_gt_i32_e64 s[88:89], 2, v246
MV 200,a,172,v,76
v_cmp_gt_i32_e64 s[90:91], 3, v246
v_cndmask_b32_e64 v160, v160, v14, s[84:85]
v_mfma_f32_16x16x32_bf16 v[180:183], a[176:179], v[16:19], 0
v_exp_f32 v133, v133
v_mfma_f32_16x16x32_bf16 v[188:191], a[176:179], v[32:35], 0
ds_read_b128 a[248:251], v11 offset:30720
v_cvt_pk_bf16_f32 v129, v130, v131
v_mfma_f32_16x16x32_bf16 v[196:199], a[176:179], v[48:51], 0
v_cndmask_b32_e64 v161, v161, v14, s[86:87]
v_cndmask_b32_e64 v162, v162, v14, s[88:89]
v_mfma_f32_16x16x32_bf16 v[204:207], a[176:179], v[64:67], 0
v_exp_f32 v134, v134
MV 180,a,180,v,20
v_add_f32 v4, v4, v132
v_cndmask_b32_e64 v163, v163, v14, s[90:91]
MV 188,a,180,v,36
v_add_f32 v4, v4, v133
v_add_u32 v247, -48, v13
MV 196,a,180,v,52
v_exp_f32 v135, v135
MV 204,a,180,v,68
ds_read_b128 a[252:255], v11 offset:31744
v_cvt_pk_bf16_f32 v130, v132, v133
MV 180,a,184,v,24
v_cmp_gt_i32_e64 s[92:93], 0, v247
v_cmp_gt_i32_e64 s[94:95], 1, v247
MV 188,a,184,v,40
v_cmp_gt_i32_e64 s[96:97], 2, v247
v_cmp_gt_i32_e64 s[98:99], 3, v247
MV 196,a,184,v,56
v_exp_f32 v136, v136
MV 204,a,184,v,72
v_add_f32 v4, v4, v134
v_add_f32 v4, v4, v135
MV 180,a,188,v,28
v_cndmask_b32_e64 v168, v168, v14, s[92:93]
v_cndmask_b32_e64 v169, v169, v14, s[94:95]
MV 188,a,188,v,44
v_exp_f32 v137, v137
MV 196,a,188,v,60
v_cvt_pk_bf16_f32 v131, v134, v135
v_cndmask_b32_e64 v170, v170, v14, s[96:97]
MV 204,a,188,v,76
s_add_u32 s71, s71, 16384
v_exp_f32 v138, v138
v_cndmask_b32_e64 v171, v171, v14, s[98:99]
v_add_f32 v5, v5, v136
v_add_u32 v246, -80, v13
v_cmp_gt_i32_e64 s[84:85], 0, v246
v_add_f32 v5, v5, v137
v_exp_f32 v139, v139
v_cmp_gt_i32_e64 s[86:87], 1, v246
v_cvt_pk_bf16_f32 v136, v136, v137
v_cmp_gt_i32_e64 s[88:89], 2, v246
v_cmp_gt_i32_e64 s[90:91], 3, v246
v_exp_f32 v140, v140
v_cndmask_b32_e64 v164, v164, v14, s[84:85]
v_add_f32 v5, v5, v138
v_cndmask_b32_e64 v165, v165, v14, s[86:87]
v_add_f32 v5, v5, v139
v_exp_f32 v141, v141
v_cndmask_b32_e64 v166, v166, v14, s[88:89]
v_cndmask_b32_e64 v167, v167, v14, s[90:91]
v_cvt_pk_bf16_f32 v137, v138, v139
v_add_u32 v247, -64, v13
v_exp_f32 v142, v142
v_cmp_gt_i32_e64 s[92:93], 0, v247
v_cmp_gt_i32_e64 s[94:95], 1, v247
v_add_f32 v5, v5, v140
v_cmp_gt_i32_e64 s[96:97], 2, v247
v_add_f32 v5, v5, v141
v_exp_f32 v143, v143
v_cmp_gt_i32_e64 s[98:99], 3, v247
v_cvt_pk_bf16_f32 v138, v140, v141
v_cndmask_b32_e64 v172, v172, v14, s[92:93]
v_cndmask_b32_e64 v173, v173, v14, s[94:95]
v_add_f32 v5, v5, v142
v_add_f32 v5, v5, v143
v_cndmask_b32_e64 v174, v174, v14, s[96:97]
v_cvt_pk_bf16_f32 v139, v142, v143
v_cndmask_b32_e64 v175, v175, v14, s[98:99]
s_waitcnt vmcnt(16) lgkmcnt(0)
MA 0,a,192,v,80
s_barrier
MA 32,a,192,v,88
s_add_u32 m0, s72, 0
ds_read_b128 a[128:131], v10 offset:16384
MA 64,a,192,v,96
v_exp_f32 v144, v144
MA 96,a,192,v,104
ds_read_b128 a[132:135], v10 offset:17408
buffer_load_dwordx4 v12, s[52:55], s71 offen offset:0 sc1 lds
MA 4,a,196,v,80
v_exp_f32 v145, v145
MA 36,a,196,v,88
v_exp_f32 v146, v146
MA 68,a,196,v,96
v_add_f32 v2, v2, v144
v_add_f32 v2, v2, v145
MA 100,a,196,v,104
v_exp_f32 v147, v147
MA 8,a,200,v,80
ds_read_b128 a[136:139], v10 offset:18432
v_cvt_pk_bf16_f32 v144, v144, v145
MA 40,a,200,v,88
v_add_u32 v246, -96, v13
v_cmp_gt_i32_e64 s[84:85], 0, v246
MA 72,a,200,v,96
v_exp_f32 v148, v148
MA 104,a,200,v,104
v_add_f32 v2, v2, v146
v_add_f32 v2, v2, v147
MA 12,a,204,v,80
ds_read_b128 a[140:143], v10 offset:19456
v_cmp_gt_i32_e64 s[86:87], 1, v246
MA 44,a,204,v,88
v_exp_f32 v149, v149
MA 76,a,204,v,96
v_cvt_pk_bf16_f32 v145, v146, v147
v_cmp_gt_i32_e64 s[88:89], 2, v246
MA 108,a,204,v,104
v_exp_f32 v150, v150
MA 16,a,208,v,80
ds_read_b128 a[144:147], v10 offset:20480
v_add_f32 v2, v2, v148
MA 48,a,208,v,88
v_add_f32 v2, v2, v149
v_cmp_gt_i32_e64 s[90:91], 3, v246
MA 80,a,208,v,96
v_exp_f32 v151, v151
MA 112,a,208,v,104
buffer_load_dwordx4 v12, s[52:55], s71 offen offset:1024 sc1 lds
v_cvt_pk_bf16_f32 v146, v148, v149
MA 20,a,212,v,80
ds_read_b128 a[148:151], v10 offset:21504
v_cndmask_b32_e64 v192, v192, v14, s[84:85]
MA 52,a,212,v,88
v_cndmask_b32_e64 v193, v193, v14, s[86:87]
v_cndmask_b32_e64 v194, v194, v14, s[88:89]
MA 84,a,212,v,96
v_exp_f32 v152, v152
MA 116,a,212,v,104
v_add_f32 v2, v2, v150
v_add_f32 v2, v2, v151
MA 24,a,216,v,80
v_exp_f32 v153, v153
MA 56,a,216,v,88
ds_read_b128 a[152:155], v10 offset:22528
v_cvt_pk_bf16_f32 v147, v150, v151
MA 88,a,216,v,96
v_cndmask_b32_e64 v195, v195, v14, s[90:91]
v_add_u32 v247, -80, v13
MA 120,a,216,v,104
v_exp_f32 v154, v154
MA 28,a,220,v,80
v_add_f32 v3, v3, v152
v_add_f32 v3, v3, v153
MA 60,a,220,v,88
ds_read_b128 a[156:159], v10 offset:23552
v_cmp_gt_i32_e64 s[92:93], 0, v247
MA 92,a,220,v,96
v_exp_f32 v155, v155
MA 124,a,220,v,104
v_cvt_pk_bf16_f32 v152, v152, v153
v_cmp_gt_i32_e64 s[94:95], 1, v247
MA 0,a,224,v,112
v_exp_f32 v156, v156
MA 32,a,224,v,120
ds_read_b128 a[160:163], v10 offset:24576
v_add_f32 v3, v3, v154
MA 64,a,224,v,128
v_add_f32 v3, v3, v155
v_cmp_gt_i32_e64 s[96:97], 2, v247
MA 96,a,224,v,136
v_exp_f32 v157, v157
MA 4,a,228,v,112
buffer_load_dwordx4 v12, s[52:55], s71 offen offset:2048 sc1 lds
v_cvt_pk_bf16_f32 v153, v154, v155
MA 36,a,228,v,120
ds_read_b128 a[164:167], v10 offset:25600
v_cmp_gt_i32_e64 s[98:99], 3, v247
MA 68,a,228,v,128
v_exp_f32 v158, v158
MA 100,a,228,v,136
v_add_f32 v3, v3, v156
v_add_f32 v3, v3, v157
MA 8,a,232,v,112
ds_read_b128 a[168:171], v10 offset:26624
v_cndmask_b32_e64 v200, v200, v14, s[92:93]
MA 40,a,232,v,120
v_exp_f32 v159, v159
MA 72,a,232,v,128
v_cvt_pk_bf16_f32 v154, v156, v157
v_cndmask_b32_e64 v201, v201, v14, s[94:95]
MA 104,a,232,v,136
v_exp_f32 v160, v160
MA 12,a,236,v,112
v_add_f32 v3, v3, v158
v_cndmask_b32_e64 v202, v202, v14, s[96:97]
MA 44,a,236,v,120
ds_read_b128 a[172:175], v10 offset:27648
v_add_f32 v3, v3, v159
MA 76,a,236,v,128
v_cndmask_b32_e64 v203, v203, v14, s[98:99]
v_add_u32 v246, -112, v13
MA 108,a,236,v,136
v_exp_f32 v161, v161
MA 16,a,240,v,112
ds_read_b128 a[176:179], v10 offset:28672
v_cvt_pk_bf16_f32 v155, v158, v159
MA 48,a,240,v,120
v_exp_f32 v162, v162
MA 80,a,240,v,128
v_add_f32 v4, v4, v160
v_add_f32 v4, v4, v161
MA 112,a,240,v,136
v_cmp_gt_i32_e64 s[84:85], 0, v246
v_cmp_gt_i32_e64 s[86:87], 1, v246
MA 20,a,244,v,112
v_exp_f32 v163, v163
MA 52,a,244,v,120
ds_read_b128 a[180:183], v10 offset:29696
v_cvt_pk_bf16_f32 v160, v160, v161
MA 84,a,244,v,128
v_exp_f32 v164, v164
MA 116,a,244,v,136
buffer_load_dwordx4 v12, s[52:55], s71 offen offset:3072 sc1 lds
v_add_f32 v4, v4, v162
MA 24,a,248,v,112
v_add_f32 v4, v4, v163
v_cmp_gt_i32_e64 s[88:89], 2, v246
MA 56,a,248,v,120
v_exp_f32 v165, v165
MA 88,a,248,v,128
ds_read_b128 a[184:187], v10 offset:30720
v_cmp_gt_i32_e64 s[90:91], 3, v246
MA 120,a,248,v,136
v_cvt_pk_bf16_f32 v161, v162, v163
v_cndmask_b32_e64 v196, v196, v14, s[84:85]
MA 28,a,252,v,112
v_exp_f32 v166, v166
MA 60,a,252,v,120
v_add_f32 v4, v4, v164
v_add_f32 v4, v4, v165
MA 92,a,252,v,128
ds_read_b128 a[188:191], v10 offset:31744
v_cndmask_b32_e64 v197, v197, v14, s[86:87]
MA 124,a,252,v,136
s_cmp_eq_u32 s70, 7
v_exp_f32 v167, v167
v_cvt_pk_bf16_f32 v162, v164, v165
v_exp_f32 v168, v168
v_cndmask_b32_e64 v198, v198, v14, s[88:89]
v_add_f32 v4, v4, v166
v_cndmask_b32_e64 v199, v199, v14, s[90:91]
v_add_f32 v4, v4, v167
v_exp_f32 v169, v169
v_cvt_pk_bf16_f32 v163, v166, v167
v_add_u32 v247, -96, v13
v_exp_f32 v170, v170
v_add_f32 v5, v5, v168
v_cmp_gt_i32_e64 s[92:93], 0, v247
v_add_f32 v5, v5, v169
v_exp_f32 v171, v171
v_cmp_gt_i32_e64 s[94:95], 1, v247
v_cvt_pk_bf16_f32 v168, v168, v169
v_exp_f32 v172, v172
v_cmp_gt_i32_e64 s[96:97], 2, v247
v_add_f32 v5, v5, v170
v_cmp_gt_i32_e64 s[98:99], 3, v247
v_add_f32 v5, v5, v171
v_exp_f32 v173, v173
v_cvt_pk_bf16_f32 v169, v170, v171
v_cndmask_b32_e64 v204, v204, v14, s[92:93]
v_exp_f32 v174, v174
v_add_f32 v5, v5, v172
v_cndmask_b32_e64 v205, v205, v14, s[94:95]
v_add_f32 v5, v5, v173
v_exp_f32 v175, v175
v_cndmask_b32_e64 v206, v206, v14, s[96:97]
v_cvt_pk_bf16_f32 v170, v172, v173
v_add_f32 v5, v5, v174
v_add_f32 v5, v5, v175
v_cndmask_b32_e64 v207, v207, v14, s[98:99]
v_cvt_pk_bf16_f32 v171, v174, v175
s_cbranch_scc1 L_p3_mxm_top
s_waitcnt lgkmcnt(0)
v_xor_b32 v11, 0x8000, v11
v_mfma_f32_16x16x32_bf16 v[80:83], a[128:131], v[16:19], 0
s_add_u32 m0, s73, 16384
ds_read_b128 a[192:195], v11 offset:0
v_mfma_f32_16x16x32_bf16 v[88:91], a[128:131], v[32:35], 0
v_exp_f32 v176, v176
MV 80,a,132,v,20
v_exp_f32 v177, v177
MV 88,a,132,v,36
ds_read_b128 a[196:199], v11 offset:1024
buffer_load_dwordx4 v12, s[56:59], s71 offen offset:0 sc1 lds
MV 80,a,136,v,24
v_exp_f32 v178, v178
MV 88,a,136,v,40
v_add_f32 v2, v2, v176
v_add_f32 v2, v2, v177
MV 80,a,140,v,28
v_exp_f32 v179, v179
MV 88,a,140,v,44
ds_read_b128 a[200:203], v11 offset:2048
v_cvt_pk_bf16_f32 v176, v176, v177
v_mfma_f32_16x16x32_bf16 v[84:87], a[144:147], v[16:19], 0
v_exp_f32 v180, v180
v_mfma_f32_16x16x32_bf16 v[92:95], a[144:147], v[32:35], 0
ds_read_b128 a[204:207], v11 offset:3072
v_add_f32 v2, v2, v178
MV 84,a,148,v,20
ds_read_b128 a[208:211], v11 offset:4096
v_add_f32 v2, v2, v179
MV 92,a,148,v,36
v_exp_f32 v181, v181
MV 84,a,152,v,24
buffer_load_dwordx4 v12, s[56:59], s71 offen offset:1024 sc1 lds
v_cvt_pk_bf16_f32 v177, v178, v179
MV 92,a,152,v,40
v_exp_f32 v182, v182
MV 84,a,156,v,28
v_add_f32 v2, v2, v180
v_add_f32 v2, v2, v181
MV 92,a,156,v,44
v_exp_f32 v183, v183
v_mfma_f32_16x16x32_bf16 v[112:115], a[160:163], v[16:19], 0
ds_read_b128 a[212:215], v11 offset:5120
v_cvt_pk_bf16_f32 v178, v180, v181
v_mfma_f32_16x16x32_bf16 v[120:123], a[160:163], v[32:35], 0
v_exp_f32 v184, v184
MV 112,a,164,v,20
v_add_f32 v2, v2, v182
v_add_f32 v2, v2, v183
MV 120,a,164,v,36
v_exp_f32 v185, v185
MV 112,a,168,v,24
ds_read_b128 a[216:219], v11 offset:6144
v_cvt_pk_bf16_f32 v179, v182, v183
MV 120,a,168,v,40
v_exp_f32 v186, v186
MV 112,a,172,v,28
ds_read_b128 a[220:223], v11 offset:7168
v_add_f32 v3, v3, v184
MV 120,a,172,v,44
buffer_load_dwordx4 v12, s[56:59], s71 offen offset:2048 sc1 lds
v_add_f32 v3, v3, v185
v_mfma_f32_16x16x32_bf16 v[116:119], a[176:179], v[16:19], 0
v_exp_f32 v187, v187
v_mfma_f32_16x16x32_bf16 v[124:127], a[176:179], v[32:35], 0
ds_read_b128 a[224:227], v11 offset:8192
v_cvt_pk_bf16_f32 v184, v184, v185
MV 116,a,180,v,20
v_exp_f32 v188, v188
MV 124,a,180,v,36
v_add_f32 v3, v3, v186
v_add_f32 v3, v3, v187
MV 116,a,184,v,24
v_exp_f32 v189, v189
MV 124,a,184,v,40
ds_read_b128 a[228:231], v11 offset:9216
v_cvt_pk_bf16_f32 v185, v186, v187
MV 116,a,188,v,28
v_exp_f32 v190, v190
MV 124,a,188,v,44
ds_read_b128 a[232:235], v11 offset:10240
ds_read_b128 a[236:239], v11 offset:11264
ds_read_b128 a[240:243], v11 offset:12288
ds_read_b128 a[244:247], v11 offset:13312
ds_read_b128 a[248:251], v11 offset:14336
ds_read_b128 a[252:255], v11 offset:15360
buffer_load_dwordx4 v12, s[56:59], s71 offen offset:3072 sc1 lds
s_add_u32 s71, s71, 16384
s_xor_b32 s73, s73, 0x8000
v_add_f32 v3, v3, v188
v_add_f32 v3, v3, v189
v_exp_f32 v191, v191
v_cvt_pk_bf16_f32 v186, v188, v189
v_exp_f32 v192, v192
v_add_f32 v3, v3, v190
v_add_f32 v3, v3, v191
v_exp_f32 v193, v193
v_cvt_pk_bf16_f32 v187, v190, v191
v_exp_f32 v194, v194
v_add_f32 v4, v4, v192
v_add_f32 v4, v4, v193
v_exp_f32 v195, v195
v_cvt_pk_bf16_f32 v192, v192, v193
v_exp_f32 v196, v196
v_add_f32 v4, v4, v194
v_add_f32 v4, v4, v195
v_exp_f32 v197, v197
v_cvt_pk_bf16_f32 v193, v194, v195
v_exp_f32 v198, v198
v_add_f32 v4, v4, v196
v_add_f32 v4, v4, v197
v_exp_f32 v199, v199
v_cvt_pk_bf16_f32 v194, v196, v197
v_exp_f32 v200, v200
v_add_f32 v4, v4, v198
v_add_f32 v4, v4, v199
v_exp_f32 v201, v201
v_cvt_pk_bf16_f32 v195, v198, v199
v_exp_f32 v202, v202
v_add_f32 v5, v5, v200
v_add_f32 v5, v5, v201
v_exp_f32 v203, v203
v_cvt_pk_bf16_f32 v200, v200, v201
v_exp_f32 v204, v204
v_add_f32 v5, v5, v202
v_add_f32 v5, v5, v203
v_exp_f32 v205, v205
v_cvt_pk_bf16_f32 v201, v202, v203
v_exp_f32 v206, v206
v_add_f32 v5, v5, v204
v_add_f32 v5, v5, v205
v_exp_f32 v207, v207
v_cvt_pk_bf16_f32 v202, v204, v205
v_add_f32 v5, v5, v206
v_add_f32 v5, v5, v207
v_cvt_pk_bf16_f32 v203, v206, v207
s_waitcnt vmcnt(16) lgkmcnt(0)
MA 0,a,192,v,144
s_barrier
v_xor_b32 v10, 0x8000, v10
MA 32,a,192,v,152
s_add_u32 m0, s72, 16384
ds_read_b128 a[128:131], v10 offset:0
MA 64,a,192,v,160
v_exp_f32 v80, v80
MA 96,a,192,v,168
buffer_load_dwordx4 v12, s[52:55], s71 offen offset:0 sc1 lds
v_lshrrev_b32 v249, 2, v1
MA 4,a,196,v,144
ds_read_b128 a[132:135], v10 offset:1024
v_and_b32 v248, 7, v249
MA 36,a,196,v,152
v_lshlrev_b32 v249, 8, v249
v_and_b32 v250, 3, v1
MA 68,a,196,v,160
v_lshl_add_u32 v249, v250, 3, v249
s_lshl_b32 s36, s3, 13
MA 100,a,196,v,168
v_exp_f32 v81, v81
MA 8,a,200,v,144
ds_read_b128 a[136:139], v10 offset:2048
s_add_u32 s36, s36, 131072
MA 40,a,200,v,152
v_add_u32 v249, s36, v249
s_waitcnt vmcnt(13)
MA 72,a,200,v,160
v_exp_f32 v82, v82
MA 104,a,200,v,168
ds_read_b128 a[140:143], v10 offset:3072
v_xor_b32 v250, 0, v248
MA 12,a,204,v,144
v_lshl_add_u32 v250, v250, 5, v249
TR 96,250,0
MA 44,a,204,v,152
TR 98,250,4096
v_xor_b32 v250, 1, v248
MA 76,a,204,v,160
v_exp_f32 v83, v83
MA 108,a,204,v,168
ds_read_b128 a[144:147], v10 offset:4096
v_lshl_add_u32 v250, v250, 5, v249
MA 16,a,208,v,144
v_cvt_pk_bf16_f32 v80, v80, v81
TR 100,250,0
MA 48,a,208,v,152
buffer_load_dwordx4 v12, s[52:55], s71 offen offset:1024 sc1 lds
TR 102,250,4096
MA 80,a,208,v,160
v_xor_b32 v250, 2, v248
v_lshl_add_u32 v250, v250, 5, v249
MA 112,a,208,v,168
ds_read_b128 a[148:151], v10 offset:5120
TR 104,250,0
MA 20,a,212,v,144
v_exp_f32 v84, v84
MA 52,a,212,v,152
TR 106,250,4096
v_xor_b32 v250, 3, v248
MA 84,a,212,v,160
ds_read_b128 a[152:155], v10 offset:6144
v_lshl_add_u32 v250, v250, 5, v249
MA 116,a,212,v,168
TR 108,250,0
TR 110,250,4096
MA 24,a,216,v,144
v_exp_f32 v85, v85
MA 56,a,216,v,152
v_xor_b32 v250, 4, v248
v_lshl_add_u32 v250, v250, 5, v249
MA 88,a,216,v,160
ds_read_b128 a[156:159], v10 offset:7168
v_cvt_pk_bf16_f32 v81, v82, v83
MA 120,a,216,v,168
TR 128,250,0
TR 130,250,4096
MA 28,a,220,v,144
v_xor_b32 v250, 5, v248
v_lshl_add_u32 v250, v250, 5, v249
MA 60,a,220,v,152
v_exp_f32 v86, v86
MA 92,a,220,v,160
ds_read_b128 a[160:163], v10 offset:8192
TR 132,250,0
MA 124,a,220,v,168
TR 134,250,4096
v_xor_b32 v250, 6, v248
MA 0,a,224,v,176
buffer_load_dwordx4 v12, s[52:55], s71 offen offset:2048 sc1 lds
v_lshl_add_u32 v250, v250, 5, v249
MA 32,a,224,v,184
v_exp_f32 v87, v87
MA 64,a,224,v,192
ds_read_b128 a[164:167], v10 offset:9216
TR 136,250,0
MA 96,a,224,v,200
TR 138,250,4096
v_xor_b32 v250, 7, v248
MA 4,a,228,v,176
v_cvt_pk_bf16_f32 v82, v84, v85
v_lshl_add_u32 v250, v250, 5, v249
MA 36,a,228,v,184
ds_read_b128 a[168:171], v10 offset:10240
TR 140,250,0
MA 68,a,228,v,192
ds_read_b128 a[172:175], v10 offset:11264
TR 142,250,4096
MA 100,a,228,v,200
v_exp_f32 v88, v88
MA 8,a,232,v,176
s_add_u32 s32, s40, 100663296
s_addc_u32 s33, s41, 0
MA 40,a,232,v,184
s_mov_b32 s34, 8388608
s_mov_b32 s35, 0x20000
MA 72,a,232,v,192
s_and_b32 s36, s2, 7
s_lshl_b32 s36, s36, 20
MA 104,a,232,v,200
v_exp_f32 v89, v89
MA 12,a,236,v,176
ds_read_b128 a[176:179], v10 offset:12288
s_lshr_b32 s37, s2, 3
MA 44,a,236,v,184
v_cvt_pk_bf16_f32 v83, v86, v87
s_lshl_b32 s37, s37, 15
MA 76,a,236,v,192
s_add_u32 s36, s36, s37
s_lshl_b32 s37, s3, 12
MA 108,a,236,v,200
ds_read_b128 a[180:183], v10 offset:13312
s_add_u32 s36, s36, s37
MA 16,a,240,v,176
v_exp_f32 v90, v90
MA 48,a,240,v,184
buffer_load_dwordx4 v12, s[52:55], s71 offen offset:3072 sc1 lds
s_add_u32 s37, s36, 4096
MA 80,a,240,v,192
s_waitcnt lgkmcnt(15)
buffer_store_dwordx4 v[96:99], v12, s[32:35], s36 offen offset:0 sc1
buffer_store_dwordx4 v[100:103], v12, s[32:35], s36 offen offset:1024 sc1
MA 112,a,240,v,200
ds_read_b128 a[184:187], v10 offset:14336
buffer_store_dwordx4 v[104:107], v12, s[32:35], s36 offen offset:2048 sc1
MA 20,a,244,v,176
v_exp_f32 v91, v91
MA 52,a,244,v,184
buffer_store_dwordx4 v[108:111], v12, s[32:35], s36 offen offset:3072 sc1
s_waitcnt lgkmcnt(13)
buffer_store_dwordx4 v[128:131], v12, s[32:35], s37 offen offset:0 sc1
MA 84,a,244,v,192
s_waitcnt lgkmcnt(10)
buffer_store_dwordx4 v[132:135], v12, s[32:35], s37 offen offset:1024 sc1
s_waitcnt lgkmcnt(7)
buffer_store_dwordx4 v[136:139], v12, s[32:35], s37 offen offset:2048 sc1
MA 116,a,244,v,200
ds_read_b128 a[188:191], v10 offset:15360
v_cvt_pk_bf16_f32 v88, v88, v89
MA 24,a,248,v,176
s_xor_b32 s72, s72, 0x8000
s_waitcnt lgkmcnt(4)
buffer_store_dwordx4 v[140:143], v12, s[32:35], s37 offen offset:3072 sc1
MA 56,a,248,v,184
s_add_u32 s32, s40, 109051904
s_addc_u32 s33, s41, 0
MA 88,a,248,v,192
v_exp_f32 v92, v92
MA 120,a,248,v,200
s_mov_b32 s34, 4194304
s_mov_b32 s35, 0x20000
MA 28,a,252,v,176
s_lshl_b32 s36, s2, 14
v_mov_b32 v252, -1
MA 60,a,252,v,184
v_exp_f32 v93, v93
MA 92,a,252,v,192
v_mov_b32 v253, -1
v_mov_b32 v254, -1
MA 124,a,252,v,200
v_mov_b32 v255, -1
v_cvt_pk_bf16_f32 v89, v90, v91
buffer_store_dwordx4 v[252:255], v12, s[32:35], s36 offen offset:0 sc1
buffer_store_dwordx4 v[252:255], v12, s[32:35], s36 offen offset:1024 sc1
buffer_store_dwordx4 v[252:255], v12, s[32:35], s36 offen offset:2048 sc1
v_exp_f32 v94, v94
buffer_store_dwordx4 v[252:255], v12, s[32:35], s36 offen offset:3072 sc1
v_lshlrev_b32 v232, 4, v1
v_add_u32 v233, -8, v232
v_mov_b32 v235, 0
v_exp_f32 v95, v95
buffer_load_ushort v234, v235, s[28:31], s42 offen
buffer_load_dwordx2 v[208:209], v233, s[16:19], 0 offen
buffer_load_dwordx4 v[210:213], v232, s[16:19], 0 offen offset:0
buffer_load_dwordx2 v[214:215], v232, s[16:19], 0 offen offset:1016
v_cvt_pk_bf16_f32 v90, v92, v93
buffer_load_dwordx4 v[216:219], v232, s[16:19], 0 offen offset:1024
buffer_load_dwordx2 v[220:221], v232, s[16:19], 0 offen offset:2040
buffer_load_dwordx4 v[222:225], v232, s[16:19], 0 offen offset:2048
v_cvt_pk_bf16_f32 v91, v94, v95
buffer_load_dwordx2 v[226:227], v232, s[16:19], 0 offen offset:3064
buffer_load_dwordx4 v[228:231], v232, s[16:19], 0 offen offset:3072
L_p3_eps:
v_mov_b32 v240, v4
v_mov_b32 v241, v5
s_nop 0
v_permlane32_swap_b32 v4, v240
v_permlane32_swap_b32 v5, v241
v_add_f32 v4, v4, v240
v_add_f32 v5, v5, v241
v_mov_b32 v240, v4
v_mov_b32 v241, v5
s_nop 0
v_permlane16_swap_b32 v4, v240
v_permlane16_swap_b32 v5, v241
v_add_f32 v4, v4, v240
v_add_f32 v5, v5, v241
v_min_f32 v240, v4, v5
v_add_f32 v241, v4, v5
v_cmp_nle_f32 vcc, 0x30800000, v240
s_nop 0
s_mov_b64 s[78:79], vcc
v_cmp_nge_f32 vcc, 0x4e800000, v241
s_nop 0
s_or_b64 s[78:79], s[78:79], vcc
v_rcp_f32 v4, v4
v_rcp_f32 v5, v5
s_add_u32 s80, s101, 0x20000
s_nop 4
v_accvgpr_read_b32 v240, a64
v_accvgpr_read_b32 v241, a65
v_accvgpr_read_b32 v242, a66
v_accvgpr_read_b32 v243, a67
v_accvgpr_read_b32 v244, a68
v_accvgpr_read_b32 v245, a69
v_accvgpr_read_b32 v246, a70
v_accvgpr_read_b32 v247, a71
v_mul_f32 v240, v240, v4
v_mul_f32 v241, v241, v4
v_mul_f32 v242, v242, v4
v_mul_f32 v243, v243, v4
v_mul_f32 v244, v244, v4
v_mul_f32 v245, v245, v4
v_mul_f32 v246, v246, v4
v_mul_f32 v247, v247, v4
v_cvt_pk_bf16_f32 v248, v240, v241
v_cvt_pk_bf16_f32 v249, v242, v243
v_cvt_pk_bf16_f32 v250, v244, v245
v_cvt_pk_bf16_f32 v251, v246, v247
buffer_store_dwordx4 v[248:251], v15, s[60:63], s101 offen offset:0 sc1
v_accvgpr_read_b32 v240, a72
v_accvgpr_read_b32 v241, a73
v_accvgpr_read_b32 v242, a74
v_accvgpr_read_b32 v243, a75
v_accvgpr_read_b32 v244, a76
v_accvgpr_read_b32 v245, a77
v_accvgpr_read_b32 v246, a78
v_accvgpr_read_b32 v247, a79
v_mul_f32 v240, v240, v4
v_mul_f32 v241, v241, v4
v_mul_f32 v242, v242, v4
v_mul_f32 v243, v243, v4
v_mul_f32 v244, v244, v4
v_mul_f32 v245, v245, v4
v_mul_f32 v246, v246, v4
v_mul_f32 v247, v247, v4
v_cvt_pk_bf16_f32 v252, v240, v241
v_cvt_pk_bf16_f32 v253, v242, v243
v_cvt_pk_bf16_f32 v254, v244, v245
v_cvt_pk_bf16_f32 v255, v246, v247
buffer_store_dwordx4 v[252:255], v15, s[60:63], s101 offen offset:1024 sc1
v_accvgpr_read_b32 v240, a80
v_accvgpr_read_b32 v241, a81
v_accvgpr_read_b32 v242, a82
v_accvgpr_read_b32 v243, a83
v_accvgpr_read_b32 v244, a84
v_accvgpr_read_b32 v245, a85
v_accvgpr_read_b32 v246, a86
v_accvgpr_read_b32 v247, a87
v_mul_f32 v240, v240, v4
v_mul_f32 v241, v241, v4
v_mul_f32 v242, v242, v4
v_mul_f32 v243, v243, v4
v_mul_f32 v244, v244, v4
v_mul_f32 v245, v245, v4
v_mul_f32 v246, v246, v4
v_mul_f32 v247, v247, v4
v_cvt_pk_bf16_f32 v248, v240, v241
v_cvt_pk_bf16_f32 v249, v242, v243
v_cvt_pk_bf16_f32 v250, v244, v245
v_cvt_pk_bf16_f32 v251, v246, v247
buffer_store_dwordx4 v[248:251], v15, s[60:63], s101 offen offset:2048 sc1
v_accvgpr_read_b32 v240, a88
v_accvgpr_read_b32 v241, a89
v_accvgpr_read_b32 v242, a90
v_accvgpr_read_b32 v243, a91
v_accvgpr_read_b32 v244, a92
v_accvgpr_read_b32 v245, a93
v_accvgpr_read_b32 v246, a94
v_accvgpr_read_b32 v247, a95
v_mul_f32 v240, v240, v4
v_mul_f32 v241, v241, v4
v_mul_f32 v242, v242, v4
v_mul_f32 v243, v243, v4
v_mul_f32 v244, v244, v4
v_mul_f32 v245, v245, v4
v_mul_f32 v246, v246, v4
v_mul_f32 v247, v247, v4
v_cvt_pk_bf16_f32 v252, v240, v241
v_cvt_pk_bf16_f32 v253, v242, v243
v_cvt_pk_bf16_f32 v254, v244, v245
v_cvt_pk_bf16_f32 v255, v246, v247
buffer_store_dwordx4 v[252:255], v15, s[60:63], s101 offen offset:3072 sc1
v_accvgpr_read_b32 v240, a96
v_accvgpr_read_b32 v241, a97
v_accvgpr_read_b32 v242, a98
v_accvgpr_read_b32 v243, a99
v_accvgpr_read_b32 v244, a100
v_accvgpr_read_b32 v245, a101
v_accvgpr_read_b32 v246, a102
v_accvgpr_read_b32 v247, a103
v_mul_f32 v240, v240, v5
v_mul_f32 v241, v241, v5
v_mul_f32 v242, v242, v5
v_mul_f32 v243, v243, v5
v_mul_f32 v244, v244, v5
v_mul_f32 v245, v245, v5
v_mul_f32 v246, v246, v5
v_mul_f32 v247, v247, v5
v_cvt_pk_bf16_f32 v248, v240, v241
v_cvt_pk_bf16_f32 v249, v242, v243
v_cvt_pk_bf16_f32 v250, v244, v245
v_cvt_pk_bf16_f32 v251, v246, v247
buffer_store_dwordx4 v[248:251], v15, s[60:63], s80 offen offset:0 sc1
v_accvgpr_read_b32 v240, a104
v_accvgpr_read_b32 v241, a105
v_accvgpr_read_b32 v242, a106
v_accvgpr_read_b32 v243, a107
v_accvgpr_read_b32 v244, a108
v_accvgpr_read_b32 v245, a109
v_accvgpr_read_b32 v246, a110
v_accvgpr_read_b32 v247, a111
v_mul_f32 v240, v240, v5
v_mul_f32 v241, v241, v5
v_mul_f32 v242, v242, v5
v_mul_f32 v243, v243, v5
v_mul_f32 v244, v244, v5
v_mul_f32 v245, v245, v5
v_mul_f32 v246, v246, v5
v_mul_f32 v247, v247, v5
v_cvt_pk_bf16_f32 v252, v240, v241
v_cvt_pk_bf16_f32 v253, v242, v243
v_cvt_pk_bf16_f32 v254, v244, v245
v_cvt_pk_bf16_f32 v255, v246, v247
buffer_store_dwordx4 v[252:255], v15, s[60:63], s80 offen offset:1024 sc1
v_accvgpr_read_b32 v240, a112
v_accvgpr_read_b32 v241, a113
v_accvgpr_read_b32 v242, a114
v_accvgpr_read_b32 v243, a115
v_accvgpr_read_b32 v244, a116
v_accvgpr_read_b32 v245, a117
v_accvgpr_read_b32 v246, a118
v_accvgpr_read_b32 v247, a119
v_mul_f32 v240, v240, v5
v_mul_f32 v241, v241, v5
v_mul_f32 v242, v242, v5
v_mul_f32 v243, v243, v5
v_mul_f32 v244, v244, v5
v_mul_f32 v245, v245, v5
v_mul_f32 v246, v246, v5
v_mul_f32 v247, v247, v5
v_cvt_pk_bf16_f32 v248, v240, v241
v_cvt_pk_bf16_f32 v249, v242, v243
v_cvt_pk_bf16_f32 v250, v244, v245
v_cvt_pk_bf16_f32 v251, v246, v247
buffer_store_dwordx4 v[248:251], v15, s[60:63], s80 offen offset:2048 sc1
v_accvgpr_read_b32 v240, a120
v_accvgpr_read_b32 v241, a121
v_accvgpr_read_b32 v242, a122
v_accvgpr_read_b32 v243, a123
v_accvgpr_read_b32 v244, a124
v_accvgpr_read_b32 v245, a125
v_accvgpr_read_b32 v246, a126
v_accvgpr_read_b32 v247, a127
v_mul_f32 v240, v240, v5
v_mul_f32 v241, v241, v5
v_mul_f32 v242, v242, v5
v_mul_f32 v243, v243, v5
v_mul_f32 v244, v244, v5
v_mul_f32 v245, v245, v5
v_mul_f32 v246, v246, v5
v_mul_f32 v247, v247, v5
v_cvt_pk_bf16_f32 v252, v240, v241
v_cvt_pk_bf16_f32 v253, v242, v243
v_cvt_pk_bf16_f32 v254, v244, v245
v_cvt_pk_bf16_f32 v255, v246, v247
buffer_store_dwordx4 v[252:255], v15, s[60:63], s80 offen offset:3072 sc1
v_mov_b32 v160, 0x3f803f80
v_mov_b32 v161, 0x3f803f80
v_mov_b32 v162, 0x3f803f80
v_mov_b32 v163, 0x3f803f80
v_mov_b32 v164, 0
v_mov_b32 v165, 0
v_mov_b32 v166, 0
v_mov_b32 v167, 0
v_mov_b32 v168, 0
v_mov_b32 v169, 0
v_mov_b32 v170, 0
v_mov_b32 v171, 0
s_and_b32 s36, s2, 3
s_lshl_b32 s36, s36, 1
s_sub_u32 s32, 14, s36
s_bitcmp1_b32 s2, 4
s_cselect_b32 s36, s32, s36
s_bfe_u32 s32, s2, 0x10003
s_add_u32 s36, s36, s32
s_bfe_u32 s37, s2, 0x10002
s_lshr_b32 s32, s2, 5
s_lshl_b32 s32, s32, 1
s_add_u32 s37, s37, s32
s_lshl_b32 s36, s36, 2
s_add_u32 s36, s36, s3
s_lshl_b32 s37, s37, 7
s_lshl_b32 s32, s36, 16
s_add_u32 s37, s37, s32
s_lshl_b32 s36, s36, 7
v_and_b32 v240, 15, v1
v_bfe_u32 v241, v1, 4, 1
v_lshlrev_b32 v241, 5, v241
v_lshrrev_b32 v242, 5, v1
v_lshl_add_u32 v241, v242, 4, v241
v_lshl_add_u32 v241, v240, 11, v241
v_lshlrev_b32 v240, 2, v240
s_add_u32 s32, s40, 58720256
s_addc_u32 s33, s41, 0
s_mov_b32 s34, 8192
s_mov_b32 s35, 0x20000
buffer_load_dwordx4 v[192:195], v241, s[44:47], s37 offen offset:0
buffer_load_dwordx4 v[196:199], v241, s[44:47], s37 offen offset:64
buffer_load_dword v6, v240, s[32:35], s36 offen offset:0 sc1
s_add_u32 s37, s37, 32768
buffer_load_dwordx4 v[200:203], v241, s[44:47], s37 offen offset:0
buffer_load_dwordx4 v[204:207], v241, s[44:47], s37 offen offset:64
buffer_load_dword v7, v240, s[32:35], s36 offen offset:64 sc1
v_lshlrev_b32 v236, 20, v1
s_lshl_b32 s36, s3, 26
v_add_u32 v236, s36, v236
v_mov_b32 v237, 1
s_lshl_b32 s37, s2, 2
s_lshl_b32 s74, s70, 1
s_sub_u32 s74, 13, s74
s_cbranch_scc1 L_p3_s0m_top
.p2align 5
L_p3_s0_top:
s_waitcnt lgkmcnt(0)
v_mfma_f32_16x16x32_bf16 v[144:147], a[128:131], v[16:19], 0
s_add_u32 m0, s73, 0
ds_read_b128 a[192:195], v11 offset:16384
v_mfma_f32_16x16x32_bf16 v[152:155], a[128:131], v[32:35], 0
v_exp_f32 v112, v112
MV 144,a,132,v,20
ds_read_b128 a[196:199], v11 offset:17408
buffer_load_dwordx4 v12, s[56:59], s71 offen offset:0 sc1 lds
MV 152,a,132,v,36
v_exp_f32 v113, v113
MV 144,a,136,v,24
ds_read_b128 a[200:203], v11 offset:18432
ds_read_b128 a[204:207], v11 offset:19456
MV 152,a,136,v,40
v_exp_f32 v114, v114
MV 144,a,140,v,28
v_exp_f32 v115, v115
MV 152,a,140,v,44
ds_read_b128 a[208:211], v11 offset:20480
v_cvt_pk_bf16_f32 v112, v112, v113
v_mfma_f32_16x16x32_bf16 v[148:151], a[144:147], v[16:19], 0
ds_read_b128 a[212:215], v11 offset:21504
buffer_load_dwordx4 v12, s[56:59], s71 offen offset:1024 sc1 lds
v_mfma_f32_16x16x32_bf16 v[156:159], a[144:147], v[32:35], 0
v_exp_f32 v116, v116
MV 148,a,148,v,20
v_exp_f32 v117, v117
MV 156,a,148,v,36
ds_read_b128 a[216:219], v11 offset:22528
ds_read_b128 a[220:223], v11 offset:23552
MV 148,a,152,v,24
ds_read_b128 a[224:227], v11 offset:24576
v_cvt_pk_bf16_f32 v113, v114, v115
MV 156,a,152,v,40
v_exp_f32 v118, v118
MV 148,a,156,v,28
v_exp_f32 v119, v119
MV 156,a,156,v,44
ds_read_b128 a[228:231], v11 offset:25600
buffer_load_dwordx4 v12, s[56:59], s71 offen offset:2048 sc1 lds
v_mfma_f32_16x16x32_bf16 v[176:179], a[160:163], v[16:19], 0
ds_read_b128 a[232:235], v11 offset:26624
v_cvt_pk_bf16_f32 v114, v116, v117
v_mfma_f32_16x16x32_bf16 v[184:187], a[160:163], v[32:35], 0
v_exp_f32 v120, v120
MV 176,a,164,v,20
ds_read_b128 a[236:239], v11 offset:27648
ds_read_b128 a[240:243], v11 offset:28672
MV 184,a,164,v,36
v_exp_f32 v121, v121
MV 176,a,168,v,24
ds_read_b128 a[244:247], v11 offset:29696
v_cvt_pk_bf16_f32 v115, v118, v119
MV 184,a,168,v,40
ds_read_b128 a[248:251], v11 offset:30720
buffer_load_dwordx4 v12, s[56:59], s71 offen offset:3072 sc1 lds
MV 176,a,172,v,28
v_exp_f32 v122, v122
MV 184,a,172,v,44
v_exp_f32 v123, v123
v_mfma_f32_16x16x32_bf16 v[180:183], a[176:179], v[16:19], 0
ds_read_b128 a[252:255], v11 offset:31744
v_cvt_pk_bf16_f32 v120, v120, v121
v_mfma_f32_16x16x32_bf16 v[188:191], a[176:179], v[32:35], 0
v_exp_f32 v124, v124
MV 180,a,180,v,20
v_exp_f32 v125, v125
MV 188,a,180,v,36
s_add_u32 s71, s71, 16384
v_cvt_pk_bf16_f32 v121, v122, v123
MV 180,a,184,v,24
v_exp_f32 v126, v126
MV 188,a,184,v,40
v_exp_f32 v127, v127
MV 180,a,188,v,28
v_cvt_pk_bf16_f32 v122, v124, v125
v_cvt_pk_bf16_f32 v123, v126, v127
MV 188,a,188,v,44
s_waitcnt vmcnt(16) lgkmcnt(0)
MA 0,a,192,v,80
s_barrier
MA 32,a,192,v,88
s_add_u32 m0, s72, 0
ds_read_b128 a[128:131], v10 offset:16384
MA 4,a,196,v,80
v_exp_f32 v144, v144
MA 36,a,196,v,88
ds_read_b128 a[132:135], v10 offset:17408
buffer_load_dwordx4 v12, s[52:55], s71 offen offset:0 sc1 lds
MA 8,a,200,v,80
v_exp_f32 v145, v145
MA 40,a,200,v,88
ds_read_b128 a[136:139], v10 offset:18432
ds_read_b128 a[140:143], v10 offset:19456
MA 12,a,204,v,80
v_exp_f32 v146, v146
MA 44,a,204,v,88
v_exp_f32 v147, v147
MV 164,v,160,v,80
ds_read_b128 a[144:147], v10 offset:20480
buffer_load_dwordx4 v12, s[52:55], s71 offen offset:1024 sc1 lds
MV 168,v,160,v,88
ds_read_b128 a[148:151], v10 offset:21504
v_cvt_pk_bf16_f32 v144, v144, v145
MA 16,a,208,v,80
v_exp_f32 v148, v148
MA 48,a,208,v,88
ds_read_b128 a[152:155], v10 offset:22528
ds_read_b128 a[156:159], v10 offset:23552
MA 20,a,212,v,80
v_exp_f32 v149, v149
MA 52,a,212,v,88
ds_read_b128 a[160:163], v10 offset:24576
v_cvt_pk_bf16_f32 v145, v146, v147
MA 24,a,216,v,80
v_exp_f32 v150, v150
MA 56,a,216,v,88
ds_read_b128 a[164:167], v10 offset:25600
buffer_load_dwordx4 v12, s[52:55], s71 offen offset:2048 sc1 lds
MA 28,a,220,v,80
v_exp_f32 v151, v151
MA 60,a,220,v,88
ds_read_b128 a[168:171], v10 offset:26624
v_cvt_pk_bf16_f32 v146, v148, v149
MA 0,a,224,v,112
v_exp_f32 v152, v152
MA 32,a,224,v,120
ds_read_b128 a[172:175], v10 offset:27648
ds_read_b128 a[176:179], v10 offset:28672
MA 4,a,228,v,112
v_exp_f32 v153, v153
MA 36,a,228,v,120
ds_read_b128 a[180:183], v10 offset:29696
v_cvt_pk_bf16_f32 v147, v150, v151
MA 8,a,232,v,112
ds_read_b128 a[184:187], v10 offset:30720
buffer_load_dwordx4 v12, s[52:55], s71 offen offset:3072 sc1 lds
MA 40,a,232,v,120
v_exp_f32 v154, v154
MA 12,a,236,v,112
v_exp_f32 v155, v155
MA 44,a,236,v,120
ds_read_b128 a[188:191], v10 offset:31744
v_cvt_pk_bf16_f32 v152, v152, v153
MV 164,v,160,v,112
v_exp_f32 v156, v156
MV 168,v,160,v,120
MA 16,a,240,v,112
v_exp_f32 v157, v157
MA 48,a,240,v,120
s_sub_u32 s74, s74, 1
v_cvt_pk_bf16_f32 v153, v154, v155
MA 20,a,244,v,112
v_exp_f32 v158, v158
MA 52,a,244,v,120
MA 24,a,248,v,112
v_exp_f32 v159, v159
MA 56,a,248,v,120
MA 28,a,252,v,112
v_cvt_pk_bf16_f32 v154, v156, v157
v_cvt_pk_bf16_f32 v155, v158, v159
MA 60,a,252,v,120
s_cbranch_scc1 L_p3_s1m_top
s_waitcnt lgkmcnt(0)
v_xor_b32 v11, 0x8000, v11
v_mfma_f32_16x16x32_bf16 v[80:83], a[128:131], v[16:19], 0
s_add_u32 m0, s73, 16384
ds_read_b128 a[192:195], v11 offset:0
v_mfma_f32_16x16x32_bf16 v[88:91], a[128:131], v[32:35], 0
v_exp_f32 v176, v176
MV 80,a,132,v,20
ds_read_b128 a[196:199], v11 offset:1024
buffer_load_dwordx4 v12, s[56:59], s71 offen offset:0 sc1 lds
MV 88,a,132,v,36
v_exp_f32 v177, v177
MV 80,a,136,v,24
ds_read_b128 a[200:203], v11 offset:2048
ds_read_b128 a[204:207], v11 offset:3072
MV 88,a,136,v,40
v_exp_f32 v178, v178
MV 80,a,140,v,28
v_exp_f32 v179, v179
MV 88,a,140,v,44
ds_read_b128 a[208:211], v11 offset:4096
buffer_load_dwordx4 v12, s[56:59], s71 offen offset:1024 sc1 lds
v_mfma_f32_16x16x32_bf16 v[84:87], a[144:147], v[16:19], 0
ds_read_b128 a[212:215], v11 offset:5120
v_cvt_pk_bf16_f32 v176, v176, v177
v_mfma_f32_16x16x32_bf16 v[92:95], a[144:147], v[32:35], 0
v_exp_f32 v180, v180
MV 84,a,148,v,20
v_exp_f32 v181, v181
MV 92,a,148,v,36
ds_read_b128 a[216:219], v11 offset:6144
ds_read_b128 a[220:223], v11 offset:7168
MV 84,a,152,v,24
buffer_load_dwordx4 v12, s[56:59], s71 offen offset:2048 sc1 lds
v_cvt_pk_bf16_f32 v177, v178, v179
MV 92,a,152,v,40
v_exp_f32 v182, v182
MV 84,a,156,v,28
ds_read_b128 a[224:227], v11 offset:8192
ds_read_b128 a[228:231], v11 offset:9216
MV 92,a,156,v,44
v_exp_f32 v183, v183
v_mfma_f32_16x16x32_bf16 v[112:115], a[160:163], v[16:19], 0
ds_read_b128 a[232:235], v11 offset:10240
v_cvt_pk_bf16_f32 v178, v180, v181
v_mfma_f32_16x16x32_bf16 v[120:123], a[160:163], v[32:35], 0
v_exp_f32 v184, v184
MV 112,a,164,v,20
ds_read_b128 a[236:239], v11 offset:11264
buffer_load_dwordx4 v12, s[56:59], s71 offen offset:3072 sc1 lds
MV 120,a,164,v,36
v_exp_f32 v185, v185
MV 112,a,168,v,24
ds_read_b128 a[240:243], v11 offset:12288
v_cvt_pk_bf16_f32 v179, v182, v183
MV 120,a,168,v,40
ds_read_b128 a[244:247], v11 offset:13312
ds_read_b128 a[248:251], v11 offset:14336
MV 112,a,172,v,28
v_exp_f32 v186, v186
MV 120,a,172,v,44
v_exp_f32 v187, v187
v_mfma_f32_16x16x32_bf16 v[116:119], a[176:179], v[16:19], 0
ds_read_b128 a[252:255], v11 offset:15360
s_add_u32 s71, s71, 16384
v_mfma_f32_16x16x32_bf16 v[124:127], a[176:179], v[32:35], 0
s_xor_b32 s73, s73, 0x8000
v_cvt_pk_bf16_f32 v184, v184, v185
MV 116,a,180,v,20
v_exp_f32 v188, v188
MV 124,a,180,v,36
v_exp_f32 v189, v189
MV 116,a,184,v,24
v_cvt_pk_bf16_f32 v185, v186, v187
MV 124,a,184,v,40
v_exp_f32 v190, v190
MV 116,a,188,v,28
v_exp_f32 v191, v191
MV 124,a,188,v,44
v_cvt_pk_bf16_f32 v186, v188, v189
v_cvt_pk_bf16_f32 v187, v190, v191
s_waitcnt vmcnt(16) lgkmcnt(0)
MA 0,a,192,v,144
s_barrier
v_xor_b32 v10, 0x8000, v10
MA 32,a,192,v,152
s_add_u32 m0, s72, 16384
ds_read_b128 a[128:131], v10 offset:0
MA 4,a,196,v,144
v_exp_f32 v80, v80
MA 36,a,196,v,152
ds_read_b128 a[132:135], v10 offset:1024
buffer_load_dwordx4 v12, s[52:55], s71 offen offset:0 sc1 lds
MA 8,a,200,v,144
v_exp_f32 v81, v81
MA 40,a,200,v,152
ds_read_b128 a[136:139], v10 offset:2048
ds_read_b128 a[140:143], v10 offset:3072
MA 12,a,204,v,144
v_exp_f32 v82, v82
MA 44,a,204,v,152
v_exp_f32 v83, v83
MV 164,v,160,v,144
ds_read_b128 a[144:147], v10 offset:4096
buffer_load_dwordx4 v12, s[52:55], s71 offen offset:1024 sc1 lds
MV 168,v,160,v,152
ds_read_b128 a[148:151], v10 offset:5120
v_cvt_pk_bf16_f32 v80, v80, v81
MA 16,a,208,v,144
v_exp_f32 v84, v84
MA 48,a,208,v,152
ds_read_b128 a[152:155], v10 offset:6144
ds_read_b128 a[156:159], v10 offset:7168
MA 20,a,212,v,144
v_exp_f32 v85, v85
MA 52,a,212,v,152
buffer_load_dwordx4 v12, s[52:55], s71 offen offset:2048 sc1 lds
v_cvt_pk_bf16_f32 v81, v82, v83
MA 24,a,216,v,144
v_exp_f32 v86, v86
MA 56,a,216,v,152
ds_read_b128 a[160:163], v10 offset:8192
ds_read_b128 a[164:167], v10 offset:9216
MA 28,a,220,v,144
v_exp_f32 v87, v87
MA 60,a,220,v,152
ds_read_b128 a[168:171], v10 offset:10240
v_cvt_pk_bf16_f32 v82, v84, v85
MA 0,a,224,v,176
v_exp_f32 v88, v88
MA 32,a,224,v,184
ds_read_b128 a[172:175], v10 offset:11264
buffer_load_dwordx4 v12, s[52:55], s71 offen offset:3072 sc1 lds
MA 4,a,228,v,176
v_exp_f32 v89, v89
MA 36,a,228,v,184
ds_read_b128 a[176:179], v10 offset:12288
v_cvt_pk_bf16_f32 v83, v86, v87
MA 8,a,232,v,176
ds_read_b128 a[180:183], v10 offset:13312
ds_read_b128 a[184:187], v10 offset:14336
MA 40,a,232,v,184
v_exp_f32 v90, v90
MA 12,a,236,v,176
v_exp_f32 v91, v91
MA 44,a,236,v,184
ds_read_b128 a[188:191], v10 offset:15360
s_xor_b32 s72, s72, 0x8000
MV 164,v,160,v,176
buffer_store_dword v237, v236, s[8:11], s37 offen offset:1024 sc1
v_cvt_pk_bf16_f32 v88, v88, v89
MV 168,v,160,v,184
v_exp_f32 v92, v92
MA 16,a,240,v,176
v_exp_f32 v93, v93
MA 48,a,240,v,184
v_cvt_pk_bf16_f32 v89, v90, v91
MA 20,a,244,v,176
v_exp_f32 v94, v94
MA 52,a,244,v,184
MA 24,a,248,v,176
v_exp_f32 v95, v95
MA 56,a,248,v,184
MA 28,a,252,v,176
v_cvt_pk_bf16_f32 v90, v92, v93
v_cvt_pk_bf16_f32 v91, v94, v95
MA 60,a,252,v,184
s_branch L_p3_s0_top
L_p3_s1m_top:
s_waitcnt lgkmcnt(0)
v_xor_b32 v11, 0x8000, v11
v_mfma_f32_16x16x32_bf16 v[80:83], a[128:131], v[16:19], 0
s_add_u32 m0, s73, 16384
ds_read_b128 a[192:195], v11 offset:0
v_mfma_f32_16x16x32_bf16 v[88:91], a[128:131], v[32:35], 0
v_exp_f32 v176, v176
MV 80,a,132,v,20
ds_read_b128 a[196:199], v11 offset:1024
buffer_load_dwordx4 v12, s[56:59], s71 offen offset:0 sc1 lds
MV 88,a,132,v,36
v_exp_f32 v177, v177
MV 80,a,136,v,24
ds_read_b128 a[200:203], v11 offset:2048
ds_read_b128 a[204:207], v11 offset:3072
MV 88,a,136,v,40
v_exp_f32 v178, v178
MV 80,a,140,v,28
v_exp_f32 v179, v179
MV 88,a,140,v,44
ds_read_b128 a[208:211], v11 offset:4096
buffer_load_dwordx4 v12, s[56:59], s71 offen offset:1024 sc1 lds
v_mfma_f32_16x16x32_bf16 v[84:87], a[144:147], v[16:19], 0
ds_read_b128 a[212:215], v11 offset:5120
v_cvt_pk_bf16_f32 v176, v176, v177
v_mfma_f32_16x16x32_bf16 v[92:95], a[144:147], v[32:35], 0
v_exp_f32 v180, v180
MV 84,a,148,v,20
v_exp_f32 v181, v181
MV 92,a,148,v,36
ds_read_b128 a[216:219], v11 offset:6144
ds_read_b128 a[220:223], v11 offset:7168
MV 84,a,152,v,24
buffer_load_dwordx4 v12, s[56:59], s71 offen offset:2048 sc1 lds
v_cvt_pk_bf16_f32 v177, v178, v179
MV 92,a,152,v,40
v_exp_f32 v182, v182
MV 84,a,156,v,28
ds_read_b128 a[224:227], v11 offset:8192
ds_read_b128 a[228:231], v11 offset:9216
MV 92,a,156,v,44
v_exp_f32 v183, v183
v_mfma_f32_16x16x32_bf16 v[112:115], a[160:163], v[16:19], 0
ds_read_b128 a[232:235], v11 offset:10240
v_cvt_pk_bf16_f32 v178, v180, v181
v_mfma_f32_16x16x32_bf16 v[120:123], a[160:163], v[32:35], 0
v_exp_f32 v184, v184
MV 112,a,164,v,20
ds_read_b128 a[236:239], v11 offset:11264
buffer_load_dwordx4 v12, s[56:59], s71 offen offset:3072 sc1 lds
MV 120,a,164,v,36
v_exp_f32 v185, v185
MV 112,a,168,v,24
ds_read_b128 a[240:243], v11 offset:12288
v_cvt_pk_bf16_f32 v179, v182, v183
MV 120,a,168,v,40
ds_read_b128 a[244:247], v11 offset:13312
ds_read_b128 a[248:251], v11 offset:14336
MV 112,a,172,v,28
v_exp_f32 v186, v186
MV 120,a,172,v,44
v_exp_f32 v187, v187
v_mfma_f32_16x16x32_bf16 v[116:119], a[176:179], v[16:19], 0
ds_read_b128 a[252:255], v11 offset:15360
s_add_u32 s71, s71, 16384
v_mfma_f32_16x16x32_bf16 v[124:127], a[176:179], v[32:35], 0
v_cvt_pk_bf16_f32 v184, v184, v185
v_add_u32 v246, 0, v13
MV 116,a,180,v,20
v_cmp_gt_i32_e64 s[84:85], 0, v246
v_cmp_gt_i32_e64 s[86:87], 1, v246
MV 124,a,180,v,36
v_cmp_gt_i32_e64 s[88:89], 2, v246
v_cmp_gt_i32_e64 s[90:91], 3, v246
MV 116,a,184,v,24
v_cndmask_b32_e64 v80, v80, v14, s[84:85]
v_cndmask_b32_e64 v81, v81, v14, s[86:87]
MV 124,a,184,v,40
v_cndmask_b32_e64 v82, v82, v14, s[88:89]
v_cndmask_b32_e64 v83, v83, v14, s[90:91]
MV 116,a,188,v,28
v_exp_f32 v188, v188
MV 124,a,188,v,44
s_xor_b32 s73, s73, 0x8000
v_exp_f32 v189, v189
v_add_u32 v247, 16, v13
v_cmp_gt_i32_e64 s[92:93], 0, v247
v_cmp_gt_i32_e64 s[94:95], 1, v247
v_cmp_gt_i32_e64 s[96:97], 2, v247
v_cmp_gt_i32_e64 s[98:99], 3, v247
v_cndmask_b32_e64 v88, v88, v14, s[92:93]
v_cvt_pk_bf16_f32 v185, v186, v187
v_cndmask_b32_e64 v89, v89, v14, s[94:95]
v_cndmask_b32_e64 v90, v90, v14, s[96:97]
v_cndmask_b32_e64 v91, v91, v14, s[98:99]
v_exp_f32 v190, v190
v_add_u32 v246, -16, v13
v_cmp_gt_i32_e64 s[84:85], 0, v246
v_cmp_gt_i32_e64 s[86:87], 1, v246
v_cmp_gt_i32_e64 s[88:89], 2, v246
v_exp_f32 v191, v191
v_cmp_gt_i32_e64 s[90:91], 3, v246
v_cndmask_b32_e64 v84, v84, v14, s[84:85]
v_cndmask_b32_e64 v85, v85, v14, s[86:87]
v_cndmask_b32_e64 v86, v86, v14, s[88:89]
v_cndmask_b32_e64 v87, v87, v14, s[90:91]
v_add_u32 v247, 0, v13
v_cmp_gt_i32_e64 s[92:93], 0, v247
v_cvt_pk_bf16_f32 v186, v188, v189
v_cmp_gt_i32_e64 s[94:95], 1, v247
v_cmp_gt_i32_e64 s[96:97], 2, v247
v_cmp_gt_i32_e64 s[98:99], 3, v247
v_cndmask_b32_e64 v92, v92, v14, s[92:93]
v_cvt_pk_bf16_f32 v187, v190, v191
v_cndmask_b32_e64 v93, v93, v14, s[94:95]
v_cndmask_b32_e64 v94, v94, v14, s[96:97]
v_cndmask_b32_e64 v95, v95, v14, s[98:99]
s_waitcnt vmcnt(16) lgkmcnt(0)
MA 0,a,192,v,144
s_barrier
v_xor_b32 v10, 0x8000, v10
MA 32,a,192,v,152
s_add_u32 m0, s72, 16384
ds_read_b128 a[128:131], v10 offset:0
MA 4,a,196,v,144
v_exp_f32 v80, v80
MA 36,a,196,v,152
ds_read_b128 a[132:135], v10 offset:1024
buffer_load_dwordx4 v12, s[52:55], s71 offen offset:0 sc1 lds
MA 8,a,200,v,144
v_exp_f32 v81, v81
MA 40,a,200,v,152
ds_read_b128 a[136:139], v10 offset:2048
ds_read_b128 a[140:143], v10 offset:3072
MA 12,a,204,v,144
v_exp_f32 v82, v82
MA 44,a,204,v,152
v_add_u32 v246, -32, v13
v_cmp_gt_i32_e64 s[84:85], 0, v246
MV 164,v,160,v,144
v_exp_f32 v83, v83
MV 168,v,160,v,152
ds_read_b128 a[144:147], v10 offset:4096
v_cmp_gt_i32_e64 s[86:87], 1, v246
MA 16,a,208,v,144
buffer_load_dwordx4 v12, s[52:55], s71 offen offset:1024 sc1 lds
v_cvt_pk_bf16_f32 v80, v80, v81
MA 48,a,208,v,152
ds_read_b128 a[148:151], v10 offset:5120
v_cmp_gt_i32_e64 s[88:89], 2, v246
MA 20,a,212,v,144
v_exp_f32 v84, v84
MA 52,a,212,v,152
ds_read_b128 a[152:155], v10 offset:6144
v_cmp_gt_i32_e64 s[90:91], 3, v246
MA 24,a,216,v,144
v_cndmask_b32_e64 v112, v112, v14, s[84:85]
v_cndmask_b32_e64 v113, v113, v14, s[86:87]
MA 56,a,216,v,152
v_exp_f32 v85, v85
MA 28,a,220,v,144
ds_read_b128 a[156:159], v10 offset:7168
v_cndmask_b32_e64 v114, v114, v14, s[88:89]
MA 60,a,220,v,152
v_cvt_pk_bf16_f32 v81, v82, v83
v_cndmask_b32_e64 v115, v115, v14, s[90:91]
MA 0,a,224,v,176
ds_read_b128 a[160:163], v10 offset:8192
v_add_u32 v247, -16, v13
MA 32,a,224,v,184
v_exp_f32 v86, v86
MA 4,a,228,v,176
ds_read_b128 a[164:167], v10 offset:9216
v_cmp_gt_i32_e64 s[92:93], 0, v247
MA 36,a,228,v,184
buffer_load_dwordx4 v12, s[52:55], s71 offen offset:2048 sc1 lds
v_cmp_gt_i32_e64 s[94:95], 1, v247
MA 8,a,232,v,176
v_exp_f32 v87, v87
MA 40,a,232,v,184
v_cvt_pk_bf16_f32 v82, v84, v85
v_cmp_gt_i32_e64 s[96:97], 2, v247
MA 12,a,236,v,176
ds_read_b128 a[168:171], v10 offset:10240
v_cmp_gt_i32_e64 s[98:99], 3, v247
MA 44,a,236,v,184
ds_read_b128 a[172:175], v10 offset:11264
v_cndmask_b32_e64 v120, v120, v14, s[92:93]
MV 164,v,160,v,176
v_exp_f32 v88, v88
MV 168,v,160,v,184
v_cndmask_b32_e64 v121, v121, v14, s[94:95]
v_cndmask_b32_e64 v122, v122, v14, s[96:97]
MA 16,a,240,v,176
v_exp_f32 v89, v89
MA 48,a,240,v,184
ds_read_b128 a[176:179], v10 offset:12288
v_cndmask_b32_e64 v123, v123, v14, s[98:99]
MA 20,a,244,v,176
v_cvt_pk_bf16_f32 v83, v86, v87
v_add_u32 v246, -48, v13
MA 52,a,244,v,184
ds_read_b128 a[180:183], v10 offset:13312
v_cmp_gt_i32_e64 s[84:85], 0, v246
MA 24,a,248,v,176
buffer_load_dwordx4 v12, s[52:55], s71 offen offset:3072 sc1 lds
v_cmp_gt_i32_e64 s[86:87], 1, v246
MA 56,a,248,v,184
v_exp_f32 v90, v90
MA 28,a,252,v,176
ds_read_b128 a[184:187], v10 offset:14336
v_cmp_gt_i32_e64 s[88:89], 2, v246
MA 60,a,252,v,184
ds_read_b128 a[188:191], v10 offset:15360
s_xor_b32 s72, s72, 0x8000
v_exp_f32 v91, v91
v_cmp_gt_i32_e64 s[90:91], 3, v246
v_cvt_pk_bf16_f32 v88, v88, v89
v_cndmask_b32_e64 v116, v116, v14, s[84:85]
v_exp_f32 v92, v92
v_cndmask_b32_e64 v117, v117, v14, s[86:87]
v_cndmask_b32_e64 v118, v118, v14, s[88:89]
v_cndmask_b32_e64 v119, v119, v14, s[90:91]
v_exp_f32 v93, v93
v_add_u32 v247, -32, v13
v_cvt_pk_bf16_f32 v89, v90, v91
v_cmp_gt_i32_e64 s[92:93], 0, v247
v_exp_f32 v94, v94
v_cmp_gt_i32_e64 s[94:95], 1, v247
v_cmp_gt_i32_e64 s[96:97], 2, v247
v_cmp_gt_i32_e64 s[98:99], 3, v247
v_exp_f32 v95, v95
v_cndmask_b32_e64 v124, v124, v14, s[92:93]
v_cndmask_b32_e64 v125, v125, v14, s[94:95]
v_cvt_pk_bf16_f32 v90, v92, v93
v_cndmask_b32_e64 v126, v126, v14, s[96:97]
v_cvt_pk_bf16_f32 v91, v94, v95
v_cndmask_b32_e64 v127, v127, v14, s[98:99]
L_p3_s0m_top:
s_waitcnt lgkmcnt(0)
v_mfma_f32_16x16x32_bf16 v[144:147], a[128:131], v[16:19], 0
s_add_u32 m0, s73, 0
ds_read_b128 a[192:195], v11 offset:16384
v_mfma_f32_16x16x32_bf16 v[152:155], a[128:131], v[32:35], 0
v_exp_f32 v112, v112
MV 144,a,132,v,20
ds_read_b128 a[196:199], v11 offset:17408
buffer_load_dwordx4 v12, s[56:59], s71 offen offset:0 sc1 lds
MV 152,a,132,v,36
v_exp_f32 v113, v113
MV 144,a,136,v,24
ds_read_b128 a[200:203], v11 offset:18432
ds_read_b128 a[204:207], v11 offset:19456
MV 152,a,136,v,40
v_exp_f32 v114, v114
MV 144,a,140,v,28
v_exp_f32 v115, v115
MV 152,a,140,v,44
ds_read_b128 a[208:211], v11 offset:20480
v_cvt_pk_bf16_f32 v112, v112, v113
v_mfma_f32_16x16x32_bf16 v[148:151], a[144:147], v[16:19], 0
ds_read_b128 a[212:215], v11 offset:21504
buffer_load_dwordx4 v12, s[56:59], s71 offen offset:1024 sc1 lds
v_mfma_f32_16x16x32_bf16 v[156:159], a[144:147], v[32:35], 0
v_exp_f32 v116, v116
MV 148,a,148,v,20
v_exp_f32 v117, v117
MV 156,a,148,v,36
ds_read_b128 a[216:219], v11 offset:22528
ds_read_b128 a[220:223], v11 offset:23552
MV 148,a,152,v,24
ds_read_b128 a[224:227], v11 offset:24576
v_cvt_pk_bf16_f32 v113, v114, v115
MV 156,a,152,v,40
v_exp_f32 v118, v118
MV 148,a,156,v,28
v_exp_f32 v119, v119
MV 156,a,156,v,44
ds_read_b128 a[228:231], v11 offset:25600
buffer_load_dwordx4 v12, s[56:59], s71 offen offset:2048 sc1 lds
v_mfma_f32_16x16x32_bf16 v[176:179], a[160:163], v[16:19], 0
ds_read_b128 a[232:235], v11 offset:26624
v_cvt_pk_bf16_f32 v114, v116, v117
v_mfma_f32_16x16x32_bf16 v[184:187], a[160:163], v[32:35], 0
v_exp_f32 v120, v120
MV 176,a,164,v,20
ds_read_b128 a[236:239], v11 offset:27648
ds_read_b128 a[240:243], v11 offset:28672
MV 184,a,164,v,36
v_exp_f32 v121, v121
MV 176,a,168,v,24
ds_read_b128 a[244:247], v11 offset:29696
v_cvt_pk_bf16_f32 v115, v118, v119
MV 184,a,168,v,40
ds_read_b128 a[248:251], v11 offset:30720
buffer_load_dwordx4 v12, s[56:59], s71 offen offset:3072 sc1 lds
MV 176,a,172,v,28
v_exp_f32 v122, v122
MV 184,a,172,v,44
v_exp_f32 v123, v123
v_mfma_f32_16x16x32_bf16 v[180:183], a[176:179], v[16:19], 0
ds_read_b128 a[252:255], v11 offset:31744
v_cvt_pk_bf16_f32 v120, v120, v121
v_mfma_f32_16x16x32_bf16 v[188:191], a[176:179], v[32:35], 0
v_add_u32 v246, -64, v13
v_cmp_gt_i32_e64 s[84:85], 0, v246
MV 180,a,180,v,20
v_cmp_gt_i32_e64 s[86:87], 1, v246
v_cmp_gt_i32_e64 s[88:89], 2, v246
MV 188,a,180,v,36
v_cmp_gt_i32_e64 s[90:91], 3, v246
v_cndmask_b32_e64 v144, v144, v14, s[84:85]
MV 180,a,184,v,24
v_cndmask_b32_e64 v145, v145, v14, s[86:87]
v_cndmask_b32_e64 v146, v146, v14, s[88:89]
MV 188,a,184,v,40
v_exp_f32 v124, v124
MV 180,a,188,v,28
v_cndmask_b32_e64 v147, v147, v14, s[90:91]
v_add_u32 v247, -48, v13
MV 188,a,188,v,44
s_add_u32 s71, s71, 16384
v_exp_f32 v125, v125
v_cmp_gt_i32_e64 s[92:93], 0, v247
v_cmp_gt_i32_e64 s[94:95], 1, v247
v_cmp_gt_i32_e64 s[96:97], 2, v247
v_cmp_gt_i32_e64 s[98:99], 3, v247
v_cndmask_b32_e64 v152, v152, v14, s[92:93]
v_cvt_pk_bf16_f32 v121, v122, v123
v_cndmask_b32_e64 v153, v153, v14, s[94:95]
v_cndmask_b32_e64 v154, v154, v14, s[96:97]
v_cndmask_b32_e64 v155, v155, v14, s[98:99]
v_exp_f32 v126, v126
v_add_u32 v246, -80, v13
v_cmp_gt_i32_e64 s[84:85], 0, v246
v_cmp_gt_i32_e64 s[86:87], 1, v246
v_cmp_gt_i32_e64 s[88:89], 2, v246
v_exp_f32 v127, v127
v_cmp_gt_i32_e64 s[90:91], 3, v246
v_cndmask_b32_e64 v148, v148, v14, s[84:85]
v_cndmask_b32_e64 v149, v149, v14, s[86:87]
v_cndmask_b32_e64 v150, v150, v14, s[88:89]
v_cndmask_b32_e64 v151, v151, v14, s[90:91]
v_add_u32 v247, -64, v13
v_cmp_gt_i32_e64 s[92:93], 0, v247
v_cvt_pk_bf16_f32 v122, v124, v125
v_cmp_gt_i32_e64 s[94:95], 1, v247
v_cmp_gt_i32_e64 s[96:97], 2, v247
v_cmp_gt_i32_e64 s[98:99], 3, v247
v_cndmask_b32_e64 v156, v156, v14, s[92:93]
v_cvt_pk_bf16_f32 v123, v126, v127
v_cndmask_b32_e64 v157, v157, v14, s[94:95]
v_cndmask_b32_e64 v158, v158, v14, s[96:97]
v_cndmask_b32_e64 v159, v159, v14, s[98:99]
s_waitcnt vmcnt(16) lgkmcnt(0)
MA 0,a,192,v,80
s_barrier
MA 32,a,192,v,88
s_add_u32 m0, s72, 0
ds_read_b128 a[128:131], v10 offset:16384
MA 4,a,196,v,80
v_exp_f32 v144, v144
MA 36,a,196,v,88
ds_read_b128 a[132:135], v10 offset:17408
buffer_load_dwordx4 v12, s[52:55], s71 offen offset:0 sc1 lds
MA 8,a,200,v,80
v_exp_f32 v145, v145
MA 40,a,200,v,88
ds_read_b128 a[136:139], v10 offset:18432
ds_read_b128 a[140:143], v10 offset:19456
MA 12,a,204,v,80
v_exp_f32 v146, v146
MA 44,a,204,v,88
buffer_load_dwordx4 v12, s[52:55], s71 offen offset:1024 sc1 lds
v_add_u32 v246, -96, v13
MV 164,v,160,v,80
ds_read_b128 a[144:147], v10 offset:20480
v_cmp_gt_i32_e64 s[84:85], 0, v246
MV 168,v,160,v,88
v_exp_f32 v147, v147
MA 16,a,208,v,80
buffer_load_dwordx4 v12, s[52:55], s71 offen offset:2048 sc1 lds
v_cmp_gt_i32_e64 s[86:87], 1, v246
MA 48,a,208,v,88
v_cvt_pk_bf16_f32 v144, v144, v145
v_cmp_gt_i32_e64 s[88:89], 2, v246
MA 20,a,212,v,80
v_exp_f32 v148, v148
MA 52,a,212,v,88
ds_read_b128 a[148:151], v10 offset:21504
v_cmp_gt_i32_e64 s[90:91], 3, v246
MA 24,a,216,v,80
ds_read_b128 a[152:155], v10 offset:22528
v_cndmask_b32_e64 v176, v176, v14, s[84:85]
MA 56,a,216,v,88
v_exp_f32 v149, v149
MA 28,a,220,v,80
buffer_load_dwordx4 v12, s[52:55], s71 offen offset:3072 sc1 lds
v_cndmask_b32_e64 v177, v177, v14, s[86:87]
MA 60,a,220,v,88
ds_read_b128 a[156:159], v10 offset:23552
v_cndmask_b32_e64 v178, v178, v14, s[88:89]
MA 0,a,224,v,112
v_cvt_pk_bf16_f32 v145, v146, v147
v_cndmask_b32_e64 v179, v179, v14, s[90:91]
MA 32,a,224,v,120
ds_read_b128 a[160:163], v10 offset:24576
v_add_u32 v247, -80, v13
MA 4,a,228,v,112
v_exp_f32 v150, v150
MA 36,a,228,v,120
v_lshlrev_b32 v245, 4, v1
v_cmp_gt_i32_e64 s[92:93], 0, v247
MA 8,a,232,v,112
ds_read_b128 a[164:167], v10 offset:25600
v_cmp_gt_i32_e64 s[94:95], 1, v247
MA 40,a,232,v,120
v_exp_f32 v151, v151
MA 12,a,236,v,112
v_cvt_pk_bf16_f32 v146, v148, v149
v_cmp_gt_i32_e64 s[96:97], 2, v247
MA 44,a,236,v,120
ds_read_b128 a[168:171], v10 offset:26624
v_cmp_gt_i32_e64 s[98:99], 3, v247
MV 164,v,160,v,112
s_mov_b32 m0, s43
v_cndmask_b32_e64 v184, v184, v14, s[92:93]
MV 168,v,160,v,120
v_exp_f32 v152, v152
MA 16,a,240,v,112
ds_read_b128 a[172:175], v10 offset:27648
v_cndmask_b32_e64 v185, v185, v14, s[94:95]
MA 48,a,240,v,120
ds_read_b128 a[176:179], v10 offset:28672
v_cndmask_b32_e64 v186, v186, v14, s[96:97]
MA 20,a,244,v,112
v_exp_f32 v153, v153
MA 52,a,244,v,120
s_nop 0
v_cndmask_b32_e64 v187, v187, v14, s[98:99]
MA 24,a,248,v,112
v_cvt_pk_bf16_f32 v147, v150, v151
v_add_u32 v246, -112, v13
MA 56,a,248,v,120
ds_read_b128 a[180:183], v10 offset:29696
v_cmp_gt_i32_e64 s[84:85], 0, v246
MA 28,a,252,v,112
ds_read_b128 a[184:187], v10 offset:30720
v_cmp_gt_i32_e64 s[86:87], 1, v246
MA 60,a,252,v,120
ds_read_b128 a[188:191], v10 offset:31744
buffer_load_dwordx4 v245, s[20:23], 0 offen offset:0 sc1 lds
buffer_load_dwordx4 v245, s[20:23], 0 offen offset:1024 sc1 lds
buffer_load_dwordx4 v245, s[20:23], 0 offen offset:2048 sc1 lds
buffer_load_dwordx4 v245, s[20:23], 0 offen offset:3072 sc1 lds
v_exp_f32 v154, v154
v_exp_f32 v155, v155
v_cmp_gt_i32_e64 s[88:89], 2, v246
v_cmp_gt_i32_e64 s[90:91], 3, v246
v_cvt_pk_bf16_f32 v152, v152, v153
v_cndmask_b32_e64 v180, v180, v14, s[84:85]
v_exp_f32 v156, v156
v_cndmask_b32_e64 v181, v181, v14, s[86:87]
v_cndmask_b32_e64 v182, v182, v14, s[88:89]
v_cndmask_b32_e64 v183, v183, v14, s[90:91]
v_exp_f32 v157, v157
v_add_u32 v247, -96, v13
v_cvt_pk_bf16_f32 v153, v154, v155
v_cmp_gt_i32_e64 s[92:93], 0, v247
v_exp_f32 v158, v158
v_cmp_gt_i32_e64 s[94:95], 1, v247
v_cmp_gt_i32_e64 s[96:97], 2, v247
v_cmp_gt_i32_e64 s[98:99], 3, v247
v_exp_f32 v159, v159
v_cndmask_b32_e64 v188, v188, v14, s[92:93]
v_cndmask_b32_e64 v189, v189, v14, s[94:95]
v_cvt_pk_bf16_f32 v154, v156, v157
v_cndmask_b32_e64 v190, v190, v14, s[96:97]
v_cvt_pk_bf16_f32 v155, v158, v159
v_cndmask_b32_e64 v191, v191, v14, s[98:99]
s_load_dwordx2 s[88:89], s[0:1], 104
s_waitcnt lgkmcnt(0)
v_xor_b32 v11, 0x8000, v11
ds_read_b128 a[192:195], v11 offset:0
ds_read_b128 a[196:199], v11 offset:1024
ds_read_b128 a[200:203], v11 offset:2048
ds_read_b128 a[204:207], v11 offset:3072
ds_read_b128 a[208:211], v11 offset:4096
ds_read_b128 a[212:215], v11 offset:5120
ds_read_b128 a[216:219], v11 offset:6144
ds_read_b128 a[220:223], v11 offset:7168
ds_read_b128 a[224:227], v11 offset:8192
ds_read_b128 a[228:231], v11 offset:9216
ds_read_b128 a[232:235], v11 offset:10240
ds_read_b128 a[236:239], v11 offset:11264
ds_read_b128 a[240:243], v11 offset:12288
ds_read_b128 a[244:247], v11 offset:13312
ds_read_b128 a[248:251], v11 offset:14336
ds_read_b128 a[252:255], v11 offset:15360
v_exp_f32 v176, v176
v_exp_f32 v177, v177
v_exp_f32 v178, v178
v_exp_f32 v179, v179
v_cvt_pk_bf16_f32 v176, v176, v177
v_exp_f32 v180, v180
v_exp_f32 v181, v181
v_cvt_pk_bf16_f32 v177, v178, v179
v_exp_f32 v182, v182
v_exp_f32 v183, v183
v_cvt_pk_bf16_f32 v178, v180, v181
v_exp_f32 v184, v184
v_exp_f32 v185, v185
v_cvt_pk_bf16_f32 v179, v182, v183
v_exp_f32 v186, v186
v_exp_f32 v187, v187
v_cvt_pk_bf16_f32 v184, v184, v185
v_exp_f32 v188, v188
v_exp_f32 v189, v189
v_cvt_pk_bf16_f32 v185, v186, v187
v_exp_f32 v190, v190
v_exp_f32 v191, v191
v_cvt_pk_bf16_f32 v186, v188, v189
v_cvt_pk_bf16_f32 v187, v190, v191
MV 164,v,160,v,144
MV 168,v,160,v,152
MV 164,v,160,v,176
MV 168,v,160,v,184
v_mov_b32 v240, v2
v_mov_b32 v241, v3
s_nop 0
v_permlane32_swap_b32 v2, v240
v_permlane32_swap_b32 v3, v241
v_add_f32 v2, v2, v240
v_add_f32 v3, v3, v241
v_mov_b32 v240, v2
v_mov_b32 v241, v3
s_nop 0
v_permlane16_swap_b32 v2, v240
v_permlane16_swap_b32 v3, v241
v_add_f32 v2, v2, v240
v_add_f32 v3, v3, v241
v_add_f32 v2, v2, v164
v_add_f32 v3, v3, v168
v_min_f32 v240, v2, v3
v_add_f32 v241, v2, v3
v_cmp_nle_f32 vcc, 0x30800000, v240
s_nop 0
s_or_b64 s[78:79], s[78:79], vcc
v_cmp_nge_f32 vcc, 0x4e800000, v241
s_nop 0
s_or_b64 s[78:79], s[78:79], vcc
s_cmp_lg_u64 s[78:79], 0
s_cselect_b32 s80, 1, 0
v_mov_b32 v240, s80
s_lshl_b32 s80, s3, 2
s_add_u32 s80, s80, 163824
v_mov_b32 v241, s80
ds_write_b32 v241, v240
v_mov_b32 v241, 163824
s_waitcnt vmcnt(0) lgkmcnt(0)
s_barrier
ds_read_b128 v[244:247], v241
buffer_store_dword v237, v236, s[8:11], s37 offen offset:1024 sc1
MA 0,a,192,v,144
MA 32,a,192,v,152
MA 4,a,196,v,144
MA 36,a,196,v,152
MA 8,a,200,v,144
MA 40,a,200,v,152
s_waitcnt lgkmcnt(0)
v_or3_b32 v240, v244, v245, v246
v_or_b32 v240, v240, v247
MA 12,a,204,v,144
v_cmp_ne_u32 vcc, 0, v240
MA 44,a,204,v,152
MA 16,a,208,v,144
s_cbranch_vccnz L_fallback
MA 48,a,208,v,152
s_mul_i32 s36, s3, 16640
v_and_b32 v16, 15, v1
MA 20,a,212,v,144
v_lshrrev_b32 v17, 4, v1
v_add_u32 v18, 13, v16
MA 52,a,212,v,152
v_and_b32 v19, 3, v18
v_cmp_eq_u32 vcc, 0, v19
MA 24,a,216,v,144
v_lshrrev_b32 v18, 2, v18
v_mul_u32_u24 v19, 4160, v19
MA 56,a,216,v,152
v_cndmask_b32 v19, v19, 8, vcc
v_lshl_add_u32 v19, v18, 3, v19
MA 28,a,220,v,144
v_lshl_add_u32 v19, v17, 4, v19
v_add_u32 v4, s36, v19
MA 60,a,220,v,152
v_add_u32 v10, s36, v232
v_lshlrev_b32 v18, 5, v16
MA 0,a,224,v,176
v_lshlrev_b32 v19, 4, v17
v_sub_u32 v19, v19, v18
MA 32,a,224,v,184
s_add_u32 s37, s43, 480
v_add_u32 v5, s37, v19
MA 4,a,228,v,176
v_mul_u32_u24 v18, 136, v16
v_lshl_add_u32 v18, v17, 5, v18
MA 36,a,228,v,184
s_lshl_b32 s37, s3, 1
s_add_u32 s37, s37, 49152
MA 8,a,232,v,176
v_add_u32 v11, s37, v18
v_lshrrev_b32 v18, 3, v1
MA 40,a,232,v,184
v_mul_u32_u24 v18, 136, v18
v_and_b32 v19, 7, v1
MA 12,a,236,v,176
v_lshl_add_u32 v18, v19, 4, v18
s_mul_i32 s37, s3, 4352
MA 44,a,236,v,184
s_add_u32 s37, s37, 49152
v_add_u32 v12, s37, v18
MA 16,a,240,v,176
s_lshl_b32 s37, s3, 12
v_add_u32 v13, s37, v232
MA 48,a,240,v,184
v_lshl_add_u32 v18, v17, 3, v16
v_sub_u32 v235, 15, v18
MA 20,a,244,v,176
v_mov_b32 v20, 0
v_mov_b32 v21, 0
MA 52,a,244,v,184
v_mov_b32 v22, 0
v_mov_b32 v23, 0
MA 24,a,248,v,176
v_and_b32 v16, 3, v1
v_mul_u32_u24 v16, 4160, v16
MA 56,a,248,v,184
v_lshrrev_b32 v17, 2, v1
v_min_u32 v17, 3, v17
MA 28,a,252,v,176
v_lshl_add_u32 v16, v17, 4, v16
v_add_u32 v16, s36, v16
MA 60,a,252,v,184
ds_write_b128 v16, v[20:23]
v_and_b32 v17, 31, v1
v_lshlrev_b32 v17, 4, v17
v_add_u32 v17, s43, v17
ds_write_b128 v17, v[20:23] offset:4096
v_alignbit_b32 v24, v209, v208, 16
v_alignbit_b32 v25, v210, v209, 16
v_alignbit_b32 v26, v211, v210, 16
v_alignbit_b32 v27, v212, v211, 16
v_alignbit_b32 v28, v213, v212, 16
ds_write_b128 v10, v[210:213] offset:64
ds_write_b128 v10, v[24:27] offset:4208
v_mov_b32 v16, v209
v_mov_b32 v17, v210
v_mov_b32 v18, v211
v_mov_b32 v19, v212
ds_write_b128 v10, v[16:19] offset:8368
v_mov_b32 v16, v25
v_mov_b32 v17, v26
v_mov_b32 v18, v27
v_mov_b32 v19, v28
ds_write_b128 v10, v[16:19] offset:12528
v_alignbit_b32 v30, v215, v214, 16
v_alignbit_b32 v31, v216, v215, 16
v_alignbit_b32 v32, v217, v216, 16
v_alignbit_b32 v33, v218, v217, 16
v_alignbit_b32 v34, v219, v218, 16
ds_write_b128 v10, v[216:219] offset:1088
ds_write_b128 v10, v[30:33] offset:5232
v_mov_b32 v16, v215
v_mov_b32 v17, v216
v_mov_b32 v18, v217
v_mov_b32 v19, v218
ds_write_b128 v10, v[16:19] offset:9392
v_mov_b32 v16, v31
v_mov_b32 v17, v32
v_mov_b32 v18, v33
v_mov_b32 v19, v34
ds_write_b128 v10, v[16:19] offset:13552
v_alignbit_b32 v24, v221, v220, 16
v_alignbit_b32 v25, v222, v221, 16
v_alignbit_b32 v26, v223, v222, 16
v_alignbit_b32 v27, v224, v223, 16
v_alignbit_b32 v28, v225, v224, 16
ds_write_b128 v10, v[222:225] offset:2112
ds_write_b128 v10, v[24:27] offset:6256
v_mov_b32 v16, v221
v_mov_b32 v17, v222
v_mov_b32 v18, v223
v_mov_b32 v19, v224
ds_write_b128 v10, v[16:19] offset:10416
v_mov_b32 v16, v25
v_mov_b32 v17, v26
v_mov_b32 v18, v27
v_mov_b32 v19, v28
ds_write_b128 v10, v[16:19] offset:14576
v_alignbit_b32 v30, v227, v226, 16
v_alignbit_b32 v31, v228, v227, 16
v_alignbit_b32 v32, v229, v228, 16
v_alignbit_b32 v33, v230, v229, 16
v_alignbit_b32 v34, v231, v230, 16
ds_write_b128 v10, v[228:231] offset:3136
ds_write_b128 v10, v[30:33] offset:7280
v_mov_b32 v16, v227
v_mov_b32 v17, v228
v_mov_b32 v18, v229
v_mov_b32 v19, v230
ds_write_b128 v10, v[16:19] offset:11440
v_mov_b32 v16, v31
v_mov_b32 v17, v32
v_mov_b32 v18, v33
v_mov_b32 v19, v34
ds_write_b128 v10, v[16:19] offset:15600
v_lshlrev_b32 v16, 16, v234
v_cmp_eq_u32 vcc, 0, v235
s_nop 1
v_cndmask_b32 v44, 0, v234, vcc
v_cmp_eq_u32 vcc, 1, v235
s_nop 1
v_cndmask_b32 v44, v44, v16, vcc
v_cmp_eq_u32 vcc, 2, v235
s_nop 1
v_cndmask_b32 v45, 0, v234, vcc
v_cmp_eq_u32 vcc, 3, v235
s_nop 1
v_cndmask_b32 v45, v45, v16, vcc
v_cmp_eq_u32 vcc, 4, v235
s_nop 1
v_cndmask_b32 v46, 0, v234, vcc
v_cmp_eq_u32 vcc, 5, v235
s_nop 1
v_cndmask_b32 v46, v46, v16, vcc
v_cmp_eq_u32 vcc, 6, v235
s_nop 1
v_cndmask_b32 v47, 0, v234, vcc
v_cmp_eq_u32 vcc, 7, v235
s_nop 1
v_cndmask_b32 v47, v47, v16, vcc
v_rcp_f32 v2, v2
v_rcp_f32 v3, v3
s_add_u32 s80, s100, 0x20000
s_nop 4
v_accvgpr_read_b32 v240, a0
v_accvgpr_read_b32 v241, a1
v_accvgpr_read_b32 v242, a2
v_accvgpr_read_b32 v243, a3
v_accvgpr_read_b32 v244, a4
v_accvgpr_read_b32 v245, a5
v_accvgpr_read_b32 v246, a6
v_accvgpr_read_b32 v247, a7
v_mul_f32 v240, v240, v2
v_mul_f32 v241, v241, v2
v_mul_f32 v242, v242, v2
v_mul_f32 v243, v243, v2
v_mul_f32 v244, v244, v2
v_mul_f32 v245, v245, v2
v_mul_f32 v246, v246, v2
v_mul_f32 v247, v247, v2
v_cvt_pk_bf16_f32 v248, v240, v241
v_cvt_pk_bf16_f32 v249, v242, v243
v_cvt_pk_bf16_f32 v250, v244, v245
v_cvt_pk_bf16_f32 v251, v246, v247
buffer_store_dwordx4 v[248:251], v15, s[60:63], s100 offen offset:0 sc1
v_accvgpr_read_b32 v240, a8
v_accvgpr_read_b32 v241, a9
v_accvgpr_read_b32 v242, a10
v_accvgpr_read_b32 v243, a11
v_accvgpr_read_b32 v244, a12
v_accvgpr_read_b32 v245, a13
v_accvgpr_read_b32 v246, a14
v_accvgpr_read_b32 v247, a15
v_mul_f32 v240, v240, v2
v_mul_f32 v241, v241, v2
v_mul_f32 v242, v242, v2
v_mul_f32 v243, v243, v2
v_mul_f32 v244, v244, v2
v_mul_f32 v245, v245, v2
v_mul_f32 v246, v246, v2
v_mul_f32 v247, v247, v2
v_cvt_pk_bf16_f32 v252, v240, v241
v_cvt_pk_bf16_f32 v253, v242, v243
v_cvt_pk_bf16_f32 v254, v244, v245
v_cvt_pk_bf16_f32 v255, v246, v247
buffer_store_dwordx4 v[252:255], v15, s[60:63], s100 offen offset:1024 sc1
v_accvgpr_read_b32 v240, a16
v_accvgpr_read_b32 v241, a17
v_accvgpr_read_b32 v242, a18
v_accvgpr_read_b32 v243, a19
v_accvgpr_read_b32 v244, a20
v_accvgpr_read_b32 v245, a21
v_accvgpr_read_b32 v246, a22
v_accvgpr_read_b32 v247, a23
v_mul_f32 v240, v240, v2
v_mul_f32 v241, v241, v2
v_mul_f32 v242, v242, v2
v_mul_f32 v243, v243, v2
v_mul_f32 v244, v244, v2
v_mul_f32 v245, v245, v2
v_mul_f32 v246, v246, v2
v_mul_f32 v247, v247, v2
v_cvt_pk_bf16_f32 v248, v240, v241
v_cvt_pk_bf16_f32 v249, v242, v243
v_cvt_pk_bf16_f32 v250, v244, v245
v_cvt_pk_bf16_f32 v251, v246, v247
buffer_store_dwordx4 v[248:251], v15, s[60:63], s100 offen offset:2048 sc1
v_accvgpr_read_b32 v240, a24
v_accvgpr_read_b32 v241, a25
v_accvgpr_read_b32 v242, a26
v_accvgpr_read_b32 v243, a27
v_accvgpr_read_b32 v244, a28
v_accvgpr_read_b32 v245, a29
v_accvgpr_read_b32 v246, a30
v_accvgpr_read_b32 v247, a31
v_mul_f32 v240, v240, v2
v_mul_f32 v241, v241, v2
v_mul_f32 v242, v242, v2
v_mul_f32 v243, v243, v2
v_mul_f32 v244, v244, v2
v_mul_f32 v245, v245, v2
v_mul_f32 v246, v246, v2
v_mul_f32 v247, v247, v2
v_cvt_pk_bf16_f32 v252, v240, v241
v_cvt_pk_bf16_f32 v253, v242, v243
v_cvt_pk_bf16_f32 v254, v244, v245
v_cvt_pk_bf16_f32 v255, v246, v247
buffer_store_dwordx4 v[252:255], v15, s[60:63], s100 offen offset:3072 sc1
v_accvgpr_read_b32 v240, a32
v_accvgpr_read_b32 v241, a33
v_accvgpr_read_b32 v242, a34
v_accvgpr_read_b32 v243, a35
v_accvgpr_read_b32 v244, a36
v_accvgpr_read_b32 v245, a37
v_accvgpr_read_b32 v246, a38
v_accvgpr_read_b32 v247, a39
v_mul_f32 v240, v240, v3
v_mul_f32 v241, v241, v3
v_mul_f32 v242, v242, v3
v_mul_f32 v243, v243, v3
v_mul_f32 v244, v244, v3
v_mul_f32 v245, v245, v3
v_mul_f32 v246, v246, v3
v_mul_f32 v247, v247, v3
v_cvt_pk_bf16_f32 v248, v240, v241
v_cvt_pk_bf16_f32 v249, v242, v243
v_cvt_pk_bf16_f32 v250, v244, v245
v_cvt_pk_bf16_f32 v251, v246, v247
buffer_store_dwordx4 v[248:251], v15, s[60:63], s80 offen offset:0 sc1
v_accvgpr_read_b32 v240, a40
v_accvgpr_read_b32 v241, a41
v_accvgpr_read_b32 v242, a42
v_accvgpr_read_b32 v243, a43
v_accvgpr_read_b32 v244, a44
v_accvgpr_read_b32 v245, a45
v_accvgpr_read_b32 v246, a46
v_accvgpr_read_b32 v247, a47
v_mul_f32 v240, v240, v3
v_mul_f32 v241, v241, v3
v_mul_f32 v242, v242, v3
v_mul_f32 v243, v243, v3
v_mul_f32 v244, v244, v3
v_mul_f32 v245, v245, v3
v_mul_f32 v246, v246, v3
v_mul_f32 v247, v247, v3
v_cvt_pk_bf16_f32 v252, v240, v241
v_cvt_pk_bf16_f32 v253, v242, v243
v_cvt_pk_bf16_f32 v254, v244, v245
v_cvt_pk_bf16_f32 v255, v246, v247
buffer_store_dwordx4 v[252:255], v15, s[60:63], s80 offen offset:1024 sc1
v_accvgpr_read_b32 v240, a48
v_accvgpr_read_b32 v241, a49
v_accvgpr_read_b32 v242, a50
v_accvgpr_read_b32 v243, a51
v_accvgpr_read_b32 v244, a52
v_accvgpr_read_b32 v245, a53
v_accvgpr_read_b32 v246, a54
v_accvgpr_read_b32 v247, a55
v_mul_f32 v240, v240, v3
v_mul_f32 v241, v241, v3
v_mul_f32 v242, v242, v3
v_mul_f32 v243, v243, v3
v_mul_f32 v244, v244, v3
v_mul_f32 v245, v245, v3
v_mul_f32 v246, v246, v3
v_mul_f32 v247, v247, v3
v_cvt_pk_bf16_f32 v248, v240, v241
v_cvt_pk_bf16_f32 v249, v242, v243
v_cvt_pk_bf16_f32 v250, v244, v245
v_cvt_pk_bf16_f32 v251, v246, v247
buffer_store_dwordx4 v[248:251], v15, s[60:63], s80 offen offset:2048 sc1
v_accvgpr_read_b32 v240, a56
v_accvgpr_read_b32 v241, a57
v_accvgpr_read_b32 v242, a58
v_accvgpr_read_b32 v243, a59
v_accvgpr_read_b32 v244, a60
v_accvgpr_read_b32 v245, a61
v_accvgpr_read_b32 v246, a62
v_accvgpr_read_b32 v247, a63
v_mul_f32 v240, v240, v3
v_mul_f32 v241, v241, v3
v_mul_f32 v242, v242, v3
v_mul_f32 v243, v243, v3
v_mul_f32 v244, v244, v3
v_mul_f32 v245, v245, v3
v_mul_f32 v246, v246, v3
v_mul_f32 v247, v247, v3
v_cvt_pk_bf16_f32 v252, v240, v241
v_cvt_pk_bf16_f32 v253, v242, v243
v_cvt_pk_bf16_f32 v254, v244, v245
v_cvt_pk_bf16_f32 v255, v246, v247
buffer_store_dwordx4 v[252:255], v15, s[60:63], s80 offen offset:3072 sc1
L_p3_done:
s_waitcnt lgkmcnt(0)
ds_read_b128 a[160:163], v5 offset:3584
ds_read_b64 a[128:129], v4 offset:0
ds_read_b64 a[130:131], v4 offset:8
ds_read_b128 a[164:167], v5 offset:3072
ds_read_b64 a[132:133], v4 offset:512
ds_read_b64 a[134:135], v4 offset:520
ds_read_b128 a[168:171], v5 offset:2560
ds_read_b64 a[136:137], v4 offset:1024
ds_read_b64 a[138:139], v4 offset:1032
ds_read_b128 a[172:175], v5 offset:2048
ds_read_b64 a[140:141], v4 offset:1536
ds_read_b64 a[142:143], v4 offset:1544
ds_read_b128 a[176:179], v5 offset:1536
ds_read_b64 a[144:145], v4 offset:2048
ds_read_b64 a[146:147], v4 offset:2056
ds_read_b128 a[180:183], v5 offset:1024
ds_read_b64 a[148:149], v4 offset:2560
ds_read_b64 a[150:151], v4 offset:2568
ds_read_b128 a[184:187], v5 offset:512
ds_read_b64 a[152:153], v4 offset:3072
ds_read_b64 a[154:155], v4 offset:3080
ds_read_b128 a[188:191], v5 offset:0
ds_read_b64 a[156:157], v4 offset:3584
ds_read_b64 a[158:159], v4 offset:3592
v_lshlrev_b32 v255, 20, v1
s_lshl_b32 s36, s3, 26
v_add_u32 v255, s36, v255
s_waitcnt lgkmcnt(15)
v_mfma_f32_16x16x32_bf16 v[76:79], a[128:131], a[160:163], 0
ds_read_b128 a[224:227], v5 offset:3648
s_and_b32 s81, s2, 3
v_mfma_f32_16x16x32_bf16 v[80:83], a[128:131], a[164:167], 0
ds_read_b64 a[192:193], v4 offset:64
s_lshl_b32 s81, s81, 1
v_mfma_f32_16x16x32_bf16 v[84:87], a[128:131], a[168:171], 0
ds_read_b64 a[194:195], v4 offset:72
s_sub_u32 s74, 14, s81
s_waitcnt lgkmcnt(15)
v_mfma_f32_16x16x32_bf16 v[88:91], a[128:131], a[172:175], 0
ds_read_b128 a[228:231], v5 offset:3136
s_waitcnt lgkmcnt(15)
v_mfma_f32_16x16x32_bf16 v[92:95], a[128:131], a[176:179], 0
s_bitcmp1_b32 s2, 4
s_cselect_b32 s81, s74, s81
s_waitcnt lgkmcnt(12)
v_mfma_f32_16x16x32_bf16 v[96:99], a[128:131], a[180:183], 0
ds_read_b64 a[196:197], v4 offset:576
s_waitcnt lgkmcnt(10)
v_mfma_f32_16x16x32_bf16 v[100:103], a[128:131], a[184:187], 0
ds_read_b64 a[198:199], v4 offset:584
s_waitcnt lgkmcnt(8)
v_mfma_f32_16x16x32_bf16 v[104:107], a[128:131], a[188:191], 0
ds_read_b128 a[232:235], v5 offset:2624
s_bfe_u32 s74, s2, 0x10003
MV 76,v,44,a,160
ds_read_b64 a[200:201], v4 offset:1088
s_add_u32 s81, s81, s74
MV 80,v,44,a,164
MV 84,v,44,a,168
ds_read_b64 a[202:203], v4 offset:1096
s_bfe_u32 s82, s2, 0x10002
MV 88,v,44,a,172
ds_read_b128 a[236:239], v5 offset:2112
s_lshr_b32 s74, s2, 5
MV 92,v,44,a,176
ds_read_b64 a[204:205], v4 offset:1600
s_lshl_b32 s74, s74, 1
MV 96,v,44,a,180
ds_read_b64 a[206:207], v4 offset:1608
MV 100,v,44,a,184
s_add_u32 s82, s82, s74
MV 104,v,44,a,188
ds_read_b128 a[240:243], v5 offset:1600
s_mov_b32 s72, s81
MV 80,a,132,a,160
ds_read_b64 a[208:209], v4 offset:2112
MV 84,a,132,a,164
ds_read_b64 a[210:211], v4 offset:2120
s_mov_b32 s73, s82
MV 88,a,132,a,168
ds_read_b128 a[244:247], v5 offset:1088
s_lshl_b32 s74, s72, 2
MV 92,a,132,a,172
MV 96,a,132,a,176
ds_read_b64 a[212:213], v4 offset:2624
s_add_u32 s74, s74, s3
MV 100,a,132,a,180
ds_read_b64 a[214:215], v4 offset:2632
s_lshl_b32 s68, s74, 18
MV 104,a,132,a,184
ds_read_b128 a[248:251], v5 offset:576
s_and_b32 s80, s73, 1
MV 84,a,136,a,160
ds_read_b64 a[216:217], v4 offset:3136
MV 88,a,136,a,164
s_lshl_b32 s75, s80, 16
MV 92,a,136,a,168
ds_read_b64 a[218:219], v4 offset:3144
s_add_u32 s68, s68, s75
MV 96,a,136,a,172
ds_read_b128 a[252:255], v5 offset:64
MV 100,a,136,a,176
ds_read_b64 a[220:221], v4 offset:3648
s_lshl_b32 s69, s73, 19
MV 104,a,136,a,180
ds_read_b64 a[222:223], v4 offset:3656
s_lshl_b32 s75, s73, 7
MV 88,a,140,a,160
MV 92,a,140,a,164
s_lshl_b32 s70, s3, 12
MV 96,a,140,a,168
s_lshl_b32 s78, s74, 16
MV 100,a,140,a,172
s_add_u32 s78, s78, s75
MV 104,a,140,a,176
MV 92,a,144,a,160
s_lshl_b32 s79, s73, 18
MV 96,a,144,a,164
s_lshl_b32 s75, s74, 8
MV 100,a,144,a,168
MV 104,a,144,a,172
s_add_u32 s79, s79, s75
MV 96,a,148,a,160
v_lshlrev_b32 v236, 4, v1
MV 100,a,148,a,164
MV 104,a,148,a,168
v_add_u32 v237, 0x20000, v236
MV 100,a,152,a,160
v_add_u32 v238, s70, v236
MV 104,a,152,a,164
s_waitcnt lgkmcnt(15)
MV 104,a,156,a,160
s_waitcnt vmcnt(0)
s_barrier
v_mov_b32 v253, 1
s_lshl_b32 s36, s2, 2
buffer_store_dword v253, v255, s[8:11], s36 offen offset:2048 sc1
MV 76,a,192,a,224
ds_read_b128 a[160:163], v5 offset:3712
s_lshl_b32 s75, s80, 12
MV 80,a,192,a,228
ds_read_b64 a[128:129], v4 offset:128
v_add_u32 v244, s75, v236
MV 84,a,192,a,232
ds_read_b64 a[130:131], v4 offset:136
v_xor_b32 v245, 0x1000, v244
s_waitcnt lgkmcnt(15)
MV 88,a,192,a,236
ds_read_b128 a[164:167], v5 offset:3200
v_add_u32 v242, 66560, v244
s_waitcnt lgkmcnt(15)
MV 92,a,192,a,240
v_add_u32 v243, 66560, v245
s_waitcnt lgkmcnt(12)
MV 96,a,192,a,244
ds_read_b64 a[132:133], v4 offset:640
v_bfe_u32 v38, v1, 4, 1
s_waitcnt lgkmcnt(10)
MV 100,a,192,a,248
ds_read_b64 a[134:135], v4 offset:648
v_lshrrev_b32 v40, 5, v1
s_waitcnt lgkmcnt(8)
MV 104,a,192,a,252
ds_read_b128 a[168:171], v5 offset:2688
v_and_b32 v36, 15, v1
MV 80,a,196,a,224
ds_read_b64 a[136:137], v4 offset:1152
v_lshlrev_b32 v41, 5, v38
MV 84,a,196,a,228
v_lshl_add_u32 v41, v40, 4, v41
MV 88,a,196,a,232
ds_read_b64 a[138:139], v4 offset:1160
v_lshl_add_u32 v250, v36, 11, v41
MV 92,a,196,a,236
ds_read_b128 a[172:175], v5 offset:2176
v_lshlrev_b32 v41, 11, v41
MV 96,a,196,a,240
ds_read_b64 a[140:141], v4 offset:1664
v_lshl_add_u32 v251, v36, 3, v41
MV 100,a,196,a,244
ds_read_b64 a[142:143], v4 offset:1672
MV 104,a,196,a,248
s_add_u32 s44, s40, 33554432
s_addc_u32 s45, s41, 0
MV 84,a,200,a,224
ds_read_b128 a[176:179], v5 offset:1664
s_mov_b32 s46, 16777216
MV 88,a,200,a,228
ds_read_b64 a[144:145], v4 offset:2176
s_mov_b32 s47, 0x20000
MV 92,a,200,a,232
ds_read_b64 a[146:147], v4 offset:2184
MV 96,a,200,a,236
ds_read_b128 a[180:183], v5 offset:1152
MV 100,a,200,a,240
s_add_u32 s48, s40, 100663296
s_addc_u32 s49, s41, 0
MV 104,a,200,a,244
ds_read_b64 a[148:149], v4 offset:2688
s_mov_b32 s50, 8388608
MV 88,a,204,a,224
ds_read_b64 a[150:151], v4 offset:2696
s_mov_b32 s51, 0x20000
MV 92,a,204,a,228
ds_read_b128 a[184:187], v5 offset:640
MV 96,a,204,a,232
ds_read_b64 a[152:153], v4 offset:3200
MV 100,a,204,a,236
s_add_u32 s52, s40, 109051904
s_addc_u32 s53, s41, 0
MV 104,a,204,a,240
ds_read_b64 a[154:155], v4 offset:3208
s_mov_b32 s54, 4194304
MV 92,a,208,a,224
ds_read_b128 a[188:191], v5 offset:128
s_mov_b32 s55, 0x20000
MV 96,a,208,a,228
ds_read_b64 a[156:157], v4 offset:3712
MV 100,a,208,a,232
ds_read_b64 a[158:159], v4 offset:3720
MV 104,a,208,a,236
s_add_u32 s56, s40, 54525952
s_addc_u32 s57, s41, 0
MV 96,a,212,a,224
s_mov_b32 s58, 4194304
s_mov_b32 s59, 0x20000
MV 100,a,212,a,228
s_mov_b32 s60, s88
s_mov_b32 s61, s89
MV 104,a,212,a,232
s_mov_b32 s62, 4194304
MV 100,a,216,a,224
s_mov_b32 s63, 0x20000
MV 104,a,216,a,228
s_waitcnt lgkmcnt(15)
MV 104,a,220,a,224
MV 76,a,128,a,160
ds_read_b128 a[224:227], v5 offset:3776
s_sub_u32 s36, 15, s81
MV 80,a,128,a,164
ds_read_b64 a[192:193], v4 offset:192
s_min_u32 s36, s36, s81
MV 84,a,128,a,168
ds_read_b64 a[194:195], v4 offset:200
s_lshl_b32 s36, s36, 5
s_waitcnt lgkmcnt(15)
MV 88,a,128,a,172
ds_read_b128 a[228:231], v5 offset:3264
s_waitcnt lgkmcnt(15)
MV 92,a,128,a,176
s_lshl_b32 s37, s80, 2
s_waitcnt lgkmcnt(12)
MV 96,a,128,a,180
ds_read_b64 a[196:197], v4 offset:704
s_add_u32 s36, s36, s37
s_waitcnt lgkmcnt(10)
MV 100,a,128,a,184
ds_read_b64 a[198:199], v4 offset:712
s_add_u32 s36, s36, 256
s_waitcnt lgkmcnt(8)
MV 104,a,128,a,188
ds_read_b128 a[232:235], v5 offset:2752
MV 80,a,132,a,160
ds_read_b64 a[200:201], v4 offset:1216
v_and_b32 v254, 3, v1
MV 84,a,132,a,164
v_lshlrev_b32 v254, 3, v254
MV 88,a,132,a,168
ds_read_b64 a[202:203], v4 offset:1224
v_bfe_u32 v253, v1, 2, 2
MV 92,a,132,a,172
ds_read_b128 a[236:239], v5 offset:2240
MV 96,a,132,a,176
ds_read_b64 a[204:205], v4 offset:1728
v_add3_u32 v254, v254, v253, s36
MV 100,a,132,a,180
ds_read_b64 a[206:207], v4 offset:1736
s_lshr_b32 s36, s82, 1
MV 104,a,132,a,184
s_lshl_b32 s37, s80, 7
MV 84,a,136,a,160
ds_read_b128 a[240:243], v5 offset:1728
MV 88,a,136,a,164
ds_read_b64 a[208:209], v4 offset:2240
s_add_u32 s36, s36, s37
MV 92,a,136,a,168
ds_read_b64 a[210:211], v4 offset:2248
v_and_b32 v253, 15, v1
MV 96,a,136,a,172
ds_read_b128 a[244:247], v5 offset:1216
v_lshl_add_u32 v253, v253, 3, s36
MV 100,a,136,a,176
MV 104,a,136,a,180
ds_read_b64 a[212:213], v4 offset:2752
s_xor_b32 s36, s2, 4
MV 88,a,140,a,160
ds_read_b64 a[214:215], v4 offset:2760
v_mov_b32 v228, s36
MV 92,a,140,a,164
ds_read_b128 a[248:251], v5 offset:704
MV 96,a,140,a,168
ds_read_b64 a[216:217], v4 offset:3264
MV 100,a,140,a,172
v_cmp_lt_u32 vcc, 15, v1
s_nop 1
v_cndmask_b32 v254, v254, v228, vcc
MV 104,a,140,a,176
ds_read_b64 a[218:219], v4 offset:3272
MV 92,a,144,a,160
ds_read_b128 a[252:255], v5 offset:192
MV 96,a,144,a,164
ds_read_b64 a[220:221], v4 offset:3776
MV 100,a,144,a,168
ds_read_b64 a[222:223], v4 offset:3784
MV 104,a,144,a,172
v_cmp_lt_u32 vcc, 31, v1
s_nop 1
v_cndmask_b32 v254, v254, v253, vcc
MV 96,a,148,a,160
MV 100,a,148,a,164
MV 104,a,148,a,168
MV 100,a,152,a,160
v_lshlrev_b32 v254, 2, v254
MV 104,a,152,a,164
s_waitcnt lgkmcnt(15)
MV 104,a,156,a,160
MV 76,a,192,a,224
ds_read_b128 a[160:163], v5 offset:3840
MV 80,a,192,a,228
ds_read_b64 a[128:129], v4 offset:256
MV 84,a,192,a,232
ds_read_b64 a[130:131], v4 offset:264
s_waitcnt lgkmcnt(15)
MV 88,a,192,a,236
ds_read_b128 a[164:167], v5 offset:3328
s_waitcnt lgkmcnt(15)
MV 92,a,192,a,240
s_waitcnt lgkmcnt(12)
MV 96,a,192,a,244
ds_read_b64 a[132:133], v4 offset:768
s_waitcnt lgkmcnt(10)
MV 100,a,192,a,248
ds_read_b64 a[134:135], v4 offset:776
s_waitcnt lgkmcnt(8)
MV 104,a,192,a,252
ds_read_b128 a[168:171], v5 offset:2816
MV 80,a,196,a,224
ds_read_b64 a[136:137], v4 offset:1280
MV 84,a,196,a,228
MV 88,a,196,a,232
ds_read_b64 a[138:139], v4 offset:1288
MV 92,a,196,a,236
ds_read_b128 a[172:175], v5 offset:2304
MV 96,a,196,a,240
ds_read_b64 a[140:141], v4 offset:1792
MV 100,a,196,a,244
ds_read_b64 a[142:143], v4 offset:1800
MV 104,a,196,a,248
MV 84,a,200,a,224
ds_read_b128 a[176:179], v5 offset:1792
MV 88,a,200,a,228
ds_read_b64 a[144:145], v4 offset:2304
MV 92,a,200,a,232
ds_read_b64 a[146:147], v4 offset:2312
MV 96,a,200,a,236
ds_read_b128 a[180:183], v5 offset:1280
MV 100,a,200,a,240
MV 104,a,200,a,244
ds_read_b64 a[148:149], v4 offset:2816
MV 88,a,204,a,224
ds_read_b64 a[150:151], v4 offset:2824
MV 92,a,204,a,228
ds_read_b128 a[184:187], v5 offset:768
MV 96,a,204,a,232
ds_read_b64 a[152:153], v4 offset:3328
MV 100,a,204,a,236
MV 104,a,204,a,240
ds_read_b64 a[154:155], v4 offset:3336
MV 92,a,208,a,224
ds_read_b128 a[188:191], v5 offset:256
MV 96,a,208,a,228
ds_read_b64 a[156:157], v4 offset:3840
MV 100,a,208,a,232
ds_read_b64 a[158:159], v4 offset:3848
MV 104,a,208,a,236
MV 96,a,212,a,224
MV 100,a,212,a,228
MV 104,a,212,a,232
MV 100,a,216,a,224
MV 104,a,216,a,228
s_waitcnt lgkmcnt(15)
MV 104,a,220,a,224
MV 76,a,128,a,160
ds_read_b128 a[224:227], v5 offset:3904
MV 80,a,128,a,164
ds_read_b64 a[192:193], v4 offset:320
MV 84,a,128,a,168
ds_read_b64 a[194:195], v4 offset:328
s_waitcnt lgkmcnt(15)
MV 88,a,128,a,172
ds_read_b128 a[228:231], v5 offset:3392
s_waitcnt lgkmcnt(15)
MV 92,a,128,a,176
s_waitcnt lgkmcnt(12)
MV 96,a,128,a,180
ds_read_b64 a[196:197], v4 offset:832
s_waitcnt lgkmcnt(10)
MV 100,a,128,a,184
ds_read_b64 a[198:199], v4 offset:840
s_waitcnt lgkmcnt(8)
MV 104,a,128,a,188
ds_read_b128 a[232:235], v5 offset:2880
MV 80,a,132,a,160
ds_read_b64 a[200:201], v4 offset:1344
MV 84,a,132,a,164
MV 88,a,132,a,168
ds_read_b64 a[202:203], v4 offset:1352
MV 92,a,132,a,172
ds_read_b128 a[236:239], v5 offset:2368
MV 96,a,132,a,176
ds_read_b64 a[204:205], v4 offset:1856
MV 100,a,132,a,180
ds_read_b64 a[206:207], v4 offset:1864
MV 104,a,132,a,184
MV 84,a,136,a,160
ds_read_b128 a[240:243], v5 offset:1856
MV 88,a,136,a,164
ds_read_b64 a[208:209], v4 offset:2368
MV 92,a,136,a,168
ds_read_b64 a[210:211], v4 offset:2376
MV 96,a,136,a,172
ds_read_b128 a[244:247], v5 offset:1344
MV 100,a,136,a,176
MV 104,a,136,a,180
ds_read_b64 a[212:213], v4 offset:2880
MV 88,a,140,a,160
ds_read_b64 a[214:215], v4 offset:2888
MV 92,a,140,a,164
ds_read_b128 a[248:251], v5 offset:832
MV 96,a,140,a,168
ds_read_b64 a[216:217], v4 offset:3392
MV 100,a,140,a,172
MV 104,a,140,a,176
ds_read_b64 a[218:219], v4 offset:3400
MV 92,a,144,a,160
ds_read_b128 a[252:255], v5 offset:320
MV 96,a,144,a,164
ds_read_b64 a[220:221], v4 offset:3904
MV 100,a,144,a,168
ds_read_b64 a[222:223], v4 offset:3912
MV 104,a,144,a,172
MV 96,a,148,a,160
MV 100,a,148,a,164
MV 104,a,148,a,168
MV 100,a,152,a,160
MV 104,a,152,a,164
s_waitcnt lgkmcnt(15)
MV 104,a,156,a,160
MV 76,a,192,a,224
ds_read_b128 a[160:163], v5 offset:3968
MV 80,a,192,a,228
ds_read_b64 a[128:129], v4 offset:384
MV 84,a,192,a,232
ds_read_b64 a[130:131], v4 offset:392
s_waitcnt lgkmcnt(15)
MV 88,a,192,a,236
ds_read_b128 a[164:167], v5 offset:3456
s_waitcnt lgkmcnt(15)
MV 92,a,192,a,240
s_waitcnt lgkmcnt(12)
MV 96,a,192,a,244
ds_read_b64 a[132:133], v4 offset:896
s_waitcnt lgkmcnt(10)
MV 100,a,192,a,248
ds_read_b64 a[134:135], v4 offset:904
s_waitcnt lgkmcnt(8)
MV 104,a,192,a,252
ds_read_b128 a[168:171], v5 offset:2944
MV 80,a,196,a,224
ds_read_b64 a[136:137], v4 offset:1408
MV 84,a,196,a,228
MV 88,a,196,a,232
ds_read_b64 a[138:139], v4 offset:1416
MV 92,a,196,a,236
ds_read_b128 a[172:175], v5 offset:2432
MV 96,a,196,a,240
ds_read_b64 a[140:141], v4 offset:1920
MV 100,a,196,a,244
ds_read_b64 a[142:143], v4 offset:1928
MV 104,a,196,a,248
MV 84,a,200,a,224
ds_read_b128 a[176:179], v5 offset:1920
MV 88,a,200,a,228
ds_read_b64 a[144:145], v4 offset:2432
MV 92,a,200,a,232
ds_read_b64 a[146:147], v4 offset:2440
MV 96,a,200,a,236
ds_read_b128 a[180:183], v5 offset:1408
MV 100,a,200,a,240
MV 104,a,200,a,244
ds_read_b64 a[148:149], v4 offset:2944
MV 88,a,204,a,224
ds_read_b64 a[150:151], v4 offset:2952
MV 92,a,204,a,228
ds_read_b128 a[184:187], v5 offset:896
MV 96,a,204,a,232
ds_read_b64 a[152:153], v4 offset:3456
MV 100,a,204,a,236
MV 104,a,204,a,240
ds_read_b64 a[154:155], v4 offset:3464
MV 92,a,208,a,224
ds_read_b128 a[188:191], v5 offset:384
MV 96,a,208,a,228
ds_read_b64 a[156:157], v4 offset:3968
MV 100,a,208,a,232
ds_read_b64 a[158:159], v4 offset:3976
MV 104,a,208,a,236
MV 96,a,212,a,224
MV 100,a,212,a,228
MV 104,a,212,a,232
MV 100,a,216,a,224
MV 104,a,216,a,228
s_waitcnt lgkmcnt(15)
MV 104,a,220,a,224
MV 76,a,128,a,160
ds_read_b128 a[224:227], v5 offset:4032
MV 80,a,128,a,164
ds_read_b64 a[192:193], v4 offset:448
MV 84,a,128,a,168
ds_read_b64 a[194:195], v4 offset:456
s_waitcnt lgkmcnt(15)
MV 88,a,128,a,172
ds_read_b128 a[228:231], v5 offset:3520
s_waitcnt lgkmcnt(15)
MV 92,a,128,a,176
s_waitcnt lgkmcnt(12)
MV 96,a,128,a,180
ds_read_b64 a[196:197], v4 offset:960
s_waitcnt lgkmcnt(10)
MV 100,a,128,a,184
ds_read_b64 a[198:199], v4 offset:968
s_waitcnt lgkmcnt(8)
MV 104,a,128,a,188
ds_read_b128 a[232:235], v5 offset:3008
MV 80,a,132,a,160
ds_read_b64 a[200:201], v4 offset:1472
MV 84,a,132,a,164
MV 88,a,132,a,168
ds_read_b64 a[202:203], v4 offset:1480
MV 92,a,132,a,172
ds_read_b128 a[236:239], v5 offset:2496
MV 96,a,132,a,176
ds_read_b64 a[204:205], v4 offset:1984
MV 100,a,132,a,180
ds_read_b64 a[206:207], v4 offset:1992
MV 104,a,132,a,184
MV 84,a,136,a,160
ds_read_b128 a[240:243], v5 offset:1984
MV 88,a,136,a,164
ds_read_b64 a[208:209], v4 offset:2496
MV 92,a,136,a,168
ds_read_b64 a[210:211], v4 offset:2504
MV 96,a,136,a,172
ds_read_b128 a[244:247], v5 offset:1472
MV 100,a,136,a,176
MV 104,a,136,a,180
ds_read_b64 a[212:213], v4 offset:3008
MV 88,a,140,a,160
ds_read_b64 a[214:215], v4 offset:3016
MV 92,a,140,a,164
ds_read_b128 a[248:251], v5 offset:960
MV 96,a,140,a,168
ds_read_b64 a[216:217], v4 offset:3520
MV 100,a,140,a,172
MV 104,a,140,a,176
ds_read_b64 a[218:219], v4 offset:3528
MV 92,a,144,a,160
ds_read_b128 a[252:255], v5 offset:448
MV 96,a,144,a,164
ds_read_b64 a[220:221], v4 offset:4032
MV 100,a,144,a,168
ds_read_b64 a[222:223], v4 offset:4040
MV 104,a,144,a,172
MV 96,a,148,a,160
MV 100,a,148,a,164
MV 104,a,148,a,168
MV 100,a,152,a,160
MV 104,a,152,a,164
s_waitcnt lgkmcnt(15)
MV 104,a,156,a,160
buffer_load_dword v253, v254, s[8:11], 0 offen offset:1024 sc1
s_waitcnt vmcnt(0)
v_cmp_gt_u32 vcc, 1, v253
s_nop 4
s_cbranch_vccnz L_spin_f2
L_spin_f2_ret:
s_add_u32 m0, s70, 66560
s_nop 0
buffer_load_dwordx4 v238, s[48:51], s69 offen offset:0 sc1 lds
buffer_load_dwordx4 v238, s[48:51], s69 offen offset:1024 sc1 lds
buffer_load_dwordx4 v238, s[48:51], s69 offen offset:2048 sc1 lds
buffer_load_dwordx4 v238, s[48:51], s69 offen offset:3072 sc1 lds
s_add_u32 s69, s69, 16384
buffer_load_dwordx4 a[0:3], v236, s[44:47], s68 offen offset:0 sc1
buffer_load_dwordx4 a[4:7], v237, s[44:47], s68 offen offset:0 sc1
buffer_load_dwordx4 a[8:11], v236, s[44:47], s68 offen offset:1024 sc1
buffer_load_dwordx4 a[12:15], v237, s[44:47], s68 offen offset:1024 sc1
s_add_u32 s68, s68, 2048
MV 76,a,192,a,224
s_add_u32 m0, s70, 82944
MV 80,a,192,a,228
MV 84,a,192,a,232
s_waitcnt lgkmcnt(14)
MV 88,a,192,a,236
buffer_load_dwordx4 v238, s[48:51], s69 offen offset:0 sc1 lds
s_waitcnt lgkmcnt(11)
MV 92,a,192,a,240
s_waitcnt lgkmcnt(8)
MV 96,a,192,a,244
s_waitcnt lgkmcnt(5)
MV 100,a,192,a,248
buffer_load_dwordx4 v238, s[48:51], s69 offen offset:1024 sc1 lds
s_waitcnt lgkmcnt(2)
MV 104,a,192,a,252
MV 80,a,196,a,224
MV 84,a,196,a,228
buffer_load_dwordx4 v238, s[48:51], s69 offen offset:2048 sc1 lds
MV 88,a,196,a,232
MV 92,a,196,a,236
MV 96,a,196,a,240
buffer_load_dwordx4 v238, s[48:51], s69 offen offset:3072 sc1 lds
MV 100,a,196,a,244
MV 104,a,196,a,248
MV 84,a,200,a,224
s_add_u32 s69, s69, 16384
MV 88,a,200,a,228
MV 92,a,200,a,232
MV 96,a,200,a,236
MV 100,a,200,a,240
buffer_load_dwordx4 a[16:19], v236, s[44:47], s68 offen offset:0 sc1
MV 104,a,200,a,244
MV 88,a,204,a,224
MV 92,a,204,a,228
buffer_load_dwordx4 a[20:23], v237, s[44:47], s68 offen offset:0 sc1
MV 96,a,204,a,232
MV 100,a,204,a,236
MV 104,a,204,a,240
buffer_load_dwordx4 a[24:27], v236, s[44:47], s68 offen offset:1024 sc1
MV 92,a,208,a,224
MV 96,a,208,a,228
MV 100,a,208,a,232
buffer_load_dwordx4 a[28:31], v237, s[44:47], s68 offen offset:1024 sc1
MV 104,a,208,a,236
MV 96,a,212,a,224
MV 100,a,212,a,228
s_add_u32 s68, s68, 2048
MV 104,a,212,a,232
MV 100,a,216,a,224
MV 104,a,216,a,228
s_waitcnt lgkmcnt(0)
MV 104,a,220,a,224
s_waitcnt vmcnt(12) lgkmcnt(0)
s_barrier
ds_read_b128 a[128:131], v242 offset:0
ds_read_b128 a[132:135], v242 offset:1024
ds_read_b128 a[136:139], v242 offset:2048
ds_read_b128 a[140:143], v242 offset:3072
ds_read_b128 a[144:147], v243 offset:0
ds_read_b128 a[148:151], v243 offset:1024
ds_read_b128 a[152:155], v243 offset:2048
ds_read_b128 a[156:159], v243 offset:3072
s_waitcnt lgkmcnt(0)
s_waitcnt vmcnt(11)
v_mfma_f32_16x16x32_bf16 v[124:127], a[128:131], a[0:3], 0
s_add_u32 m0, s70, 99328
s_nop 0
buffer_load_dwordx4 v238, s[48:51], s69 offen offset:0 sc1 lds
s_waitcnt vmcnt(11)
v_mfma_f32_16x16x32_bf16 v[128:131], a[128:131], a[4:7], 0
buffer_load_dwordx4 v238, s[48:51], s69 offen offset:1024 sc1 lds
ds_read_b128 a[160:163], v242 offset:8192
v_mfma_f32_16x16x32_bf16 v[132:135], a[132:135], a[0:3], 0
buffer_load_dwordx4 v238, s[48:51], s69 offen offset:2048 sc1 lds
buffer_load_dwordx4 v238, s[48:51], s69 offen offset:3072 sc1 lds
v_mfma_f32_16x16x32_bf16 v[136:139], a[132:135], a[4:7], 0
s_add_u32 s69, s69, 16384
ds_read_b128 a[164:167], v242 offset:9216
v_mfma_f32_16x16x32_bf16 v[140:143], a[136:139], a[0:3], 0
buffer_load_dwordx4 a[32:35], v236, s[44:47], s68 offen offset:0 sc1
ds_read_b128 a[168:171], v242 offset:10240
v_mfma_f32_16x16x32_bf16 v[144:147], a[136:139], a[4:7], 0
buffer_load_dwordx4 a[36:39], v237, s[44:47], s68 offen offset:0 sc1
buffer_load_dwordx4 a[40:43], v236, s[44:47], s68 offen offset:1024 sc1
v_mfma_f32_16x16x32_bf16 v[148:151], a[140:143], a[0:3], 0
buffer_load_dwordx4 a[44:47], v237, s[44:47], s68 offen offset:1024 sc1
ds_read_b128 a[172:175], v242 offset:11264
v_mfma_f32_16x16x32_bf16 v[152:155], a[140:143], a[4:7], 0
s_add_u32 s68, s68, 2048
ds_read_b128 a[176:179], v243 offset:8192
v_mfma_f32_16x16x32_bf16 v[156:159], a[144:147], a[0:3], 0
buffer_load_dwordx4 a[48:51], v236, s[44:47], s68 offen offset:0 sc1
buffer_load_dwordx4 a[52:55], v237, s[44:47], s68 offen offset:0 sc1
v_mfma_f32_16x16x32_bf16 v[160:163], a[144:147], a[4:7], 0
buffer_load_dwordx4 a[56:59], v236, s[44:47], s68 offen offset:1024 sc1
ds_read_b128 a[180:183], v243 offset:9216
v_mfma_f32_16x16x32_bf16 v[164:167], a[148:151], a[0:3], 0
buffer_load_dwordx4 a[60:63], v237, s[44:47], s68 offen offset:1024 sc1
ds_read_b128 a[184:187], v243 offset:10240
v_mfma_f32_16x16x32_bf16 v[168:171], a[148:151], a[4:7], 0
s_add_u32 s68, s68, 2048
s_add_u32 m0, s70, 115712
v_mfma_f32_16x16x32_bf16 v[172:175], a[152:155], a[0:3], 0
buffer_load_dwordx4 v238, s[48:51], s69 offen offset:0 sc1 lds
ds_read_b128 a[188:191], v243 offset:11264
v_mfma_f32_16x16x32_bf16 v[176:179], a[152:155], a[4:7], 0
buffer_load_dwordx4 v238, s[48:51], s69 offen offset:1024 sc1 lds
v_cvt_pk_bf16_f32 v16, v76, v77
v_mfma_f32_16x16x32_bf16 v[180:183], a[156:159], a[0:3], 0
buffer_load_dwordx4 a[0:3], v236, s[44:47], s68 offen offset:0 sc1
v_cvt_pk_bf16_f32 v17, v78, v79
v_mfma_f32_16x16x32_bf16 v[184:187], a[156:159], a[4:7], 0
buffer_load_dwordx4 a[4:7], v237, s[44:47], s68 offen offset:0 sc1
ds_write_b16 v11, v16 offset:0
ds_write_b16_d16_hi v11, v16 offset:8
ds_write_b16 v11, v17 offset:16
ds_write_b16_d16_hi v11, v17 offset:24
v_cvt_pk_bf16_f32 v18, v80, v81
v_cvt_pk_bf16_f32 v19, v82, v83
ds_write_b16 v11, v18 offset:2176
s_waitcnt vmcnt(20) lgkmcnt(0)
s_barrier
MV 124,a,160,a,8
ds_read_b128 a[128:131], v242 offset:16384
ds_write_b16_d16_hi v11, v18 offset:2184
MV 128,a,160,a,12
ds_read_b128 a[132:135], v242 offset:17408
buffer_load_dwordx4 v238, s[48:51], s69 offen offset:2048 sc1 lds
MV 132,a,164,a,8
ds_write_b16 v11, v19 offset:2192
MV 136,a,164,a,12
ds_read_b128 a[136:139], v242 offset:18432
ds_write_b16_d16_hi v11, v19 offset:2200
MV 140,a,168,a,8
ds_read_b128 a[140:143], v242 offset:19456
v_cvt_pk_bf16_f32 v16, v84, v85
MV 144,a,168,a,12
buffer_load_dwordx4 v238, s[48:51], s69 offen offset:3072 sc1 lds
MV 148,a,172,a,8
ds_read_b128 a[144:147], v243 offset:16384
v_cvt_pk_bf16_f32 v17, v86, v87
MV 152,a,172,a,12
ds_read_b128 a[148:151], v243 offset:17408
MV 156,a,176,a,8
ds_write_b16 v11, v16 offset:4352
MV 160,a,176,a,12
ds_read_b128 a[152:155], v243 offset:18432
s_add_u32 s69, s69, 16384
MV 164,a,180,a,8
ds_read_b128 a[156:159], v243 offset:19456
ds_write_b16_d16_hi v11, v16 offset:4360
MV 168,a,180,a,12
ds_write_b16 v11, v17 offset:4368
MV 172,a,184,a,8
ds_write_b16_d16_hi v11, v17 offset:4376
MV 176,a,184,a,12
MV 180,a,188,a,8
buffer_load_dwordx4 a[8:11], v236, s[44:47], s68 offen offset:1024 sc1
v_cvt_pk_bf16_f32 v18, v88, v89
MV 184,a,188,a,12
buffer_load_dwordx4 a[12:15], v237, s[44:47], s68 offen offset:1024 sc1
s_add_u32 s68, s68, 2048
s_waitcnt lgkmcnt(0)
s_waitcnt vmcnt(23)
MV 124,a,128,a,16
ds_read_b128 a[160:163], v242 offset:24576
v_cvt_pk_bf16_f32 v19, v90, v91
s_waitcnt vmcnt(22)
MV 128,a,128,a,20
ds_read_b128 a[164:167], v242 offset:25600
s_add_u32 m0, s70, 66560
MV 132,a,132,a,16
ds_write_b16 v11, v18 offset:6528
MV 136,a,132,a,20
ds_read_b128 a[168:171], v242 offset:26624
ds_write_b16_d16_hi v11, v18 offset:6536
MV 140,a,136,a,16
ds_read_b128 a[172:175], v242 offset:27648
MV 144,a,136,a,20
buffer_load_dwordx4 v238, s[48:51], s69 offen offset:0 sc1 lds
ds_write_b16 v11, v19 offset:6544
MV 148,a,140,a,16
ds_read_b128 a[176:179], v243 offset:24576
MV 152,a,140,a,20
ds_read_b128 a[180:183], v243 offset:25600
ds_write_b16_d16_hi v11, v19 offset:6552
MV 156,a,144,a,16
v_cvt_pk_bf16_f32 v16, v92, v93
MV 160,a,144,a,20
ds_read_b128 a[184:187], v243 offset:26624
buffer_load_dwordx4 v238, s[48:51], s69 offen offset:1024 sc1 lds
MV 164,a,148,a,16
ds_read_b128 a[188:191], v243 offset:27648
v_cvt_pk_bf16_f32 v17, v94, v95
MV 168,a,148,a,20
MV 172,a,152,a,16
ds_write_b16 v11, v16 offset:8704
MV 176,a,152,a,20
MV 180,a,156,a,16
buffer_load_dwordx4 a[16:19], v236, s[44:47], s68 offen offset:0 sc1
ds_write_b16_d16_hi v11, v16 offset:8712
MV 184,a,156,a,20
buffer_load_dwordx4 a[20:23], v237, s[44:47], s68 offen offset:0 sc1
s_waitcnt vmcnt(20) lgkmcnt(0)
s_barrier
MV 124,a,160,a,24
ds_read_b128 a[128:131], v242 offset:32768
ds_write_b16 v11, v17 offset:8720
MV 128,a,160,a,28
ds_read_b128 a[132:135], v242 offset:33792
buffer_load_dwordx4 v238, s[48:51], s69 offen offset:2048 sc1 lds
MV 132,a,164,a,24
ds_write_b16_d16_hi v11, v17 offset:8728
MV 136,a,164,a,28
ds_read_b128 a[136:139], v242 offset:34816
v_cvt_pk_bf16_f32 v18, v96, v97
MV 140,a,168,a,24
ds_read_b128 a[140:143], v242 offset:35840
v_cvt_pk_bf16_f32 v19, v98, v99
MV 144,a,168,a,28
buffer_load_dwordx4 v238, s[48:51], s69 offen offset:3072 sc1 lds
MV 148,a,172,a,24
ds_read_b128 a[144:147], v243 offset:32768
ds_write_b16 v11, v18 offset:10880
MV 152,a,172,a,28
ds_read_b128 a[148:151], v243 offset:33792
MV 156,a,176,a,24
ds_write_b16_d16_hi v11, v18 offset:10888
MV 160,a,176,a,28
ds_read_b128 a[152:155], v243 offset:34816
s_add_u32 s69, s69, 16384
MV 164,a,180,a,24
ds_read_b128 a[156:159], v243 offset:35840
ds_write_b16 v11, v19 offset:10896
MV 168,a,180,a,28
ds_write_b16_d16_hi v11, v19 offset:10904
MV 172,a,184,a,24
v_cvt_pk_bf16_f32 v16, v100, v101
MV 176,a,184,a,28
MV 180,a,188,a,24
buffer_load_dwordx4 a[24:27], v236, s[44:47], s68 offen offset:1024 sc1
v_cvt_pk_bf16_f32 v17, v102, v103
MV 184,a,188,a,28
buffer_load_dwordx4 a[28:31], v237, s[44:47], s68 offen offset:1024 sc1
s_add_u32 s68, s68, 2048
s_waitcnt lgkmcnt(0)
s_waitcnt vmcnt(23)
MV 124,a,128,a,32
ds_read_b128 a[160:163], v242 offset:40960
ds_write_b16 v11, v16 offset:13056
s_waitcnt vmcnt(22)
MV 128,a,128,a,36
ds_read_b128 a[164:167], v242 offset:41984
s_add_u32 m0, s70, 82944
MV 132,a,132,a,32
ds_write_b16_d16_hi v11, v16 offset:13064
MV 136,a,132,a,36
ds_read_b128 a[168:171], v242 offset:43008
ds_write_b16 v11, v17 offset:13072
MV 140,a,136,a,32
ds_read_b128 a[172:175], v242 offset:44032
ds_write_b16_d16_hi v11, v17 offset:13080
MV 144,a,136,a,36
buffer_load_dwordx4 v238, s[48:51], s69 offen offset:0 sc1 lds
MV 148,a,140,a,32
ds_read_b128 a[176:179], v243 offset:40960
v_cvt_pk_bf16_f32 v18, v104, v105
MV 152,a,140,a,36
ds_read_b128 a[180:183], v243 offset:41984
MV 156,a,144,a,32
v_cvt_pk_bf16_f32 v19, v106, v107
MV 160,a,144,a,36
ds_read_b128 a[184:187], v243 offset:43008
buffer_load_dwordx4 v238, s[48:51], s69 offen offset:1024 sc1 lds
MV 164,a,148,a,32
ds_read_b128 a[188:191], v243 offset:44032
ds_write_b16 v11, v18 offset:15232
MV 168,a,148,a,36
ds_write_b16_d16_hi v11, v18 offset:15240
MV 172,a,152,a,32
ds_write_b16 v11, v19 offset:15248
MV 176,a,152,a,36
MV 180,a,156,a,32
buffer_load_dwordx4 a[32:35], v236, s[44:47], s68 offen offset:0 sc1
ds_write_b16_d16_hi v11, v19 offset:15256
MV 184,a,156,a,36
buffer_load_dwordx4 a[36:39], v237, s[44:47], s68 offen offset:0 sc1
s_waitcnt vmcnt(14) lgkmcnt(0)
s_barrier
MV 124,a,160,a,40
ds_read_b128 a[128:131], v242 offset:49152
ds_read_b64 v[108:109], v12 offset:0
MV 128,a,160,a,44
ds_read_b128 a[132:135], v242 offset:50176
buffer_load_dwordx4 v238, s[48:51], s69 offen offset:2048 sc1 lds
MV 132,a,164,a,40
ds_read_b64 v[110:111], v12 offset:8
MV 136,a,164,a,44
ds_read_b128 a[136:139], v242 offset:51200
MV 140,a,168,a,40
ds_read_b128 a[140:143], v242 offset:52224
ds_read_b64 v[112:113], v12 offset:1088
MV 144,a,168,a,44
buffer_load_dwordx4 v238, s[48:51], s69 offen offset:3072 sc1 lds
MV 148,a,172,a,40
ds_read_b128 a[144:147], v243 offset:49152
ds_read_b64 v[114:115], v12 offset:1096
MV 152,a,172,a,44
ds_read_b128 a[148:151], v243 offset:50176
MV 156,a,176,a,40
ds_read_b64 v[116:117], v12 offset:2176
MV 160,a,176,a,44
ds_read_b128 a[152:155], v243 offset:51200
s_add_u32 s69, s69, 16384
MV 164,a,180,a,40
ds_read_b128 a[156:159], v243 offset:52224
ds_read_b64 v[118:119], v12 offset:2184
MV 168,a,180,a,44
MV 172,a,184,a,40
ds_read_b64 v[120:121], v12 offset:3264
MV 176,a,184,a,44
MV 180,a,188,a,40
buffer_load_dwordx4 a[40:43], v236, s[44:47], s68 offen offset:1024 sc1
ds_read_b64 v[122:123], v12 offset:3272
MV 184,a,188,a,44
buffer_load_dwordx4 a[44:47], v237, s[44:47], s68 offen offset:1024 sc1
s_add_u32 s68, s68, 2048
s_waitcnt lgkmcnt(0)
MV 124,a,128,a,48
ds_read_b128 a[160:163], v242 offset:57344
buffer_store_dwordx4 v[108:111], v13, s[24:27], 0 offen offset:0 sc1
MV 128,a,128,a,52
ds_read_b128 a[164:167], v242 offset:58368
s_add_u32 m0, s70, 99328
MV 132,a,132,a,48
MV 136,a,132,a,52
ds_read_b128 a[168:171], v242 offset:59392
MV 140,a,136,a,48
ds_read_b128 a[172:175], v242 offset:60416
MV 144,a,136,a,52
buffer_load_dwordx4 v238, s[48:51], s69 offen offset:0 sc1 lds
MV 148,a,140,a,48
ds_read_b128 a[176:179], v243 offset:57344
MV 152,a,140,a,52
ds_read_b128 a[180:183], v243 offset:58368
MV 156,a,144,a,48
buffer_store_dwordx4 v[112:115], v13, s[24:27], 0 offen offset:1024 sc1
MV 160,a,144,a,52
ds_read_b128 a[184:187], v243 offset:59392
buffer_load_dwordx4 v238, s[48:51], s69 offen offset:1024 sc1 lds
MV 164,a,148,a,48
ds_read_b128 a[188:191], v243 offset:60416
MV 168,a,148,a,52
MV 172,a,152,a,48
MV 176,a,152,a,52
MV 180,a,156,a,48
buffer_load_dwordx4 a[48:51], v236, s[44:47], s68 offen offset:0 sc1
MV 184,a,156,a,52
buffer_load_dwordx4 a[52:55], v237, s[44:47], s68 offen offset:0 sc1
s_waitcnt vmcnt(16) lgkmcnt(0)
s_barrier
MV 124,a,160,a,56
ds_read_b128 a[128:131], v242 offset:0
buffer_store_dwordx4 v[116:119], v13, s[24:27], 0 offen offset:2048 sc1
MV 128,a,160,a,60
ds_read_b128 a[132:135], v242 offset:1024
buffer_load_dwordx4 v238, s[48:51], s69 offen offset:2048 sc1 lds
MV 132,a,164,a,56
MV 136,a,164,a,60
ds_read_b128 a[136:139], v242 offset:2048
MV 140,a,168,a,56
ds_read_b128 a[140:143], v242 offset:3072
MV 144,a,168,a,60
buffer_load_dwordx4 v238, s[48:51], s69 offen offset:3072 sc1 lds
MV 148,a,172,a,56
ds_read_b128 a[144:147], v243 offset:0
MV 152,a,172,a,60
ds_read_b128 a[148:151], v243 offset:1024
MV 156,a,176,a,56
buffer_store_dwordx4 v[120:123], v13, s[24:27], 0 offen offset:3072 sc1
MV 160,a,176,a,60
ds_read_b128 a[152:155], v243 offset:2048
s_add_u32 s69, s69, 16384
MV 164,a,180,a,56
ds_read_b128 a[156:159], v243 offset:3072
MV 168,a,180,a,60
MV 172,a,184,a,56
MV 176,a,184,a,60
MV 180,a,188,a,56
buffer_load_dwordx4 a[56:59], v236, s[44:47], s68 offen offset:1024 sc1
MV 184,a,188,a,60
buffer_load_dwordx4 a[60:63], v237, s[44:47], s68 offen offset:1024 sc1
s_add_u32 s68, s68, 2048
s_waitcnt lgkmcnt(0)
MV 124,a,128,a,0
ds_read_b128 a[160:163], v242 offset:8192
MV 128,a,128,a,4
ds_read_b128 a[164:167], v242 offset:9216
s_add_u32 m0, s70, 115712
MV 132,a,132,a,0
MV 136,a,132,a,4
ds_read_b128 a[168:171], v242 offset:10240
MV 140,a,136,a,0
ds_read_b128 a[172:175], v242 offset:11264
MV 144,a,136,a,4
buffer_load_dwordx4 v238, s[48:51], s69 offen offset:0 sc1 lds
MV 148,a,140,a,0
ds_read_b128 a[176:179], v243 offset:8192
MV 152,a,140,a,4
ds_read_b128 a[180:183], v243 offset:9216
MV 156,a,144,a,0
MV 160,a,144,a,4
ds_read_b128 a[184:187], v243 offset:10240
buffer_load_dwordx4 v238, s[48:51], s69 offen offset:1024 sc1 lds
MV 164,a,148,a,0
ds_read_b128 a[188:191], v243 offset:11264
MV 168,a,148,a,4
MV 172,a,152,a,0
MV 176,a,152,a,4
MV 180,a,156,a,0
buffer_load_dwordx4 a[0:3], v236, s[44:47], s68 offen offset:0 sc1
MV 184,a,156,a,4
buffer_load_dwordx4 a[4:7], v237, s[44:47], s68 offen offset:0 sc1
s_waitcnt vmcnt(18) lgkmcnt(0)
s_barrier
MV 124,a,160,a,8
ds_read_b128 a[128:131], v242 offset:16384
MV 128,a,160,a,12
ds_read_b128 a[132:135], v242 offset:17408
buffer_load_dwordx4 v238, s[48:51], s69 offen offset:2048 sc1 lds
MV 132,a,164,a,8
MV 136,a,164,a,12
ds_read_b128 a[136:139], v242 offset:18432
MV 140,a,168,a,8
ds_read_b128 a[140:143], v242 offset:19456
MV 144,a,168,a,12
buffer_load_dwordx4 v238, s[48:51], s69 offen offset:3072 sc1 lds
MV 148,a,172,a,8
ds_read_b128 a[144:147], v243 offset:16384
MV 152,a,172,a,12
ds_read_b128 a[148:151], v243 offset:17408
MV 156,a,176,a,8
MV 160,a,176,a,12
ds_read_b128 a[152:155], v243 offset:18432
s_add_u32 s69, s69, 16384
MV 164,a,180,a,8
ds_read_b128 a[156:159], v243 offset:19456
MV 168,a,180,a,12
MV 172,a,184,a,8
MV 176,a,184,a,12
MV 180,a,188,a,8
buffer_load_dwordx4 a[8:11], v236, s[44:47], s68 offen offset:1024 sc1
MV 184,a,188,a,12
buffer_load_dwordx4 a[12:15], v237, s[44:47], s68 offen offset:1024 sc1
s_add_u32 s68, s68, 2048
s_waitcnt lgkmcnt(0)
MV 124,a,128,a,16
ds_read_b128 a[160:163], v242 offset:24576
MV 128,a,128,a,20
ds_read_b128 a[164:167], v242 offset:25600
s_add_u32 m0, s70, 66560
MV 132,a,132,a,16
MV 136,a,132,a,20
ds_read_b128 a[168:171], v242 offset:26624
MV 140,a,136,a,16
ds_read_b128 a[172:175], v242 offset:27648
MV 144,a,136,a,20
buffer_load_dwordx4 v238, s[48:51], s69 offen offset:0 sc1 lds
MV 148,a,140,a,16
ds_read_b128 a[176:179], v243 offset:24576
MV 152,a,140,a,20
ds_read_b128 a[180:183], v243 offset:25600
MV 156,a,144,a,16
MV 160,a,144,a,20
ds_read_b128 a[184:187], v243 offset:26624
buffer_load_dwordx4 v238, s[48:51], s69 offen offset:1024 sc1 lds
MV 164,a,148,a,16
ds_read_b128 a[188:191], v243 offset:27648
MV 168,a,148,a,20
MV 172,a,152,a,16
MV 176,a,152,a,20
MV 180,a,156,a,16
buffer_load_dwordx4 a[16:19], v236, s[44:47], s68 offen offset:0 sc1
MV 184,a,156,a,20
buffer_load_dwordx4 a[20:23], v237, s[44:47], s68 offen offset:0 sc1
s_waitcnt vmcnt(15) lgkmcnt(0)
s_barrier
MV 124,a,160,a,24
ds_read_b128 a[128:131], v242 offset:32768
MV 128,a,160,a,28
ds_read_b128 a[132:135], v242 offset:33792
buffer_load_dwordx4 v238, s[48:51], s69 offen offset:2048 sc1 lds
MV 132,a,164,a,24
MV 136,a,164,a,28
ds_read_b128 a[136:139], v242 offset:34816
MV 140,a,168,a,24
ds_read_b128 a[140:143], v242 offset:35840
MV 144,a,168,a,28
buffer_load_dwordx4 v238, s[48:51], s69 offen offset:3072 sc1 lds
MV 148,a,172,a,24
ds_read_b128 a[144:147], v243 offset:32768
MV 152,a,172,a,28
ds_read_b128 a[148:151], v243 offset:33792
MV 156,a,176,a,24
MV 160,a,176,a,28
ds_read_b128 a[152:155], v243 offset:34816
s_add_u32 s69, s69, 16384
MV 164,a,180,a,24
ds_read_b128 a[156:159], v243 offset:35840
MV 168,a,180,a,28
MV 172,a,184,a,24
MV 176,a,184,a,28
MV 180,a,188,a,24
buffer_load_dwordx4 a[24:27], v236, s[44:47], s68 offen offset:1024 sc1
MV 184,a,188,a,28
buffer_load_dwordx4 a[28:31], v237, s[44:47], s68 offen offset:1024 sc1
s_add_u32 s68, s68, 2048
s_waitcnt lgkmcnt(0)
MV 124,a,128,a,32
ds_read_b128 a[160:163], v242 offset:40960
MV 128,a,128,a,36
ds_read_b128 a[164:167], v242 offset:41984
s_add_u32 m0, s70, 82944
MV 132,a,132,a,32
MV 136,a,132,a,36
ds_read_b128 a[168:171], v242 offset:43008
MV 140,a,136,a,32
ds_read_b128 a[172:175], v242 offset:44032
MV 144,a,136,a,36
buffer_load_dwordx4 v238, s[48:51], s69 offen offset:0 sc1 lds
MV 148,a,140,a,32
ds_read_b128 a[176:179], v243 offset:40960
MV 152,a,140,a,36
ds_read_b128 a[180:183], v243 offset:41984
MV 156,a,144,a,32
MV 160,a,144,a,36
ds_read_b128 a[184:187], v243 offset:43008
buffer_load_dwordx4 v238, s[48:51], s69 offen offset:1024 sc1 lds
MV 164,a,148,a,32
ds_read_b128 a[188:191], v243 offset:44032
MV 168,a,148,a,36
MV 172,a,152,a,32
MV 176,a,152,a,36
MV 180,a,156,a,32
buffer_load_dwordx4 a[32:35], v236, s[44:47], s68 offen offset:0 sc1
MV 184,a,156,a,36
buffer_load_dwordx4 a[36:39], v237, s[44:47], s68 offen offset:0 sc1
s_waitcnt vmcnt(14) lgkmcnt(0)
s_barrier
MV 124,a,160,a,40
ds_read_b128 a[128:131], v242 offset:49152
MV 128,a,160,a,44
ds_read_b128 a[132:135], v242 offset:50176
buffer_load_dwordx4 v238, s[48:51], s69 offen offset:2048 sc1 lds
MV 132,a,164,a,40
MV 136,a,164,a,44
ds_read_b128 a[136:139], v242 offset:51200
MV 140,a,168,a,40
ds_read_b128 a[140:143], v242 offset:52224
MV 144,a,168,a,44
buffer_load_dwordx4 v238, s[48:51], s69 offen offset:3072 sc1 lds
MV 148,a,172,a,40
ds_read_b128 a[144:147], v243 offset:49152
MV 152,a,172,a,44
ds_read_b128 a[148:151], v243 offset:50176
MV 156,a,176,a,40
MV 160,a,176,a,44
ds_read_b128 a[152:155], v243 offset:51200
s_add_u32 s69, s69, 16384
MV 164,a,180,a,40
ds_read_b128 a[156:159], v243 offset:52224
MV 168,a,180,a,44
MV 172,a,184,a,40
MV 176,a,184,a,44
MV 180,a,188,a,40
buffer_load_dwordx4 a[40:43], v236, s[44:47], s68 offen offset:1024 sc1
MV 184,a,188,a,44
buffer_load_dwordx4 a[44:47], v237, s[44:47], s68 offen offset:1024 sc1
s_add_u32 s68, s68, 2048
s_waitcnt lgkmcnt(0)
MV 124,a,128,a,48
ds_read_b128 a[160:163], v242 offset:57344
MV 128,a,128,a,52
ds_read_b128 a[164:167], v242 offset:58368
s_add_u32 m0, s70, 99328
MV 132,a,132,a,48
MV 136,a,132,a,52
ds_read_b128 a[168:171], v242 offset:59392
MV 140,a,136,a,48
ds_read_b128 a[172:175], v242 offset:60416
MV 144,a,136,a,52
buffer_load_dwordx4 v238, s[48:51], s69 offen offset:0 sc1 lds
MV 148,a,140,a,48
ds_read_b128 a[176:179], v243 offset:57344
MV 152,a,140,a,52
ds_read_b128 a[180:183], v243 offset:58368
MV 156,a,144,a,48
MV 160,a,144,a,52
ds_read_b128 a[184:187], v243 offset:59392
buffer_load_dwordx4 v238, s[48:51], s69 offen offset:1024 sc1 lds
MV 164,a,148,a,48
ds_read_b128 a[188:191], v243 offset:60416
MV 168,a,148,a,52
MV 172,a,152,a,48
MV 176,a,152,a,52
MV 180,a,156,a,48
buffer_load_dwordx4 a[48:51], v236, s[44:47], s68 offen offset:0 sc1
MV 184,a,156,a,52
buffer_load_dwordx4 a[52:55], v237, s[44:47], s68 offen offset:0 sc1
s_waitcnt vmcnt(14) lgkmcnt(0)
s_barrier
MV 124,a,160,a,56
ds_read_b128 a[128:131], v242 offset:0
MV 128,a,160,a,60
ds_read_b128 a[132:135], v242 offset:1024
buffer_load_dwordx4 v238, s[48:51], s69 offen offset:2048 sc1 lds
MV 132,a,164,a,56
MV 136,a,164,a,60
ds_read_b128 a[136:139], v242 offset:2048
MV 140,a,168,a,56
ds_read_b128 a[140:143], v242 offset:3072
MV 144,a,168,a,60
buffer_load_dwordx4 v238, s[48:51], s69 offen offset:3072 sc1 lds
MV 148,a,172,a,56
ds_read_b128 a[144:147], v243 offset:0
MV 152,a,172,a,60
ds_read_b128 a[148:151], v243 offset:1024
MV 156,a,176,a,56
MV 160,a,176,a,60
ds_read_b128 a[152:155], v243 offset:2048
s_add_u32 s69, s69, 16384
MV 164,a,180,a,56
ds_read_b128 a[156:159], v243 offset:3072
MV 168,a,180,a,60
MV 172,a,184,a,56
MV 176,a,184,a,60
MV 180,a,188,a,56
buffer_load_dwordx4 a[56:59], v236, s[44:47], s68 offen offset:1024 sc1
MV 184,a,188,a,60
buffer_load_dwordx4 a[60:63], v237, s[44:47], s68 offen offset:1024 sc1
s_add_u32 s68, s68, 2048
s_waitcnt lgkmcnt(0)
MV 124,a,128,a,0
ds_read_b128 a[160:163], v242 offset:8192
MV 128,a,128,a,4
ds_read_b128 a[164:167], v242 offset:9216
s_add_u32 m0, s70, 115712
MV 132,a,132,a,0
MV 136,a,132,a,4
ds_read_b128 a[168:171], v242 offset:10240
MV 140,a,136,a,0
ds_read_b128 a[172:175], v242 offset:11264
MV 144,a,136,a,4
buffer_load_dwordx4 v238, s[48:51], s69 offen offset:0 sc1 lds
MV 148,a,140,a,0
ds_read_b128 a[176:179], v243 offset:8192
MV 152,a,140,a,4
ds_read_b128 a[180:183], v243 offset:9216
MV 156,a,144,a,0
MV 160,a,144,a,4
ds_read_b128 a[184:187], v243 offset:10240
buffer_load_dwordx4 v238, s[48:51], s69 offen offset:1024 sc1 lds
MV 164,a,148,a,0
ds_read_b128 a[188:191], v243 offset:11264
MV 168,a,148,a,4
MV 172,a,152,a,0
MV 176,a,152,a,4
MV 180,a,156,a,0
buffer_load_dwordx4 a[0:3], v236, s[44:47], s68 offen offset:0 sc1
MV 184,a,156,a,4
buffer_load_dwordx4 a[4:7], v237, s[44:47], s68 offen offset:0 sc1
s_waitcnt vmcnt(14) lgkmcnt(0)
s_barrier
MV 124,a,160,a,8
ds_read_b128 a[128:131], v242 offset:16384
MV 128,a,160,a,12
ds_read_b128 a[132:135], v242 offset:17408
buffer_load_dwordx4 v238, s[48:51], s69 offen offset:2048 sc1 lds
MV 132,a,164,a,8
MV 136,a,164,a,12
ds_read_b128 a[136:139], v242 offset:18432
MV 140,a,168,a,8
ds_read_b128 a[140:143], v242 offset:19456
MV 144,a,168,a,12
buffer_load_dwordx4 v238, s[48:51], s69 offen offset:3072 sc1 lds
MV 148,a,172,a,8
ds_read_b128 a[144:147], v243 offset:16384
MV 152,a,172,a,12
ds_read_b128 a[148:151], v243 offset:17408
MV 156,a,176,a,8
MV 160,a,176,a,12
ds_read_b128 a[152:155], v243 offset:18432
s_add_u32 s69, s69, 16384
MV 164,a,180,a,8
ds_read_b128 a[156:159], v243 offset:19456
MV 168,a,180,a,12
MV 172,a,184,a,8
MV 176,a,184,a,12
MV 180,a,188,a,8
buffer_load_dwordx4 a[8:11], v236, s[44:47], s68 offen offset:1024 sc1
MV 184,a,188,a,12
buffer_load_dwordx4 a[12:15], v237, s[44:47], s68 offen offset:1024 sc1
s_add_u32 s68, s68, 2048
s_waitcnt lgkmcnt(0)
MV 124,a,128,a,16
ds_read_b128 a[160:163], v242 offset:24576
MV 128,a,128,a,20
ds_read_b128 a[164:167], v242 offset:25600
s_add_u32 m0, s70, 66560
MV 132,a,132,a,16
MV 136,a,132,a,20
ds_read_b128 a[168:171], v242 offset:26624
MV 140,a,136,a,16
ds_read_b128 a[172:175], v242 offset:27648
MV 144,a,136,a,20
buffer_load_dwordx4 v238, s[48:51], s69 offen offset:0 sc1 lds
MV 148,a,140,a,16
ds_read_b128 a[176:179], v243 offset:24576
MV 152,a,140,a,20
ds_read_b128 a[180:183], v243 offset:25600
MV 156,a,144,a,16
MV 160,a,144,a,20
ds_read_b128 a[184:187], v243 offset:26624
buffer_load_dwordx4 v238, s[48:51], s69 offen offset:1024 sc1 lds
MV 164,a,148,a,16
ds_read_b128 a[188:191], v243 offset:27648
MV 168,a,148,a,20
MV 172,a,152,a,16
MV 176,a,152,a,20
MV 180,a,156,a,16
buffer_load_dwordx4 a[16:19], v236, s[44:47], s68 offen offset:0 sc1
MV 184,a,156,a,20
buffer_load_dwordx4 a[20:23], v237, s[44:47], s68 offen offset:0 sc1
s_waitcnt vmcnt(14) lgkmcnt(0)
s_barrier
MV 124,a,160,a,24
ds_read_b128 a[128:131], v242 offset:32768
MV 128,a,160,a,28
ds_read_b128 a[132:135], v242 offset:33792
buffer_load_dwordx4 v238, s[48:51], s69 offen offset:2048 sc1 lds
MV 132,a,164,a,24
MV 136,a,164,a,28
ds_read_b128 a[136:139], v242 offset:34816
MV 140,a,168,a,24
ds_read_b128 a[140:143], v242 offset:35840
MV 144,a,168,a,28
buffer_load_dwordx4 v238, s[48:51], s69 offen offset:3072 sc1 lds
MV 148,a,172,a,24
ds_read_b128 a[144:147], v243 offset:32768
MV 152,a,172,a,28
ds_read_b128 a[148:151], v243 offset:33792
MV 156,a,176,a,24
MV 160,a,176,a,28
ds_read_b128 a[152:155], v243 offset:34816
s_add_u32 s69, s69, 16384
MV 164,a,180,a,24
ds_read_b128 a[156:159], v243 offset:35840
MV 168,a,180,a,28
MV 172,a,184,a,24
MV 176,a,184,a,28
MV 180,a,188,a,24
buffer_load_dwordx4 a[24:27], v236, s[44:47], s68 offen offset:1024 sc1
MV 184,a,188,a,28
buffer_load_dwordx4 a[28:31], v237, s[44:47], s68 offen offset:1024 sc1
s_add_u32 s68, s68, 2048
s_waitcnt lgkmcnt(0)
MV 124,a,128,a,32
ds_read_b128 a[160:163], v242 offset:40960
MV 128,a,128,a,36
ds_read_b128 a[164:167], v242 offset:41984
s_add_u32 m0, s70, 82944
MV 132,a,132,a,32
MV 136,a,132,a,36
ds_read_b128 a[168:171], v242 offset:43008
MV 140,a,136,a,32
ds_read_b128 a[172:175], v242 offset:44032
MV 144,a,136,a,36
buffer_load_dwordx4 v238, s[48:51], s69 offen offset:0 sc1 lds
MV 148,a,140,a,32
ds_read_b128 a[176:179], v243 offset:40960
MV 152,a,140,a,36
ds_read_b128 a[180:183], v243 offset:41984
MV 156,a,144,a,32
MV 160,a,144,a,36
ds_read_b128 a[184:187], v243 offset:43008
buffer_load_dwordx4 v238, s[48:51], s69 offen offset:1024 sc1 lds
MV 164,a,148,a,32
ds_read_b128 a[188:191], v243 offset:44032
MV 168,a,148,a,36
MV 172,a,152,a,32
MV 176,a,152,a,36
MV 180,a,156,a,32
buffer_load_dwordx4 a[32:35], v236, s[44:47], s68 offen offset:0 sc1
MV 184,a,156,a,36
buffer_load_dwordx4 a[36:39], v237, s[44:47], s68 offen offset:0 sc1
s_waitcnt vmcnt(14) lgkmcnt(0)
s_barrier
v_mov_b32 v253, 1
s_lshl_b32 s36, s2, 2
buffer_store_dword v253, v255, s[8:11], s36 offen offset:3072 sc1
MV 124,a,160,a,40
ds_read_b128 a[128:131], v242 offset:49152
MV 128,a,160,a,44
ds_read_b128 a[132:135], v242 offset:50176
buffer_load_dwordx4 v238, s[48:51], s69 offen offset:2048 sc1 lds
MV 132,a,164,a,40
MV 136,a,164,a,44
ds_read_b128 a[136:139], v242 offset:51200
MV 140,a,168,a,40
ds_read_b128 a[140:143], v242 offset:52224
MV 144,a,168,a,44
buffer_load_dwordx4 v238, s[48:51], s69 offen offset:3072 sc1 lds
MV 148,a,172,a,40
ds_read_b128 a[144:147], v243 offset:49152
MV 152,a,172,a,44
ds_read_b128 a[148:151], v243 offset:50176
MV 156,a,176,a,40
MV 160,a,176,a,44
ds_read_b128 a[152:155], v243 offset:51200
s_add_u32 s69, s69, 16384
MV 164,a,180,a,40
ds_read_b128 a[156:159], v243 offset:52224
MV 168,a,180,a,44
MV 172,a,184,a,40
MV 176,a,184,a,44
MV 180,a,188,a,40
buffer_load_dwordx4 a[40:43], v236, s[44:47], s68 offen offset:1024 sc1
MV 184,a,188,a,44
buffer_load_dwordx4 a[44:47], v237, s[44:47], s68 offen offset:1024 sc1
s_add_u32 s68, s68, 2048
s_waitcnt lgkmcnt(0)
MV 124,a,128,a,48
ds_read_b128 a[160:163], v242 offset:57344
MV 128,a,128,a,52
ds_read_b128 a[164:167], v242 offset:58368
s_add_u32 m0, s70, 99328
MV 132,a,132,a,48
MV 136,a,132,a,52
ds_read_b128 a[168:171], v242 offset:59392
MV 140,a,136,a,48
ds_read_b128 a[172:175], v242 offset:60416
MV 144,a,136,a,52
buffer_load_dwordx4 v238, s[48:51], s69 offen offset:0 sc1 lds
MV 148,a,140,a,48
ds_read_b128 a[176:179], v243 offset:57344
MV 152,a,140,a,52
ds_read_b128 a[180:183], v243 offset:58368
MV 156,a,144,a,48
MV 160,a,144,a,52
ds_read_b128 a[184:187], v243 offset:59392
buffer_load_dwordx4 v238, s[48:51], s69 offen offset:1024 sc1 lds
MV 164,a,148,a,48
ds_read_b128 a[188:191], v243 offset:60416
MV 168,a,148,a,52
MV 172,a,152,a,48
MV 176,a,152,a,52
MV 180,a,156,a,48
buffer_load_dwordx4 a[48:51], v236, s[44:47], s68 offen offset:0 sc1
MV 184,a,156,a,52
buffer_load_dwordx4 a[52:55], v237, s[44:47], s68 offen offset:0 sc1
s_waitcnt vmcnt(15) lgkmcnt(0)
s_barrier
MV 124,a,160,a,56
ds_read_b128 a[128:131], v242 offset:0
MV 128,a,160,a,60
ds_read_b128 a[132:135], v242 offset:1024
buffer_load_dwordx4 v238, s[48:51], s69 offen offset:2048 sc1 lds
MV 132,a,164,a,56
MV 136,a,164,a,60
ds_read_b128 a[136:139], v242 offset:2048
MV 140,a,168,a,56
ds_read_b128 a[140:143], v242 offset:3072
MV 144,a,168,a,60
buffer_load_dwordx4 v238, s[48:51], s69 offen offset:3072 sc1 lds
MV 148,a,172,a,56
ds_read_b128 a[144:147], v243 offset:0
MV 152,a,172,a,60
ds_read_b128 a[148:151], v243 offset:1024
MV 156,a,176,a,56
MV 160,a,176,a,60
ds_read_b128 a[152:155], v243 offset:2048
s_add_u32 s69, s69, 16384
MV 164,a,180,a,56
ds_read_b128 a[156:159], v243 offset:3072
MV 168,a,180,a,60
MV 172,a,184,a,56
MV 176,a,184,a,60
MV 180,a,188,a,56
buffer_load_dwordx4 a[56:59], v236, s[44:47], s68 offen offset:1024 sc1
MV 184,a,188,a,60
buffer_load_dwordx4 a[60:63], v237, s[44:47], s68 offen offset:1024 sc1
s_add_u32 s68, s68, 2048
s_waitcnt lgkmcnt(0)
MV 124,a,128,a,0
ds_read_b128 a[160:163], v242 offset:8192
MV 128,a,128,a,4
ds_read_b128 a[164:167], v242 offset:9216
s_add_u32 m0, s70, 115712
MV 132,a,132,a,0
MV 136,a,132,a,4
ds_read_b128 a[168:171], v242 offset:10240
MV 140,a,136,a,0
ds_read_b128 a[172:175], v242 offset:11264
MV 144,a,136,a,4
buffer_load_dwordx4 v238, s[48:51], s69 offen offset:0 sc1 lds
MV 148,a,140,a,0
ds_read_b128 a[176:179], v243 offset:8192
MV 152,a,140,a,4
ds_read_b128 a[180:183], v243 offset:9216
MV 156,a,144,a,0
MV 160,a,144,a,4
ds_read_b128 a[184:187], v243 offset:10240
buffer_load_dwordx4 v238, s[48:51], s69 offen offset:1024 sc1 lds
MV 164,a,148,a,0
ds_read_b128 a[188:191], v243 offset:11264
MV 168,a,148,a,4
MV 172,a,152,a,0
MV 176,a,152,a,4
MV 180,a,156,a,0
buffer_load_dwordx4 a[0:3], v236, s[44:47], s68 offen offset:0 sc1
MV 184,a,156,a,4
buffer_load_dwordx4 a[4:7], v237, s[44:47], s68 offen offset:0 sc1
s_waitcnt vmcnt(14) lgkmcnt(0)
s_barrier
MV 124,a,160,a,8
ds_read_b128 a[128:131], v242 offset:16384
MV 128,a,160,a,12
ds_read_b128 a[132:135], v242 offset:17408
buffer_load_dwordx4 v238, s[48:51], s69 offen offset:2048 sc1 lds
MV 132,a,164,a,8
MV 136,a,164,a,12
ds_read_b128 a[136:139], v242 offset:18432
MV 140,a,168,a,8
ds_read_b128 a[140:143], v242 offset:19456
MV 144,a,168,a,12
buffer_load_dwordx4 v238, s[48:51], s69 offen offset:3072 sc1 lds
MV 148,a,172,a,8
ds_read_b128 a[144:147], v243 offset:16384
MV 152,a,172,a,12
ds_read_b128 a[148:151], v243 offset:17408
MV 156,a,176,a,8
MV 160,a,176,a,12
ds_read_b128 a[152:155], v243 offset:18432
s_add_u32 s69, s69, 16384
MV 164,a,180,a,8
ds_read_b128 a[156:159], v243 offset:19456
MV 168,a,180,a,12
MV 172,a,184,a,8
MV 176,a,184,a,12
MV 180,a,188,a,8
buffer_load_dwordx4 a[8:11], v236, s[44:47], s68 offen offset:1024 sc1
MV 184,a,188,a,12
buffer_load_dwordx4 a[12:15], v237, s[44:47], s68 offen offset:1024 sc1
s_add_u32 s68, s68, 2048
s_waitcnt lgkmcnt(0)
MV 124,a,128,a,16
ds_read_b128 a[160:163], v242 offset:24576
MV 128,a,128,a,20
ds_read_b128 a[164:167], v242 offset:25600
s_add_u32 m0, s70, 66560
MV 132,a,132,a,16
MV 136,a,132,a,20
ds_read_b128 a[168:171], v242 offset:26624
MV 140,a,136,a,16
ds_read_b128 a[172:175], v242 offset:27648
MV 144,a,136,a,20
buffer_load_dwordx4 v238, s[48:51], s69 offen offset:0 sc1 lds
MV 148,a,140,a,16
ds_read_b128 a[176:179], v243 offset:24576
MV 152,a,140,a,20
ds_read_b128 a[180:183], v243 offset:25600
MV 156,a,144,a,16
MV 160,a,144,a,20
ds_read_b128 a[184:187], v243 offset:26624
buffer_load_dwordx4 v238, s[48:51], s69 offen offset:1024 sc1 lds
MV 164,a,148,a,16
ds_read_b128 a[188:191], v243 offset:27648
MV 168,a,148,a,20
MV 172,a,152,a,16
MV 176,a,152,a,20
MV 180,a,156,a,16
buffer_load_dwordx4 a[16:19], v236, s[44:47], s68 offen offset:0 sc1
MV 184,a,156,a,20
buffer_load_dwordx4 a[20:23], v237, s[44:47], s68 offen offset:0 sc1
s_waitcnt vmcnt(14) lgkmcnt(0)
s_barrier
MV 124,a,160,a,24
ds_read_b128 a[128:131], v242 offset:32768
MV 128,a,160,a,28
ds_read_b128 a[132:135], v242 offset:33792
buffer_load_dwordx4 v238, s[48:51], s69 offen offset:2048 sc1 lds
MV 132,a,164,a,24
MV 136,a,164,a,28
ds_read_b128 a[136:139], v242 offset:34816
MV 140,a,168,a,24
ds_read_b128 a[140:143], v242 offset:35840
MV 144,a,168,a,28
buffer_load_dwordx4 v238, s[48:51], s69 offen offset:3072 sc1 lds
MV 148,a,172,a,24
ds_read_b128 a[144:147], v243 offset:32768
MV 152,a,172,a,28
ds_read_b128 a[148:151], v243 offset:33792
MV 156,a,176,a,24
MV 160,a,176,a,28
ds_read_b128 a[152:155], v243 offset:34816
s_add_u32 s69, s69, 16384
MV 164,a,180,a,24
ds_read_b128 a[156:159], v243 offset:35840
MV 168,a,180,a,28
MV 172,a,184,a,24
MV 176,a,184,a,28
MV 180,a,188,a,24
buffer_load_dwordx4 a[24:27], v236, s[44:47], s68 offen offset:1024 sc1
MV 184,a,188,a,28
buffer_load_dwordx4 a[28:31], v237, s[44:47], s68 offen offset:1024 sc1
s_add_u32 s68, s68, 2048
s_waitcnt lgkmcnt(0)
MV 124,a,128,a,32
ds_read_b128 a[160:163], v242 offset:40960
MV 128,a,128,a,36
ds_read_b128 a[164:167], v242 offset:41984
s_add_u32 m0, s70, 82944
MV 132,a,132,a,32
MV 136,a,132,a,36
ds_read_b128 a[168:171], v242 offset:43008
MV 140,a,136,a,32
ds_read_b128 a[172:175], v242 offset:44032
MV 144,a,136,a,36
buffer_load_dwordx4 v238, s[48:51], s69 offen offset:0 sc1 lds
MV 148,a,140,a,32
ds_read_b128 a[176:179], v243 offset:40960
MV 152,a,140,a,36
ds_read_b128 a[180:183], v243 offset:41984
MV 156,a,144,a,32
MV 160,a,144,a,36
ds_read_b128 a[184:187], v243 offset:43008
buffer_load_dwordx4 v238, s[48:51], s69 offen offset:1024 sc1 lds
MV 164,a,148,a,32
ds_read_b128 a[188:191], v243 offset:44032
MV 168,a,148,a,36
MV 172,a,152,a,32
MV 176,a,152,a,36
MV 180,a,156,a,32
buffer_load_dwordx4 a[32:35], v236, s[44:47], s68 offen offset:0 sc1
MV 184,a,156,a,36
buffer_load_dwordx4 a[36:39], v237, s[44:47], s68 offen offset:0 sc1
s_waitcnt vmcnt(14) lgkmcnt(0)
s_barrier
MV 124,a,160,a,40
ds_read_b128 a[128:131], v242 offset:49152
MV 128,a,160,a,44
ds_read_b128 a[132:135], v242 offset:50176
buffer_load_dwordx4 v238, s[48:51], s69 offen offset:2048 sc1 lds
MV 132,a,164,a,40
MV 136,a,164,a,44
ds_read_b128 a[136:139], v242 offset:51200
MV 140,a,168,a,40
ds_read_b128 a[140:143], v242 offset:52224
MV 144,a,168,a,44
buffer_load_dwordx4 v238, s[48:51], s69 offen offset:3072 sc1 lds
MV 148,a,172,a,40
ds_read_b128 a[144:147], v243 offset:49152
MV 152,a,172,a,44
ds_read_b128 a[148:151], v243 offset:50176
MV 156,a,176,a,40
MV 160,a,176,a,44
ds_read_b128 a[152:155], v243 offset:51200
s_add_u32 s69, s69, 16384
MV 164,a,180,a,40
ds_read_b128 a[156:159], v243 offset:52224
MV 168,a,180,a,44
MV 172,a,184,a,40
MV 176,a,184,a,44
MV 180,a,188,a,40
buffer_load_dwordx4 a[40:43], v236, s[44:47], s68 offen offset:1024 sc1
MV 184,a,188,a,44
buffer_load_dwordx4 a[44:47], v237, s[44:47], s68 offen offset:1024 sc1
s_add_u32 s68, s68, 2048
s_waitcnt lgkmcnt(0)
MV 124,a,128,a,48
ds_read_b128 a[160:163], v242 offset:57344
MV 128,a,128,a,52
ds_read_b128 a[164:167], v242 offset:58368
s_add_u32 m0, s70, 99328
MV 132,a,132,a,48
MV 136,a,132,a,52
ds_read_b128 a[168:171], v242 offset:59392
MV 140,a,136,a,48
ds_read_b128 a[172:175], v242 offset:60416
MV 144,a,136,a,52
buffer_load_dwordx4 v238, s[48:51], s69 offen offset:0 sc1 lds
MV 148,a,140,a,48
ds_read_b128 a[176:179], v243 offset:57344
MV 152,a,140,a,52
ds_read_b128 a[180:183], v243 offset:58368
MV 156,a,144,a,48
MV 160,a,144,a,52
ds_read_b128 a[184:187], v243 offset:59392
buffer_load_dwordx4 v238, s[48:51], s69 offen offset:1024 sc1 lds
MV 164,a,148,a,48
ds_read_b128 a[188:191], v243 offset:60416
MV 168,a,148,a,52
MV 172,a,152,a,48
MV 176,a,152,a,52
MV 180,a,156,a,48
buffer_load_dwordx4 a[48:51], v236, s[44:47], s68 offen offset:0 sc1
MV 184,a,156,a,52
buffer_load_dwordx4 a[52:55], v237, s[44:47], s68 offen offset:0 sc1
s_waitcnt vmcnt(14) lgkmcnt(0)
s_barrier
MV 124,a,160,a,56
ds_read_b128 a[128:131], v242 offset:0
MV 128,a,160,a,60
ds_read_b128 a[132:135], v242 offset:1024
buffer_load_dwordx4 v238, s[48:51], s69 offen offset:2048 sc1 lds
MV 132,a,164,a,56
MV 136,a,164,a,60
ds_read_b128 a[136:139], v242 offset:2048
MV 140,a,168,a,56
ds_read_b128 a[140:143], v242 offset:3072
MV 144,a,168,a,60
buffer_load_dwordx4 v238, s[48:51], s69 offen offset:3072 sc1 lds
MV 148,a,172,a,56
ds_read_b128 a[144:147], v243 offset:0
MV 152,a,172,a,60
ds_read_b128 a[148:151], v243 offset:1024
MV 156,a,176,a,56
MV 160,a,176,a,60
ds_read_b128 a[152:155], v243 offset:2048
s_add_u32 s69, s69, 16384
MV 164,a,180,a,56
ds_read_b128 a[156:159], v243 offset:3072
MV 168,a,180,a,60
MV 172,a,184,a,56
MV 176,a,184,a,60
MV 180,a,188,a,56
buffer_load_dwordx4 a[56:59], v236, s[44:47], s68 offen offset:1024 sc1
MV 184,a,188,a,60
buffer_load_dwordx4 a[60:63], v237, s[44:47], s68 offen offset:1024 sc1
s_add_u32 s68, s68, 2048
s_waitcnt lgkmcnt(0)
MV 124,a,128,a,0
ds_read_b128 a[160:163], v242 offset:8192
MV 128,a,128,a,4
ds_read_b128 a[164:167], v242 offset:9216
s_add_u32 m0, s70, 115712
MV 132,a,132,a,0
MV 136,a,132,a,4
ds_read_b128 a[168:171], v242 offset:10240
MV 140,a,136,a,0
ds_read_b128 a[172:175], v242 offset:11264
MV 144,a,136,a,4
buffer_load_dwordx4 v238, s[48:51], s69 offen offset:0 sc1 lds
MV 148,a,140,a,0
ds_read_b128 a[176:179], v243 offset:8192
MV 152,a,140,a,4
ds_read_b128 a[180:183], v243 offset:9216
MV 156,a,144,a,0
MV 160,a,144,a,4
ds_read_b128 a[184:187], v243 offset:10240
buffer_load_dwordx4 v238, s[48:51], s69 offen offset:1024 sc1 lds
MV 164,a,148,a,0
ds_read_b128 a[188:191], v243 offset:11264
MV 168,a,148,a,4
MV 172,a,152,a,0
MV 176,a,152,a,4
MV 180,a,156,a,0
buffer_load_dwordx4 a[0:3], v236, s[44:47], s68 offen offset:0 sc1
MV 184,a,156,a,4
buffer_load_dwordx4 a[4:7], v237, s[44:47], s68 offen offset:0 sc1
s_waitcnt vmcnt(14) lgkmcnt(0)
s_barrier
MV 124,a,160,a,8
ds_read_b128 a[128:131], v242 offset:16384
MV 128,a,160,a,12
ds_read_b128 a[132:135], v242 offset:17408
buffer_load_dwordx4 v238, s[48:51], s69 offen offset:2048 sc1 lds
MV 132,a,164,a,8
MV 136,a,164,a,12
ds_read_b128 a[136:139], v242 offset:18432
MV 140,a,168,a,8
ds_read_b128 a[140:143], v242 offset:19456
MV 144,a,168,a,12
buffer_load_dwordx4 v238, s[48:51], s69 offen offset:3072 sc1 lds
MV 148,a,172,a,8
ds_read_b128 a[144:147], v243 offset:16384
MV 152,a,172,a,12
ds_read_b128 a[148:151], v243 offset:17408
MV 156,a,176,a,8
MV 160,a,176,a,12
ds_read_b128 a[152:155], v243 offset:18432
s_add_u32 s69, s69, 16384
MV 164,a,180,a,8
ds_read_b128 a[156:159], v243 offset:19456
MV 168,a,180,a,12
MV 172,a,184,a,8
MV 176,a,184,a,12
MV 180,a,188,a,8
buffer_load_dwordx4 a[8:11], v236, s[44:47], s68 offen offset:1024 sc1
MV 184,a,188,a,12
buffer_load_dwordx4 a[12:15], v237, s[44:47], s68 offen offset:1024 sc1
s_add_u32 s68, s68, 2048
s_waitcnt lgkmcnt(0)
MV 124,a,128,a,16
ds_read_b128 a[160:163], v242 offset:24576
MV 128,a,128,a,20
ds_read_b128 a[164:167], v242 offset:25600
s_add_u32 m0, s70, 66560
MV 132,a,132,a,16
MV 136,a,132,a,20
ds_read_b128 a[168:171], v242 offset:26624
MV 140,a,136,a,16
ds_read_b128 a[172:175], v242 offset:27648
MV 144,a,136,a,20
buffer_load_dwordx4 v238, s[48:51], s69 offen offset:0 sc1 lds
MV 148,a,140,a,16
ds_read_b128 a[176:179], v243 offset:24576
MV 152,a,140,a,20
ds_read_b128 a[180:183], v243 offset:25600
MV 156,a,144,a,16
MV 160,a,144,a,20
ds_read_b128 a[184:187], v243 offset:26624
buffer_load_dwordx4 v238, s[48:51], s69 offen offset:1024 sc1 lds
MV 164,a,148,a,16
ds_read_b128 a[188:191], v243 offset:27648
MV 168,a,148,a,20
MV 172,a,152,a,16
MV 176,a,152,a,20
MV 180,a,156,a,16
buffer_load_dwordx4 a[16:19], v236, s[44:47], s68 offen offset:0 sc1
MV 184,a,156,a,20
buffer_load_dwordx4 a[20:23], v237, s[44:47], s68 offen offset:0 sc1
s_waitcnt vmcnt(14) lgkmcnt(0)
s_barrier
MV 124,a,160,a,24
ds_read_b128 a[128:131], v242 offset:32768
MV 128,a,160,a,28
ds_read_b128 a[132:135], v242 offset:33792
buffer_load_dwordx4 v238, s[48:51], s69 offen offset:2048 sc1 lds
MV 132,a,164,a,24
MV 136,a,164,a,28
ds_read_b128 a[136:139], v242 offset:34816
MV 140,a,168,a,24
ds_read_b128 a[140:143], v242 offset:35840
MV 144,a,168,a,28
buffer_load_dwordx4 v238, s[48:51], s69 offen offset:3072 sc1 lds
MV 148,a,172,a,24
ds_read_b128 a[144:147], v243 offset:32768
MV 152,a,172,a,28
ds_read_b128 a[148:151], v243 offset:33792
MV 156,a,176,a,24
MV 160,a,176,a,28
ds_read_b128 a[152:155], v243 offset:34816
s_add_u32 s69, s69, 16384
MV 164,a,180,a,24
ds_read_b128 a[156:159], v243 offset:35840
MV 168,a,180,a,28
MV 172,a,184,a,24
MV 176,a,184,a,28
MV 180,a,188,a,24
buffer_load_dwordx4 a[24:27], v236, s[44:47], s68 offen offset:1024 sc1
MV 184,a,188,a,28
buffer_load_dwordx4 a[28:31], v237, s[44:47], s68 offen offset:1024 sc1
s_add_u32 s68, s68, 2048
s_waitcnt lgkmcnt(0)
MV 124,a,128,a,32
ds_read_b128 a[160:163], v242 offset:40960
v_and_b32 v254, 15, v1
MV 128,a,128,a,36
ds_read_b128 a[164:167], v242 offset:41984
s_add_u32 m0, s70, 82944
MV 132,a,132,a,32
MV 136,a,132,a,36
ds_read_b128 a[168:171], v242 offset:43008
MV 140,a,136,a,32
ds_read_b128 a[172:175], v242 offset:44032
s_lshl_b32 s36, s82, 4
MV 144,a,136,a,36
buffer_load_dwordx4 v238, s[48:51], s69 offen offset:0 sc1 lds
MV 148,a,140,a,32
ds_read_b128 a[176:179], v243 offset:40960
MV 152,a,140,a,36
ds_read_b128 a[180:183], v243 offset:41984
MV 156,a,144,a,32
v_add_u32 v254, s36, v254
MV 160,a,144,a,36
ds_read_b128 a[184:187], v243 offset:43008
buffer_load_dwordx4 v238, s[48:51], s69 offen offset:1024 sc1 lds
MV 164,a,148,a,32
ds_read_b128 a[188:191], v243 offset:44032
MV 168,a,148,a,36
MV 172,a,152,a,32
v_lshlrev_b32 v254, 2, v254
MV 176,a,152,a,36
MV 180,a,156,a,32
buffer_load_dwordx4 a[32:35], v236, s[44:47], s68 offen offset:0 sc1
MV 184,a,156,a,36
buffer_load_dwordx4 a[36:39], v237, s[44:47], s68 offen offset:0 sc1
s_waitcnt vmcnt(14) lgkmcnt(0)
s_barrier
MV 124,a,160,a,40
ds_read_b128 a[128:131], v242 offset:49152
buffer_load_dword v253, v254, s[8:11], 0 offen offset:3072 sc1
MV 128,a,160,a,44
ds_read_b128 a[132:135], v242 offset:50176
buffer_load_dwordx4 v238, s[48:51], s69 offen offset:2048 sc1 lds
MV 132,a,164,a,40
MV 136,a,164,a,44
ds_read_b128 a[136:139], v242 offset:51200
MV 140,a,168,a,40
ds_read_b128 a[140:143], v242 offset:52224
MV 144,a,168,a,44
buffer_load_dwordx4 v238, s[48:51], s69 offen offset:3072 sc1 lds
MV 148,a,172,a,40
ds_read_b128 a[144:147], v243 offset:49152
MV 152,a,172,a,44
ds_read_b128 a[148:151], v243 offset:50176
MV 156,a,176,a,40
MV 160,a,176,a,44
ds_read_b128 a[152:155], v243 offset:51200
s_add_u32 s69, s69, 16384
MV 164,a,180,a,40
ds_read_b128 a[156:159], v243 offset:52224
MV 168,a,180,a,44
MV 172,a,184,a,40
MV 176,a,184,a,44
MV 180,a,188,a,40
buffer_load_dwordx4 a[40:43], v236, s[44:47], s68 offen offset:1024 sc1
MV 184,a,188,a,44
buffer_load_dwordx4 a[44:47], v237, s[44:47], s68 offen offset:1024 sc1
s_add_u32 s68, s68, 2048
s_waitcnt lgkmcnt(0)
MV 124,a,128,a,48
ds_read_b128 a[160:163], v242 offset:57344
MV 128,a,128,a,52
ds_read_b128 a[164:167], v242 offset:58368
s_add_u32 m0, s70, 99328
MV 132,a,132,a,48
MV 136,a,132,a,52
ds_read_b128 a[168:171], v242 offset:59392
MV 140,a,136,a,48
ds_read_b128 a[172:175], v242 offset:60416
MV 144,a,136,a,52
buffer_load_dwordx4 v238, s[48:51], s69 offen offset:0 sc1 lds
MV 148,a,140,a,48
ds_read_b128 a[176:179], v243 offset:57344
MV 152,a,140,a,52
ds_read_b128 a[180:183], v243 offset:58368
MV 156,a,144,a,48
MV 160,a,144,a,52
ds_read_b128 a[184:187], v243 offset:59392
buffer_load_dwordx4 v238, s[48:51], s69 offen offset:1024 sc1 lds
MV 164,a,148,a,48
ds_read_b128 a[188:191], v243 offset:60416
MV 168,a,148,a,52
MV 172,a,152,a,48
MV 176,a,152,a,52
MV 180,a,156,a,48
buffer_load_dwordx4 a[48:51], v236, s[44:47], s68 offen offset:0 sc1
MV 184,a,156,a,52
buffer_load_dwordx4 a[52:55], v237, s[44:47], s68 offen offset:0 sc1
s_waitcnt vmcnt(15) lgkmcnt(0)
s_barrier
MV 124,a,160,a,56
ds_read_b128 a[128:131], v242 offset:0
MV 128,a,160,a,60
ds_read_b128 a[132:135], v242 offset:1024
buffer_load_dwordx4 v238, s[48:51], s69 offen offset:2048 sc1 lds
MV 132,a,164,a,56
MV 136,a,164,a,60
ds_read_b128 a[136:139], v242 offset:2048
MV 140,a,168,a,56
ds_read_b128 a[140:143], v242 offset:3072
MV 144,a,168,a,60
buffer_load_dwordx4 v238, s[48:51], s69 offen offset:3072 sc1 lds
MV 148,a,172,a,56
ds_read_b128 a[144:147], v243 offset:0
MV 152,a,172,a,60
ds_read_b128 a[148:151], v243 offset:1024
MV 156,a,176,a,56
MV 160,a,176,a,60
ds_read_b128 a[152:155], v243 offset:2048
s_add_u32 s69, s69, 16384
MV 164,a,180,a,56
ds_read_b128 a[156:159], v243 offset:3072
MV 168,a,180,a,60
MV 172,a,184,a,56
MV 176,a,184,a,60
MV 180,a,188,a,56
buffer_load_dwordx4 a[56:59], v236, s[44:47], s68 offen offset:1024 sc1
MV 184,a,188,a,60
buffer_load_dwordx4 a[60:63], v237, s[44:47], s68 offen offset:1024 sc1
s_add_u32 s68, s68, 2048
s_waitcnt lgkmcnt(0)
MV 124,a,128,a,0
ds_read_b128 a[160:163], v242 offset:8192
MV 128,a,128,a,4
ds_read_b128 a[164:167], v242 offset:9216
s_add_u32 m0, s70, 115712
MV 132,a,132,a,0
MV 136,a,132,a,4
ds_read_b128 a[168:171], v242 offset:10240
MV 140,a,136,a,0
ds_read_b128 a[172:175], v242 offset:11264
MV 144,a,136,a,4
buffer_load_dwordx4 v238, s[48:51], s69 offen offset:0 sc1 lds
MV 148,a,140,a,0
ds_read_b128 a[176:179], v243 offset:8192
MV 152,a,140,a,4
ds_read_b128 a[180:183], v243 offset:9216
MV 156,a,144,a,0
MV 160,a,144,a,4
ds_read_b128 a[184:187], v243 offset:10240
buffer_load_dwordx4 v238, s[48:51], s69 offen offset:1024 sc1 lds
MV 164,a,148,a,0
ds_read_b128 a[188:191], v243 offset:11264
MV 168,a,148,a,4
MV 172,a,152,a,0
MV 176,a,152,a,4
MV 180,a,156,a,0
buffer_load_dwordx4 a[0:3], v236, s[44:47], s68 offen offset:0 sc1
MV 184,a,156,a,4
buffer_load_dwordx4 a[4:7], v237, s[44:47], s68 offen offset:0 sc1
s_waitcnt vmcnt(14) lgkmcnt(0)
s_barrier
MV 124,a,160,a,8
ds_read_b128 a[128:131], v242 offset:16384
MV 128,a,160,a,12
ds_read_b128 a[132:135], v242 offset:17408
buffer_load_dwordx4 v238, s[48:51], s69 offen offset:2048 sc1 lds
MV 132,a,164,a,8
MV 136,a,164,a,12
ds_read_b128 a[136:139], v242 offset:18432
MV 140,a,168,a,8
ds_read_b128 a[140:143], v242 offset:19456
MV 144,a,168,a,12
buffer_load_dwordx4 v238, s[48:51], s69 offen offset:3072 sc1 lds
MV 148,a,172,a,8
ds_read_b128 a[144:147], v243 offset:16384
MV 152,a,172,a,12
ds_read_b128 a[148:151], v243 offset:17408
MV 156,a,176,a,8
MV 160,a,176,a,12
ds_read_b128 a[152:155], v243 offset:18432
s_add_u32 s69, s69, 16384
MV 164,a,180,a,8
ds_read_b128 a[156:159], v243 offset:19456
MV 168,a,180,a,12
MV 172,a,184,a,8
MV 176,a,184,a,12
MV 180,a,188,a,8
buffer_load_dwordx4 a[8:11], v236, s[44:47], s68 offen offset:1024 sc1
MV 184,a,188,a,12
buffer_load_dwordx4 a[12:15], v237, s[44:47], s68 offen offset:1024 sc1
s_add_u32 s68, s68, 2048
s_waitcnt lgkmcnt(0)
MV 124,a,128,a,16
ds_read_b128 a[160:163], v242 offset:24576
MV 128,a,128,a,20
ds_read_b128 a[164:167], v242 offset:25600
s_add_u32 m0, s70, 66560
MV 132,a,132,a,16
MV 136,a,132,a,20
ds_read_b128 a[168:171], v242 offset:26624
MV 140,a,136,a,16
ds_read_b128 a[172:175], v242 offset:27648
MV 144,a,136,a,20
buffer_load_dwordx4 v238, s[48:51], s69 offen offset:0 sc1 lds
MV 148,a,140,a,16
ds_read_b128 a[176:179], v243 offset:24576
MV 152,a,140,a,20
ds_read_b128 a[180:183], v243 offset:25600
MV 156,a,144,a,16
MV 160,a,144,a,20
ds_read_b128 a[184:187], v243 offset:26624
buffer_load_dwordx4 v238, s[48:51], s69 offen offset:1024 sc1 lds
MV 164,a,148,a,16
ds_read_b128 a[188:191], v243 offset:27648
MV 168,a,148,a,20
MV 172,a,152,a,16
MV 176,a,152,a,20
MV 180,a,156,a,16
buffer_load_dwordx4 a[16:19], v236, s[44:47], s68 offen offset:0 sc1
MV 184,a,156,a,20
buffer_load_dwordx4 a[20:23], v237, s[44:47], s68 offen offset:0 sc1
s_waitcnt vmcnt(14) lgkmcnt(0)
s_barrier
MV 124,a,160,a,24
ds_read_b128 a[128:131], v242 offset:32768
MV 128,a,160,a,28
ds_read_b128 a[132:135], v242 offset:33792
buffer_load_dwordx4 v238, s[48:51], s69 offen offset:2048 sc1 lds
MV 132,a,164,a,24
MV 136,a,164,a,28
ds_read_b128 a[136:139], v242 offset:34816
MV 140,a,168,a,24
ds_read_b128 a[140:143], v242 offset:35840
MV 144,a,168,a,28
buffer_load_dwordx4 v238, s[48:51], s69 offen offset:3072 sc1 lds
MV 148,a,172,a,24
ds_read_b128 a[144:147], v243 offset:32768
MV 152,a,172,a,28
ds_read_b128 a[148:151], v243 offset:33792
MV 156,a,176,a,24
MV 160,a,176,a,28
ds_read_b128 a[152:155], v243 offset:34816
s_add_u32 s69, s69, 16384
MV 164,a,180,a,24
ds_read_b128 a[156:159], v243 offset:35840
MV 168,a,180,a,28
MV 172,a,184,a,24
MV 176,a,184,a,28
MV 180,a,188,a,24
buffer_load_dwordx4 a[24:27], v236, s[44:47], s68 offen offset:1024 sc1
MV 184,a,188,a,28
buffer_load_dwordx4 a[28:31], v237, s[44:47], s68 offen offset:1024 sc1
s_add_u32 s68, s68, 2048
s_waitcnt lgkmcnt(0)
MV 124,a,128,a,32
ds_read_b128 a[160:163], v242 offset:40960
MV 128,a,128,a,36
ds_read_b128 a[164:167], v242 offset:41984
s_add_u32 m0, s70, 82944
MV 132,a,132,a,32
MV 136,a,132,a,36
ds_read_b128 a[168:171], v242 offset:43008
MV 140,a,136,a,32
ds_read_b128 a[172:175], v242 offset:44032
MV 144,a,136,a,36
buffer_load_dwordx4 v238, s[48:51], s69 offen offset:0 sc1 lds
MV 148,a,140,a,32
ds_read_b128 a[176:179], v243 offset:40960
MV 152,a,140,a,36
ds_read_b128 a[180:183], v243 offset:41984
MV 156,a,144,a,32
MV 160,a,144,a,36
ds_read_b128 a[184:187], v243 offset:43008
buffer_load_dwordx4 v238, s[48:51], s69 offen offset:1024 sc1 lds
MV 164,a,148,a,32
ds_read_b128 a[188:191], v243 offset:44032
MV 168,a,148,a,36
MV 172,a,152,a,32
MV 176,a,152,a,36
MV 180,a,156,a,32
buffer_load_dwordx4 a[32:35], v236, s[44:47], s68 offen offset:0 sc1
MV 184,a,156,a,36
buffer_load_dwordx4 a[36:39], v237, s[44:47], s68 offen offset:0 sc1
s_waitcnt vmcnt(14) lgkmcnt(0)
s_barrier
MV 124,a,160,a,40
ds_read_b128 a[128:131], v242 offset:49152
MV 128,a,160,a,44
ds_read_b128 a[132:135], v242 offset:50176
buffer_load_dwordx4 v238, s[48:51], s69 offen offset:2048 sc1 lds
MV 132,a,164,a,40
MV 136,a,164,a,44
ds_read_b128 a[136:139], v242 offset:51200
MV 140,a,168,a,40
ds_read_b128 a[140:143], v242 offset:52224
MV 144,a,168,a,44
buffer_load_dwordx4 v238, s[48:51], s69 offen offset:3072 sc1 lds
MV 148,a,172,a,40
ds_read_b128 a[144:147], v243 offset:49152
MV 152,a,172,a,44
ds_read_b128 a[148:151], v243 offset:50176
MV 156,a,176,a,40
MV 160,a,176,a,44
ds_read_b128 a[152:155], v243 offset:51200
s_add_u32 s69, s69, 16384
MV 164,a,180,a,40
ds_read_b128 a[156:159], v243 offset:52224
MV 168,a,180,a,44
MV 172,a,184,a,40
MV 176,a,184,a,44
MV 180,a,188,a,40
buffer_load_dwordx4 a[40:43], v236, s[44:47], s68 offen offset:1024 sc1
MV 184,a,188,a,44
buffer_load_dwordx4 a[44:47], v237, s[44:47], s68 offen offset:1024 sc1
s_add_u32 s68, s68, 2048
s_waitcnt lgkmcnt(0)
MV 124,a,128,a,48
ds_read_b128 a[160:163], v242 offset:57344
MV 128,a,128,a,52
ds_read_b128 a[164:167], v242 offset:58368
s_add_u32 m0, s70, 99328
MV 132,a,132,a,48
MV 136,a,132,a,52
ds_read_b128 a[168:171], v242 offset:59392
MV 140,a,136,a,48
ds_read_b128 a[172:175], v242 offset:60416
MV 144,a,136,a,52
buffer_load_dwordx4 v238, s[48:51], s69 offen offset:0 sc1 lds
MV 148,a,140,a,48
ds_read_b128 a[176:179], v243 offset:57344
MV 152,a,140,a,52
ds_read_b128 a[180:183], v243 offset:58368
MV 156,a,144,a,48
MV 160,a,144,a,52
ds_read_b128 a[184:187], v243 offset:59392
buffer_load_dwordx4 v238, s[48:51], s69 offen offset:1024 sc1 lds
MV 164,a,148,a,48
ds_read_b128 a[188:191], v243 offset:60416
MV 168,a,148,a,52
MV 172,a,152,a,48
MV 176,a,152,a,52
MV 180,a,156,a,48
buffer_load_dwordx4 a[48:51], v236, s[44:47], s68 offen offset:0 sc1
MV 184,a,156,a,52
buffer_load_dwordx4 a[52:55], v237, s[44:47], s68 offen offset:0 sc1
s_waitcnt vmcnt(14) lgkmcnt(0)
s_barrier
MV 124,a,160,a,56
ds_read_b128 a[128:131], v242 offset:0
MV 128,a,160,a,60
ds_read_b128 a[132:135], v242 offset:1024
buffer_load_dwordx4 v238, s[48:51], s69 offen offset:2048 sc1 lds
MV 132,a,164,a,56
MV 136,a,164,a,60
ds_read_b128 a[136:139], v242 offset:2048
MV 140,a,168,a,56
ds_read_b128 a[140:143], v242 offset:3072
MV 144,a,168,a,60
buffer_load_dwordx4 v238, s[48:51], s69 offen offset:3072 sc1 lds
MV 148,a,172,a,56
ds_read_b128 a[144:147], v243 offset:0
MV 152,a,172,a,60
ds_read_b128 a[148:151], v243 offset:1024
MV 156,a,176,a,56
MV 160,a,176,a,60
ds_read_b128 a[152:155], v243 offset:2048
s_add_u32 s69, s69, 16384
MV 164,a,180,a,56
ds_read_b128 a[156:159], v243 offset:3072
MV 168,a,180,a,60
MV 172,a,184,a,56
MV 176,a,184,a,60
MV 180,a,188,a,56
buffer_load_dwordx4 a[56:59], v236, s[44:47], s68 offen offset:1024 sc1
MV 184,a,188,a,60
buffer_load_dwordx4 a[60:63], v237, s[44:47], s68 offen offset:1024 sc1
s_add_u32 s68, s68, 2048
s_waitcnt lgkmcnt(0)
MV 124,a,128,a,0
ds_read_b128 a[160:163], v242 offset:8192
MV 128,a,128,a,4
ds_read_b128 a[164:167], v242 offset:9216
s_add_u32 m0, s70, 115712
MV 132,a,132,a,0
MV 136,a,132,a,4
ds_read_b128 a[168:171], v242 offset:10240
MV 140,a,136,a,0
ds_read_b128 a[172:175], v242 offset:11264
MV 144,a,136,a,4
buffer_load_dwordx4 v238, s[48:51], s69 offen offset:0 sc1 lds
MV 148,a,140,a,0
ds_read_b128 a[176:179], v243 offset:8192
MV 152,a,140,a,4
ds_read_b128 a[180:183], v243 offset:9216
MV 156,a,144,a,0
MV 160,a,144,a,4
ds_read_b128 a[184:187], v243 offset:10240
buffer_load_dwordx4 v238, s[48:51], s69 offen offset:1024 sc1 lds
MV 164,a,148,a,0
ds_read_b128 a[188:191], v243 offset:11264
MV 168,a,148,a,4
MV 172,a,152,a,0
MV 176,a,152,a,4
MV 180,a,156,a,0
buffer_load_dwordx4 a[0:3], v236, s[44:47], s68 offen offset:0 sc1
MV 184,a,156,a,4
buffer_load_dwordx4 a[4:7], v237, s[44:47], s68 offen offset:0 sc1
s_waitcnt vmcnt(14) lgkmcnt(0)
s_barrier
MV 124,a,160,a,8
ds_read_b128 a[128:131], v242 offset:16384
MV 128,a,160,a,12
ds_read_b128 a[132:135], v242 offset:17408
buffer_load_dwordx4 v238, s[48:51], s69 offen offset:2048 sc1 lds
MV 132,a,164,a,8
MV 136,a,164,a,12
ds_read_b128 a[136:139], v242 offset:18432
MV 140,a,168,a,8
ds_read_b128 a[140:143], v242 offset:19456
MV 144,a,168,a,12
buffer_load_dwordx4 v238, s[48:51], s69 offen offset:3072 sc1 lds
MV 148,a,172,a,8
ds_read_b128 a[144:147], v243 offset:16384
MV 152,a,172,a,12
ds_read_b128 a[148:151], v243 offset:17408
MV 156,a,176,a,8
MV 160,a,176,a,12
ds_read_b128 a[152:155], v243 offset:18432
s_add_u32 s69, s69, 16384
MV 164,a,180,a,8
ds_read_b128 a[156:159], v243 offset:19456
MV 168,a,180,a,12
MV 172,a,184,a,8
MV 176,a,184,a,12
MV 180,a,188,a,8
buffer_load_dwordx4 a[8:11], v236, s[44:47], s68 offen offset:1024 sc1
MV 184,a,188,a,12
buffer_load_dwordx4 a[12:15], v237, s[44:47], s68 offen offset:1024 sc1
s_add_u32 s68, s68, 2048
s_waitcnt lgkmcnt(0)
MV 124,a,128,a,16
ds_read_b128 a[160:163], v242 offset:24576
MV 128,a,128,a,20
ds_read_b128 a[164:167], v242 offset:25600
s_add_u32 m0, s70, 66560
MV 132,a,132,a,16
v_cmp_gt_u32 vcc, 1, v253
s_nop 4
s_cbranch_vccnz L_spin_f3
L_spin_f3_ret:
MV 136,a,132,a,20
ds_read_b128 a[168:171], v242 offset:26624
MV 140,a,136,a,16
ds_read_b128 a[172:175], v242 offset:27648
MV 144,a,136,a,20
buffer_load_dwordx4 v238, s[48:51], s69 offen offset:0 sc1 lds
MV 148,a,140,a,16
ds_read_b128 a[176:179], v243 offset:24576
MV 152,a,140,a,20
ds_read_b128 a[180:183], v243 offset:25600
MV 156,a,144,a,16
MV 160,a,144,a,20
ds_read_b128 a[184:187], v243 offset:26624
buffer_load_dwordx4 v238, s[48:51], s69 offen offset:1024 sc1 lds
MV 164,a,148,a,16
ds_read_b128 a[188:191], v243 offset:27648
MV 168,a,148,a,20
MV 172,a,152,a,16
s_add_u32 s72, s79, 0
MV 176,a,152,a,20
MV 180,a,156,a,16
buffer_load_dwordx4 a[16:19], v236, s[44:47], s68 offen offset:0 sc1
buffer_load_dwordx2 v[208:209], v251, s[56:59], s72 offen offset:0 sc1
MV 184,a,156,a,20
buffer_load_dwordx4 a[20:23], v237, s[44:47], s68 offen offset:0 sc1
s_waitcnt vmcnt(15) lgkmcnt(0)
s_barrier
MV 124,a,160,a,24
ds_read_b128 a[128:131], v242 offset:32768
s_add_u32 s72, s79, 16384
MV 128,a,160,a,28
ds_read_b128 a[132:135], v242 offset:33792
buffer_load_dwordx4 v238, s[48:51], s69 offen offset:2048 sc1 lds
MV 132,a,164,a,24
MV 136,a,164,a,28
ds_read_b128 a[136:139], v242 offset:34816
MV 140,a,168,a,24
ds_read_b128 a[140:143], v242 offset:35840
MV 144,a,168,a,28
buffer_load_dwordx4 v238, s[48:51], s69 offen offset:3072 sc1 lds
MV 148,a,172,a,24
ds_read_b128 a[144:147], v243 offset:32768
MV 152,a,172,a,28
ds_read_b128 a[148:151], v243 offset:33792
MV 156,a,176,a,24
buffer_load_dwordx2 v[210:211], v251, s[56:59], s72 offen offset:0 sc1
MV 160,a,176,a,28
ds_read_b128 a[152:155], v243 offset:34816
s_add_u32 s69, s69, 16384
MV 164,a,180,a,24
ds_read_b128 a[156:159], v243 offset:35840
MV 168,a,180,a,28
MV 172,a,184,a,24
MV 176,a,184,a,28
MV 180,a,188,a,24
buffer_load_dwordx4 a[24:27], v236, s[44:47], s68 offen offset:1024 sc1
MV 184,a,188,a,28
buffer_load_dwordx4 a[28:31], v237, s[44:47], s68 offen offset:1024 sc1
s_add_u32 s68, s68, 2048
s_waitcnt lgkmcnt(0)
MV 124,a,128,a,32
ds_read_b128 a[160:163], v242 offset:40960
s_add_u32 s72, s79, 131072
MV 128,a,128,a,36
ds_read_b128 a[164:167], v242 offset:41984
s_add_u32 m0, s70, 82944
MV 132,a,132,a,32
MV 136,a,132,a,36
ds_read_b128 a[168:171], v242 offset:43008
MV 140,a,136,a,32
ds_read_b128 a[172:175], v242 offset:44032
MV 144,a,136,a,36
buffer_load_dwordx4 v238, s[48:51], s69 offen offset:0 sc1 lds
MV 148,a,140,a,32
ds_read_b128 a[176:179], v243 offset:40960
MV 152,a,140,a,36
ds_read_b128 a[180:183], v243 offset:41984
MV 156,a,144,a,32
buffer_load_dwordx2 v[212:213], v251, s[56:59], s72 offen offset:0 sc1
MV 160,a,144,a,36
ds_read_b128 a[184:187], v243 offset:43008
buffer_load_dwordx4 v238, s[48:51], s69 offen offset:1024 sc1 lds
MV 164,a,148,a,32
ds_read_b128 a[188:191], v243 offset:44032
MV 168,a,148,a,36
MV 172,a,152,a,32
MV 176,a,152,a,36
MV 180,a,156,a,32
buffer_load_dwordx4 a[32:35], v236, s[44:47], s68 offen offset:0 sc1
MV 184,a,156,a,36
buffer_load_dwordx4 a[36:39], v237, s[44:47], s68 offen offset:0 sc1
s_waitcnt vmcnt(17) lgkmcnt(0)
s_barrier
MV 124,a,160,a,40
ds_read_b128 a[128:131], v242 offset:49152
s_add_u32 s72, s79, 147456
MV 128,a,160,a,44
ds_read_b128 a[132:135], v242 offset:50176
buffer_load_dwordx4 v238, s[48:51], s69 offen offset:2048 sc1 lds
MV 132,a,164,a,40
MV 136,a,164,a,44
ds_read_b128 a[136:139], v242 offset:51200
MV 140,a,168,a,40
ds_read_b128 a[140:143], v242 offset:52224
MV 144,a,168,a,44
buffer_load_dwordx4 v238, s[48:51], s69 offen offset:3072 sc1 lds
MV 148,a,172,a,40
ds_read_b128 a[144:147], v243 offset:49152
MV 152,a,172,a,44
ds_read_b128 a[148:151], v243 offset:50176
MV 156,a,176,a,40
buffer_load_dwordx2 v[214:215], v251, s[56:59], s72 offen offset:0 sc1
MV 160,a,176,a,44
ds_read_b128 a[152:155], v243 offset:51200
s_add_u32 s69, s69, 16384
MV 164,a,180,a,40
ds_read_b128 a[156:159], v243 offset:52224
MV 168,a,180,a,44
MV 172,a,184,a,40
MV 176,a,184,a,44
MV 180,a,188,a,40
buffer_load_dwordx4 a[40:43], v236, s[44:47], s68 offen offset:1024 sc1
MV 184,a,188,a,44
buffer_load_dwordx4 a[44:47], v237, s[44:47], s68 offen offset:1024 sc1
s_add_u32 s68, s68, 2048
s_waitcnt lgkmcnt(0)
MV 124,a,128,a,48
ds_read_b128 a[160:163], v242 offset:57344
s_add_u32 s72, s79, 0
MV 128,a,128,a,52
ds_read_b128 a[164:167], v242 offset:58368
s_add_u32 m0, s70, 99328
MV 132,a,132,a,48
MV 136,a,132,a,52
ds_read_b128 a[168:171], v242 offset:59392
MV 140,a,136,a,48
ds_read_b128 a[172:175], v242 offset:60416
MV 144,a,136,a,52
buffer_load_dwordx4 v238, s[48:51], s69 offen offset:0 sc1 lds
MV 148,a,140,a,48
ds_read_b128 a[176:179], v243 offset:57344
MV 152,a,140,a,52
ds_read_b128 a[180:183], v243 offset:58368
MV 156,a,144,a,48
buffer_load_dwordx2 v[216:217], v251, s[56:59], s72 offen offset:128 sc1
MV 160,a,144,a,52
ds_read_b128 a[184:187], v243 offset:59392
buffer_load_dwordx4 v238, s[48:51], s69 offen offset:1024 sc1 lds
MV 164,a,148,a,48
ds_read_b128 a[188:191], v243 offset:60416
MV 168,a,148,a,52
MV 172,a,152,a,48
MV 176,a,152,a,52
MV 180,a,156,a,48
buffer_load_dwordx4 a[48:51], v236, s[44:47], s68 offen offset:0 sc1
MV 184,a,156,a,52
buffer_load_dwordx4 a[52:55], v237, s[44:47], s68 offen offset:0 sc1
s_waitcnt vmcnt(18) lgkmcnt(0)
s_barrier
MV 124,a,160,a,56
ds_read_b128 a[128:131], v242 offset:0
s_add_u32 s72, s79, 16384
MV 128,a,160,a,60
ds_read_b128 a[132:135], v242 offset:1024
buffer_load_dwordx4 v238, s[48:51], s69 offen offset:2048 sc1 lds
MV 132,a,164,a,56
MV 136,a,164,a,60
ds_read_b128 a[136:139], v242 offset:2048
MV 140,a,168,a,56
ds_read_b128 a[140:143], v242 offset:3072
MV 144,a,168,a,60
buffer_load_dwordx4 v238, s[48:51], s69 offen offset:3072 sc1 lds
MV 148,a,172,a,56
ds_read_b128 a[144:147], v243 offset:0
MV 152,a,172,a,60
ds_read_b128 a[148:151], v243 offset:1024
MV 156,a,176,a,56
buffer_load_dwordx2 v[218:219], v251, s[56:59], s72 offen offset:128 sc1
MV 160,a,176,a,60
ds_read_b128 a[152:155], v243 offset:2048
s_add_u32 s69, s69, 16384
MV 164,a,180,a,56
ds_read_b128 a[156:159], v243 offset:3072
MV 168,a,180,a,60
MV 172,a,184,a,56
MV 176,a,184,a,60
MV 180,a,188,a,56
buffer_load_dwordx4 a[56:59], v236, s[44:47], s68 offen offset:1024 sc1
MV 184,a,188,a,60
buffer_load_dwordx4 a[60:63], v237, s[44:47], s68 offen offset:1024 sc1
s_add_u32 s68, s68, 2048
s_waitcnt lgkmcnt(0)
MV 124,a,128,a,0
ds_read_b128 a[160:163], v242 offset:8192
s_add_u32 s72, s79, 131072
MV 128,a,128,a,4
ds_read_b128 a[164:167], v242 offset:9216
s_add_u32 m0, s70, 115712
MV 132,a,132,a,0
MV 136,a,132,a,4
ds_read_b128 a[168:171], v242 offset:10240
MV 140,a,136,a,0
ds_read_b128 a[172:175], v242 offset:11264
MV 144,a,136,a,4
buffer_load_dwordx4 v238, s[48:51], s69 offen offset:0 sc1 lds
MV 148,a,140,a,0
ds_read_b128 a[176:179], v243 offset:8192
MV 152,a,140,a,4
ds_read_b128 a[180:183], v243 offset:9216
MV 156,a,144,a,0
buffer_load_dwordx2 v[220:221], v251, s[56:59], s72 offen offset:128 sc1
MV 160,a,144,a,4
ds_read_b128 a[184:187], v243 offset:10240
buffer_load_dwordx4 v238, s[48:51], s69 offen offset:1024 sc1 lds
MV 164,a,148,a,0
ds_read_b128 a[188:191], v243 offset:11264
MV 168,a,148,a,4
MV 172,a,152,a,0
MV 176,a,152,a,4
MV 180,a,156,a,0
MV 184,a,156,a,4
s_waitcnt vmcnt(16) lgkmcnt(0)
s_barrier
MV 124,a,160,a,8
ds_read_b128 a[128:131], v242 offset:16384
s_add_u32 s72, s79, 147456
MV 128,a,160,a,12
ds_read_b128 a[132:135], v242 offset:17408
buffer_load_dwordx4 v238, s[48:51], s69 offen offset:2048 sc1 lds
MV 132,a,164,a,8
MV 136,a,164,a,12
ds_read_b128 a[136:139], v242 offset:18432
MV 140,a,168,a,8
ds_read_b128 a[140:143], v242 offset:19456
MV 144,a,168,a,12
buffer_load_dwordx4 v238, s[48:51], s69 offen offset:3072 sc1 lds
MV 148,a,172,a,8
ds_read_b128 a[144:147], v243 offset:16384
MV 152,a,172,a,12
ds_read_b128 a[148:151], v243 offset:17408
MV 156,a,176,a,8
buffer_load_dwordx2 v[222:223], v251, s[56:59], s72 offen offset:128 sc1
MV 160,a,176,a,12
ds_read_b128 a[152:155], v243 offset:18432
s_add_u32 s69, s69, 16384
MV 164,a,180,a,8
ds_read_b128 a[156:159], v243 offset:19456
MV 168,a,180,a,12
MV 172,a,184,a,8
MV 176,a,184,a,12
MV 180,a,188,a,8
MV 184,a,188,a,12
s_waitcnt lgkmcnt(0)
MV 124,a,128,a,16
ds_read_b128 a[160:163], v242 offset:24576
MV 128,a,128,a,20
ds_read_b128 a[164:167], v242 offset:25600
MV 132,a,132,a,16
MV 136,a,132,a,20
ds_read_b128 a[168:171], v242 offset:26624
MV 140,a,136,a,16
ds_read_b128 a[172:175], v242 offset:27648
MV 144,a,136,a,20
MV 148,a,140,a,16
ds_read_b128 a[176:179], v243 offset:24576
MV 152,a,140,a,20
ds_read_b128 a[180:183], v243 offset:25600
MV 156,a,144,a,16
MV 160,a,144,a,20
ds_read_b128 a[184:187], v243 offset:26624
MV 164,a,148,a,16
ds_read_b128 a[188:191], v243 offset:27648
MV 168,a,148,a,20
MV 172,a,152,a,16
MV 176,a,152,a,20
MV 180,a,156,a,16
MV 184,a,156,a,20
s_waitcnt vmcnt(9) lgkmcnt(0)
s_barrier
MV 124,a,160,a,24
ds_read_b128 a[128:131], v242 offset:32768
MV 128,a,160,a,28
ds_read_b128 a[132:135], v242 offset:33792
MV 132,a,164,a,24
MV 136,a,164,a,28
ds_read_b128 a[136:139], v242 offset:34816
MV 140,a,168,a,24
ds_read_b128 a[140:143], v242 offset:35840
MV 144,a,168,a,28
MV 148,a,172,a,24
ds_read_b128 a[144:147], v243 offset:32768
MV 152,a,172,a,28
ds_read_b128 a[148:151], v243 offset:33792
MV 156,a,176,a,24
MV 160,a,176,a,28
ds_read_b128 a[152:155], v243 offset:34816
MV 164,a,180,a,24
ds_read_b128 a[156:159], v243 offset:35840
MV 168,a,180,a,28
MV 172,a,184,a,24
MV 176,a,184,a,28
MV 180,a,188,a,24
MV 184,a,188,a,28
s_waitcnt lgkmcnt(0)
MV 124,a,128,a,32
ds_read_b128 a[160:163], v242 offset:40960
MV 128,a,128,a,36
ds_read_b128 a[164:167], v242 offset:41984
MV 132,a,132,a,32
MV 136,a,132,a,36
ds_read_b128 a[168:171], v242 offset:43008
MV 140,a,136,a,32
ds_read_b128 a[172:175], v242 offset:44032
MV 144,a,136,a,36
MV 148,a,140,a,32
ds_read_b128 a[176:179], v243 offset:40960
MV 152,a,140,a,36
ds_read_b128 a[180:183], v243 offset:41984
MV 156,a,144,a,32
MV 160,a,144,a,36
ds_read_b128 a[184:187], v243 offset:43008
MV 164,a,148,a,32
ds_read_b128 a[188:191], v243 offset:44032
MV 168,a,148,a,36
MV 172,a,152,a,32
MV 176,a,152,a,36
MV 180,a,156,a,32
MV 184,a,156,a,36
s_waitcnt vmcnt(1) lgkmcnt(0)
s_barrier
MV 124,a,160,a,40
ds_read_b128 a[128:131], v242 offset:49152
MV 128,a,160,a,44
ds_read_b128 a[132:135], v242 offset:50176
MV 132,a,164,a,40
MV 136,a,164,a,44
ds_read_b128 a[136:139], v242 offset:51200
MV 140,a,168,a,40
ds_read_b128 a[140:143], v242 offset:52224
MV 144,a,168,a,44
MV 148,a,172,a,40
ds_read_b128 a[144:147], v243 offset:49152
MV 152,a,172,a,44
ds_read_b128 a[148:151], v243 offset:50176
MV 156,a,176,a,40
MV 160,a,176,a,44
ds_read_b128 a[152:155], v243 offset:51200
MV 164,a,180,a,40
ds_read_b128 a[156:159], v243 offset:52224
MV 168,a,180,a,44
MV 172,a,184,a,40
MV 176,a,184,a,44
MV 180,a,188,a,40
MV 184,a,188,a,44
s_waitcnt lgkmcnt(0)
MV 124,a,128,a,48
ds_read_b128 a[160:163], v242 offset:57344
MV 128,a,128,a,52
ds_read_b128 a[164:167], v242 offset:58368
MV 132,a,132,a,48
MV 136,a,132,a,52
ds_read_b128 a[168:171], v242 offset:59392
MV 140,a,136,a,48
ds_read_b128 a[172:175], v242 offset:60416
MV 144,a,136,a,52
MV 148,a,140,a,48
ds_read_b128 a[176:179], v243 offset:57344
MV 152,a,140,a,52
ds_read_b128 a[180:183], v243 offset:58368
MV 156,a,144,a,48
MV 160,a,144,a,52
ds_read_b128 a[184:187], v243 offset:59392
MV 164,a,148,a,48
ds_read_b128 a[188:191], v243 offset:60416
MV 168,a,148,a,52
MV 172,a,152,a,48
MV 176,a,152,a,52
MV 180,a,156,a,48
MV 184,a,156,a,52
s_waitcnt lgkmcnt(3)
MV 156,a,176,a,56
MV 160,a,176,a,60
s_waitcnt lgkmcnt(2)
MV 164,a,180,a,56
MV 168,a,180,a,60
s_waitcnt lgkmcnt(1)
MV 172,a,184,a,56
MV 176,a,184,a,60
s_waitcnt lgkmcnt(0)
MV 180,a,188,a,56
MV 184,a,188,a,60
MV 124,a,160,a,56
MV 128,a,160,a,60
MV 132,a,164,a,56
MV 136,a,164,a,60
MV 140,a,168,a,56
MV 144,a,168,a,60
MV 148,a,172,a,56
MV 152,a,172,a,60
s_xor_b32 s72, s2, 4
s_lshl_b32 s72, s72, 14
v_cvt_pk_bf16_f32 v156, v156, v157
v_cvt_pk_bf16_f32 v157, v158, v159
v_cvt_pk_bf16_f32 v158, v160, v161
v_cvt_pk_bf16_f32 v159, v162, v163
buffer_store_dwordx4 v[156:159], v238, s[52:55], s72 offen offset:0 sc1
v_cvt_pk_bf16_f32 v164, v164, v165
v_cvt_pk_bf16_f32 v165, v166, v167
v_cvt_pk_bf16_f32 v166, v168, v169
v_cvt_pk_bf16_f32 v167, v170, v171
buffer_store_dwordx4 v[164:167], v238, s[52:55], s72 offen offset:1024 sc1
v_cvt_pk_bf16_f32 v172, v172, v173
v_cvt_pk_bf16_f32 v173, v174, v175
v_cvt_pk_bf16_f32 v174, v176, v177
v_cvt_pk_bf16_f32 v175, v178, v179
buffer_store_dwordx4 v[172:175], v238, s[52:55], s72 offen offset:2048 sc1
v_cvt_pk_bf16_f32 v180, v180, v181
v_cvt_pk_bf16_f32 v181, v182, v183
v_cvt_pk_bf16_f32 v182, v184, v185
v_cvt_pk_bf16_f32 v183, v186, v187
buffer_store_dwordx4 v[180:183], v238, s[52:55], s72 offen offset:3072 sc1
v_sub_f32 v8, 1.0, v6
v_lshlrev_b32 v36, 16, v192
v_lshlrev_b32 v228, 16, v208
v_and_b32 v37, 0xffff0000, v192
v_and_b32 v229, 0xffff0000, v208
v_mul_f32 v36, v36, v228
v_mul_f32 v37, v37, v229
v_mul_f32 v36, v36, v6
v_mul_f32 v37, v37, v6
v_lshlrev_b32 v38, 16, v193
v_lshlrev_b32 v228, 16, v209
v_and_b32 v39, 0xffff0000, v193
v_and_b32 v229, 0xffff0000, v209
v_mul_f32 v38, v38, v228
v_mul_f32 v39, v39, v229
v_mul_f32 v38, v38, v6
v_mul_f32 v39, v39, v6
v_lshlrev_b32 v40, 16, v194
v_lshlrev_b32 v228, 16, v210
v_and_b32 v41, 0xffff0000, v194
v_and_b32 v229, 0xffff0000, v210
v_mul_f32 v40, v40, v228
v_mul_f32 v41, v41, v229
v_mul_f32 v40, v40, v6
v_mul_f32 v41, v41, v6
v_lshlrev_b32 v42, 16, v195
v_lshlrev_b32 v228, 16, v211
v_and_b32 v43, 0xffff0000, v195
v_and_b32 v229, 0xffff0000, v211
v_mul_f32 v42, v42, v228
v_mul_f32 v43, v43, v229
v_mul_f32 v42, v42, v6
v_mul_f32 v43, v43, v6
v_lshlrev_b32 v44, 16, v196
v_lshlrev_b32 v228, 16, v212
v_and_b32 v45, 0xffff0000, v196
v_and_b32 v229, 0xffff0000, v212
v_mul_f32 v44, v44, v228
v_mul_f32 v45, v45, v229
v_mul_f32 v44, v44, v6
v_mul_f32 v45, v45, v6
v_lshlrev_b32 v46, 16, v197
v_lshlrev_b32 v228, 16, v213
v_and_b32 v47, 0xffff0000, v197
v_and_b32 v229, 0xffff0000, v213
v_mul_f32 v46, v46, v228
v_mul_f32 v47, v47, v229
v_mul_f32 v46, v46, v6
v_mul_f32 v47, v47, v6
v_lshlrev_b32 v48, 16, v198
v_lshlrev_b32 v228, 16, v214
v_and_b32 v49, 0xffff0000, v198
v_and_b32 v229, 0xffff0000, v214
v_mul_f32 v48, v48, v228
v_mul_f32 v49, v49, v229
v_mul_f32 v48, v48, v6
v_mul_f32 v49, v49, v6
v_lshlrev_b32 v50, 16, v199
v_lshlrev_b32 v228, 16, v215
v_and_b32 v51, 0xffff0000, v199
v_and_b32 v229, 0xffff0000, v215
v_mul_f32 v50, v50, v228
v_mul_f32 v51, v51, v229
v_mul_f32 v50, v50, v6
v_mul_f32 v51, v51, v6
v_sub_f32 v9, 1.0, v7
v_lshlrev_b32 v52, 16, v200
v_lshlrev_b32 v228, 16, v216
v_and_b32 v53, 0xffff0000, v200
v_and_b32 v229, 0xffff0000, v216
v_mul_f32 v52, v52, v228
v_mul_f32 v53, v53, v229
v_mul_f32 v52, v52, v7
v_mul_f32 v53, v53, v7
v_lshlrev_b32 v54, 16, v201
v_lshlrev_b32 v228, 16, v217
v_and_b32 v55, 0xffff0000, v201
v_and_b32 v229, 0xffff0000, v217
v_mul_f32 v54, v54, v228
v_mul_f32 v55, v55, v229
v_mul_f32 v54, v54, v7
v_mul_f32 v55, v55, v7
v_lshlrev_b32 v56, 16, v202
v_lshlrev_b32 v228, 16, v218
v_and_b32 v57, 0xffff0000, v202
v_and_b32 v229, 0xffff0000, v218
v_mul_f32 v56, v56, v228
v_mul_f32 v57, v57, v229
v_mul_f32 v56, v56, v7
v_mul_f32 v57, v57, v7
v_lshlrev_b32 v58, 16, v203
v_lshlrev_b32 v228, 16, v219
v_and_b32 v59, 0xffff0000, v203
v_and_b32 v229, 0xffff0000, v219
v_mul_f32 v58, v58, v228
v_mul_f32 v59, v59, v229
v_mul_f32 v58, v58, v7
v_mul_f32 v59, v59, v7
v_lshlrev_b32 v60, 16, v204
v_lshlrev_b32 v228, 16, v220
v_and_b32 v61, 0xffff0000, v204
v_and_b32 v229, 0xffff0000, v220
v_mul_f32 v60, v60, v228
v_mul_f32 v61, v61, v229
v_mul_f32 v60, v60, v7
v_mul_f32 v61, v61, v7
v_lshlrev_b32 v62, 16, v205
v_lshlrev_b32 v228, 16, v221
v_and_b32 v63, 0xffff0000, v205
v_and_b32 v229, 0xffff0000, v221
v_mul_f32 v62, v62, v228
v_mul_f32 v63, v63, v229
v_mul_f32 v62, v62, v7
v_mul_f32 v63, v63, v7
v_lshlrev_b32 v64, 16, v206
s_waitcnt vmcnt(4)
v_lshlrev_b32 v228, 16, v222
v_and_b32 v65, 0xffff0000, v206
v_and_b32 v229, 0xffff0000, v222
v_mul_f32 v64, v64, v228
v_mul_f32 v65, v65, v229
v_mul_f32 v64, v64, v7
v_mul_f32 v65, v65, v7
v_lshlrev_b32 v66, 16, v207
v_lshlrev_b32 v228, 16, v223
v_and_b32 v67, 0xffff0000, v207
v_and_b32 v229, 0xffff0000, v223
v_mul_f32 v66, v66, v228
v_mul_f32 v67, v67, v229
v_mul_f32 v66, v66, v7
v_mul_f32 v67, v67, v7
s_lshl_b32 s72, s2, 14
s_mov_b32 s73, 400000
L_xb:
buffer_load_dwordx4 v[76:79], v238, s[52:55], s72 offen offset:0 sc1
buffer_load_dwordx4 v[80:83], v238, s[52:55], s72 offen offset:1024 sc1
buffer_load_dwordx4 v[84:87], v238, s[52:55], s72 offen offset:2048 sc1
buffer_load_dwordx4 v[88:91], v238, s[52:55], s72 offen offset:3072 sc1
s_sub_u32 s73, s73, 1
s_cbranch_scc1 L_xb_done
s_waitcnt vmcnt(3)
v_max3_u32 v228, v76, v77, v78
s_waitcnt vmcnt(2)
v_max3_u32 v228, v228, v79, v80
v_max3_u32 v228, v228, v81, v82
s_waitcnt vmcnt(1)
v_max3_u32 v228, v228, v83, v84
v_max3_u32 v228, v228, v85, v86
s_waitcnt vmcnt(0)
v_max3_u32 v228, v228, v87, v88
v_max3_u32 v228, v228, v89, v90
v_max_u32 v228, v228, v91
v_cmp_eq_u32 vcc, -1, v228
s_nop 4
s_cbranch_vccnz L_xb
L_xb_done:
s_waitcnt vmcnt(0)
v_lshlrev_b32 v92, 16, v76
v_and_b32 v93, 0xffff0000, v76
v_add_f32 v124, v124, v92
v_add_f32 v125, v125, v93
v_lshlrev_b32 v92, 16, v77
v_and_b32 v93, 0xffff0000, v77
v_add_f32 v126, v126, v92
v_add_f32 v127, v127, v93
v_lshlrev_b32 v92, 16, v78
v_and_b32 v93, 0xffff0000, v78
v_add_f32 v128, v128, v92
v_add_f32 v129, v129, v93
v_lshlrev_b32 v92, 16, v79
v_and_b32 v93, 0xffff0000, v79
v_add_f32 v130, v130, v92
v_add_f32 v131, v131, v93
v_lshlrev_b32 v92, 16, v80
v_and_b32 v93, 0xffff0000, v80
v_add_f32 v132, v132, v92
v_add_f32 v133, v133, v93
v_lshlrev_b32 v92, 16, v81
v_and_b32 v93, 0xffff0000, v81
v_add_f32 v134, v134, v92
v_add_f32 v135, v135, v93
v_lshlrev_b32 v92, 16, v82
v_and_b32 v93, 0xffff0000, v82
v_add_f32 v136, v136, v92
v_add_f32 v137, v137, v93
v_lshlrev_b32 v92, 16, v83
v_and_b32 v93, 0xffff0000, v83
v_add_f32 v138, v138, v92
v_add_f32 v139, v139, v93
v_lshlrev_b32 v92, 16, v84
v_and_b32 v93, 0xffff0000, v84
v_add_f32 v140, v140, v92
v_add_f32 v141, v141, v93
v_lshlrev_b32 v92, 16, v85
v_and_b32 v93, 0xffff0000, v85
v_add_f32 v142, v142, v92
v_add_f32 v143, v143, v93
v_lshlrev_b32 v92, 16, v86
v_and_b32 v93, 0xffff0000, v86
v_add_f32 v144, v144, v92
v_add_f32 v145, v145, v93
v_lshlrev_b32 v92, 16, v87
v_and_b32 v93, 0xffff0000, v87
v_add_f32 v146, v146, v92
v_add_f32 v147, v147, v93
v_lshlrev_b32 v92, 16, v88
v_and_b32 v93, 0xffff0000, v88
v_add_f32 v148, v148, v92
v_add_f32 v149, v149, v93
v_lshlrev_b32 v92, 16, v89
v_and_b32 v93, 0xffff0000, v89
v_add_f32 v150, v150, v92
v_add_f32 v151, v151, v93
v_lshlrev_b32 v92, 16, v90
v_and_b32 v93, 0xffff0000, v90
v_add_f32 v152, v152, v92
v_add_f32 v153, v153, v93
v_lshlrev_b32 v92, 16, v91
v_and_b32 v93, 0xffff0000, v91
v_add_f32 v154, v154, v92
v_add_f32 v155, v155, v93
v_permlane16_swap_b32 v124, v132
v_permlane16_swap_b32 v125, v133
v_permlane16_swap_b32 v126, v134
v_permlane16_swap_b32 v127, v135
v_permlane16_swap_b32 v140, v148
v_permlane16_swap_b32 v141, v149
v_permlane16_swap_b32 v142, v150
v_permlane16_swap_b32 v143, v151
v_permlane16_swap_b32 v128, v136
v_permlane16_swap_b32 v129, v137
v_permlane16_swap_b32 v130, v138
v_permlane16_swap_b32 v131, v139
v_permlane16_swap_b32 v144, v152
v_permlane16_swap_b32 v145, v153
v_permlane16_swap_b32 v146, v154
v_permlane16_swap_b32 v147, v155
s_add_u32 s72, s78, 0
v_fma_f32 v36, v124, v8, v36
v_fma_f32 v37, v125, v8, v37
v_fma_f32 v38, v126, v8, v38
v_fma_f32 v39, v127, v8, v39
v_fma_f32 v40, v132, v8, v40
v_fma_f32 v41, v133, v8, v41
v_fma_f32 v42, v134, v8, v42
v_fma_f32 v43, v135, v8, v43
v_cvt_pk_bf16_f32 v192, v36, v37
v_cvt_pk_bf16_f32 v193, v38, v39
v_cvt_pk_bf16_f32 v194, v40, v41
v_cvt_pk_bf16_f32 v195, v42, v43
buffer_store_dwordx4 v[192:195], v250, s[60:63], s72 offen offset:0 sc1
v_fma_f32 v44, v140, v8, v44
v_fma_f32 v45, v141, v8, v45
v_fma_f32 v46, v142, v8, v46
v_fma_f32 v47, v143, v8, v47
v_fma_f32 v48, v148, v8, v48
v_fma_f32 v49, v149, v8, v49
v_fma_f32 v50, v150, v8, v50
v_fma_f32 v51, v151, v8, v51
v_cvt_pk_bf16_f32 v196, v44, v45
v_cvt_pk_bf16_f32 v197, v46, v47
v_cvt_pk_bf16_f32 v198, v48, v49
v_cvt_pk_bf16_f32 v199, v50, v51
buffer_store_dwordx4 v[196:199], v250, s[60:63], s72 offen offset:64 sc1
s_add_u32 s72, s78, 32768
v_fma_f32 v52, v128, v9, v52
v_fma_f32 v53, v129, v9, v53
v_fma_f32 v54, v130, v9, v54
v_fma_f32 v55, v131, v9, v55
v_fma_f32 v56, v136, v9, v56
v_fma_f32 v57, v137, v9, v57
v_fma_f32 v58, v138, v9, v58
v_fma_f32 v59, v139, v9, v59
v_cvt_pk_bf16_f32 v200, v52, v53
v_cvt_pk_bf16_f32 v201, v54, v55
v_cvt_pk_bf16_f32 v202, v56, v57
v_cvt_pk_bf16_f32 v203, v58, v59
buffer_store_dwordx4 v[200:203], v250, s[60:63], s72 offen offset:0 sc1
v_fma_f32 v60, v144, v9, v60
v_fma_f32 v61, v145, v9, v61
v_fma_f32 v62, v146, v9, v62
v_fma_f32 v63, v147, v9, v63
v_fma_f32 v64, v152, v9, v64
v_fma_f32 v65, v153, v9, v65
v_fma_f32 v66, v154, v9, v66
v_fma_f32 v67, v155, v9, v67
v_cvt_pk_bf16_f32 v204, v60, v61
v_cvt_pk_bf16_f32 v205, v62, v63
v_cvt_pk_bf16_f32 v206, v64, v65
v_cvt_pk_bf16_f32 v207, v66, v67
buffer_store_dwordx4 v[204:207], v250, s[60:63], s72 offen offset:64 sc1
L_end:
s_endpgm
L_p3_pmask:
s_nop 7
v_add_u32 v246, 0, v13
v_cmp_gt_i32_e64 s[84:85], 0, v246
v_cmp_gt_i32_e64 s[86:87], 1, v246
v_cmp_gt_i32_e64 s[88:89], 2, v246
v_cmp_gt_i32_e64 s[90:91], 3, v246
v_cndmask_b32_e64 v96, v96, v14, s[84:85]
v_cndmask_b32_e64 v97, v97, v14, s[86:87]
v_cndmask_b32_e64 v98, v98, v14, s[88:89]
v_cndmask_b32_e64 v99, v99, v14, s[90:91]
v_add_u32 v247, 16, v13
v_cmp_gt_i32_e64 s[92:93], 0, v247
v_cmp_gt_i32_e64 s[94:95], 1, v247
v_cmp_gt_i32_e64 s[96:97], 2, v247
v_cmp_gt_i32_e64 s[98:99], 3, v247
v_cndmask_b32_e64 v104, v104, v14, s[92:93]
v_cndmask_b32_e64 v105, v105, v14, s[94:95]
v_cndmask_b32_e64 v106, v106, v14, s[96:97]
v_cndmask_b32_e64 v107, v107, v14, s[98:99]
v_add_u32 v246, -16, v13
v_cmp_gt_i32_e64 s[84:85], 0, v246
v_cmp_gt_i32_e64 s[86:87], 1, v246
v_cmp_gt_i32_e64 s[88:89], 2, v246
v_cmp_gt_i32_e64 s[90:91], 3, v246
v_cndmask_b32_e64 v100, v100, v14, s[84:85]
v_cndmask_b32_e64 v101, v101, v14, s[86:87]
v_cndmask_b32_e64 v102, v102, v14, s[88:89]
v_cndmask_b32_e64 v103, v103, v14, s[90:91]
v_add_u32 v247, 0, v13
v_cmp_gt_i32_e64 s[92:93], 0, v247
v_cmp_gt_i32_e64 s[94:95], 1, v247
v_cmp_gt_i32_e64 s[96:97], 2, v247
v_cmp_gt_i32_e64 s[98:99], 3, v247
v_cndmask_b32_e64 v108, v108, v14, s[92:93]
v_cndmask_b32_e64 v109, v109, v14, s[94:95]
v_cndmask_b32_e64 v110, v110, v14, s[96:97]
v_cndmask_b32_e64 v111, v111, v14, s[98:99]
v_add_u32 v246, -32, v13
v_cmp_gt_i32_e64 s[84:85], 0, v246
v_cmp_gt_i32_e64 s[86:87], 1, v246
v_cmp_gt_i32_e64 s[88:89], 2, v246
v_cmp_gt_i32_e64 s[90:91], 3, v246
v_cndmask_b32_e64 v128, v128, v14, s[84:85]
v_cndmask_b32_e64 v129, v129, v14, s[86:87]
v_cndmask_b32_e64 v130, v130, v14, s[88:89]
v_cndmask_b32_e64 v131, v131, v14, s[90:91]
v_add_u32 v247, -16, v13
v_cmp_gt_i32_e64 s[92:93], 0, v247
v_cmp_gt_i32_e64 s[94:95], 1, v247
v_cmp_gt_i32_e64 s[96:97], 2, v247
v_cmp_gt_i32_e64 s[98:99], 3, v247
v_cndmask_b32_e64 v136, v136, v14, s[92:93]
v_cndmask_b32_e64 v137, v137, v14, s[94:95]
v_cndmask_b32_e64 v138, v138, v14, s[96:97]
v_cndmask_b32_e64 v139, v139, v14, s[98:99]
v_add_u32 v246, -48, v13
v_cmp_gt_i32_e64 s[84:85], 0, v246
v_cmp_gt_i32_e64 s[86:87], 1, v246
v_cmp_gt_i32_e64 s[88:89], 2, v246
v_cmp_gt_i32_e64 s[90:91], 3, v246
v_cndmask_b32_e64 v132, v132, v14, s[84:85]
v_cndmask_b32_e64 v133, v133, v14, s[86:87]
v_cndmask_b32_e64 v134, v134, v14, s[88:89]
v_cndmask_b32_e64 v135, v135, v14, s[90:91]
v_add_u32 v247, -32, v13
v_cmp_gt_i32_e64 s[92:93], 0, v247
v_cmp_gt_i32_e64 s[94:95], 1, v247
v_cmp_gt_i32_e64 s[96:97], 2, v247
v_cmp_gt_i32_e64 s[98:99], 3, v247
v_cndmask_b32_e64 v140, v140, v14, s[92:93]
v_cndmask_b32_e64 v141, v141, v14, s[94:95]
v_cndmask_b32_e64 v142, v142, v14, s[96:97]
v_cndmask_b32_e64 v143, v143, v14, s[98:99]
s_branch L_p3_pmask_ret
L_p3_mxm_top:
s_waitcnt lgkmcnt(0)
v_xor_b32 v11, 0x8000, v11
v_mfma_f32_16x16x32_bf16 v[80:83], a[128:131], v[16:19], 0
s_add_u32 m0, s73, 16384
ds_read_b128 a[192:195], v11 offset:0
v_mfma_f32_16x16x32_bf16 v[88:91], a[128:131], v[32:35], 0
v_exp_f32 v176, v176
MV 80,a,132,v,20
v_exp_f32 v177, v177
MV 88,a,132,v,36
ds_read_b128 a[196:199], v11 offset:1024
buffer_load_dwordx4 v12, s[56:59], s71 offen offset:0 sc1 lds
MV 80,a,136,v,24
v_exp_f32 v178, v178
MV 88,a,136,v,40
v_add_f32 v2, v2, v176
v_add_f32 v2, v2, v177
MV 80,a,140,v,28
v_exp_f32 v179, v179
MV 88,a,140,v,44
ds_read_b128 a[200:203], v11 offset:2048
v_cvt_pk_bf16_f32 v176, v176, v177
v_mfma_f32_16x16x32_bf16 v[84:87], a[144:147], v[16:19], 0
v_exp_f32 v180, v180
v_mfma_f32_16x16x32_bf16 v[92:95], a[144:147], v[32:35], 0
ds_read_b128 a[204:207], v11 offset:3072
v_add_f32 v2, v2, v178
MV 84,a,148,v,20
ds_read_b128 a[208:211], v11 offset:4096
v_add_f32 v2, v2, v179
MV 92,a,148,v,36
v_exp_f32 v181, v181
MV 84,a,152,v,24
buffer_load_dwordx4 v12, s[56:59], s71 offen offset:1024 sc1 lds
v_cvt_pk_bf16_f32 v177, v178, v179
MV 92,a,152,v,40
v_exp_f32 v182, v182
MV 84,a,156,v,28
v_add_f32 v2, v2, v180
v_add_f32 v2, v2, v181
MV 92,a,156,v,44
v_exp_f32 v183, v183
v_mfma_f32_16x16x32_bf16 v[112:115], a[160:163], v[16:19], 0
ds_read_b128 a[212:215], v11 offset:5120
v_cvt_pk_bf16_f32 v178, v180, v181
v_mfma_f32_16x16x32_bf16 v[120:123], a[160:163], v[32:35], 0
v_exp_f32 v184, v184
MV 112,a,164,v,20
v_add_f32 v2, v2, v182
v_add_f32 v2, v2, v183
MV 120,a,164,v,36
v_exp_f32 v185, v185
MV 112,a,168,v,24
ds_read_b128 a[216:219], v11 offset:6144
v_cvt_pk_bf16_f32 v179, v182, v183
MV 120,a,168,v,40
v_exp_f32 v186, v186
MV 112,a,172,v,28
ds_read_b128 a[220:223], v11 offset:7168
v_add_f32 v3, v3, v184
MV 120,a,172,v,44
buffer_load_dwordx4 v12, s[56:59], s71 offen offset:2048 sc1 lds
v_add_f32 v3, v3, v185
v_mfma_f32_16x16x32_bf16 v[116:119], a[176:179], v[16:19], 0
v_exp_f32 v187, v187
v_mfma_f32_16x16x32_bf16 v[124:127], a[176:179], v[32:35], 0
ds_read_b128 a[224:227], v11 offset:8192
v_cvt_pk_bf16_f32 v184, v184, v185
MV 116,a,180,v,20
v_exp_f32 v188, v188
MV 124,a,180,v,36
v_add_f32 v3, v3, v186
v_add_f32 v3, v3, v187
MV 116,a,184,v,24
v_exp_f32 v189, v189
MV 124,a,184,v,40
ds_read_b128 a[228:231], v11 offset:9216
v_cvt_pk_bf16_f32 v185, v186, v187
MV 116,a,188,v,28
v_exp_f32 v190, v190
MV 124,a,188,v,44
ds_read_b128 a[232:235], v11 offset:10240
ds_read_b128 a[236:239], v11 offset:11264
ds_read_b128 a[240:243], v11 offset:12288
ds_read_b128 a[244:247], v11 offset:13312
ds_read_b128 a[248:251], v11 offset:14336
ds_read_b128 a[252:255], v11 offset:15360
buffer_load_dwordx4 v12, s[56:59], s71 offen offset:3072 sc1 lds
s_add_u32 s71, s71, 16384
s_xor_b32 s73, s73, 0x8000
v_add_f32 v3, v3, v188
v_add_f32 v3, v3, v189
v_exp_f32 v191, v191
v_cvt_pk_bf16_f32 v186, v188, v189
v_exp_f32 v192, v192
v_add_f32 v3, v3, v190
v_add_f32 v3, v3, v191
v_exp_f32 v193, v193
v_cvt_pk_bf16_f32 v187, v190, v191
v_exp_f32 v194, v194
v_add_f32 v4, v4, v192
v_add_f32 v4, v4, v193
v_exp_f32 v195, v195
v_cvt_pk_bf16_f32 v192, v192, v193
v_exp_f32 v196, v196
v_add_f32 v4, v4, v194
v_add_f32 v4, v4, v195
v_exp_f32 v197, v197
v_cvt_pk_bf16_f32 v193, v194, v195
v_exp_f32 v198, v198
v_add_f32 v4, v4, v196
v_add_f32 v4, v4, v197
v_exp_f32 v199, v199
v_cvt_pk_bf16_f32 v194, v196, v197
v_add_u32 v246, 0, v13
v_cmp_gt_i32_e64 s[84:85], 0, v246
v_cmp_gt_i32_e64 s[86:87], 1, v246
v_cmp_gt_i32_e64 s[88:89], 2, v246
v_exp_f32 v200, v200
v_add_f32 v4, v4, v198
v_cmp_gt_i32_e64 s[90:91], 3, v246
v_cndmask_b32_e64 v80, v80, v14, s[84:85]
v_cndmask_b32_e64 v81, v81, v14, s[86:87]
v_cndmask_b32_e64 v82, v82, v14, s[88:89]
v_add_f32 v4, v4, v199
v_exp_f32 v201, v201
v_cvt_pk_bf16_f32 v195, v198, v199
v_cndmask_b32_e64 v83, v83, v14, s[90:91]
v_add_u32 v247, 16, v13
v_cmp_gt_i32_e64 s[92:93], 0, v247
v_exp_f32 v202, v202
v_add_f32 v5, v5, v200
v_cmp_gt_i32_e64 s[94:95], 1, v247
v_cmp_gt_i32_e64 s[96:97], 2, v247
v_cmp_gt_i32_e64 s[98:99], 3, v247
v_cndmask_b32_e64 v88, v88, v14, s[92:93]
v_add_f32 v5, v5, v201
v_exp_f32 v203, v203
v_cvt_pk_bf16_f32 v200, v200, v201
v_cndmask_b32_e64 v89, v89, v14, s[94:95]
v_cndmask_b32_e64 v90, v90, v14, s[96:97]
v_cndmask_b32_e64 v91, v91, v14, s[98:99]
v_exp_f32 v204, v204
v_add_f32 v5, v5, v202
v_add_u32 v246, -16, v13
v_cmp_gt_i32_e64 s[84:85], 0, v246
v_cmp_gt_i32_e64 s[86:87], 1, v246
v_cmp_gt_i32_e64 s[88:89], 2, v246
v_add_f32 v5, v5, v203
v_exp_f32 v205, v205
v_cvt_pk_bf16_f32 v201, v202, v203
v_cmp_gt_i32_e64 s[90:91], 3, v246
v_cndmask_b32_e64 v84, v84, v14, s[84:85]
v_cndmask_b32_e64 v85, v85, v14, s[86:87]
v_cndmask_b32_e64 v86, v86, v14, s[88:89]
v_exp_f32 v206, v206
v_add_f32 v5, v5, v204
v_cndmask_b32_e64 v87, v87, v14, s[90:91]
v_add_u32 v247, 0, v13
v_cmp_gt_i32_e64 s[92:93], 0, v247
v_add_f32 v5, v5, v205
v_exp_f32 v207, v207
v_cvt_pk_bf16_f32 v202, v204, v205
v_cmp_gt_i32_e64 s[94:95], 1, v247
v_cmp_gt_i32_e64 s[96:97], 2, v247
v_cmp_gt_i32_e64 s[98:99], 3, v247
v_cndmask_b32_e64 v92, v92, v14, s[92:93]
v_add_f32 v5, v5, v206
v_add_f32 v5, v5, v207
v_cvt_pk_bf16_f32 v203, v206, v207
v_cndmask_b32_e64 v93, v93, v14, s[94:95]
v_cndmask_b32_e64 v94, v94, v14, s[96:97]
v_cndmask_b32_e64 v95, v95, v14, s[98:99]
s_waitcnt vmcnt(16) lgkmcnt(0)
MA 0,a,192,v,144
s_barrier
v_xor_b32 v10, 0x8000, v10
MA 32,a,192,v,152
s_add_u32 m0, s72, 16384
ds_read_b128 a[128:131], v10 offset:0
MA 64,a,192,v,160
v_exp_f32 v80, v80
MA 96,a,192,v,168
buffer_load_dwordx4 v12, s[52:55], s71 offen offset:0 sc1 lds
v_lshrrev_b32 v249, 2, v1
MA 4,a,196,v,144
ds_read_b128 a[132:135], v10 offset:1024
v_and_b32 v248, 7, v249
MA 36,a,196,v,152
v_lshlrev_b32 v249, 8, v249
v_and_b32 v250, 3, v1
MA 68,a,196,v,160
v_lshl_add_u32 v249, v250, 3, v249
s_lshl_b32 s36, s3, 13
MA 100,a,196,v,168
v_exp_f32 v81, v81
MA 8,a,200,v,144
ds_read_b128 a[136:139], v10 offset:2048
v_add_u32 v246, -32, v13
MA 40,a,200,v,152
v_cmp_gt_i32_e64 s[84:85], 0, v246
s_add_u32 s36, s36, 131072
MA 72,a,200,v,160
v_add_u32 v249, s36, v249
s_nop 0
MA 104,a,200,v,168
v_exp_f32 v82, v82
MA 12,a,204,v,144
ds_read_b128 a[140:143], v10 offset:3072
v_xor_b32 v250, 0, v248
MA 44,a,204,v,152
v_cmp_gt_i32_e64 s[86:87], 1, v246
v_lshl_add_u32 v250, v250, 5, v249
MA 76,a,204,v,160
v_cmp_gt_i32_e64 s[88:89], 2, v246
TR 96,250,0
MA 108,a,204,v,168
TR 98,250,4096
v_xor_b32 v250, 1, v248
MA 16,a,208,v,144
v_exp_f32 v83, v83
MA 48,a,208,v,152
ds_read_b128 a[144:147], v10 offset:4096
v_cmp_gt_i32_e64 s[90:91], 3, v246
MA 80,a,208,v,160
v_lshl_add_u32 v250, v250, 5, v249
TR 100,250,0
MA 112,a,208,v,168
v_cvt_pk_bf16_f32 v80, v80, v81
TR 102,250,4096
MA 20,a,212,v,144
buffer_load_dwordx4 v12, s[52:55], s71 offen offset:1024 sc1 lds
v_cndmask_b32_e64 v112, v112, v14, s[84:85]
MA 52,a,212,v,152
v_xor_b32 v250, 2, v248
v_lshl_add_u32 v250, v250, 5, v249
MA 84,a,212,v,160
ds_read_b128 a[148:151], v10 offset:5120
v_cndmask_b32_e64 v113, v113, v14, s[86:87]
MA 116,a,212,v,168
TR 104,250,0
TR 106,250,4096
MA 24,a,216,v,144
v_exp_f32 v84, v84
MA 56,a,216,v,152
v_cndmask_b32_e64 v114, v114, v14, s[88:89]
v_xor_b32 v250, 3, v248
MA 88,a,216,v,160
ds_read_b128 a[152:155], v10 offset:6144
v_lshl_add_u32 v250, v250, 5, v249
MA 120,a,216,v,168
v_cndmask_b32_e64 v115, v115, v14, s[90:91]
TR 108,250,0
MA 28,a,220,v,144
v_exp_f32 v85, v85
MA 60,a,220,v,152
v_add_u32 v247, -16, v13
TR 110,250,4096
MA 92,a,220,v,160
v_xor_b32 v250, 4, v248
v_lshl_add_u32 v250, v250, 5, v249
MA 124,a,220,v,168
ds_read_b128 a[156:159], v10 offset:7168
v_cvt_pk_bf16_f32 v81, v82, v83
MA 0,a,224,v,176
v_cmp_gt_i32_e64 s[92:93], 0, v247
TR 128,250,0
MA 32,a,224,v,184
TR 130,250,4096
v_xor_b32 v250, 5, v248
MA 64,a,224,v,192
v_cmp_gt_i32_e64 s[94:95], 1, v247
v_lshl_add_u32 v250, v250, 5, v249
MA 96,a,224,v,200
v_exp_f32 v86, v86
MA 4,a,228,v,176
ds_read_b128 a[160:163], v10 offset:8192
TR 132,250,0
MA 36,a,228,v,184
v_cmp_gt_i32_e64 s[96:97], 2, v247
TR 134,250,4096
MA 68,a,228,v,192
buffer_load_dwordx4 v12, s[52:55], s71 offen offset:2048 sc1 lds
v_xor_b32 v250, 6, v248
MA 100,a,228,v,200
v_cmp_gt_i32_e64 s[98:99], 3, v247
v_lshl_add_u32 v250, v250, 5, v249
MA 8,a,232,v,176
v_exp_f32 v87, v87
MA 40,a,232,v,184
ds_read_b128 a[164:167], v10 offset:9216
TR 136,250,0
MA 72,a,232,v,192
v_cndmask_b32_e64 v120, v120, v14, s[92:93]
TR 138,250,4096
MA 104,a,232,v,200
v_cvt_pk_bf16_f32 v82, v84, v85
v_xor_b32 v250, 7, v248
MA 12,a,236,v,176
ds_read_b128 a[168:171], v10 offset:10240
v_lshl_add_u32 v250, v250, 5, v249
MA 44,a,236,v,184
v_cndmask_b32_e64 v121, v121, v14, s[94:95]
TR 140,250,0
MA 76,a,236,v,192
v_cndmask_b32_e64 v122, v122, v14, s[96:97]
TR 142,250,4096
MA 108,a,236,v,200
v_exp_f32 v88, v88
MA 16,a,240,v,176
s_add_u32 s32, s40, 100663296
s_addc_u32 s33, s41, 0
MA 48,a,240,v,184
ds_read_b128 a[172:175], v10 offset:11264
v_cndmask_b32_e64 v123, v123, v14, s[98:99]
MA 80,a,240,v,192
s_mov_b32 s34, 8388608
s_mov_b32 s35, 0x20000
MA 112,a,240,v,200
v_add_u32 v246, -48, v13
s_and_b32 s36, s2, 7
MA 20,a,244,v,176
v_exp_f32 v89, v89
MA 52,a,244,v,184
s_lshl_b32 s36, s36, 20
s_lshr_b32 s37, s2, 3
MA 84,a,244,v,192
ds_read_b128 a[176:179], v10 offset:12288
v_cmp_gt_i32_e64 s[84:85], 0, v246
MA 116,a,244,v,200
v_cvt_pk_bf16_f32 v83, v86, v87
s_lshl_b32 s37, s37, 15
MA 24,a,248,v,176
v_cmp_gt_i32_e64 s[86:87], 1, v246
s_add_u32 s36, s36, s37
MA 56,a,248,v,184
s_lshl_b32 s37, s3, 12
s_add_u32 s36, s36, s37
MA 88,a,248,v,192
v_exp_f32 v90, v90
MA 120,a,248,v,200
ds_read_b128 a[180:183], v10 offset:13312
buffer_load_dwordx4 v12, s[52:55], s71 offen offset:3072 sc1 lds
MA 28,a,252,v,176
v_cmp_gt_i32_e64 s[88:89], 2, v246
s_add_u32 s37, s36, 4096
MA 60,a,252,v,184
s_waitcnt lgkmcnt(15)
buffer_store_dwordx4 v[96:99], v12, s[32:35], s36 offen offset:0 sc1
buffer_store_dwordx4 v[100:103], v12, s[32:35], s36 offen offset:1024 sc1
MA 92,a,252,v,192
v_cmp_gt_i32_e64 s[90:91], 3, v246
buffer_store_dwordx4 v[104:107], v12, s[32:35], s36 offen offset:2048 sc1
MA 124,a,252,v,200
ds_read_b128 a[184:187], v10 offset:14336
ds_read_b128 a[188:191], v10 offset:15360
s_xor_b32 s72, s72, 0x8000
v_exp_f32 v91, v91
buffer_store_dwordx4 v[108:111], v12, s[32:35], s36 offen offset:3072 sc1
v_cndmask_b32_e64 v116, v116, v14, s[84:85]
s_waitcnt lgkmcnt(14)
buffer_store_dwordx4 v[128:131], v12, s[32:35], s37 offen offset:0 sc1
s_waitcnt lgkmcnt(11)
buffer_store_dwordx4 v[132:135], v12, s[32:35], s37 offen offset:1024 sc1
v_cndmask_b32_e64 v117, v117, v14, s[86:87]
s_waitcnt lgkmcnt(8)
buffer_store_dwordx4 v[136:139], v12, s[32:35], s37 offen offset:2048 sc1
v_cvt_pk_bf16_f32 v88, v88, v89
s_waitcnt lgkmcnt(5)
buffer_store_dwordx4 v[140:143], v12, s[32:35], s37 offen offset:3072 sc1
s_add_u32 s32, s40, 109051904
s_addc_u32 s33, s41, 0
v_exp_f32 v92, v92
v_cndmask_b32_e64 v118, v118, v14, s[88:89]
v_cndmask_b32_e64 v119, v119, v14, s[90:91]
s_mov_b32 s34, 4194304
s_mov_b32 s35, 0x20000
s_lshl_b32 s36, s2, 14
v_exp_f32 v93, v93
v_add_u32 v247, -32, v13
v_mov_b32 v252, -1
v_mov_b32 v253, -1
v_cmp_gt_i32_e64 s[92:93], 0, v247
v_mov_b32 v254, -1
v_mov_b32 v255, -1
v_cvt_pk_bf16_f32 v89, v90, v91
v_cmp_gt_i32_e64 s[94:95], 1, v247
buffer_store_dwordx4 v[252:255], v12, s[32:35], s36 offen offset:0 sc1
buffer_store_dwordx4 v[252:255], v12, s[32:35], s36 offen offset:1024 sc1
buffer_store_dwordx4 v[252:255], v12, s[32:35], s36 offen offset:2048 sc1
v_exp_f32 v94, v94
v_cmp_gt_i32_e64 s[96:97], 2, v247
buffer_store_dwordx4 v[252:255], v12, s[32:35], s36 offen offset:3072 sc1
v_cmp_gt_i32_e64 s[98:99], 3, v247
v_lshlrev_b32 v232, 4, v1
v_add_u32 v233, -8, v232
v_mov_b32 v235, 0
v_exp_f32 v95, v95
v_cndmask_b32_e64 v124, v124, v14, s[92:93]
buffer_load_ushort v234, v235, s[28:31], s42 offen
buffer_load_dwordx2 v[208:209], v233, s[16:19], 0 offen
buffer_load_dwordx4 v[210:213], v232, s[16:19], 0 offen offset:0
v_cndmask_b32_e64 v125, v125, v14, s[94:95]
buffer_load_dwordx2 v[214:215], v232, s[16:19], 0 offen offset:1016
v_cvt_pk_bf16_f32 v90, v92, v93
v_cndmask_b32_e64 v126, v126, v14, s[96:97]
buffer_load_dwordx4 v[216:219], v232, s[16:19], 0 offen offset:1024
buffer_load_dwordx2 v[220:221], v232, s[16:19], 0 offen offset:2040
buffer_load_dwordx4 v[222:225], v232, s[16:19], 0 offen offset:2048
v_cvt_pk_bf16_f32 v91, v94, v95
v_cndmask_b32_e64 v127, v127, v14, s[98:99]
buffer_load_dwordx2 v[226:227], v232, s[16:19], 0 offen offset:3064
buffer_load_dwordx4 v[228:231], v232, s[16:19], 0 offen offset:3072
s_branch L_p3_eps
L_fallback:
s_mov_b32 s81, 0
s_mov_b32 s74, s77
s_mov_b32 s73, s100
s_sub_u32 s72, 15, s70
v_mov_b32 v10, v15
v_add_u32 v11, 16384, v15
s_nop 15
L_fb_set:
s_lshl_b32 s72, s72, 7
s_mov_b32 s71, 0
v_accvgpr_write_b32 a0, 0
v_accvgpr_write_b32 a1, 0
v_accvgpr_write_b32 a2, 0
v_accvgpr_write_b32 a3, 0
v_accvgpr_write_b32 a4, 0
v_accvgpr_write_b32 a5, 0
v_accvgpr_write_b32 a6, 0
v_accvgpr_write_b32 a7, 0
v_accvgpr_write_b32 a8, 0
v_accvgpr_write_b32 a9, 0
v_accvgpr_write_b32 a10, 0
v_accvgpr_write_b32 a11, 0
v_accvgpr_write_b32 a12, 0
v_accvgpr_write_b32 a13, 0
v_accvgpr_write_b32 a14, 0
v_accvgpr_write_b32 a15, 0
v_accvgpr_write_b32 a16, 0
v_accvgpr_write_b32 a17, 0
v_accvgpr_write_b32 a18, 0
v_accvgpr_write_b32 a19, 0
v_accvgpr_write_b32 a20, 0
v_accvgpr_write_b32 a21, 0
v_accvgpr_write_b32 a22, 0
v_accvgpr_write_b32 a23, 0
v_accvgpr_write_b32 a24, 0
v_accvgpr_write_b32 a25, 0
v_accvgpr_write_b32 a26, 0
v_accvgpr_write_b32 a27, 0
v_accvgpr_write_b32 a28, 0
v_accvgpr_write_b32 a29, 0
v_accvgpr_write_b32 a30, 0
v_accvgpr_write_b32 a31, 0
v_accvgpr_write_b32 a32, 0
v_accvgpr_write_b32 a33, 0
v_accvgpr_write_b32 a34, 0
v_accvgpr_write_b32 a35, 0
v_accvgpr_write_b32 a36, 0
v_accvgpr_write_b32 a37, 0
v_accvgpr_write_b32 a38, 0
v_accvgpr_write_b32 a39, 0
v_accvgpr_write_b32 a40, 0
v_accvgpr_write_b32 a41, 0
v_accvgpr_write_b32 a42, 0
v_accvgpr_write_b32 a43, 0
v_accvgpr_write_b32 a44, 0
v_accvgpr_write_b32 a45, 0
v_accvgpr_write_b32 a46, 0
v_accvgpr_write_b32 a47, 0
v_accvgpr_write_b32 a48, 0
v_accvgpr_write_b32 a49, 0
v_accvgpr_write_b32 a50, 0
v_accvgpr_write_b32 a51, 0
v_accvgpr_write_b32 a52, 0
v_accvgpr_write_b32 a53, 0
v_accvgpr_write_b32 a54, 0
v_accvgpr_write_b32 a55, 0
v_accvgpr_write_b32 a56, 0
v_accvgpr_write_b32 a57, 0
v_accvgpr_write_b32 a58, 0
v_accvgpr_write_b32 a59, 0
v_accvgpr_write_b32 a60, 0
v_accvgpr_write_b32 a61, 0
v_accvgpr_write_b32 a62, 0
v_accvgpr_write_b32 a63, 0
v_mov_b32 v2, 0
v_mov_b32 v96, v14
v_mov_b32 v3, 0
v_mov_b32 v97, v14
L_fb_tile:
s_waitcnt vmcnt(0) lgkmcnt(0)
s_barrier
s_mov_b32 m0, s68
s_add_u32 s80, s71, 16384
buffer_load_dwordx4 v12, s[52:55], s71 offen offset:0 sc1 lds
buffer_load_dwordx4 v12, s[52:55], s71 offen offset:1024 sc1 lds
buffer_load_dwordx4 v12, s[52:55], s71 offen offset:2048 sc1 lds
buffer_load_dwordx4 v12, s[52:55], s71 offen offset:3072 sc1 lds
s_add_u32 m0, s68, 16384
s_nop 0
buffer_load_dwordx4 v12, s[56:59], s80 offen offset:0 sc1 lds
buffer_load_dwordx4 v12, s[56:59], s80 offen offset:1024 sc1 lds
buffer_load_dwordx4 v12, s[56:59], s80 offen offset:2048 sc1 lds
buffer_load_dwordx4 v12, s[56:59], s80 offen offset:3072 sc1 lds
s_waitcnt vmcnt(0)
s_barrier
ds_read_b128 a[128:131], v10 offset:0
ds_read_b128 a[132:135], v10 offset:1024
ds_read_b128 a[136:139], v10 offset:2048
ds_read_b128 a[140:143], v10 offset:3072
ds_read_b128 a[144:147], v10 offset:4096
ds_read_b128 a[148:151], v10 offset:5120
ds_read_b128 a[152:155], v10 offset:6144
ds_read_b128 a[156:159], v10 offset:7168
ds_read_b128 a[160:163], v10 offset:8192
ds_read_b128 a[164:167], v10 offset:9216
ds_read_b128 a[168:171], v10 offset:10240
ds_read_b128 a[172:175], v10 offset:11264
ds_read_b128 a[176:179], v10 offset:12288
ds_read_b128 a[180:183], v10 offset:13312
ds_read_b128 a[184:187], v10 offset:14336
ds_read_b128 a[188:191], v10 offset:15360
s_waitcnt lgkmcnt(0)
ds_read_b128 a[192:195], v11 offset:0
ds_read_b128 a[196:199], v11 offset:1024
ds_read_b128 a[200:203], v11 offset:2048
ds_read_b128 a[204:207], v11 offset:3072
ds_read_b128 a[208:211], v11 offset:4096
ds_read_b128 a[212:215], v11 offset:5120
ds_read_b128 a[216:219], v11 offset:6144
ds_read_b128 a[220:223], v11 offset:7168
ds_read_b128 a[224:227], v11 offset:8192
ds_read_b128 a[228:231], v11 offset:9216
ds_read_b128 a[232:235], v11 offset:10240
ds_read_b128 a[236:239], v11 offset:11264
ds_read_b128 a[240:243], v11 offset:12288
ds_read_b128 a[244:247], v11 offset:13312
ds_read_b128 a[248:251], v11 offset:14336
ds_read_b128 a[252:255], v11 offset:15360
v_mfma_f32_16x16x32_bf16 v[80:83], a[128:131], v[16:19], 0
v_mfma_f32_16x16x32_bf16 v[88:91], a[128:131], v[32:35], 0
MV 80,a,132,v,20
MV 88,a,132,v,36
MV 80,a,136,v,24
MV 88,a,136,v,40
MV 80,a,140,v,28
MV 88,a,140,v,44
v_mfma_f32_16x16x32_bf16 v[84:87], a[144:147], v[16:19], 0
v_mfma_f32_16x16x32_bf16 v[92:95], a[144:147], v[32:35], 0
MV 84,a,148,v,20
MV 92,a,148,v,36
MV 84,a,152,v,24
MV 92,a,152,v,40
MV 84,a,156,v,28
MV 92,a,156,v,44
v_mfma_f32_16x16x32_bf16 v[112:115], a[160:163], v[16:19], 0
v_mfma_f32_16x16x32_bf16 v[120:123], a[160:163], v[32:35], 0
MV 112,a,164,v,20
MV 120,a,164,v,36
MV 112,a,168,v,24
MV 120,a,168,v,40
MV 112,a,172,v,28
MV 120,a,172,v,44
v_mfma_f32_16x16x32_bf16 v[116:119], a[176:179], v[16:19], 0
v_mfma_f32_16x16x32_bf16 v[124:127], a[176:179], v[32:35], 0
MV 116,a,180,v,20
MV 124,a,180,v,36
MV 116,a,184,v,24
MV 124,a,184,v,40
MV 116,a,188,v,28
MV 124,a,188,v,44
v_add_u32 v246, s72, v13
v_add_u32 v246, 0, v246
v_cmp_gt_i32_e64 s[84:85], 0, v246
v_cmp_gt_i32_e64 s[86:87], 1, v246
v_cmp_gt_i32_e64 s[88:89], 2, v246
v_cmp_gt_i32_e64 s[90:91], 3, v246
v_cndmask_b32_e64 v80, v80, v14, s[84:85]
v_cndmask_b32_e64 v81, v81, v14, s[86:87]
v_cndmask_b32_e64 v82, v82, v14, s[88:89]
v_cndmask_b32_e64 v83, v83, v14, s[90:91]
v_add_u32 v247, s72, v13
v_add_u32 v247, 16, v247
v_cmp_gt_i32_e64 s[92:93], 0, v247
v_cmp_gt_i32_e64 s[94:95], 1, v247
v_cmp_gt_i32_e64 s[96:97], 2, v247
v_cmp_gt_i32_e64 s[98:99], 3, v247
v_cndmask_b32_e64 v88, v88, v14, s[92:93]
v_cndmask_b32_e64 v89, v89, v14, s[94:95]
v_cndmask_b32_e64 v90, v90, v14, s[96:97]
v_cndmask_b32_e64 v91, v91, v14, s[98:99]
v_add_u32 v246, s72, v13
v_add_u32 v246, -16, v246
v_cmp_gt_i32_e64 s[84:85], 0, v246
v_cmp_gt_i32_e64 s[86:87], 1, v246
v_cmp_gt_i32_e64 s[88:89], 2, v246
v_cmp_gt_i32_e64 s[90:91], 3, v246
v_cndmask_b32_e64 v84, v84, v14, s[84:85]
v_cndmask_b32_e64 v85, v85, v14, s[86:87]
v_cndmask_b32_e64 v86, v86, v14, s[88:89]
v_cndmask_b32_e64 v87, v87, v14, s[90:91]
v_add_u32 v247, s72, v13
v_add_u32 v247, 0, v247
v_cmp_gt_i32_e64 s[92:93], 0, v247
v_cmp_gt_i32_e64 s[94:95], 1, v247
v_cmp_gt_i32_e64 s[96:97], 2, v247
v_cmp_gt_i32_e64 s[98:99], 3, v247
v_cndmask_b32_e64 v92, v92, v14, s[92:93]
v_cndmask_b32_e64 v93, v93, v14, s[94:95]
v_cndmask_b32_e64 v94, v94, v14, s[96:97]
v_cndmask_b32_e64 v95, v95, v14, s[98:99]
v_add_u32 v246, s72, v13
v_add_u32 v246, -32, v246
v_cmp_gt_i32_e64 s[84:85], 0, v246
v_cmp_gt_i32_e64 s[86:87], 1, v246
v_cmp_gt_i32_e64 s[88:89], 2, v246
v_cmp_gt_i32_e64 s[90:91], 3, v246
v_cndmask_b32_e64 v112, v112, v14, s[84:85]
v_cndmask_b32_e64 v113, v113, v14, s[86:87]
v_cndmask_b32_e64 v114, v114, v14, s[88:89]
v_cndmask_b32_e64 v115, v115, v14, s[90:91]
v_add_u32 v247, s72, v13
v_add_u32 v247, -16, v247
v_cmp_gt_i32_e64 s[92:93], 0, v247
v_cmp_gt_i32_e64 s[94:95], 1, v247
v_cmp_gt_i32_e64 s[96:97], 2, v247
v_cmp_gt_i32_e64 s[98:99], 3, v247
v_cndmask_b32_e64 v120, v120, v14, s[92:93]
v_cndmask_b32_e64 v121, v121, v14, s[94:95]
v_cndmask_b32_e64 v122, v122, v14, s[96:97]
v_cndmask_b32_e64 v123, v123, v14, s[98:99]
v_add_u32 v246, s72, v13
v_add_u32 v246, -48, v246
v_cmp_gt_i32_e64 s[84:85], 0, v246
v_cmp_gt_i32_e64 s[86:87], 1, v246
v_cmp_gt_i32_e64 s[88:89], 2, v246
v_cmp_gt_i32_e64 s[90:91], 3, v246
v_cndmask_b32_e64 v116, v116, v14, s[84:85]
v_cndmask_b32_e64 v117, v117, v14, s[86:87]
v_cndmask_b32_e64 v118, v118, v14, s[88:89]
v_cndmask_b32_e64 v119, v119, v14, s[90:91]
v_add_u32 v247, s72, v13
v_add_u32 v247, -32, v247
v_cmp_gt_i32_e64 s[92:93], 0, v247
v_cmp_gt_i32_e64 s[94:95], 1, v247
v_cmp_gt_i32_e64 s[96:97], 2, v247
v_cmp_gt_i32_e64 s[98:99], 3, v247
v_cndmask_b32_e64 v124, v124, v14, s[92:93]
v_cndmask_b32_e64 v125, v125, v14, s[94:95]
v_cndmask_b32_e64 v126, v126, v14, s[96:97]
v_cndmask_b32_e64 v127, v127, v14, s[98:99]
v_mov_b32 v242, v96
v_max3_f32 v242, v242, v80, v81
v_max3_f32 v242, v242, v82, v83
v_max3_f32 v242, v242, v84, v85
v_max3_f32 v242, v242, v86, v87
v_max3_f32 v242, v242, v112, v113
v_max3_f32 v242, v242, v114, v115
v_max3_f32 v242, v242, v116, v117
v_max3_f32 v242, v242, v118, v119
v_mov_b32 v243, v242
s_nop 1
v_permlane32_swap_b32 v242, v243
v_max_f32 v242, v242, v243
v_mov_b32 v243, v242
s_nop 1
v_permlane16_swap_b32 v242, v243
v_max_f32 v242, v242, v243
v_sub_f32 v98, v96, v242
v_exp_f32 v98, v98
v_mov_b32 v96, v242
v_sub_f32 v80, v80, v242
v_sub_f32 v81, v81, v242
v_sub_f32 v82, v82, v242
v_sub_f32 v83, v83, v242
v_sub_f32 v84, v84, v242
v_sub_f32 v85, v85, v242
v_sub_f32 v86, v86, v242
v_sub_f32 v87, v87, v242
v_sub_f32 v112, v112, v242
v_sub_f32 v113, v113, v242
v_sub_f32 v114, v114, v242
v_sub_f32 v115, v115, v242
v_sub_f32 v116, v116, v242
v_sub_f32 v117, v117, v242
v_sub_f32 v118, v118, v242
v_sub_f32 v119, v119, v242
v_mul_f32 v2, v2, v98
v_accvgpr_read_b32 v243, a0
v_mul_f32 v243, v243, v98
v_accvgpr_write_b32 a0, v243
v_accvgpr_read_b32 v243, a1
v_mul_f32 v243, v243, v98
v_accvgpr_write_b32 a1, v243
v_accvgpr_read_b32 v243, a2
v_mul_f32 v243, v243, v98
v_accvgpr_write_b32 a2, v243
v_accvgpr_read_b32 v243, a3
v_mul_f32 v243, v243, v98
v_accvgpr_write_b32 a3, v243
v_accvgpr_read_b32 v243, a4
v_mul_f32 v243, v243, v98
v_accvgpr_write_b32 a4, v243
v_accvgpr_read_b32 v243, a5
v_mul_f32 v243, v243, v98
v_accvgpr_write_b32 a5, v243
v_accvgpr_read_b32 v243, a6
v_mul_f32 v243, v243, v98
v_accvgpr_write_b32 a6, v243
v_accvgpr_read_b32 v243, a7
v_mul_f32 v243, v243, v98
v_accvgpr_write_b32 a7, v243
v_accvgpr_read_b32 v243, a8
v_mul_f32 v243, v243, v98
v_accvgpr_write_b32 a8, v243
v_accvgpr_read_b32 v243, a9
v_mul_f32 v243, v243, v98
v_accvgpr_write_b32 a9, v243
v_accvgpr_read_b32 v243, a10
v_mul_f32 v243, v243, v98
v_accvgpr_write_b32 a10, v243
v_accvgpr_read_b32 v243, a11
v_mul_f32 v243, v243, v98
v_accvgpr_write_b32 a11, v243
v_accvgpr_read_b32 v243, a12
v_mul_f32 v243, v243, v98
v_accvgpr_write_b32 a12, v243
v_accvgpr_read_b32 v243, a13
v_mul_f32 v243, v243, v98
v_accvgpr_write_b32 a13, v243
v_accvgpr_read_b32 v243, a14
v_mul_f32 v243, v243, v98
v_accvgpr_write_b32 a14, v243
v_accvgpr_read_b32 v243, a15
v_mul_f32 v243, v243, v98
v_accvgpr_write_b32 a15, v243
v_accvgpr_read_b32 v243, a16
v_mul_f32 v243, v243, v98
v_accvgpr_write_b32 a16, v243
v_accvgpr_read_b32 v243, a17
v_mul_f32 v243, v243, v98
v_accvgpr_write_b32 a17, v243
v_accvgpr_read_b32 v243, a18
v_mul_f32 v243, v243, v98
v_accvgpr_write_b32 a18, v243
v_accvgpr_read_b32 v243, a19
v_mul_f32 v243, v243, v98
v_accvgpr_write_b32 a19, v243
v_accvgpr_read_b32 v243, a20
v_mul_f32 v243, v243, v98
v_accvgpr_write_b32 a20, v243
v_accvgpr_read_b32 v243, a21
v_mul_f32 v243, v243, v98
v_accvgpr_write_b32 a21, v243
v_accvgpr_read_b32 v243, a22
v_mul_f32 v243, v243, v98
v_accvgpr_write_b32 a22, v243
v_accvgpr_read_b32 v243, a23
v_mul_f32 v243, v243, v98
v_accvgpr_write_b32 a23, v243
v_accvgpr_read_b32 v243, a24
v_mul_f32 v243, v243, v98
v_accvgpr_write_b32 a24, v243
v_accvgpr_read_b32 v243, a25
v_mul_f32 v243, v243, v98
v_accvgpr_write_b32 a25, v243
v_accvgpr_read_b32 v243, a26
v_mul_f32 v243, v243, v98
v_accvgpr_write_b32 a26, v243
v_accvgpr_read_b32 v243, a27
v_mul_f32 v243, v243, v98
v_accvgpr_write_b32 a27, v243
v_accvgpr_read_b32 v243, a28
v_mul_f32 v243, v243, v98
v_accvgpr_write_b32 a28, v243
v_accvgpr_read_b32 v243, a29
v_mul_f32 v243, v243, v98
v_accvgpr_write_b32 a29, v243
v_accvgpr_read_b32 v243, a30
v_mul_f32 v243, v243, v98
v_accvgpr_write_b32 a30, v243
v_accvgpr_read_b32 v243, a31
v_mul_f32 v243, v243, v98
v_accvgpr_write_b32 a31, v243
v_mov_b32 v242, v97
v_max3_f32 v242, v242, v88, v89
v_max3_f32 v242, v242, v90, v91
v_max3_f32 v242, v242, v92, v93
v_max3_f32 v242, v242, v94, v95
v_max3_f32 v242, v242, v120, v121
v_max3_f32 v242, v242, v122, v123
v_max3_f32 v242, v242, v124, v125
v_max3_f32 v242, v242, v126, v127
v_mov_b32 v243, v242
s_nop 1
v_permlane32_swap_b32 v242, v243
v_max_f32 v242, v242, v243
v_mov_b32 v243, v242
s_nop 1
v_permlane16_swap_b32 v242, v243
v_max_f32 v242, v242, v243
v_sub_f32 v99, v97, v242
v_exp_f32 v99, v99
v_mov_b32 v97, v242
v_sub_f32 v88, v88, v242
v_sub_f32 v89, v89, v242
v_sub_f32 v90, v90, v242
v_sub_f32 v91, v91, v242
v_sub_f32 v92, v92, v242
v_sub_f32 v93, v93, v242
v_sub_f32 v94, v94, v242
v_sub_f32 v95, v95, v242
v_sub_f32 v120, v120, v242
v_sub_f32 v121, v121, v242
v_sub_f32 v122, v122, v242
v_sub_f32 v123, v123, v242
v_sub_f32 v124, v124, v242
v_sub_f32 v125, v125, v242
v_sub_f32 v126, v126, v242
v_sub_f32 v127, v127, v242
v_mul_f32 v3, v3, v99
v_accvgpr_read_b32 v243, a32
v_mul_f32 v243, v243, v99
v_accvgpr_write_b32 a32, v243
v_accvgpr_read_b32 v243, a33
v_mul_f32 v243, v243, v99
v_accvgpr_write_b32 a33, v243
v_accvgpr_read_b32 v243, a34
v_mul_f32 v243, v243, v99
v_accvgpr_write_b32 a34, v243
v_accvgpr_read_b32 v243, a35
v_mul_f32 v243, v243, v99
v_accvgpr_write_b32 a35, v243
v_accvgpr_read_b32 v243, a36
v_mul_f32 v243, v243, v99
v_accvgpr_write_b32 a36, v243
v_accvgpr_read_b32 v243, a37
v_mul_f32 v243, v243, v99
v_accvgpr_write_b32 a37, v243
v_accvgpr_read_b32 v243, a38
v_mul_f32 v243, v243, v99
v_accvgpr_write_b32 a38, v243
v_accvgpr_read_b32 v243, a39
v_mul_f32 v243, v243, v99
v_accvgpr_write_b32 a39, v243
v_accvgpr_read_b32 v243, a40
v_mul_f32 v243, v243, v99
v_accvgpr_write_b32 a40, v243
v_accvgpr_read_b32 v243, a41
v_mul_f32 v243, v243, v99
v_accvgpr_write_b32 a41, v243
v_accvgpr_read_b32 v243, a42
v_mul_f32 v243, v243, v99
v_accvgpr_write_b32 a42, v243
v_accvgpr_read_b32 v243, a43
v_mul_f32 v243, v243, v99
v_accvgpr_write_b32 a43, v243
v_accvgpr_read_b32 v243, a44
v_mul_f32 v243, v243, v99
v_accvgpr_write_b32 a44, v243
v_accvgpr_read_b32 v243, a45
v_mul_f32 v243, v243, v99
v_accvgpr_write_b32 a45, v243
v_accvgpr_read_b32 v243, a46
v_mul_f32 v243, v243, v99
v_accvgpr_write_b32 a46, v243
v_accvgpr_read_b32 v243, a47
v_mul_f32 v243, v243, v99
v_accvgpr_write_b32 a47, v243
v_accvgpr_read_b32 v243, a48
v_mul_f32 v243, v243, v99
v_accvgpr_write_b32 a48, v243
v_accvgpr_read_b32 v243, a49
v_mul_f32 v243, v243, v99
v_accvgpr_write_b32 a49, v243
v_accvgpr_read_b32 v243, a50
v_mul_f32 v243, v243, v99
v_accvgpr_write_b32 a50, v243
v_accvgpr_read_b32 v243, a51
v_mul_f32 v243, v243, v99
v_accvgpr_write_b32 a51, v243
v_accvgpr_read_b32 v243, a52
v_mul_f32 v243, v243, v99
v_accvgpr_write_b32 a52, v243
v_accvgpr_read_b32 v243, a53
v_mul_f32 v243, v243, v99
v_accvgpr_write_b32 a53, v243
v_accvgpr_read_b32 v243, a54
v_mul_f32 v243, v243, v99
v_accvgpr_write_b32 a54, v243
v_accvgpr_read_b32 v243, a55
v_mul_f32 v243, v243, v99
v_accvgpr_write_b32 a55, v243
v_accvgpr_read_b32 v243, a56
v_mul_f32 v243, v243, v99
v_accvgpr_write_b32 a56, v243
v_accvgpr_read_b32 v243, a57
v_mul_f32 v243, v243, v99
v_accvgpr_write_b32 a57, v243
v_accvgpr_read_b32 v243, a58
v_mul_f32 v243, v243, v99
v_accvgpr_write_b32 a58, v243
v_accvgpr_read_b32 v243, a59
v_mul_f32 v243, v243, v99
v_accvgpr_write_b32 a59, v243
v_accvgpr_read_b32 v243, a60
v_mul_f32 v243, v243, v99
v_accvgpr_write_b32 a60, v243
v_accvgpr_read_b32 v243, a61
v_mul_f32 v243, v243, v99
v_accvgpr_write_b32 a61, v243
v_accvgpr_read_b32 v243, a62
v_mul_f32 v243, v243, v99
v_accvgpr_write_b32 a62, v243
v_accvgpr_read_b32 v243, a63
v_mul_f32 v243, v243, v99
v_accvgpr_write_b32 a63, v243
v_exp_f32 v80, v80
v_exp_f32 v81, v81
v_exp_f32 v82, v82
v_add_f32 v2, v2, v80
v_add_f32 v2, v2, v81
v_exp_f32 v83, v83
v_cvt_pk_bf16_f32 v80, v80, v81
v_exp_f32 v84, v84
v_add_f32 v2, v2, v82
v_add_f32 v2, v2, v83
v_exp_f32 v85, v85
v_cvt_pk_bf16_f32 v81, v82, v83
v_exp_f32 v86, v86
v_add_f32 v2, v2, v84
v_add_f32 v2, v2, v85
v_exp_f32 v87, v87
v_cvt_pk_bf16_f32 v82, v84, v85
v_exp_f32 v88, v88
v_add_f32 v2, v2, v86
v_add_f32 v2, v2, v87
v_exp_f32 v89, v89
v_cvt_pk_bf16_f32 v83, v86, v87
v_exp_f32 v90, v90
v_add_f32 v3, v3, v88
v_add_f32 v3, v3, v89
v_exp_f32 v91, v91
v_cvt_pk_bf16_f32 v88, v88, v89
v_exp_f32 v92, v92
v_add_f32 v3, v3, v90
v_add_f32 v3, v3, v91
v_exp_f32 v93, v93
v_cvt_pk_bf16_f32 v89, v90, v91
v_exp_f32 v94, v94
v_add_f32 v3, v3, v92
v_add_f32 v3, v3, v93
v_exp_f32 v95, v95
v_cvt_pk_bf16_f32 v90, v92, v93
v_exp_f32 v112, v112
v_add_f32 v3, v3, v94
v_add_f32 v3, v3, v95
v_exp_f32 v113, v113
v_cvt_pk_bf16_f32 v91, v94, v95
v_exp_f32 v114, v114
v_add_f32 v2, v2, v112
v_add_f32 v2, v2, v113
v_exp_f32 v115, v115
v_cvt_pk_bf16_f32 v112, v112, v113
v_exp_f32 v116, v116
v_add_f32 v2, v2, v114
v_add_f32 v2, v2, v115
v_exp_f32 v117, v117
v_cvt_pk_bf16_f32 v113, v114, v115
v_exp_f32 v118, v118
v_add_f32 v2, v2, v116
v_add_f32 v2, v2, v117
v_exp_f32 v119, v119
v_cvt_pk_bf16_f32 v114, v116, v117
v_exp_f32 v120, v120
v_add_f32 v2, v2, v118
v_add_f32 v2, v2, v119
v_exp_f32 v121, v121
v_cvt_pk_bf16_f32 v115, v118, v119
v_exp_f32 v122, v122
v_add_f32 v3, v3, v120
v_add_f32 v3, v3, v121
v_exp_f32 v123, v123
v_cvt_pk_bf16_f32 v120, v120, v121
v_exp_f32 v124, v124
v_add_f32 v3, v3, v122
v_add_f32 v3, v3, v123
v_exp_f32 v125, v125
v_cvt_pk_bf16_f32 v121, v122, v123
v_exp_f32 v126, v126
v_add_f32 v3, v3, v124
v_add_f32 v3, v3, v125
v_exp_f32 v127, v127
v_cvt_pk_bf16_f32 v122, v124, v125
v_add_f32 v3, v3, v126
v_add_f32 v3, v3, v127
v_cvt_pk_bf16_f32 v123, v126, v127
s_waitcnt lgkmcnt(15)
MA 0,a,192,v,80
MA 32,a,192,v,88
s_waitcnt lgkmcnt(14)
MA 4,a,196,v,80
MA 36,a,196,v,88
s_waitcnt lgkmcnt(13)
MA 8,a,200,v,80
MA 40,a,200,v,88
s_waitcnt lgkmcnt(12)
MA 12,a,204,v,80
MA 44,a,204,v,88
s_waitcnt lgkmcnt(11)
MA 16,a,208,v,80
MA 48,a,208,v,88
s_waitcnt lgkmcnt(10)
MA 20,a,212,v,80
MA 52,a,212,v,88
s_waitcnt lgkmcnt(9)
MA 24,a,216,v,80
MA 56,a,216,v,88
s_waitcnt lgkmcnt(8)
MA 28,a,220,v,80
MA 60,a,220,v,88
s_waitcnt lgkmcnt(7)
MA 0,a,224,v,112
MA 32,a,224,v,120
s_waitcnt lgkmcnt(6)
MA 4,a,228,v,112
MA 36,a,228,v,120
s_waitcnt lgkmcnt(5)
MA 8,a,232,v,112
MA 40,a,232,v,120
s_waitcnt lgkmcnt(4)
MA 12,a,236,v,112
MA 44,a,236,v,120
s_waitcnt lgkmcnt(3)
MA 16,a,240,v,112
MA 48,a,240,v,120
s_waitcnt lgkmcnt(2)
MA 20,a,244,v,112
MA 52,a,244,v,120
s_waitcnt lgkmcnt(1)
MA 24,a,248,v,112
MA 56,a,248,v,120
s_waitcnt lgkmcnt(0)
MA 28,a,252,v,112
MA 60,a,252,v,120
s_add_u32 s71, s71, 16384
s_sub_u32 s72, s72, 64
s_sub_u32 s74, s74, 1
s_nop 15
s_cmp_lg_u32 s74, 0
s_cbranch_scc1 L_fb_tile
v_mov_b32 v240, v2
s_nop 1
v_permlane32_swap_b32 v2, v240
v_add_f32 v2, v2, v240
v_mov_b32 v240, v2
s_nop 1
v_permlane16_swap_b32 v2, v240
v_add_f32 v2, v2, v240
v_mov_b32 v240, v3
s_nop 1
v_permlane32_swap_b32 v3, v240
v_add_f32 v3, v3, v240
v_mov_b32 v240, v3
s_nop 1
v_permlane16_swap_b32 v3, v240
v_add_f32 v3, v3, v240
v_rcp_f32 v2, v2
v_rcp_f32 v3, v3
s_add_u32 s80, s73, 0x20000
s_nop 4
v_accvgpr_read_b32 v240, a0
v_accvgpr_read_b32 v241, a1
v_accvgpr_read_b32 v242, a2
v_accvgpr_read_b32 v243, a3
v_accvgpr_read_b32 v244, a4
v_accvgpr_read_b32 v245, a5
v_accvgpr_read_b32 v246, a6
v_accvgpr_read_b32 v247, a7
v_mul_f32 v240, v240, v2
v_mul_f32 v241, v241, v2
v_mul_f32 v242, v242, v2
v_mul_f32 v243, v243, v2
v_mul_f32 v244, v244, v2
v_mul_f32 v245, v245, v2
v_mul_f32 v246, v246, v2
v_mul_f32 v247, v247, v2
v_cvt_pk_bf16_f32 v248, v240, v241
v_cvt_pk_bf16_f32 v249, v242, v243
v_cvt_pk_bf16_f32 v250, v244, v245
v_cvt_pk_bf16_f32 v251, v246, v247
buffer_store_dwordx4 v[248:251], v15, s[60:63], s73 offen offset:0 sc1
v_accvgpr_read_b32 v240, a8
v_accvgpr_read_b32 v241, a9
v_accvgpr_read_b32 v242, a10
v_accvgpr_read_b32 v243, a11
v_accvgpr_read_b32 v244, a12
v_accvgpr_read_b32 v245, a13
v_accvgpr_read_b32 v246, a14
v_accvgpr_read_b32 v247, a15
v_mul_f32 v240, v240, v2
v_mul_f32 v241, v241, v2
v_mul_f32 v242, v242, v2
v_mul_f32 v243, v243, v2
v_mul_f32 v244, v244, v2
v_mul_f32 v245, v245, v2
v_mul_f32 v246, v246, v2
v_mul_f32 v247, v247, v2
v_cvt_pk_bf16_f32 v252, v240, v241
v_cvt_pk_bf16_f32 v253, v242, v243
v_cvt_pk_bf16_f32 v254, v244, v245
v_cvt_pk_bf16_f32 v255, v246, v247
buffer_store_dwordx4 v[252:255], v15, s[60:63], s73 offen offset:1024 sc1
v_accvgpr_read_b32 v240, a16
v_accvgpr_read_b32 v241, a17
v_accvgpr_read_b32 v242, a18
v_accvgpr_read_b32 v243, a19
v_accvgpr_read_b32 v244, a20
v_accvgpr_read_b32 v245, a21
v_accvgpr_read_b32 v246, a22
v_accvgpr_read_b32 v247, a23
v_mul_f32 v240, v240, v2
v_mul_f32 v241, v241, v2
v_mul_f32 v242, v242, v2
v_mul_f32 v243, v243, v2
v_mul_f32 v244, v244, v2
v_mul_f32 v245, v245, v2
v_mul_f32 v246, v246, v2
v_mul_f32 v247, v247, v2
v_cvt_pk_bf16_f32 v248, v240, v241
v_cvt_pk_bf16_f32 v249, v242, v243
v_cvt_pk_bf16_f32 v250, v244, v245
v_cvt_pk_bf16_f32 v251, v246, v247
buffer_store_dwordx4 v[248:251], v15, s[60:63], s73 offen offset:2048 sc1
v_accvgpr_read_b32 v240, a24
v_accvgpr_read_b32 v241, a25
v_accvgpr_read_b32 v242, a26
v_accvgpr_read_b32 v243, a27
v_accvgpr_read_b32 v244, a28
v_accvgpr_read_b32 v245, a29
v_accvgpr_read_b32 v246, a30
v_accvgpr_read_b32 v247, a31
v_mul_f32 v240, v240, v2
v_mul_f32 v241, v241, v2
v_mul_f32 v242, v242, v2
v_mul_f32 v243, v243, v2
v_mul_f32 v244, v244, v2
v_mul_f32 v245, v245, v2
v_mul_f32 v246, v246, v2
v_mul_f32 v247, v247, v2
v_cvt_pk_bf16_f32 v252, v240, v241
v_cvt_pk_bf16_f32 v253, v242, v243
v_cvt_pk_bf16_f32 v254, v244, v245
v_cvt_pk_bf16_f32 v255, v246, v247
buffer_store_dwordx4 v[252:255], v15, s[60:63], s73 offen offset:3072 sc1
v_accvgpr_read_b32 v240, a32
v_accvgpr_read_b32 v241, a33
v_accvgpr_read_b32 v242, a34
v_accvgpr_read_b32 v243, a35
v_accvgpr_read_b32 v244, a36
v_accvgpr_read_b32 v245, a37
v_accvgpr_read_b32 v246, a38
v_accvgpr_read_b32 v247, a39
v_mul_f32 v240, v240, v3
v_mul_f32 v241, v241, v3
v_mul_f32 v242, v242, v3
v_mul_f32 v243, v243, v3
v_mul_f32 v244, v244, v3
v_mul_f32 v245, v245, v3
v_mul_f32 v246, v246, v3
v_mul_f32 v247, v247, v3
v_cvt_pk_bf16_f32 v248, v240, v241
v_cvt_pk_bf16_f32 v249, v242, v243
v_cvt_pk_bf16_f32 v250, v244, v245
v_cvt_pk_bf16_f32 v251, v246, v247
buffer_store_dwordx4 v[248:251], v15, s[60:63], s80 offen offset:0 sc1
v_accvgpr_read_b32 v240, a40
v_accvgpr_read_b32 v241, a41
v_accvgpr_read_b32 v242, a42
v_accvgpr_read_b32 v243, a43
v_accvgpr_read_b32 v244, a44
v_accvgpr_read_b32 v245, a45
v_accvgpr_read_b32 v246, a46
v_accvgpr_read_b32 v247, a47
v_mul_f32 v240, v240, v3
v_mul_f32 v241, v241, v3
v_mul_f32 v242, v242, v3
v_mul_f32 v243, v243, v3
v_mul_f32 v244, v244, v3
v_mul_f32 v245, v245, v3
v_mul_f32 v246, v246, v3
v_mul_f32 v247, v247, v3
v_cvt_pk_bf16_f32 v252, v240, v241
v_cvt_pk_bf16_f32 v253, v242, v243
v_cvt_pk_bf16_f32 v254, v244, v245
v_cvt_pk_bf16_f32 v255, v246, v247
buffer_store_dwordx4 v[252:255], v15, s[60:63], s80 offen offset:1024 sc1
v_accvgpr_read_b32 v240, a48
v_accvgpr_read_b32 v241, a49
v_accvgpr_read_b32 v242, a50
v_accvgpr_read_b32 v243, a51
v_accvgpr_read_b32 v244, a52
v_accvgpr_read_b32 v245, a53
v_accvgpr_read_b32 v246, a54
v_accvgpr_read_b32 v247, a55
v_mul_f32 v240, v240, v3
v_mul_f32 v241, v241, v3
v_mul_f32 v242, v242, v3
v_mul_f32 v243, v243, v3
v_mul_f32 v244, v244, v3
v_mul_f32 v245, v245, v3
v_mul_f32 v246, v246, v3
v_mul_f32 v247, v247, v3
v_cvt_pk_bf16_f32 v248, v240, v241
v_cvt_pk_bf16_f32 v249, v242, v243
v_cvt_pk_bf16_f32 v250, v244, v245
v_cvt_pk_bf16_f32 v251, v246, v247
buffer_store_dwordx4 v[248:251], v15, s[60:63], s80 offen offset:2048 sc1
v_accvgpr_read_b32 v240, a56
v_accvgpr_read_b32 v241, a57
v_accvgpr_read_b32 v242, a58
v_accvgpr_read_b32 v243, a59
v_accvgpr_read_b32 v244, a60
v_accvgpr_read_b32 v245, a61
v_accvgpr_read_b32 v246, a62
v_accvgpr_read_b32 v247, a63
v_mul_f32 v240, v240, v3
v_mul_f32 v241, v241, v3
v_mul_f32 v242, v242, v3
v_mul_f32 v243, v243, v3
v_mul_f32 v244, v244, v3
v_mul_f32 v245, v245, v3
v_mul_f32 v246, v246, v3
v_mul_f32 v247, v247, v3
v_cvt_pk_bf16_f32 v252, v240, v241
v_cvt_pk_bf16_f32 v253, v242, v243
v_cvt_pk_bf16_f32 v254, v244, v245
v_cvt_pk_bf16_f32 v255, v246, v247
buffer_store_dwordx4 v[252:255], v15, s[60:63], s80 offen offset:3072 sc1
s_cmp_lg_u32 s81, 0
s_cbranch_scc1 L_fb_done
s_mov_b32 s81, 1
s_sub_u32 s74, 34, s77
s_mov_b32 s73, s101
s_mov_b32 s72, s70
v_mov_b32 v16, v48
v_mov_b32 v17, v49
v_mov_b32 v18, v50
v_mov_b32 v19, v51
v_mov_b32 v20, v52
v_mov_b32 v21, v53
v_mov_b32 v22, v54
v_mov_b32 v23, v55
v_mov_b32 v24, v56
v_mov_b32 v25, v57
v_mov_b32 v26, v58
v_mov_b32 v27, v59
v_mov_b32 v28, v60
v_mov_b32 v29, v61
v_mov_b32 v30, v62
v_mov_b32 v31, v63
v_mov_b32 v32, v64
v_mov_b32 v33, v65
v_mov_b32 v34, v66
v_mov_b32 v35, v67
v_mov_b32 v36, v68
v_mov_b32 v37, v69
v_mov_b32 v38, v70
v_mov_b32 v39, v71
v_mov_b32 v40, v72
v_mov_b32 v41, v73
v_mov_b32 v42, v74
v_mov_b32 v43, v75
v_mov_b32 v44, v76
v_mov_b32 v45, v77
v_mov_b32 v46, v78
v_mov_b32 v47, v79
s_branch L_fb_set
L_fb_done:
s_waitcnt vmcnt(0) lgkmcnt(0)
s_barrier
s_load_dwordx2 s[88:89], s[0:1], 104
s_mul_i32 s36, s3, 16640
v_and_b32 v16, 15, v1
v_lshrrev_b32 v17, 4, v1
v_add_u32 v18, 13, v16
v_and_b32 v19, 3, v18
v_cmp_eq_u32 vcc, 0, v19
v_lshrrev_b32 v18, 2, v18
v_mul_u32_u24 v19, 4160, v19
v_cndmask_b32 v19, v19, 8, vcc
v_lshl_add_u32 v19, v18, 3, v19
v_lshl_add_u32 v19, v17, 4, v19
v_add_u32 v4, s36, v19
v_add_u32 v10, s36, v232
v_lshlrev_b32 v18, 5, v16
v_lshlrev_b32 v19, 4, v17
v_sub_u32 v19, v19, v18
s_add_u32 s37, s43, 480
v_add_u32 v5, s37, v19
v_mul_u32_u24 v18, 136, v16
v_lshl_add_u32 v18, v17, 5, v18
s_lshl_b32 s37, s3, 1
s_add_u32 s37, s37, 49152
v_add_u32 v11, s37, v18
v_lshrrev_b32 v18, 3, v1
v_mul_u32_u24 v18, 136, v18
v_and_b32 v19, 7, v1
v_lshl_add_u32 v18, v19, 4, v18
s_mul_i32 s37, s3, 4352
s_add_u32 s37, s37, 49152
v_add_u32 v12, s37, v18
s_lshl_b32 s37, s3, 12
v_add_u32 v13, s37, v232
v_lshl_add_u32 v18, v17, 3, v16
v_sub_u32 v235, 15, v18
v_mov_b32 v20, 0
v_mov_b32 v21, 0
v_mov_b32 v22, 0
v_mov_b32 v23, 0
v_and_b32 v16, 3, v1
v_mul_u32_u24 v16, 4160, v16
v_lshrrev_b32 v17, 2, v1
v_min_u32 v17, 3, v17
v_lshl_add_u32 v16, v17, 4, v16
v_add_u32 v16, s36, v16
ds_write_b128 v16, v[20:23]
v_and_b32 v17, 31, v1
v_lshlrev_b32 v17, 4, v17
v_add_u32 v17, s43, v17
ds_write_b128 v17, v[20:23] offset:4096
v_alignbit_b32 v24, v209, v208, 16
v_alignbit_b32 v25, v210, v209, 16
v_alignbit_b32 v26, v211, v210, 16
v_alignbit_b32 v27, v212, v211, 16
v_alignbit_b32 v28, v213, v212, 16
ds_write_b128 v10, v[210:213] offset:64
ds_write_b128 v10, v[24:27] offset:4208
v_mov_b32 v16, v209
v_mov_b32 v17, v210
v_mov_b32 v18, v211
v_mov_b32 v19, v212
ds_write_b128 v10, v[16:19] offset:8368
v_mov_b32 v16, v25
v_mov_b32 v17, v26
v_mov_b32 v18, v27
v_mov_b32 v19, v28
ds_write_b128 v10, v[16:19] offset:12528
v_alignbit_b32 v30, v215, v214, 16
v_alignbit_b32 v31, v216, v215, 16
v_alignbit_b32 v32, v217, v216, 16
v_alignbit_b32 v33, v218, v217, 16
v_alignbit_b32 v34, v219, v218, 16
ds_write_b128 v10, v[216:219] offset:1088
ds_write_b128 v10, v[30:33] offset:5232
v_mov_b32 v16, v215
v_mov_b32 v17, v216
v_mov_b32 v18, v217
v_mov_b32 v19, v218
ds_write_b128 v10, v[16:19] offset:9392
v_mov_b32 v16, v31
v_mov_b32 v17, v32
v_mov_b32 v18, v33
v_mov_b32 v19, v34
ds_write_b128 v10, v[16:19] offset:13552
v_alignbit_b32 v24, v221, v220, 16
v_alignbit_b32 v25, v222, v221, 16
v_alignbit_b32 v26, v223, v222, 16
v_alignbit_b32 v27, v224, v223, 16
v_alignbit_b32 v28, v225, v224, 16
ds_write_b128 v10, v[222:225] offset:2112
ds_write_b128 v10, v[24:27] offset:6256
v_mov_b32 v16, v221
v_mov_b32 v17, v222
v_mov_b32 v18, v223
v_mov_b32 v19, v224
ds_write_b128 v10, v[16:19] offset:10416
v_mov_b32 v16, v25
v_mov_b32 v17, v26
v_mov_b32 v18, v27
v_mov_b32 v19, v28
ds_write_b128 v10, v[16:19] offset:14576
v_alignbit_b32 v30, v227, v226, 16
v_alignbit_b32 v31, v228, v227, 16
v_alignbit_b32 v32, v229, v228, 16
v_alignbit_b32 v33, v230, v229, 16
v_alignbit_b32 v34, v231, v230, 16
ds_write_b128 v10, v[228:231] offset:3136
ds_write_b128 v10, v[30:33] offset:7280
v_mov_b32 v16, v227
v_mov_b32 v17, v228
v_mov_b32 v18, v229
v_mov_b32 v19, v230
ds_write_b128 v10, v[16:19] offset:11440
v_mov_b32 v16, v31
v_mov_b32 v17, v32
v_mov_b32 v18, v33
v_mov_b32 v19, v34
ds_write_b128 v10, v[16:19] offset:15600
v_lshlrev_b32 v16, 16, v234
v_cmp_eq_u32 vcc, 0, v235
s_nop 1
v_cndmask_b32 v44, 0, v234, vcc
v_cmp_eq_u32 vcc, 1, v235
s_nop 1
v_cndmask_b32 v44, v44, v16, vcc
v_cmp_eq_u32 vcc, 2, v235
s_nop 1
v_cndmask_b32 v45, 0, v234, vcc
v_cmp_eq_u32 vcc, 3, v235
s_nop 1
v_cndmask_b32 v45, v45, v16, vcc
v_cmp_eq_u32 vcc, 4, v235
s_nop 1
v_cndmask_b32 v46, 0, v234, vcc
v_cmp_eq_u32 vcc, 5, v235
s_nop 1
v_cndmask_b32 v46, v46, v16, vcc
v_cmp_eq_u32 vcc, 6, v235
s_nop 1
v_cndmask_b32 v47, 0, v234, vcc
v_cmp_eq_u32 vcc, 7, v235
s_nop 1
v_cndmask_b32 v47, v47, v16, vcc
s_waitcnt lgkmcnt(0)
s_branch L_p3_done
L_spin_go:
s_mov_b32 s36, 400000
L_spin_go_l:
s_sleep 1
buffer_load_dword v254, off, s[12:15], 0 sc1
s_waitcnt vmcnt(0)
v_cmp_gt_u32 vcc, 1, v254
s_nop 4
s_cbranch_vccz L_spin_go_ret
s_sub_u32 s36, s36, 1
s_cmp_lg_u32 s36, 0
s_cbranch_scc1 L_spin_go_l
s_branch L_spin_go_ret
L_spin_f1:
s_mov_b32 s36, 400000
L_spin_f1_l:
s_sleep 1
buffer_load_dword v237, v233, s[8:11], 0 offen offset:0 sc1
s_waitcnt vmcnt(0)
v_cmp_gt_u32 vcc, 1, v237
s_nop 4
s_cbranch_vccz L_spin_f1_ret
s_sub_u32 s36, s36, 1
s_cmp_lg_u32 s36, 0
s_cbranch_scc1 L_spin_f1_l
s_branch L_spin_f1_ret
L_spin_f2:
s_mov_b32 s36, 400000
L_spin_f2_l:
s_sleep 1
buffer_load_dword v253, v254, s[8:11], 0 offen offset:1024 sc1
s_waitcnt vmcnt(0)
v_cmp_gt_u32 vcc, 1, v253
s_nop 4
s_cbranch_vccz L_spin_f2_ret
s_sub_u32 s36, s36, 1
s_cmp_lg_u32 s36, 0
s_cbranch_scc1 L_spin_f2_l
s_branch L_spin_f2_ret
L_spin_f3:
s_mov_b32 s36, 400000
L_spin_f3_l:
s_sleep 1
buffer_load_dword v253, v254, s[8:11], 0 offen offset:3072 sc1
s_waitcnt vmcnt(0)
v_cmp_gt_u32 vcc, 1, v253
s_nop 4
s_cbranch_vccz L_spin_f3_ret
s_sub_u32 s36, s36, 1
s_cmp_lg_u32 s36, 0
s_cbranch_scc1 L_spin_f3_l
s_branch L_spin_f3_ret
L_code_end:
s_endpgm
.section .rodata,"a"
.p2align 6
.amdhsa_kernel gated_mix__ssm_conv_h3__compressed_kv_cla__prompt_kernel
  .amdhsa_next_free_vgpr 512
  .amdhsa_next_free_sgpr 102
  .amdhsa_accum_offset 256
  .amdhsa_group_segment_fixed_size 0
  .amdhsa_kernarg_size 128
  .amdhsa_user_sgpr_count 2
  .amdhsa_user_sgpr_kernarg_segment_ptr 1
  .amdhsa_system_sgpr_workgroup_id_x 1
  .amdhsa_float_denorm_mode_32 3
.end_amdhsa_kernel
.text
```

```asm
; @launch grid=(256,1,1) block=(256,1,1) lds=163840
.amdgcn_target "amdgcn-amd-amdhsa--gfx950"
.text
.macro MA d,x,a,y,b
v_mfma_f32_16x16x32_bf16 a[\d:\d+3], \x[\a:\a+3], \y[\b:\b+3], a[\d:\d+3]
.endm
.macro MV d,x,a,y,b
v_mfma_f32_16x16x32_bf16 v[\d:\d+3], \x[\a:\a+3], \y[\b:\b+3], v[\d:\d+3]
.endm
.macro TR d,a,o
ds_read_b64_tr_b16 v[\d:\d+1], v\a offset:\o
.endm
.globl gated_mix__ssm_conv_h3__compressed_kv_cla__prompt_kernel
.p2align 8
.type gated_mix__ssm_conv_h3__compressed_kv_cla__prompt_kernel,@function
gated_mix__ssm_conv_h3__compressed_kv_cla__prompt_kernel:
s_cmp_ge_u32 s2, 256
s_cbranch_scc1 L_end
s_load_dwordx2 s[44:45], s[0:1], 56
s_load_dwordx4 s[48:51], s[0:1], 72
s_load_dwordx2 s[40:41], s[0:1], 120
s_load_dwordx2 s[52:53], s[0:1], 112
s_load_dwordx2 s[32:33], s[0:1], 0
s_load_dwordx2 s[34:35], s[0:1], 64
v_lshrrev_b32 v2, 6, v0
v_and_b32 v1, 63, v0
v_lshlrev_b32 v3, 4, v0
v_readfirstlane_b32 s3, v2
s_and_b32 s36, s2, 7
s_lshr_b32 s37, s2, 3
s_and_b32 s38, s37, 7
s_lshr_b32 s37, s37, 3
s_lshr_b32 s42, s37, 1
s_and_b32 s37, s37, 1
s_lshl_b32 s36, s36, 1
s_add_u32 s36, s36, s37
s_lshl_b32 s24, s38, 18
s_lshl_b32 s39, s3, 16
s_add_u32 s24, s24, s39
s_lshl_b32 s25, s3, 17
s_lshl_b32 s39, s36, 9
s_add_u32 s25, s25, s39
s_and_b32 s20, s2, 7
s_lshl_b32 s21, s20, 19
s_lshl_b32 s20, s20, 7
s_lshl_b32 s22, s3, 13
s_add_u32 s23, s22, 98304
v_lshrrev_b32 v204, 3, v1
v_lshlrev_b32 v204, 10, v204
v_lshrrev_b32 v205, 4, v1
v_and_b32 v206, 7, v1
v_xor_b32 v206, v206, v205
v_lshl_add_u32 v204, v206, 4, v204
v_xor_b32 v207, 64, v204
v_add_u32 v176, 0, v204
v_add_u32 v177, 7168, v207
v_add_u32 v178, 14336, v204
v_add_u32 v179, 21504, v207
v_add_u32 v180, 32768, v204
v_add_u32 v181, 39936, v207
v_add_u32 v182, 47104, v204
v_add_u32 v183, 54272, v207
v_lshrrev_b32 v204, 5, v1
v_and_b32 v206, 31, v1
v_lshlrev_b32 v207, 1, v204
v_xor_b32 v206, v206, v207
v_lshlrev_b32 v204, 13, v204
v_xor_b32 v207, 0, v206
v_lshl_add_u32 v207, v207, 4, v204
v_add_u32 v184, 0, v207
v_xor_b32 v207, 4, v206
v_lshl_add_u32 v207, v207, 4, v204
v_add_u32 v185, 15360, v207
v_xor_b32 v207, 0, v206
v_lshl_add_u32 v207, v207, 4, v204
v_add_u32 v186, 30720, v207
v_xor_b32 v207, 4, v206
v_lshl_add_u32 v207, v207, 4, v204
v_add_u32 v187, 46080, v207
v_xor_b32 v207, 8, v206
v_lshl_add_u32 v207, v207, 4, v204
v_add_u32 v188, 65536, v207
v_xor_b32 v207, 12, v206
v_lshl_add_u32 v207, v207, 4, v204
v_add_u32 v189, 80896, v207
v_xor_b32 v207, 8, v206
v_lshl_add_u32 v207, v207, 4, v204
v_add_u32 v190, 96256, v207
v_xor_b32 v207, 12, v206
v_lshl_add_u32 v207, v207, 4, v204
v_add_u32 v191, 111616, v207
s_waitcnt lgkmcnt(0)
s_add_u32 s8, s44, s24
s_addc_u32 s9, s45, 0
s_mov_b32 s10, 65536
s_mov_b32 s11, 0x20000
s_cmp_eq_u32 s42, 0
s_cselect_b32 s12, s48, s50
s_cselect_b32 s13, s49, s51
s_add_u32 s12, s12, s25
s_addc_u32 s13, s13, 0
s_sub_u32 s14, 4194304, s25
s_mov_b32 s15, 0x20000
s_add_u32 s4, s40, 59768832
s_addc_u32 s5, s41, 0
s_mov_b32 s6, 8192
s_mov_b32 s7, 0x20000
s_lshl_b32 s43, s2, 20
v_add_u32 v3, s43, v3
v_mov_b32 v4, 0
v_mov_b32 v5, 0
v_mov_b32 v6, 0
v_mov_b32 v7, 0
s_movk_i32 s43, 4096
buffer_store_dwordx4 v[4:7], v3, s[4:7], 0 offen sc1
buffer_store_dwordx4 v[4:7], v3, s[4:7], s43 offen sc1
v_lshlrev_b32 v79, 16, v3
s_add_u32 m0, s23, 0
s_nop 0
buffer_load_dwordx4 v184, s[12:15], s21 offen offset:0 lds
buffer_load_dwordx4 v185, s[12:15], s21 offen offset:1024 lds
buffer_load_dwordx4 v186, s[12:15], s21 offen offset:2048 lds
buffer_load_dwordx4 v187, s[12:15], s21 offen offset:3072 lds
s_add_u32 m0, s23, 4096
s_nop 0
buffer_load_dwordx4 v188, s[12:15], s21 offen offset:0 lds
buffer_load_dwordx4 v189, s[12:15], s21 offen offset:1024 lds
buffer_load_dwordx4 v190, s[12:15], s21 offen offset:2048 lds
buffer_load_dwordx4 v191, s[12:15], s21 offen offset:3072 lds
s_add_u32 s21, s21, 524288
s_and_b32 s21, s21, 4194303
s_add_u32 m0, s22, 0
s_nop 0
buffer_load_dwordx4 v176, s[8:11], s20 offen offset:0 lds
buffer_load_dwordx4 v177, s[8:11], s20 offen offset:1024 lds
buffer_load_dwordx4 v178, s[8:11], s20 offen offset:2048 lds
buffer_load_dwordx4 v179, s[8:11], s20 offen offset:3072 lds
s_add_u32 m0, s22, 4096
s_nop 0
buffer_load_dwordx4 v180, s[8:11], s20 offen offset:0 lds
buffer_load_dwordx4 v181, s[8:11], s20 offen offset:1024 lds
buffer_load_dwordx4 v182, s[8:11], s20 offen offset:2048 lds
buffer_load_dwordx4 v183, s[8:11], s20 offen offset:3072 lds
s_add_u32 s20, s20, 128
s_and_b32 s20, s20, 1023
v_and_b32 v204, 15, v1
v_lshrrev_b32 v206, 1, v204
v_xor_b32 v206, v206, v205
v_lshlrev_b32 v206, 4, v206
v_lshl_add_u32 v206, v204, 7, v206
s_and_b32 s39, s3, 1
s_lshl_b32 s39, s39, 14
v_add_u32 v192, s39, v206
v_xor_b32 v193, 64, v192
v_add_u32 v194, 0x10000, v192
v_add_u32 v195, 0x10000, v193
v_bfe_u32 v204, v1, 2, 2
v_and_b32 v206, 1, v205
v_lshl_or_b32 v206, v206, 2, v204
v_lshl_add_u32 v204, v205, 3, v204
v_lshlrev_b32 v204, 9, v204
v_and_b32 v207, 3, v1
v_lshl_add_u32 v204, v207, 3, v204
s_lshr_b32 s39, s3, 1
s_lshl_b32 s39, s39, 8
s_add_u32 s39, s39, 98304
v_add_u32 v204, s39, v204
v_xor_b32 v207, 0, v206
v_lshl_add_u32 v196, v207, 5, v204
v_xor_b32 v207, 1, v206
v_lshl_add_u32 v197, v207, 5, v204
v_xor_b32 v207, 2, v206
v_lshl_add_u32 v198, v207, 5, v204
v_xor_b32 v207, 3, v206
v_lshl_add_u32 v199, v207, 5, v204
v_xor_b32 v207, 4, v206
v_lshl_add_u32 v200, v207, 5, v204
v_xor_b32 v207, 5, v206
v_lshl_add_u32 v201, v207, 5, v204
v_xor_b32 v207, 6, v206
v_lshl_add_u32 v202, v207, 5, v204
v_xor_b32 v207, 7, v206
v_lshl_add_u32 v203, v207, 5, v204
s_lshl_b32 s36, s36, 1
s_lshr_b32 s39, s3, 1
s_add_u32 s36, s36, s39
s_lshl_b32 s24, s36, 19
s_lshl_b32 s38, s38, 16
s_add_u32 s24, s24, s38
s_and_b32 s39, s3, 1
s_lshl_b32 s39, s39, 15
s_add_u32 s24, s24, s39
s_lshl_b32 s36, s42, 24
s_add_u32 s16, s40, s36
s_addc_u32 s17, s41, 0
s_mov_b32 s18, 16777216
s_mov_b32 s19, 0x20000
s_mov_b32 s54, 256
s_mov_b32 s55, 0x20000
v_mov_b32 v78, 1
s_cmp_lg_u32 s2, 0
s_cselect_b32 s43, 0x10000000, 0
v_or_b32 v79, s43, v79
s_waitcnt vmcnt(0)
s_barrier
buffer_store_dword v78, v79, s[52:55], 0 offen sc1
ds_read_b128 v[80:83], v192 offset:0
ds_read_b128 v[84:87], v192 offset:2048
ds_read_b128 v[88:91], v192 offset:4096
ds_read_b128 v[92:95], v192 offset:6144
ds_read_b128 v[96:99], v192 offset:8192
ds_read_b128 v[100:103], v192 offset:10240
ds_read_b128 v[104:107], v192 offset:12288
ds_read_b128 v[108:111], v192 offset:14336
TR 144,196,0
TR 146,196,2048
TR 148,197,0
TR 150,197,2048
TR 152,198,0
TR 154,198,2048
TR 156,199,0
TR 158,199,2048
TR 160,200,0
TR 162,200,2048
TR 164,201,0
TR 166,201,2048
TR 168,202,0
TR 170,202,2048
TR 172,203,0
TR 174,203,2048
s_cmp_eq_u32 s42, 0
s_cbranch_scc0 L_p1_V
s_waitcnt lgkmcnt(14)
v_mfma_f32_16x16x32_bf16 a[0:3], v[144:147], v[80:83], 0
s_add_u32 m0, s23, 32768
v_lshlrev_b32 v74, 7, v1
v_mfma_f32_16x16x32_bf16 a[32:35], v[144:147], v[84:87], 0
ds_read_b128 v[112:115], v193 offset:0
v_mfma_f32_16x16x32_bf16 a[64:67], v[144:147], v[88:91], 0
buffer_load_dwordx4 v184, s[12:15], s21 offen offset:0 lds
v_mfma_f32_16x16x32_bf16 a[96:99], v[144:147], v[92:95], 0
v_mfma_f32_16x16x32_bf16 a[128:131], v[144:147], v[96:99], 0
s_getpc_b64 s[4:5]
L_pcK:
v_mfma_f32_16x16x32_bf16 a[160:163], v[144:147], v[100:103], 0
buffer_load_dwordx4 v185, s[12:15], s21 offen offset:1024 lds
v_mfma_f32_16x16x32_bf16 a[192:195], v[144:147], v[104:107], 0
v_mfma_f32_16x16x32_bf16 a[224:227], v[144:147], v[108:111], 0
TR 144,196,16384
TR 146,196,18432
s_waitcnt lgkmcnt(15)
v_mfma_f32_16x16x32_bf16 a[4:7], v[148:151], v[80:83], 0
ds_read_b128 v[116:119], v193 offset:2048
buffer_load_dwordx4 v186, s[12:15], s21 offen offset:2048 lds
v_mfma_f32_16x16x32_bf16 a[36:39], v[148:151], v[84:87], 0
s_lshr_b32 s98, s2, 3
v_mfma_f32_16x16x32_bf16 a[68:71], v[148:151], v[88:91], 0
buffer_load_dwordx4 v187, s[12:15], s21 offen offset:3072 lds
v_mfma_f32_16x16x32_bf16 a[100:103], v[148:151], v[92:95], 0
v_mfma_f32_16x16x32_bf16 a[132:135], v[148:151], v[96:99], 0
s_add_u32 m0, s23, 36864
s_lshl_b32 s98, s98, 2
v_mfma_f32_16x16x32_bf16 a[164:167], v[148:151], v[100:103], 0
ds_read_b128 v[120:123], v193 offset:4096
v_mfma_f32_16x16x32_bf16 a[196:199], v[148:151], v[104:107], 0
v_mfma_f32_16x16x32_bf16 a[228:231], v[148:151], v[108:111], 0
TR 148,197,16384
TR 150,197,18432
s_waitcnt lgkmcnt(15)
v_mfma_f32_16x16x32_bf16 a[8:11], v[152:155], v[80:83], 0
buffer_load_dwordx4 v188, s[12:15], s21 offen offset:0 lds
s_add_u32 s98, s98, s3
v_mfma_f32_16x16x32_bf16 a[40:43], v[152:155], v[84:87], 0
v_mfma_f32_16x16x32_bf16 a[72:75], v[152:155], v[88:91], 0
buffer_load_dwordx4 v189, s[12:15], s21 offen offset:1024 lds
v_mfma_f32_16x16x32_bf16 a[104:107], v[152:155], v[92:95], 0
v_mfma_f32_16x16x32_bf16 a[136:139], v[152:155], v[96:99], 0
ds_read_b128 v[124:127], v193 offset:6144
buffer_load_dwordx4 v190, s[12:15], s21 offen offset:2048 lds
v_mfma_f32_16x16x32_bf16 a[168:171], v[152:155], v[100:103], 0
s_lshl_b32 s98, s98, 10
v_mfma_f32_16x16x32_bf16 a[200:203], v[152:155], v[104:107], 0
v_mfma_f32_16x16x32_bf16 a[232:235], v[152:155], v[108:111], 0
TR 152,198,16384
TR 154,198,18432
v_mfma_f32_16x16x32_bf16 a[12:15], v[156:159], v[80:83], 0
buffer_load_dwordx4 v191, s[12:15], s21 offen offset:3072 lds
v_and_b32 v75, 0x380, v74
v_mfma_f32_16x16x32_bf16 a[44:47], v[156:159], v[84:87], 0
s_add_u32 s21, s21, 524288
v_mfma_f32_16x16x32_bf16 a[76:79], v[156:159], v[88:91], 0
ds_read_b128 v[128:131], v193 offset:8192
v_mfma_f32_16x16x32_bf16 a[108:111], v[156:159], v[92:95], 0
v_mfma_f32_16x16x32_bf16 a[140:143], v[156:159], v[96:99], 0
s_and_b32 s21, s21, 4194303
v_add_u32 v75, s98, v75
v_mfma_f32_16x16x32_bf16 a[172:175], v[156:159], v[100:103], 0
v_mfma_f32_16x16x32_bf16 a[204:207], v[156:159], v[104:107], 0
v_mfma_f32_16x16x32_bf16 a[236:239], v[156:159], v[108:111], 0
TR 156,199,16384
TR 158,199,18432
s_waitcnt lgkmcnt(15)
v_mfma_f32_16x16x32_bf16 a[16:19], v[160:163], v[80:83], 0
ds_read_b128 v[132:135], v193 offset:10240
s_add_u32 m0, s22, 32768
v_mfma_f32_16x16x32_bf16 a[48:51], v[160:163], v[84:87], 0
buffer_load_dwordx4 v176, s[8:11], s20 offen offset:0 lds
v_min_u32 v75, L_code_end - L_pcK - 4, v75
v_mfma_f32_16x16x32_bf16 a[80:83], v[160:163], v[88:91], 0
v_mfma_f32_16x16x32_bf16 a[112:115], v[160:163], v[92:95], 0
v_mfma_f32_16x16x32_bf16 a[144:147], v[160:163], v[96:99], 0
buffer_load_dwordx4 v177, s[8:11], s20 offen offset:1024 lds
v_mfma_f32_16x16x32_bf16 a[176:179], v[160:163], v[100:103], 0
v_mov_b32 v77, s5
v_mfma_f32_16x16x32_bf16 a[208:211], v[160:163], v[104:107], 0
buffer_load_dwordx4 v178, s[8:11], s20 offen offset:2048 lds
v_mfma_f32_16x16x32_bf16 a[240:243], v[160:163], v[108:111], 0
TR 160,200,16384
TR 162,200,18432
v_mfma_f32_16x16x32_bf16 a[20:23], v[164:167], v[80:83], 0
ds_read_b128 v[136:139], v193 offset:12288
v_mfma_f32_16x16x32_bf16 a[52:55], v[164:167], v[84:87], 0
buffer_load_dwordx4 v179, s[8:11], s20 offen offset:3072 lds
v_mfma_f32_16x16x32_bf16 a[84:87], v[164:167], v[88:91], 0
v_add_co_u32 v76, vcc, s4, v75
s_nop 1
v_addc_co_u32 v77, vcc, 0, v77, vcc
v_mfma_f32_16x16x32_bf16 a[116:119], v[164:167], v[92:95], 0
s_add_u32 m0, s22, 36864
v_mfma_f32_16x16x32_bf16 a[148:151], v[164:167], v[96:99], 0
v_mfma_f32_16x16x32_bf16 a[180:183], v[164:167], v[100:103], 0
ds_read_b128 v[140:143], v193 offset:14336
v_mfma_f32_16x16x32_bf16 a[212:215], v[164:167], v[104:107], 0
buffer_load_dwordx4 v180, s[8:11], s20 offen offset:0 lds
v_mfma_f32_16x16x32_bf16 a[244:247], v[164:167], v[108:111], 0
TR 164,201,16384
TR 166,201,18432
v_mfma_f32_16x16x32_bf16 a[24:27], v[168:171], v[80:83], 0
v_mfma_f32_16x16x32_bf16 a[56:59], v[168:171], v[84:87], 0
buffer_load_dwordx4 v181, s[8:11], s20 offen offset:1024 lds
v_mfma_f32_16x16x32_bf16 a[88:91], v[168:171], v[88:91], 0
v_mfma_f32_16x16x32_bf16 a[120:123], v[168:171], v[92:95], 0
buffer_load_dwordx4 v182, s[8:11], s20 offen offset:2048 lds
v_mfma_f32_16x16x32_bf16 a[152:155], v[168:171], v[96:99], 0
v_mfma_f32_16x16x32_bf16 a[184:187], v[168:171], v[100:103], 0
v_mfma_f32_16x16x32_bf16 a[216:219], v[168:171], v[104:107], 0
buffer_load_dwordx4 v183, s[8:11], s20 offen offset:3072 lds
v_mfma_f32_16x16x32_bf16 a[248:251], v[168:171], v[108:111], 0
TR 168,202,16384
TR 170,202,18432
s_waitcnt lgkmcnt(15)
v_mfma_f32_16x16x32_bf16 a[28:31], v[172:175], v[80:83], 0
s_add_u32 s20, s20, 128
v_mfma_f32_16x16x32_bf16 a[60:63], v[172:175], v[84:87], 0
global_load_dword v79, v[76:77], off
v_mfma_f32_16x16x32_bf16 a[92:95], v[172:175], v[88:91], 0
v_mfma_f32_16x16x32_bf16 a[124:127], v[172:175], v[92:95], 0
s_and_b32 s20, s20, 1023
v_mfma_f32_16x16x32_bf16 a[156:159], v[172:175], v[96:99], 0
v_mfma_f32_16x16x32_bf16 a[188:191], v[172:175], v[100:103], 0
v_mfma_f32_16x16x32_bf16 a[220:223], v[172:175], v[104:107], 0
v_mfma_f32_16x16x32_bf16 a[252:255], v[172:175], v[108:111], 0
TR 172,203,16384
TR 174,203,18432
s_waitcnt lgkmcnt(2)
MA 0,v,144,v,112
s_add_u32 m0, s22, 65536
MA 32,v,144,v,116
MA 64,v,144,v,120
MA 96,v,144,v,124
buffer_load_dwordx4 v176, s[8:11], s20 offen offset:0 lds
MA 128,v,144,v,128
MA 160,v,144,v,132
MA 192,v,144,v,136
MA 224,v,144,v,140
buffer_load_dwordx4 v177, s[8:11], s20 offen offset:1024 lds
MA 4,v,148,v,112
MA 36,v,148,v,116
MA 68,v,148,v,120
buffer_load_dwordx4 v178, s[8:11], s20 offen offset:2048 lds
MA 100,v,148,v,124
MA 132,v,148,v,128
MA 164,v,148,v,132
MA 196,v,148,v,136
buffer_load_dwordx4 v179, s[8:11], s20 offen offset:3072 lds
MA 228,v,148,v,140
MA 8,v,152,v,112
MA 40,v,152,v,116
s_add_u32 m0, s22, 69632
MA 72,v,152,v,120
MA 104,v,152,v,124
MA 136,v,152,v,128
MA 168,v,152,v,132
buffer_load_dwordx4 v180, s[8:11], s20 offen offset:0 lds
MA 200,v,152,v,136
MA 232,v,152,v,140
MA 12,v,156,v,112
MA 44,v,156,v,116
buffer_load_dwordx4 v181, s[8:11], s20 offen offset:1024 lds
MA 76,v,156,v,120
MA 108,v,156,v,124
MA 140,v,156,v,128
buffer_load_dwordx4 v182, s[8:11], s20 offen offset:2048 lds
MA 172,v,156,v,132
MA 204,v,156,v,136
MA 236,v,156,v,140
MA 16,v,160,v,112
buffer_load_dwordx4 v183, s[8:11], s20 offen offset:3072 lds
MA 48,v,160,v,116
MA 80,v,160,v,120
MA 112,v,160,v,124
s_add_u32 s20, s20, 128
MA 144,v,160,v,128
MA 176,v,160,v,132
MA 208,v,160,v,136
MA 240,v,160,v,140
s_and_b32 s20, s20, 1023
MA 20,v,164,v,112
MA 52,v,164,v,116
MA 84,v,164,v,120
MA 116,v,164,v,124
MA 148,v,164,v,128
s_waitcnt vmcnt(9) lgkmcnt(0)
s_barrier
MA 180,v,164,v,132
TR 144,196,32768
TR 146,196,34816
MA 212,v,164,v,136
ds_read_b128 v[80:83], v192 offset:32768
s_add_u32 m0, s23, 0
MA 244,v,164,v,140
TR 148,197,32768
TR 150,197,34816
MA 24,v,168,v,112
ds_read_b128 v[84:87], v192 offset:34816
ds_read_b128 v[88:91], v192 offset:36864
MA 56,v,168,v,116
TR 152,198,32768
TR 154,198,34816
MA 88,v,168,v,120
ds_read_b128 v[92:95], v192 offset:38912
ds_read_b128 v[96:99], v192 offset:40960
MA 120,v,168,v,124
TR 156,199,32768
TR 158,199,34816
MA 152,v,168,v,128
ds_read_b128 v[100:103], v192 offset:43008
ds_read_b128 v[104:107], v192 offset:45056
MA 184,v,168,v,132
TR 160,200,32768
TR 162,200,34816
MA 216,v,168,v,136
ds_read_b128 v[108:111], v192 offset:47104
buffer_load_dwordx4 v184, s[12:15], s21 offen offset:0 lds
MA 248,v,168,v,140
TR 164,201,32768
TR 166,201,34816
MA 28,v,172,v,112
buffer_load_dwordx4 v185, s[12:15], s21 offen offset:1024 lds
buffer_load_dwordx4 v186, s[12:15], s21 offen offset:2048 lds
MA 60,v,172,v,116
TR 168,202,32768
TR 170,202,34816
MA 92,v,172,v,120
buffer_load_dwordx4 v187, s[12:15], s21 offen offset:3072 lds
s_add_u32 m0, s23, 4096
MA 124,v,172,v,124
buffer_load_dwordx4 v188, s[12:15], s21 offen offset:0 lds
buffer_load_dwordx4 v189, s[12:15], s21 offen offset:1024 lds
MA 156,v,172,v,128
buffer_load_dwordx4 v190, s[12:15], s21 offen offset:2048 lds
buffer_load_dwordx4 v191, s[12:15], s21 offen offset:3072 lds
MA 188,v,172,v,132
s_add_u32 s21, s21, 524288
s_and_b32 s21, s21, 4194303
MA 220,v,172,v,136
s_load_dwordx2 s[84:85], s[0:1], 8
s_load_dwordx2 s[88:89], s[0:1], 16
MA 252,v,172,v,140
TR 172,203,32768
TR 174,203,34816
s_load_dwordx2 s[92:93], s[0:1], 0
s_load_dwordx2 s[96:97], s[0:1], 24
s_load_dwordx2 s[76:77], s[0:1], 96
s_waitcnt lgkmcnt(2)
MA 0,v,144,v,80
s_add_u32 m0, s22, 0
MA 32,v,144,v,84
ds_read_b128 v[112:115], v193 offset:32768
MA 64,v,144,v,88
s_mov_b32 s4, s34
s_mov_b32 s5, s35
MA 96,v,144,v,92
MA 128,v,144,v,96
MA 160,v,144,v,100
buffer_load_dwordx4 v176, s[8:11], s20 offen offset:0 lds
MA 192,v,144,v,104
MA 224,v,144,v,108
TR 144,196,49152
TR 146,196,51200
MA 4,v,148,v,80
ds_read_b128 v[116:119], v193 offset:34816
MA 36,v,148,v,84
s_mov_b32 s6, 8388608
s_mov_b32 s7, 0x20000
MA 68,v,148,v,88
buffer_load_dwordx4 v177, s[8:11], s20 offen offset:1024 lds
MA 100,v,148,v,92
MA 132,v,148,v,96
MA 164,v,148,v,100
ds_read_b128 v[120:123], v193 offset:36864
MA 196,v,148,v,104
MA 228,v,148,v,108
TR 148,197,49152
TR 150,197,51200
MA 8,v,152,v,80
buffer_load_dwordx4 v178, s[8:11], s20 offen offset:2048 lds
s_lshr_b32 s43, s2, 3
MA 40,v,152,v,84
MA 72,v,152,v,88
MA 104,v,152,v,92
s_lshl_b32 s43, s43, 2
MA 136,v,152,v,96
ds_read_b128 v[124:127], v193 offset:38912
buffer_load_dwordx4 v179, s[8:11], s20 offen offset:3072 lds
MA 168,v,152,v,100
MA 200,v,152,v,104
MA 232,v,152,v,108
TR 152,198,49152
TR 154,198,51200
MA 12,v,156,v,80
s_add_u32 s43, s43, s3
MA 44,v,156,v,84
s_add_u32 m0, s22, 4096
MA 76,v,156,v,88
ds_read_b128 v[128:131], v193 offset:40960
MA 108,v,156,v,92
s_lshl_b32 s43, s43, 16
MA 140,v,156,v,96
MA 172,v,156,v,100
MA 204,v,156,v,104
MA 236,v,156,v,108
TR 156,199,49152
TR 158,199,51200
MA 16,v,160,v,80
ds_read_b128 v[132:135], v193 offset:43008
buffer_load_dwordx4 v180, s[8:11], s20 offen offset:0 lds
MA 48,v,160,v,84
s_and_b32 s37, s2, 7
MA 80,v,160,v,88
s_lshl_b32 s37, s37, 10
MA 112,v,160,v,92
MA 144,v,160,v,96
buffer_load_dwordx4 v181, s[8:11], s20 offen offset:1024 lds
MA 176,v,160,v,100
MA 208,v,160,v,104
s_add_u32 s43, s43, s37
MA 240,v,160,v,108
TR 160,200,49152
TR 162,200,51200
MA 20,v,164,v,80
ds_read_b128 v[136:139], v193 offset:45056
MA 52,v,164,v,84
buffer_load_dwordx4 v182, s[8:11], s20 offen offset:2048 lds
MA 84,v,164,v,88
v_lshrrev_b32 v78, 3, v1
MA 116,v,164,v,92
MA 148,v,164,v,96
MA 180,v,164,v,100
ds_read_b128 v[140:143], v193 offset:47104
MA 212,v,164,v,104
buffer_load_dwordx4 v183, s[8:11], s20 offen offset:3072 lds
s_waitcnt vmcnt(24)
v_and_b32 v79, 7, v1
MA 244,v,164,v,108
TR 164,201,49152
TR 166,201,51200
MA 24,v,168,v,80
MA 56,v,168,v,84
MA 88,v,168,v,88
v_lshlrev_b32 v79, 7, v79
MA 120,v,168,v,92
s_add_u32 s20, s20, 128
MA 152,v,168,v,96
MA 184,v,168,v,100
MA 216,v,168,v,104
v_lshl_add_u32 v78, v78, 13, v79
MA 248,v,168,v,108
TR 168,202,49152
TR 170,202,51200
s_waitcnt lgkmcnt(15)
MA 28,v,172,v,80
s_and_b32 s20, s20, 1023
MA 60,v,172,v,84
MA 92,v,172,v,88
v_add_u32 v78, s43, v78
MA 124,v,172,v,92
MA 156,v,172,v,96
MA 188,v,172,v,100
MA 220,v,172,v,104
MA 252,v,172,v,108
TR 172,203,49152
TR 174,203,51200
s_waitcnt lgkmcnt(2)
MA 0,v,144,v,112
MA 32,v,144,v,116
MA 64,v,144,v,120
MA 96,v,144,v,124
MA 128,v,144,v,128
MA 160,v,144,v,132
MA 192,v,144,v,136
MA 224,v,144,v,140
MA 4,v,148,v,112
MA 36,v,148,v,116
s_waitcnt vmcnt(8) lgkmcnt(0)
s_barrier
MA 68,v,148,v,120
TR 144,196,0
TR 146,196,2048
MA 100,v,148,v,124
ds_read_b128 v[80:83], v194 offset:0
s_add_u32 m0, s23, 32768
MA 132,v,148,v,128
s_mov_b32 s86, 4194304
s_mov_b32 s87, 0x20000
MA 164,v,148,v,132
s_mov_b32 s90, 4194304
s_mov_b32 s91, 0x20000
MA 196,v,148,v,136
buffer_load_dwordx4 v184, s[12:15], s21 offen offset:0 lds
MA 228,v,148,v,140
TR 148,197,0
TR 150,197,2048
MA 8,v,152,v,112
ds_read_b128 v[84:87], v194 offset:2048
s_mov_b32 s94, 4194304
MA 40,v,152,v,116
s_mov_b32 s95, 0x20000
s_mov_b32 s98, 8192
MA 72,v,152,v,120
buffer_load_dwordx4 v185, s[12:15], s21 offen offset:1024 lds
s_mov_b32 s99, 0x20000
MA 104,v,152,v,124
MA 136,v,152,v,128
s_mov_b32 s78, 2048
MA 168,v,152,v,132
ds_read_b128 v[88:91], v194 offset:4096
s_mov_b32 s79, 0x20000
MA 200,v,152,v,136
s_and_b32 s36, s2, 15
MA 232,v,152,v,140
TR 152,198,0
TR 154,198,2048
MA 12,v,156,v,112
buffer_load_dwordx4 v186, s[12:15], s21 offen offset:2048 lds
s_lshl_b32 s36, s36, 1
MA 44,v,156,v,116
s_lshr_b32 s37, s3, 1
MA 76,v,156,v,120
ds_read_b128 v[92:95], v194 offset:6144
s_add_u32 s36, s36, s37
MA 108,v,156,v,124
buffer_load_dwordx4 v187, s[12:15], s21 offen offset:3072 lds
s_lshl_b32 s36, s36, 3
MA 140,v,156,v,128
MA 172,v,156,v,132
v_and_b32 v252, 7, v1
MA 204,v,156,v,136
v_add_u32 v252, s36, v252
MA 236,v,156,v,140
TR 156,199,0
TR 158,199,2048
MA 16,v,160,v,112
ds_read_b128 v[96:99], v194 offset:8192
s_add_u32 m0, s23, 36864
MA 48,v,160,v,116
s_lshr_b32 s36, s2, 4
s_lshl_b32 s36, s36, 1
MA 80,v,160,v,120
s_and_b32 s37, s3, 1
MA 112,v,160,v,124
s_add_u32 s36, s36, s37
MA 144,v,160,v,128
ds_read_b128 v[100:103], v194 offset:10240
buffer_load_dwordx4 v188, s[12:15], s21 offen offset:0 lds
MA 176,v,160,v,132
s_lshl_b32 s36, s36, 3
v_lshrrev_b32 v253, 3, v1
MA 208,v,160,v,136
MA 240,v,160,v,140
TR 160,200,0
TR 162,200,2048
MA 20,v,164,v,112
buffer_load_dwordx4 v189, s[12:15], s21 offen offset:1024 lds
v_add_u32 v253, s36, v253
MA 52,v,164,v,116
ds_read_b128 v[104:107], v194 offset:12288
v_lshlrev_b32 v254, 14, v253
MA 84,v,164,v,120
v_lshl_add_u32 v254, v252, 3, v254
v_add_u32 v229, -6144, v254
MA 116,v,164,v,124
MA 148,v,164,v,128
buffer_load_dwordx4 v190, s[12:15], s21 offen offset:2048 lds
v_lshlrev_b32 v62, 5, v252
MA 180,v,164,v,132
v_lshlrev_b32 v254, 4, v253
MA 212,v,164,v,136
ds_read_b128 v[108:111], v194 offset:14336
v_sub_u32 v254, 4080, v254
MA 244,v,164,v,140
TR 164,201,0
TR 166,201,2048
MA 24,v,168,v,112
v_lshl_add_u32 v10, v252, 14, v254
MA 56,v,168,v,116
buffer_load_dwordx4 v191, s[12:15], s21 offen offset:3072 lds
v_and_b32 v252, 31, v1
MA 88,v,168,v,120
v_lshlrev_b32 v64, 4, v252
MA 120,v,168,v,124
s_lshl_b32 s36, s2, 2
MA 152,v,168,v,128
MA 184,v,168,v,132
s_add_u32 s21, s21, 524288
s_add_u32 s36, s36, s3
MA 216,v,168,v,136
s_lshl_b32 s36, s36, 1
MA 248,v,168,v,140
TR 168,202,0
TR 170,202,2048
MA 28,v,172,v,112
v_lshrrev_b32 v253, 5, v1
v_add_u32 v253, s36, v253
MA 60,v,172,v,116
s_and_b32 s21, s21, 4194303
MA 92,v,172,v,120
v_lshl_add_u32 v63, v253, 11, v64
MA 124,v,172,v,124
v_lshlrev_b32 v253, 2, v253
MA 156,v,172,v,128
v_lshl_add_u32 v11, v252, 20, v253
MA 188,v,172,v,132
MA 220,v,172,v,136
MA 252,v,172,v,140
TR 172,203,0
TR 174,203,2048
s_waitcnt lgkmcnt(2)
MA 0,v,144,v,80
s_add_u32 m0, s22, 32768
buffer_load_dwordx4 v[230:233], v63, s[92:95], 0 offen offset:0
MA 32,v,144,v,84
ds_read_b128 v[112:115], v195 offset:0
MA 64,v,144,v,88
MA 96,v,144,v,92
MA 128,v,144,v,96
buffer_load_dwordx4 v[2:5], v64, s[76:79], 0 offen offset:0
MA 160,v,144,v,100
buffer_load_dwordx4 v176, s[8:11], s20 offen offset:0 lds
MA 192,v,144,v,104
MA 224,v,144,v,108
TR 144,196,16384
TR 146,196,18432
MA 4,v,148,v,80
ds_read_b128 v[116:119], v195 offset:2048
MA 36,v,148,v,84
buffer_load_dwordx4 v[234:237], v63, s[92:95], 0 offen offset:512
MA 68,v,148,v,88
buffer_load_dwordx4 v177, s[8:11], s20 offen offset:1024 lds
MA 100,v,148,v,92
MA 132,v,148,v,96
MA 164,v,148,v,100
ds_read_b128 v[120:123], v195 offset:4096
MA 196,v,148,v,104
buffer_load_dwordx4 v[6:9], v64, s[76:79], 0 offen offset:512
MA 228,v,148,v,108
TR 148,197,16384
TR 150,197,18432
MA 8,v,152,v,80
buffer_load_dwordx4 v178, s[8:11], s20 offen offset:2048 lds
MA 40,v,152,v,84
MA 72,v,152,v,88
MA 104,v,152,v,92
buffer_load_dwordx4 v[238:241], v63, s[92:95], 0 offen offset:1024
MA 136,v,152,v,96
ds_read_b128 v[124:127], v195 offset:6144
buffer_load_dwordx4 v179, s[8:11], s20 offen offset:3072 lds
MA 168,v,152,v,100
MA 200,v,152,v,104
MA 232,v,152,v,108
TR 152,198,16384
TR 154,198,18432
MA 12,v,156,v,80
buffer_load_dwordx4 v[12:15], v64, s[76:79], 0 offen offset:1024
MA 44,v,156,v,84
s_add_u32 m0, s22, 36864
MA 76,v,156,v,88
ds_read_b128 v[128:131], v195 offset:8192
MA 108,v,156,v,92
MA 140,v,156,v,96
buffer_load_dwordx4 v[242:245], v63, s[92:95], 0 offen offset:1536
MA 172,v,156,v,100
MA 204,v,156,v,104
MA 236,v,156,v,108
TR 156,199,16384
TR 158,199,18432
MA 16,v,160,v,80
ds_read_b128 v[132:135], v195 offset:10240
buffer_load_dwordx4 v180, s[8:11], s20 offen offset:0 lds
MA 48,v,160,v,84
buffer_load_dwordx4 v[246:249], v64, s[76:79], 0 offen offset:1536
MA 80,v,160,v,88
MA 112,v,160,v,92
MA 144,v,160,v,96
buffer_load_dwordx4 v181, s[8:11], s20 offen offset:1024 lds
MA 176,v,160,v,100
MA 208,v,160,v,104
buffer_load_dwordx4 v[54:57], v62, s[96:99], 0 offen offset:0
MA 240,v,160,v,108
TR 160,200,16384
TR 162,200,18432
MA 20,v,164,v,80
ds_read_b128 v[136:139], v195 offset:12288
MA 52,v,164,v,84
buffer_load_dwordx4 v182, s[8:11], s20 offen offset:2048 lds
MA 84,v,164,v,88
buffer_load_dwordx4 v[58:61], v62, s[96:99], 0 offen offset:16
MA 116,v,164,v,92
MA 148,v,164,v,96
MA 180,v,164,v,100
ds_read_b128 v[140:143], v195 offset:14336
MA 212,v,164,v,104
buffer_load_dwordx4 v183, s[8:11], s20 offen offset:3072 lds
MA 244,v,164,v,108
TR 164,201,16384
TR 166,201,18432
MA 24,v,168,v,80
v_add_u32 v252, 0, v229
MA 56,v,168,v,84
MA 88,v,168,v,88
MA 120,v,168,v,92
s_add_u32 s20, s20, 128
MA 152,v,168,v,96
buffer_load_dwordx2 v[16:17], v252, s[84:87], 0 offen
MA 184,v,168,v,100
MA 216,v,168,v,104
MA 248,v,168,v,108
TR 168,202,16384
TR 170,202,18432
s_waitcnt lgkmcnt(15)
MA 28,v,172,v,80
s_and_b32 s20, s20, 1023
MA 60,v,172,v,84
v_add_u32 v253, 2048, v229
MA 92,v,172,v,88
MA 124,v,172,v,92
MA 156,v,172,v,96
MA 188,v,172,v,100
MA 220,v,172,v,104
MA 252,v,172,v,108
TR 172,203,16384
TR 174,203,18432
s_waitcnt lgkmcnt(2)
MA 0,v,144,v,112
MA 32,v,144,v,116
MA 64,v,144,v,120
MA 96,v,144,v,124
MA 128,v,144,v,128
MA 160,v,144,v,132
MA 192,v,144,v,136
MA 224,v,144,v,140
MA 4,v,148,v,112
MA 36,v,148,v,116
s_waitcnt vmcnt(19) lgkmcnt(0)
s_barrier
MA 68,v,148,v,120
TR 144,196,32768
TR 146,196,34816
MA 100,v,148,v,124
ds_read_b128 v[80:83], v192 offset:0
s_add_u32 m0, s23, 0
MA 132,v,148,v,128
s_and_b32 s80, s2, 7
s_lshr_b32 s81, s2, 3
MA 164,v,148,v,132
s_and_b32 s69, s81, 3
s_lshl_b32 s80, s80, 2
MA 196,v,148,v,136
buffer_load_dwordx4 v184, s[12:15], s21 offen offset:0 lds
s_add_u32 s69, s69, s80
MA 228,v,148,v,140
TR 148,197,32768
TR 150,197,34816
MA 8,v,152,v,112
ds_read_b128 v[84:87], v192 offset:2048
s_lshr_b32 s70, s81, 2
MA 40,v,152,v,116
s_lshl_b32 s80, s3, 16
s_lshl_b32 s65, s70, 18
MA 72,v,152,v,120
buffer_load_dwordx4 v185, s[12:15], s21 offen offset:1024 lds
s_sub_u32 s64, 3932160, s65
MA 104,v,152,v,124
s_add_u32 s65, s65, s80
MA 136,v,152,v,128
s_add_u32 s64, s64, s80
MA 168,v,152,v,132
ds_read_b128 v[88:91], v192 offset:4096
s_lshl_b32 s81, s69, 12
MA 200,v,152,v,136
s_lshl_b32 s100, s64, 2
MA 232,v,152,v,140
TR 152,198,32768
TR 154,198,34816
MA 12,v,156,v,112
buffer_load_dwordx4 v186, s[12:15], s21 offen offset:2048 lds
s_add_u32 s100, s100, s81
MA 44,v,156,v,116
s_lshl_b32 s101, s65, 2
s_add_u32 s101, s101, s81
MA 76,v,156,v,120
ds_read_b128 v[92:95], v192 offset:6144
s_lshl_b32 s66, s3, 17
MA 108,v,156,v,124
buffer_load_dwordx4 v187, s[12:15], s21 offen offset:3072 lds
s_lshl_b32 s81, s69, 8
MA 140,v,156,v,128
s_add_u32 s66, s66, s81
MA 172,v,156,v,132
s_and_b32 s74, s2, 7
MA 204,v,156,v,136
s_lshl_b32 s74, s74, 8
MA 236,v,156,v,140
TR 156,199,32768
TR 158,199,34816
MA 16,v,160,v,112
ds_read_b128 v[96:99], v192 offset:8192
s_add_u32 m0, s23, 4096
MA 48,v,160,v,116
s_mov_b32 s82, s66
s_lshl_b32 s66, s74, 12
MA 80,v,160,v,120
s_lshl_b32 s67, s3, 13
s_lshl_b32 s68, s3, 12
MA 112,v,160,v,124
s_lshl_b32 s77, s70, 1
MA 144,v,160,v,128
ds_read_b128 v[100:103], v192 offset:10240
buffer_load_dwordx4 v188, s[12:15], s21 offen offset:0 lds
MA 176,v,160,v,132
s_sub_u32 s77, 32, s77
v_lshrrev_b32 v66, 3, v1
MA 208,v,160,v,136
v_lshlrev_b32 v66, 11, v66
MA 240,v,160,v,140
TR 160,200,32768
TR 162,200,34816
MA 20,v,164,v,112
buffer_load_dwordx4 v189, s[12:15], s21 offen offset:1024 lds
v_lshrrev_b32 v67, 4, v1
MA 52,v,164,v,116
ds_read_b128 v[104:107], v192 offset:12288
v_and_b32 v68, 7, v1
MA 84,v,164,v,120
v_xor_b32 v68, v68, v67
v_lshl_add_u32 v66, v68, 4, v66
MA 116,v,164,v,124
v_xor_b32 v69, 64, v66
MA 148,v,164,v,128
buffer_load_dwordx4 v190, s[12:15], s21 offen offset:2048 lds
v_add_u32 v208, 0, v66
MA 180,v,164,v,132
v_add_u32 v209, 15360, v69
MA 212,v,164,v,136
ds_read_b128 v[108:111], v192 offset:14336
v_add_u32 v210, 30720, v66
MA 244,v,164,v,140
TR 164,201,32768
TR 166,201,34816
MA 24,v,168,v,112
v_add_u32 v211, 46080, v69
v_and_b32 v68, 15, v1
MA 56,v,168,v,116
buffer_load_dwordx4 v191, s[12:15], s21 offen offset:3072 lds
v_lshlrev_b32 v69, 1, v67
MA 88,v,168,v,120
v_xor_b32 v68, v68, v69
MA 120,v,168,v,124
v_lshlrev_b32 v66, 13, v67
MA 152,v,168,v,128
v_xor_b32 v69, 0, v68
MA 184,v,168,v,132
s_add_u32 s21, s21, 524288
v_lshl_add_u32 v69, v69, 4, v66
MA 216,v,168,v,136
v_add_u32 v212, 0, v69
MA 248,v,168,v,140
TR 168,202,32768
TR 170,202,34816
MA 28,v,172,v,112
v_xor_b32 v69, 0, v68
v_lshl_add_u32 v69, v69, 4, v66
MA 60,v,172,v,116
s_and_b32 s21, s21, 4194303
v_add_u32 v213, 31744, v69
MA 92,v,172,v,120
v_xor_b32 v69, 8, v68
MA 124,v,172,v,124
v_lshl_add_u32 v69, v69, 4, v66
MA 156,v,172,v,128
v_add_u32 v214, 63488, v69
MA 188,v,172,v,132
v_xor_b32 v69, 8, v68
MA 220,v,172,v,136
MA 252,v,172,v,140
TR 172,203,32768
TR 174,203,34816
s_waitcnt lgkmcnt(2)
MA 0,v,144,v,80
s_add_u32 m0, s22, 65536
buffer_load_dwordx2 v[18:19], v253, s[84:87], 0 offen
MA 32,v,144,v,84
ds_read_b128 v[112:115], v193 offset:0
MA 64,v,144,v,88
MA 96,v,144,v,92
MA 128,v,144,v,96
v_add_u32 v254, 4096, v229
MA 160,v,144,v,100
buffer_load_dwordx4 v176, s[8:11], s20 offen offset:0 lds
MA 192,v,144,v,104
MA 224,v,144,v,108
TR 144,196,49152
TR 146,196,51200
MA 4,v,148,v,80
ds_read_b128 v[116:119], v193 offset:2048
MA 36,v,148,v,84
buffer_load_dwordx2 v[20:21], v254, s[84:87], 0 offen
MA 68,v,148,v,88
buffer_load_dwordx4 v177, s[8:11], s20 offen offset:1024 lds
MA 100,v,148,v,92
MA 132,v,148,v,96
MA 164,v,148,v,100
ds_read_b128 v[120:123], v193 offset:4096
MA 196,v,148,v,104
v_add_u32 v255, 6144, v229
MA 228,v,148,v,108
TR 148,197,49152
TR 150,197,51200
MA 8,v,152,v,80
buffer_load_dwordx4 v178, s[8:11], s20 offen offset:2048 lds
MA 40,v,152,v,84
MA 72,v,152,v,88
MA 104,v,152,v,92
buffer_load_dwordx2 v[22:23], v255, s[84:87], 0 offen
MA 136,v,152,v,96
ds_read_b128 v[124:127], v193 offset:6144
buffer_load_dwordx4 v179, s[8:11], s20 offen offset:3072 lds
MA 168,v,152,v,100
MA 200,v,152,v,104
MA 232,v,152,v,108
TR 152,198,49152
TR 154,198,51200
MA 12,v,156,v,80
buffer_load_dwordx2 v[38:39], v255, s[88:91], 0 offen
MA 44,v,156,v,84
s_add_u32 m0, s22, 69632
MA 76,v,156,v,88
ds_read_b128 v[128:131], v193 offset:8192
MA 108,v,156,v,92
MA 140,v,156,v,96
v_add_u32 v252, 8192, v229
MA 172,v,156,v,100
MA 204,v,156,v,104
MA 236,v,156,v,108
TR 156,199,49152
TR 158,199,51200
MA 16,v,160,v,80
ds_read_b128 v[132:135], v193 offset:10240
buffer_load_dwordx4 v180, s[8:11], s20 offen offset:0 lds
MA 48,v,160,v,84
buffer_load_dwordx2 v[24:25], v252, s[84:87], 0 offen
MA 80,v,160,v,88
MA 112,v,160,v,92
MA 144,v,160,v,96
buffer_load_dwordx4 v181, s[8:11], s20 offen offset:1024 lds
MA 176,v,160,v,100
MA 208,v,160,v,104
buffer_load_dwordx2 v[40:41], v252, s[88:91], 0 offen
MA 240,v,160,v,108
TR 160,200,49152
TR 162,200,51200
MA 20,v,164,v,80
ds_read_b128 v[136:139], v193 offset:12288
MA 52,v,164,v,84
buffer_load_dwordx4 v182, s[8:11], s20 offen offset:2048 lds
MA 84,v,164,v,88
v_add_u32 v253, 10240, v229
MA 116,v,164,v,92
MA 148,v,164,v,96
MA 180,v,164,v,100
ds_read_b128 v[140:143], v193 offset:14336
MA 212,v,164,v,104
buffer_load_dwordx4 v183, s[8:11], s20 offen offset:3072 lds
MA 244,v,164,v,108
TR 164,201,49152
TR 166,201,51200
MA 24,v,168,v,80
buffer_load_dwordx2 v[26:27], v253, s[84:87], 0 offen
MA 56,v,168,v,84
MA 88,v,168,v,88
MA 120,v,168,v,92
s_add_u32 s20, s20, 128
MA 152,v,168,v,96
buffer_load_dwordx2 v[42:43], v253, s[88:91], 0 offen
MA 184,v,168,v,100
MA 216,v,168,v,104
MA 248,v,168,v,108
TR 168,202,49152
TR 170,202,51200
s_waitcnt lgkmcnt(15)
MA 28,v,172,v,80
s_and_b32 s20, s20, 1023
MA 60,v,172,v,84
v_add_u32 v254, 12288, v229
MA 92,v,172,v,88
MA 124,v,172,v,92
MA 156,v,172,v,96
MA 188,v,172,v,100
MA 220,v,172,v,104
MA 252,v,172,v,108
TR 172,203,49152
TR 174,203,51200
s_waitcnt lgkmcnt(2)
MA 0,v,144,v,112
MA 32,v,144,v,116
MA 64,v,144,v,120
MA 96,v,144,v,124
MA 128,v,144,v,128
MA 160,v,144,v,132
MA 192,v,144,v,136
MA 224,v,144,v,140
MA 4,v,148,v,112
MA 36,v,148,v,116
s_waitcnt vmcnt(16) lgkmcnt(0)
s_barrier
MA 68,v,148,v,120
TR 144,196,0
TR 146,196,2048
MA 100,v,148,v,124
ds_read_b128 v[80:83], v192 offset:32768
s_add_u32 m0, s23, 32768
MA 132,v,148,v,128
v_lshl_add_u32 v69, v69, 4, v66
v_add_u32 v215, 95232, v69
MA 164,v,148,v,132
v_and_b32 v66, 15, v1
v_lshrrev_b32 v68, 1, v66
MA 196,v,148,v,136
buffer_load_dwordx4 v184, s[12:15], s21 offen offset:0 lds
v_xor_b32 v68, v68, v67
MA 228,v,148,v,140
TR 148,197,0
TR 150,197,2048
MA 8,v,152,v,112
ds_read_b128 v[84:87], v192 offset:34816
v_lshlrev_b32 v68, 4, v68
MA 40,v,152,v,116
v_lshl_add_u32 v68, v66, 7, v68
v_add_u32 v224, s67, v68
MA 72,v,152,v,120
buffer_load_dwordx4 v185, s[12:15], s21 offen offset:1024 lds
v_xor_b32 v225, 64, v224
MA 104,v,152,v,124
v_add_u32 v226, 0x10000, v224
v_add_u32 v227, 0x10000, v225
MA 136,v,152,v,128
v_bfe_u32 v66, v1, 2, 2
v_and_b32 v68, 1, v67
MA 168,v,152,v,132
ds_read_b128 v[88:91], v192 offset:36864
v_lshl_or_b32 v68, v68, 2, v66
MA 200,v,152,v,136
v_lshl_add_u32 v66, v67, 3, v66
MA 232,v,152,v,140
TR 152,198,0
TR 154,198,2048
MA 12,v,156,v,112
buffer_load_dwordx4 v186, s[12:15], s21 offen offset:2048 lds
v_lshlrev_b32 v66, 8, v66
MA 44,v,156,v,116
v_and_b32 v69, 3, v1
v_lshl_add_u32 v66, v69, 3, v66
MA 76,v,156,v,120
ds_read_b128 v[92:95], v192 offset:38912
v_add_u32 v66, 98304, v66
MA 108,v,156,v,124
buffer_load_dwordx4 v187, s[12:15], s21 offen offset:3072 lds
v_xor_b32 v69, 0, v68
MA 140,v,156,v,128
v_lshl_add_u32 v216, v69, 5, v66
v_xor_b32 v69, 1, v68
MA 172,v,156,v,132
v_lshl_add_u32 v217, v69, 5, v66
MA 204,v,156,v,136
v_xor_b32 v69, 2, v68
MA 236,v,156,v,140
TR 156,199,0
TR 158,199,2048
MA 16,v,160,v,112
ds_read_b128 v[96:99], v192 offset:40960
s_add_u32 m0, s23, 36864
MA 48,v,160,v,116
v_lshl_add_u32 v218, v69, 5, v66
v_xor_b32 v69, 3, v68
MA 80,v,160,v,120
v_lshl_add_u32 v219, v69, 5, v66
v_xor_b32 v69, 4, v68
MA 112,v,160,v,124
v_lshl_add_u32 v220, v69, 5, v66
MA 144,v,160,v,128
ds_read_b128 v[100:103], v192 offset:43008
buffer_load_dwordx4 v188, s[12:15], s21 offen offset:0 lds
MA 176,v,160,v,132
v_xor_b32 v69, 5, v68
v_lshl_add_u32 v221, v69, 5, v66
MA 208,v,160,v,136
v_xor_b32 v69, 6, v68
v_lshl_add_u32 v222, v69, 5, v66
MA 240,v,160,v,140
TR 160,200,0
TR 162,200,2048
MA 20,v,164,v,112
buffer_load_dwordx4 v189, s[12:15], s21 offen offset:1024 lds
v_xor_b32 v69, 7, v68
MA 52,v,164,v,116
ds_read_b128 v[104:107], v192 offset:45056
v_lshl_add_u32 v223, v69, 5, v66
MA 84,v,164,v,120
s_mov_b32 s44, s32
s_mov_b32 s45, s33
MA 116,v,164,v,124
s_mov_b32 s46, 4194304
MA 148,v,164,v,128
buffer_load_dwordx4 v190, s[12:15], s21 offen offset:2048 lds
s_mov_b32 s47, 0x20000
MA 180,v,164,v,132
s_add_u32 s48, s34, s82
s_addc_u32 s49, s35, 0
MA 212,v,164,v,136
ds_read_b128 v[108:111], v192 offset:47104
s_sub_u32 s50, 8388608, s82
MA 244,v,164,v,140
TR 164,201,0
TR 166,201,2048
MA 24,v,168,v,112
s_mov_b32 s51, 0x20000
MA 56,v,168,v,116
buffer_load_dwordx4 v191, s[12:15], s21 offen offset:3072 lds
MA 88,v,168,v,120
s_add_u32 s60, s40, 33554432
s_addc_u32 s61, s41, 0
MA 120,v,168,v,124
s_mov_b32 s62, 16777216
s_mov_b32 s63, 0x20000
MA 152,v,168,v,128
s_lshl_b32 s80, s69, 19
MA 184,v,168,v,132
s_add_u32 s21, s21, 524288
MA 216,v,168,v,136
s_add_u32 s52, s40, s80
s_addc_u32 s53, s41, 0
MA 248,v,168,v,140
TR 168,202,0
TR 170,202,2048
MA 28,v,172,v,112
s_lshl_b32 s54, s77, 14
s_mov_b32 s55, 0x20000
MA 60,v,172,v,116
s_and_b32 s21, s21, 4194303
s_add_u32 s80, s80, 16760832
MA 92,v,172,v,120
s_add_u32 s56, s40, s80
s_addc_u32 s57, s41, 0
MA 124,v,172,v,124
s_add_u32 s58, s54, 16384
MA 156,v,172,v,128
s_mov_b32 s59, 0x20000
MA 188,v,172,v,132
s_load_dwordx2 s[38:39], s[0:1], 112
MA 220,v,172,v,136
MA 252,v,172,v,140
TR 172,203,0
TR 174,203,2048
s_waitcnt lgkmcnt(2)
MA 0,v,144,v,80
s_add_u32 m0, s22, 0
buffer_load_dwordx2 v[28:29], v254, s[84:87], 0 offen
MA 32,v,144,v,84
ds_read_b128 v[112:115], v193 offset:32768
MA 64,v,144,v,88
MA 96,v,144,v,92
MA 128,v,144,v,96
buffer_load_dwordx2 v[44:45], v254, s[88:91], 0 offen
MA 160,v,144,v,100
buffer_load_dwordx4 v176, s[8:11], s20 offen offset:0 lds
MA 192,v,144,v,104
MA 224,v,144,v,108
TR 144,196,16384
TR 146,196,18432
MA 4,v,148,v,80
ds_read_b128 v[116:119], v193 offset:34816
v_add_u32 v255, 14336, v229
MA 36,v,148,v,84
MA 68,v,148,v,88
buffer_load_dwordx4 v177, s[8:11], s20 offen offset:1024 lds
MA 100,v,148,v,92
MA 132,v,148,v,96
MA 164,v,148,v,100
ds_read_b128 v[120:123], v193 offset:36864
buffer_load_dwordx2 v[30:31], v255, s[84:87], 0 offen
MA 196,v,148,v,104
MA 228,v,148,v,108
TR 148,197,16384
TR 150,197,18432
MA 8,v,152,v,80
buffer_load_dwordx4 v178, s[8:11], s20 offen offset:2048 lds
MA 40,v,152,v,84
buffer_load_dwordx2 v[46:47], v255, s[88:91], 0 offen
MA 72,v,152,v,88
MA 104,v,152,v,92
MA 136,v,152,v,96
ds_read_b128 v[124:127], v193 offset:38912
buffer_load_dwordx4 v179, s[8:11], s20 offen offset:3072 lds
MA 168,v,152,v,100
MA 200,v,152,v,104
v_add_u32 v252, 16384, v229
MA 232,v,152,v,108
TR 152,198,16384
TR 154,198,18432
MA 12,v,156,v,80
MA 44,v,156,v,84
s_add_u32 m0, s22, 4096
MA 76,v,156,v,88
ds_read_b128 v[128:131], v193 offset:40960
buffer_load_dwordx2 v[32:33], v252, s[84:87], 0 offen
MA 108,v,156,v,92
MA 140,v,156,v,96
MA 172,v,156,v,100
MA 204,v,156,v,104
MA 236,v,156,v,108
TR 156,199,16384
TR 158,199,18432
MA 16,v,160,v,80
ds_read_b128 v[132:135], v193 offset:43008
buffer_load_dwordx4 v180, s[8:11], s20 offen offset:0 lds
MA 48,v,160,v,84
buffer_load_dwordx2 v[48:49], v252, s[88:91], 0 offen
MA 80,v,160,v,88
MA 112,v,160,v,92
v_add_u32 v253, 18432, v229
MA 144,v,160,v,96
buffer_load_dwordx4 v181, s[8:11], s20 offen offset:1024 lds
MA 176,v,160,v,100
MA 208,v,160,v,104
MA 240,v,160,v,108
TR 160,200,16384
TR 162,200,18432
MA 20,v,164,v,80
ds_read_b128 v[136:139], v193 offset:45056
buffer_load_dwordx2 v[34:35], v253, s[84:87], 0 offen
MA 52,v,164,v,84
buffer_load_dwordx4 v182, s[8:11], s20 offen offset:2048 lds
MA 84,v,164,v,88
MA 116,v,164,v,92
MA 148,v,164,v,96
buffer_load_dwordx2 v[50:51], v253, s[88:91], 0 offen
MA 180,v,164,v,100
ds_read_b128 v[140:143], v193 offset:47104
MA 212,v,164,v,104
buffer_load_dwordx4 v183, s[8:11], s20 offen offset:3072 lds
MA 244,v,164,v,108
TR 164,201,16384
TR 166,201,18432
MA 24,v,168,v,80
v_add_u32 v254, 20480, v229
MA 56,v,168,v,84
MA 88,v,168,v,88
MA 120,v,168,v,92
s_add_u32 s20, s20, 128
MA 152,v,168,v,96
MA 184,v,168,v,100
buffer_load_dwordx2 v[36:37], v254, s[84:87], 0 offen
MA 216,v,168,v,104
MA 248,v,168,v,108
TR 168,202,16384
TR 170,202,18432
s_waitcnt lgkmcnt(15)
MA 28,v,172,v,80
s_and_b32 s20, s20, 1023
MA 60,v,172,v,84
buffer_load_dwordx2 v[52:53], v254, s[88:91], 0 offen
MA 92,v,172,v,88
MA 124,v,172,v,92
MA 156,v,172,v,96
MA 188,v,172,v,100
MA 220,v,172,v,104
MA 252,v,172,v,108
TR 172,203,16384
TR 174,203,18432
s_waitcnt lgkmcnt(2)
MA 0,v,144,v,112
MA 32,v,144,v,116
MA 64,v,144,v,120
MA 96,v,144,v,124
MA 128,v,144,v,128
MA 160,v,144,v,132
MA 192,v,144,v,136
MA 224,v,144,v,140
MA 4,v,148,v,112
MA 36,v,148,v,116
s_waitcnt vmcnt(18) lgkmcnt(0)
s_barrier
MA 68,v,148,v,120
TR 144,196,32768
TR 146,196,34816
MA 100,v,148,v,124
ds_read_b128 v[80:83], v194 offset:0
s_add_u32 m0, s23, 0
MA 132,v,148,v,128
MA 164,v,148,v,132
MA 196,v,148,v,136
buffer_load_dwordx4 v184, s[12:15], s21 offen offset:0 lds
MA 228,v,148,v,140
TR 148,197,32768
TR 150,197,34816
MA 8,v,152,v,112
ds_read_b128 v[84:87], v194 offset:2048
MA 40,v,152,v,116
MA 72,v,152,v,120
buffer_load_dwordx4 v185, s[12:15], s21 offen offset:1024 lds
MA 104,v,152,v,124
MA 136,v,152,v,128
MA 168,v,152,v,132
ds_read_b128 v[88:91], v194 offset:4096
MA 200,v,152,v,136
MA 232,v,152,v,140
TR 152,198,32768
TR 154,198,34816
MA 12,v,156,v,112
buffer_load_dwordx4 v186, s[12:15], s21 offen offset:2048 lds
MA 44,v,156,v,116
MA 76,v,156,v,120
ds_read_b128 v[92:95], v194 offset:6144
MA 108,v,156,v,124
buffer_load_dwordx4 v187, s[12:15], s21 offen offset:3072 lds
MA 140,v,156,v,128
MA 172,v,156,v,132
MA 204,v,156,v,136
MA 236,v,156,v,140
TR 156,199,32768
TR 158,199,34816
MA 16,v,160,v,112
ds_read_b128 v[96:99], v194 offset:8192
s_add_u32 m0, s23, 4096
MA 48,v,160,v,116
MA 80,v,160,v,120
MA 112,v,160,v,124
MA 144,v,160,v,128
ds_read_b128 v[100:103], v194 offset:10240
buffer_load_dwordx4 v188, s[12:15], s21 offen offset:0 lds
MA 176,v,160,v,132
MA 208,v,160,v,136
MA 240,v,160,v,140
TR 160,200,32768
TR 162,200,34816
MA 20,v,164,v,112
buffer_load_dwordx4 v189, s[12:15], s21 offen offset:1024 lds
MA 52,v,164,v,116
ds_read_b128 v[104:107], v194 offset:12288
MA 84,v,164,v,120
MA 116,v,164,v,124
MA 148,v,164,v,128
buffer_load_dwordx4 v190, s[12:15], s21 offen offset:2048 lds
MA 180,v,164,v,132
MA 212,v,164,v,136
ds_read_b128 v[108:111], v194 offset:14336
MA 244,v,164,v,140
TR 164,201,32768
TR 166,201,34816
MA 24,v,168,v,112
MA 56,v,168,v,116
buffer_load_dwordx4 v191, s[12:15], s21 offen offset:3072 lds
MA 88,v,168,v,120
MA 120,v,168,v,124
MA 152,v,168,v,128
MA 184,v,168,v,132
s_add_u32 s21, s21, 524288
MA 216,v,168,v,136
MA 248,v,168,v,140
TR 168,202,32768
TR 170,202,34816
MA 28,v,172,v,112
MA 60,v,172,v,116
s_and_b32 s21, s21, 4194303
MA 92,v,172,v,120
MA 124,v,172,v,124
MA 156,v,172,v,128
MA 188,v,172,v,132
MA 220,v,172,v,136
MA 252,v,172,v,140
TR 172,203,32768
TR 174,203,34816
s_waitcnt lgkmcnt(2)
MA 0,v,144,v,80
s_add_u32 m0, s22, 32768
MA 32,v,144,v,84
ds_read_b128 v[112:115], v195 offset:0
MA 64,v,144,v,88
MA 96,v,144,v,92
MA 128,v,144,v,96
MA 160,v,144,v,100
buffer_load_dwordx4 v176, s[8:11], s20 offen offset:0 lds
MA 192,v,144,v,104
MA 224,v,144,v,108
TR 144,196,49152
TR 146,196,51200
MA 4,v,148,v,80
ds_read_b128 v[116:119], v195 offset:2048
MA 36,v,148,v,84
MA 68,v,148,v,88
buffer_load_dwordx4 v177, s[8:11], s20 offen offset:1024 lds
MA 100,v,148,v,92
MA 132,v,148,v,96
MA 164,v,148,v,100
ds_read_b128 v[120:123], v195 offset:4096
MA 196,v,148,v,104
MA 228,v,148,v,108
TR 148,197,49152
TR 150,197,51200
MA 8,v,152,v,80
buffer_load_dwordx4 v178, s[8:11], s20 offen offset:2048 lds
MA 40,v,152,v,84
MA 72,v,152,v,88
MA 104,v,152,v,92
MA 136,v,152,v,96
ds_read_b128 v[124:127], v195 offset:6144
buffer_load_dwordx4 v179, s[8:11], s20 offen offset:3072 lds
MA 168,v,152,v,100
MA 200,v,152,v,104
MA 232,v,152,v,108
TR 152,198,49152
TR 154,198,51200
MA 12,v,156,v,80
MA 44,v,156,v,84
s_add_u32 m0, s22, 36864
MA 76,v,156,v,88
ds_read_b128 v[128:131], v195 offset:8192
MA 108,v,156,v,92
MA 140,v,156,v,96
MA 172,v,156,v,100
MA 204,v,156,v,104
MA 236,v,156,v,108
TR 156,199,49152
TR 158,199,51200
MA 16,v,160,v,80
ds_read_b128 v[132:135], v195 offset:10240
buffer_load_dwordx4 v180, s[8:11], s20 offen offset:0 lds
MA 48,v,160,v,84
MA 80,v,160,v,88
MA 112,v,160,v,92
MA 144,v,160,v,96
buffer_load_dwordx4 v181, s[8:11], s20 offen offset:1024 lds
MA 176,v,160,v,100
MA 208,v,160,v,104
MA 240,v,160,v,108
TR 160,200,49152
TR 162,200,51200
MA 20,v,164,v,80
ds_read_b128 v[136:139], v195 offset:12288
MA 52,v,164,v,84
buffer_load_dwordx4 v182, s[8:11], s20 offen offset:2048 lds
MA 84,v,164,v,88
MA 116,v,164,v,92
MA 148,v,164,v,96
MA 180,v,164,v,100
ds_read_b128 v[140:143], v195 offset:14336
MA 212,v,164,v,104
buffer_load_dwordx4 v183, s[8:11], s20 offen offset:3072 lds
MA 244,v,164,v,108
TR 164,201,49152
TR 166,201,51200
MA 24,v,168,v,80
MA 56,v,168,v,84
MA 88,v,168,v,88
MA 120,v,168,v,92
s_add_u32 s20, s20, 128
MA 152,v,168,v,96
MA 184,v,168,v,100
MA 216,v,168,v,104
MA 248,v,168,v,108
TR 168,202,49152
TR 170,202,51200
s_waitcnt lgkmcnt(15)
MA 28,v,172,v,80
s_and_b32 s20, s20, 1023
MA 60,v,172,v,84
MA 92,v,172,v,88
MA 124,v,172,v,92
MA 156,v,172,v,96
MA 188,v,172,v,100
MA 220,v,172,v,104
MA 252,v,172,v,108
TR 172,203,49152
TR 174,203,51200
s_waitcnt lgkmcnt(2)
MA 0,v,144,v,112
MA 32,v,144,v,116
MA 64,v,144,v,120
MA 96,v,144,v,124
MA 128,v,144,v,128
MA 160,v,144,v,132
MA 192,v,144,v,136
MA 224,v,144,v,140
MA 4,v,148,v,112
MA 36,v,148,v,116
s_waitcnt vmcnt(8) lgkmcnt(0)
s_barrier
MA 68,v,148,v,120
TR 144,196,0
TR 146,196,2048
MA 100,v,148,v,124
ds_read_b128 v[80:83], v192 offset:0
s_add_u32 m0, s23, 32768
MA 132,v,148,v,128
buffer_load_dword v79, v78, s[4:7], 0 offen
MA 164,v,148,v,132
s_add_u32 s84, s40, 50331648
s_addc_u32 s85, s41, 0
MA 196,v,148,v,136
buffer_load_dwordx4 v184, s[12:15], s21 offen offset:0 lds
s_mov_b32 s86, 4194304
MA 228,v,148,v,140
TR 148,197,0
TR 150,197,2048
MA 8,v,152,v,112
ds_read_b128 v[84:87], v192 offset:2048
s_mov_b32 s87, 0x20000
MA 40,v,152,v,116
s_add_u32 s88, s40, 58720256
s_addc_u32 s89, s41, 0
MA 72,v,152,v,120
buffer_load_dwordx4 v185, s[12:15], s21 offen offset:1024 lds
s_mov_b32 s90, 8192
MA 104,v,152,v,124
s_mov_b32 s91, 0x20000
v_mov_b32 v252, 0
MA 136,v,152,v,128
v_mov_b32 v253, 0
v_dot2_f32_bf16 v252, v230, v2, v252
MA 168,v,152,v,132
ds_read_b128 v[88:91], v192 offset:4096
v_dot2_f32_bf16 v253, v231, v3, v253
MA 200,v,152,v,136
v_dot2_f32_bf16 v252, v232, v4, v252
v_dot2_f32_bf16 v253, v233, v5, v253
MA 232,v,152,v,140
TR 152,198,0
TR 154,198,2048
MA 12,v,156,v,112
buffer_load_dwordx4 v186, s[12:15], s21 offen offset:2048 lds
v_dot2_f32_bf16 v252, v234, v6, v252
MA 44,v,156,v,116
v_dot2_f32_bf16 v253, v235, v7, v253
v_dot2_f32_bf16 v252, v236, v8, v252
MA 76,v,156,v,120
ds_read_b128 v[92:95], v192 offset:6144
v_dot2_f32_bf16 v253, v237, v9, v253
MA 108,v,156,v,124
buffer_load_dwordx4 v187, s[12:15], s21 offen offset:3072 lds
v_dot2_f32_bf16 v252, v238, v12, v252
MA 140,v,156,v,128
v_dot2_f32_bf16 v253, v239, v13, v253
v_dot2_f32_bf16 v252, v240, v14, v252
MA 172,v,156,v,132
v_dot2_f32_bf16 v253, v241, v15, v253
v_dot2_f32_bf16 v252, v242, v246, v252
MA 204,v,156,v,136
v_dot2_f32_bf16 v253, v243, v247, v253
v_dot2_f32_bf16 v252, v244, v248, v252
MA 236,v,156,v,140
TR 156,199,0
TR 158,199,2048
MA 16,v,160,v,112
ds_read_b128 v[96:99], v192 offset:8192
s_add_u32 m0, s23, 36864
MA 48,v,160,v,116
v_dot2_f32_bf16 v253, v245, v249, v253
MA 80,v,160,v,120
s_nop 2
v_add_f32 v252, v252, v253
MA 112,v,160,v,124
s_nop 0
v_add_f32_dpp v252, v252, v252 row_ror:8 row_mask:0xf bank_mask:0xf
s_nop 1
v_add_f32_dpp v252, v252, v252 row_ror:4 row_mask:0xf bank_mask:0xf
MA 144,v,160,v,128
ds_read_b128 v[100:103], v192 offset:10240
buffer_load_dwordx4 v188, s[12:15], s21 offen offset:0 lds
MA 176,v,160,v,132
v_add_f32_dpp v252, v252, v252 row_ror:2 row_mask:0xf bank_mask:0xf
s_nop 1
v_add_f32_dpp v252, v252, v252 row_ror:1 row_mask:0xf bank_mask:0xf
MA 208,v,160,v,136
v_mov_b32 v253, v252
s_nop 1
v_permlane16_swap_b32 v252, v253
MA 240,v,160,v,140
TR 160,200,0
TR 162,200,2048
MA 20,v,164,v,112
buffer_load_dwordx4 v189, s[12:15], s21 offen offset:1024 lds
v_add_f32 v252, v252, v253
MA 52,v,164,v,116
ds_read_b128 v[104:107], v192 offset:12288
v_mul_f32 v252, 0xbfb8aa3b, v252
MA 84,v,164,v,120
v_exp_f32 v252, v252
MA 116,v,164,v,124
v_add_f32 v252, 1.0, v252
MA 148,v,164,v,128
buffer_load_dwordx4 v190, s[12:15], s21 offen offset:2048 lds
MA 180,v,164,v,132
v_rcp_f32 v252, v252
MA 212,v,164,v,136
ds_read_b128 v[108:111], v192 offset:14336
MA 244,v,164,v,140
TR 164,201,0
TR 166,201,2048
MA 24,v,168,v,112
s_nop 0
buffer_store_dword v252, v11, s[88:91], 0 offen sc1
MA 56,v,168,v,116
buffer_load_dwordx4 v191, s[12:15], s21 offen offset:3072 lds
v_lshlrev_b32 v2, 16, v54
MA 88,v,168,v,120
v_and_b32 v3, 0xffff0000, v54
v_lshlrev_b32 v4, 16, v55
MA 120,v,168,v,124
v_and_b32 v5, 0xffff0000, v55
v_lshlrev_b32 v6, 16, v56
MA 152,v,168,v,128
v_and_b32 v7, 0xffff0000, v56
v_lshlrev_b32 v8, 16, v57
MA 184,v,168,v,132
s_add_u32 s21, s21, 524288
v_and_b32 v9, 0xffff0000, v57
MA 216,v,168,v,136
v_lshlrev_b32 v230, 16, v16
v_and_b32 v231, 0xffff0000, v16
MA 248,v,168,v,140
TR 168,202,0
TR 170,202,2048
MA 28,v,172,v,112
v_lshlrev_b32 v232, 16, v18
v_and_b32 v233, 0xffff0000, v18
MA 60,v,172,v,116
s_and_b32 s21, s21, 4194303
v_lshlrev_b32 v234, 16, v20
MA 92,v,172,v,120
v_and_b32 v235, 0xffff0000, v20
v_lshlrev_b32 v236, 16, v22
MA 124,v,172,v,124
v_and_b32 v237, 0xffff0000, v22
v_lshlrev_b32 v238, 16, v24
MA 156,v,172,v,128
v_and_b32 v239, 0xffff0000, v24
v_lshlrev_b32 v240, 16, v26
MA 188,v,172,v,132
v_and_b32 v241, 0xffff0000, v26
v_lshlrev_b32 v242, 16, v28
MA 220,v,172,v,136
v_and_b32 v243, 0xffff0000, v28
v_lshlrev_b32 v244, 16, v30
MA 252,v,172,v,140
TR 172,203,0
TR 174,203,2048
v_and_b32 v245, 0xffff0000, v30
v_lshlrev_b32 v246, 16, v32
v_and_b32 v247, 0xffff0000, v32
v_lshlrev_b32 v248, 16, v34
v_and_b32 v249, 0xffff0000, v34
v_lshlrev_b32 v250, 16, v36
v_and_b32 v251, 0xffff0000, v36
v_lshlrev_b32 v254, 16, v38
v_and_b32 v255, 0xffff0000, v38
v_mul_f32 v62, v236, v2
v_mul_f32 v70, v237, v6
v_fmac_f32 v62, v234, v3
v_fmac_f32 v70, v235, v7
v_fmac_f32 v62, v232, v4
v_fmac_f32 v70, v233, v8
v_fmac_f32 v62, v230, v5
v_fmac_f32 v70, v231, v9
v_mul_f32 v62, v62, v254
s_waitcnt lgkmcnt(2)
MA 0,v,144,v,80
s_add_u32 s75, s64, s74
v_mul_f32 v70, v70, v255
MA 32,v,144,v,84
ds_read_b128 v[112:115], v193 offset:0
v_lshlrev_b32 v254, 16, v40
MA 64,v,144,v,88
v_and_b32 v255, 0xffff0000, v40
v_mul_f32 v63, v238, v2
MA 96,v,144,v,92
v_mul_f32 v71, v239, v6
v_fmac_f32 v63, v236, v3
MA 128,v,144,v,96
s_add_u32 m0, s67, 65536
v_fmac_f32 v71, v237, v7
MA 160,v,144,v,100
v_fmac_f32 v63, v234, v4
MA 192,v,144,v,104
v_fmac_f32 v71, v235, v8
MA 224,v,144,v,108
TR 144,196,16384
TR 146,196,18432
MA 4,v,148,v,80
ds_read_b128 v[116:119], v193 offset:2048
buffer_load_dwordx4 v208, s[44:47], s75 offen offset:0 lds
MA 36,v,148,v,84
v_fmac_f32 v63, v232, v5
v_fmac_f32 v71, v233, v9
MA 68,v,148,v,88
v_mul_f32 v63, v63, v254
v_mul_f32 v71, v71, v255
MA 100,v,148,v,92
v_lshlrev_b32 v254, 16, v42
v_and_b32 v255, 0xffff0000, v42
MA 132,v,148,v,96
v_mul_f32 v64, v240, v2
v_mul_f32 v72, v241, v6
MA 164,v,148,v,100
ds_read_b128 v[120:123], v193 offset:4096
buffer_load_dwordx4 v209, s[44:47], s75 offen offset:1024 lds
MA 196,v,148,v,104
v_fmac_f32 v64, v238, v3
v_fmac_f32 v72, v239, v7
MA 228,v,148,v,108
TR 148,197,16384
TR 150,197,18432
MA 8,v,152,v,80
v_fmac_f32 v64, v236, v4
v_fmac_f32 v72, v237, v8
MA 40,v,152,v,84
buffer_load_dwordx4 v210, s[44:47], s75 offen offset:2048 lds
v_fmac_f32 v64, v234, v5
MA 72,v,152,v,88
v_fmac_f32 v72, v235, v9
v_mul_f32 v64, v64, v254
MA 104,v,152,v,92
v_mul_f32 v72, v72, v255
v_lshlrev_b32 v254, 16, v44
MA 136,v,152,v,96
ds_read_b128 v[124:127], v193 offset:6144
v_and_b32 v255, 0xffff0000, v44
MA 168,v,152,v,100
v_mul_f32 v65, v242, v2
MA 200,v,152,v,104
buffer_load_dwordx4 v211, s[44:47], s75 offen offset:3072 lds
v_mul_f32 v73, v243, v6
MA 232,v,152,v,108
TR 152,198,16384
TR 154,198,18432
MA 12,v,156,v,80
v_fmac_f32 v65, v240, v3
v_fmac_f32 v73, v241, v7
MA 44,v,156,v,84
v_fmac_f32 v65, v238, v4
v_fmac_f32 v73, v239, v8
MA 76,v,156,v,88
ds_read_b128 v[128:131], v193 offset:8192
s_add_u32 s75, s65, s74
MA 108,v,156,v,92
v_fmac_f32 v65, v236, v5
v_fmac_f32 v73, v237, v9
MA 140,v,156,v,96
v_mul_f32 v65, v65, v254
v_mul_f32 v73, v73, v255
MA 172,v,156,v,100
v_lshlrev_b32 v254, 16, v46
MA 204,v,156,v,104
v_and_b32 v255, 0xffff0000, v46
MA 236,v,156,v,108
TR 156,199,16384
TR 158,199,18432
MA 16,v,160,v,80
ds_read_b128 v[132:135], v193 offset:10240
s_add_u32 m0, s67, 69632
MA 48,v,160,v,84
v_mul_f32 v66, v244, v2
v_mul_f32 v74, v245, v6
MA 80,v,160,v,88
v_fmac_f32 v66, v242, v3
v_fmac_f32 v74, v243, v7
MA 112,v,160,v,92
buffer_load_dwordx4 v208, s[44:47], s75 offen offset:0 lds
v_fmac_f32 v66, v240, v4
MA 144,v,160,v,96
v_fmac_f32 v74, v241, v8
v_fmac_f32 v66, v238, v5
MA 176,v,160,v,100
v_fmac_f32 v74, v239, v9
v_mul_f32 v66, v66, v254
MA 208,v,160,v,104
v_mul_f32 v74, v74, v255
v_lshlrev_b32 v254, 16, v48
MA 240,v,160,v,108
TR 160,200,16384
TR 162,200,18432
MA 20,v,164,v,80
ds_read_b128 v[136:139], v193 offset:12288
buffer_load_dwordx4 v209, s[44:47], s75 offen offset:1024 lds
MA 52,v,164,v,84
v_and_b32 v255, 0xffff0000, v48
v_mul_f32 v67, v246, v2
MA 84,v,164,v,88
v_mul_f32 v75, v247, v6
v_fmac_f32 v67, v244, v3
MA 116,v,164,v,92
v_fmac_f32 v75, v245, v7
v_fmac_f32 v67, v242, v4
MA 148,v,164,v,96
buffer_load_dwordx4 v210, s[44:47], s75 offen offset:2048 lds
v_fmac_f32 v75, v243, v8
MA 180,v,164,v,100
ds_read_b128 v[140:143], v193 offset:14336
v_fmac_f32 v67, v240, v5
MA 212,v,164,v,104
v_fmac_f32 v75, v241, v9
v_mul_f32 v67, v67, v254
MA 244,v,164,v,108
TR 164,201,16384
TR 166,201,18432
MA 24,v,168,v,80
buffer_load_dwordx4 v211, s[44:47], s75 offen offset:3072 lds
v_mul_f32 v75, v75, v255
MA 56,v,168,v,84
v_lshlrev_b32 v254, 16, v50
v_and_b32 v255, 0xffff0000, v50
MA 88,v,168,v,88
v_mul_f32 v68, v248, v2
v_mul_f32 v76, v249, v6
MA 120,v,168,v,92
v_fmac_f32 v68, v246, v3
MA 152,v,168,v,96
v_fmac_f32 v76, v247, v7
MA 184,v,168,v,100
s_add_u32 s74, s74, 128
v_fmac_f32 v68, v244, v4
MA 216,v,168,v,104
v_fmac_f32 v76, v245, v8
v_fmac_f32 v68, v242, v5
MA 248,v,168,v,108
TR 168,202,16384
TR 170,202,18432
s_waitcnt lgkmcnt(15)
MA 28,v,172,v,80
v_fmac_f32 v76, v243, v9
v_mul_f32 v68, v68, v254
MA 60,v,172,v,84
s_and_b32 s74, s74, 2047
v_mul_f32 v76, v76, v255
MA 92,v,172,v,88
v_lshlrev_b32 v254, 16, v52
v_and_b32 v255, 0xffff0000, v52
MA 124,v,172,v,92
v_mul_f32 v69, v250, v2
MA 156,v,172,v,96
v_mul_f32 v77, v251, v6
MA 188,v,172,v,100
v_fmac_f32 v69, v248, v3
MA 220,v,172,v,104
MA 252,v,172,v,108
TR 172,203,16384
TR 174,203,18432
s_waitcnt lgkmcnt(2)
MA 0,v,144,v,112
MA 32,v,144,v,116
MA 64,v,144,v,120
MA 96,v,144,v,124
MA 128,v,144,v,128
MA 160,v,144,v,132
MA 192,v,144,v,136
MA 224,v,144,v,140
MA 4,v,148,v,112
MA 36,v,148,v,116
s_waitcnt vmcnt(8) lgkmcnt(0)
s_barrier
MA 68,v,148,v,120
TR 144,196,32768
TR 146,196,34816
MA 100,v,148,v,124
ds_read_b128 v[80:83], v192 offset:32768
s_add_u32 m0, s68, 98304
MA 132,v,148,v,128
v_fmac_f32 v77, v249, v7
v_fmac_f32 v69, v246, v4
MA 164,v,148,v,132
buffer_load_dwordx4 v212, s[48:51], s66 offen offset:0 lds
v_fmac_f32 v77, v247, v8
MA 196,v,148,v,136
v_fmac_f32 v69, v244, v5
v_fmac_f32 v77, v245, v9
MA 228,v,148,v,140
TR 148,197,32768
TR 150,197,34816
MA 8,v,152,v,112
ds_read_b128 v[84:87], v192 offset:34816
v_mul_f32 v69, v69, v254
MA 40,v,152,v,116
buffer_load_dwordx4 v213, s[48:51], s66 offen offset:1024 lds
v_mul_f32 v77, v77, v255
MA 72,v,152,v,120
v_cvt_pk_bf16_f32 v12, v69, v68
v_cvt_pk_bf16_f32 v13, v67, v66
MA 104,v,152,v,124
v_cvt_pk_bf16_f32 v14, v65, v64
v_cvt_pk_bf16_f32 v15, v63, v62
MA 136,v,152,v,128
s_mov_b32 s36, 0
buffer_store_dwordx4 v[12:15], v10, s[84:87], s36 offen sc1
MA 168,v,152,v,132
ds_read_b128 v[88:91], v192 offset:36864
buffer_load_dwordx4 v214, s[48:51], s66 offen offset:2048 lds
MA 200,v,152,v,136
v_cvt_pk_bf16_f32 v54, v77, v76
v_cvt_pk_bf16_f32 v55, v75, v74
MA 232,v,152,v,140
TR 152,198,32768
TR 154,198,34816
MA 12,v,156,v,112
buffer_load_dwordx4 v215, s[48:51], s66 offen offset:3072 lds
v_cvt_pk_bf16_f32 v56, v73, v72
MA 44,v,156,v,116
v_cvt_pk_bf16_f32 v57, v71, v70
s_mov_b32 s36, 4096
MA 76,v,156,v,120
ds_read_b128 v[92:95], v192 offset:38912
buffer_store_dwordx4 v[54:57], v10, s[84:87], s36 offen sc1
MA 108,v,156,v,124
v_lshlrev_b32 v2, 16, v58
v_and_b32 v3, 0xffff0000, v58
MA 140,v,156,v,128
s_add_u32 s66, s66, 524288
v_lshlrev_b32 v4, 16, v59
MA 172,v,156,v,132
v_and_b32 v5, 0xffff0000, v59
v_lshlrev_b32 v6, 16, v60
MA 204,v,156,v,136
v_and_b32 v7, 0xffff0000, v60
v_lshlrev_b32 v8, 16, v61
MA 236,v,156,v,140
TR 156,199,32768
TR 158,199,34816
MA 16,v,160,v,112
ds_read_b128 v[96:99], v192 offset:40960
s_and_b32 s66, s66, 8388607
MA 48,v,160,v,116
v_and_b32 v9, 0xffff0000, v61
v_lshlrev_b32 v230, 16, v17
MA 80,v,160,v,120
v_and_b32 v231, 0xffff0000, v17
v_lshlrev_b32 v232, 16, v19
MA 112,v,160,v,124
v_and_b32 v233, 0xffff0000, v19
v_lshlrev_b32 v234, 16, v21
MA 144,v,160,v,128
ds_read_b128 v[100:103], v192 offset:43008
s_add_u32 m0, s68, 114688
MA 176,v,160,v,132
v_and_b32 v235, 0xffff0000, v21
v_lshlrev_b32 v236, 16, v23
MA 208,v,160,v,136
v_and_b32 v237, 0xffff0000, v23
v_lshlrev_b32 v238, 16, v25
MA 240,v,160,v,140
TR 160,200,32768
TR 162,200,34816
MA 20,v,164,v,112
buffer_load_dwordx4 v212, s[48:51], s66 offen offset:0 lds
v_and_b32 v239, 0xffff0000, v25
MA 52,v,164,v,116
ds_read_b128 v[104:107], v192 offset:45056
v_lshlrev_b32 v240, 16, v27
MA 84,v,164,v,120
v_and_b32 v241, 0xffff0000, v27
v_lshlrev_b32 v242, 16, v29
MA 116,v,164,v,124
buffer_load_dwordx4 v213, s[48:51], s66 offen offset:1024 lds
v_and_b32 v243, 0xffff0000, v29
MA 148,v,164,v,128
v_lshlrev_b32 v244, 16, v31
v_and_b32 v245, 0xffff0000, v31
MA 180,v,164,v,132
v_lshlrev_b32 v246, 16, v33
v_and_b32 v247, 0xffff0000, v33
MA 212,v,164,v,136
ds_read_b128 v[108:111], v192 offset:47104
v_lshlrev_b32 v248, 16, v35
MA 244,v,164,v,140
TR 164,201,32768
TR 166,201,34816
MA 24,v,168,v,112
buffer_load_dwordx4 v214, s[48:51], s66 offen offset:2048 lds
v_and_b32 v249, 0xffff0000, v35
MA 56,v,168,v,116
v_lshlrev_b32 v250, 16, v37
v_and_b32 v251, 0xffff0000, v37
MA 88,v,168,v,120
buffer_load_dwordx4 v215, s[48:51], s66 offen offset:3072 lds
v_lshlrev_b32 v254, 16, v39
MA 120,v,168,v,124
v_and_b32 v255, 0xffff0000, v39
v_mul_f32 v62, v236, v2
MA 152,v,168,v,128
v_mul_f32 v70, v237, v6
v_fmac_f32 v62, v234, v3
MA 184,v,168,v,132
v_fmac_f32 v70, v235, v7
v_fmac_f32 v62, v232, v4
MA 216,v,168,v,136
s_add_u32 s66, s66, 524288
v_fmac_f32 v70, v233, v8
MA 248,v,168,v,140
TR 168,202,32768
TR 170,202,34816
MA 28,v,172,v,112
v_fmac_f32 v62, v230, v5
v_fmac_f32 v70, v231, v9
MA 60,v,172,v,116
v_mul_f32 v62, v62, v254
v_mul_f32 v70, v70, v255
MA 92,v,172,v,120
s_and_b32 s66, s66, 8388607
v_lshlrev_b32 v254, 16, v41
MA 124,v,172,v,124
v_and_b32 v255, 0xffff0000, v41
v_mul_f32 v63, v238, v2
MA 156,v,172,v,128
v_mul_f32 v71, v239, v6
v_fmac_f32 v63, v236, v3
MA 188,v,172,v,132
v_fmac_f32 v71, v237, v7
v_fmac_f32 v63, v234, v4
MA 220,v,172,v,136
v_fmac_f32 v71, v235, v8
v_fmac_f32 v63, v232, v5
MA 252,v,172,v,140
TR 172,203,32768
TR 174,203,34816
v_fmac_f32 v71, v233, v9
v_mul_f32 v63, v63, v254
v_mul_f32 v71, v71, v255
v_lshlrev_b32 v254, 16, v43
v_and_b32 v255, 0xffff0000, v43
v_mul_f32 v64, v240, v2
v_mul_f32 v72, v241, v6
v_fmac_f32 v64, v238, v3
s_waitcnt lgkmcnt(2)
MA 0,v,144,v,80
s_add_u32 s75, s64, s74
v_fmac_f32 v72, v239, v7
MA 32,v,144,v,84
ds_read_b128 v[112:115], v193 offset:32768
v_fmac_f32 v64, v236, v4
MA 64,v,144,v,88
v_fmac_f32 v72, v237, v8
v_fmac_f32 v64, v234, v5
MA 96,v,144,v,92
v_fmac_f32 v72, v235, v9
v_mul_f32 v64, v64, v254
MA 128,v,144,v,96
s_add_u32 m0, s67, 0
v_mul_f32 v72, v72, v255
MA 160,v,144,v,100
v_lshlrev_b32 v254, 16, v45
MA 192,v,144,v,104
v_and_b32 v255, 0xffff0000, v45
v_mul_f32 v65, v242, v2
MA 224,v,144,v,108
TR 144,196,49152
TR 146,196,51200
MA 4,v,148,v,80
ds_read_b128 v[116:119], v193 offset:34816
buffer_load_dwordx4 v208, s[44:47], s75 offen offset:0 lds
MA 36,v,148,v,84
v_mul_f32 v73, v243, v6
v_fmac_f32 v65, v240, v3
MA 68,v,148,v,88
v_fmac_f32 v73, v241, v7
v_fmac_f32 v65, v238, v4
MA 100,v,148,v,92
v_fmac_f32 v73, v239, v8
v_fmac_f32 v65, v236, v5
MA 132,v,148,v,96
v_fmac_f32 v73, v237, v9
MA 164,v,148,v,100
ds_read_b128 v[120:123], v193 offset:36864
buffer_load_dwordx4 v209, s[44:47], s75 offen offset:1024 lds
MA 196,v,148,v,104
v_mul_f32 v65, v65, v254
v_mul_f32 v73, v73, v255
MA 228,v,148,v,108
TR 148,197,49152
TR 150,197,51200
MA 8,v,152,v,80
v_lshlrev_b32 v254, 16, v47
v_and_b32 v255, 0xffff0000, v47
MA 40,v,152,v,84
buffer_load_dwordx4 v210, s[44:47], s75 offen offset:2048 lds
v_mul_f32 v66, v244, v2
MA 72,v,152,v,88
v_mul_f32 v74, v245, v6
v_fmac_f32 v66, v242, v3
MA 104,v,152,v,92
v_fmac_f32 v74, v243, v7
v_fmac_f32 v66, v240, v4
MA 136,v,152,v,96
ds_read_b128 v[124:127], v193 offset:38912
v_fmac_f32 v74, v241, v8
MA 168,v,152,v,100
v_fmac_f32 v66, v238, v5
v_fmac_f32 v74, v239, v9
MA 200,v,152,v,104
buffer_load_dwordx4 v211, s[44:47], s75 offen offset:3072 lds
v_mul_f32 v66, v66, v254
MA 232,v,152,v,108
TR 152,198,49152
TR 154,198,51200
MA 12,v,156,v,80
v_mul_f32 v74, v74, v255
v_lshlrev_b32 v254, 16, v49
MA 44,v,156,v,84
v_and_b32 v255, 0xffff0000, v49
v_mul_f32 v67, v246, v2
MA 76,v,156,v,88
ds_read_b128 v[128:131], v193 offset:40960
s_add_u32 s75, s65, s74
MA 108,v,156,v,92
v_mul_f32 v75, v247, v6
v_fmac_f32 v67, v244, v3
MA 140,v,156,v,96
v_fmac_f32 v75, v245, v7
v_fmac_f32 v67, v242, v4
MA 172,v,156,v,100
v_fmac_f32 v75, v243, v8
MA 204,v,156,v,104
v_fmac_f32 v67, v240, v5
MA 236,v,156,v,108
TR 156,199,49152
TR 158,199,51200
MA 16,v,160,v,80
ds_read_b128 v[132:135], v193 offset:43008
s_add_u32 m0, s67, 4096
MA 48,v,160,v,84
v_fmac_f32 v75, v241, v9
v_mul_f32 v67, v67, v254
MA 80,v,160,v,88
v_mul_f32 v75, v75, v255
v_lshlrev_b32 v254, 16, v51
MA 112,v,160,v,92
buffer_load_dwordx4 v208, s[44:47], s75 offen offset:0 lds
v_and_b32 v255, 0xffff0000, v51
MA 144,v,160,v,96
v_mul_f32 v68, v248, v2
v_mul_f32 v76, v249, v6
MA 176,v,160,v,100
v_fmac_f32 v68, v246, v3
v_fmac_f32 v76, v247, v7
MA 208,v,160,v,104
v_fmac_f32 v68, v244, v4
v_fmac_f32 v76, v245, v8
MA 240,v,160,v,108
TR 160,200,49152
TR 162,200,51200
MA 20,v,164,v,80
ds_read_b128 v[136:139], v193 offset:45056
buffer_load_dwordx4 v209, s[44:47], s75 offen offset:1024 lds
MA 52,v,164,v,84
v_fmac_f32 v68, v242, v5
v_fmac_f32 v76, v243, v9
MA 84,v,164,v,88
v_mul_f32 v68, v68, v254
v_mul_f32 v76, v76, v255
MA 116,v,164,v,92
v_lshlrev_b32 v254, 16, v53
v_and_b32 v255, 0xffff0000, v53
MA 148,v,164,v,96
buffer_load_dwordx4 v210, s[44:47], s75 offen offset:2048 lds
v_mul_f32 v69, v250, v2
MA 180,v,164,v,100
ds_read_b128 v[140:143], v193 offset:47104
v_mul_f32 v77, v251, v6
MA 212,v,164,v,104
v_fmac_f32 v69, v248, v3
v_fmac_f32 v77, v249, v7
MA 244,v,164,v,108
TR 164,201,49152
TR 166,201,51200
MA 24,v,168,v,80
buffer_load_dwordx4 v211, s[44:47], s75 offen offset:3072 lds
v_fmac_f32 v69, v246, v4
MA 56,v,168,v,84
v_fmac_f32 v77, v247, v8
v_fmac_f32 v69, v244, v5
MA 88,v,168,v,88
v_fmac_f32 v77, v245, v9
v_mul_f32 v69, v69, v254
MA 120,v,168,v,92
v_mul_f32 v77, v77, v255
v_cvt_pk_bf16_f32 v230, v69, v68
MA 152,v,168,v,96
v_cvt_pk_bf16_f32 v231, v67, v66
MA 184,v,168,v,100
s_add_u32 s74, s74, 128
v_cvt_pk_bf16_f32 v232, v65, v64
MA 216,v,168,v,104
v_cvt_pk_bf16_f32 v233, v63, v62
MA 248,v,168,v,108
TR 168,202,49152
TR 170,202,51200
s_waitcnt lgkmcnt(15)
MA 28,v,172,v,80
s_mov_b32 s36, 8192
buffer_store_dwordx4 v[230:233], v10, s[84:87], s36 offen sc1
MA 60,v,172,v,84
s_and_b32 s74, s74, 2047
v_cvt_pk_bf16_f32 v234, v77, v76
MA 92,v,172,v,88
v_cvt_pk_bf16_f32 v235, v75, v74
v_cvt_pk_bf16_f32 v236, v73, v72
MA 124,v,172,v,92
v_cvt_pk_bf16_f32 v237, v71, v70
s_mov_b32 s36, 12288
MA 156,v,172,v,96
buffer_store_dwordx4 v[234:237], v10, s[84:87], s36 offen sc1
MA 188,v,172,v,100
v_lshlrev_b32 v228, 4, v1
MA 220,v,172,v,104
MA 252,v,172,v,108
TR 172,203,49152
TR 174,203,51200
s_waitcnt lgkmcnt(2)
MA 0,v,144,v,112
MA 32,v,144,v,116
MA 64,v,144,v,120
MA 96,v,144,v,124
MA 128,v,144,v,128
MA 160,v,144,v,132
MA 192,v,144,v,136
MA 224,v,144,v,140
MA 4,v,148,v,112
MA 36,v,148,v,116
s_waitcnt vmcnt(15) lgkmcnt(0)
s_barrier
MA 68,v,148,v,120
ds_read_b128 v[48:51], v226 offset:0
s_add_u32 m0, s68, 131072
MA 100,v,148,v,124
MA 132,v,148,v,128
ds_read_b128 v[52:55], v226 offset:2048
buffer_load_dwordx4 v212, s[48:51], s66 offen offset:0 lds
MA 164,v,148,v,132
MA 196,v,148,v,136
ds_read_b128 v[56:59], v226 offset:4096
buffer_load_dwordx4 v213, s[48:51], s66 offen offset:1024 lds
MA 228,v,148,v,140
MA 8,v,152,v,112
ds_read_b128 v[60:63], v226 offset:6144
MA 40,v,152,v,116
buffer_load_dwordx4 v214, s[48:51], s66 offen offset:2048 lds
MA 72,v,152,v,120
TR 16,216,0
MA 104,v,152,v,124
buffer_load_dwordx4 v215, s[48:51], s66 offen offset:3072 lds
MA 136,v,152,v,128
TR 18,216,1024
MA 168,v,152,v,132
MA 200,v,152,v,136
TR 20,217,0
s_add_u32 s66, s66, 524288
MA 232,v,152,v,140
MA 12,v,156,v,112
TR 22,217,1024
s_and_b32 s66, s66, 8388607
MA 44,v,156,v,116
MA 76,v,156,v,120
TR 24,218,0
MA 108,v,156,v,124
s_add_u32 s75, s64, s74
MA 140,v,156,v,128
TR 26,218,1024
MA 172,v,156,v,132
s_add_u32 m0, s67, 32768
MA 204,v,156,v,136
TR 28,219,0
MA 236,v,156,v,140
MA 16,v,160,v,112
TR 30,219,1024
buffer_load_dwordx4 v208, s[44:47], s75 offen offset:0 lds
MA 48,v,160,v,116
MA 80,v,160,v,120
TR 32,220,0
buffer_load_dwordx4 v209, s[44:47], s75 offen offset:1024 lds
MA 112,v,160,v,124
MA 144,v,160,v,128
TR 34,220,1024
MA 176,v,160,v,132
buffer_load_dwordx4 v210, s[44:47], s75 offen offset:2048 lds
MA 208,v,160,v,136
TR 36,221,0
MA 240,v,160,v,140
buffer_load_dwordx4 v211, s[44:47], s75 offen offset:3072 lds
MA 20,v,164,v,112
TR 38,221,1024
MA 52,v,164,v,116
MA 84,v,164,v,120
TR 40,222,0
s_add_u32 s75, s65, s74
MA 116,v,164,v,124
MA 148,v,164,v,128
TR 42,222,1024
s_add_u32 m0, s67, 36864
MA 180,v,164,v,132
MA 212,v,164,v,136
TR 44,223,0
MA 244,v,164,v,140
buffer_load_dwordx4 v208, s[44:47], s75 offen offset:0 lds
MA 24,v,168,v,112
TR 46,223,1024
MA 56,v,168,v,116
buffer_load_dwordx4 v209, s[44:47], s75 offen offset:1024 lds
MA 88,v,168,v,120
MA 120,v,168,v,124
MA 152,v,168,v,128
buffer_load_dwordx4 v210, s[44:47], s75 offen offset:2048 lds
MA 184,v,168,v,132
MA 216,v,168,v,136
buffer_load_dwordx4 v211, s[44:47], s75 offen offset:3072 lds
MA 248,v,168,v,140
MA 28,v,172,v,112
MA 60,v,172,v,116
s_add_u32 s74, s74, 128
MA 92,v,172,v,120
MA 124,v,172,v,124
s_and_b32 s74, s74, 2047
MA 156,v,172,v,128
MA 188,v,172,v,132
MA 220,v,172,v,136
MA 252,v,172,v,140
s_branch L_p2
L_p1_V:
s_waitcnt lgkmcnt(14)
v_mfma_f32_16x16x32_bf16 a[0:3], v[80:83], v[144:147], 0
s_add_u32 m0, s23, 32768
v_lshlrev_b32 v74, 7, v1
v_mfma_f32_16x16x32_bf16 a[4:7], v[84:87], v[144:147], 0
ds_read_b128 v[112:115], v193 offset:0
v_mfma_f32_16x16x32_bf16 a[64:67], v[88:91], v[144:147], 0
buffer_load_dwordx4 v184, s[12:15], s21 offen offset:0 lds
v_mfma_f32_16x16x32_bf16 a[68:71], v[92:95], v[144:147], 0
v_mfma_f32_16x16x32_bf16 a[128:131], v[96:99], v[144:147], 0
s_getpc_b64 s[4:5]
L_pcV:
v_mfma_f32_16x16x32_bf16 a[132:135], v[100:103], v[144:147], 0
buffer_load_dwordx4 v185, s[12:15], s21 offen offset:1024 lds
v_mfma_f32_16x16x32_bf16 a[192:195], v[104:107], v[144:147], 0
v_mfma_f32_16x16x32_bf16 a[196:199], v[108:111], v[144:147], 0
TR 144,196,16384
TR 146,196,18432
s_waitcnt lgkmcnt(15)
v_mfma_f32_16x16x32_bf16 a[8:11], v[80:83], v[148:151], 0
ds_read_b128 v[116:119], v193 offset:2048
buffer_load_dwordx4 v186, s[12:15], s21 offen offset:2048 lds
v_mfma_f32_16x16x32_bf16 a[12:15], v[84:87], v[148:151], 0
s_lshr_b32 s98, s2, 3
v_mfma_f32_16x16x32_bf16 a[72:75], v[88:91], v[148:151], 0
buffer_load_dwordx4 v187, s[12:15], s21 offen offset:3072 lds
v_mfma_f32_16x16x32_bf16 a[76:79], v[92:95], v[148:151], 0
v_mfma_f32_16x16x32_bf16 a[136:139], v[96:99], v[148:151], 0
s_add_u32 m0, s23, 36864
s_lshl_b32 s98, s98, 2
v_mfma_f32_16x16x32_bf16 a[140:143], v[100:103], v[148:151], 0
ds_read_b128 v[120:123], v193 offset:4096
v_mfma_f32_16x16x32_bf16 a[200:203], v[104:107], v[148:151], 0
v_mfma_f32_16x16x32_bf16 a[204:207], v[108:111], v[148:151], 0
TR 148,197,16384
TR 150,197,18432
s_waitcnt lgkmcnt(15)
v_mfma_f32_16x16x32_bf16 a[16:19], v[80:83], v[152:155], 0
buffer_load_dwordx4 v188, s[12:15], s21 offen offset:0 lds
s_add_u32 s98, s98, s3
v_mfma_f32_16x16x32_bf16 a[20:23], v[84:87], v[152:155], 0
v_mfma_f32_16x16x32_bf16 a[80:83], v[88:91], v[152:155], 0
buffer_load_dwordx4 v189, s[12:15], s21 offen offset:1024 lds
v_mfma_f32_16x16x32_bf16 a[84:87], v[92:95], v[152:155], 0
v_mfma_f32_16x16x32_bf16 a[144:147], v[96:99], v[152:155], 0
ds_read_b128 v[124:127], v193 offset:6144
buffer_load_dwordx4 v190, s[12:15], s21 offen offset:2048 lds
v_mfma_f32_16x16x32_bf16 a[148:151], v[100:103], v[152:155], 0
s_lshl_b32 s98, s98, 10
v_mfma_f32_16x16x32_bf16 a[208:211], v[104:107], v[152:155], 0
v_mfma_f32_16x16x32_bf16 a[212:215], v[108:111], v[152:155], 0
TR 152,198,16384
TR 154,198,18432
v_mfma_f32_16x16x32_bf16 a[24:27], v[80:83], v[156:159], 0
buffer_load_dwordx4 v191, s[12:15], s21 offen offset:3072 lds
v_and_b32 v75, 0x380, v74
v_mfma_f32_16x16x32_bf16 a[28:31], v[84:87], v[156:159], 0
s_add_u32 s21, s21, 524288
v_mfma_f32_16x16x32_bf16 a[88:91], v[88:91], v[156:159], 0
ds_read_b128 v[128:131], v193 offset:8192
v_mfma_f32_16x16x32_bf16 a[92:95], v[92:95], v[156:159], 0
v_mfma_f32_16x16x32_bf16 a[152:155], v[96:99], v[156:159], 0
s_and_b32 s21, s21, 4194303
v_add_u32 v75, s98, v75
v_mfma_f32_16x16x32_bf16 a[156:159], v[100:103], v[156:159], 0
v_mfma_f32_16x16x32_bf16 a[216:219], v[104:107], v[156:159], 0
v_mfma_f32_16x16x32_bf16 a[220:223], v[108:111], v[156:159], 0
TR 156,199,16384
TR 158,199,18432
s_waitcnt lgkmcnt(15)
v_mfma_f32_16x16x32_bf16 a[32:35], v[80:83], v[160:163], 0
ds_read_b128 v[132:135], v193 offset:10240
s_add_u32 m0, s22, 32768
v_mfma_f32_16x16x32_bf16 a[36:39], v[84:87], v[160:163], 0
buffer_load_dwordx4 v176, s[8:11], s20 offen offset:0 lds
v_min_u32 v75, L_code_end - L_pcV - 4, v75
v_mfma_f32_16x16x32_bf16 a[96:99], v[88:91], v[160:163], 0
v_mfma_f32_16x16x32_bf16 a[100:103], v[92:95], v[160:163], 0
v_mfma_f32_16x16x32_bf16 a[160:163], v[96:99], v[160:163], 0
buffer_load_dwordx4 v177, s[8:11], s20 offen offset:1024 lds
v_mfma_f32_16x16x32_bf16 a[164:167], v[100:103], v[160:163], 0
v_mov_b32 v77, s5
v_mfma_f32_16x16x32_bf16 a[224:227], v[104:107], v[160:163], 0
buffer_load_dwordx4 v178, s[8:11], s20 offen offset:2048 lds
v_mfma_f32_16x16x32_bf16 a[228:231], v[108:111], v[160:163], 0
TR 160,200,16384
TR 162,200,18432
v_mfma_f32_16x16x32_bf16 a[40:43], v[80:83], v[164:167], 0
ds_read_b128 v[136:139], v193 offset:12288
v_mfma_f32_16x16x32_bf16 a[44:47], v[84:87], v[164:167], 0
buffer_load_dwordx4 v179, s[8:11], s20 offen offset:3072 lds
v_mfma_f32_16x16x32_bf16 a[104:107], v[88:91], v[164:167], 0
v_add_co_u32 v76, vcc, s4, v75
s_nop 1
v_addc_co_u32 v77, vcc, 0, v77, vcc
v_mfma_f32_16x16x32_bf16 a[108:111], v[92:95], v[164:167], 0
s_add_u32 m0, s22, 36864
v_mfma_f32_16x16x32_bf16 a[168:171], v[96:99], v[164:167], 0
v_mfma_f32_16x16x32_bf16 a[172:175], v[100:103], v[164:167], 0
ds_read_b128 v[140:143], v193 offset:14336
v_mfma_f32_16x16x32_bf16 a[232:235], v[104:107], v[164:167], 0
buffer_load_dwordx4 v180, s[8:11], s20 offen offset:0 lds
v_mfma_f32_16x16x32_bf16 a[236:239], v[108:111], v[164:167], 0
TR 164,201,16384
TR 166,201,18432
v_mfma_f32_16x16x32_bf16 a[48:51], v[80:83], v[168:171], 0
v_mfma_f32_16x16x32_bf16 a[52:55], v[84:87], v[168:171], 0
buffer_load_dwordx4 v181, s[8:11], s20 offen offset:1024 lds
v_mfma_f32_16x16x32_bf16 a[112:115], v[88:91], v[168:171], 0
v_mfma_f32_16x16x32_bf16 a[116:119], v[92:95], v[168:171], 0
buffer_load_dwordx4 v182, s[8:11], s20 offen offset:2048 lds
v_mfma_f32_16x16x32_bf16 a[176:179], v[96:99], v[168:171], 0
v_mfma_f32_16x16x32_bf16 a[180:183], v[100:103], v[168:171], 0
v_mfma_f32_16x16x32_bf16 a[240:243], v[104:107], v[168:171], 0
buffer_load_dwordx4 v183, s[8:11], s20 offen offset:3072 lds
v_mfma_f32_16x16x32_bf16 a[244:247], v[108:111], v[168:171], 0
TR 168,202,16384
TR 170,202,18432
s_waitcnt lgkmcnt(15)
v_mfma_f32_16x16x32_bf16 a[56:59], v[80:83], v[172:175], 0
s_add_u32 s20, s20, 128
v_mfma_f32_16x16x32_bf16 a[60:63], v[84:87], v[172:175], 0
global_load_dword v79, v[76:77], off
v_mfma_f32_16x16x32_bf16 a[120:123], v[88:91], v[172:175], 0
v_mfma_f32_16x16x32_bf16 a[124:127], v[92:95], v[172:175], 0
s_and_b32 s20, s20, 1023
v_mfma_f32_16x16x32_bf16 a[184:187], v[96:99], v[172:175], 0
v_mfma_f32_16x16x32_bf16 a[188:191], v[100:103], v[172:175], 0
v_mfma_f32_16x16x32_bf16 a[248:251], v[104:107], v[172:175], 0
v_mfma_f32_16x16x32_bf16 a[252:255], v[108:111], v[172:175], 0
TR 172,203,16384
TR 174,203,18432
s_waitcnt lgkmcnt(2)
MA 0,v,112,v,144
s_add_u32 m0, s22, 65536
MA 4,v,116,v,144
MA 64,v,120,v,144
MA 68,v,124,v,144
buffer_load_dwordx4 v176, s[8:11], s20 offen offset:0 lds
MA 128,v,128,v,144
MA 132,v,132,v,144
MA 192,v,136,v,144
MA 196,v,140,v,144
buffer_load_dwordx4 v177, s[8:11], s20 offen offset:1024 lds
MA 8,v,112,v,148
MA 12,v,116,v,148
MA 72,v,120,v,148
buffer_load_dwordx4 v178, s[8:11], s20 offen offset:2048 lds
MA 76,v,124,v,148
MA 136,v,128,v,148
MA 140,v,132,v,148
MA 200,v,136,v,148
buffer_load_dwordx4 v179, s[8:11], s20 offen offset:3072 lds
MA 204,v,140,v,148
MA 16,v,112,v,152
MA 20,v,116,v,152
s_add_u32 m0, s22, 69632
MA 80,v,120,v,152
MA 84,v,124,v,152
MA 144,v,128,v,152
MA 148,v,132,v,152
buffer_load_dwordx4 v180, s[8:11], s20 offen offset:0 lds
MA 208,v,136,v,152
MA 212,v,140,v,152
MA 24,v,112,v,156
MA 28,v,116,v,156
buffer_load_dwordx4 v181, s[8:11], s20 offen offset:1024 lds
MA 88,v,120,v,156
MA 92,v,124,v,156
MA 152,v,128,v,156
buffer_load_dwordx4 v182, s[8:11], s20 offen offset:2048 lds
MA 156,v,132,v,156
MA 216,v,136,v,156
MA 220,v,140,v,156
MA 32,v,112,v,160
buffer_load_dwordx4 v183, s[8:11], s20 offen offset:3072 lds
MA 36,v,116,v,160
MA 96,v,120,v,160
MA 100,v,124,v,160
s_add_u32 s20, s20, 128
MA 160,v,128,v,160
MA 164,v,132,v,160
MA 224,v,136,v,160
MA 228,v,140,v,160
s_and_b32 s20, s20, 1023
MA 40,v,112,v,164
MA 44,v,116,v,164
MA 104,v,120,v,164
MA 108,v,124,v,164
MA 168,v,128,v,164
s_waitcnt vmcnt(9) lgkmcnt(0)
s_barrier
MA 172,v,132,v,164
TR 144,196,32768
TR 146,196,34816
MA 232,v,136,v,164
ds_read_b128 v[80:83], v192 offset:32768
s_add_u32 m0, s23, 0
MA 236,v,140,v,164
TR 148,197,32768
TR 150,197,34816
MA 48,v,112,v,168
ds_read_b128 v[84:87], v192 offset:34816
ds_read_b128 v[88:91], v192 offset:36864
MA 52,v,116,v,168
TR 152,198,32768
TR 154,198,34816
MA 112,v,120,v,168
ds_read_b128 v[92:95], v192 offset:38912
ds_read_b128 v[96:99], v192 offset:40960
MA 116,v,124,v,168
TR 156,199,32768
TR 158,199,34816
MA 176,v,128,v,168
ds_read_b128 v[100:103], v192 offset:43008
ds_read_b128 v[104:107], v192 offset:45056
MA 180,v,132,v,168
TR 160,200,32768
TR 162,200,34816
MA 240,v,136,v,168
ds_read_b128 v[108:111], v192 offset:47104
buffer_load_dwordx4 v184, s[12:15], s21 offen offset:0 lds
MA 244,v,140,v,168
TR 164,201,32768
TR 166,201,34816
MA 56,v,112,v,172
buffer_load_dwordx4 v185, s[12:15], s21 offen offset:1024 lds
buffer_load_dwordx4 v186, s[12:15], s21 offen offset:2048 lds
MA 60,v,116,v,172
TR 168,202,32768
TR 170,202,34816
MA 120,v,120,v,172
buffer_load_dwordx4 v187, s[12:15], s21 offen offset:3072 lds
s_add_u32 m0, s23, 4096
MA 124,v,124,v,172
buffer_load_dwordx4 v188, s[12:15], s21 offen offset:0 lds
buffer_load_dwordx4 v189, s[12:15], s21 offen offset:1024 lds
MA 184,v,128,v,172
buffer_load_dwordx4 v190, s[12:15], s21 offen offset:2048 lds
buffer_load_dwordx4 v191, s[12:15], s21 offen offset:3072 lds
MA 188,v,132,v,172
s_add_u32 s21, s21, 524288
s_and_b32 s21, s21, 4194303
MA 248,v,136,v,172
s_load_dwordx2 s[84:85], s[0:1], 8
s_load_dwordx2 s[88:89], s[0:1], 16
MA 252,v,140,v,172
TR 172,203,32768
TR 174,203,34816
s_load_dwordx2 s[92:93], s[0:1], 0
s_load_dwordx2 s[96:97], s[0:1], 24
s_load_dwordx2 s[76:77], s[0:1], 96
s_waitcnt lgkmcnt(2)
MA 0,v,80,v,144
s_add_u32 m0, s22, 0
MA 4,v,84,v,144
ds_read_b128 v[112:115], v193 offset:32768
MA 64,v,88,v,144
s_mov_b32 s4, s34
s_mov_b32 s5, s35
MA 68,v,92,v,144
MA 128,v,96,v,144
MA 132,v,100,v,144
buffer_load_dwordx4 v176, s[8:11], s20 offen offset:0 lds
MA 192,v,104,v,144
MA 196,v,108,v,144
TR 144,196,49152
TR 146,196,51200
MA 8,v,80,v,148
ds_read_b128 v[116:119], v193 offset:34816
MA 12,v,84,v,148
s_mov_b32 s6, 8388608
s_mov_b32 s7, 0x20000
MA 72,v,88,v,148
buffer_load_dwordx4 v177, s[8:11], s20 offen offset:1024 lds
MA 76,v,92,v,148
MA 136,v,96,v,148
MA 140,v,100,v,148
ds_read_b128 v[120:123], v193 offset:36864
MA 200,v,104,v,148
MA 204,v,108,v,148
TR 148,197,49152
TR 150,197,51200
MA 16,v,80,v,152
buffer_load_dwordx4 v178, s[8:11], s20 offen offset:2048 lds
s_lshr_b32 s43, s2, 3
MA 20,v,84,v,152
MA 80,v,88,v,152
MA 84,v,92,v,152
s_lshl_b32 s43, s43, 2
MA 144,v,96,v,152
ds_read_b128 v[124:127], v193 offset:38912
buffer_load_dwordx4 v179, s[8:11], s20 offen offset:3072 lds
MA 148,v,100,v,152
MA 208,v,104,v,152
MA 212,v,108,v,152
TR 152,198,49152
TR 154,198,51200
MA 24,v,80,v,156
s_add_u32 s43, s43, s3
MA 28,v,84,v,156
s_add_u32 m0, s22, 4096
MA 88,v,88,v,156
ds_read_b128 v[128:131], v193 offset:40960
MA 92,v,92,v,156
s_lshl_b32 s43, s43, 16
MA 152,v,96,v,156
MA 156,v,100,v,156
MA 216,v,104,v,156
MA 220,v,108,v,156
TR 156,199,49152
TR 158,199,51200
MA 32,v,80,v,160
ds_read_b128 v[132:135], v193 offset:43008
buffer_load_dwordx4 v180, s[8:11], s20 offen offset:0 lds
MA 36,v,84,v,160
s_and_b32 s37, s2, 7
MA 96,v,88,v,160
s_lshl_b32 s37, s37, 10
MA 100,v,92,v,160
MA 160,v,96,v,160
buffer_load_dwordx4 v181, s[8:11], s20 offen offset:1024 lds
MA 164,v,100,v,160
MA 224,v,104,v,160
s_add_u32 s43, s43, s37
MA 228,v,108,v,160
TR 160,200,49152
TR 162,200,51200
MA 40,v,80,v,164
ds_read_b128 v[136:139], v193 offset:45056
MA 44,v,84,v,164
buffer_load_dwordx4 v182, s[8:11], s20 offen offset:2048 lds
MA 104,v,88,v,164
v_lshrrev_b32 v78, 3, v1
MA 108,v,92,v,164
MA 168,v,96,v,164
MA 172,v,100,v,164
ds_read_b128 v[140:143], v193 offset:47104
MA 232,v,104,v,164
buffer_load_dwordx4 v183, s[8:11], s20 offen offset:3072 lds
s_waitcnt vmcnt(24)
v_and_b32 v79, 7, v1
MA 236,v,108,v,164
TR 164,201,49152
TR 166,201,51200
MA 48,v,80,v,168
MA 52,v,84,v,168
MA 112,v,88,v,168
v_lshlrev_b32 v79, 7, v79
MA 116,v,92,v,168
s_add_u32 s20, s20, 128
MA 176,v,96,v,168
MA 180,v,100,v,168
MA 240,v,104,v,168
v_lshl_add_u32 v78, v78, 13, v79
MA 244,v,108,v,168
TR 168,202,49152
TR 170,202,51200
s_waitcnt lgkmcnt(15)
MA 56,v,80,v,172
s_and_b32 s20, s20, 1023
MA 60,v,84,v,172
MA 120,v,88,v,172
v_add_u32 v78, s43, v78
MA 124,v,92,v,172
MA 184,v,96,v,172
MA 188,v,100,v,172
MA 248,v,104,v,172
MA 252,v,108,v,172
TR 172,203,49152
TR 174,203,51200
s_waitcnt lgkmcnt(2)
MA 0,v,112,v,144
MA 4,v,116,v,144
MA 64,v,120,v,144
MA 68,v,124,v,144
MA 128,v,128,v,144
MA 132,v,132,v,144
MA 192,v,136,v,144
MA 196,v,140,v,144
MA 8,v,112,v,148
MA 12,v,116,v,148
s_waitcnt vmcnt(8) lgkmcnt(0)
s_barrier
MA 72,v,120,v,148
TR 144,196,0
TR 146,196,2048
MA 76,v,124,v,148
ds_read_b128 v[80:83], v194 offset:0
s_add_u32 m0, s23, 32768
MA 136,v,128,v,148
s_mov_b32 s86, 4194304
s_mov_b32 s87, 0x20000
MA 140,v,132,v,148
s_mov_b32 s90, 4194304
s_mov_b32 s91, 0x20000
MA 200,v,136,v,148
buffer_load_dwordx4 v184, s[12:15], s21 offen offset:0 lds
MA 204,v,140,v,148
TR 148,197,0
TR 150,197,2048
MA 16,v,112,v,152
ds_read_b128 v[84:87], v194 offset:2048
s_mov_b32 s94, 4194304
MA 20,v,116,v,152
s_mov_b32 s95, 0x20000
s_mov_b32 s98, 8192
MA 80,v,120,v,152
buffer_load_dwordx4 v185, s[12:15], s21 offen offset:1024 lds
s_mov_b32 s99, 0x20000
MA 84,v,124,v,152
MA 144,v,128,v,152
s_mov_b32 s78, 2048
MA 148,v,132,v,152
ds_read_b128 v[88:91], v194 offset:4096
s_mov_b32 s79, 0x20000
MA 208,v,136,v,152
s_and_b32 s36, s2, 15
MA 212,v,140,v,152
TR 152,198,0
TR 154,198,2048
MA 24,v,112,v,156
buffer_load_dwordx4 v186, s[12:15], s21 offen offset:2048 lds
s_lshl_b32 s36, s36, 1
MA 28,v,116,v,156
s_lshr_b32 s37, s3, 1
MA 88,v,120,v,156
ds_read_b128 v[92:95], v194 offset:6144
s_add_u32 s36, s36, s37
MA 92,v,124,v,156
buffer_load_dwordx4 v187, s[12:15], s21 offen offset:3072 lds
s_lshl_b32 s36, s36, 3
MA 152,v,128,v,156
MA 156,v,132,v,156
v_and_b32 v252, 7, v1
MA 216,v,136,v,156
v_add_u32 v252, s36, v252
MA 220,v,140,v,156
TR 156,199,0
TR 158,199,2048
MA 32,v,112,v,160
ds_read_b128 v[96:99], v194 offset:8192
s_add_u32 m0, s23, 36864
MA 36,v,116,v,160
s_lshr_b32 s36, s2, 4
s_lshl_b32 s36, s36, 1
MA 96,v,120,v,160
s_and_b32 s37, s3, 1
MA 100,v,124,v,160
s_add_u32 s36, s36, s37
MA 160,v,128,v,160
ds_read_b128 v[100:103], v194 offset:10240
buffer_load_dwordx4 v188, s[12:15], s21 offen offset:0 lds
MA 164,v,132,v,160
s_lshl_b32 s36, s36, 3
v_lshrrev_b32 v253, 3, v1
MA 224,v,136,v,160
MA 228,v,140,v,160
TR 160,200,0
TR 162,200,2048
MA 40,v,112,v,164
buffer_load_dwordx4 v189, s[12:15], s21 offen offset:1024 lds
v_add_u32 v253, s36, v253
MA 44,v,116,v,164
ds_read_b128 v[104:107], v194 offset:12288
v_lshlrev_b32 v254, 14, v253
MA 104,v,120,v,164
v_lshl_add_u32 v254, v252, 3, v254
v_add_u32 v229, -6144, v254
MA 108,v,124,v,164
MA 168,v,128,v,164
buffer_load_dwordx4 v190, s[12:15], s21 offen offset:2048 lds
v_lshlrev_b32 v62, 5, v252
MA 172,v,132,v,164
v_lshlrev_b32 v254, 4, v253
MA 232,v,136,v,164
ds_read_b128 v[108:111], v194 offset:14336
v_sub_u32 v254, 4080, v254
MA 236,v,140,v,164
TR 164,201,0
TR 166,201,2048
MA 48,v,112,v,168
v_lshl_add_u32 v10, v252, 14, v254
MA 52,v,116,v,168
buffer_load_dwordx4 v191, s[12:15], s21 offen offset:3072 lds
v_and_b32 v252, 31, v1
MA 112,v,120,v,168
v_lshlrev_b32 v64, 4, v252
MA 116,v,124,v,168
s_lshl_b32 s36, s2, 2
MA 176,v,128,v,168
MA 180,v,132,v,168
s_add_u32 s21, s21, 524288
s_add_u32 s36, s36, s3
MA 240,v,136,v,168
s_lshl_b32 s36, s36, 1
MA 244,v,140,v,168
TR 168,202,0
TR 170,202,2048
MA 56,v,112,v,172
v_lshrrev_b32 v253, 5, v1
v_add_u32 v253, s36, v253
MA 60,v,116,v,172
s_and_b32 s21, s21, 4194303
MA 120,v,120,v,172
v_lshl_add_u32 v63, v253, 11, v64
MA 124,v,124,v,172
v_lshlrev_b32 v253, 2, v253
MA 184,v,128,v,172
v_lshl_add_u32 v11, v252, 20, v253
MA 188,v,132,v,172
MA 248,v,136,v,172
MA 252,v,140,v,172
TR 172,203,0
TR 174,203,2048
s_waitcnt lgkmcnt(2)
MA 0,v,80,v,144
s_add_u32 m0, s22, 32768
buffer_load_dwordx4 v[230:233], v63, s[92:95], 0 offen offset:0
MA 4,v,84,v,144
ds_read_b128 v[112:115], v195 offset:0
MA 64,v,88,v,144
MA 68,v,92,v,144
MA 128,v,96,v,144
buffer_load_dwordx4 v[2:5], v64, s[76:79], 0 offen offset:0
MA 132,v,100,v,144
buffer_load_dwordx4 v176, s[8:11], s20 offen offset:0 lds
MA 192,v,104,v,144
MA 196,v,108,v,144
TR 144,196,16384
TR 146,196,18432
MA 8,v,80,v,148
ds_read_b128 v[116:119], v195 offset:2048
MA 12,v,84,v,148
buffer_load_dwordx4 v[234:237], v63, s[92:95], 0 offen offset:512
MA 72,v,88,v,148
buffer_load_dwordx4 v177, s[8:11], s20 offen offset:1024 lds
MA 76,v,92,v,148
MA 136,v,96,v,148
MA 140,v,100,v,148
ds_read_b128 v[120:123], v195 offset:4096
MA 200,v,104,v,148
buffer_load_dwordx4 v[6:9], v64, s[76:79], 0 offen offset:512
MA 204,v,108,v,148
TR 148,197,16384
TR 150,197,18432
MA 16,v,80,v,152
buffer_load_dwordx4 v178, s[8:11], s20 offen offset:2048 lds
MA 20,v,84,v,152
MA 80,v,88,v,152
MA 84,v,92,v,152
buffer_load_dwordx4 v[238:241], v63, s[92:95], 0 offen offset:1024
MA 144,v,96,v,152
ds_read_b128 v[124:127], v195 offset:6144
buffer_load_dwordx4 v179, s[8:11], s20 offen offset:3072 lds
MA 148,v,100,v,152
MA 208,v,104,v,152
MA 212,v,108,v,152
TR 152,198,16384
TR 154,198,18432
MA 24,v,80,v,156
buffer_load_dwordx4 v[12:15], v64, s[76:79], 0 offen offset:1024
MA 28,v,84,v,156
s_add_u32 m0, s22, 36864
MA 88,v,88,v,156
ds_read_b128 v[128:131], v195 offset:8192
MA 92,v,92,v,156
MA 152,v,96,v,156
buffer_load_dwordx4 v[242:245], v63, s[92:95], 0 offen offset:1536
MA 156,v,100,v,156
MA 216,v,104,v,156
MA 220,v,108,v,156
TR 156,199,16384
TR 158,199,18432
MA 32,v,80,v,160
ds_read_b128 v[132:135], v195 offset:10240
buffer_load_dwordx4 v180, s[8:11], s20 offen offset:0 lds
MA 36,v,84,v,160
buffer_load_dwordx4 v[246:249], v64, s[76:79], 0 offen offset:1536
MA 96,v,88,v,160
MA 100,v,92,v,160
MA 160,v,96,v,160
buffer_load_dwordx4 v181, s[8:11], s20 offen offset:1024 lds
MA 164,v,100,v,160
MA 224,v,104,v,160
buffer_load_dwordx4 v[54:57], v62, s[96:99], 0 offen offset:0
MA 228,v,108,v,160
TR 160,200,16384
TR 162,200,18432
MA 40,v,80,v,164
ds_read_b128 v[136:139], v195 offset:12288
MA 44,v,84,v,164
buffer_load_dwordx4 v182, s[8:11], s20 offen offset:2048 lds
MA 104,v,88,v,164
buffer_load_dwordx4 v[58:61], v62, s[96:99], 0 offen offset:16
MA 108,v,92,v,164
MA 168,v,96,v,164
MA 172,v,100,v,164
ds_read_b128 v[140:143], v195 offset:14336
MA 232,v,104,v,164
buffer_load_dwordx4 v183, s[8:11], s20 offen offset:3072 lds
MA 236,v,108,v,164
TR 164,201,16384
TR 166,201,18432
MA 48,v,80,v,168
v_add_u32 v252, 0, v229
MA 52,v,84,v,168
MA 112,v,88,v,168
MA 116,v,92,v,168
s_add_u32 s20, s20, 128
MA 176,v,96,v,168
buffer_load_dwordx2 v[16:17], v252, s[84:87], 0 offen
MA 180,v,100,v,168
MA 240,v,104,v,168
MA 244,v,108,v,168
TR 168,202,16384
TR 170,202,18432
s_waitcnt lgkmcnt(15)
MA 56,v,80,v,172
s_and_b32 s20, s20, 1023
MA 60,v,84,v,172
v_add_u32 v253, 2048, v229
MA 120,v,88,v,172
MA 124,v,92,v,172
MA 184,v,96,v,172
MA 188,v,100,v,172
MA 248,v,104,v,172
MA 252,v,108,v,172
TR 172,203,16384
TR 174,203,18432
s_waitcnt lgkmcnt(2)
MA 0,v,112,v,144
MA 4,v,116,v,144
MA 64,v,120,v,144
MA 68,v,124,v,144
MA 128,v,128,v,144
MA 132,v,132,v,144
MA 192,v,136,v,144
MA 196,v,140,v,144
MA 8,v,112,v,148
MA 12,v,116,v,148
s_waitcnt vmcnt(19) lgkmcnt(0)
s_barrier
MA 72,v,120,v,148
TR 144,196,32768
TR 146,196,34816
MA 76,v,124,v,148
ds_read_b128 v[80:83], v192 offset:0
s_add_u32 m0, s23, 0
MA 136,v,128,v,148
s_and_b32 s80, s2, 7
s_lshr_b32 s81, s2, 3
MA 140,v,132,v,148
s_and_b32 s69, s81, 3
s_lshl_b32 s80, s80, 2
MA 200,v,136,v,148
buffer_load_dwordx4 v184, s[12:15], s21 offen offset:0 lds
s_add_u32 s69, s69, s80
MA 204,v,140,v,148
TR 148,197,32768
TR 150,197,34816
MA 16,v,112,v,152
ds_read_b128 v[84:87], v192 offset:2048
s_lshr_b32 s70, s81, 2
MA 20,v,116,v,152
s_lshl_b32 s80, s3, 16
s_lshl_b32 s65, s70, 18
MA 80,v,120,v,152
buffer_load_dwordx4 v185, s[12:15], s21 offen offset:1024 lds
s_sub_u32 s64, 3932160, s65
MA 84,v,124,v,152
s_add_u32 s65, s65, s80
MA 144,v,128,v,152
s_add_u32 s64, s64, s80
MA 148,v,132,v,152
ds_read_b128 v[88:91], v192 offset:4096
s_lshl_b32 s81, s69, 12
MA 208,v,136,v,152
s_lshl_b32 s100, s64, 2
MA 212,v,140,v,152
TR 152,198,32768
TR 154,198,34816
MA 24,v,112,v,156
buffer_load_dwordx4 v186, s[12:15], s21 offen offset:2048 lds
s_add_u32 s100, s100, s81
MA 28,v,116,v,156
s_lshl_b32 s101, s65, 2
s_add_u32 s101, s101, s81
MA 88,v,120,v,156
ds_read_b128 v[92:95], v192 offset:6144
s_lshl_b32 s66, s3, 17
MA 92,v,124,v,156
buffer_load_dwordx4 v187, s[12:15], s21 offen offset:3072 lds
s_lshl_b32 s81, s69, 8
MA 152,v,128,v,156
s_add_u32 s66, s66, s81
MA 156,v,132,v,156
s_and_b32 s74, s2, 7
MA 216,v,136,v,156
s_lshl_b32 s74, s74, 8
MA 220,v,140,v,156
TR 156,199,32768
TR 158,199,34816
MA 32,v,112,v,160
ds_read_b128 v[96:99], v192 offset:8192
s_add_u32 m0, s23, 4096
MA 36,v,116,v,160
s_mov_b32 s82, s66
s_lshl_b32 s66, s74, 12
MA 96,v,120,v,160
s_lshl_b32 s67, s3, 13
s_lshl_b32 s68, s3, 12
MA 100,v,124,v,160
s_lshl_b32 s77, s70, 1
MA 160,v,128,v,160
ds_read_b128 v[100:103], v192 offset:10240
buffer_load_dwordx4 v188, s[12:15], s21 offen offset:0 lds
MA 164,v,132,v,160
s_sub_u32 s77, 32, s77
v_lshrrev_b32 v66, 3, v1
MA 224,v,136,v,160
v_lshlrev_b32 v66, 11, v66
MA 228,v,140,v,160
TR 160,200,32768
TR 162,200,34816
MA 40,v,112,v,164
buffer_load_dwordx4 v189, s[12:15], s21 offen offset:1024 lds
v_lshrrev_b32 v67, 4, v1
MA 44,v,116,v,164
ds_read_b128 v[104:107], v192 offset:12288
v_and_b32 v68, 7, v1
MA 104,v,120,v,164
v_xor_b32 v68, v68, v67
v_lshl_add_u32 v66, v68, 4, v66
MA 108,v,124,v,164
v_xor_b32 v69, 64, v66
MA 168,v,128,v,164
buffer_load_dwordx4 v190, s[12:15], s21 offen offset:2048 lds
v_add_u32 v208, 0, v66
MA 172,v,132,v,164
v_add_u32 v209, 15360, v69
MA 232,v,136,v,164
ds_read_b128 v[108:111], v192 offset:14336
v_add_u32 v210, 30720, v66
MA 236,v,140,v,164
TR 164,201,32768
TR 166,201,34816
MA 48,v,112,v,168
v_add_u32 v211, 46080, v69
v_and_b32 v68, 15, v1
MA 52,v,116,v,168
buffer_load_dwordx4 v191, s[12:15], s21 offen offset:3072 lds
v_lshlrev_b32 v69, 1, v67
MA 112,v,120,v,168
v_xor_b32 v68, v68, v69
MA 116,v,124,v,168
v_lshlrev_b32 v66, 13, v67
MA 176,v,128,v,168
v_xor_b32 v69, 0, v68
MA 180,v,132,v,168
s_add_u32 s21, s21, 524288
v_lshl_add_u32 v69, v69, 4, v66
MA 240,v,136,v,168
v_add_u32 v212, 0, v69
MA 244,v,140,v,168
TR 168,202,32768
TR 170,202,34816
MA 56,v,112,v,172
v_xor_b32 v69, 0, v68
v_lshl_add_u32 v69, v69, 4, v66
MA 60,v,116,v,172
s_and_b32 s21, s21, 4194303
v_add_u32 v213, 31744, v69
MA 120,v,120,v,172
v_xor_b32 v69, 8, v68
MA 124,v,124,v,172
v_lshl_add_u32 v69, v69, 4, v66
MA 184,v,128,v,172
v_add_u32 v214, 63488, v69
MA 188,v,132,v,172
v_xor_b32 v69, 8, v68
MA 248,v,136,v,172
MA 252,v,140,v,172
TR 172,203,32768
TR 174,203,34816
s_waitcnt lgkmcnt(2)
MA 0,v,80,v,144
s_add_u32 m0, s22, 65536
buffer_load_dwordx2 v[18:19], v253, s[84:87], 0 offen
MA 4,v,84,v,144
ds_read_b128 v[112:115], v193 offset:0
MA 64,v,88,v,144
MA 68,v,92,v,144
MA 128,v,96,v,144
v_add_u32 v254, 4096, v229
MA 132,v,100,v,144
buffer_load_dwordx4 v176, s[8:11], s20 offen offset:0 lds
MA 192,v,104,v,144
MA 196,v,108,v,144
TR 144,196,49152
TR 146,196,51200
MA 8,v,80,v,148
ds_read_b128 v[116:119], v193 offset:2048
MA 12,v,84,v,148
buffer_load_dwordx2 v[20:21], v254, s[84:87], 0 offen
MA 72,v,88,v,148
buffer_load_dwordx4 v177, s[8:11], s20 offen offset:1024 lds
MA 76,v,92,v,148
MA 136,v,96,v,148
MA 140,v,100,v,148
ds_read_b128 v[120:123], v193 offset:4096
MA 200,v,104,v,148
v_add_u32 v255, 6144, v229
MA 204,v,108,v,148
TR 148,197,49152
TR 150,197,51200
MA 16,v,80,v,152
buffer_load_dwordx4 v178, s[8:11], s20 offen offset:2048 lds
MA 20,v,84,v,152
MA 80,v,88,v,152
MA 84,v,92,v,152
buffer_load_dwordx2 v[22:23], v255, s[84:87], 0 offen
MA 144,v,96,v,152
ds_read_b128 v[124:127], v193 offset:6144
buffer_load_dwordx4 v179, s[8:11], s20 offen offset:3072 lds
MA 148,v,100,v,152
MA 208,v,104,v,152
MA 212,v,108,v,152
TR 152,198,49152
TR 154,198,51200
MA 24,v,80,v,156
buffer_load_dwordx2 v[38:39], v255, s[88:91], 0 offen
MA 28,v,84,v,156
s_add_u32 m0, s22, 69632
MA 88,v,88,v,156
ds_read_b128 v[128:131], v193 offset:8192
MA 92,v,92,v,156
MA 152,v,96,v,156
v_add_u32 v252, 8192, v229
MA 156,v,100,v,156
MA 216,v,104,v,156
MA 220,v,108,v,156
TR 156,199,49152
TR 158,199,51200
MA 32,v,80,v,160
ds_read_b128 v[132:135], v193 offset:10240
buffer_load_dwordx4 v180, s[8:11], s20 offen offset:0 lds
MA 36,v,84,v,160
buffer_load_dwordx2 v[24:25], v252, s[84:87], 0 offen
MA 96,v,88,v,160
MA 100,v,92,v,160
MA 160,v,96,v,160
buffer_load_dwordx4 v181, s[8:11], s20 offen offset:1024 lds
MA 164,v,100,v,160
MA 224,v,104,v,160
buffer_load_dwordx2 v[40:41], v252, s[88:91], 0 offen
MA 228,v,108,v,160
TR 160,200,49152
TR 162,200,51200
MA 40,v,80,v,164
ds_read_b128 v[136:139], v193 offset:12288
MA 44,v,84,v,164
buffer_load_dwordx4 v182, s[8:11], s20 offen offset:2048 lds
MA 104,v,88,v,164
v_add_u32 v253, 10240, v229
MA 108,v,92,v,164
MA 168,v,96,v,164
MA 172,v,100,v,164
ds_read_b128 v[140:143], v193 offset:14336
MA 232,v,104,v,164
buffer_load_dwordx4 v183, s[8:11], s20 offen offset:3072 lds
MA 236,v,108,v,164
TR 164,201,49152
TR 166,201,51200
MA 48,v,80,v,168
buffer_load_dwordx2 v[26:27], v253, s[84:87], 0 offen
MA 52,v,84,v,168
MA 112,v,88,v,168
MA 116,v,92,v,168
s_add_u32 s20, s20, 128
MA 176,v,96,v,168
buffer_load_dwordx2 v[42:43], v253, s[88:91], 0 offen
MA 180,v,100,v,168
MA 240,v,104,v,168
MA 244,v,108,v,168
TR 168,202,49152
TR 170,202,51200
s_waitcnt lgkmcnt(15)
MA 56,v,80,v,172
s_and_b32 s20, s20, 1023
MA 60,v,84,v,172
v_add_u32 v254, 12288, v229
MA 120,v,88,v,172
MA 124,v,92,v,172
MA 184,v,96,v,172
MA 188,v,100,v,172
MA 248,v,104,v,172
MA 252,v,108,v,172
TR 172,203,49152
TR 174,203,51200
s_waitcnt lgkmcnt(2)
MA 0,v,112,v,144
MA 4,v,116,v,144
MA 64,v,120,v,144
MA 68,v,124,v,144
MA 128,v,128,v,144
MA 132,v,132,v,144
MA 192,v,136,v,144
MA 196,v,140,v,144
MA 8,v,112,v,148
MA 12,v,116,v,148
s_waitcnt vmcnt(16) lgkmcnt(0)
s_barrier
MA 72,v,120,v,148
TR 144,196,0
TR 146,196,2048
MA 76,v,124,v,148
ds_read_b128 v[80:83], v192 offset:32768
s_add_u32 m0, s23, 32768
MA 136,v,128,v,148
v_lshl_add_u32 v69, v69, 4, v66
v_add_u32 v215, 95232, v69
MA 140,v,132,v,148
v_and_b32 v66, 15, v1
v_lshrrev_b32 v68, 1, v66
MA 200,v,136,v,148
buffer_load_dwordx4 v184, s[12:15], s21 offen offset:0 lds
v_xor_b32 v68, v68, v67
MA 204,v,140,v,148
TR 148,197,0
TR 150,197,2048
MA 16,v,112,v,152
ds_read_b128 v[84:87], v192 offset:34816
v_lshlrev_b32 v68, 4, v68
MA 20,v,116,v,152
v_lshl_add_u32 v68, v66, 7, v68
v_add_u32 v224, s67, v68
MA 80,v,120,v,152
buffer_load_dwordx4 v185, s[12:15], s21 offen offset:1024 lds
v_xor_b32 v225, 64, v224
MA 84,v,124,v,152
v_add_u32 v226, 0x10000, v224
v_add_u32 v227, 0x10000, v225
MA 144,v,128,v,152
v_bfe_u32 v66, v1, 2, 2
v_and_b32 v68, 1, v67
MA 148,v,132,v,152
ds_read_b128 v[88:91], v192 offset:36864
v_lshl_or_b32 v68, v68, 2, v66
MA 208,v,136,v,152
v_lshl_add_u32 v66, v67, 3, v66
MA 212,v,140,v,152
TR 152,198,0
TR 154,198,2048
MA 24,v,112,v,156
buffer_load_dwordx4 v186, s[12:15], s21 offen offset:2048 lds
v_lshlrev_b32 v66, 8, v66
MA 28,v,116,v,156
v_and_b32 v69, 3, v1
v_lshl_add_u32 v66, v69, 3, v66
MA 88,v,120,v,156
ds_read_b128 v[92:95], v192 offset:38912
v_add_u32 v66, 98304, v66
MA 92,v,124,v,156
buffer_load_dwordx4 v187, s[12:15], s21 offen offset:3072 lds
v_xor_b32 v69, 0, v68
MA 152,v,128,v,156
v_lshl_add_u32 v216, v69, 5, v66
v_xor_b32 v69, 1, v68
MA 156,v,132,v,156
v_lshl_add_u32 v217, v69, 5, v66
MA 216,v,136,v,156
v_xor_b32 v69, 2, v68
MA 220,v,140,v,156
TR 156,199,0
TR 158,199,2048
MA 32,v,112,v,160
ds_read_b128 v[96:99], v192 offset:40960
s_add_u32 m0, s23, 36864
MA 36,v,116,v,160
v_lshl_add_u32 v218, v69, 5, v66
v_xor_b32 v69, 3, v68
MA 96,v,120,v,160
v_lshl_add_u32 v219, v69, 5, v66
v_xor_b32 v69, 4, v68
MA 100,v,124,v,160
v_lshl_add_u32 v220, v69, 5, v66
MA 160,v,128,v,160
ds_read_b128 v[100:103], v192 offset:43008
buffer_load_dwordx4 v188, s[12:15], s21 offen offset:0 lds
MA 164,v,132,v,160
v_xor_b32 v69, 5, v68
v_lshl_add_u32 v221, v69, 5, v66
MA 224,v,136,v,160
v_xor_b32 v69, 6, v68
v_lshl_add_u32 v222, v69, 5, v66
MA 228,v,140,v,160
TR 160,200,0
TR 162,200,2048
MA 40,v,112,v,164
buffer_load_dwordx4 v189, s[12:15], s21 offen offset:1024 lds
v_xor_b32 v69, 7, v68
MA 44,v,116,v,164
ds_read_b128 v[104:107], v192 offset:45056
v_lshl_add_u32 v223, v69, 5, v66
MA 104,v,120,v,164
s_mov_b32 s44, s32
s_mov_b32 s45, s33
MA 108,v,124,v,164
s_mov_b32 s46, 4194304
MA 168,v,128,v,164
buffer_load_dwordx4 v190, s[12:15], s21 offen offset:2048 lds
s_mov_b32 s47, 0x20000
MA 172,v,132,v,164
s_add_u32 s48, s34, s82
s_addc_u32 s49, s35, 0
MA 232,v,136,v,164
ds_read_b128 v[108:111], v192 offset:47104
s_sub_u32 s50, 8388608, s82
MA 236,v,140,v,164
TR 164,201,0
TR 166,201,2048
MA 48,v,112,v,168
s_mov_b32 s51, 0x20000
MA 52,v,116,v,168
buffer_load_dwordx4 v191, s[12:15], s21 offen offset:3072 lds
MA 112,v,120,v,168
s_add_u32 s60, s40, 33554432
s_addc_u32 s61, s41, 0
MA 116,v,124,v,168
s_mov_b32 s62, 16777216
s_mov_b32 s63, 0x20000
MA 176,v,128,v,168
s_lshl_b32 s80, s69, 19
MA 180,v,132,v,168
s_add_u32 s21, s21, 524288
MA 240,v,136,v,168
s_add_u32 s52, s40, s80
s_addc_u32 s53, s41, 0
MA 244,v,140,v,168
TR 168,202,0
TR 170,202,2048
MA 56,v,112,v,172
s_lshl_b32 s54, s77, 14
s_mov_b32 s55, 0x20000
MA 60,v,116,v,172
s_and_b32 s21, s21, 4194303
s_add_u32 s80, s80, 16760832
MA 120,v,120,v,172
s_add_u32 s56, s40, s80
s_addc_u32 s57, s41, 0
MA 124,v,124,v,172
s_add_u32 s58, s54, 16384
MA 184,v,128,v,172
s_mov_b32 s59, 0x20000
MA 188,v,132,v,172
s_load_dwordx2 s[38:39], s[0:1], 112
MA 248,v,136,v,172
MA 252,v,140,v,172
TR 172,203,0
TR 174,203,2048
s_waitcnt lgkmcnt(2)
MA 0,v,80,v,144
s_add_u32 m0, s22, 0
buffer_load_dwordx2 v[28:29], v254, s[84:87], 0 offen
MA 4,v,84,v,144
ds_read_b128 v[112:115], v193 offset:32768
MA 64,v,88,v,144
MA 68,v,92,v,144
MA 128,v,96,v,144
buffer_load_dwordx2 v[44:45], v254, s[88:91], 0 offen
MA 132,v,100,v,144
buffer_load_dwordx4 v176, s[8:11], s20 offen offset:0 lds
MA 192,v,104,v,144
MA 196,v,108,v,144
TR 144,196,16384
TR 146,196,18432
MA 8,v,80,v,148
ds_read_b128 v[116:119], v193 offset:34816
v_add_u32 v255, 14336, v229
MA 12,v,84,v,148
MA 72,v,88,v,148
buffer_load_dwordx4 v177, s[8:11], s20 offen offset:1024 lds
MA 76,v,92,v,148
MA 136,v,96,v,148
MA 140,v,100,v,148
ds_read_b128 v[120:123], v193 offset:36864
buffer_load_dwordx2 v[30:31], v255, s[84:87], 0 offen
MA 200,v,104,v,148
MA 204,v,108,v,148
TR 148,197,16384
TR 150,197,18432
MA 16,v,80,v,152
buffer_load_dwordx4 v178, s[8:11], s20 offen offset:2048 lds
MA 20,v,84,v,152
buffer_load_dwordx2 v[46:47], v255, s[88:91], 0 offen
MA 80,v,88,v,152
MA 84,v,92,v,152
MA 144,v,96,v,152
ds_read_b128 v[124:127], v193 offset:38912
buffer_load_dwordx4 v179, s[8:11], s20 offen offset:3072 lds
MA 148,v,100,v,152
MA 208,v,104,v,152
v_add_u32 v252, 16384, v229
MA 212,v,108,v,152
TR 152,198,16384
TR 154,198,18432
MA 24,v,80,v,156
MA 28,v,84,v,156
s_add_u32 m0, s22, 4096
MA 88,v,88,v,156
ds_read_b128 v[128:131], v193 offset:40960
buffer_load_dwordx2 v[32:33], v252, s[84:87], 0 offen
MA 92,v,92,v,156
MA 152,v,96,v,156
MA 156,v,100,v,156
MA 216,v,104,v,156
MA 220,v,108,v,156
TR 156,199,16384
TR 158,199,18432
MA 32,v,80,v,160
ds_read_b128 v[132:135], v193 offset:43008
buffer_load_dwordx4 v180, s[8:11], s20 offen offset:0 lds
MA 36,v,84,v,160
buffer_load_dwordx2 v[48:49], v252, s[88:91], 0 offen
MA 96,v,88,v,160
MA 100,v,92,v,160
v_add_u32 v253, 18432, v229
MA 160,v,96,v,160
buffer_load_dwordx4 v181, s[8:11], s20 offen offset:1024 lds
MA 164,v,100,v,160
MA 224,v,104,v,160
MA 228,v,108,v,160
TR 160,200,16384
TR 162,200,18432
MA 40,v,80,v,164
ds_read_b128 v[136:139], v193 offset:45056
buffer_load_dwordx2 v[34:35], v253, s[84:87], 0 offen
MA 44,v,84,v,164
buffer_load_dwordx4 v182, s[8:11], s20 offen offset:2048 lds
MA 104,v,88,v,164
MA 108,v,92,v,164
MA 168,v,96,v,164
buffer_load_dwordx2 v[50:51], v253, s[88:91], 0 offen
MA 172,v,100,v,164
ds_read_b128 v[140:143], v193 offset:47104
MA 232,v,104,v,164
buffer_load_dwordx4 v183, s[8:11], s20 offen offset:3072 lds
MA 236,v,108,v,164
TR 164,201,16384
TR 166,201,18432
MA 48,v,80,v,168
v_add_u32 v254, 20480, v229
MA 52,v,84,v,168
MA 112,v,88,v,168
MA 116,v,92,v,168
s_add_u32 s20, s20, 128
MA 176,v,96,v,168
MA 180,v,100,v,168
buffer_load_dwordx2 v[36:37], v254, s[84:87], 0 offen
MA 240,v,104,v,168
MA 244,v,108,v,168
TR 168,202,16384
TR 170,202,18432
s_waitcnt lgkmcnt(15)
MA 56,v,80,v,172
s_and_b32 s20, s20, 1023
MA 60,v,84,v,172
buffer_load_dwordx2 v[52:53], v254, s[88:91], 0 offen
MA 120,v,88,v,172
MA 124,v,92,v,172
MA 184,v,96,v,172
MA 188,v,100,v,172
MA 248,v,104,v,172
MA 252,v,108,v,172
TR 172,203,16384
TR 174,203,18432
s_waitcnt lgkmcnt(2)
MA 0,v,112,v,144
MA 4,v,116,v,144
MA 64,v,120,v,144
MA 68,v,124,v,144
MA 128,v,128,v,144
MA 132,v,132,v,144
MA 192,v,136,v,144
MA 196,v,140,v,144
MA 8,v,112,v,148
MA 12,v,116,v,148
s_waitcnt vmcnt(18) lgkmcnt(0)
s_barrier
MA 72,v,120,v,148
TR 144,196,32768
TR 146,196,34816
MA 76,v,124,v,148
ds_read_b128 v[80:83], v194 offset:0
s_add_u32 m0, s23, 0
MA 136,v,128,v,148
MA 140,v,132,v,148
MA 200,v,136,v,148
buffer_load_dwordx4 v184, s[12:15], s21 offen offset:0 lds
MA 204,v,140,v,148
TR 148,197,32768
TR 150,197,34816
MA 16,v,112,v,152
ds_read_b128 v[84:87], v194 offset:2048
MA 20,v,116,v,152
MA 80,v,120,v,152
buffer_load_dwordx4 v185, s[12:15], s21 offen offset:1024 lds
MA 84,v,124,v,152
MA 144,v,128,v,152
MA 148,v,132,v,152
ds_read_b128 v[88:91], v194 offset:4096
MA 208,v,136,v,152
MA 212,v,140,v,152
TR 152,198,32768
TR 154,198,34816
MA 24,v,112,v,156
buffer_load_dwordx4 v186, s[12:15], s21 offen offset:2048 lds
MA 28,v,116,v,156
MA 88,v,120,v,156
ds_read_b128 v[92:95], v194 offset:6144
MA 92,v,124,v,156
buffer_load_dwordx4 v187, s[12:15], s21 offen offset:3072 lds
MA 152,v,128,v,156
MA 156,v,132,v,156
MA 216,v,136,v,156
MA 220,v,140,v,156
TR 156,199,32768
TR 158,199,34816
MA 32,v,112,v,160
ds_read_b128 v[96:99], v194 offset:8192
s_add_u32 m0, s23, 4096
MA 36,v,116,v,160
MA 96,v,120,v,160
MA 100,v,124,v,160
MA 160,v,128,v,160
ds_read_b128 v[100:103], v194 offset:10240
buffer_load_dwordx4 v188, s[12:15], s21 offen offset:0 lds
MA 164,v,132,v,160
MA 224,v,136,v,160
MA 228,v,140,v,160
TR 160,200,32768
TR 162,200,34816
MA 40,v,112,v,164
buffer_load_dwordx4 v189, s[12:15], s21 offen offset:1024 lds
MA 44,v,116,v,164
ds_read_b128 v[104:107], v194 offset:12288
MA 104,v,120,v,164
MA 108,v,124,v,164
MA 168,v,128,v,164
buffer_load_dwordx4 v190, s[12:15], s21 offen offset:2048 lds
MA 172,v,132,v,164
MA 232,v,136,v,164
ds_read_b128 v[108:111], v194 offset:14336
MA 236,v,140,v,164
TR 164,201,32768
TR 166,201,34816
MA 48,v,112,v,168
MA 52,v,116,v,168
buffer_load_dwordx4 v191, s[12:15], s21 offen offset:3072 lds
MA 112,v,120,v,168
MA 116,v,124,v,168
MA 176,v,128,v,168
MA 180,v,132,v,168
s_add_u32 s21, s21, 524288
MA 240,v,136,v,168
MA 244,v,140,v,168
TR 168,202,32768
TR 170,202,34816
MA 56,v,112,v,172
MA 60,v,116,v,172
s_and_b32 s21, s21, 4194303
MA 120,v,120,v,172
MA 124,v,124,v,172
MA 184,v,128,v,172
MA 188,v,132,v,172
MA 248,v,136,v,172
MA 252,v,140,v,172
TR 172,203,32768
TR 174,203,34816
s_waitcnt lgkmcnt(2)
MA 0,v,80,v,144
s_add_u32 m0, s22, 32768
MA 4,v,84,v,144
ds_read_b128 v[112:115], v195 offset:0
MA 64,v,88,v,144
MA 68,v,92,v,144
MA 128,v,96,v,144
MA 132,v,100,v,144
buffer_load_dwordx4 v176, s[8:11], s20 offen offset:0 lds
MA 192,v,104,v,144
MA 196,v,108,v,144
TR 144,196,49152
TR 146,196,51200
MA 8,v,80,v,148
ds_read_b128 v[116:119], v195 offset:2048
MA 12,v,84,v,148
MA 72,v,88,v,148
buffer_load_dwordx4 v177, s[8:11], s20 offen offset:1024 lds
MA 76,v,92,v,148
MA 136,v,96,v,148
MA 140,v,100,v,148
ds_read_b128 v[120:123], v195 offset:4096
MA 200,v,104,v,148
MA 204,v,108,v,148
TR 148,197,49152
TR 150,197,51200
MA 16,v,80,v,152
buffer_load_dwordx4 v178, s[8:11], s20 offen offset:2048 lds
MA 20,v,84,v,152
MA 80,v,88,v,152
MA 84,v,92,v,152
MA 144,v,96,v,152
ds_read_b128 v[124:127], v195 offset:6144
buffer_load_dwordx4 v179, s[8:11], s20 offen offset:3072 lds
MA 148,v,100,v,152
MA 208,v,104,v,152
MA 212,v,108,v,152
TR 152,198,49152
TR 154,198,51200
MA 24,v,80,v,156
MA 28,v,84,v,156
s_add_u32 m0, s22, 36864
MA 88,v,88,v,156
ds_read_b128 v[128:131], v195 offset:8192
MA 92,v,92,v,156
MA 152,v,96,v,156
MA 156,v,100,v,156
MA 216,v,104,v,156
MA 220,v,108,v,156
TR 156,199,49152
TR 158,199,51200
MA 32,v,80,v,160
ds_read_b128 v[132:135], v195 offset:10240
buffer_load_dwordx4 v180, s[8:11], s20 offen offset:0 lds
MA 36,v,84,v,160
MA 96,v,88,v,160
MA 100,v,92,v,160
MA 160,v,96,v,160
buffer_load_dwordx4 v181, s[8:11], s20 offen offset:1024 lds
MA 164,v,100,v,160
MA 224,v,104,v,160
MA 228,v,108,v,160
TR 160,200,49152
TR 162,200,51200
MA 40,v,80,v,164
ds_read_b128 v[136:139], v195 offset:12288
MA 44,v,84,v,164
buffer_load_dwordx4 v182, s[8:11], s20 offen offset:2048 lds
MA 104,v,88,v,164
MA 108,v,92,v,164
MA 168,v,96,v,164
MA 172,v,100,v,164
ds_read_b128 v[140:143], v195 offset:14336
MA 232,v,104,v,164
buffer_load_dwordx4 v183, s[8:11], s20 offen offset:3072 lds
MA 236,v,108,v,164
TR 164,201,49152
TR 166,201,51200
MA 48,v,80,v,168
MA 52,v,84,v,168
MA 112,v,88,v,168
MA 116,v,92,v,168
s_add_u32 s20, s20, 128
MA 176,v,96,v,168
MA 180,v,100,v,168
MA 240,v,104,v,168
MA 244,v,108,v,168
TR 168,202,49152
TR 170,202,51200
s_waitcnt lgkmcnt(15)
MA 56,v,80,v,172
s_and_b32 s20, s20, 1023
MA 60,v,84,v,172
MA 120,v,88,v,172
MA 124,v,92,v,172
MA 184,v,96,v,172
MA 188,v,100,v,172
MA 248,v,104,v,172
MA 252,v,108,v,172
TR 172,203,49152
TR 174,203,51200
s_waitcnt lgkmcnt(2)
MA 0,v,112,v,144
MA 4,v,116,v,144
MA 64,v,120,v,144
MA 68,v,124,v,144
MA 128,v,128,v,144
MA 132,v,132,v,144
MA 192,v,136,v,144
MA 196,v,140,v,144
MA 8,v,112,v,148
MA 12,v,116,v,148
s_waitcnt vmcnt(8) lgkmcnt(0)
s_barrier
MA 72,v,120,v,148
TR 144,196,0
TR 146,196,2048
MA 76,v,124,v,148
ds_read_b128 v[80:83], v192 offset:0
s_add_u32 m0, s23, 32768
MA 136,v,128,v,148
buffer_load_dword v79, v78, s[4:7], 0 offen
MA 140,v,132,v,148
s_add_u32 s84, s40, 50331648
s_addc_u32 s85, s41, 0
MA 200,v,136,v,148
buffer_load_dwordx4 v184, s[12:15], s21 offen offset:0 lds
s_mov_b32 s86, 4194304
MA 204,v,140,v,148
TR 148,197,0
TR 150,197,2048
MA 16,v,112,v,152
ds_read_b128 v[84:87], v192 offset:2048
s_mov_b32 s87, 0x20000
MA 20,v,116,v,152
s_add_u32 s88, s40, 58720256
s_addc_u32 s89, s41, 0
MA 80,v,120,v,152
buffer_load_dwordx4 v185, s[12:15], s21 offen offset:1024 lds
s_mov_b32 s90, 8192
MA 84,v,124,v,152
s_mov_b32 s91, 0x20000
v_mov_b32 v252, 0
MA 144,v,128,v,152
v_mov_b32 v253, 0
v_dot2_f32_bf16 v252, v230, v2, v252
MA 148,v,132,v,152
ds_read_b128 v[88:91], v192 offset:4096
v_dot2_f32_bf16 v253, v231, v3, v253
MA 208,v,136,v,152
v_dot2_f32_bf16 v252, v232, v4, v252
v_dot2_f32_bf16 v253, v233, v5, v253
MA 212,v,140,v,152
TR 152,198,0
TR 154,198,2048
MA 24,v,112,v,156
buffer_load_dwordx4 v186, s[12:15], s21 offen offset:2048 lds
v_dot2_f32_bf16 v252, v234, v6, v252
MA 28,v,116,v,156
v_dot2_f32_bf16 v253, v235, v7, v253
v_dot2_f32_bf16 v252, v236, v8, v252
MA 88,v,120,v,156
ds_read_b128 v[92:95], v192 offset:6144
v_dot2_f32_bf16 v253, v237, v9, v253
MA 92,v,124,v,156
buffer_load_dwordx4 v187, s[12:15], s21 offen offset:3072 lds
v_dot2_f32_bf16 v252, v238, v12, v252
MA 152,v,128,v,156
v_dot2_f32_bf16 v253, v239, v13, v253
v_dot2_f32_bf16 v252, v240, v14, v252
MA 156,v,132,v,156
v_dot2_f32_bf16 v253, v241, v15, v253
v_dot2_f32_bf16 v252, v242, v246, v252
MA 216,v,136,v,156
v_dot2_f32_bf16 v253, v243, v247, v253
v_dot2_f32_bf16 v252, v244, v248, v252
MA 220,v,140,v,156
TR 156,199,0
TR 158,199,2048
MA 32,v,112,v,160
ds_read_b128 v[96:99], v192 offset:8192
s_add_u32 m0, s23, 36864
MA 36,v,116,v,160
v_dot2_f32_bf16 v253, v245, v249, v253
MA 96,v,120,v,160
s_nop 2
v_add_f32 v252, v252, v253
MA 100,v,124,v,160
s_nop 0
v_add_f32_dpp v252, v252, v252 row_ror:8 row_mask:0xf bank_mask:0xf
s_nop 1
v_add_f32_dpp v252, v252, v252 row_ror:4 row_mask:0xf bank_mask:0xf
MA 160,v,128,v,160
ds_read_b128 v[100:103], v192 offset:10240
buffer_load_dwordx4 v188, s[12:15], s21 offen offset:0 lds
MA 164,v,132,v,160
v_add_f32_dpp v252, v252, v252 row_ror:2 row_mask:0xf bank_mask:0xf
s_nop 1
v_add_f32_dpp v252, v252, v252 row_ror:1 row_mask:0xf bank_mask:0xf
MA 224,v,136,v,160
v_mov_b32 v253, v252
s_nop 1
v_permlane16_swap_b32 v252, v253
MA 228,v,140,v,160
TR 160,200,0
TR 162,200,2048
MA 40,v,112,v,164
buffer_load_dwordx4 v189, s[12:15], s21 offen offset:1024 lds
v_add_f32 v252, v252, v253
MA 44,v,116,v,164
ds_read_b128 v[104:107], v192 offset:12288
v_mul_f32 v252, 0xbfb8aa3b, v252
MA 104,v,120,v,164
v_exp_f32 v252, v252
MA 108,v,124,v,164
v_add_f32 v252, 1.0, v252
MA 168,v,128,v,164
buffer_load_dwordx4 v190, s[12:15], s21 offen offset:2048 lds
MA 172,v,132,v,164
v_rcp_f32 v252, v252
MA 232,v,136,v,164
ds_read_b128 v[108:111], v192 offset:14336
MA 236,v,140,v,164
TR 164,201,0
TR 166,201,2048
MA 48,v,112,v,168
s_nop 0
buffer_store_dword v252, v11, s[88:91], 0 offen sc1
MA 52,v,116,v,168
buffer_load_dwordx4 v191, s[12:15], s21 offen offset:3072 lds
v_lshlrev_b32 v2, 16, v54
MA 112,v,120,v,168
v_and_b32 v3, 0xffff0000, v54
v_lshlrev_b32 v4, 16, v55
MA 116,v,124,v,168
v_and_b32 v5, 0xffff0000, v55
v_lshlrev_b32 v6, 16, v56
MA 176,v,128,v,168
v_and_b32 v7, 0xffff0000, v56
v_lshlrev_b32 v8, 16, v57
MA 180,v,132,v,168
s_add_u32 s21, s21, 524288
v_and_b32 v9, 0xffff0000, v57
MA 240,v,136,v,168
v_lshlrev_b32 v230, 16, v16
v_and_b32 v231, 0xffff0000, v16
MA 244,v,140,v,168
TR 168,202,0
TR 170,202,2048
MA 56,v,112,v,172
v_lshlrev_b32 v232, 16, v18
v_and_b32 v233, 0xffff0000, v18
MA 60,v,116,v,172
s_and_b32 s21, s21, 4194303
v_lshlrev_b32 v234, 16, v20
MA 120,v,120,v,172
v_and_b32 v235, 0xffff0000, v20
v_lshlrev_b32 v236, 16, v22
MA 124,v,124,v,172
v_and_b32 v237, 0xffff0000, v22
v_lshlrev_b32 v238, 16, v24
MA 184,v,128,v,172
v_and_b32 v239, 0xffff0000, v24
v_lshlrev_b32 v240, 16, v26
MA 188,v,132,v,172
v_and_b32 v241, 0xffff0000, v26
v_lshlrev_b32 v242, 16, v28
MA 248,v,136,v,172
v_and_b32 v243, 0xffff0000, v28
v_lshlrev_b32 v244, 16, v30
MA 252,v,140,v,172
TR 172,203,0
TR 174,203,2048
v_and_b32 v245, 0xffff0000, v30
v_lshlrev_b32 v246, 16, v32
v_and_b32 v247, 0xffff0000, v32
v_lshlrev_b32 v248, 16, v34
v_and_b32 v249, 0xffff0000, v34
v_lshlrev_b32 v250, 16, v36
v_and_b32 v251, 0xffff0000, v36
v_lshlrev_b32 v254, 16, v38
v_and_b32 v255, 0xffff0000, v38
v_mul_f32 v62, v236, v2
v_mul_f32 v70, v237, v6
v_fmac_f32 v62, v234, v3
v_fmac_f32 v70, v235, v7
v_fmac_f32 v62, v232, v4
v_fmac_f32 v70, v233, v8
v_fmac_f32 v62, v230, v5
v_fmac_f32 v70, v231, v9
v_mul_f32 v62, v62, v254
s_waitcnt lgkmcnt(2)
MA 0,v,80,v,144
s_add_u32 s75, s64, s74
v_mul_f32 v70, v70, v255
MA 4,v,84,v,144
ds_read_b128 v[112:115], v193 offset:0
v_lshlrev_b32 v254, 16, v40
MA 64,v,88,v,144
v_and_b32 v255, 0xffff0000, v40
v_mul_f32 v63, v238, v2
MA 68,v,92,v,144
v_mul_f32 v71, v239, v6
v_fmac_f32 v63, v236, v3
MA 128,v,96,v,144
s_add_u32 m0, s67, 65536
v_fmac_f32 v71, v237, v7
MA 132,v,100,v,144
v_fmac_f32 v63, v234, v4
MA 192,v,104,v,144
v_fmac_f32 v71, v235, v8
MA 196,v,108,v,144
TR 144,196,16384
TR 146,196,18432
MA 8,v,80,v,148
ds_read_b128 v[116:119], v193 offset:2048
buffer_load_dwordx4 v208, s[44:47], s75 offen offset:0 lds
MA 12,v,84,v,148
v_fmac_f32 v63, v232, v5
v_fmac_f32 v71, v233, v9
MA 72,v,88,v,148
v_mul_f32 v63, v63, v254
v_mul_f32 v71, v71, v255
MA 76,v,92,v,148
v_lshlrev_b32 v254, 16, v42
v_and_b32 v255, 0xffff0000, v42
MA 136,v,96,v,148
v_mul_f32 v64, v240, v2
v_mul_f32 v72, v241, v6
MA 140,v,100,v,148
ds_read_b128 v[120:123], v193 offset:4096
buffer_load_dwordx4 v209, s[44:47], s75 offen offset:1024 lds
MA 200,v,104,v,148
v_fmac_f32 v64, v238, v3
v_fmac_f32 v72, v239, v7
MA 204,v,108,v,148
TR 148,197,16384
TR 150,197,18432
MA 16,v,80,v,152
v_fmac_f32 v64, v236, v4
v_fmac_f32 v72, v237, v8
MA 20,v,84,v,152
buffer_load_dwordx4 v210, s[44:47], s75 offen offset:2048 lds
v_fmac_f32 v64, v234, v5
MA 80,v,88,v,152
v_fmac_f32 v72, v235, v9
v_mul_f32 v64, v64, v254
MA 84,v,92,v,152
v_mul_f32 v72, v72, v255
v_lshlrev_b32 v254, 16, v44
MA 144,v,96,v,152
ds_read_b128 v[124:127], v193 offset:6144
v_and_b32 v255, 0xffff0000, v44
MA 148,v,100,v,152
v_mul_f32 v65, v242, v2
MA 208,v,104,v,152
buffer_load_dwordx4 v211, s[44:47], s75 offen offset:3072 lds
v_mul_f32 v73, v243, v6
MA 212,v,108,v,152
TR 152,198,16384
TR 154,198,18432
MA 24,v,80,v,156
v_fmac_f32 v65, v240, v3
v_fmac_f32 v73, v241, v7
MA 28,v,84,v,156
v_fmac_f32 v65, v238, v4
v_fmac_f32 v73, v239, v8
MA 88,v,88,v,156
ds_read_b128 v[128:131], v193 offset:8192
s_add_u32 s75, s65, s74
MA 92,v,92,v,156
v_fmac_f32 v65, v236, v5
v_fmac_f32 v73, v237, v9
MA 152,v,96,v,156
v_mul_f32 v65, v65, v254
v_mul_f32 v73, v73, v255
MA 156,v,100,v,156
v_lshlrev_b32 v254, 16, v46
MA 216,v,104,v,156
v_and_b32 v255, 0xffff0000, v46
MA 220,v,108,v,156
TR 156,199,16384
TR 158,199,18432
MA 32,v,80,v,160
ds_read_b128 v[132:135], v193 offset:10240
s_add_u32 m0, s67, 69632
MA 36,v,84,v,160
v_mul_f32 v66, v244, v2
v_mul_f32 v74, v245, v6
MA 96,v,88,v,160
v_fmac_f32 v66, v242, v3
v_fmac_f32 v74, v243, v7
MA 100,v,92,v,160
buffer_load_dwordx4 v208, s[44:47], s75 offen offset:0 lds
v_fmac_f32 v66, v240, v4
MA 160,v,96,v,160
v_fmac_f32 v74, v241, v8
v_fmac_f32 v66, v238, v5
MA 164,v,100,v,160
v_fmac_f32 v74, v239, v9
v_mul_f32 v66, v66, v254
MA 224,v,104,v,160
v_mul_f32 v74, v74, v255
v_lshlrev_b32 v254, 16, v48
MA 228,v,108,v,160
TR 160,200,16384
TR 162,200,18432
MA 40,v,80,v,164
ds_read_b128 v[136:139], v193 offset:12288
buffer_load_dwordx4 v209, s[44:47], s75 offen offset:1024 lds
MA 44,v,84,v,164
v_and_b32 v255, 0xffff0000, v48
v_mul_f32 v67, v246, v2
MA 104,v,88,v,164
v_mul_f32 v75, v247, v6
v_fmac_f32 v67, v244, v3
MA 108,v,92,v,164
v_fmac_f32 v75, v245, v7
v_fmac_f32 v67, v242, v4
MA 168,v,96,v,164
buffer_load_dwordx4 v210, s[44:47], s75 offen offset:2048 lds
v_fmac_f32 v75, v243, v8
MA 172,v,100,v,164
ds_read_b128 v[140:143], v193 offset:14336
v_fmac_f32 v67, v240, v5
MA 232,v,104,v,164
v_fmac_f32 v75, v241, v9
v_mul_f32 v67, v67, v254
MA 236,v,108,v,164
TR 164,201,16384
TR 166,201,18432
MA 48,v,80,v,168
buffer_load_dwordx4 v211, s[44:47], s75 offen offset:3072 lds
v_mul_f32 v75, v75, v255
MA 52,v,84,v,168
v_lshlrev_b32 v254, 16, v50
v_and_b32 v255, 0xffff0000, v50
MA 112,v,88,v,168
v_mul_f32 v68, v248, v2
v_mul_f32 v76, v249, v6
MA 116,v,92,v,168
v_fmac_f32 v68, v246, v3
MA 176,v,96,v,168
v_fmac_f32 v76, v247, v7
MA 180,v,100,v,168
s_add_u32 s74, s74, 128
v_fmac_f32 v68, v244, v4
MA 240,v,104,v,168
v_fmac_f32 v76, v245, v8
v_fmac_f32 v68, v242, v5
MA 244,v,108,v,168
TR 168,202,16384
TR 170,202,18432
s_waitcnt lgkmcnt(15)
MA 56,v,80,v,172
v_fmac_f32 v76, v243, v9
v_mul_f32 v68, v68, v254
MA 60,v,84,v,172
s_and_b32 s74, s74, 2047
v_mul_f32 v76, v76, v255
MA 120,v,88,v,172
v_lshlrev_b32 v254, 16, v52
v_and_b32 v255, 0xffff0000, v52
MA 124,v,92,v,172
v_mul_f32 v69, v250, v2
MA 184,v,96,v,172
v_mul_f32 v77, v251, v6
MA 188,v,100,v,172
v_fmac_f32 v69, v248, v3
MA 248,v,104,v,172
MA 252,v,108,v,172
TR 172,203,16384
TR 174,203,18432
s_waitcnt lgkmcnt(2)
MA 0,v,112,v,144
MA 4,v,116,v,144
MA 64,v,120,v,144
MA 68,v,124,v,144
MA 128,v,128,v,144
MA 132,v,132,v,144
MA 192,v,136,v,144
MA 196,v,140,v,144
MA 8,v,112,v,148
MA 12,v,116,v,148
s_waitcnt vmcnt(8) lgkmcnt(0)
s_barrier
MA 72,v,120,v,148
TR 144,196,32768
TR 146,196,34816
MA 76,v,124,v,148
ds_read_b128 v[80:83], v192 offset:32768
s_add_u32 m0, s68, 98304
MA 136,v,128,v,148
v_fmac_f32 v77, v249, v7
v_fmac_f32 v69, v246, v4
MA 140,v,132,v,148
buffer_load_dwordx4 v212, s[48:51], s66 offen offset:0 lds
v_fmac_f32 v77, v247, v8
MA 200,v,136,v,148
v_fmac_f32 v69, v244, v5
v_fmac_f32 v77, v245, v9
MA 204,v,140,v,148
TR 148,197,32768
TR 150,197,34816
MA 16,v,112,v,152
ds_read_b128 v[84:87], v192 offset:34816
v_mul_f32 v69, v69, v254
MA 20,v,116,v,152
buffer_load_dwordx4 v213, s[48:51], s66 offen offset:1024 lds
v_mul_f32 v77, v77, v255
MA 80,v,120,v,152
v_cvt_pk_bf16_f32 v12, v69, v68
v_cvt_pk_bf16_f32 v13, v67, v66
MA 84,v,124,v,152
v_cvt_pk_bf16_f32 v14, v65, v64
v_cvt_pk_bf16_f32 v15, v63, v62
MA 144,v,128,v,152
s_mov_b32 s36, 0
buffer_store_dwordx4 v[12:15], v10, s[84:87], s36 offen sc1
MA 148,v,132,v,152
ds_read_b128 v[88:91], v192 offset:36864
buffer_load_dwordx4 v214, s[48:51], s66 offen offset:2048 lds
MA 208,v,136,v,152
v_cvt_pk_bf16_f32 v54, v77, v76
v_cvt_pk_bf16_f32 v55, v75, v74
MA 212,v,140,v,152
TR 152,198,32768
TR 154,198,34816
MA 24,v,112,v,156
buffer_load_dwordx4 v215, s[48:51], s66 offen offset:3072 lds
v_cvt_pk_bf16_f32 v56, v73, v72
MA 28,v,116,v,156
v_cvt_pk_bf16_f32 v57, v71, v70
s_mov_b32 s36, 4096
MA 88,v,120,v,156
ds_read_b128 v[92:95], v192 offset:38912
buffer_store_dwordx4 v[54:57], v10, s[84:87], s36 offen sc1
MA 92,v,124,v,156
v_lshlrev_b32 v2, 16, v58
v_and_b32 v3, 0xffff0000, v58
MA 152,v,128,v,156
s_add_u32 s66, s66, 524288
v_lshlrev_b32 v4, 16, v59
MA 156,v,132,v,156
v_and_b32 v5, 0xffff0000, v59
v_lshlrev_b32 v6, 16, v60
MA 216,v,136,v,156
v_and_b32 v7, 0xffff0000, v60
v_lshlrev_b32 v8, 16, v61
MA 220,v,140,v,156
TR 156,199,32768
TR 158,199,34816
MA 32,v,112,v,160
ds_read_b128 v[96:99], v192 offset:40960
s_and_b32 s66, s66, 8388607
MA 36,v,116,v,160
v_and_b32 v9, 0xffff0000, v61
v_lshlrev_b32 v230, 16, v17
MA 96,v,120,v,160
v_and_b32 v231, 0xffff0000, v17
v_lshlrev_b32 v232, 16, v19
MA 100,v,124,v,160
v_and_b32 v233, 0xffff0000, v19
v_lshlrev_b32 v234, 16, v21
MA 160,v,128,v,160
ds_read_b128 v[100:103], v192 offset:43008
s_add_u32 m0, s68, 114688
MA 164,v,132,v,160
v_and_b32 v235, 0xffff0000, v21
v_lshlrev_b32 v236, 16, v23
MA 224,v,136,v,160
v_and_b32 v237, 0xffff0000, v23
v_lshlrev_b32 v238, 16, v25
MA 228,v,140,v,160
TR 160,200,32768
TR 162,200,34816
MA 40,v,112,v,164
buffer_load_dwordx4 v212, s[48:51], s66 offen offset:0 lds
v_and_b32 v239, 0xffff0000, v25
MA 44,v,116,v,164
ds_read_b128 v[104:107], v192 offset:45056
v_lshlrev_b32 v240, 16, v27
MA 104,v,120,v,164
v_and_b32 v241, 0xffff0000, v27
v_lshlrev_b32 v242, 16, v29
MA 108,v,124,v,164
buffer_load_dwordx4 v213, s[48:51], s66 offen offset:1024 lds
v_and_b32 v243, 0xffff0000, v29
MA 168,v,128,v,164
v_lshlrev_b32 v244, 16, v31
v_and_b32 v245, 0xffff0000, v31
MA 172,v,132,v,164
v_lshlrev_b32 v246, 16, v33
v_and_b32 v247, 0xffff0000, v33
MA 232,v,136,v,164
ds_read_b128 v[108:111], v192 offset:47104
v_lshlrev_b32 v248, 16, v35
MA 236,v,140,v,164
TR 164,201,32768
TR 166,201,34816
MA 48,v,112,v,168
buffer_load_dwordx4 v214, s[48:51], s66 offen offset:2048 lds
v_and_b32 v249, 0xffff0000, v35
MA 52,v,116,v,168
v_lshlrev_b32 v250, 16, v37
v_and_b32 v251, 0xffff0000, v37
MA 112,v,120,v,168
buffer_load_dwordx4 v215, s[48:51], s66 offen offset:3072 lds
v_lshlrev_b32 v254, 16, v39
MA 116,v,124,v,168
v_and_b32 v255, 0xffff0000, v39
v_mul_f32 v62, v236, v2
MA 176,v,128,v,168
v_mul_f32 v70, v237, v6
v_fmac_f32 v62, v234, v3
MA 180,v,132,v,168
v_fmac_f32 v70, v235, v7
v_fmac_f32 v62, v232, v4
MA 240,v,136,v,168
s_add_u32 s66, s66, 524288
v_fmac_f32 v70, v233, v8
MA 244,v,140,v,168
TR 168,202,32768
TR 170,202,34816
MA 56,v,112,v,172
v_fmac_f32 v62, v230, v5
v_fmac_f32 v70, v231, v9
MA 60,v,116,v,172
v_mul_f32 v62, v62, v254
v_mul_f32 v70, v70, v255
MA 120,v,120,v,172
s_and_b32 s66, s66, 8388607
v_lshlrev_b32 v254, 16, v41
MA 124,v,124,v,172
v_and_b32 v255, 0xffff0000, v41
v_mul_f32 v63, v238, v2
MA 184,v,128,v,172
v_mul_f32 v71, v239, v6
v_fmac_f32 v63, v236, v3
MA 188,v,132,v,172
v_fmac_f32 v71, v237, v7
v_fmac_f32 v63, v234, v4
MA 248,v,136,v,172
v_fmac_f32 v71, v235, v8
v_fmac_f32 v63, v232, v5
MA 252,v,140,v,172
TR 172,203,32768
TR 174,203,34816
v_fmac_f32 v71, v233, v9
v_mul_f32 v63, v63, v254
v_mul_f32 v71, v71, v255
v_lshlrev_b32 v254, 16, v43
v_and_b32 v255, 0xffff0000, v43
v_mul_f32 v64, v240, v2
v_mul_f32 v72, v241, v6
v_fmac_f32 v64, v238, v3
s_waitcnt lgkmcnt(2)
MA 0,v,80,v,144
s_add_u32 s75, s64, s74
v_fmac_f32 v72, v239, v7
MA 4,v,84,v,144
ds_read_b128 v[112:115], v193 offset:32768
v_fmac_f32 v64, v236, v4
MA 64,v,88,v,144
v_fmac_f32 v72, v237, v8
v_fmac_f32 v64, v234, v5
MA 68,v,92,v,144
v_fmac_f32 v72, v235, v9
v_mul_f32 v64, v64, v254
MA 128,v,96,v,144
s_add_u32 m0, s67, 0
v_mul_f32 v72, v72, v255
MA 132,v,100,v,144
v_lshlrev_b32 v254, 16, v45
MA 192,v,104,v,144
v_and_b32 v255, 0xffff0000, v45
v_mul_f32 v65, v242, v2
MA 196,v,108,v,144
TR 144,196,49152
TR 146,196,51200
MA 8,v,80,v,148
ds_read_b128 v[116:119], v193 offset:34816
buffer_load_dwordx4 v208, s[44:47], s75 offen offset:0 lds
MA 12,v,84,v,148
v_mul_f32 v73, v243, v6
v_fmac_f32 v65, v240, v3
MA 72,v,88,v,148
v_fmac_f32 v73, v241, v7
v_fmac_f32 v65, v238, v4
MA 76,v,92,v,148
v_fmac_f32 v73, v239, v8
v_fmac_f32 v65, v236, v5
MA 136,v,96,v,148
v_fmac_f32 v73, v237, v9
MA 140,v,100,v,148
ds_read_b128 v[120:123], v193 offset:36864
buffer_load_dwordx4 v209, s[44:47], s75 offen offset:1024 lds
MA 200,v,104,v,148
v_mul_f32 v65, v65, v254
v_mul_f32 v73, v73, v255
MA 204,v,108,v,148
TR 148,197,49152
TR 150,197,51200
MA 16,v,80,v,152
v_lshlrev_b32 v254, 16, v47
v_and_b32 v255, 0xffff0000, v47
MA 20,v,84,v,152
buffer_load_dwordx4 v210, s[44:47], s75 offen offset:2048 lds
v_mul_f32 v66, v244, v2
MA 80,v,88,v,152
v_mul_f32 v74, v245, v6
v_fmac_f32 v66, v242, v3
MA 84,v,92,v,152
v_fmac_f32 v74, v243, v7
v_fmac_f32 v66, v240, v4
MA 144,v,96,v,152
ds_read_b128 v[124:127], v193 offset:38912
v_fmac_f32 v74, v241, v8
MA 148,v,100,v,152
v_fmac_f32 v66, v238, v5
v_fmac_f32 v74, v239, v9
MA 208,v,104,v,152
buffer_load_dwordx4 v211, s[44:47], s75 offen offset:3072 lds
v_mul_f32 v66, v66, v254
MA 212,v,108,v,152
TR 152,198,49152
TR 154,198,51200
MA 24,v,80,v,156
v_mul_f32 v74, v74, v255
v_lshlrev_b32 v254, 16, v49
MA 28,v,84,v,156
v_and_b32 v255, 0xffff0000, v49
v_mul_f32 v67, v246, v2
MA 88,v,88,v,156
ds_read_b128 v[128:131], v193 offset:40960
s_add_u32 s75, s65, s74
MA 92,v,92,v,156
v_mul_f32 v75, v247, v6
v_fmac_f32 v67, v244, v3
MA 152,v,96,v,156
v_fmac_f32 v75, v245, v7
v_fmac_f32 v67, v242, v4
MA 156,v,100,v,156
v_fmac_f32 v75, v243, v8
MA 216,v,104,v,156
v_fmac_f32 v67, v240, v5
MA 220,v,108,v,156
TR 156,199,49152
TR 158,199,51200
MA 32,v,80,v,160
ds_read_b128 v[132:135], v193 offset:43008
s_add_u32 m0, s67, 4096
MA 36,v,84,v,160
v_fmac_f32 v75, v241, v9
v_mul_f32 v67, v67, v254
MA 96,v,88,v,160
v_mul_f32 v75, v75, v255
v_lshlrev_b32 v254, 16, v51
MA 100,v,92,v,160
buffer_load_dwordx4 v208, s[44:47], s75 offen offset:0 lds
v_and_b32 v255, 0xffff0000, v51
MA 160,v,96,v,160
v_mul_f32 v68, v248, v2
v_mul_f32 v76, v249, v6
MA 164,v,100,v,160
v_fmac_f32 v68, v246, v3
v_fmac_f32 v76, v247, v7
MA 224,v,104,v,160
v_fmac_f32 v68, v244, v4
v_fmac_f32 v76, v245, v8
MA 228,v,108,v,160
TR 160,200,49152
TR 162,200,51200
MA 40,v,80,v,164
ds_read_b128 v[136:139], v193 offset:45056
buffer_load_dwordx4 v209, s[44:47], s75 offen offset:1024 lds
MA 44,v,84,v,164
v_fmac_f32 v68, v242, v5
v_fmac_f32 v76, v243, v9
MA 104,v,88,v,164
v_mul_f32 v68, v68, v254
v_mul_f32 v76, v76, v255
MA 108,v,92,v,164
v_lshlrev_b32 v254, 16, v53
v_and_b32 v255, 0xffff0000, v53
MA 168,v,96,v,164
buffer_load_dwordx4 v210, s[44:47], s75 offen offset:2048 lds
v_mul_f32 v69, v250, v2
MA 172,v,100,v,164
ds_read_b128 v[140:143], v193 offset:47104
v_mul_f32 v77, v251, v6
MA 232,v,104,v,164
v_fmac_f32 v69, v248, v3
v_fmac_f32 v77, v249, v7
MA 236,v,108,v,164
TR 164,201,49152
TR 166,201,51200
MA 48,v,80,v,168
buffer_load_dwordx4 v211, s[44:47], s75 offen offset:3072 lds
v_fmac_f32 v69, v246, v4
MA 52,v,84,v,168
v_fmac_f32 v77, v247, v8
v_fmac_f32 v69, v244, v5
MA 112,v,88,v,168
v_fmac_f32 v77, v245, v9
v_mul_f32 v69, v69, v254
MA 116,v,92,v,168
v_mul_f32 v77, v77, v255
v_cvt_pk_bf16_f32 v230, v69, v68
MA 176,v,96,v,168
v_cvt_pk_bf16_f32 v231, v67, v66
MA 180,v,100,v,168
s_add_u32 s74, s74, 128
v_cvt_pk_bf16_f32 v232, v65, v64
MA 240,v,104,v,168
v_cvt_pk_bf16_f32 v233, v63, v62
MA 244,v,108,v,168
TR 168,202,49152
TR 170,202,51200
s_waitcnt lgkmcnt(15)
MA 56,v,80,v,172
s_mov_b32 s36, 8192
buffer_store_dwordx4 v[230:233], v10, s[84:87], s36 offen sc1
MA 60,v,84,v,172
s_and_b32 s74, s74, 2047
v_cvt_pk_bf16_f32 v234, v77, v76
MA 120,v,88,v,172
v_cvt_pk_bf16_f32 v235, v75, v74
v_cvt_pk_bf16_f32 v236, v73, v72
MA 124,v,92,v,172
v_cvt_pk_bf16_f32 v237, v71, v70
s_mov_b32 s36, 12288
MA 184,v,96,v,172
buffer_store_dwordx4 v[234:237], v10, s[84:87], s36 offen sc1
MA 188,v,100,v,172
v_lshlrev_b32 v228, 4, v1
MA 248,v,104,v,172
MA 252,v,108,v,172
TR 172,203,49152
TR 174,203,51200
s_waitcnt lgkmcnt(2)
MA 0,v,112,v,144
MA 4,v,116,v,144
MA 64,v,120,v,144
MA 68,v,124,v,144
MA 128,v,128,v,144
MA 132,v,132,v,144
MA 192,v,136,v,144
MA 196,v,140,v,144
MA 8,v,112,v,148
MA 12,v,116,v,148
s_waitcnt vmcnt(15) lgkmcnt(0)
s_barrier
MA 72,v,120,v,148
ds_read_b128 v[48:51], v226 offset:0
s_add_u32 m0, s68, 131072
MA 76,v,124,v,148
MA 136,v,128,v,148
ds_read_b128 v[52:55], v226 offset:2048
buffer_load_dwordx4 v212, s[48:51], s66 offen offset:0 lds
MA 140,v,132,v,148
MA 200,v,136,v,148
ds_read_b128 v[56:59], v226 offset:4096
buffer_load_dwordx4 v213, s[48:51], s66 offen offset:1024 lds
MA 204,v,140,v,148
MA 16,v,112,v,152
ds_read_b128 v[60:63], v226 offset:6144
MA 20,v,116,v,152
buffer_load_dwordx4 v214, s[48:51], s66 offen offset:2048 lds
MA 80,v,120,v,152
TR 16,216,0
MA 84,v,124,v,152
buffer_load_dwordx4 v215, s[48:51], s66 offen offset:3072 lds
MA 144,v,128,v,152
TR 18,216,1024
MA 148,v,132,v,152
MA 208,v,136,v,152
TR 20,217,0
s_add_u32 s66, s66, 524288
MA 212,v,140,v,152
MA 24,v,112,v,156
TR 22,217,1024
s_and_b32 s66, s66, 8388607
MA 28,v,116,v,156
MA 88,v,120,v,156
TR 24,218,0
MA 92,v,124,v,156
s_add_u32 s75, s64, s74
MA 152,v,128,v,156
TR 26,218,1024
MA 156,v,132,v,156
s_add_u32 m0, s67, 32768
MA 216,v,136,v,156
TR 28,219,0
MA 220,v,140,v,156
MA 32,v,112,v,160
TR 30,219,1024
buffer_load_dwordx4 v208, s[44:47], s75 offen offset:0 lds
MA 36,v,116,v,160
MA 96,v,120,v,160
TR 32,220,0
buffer_load_dwordx4 v209, s[44:47], s75 offen offset:1024 lds
MA 100,v,124,v,160
MA 160,v,128,v,160
TR 34,220,1024
MA 164,v,132,v,160
buffer_load_dwordx4 v210, s[44:47], s75 offen offset:2048 lds
MA 224,v,136,v,160
TR 36,221,0
MA 228,v,140,v,160
buffer_load_dwordx4 v211, s[44:47], s75 offen offset:3072 lds
MA 40,v,112,v,164
TR 38,221,1024
MA 44,v,116,v,164
MA 104,v,120,v,164
TR 40,222,0
s_add_u32 s75, s65, s74
MA 108,v,124,v,164
MA 168,v,128,v,164
TR 42,222,1024
s_add_u32 m0, s67, 36864
MA 172,v,132,v,164
MA 232,v,136,v,164
TR 44,223,0
MA 236,v,140,v,164
buffer_load_dwordx4 v208, s[44:47], s75 offen offset:0 lds
MA 48,v,112,v,168
TR 46,223,1024
MA 52,v,116,v,168
buffer_load_dwordx4 v209, s[44:47], s75 offen offset:1024 lds
MA 112,v,120,v,168
MA 116,v,124,v,168
MA 176,v,128,v,168
buffer_load_dwordx4 v210, s[44:47], s75 offen offset:2048 lds
MA 180,v,132,v,168
MA 240,v,136,v,168
buffer_load_dwordx4 v211, s[44:47], s75 offen offset:3072 lds
MA 244,v,140,v,168
MA 56,v,112,v,172
MA 60,v,116,v,172
s_add_u32 s74, s74, 128
MA 120,v,120,v,172
MA 124,v,124,v,172
s_and_b32 s74, s74, 2047
MA 184,v,128,v,172
MA 188,v,132,v,172
MA 248,v,136,v,172
MA 252,v,140,v,172
L_p2:
s_waitcnt lgkmcnt(4)
v_mfma_f32_16x16x32_bf16 v[80:83], v[16:19], v[48:51], 0
s_add_u32 s8, s40, 59768832
s_addc_u32 s9, s41, 0
v_mfma_f32_16x16x32_bf16 v[84:87], v[16:19], v[52:55], 0
ds_read_b128 v[64:67], v227 offset:0
v_mfma_f32_16x16x32_bf16 v[88:91], v[16:19], v[56:59], 0
s_mov_b32 s10, 8192
v_mfma_f32_16x16x32_bf16 v[92:95], v[16:19], v[60:63], 0
TR 16,216,8192
TR 18,216,9216
v_mfma_f32_16x16x32_bf16 v[96:99], v[20:23], v[48:51], 0
s_mov_b32 s11, 0x20000
s_mov_b32 s12, s38
v_mfma_f32_16x16x32_bf16 v[100:103], v[20:23], v[52:55], 0
s_mov_b32 s13, s39
v_mfma_f32_16x16x32_bf16 v[104:107], v[20:23], v[56:59], 0
ds_read_b128 v[68:71], v227 offset:2048
s_mov_b32 s14, 256
v_mfma_f32_16x16x32_bf16 v[108:111], v[20:23], v[60:63], 0
TR 20,217,8192
TR 22,217,9216
v_mfma_f32_16x16x32_bf16 v[112:115], v[24:27], v[48:51], 0
s_mov_b32 s15, 0x20000
v_accvgpr_read_b32 v234, a0
v_mfma_f32_16x16x32_bf16 v[116:119], v[24:27], v[52:55], 0
v_accvgpr_read_b32 v235, a1
v_mfma_f32_16x16x32_bf16 v[120:123], v[24:27], v[56:59], 0
v_accvgpr_read_b32 v236, a2
v_mfma_f32_16x16x32_bf16 v[124:127], v[24:27], v[60:63], 0
TR 24,218,8192
TR 26,218,9216
v_mfma_f32_16x16x32_bf16 v[128:131], v[28:31], v[48:51], 0
ds_read_b128 v[72:75], v227 offset:4096
v_accvgpr_read_b32 v237, a3
v_mfma_f32_16x16x32_bf16 v[132:135], v[28:31], v[52:55], 0
v_accvgpr_read_b32 v238, a4
v_accvgpr_read_b32 v239, a5
v_mfma_f32_16x16x32_bf16 v[136:139], v[28:31], v[56:59], 0
v_accvgpr_read_b32 v240, a6
v_mfma_f32_16x16x32_bf16 v[140:143], v[28:31], v[60:63], 0
TR 28,219,8192
TR 30,219,9216
v_mfma_f32_16x16x32_bf16 v[144:147], v[32:35], v[48:51], 0
v_accvgpr_read_b32 v241, a7
v_cvt_pk_bf16_f32 v230, v234, v235
v_mfma_f32_16x16x32_bf16 v[148:151], v[32:35], v[52:55], 0
v_cvt_pk_bf16_f32 v231, v236, v237
v_mfma_f32_16x16x32_bf16 v[152:155], v[32:35], v[56:59], 0
ds_read_b128 v[76:79], v227 offset:6144
v_cvt_pk_bf16_f32 v232, v238, v239
v_mfma_f32_16x16x32_bf16 v[156:159], v[32:35], v[60:63], 0
TR 32,220,8192
TR 34,220,9216
v_mfma_f32_16x16x32_bf16 v[160:163], v[36:39], v[48:51], 0
v_cvt_pk_bf16_f32 v233, v240, v241
buffer_store_dwordx4 v[230:233], v228, s[16:19], s24 offen offset:0 sc1
v_mfma_f32_16x16x32_bf16 v[164:167], v[36:39], v[52:55], 0
v_accvgpr_read_b32 v246, a8
v_mfma_f32_16x16x32_bf16 v[168:171], v[36:39], v[56:59], 0
v_accvgpr_read_b32 v247, a9
v_mfma_f32_16x16x32_bf16 v[172:175], v[36:39], v[60:63], 0
TR 36,221,8192
TR 38,221,9216
s_waitcnt lgkmcnt(15)
v_mfma_f32_16x16x32_bf16 v[176:179], v[40:43], v[48:51], 0
v_accvgpr_read_b32 v248, a10
v_accvgpr_read_b32 v249, a11
v_mfma_f32_16x16x32_bf16 v[180:183], v[40:43], v[52:55], 0
v_accvgpr_read_b32 v250, a12
v_mfma_f32_16x16x32_bf16 v[184:187], v[40:43], v[56:59], 0
v_accvgpr_read_b32 v251, a13
v_mfma_f32_16x16x32_bf16 v[188:191], v[40:43], v[60:63], 0
TR 40,222,8192
TR 42,222,9216
v_mfma_f32_16x16x32_bf16 v[192:195], v[44:47], v[48:51], 0
v_accvgpr_read_b32 v252, a14
v_accvgpr_read_b32 v253, a15
v_mfma_f32_16x16x32_bf16 v[196:199], v[44:47], v[52:55], 0
v_mfma_f32_16x16x32_bf16 v[200:203], v[44:47], v[56:59], 0
v_mfma_f32_16x16x32_bf16 v[204:207], v[44:47], v[60:63], 0
TR 44,223,8192
TR 46,223,9216
s_waitcnt lgkmcnt(4)
MV 80,v,16,v,64
v_cvt_pk_bf16_f32 v242, v246, v247
MV 84,v,16,v,68
v_cvt_pk_bf16_f32 v243, v248, v249
MV 88,v,16,v,72
v_cvt_pk_bf16_f32 v244, v250, v251
MV 92,v,16,v,76
MV 96,v,20,v,64
v_cvt_pk_bf16_f32 v245, v252, v253
MV 100,v,20,v,68
buffer_store_dwordx4 v[242:245], v228, s[16:19], s24 offen offset:1024 sc1
MV 104,v,20,v,72
MV 108,v,20,v,76
s_waitcnt vmcnt(16) lgkmcnt(0)
s_barrier
MV 112,v,24,v,64
TR 16,216,16384
TR 18,216,17408
MV 116,v,24,v,68
ds_read_b128 v[48:51], v224 offset:0
s_add_u32 m0, s68, 98304
MV 120,v,24,v,72
TR 20,217,16384
TR 22,217,17408
MV 124,v,24,v,76
buffer_load_dwordx4 v212, s[48:51], s66 offen offset:0 lds
v_accvgpr_read_b32 v234, a16
MV 128,v,28,v,64
TR 24,218,16384
TR 26,218,17408
MV 132,v,28,v,68
ds_read_b128 v[52:55], v224 offset:2048
buffer_load_dwordx4 v213, s[48:51], s66 offen offset:1024 lds
MV 136,v,28,v,72
buffer_load_dwordx4 v214, s[48:51], s66 offen offset:2048 lds
v_accvgpr_read_b32 v235, a17
MV 140,v,28,v,76
TR 28,219,16384
TR 30,219,17408
MV 144,v,32,v,64
ds_read_b128 v[56:59], v224 offset:4096
v_accvgpr_read_b32 v236, a18
MV 148,v,32,v,68
buffer_load_dwordx4 v215, s[48:51], s66 offen offset:3072 lds
v_accvgpr_read_b32 v237, a19
MV 152,v,32,v,72
v_accvgpr_read_b32 v238, a20
v_accvgpr_read_b32 v239, a21
MV 156,v,32,v,76
TR 32,220,16384
TR 34,220,17408
MV 160,v,36,v,64
ds_read_b128 v[60:63], v224 offset:6144
s_add_u32 s66, s66, 524288
MV 164,v,36,v,68
s_and_b32 s66, s66, 8388607
v_accvgpr_read_b32 v240, a22
MV 168,v,36,v,72
v_accvgpr_read_b32 v241, a23
v_cvt_pk_bf16_f32 v230, v234, v235
MV 172,v,36,v,76
TR 36,221,16384
TR 38,221,17408
MV 176,v,40,v,64
s_add_u32 s75, s64, s74
v_cvt_pk_bf16_f32 v231, v236, v237
MV 180,v,40,v,68
v_cvt_pk_bf16_f32 v232, v238, v239
v_cvt_pk_bf16_f32 v233, v240, v241
MV 184,v,40,v,72
s_add_u32 m0, s67, 65536
buffer_store_dwordx4 v[230:233], v228, s[16:19], s24 offen offset:2048 sc1
MV 188,v,40,v,76
TR 40,222,16384
TR 42,222,17408
MV 192,v,44,v,64
buffer_load_dwordx4 v208, s[44:47], s75 offen offset:0 lds
v_accvgpr_read_b32 v246, a24
MV 196,v,44,v,68
v_accvgpr_read_b32 v247, a25
v_accvgpr_read_b32 v248, a26
MV 200,v,44,v,72
MV 204,v,44,v,76
TR 44,223,16384
TR 46,223,17408
s_waitcnt lgkmcnt(4)
MV 80,v,16,v,48
buffer_load_dwordx4 v209, s[44:47], s75 offen offset:1024 lds
v_accvgpr_read_b32 v249, a27
MV 84,v,16,v,52
ds_read_b128 v[64:67], v225 offset:0
v_accvgpr_read_b32 v250, a28
MV 88,v,16,v,56
buffer_load_dwordx4 v210, s[44:47], s75 offen offset:2048 lds
v_accvgpr_read_b32 v251, a29
MV 92,v,16,v,60
TR 16,216,24576
TR 18,216,25600
MV 96,v,20,v,48
v_accvgpr_read_b32 v252, a30
MV 100,v,20,v,52
buffer_load_dwordx4 v211, s[44:47], s75 offen offset:3072 lds
v_accvgpr_read_b32 v253, a31
MV 104,v,20,v,56
ds_read_b128 v[68:71], v225 offset:2048
MV 108,v,20,v,60
TR 20,217,24576
TR 22,217,25600
MV 112,v,24,v,48
s_add_u32 s75, s65, s74
v_cvt_pk_bf16_f32 v242, v246, v247
MV 116,v,24,v,52
v_cvt_pk_bf16_f32 v243, v248, v249
MV 120,v,24,v,56
v_cvt_pk_bf16_f32 v244, v250, v251
MV 124,v,24,v,60
TR 24,218,24576
TR 26,218,25600
MV 128,v,28,v,48
ds_read_b128 v[72:75], v225 offset:4096
s_add_u32 m0, s67, 69632
MV 132,v,28,v,52
v_cvt_pk_bf16_f32 v245, v252, v253
buffer_store_dwordx4 v[242:245], v228, s[16:19], s24 offen offset:3072 sc1
MV 136,v,28,v,56
buffer_load_dwordx4 v208, s[44:47], s75 offen offset:0 lds
v_accvgpr_read_b32 v234, a32
MV 140,v,28,v,60
TR 28,219,24576
TR 30,219,25600
MV 144,v,32,v,48
buffer_load_dwordx4 v209, s[44:47], s75 offen offset:1024 lds
v_accvgpr_read_b32 v235, a33
MV 148,v,32,v,52
v_accvgpr_read_b32 v236, a34
MV 152,v,32,v,56
ds_read_b128 v[76:79], v225 offset:6144
v_accvgpr_read_b32 v237, a35
MV 156,v,32,v,60
TR 32,220,24576
TR 34,220,25600
MV 160,v,36,v,48
buffer_load_dwordx4 v210, s[44:47], s75 offen offset:2048 lds
v_accvgpr_read_b32 v238, a36
MV 164,v,36,v,52
v_accvgpr_read_b32 v239, a37
MV 168,v,36,v,56
buffer_load_dwordx4 v211, s[44:47], s75 offen offset:3072 lds
v_accvgpr_read_b32 v240, a38
MV 172,v,36,v,60
TR 36,221,24576
TR 38,221,25600
s_waitcnt lgkmcnt(15)
MV 176,v,40,v,48
v_accvgpr_read_b32 v241, a39
MV 180,v,40,v,52
s_add_u32 s74, s74, 128
v_cvt_pk_bf16_f32 v230, v234, v235
MV 184,v,40,v,56
MV 188,v,40,v,60
TR 40,222,24576
TR 42,222,25600
MV 192,v,44,v,48
s_and_b32 s74, s74, 2047
v_cvt_pk_bf16_f32 v231, v236, v237
MV 196,v,44,v,52
v_cvt_pk_bf16_f32 v232, v238, v239
MV 200,v,44,v,56
MV 204,v,44,v,60
TR 44,223,24576
TR 46,223,25600
s_waitcnt lgkmcnt(4)
MV 80,v,16,v,64
v_cvt_pk_bf16_f32 v233, v240, v241
MV 84,v,16,v,68
s_add_u32 s24, s24, 4096
MV 88,v,16,v,72
buffer_store_dwordx4 v[230:233], v228, s[16:19], s24 offen offset:0 sc1
MV 92,v,16,v,76
MV 96,v,20,v,64
v_accvgpr_read_b32 v246, a40
MV 100,v,20,v,68
v_accvgpr_read_b32 v247, a41
MV 104,v,20,v,72
MV 108,v,20,v,76
s_waitcnt vmcnt(17) lgkmcnt(0)
s_barrier
MV 112,v,24,v,64
TR 16,216,32768
TR 18,216,33792
MV 116,v,24,v,68
ds_read_b128 v[48:51], v224 offset:32768
s_add_u32 m0, s68, 114688
MV 120,v,24,v,72
TR 20,217,32768
TR 22,217,33792
MV 124,v,24,v,76
buffer_load_dwordx4 v212, s[48:51], s66 offen offset:0 lds
v_accvgpr_read_b32 v248, a42
MV 128,v,28,v,64
TR 24,218,32768
TR 26,218,33792
MV 132,v,28,v,68
ds_read_b128 v[52:55], v224 offset:34816
buffer_load_dwordx4 v213, s[48:51], s66 offen offset:1024 lds
MV 136,v,28,v,72
buffer_load_dwordx4 v214, s[48:51], s66 offen offset:2048 lds
v_accvgpr_read_b32 v249, a43
MV 140,v,28,v,76
TR 28,219,32768
TR 30,219,33792
MV 144,v,32,v,64
ds_read_b128 v[56:59], v224 offset:36864
v_accvgpr_read_b32 v250, a44
MV 148,v,32,v,68
buffer_load_dwordx4 v215, s[48:51], s66 offen offset:3072 lds
v_accvgpr_read_b32 v251, a45
MV 152,v,32,v,72
v_accvgpr_read_b32 v252, a46
v_accvgpr_read_b32 v253, a47
MV 156,v,32,v,76
TR 32,220,32768
TR 34,220,33792
MV 160,v,36,v,64
ds_read_b128 v[60:63], v224 offset:38912
s_add_u32 s66, s66, 524288
MV 164,v,36,v,68
s_and_b32 s66, s66, 8388607
v_cvt_pk_bf16_f32 v242, v246, v247
MV 168,v,36,v,72
v_cvt_pk_bf16_f32 v243, v248, v249
v_cvt_pk_bf16_f32 v244, v250, v251
MV 172,v,36,v,76
TR 36,221,32768
TR 38,221,33792
MV 176,v,40,v,64
s_add_u32 s75, s64, s74
v_cvt_pk_bf16_f32 v245, v252, v253
MV 180,v,40,v,68
buffer_store_dwordx4 v[242:245], v228, s[16:19], s24 offen offset:1024 sc1
v_accvgpr_read_b32 v234, a48
MV 184,v,40,v,72
s_add_u32 m0, s67, 0
v_accvgpr_read_b32 v235, a49
MV 188,v,40,v,76
TR 40,222,32768
TR 42,222,33792
MV 192,v,44,v,64
buffer_load_dwordx4 v208, s[44:47], s75 offen offset:0 lds
v_accvgpr_read_b32 v236, a50
MV 196,v,44,v,68
v_accvgpr_read_b32 v237, a51
v_accvgpr_read_b32 v238, a52
MV 200,v,44,v,72
MV 204,v,44,v,76
TR 44,223,32768
TR 46,223,33792
s_waitcnt lgkmcnt(4)
MV 80,v,16,v,48
buffer_load_dwordx4 v209, s[44:47], s75 offen offset:1024 lds
v_accvgpr_read_b32 v239, a53
MV 84,v,16,v,52
ds_read_b128 v[64:67], v225 offset:32768
v_accvgpr_read_b32 v240, a54
MV 88,v,16,v,56
buffer_load_dwordx4 v210, s[44:47], s75 offen offset:2048 lds
v_accvgpr_read_b32 v241, a55
MV 92,v,16,v,60
TR 16,216,40960
TR 18,216,41984
MV 96,v,20,v,48
v_cvt_pk_bf16_f32 v230, v234, v235
MV 100,v,20,v,52
buffer_load_dwordx4 v211, s[44:47], s75 offen offset:3072 lds
v_cvt_pk_bf16_f32 v231, v236, v237
MV 104,v,20,v,56
ds_read_b128 v[68:71], v225 offset:34816
MV 108,v,20,v,60
TR 20,217,40960
TR 22,217,41984
MV 112,v,24,v,48
s_add_u32 s75, s65, s74
v_cvt_pk_bf16_f32 v232, v238, v239
MV 116,v,24,v,52
v_cvt_pk_bf16_f32 v233, v240, v241
MV 120,v,24,v,56
buffer_store_dwordx4 v[230:233], v228, s[16:19], s24 offen offset:2048 sc1
MV 124,v,24,v,60
TR 24,218,40960
TR 26,218,41984
MV 128,v,28,v,48
ds_read_b128 v[72:75], v225 offset:36864
s_add_u32 m0, s67, 4096
MV 132,v,28,v,52
v_accvgpr_read_b32 v246, a56
v_accvgpr_read_b32 v247, a57
MV 136,v,28,v,56
buffer_load_dwordx4 v208, s[44:47], s75 offen offset:0 lds
v_accvgpr_read_b32 v248, a58
MV 140,v,28,v,60
TR 28,219,40960
TR 30,219,41984
MV 144,v,32,v,48
buffer_load_dwordx4 v209, s[44:47], s75 offen offset:1024 lds
v_accvgpr_read_b32 v249, a59
MV 148,v,32,v,52
v_accvgpr_read_b32 v250, a60
MV 152,v,32,v,56
ds_read_b128 v[76:79], v225 offset:38912
v_accvgpr_read_b32 v251, a61
MV 156,v,32,v,60
TR 32,220,40960
TR 34,220,41984
MV 160,v,36,v,48
buffer_load_dwordx4 v210, s[44:47], s75 offen offset:2048 lds
v_accvgpr_read_b32 v252, a62
MV 164,v,36,v,52
v_accvgpr_read_b32 v253, a63
MV 168,v,36,v,56
buffer_load_dwordx4 v211, s[44:47], s75 offen offset:3072 lds
v_cvt_pk_bf16_f32 v242, v246, v247
MV 172,v,36,v,60
TR 36,221,40960
TR 38,221,41984
s_waitcnt lgkmcnt(15)
MV 176,v,40,v,48
v_cvt_pk_bf16_f32 v243, v248, v249
MV 180,v,40,v,52
s_add_u32 s74, s74, 128
v_cvt_pk_bf16_f32 v244, v250, v251
MV 184,v,40,v,56
MV 188,v,40,v,60
TR 40,222,40960
TR 42,222,41984
MV 192,v,44,v,48
s_and_b32 s74, s74, 2047
v_cvt_pk_bf16_f32 v245, v252, v253
MV 196,v,44,v,52
buffer_store_dwordx4 v[242:245], v228, s[16:19], s24 offen offset:3072 sc1
MV 200,v,44,v,56
MV 204,v,44,v,60
TR 44,223,40960
TR 46,223,41984
s_waitcnt lgkmcnt(4)
MV 80,v,16,v,64
v_accvgpr_read_b32 v234, a64
MV 84,v,16,v,68
v_accvgpr_read_b32 v235, a65
MV 88,v,16,v,72
v_accvgpr_read_b32 v236, a66
MV 92,v,16,v,76
MV 96,v,20,v,64
v_accvgpr_read_b32 v237, a67
MV 100,v,20,v,68
v_accvgpr_read_b32 v238, a68
MV 104,v,20,v,72
MV 108,v,20,v,76
s_waitcnt vmcnt(16) lgkmcnt(0)
s_barrier
MV 112,v,24,v,64
TR 16,216,0
TR 18,216,1024
MV 116,v,24,v,68
ds_read_b128 v[48:51], v226 offset:0
s_add_u32 m0, s68, 131072
MV 120,v,24,v,72
TR 20,217,0
TR 22,217,1024
MV 124,v,24,v,76
buffer_load_dwordx4 v212, s[48:51], s66 offen offset:0 lds
v_accvgpr_read_b32 v239, a69
MV 128,v,28,v,64
TR 24,218,0
TR 26,218,1024
MV 132,v,28,v,68
ds_read_b128 v[52:55], v226 offset:2048
buffer_load_dwordx4 v213, s[48:51], s66 offen offset:1024 lds
MV 136,v,28,v,72
buffer_load_dwordx4 v214, s[48:51], s66 offen offset:2048 lds
v_accvgpr_read_b32 v240, a70
MV 140,v,28,v,76
TR 28,219,0
TR 30,219,1024
MV 144,v,32,v,64
ds_read_b128 v[56:59], v226 offset:4096
v_accvgpr_read_b32 v241, a71
MV 148,v,32,v,68
buffer_load_dwordx4 v215, s[48:51], s66 offen offset:3072 lds
v_cvt_pk_bf16_f32 v230, v234, v235
MV 152,v,32,v,72
v_cvt_pk_bf16_f32 v231, v236, v237
v_cvt_pk_bf16_f32 v232, v238, v239
MV 156,v,32,v,76
TR 32,220,0
TR 34,220,1024
MV 160,v,36,v,64
ds_read_b128 v[60:63], v226 offset:6144
s_add_u32 s66, s66, 524288
MV 164,v,36,v,68
s_and_b32 s66, s66, 8388607
v_cvt_pk_bf16_f32 v233, v240, v241
MV 168,v,36,v,72
s_add_u32 s24, s24, 4096
buffer_store_dwordx4 v[230:233], v228, s[16:19], s24 offen offset:0 sc1
MV 172,v,36,v,76
TR 36,221,0
TR 38,221,1024
MV 176,v,40,v,64
s_add_u32 s75, s64, s74
v_accvgpr_read_b32 v246, a72
MV 180,v,40,v,68
v_accvgpr_read_b32 v247, a73
v_accvgpr_read_b32 v248, a74
MV 184,v,40,v,72
s_add_u32 m0, s67, 32768
v_accvgpr_read_b32 v249, a75
MV 188,v,40,v,76
TR 40,222,0
TR 42,222,1024
MV 192,v,44,v,64
buffer_load_dwordx4 v208, s[44:47], s75 offen offset:0 lds
v_accvgpr_read_b32 v250, a76
MV 196,v,44,v,68
v_accvgpr_read_b32 v251, a77
v_accvgpr_read_b32 v252, a78
MV 200,v,44,v,72
MV 204,v,44,v,76
TR 44,223,0
TR 46,223,1024
s_waitcnt lgkmcnt(4)
MV 80,v,16,v,48
buffer_load_dwordx4 v209, s[44:47], s75 offen offset:1024 lds
v_accvgpr_read_b32 v253, a79
MV 84,v,16,v,52
ds_read_b128 v[64:67], v227 offset:0
v_cvt_pk_bf16_f32 v242, v246, v247
MV 88,v,16,v,56
buffer_load_dwordx4 v210, s[44:47], s75 offen offset:2048 lds
v_cvt_pk_bf16_f32 v243, v248, v249
MV 92,v,16,v,60
TR 16,216,8192
TR 18,216,9216
MV 96,v,20,v,48
v_cvt_pk_bf16_f32 v244, v250, v251
MV 100,v,20,v,52
buffer_load_dwordx4 v211, s[44:47], s75 offen offset:3072 lds
v_cvt_pk_bf16_f32 v245, v252, v253
MV 104,v,20,v,56
ds_read_b128 v[68:71], v227 offset:2048
buffer_store_dwordx4 v[242:245], v228, s[16:19], s24 offen offset:1024 sc1
MV 108,v,20,v,60
TR 20,217,8192
TR 22,217,9216
MV 112,v,24,v,48
s_add_u32 s75, s65, s74
v_accvgpr_read_b32 v234, a80
MV 116,v,24,v,52
v_accvgpr_read_b32 v235, a81
MV 120,v,24,v,56
v_accvgpr_read_b32 v236, a82
MV 124,v,24,v,60
TR 24,218,8192
TR 26,218,9216
MV 128,v,28,v,48
ds_read_b128 v[72:75], v227 offset:4096
s_add_u32 m0, s67, 36864
MV 132,v,28,v,52
v_accvgpr_read_b32 v237, a83
v_accvgpr_read_b32 v238, a84
MV 136,v,28,v,56
buffer_load_dwordx4 v208, s[44:47], s75 offen offset:0 lds
MV 140,v,28,v,60
TR 28,219,8192
TR 30,219,9216
MV 144,v,32,v,48
buffer_load_dwordx4 v209, s[44:47], s75 offen offset:1024 lds
v_accvgpr_read_b32 v239, a85
MV 148,v,32,v,52
v_accvgpr_read_b32 v240, a86
v_accvgpr_read_b32 v241, a87
MV 152,v,32,v,56
ds_read_b128 v[76:79], v227 offset:6144
MV 156,v,32,v,60
TR 32,220,8192
TR 34,220,9216
MV 160,v,36,v,48
buffer_load_dwordx4 v210, s[44:47], s75 offen offset:2048 lds
v_cvt_pk_bf16_f32 v230, v234, v235
MV 164,v,36,v,52
v_cvt_pk_bf16_f32 v231, v236, v237
v_cvt_pk_bf16_f32 v232, v238, v239
MV 168,v,36,v,56
buffer_load_dwordx4 v211, s[44:47], s75 offen offset:3072 lds
MV 172,v,36,v,60
TR 36,221,8192
TR 38,221,9216
s_waitcnt lgkmcnt(15)
MV 176,v,40,v,48
v_cvt_pk_bf16_f32 v233, v240, v241
buffer_store_dwordx4 v[230:233], v228, s[16:19], s24 offen offset:2048 sc1
MV 180,v,40,v,52
s_add_u32 s74, s74, 128
v_accvgpr_read_b32 v246, a88
MV 184,v,40,v,56
MV 188,v,40,v,60
TR 40,222,8192
TR 42,222,9216
MV 192,v,44,v,48
s_and_b32 s74, s74, 2047
v_accvgpr_read_b32 v247, a89
MV 196,v,44,v,52
v_accvgpr_read_b32 v248, a90
MV 200,v,44,v,56
MV 204,v,44,v,60
TR 44,223,8192
TR 46,223,9216
s_waitcnt lgkmcnt(4)
MV 80,v,16,v,64
v_accvgpr_read_b32 v249, a91
MV 84,v,16,v,68
v_accvgpr_read_b32 v250, a92
MV 88,v,16,v,72
v_accvgpr_read_b32 v251, a93
MV 92,v,16,v,76
MV 96,v,20,v,64
v_accvgpr_read_b32 v252, a94
MV 100,v,20,v,68
v_accvgpr_read_b32 v253, a95
MV 104,v,20,v,72
MV 108,v,20,v,76
s_waitcnt vmcnt(16) lgkmcnt(0)
s_barrier
MV 112,v,24,v,64
TR 16,216,16384
TR 18,216,17408
MV 116,v,24,v,68
ds_read_b128 v[48:51], v224 offset:0
s_add_u32 m0, s68, 98304
MV 120,v,24,v,72
TR 20,217,16384
TR 22,217,17408
MV 124,v,24,v,76
buffer_load_dwordx4 v212, s[48:51], s66 offen offset:0 lds
v_cvt_pk_bf16_f32 v242, v246, v247
MV 128,v,28,v,64
TR 24,218,16384
TR 26,218,17408
MV 132,v,28,v,68
ds_read_b128 v[52:55], v224 offset:2048
buffer_load_dwordx4 v213, s[48:51], s66 offen offset:1024 lds
MV 136,v,28,v,72
buffer_load_dwordx4 v214, s[48:51], s66 offen offset:2048 lds
v_cvt_pk_bf16_f32 v243, v248, v249
MV 140,v,28,v,76
TR 28,219,16384
TR 30,219,17408
MV 144,v,32,v,64
ds_read_b128 v[56:59], v224 offset:4096
v_cvt_pk_bf16_f32 v244, v250, v251
MV 148,v,32,v,68
buffer_load_dwordx4 v215, s[48:51], s66 offen offset:3072 lds
v_cvt_pk_bf16_f32 v245, v252, v253
MV 152,v,32,v,72
buffer_store_dwordx4 v[242:245], v228, s[16:19], s24 offen offset:3072 sc1
v_accvgpr_read_b32 v234, a96
MV 156,v,32,v,76
TR 32,220,16384
TR 34,220,17408
MV 160,v,36,v,64
ds_read_b128 v[60:63], v224 offset:6144
s_add_u32 s66, s66, 524288
MV 164,v,36,v,68
s_and_b32 s66, s66, 8388607
v_accvgpr_read_b32 v235, a97
MV 168,v,36,v,72
v_accvgpr_read_b32 v236, a98
v_accvgpr_read_b32 v237, a99
MV 172,v,36,v,76
TR 36,221,16384
TR 38,221,17408
MV 176,v,40,v,64
s_add_u32 s75, s64, s74
v_accvgpr_read_b32 v238, a100
MV 180,v,40,v,68
v_accvgpr_read_b32 v239, a101
v_accvgpr_read_b32 v240, a102
MV 184,v,40,v,72
s_add_u32 m0, s67, 65536
v_accvgpr_read_b32 v241, a103
MV 188,v,40,v,76
TR 40,222,16384
TR 42,222,17408
MV 192,v,44,v,64
buffer_load_dwordx4 v208, s[44:47], s75 offen offset:0 lds
v_cvt_pk_bf16_f32 v230, v234, v235
MV 196,v,44,v,68
v_cvt_pk_bf16_f32 v231, v236, v237
v_cvt_pk_bf16_f32 v232, v238, v239
MV 200,v,44,v,72
MV 204,v,44,v,76
TR 44,223,16384
TR 46,223,17408
s_waitcnt lgkmcnt(4)
MV 80,v,16,v,48
buffer_load_dwordx4 v209, s[44:47], s75 offen offset:1024 lds
v_cvt_pk_bf16_f32 v233, v240, v241
MV 84,v,16,v,52
ds_read_b128 v[64:67], v225 offset:0
s_add_u32 s24, s24, 4096
MV 88,v,16,v,56
buffer_load_dwordx4 v210, s[44:47], s75 offen offset:2048 lds
buffer_store_dwordx4 v[230:233], v228, s[16:19], s24 offen offset:0 sc1
MV 92,v,16,v,60
TR 16,216,24576
TR 18,216,25600
MV 96,v,20,v,48
v_accvgpr_read_b32 v246, a104
MV 100,v,20,v,52
buffer_load_dwordx4 v211, s[44:47], s75 offen offset:3072 lds
v_accvgpr_read_b32 v247, a105
MV 104,v,20,v,56
ds_read_b128 v[68:71], v225 offset:2048
MV 108,v,20,v,60
TR 20,217,24576
TR 22,217,25600
MV 112,v,24,v,48
s_add_u32 s75, s65, s74
v_accvgpr_read_b32 v248, a106
MV 116,v,24,v,52
v_accvgpr_read_b32 v249, a107
MV 120,v,24,v,56
v_accvgpr_read_b32 v250, a108
MV 124,v,24,v,60
TR 24,218,24576
TR 26,218,25600
MV 128,v,28,v,48
ds_read_b128 v[72:75], v225 offset:4096
s_add_u32 m0, s67, 69632
MV 132,v,28,v,52
v_accvgpr_read_b32 v251, a109
v_accvgpr_read_b32 v252, a110
MV 136,v,28,v,56
buffer_load_dwordx4 v208, s[44:47], s75 offen offset:0 lds
v_accvgpr_read_b32 v253, a111
MV 140,v,28,v,60
TR 28,219,24576
TR 30,219,25600
MV 144,v,32,v,48
buffer_load_dwordx4 v209, s[44:47], s75 offen offset:1024 lds
v_cvt_pk_bf16_f32 v242, v246, v247
MV 148,v,32,v,52
v_cvt_pk_bf16_f32 v243, v248, v249
MV 152,v,32,v,56
ds_read_b128 v[76:79], v225 offset:6144
v_cvt_pk_bf16_f32 v244, v250, v251
MV 156,v,32,v,60
TR 32,220,24576
TR 34,220,25600
MV 160,v,36,v,48
buffer_load_dwordx4 v210, s[44:47], s75 offen offset:2048 lds
v_cvt_pk_bf16_f32 v245, v252, v253
MV 164,v,36,v,52
buffer_store_dwordx4 v[242:245], v228, s[16:19], s24 offen offset:1024 sc1
MV 168,v,36,v,56
buffer_load_dwordx4 v211, s[44:47], s75 offen offset:3072 lds
v_accvgpr_read_b32 v234, a112
MV 172,v,36,v,60
TR 36,221,24576
TR 38,221,25600
s_waitcnt lgkmcnt(15)
MV 176,v,40,v,48
v_accvgpr_read_b32 v235, a113
MV 180,v,40,v,52
s_add_u32 s74, s74, 128
v_accvgpr_read_b32 v236, a114
MV 184,v,40,v,56
MV 188,v,40,v,60
TR 40,222,24576
TR 42,222,25600
MV 192,v,44,v,48
s_and_b32 s74, s74, 2047
v_accvgpr_read_b32 v237, a115
MV 196,v,44,v,52
v_accvgpr_read_b32 v238, a116
MV 200,v,44,v,56
MV 204,v,44,v,60
TR 44,223,24576
TR 46,223,25600
s_waitcnt lgkmcnt(4)
MV 80,v,16,v,64
v_accvgpr_read_b32 v239, a117
MV 84,v,16,v,68
v_accvgpr_read_b32 v240, a118
MV 88,v,16,v,72
v_accvgpr_read_b32 v241, a119
MV 92,v,16,v,76
MV 96,v,20,v,64
v_cvt_pk_bf16_f32 v230, v234, v235
MV 100,v,20,v,68
v_cvt_pk_bf16_f32 v231, v236, v237
MV 104,v,20,v,72
MV 108,v,20,v,76
s_waitcnt vmcnt(16) lgkmcnt(0)
s_barrier
MV 112,v,24,v,64
TR 16,216,32768
TR 18,216,33792
MV 116,v,24,v,68
ds_read_b128 v[48:51], v224 offset:32768
s_add_u32 m0, s68, 114688
MV 120,v,24,v,72
TR 20,217,32768
TR 22,217,33792
MV 124,v,24,v,76
buffer_load_dwordx4 v212, s[48:51], s66 offen offset:0 lds
v_cvt_pk_bf16_f32 v232, v238, v239
MV 128,v,28,v,64
TR 24,218,32768
TR 26,218,33792
MV 132,v,28,v,68
ds_read_b128 v[52:55], v224 offset:34816
buffer_load_dwordx4 v213, s[48:51], s66 offen offset:1024 lds
MV 136,v,28,v,72
buffer_load_dwordx4 v214, s[48:51], s66 offen offset:2048 lds
v_cvt_pk_bf16_f32 v233, v240, v241
MV 140,v,28,v,76
TR 28,219,32768
TR 30,219,33792
MV 144,v,32,v,64
ds_read_b128 v[56:59], v224 offset:36864
buffer_store_dwordx4 v[230:233], v228, s[16:19], s24 offen offset:2048 sc1
MV 148,v,32,v,68
buffer_load_dwordx4 v215, s[48:51], s66 offen offset:3072 lds
v_accvgpr_read_b32 v246, a120
MV 152,v,32,v,72
v_accvgpr_read_b32 v247, a121
v_accvgpr_read_b32 v248, a122
MV 156,v,32,v,76
TR 32,220,32768
TR 34,220,33792
MV 160,v,36,v,64
ds_read_b128 v[60:63], v224 offset:38912
s_add_u32 s66, s66, 524288
MV 164,v,36,v,68
s_and_b32 s66, s66, 8388607
v_accvgpr_read_b32 v249, a123
MV 168,v,36,v,72
v_accvgpr_read_b32 v250, a124
v_accvgpr_read_b32 v251, a125
MV 172,v,36,v,76
TR 36,221,32768
TR 38,221,33792
MV 176,v,40,v,64
s_add_u32 s75, s64, s74
v_accvgpr_read_b32 v252, a126
MV 180,v,40,v,68
v_accvgpr_read_b32 v253, a127
v_cvt_pk_bf16_f32 v242, v246, v247
MV 184,v,40,v,72
s_add_u32 m0, s67, 0
v_cvt_pk_bf16_f32 v243, v248, v249
MV 188,v,40,v,76
TR 40,222,32768
TR 42,222,33792
MV 192,v,44,v,64
buffer_load_dwordx4 v208, s[44:47], s75 offen offset:0 lds
v_cvt_pk_bf16_f32 v244, v250, v251
MV 196,v,44,v,68
v_cvt_pk_bf16_f32 v245, v252, v253
buffer_store_dwordx4 v[242:245], v228, s[16:19], s24 offen offset:3072 sc1
MV 200,v,44,v,72
MV 204,v,44,v,76
TR 44,223,32768
TR 46,223,33792
s_waitcnt lgkmcnt(4)
MV 80,v,16,v,48
buffer_load_dwordx4 v209, s[44:47], s75 offen offset:1024 lds
v_accvgpr_read_b32 v234, a128
MV 84,v,16,v,52
ds_read_b128 v[64:67], v225 offset:32768
v_accvgpr_read_b32 v235, a129
MV 88,v,16,v,56
buffer_load_dwordx4 v210, s[44:47], s75 offen offset:2048 lds
v_accvgpr_read_b32 v236, a130
MV 92,v,16,v,60
TR 16,216,40960
TR 18,216,41984
MV 96,v,20,v,48
v_accvgpr_read_b32 v237, a131
MV 100,v,20,v,52
buffer_load_dwordx4 v211, s[44:47], s75 offen offset:3072 lds
v_accvgpr_read_b32 v238, a132
MV 104,v,20,v,56
ds_read_b128 v[68:71], v225 offset:34816
MV 108,v,20,v,60
TR 20,217,40960
TR 22,217,41984
MV 112,v,24,v,48
s_add_u32 s75, s65, s74
v_accvgpr_read_b32 v239, a133
MV 116,v,24,v,52
v_accvgpr_read_b32 v240, a134
MV 120,v,24,v,56
v_accvgpr_read_b32 v241, a135
MV 124,v,24,v,60
TR 24,218,40960
TR 26,218,41984
MV 128,v,28,v,48
ds_read_b128 v[72:75], v225 offset:36864
s_add_u32 m0, s67, 4096
MV 132,v,28,v,52
v_cvt_pk_bf16_f32 v230, v234, v235
v_cvt_pk_bf16_f32 v231, v236, v237
MV 136,v,28,v,56
buffer_load_dwordx4 v208, s[44:47], s75 offen offset:0 lds
v_cvt_pk_bf16_f32 v232, v238, v239
MV 140,v,28,v,60
TR 28,219,40960
TR 30,219,41984
MV 144,v,32,v,48
buffer_load_dwordx4 v209, s[44:47], s75 offen offset:1024 lds
v_cvt_pk_bf16_f32 v233, v240, v241
MV 148,v,32,v,52
s_add_u32 s24, s24, 4096
MV 152,v,32,v,56
ds_read_b128 v[76:79], v225 offset:38912
buffer_store_dwordx4 v[230:233], v228, s[16:19], s24 offen offset:0 sc1
MV 156,v,32,v,60
TR 32,220,40960
TR 34,220,41984
MV 160,v,36,v,48
buffer_load_dwordx4 v210, s[44:47], s75 offen offset:2048 lds
v_accvgpr_read_b32 v246, a136
MV 164,v,36,v,52
v_accvgpr_read_b32 v247, a137
MV 168,v,36,v,56
buffer_load_dwordx4 v211, s[44:47], s75 offen offset:3072 lds
v_accvgpr_read_b32 v248, a138
MV 172,v,36,v,60
TR 36,221,40960
TR 38,221,41984
s_waitcnt lgkmcnt(15)
MV 176,v,40,v,48
v_accvgpr_read_b32 v249, a139
MV 180,v,40,v,52
s_add_u32 s74, s74, 128
v_accvgpr_read_b32 v250, a140
MV 184,v,40,v,56
MV 188,v,40,v,60
TR 40,222,40960
TR 42,222,41984
MV 192,v,44,v,48
s_and_b32 s74, s74, 2047
v_accvgpr_read_b32 v251, a141
MV 196,v,44,v,52
v_accvgpr_read_b32 v252, a142
MV 200,v,44,v,56
MV 204,v,44,v,60
TR 44,223,40960
TR 46,223,41984
s_waitcnt lgkmcnt(4)
MV 80,v,16,v,64
v_accvgpr_read_b32 v253, a143
MV 84,v,16,v,68
v_cvt_pk_bf16_f32 v242, v246, v247
MV 88,v,16,v,72
v_cvt_pk_bf16_f32 v243, v248, v249
MV 92,v,16,v,76
MV 96,v,20,v,64
v_cvt_pk_bf16_f32 v244, v250, v251
MV 100,v,20,v,68
v_cvt_pk_bf16_f32 v245, v252, v253
MV 104,v,20,v,72
MV 108,v,20,v,76
s_waitcnt vmcnt(15) lgkmcnt(0)
s_barrier
MV 112,v,24,v,64
TR 16,216,0
TR 18,216,1024
MV 116,v,24,v,68
ds_read_b128 v[48:51], v226 offset:0
s_add_u32 m0, s68, 131072
MV 120,v,24,v,72
TR 20,217,0
TR 22,217,1024
MV 124,v,24,v,76
buffer_load_dwordx4 v212, s[48:51], s66 offen offset:0 lds
buffer_store_dwordx4 v[242:245], v228, s[16:19], s24 offen offset:1024 sc1
MV 128,v,28,v,64
TR 24,218,0
TR 26,218,1024
MV 132,v,28,v,68
ds_read_b128 v[52:55], v226 offset:2048
buffer_load_dwordx4 v213, s[48:51], s66 offen offset:1024 lds
MV 136,v,28,v,72
buffer_load_dwordx4 v214, s[48:51], s66 offen offset:2048 lds
v_accvgpr_read_b32 v234, a144
MV 140,v,28,v,76
TR 28,219,0
TR 30,219,1024
MV 144,v,32,v,64
ds_read_b128 v[56:59], v226 offset:4096
v_accvgpr_read_b32 v235, a145
MV 148,v,32,v,68
buffer_load_dwordx4 v215, s[48:51], s66 offen offset:3072 lds
v_accvgpr_read_b32 v236, a146
MV 152,v,32,v,72
v_accvgpr_read_b32 v237, a147
v_accvgpr_read_b32 v238, a148
MV 156,v,32,v,76
TR 32,220,0
TR 34,220,1024
MV 160,v,36,v,64
ds_read_b128 v[60:63], v226 offset:6144
s_add_u32 s66, s66, 524288
MV 164,v,36,v,68
s_and_b32 s66, s66, 8388607
v_accvgpr_read_b32 v239, a149
MV 168,v,36,v,72
v_accvgpr_read_b32 v240, a150
v_accvgpr_read_b32 v241, a151
MV 172,v,36,v,76
TR 36,221,0
TR 38,221,1024
MV 176,v,40,v,64
s_add_u32 s75, s64, s74
v_cvt_pk_bf16_f32 v230, v234, v235
MV 180,v,40,v,68
v_cvt_pk_bf16_f32 v231, v236, v237
v_cvt_pk_bf16_f32 v232, v238, v239
MV 184,v,40,v,72
s_add_u32 m0, s67, 32768
v_cvt_pk_bf16_f32 v233, v240, v241
MV 188,v,40,v,76
TR 40,222,0
TR 42,222,1024
MV 192,v,44,v,64
buffer_load_dwordx4 v208, s[44:47], s75 offen offset:0 lds
buffer_store_dwordx4 v[230:233], v228, s[16:19], s24 offen offset:2048 sc1
MV 196,v,44,v,68
v_accvgpr_read_b32 v246, a152
v_accvgpr_read_b32 v247, a153
MV 200,v,44,v,72
MV 204,v,44,v,76
TR 44,223,0
TR 46,223,1024
s_waitcnt lgkmcnt(4)
MV 80,v,16,v,48
buffer_load_dwordx4 v209, s[44:47], s75 offen offset:1024 lds
v_accvgpr_read_b32 v248, a154
MV 84,v,16,v,52
ds_read_b128 v[64:67], v227 offset:0
v_accvgpr_read_b32 v249, a155
MV 88,v,16,v,56
buffer_load_dwordx4 v210, s[44:47], s75 offen offset:2048 lds
v_accvgpr_read_b32 v250, a156
MV 92,v,16,v,60
TR 16,216,8192
TR 18,216,9216
MV 96,v,20,v,48
v_accvgpr_read_b32 v251, a157
MV 100,v,20,v,52
buffer_load_dwordx4 v211, s[44:47], s75 offen offset:3072 lds
v_accvgpr_read_b32 v252, a158
MV 104,v,20,v,56
ds_read_b128 v[68:71], v227 offset:2048
MV 108,v,20,v,60
TR 20,217,8192
TR 22,217,9216
MV 112,v,24,v,48
s_add_u32 s75, s65, s74
v_accvgpr_read_b32 v253, a159
MV 116,v,24,v,52
v_cvt_pk_bf16_f32 v242, v246, v247
MV 120,v,24,v,56
v_cvt_pk_bf16_f32 v243, v248, v249
MV 124,v,24,v,60
TR 24,218,8192
TR 26,218,9216
MV 128,v,28,v,48
ds_read_b128 v[72:75], v227 offset:4096
s_add_u32 m0, s67, 36864
MV 132,v,28,v,52
v_cvt_pk_bf16_f32 v244, v250, v251
v_cvt_pk_bf16_f32 v245, v252, v253
MV 136,v,28,v,56
buffer_load_dwordx4 v208, s[44:47], s75 offen offset:0 lds
buffer_store_dwordx4 v[242:245], v228, s[16:19], s24 offen offset:3072 sc1
MV 140,v,28,v,60
TR 28,219,8192
TR 30,219,9216
MV 144,v,32,v,48
buffer_load_dwordx4 v209, s[44:47], s75 offen offset:1024 lds
v_accvgpr_read_b32 v234, a160
MV 148,v,32,v,52
v_accvgpr_read_b32 v235, a161
MV 152,v,32,v,56
ds_read_b128 v[76:79], v227 offset:6144
v_accvgpr_read_b32 v236, a162
MV 156,v,32,v,60
TR 32,220,8192
TR 34,220,9216
MV 160,v,36,v,48
buffer_load_dwordx4 v210, s[44:47], s75 offen offset:2048 lds
v_accvgpr_read_b32 v237, a163
MV 164,v,36,v,52
v_accvgpr_read_b32 v238, a164
MV 168,v,36,v,56
buffer_load_dwordx4 v211, s[44:47], s75 offen offset:3072 lds
v_accvgpr_read_b32 v239, a165
MV 172,v,36,v,60
TR 36,221,8192
TR 38,221,9216
s_waitcnt lgkmcnt(15)
MV 176,v,40,v,48
v_accvgpr_read_b32 v240, a166
MV 180,v,40,v,52
s_add_u32 s74, s74, 128
v_accvgpr_read_b32 v241, a167
MV 184,v,40,v,56
MV 188,v,40,v,60
TR 40,222,8192
TR 42,222,9216
MV 192,v,44,v,48
s_and_b32 s74, s74, 2047
v_cvt_pk_bf16_f32 v230, v234, v235
MV 196,v,44,v,52
v_cvt_pk_bf16_f32 v231, v236, v237
MV 200,v,44,v,56
MV 204,v,44,v,60
TR 44,223,8192
TR 46,223,9216
s_waitcnt lgkmcnt(4)
MV 80,v,16,v,64
v_cvt_pk_bf16_f32 v232, v238, v239
MV 84,v,16,v,68
v_cvt_pk_bf16_f32 v233, v240, v241
MV 88,v,16,v,72
s_add_u32 s24, s24, 4096
MV 92,v,16,v,76
MV 96,v,20,v,64
buffer_store_dwordx4 v[230:233], v228, s[16:19], s24 offen offset:0 sc1
MV 100,v,20,v,68
v_accvgpr_read_b32 v246, a168
MV 104,v,20,v,72
v_accvgpr_read_b32 v247, a169
MV 108,v,20,v,76
s_waitcnt vmcnt(16) lgkmcnt(0)
s_barrier
MV 112,v,24,v,64
TR 16,216,16384
TR 18,216,17408
MV 116,v,24,v,68
ds_read_b128 v[48:51], v224 offset:0
s_add_u32 m0, s68, 98304
MV 120,v,24,v,72
TR 20,217,16384
TR 22,217,17408
MV 124,v,24,v,76
buffer_load_dwordx4 v212, s[48:51], s66 offen offset:0 lds
v_accvgpr_read_b32 v248, a170
MV 128,v,28,v,64
TR 24,218,16384
TR 26,218,17408
MV 132,v,28,v,68
ds_read_b128 v[52:55], v224 offset:2048
buffer_load_dwordx4 v213, s[48:51], s66 offen offset:1024 lds
MV 136,v,28,v,72
buffer_load_dwordx4 v214, s[48:51], s66 offen offset:2048 lds
v_accvgpr_read_b32 v249, a171
MV 140,v,28,v,76
TR 28,219,16384
TR 30,219,17408
MV 144,v,32,v,64
ds_read_b128 v[56:59], v224 offset:4096
v_accvgpr_read_b32 v250, a172
MV 148,v,32,v,68
buffer_load_dwordx4 v215, s[48:51], s66 offen offset:3072 lds
v_accvgpr_read_b32 v251, a173
MV 152,v,32,v,72
v_accvgpr_read_b32 v252, a174
v_accvgpr_read_b32 v253, a175
MV 156,v,32,v,76
TR 32,220,16384
TR 34,220,17408
MV 160,v,36,v,64
ds_read_b128 v[60:63], v224 offset:6144
s_add_u32 s66, s66, 524288
MV 164,v,36,v,68
s_and_b32 s66, s66, 8388607
v_cvt_pk_bf16_f32 v242, v246, v247
MV 168,v,36,v,72
v_cvt_pk_bf16_f32 v243, v248, v249
v_cvt_pk_bf16_f32 v244, v250, v251
MV 172,v,36,v,76
TR 36,221,16384
TR 38,221,17408
MV 176,v,40,v,64
s_add_u32 s75, s64, s74
v_cvt_pk_bf16_f32 v245, v252, v253
MV 180,v,40,v,68
buffer_store_dwordx4 v[242:245], v228, s[16:19], s24 offen offset:1024 sc1
v_accvgpr_read_b32 v234, a176
MV 184,v,40,v,72
s_add_u32 m0, s67, 65536
v_accvgpr_read_b32 v235, a177
MV 188,v,40,v,76
TR 40,222,16384
TR 42,222,17408
MV 192,v,44,v,64
buffer_load_dwordx4 v208, s[44:47], s75 offen offset:0 lds
v_accvgpr_read_b32 v236, a178
MV 196,v,44,v,68
v_accvgpr_read_b32 v237, a179
v_accvgpr_read_b32 v238, a180
MV 200,v,44,v,72
MV 204,v,44,v,76
TR 44,223,16384
TR 46,223,17408
s_waitcnt lgkmcnt(4)
MV 80,v,16,v,48
buffer_load_dwordx4 v209, s[44:47], s75 offen offset:1024 lds
v_accvgpr_read_b32 v239, a181
MV 84,v,16,v,52
ds_read_b128 v[64:67], v225 offset:0
v_accvgpr_read_b32 v240, a182
MV 88,v,16,v,56
buffer_load_dwordx4 v210, s[44:47], s75 offen offset:2048 lds
v_accvgpr_read_b32 v241, a183
MV 92,v,16,v,60
TR 16,216,24576
TR 18,216,25600
MV 96,v,20,v,48
v_cvt_pk_bf16_f32 v230, v234, v235
MV 100,v,20,v,52
buffer_load_dwordx4 v211, s[44:47], s75 offen offset:3072 lds
v_cvt_pk_bf16_f32 v231, v236, v237
MV 104,v,20,v,56
ds_read_b128 v[68:71], v225 offset:2048
v_cvt_pk_bf16_f32 v232, v238, v239
MV 108,v,20,v,60
TR 20,217,24576
TR 22,217,25600
MV 112,v,24,v,48
s_add_u32 s75, s65, s74
v_cvt_pk_bf16_f32 v233, v240, v241
MV 116,v,24,v,52
buffer_store_dwordx4 v[230:233], v228, s[16:19], s24 offen offset:2048 sc1
MV 120,v,24,v,56
v_accvgpr_read_b32 v246, a184
MV 124,v,24,v,60
TR 24,218,24576
TR 26,218,25600
MV 128,v,28,v,48
ds_read_b128 v[72:75], v225 offset:4096
s_add_u32 m0, s67, 69632
MV 132,v,28,v,52
v_accvgpr_read_b32 v247, a185
v_accvgpr_read_b32 v248, a186
MV 136,v,28,v,56
buffer_load_dwordx4 v208, s[44:47], s75 offen offset:0 lds
MV 140,v,28,v,60
TR 28,219,24576
TR 30,219,25600
MV 144,v,32,v,48
buffer_load_dwordx4 v209, s[44:47], s75 offen offset:1024 lds
v_accvgpr_read_b32 v249, a187
MV 148,v,32,v,52
v_accvgpr_read_b32 v250, a188
v_accvgpr_read_b32 v251, a189
MV 152,v,32,v,56
ds_read_b128 v[76:79], v225 offset:6144
MV 156,v,32,v,60
TR 32,220,24576
TR 34,220,25600
MV 160,v,36,v,48
buffer_load_dwordx4 v210, s[44:47], s75 offen offset:2048 lds
v_accvgpr_read_b32 v252, a190
MV 164,v,36,v,52
v_accvgpr_read_b32 v253, a191
v_cvt_pk_bf16_f32 v242, v246, v247
MV 168,v,36,v,56
buffer_load_dwordx4 v211, s[44:47], s75 offen offset:3072 lds
MV 172,v,36,v,60
TR 36,221,24576
TR 38,221,25600
s_waitcnt lgkmcnt(15)
MV 176,v,40,v,48
v_cvt_pk_bf16_f32 v243, v248, v249
v_cvt_pk_bf16_f32 v244, v250, v251
MV 180,v,40,v,52
s_add_u32 s74, s74, 128
v_cvt_pk_bf16_f32 v245, v252, v253
MV 184,v,40,v,56
MV 188,v,40,v,60
TR 40,222,24576
TR 42,222,25600
MV 192,v,44,v,48
s_and_b32 s74, s74, 2047
buffer_store_dwordx4 v[242:245], v228, s[16:19], s24 offen offset:3072 sc1
MV 196,v,44,v,52
buffer_load_dword v254, off, s[12:15], 0 sc1
MV 200,v,44,v,56
MV 204,v,44,v,60
TR 44,223,24576
TR 46,223,25600
s_waitcnt lgkmcnt(4)
MV 80,v,16,v,64
v_accvgpr_read_b32 v234, a192
MV 84,v,16,v,68
v_accvgpr_read_b32 v235, a193
MV 88,v,16,v,72
v_accvgpr_read_b32 v236, a194
MV 92,v,16,v,76
MV 96,v,20,v,64
v_accvgpr_read_b32 v237, a195
MV 100,v,20,v,68
v_accvgpr_read_b32 v238, a196
MV 104,v,20,v,72
MV 108,v,20,v,76
s_waitcnt vmcnt(17) lgkmcnt(0)
s_barrier
MV 112,v,24,v,64
TR 16,216,32768
TR 18,216,33792
MV 116,v,24,v,68
ds_read_b128 v[48:51], v224 offset:32768
s_add_u32 m0, s68, 114688
MV 120,v,24,v,72
TR 20,217,32768
TR 22,217,33792
MV 124,v,24,v,76
buffer_load_dwordx4 v212, s[48:51], s66 offen offset:0 lds
v_accvgpr_read_b32 v239, a197
MV 128,v,28,v,64
TR 24,218,32768
TR 26,218,33792
MV 132,v,28,v,68
ds_read_b128 v[52:55], v224 offset:34816
buffer_load_dwordx4 v213, s[48:51], s66 offen offset:1024 lds
MV 136,v,28,v,72
buffer_load_dwordx4 v214, s[48:51], s66 offen offset:2048 lds
v_accvgpr_read_b32 v240, a198
MV 140,v,28,v,76
TR 28,219,32768
TR 30,219,33792
MV 144,v,32,v,64
ds_read_b128 v[56:59], v224 offset:36864
v_accvgpr_read_b32 v241, a199
MV 148,v,32,v,68
buffer_load_dwordx4 v215, s[48:51], s66 offen offset:3072 lds
v_cvt_pk_bf16_f32 v230, v234, v235
MV 152,v,32,v,72
v_cvt_pk_bf16_f32 v231, v236, v237
v_cvt_pk_bf16_f32 v232, v238, v239
MV 156,v,32,v,76
TR 32,220,32768
TR 34,220,33792
MV 160,v,36,v,64
ds_read_b128 v[60:63], v224 offset:38912
s_add_u32 s66, s66, 524288
MV 164,v,36,v,68
s_and_b32 s66, s66, 8388607
v_cvt_pk_bf16_f32 v233, v240, v241
MV 168,v,36,v,72
s_add_u32 s24, s24, 4096
buffer_store_dwordx4 v[230:233], v228, s[16:19], s24 offen offset:0 sc1
MV 172,v,36,v,76
TR 36,221,32768
TR 38,221,33792
MV 176,v,40,v,64
s_add_u32 s75, s64, s74
v_accvgpr_read_b32 v246, a200
MV 180,v,40,v,68
v_accvgpr_read_b32 v247, a201
v_accvgpr_read_b32 v248, a202
MV 184,v,40,v,72
s_add_u32 m0, s67, 0
v_accvgpr_read_b32 v249, a203
MV 188,v,40,v,76
TR 40,222,32768
TR 42,222,33792
MV 192,v,44,v,64
buffer_load_dwordx4 v208, s[44:47], s75 offen offset:0 lds
v_accvgpr_read_b32 v250, a204
MV 196,v,44,v,68
v_accvgpr_read_b32 v251, a205
v_accvgpr_read_b32 v252, a206
MV 200,v,44,v,72
MV 204,v,44,v,76
TR 44,223,32768
TR 46,223,33792
s_waitcnt lgkmcnt(4)
MV 80,v,16,v,48
buffer_load_dwordx4 v209, s[44:47], s75 offen offset:1024 lds
v_accvgpr_read_b32 v253, a207
MV 84,v,16,v,52
ds_read_b128 v[64:67], v225 offset:32768
v_cvt_pk_bf16_f32 v242, v246, v247
MV 88,v,16,v,56
buffer_load_dwordx4 v210, s[44:47], s75 offen offset:2048 lds
v_cvt_pk_bf16_f32 v243, v248, v249
MV 92,v,16,v,60
TR 16,216,40960
TR 18,216,41984
MV 96,v,20,v,48
v_cvt_pk_bf16_f32 v244, v250, v251
MV 100,v,20,v,52
buffer_load_dwordx4 v211, s[44:47], s75 offen offset:3072 lds
v_cvt_pk_bf16_f32 v245, v252, v253
MV 104,v,20,v,56
ds_read_b128 v[68:71], v225 offset:34816
MV 108,v,20,v,60
TR 20,217,40960
TR 22,217,41984
MV 112,v,24,v,48
s_add_u32 s75, s65, s74
buffer_store_dwordx4 v[242:245], v228, s[16:19], s24 offen offset:1024 sc1
MV 116,v,24,v,52
v_accvgpr_read_b32 v234, a208
MV 120,v,24,v,56
v_accvgpr_read_b32 v235, a209
MV 124,v,24,v,60
TR 24,218,40960
TR 26,218,41984
MV 128,v,28,v,48
ds_read_b128 v[72:75], v225 offset:36864
s_add_u32 m0, s67, 4096
MV 132,v,28,v,52
v_accvgpr_read_b32 v236, a210
v_accvgpr_read_b32 v237, a211
MV 136,v,28,v,56
buffer_load_dwordx4 v208, s[44:47], s75 offen offset:0 lds
v_accvgpr_read_b32 v238, a212
MV 140,v,28,v,60
TR 28,219,40960
TR 30,219,41984
MV 144,v,32,v,48
buffer_load_dwordx4 v209, s[44:47], s75 offen offset:1024 lds
v_accvgpr_read_b32 v239, a213
MV 148,v,32,v,52
v_accvgpr_read_b32 v240, a214
MV 152,v,32,v,56
ds_read_b128 v[76:79], v225 offset:38912
v_accvgpr_read_b32 v241, a215
MV 156,v,32,v,60
TR 32,220,40960
TR 34,220,41984
MV 160,v,36,v,48
buffer_load_dwordx4 v210, s[44:47], s75 offen offset:2048 lds
v_cvt_pk_bf16_f32 v230, v234, v235
MV 164,v,36,v,52
v_cvt_pk_bf16_f32 v231, v236, v237
MV 168,v,36,v,56
buffer_load_dwordx4 v211, s[44:47], s75 offen offset:3072 lds
v_cvt_pk_bf16_f32 v232, v238, v239
MV 172,v,36,v,60
TR 36,221,40960
TR 38,221,41984
s_waitcnt lgkmcnt(15)
MV 176,v,40,v,48
v_cvt_pk_bf16_f32 v233, v240, v241
MV 180,v,40,v,52
s_add_u32 s74, s74, 128
buffer_store_dwordx4 v[230:233], v228, s[16:19], s24 offen offset:2048 sc1
MV 184,v,40,v,56
MV 188,v,40,v,60
TR 40,222,40960
TR 42,222,41984
MV 192,v,44,v,48
s_and_b32 s74, s74, 2047
v_accvgpr_read_b32 v246, a216
MV 196,v,44,v,52
v_accvgpr_read_b32 v247, a217
MV 200,v,44,v,56
MV 204,v,44,v,60
TR 44,223,40960
TR 46,223,41984
s_waitcnt lgkmcnt(4)
MV 80,v,16,v,64
v_accvgpr_read_b32 v248, a218
MV 84,v,16,v,68
v_accvgpr_read_b32 v249, a219
MV 88,v,16,v,72
v_accvgpr_read_b32 v250, a220
MV 92,v,16,v,76
MV 96,v,20,v,64
v_accvgpr_read_b32 v251, a221
MV 100,v,20,v,68
v_accvgpr_read_b32 v252, a222
MV 104,v,20,v,72
MV 108,v,20,v,76
s_waitcnt vmcnt(17) lgkmcnt(0)
s_barrier
MV 112,v,24,v,64
TR 16,216,0
TR 18,216,1024
MV 116,v,24,v,68
ds_read_b128 v[48:51], v226 offset:0
s_add_u32 m0, s68, 131072
MV 120,v,24,v,72
TR 20,217,0
TR 22,217,1024
MV 124,v,24,v,76
buffer_load_dwordx4 v212, s[48:51], s66 offen offset:0 lds
v_accvgpr_read_b32 v253, a223
MV 128,v,28,v,64
TR 24,218,0
TR 26,218,1024
MV 132,v,28,v,68
ds_read_b128 v[52:55], v226 offset:2048
buffer_load_dwordx4 v213, s[48:51], s66 offen offset:1024 lds
MV 136,v,28,v,72
buffer_load_dwordx4 v214, s[48:51], s66 offen offset:2048 lds
v_cvt_pk_bf16_f32 v242, v246, v247
MV 140,v,28,v,76
TR 28,219,0
TR 30,219,1024
MV 144,v,32,v,64
ds_read_b128 v[56:59], v226 offset:4096
v_cvt_pk_bf16_f32 v243, v248, v249
MV 148,v,32,v,68
buffer_load_dwordx4 v215, s[48:51], s66 offen offset:3072 lds
v_cvt_pk_bf16_f32 v244, v250, v251
MV 152,v,32,v,72
v_cvt_pk_bf16_f32 v245, v252, v253
buffer_store_dwordx4 v[242:245], v228, s[16:19], s24 offen offset:3072 sc1
MV 156,v,32,v,76
TR 32,220,0
TR 34,220,1024
MV 160,v,36,v,64
ds_read_b128 v[60:63], v226 offset:6144
s_add_u32 s66, s66, 524288
MV 164,v,36,v,68
s_and_b32 s66, s66, 8388607
v_accvgpr_read_b32 v234, a224
MV 168,v,36,v,72
v_accvgpr_read_b32 v235, a225
v_accvgpr_read_b32 v236, a226
MV 172,v,36,v,76
TR 36,221,0
TR 38,221,1024
MV 176,v,40,v,64
s_add_u32 s75, s64, s74
v_accvgpr_read_b32 v237, a227
MV 180,v,40,v,68
v_accvgpr_read_b32 v238, a228
v_accvgpr_read_b32 v239, a229
MV 184,v,40,v,72
s_add_u32 m0, s67, 32768
v_accvgpr_read_b32 v240, a230
MV 188,v,40,v,76
TR 40,222,0
TR 42,222,1024
MV 192,v,44,v,64
buffer_load_dwordx4 v208, s[44:47], s75 offen offset:0 lds
v_accvgpr_read_b32 v241, a231
MV 196,v,44,v,68
v_cvt_pk_bf16_f32 v230, v234, v235
v_cvt_pk_bf16_f32 v231, v236, v237
MV 200,v,44,v,72
MV 204,v,44,v,76
TR 44,223,0
TR 46,223,1024
s_waitcnt lgkmcnt(4)
MV 80,v,16,v,48
buffer_load_dwordx4 v209, s[44:47], s75 offen offset:1024 lds
v_cvt_pk_bf16_f32 v232, v238, v239
MV 84,v,16,v,52
ds_read_b128 v[64:67], v227 offset:0
v_cvt_pk_bf16_f32 v233, v240, v241
MV 88,v,16,v,56
buffer_load_dwordx4 v210, s[44:47], s75 offen offset:2048 lds
s_add_u32 s24, s24, 4096
MV 92,v,16,v,60
TR 16,216,8192
TR 18,216,9216
MV 96,v,20,v,48
buffer_store_dwordx4 v[230:233], v228, s[16:19], s24 offen offset:0 sc1
MV 100,v,20,v,52
buffer_load_dwordx4 v211, s[44:47], s75 offen offset:3072 lds
v_accvgpr_read_b32 v246, a232
MV 104,v,20,v,56
ds_read_b128 v[68:71], v227 offset:2048
MV 108,v,20,v,60
TR 20,217,8192
TR 22,217,9216
MV 112,v,24,v,48
s_add_u32 s75, s65, s74
v_accvgpr_read_b32 v247, a233
MV 116,v,24,v,52
v_accvgpr_read_b32 v248, a234
MV 120,v,24,v,56
v_accvgpr_read_b32 v249, a235
MV 124,v,24,v,60
TR 24,218,8192
TR 26,218,9216
MV 128,v,28,v,48
ds_read_b128 v[72:75], v227 offset:4096
s_add_u32 m0, s67, 36864
MV 132,v,28,v,52
v_accvgpr_read_b32 v250, a236
v_accvgpr_read_b32 v251, a237
MV 136,v,28,v,56
buffer_load_dwordx4 v208, s[44:47], s75 offen offset:0 lds
v_accvgpr_read_b32 v252, a238
MV 140,v,28,v,60
TR 28,219,8192
TR 30,219,9216
MV 144,v,32,v,48
buffer_load_dwordx4 v209, s[44:47], s75 offen offset:1024 lds
v_accvgpr_read_b32 v253, a239
MV 148,v,32,v,52
v_cvt_pk_bf16_f32 v242, v246, v247
MV 152,v,32,v,56
ds_read_b128 v[76:79], v227 offset:6144
v_cvt_pk_bf16_f32 v243, v248, v249
MV 156,v,32,v,60
TR 32,220,8192
TR 34,220,9216
MV 160,v,36,v,48
buffer_load_dwordx4 v210, s[44:47], s75 offen offset:2048 lds
v_cvt_pk_bf16_f32 v244, v250, v251
MV 164,v,36,v,52
v_cvt_pk_bf16_f32 v245, v252, v253
MV 168,v,36,v,56
buffer_load_dwordx4 v211, s[44:47], s75 offen offset:3072 lds
buffer_store_dwordx4 v[242:245], v228, s[16:19], s24 offen offset:1024 sc1
MV 172,v,36,v,60
TR 36,221,8192
TR 38,221,9216
s_waitcnt lgkmcnt(15)
MV 176,v,40,v,48
v_accvgpr_read_b32 v234, a240
MV 180,v,40,v,52
s_add_u32 s74, s74, 128
v_accvgpr_read_b32 v235, a241
MV 184,v,40,v,56
MV 188,v,40,v,60
TR 40,222,8192
TR 42,222,9216
MV 192,v,44,v,48
s_and_b32 s74, s74, 2047
v_accvgpr_read_b32 v236, a242
MV 196,v,44,v,52
v_accvgpr_read_b32 v237, a243
MV 200,v,44,v,56
MV 204,v,44,v,60
TR 44,223,8192
TR 46,223,9216
s_waitcnt lgkmcnt(4)
MV 80,v,16,v,64
v_accvgpr_read_b32 v238, a244
MV 84,v,16,v,68
v_accvgpr_read_b32 v239, a245
MV 88,v,16,v,72
v_accvgpr_read_b32 v240, a246
MV 92,v,16,v,76
MV 96,v,20,v,64
v_accvgpr_read_b32 v241, a247
MV 100,v,20,v,68
v_cvt_pk_bf16_f32 v230, v234, v235
MV 104,v,20,v,72
v_cvt_pk_bf16_f32 v231, v236, v237
MV 108,v,20,v,76
s_waitcnt vmcnt(16) lgkmcnt(0)
s_barrier
MV 112,v,24,v,64
TR 16,216,16384
TR 18,216,17408
MV 116,v,24,v,68
ds_read_b128 v[48:51], v224 offset:0
s_add_u32 m0, s68, 98304
MV 120,v,24,v,72
TR 20,217,16384
TR 22,217,17408
MV 124,v,24,v,76
buffer_load_dwordx4 v212, s[48:51], s66 offen offset:0 lds
v_cvt_pk_bf16_f32 v232, v238, v239
MV 128,v,28,v,64
TR 24,218,16384
TR 26,218,17408
MV 132,v,28,v,68
ds_read_b128 v[52:55], v224 offset:2048
buffer_load_dwordx4 v213, s[48:51], s66 offen offset:1024 lds
MV 136,v,28,v,72
buffer_load_dwordx4 v214, s[48:51], s66 offen offset:2048 lds
v_cvt_pk_bf16_f32 v233, v240, v241
MV 140,v,28,v,76
TR 28,219,16384
TR 30,219,17408
MV 144,v,32,v,64
ds_read_b128 v[56:59], v224 offset:4096
buffer_store_dwordx4 v[230:233], v228, s[16:19], s24 offen offset:2048 sc1
MV 148,v,32,v,68
buffer_load_dwordx4 v215, s[48:51], s66 offen offset:3072 lds
v_accvgpr_read_b32 v246, a248
MV 152,v,32,v,72
v_accvgpr_read_b32 v247, a249
v_accvgpr_read_b32 v248, a250
MV 156,v,32,v,76
TR 32,220,16384
TR 34,220,17408
MV 160,v,36,v,64
ds_read_b128 v[60:63], v224 offset:6144
s_add_u32 s66, s66, 524288
MV 164,v,36,v,68
s_and_b32 s66, s66, 8388607
v_accvgpr_read_b32 v249, a251
MV 168,v,36,v,72
v_accvgpr_read_b32 v250, a252
v_accvgpr_read_b32 v251, a253
MV 172,v,36,v,76
TR 36,221,16384
TR 38,221,17408
MV 176,v,40,v,64
s_add_u32 s75, s64, s74
v_accvgpr_read_b32 v252, a254
MV 180,v,40,v,68
v_accvgpr_read_b32 v253, a255
v_cvt_pk_bf16_f32 v242, v246, v247
MV 184,v,40,v,72
s_add_u32 m0, s67, 65536
v_cvt_pk_bf16_f32 v243, v248, v249
MV 188,v,40,v,76
TR 40,222,16384
TR 42,222,17408
MV 192,v,44,v,64
buffer_load_dwordx4 v208, s[44:47], s75 offen offset:0 lds
v_cvt_pk_bf16_f32 v244, v250, v251
MV 196,v,44,v,68
v_cvt_pk_bf16_f32 v245, v252, v253
buffer_store_dwordx4 v[242:245], v228, s[16:19], s24 offen offset:3072 sc1
MV 200,v,44,v,72
MV 204,v,44,v,76
TR 44,223,16384
TR 46,223,17408
s_waitcnt lgkmcnt(4)
MV 80,v,16,v,48
buffer_load_dwordx4 v209, s[44:47], s75 offen offset:1024 lds
v_lshlrev_b32 v255, 20, v1
MV 84,v,16,v,52
ds_read_b128 v[64:67], v225 offset:0
MV 88,v,16,v,56
buffer_load_dwordx4 v210, s[44:47], s75 offen offset:2048 lds
MV 92,v,16,v,60
TR 16,216,24576
TR 18,216,25600
MV 96,v,20,v,48
MV 100,v,20,v,52
buffer_load_dwordx4 v211, s[44:47], s75 offen offset:3072 lds
MV 104,v,20,v,56
ds_read_b128 v[68:71], v225 offset:2048
MV 108,v,20,v,60
TR 20,217,24576
TR 22,217,25600
MV 112,v,24,v,48
s_add_u32 s75, s65, s74
MV 116,v,24,v,52
MV 120,v,24,v,56
s_lshl_b32 s36, s3, 26
MV 124,v,24,v,60
TR 24,218,24576
TR 26,218,25600
MV 128,v,28,v,48
ds_read_b128 v[72:75], v225 offset:4096
s_add_u32 m0, s67, 69632
MV 132,v,28,v,52
MV 136,v,28,v,56
buffer_load_dwordx4 v208, s[44:47], s75 offen offset:0 lds
MV 140,v,28,v,60
TR 28,219,24576
TR 30,219,25600
MV 144,v,32,v,48
buffer_load_dwordx4 v209, s[44:47], s75 offen offset:1024 lds
MV 148,v,32,v,52
MV 152,v,32,v,56
ds_read_b128 v[76:79], v225 offset:6144
MV 156,v,32,v,60
TR 32,220,24576
TR 34,220,25600
MV 160,v,36,v,48
buffer_load_dwordx4 v210, s[44:47], s75 offen offset:2048 lds
v_add_u32 v255, s36, v255
MV 164,v,36,v,52
MV 168,v,36,v,56
buffer_load_dwordx4 v211, s[44:47], s75 offen offset:3072 lds
MV 172,v,36,v,60
TR 36,221,24576
TR 38,221,25600
s_waitcnt lgkmcnt(15)
MV 176,v,40,v,48
MV 180,v,40,v,52
s_add_u32 s74, s74, 128
MV 184,v,40,v,56
MV 188,v,40,v,60
TR 40,222,24576
TR 42,222,25600
MV 192,v,44,v,48
s_and_b32 s74, s74, 2047
MV 196,v,44,v,52
MV 200,v,44,v,56
MV 204,v,44,v,60
TR 44,223,24576
TR 46,223,25600
s_waitcnt lgkmcnt(4)
MV 80,v,16,v,64
v_lshlrev_b32 v230, 4, v1
MV 84,v,16,v,68
MV 88,v,16,v,72
s_lshl_b32 s80, s3, 12
MV 92,v,16,v,76
MV 96,v,20,v,64
v_add_u32 v12, s80, v230
MV 100,v,20,v,68
MV 104,v,20,v,72
v_add_u32 v10, 0x8000, v230
MV 108,v,20,v,76
s_waitcnt vmcnt(15) lgkmcnt(0)
s_barrier
MV 112,v,24,v,64
TR 16,216,32768
TR 18,216,33792
MV 116,v,24,v,68
ds_read_b128 v[48:51], v224 offset:32768
s_add_u32 m0, s68, 114688
MV 120,v,24,v,72
TR 20,217,32768
TR 22,217,33792
MV 124,v,24,v,76
buffer_load_dwordx4 v212, s[48:51], s66 offen offset:0 lds
v_add_u32 v11, 0x10000, v230
MV 128,v,28,v,64
TR 24,218,32768
TR 26,218,33792
MV 132,v,28,v,68
ds_read_b128 v[52:55], v224 offset:34816
buffer_load_dwordx4 v213, s[48:51], s66 offen offset:1024 lds
MV 136,v,28,v,72
buffer_load_dwordx4 v214, s[48:51], s66 offen offset:2048 lds
s_add_u32 s72, s80, 0x8000
MV 140,v,28,v,76
TR 28,219,32768
TR 30,219,33792
MV 144,v,32,v,64
ds_read_b128 v[56:59], v224 offset:36864
s_add_u32 s73, s80, 0x10000
MV 148,v,32,v,68
buffer_load_dwordx4 v215, s[48:51], s66 offen offset:3072 lds
v_mov_b32 v15, v230
MV 152,v,32,v,72
v_and_b32 v230, 15, v1
v_lshrrev_b32 v232, 4, v1
MV 156,v,32,v,76
TR 32,220,32768
TR 34,220,33792
MV 160,v,36,v,64
ds_read_b128 v[60:63], v224 offset:38912
s_add_u32 s66, s66, 524288
MV 164,v,36,v,68
s_and_b32 s66, s66, 8388607
v_lshlrev_b32 v232, 2, v232
MV 168,v,36,v,72
v_sub_u32 v13, v230, v232
MV 172,v,36,v,76
TR 36,221,32768
TR 38,221,33792
MV 176,v,40,v,64
s_add_u32 s75, s64, s74
s_lshl_b32 s81, s3, 5
MV 180,v,40,v,68
MV 184,v,40,v,72
s_add_u32 m0, s67, 0
v_add_u32 v13, s81, v13
MV 188,v,40,v,76
TR 40,222,32768
TR 42,222,33792
MV 192,v,44,v,64
buffer_load_dwordx4 v208, s[44:47], s75 offen offset:0 lds
v_mov_b32 v14, 0xff800000
MV 196,v,44,v,68
MV 200,v,44,v,72
MV 204,v,44,v,76
TR 44,223,32768
TR 46,223,33792
s_waitcnt lgkmcnt(4)
MV 80,v,16,v,48
buffer_load_dwordx4 v209, s[44:47], s75 offen offset:1024 lds
MV 84,v,16,v,52
ds_read_b128 v[64:67], v225 offset:32768
MV 88,v,16,v,56
buffer_load_dwordx4 v210, s[44:47], s75 offen offset:2048 lds
MV 92,v,16,v,60
TR 16,216,40960
TR 18,216,41984
MV 96,v,20,v,48
MV 100,v,20,v,52
buffer_load_dwordx4 v211, s[44:47], s75 offen offset:3072 lds
MV 104,v,20,v,56
ds_read_b128 v[68:71], v225 offset:34816
MV 108,v,20,v,60
TR 20,217,40960
TR 22,217,41984
MV 112,v,24,v,48
s_add_u32 s75, s65, s74
MV 116,v,24,v,52
MV 120,v,24,v,56
MV 124,v,24,v,60
TR 24,218,40960
TR 26,218,41984
MV 128,v,28,v,48
ds_read_b128 v[72:75], v225 offset:36864
s_add_u32 m0, s67, 4096
MV 132,v,28,v,52
MV 136,v,28,v,56
buffer_load_dwordx4 v208, s[44:47], s75 offen offset:0 lds
MV 140,v,28,v,60
TR 28,219,40960
TR 30,219,41984
MV 144,v,32,v,48
buffer_load_dwordx4 v209, s[44:47], s75 offen offset:1024 lds
MV 148,v,32,v,52
MV 152,v,32,v,56
ds_read_b128 v[76:79], v225 offset:38912
MV 156,v,32,v,60
TR 32,220,40960
TR 34,220,41984
MV 160,v,36,v,48
buffer_load_dwordx4 v210, s[44:47], s75 offen offset:2048 lds
MV 164,v,36,v,52
MV 168,v,36,v,56
buffer_load_dwordx4 v211, s[44:47], s75 offen offset:3072 lds
MV 172,v,36,v,60
TR 36,221,40960
TR 38,221,41984
s_waitcnt lgkmcnt(15)
MV 176,v,40,v,48
MV 180,v,40,v,52
s_add_u32 s74, s74, 128
MV 184,v,40,v,56
MV 188,v,40,v,60
TR 40,222,40960
TR 42,222,41984
MV 192,v,44,v,48
s_and_b32 s74, s74, 2047
MV 196,v,44,v,52
MV 200,v,44,v,56
MV 204,v,44,v,60
TR 44,223,40960
TR 46,223,41984
s_waitcnt lgkmcnt(4)
MV 80,v,16,v,64
MV 84,v,16,v,68
MV 88,v,16,v,72
MV 92,v,16,v,76
MV 96,v,20,v,64
MV 100,v,20,v,68
MV 104,v,20,v,72
MV 108,v,20,v,76
s_waitcnt vmcnt(12) lgkmcnt(0)
s_barrier
MV 112,v,24,v,64
v_cmp_gt_u32 vcc, 1, v254
s_nop 4
s_cbranch_vccnz L_spin_go
L_spin_go_ret:
v_mov_b32 v254, 1
s_lshl_b32 s36, s2, 2
buffer_store_dword v254, v255, s[8:11], s36 offen offset:0 sc1
s_load_dwordx4 s[32:35], s[0:1], 32
MV 116,v,24,v,68
TR 16,216,0
TR 18,216,1024
MV 120,v,24,v,72
TR 20,217,0
TR 22,217,1024
MV 124,v,24,v,76
ds_read_b128 v[48:51], v226 offset:0
s_add_u32 m0, s68, 131072
MV 128,v,28,v,64
TR 24,218,0
TR 26,218,1024
MV 132,v,28,v,68
ds_read_b128 v[52:55], v226 offset:2048
buffer_load_dwordx4 v212, s[48:51], s66 offen offset:0 lds
MV 136,v,28,v,72
buffer_load_dwordx4 v213, s[48:51], s66 offen offset:1024 lds
buffer_load_dwordx4 v214, s[48:51], s66 offen offset:2048 lds
MV 140,v,28,v,76
TR 28,219,0
TR 30,219,1024
MV 144,v,32,v,64
ds_read_b128 v[56:59], v226 offset:4096
MV 148,v,32,v,68
buffer_load_dwordx4 v215, s[48:51], s66 offen offset:3072 lds
MV 152,v,32,v,72
MV 156,v,32,v,76
TR 32,220,0
TR 34,220,1024
MV 160,v,36,v,64
ds_read_b128 v[60:63], v226 offset:6144
s_add_u32 s66, s66, 524288
MV 164,v,36,v,68
s_and_b32 s66, s66, 8388607
MV 168,v,36,v,72
MV 172,v,36,v,76
TR 36,221,0
TR 38,221,1024
MV 176,v,40,v,64
s_add_u32 s75, s64, s74
MV 180,v,40,v,68
MV 184,v,40,v,72
s_add_u32 m0, s67, 32768
MV 188,v,40,v,76
TR 40,222,0
TR 42,222,1024
MV 192,v,44,v,64
buffer_load_dwordx4 v208, s[44:47], s75 offen offset:0 lds
MV 196,v,44,v,68
MV 200,v,44,v,72
MV 204,v,44,v,76
TR 44,223,0
TR 46,223,1024
s_waitcnt lgkmcnt(4)
MV 80,v,16,v,48
buffer_load_dwordx4 v209, s[44:47], s75 offen offset:1024 lds
s_and_b32 s36, s2, 3
MV 84,v,16,v,52
ds_read_b128 v[64:67], v227 offset:0
s_lshl_b32 s36, s36, 1
MV 88,v,16,v,56
buffer_load_dwordx4 v210, s[44:47], s75 offen offset:2048 lds
s_sub_u32 s43, 14, s36
MV 92,v,16,v,60
TR 16,216,8192
TR 18,216,9216
MV 96,v,20,v,48
s_bitcmp1_b32 s2, 4
s_cselect_b32 s36, s43, s36
MV 100,v,20,v,52
buffer_load_dwordx4 v211, s[44:47], s75 offen offset:3072 lds
s_bfe_u32 s43, s2, 0x10003
MV 104,v,20,v,56
ds_read_b128 v[68:71], v227 offset:2048
s_add_u32 s36, s36, s43
MV 108,v,20,v,60
TR 20,217,8192
TR 22,217,9216
MV 112,v,24,v,48
s_add_u32 s75, s65, s74
s_bfe_u32 s37, s2, 0x10002
MV 116,v,24,v,52
s_lshr_b32 s43, s2, 5
s_lshl_b32 s43, s43, 1
MV 120,v,24,v,56
s_add_u32 s37, s37, s43
v_and_b32 v230, 15, v1
MV 124,v,24,v,60
TR 24,218,8192
TR 26,218,9216
MV 128,v,28,v,48
ds_read_b128 v[72:75], v227 offset:4096
s_add_u32 m0, s67, 36864
MV 132,v,28,v,52
s_lshl_b32 s36, s36, 4
v_add_u32 v231, s36, v230
MV 136,v,28,v,56
buffer_load_dwordx4 v208, s[44:47], s75 offen offset:0 lds
s_lshr_b32 s36, s2, 4
MV 140,v,28,v,60
TR 28,219,8192
TR 30,219,9216
MV 144,v,32,v,48
buffer_load_dwordx4 v209, s[44:47], s75 offen offset:1024 lds
v_lshl_add_u32 v232, v230, 4, s36
MV 148,v,32,v,52
v_and_b32 v233, 7, v1
v_bfe_u32 v234, v1, 3, 1
MV 152,v,32,v,56
ds_read_b128 v[76:79], v227 offset:6144
v_lshlrev_b32 v233, 3, v233
MV 156,v,32,v,60
TR 32,220,8192
TR 34,220,9216
MV 160,v,36,v,48
buffer_load_dwordx4 v210, s[44:47], s75 offen offset:2048 lds
v_lshl_add_u32 v233, v234, 7, v233
MV 164,v,36,v,52
s_bfe_u32 s36, s2, 0x10004
s_lshl_b32 s36, s36, 6
MV 168,v,36,v,56
buffer_load_dwordx4 v211, s[44:47], s75 offen offset:3072 lds
s_and_b32 s37, s2, 7
MV 172,v,36,v,60
TR 36,221,8192
TR 38,221,9216
s_waitcnt lgkmcnt(15)
MV 176,v,40,v,48
s_add_u32 s36, s36, s37
v_add_u32 v233, s36, v233
MV 180,v,40,v,52
s_add_u32 s74, s74, 128
v_lshrrev_b32 v234, 4, v1
MV 184,v,40,v,56
v_cmp_eq_u32 vcc, 1, v234
s_nop 1
v_cndmask_b32 v233, v233, v232, vcc
MV 188,v,40,v,60
TR 40,222,8192
TR 42,222,9216
MV 192,v,44,v,48
s_and_b32 s74, s74, 2047
MV 196,v,44,v,52
v_cmp_eq_u32 vcc, 2, v234
s_nop 1
v_cndmask_b32 v233, v233, v231, vcc
MV 200,v,44,v,56
v_lshlrev_b32 v233, 2, v233
MV 204,v,44,v,60
TR 44,223,8192
TR 46,223,9216
s_waitcnt lgkmcnt(4)
MV 80,v,16,v,64
MV 84,v,16,v,68
MV 88,v,16,v,72
MV 92,v,16,v,76
MV 96,v,20,v,64
MV 100,v,20,v,68
MV 104,v,20,v,72
MV 108,v,20,v,76
s_waitcnt vmcnt(13) lgkmcnt(0)
s_barrier
MV 112,v,24,v,64
TR 16,216,16384
TR 18,216,17408
MV 116,v,24,v,68
ds_read_b128 v[48:51], v224 offset:0
s_add_u32 m0, s68, 98304
MV 120,v,24,v,72
TR 20,217,16384
TR 22,217,17408
MV 124,v,24,v,76
buffer_load_dwordx4 v212, s[48:51], s66 offen offset:0 lds
MV 128,v,28,v,64
TR 24,218,16384
TR 26,218,17408
MV 132,v,28,v,68
ds_read_b128 v[52:55], v224 offset:2048
buffer_load_dwordx4 v213, s[48:51], s66 offen offset:1024 lds
MV 136,v,28,v,72
buffer_load_dwordx4 v214, s[48:51], s66 offen offset:2048 lds
MV 140,v,28,v,76
TR 28,219,16384
TR 30,219,17408
MV 144,v,32,v,64
ds_read_b128 v[56:59], v224 offset:4096
MV 148,v,32,v,68
buffer_load_dwordx4 v215, s[48:51], s66 offen offset:3072 lds
MV 152,v,32,v,72
MV 156,v,32,v,76
TR 32,220,16384
TR 34,220,17408
MV 160,v,36,v,64
ds_read_b128 v[60:63], v224 offset:6144
s_add_u32 s66, s66, 524288
MV 164,v,36,v,68
s_and_b32 s66, s66, 8388607
MV 168,v,36,v,72
MV 172,v,36,v,76
TR 36,221,16384
TR 38,221,17408
MV 176,v,40,v,64
s_add_u32 s75, s64, s74
MV 180,v,40,v,68
MV 184,v,40,v,72
s_add_u32 m0, s67, 65536
MV 188,v,40,v,76
TR 40,222,16384
TR 42,222,17408
MV 192,v,44,v,64
buffer_load_dwordx4 v208, s[44:47], s75 offen offset:0 lds
MV 196,v,44,v,68
MV 200,v,44,v,72
MV 204,v,44,v,76
TR 44,223,16384
TR 46,223,17408
s_waitcnt lgkmcnt(4)
MV 80,v,16,v,48
buffer_load_dwordx4 v209, s[44:47], s75 offen offset:1024 lds
s_lshl_b32 s36, s2, 2
MV 84,v,16,v,52
ds_read_b128 v[64:67], v225 offset:0
s_add_u32 s36, s36, s3
MV 88,v,16,v,56
buffer_load_dwordx4 v210, s[44:47], s75 offen offset:2048 lds
s_lshl_b32 s42, s36, 1
MV 92,v,16,v,60
TR 16,216,24576
TR 18,216,25600
MV 96,v,20,v,48
s_lshl_b32 s37, s36, 12
MV 100,v,20,v,52
buffer_load_dwordx4 v211, s[44:47], s75 offen offset:3072 lds
MV 104,v,20,v,56
ds_read_b128 v[68:71], v225 offset:2048
MV 108,v,20,v,60
TR 20,217,24576
TR 22,217,25600
MV 112,v,24,v,48
s_add_u32 s75, s65, s74
MV 116,v,24,v,52
s_add_u32 s16, s32, s37
s_addc_u32 s17, s33, 0
MV 120,v,24,v,56
s_mov_b32 s18, 4096
s_mov_b32 s19, 0x20000
MV 124,v,24,v,60
TR 24,218,24576
TR 26,218,25600
MV 128,v,28,v,48
ds_read_b128 v[72:75], v225 offset:4096
s_add_u32 m0, s67, 69632
MV 132,v,28,v,52
s_add_u32 s37, s37, 50331648
MV 136,v,28,v,56
buffer_load_dwordx4 v208, s[44:47], s75 offen offset:0 lds
MV 140,v,28,v,60
TR 28,219,24576
TR 30,219,25600
MV 144,v,32,v,48
buffer_load_dwordx4 v209, s[44:47], s75 offen offset:1024 lds
MV 148,v,32,v,52
s_add_u32 s20, s40, s37
s_addc_u32 s21, s41, 0
MV 152,v,32,v,56
ds_read_b128 v[76:79], v225 offset:6144
s_mov_b32 s22, 4096
MV 156,v,32,v,60
TR 32,220,24576
TR 34,220,25600
MV 160,v,36,v,48
buffer_load_dwordx4 v210, s[44:47], s75 offen offset:2048 lds
s_mov_b32 s23, 0x20000
MV 164,v,36,v,52
s_lshl_b32 s37, s2, 14
s_add_u32 s37, s37, 54525952
MV 168,v,36,v,56
buffer_load_dwordx4 v211, s[44:47], s75 offen offset:3072 lds
MV 172,v,36,v,60
TR 36,221,24576
TR 38,221,25600
s_waitcnt lgkmcnt(15)
MV 176,v,40,v,48
s_add_u32 s24, s40, s37
s_addc_u32 s25, s41, 0
MV 180,v,40,v,52
s_add_u32 s74, s74, 128
s_mov_b32 s26, 16384
MV 184,v,40,v,56
s_mov_b32 s27, 0x20000
s_mov_b32 s28, s34
MV 188,v,40,v,60
TR 40,222,24576
TR 42,222,25600
MV 192,v,44,v,48
s_and_b32 s74, s74, 2047
s_mov_b32 s29, s35
MV 196,v,44,v,52
s_mov_b32 s30, 2048
s_mov_b32 s31, 0x20000
MV 200,v,44,v,56
s_mul_i32 s43, s3, 4608
s_add_u32 s43, s43, 132096
MV 204,v,44,v,60
TR 44,223,24576
TR 46,223,25600
s_waitcnt lgkmcnt(4)
MV 80,v,16,v,64
v_mov_b32 v229, 0x40000000
MV 84,v,16,v,68
MV 88,v,16,v,72
buffer_load_dwordx4 a[0:3], v229, s[8:11], 0 offen
MV 92,v,16,v,76
MV 96,v,20,v,64
MV 100,v,20,v,68
buffer_load_dwordx4 a[4:7], v229, s[8:11], 0 offen
MV 104,v,20,v,72
MV 108,v,20,v,76
s_waitcnt vmcnt(14) lgkmcnt(0)
s_barrier
MV 112,v,24,v,64
s_load_dwordx2 s[32:33], s[0:1], 88
TR 16,216,32768
MV 116,v,24,v,68
TR 18,216,33792
ds_read_b128 v[48:51], v224 offset:32768
MV 120,v,24,v,72
TR 20,217,32768
TR 22,217,33792
MV 124,v,24,v,76
buffer_load_dwordx4 a[8:11], v229, s[8:11], 0 offen
buffer_load_dwordx4 a[12:15], v229, s[8:11], 0 offen
MV 128,v,28,v,64
TR 24,218,32768
TR 26,218,33792
MV 132,v,28,v,68
ds_read_b128 v[52:55], v224 offset:34816
buffer_load_dwordx4 a[16:19], v229, s[8:11], 0 offen
MV 136,v,28,v,72
MV 140,v,28,v,76
TR 28,219,32768
TR 30,219,33792
MV 144,v,32,v,64
ds_read_b128 v[56:59], v224 offset:36864
buffer_load_dwordx4 a[20:23], v229, s[8:11], 0 offen
MV 148,v,32,v,68
MV 152,v,32,v,72
MV 156,v,32,v,76
TR 32,220,32768
TR 34,220,33792
MV 160,v,36,v,64
ds_read_b128 v[60:63], v224 offset:38912
buffer_load_dwordx4 a[24:27], v229, s[8:11], 0 offen
MV 164,v,36,v,68
buffer_load_dwordx4 a[28:31], v229, s[8:11], 0 offen
MV 168,v,36,v,72
MV 172,v,36,v,76
TR 36,221,32768
TR 38,221,33792
MV 176,v,40,v,64
buffer_load_dwordx4 a[32:35], v229, s[8:11], 0 offen
MV 180,v,40,v,68
MV 184,v,40,v,72
MV 188,v,40,v,76
TR 40,222,32768
TR 42,222,33792
MV 192,v,44,v,64
buffer_load_dwordx4 a[36:39], v229, s[8:11], 0 offen
MV 196,v,44,v,68
MV 200,v,44,v,72
MV 204,v,44,v,76
TR 44,223,32768
TR 46,223,33792
s_waitcnt lgkmcnt(4)
MV 80,v,16,v,48
buffer_load_dwordx4 a[40:43], v229, s[8:11], 0 offen
MV 84,v,16,v,52
ds_read_b128 v[64:67], v225 offset:32768
MV 88,v,16,v,56
buffer_load_dwordx4 a[44:47], v229, s[8:11], 0 offen
MV 92,v,16,v,60
TR 16,216,40960
TR 18,216,41984
MV 96,v,20,v,48
MV 100,v,20,v,52
buffer_load_dwordx4 a[48:51], v229, s[8:11], 0 offen
MV 104,v,20,v,56
ds_read_b128 v[68:71], v225 offset:34816
MV 108,v,20,v,60
TR 20,217,40960
TR 22,217,41984
MV 112,v,24,v,48
buffer_load_dwordx4 a[52:55], v229, s[8:11], 0 offen
MV 116,v,24,v,52
MV 120,v,24,v,56
buffer_load_dwordx4 a[56:59], v229, s[8:11], 0 offen
MV 124,v,24,v,60
TR 24,218,40960
TR 26,218,41984
MV 128,v,28,v,48
ds_read_b128 v[72:75], v225 offset:36864
MV 132,v,28,v,52
buffer_load_dwordx4 a[60:63], v229, s[8:11], 0 offen
MV 136,v,28,v,56
MV 140,v,28,v,60
TR 28,219,40960
TR 30,219,41984
MV 144,v,32,v,48
buffer_load_dwordx4 a[64:67], v229, s[8:11], 0 offen
MV 148,v,32,v,52
MV 152,v,32,v,56
ds_read_b128 v[76:79], v225 offset:38912
MV 156,v,32,v,60
TR 32,220,40960
TR 34,220,41984
MV 160,v,36,v,48
buffer_load_dwordx4 a[68:71], v229, s[8:11], 0 offen
MV 164,v,36,v,52
buffer_load_dwordx4 a[72:75], v229, s[8:11], 0 offen
MV 168,v,36,v,56
MV 172,v,36,v,60
TR 36,221,40960
TR 38,221,41984
s_waitcnt lgkmcnt(15)
MV 176,v,40,v,48
buffer_load_dwordx4 a[76:79], v229, s[8:11], 0 offen
MV 180,v,40,v,52
MV 184,v,40,v,56
MV 188,v,40,v,60
TR 40,222,40960
TR 42,222,41984
MV 192,v,44,v,48
buffer_load_dwordx4 a[80:83], v229, s[8:11], 0 offen
MV 196,v,44,v,52
MV 200,v,44,v,56
MV 204,v,44,v,60
TR 44,223,40960
TR 46,223,41984
s_waitcnt lgkmcnt(4)
MV 80,v,16,v,64
buffer_load_dwordx4 a[84:87], v229, s[8:11], 0 offen
MV 84,v,16,v,68
MV 88,v,16,v,72
buffer_load_dwordx4 a[88:91], v229, s[8:11], 0 offen
MV 92,v,16,v,76
MV 96,v,20,v,64
MV 100,v,20,v,68
buffer_load_dwordx4 a[92:95], v229, s[8:11], 0 offen
MV 104,v,20,v,72
MV 108,v,20,v,76
s_waitcnt vmcnt(24) lgkmcnt(0)
s_barrier
MV 112,v,24,v,64
TR 16,216,0
TR 18,216,1024
MV 116,v,24,v,68
ds_read_b128 v[48:51], v226 offset:0
buffer_load_dwordx4 a[96:99], v229, s[8:11], 0 offen
MV 120,v,24,v,72
TR 20,217,0
TR 22,217,1024
MV 124,v,24,v,76
buffer_load_dwordx4 a[100:103], v229, s[8:11], 0 offen
MV 128,v,28,v,64
TR 24,218,0
TR 26,218,1024
MV 132,v,28,v,68
ds_read_b128 v[52:55], v226 offset:2048
buffer_load_dwordx4 a[104:107], v229, s[8:11], 0 offen
MV 136,v,28,v,72
MV 140,v,28,v,76
TR 28,219,0
TR 30,219,1024
MV 144,v,32,v,64
ds_read_b128 v[56:59], v226 offset:4096
buffer_load_dwordx4 a[108:111], v229, s[8:11], 0 offen
MV 148,v,32,v,68
MV 152,v,32,v,72
MV 156,v,32,v,76
TR 32,220,0
TR 34,220,1024
MV 160,v,36,v,64
ds_read_b128 v[60:63], v226 offset:6144
buffer_load_dwordx4 a[112:115], v229, s[8:11], 0 offen
MV 164,v,36,v,68
buffer_load_dwordx4 a[116:119], v229, s[8:11], 0 offen
MV 168,v,36,v,72
MV 172,v,36,v,76
TR 36,221,0
TR 38,221,1024
MV 176,v,40,v,64
buffer_load_dwordx4 a[120:123], v229, s[8:11], 0 offen
MV 180,v,40,v,68
MV 184,v,40,v,72
MV 188,v,40,v,76
TR 40,222,0
TR 42,222,1024
MV 192,v,44,v,64
buffer_load_dwordx4 a[124:127], v229, s[8:11], 0 offen
MV 196,v,44,v,68
MV 200,v,44,v,72
MV 204,v,44,v,76
TR 44,223,0
TR 46,223,1024
s_waitcnt lgkmcnt(4)
MV 80,v,16,v,48
buffer_load_dword v237, v233, s[8:11], 0 offen offset:0 sc1
MV 84,v,16,v,52
ds_read_b128 v[64:67], v227 offset:0
MV 88,v,16,v,56
s_lshr_b32 s36, s2, 3
MV 92,v,16,v,60
TR 16,216,8192
TR 18,216,9216
MV 96,v,20,v,48
MV 100,v,20,v,52
s_lshl_b32 s36, s36, 18
MV 104,v,20,v,56
ds_read_b128 v[68:71], v227 offset:2048
MV 108,v,20,v,60
TR 20,217,8192
TR 22,217,9216
MV 112,v,24,v,48
s_and_b32 s37, s2, 7
MV 116,v,24,v,52
MV 120,v,24,v,56
s_lshl_b32 s37, s37, 8
MV 124,v,24,v,60
TR 24,218,8192
TR 26,218,9216
MV 128,v,28,v,48
ds_read_b128 v[72:75], v227 offset:4096
s_add_u32 s36, s36, s37
MV 132,v,28,v,52
MV 136,v,28,v,56
MV 140,v,28,v,60
TR 28,219,8192
TR 30,219,9216
MV 144,v,32,v,48
s_lshl_b32 s37, s3, 16
MV 148,v,32,v,52
s_add_u32 s36, s36, s37
MV 152,v,32,v,56
ds_read_b128 v[76:79], v227 offset:6144
MV 156,v,32,v,60
TR 32,220,8192
TR 34,220,9216
MV 160,v,36,v,48
s_add_u32 s32, s32, s36
s_addc_u32 s33, s33, 0
MV 164,v,36,v,52
MV 168,v,36,v,56
MV 172,v,36,v,60
TR 36,221,8192
TR 38,221,9216
s_waitcnt lgkmcnt(15)
MV 176,v,40,v,48
MV 180,v,40,v,52
s_mov_b32 s34, 65536
MV 184,v,40,v,56
MV 188,v,40,v,60
TR 40,222,8192
TR 42,222,9216
MV 192,v,44,v,48
s_mov_b32 s35, 0x20000
MV 196,v,44,v,52
MV 200,v,44,v,56
MV 204,v,44,v,60
TR 44,223,8192
TR 46,223,9216
s_waitcnt lgkmcnt(4)
MV 80,v,16,v,64
MV 84,v,16,v,68
MV 88,v,16,v,72
MV 92,v,16,v,76
MV 96,v,20,v,64
MV 100,v,20,v,68
MV 104,v,20,v,72
MV 108,v,20,v,76
MV 112,v,24,v,64
MV 116,v,24,v,68
MV 120,v,24,v,72
MV 124,v,24,v,76
MV 128,v,28,v,64
MV 132,v,28,v,68
MV 136,v,28,v,72
MV 140,v,28,v,76
MV 144,v,32,v,64
MV 148,v,32,v,68
MV 152,v,32,v,72
MV 156,v,32,v,76
MV 160,v,36,v,64
MV 164,v,36,v,68
MV 168,v,36,v,72
MV 172,v,36,v,76
s_waitcnt lgkmcnt(2)
MV 176,v,40,v,64
MV 180,v,40,v,68
MV 184,v,40,v,72
MV 188,v,40,v,76
s_waitcnt lgkmcnt(0)
MV 192,v,44,v,64
MV 196,v,44,v,68
MV 200,v,44,v,72
MV 204,v,44,v,76
s_waitcnt vmcnt(0)
v_cmp_gt_u32 vcc, 1, v237
s_nop 4
s_cbranch_vccnz L_spin_f1
L_spin_f1_ret:
s_waitcnt lgkmcnt(0)
s_barrier
s_add_u32 m0, s68, 16384
s_mov_b32 s80, 0
buffer_load_dwordx4 v12, s[52:55], s80 offen offset:0 sc1 lds
buffer_load_dwordx4 v12, s[52:55], s80 offen offset:1024 sc1 lds
buffer_load_dwordx4 v12, s[52:55], s80 offen offset:2048 sc1 lds
buffer_load_dwordx4 v12, s[52:55], s80 offen offset:3072 sc1 lds
s_add_u32 m0, s68, 32768
s_mov_b32 s80, 16384
buffer_load_dwordx4 v12, s[52:55], s80 offen offset:0 sc1 lds
buffer_load_dwordx4 v12, s[52:55], s80 offen offset:1024 sc1 lds
buffer_load_dwordx4 v12, s[52:55], s80 offen offset:2048 sc1 lds
buffer_load_dwordx4 v12, s[52:55], s80 offen offset:3072 sc1 lds
s_mov_b32 s82, 0x3e0293ee
s_mov_b32 s83, 0x3e0293ee
v_pk_mul_f32 v[80:81], v[80:81], s[82:83]
v_pk_mul_f32 v[82:83], v[82:83], s[82:83]
v_pk_mul_f32 v[84:85], v[84:85], s[82:83]
v_pk_mul_f32 v[86:87], v[86:87], s[82:83]
v_pk_mul_f32 v[88:89], v[88:89], s[82:83]
s_add_u32 m0, s68, 81920
v_pk_mul_f32 v[90:91], v[90:91], s[82:83]
v_pk_mul_f32 v[92:93], v[92:93], s[82:83]
v_pk_mul_f32 v[94:95], v[94:95], s[82:83]
v_pk_mul_f32 v[96:97], v[96:97], s[82:83]
v_pk_mul_f32 v[98:99], v[98:99], s[82:83]
v_pk_mul_f32 v[100:101], v[100:101], s[82:83]
v_pk_mul_f32 v[102:103], v[102:103], s[82:83]
v_pk_mul_f32 v[104:105], v[104:105], s[82:83]
s_mov_b32 s80, 16384
v_pk_mul_f32 v[106:107], v[106:107], s[82:83]
v_pk_mul_f32 v[108:109], v[108:109], s[82:83]
v_pk_mul_f32 v[110:111], v[110:111], s[82:83]
v_cvt_pk_bf16_f32 v16, v80, v81
v_cvt_pk_bf16_f32 v17, v82, v83
v_cvt_pk_bf16_f32 v18, v96, v97
v_cvt_pk_bf16_f32 v19, v98, v99
buffer_load_dwordx4 v12, s[56:59], s80 offen offset:0 sc1 lds
v_cvt_pk_bf16_f32 v32, v84, v85
v_cvt_pk_bf16_f32 v33, v86, v87
v_cvt_pk_bf16_f32 v34, v100, v101
v_cvt_pk_bf16_f32 v35, v102, v103
v_cvt_pk_bf16_f32 v48, v88, v89
v_cvt_pk_bf16_f32 v49, v90, v91
v_cvt_pk_bf16_f32 v50, v104, v105
v_cvt_pk_bf16_f32 v51, v106, v107
buffer_load_dwordx4 v12, s[56:59], s80 offen offset:1024 sc1 lds
v_cvt_pk_bf16_f32 v64, v92, v93
v_cvt_pk_bf16_f32 v65, v94, v95
v_cvt_pk_bf16_f32 v66, v108, v109
v_cvt_pk_bf16_f32 v67, v110, v111
v_pk_mul_f32 v[112:113], v[112:113], s[82:83]
v_pk_mul_f32 v[114:115], v[114:115], s[82:83]
v_pk_mul_f32 v[116:117], v[116:117], s[82:83]
buffer_load_dwordx4 v12, s[56:59], s80 offen offset:2048 sc1 lds
v_pk_mul_f32 v[118:119], v[118:119], s[82:83]
v_pk_mul_f32 v[120:121], v[120:121], s[82:83]
v_pk_mul_f32 v[122:123], v[122:123], s[82:83]
v_pk_mul_f32 v[124:125], v[124:125], s[82:83]
v_pk_mul_f32 v[126:127], v[126:127], s[82:83]
v_pk_mul_f32 v[128:129], v[128:129], s[82:83]
v_pk_mul_f32 v[130:131], v[130:131], s[82:83]
v_pk_mul_f32 v[132:133], v[132:133], s[82:83]
buffer_load_dwordx4 v12, s[56:59], s80 offen offset:3072 sc1 lds
v_pk_mul_f32 v[134:135], v[134:135], s[82:83]
v_pk_mul_f32 v[136:137], v[136:137], s[82:83]
v_pk_mul_f32 v[138:139], v[138:139], s[82:83]
v_pk_mul_f32 v[140:141], v[140:141], s[82:83]
v_pk_mul_f32 v[142:143], v[142:143], s[82:83]
v_cvt_pk_bf16_f32 v20, v112, v113
v_cvt_pk_bf16_f32 v21, v114, v115
s_add_u32 m0, s68, 49152
v_cvt_pk_bf16_f32 v22, v128, v129
v_cvt_pk_bf16_f32 v23, v130, v131
v_cvt_pk_bf16_f32 v36, v116, v117
v_cvt_pk_bf16_f32 v37, v118, v119
v_cvt_pk_bf16_f32 v38, v132, v133
v_cvt_pk_bf16_f32 v39, v134, v135
v_cvt_pk_bf16_f32 v52, v120, v121
v_cvt_pk_bf16_f32 v53, v122, v123
s_mov_b32 s80, 32768
v_cvt_pk_bf16_f32 v54, v136, v137
v_cvt_pk_bf16_f32 v55, v138, v139
v_cvt_pk_bf16_f32 v68, v124, v125
v_cvt_pk_bf16_f32 v69, v126, v127
v_cvt_pk_bf16_f32 v70, v140, v141
v_cvt_pk_bf16_f32 v71, v142, v143
v_pk_mul_f32 v[144:145], v[144:145], s[82:83]
buffer_load_dwordx4 v12, s[52:55], s80 offen offset:0 sc1 lds
v_pk_mul_f32 v[146:147], v[146:147], s[82:83]
v_pk_mul_f32 v[148:149], v[148:149], s[82:83]
v_pk_mul_f32 v[150:151], v[150:151], s[82:83]
v_pk_mul_f32 v[152:153], v[152:153], s[82:83]
v_pk_mul_f32 v[154:155], v[154:155], s[82:83]
v_pk_mul_f32 v[156:157], v[156:157], s[82:83]
v_pk_mul_f32 v[158:159], v[158:159], s[82:83]
v_pk_mul_f32 v[160:161], v[160:161], s[82:83]
buffer_load_dwordx4 v12, s[52:55], s80 offen offset:1024 sc1 lds
v_pk_mul_f32 v[162:163], v[162:163], s[82:83]
v_pk_mul_f32 v[164:165], v[164:165], s[82:83]
v_pk_mul_f32 v[166:167], v[166:167], s[82:83]
v_pk_mul_f32 v[168:169], v[168:169], s[82:83]
v_pk_mul_f32 v[170:171], v[170:171], s[82:83]
v_pk_mul_f32 v[172:173], v[172:173], s[82:83]
v_pk_mul_f32 v[174:175], v[174:175], s[82:83]
buffer_load_dwordx4 v12, s[52:55], s80 offen offset:2048 sc1 lds
v_cvt_pk_bf16_f32 v24, v144, v145
v_cvt_pk_bf16_f32 v25, v146, v147
v_cvt_pk_bf16_f32 v26, v160, v161
v_cvt_pk_bf16_f32 v27, v162, v163
v_cvt_pk_bf16_f32 v40, v148, v149
v_cvt_pk_bf16_f32 v41, v150, v151
v_cvt_pk_bf16_f32 v42, v164, v165
v_cvt_pk_bf16_f32 v43, v166, v167
buffer_load_dwordx4 v12, s[52:55], s80 offen offset:3072 sc1 lds
v_cvt_pk_bf16_f32 v56, v152, v153
v_cvt_pk_bf16_f32 v57, v154, v155
v_cvt_pk_bf16_f32 v58, v168, v169
v_cvt_pk_bf16_f32 v59, v170, v171
v_cvt_pk_bf16_f32 v72, v156, v157
v_cvt_pk_bf16_f32 v73, v158, v159
v_cvt_pk_bf16_f32 v74, v172, v173
s_add_u32 m0, s68, 98304
v_cvt_pk_bf16_f32 v75, v174, v175
v_pk_mul_f32 v[176:177], v[176:177], s[82:83]
v_pk_mul_f32 v[178:179], v[178:179], s[82:83]
v_pk_mul_f32 v[180:181], v[180:181], s[82:83]
v_pk_mul_f32 v[182:183], v[182:183], s[82:83]
v_pk_mul_f32 v[184:185], v[184:185], s[82:83]
v_pk_mul_f32 v[186:187], v[186:187], s[82:83]
v_pk_mul_f32 v[188:189], v[188:189], s[82:83]
s_mov_b32 s80, 32768
v_pk_mul_f32 v[190:191], v[190:191], s[82:83]
v_pk_mul_f32 v[192:193], v[192:193], s[82:83]
v_pk_mul_f32 v[194:195], v[194:195], s[82:83]
v_pk_mul_f32 v[196:197], v[196:197], s[82:83]
v_pk_mul_f32 v[198:199], v[198:199], s[82:83]
v_pk_mul_f32 v[200:201], v[200:201], s[82:83]
v_pk_mul_f32 v[202:203], v[202:203], s[82:83]
buffer_load_dwordx4 v12, s[56:59], s80 offen offset:0 sc1 lds
v_pk_mul_f32 v[204:205], v[204:205], s[82:83]
v_pk_mul_f32 v[206:207], v[206:207], s[82:83]
v_cvt_pk_bf16_f32 v28, v176, v177
v_cvt_pk_bf16_f32 v29, v178, v179
v_cvt_pk_bf16_f32 v30, v192, v193
v_cvt_pk_bf16_f32 v31, v194, v195
v_cvt_pk_bf16_f32 v44, v180, v181
v_cvt_pk_bf16_f32 v45, v182, v183
buffer_load_dwordx4 v12, s[56:59], s80 offen offset:1024 sc1 lds
v_cvt_pk_bf16_f32 v46, v196, v197
v_cvt_pk_bf16_f32 v47, v198, v199
v_cvt_pk_bf16_f32 v60, v184, v185
v_cvt_pk_bf16_f32 v61, v186, v187
v_cvt_pk_bf16_f32 v62, v200, v201
v_cvt_pk_bf16_f32 v63, v202, v203
v_cvt_pk_bf16_f32 v76, v188, v189
buffer_load_dwordx4 v12, s[56:59], s80 offen offset:2048 sc1 lds
v_cvt_pk_bf16_f32 v77, v190, v191
v_cvt_pk_bf16_f32 v78, v204, v205
v_cvt_pk_bf16_f32 v79, v206, v207
v_mov_b32 v2, 0
v_mov_b32 v3, 0
v_mov_b32 v4, 0
v_mov_b32 v5, 0
v_xor_b32 v244, 0x8000, v10
buffer_load_dwordx4 v12, s[56:59], s80 offen offset:3072 sc1 lds
s_waitcnt vmcnt(16)
s_barrier
ds_read_b128 a[128:131], v244 offset:16384
ds_read_b128 a[132:135], v244 offset:17408
ds_read_b128 a[136:139], v244 offset:18432
ds_read_b128 a[140:143], v244 offset:19456
ds_read_b128 a[144:147], v244 offset:20480
ds_read_b128 a[148:151], v244 offset:21504
ds_read_b128 a[152:155], v244 offset:22528
ds_read_b128 a[156:159], v244 offset:23552
ds_read_b128 a[160:163], v244 offset:24576
ds_read_b128 a[164:167], v244 offset:25600
ds_read_b128 a[168:171], v244 offset:26624
ds_read_b128 a[172:175], v244 offset:27648
ds_read_b128 a[176:179], v244 offset:28672
ds_read_b128 a[180:183], v244 offset:29696
ds_read_b128 a[184:187], v244 offset:30720
ds_read_b128 a[188:191], v244 offset:31744
s_waitcnt lgkmcnt(15)
v_mfma_f32_16x16x32_bf16 v[80:83], a[128:131], v[16:19], 0
s_add_u32 m0, s68, 0
v_mfma_f32_16x16x32_bf16 v[88:91], a[128:131], v[32:35], 0
s_mov_b32 s80, 49152
v_mfma_f32_16x16x32_bf16 v[96:99], a[128:131], v[48:51], 0
v_mfma_f32_16x16x32_bf16 v[104:107], a[128:131], v[64:67], 0
buffer_load_dwordx4 v12, s[52:55], s80 offen offset:0 sc1 lds
s_waitcnt lgkmcnt(14)
MV 80,a,132,v,20
MV 88,a,132,v,36
buffer_load_dwordx4 v12, s[52:55], s80 offen offset:1024 sc1 lds
MV 96,a,132,v,52
MV 104,a,132,v,68
buffer_load_dwordx4 v12, s[52:55], s80 offen offset:2048 sc1 lds
s_waitcnt lgkmcnt(13)
MV 80,a,136,v,24
MV 88,a,136,v,40
buffer_load_dwordx4 v12, s[52:55], s80 offen offset:3072 sc1 lds
MV 96,a,136,v,56
MV 104,a,136,v,72
s_add_u32 m0, s68, 114688
s_waitcnt lgkmcnt(12)
MV 80,a,140,v,28
s_mov_b32 s80, 49152
MV 88,a,140,v,44
MV 96,a,140,v,60
buffer_load_dwordx4 v12, s[56:59], s80 offen offset:0 sc1 lds
MV 104,a,140,v,76
s_waitcnt lgkmcnt(11)
v_mfma_f32_16x16x32_bf16 v[84:87], a[144:147], v[16:19], 0
buffer_load_dwordx4 v12, s[56:59], s80 offen offset:1024 sc1 lds
v_mfma_f32_16x16x32_bf16 v[92:95], a[144:147], v[32:35], 0
v_mfma_f32_16x16x32_bf16 v[100:103], a[144:147], v[48:51], 0
buffer_load_dwordx4 v12, s[56:59], s80 offen offset:2048 sc1 lds
v_mfma_f32_16x16x32_bf16 v[108:111], a[144:147], v[64:67], 0
s_waitcnt lgkmcnt(10)
MV 84,a,148,v,20
buffer_load_dwordx4 v12, s[56:59], s80 offen offset:3072 sc1 lds
MV 92,a,148,v,36
MV 100,a,148,v,52
MV 108,a,148,v,68
s_waitcnt lgkmcnt(9)
MV 84,a,152,v,24
s_waitcnt vmcnt(16) lgkmcnt(0)
s_barrier
MV 92,a,152,v,40
ds_read_b128 a[128:131], v10 offset:0
s_add_u32 m0, s68, 16384
MV 100,a,152,v,56
ds_read_b128 a[132:135], v10 offset:1024
s_mov_b32 s80, 65536
MV 108,a,152,v,72
ds_read_b128 a[136:139], v10 offset:2048
buffer_load_dwordx4 v12, s[52:55], s80 offen offset:0 sc1 lds
MV 84,a,156,v,28
ds_read_b128 a[140:143], v10 offset:3072
buffer_load_dwordx4 v12, s[52:55], s80 offen offset:1024 sc1 lds
MV 92,a,156,v,44
ds_read_b128 a[144:147], v10 offset:4096
buffer_load_dwordx4 v12, s[52:55], s80 offen offset:2048 sc1 lds
MV 100,a,156,v,60
ds_read_b128 a[148:151], v10 offset:5120
buffer_load_dwordx4 v12, s[52:55], s80 offen offset:3072 sc1 lds
MV 108,a,156,v,76
ds_read_b128 a[152:155], v10 offset:6144
s_mov_b32 s71, 65536
v_mfma_f32_16x16x32_bf16 v[112:115], a[160:163], v[16:19], 0
ds_read_b128 a[156:159], v10 offset:7168
v_mfma_f32_16x16x32_bf16 v[120:123], a[160:163], v[32:35], 0
v_lshrrev_b32 v245, 4, v1
v_mfma_f32_16x16x32_bf16 v[128:131], a[160:163], v[48:51], 0
v_and_b32 v246, 15, v1
v_mfma_f32_16x16x32_bf16 v[136:139], a[160:163], v[64:67], 0
ds_read_b128 a[160:163], v10 offset:8192
v_lshlrev_b32 v247, 1, v245
MV 112,a,164,v,20
v_xor_b32 v246, v246, v247
MV 120,a,164,v,36
v_lshlrev_b32 v245, 11, v245
MV 128,a,164,v,52
v_lshl_add_u32 v245, v246, 4, v245
MV 136,a,164,v,68
ds_read_b128 a[164:167], v10 offset:9216
v_xor_b32 v246, 128, v245
MV 112,a,168,v,24
MV 120,a,168,v,40
s_lshl_b32 s36, s3, 13
MV 128,a,168,v,56
s_add_u32 m0, s36, 131072
MV 136,a,168,v,72
ds_read_b128 a[168:171], v10 offset:10240
s_mov_b32 s37, 0
MV 112,a,172,v,28
buffer_load_dwordx4 v245, s[32:35], s37 offen offset:0 lds
MV 120,a,172,v,44
s_mov_b32 s37, 7168
MV 128,a,172,v,60
buffer_load_dwordx4 v246, s[32:35], s37 offen offset:1024 lds
MV 136,a,172,v,76
ds_read_b128 a[172:175], v10 offset:11264
v_mfma_f32_16x16x32_bf16 v[116:119], a[176:179], v[16:19], 0
s_mov_b32 s37, 14336
v_mfma_f32_16x16x32_bf16 v[124:127], a[176:179], v[32:35], 0
buffer_load_dwordx4 v245, s[32:35], s37 offen offset:2048 lds
v_mfma_f32_16x16x32_bf16 v[132:135], a[176:179], v[48:51], 0
s_mov_b32 s37, 21504
v_mfma_f32_16x16x32_bf16 v[140:143], a[176:179], v[64:67], 0
ds_read_b128 a[176:179], v10 offset:12288
buffer_load_dwordx4 v246, s[32:35], s37 offen offset:3072 lds
MV 116,a,180,v,20
s_add_u32 m0, s36, 135168
MV 124,a,180,v,36
s_mov_b32 s37, 32768
MV 132,a,180,v,52
buffer_load_dwordx4 v245, s[32:35], s37 offen offset:0 lds
MV 140,a,180,v,68
ds_read_b128 a[180:183], v10 offset:13312
MV 116,a,184,v,24
s_mov_b32 s37, 39936
MV 124,a,184,v,40
buffer_load_dwordx4 v246, s[32:35], s37 offen offset:1024 lds
MV 132,a,184,v,56
s_mov_b32 s37, 47104
MV 140,a,184,v,72
ds_read_b128 a[184:187], v10 offset:14336
buffer_load_dwordx4 v245, s[32:35], s37 offen offset:2048 lds
MV 116,a,188,v,28
s_mov_b32 s37, 54272
MV 124,a,188,v,44
buffer_load_dwordx4 v246, s[32:35], s37 offen offset:3072 lds
MV 132,a,188,v,60
MV 140,a,188,v,76
ds_read_b128 a[188:191], v10 offset:15360
s_cmp_eq_u32 s70, 0
s_cbranch_scc1 L_p3_pmask
L_p3_pmask_ret:
v_exp_f32 v80, v80
v_exp_f32 v81, v81
v_exp_f32 v82, v82
v_add_f32 v2, v2, v80
v_add_f32 v2, v2, v81
v_exp_f32 v83, v83
v_cvt_pk_bf16_f32 v80, v80, v81
v_exp_f32 v84, v84
v_add_f32 v2, v2, v82
v_add_f32 v2, v2, v83
v_exp_f32 v85, v85
v_cvt_pk_bf16_f32 v81, v82, v83
v_exp_f32 v86, v86
v_add_f32 v2, v2, v84
v_add_f32 v2, v2, v85
v_exp_f32 v87, v87
v_cvt_pk_bf16_f32 v82, v84, v85
v_exp_f32 v88, v88
v_add_f32 v2, v2, v86
v_add_f32 v2, v2, v87
v_exp_f32 v89, v89
v_cvt_pk_bf16_f32 v83, v86, v87
v_exp_f32 v90, v90
v_add_f32 v3, v3, v88
v_add_f32 v3, v3, v89
v_exp_f32 v91, v91
v_cvt_pk_bf16_f32 v88, v88, v89
v_exp_f32 v92, v92
v_add_f32 v3, v3, v90
v_add_f32 v3, v3, v91
v_exp_f32 v93, v93
v_cvt_pk_bf16_f32 v89, v90, v91
v_exp_f32 v94, v94
v_add_f32 v3, v3, v92
v_add_f32 v3, v3, v93
v_exp_f32 v95, v95
v_cvt_pk_bf16_f32 v90, v92, v93
v_exp_f32 v96, v96
v_add_f32 v3, v3, v94
v_add_f32 v3, v3, v95
v_exp_f32 v97, v97
v_cvt_pk_bf16_f32 v91, v94, v95
v_exp_f32 v98, v98
v_add_f32 v4, v4, v96
v_add_f32 v4, v4, v97
v_exp_f32 v99, v99
v_cvt_pk_bf16_f32 v96, v96, v97
v_exp_f32 v100, v100
v_add_f32 v4, v4, v98
v_add_f32 v4, v4, v99
v_exp_f32 v101, v101
v_cvt_pk_bf16_f32 v97, v98, v99
v_exp_f32 v102, v102
v_add_f32 v4, v4, v100
v_add_f32 v4, v4, v101
v_exp_f32 v103, v103
v_cvt_pk_bf16_f32 v98, v100, v101
v_exp_f32 v104, v104
v_add_f32 v4, v4, v102
v_add_f32 v4, v4, v103
v_exp_f32 v105, v105
v_cvt_pk_bf16_f32 v99, v102, v103
v_exp_f32 v106, v106
v_add_f32 v5, v5, v104
v_add_f32 v5, v5, v105
v_exp_f32 v107, v107
v_cvt_pk_bf16_f32 v104, v104, v105
v_exp_f32 v108, v108
v_add_f32 v5, v5, v106
v_add_f32 v5, v5, v107
v_exp_f32 v109, v109
v_cvt_pk_bf16_f32 v105, v106, v107
v_exp_f32 v110, v110
v_add_f32 v5, v5, v108
v_add_f32 v5, v5, v109
v_exp_f32 v111, v111
v_cvt_pk_bf16_f32 v106, v108, v109
v_add_f32 v5, v5, v110
v_add_f32 v5, v5, v111
v_cvt_pk_bf16_f32 v107, v110, v111
s_sub_u32 s74, s70, 1
s_cbranch_scc1 L_p3_d0m_top
.p2align 5
L_p3_d0_top:
s_waitcnt lgkmcnt(0)
v_mfma_f32_16x16x32_bf16 v[144:147], a[128:131], v[16:19], 0
s_add_u32 m0, s73, 0
ds_read_b128 a[192:195], v11 offset:16384
v_mfma_f32_16x16x32_bf16 v[152:155], a[128:131], v[32:35], 0
v_exp_f32 v112, v112
v_mfma_f32_16x16x32_bf16 v[160:163], a[128:131], v[48:51], 0
ds_read_b128 a[196:199], v11 offset:17408
buffer_load_dwordx4 v12, s[56:59], s71 offen offset:0 sc1 lds
v_mfma_f32_16x16x32_bf16 v[168:171], a[128:131], v[64:67], 0
v_exp_f32 v113, v113
MV 144,a,132,v,20
v_exp_f32 v114, v114
MV 152,a,132,v,36
v_add_f32 v2, v2, v112
v_add_f32 v2, v2, v113
MV 160,a,132,v,52
v_exp_f32 v115, v115
MV 168,a,132,v,68
ds_read_b128 a[200:203], v11 offset:18432
v_cvt_pk_bf16_f32 v112, v112, v113
MV 144,a,136,v,24
v_exp_f32 v116, v116
MV 152,a,136,v,40
v_add_f32 v2, v2, v114
v_add_f32 v2, v2, v115
MV 160,a,136,v,56
v_exp_f32 v117, v117
MV 168,a,136,v,72
ds_read_b128 a[204:207], v11 offset:19456
v_cvt_pk_bf16_f32 v113, v114, v115
MV 144,a,140,v,28
v_exp_f32 v118, v118
MV 152,a,140,v,44
ds_read_b128 a[208:211], v11 offset:20480
v_add_f32 v2, v2, v116
MV 160,a,140,v,60
buffer_load_dwordx4 v12, s[56:59], s71 offen offset:1024 sc1 lds
v_add_f32 v2, v2, v117
MV 168,a,140,v,76
v_exp_f32 v119, v119
v_mfma_f32_16x16x32_bf16 v[148:151], a[144:147], v[16:19], 0
ds_read_b128 a[212:215], v11 offset:21504
v_cvt_pk_bf16_f32 v114, v116, v117
v_mfma_f32_16x16x32_bf16 v[156:159], a[144:147], v[32:35], 0
v_exp_f32 v120, v120
v_mfma_f32_16x16x32_bf16 v[164:167], a[144:147], v[48:51], 0
v_add_f32 v2, v2, v118
v_add_f32 v2, v2, v119
v_mfma_f32_16x16x32_bf16 v[172:175], a[144:147], v[64:67], 0
v_exp_f32 v121, v121
MV 148,a,148,v,20
ds_read_b128 a[216:219], v11 offset:22528
v_cvt_pk_bf16_f32 v115, v118, v119
MV 156,a,148,v,36
v_exp_f32 v122, v122
MV 164,a,148,v,52
v_add_f32 v3, v3, v120
v_add_f32 v3, v3, v121
MV 172,a,148,v,68
v_exp_f32 v123, v123
MV 148,a,152,v,24
ds_read_b128 a[220:223], v11 offset:23552
v_cvt_pk_bf16_f32 v120, v120, v121
MV 156,a,152,v,40
v_exp_f32 v124, v124
MV 164,a,152,v,56
ds_read_b128 a[224:227], v11 offset:24576
v_add_f32 v3, v3, v122
MV 172,a,152,v,72
buffer_load_dwordx4 v12, s[56:59], s71 offen offset:2048 sc1 lds
v_add_f32 v3, v3, v123
MV 148,a,156,v,28
v_exp_f32 v125, v125
MV 156,a,156,v,44
ds_read_b128 a[228:231], v11 offset:25600
v_cvt_pk_bf16_f32 v121, v122, v123
MV 164,a,156,v,60
v_exp_f32 v126, v126
MV 172,a,156,v,76
v_add_f32 v3, v3, v124
v_add_f32 v3, v3, v125
v_mfma_f32_16x16x32_bf16 v[176:179], a[160:163], v[16:19], 0
v_exp_f32 v127, v127
v_mfma_f32_16x16x32_bf16 v[184:187], a[160:163], v[32:35], 0
ds_read_b128 a[232:235], v11 offset:26624
v_cvt_pk_bf16_f32 v122, v124, v125
v_mfma_f32_16x16x32_bf16 v[192:195], a[160:163], v[48:51], 0
v_exp_f32 v128, v128
v_mfma_f32_16x16x32_bf16 v[200:203], a[160:163], v[64:67], 0
v_add_f32 v3, v3, v126
v_add_f32 v3, v3, v127
MV 176,a,164,v,20
v_exp_f32 v129, v129
MV 184,a,164,v,36
ds_read_b128 a[236:239], v11 offset:27648
v_cvt_pk_bf16_f32 v123, v126, v127
MV 192,a,164,v,52
v_exp_f32 v130, v130
MV 200,a,164,v,68
ds_read_b128 a[240:243], v11 offset:28672
v_add_f32 v4, v4, v128
MV 176,a,168,v,24
buffer_load_dwordx4 v12, s[56:59], s71 offen offset:3072 sc1 lds
v_add_f32 v4, v4, v129
MV 184,a,168,v,40
v_exp_f32 v131, v131
MV 192,a,168,v,56
ds_read_b128 a[244:247], v11 offset:29696
v_cvt_pk_bf16_f32 v128, v128, v129
MV 200,a,168,v,72
v_exp_f32 v132, v132
MV 176,a,172,v,28
v_add_f32 v4, v4, v130
v_add_f32 v4, v4, v131
MV 184,a,172,v,44
v_exp_f32 v133, v133
MV 192,a,172,v,60
ds_read_b128 a[248:251], v11 offset:30720
v_cvt_pk_bf16_f32 v129, v130, v131
MV 200,a,172,v,76
v_exp_f32 v134, v134
v_mfma_f32_16x16x32_bf16 v[180:183], a[176:179], v[16:19], 0
v_add_f32 v4, v4, v132
v_add_f32 v4, v4, v133
v_mfma_f32_16x16x32_bf16 v[188:191], a[176:179], v[32:35], 0
v_exp_f32 v135, v135
v_mfma_f32_16x16x32_bf16 v[196:199], a[176:179], v[48:51], 0
ds_read_b128 a[252:255], v11 offset:31744
v_cvt_pk_bf16_f32 v130, v132, v133
v_mfma_f32_16x16x32_bf16 v[204:207], a[176:179], v[64:67], 0
v_exp_f32 v136, v136
MV 180,a,180,v,20
v_add_f32 v4, v4, v134
v_add_f32 v4, v4, v135
MV 188,a,180,v,36
v_exp_f32 v137, v137
MV 196,a,180,v,52
s_add_u32 s71, s71, 16384
v_cvt_pk_bf16_f32 v131, v134, v135
MV 204,a,180,v,68
v_exp_f32 v138, v138
MV 180,a,184,v,24
v_add_f32 v5, v5, v136
v_add_f32 v5, v5, v137
MV 188,a,184,v,40
v_exp_f32 v139, v139
MV 196,a,184,v,56
v_cvt_pk_bf16_f32 v136, v136, v137
MV 204,a,184,v,72
v_exp_f32 v140, v140
MV 180,a,188,v,28
v_add_f32 v5, v5, v138
v_add_f32 v5, v5, v139
MV 188,a,188,v,44
v_exp_f32 v141, v141
MV 196,a,188,v,60
v_cvt_pk_bf16_f32 v137, v138, v139
MV 204,a,188,v,76
v_exp_f32 v142, v142
v_add_f32 v5, v5, v140
v_add_f32 v5, v5, v141
v_exp_f32 v143, v143
v_cvt_pk_bf16_f32 v138, v140, v141
v_add_f32 v5, v5, v142
v_add_f32 v5, v5, v143
v_cvt_pk_bf16_f32 v139, v142, v143
s_waitcnt vmcnt(16) lgkmcnt(0)
MA 0,a,192,v,80
s_barrier
MA 32,a,192,v,88
s_add_u32 m0, s72, 0
ds_read_b128 a[128:131], v10 offset:16384
MA 64,a,192,v,96
v_exp_f32 v144, v144
MA 96,a,192,v,104
ds_read_b128 a[132:135], v10 offset:17408
buffer_load_dwordx4 v12, s[52:55], s71 offen offset:0 sc1 lds
MA 4,a,196,v,80
v_exp_f32 v145, v145
MA 36,a,196,v,88
v_exp_f32 v146, v146
MA 68,a,196,v,96
v_add_f32 v2, v2, v144
v_add_f32 v2, v2, v145
MA 100,a,196,v,104
v_exp_f32 v147, v147
MA 8,a,200,v,80
ds_read_b128 a[136:139], v10 offset:18432
v_cvt_pk_bf16_f32 v144, v144, v145
MA 40,a,200,v,88
v_exp_f32 v148, v148
MA 72,a,200,v,96
v_add_f32 v2, v2, v146
v_add_f32 v2, v2, v147
MA 104,a,200,v,104
ds_read_b128 a[140:143], v10 offset:19456
ds_read_b128 a[144:147], v10 offset:20480
MA 12,a,204,v,80
v_exp_f32 v149, v149
MA 44,a,204,v,88
buffer_load_dwordx4 v12, s[52:55], s71 offen offset:1024 sc1 lds
v_cvt_pk_bf16_f32 v145, v146, v147
MA 76,a,204,v,96
v_exp_f32 v150, v150
MA 108,a,204,v,104
v_add_f32 v2, v2, v148
v_add_f32 v2, v2, v149
MA 16,a,208,v,80
v_exp_f32 v151, v151
MA 48,a,208,v,88
ds_read_b128 a[148:151], v10 offset:21504
v_cvt_pk_bf16_f32 v146, v148, v149
MA 80,a,208,v,96
v_exp_f32 v152, v152
MA 112,a,208,v,104
v_add_f32 v2, v2, v150
v_add_f32 v2, v2, v151
MA 20,a,212,v,80
v_exp_f32 v153, v153
MA 52,a,212,v,88
ds_read_b128 a[152:155], v10 offset:22528
v_cvt_pk_bf16_f32 v147, v150, v151
MA 84,a,212,v,96
v_exp_f32 v154, v154
MA 116,a,212,v,104
v_add_f32 v3, v3, v152
v_add_f32 v3, v3, v153
MA 24,a,216,v,80
ds_read_b128 a[156:159], v10 offset:23552
ds_read_b128 a[160:163], v10 offset:24576
MA 56,a,216,v,88
v_exp_f32 v155, v155
MA 88,a,216,v,96
buffer_load_dwordx4 v12, s[52:55], s71 offen offset:2048 sc1 lds
v_cvt_pk_bf16_f32 v152, v152, v153
MA 120,a,216,v,104
v_exp_f32 v156, v156
MA 28,a,220,v,80
v_add_f32 v3, v3, v154
v_add_f32 v3, v3, v155
MA 60,a,220,v,88
v_exp_f32 v157, v157
MA 92,a,220,v,96
ds_read_b128 a[164:167], v10 offset:25600
v_cvt_pk_bf16_f32 v153, v154, v155
MA 124,a,220,v,104
v_exp_f32 v158, v158
MA 0,a,224,v,112
v_add_f32 v3, v3, v156
v_add_f32 v3, v3, v157
MA 32,a,224,v,120
v_exp_f32 v159, v159
MA 64,a,224,v,128
ds_read_b128 a[168:171], v10 offset:26624
v_cvt_pk_bf16_f32 v154, v156, v157
MA 96,a,224,v,136
v_exp_f32 v160, v160
MA 4,a,228,v,112
v_add_f32 v3, v3, v158
v_add_f32 v3, v3, v159
MA 36,a,228,v,120
ds_read_b128 a[172:175], v10 offset:27648
ds_read_b128 a[176:179], v10 offset:28672
MA 68,a,228,v,128
v_exp_f32 v161, v161
MA 100,a,228,v,136
ds_read_b128 a[180:183], v10 offset:29696
v_cvt_pk_bf16_f32 v155, v158, v159
MA 8,a,232,v,112
v_exp_f32 v162, v162
MA 40,a,232,v,120
v_add_f32 v4, v4, v160
v_add_f32 v4, v4, v161
MA 72,a,232,v,128
v_exp_f32 v163, v163
MA 104,a,232,v,136
buffer_load_dwordx4 v12, s[52:55], s71 offen offset:3072 sc1 lds
v_cvt_pk_bf16_f32 v160, v160, v161
MA 12,a,236,v,112
v_exp_f32 v164, v164
MA 44,a,236,v,120
v_add_f32 v4, v4, v162
v_add_f32 v4, v4, v163
MA 76,a,236,v,128
v_exp_f32 v165, v165
MA 108,a,236,v,136
ds_read_b128 a[184:187], v10 offset:30720
v_cvt_pk_bf16_f32 v161, v162, v163
MA 16,a,240,v,112
v_exp_f32 v166, v166
MA 48,a,240,v,120
v_add_f32 v4, v4, v164
v_add_f32 v4, v4, v165
MA 80,a,240,v,128
v_exp_f32 v167, v167
MA 112,a,240,v,136
ds_read_b128 a[188:191], v10 offset:31744
v_cvt_pk_bf16_f32 v162, v164, v165
MA 20,a,244,v,112
v_exp_f32 v168, v168
MA 52,a,244,v,120
v_add_f32 v4, v4, v166
v_add_f32 v4, v4, v167
MA 84,a,244,v,128
v_exp_f32 v169, v169
MA 116,a,244,v,136
s_sub_u32 s74, s74, 1
v_cvt_pk_bf16_f32 v163, v166, v167
MA 24,a,248,v,112
v_exp_f32 v170, v170
MA 56,a,248,v,120
v_add_f32 v5, v5, v168
v_add_f32 v5, v5, v169
MA 88,a,248,v,128
v_exp_f32 v171, v171
MA 120,a,248,v,136
v_cvt_pk_bf16_f32 v168, v168, v169
MA 28,a,252,v,112
v_exp_f32 v172, v172
MA 60,a,252,v,120
v_add_f32 v5, v5, v170
v_add_f32 v5, v5, v171
MA 92,a,252,v,128
v_exp_f32 v173, v173
MA 124,a,252,v,136
v_cvt_pk_bf16_f32 v169, v170, v171
v_exp_f32 v174, v174
v_add_f32 v5, v5, v172
v_add_f32 v5, v5, v173
v_exp_f32 v175, v175
v_cvt_pk_bf16_f32 v170, v172, v173
v_add_f32 v5, v5, v174
v_add_f32 v5, v5, v175
v_cvt_pk_bf16_f32 v171, v174, v175
s_cbranch_scc1 L_p3_d1m_top
s_waitcnt lgkmcnt(0)
v_xor_b32 v11, 0x8000, v11
v_mfma_f32_16x16x32_bf16 v[80:83], a[128:131], v[16:19], 0
s_add_u32 m0, s73, 16384
ds_read_b128 a[192:195], v11 offset:0
v_mfma_f32_16x16x32_bf16 v[88:91], a[128:131], v[32:35], 0
v_exp_f32 v176, v176
v_mfma_f32_16x16x32_bf16 v[96:99], a[128:131], v[48:51], 0
ds_read_b128 a[196:199], v11 offset:1024
buffer_load_dwordx4 v12, s[56:59], s71 offen offset:0 sc1 lds
v_mfma_f32_16x16x32_bf16 v[104:107], a[128:131], v[64:67], 0
v_exp_f32 v177, v177
MV 80,a,132,v,20
v_exp_f32 v178, v178
MV 88,a,132,v,36
v_add_f32 v2, v2, v176
v_add_f32 v2, v2, v177
MV 96,a,132,v,52
v_exp_f32 v179, v179
MV 104,a,132,v,68
ds_read_b128 a[200:203], v11 offset:2048
v_cvt_pk_bf16_f32 v176, v176, v177
MV 80,a,136,v,24
v_exp_f32 v180, v180
MV 88,a,136,v,40
v_add_f32 v2, v2, v178
v_add_f32 v2, v2, v179
MV 96,a,136,v,56
v_exp_f32 v181, v181
MV 104,a,136,v,72
ds_read_b128 a[204:207], v11 offset:3072
v_cvt_pk_bf16_f32 v177, v178, v179
MV 80,a,140,v,28
v_exp_f32 v182, v182
MV 88,a,140,v,44
buffer_load_dwordx4 v12, s[56:59], s71 offen offset:1024 sc1 lds
v_add_f32 v2, v2, v180
MV 96,a,140,v,60
ds_read_b128 a[208:211], v11 offset:4096
v_add_f32 v2, v2, v181
MV 104,a,140,v,76
v_exp_f32 v183, v183
v_mfma_f32_16x16x32_bf16 v[84:87], a[144:147], v[16:19], 0
ds_read_b128 a[212:215], v11 offset:5120
v_cvt_pk_bf16_f32 v178, v180, v181
v_mfma_f32_16x16x32_bf16 v[92:95], a[144:147], v[32:35], 0
v_exp_f32 v184, v184
v_mfma_f32_16x16x32_bf16 v[100:103], a[144:147], v[48:51], 0
v_add_f32 v2, v2, v182
v_add_f32 v2, v2, v183
v_mfma_f32_16x16x32_bf16 v[108:111], a[144:147], v[64:67], 0
v_exp_f32 v185, v185
MV 84,a,148,v,20
ds_read_b128 a[216:219], v11 offset:6144
v_cvt_pk_bf16_f32 v179, v182, v183
MV 92,a,148,v,36
v_exp_f32 v186, v186
MV 100,a,148,v,52
v_add_f32 v3, v3, v184
v_add_f32 v3, v3, v185
MV 108,a,148,v,68
v_exp_f32 v187, v187
MV 84,a,152,v,24
ds_read_b128 a[220:223], v11 offset:7168
v_cvt_pk_bf16_f32 v184, v184, v185
MV 92,a,152,v,40
ds_read_b128 a[224:227], v11 offset:8192
buffer_load_dwordx4 v12, s[56:59], s71 offen offset:2048 sc1 lds
MV 100,a,152,v,56
v_exp_f32 v188, v188
MV 108,a,152,v,72
v_add_f32 v3, v3, v186
v_add_f32 v3, v3, v187
MV 84,a,156,v,28
v_exp_f32 v189, v189
MV 92,a,156,v,44
ds_read_b128 a[228:231], v11 offset:9216
v_cvt_pk_bf16_f32 v185, v186, v187
MV 100,a,156,v,60
v_exp_f32 v190, v190
MV 108,a,156,v,76
v_add_f32 v3, v3, v188
v_add_f32 v3, v3, v189
v_mfma_f32_16x16x32_bf16 v[112:115], a[160:163], v[16:19], 0
v_exp_f32 v191, v191
v_mfma_f32_16x16x32_bf16 v[120:123], a[160:163], v[32:35], 0
ds_read_b128 a[232:235], v11 offset:10240
v_cvt_pk_bf16_f32 v186, v188, v189
v_mfma_f32_16x16x32_bf16 v[128:131], a[160:163], v[48:51], 0
v_exp_f32 v192, v192
v_mfma_f32_16x16x32_bf16 v[136:139], a[160:163], v[64:67], 0
buffer_load_dwordx4 v12, s[56:59], s71 offen offset:3072 sc1 lds
v_add_f32 v3, v3, v190
MV 112,a,164,v,20
ds_read_b128 a[236:239], v11 offset:11264
v_add_f32 v3, v3, v191
MV 120,a,164,v,36
v_exp_f32 v193, v193
MV 128,a,164,v,52
ds_read_b128 a[240:243], v11 offset:12288
v_cvt_pk_bf16_f32 v187, v190, v191
MV 136,a,164,v,68
v_exp_f32 v194, v194
MV 112,a,168,v,24
v_add_f32 v4, v4, v192
v_add_f32 v4, v4, v193
MV 120,a,168,v,40
v_exp_f32 v195, v195
MV 128,a,168,v,56
ds_read_b128 a[244:247], v11 offset:13312
v_cvt_pk_bf16_f32 v192, v192, v193
MV 136,a,168,v,72
v_exp_f32 v196, v196
MV 112,a,172,v,28
v_add_f32 v4, v4, v194
v_add_f32 v4, v4, v195
MV 120,a,172,v,44
v_exp_f32 v197, v197
MV 128,a,172,v,60
ds_read_b128 a[248:251], v11 offset:14336
v_cvt_pk_bf16_f32 v193, v194, v195
MV 136,a,172,v,76
v_exp_f32 v198, v198
v_mfma_f32_16x16x32_bf16 v[116:119], a[176:179], v[16:19], 0
s_add_u32 s71, s71, 16384
v_add_f32 v4, v4, v196
v_mfma_f32_16x16x32_bf16 v[124:127], a[176:179], v[32:35], 0
ds_read_b128 a[252:255], v11 offset:15360
v_add_f32 v4, v4, v197
v_mfma_f32_16x16x32_bf16 v[132:135], a[176:179], v[48:51], 0
v_exp_f32 v199, v199
v_mfma_f32_16x16x32_bf16 v[140:143], a[176:179], v[64:67], 0
s_xor_b32 s73, s73, 0x8000
v_cvt_pk_bf16_f32 v194, v196, v197
MV 116,a,180,v,20
v_exp_f32 v200, v200
MV 124,a,180,v,36
v_add_f32 v4, v4, v198
v_add_f32 v4, v4, v199
MV 132,a,180,v,52
v_exp_f32 v201, v201
MV 140,a,180,v,68
v_cvt_pk_bf16_f32 v195, v198, v199
MV 116,a,184,v,24
v_exp_f32 v202, v202
MV 124,a,184,v,40
v_add_f32 v5, v5, v200
v_add_f32 v5, v5, v201
MV 132,a,184,v,56
v_exp_f32 v203, v203
MV 140,a,184,v,72
v_cvt_pk_bf16_f32 v200, v200, v201
MV 116,a,188,v,28
v_exp_f32 v204, v204
MV 124,a,188,v,44
v_add_f32 v5, v5, v202
v_add_f32 v5, v5, v203
MV 132,a,188,v,60
v_exp_f32 v205, v205
MV 140,a,188,v,76
v_cvt_pk_bf16_f32 v201, v202, v203
v_exp_f32 v206, v206
v_add_f32 v5, v5, v204
v_add_f32 v5, v5, v205
v_exp_f32 v207, v207
v_cvt_pk_bf16_f32 v202, v204, v205
v_add_f32 v5, v5, v206
v_add_f32 v5, v5, v207
v_cvt_pk_bf16_f32 v203, v206, v207
s_waitcnt vmcnt(16) lgkmcnt(0)
MA 0,a,192,v,144
s_barrier
v_xor_b32 v10, 0x8000, v10
MA 32,a,192,v,152
s_add_u32 m0, s72, 16384
ds_read_b128 a[128:131], v10 offset:0
MA 64,a,192,v,160
v_exp_f32 v80, v80
MA 96,a,192,v,168
ds_read_b128 a[132:135], v10 offset:1024
buffer_load_dwordx4 v12, s[52:55], s71 offen offset:0 sc1 lds
MA 4,a,196,v,144
v_exp_f32 v81, v81
MA 36,a,196,v,152
v_exp_f32 v82, v82
MA 68,a,196,v,160
v_add_f32 v2, v2, v80
v_add_f32 v2, v2, v81
MA 100,a,196,v,168
v_exp_f32 v83, v83
MA 8,a,200,v,144
ds_read_b128 a[136:139], v10 offset:2048
v_cvt_pk_bf16_f32 v80, v80, v81
MA 40,a,200,v,152
v_exp_f32 v84, v84
MA 72,a,200,v,160
v_add_f32 v2, v2, v82
v_add_f32 v2, v2, v83
MA 104,a,200,v,168
ds_read_b128 a[140:143], v10 offset:3072
ds_read_b128 a[144:147], v10 offset:4096
MA 12,a,204,v,144
v_exp_f32 v85, v85
MA 44,a,204,v,152
buffer_load_dwordx4 v12, s[52:55], s71 offen offset:1024 sc1 lds
v_cvt_pk_bf16_f32 v81, v82, v83
MA 76,a,204,v,160
v_exp_f32 v86, v86
MA 108,a,204,v,168
v_add_f32 v2, v2, v84
v_add_f32 v2, v2, v85
MA 16,a,208,v,144
v_exp_f32 v87, v87
MA 48,a,208,v,152
ds_read_b128 a[148:151], v10 offset:5120
v_cvt_pk_bf16_f32 v82, v84, v85
MA 80,a,208,v,160
v_exp_f32 v88, v88
MA 112,a,208,v,168
v_add_f32 v2, v2, v86
v_add_f32 v2, v2, v87
MA 20,a,212,v,144
v_exp_f32 v89, v89
MA 52,a,212,v,152
ds_read_b128 a[152:155], v10 offset:6144
v_cvt_pk_bf16_f32 v83, v86, v87
MA 84,a,212,v,160
v_exp_f32 v90, v90
MA 116,a,212,v,168
v_add_f32 v3, v3, v88
v_add_f32 v3, v3, v89
MA 24,a,216,v,144
ds_read_b128 a[156:159], v10 offset:7168
ds_read_b128 a[160:163], v10 offset:8192
MA 56,a,216,v,152
v_exp_f32 v91, v91
MA 88,a,216,v,160
buffer_load_dwordx4 v12, s[52:55], s71 offen offset:2048 sc1 lds
v_cvt_pk_bf16_f32 v88, v88, v89
MA 120,a,216,v,168
v_exp_f32 v92, v92
MA 28,a,220,v,144
v_add_f32 v3, v3, v90
v_add_f32 v3, v3, v91
MA 60,a,220,v,152
v_exp_f32 v93, v93
MA 92,a,220,v,160
ds_read_b128 a[164:167], v10 offset:9216
v_cvt_pk_bf16_f32 v89, v90, v91
MA 124,a,220,v,168
v_exp_f32 v94, v94
MA 0,a,224,v,176
v_add_f32 v3, v3, v92
v_add_f32 v3, v3, v93
MA 32,a,224,v,184
v_exp_f32 v95, v95
MA 64,a,224,v,192
ds_read_b128 a[168:171], v10 offset:10240
v_cvt_pk_bf16_f32 v90, v92, v93
MA 96,a,224,v,200
v_exp_f32 v96, v96
MA 4,a,228,v,176
v_add_f32 v3, v3, v94
v_add_f32 v3, v3, v95
MA 36,a,228,v,184
ds_read_b128 a[172:175], v10 offset:11264
ds_read_b128 a[176:179], v10 offset:12288
MA 68,a,228,v,192
v_exp_f32 v97, v97
MA 100,a,228,v,200
ds_read_b128 a[180:183], v10 offset:13312
v_cvt_pk_bf16_f32 v91, v94, v95
MA 8,a,232,v,176
v_exp_f32 v98, v98
MA 40,a,232,v,184
v_add_f32 v4, v4, v96
v_add_f32 v4, v4, v97
MA 72,a,232,v,192
v_exp_f32 v99, v99
MA 104,a,232,v,200
buffer_load_dwordx4 v12, s[52:55], s71 offen offset:3072 sc1 lds
v_cvt_pk_bf16_f32 v96, v96, v97
MA 12,a,236,v,176
v_exp_f32 v100, v100
MA 44,a,236,v,184
v_add_f32 v4, v4, v98
v_add_f32 v4, v4, v99
MA 76,a,236,v,192
v_exp_f32 v101, v101
MA 108,a,236,v,200
ds_read_b128 a[184:187], v10 offset:14336
v_cvt_pk_bf16_f32 v97, v98, v99
MA 16,a,240,v,176
v_exp_f32 v102, v102
MA 48,a,240,v,184
v_add_f32 v4, v4, v100
v_add_f32 v4, v4, v101
MA 80,a,240,v,192
v_exp_f32 v103, v103
MA 112,a,240,v,200
ds_read_b128 a[188:191], v10 offset:15360
v_cvt_pk_bf16_f32 v98, v100, v101
MA 20,a,244,v,176
v_exp_f32 v104, v104
MA 52,a,244,v,184
v_add_f32 v4, v4, v102
v_add_f32 v4, v4, v103
MA 84,a,244,v,192
v_exp_f32 v105, v105
MA 116,a,244,v,200
s_xor_b32 s72, s72, 0x8000
v_cvt_pk_bf16_f32 v99, v102, v103
MA 24,a,248,v,176
v_exp_f32 v106, v106
MA 56,a,248,v,184
v_add_f32 v5, v5, v104
v_add_f32 v5, v5, v105
MA 88,a,248,v,192
v_exp_f32 v107, v107
MA 120,a,248,v,200
v_cvt_pk_bf16_f32 v104, v104, v105
MA 28,a,252,v,176
v_exp_f32 v108, v108
MA 60,a,252,v,184
v_add_f32 v5, v5, v106
v_add_f32 v5, v5, v107
MA 92,a,252,v,192
v_exp_f32 v109, v109
MA 124,a,252,v,200
v_cvt_pk_bf16_f32 v105, v106, v107
v_exp_f32 v110, v110
v_add_f32 v5, v5, v108
v_add_f32 v5, v5, v109
v_exp_f32 v111, v111
v_cvt_pk_bf16_f32 v106, v108, v109
v_add_f32 v5, v5, v110
v_add_f32 v5, v5, v111
v_cvt_pk_bf16_f32 v107, v110, v111
s_branch L_p3_d0_top
L_p3_d1m_top:
s_waitcnt lgkmcnt(0)
v_xor_b32 v11, 0x8000, v11
v_mfma_f32_16x16x32_bf16 v[80:83], a[128:131], v[16:19], 0
s_add_u32 m0, s73, 16384
ds_read_b128 a[192:195], v11 offset:0
v_mfma_f32_16x16x32_bf16 v[88:91], a[128:131], v[32:35], 0
v_exp_f32 v176, v176
v_mfma_f32_16x16x32_bf16 v[96:99], a[128:131], v[48:51], 0
ds_read_b128 a[196:199], v11 offset:1024
buffer_load_dwordx4 v12, s[56:59], s71 offen offset:0 sc1 lds
v_mfma_f32_16x16x32_bf16 v[104:107], a[128:131], v[64:67], 0
v_exp_f32 v177, v177
MV 80,a,132,v,20
v_exp_f32 v178, v178
MV 88,a,132,v,36
v_add_f32 v2, v2, v176
v_add_f32 v2, v2, v177
MV 96,a,132,v,52
v_exp_f32 v179, v179
MV 104,a,132,v,68
ds_read_b128 a[200:203], v11 offset:2048
v_cvt_pk_bf16_f32 v176, v176, v177
MV 80,a,136,v,24
v_exp_f32 v180, v180
MV 88,a,136,v,40
v_add_f32 v2, v2, v178
v_add_f32 v2, v2, v179
MV 96,a,136,v,56
v_exp_f32 v181, v181
MV 104,a,136,v,72
ds_read_b128 a[204:207], v11 offset:3072
v_cvt_pk_bf16_f32 v177, v178, v179
MV 80,a,140,v,28
v_exp_f32 v182, v182
MV 88,a,140,v,44
buffer_load_dwordx4 v12, s[56:59], s71 offen offset:1024 sc1 lds
v_add_f32 v2, v2, v180
MV 96,a,140,v,60
ds_read_b128 a[208:211], v11 offset:4096
v_add_f32 v2, v2, v181
MV 104,a,140,v,76
v_exp_f32 v183, v183
v_mfma_f32_16x16x32_bf16 v[84:87], a[144:147], v[16:19], 0
ds_read_b128 a[212:215], v11 offset:5120
v_cvt_pk_bf16_f32 v178, v180, v181
v_mfma_f32_16x16x32_bf16 v[92:95], a[144:147], v[32:35], 0
v_exp_f32 v184, v184
v_mfma_f32_16x16x32_bf16 v[100:103], a[144:147], v[48:51], 0
v_add_f32 v2, v2, v182
v_add_f32 v2, v2, v183
v_mfma_f32_16x16x32_bf16 v[108:111], a[144:147], v[64:67], 0
v_exp_f32 v185, v185
MV 84,a,148,v,20
ds_read_b128 a[216:219], v11 offset:6144
v_cvt_pk_bf16_f32 v179, v182, v183
MV 92,a,148,v,36
v_exp_f32 v186, v186
MV 100,a,148,v,52
v_add_f32 v3, v3, v184
v_add_f32 v3, v3, v185
MV 108,a,148,v,68
v_exp_f32 v187, v187
MV 84,a,152,v,24
ds_read_b128 a[220:223], v11 offset:7168
v_cvt_pk_bf16_f32 v184, v184, v185
MV 92,a,152,v,40
ds_read_b128 a[224:227], v11 offset:8192
buffer_load_dwordx4 v12, s[56:59], s71 offen offset:2048 sc1 lds
MV 100,a,152,v,56
v_exp_f32 v188, v188
MV 108,a,152,v,72
v_add_f32 v3, v3, v186
v_add_f32 v3, v3, v187
MV 84,a,156,v,28
v_exp_f32 v189, v189
MV 92,a,156,v,44
ds_read_b128 a[228:231], v11 offset:9216
v_cvt_pk_bf16_f32 v185, v186, v187
MV 100,a,156,v,60
v_exp_f32 v190, v190
MV 108,a,156,v,76
v_add_f32 v3, v3, v188
v_add_f32 v3, v3, v189
v_mfma_f32_16x16x32_bf16 v[112:115], a[160:163], v[16:19], 0
v_exp_f32 v191, v191
v_mfma_f32_16x16x32_bf16 v[120:123], a[160:163], v[32:35], 0
ds_read_b128 a[232:235], v11 offset:10240
v_cvt_pk_bf16_f32 v186, v188, v189
v_mfma_f32_16x16x32_bf16 v[128:131], a[160:163], v[48:51], 0
v_exp_f32 v192, v192
v_mfma_f32_16x16x32_bf16 v[136:139], a[160:163], v[64:67], 0
buffer_load_dwordx4 v12, s[56:59], s71 offen offset:3072 sc1 lds
v_add_f32 v3, v3, v190
MV 112,a,164,v,20
ds_read_b128 a[236:239], v11 offset:11264
v_add_f32 v3, v3, v191
MV 120,a,164,v,36
v_exp_f32 v193, v193
MV 128,a,164,v,52
ds_read_b128 a[240:243], v11 offset:12288
v_cvt_pk_bf16_f32 v187, v190, v191
MV 136,a,164,v,68
v_exp_f32 v194, v194
MV 112,a,168,v,24
v_add_f32 v4, v4, v192
v_add_f32 v4, v4, v193
MV 120,a,168,v,40
v_exp_f32 v195, v195
MV 128,a,168,v,56
v_cvt_pk_bf16_f32 v192, v192, v193
v_add_u32 v246, 0, v13
MV 136,a,168,v,72
ds_read_b128 a[244:247], v11 offset:13312
v_cmp_gt_i32_e64 s[84:85], 0, v246
MV 112,a,172,v,28
v_exp_f32 v196, v196
MV 120,a,172,v,44
v_add_f32 v4, v4, v194
v_cmp_gt_i32_e64 s[86:87], 1, v246
MV 128,a,172,v,60
v_add_f32 v4, v4, v195
v_cmp_gt_i32_e64 s[88:89], 2, v246
MV 136,a,172,v,76
v_cmp_gt_i32_e64 s[90:91], 3, v246
v_cndmask_b32_e64 v96, v96, v14, s[84:85]
v_mfma_f32_16x16x32_bf16 v[116:119], a[176:179], v[16:19], 0
v_exp_f32 v197, v197
v_mfma_f32_16x16x32_bf16 v[124:127], a[176:179], v[32:35], 0
ds_read_b128 a[248:251], v11 offset:14336
v_cvt_pk_bf16_f32 v193, v194, v195
v_mfma_f32_16x16x32_bf16 v[132:135], a[176:179], v[48:51], 0
s_add_u32 s71, s71, 16384
v_cndmask_b32_e64 v97, v97, v14, s[86:87]
v_mfma_f32_16x16x32_bf16 v[140:143], a[176:179], v[64:67], 0
v_exp_f32 v198, v198
MV 116,a,180,v,20
v_add_f32 v4, v4, v196
v_cndmask_b32_e64 v98, v98, v14, s[88:89]
MV 124,a,180,v,36
v_add_f32 v4, v4, v197
v_cndmask_b32_e64 v99, v99, v14, s[90:91]
MV 132,a,180,v,52
ds_read_b128 a[252:255], v11 offset:15360
v_add_u32 v247, 16, v13
MV 140,a,180,v,68
v_exp_f32 v199, v199
MV 116,a,184,v,24
v_cvt_pk_bf16_f32 v194, v196, v197
v_cmp_gt_i32_e64 s[92:93], 0, v247
MV 124,a,184,v,40
v_cmp_gt_i32_e64 s[94:95], 1, v247
v_cmp_gt_i32_e64 s[96:97], 2, v247
MV 132,a,184,v,56
v_exp_f32 v200, v200
MV 140,a,184,v,72
v_add_f32 v4, v4, v198
v_cmp_gt_i32_e64 s[98:99], 3, v247
MV 116,a,188,v,28
v_add_f32 v4, v4, v199
v_cndmask_b32_e64 v104, v104, v14, s[92:93]
MV 124,a,188,v,44
v_cndmask_b32_e64 v105, v105, v14, s[94:95]
v_cndmask_b32_e64 v106, v106, v14, s[96:97]
MV 132,a,188,v,60
v_exp_f32 v201, v201
MV 140,a,188,v,76
s_xor_b32 s73, s73, 0x8000
v_cvt_pk_bf16_f32 v195, v198, v199
v_exp_f32 v202, v202
v_cndmask_b32_e64 v107, v107, v14, s[98:99]
v_add_f32 v5, v5, v200
v_add_u32 v246, -16, v13
v_cmp_gt_i32_e64 s[84:85], 0, v246
v_add_f32 v5, v5, v201
v_exp_f32 v203, v203
v_cmp_gt_i32_e64 s[86:87], 1, v246
v_cvt_pk_bf16_f32 v200, v200, v201
v_cmp_gt_i32_e64 s[88:89], 2, v246
v_cmp_gt_i32_e64 s[90:91], 3, v246
v_exp_f32 v204, v204
v_cndmask_b32_e64 v100, v100, v14, s[84:85]
v_add_f32 v5, v5, v202
v_cndmask_b32_e64 v101, v101, v14, s[86:87]
v_add_f32 v5, v5, v203
v_exp_f32 v205, v205
v_cndmask_b32_e64 v102, v102, v14, s[88:89]
v_cndmask_b32_e64 v103, v103, v14, s[90:91]
v_cvt_pk_bf16_f32 v201, v202, v203
v_add_u32 v247, 0, v13
v_exp_f32 v206, v206
v_cmp_gt_i32_e64 s[92:93], 0, v247
v_cmp_gt_i32_e64 s[94:95], 1, v247
v_add_f32 v5, v5, v204
v_cmp_gt_i32_e64 s[96:97], 2, v247
v_add_f32 v5, v5, v205
v_exp_f32 v207, v207
v_cmp_gt_i32_e64 s[98:99], 3, v247
v_cvt_pk_bf16_f32 v202, v204, v205
v_cndmask_b32_e64 v108, v108, v14, s[92:93]
v_cndmask_b32_e64 v109, v109, v14, s[94:95]
v_add_f32 v5, v5, v206
v_add_f32 v5, v5, v207
v_cndmask_b32_e64 v110, v110, v14, s[96:97]
v_cvt_pk_bf16_f32 v203, v206, v207
v_cndmask_b32_e64 v111, v111, v14, s[98:99]
s_waitcnt vmcnt(16) lgkmcnt(0)
MA 0,a,192,v,144
s_barrier
v_xor_b32 v10, 0x8000, v10
MA 32,a,192,v,152
s_add_u32 m0, s72, 16384
ds_read_b128 a[128:131], v10 offset:0
MA 64,a,192,v,160
v_exp_f32 v80, v80
MA 96,a,192,v,168
ds_read_b128 a[132:135], v10 offset:1024
buffer_load_dwordx4 v12, s[52:55], s71 offen offset:0 sc1 lds
MA 4,a,196,v,144
v_exp_f32 v81, v81
MA 36,a,196,v,152
v_exp_f32 v82, v82
MA 68,a,196,v,160
v_add_f32 v2, v2, v80
v_add_f32 v2, v2, v81
MA 100,a,196,v,168
v_exp_f32 v83, v83
MA 8,a,200,v,144
ds_read_b128 a[136:139], v10 offset:2048
v_cvt_pk_bf16_f32 v80, v80, v81
MA 40,a,200,v,152
v_add_u32 v246, -32, v13
v_cmp_gt_i32_e64 s[84:85], 0, v246
MA 72,a,200,v,160
v_exp_f32 v84, v84
MA 104,a,200,v,168
v_add_f32 v2, v2, v82
v_add_f32 v2, v2, v83
MA 12,a,204,v,144
ds_read_b128 a[140:143], v10 offset:3072
v_cmp_gt_i32_e64 s[86:87], 1, v246
MA 44,a,204,v,152
v_exp_f32 v85, v85
MA 76,a,204,v,160
v_cvt_pk_bf16_f32 v81, v82, v83
v_cmp_gt_i32_e64 s[88:89], 2, v246
MA 108,a,204,v,168
v_exp_f32 v86, v86
MA 16,a,208,v,144
ds_read_b128 a[144:147], v10 offset:4096
v_add_f32 v2, v2, v84
MA 48,a,208,v,152
v_add_f32 v2, v2, v85
v_cmp_gt_i32_e64 s[90:91], 3, v246
MA 80,a,208,v,160
v_exp_f32 v87, v87
MA 112,a,208,v,168
buffer_load_dwordx4 v12, s[52:55], s71 offen offset:1024 sc1 lds
v_cvt_pk_bf16_f32 v82, v84, v85
MA 20,a,212,v,144
ds_read_b128 a[148:151], v10 offset:5120
v_cndmask_b32_e64 v128, v128, v14, s[84:85]
MA 52,a,212,v,152
v_cndmask_b32_e64 v129, v129, v14, s[86:87]
v_cndmask_b32_e64 v130, v130, v14, s[88:89]
MA 84,a,212,v,160
v_exp_f32 v88, v88
MA 116,a,212,v,168
v_add_f32 v2, v2, v86
v_add_f32 v2, v2, v87
MA 24,a,216,v,144
v_exp_f32 v89, v89
MA 56,a,216,v,152
ds_read_b128 a[152:155], v10 offset:6144
v_cvt_pk_bf16_f32 v83, v86, v87
MA 88,a,216,v,160
v_cndmask_b32_e64 v131, v131, v14, s[90:91]
v_add_u32 v247, -16, v13
MA 120,a,216,v,168
v_exp_f32 v90, v90
MA 28,a,220,v,144
v_add_f32 v3, v3, v88
v_add_f32 v3, v3, v89
MA 60,a,220,v,152
ds_read_b128 a[156:159], v10 offset:7168
v_cmp_gt_i32_e64 s[92:93], 0, v247
MA 92,a,220,v,160
v_exp_f32 v91, v91
MA 124,a,220,v,168
v_cvt_pk_bf16_f32 v88, v88, v89
v_cmp_gt_i32_e64 s[94:95], 1, v247
MA 0,a,224,v,176
v_exp_f32 v92, v92
MA 32,a,224,v,184
ds_read_b128 a[160:163], v10 offset:8192
v_add_f32 v3, v3, v90
MA 64,a,224,v,192
v_add_f32 v3, v3, v91
v_cmp_gt_i32_e64 s[96:97], 2, v247
MA 96,a,224,v,200
v_exp_f32 v93, v93
MA 4,a,228,v,176
buffer_load_dwordx4 v12, s[52:55], s71 offen offset:2048 sc1 lds
v_cvt_pk_bf16_f32 v89, v90, v91
MA 36,a,228,v,184
ds_read_b128 a[164:167], v10 offset:9216
v_cmp_gt_i32_e64 s[98:99], 3, v247
MA 68,a,228,v,192
v_exp_f32 v94, v94
MA 100,a,228,v,200
v_add_f32 v3, v3, v92
v_add_f32 v3, v3, v93
MA 8,a,232,v,176
ds_read_b128 a[168:171], v10 offset:10240
v_cndmask_b32_e64 v136, v136, v14, s[92:93]
MA 40,a,232,v,184
v_exp_f32 v95, v95
MA 72,a,232,v,192
v_cvt_pk_bf16_f32 v90, v92, v93
v_cndmask_b32_e64 v137, v137, v14, s[94:95]
MA 104,a,232,v,200
v_exp_f32 v96, v96
MA 12,a,236,v,176
v_add_f32 v3, v3, v94
v_cndmask_b32_e64 v138, v138, v14, s[96:97]
MA 44,a,236,v,184
ds_read_b128 a[172:175], v10 offset:11264
v_add_f32 v3, v3, v95
MA 76,a,236,v,192
v_cndmask_b32_e64 v139, v139, v14, s[98:99]
v_add_u32 v246, -48, v13
MA 108,a,236,v,200
v_exp_f32 v97, v97
MA 16,a,240,v,176
ds_read_b128 a[176:179], v10 offset:12288
v_cvt_pk_bf16_f32 v91, v94, v95
MA 48,a,240,v,184
v_exp_f32 v98, v98
MA 80,a,240,v,192
v_add_f32 v4, v4, v96
v_add_f32 v4, v4, v97
MA 112,a,240,v,200
v_cmp_gt_i32_e64 s[84:85], 0, v246
v_cmp_gt_i32_e64 s[86:87], 1, v246
MA 20,a,244,v,176
v_exp_f32 v99, v99
MA 52,a,244,v,184
ds_read_b128 a[180:183], v10 offset:13312
v_cvt_pk_bf16_f32 v96, v96, v97
MA 84,a,244,v,192
v_exp_f32 v100, v100
MA 116,a,244,v,200
buffer_load_dwordx4 v12, s[52:55], s71 offen offset:3072 sc1 lds
v_add_f32 v4, v4, v98
MA 24,a,248,v,176
v_add_f32 v4, v4, v99
v_cmp_gt_i32_e64 s[88:89], 2, v246
MA 56,a,248,v,184
v_exp_f32 v101, v101
MA 88,a,248,v,192
ds_read_b128 a[184:187], v10 offset:14336
v_cmp_gt_i32_e64 s[90:91], 3, v246
MA 120,a,248,v,200
v_cvt_pk_bf16_f32 v97, v98, v99
v_cndmask_b32_e64 v132, v132, v14, s[84:85]
MA 28,a,252,v,176
v_exp_f32 v102, v102
MA 60,a,252,v,184
v_add_f32 v4, v4, v100
v_add_f32 v4, v4, v101
MA 92,a,252,v,192
ds_read_b128 a[188:191], v10 offset:15360
v_cndmask_b32_e64 v133, v133, v14, s[86:87]
MA 124,a,252,v,200
s_xor_b32 s72, s72, 0x8000
v_exp_f32 v103, v103
v_cvt_pk_bf16_f32 v98, v100, v101
v_exp_f32 v104, v104
v_cndmask_b32_e64 v134, v134, v14, s[88:89]
v_add_f32 v4, v4, v102
v_cndmask_b32_e64 v135, v135, v14, s[90:91]
v_add_f32 v4, v4, v103
v_exp_f32 v105, v105
v_cvt_pk_bf16_f32 v99, v102, v103
v_add_u32 v247, -32, v13
v_exp_f32 v106, v106
v_add_f32 v5, v5, v104
v_cmp_gt_i32_e64 s[92:93], 0, v247
v_add_f32 v5, v5, v105
v_exp_f32 v107, v107
v_cmp_gt_i32_e64 s[94:95], 1, v247
v_cvt_pk_bf16_f32 v104, v104, v105
v_exp_f32 v108, v108
v_cmp_gt_i32_e64 s[96:97], 2, v247
v_add_f32 v5, v5, v106
v_cmp_gt_i32_e64 s[98:99], 3, v247
v_add_f32 v5, v5, v107
v_exp_f32 v109, v109
v_cvt_pk_bf16_f32 v105, v106, v107
v_cndmask_b32_e64 v140, v140, v14, s[92:93]
v_exp_f32 v110, v110
v_add_f32 v5, v5, v108
v_cndmask_b32_e64 v141, v141, v14, s[94:95]
v_add_f32 v5, v5, v109
v_exp_f32 v111, v111
v_cndmask_b32_e64 v142, v142, v14, s[96:97]
v_cvt_pk_bf16_f32 v106, v108, v109
v_add_f32 v5, v5, v110
v_add_f32 v5, v5, v111
v_cndmask_b32_e64 v143, v143, v14, s[98:99]
v_cvt_pk_bf16_f32 v107, v110, v111
L_p3_d0m_top:
s_waitcnt lgkmcnt(0)
v_mfma_f32_16x16x32_bf16 v[144:147], a[128:131], v[16:19], 0
s_add_u32 m0, s73, 0
ds_read_b128 a[192:195], v11 offset:16384
v_mfma_f32_16x16x32_bf16 v[152:155], a[128:131], v[32:35], 0
v_exp_f32 v112, v112
v_mfma_f32_16x16x32_bf16 v[160:163], a[128:131], v[48:51], 0
ds_read_b128 a[196:199], v11 offset:17408
buffer_load_dwordx4 v12, s[56:59], s71 offen offset:0 sc1 lds
v_mfma_f32_16x16x32_bf16 v[168:171], a[128:131], v[64:67], 0
v_exp_f32 v113, v113
MV 144,a,132,v,20
v_exp_f32 v114, v114
MV 152,a,132,v,36
v_add_f32 v2, v2, v112
v_add_f32 v2, v2, v113
MV 160,a,132,v,52
v_exp_f32 v115, v115
MV 168,a,132,v,68
ds_read_b128 a[200:203], v11 offset:18432
v_cvt_pk_bf16_f32 v112, v112, v113
MV 144,a,136,v,24
v_exp_f32 v116, v116
MV 152,a,136,v,40
v_add_f32 v2, v2, v114
v_add_f32 v2, v2, v115
MV 160,a,136,v,56
v_exp_f32 v117, v117
MV 168,a,136,v,72
ds_read_b128 a[204:207], v11 offset:19456
v_cvt_pk_bf16_f32 v113, v114, v115
MV 144,a,140,v,28
v_exp_f32 v118, v118
MV 152,a,140,v,44
ds_read_b128 a[208:211], v11 offset:20480
v_add_f32 v2, v2, v116
MV 160,a,140,v,60
buffer_load_dwordx4 v12, s[56:59], s71 offen offset:1024 sc1 lds
v_add_f32 v2, v2, v117
MV 168,a,140,v,76
v_exp_f32 v119, v119
v_mfma_f32_16x16x32_bf16 v[148:151], a[144:147], v[16:19], 0
ds_read_b128 a[212:215], v11 offset:21504
v_cvt_pk_bf16_f32 v114, v116, v117
v_mfma_f32_16x16x32_bf16 v[156:159], a[144:147], v[32:35], 0
v_exp_f32 v120, v120
v_mfma_f32_16x16x32_bf16 v[164:167], a[144:147], v[48:51], 0
v_add_f32 v2, v2, v118
v_add_f32 v2, v2, v119
v_mfma_f32_16x16x32_bf16 v[172:175], a[144:147], v[64:67], 0
v_exp_f32 v121, v121
MV 148,a,148,v,20
ds_read_b128 a[216:219], v11 offset:22528
v_cvt_pk_bf16_f32 v115, v118, v119
MV 156,a,148,v,36
v_exp_f32 v122, v122
MV 164,a,148,v,52
v_add_f32 v3, v3, v120
v_add_f32 v3, v3, v121
MV 172,a,148,v,68
v_exp_f32 v123, v123
MV 148,a,152,v,24
ds_read_b128 a[220:223], v11 offset:23552
v_cvt_pk_bf16_f32 v120, v120, v121
MV 156,a,152,v,40
v_exp_f32 v124, v124
MV 164,a,152,v,56
ds_read_b128 a[224:227], v11 offset:24576
v_add_f32 v3, v3, v122
MV 172,a,152,v,72
buffer_load_dwordx4 v12, s[56:59], s71 offen offset:2048 sc1 lds
v_add_f32 v3, v3, v123
MV 148,a,156,v,28
v_exp_f32 v125, v125
MV 156,a,156,v,44
ds_read_b128 a[228:231], v11 offset:25600
v_cvt_pk_bf16_f32 v121, v122, v123
MV 164,a,156,v,60
v_exp_f32 v126, v126
MV 172,a,156,v,76
v_add_f32 v3, v3, v124
v_add_f32 v3, v3, v125
v_mfma_f32_16x16x32_bf16 v[176:179], a[160:163], v[16:19], 0
v_exp_f32 v127, v127
v_mfma_f32_16x16x32_bf16 v[184:187], a[160:163], v[32:35], 0
ds_read_b128 a[232:235], v11 offset:26624
v_cvt_pk_bf16_f32 v122, v124, v125
v_mfma_f32_16x16x32_bf16 v[192:195], a[160:163], v[48:51], 0
v_exp_f32 v128, v128
v_mfma_f32_16x16x32_bf16 v[200:203], a[160:163], v[64:67], 0
v_add_f32 v3, v3, v126
v_add_f32 v3, v3, v127
MV 176,a,164,v,20
v_exp_f32 v129, v129
MV 184,a,164,v,36
ds_read_b128 a[236:239], v11 offset:27648
v_cvt_pk_bf16_f32 v123, v126, v127
MV 192,a,164,v,52
v_exp_f32 v130, v130
MV 200,a,164,v,68
ds_read_b128 a[240:243], v11 offset:28672
v_add_f32 v4, v4, v128
MV 176,a,168,v,24
buffer_load_dwordx4 v12, s[56:59], s71 offen offset:3072 sc1 lds
v_add_f32 v4, v4, v129
MV 184,a,168,v,40
v_exp_f32 v131, v131
MV 192,a,168,v,56
v_cvt_pk_bf16_f32 v128, v128, v129
v_add_u32 v246, -64, v13
MV 200,a,168,v,72
ds_read_b128 a[244:247], v11 offset:29696
v_cmp_gt_i32_e64 s[84:85], 0, v246
MV 176,a,172,v,28
v_exp_f32 v132, v132
MV 184,a,172,v,44
v_add_f32 v4, v4, v130
v_cmp_gt_i32_e64 s[86:87], 1, v246
MV 192,a,172,v,60
v_add_f32 v4, v4, v131
v_cmp_gt_i32_e64 s[88:89], 2, v246
MV 200,a,172,v,76
v_cmp_gt_i32_e64 s[90:91], 3, v246
v_cndmask_b32_e64 v160, v160, v14, s[84:85]
v_mfma_f32_16x16x32_bf16 v[180:183], a[176:179], v[16:19], 0
v_exp_f32 v133, v133
v_mfma_f32_16x16x32_bf16 v[188:191], a[176:179], v[32:35], 0
ds_read_b128 a[248:251], v11 offset:30720
v_cvt_pk_bf16_f32 v129, v130, v131
v_mfma_f32_16x16x32_bf16 v[196:199], a[176:179], v[48:51], 0
v_cndmask_b32_e64 v161, v161, v14, s[86:87]
v_cndmask_b32_e64 v162, v162, v14, s[88:89]
v_mfma_f32_16x16x32_bf16 v[204:207], a[176:179], v[64:67], 0
v_exp_f32 v134, v134
MV 180,a,180,v,20
v_add_f32 v4, v4, v132
v_cndmask_b32_e64 v163, v163, v14, s[90:91]
MV 188,a,180,v,36
v_add_f32 v4, v4, v133
v_add_u32 v247, -48, v13
MV 196,a,180,v,52
v_exp_f32 v135, v135
MV 204,a,180,v,68
ds_read_b128 a[252:255], v11 offset:31744
v_cvt_pk_bf16_f32 v130, v132, v133
MV 180,a,184,v,24
v_cmp_gt_i32_e64 s[92:93], 0, v247
v_cmp_gt_i32_e64 s[94:95], 1, v247
MV 188,a,184,v,40
v_cmp_gt_i32_e64 s[96:97], 2, v247
v_cmp_gt_i32_e64 s[98:99], 3, v247
MV 196,a,184,v,56
v_exp_f32 v136, v136
MV 204,a,184,v,72
v_add_f32 v4, v4, v134
v_add_f32 v4, v4, v135
MV 180,a,188,v,28
v_cndmask_b32_e64 v168, v168, v14, s[92:93]
v_cndmask_b32_e64 v169, v169, v14, s[94:95]
MV 188,a,188,v,44
v_exp_f32 v137, v137
MV 196,a,188,v,60
v_cvt_pk_bf16_f32 v131, v134, v135
v_cndmask_b32_e64 v170, v170, v14, s[96:97]
MV 204,a,188,v,76
s_add_u32 s71, s71, 16384
v_exp_f32 v138, v138
v_cndmask_b32_e64 v171, v171, v14, s[98:99]
v_add_f32 v5, v5, v136
v_add_u32 v246, -80, v13
v_cmp_gt_i32_e64 s[84:85], 0, v246
v_add_f32 v5, v5, v137
v_exp_f32 v139, v139
v_cmp_gt_i32_e64 s[86:87], 1, v246
v_cvt_pk_bf16_f32 v136, v136, v137
v_cmp_gt_i32_e64 s[88:89], 2, v246
v_cmp_gt_i32_e64 s[90:91], 3, v246
v_exp_f32 v140, v140
v_cndmask_b32_e64 v164, v164, v14, s[84:85]
v_add_f32 v5, v5, v138
v_cndmask_b32_e64 v165, v165, v14, s[86:87]
v_add_f32 v5, v5, v139
v_exp_f32 v141, v141
v_cndmask_b32_e64 v166, v166, v14, s[88:89]
v_cndmask_b32_e64 v167, v167, v14, s[90:91]
v_cvt_pk_bf16_f32 v137, v138, v139
v_add_u32 v247, -64, v13
v_exp_f32 v142, v142
v_cmp_gt_i32_e64 s[92:93], 0, v247
v_cmp_gt_i32_e64 s[94:95], 1, v247
v_add_f32 v5, v5, v140
v_cmp_gt_i32_e64 s[96:97], 2, v247
v_add_f32 v5, v5, v141
v_exp_f32 v143, v143
v_cmp_gt_i32_e64 s[98:99], 3, v247
v_cvt_pk_bf16_f32 v138, v140, v141
v_cndmask_b32_e64 v172, v172, v14, s[92:93]
v_cndmask_b32_e64 v173, v173, v14, s[94:95]
v_add_f32 v5, v5, v142
v_add_f32 v5, v5, v143
v_cndmask_b32_e64 v174, v174, v14, s[96:97]
v_cvt_pk_bf16_f32 v139, v142, v143
v_cndmask_b32_e64 v175, v175, v14, s[98:99]
s_waitcnt vmcnt(16) lgkmcnt(0)
MA 0,a,192,v,80
s_barrier
MA 32,a,192,v,88
s_add_u32 m0, s72, 0
ds_read_b128 a[128:131], v10 offset:16384
MA 64,a,192,v,96
v_exp_f32 v144, v144
MA 96,a,192,v,104
ds_read_b128 a[132:135], v10 offset:17408
buffer_load_dwordx4 v12, s[52:55], s71 offen offset:0 sc1 lds
MA 4,a,196,v,80
v_exp_f32 v145, v145
MA 36,a,196,v,88
v_exp_f32 v146, v146
MA 68,a,196,v,96
v_add_f32 v2, v2, v144
v_add_f32 v2, v2, v145
MA 100,a,196,v,104
v_exp_f32 v147, v147
MA 8,a,200,v,80
ds_read_b128 a[136:139], v10 offset:18432
v_cvt_pk_bf16_f32 v144, v144, v145
MA 40,a,200,v,88
v_add_u32 v246, -96, v13
v_cmp_gt_i32_e64 s[84:85], 0, v246
MA 72,a,200,v,96
v_exp_f32 v148, v148
MA 104,a,200,v,104
v_add_f32 v2, v2, v146
v_add_f32 v2, v2, v147
MA 12,a,204,v,80
ds_read_b128 a[140:143], v10 offset:19456
v_cmp_gt_i32_e64 s[86:87], 1, v246
MA 44,a,204,v,88
v_exp_f32 v149, v149
MA 76,a,204,v,96
v_cvt_pk_bf16_f32 v145, v146, v147
v_cmp_gt_i32_e64 s[88:89], 2, v246
MA 108,a,204,v,104
v_exp_f32 v150, v150
MA 16,a,208,v,80
ds_read_b128 a[144:147], v10 offset:20480
v_add_f32 v2, v2, v148
MA 48,a,208,v,88
v_add_f32 v2, v2, v149
v_cmp_gt_i32_e64 s[90:91], 3, v246
MA 80,a,208,v,96
v_exp_f32 v151, v151
MA 112,a,208,v,104
buffer_load_dwordx4 v12, s[52:55], s71 offen offset:1024 sc1 lds
v_cvt_pk_bf16_f32 v146, v148, v149
MA 20,a,212,v,80
ds_read_b128 a[148:151], v10 offset:21504
v_cndmask_b32_e64 v192, v192, v14, s[84:85]
MA 52,a,212,v,88
v_cndmask_b32_e64 v193, v193, v14, s[86:87]
v_cndmask_b32_e64 v194, v194, v14, s[88:89]
MA 84,a,212,v,96
v_exp_f32 v152, v152
MA 116,a,212,v,104
v_add_f32 v2, v2, v150
v_add_f32 v2, v2, v151
MA 24,a,216,v,80
v_exp_f32 v153, v153
MA 56,a,216,v,88
ds_read_b128 a[152:155], v10 offset:22528
v_cvt_pk_bf16_f32 v147, v150, v151
MA 88,a,216,v,96
v_cndmask_b32_e64 v195, v195, v14, s[90:91]
v_add_u32 v247, -80, v13
MA 120,a,216,v,104
v_exp_f32 v154, v154
MA 28,a,220,v,80
v_add_f32 v3, v3, v152
v_add_f32 v3, v3, v153
MA 60,a,220,v,88
ds_read_b128 a[156:159], v10 offset:23552
v_cmp_gt_i32_e64 s[92:93], 0, v247
MA 92,a,220,v,96
v_exp_f32 v155, v155
MA 124,a,220,v,104
v_cvt_pk_bf16_f32 v152, v152, v153
v_cmp_gt_i32_e64 s[94:95], 1, v247
MA 0,a,224,v,112
v_exp_f32 v156, v156
MA 32,a,224,v,120
ds_read_b128 a[160:163], v10 offset:24576
v_add_f32 v3, v3, v154
MA 64,a,224,v,128
v_add_f32 v3, v3, v155
v_cmp_gt_i32_e64 s[96:97], 2, v247
MA 96,a,224,v,136
v_exp_f32 v157, v157
MA 4,a,228,v,112
buffer_load_dwordx4 v12, s[52:55], s71 offen offset:2048 sc1 lds
v_cvt_pk_bf16_f32 v153, v154, v155
MA 36,a,228,v,120
ds_read_b128 a[164:167], v10 offset:25600
v_cmp_gt_i32_e64 s[98:99], 3, v247
MA 68,a,228,v,128
v_exp_f32 v158, v158
MA 100,a,228,v,136
v_add_f32 v3, v3, v156
v_add_f32 v3, v3, v157
MA 8,a,232,v,112
ds_read_b128 a[168:171], v10 offset:26624
v_cndmask_b32_e64 v200, v200, v14, s[92:93]
MA 40,a,232,v,120
v_exp_f32 v159, v159
MA 72,a,232,v,128
v_cvt_pk_bf16_f32 v154, v156, v157
v_cndmask_b32_e64 v201, v201, v14, s[94:95]
MA 104,a,232,v,136
v_exp_f32 v160, v160
MA 12,a,236,v,112
v_add_f32 v3, v3, v158
v_cndmask_b32_e64 v202, v202, v14, s[96:97]
MA 44,a,236,v,120
ds_read_b128 a[172:175], v10 offset:27648
v_add_f32 v3, v3, v159
MA 76,a,236,v,128
v_cndmask_b32_e64 v203, v203, v14, s[98:99]
v_add_u32 v246, -112, v13
MA 108,a,236,v,136
v_exp_f32 v161, v161
MA 16,a,240,v,112
ds_read_b128 a[176:179], v10 offset:28672
v_cvt_pk_bf16_f32 v155, v158, v159
MA 48,a,240,v,120
v_exp_f32 v162, v162
MA 80,a,240,v,128
v_add_f32 v4, v4, v160
v_add_f32 v4, v4, v161
MA 112,a,240,v,136
v_cmp_gt_i32_e64 s[84:85], 0, v246
v_cmp_gt_i32_e64 s[86:87], 1, v246
MA 20,a,244,v,112
v_exp_f32 v163, v163
MA 52,a,244,v,120
ds_read_b128 a[180:183], v10 offset:29696
v_cvt_pk_bf16_f32 v160, v160, v161
MA 84,a,244,v,128
v_exp_f32 v164, v164
MA 116,a,244,v,136
buffer_load_dwordx4 v12, s[52:55], s71 offen offset:3072 sc1 lds
v_add_f32 v4, v4, v162
MA 24,a,248,v,112
v_add_f32 v4, v4, v163
v_cmp_gt_i32_e64 s[88:89], 2, v246
MA 56,a,248,v,120
v_exp_f32 v165, v165
MA 88,a,248,v,128
ds_read_b128 a[184:187], v10 offset:30720
v_cmp_gt_i32_e64 s[90:91], 3, v246
MA 120,a,248,v,136
v_cvt_pk_bf16_f32 v161, v162, v163
v_cndmask_b32_e64 v196, v196, v14, s[84:85]
MA 28,a,252,v,112
v_exp_f32 v166, v166
MA 60,a,252,v,120
v_add_f32 v4, v4, v164
v_add_f32 v4, v4, v165
MA 92,a,252,v,128
ds_read_b128 a[188:191], v10 offset:31744
v_cndmask_b32_e64 v197, v197, v14, s[86:87]
MA 124,a,252,v,136
s_cmp_eq_u32 s70, 7
v_exp_f32 v167, v167
v_cvt_pk_bf16_f32 v162, v164, v165
v_exp_f32 v168, v168
v_cndmask_b32_e64 v198, v198, v14, s[88:89]
v_add_f32 v4, v4, v166
v_cndmask_b32_e64 v199, v199, v14, s[90:91]
v_add_f32 v4, v4, v167
v_exp_f32 v169, v169
v_cvt_pk_bf16_f32 v163, v166, v167
v_add_u32 v247, -96, v13
v_exp_f32 v170, v170
v_add_f32 v5, v5, v168
v_cmp_gt_i32_e64 s[92:93], 0, v247
v_add_f32 v5, v5, v169
v_exp_f32 v171, v171
v_cmp_gt_i32_e64 s[94:95], 1, v247
v_cvt_pk_bf16_f32 v168, v168, v169
v_exp_f32 v172, v172
v_cmp_gt_i32_e64 s[96:97], 2, v247
v_add_f32 v5, v5, v170
v_cmp_gt_i32_e64 s[98:99], 3, v247
v_add_f32 v5, v5, v171
v_exp_f32 v173, v173
v_cvt_pk_bf16_f32 v169, v170, v171
v_cndmask_b32_e64 v204, v204, v14, s[92:93]
v_exp_f32 v174, v174
v_add_f32 v5, v5, v172
v_cndmask_b32_e64 v205, v205, v14, s[94:95]
v_add_f32 v5, v5, v173
v_exp_f32 v175, v175
v_cndmask_b32_e64 v206, v206, v14, s[96:97]
v_cvt_pk_bf16_f32 v170, v172, v173
v_add_f32 v5, v5, v174
v_add_f32 v5, v5, v175
v_cndmask_b32_e64 v207, v207, v14, s[98:99]
v_cvt_pk_bf16_f32 v171, v174, v175
s_cbranch_scc1 L_p3_mxm_top
s_waitcnt lgkmcnt(0)
v_xor_b32 v11, 0x8000, v11
v_mfma_f32_16x16x32_bf16 v[80:83], a[128:131], v[16:19], 0
s_add_u32 m0, s73, 16384
ds_read_b128 a[192:195], v11 offset:0
v_mfma_f32_16x16x32_bf16 v[88:91], a[128:131], v[32:35], 0
v_exp_f32 v176, v176
MV 80,a,132,v,20
v_exp_f32 v177, v177
MV 88,a,132,v,36
ds_read_b128 a[196:199], v11 offset:1024
buffer_load_dwordx4 v12, s[56:59], s71 offen offset:0 sc1 lds
MV 80,a,136,v,24
v_exp_f32 v178, v178
MV 88,a,136,v,40
v_add_f32 v2, v2, v176
v_add_f32 v2, v2, v177
MV 80,a,140,v,28
v_exp_f32 v179, v179
MV 88,a,140,v,44
ds_read_b128 a[200:203], v11 offset:2048
v_cvt_pk_bf16_f32 v176, v176, v177
v_mfma_f32_16x16x32_bf16 v[84:87], a[144:147], v[16:19], 0
v_exp_f32 v180, v180
v_mfma_f32_16x16x32_bf16 v[92:95], a[144:147], v[32:35], 0
ds_read_b128 a[204:207], v11 offset:3072
v_add_f32 v2, v2, v178
MV 84,a,148,v,20
ds_read_b128 a[208:211], v11 offset:4096
v_add_f32 v2, v2, v179
MV 92,a,148,v,36
v_exp_f32 v181, v181
MV 84,a,152,v,24
buffer_load_dwordx4 v12, s[56:59], s71 offen offset:1024 sc1 lds
v_cvt_pk_bf16_f32 v177, v178, v179
MV 92,a,152,v,40
v_exp_f32 v182, v182
MV 84,a,156,v,28
v_add_f32 v2, v2, v180
v_add_f32 v2, v2, v181
MV 92,a,156,v,44
v_exp_f32 v183, v183
v_mfma_f32_16x16x32_bf16 v[112:115], a[160:163], v[16:19], 0
ds_read_b128 a[212:215], v11 offset:5120
v_cvt_pk_bf16_f32 v178, v180, v181
v_mfma_f32_16x16x32_bf16 v[120:123], a[160:163], v[32:35], 0
v_exp_f32 v184, v184
MV 112,a,164,v,20
v_add_f32 v2, v2, v182
v_add_f32 v2, v2, v183
MV 120,a,164,v,36
v_exp_f32 v185, v185
MV 112,a,168,v,24
ds_read_b128 a[216:219], v11 offset:6144
v_cvt_pk_bf16_f32 v179, v182, v183
MV 120,a,168,v,40
v_exp_f32 v186, v186
MV 112,a,172,v,28
ds_read_b128 a[220:223], v11 offset:7168
v_add_f32 v3, v3, v184
MV 120,a,172,v,44
buffer_load_dwordx4 v12, s[56:59], s71 offen offset:2048 sc1 lds
v_add_f32 v3, v3, v185
v_mfma_f32_16x16x32_bf16 v[116:119], a[176:179], v[16:19], 0
v_exp_f32 v187, v187
v_mfma_f32_16x16x32_bf16 v[124:127], a[176:179], v[32:35], 0
ds_read_b128 a[224:227], v11 offset:8192
v_cvt_pk_bf16_f32 v184, v184, v185
MV 116,a,180,v,20
v_exp_f32 v188, v188
MV 124,a,180,v,36
v_add_f32 v3, v3, v186
v_add_f32 v3, v3, v187
MV 116,a,184,v,24
v_exp_f32 v189, v189
MV 124,a,184,v,40
ds_read_b128 a[228:231], v11 offset:9216
v_cvt_pk_bf16_f32 v185, v186, v187
MV 116,a,188,v,28
v_exp_f32 v190, v190
MV 124,a,188,v,44
ds_read_b128 a[232:235], v11 offset:10240
ds_read_b128 a[236:239], v11 offset:11264
ds_read_b128 a[240:243], v11 offset:12288
ds_read_b128 a[244:247], v11 offset:13312
ds_read_b128 a[248:251], v11 offset:14336
ds_read_b128 a[252:255], v11 offset:15360
buffer_load_dwordx4 v12, s[56:59], s71 offen offset:3072 sc1 lds
s_add_u32 s71, s71, 16384
s_xor_b32 s73, s73, 0x8000
v_add_f32 v3, v3, v188
v_add_f32 v3, v3, v189
v_exp_f32 v191, v191
v_cvt_pk_bf16_f32 v186, v188, v189
v_exp_f32 v192, v192
v_add_f32 v3, v3, v190
v_add_f32 v3, v3, v191
v_exp_f32 v193, v193
v_cvt_pk_bf16_f32 v187, v190, v191
v_exp_f32 v194, v194
v_add_f32 v4, v4, v192
v_add_f32 v4, v4, v193
v_exp_f32 v195, v195
v_cvt_pk_bf16_f32 v192, v192, v193
v_exp_f32 v196, v196
v_add_f32 v4, v4, v194
v_add_f32 v4, v4, v195
v_exp_f32 v197, v197
v_cvt_pk_bf16_f32 v193, v194, v195
v_exp_f32 v198, v198
v_add_f32 v4, v4, v196
v_add_f32 v4, v4, v197
v_exp_f32 v199, v199
v_cvt_pk_bf16_f32 v194, v196, v197
v_exp_f32 v200, v200
v_add_f32 v4, v4, v198
v_add_f32 v4, v4, v199
v_exp_f32 v201, v201
v_cvt_pk_bf16_f32 v195, v198, v199
v_exp_f32 v202, v202
v_add_f32 v5, v5, v200
v_add_f32 v5, v5, v201
v_exp_f32 v203, v203
v_cvt_pk_bf16_f32 v200, v200, v201
v_exp_f32 v204, v204
v_add_f32 v5, v5, v202
v_add_f32 v5, v5, v203
v_exp_f32 v205, v205
v_cvt_pk_bf16_f32 v201, v202, v203
v_exp_f32 v206, v206
v_add_f32 v5, v5, v204
v_add_f32 v5, v5, v205
v_exp_f32 v207, v207
v_cvt_pk_bf16_f32 v202, v204, v205
v_add_f32 v5, v5, v206
v_add_f32 v5, v5, v207
v_cvt_pk_bf16_f32 v203, v206, v207
s_waitcnt vmcnt(16) lgkmcnt(0)
MA 0,a,192,v,144
s_barrier
v_xor_b32 v10, 0x8000, v10
MA 32,a,192,v,152
s_add_u32 m0, s72, 16384
ds_read_b128 a[128:131], v10 offset:0
MA 64,a,192,v,160
v_exp_f32 v80, v80
MA 96,a,192,v,168
buffer_load_dwordx4 v12, s[52:55], s71 offen offset:0 sc1 lds
v_lshrrev_b32 v249, 2, v1
MA 4,a,196,v,144
ds_read_b128 a[132:135], v10 offset:1024
v_and_b32 v248, 7, v249
MA 36,a,196,v,152
v_lshlrev_b32 v249, 8, v249
v_and_b32 v250, 3, v1
MA 68,a,196,v,160
v_lshl_add_u32 v249, v250, 3, v249
s_lshl_b32 s36, s3, 13
MA 100,a,196,v,168
v_exp_f32 v81, v81
MA 8,a,200,v,144
ds_read_b128 a[136:139], v10 offset:2048
s_add_u32 s36, s36, 131072
MA 40,a,200,v,152
v_add_u32 v249, s36, v249
s_waitcnt vmcnt(13)
MA 72,a,200,v,160
v_exp_f32 v82, v82
MA 104,a,200,v,168
ds_read_b128 a[140:143], v10 offset:3072
v_xor_b32 v250, 0, v248
MA 12,a,204,v,144
v_lshl_add_u32 v250, v250, 5, v249
TR 96,250,0
MA 44,a,204,v,152
TR 98,250,4096
v_xor_b32 v250, 1, v248
MA 76,a,204,v,160
v_exp_f32 v83, v83
MA 108,a,204,v,168
ds_read_b128 a[144:147], v10 offset:4096
v_lshl_add_u32 v250, v250, 5, v249
MA 16,a,208,v,144
v_cvt_pk_bf16_f32 v80, v80, v81
TR 100,250,0
MA 48,a,208,v,152
buffer_load_dwordx4 v12, s[52:55], s71 offen offset:1024 sc1 lds
TR 102,250,4096
MA 80,a,208,v,160
v_xor_b32 v250, 2, v248
v_lshl_add_u32 v250, v250, 5, v249
MA 112,a,208,v,168
ds_read_b128 a[148:151], v10 offset:5120
TR 104,250,0
MA 20,a,212,v,144
v_exp_f32 v84, v84
MA 52,a,212,v,152
TR 106,250,4096
v_xor_b32 v250, 3, v248
MA 84,a,212,v,160
ds_read_b128 a[152:155], v10 offset:6144
v_lshl_add_u32 v250, v250, 5, v249
MA 116,a,212,v,168
TR 108,250,0
TR 110,250,4096
MA 24,a,216,v,144
v_exp_f32 v85, v85
MA 56,a,216,v,152
v_xor_b32 v250, 4, v248
v_lshl_add_u32 v250, v250, 5, v249
MA 88,a,216,v,160
ds_read_b128 a[156:159], v10 offset:7168
v_cvt_pk_bf16_f32 v81, v82, v83
MA 120,a,216,v,168
TR 128,250,0
TR 130,250,4096
MA 28,a,220,v,144
v_xor_b32 v250, 5, v248
v_lshl_add_u32 v250, v250, 5, v249
MA 60,a,220,v,152
v_exp_f32 v86, v86
MA 92,a,220,v,160
ds_read_b128 a[160:163], v10 offset:8192
TR 132,250,0
MA 124,a,220,v,168
TR 134,250,4096
v_xor_b32 v250, 6, v248
MA 0,a,224,v,176
buffer_load_dwordx4 v12, s[52:55], s71 offen offset:2048 sc1 lds
v_lshl_add_u32 v250, v250, 5, v249
MA 32,a,224,v,184
v_exp_f32 v87, v87
MA 64,a,224,v,192
ds_read_b128 a[164:167], v10 offset:9216
TR 136,250,0
MA 96,a,224,v,200
TR 138,250,4096
v_xor_b32 v250, 7, v248
MA 4,a,228,v,176
v_cvt_pk_bf16_f32 v82, v84, v85
v_lshl_add_u32 v250, v250, 5, v249
MA 36,a,228,v,184
ds_read_b128 a[168:171], v10 offset:10240
TR 140,250,0
MA 68,a,228,v,192
ds_read_b128 a[172:175], v10 offset:11264
TR 142,250,4096
MA 100,a,228,v,200
v_exp_f32 v88, v88
MA 8,a,232,v,176
s_add_u32 s32, s40, 100663296
s_addc_u32 s33, s41, 0
MA 40,a,232,v,184
s_mov_b32 s34, 8388608
s_mov_b32 s35, 0x20000
MA 72,a,232,v,192
s_and_b32 s36, s2, 7
s_lshl_b32 s36, s36, 20
MA 104,a,232,v,200
v_exp_f32 v89, v89
MA 12,a,236,v,176
ds_read_b128 a[176:179], v10 offset:12288
s_lshr_b32 s37, s2, 3
MA 44,a,236,v,184
v_cvt_pk_bf16_f32 v83, v86, v87
s_lshl_b32 s37, s37, 15
MA 76,a,236,v,192
s_add_u32 s36, s36, s37
s_lshl_b32 s37, s3, 12
MA 108,a,236,v,200
ds_read_b128 a[180:183], v10 offset:13312
s_add_u32 s36, s36, s37
MA 16,a,240,v,176
v_exp_f32 v90, v90
MA 48,a,240,v,184
buffer_load_dwordx4 v12, s[52:55], s71 offen offset:3072 sc1 lds
s_add_u32 s37, s36, 4096
MA 80,a,240,v,192
s_waitcnt lgkmcnt(15)
buffer_store_dwordx4 v[96:99], v12, s[32:35], s36 offen offset:0 sc1
buffer_store_dwordx4 v[100:103], v12, s[32:35], s36 offen offset:1024 sc1
MA 112,a,240,v,200
ds_read_b128 a[184:187], v10 offset:14336
buffer_store_dwordx4 v[104:107], v12, s[32:35], s36 offen offset:2048 sc1
MA 20,a,244,v,176
v_exp_f32 v91, v91
MA 52,a,244,v,184
buffer_store_dwordx4 v[108:111], v12, s[32:35], s36 offen offset:3072 sc1
s_waitcnt lgkmcnt(13)
buffer_store_dwordx4 v[128:131], v12, s[32:35], s37 offen offset:0 sc1
MA 84,a,244,v,192
s_waitcnt lgkmcnt(10)
buffer_store_dwordx4 v[132:135], v12, s[32:35], s37 offen offset:1024 sc1
s_waitcnt lgkmcnt(7)
buffer_store_dwordx4 v[136:139], v12, s[32:35], s37 offen offset:2048 sc1
MA 116,a,244,v,200
ds_read_b128 a[188:191], v10 offset:15360
v_cvt_pk_bf16_f32 v88, v88, v89
MA 24,a,248,v,176
s_xor_b32 s72, s72, 0x8000
s_waitcnt lgkmcnt(4)
buffer_store_dwordx4 v[140:143], v12, s[32:35], s37 offen offset:3072 sc1
MA 56,a,248,v,184
s_add_u32 s32, s40, 109051904
s_addc_u32 s33, s41, 0
MA 88,a,248,v,192
v_exp_f32 v92, v92
MA 120,a,248,v,200
s_mov_b32 s34, 4194304
s_mov_b32 s35, 0x20000
MA 28,a,252,v,176
s_lshl_b32 s36, s2, 14
v_mov_b32 v252, -1
MA 60,a,252,v,184
v_exp_f32 v93, v93
MA 92,a,252,v,192
v_mov_b32 v253, -1
v_mov_b32 v254, -1
MA 124,a,252,v,200
v_mov_b32 v255, -1
v_cvt_pk_bf16_f32 v89, v90, v91
buffer_store_dwordx4 v[252:255], v12, s[32:35], s36 offen offset:0 sc1
buffer_store_dwordx4 v[252:255], v12, s[32:35], s36 offen offset:1024 sc1
buffer_store_dwordx4 v[252:255], v12, s[32:35], s36 offen offset:2048 sc1
v_exp_f32 v94, v94
buffer_store_dwordx4 v[252:255], v12, s[32:35], s36 offen offset:3072 sc1
v_lshlrev_b32 v232, 4, v1
v_add_u32 v233, -8, v232
v_mov_b32 v235, 0
v_exp_f32 v95, v95
buffer_load_ushort v234, v235, s[28:31], s42 offen
buffer_load_dwordx2 v[208:209], v233, s[16:19], 0 offen
buffer_load_dwordx4 v[210:213], v232, s[16:19], 0 offen offset:0
buffer_load_dwordx2 v[214:215], v232, s[16:19], 0 offen offset:1016
v_cvt_pk_bf16_f32 v90, v92, v93
buffer_load_dwordx4 v[216:219], v232, s[16:19], 0 offen offset:1024
buffer_load_dwordx2 v[220:221], v232, s[16:19], 0 offen offset:2040
buffer_load_dwordx4 v[222:225], v232, s[16:19], 0 offen offset:2048
v_cvt_pk_bf16_f32 v91, v94, v95
buffer_load_dwordx2 v[226:227], v232, s[16:19], 0 offen offset:3064
buffer_load_dwordx4 v[228:231], v232, s[16:19], 0 offen offset:3072
L_p3_eps:
v_mov_b32 v240, v4
v_mov_b32 v241, v5
s_nop 0
v_permlane32_swap_b32 v4, v240
v_permlane32_swap_b32 v5, v241
v_add_f32 v4, v4, v240
v_add_f32 v5, v5, v241
v_mov_b32 v240, v4
v_mov_b32 v241, v5
s_nop 0
v_permlane16_swap_b32 v4, v240
v_permlane16_swap_b32 v5, v241
v_add_f32 v4, v4, v240
v_add_f32 v5, v5, v241
v_min_f32 v240, v4, v5
v_add_f32 v241, v4, v5
v_cmp_nle_f32 vcc, 0x30800000, v240
s_nop 0
s_mov_b64 s[78:79], vcc
v_cmp_nge_f32 vcc, 0x4e800000, v241
s_nop 0
s_or_b64 s[78:79], s[78:79], vcc
v_rcp_f32 v4, v4
v_rcp_f32 v5, v5
s_add_u32 s80, s101, 0x20000
s_nop 4
v_accvgpr_read_b32 v240, a64
v_accvgpr_read_b32 v241, a65
v_accvgpr_read_b32 v242, a66
v_accvgpr_read_b32 v243, a67
v_accvgpr_read_b32 v244, a68
v_accvgpr_read_b32 v245, a69
v_accvgpr_read_b32 v246, a70
v_accvgpr_read_b32 v247, a71
v_mul_f32 v240, v240, v4
v_mul_f32 v241, v241, v4
v_mul_f32 v242, v242, v4
v_mul_f32 v243, v243, v4
v_mul_f32 v244, v244, v4
v_mul_f32 v245, v245, v4
v_mul_f32 v246, v246, v4
v_mul_f32 v247, v247, v4
v_cvt_pk_bf16_f32 v248, v240, v241
v_cvt_pk_bf16_f32 v249, v242, v243
v_cvt_pk_bf16_f32 v250, v244, v245
v_cvt_pk_bf16_f32 v251, v246, v247
buffer_store_dwordx4 v[248:251], v15, s[60:63], s101 offen offset:0 sc1
v_accvgpr_read_b32 v240, a72
v_accvgpr_read_b32 v241, a73
v_accvgpr_read_b32 v242, a74
v_accvgpr_read_b32 v243, a75
v_accvgpr_read_b32 v244, a76
v_accvgpr_read_b32 v245, a77
v_accvgpr_read_b32 v246, a78
v_accvgpr_read_b32 v247, a79
v_mul_f32 v240, v240, v4
v_mul_f32 v241, v241, v4
v_mul_f32 v242, v242, v4
v_mul_f32 v243, v243, v4
v_mul_f32 v244, v244, v4
v_mul_f32 v245, v245, v4
v_mul_f32 v246, v246, v4
v_mul_f32 v247, v247, v4
v_cvt_pk_bf16_f32 v252, v240, v241
v_cvt_pk_bf16_f32 v253, v242, v243
v_cvt_pk_bf16_f32 v254, v244, v245
v_cvt_pk_bf16_f32 v255, v246, v247
buffer_store_dwordx4 v[252:255], v15, s[60:63], s101 offen offset:1024 sc1
v_accvgpr_read_b32 v240, a80
v_accvgpr_read_b32 v241, a81
v_accvgpr_read_b32 v242, a82
v_accvgpr_read_b32 v243, a83
v_accvgpr_read_b32 v244, a84
v_accvgpr_read_b32 v245, a85
v_accvgpr_read_b32 v246, a86
v_accvgpr_read_b32 v247, a87
v_mul_f32 v240, v240, v4
v_mul_f32 v241, v241, v4
v_mul_f32 v242, v242, v4
v_mul_f32 v243, v243, v4
v_mul_f32 v244, v244, v4
v_mul_f32 v245, v245, v4
v_mul_f32 v246, v246, v4
v_mul_f32 v247, v247, v4
v_cvt_pk_bf16_f32 v248, v240, v241
v_cvt_pk_bf16_f32 v249, v242, v243
v_cvt_pk_bf16_f32 v250, v244, v245
v_cvt_pk_bf16_f32 v251, v246, v247
buffer_store_dwordx4 v[248:251], v15, s[60:63], s101 offen offset:2048 sc1
v_accvgpr_read_b32 v240, a88
v_accvgpr_read_b32 v241, a89
v_accvgpr_read_b32 v242, a90
v_accvgpr_read_b32 v243, a91
v_accvgpr_read_b32 v244, a92
v_accvgpr_read_b32 v245, a93
v_accvgpr_read_b32 v246, a94
v_accvgpr_read_b32 v247, a95
v_mul_f32 v240, v240, v4
v_mul_f32 v241, v241, v4
v_mul_f32 v242, v242, v4
v_mul_f32 v243, v243, v4
v_mul_f32 v244, v244, v4
v_mul_f32 v245, v245, v4
v_mul_f32 v246, v246, v4
v_mul_f32 v247, v247, v4
v_cvt_pk_bf16_f32 v252, v240, v241
v_cvt_pk_bf16_f32 v253, v242, v243
v_cvt_pk_bf16_f32 v254, v244, v245
v_cvt_pk_bf16_f32 v255, v246, v247
buffer_store_dwordx4 v[252:255], v15, s[60:63], s101 offen offset:3072 sc1
v_accvgpr_read_b32 v240, a96
v_accvgpr_read_b32 v241, a97
v_accvgpr_read_b32 v242, a98
v_accvgpr_read_b32 v243, a99
v_accvgpr_read_b32 v244, a100
v_accvgpr_read_b32 v245, a101
v_accvgpr_read_b32 v246, a102
v_accvgpr_read_b32 v247, a103
v_mul_f32 v240, v240, v5
v_mul_f32 v241, v241, v5
v_mul_f32 v242, v242, v5
v_mul_f32 v243, v243, v5
v_mul_f32 v244, v244, v5
v_mul_f32 v245, v245, v5
v_mul_f32 v246, v246, v5
v_mul_f32 v247, v247, v5
v_cvt_pk_bf16_f32 v248, v240, v241
v_cvt_pk_bf16_f32 v249, v242, v243
v_cvt_pk_bf16_f32 v250, v244, v245
v_cvt_pk_bf16_f32 v251, v246, v247
buffer_store_dwordx4 v[248:251], v15, s[60:63], s80 offen offset:0 sc1
v_accvgpr_read_b32 v240, a104
v_accvgpr_read_b32 v241, a105
v_accvgpr_read_b32 v242, a106
v_accvgpr_read_b32 v243, a107
v_accvgpr_read_b32 v244, a108
v_accvgpr_read_b32 v245, a109
v_accvgpr_read_b32 v246, a110
v_accvgpr_read_b32 v247, a111
v_mul_f32 v240, v240, v5
v_mul_f32 v241, v241, v5
v_mul_f32 v242, v242, v5
v_mul_f32 v243, v243, v5
v_mul_f32 v244, v244, v5
v_mul_f32 v245, v245, v5
v_mul_f32 v246, v246, v5
v_mul_f32 v247, v247, v5
v_cvt_pk_bf16_f32 v252, v240, v241
v_cvt_pk_bf16_f32 v253, v242, v243
v_cvt_pk_bf16_f32 v254, v244, v245
v_cvt_pk_bf16_f32 v255, v246, v247
buffer_store_dwordx4 v[252:255], v15, s[60:63], s80 offen offset:1024 sc1
v_accvgpr_read_b32 v240, a112
v_accvgpr_read_b32 v241, a113
v_accvgpr_read_b32 v242, a114
v_accvgpr_read_b32 v243, a115
v_accvgpr_read_b32 v244, a116
v_accvgpr_read_b32 v245, a117
v_accvgpr_read_b32 v246, a118
v_accvgpr_read_b32 v247, a119
v_mul_f32 v240, v240, v5
v_mul_f32 v241, v241, v5
v_mul_f32 v242, v242, v5
v_mul_f32 v243, v243, v5
v_mul_f32 v244, v244, v5
v_mul_f32 v245, v245, v5
v_mul_f32 v246, v246, v5
v_mul_f32 v247, v247, v5
v_cvt_pk_bf16_f32 v248, v240, v241
v_cvt_pk_bf16_f32 v249, v242, v243
v_cvt_pk_bf16_f32 v250, v244, v245
v_cvt_pk_bf16_f32 v251, v246, v247
buffer_store_dwordx4 v[248:251], v15, s[60:63], s80 offen offset:2048 sc1
v_accvgpr_read_b32 v240, a120
v_accvgpr_read_b32 v241, a121
v_accvgpr_read_b32 v242, a122
v_accvgpr_read_b32 v243, a123
v_accvgpr_read_b32 v244, a124
v_accvgpr_read_b32 v245, a125
v_accvgpr_read_b32 v246, a126
v_accvgpr_read_b32 v247, a127
v_mul_f32 v240, v240, v5
v_mul_f32 v241, v241, v5
v_mul_f32 v242, v242, v5
v_mul_f32 v243, v243, v5
v_mul_f32 v244, v244, v5
v_mul_f32 v245, v245, v5
v_mul_f32 v246, v246, v5
v_mul_f32 v247, v247, v5
v_cvt_pk_bf16_f32 v252, v240, v241
v_cvt_pk_bf16_f32 v253, v242, v243
v_cvt_pk_bf16_f32 v254, v244, v245
v_cvt_pk_bf16_f32 v255, v246, v247
buffer_store_dwordx4 v[252:255], v15, s[60:63], s80 offen offset:3072 sc1
v_mov_b32 v160, 0x3f803f80
v_mov_b32 v161, 0x3f803f80
v_mov_b32 v162, 0x3f803f80
v_mov_b32 v163, 0x3f803f80
v_mov_b32 v164, 0
v_mov_b32 v165, 0
v_mov_b32 v166, 0
v_mov_b32 v167, 0
v_mov_b32 v168, 0
v_mov_b32 v169, 0
v_mov_b32 v170, 0
v_mov_b32 v171, 0
s_and_b32 s36, s2, 3
s_lshl_b32 s36, s36, 1
s_sub_u32 s32, 14, s36
s_bitcmp1_b32 s2, 4
s_cselect_b32 s36, s32, s36
s_bfe_u32 s32, s2, 0x10003
s_add_u32 s36, s36, s32
s_bfe_u32 s37, s2, 0x10002
s_lshr_b32 s32, s2, 5
s_lshl_b32 s32, s32, 1
s_add_u32 s37, s37, s32
s_lshl_b32 s36, s36, 2
s_add_u32 s36, s36, s3
s_lshl_b32 s37, s37, 7
s_lshl_b32 s32, s36, 16
s_add_u32 s37, s37, s32
s_lshl_b32 s36, s36, 7
v_and_b32 v240, 15, v1
v_bfe_u32 v241, v1, 4, 1
v_lshlrev_b32 v241, 5, v241
v_lshrrev_b32 v242, 5, v1
v_lshl_add_u32 v241, v242, 4, v241
v_lshl_add_u32 v241, v240, 11, v241
v_lshlrev_b32 v240, 2, v240
s_add_u32 s32, s40, 58720256
s_addc_u32 s33, s41, 0
s_mov_b32 s34, 8192
s_mov_b32 s35, 0x20000
buffer_load_dwordx4 v[192:195], v241, s[44:47], s37 offen offset:0
buffer_load_dwordx4 v[196:199], v241, s[44:47], s37 offen offset:64
buffer_load_dword v6, v240, s[32:35], s36 offen offset:0 sc1
s_add_u32 s37, s37, 32768
buffer_load_dwordx4 v[200:203], v241, s[44:47], s37 offen offset:0
buffer_load_dwordx4 v[204:207], v241, s[44:47], s37 offen offset:64
buffer_load_dword v7, v240, s[32:35], s36 offen offset:64 sc1
v_lshlrev_b32 v236, 20, v1
s_lshl_b32 s36, s3, 26
v_add_u32 v236, s36, v236
v_mov_b32 v237, 1
s_lshl_b32 s37, s2, 2
s_lshl_b32 s74, s70, 1
s_sub_u32 s74, 13, s74
s_cbranch_scc1 L_p3_s0m_top
.p2align 5
L_p3_s0_top:
s_waitcnt lgkmcnt(0)
v_mfma_f32_16x16x32_bf16 v[144:147], a[128:131], v[16:19], 0
s_add_u32 m0, s73, 0
ds_read_b128 a[192:195], v11 offset:16384
v_mfma_f32_16x16x32_bf16 v[152:155], a[128:131], v[32:35], 0
v_exp_f32 v112, v112
MV 144,a,132,v,20
ds_read_b128 a[196:199], v11 offset:17408
buffer_load_dwordx4 v12, s[56:59], s71 offen offset:0 sc1 lds
MV 152,a,132,v,36
v_exp_f32 v113, v113
MV 144,a,136,v,24
ds_read_b128 a[200:203], v11 offset:18432
ds_read_b128 a[204:207], v11 offset:19456
MV 152,a,136,v,40
v_exp_f32 v114, v114
MV 144,a,140,v,28
v_exp_f32 v115, v115
MV 152,a,140,v,44
ds_read_b128 a[208:211], v11 offset:20480
v_cvt_pk_bf16_f32 v112, v112, v113
v_mfma_f32_16x16x32_bf16 v[148:151], a[144:147], v[16:19], 0
ds_read_b128 a[212:215], v11 offset:21504
buffer_load_dwordx4 v12, s[56:59], s71 offen offset:1024 sc1 lds
v_mfma_f32_16x16x32_bf16 v[156:159], a[144:147], v[32:35], 0
v_exp_f32 v116, v116
MV 148,a,148,v,20
v_exp_f32 v117, v117
MV 156,a,148,v,36
ds_read_b128 a[216:219], v11 offset:22528
ds_read_b128 a[220:223], v11 offset:23552
MV 148,a,152,v,24
ds_read_b128 a[224:227], v11 offset:24576
v_cvt_pk_bf16_f32 v113, v114, v115
MV 156,a,152,v,40
v_exp_f32 v118, v118
MV 148,a,156,v,28
v_exp_f32 v119, v119
MV 156,a,156,v,44
ds_read_b128 a[228:231], v11 offset:25600
buffer_load_dwordx4 v12, s[56:59], s71 offen offset:2048 sc1 lds
v_mfma_f32_16x16x32_bf16 v[176:179], a[160:163], v[16:19], 0
ds_read_b128 a[232:235], v11 offset:26624
v_cvt_pk_bf16_f32 v114, v116, v117
v_mfma_f32_16x16x32_bf16 v[184:187], a[160:163], v[32:35], 0
v_exp_f32 v120, v120
MV 176,a,164,v,20
ds_read_b128 a[236:239], v11 offset:27648
ds_read_b128 a[240:243], v11 offset:28672
MV 184,a,164,v,36
v_exp_f32 v121, v121
MV 176,a,168,v,24
ds_read_b128 a[244:247], v11 offset:29696
v_cvt_pk_bf16_f32 v115, v118, v119
MV 184,a,168,v,40
ds_read_b128 a[248:251], v11 offset:30720
buffer_load_dwordx4 v12, s[56:59], s71 offen offset:3072 sc1 lds
MV 176,a,172,v,28
v_exp_f32 v122, v122
MV 184,a,172,v,44
v_exp_f32 v123, v123
v_mfma_f32_16x16x32_bf16 v[180:183], a[176:179], v[16:19], 0
ds_read_b128 a[252:255], v11 offset:31744
v_cvt_pk_bf16_f32 v120, v120, v121
v_mfma_f32_16x16x32_bf16 v[188:191], a[176:179], v[32:35], 0
v_exp_f32 v124, v124
MV 180,a,180,v,20
v_exp_f32 v125, v125
MV 188,a,180,v,36
s_add_u32 s71, s71, 16384
v_cvt_pk_bf16_f32 v121, v122, v123
MV 180,a,184,v,24
v_exp_f32 v126, v126
MV 188,a,184,v,40
v_exp_f32 v127, v127
MV 180,a,188,v,28
v_cvt_pk_bf16_f32 v122, v124, v125
v_cvt_pk_bf16_f32 v123, v126, v127
MV 188,a,188,v,44
s_waitcnt vmcnt(16) lgkmcnt(0)
MA 0,a,192,v,80
s_barrier
MA 32,a,192,v,88
s_add_u32 m0, s72, 0
ds_read_b128 a[128:131], v10 offset:16384
MA 4,a,196,v,80
v_exp_f32 v144, v144
MA 36,a,196,v,88
ds_read_b128 a[132:135], v10 offset:17408
buffer_load_dwordx4 v12, s[52:55], s71 offen offset:0 sc1 lds
MA 8,a,200,v,80
v_exp_f32 v145, v145
MA 40,a,200,v,88
ds_read_b128 a[136:139], v10 offset:18432
ds_read_b128 a[140:143], v10 offset:19456
MA 12,a,204,v,80
v_exp_f32 v146, v146
MA 44,a,204,v,88
v_exp_f32 v147, v147
MV 164,v,160,v,80
ds_read_b128 a[144:147], v10 offset:20480
buffer_load_dwordx4 v12, s[52:55], s71 offen offset:1024 sc1 lds
MV 168,v,160,v,88
ds_read_b128 a[148:151], v10 offset:21504
v_cvt_pk_bf16_f32 v144, v144, v145
MA 16,a,208,v,80
v_exp_f32 v148, v148
MA 48,a,208,v,88
ds_read_b128 a[152:155], v10 offset:22528
ds_read_b128 a[156:159], v10 offset:23552
MA 20,a,212,v,80
v_exp_f32 v149, v149
MA 52,a,212,v,88
ds_read_b128 a[160:163], v10 offset:24576
v_cvt_pk_bf16_f32 v145, v146, v147
MA 24,a,216,v,80
v_exp_f32 v150, v150
MA 56,a,216,v,88
ds_read_b128 a[164:167], v10 offset:25600
buffer_load_dwordx4 v12, s[52:55], s71 offen offset:2048 sc1 lds
MA 28,a,220,v,80
v_exp_f32 v151, v151
MA 60,a,220,v,88
ds_read_b128 a[168:171], v10 offset:26624
v_cvt_pk_bf16_f32 v146, v148, v149
MA 0,a,224,v,112
v_exp_f32 v152, v152
MA 32,a,224,v,120
ds_read_b128 a[172:175], v10 offset:27648
ds_read_b128 a[176:179], v10 offset:28672
MA 4,a,228,v,112
v_exp_f32 v153, v153
MA 36,a,228,v,120
ds_read_b128 a[180:183], v10 offset:29696
v_cvt_pk_bf16_f32 v147, v150, v151
MA 8,a,232,v,112
ds_read_b128 a[184:187], v10 offset:30720
buffer_load_dwordx4 v12, s[52:55], s71 offen offset:3072 sc1 lds
MA 40,a,232,v,120
v_exp_f32 v154, v154
MA 12,a,236,v,112
v_exp_f32 v155, v155
MA 44,a,236,v,120
ds_read_b128 a[188:191], v10 offset:31744
v_cvt_pk_bf16_f32 v152, v152, v153
MV 164,v,160,v,112
v_exp_f32 v156, v156
MV 168,v,160,v,120
MA 16,a,240,v,112
v_exp_f32 v157, v157
MA 48,a,240,v,120
s_sub_u32 s74, s74, 1
v_cvt_pk_bf16_f32 v153, v154, v155
MA 20,a,244,v,112
v_exp_f32 v158, v158
MA 52,a,244,v,120
MA 24,a,248,v,112
v_exp_f32 v159, v159
MA 56,a,248,v,120
MA 28,a,252,v,112
v_cvt_pk_bf16_f32 v154, v156, v157
v_cvt_pk_bf16_f32 v155, v158, v159
MA 60,a,252,v,120
s_cbranch_scc1 L_p3_s1m_top
s_waitcnt lgkmcnt(0)
v_xor_b32 v11, 0x8000, v11
v_mfma_f32_16x16x32_bf16 v[80:83], a[128:131], v[16:19], 0
s_add_u32 m0, s73, 16384
ds_read_b128 a[192:195], v11 offset:0
v_mfma_f32_16x16x32_bf16 v[88:91], a[128:131], v[32:35], 0
v_exp_f32 v176, v176
MV 80,a,132,v,20
ds_read_b128 a[196:199], v11 offset:1024
buffer_load_dwordx4 v12, s[56:59], s71 offen offset:0 sc1 lds
MV 88,a,132,v,36
v_exp_f32 v177, v177
MV 80,a,136,v,24
ds_read_b128 a[200:203], v11 offset:2048
ds_read_b128 a[204:207], v11 offset:3072
MV 88,a,136,v,40
v_exp_f32 v178, v178
MV 80,a,140,v,28
v_exp_f32 v179, v179
MV 88,a,140,v,44
ds_read_b128 a[208:211], v11 offset:4096
buffer_load_dwordx4 v12, s[56:59], s71 offen offset:1024 sc1 lds
v_mfma_f32_16x16x32_bf16 v[84:87], a[144:147], v[16:19], 0
ds_read_b128 a[212:215], v11 offset:5120
v_cvt_pk_bf16_f32 v176, v176, v177
v_mfma_f32_16x16x32_bf16 v[92:95], a[144:147], v[32:35], 0
v_exp_f32 v180, v180
MV 84,a,148,v,20
v_exp_f32 v181, v181
MV 92,a,148,v,36
ds_read_b128 a[216:219], v11 offset:6144
ds_read_b128 a[220:223], v11 offset:7168
MV 84,a,152,v,24
buffer_load_dwordx4 v12, s[56:59], s71 offen offset:2048 sc1 lds
v_cvt_pk_bf16_f32 v177, v178, v179
MV 92,a,152,v,40
v_exp_f32 v182, v182
MV 84,a,156,v,28
ds_read_b128 a[224:227], v11 offset:8192
ds_read_b128 a[228:231], v11 offset:9216
MV 92,a,156,v,44
v_exp_f32 v183, v183
v_mfma_f32_16x16x32_bf16 v[112:115], a[160:163], v[16:19], 0
ds_read_b128 a[232:235], v11 offset:10240
v_cvt_pk_bf16_f32 v178, v180, v181
v_mfma_f32_16x16x32_bf16 v[120:123], a[160:163], v[32:35], 0
v_exp_f32 v184, v184
MV 112,a,164,v,20
ds_read_b128 a[236:239], v11 offset:11264
buffer_load_dwordx4 v12, s[56:59], s71 offen offset:3072 sc1 lds
MV 120,a,164,v,36
v_exp_f32 v185, v185
MV 112,a,168,v,24
ds_read_b128 a[240:243], v11 offset:12288
v_cvt_pk_bf16_f32 v179, v182, v183
MV 120,a,168,v,40
ds_read_b128 a[244:247], v11 offset:13312
ds_read_b128 a[248:251], v11 offset:14336
MV 112,a,172,v,28
v_exp_f32 v186, v186
MV 120,a,172,v,44
v_exp_f32 v187, v187
v_mfma_f32_16x16x32_bf16 v[116:119], a[176:179], v[16:19], 0
ds_read_b128 a[252:255], v11 offset:15360
s_add_u32 s71, s71, 16384
v_mfma_f32_16x16x32_bf16 v[124:127], a[176:179], v[32:35], 0
s_xor_b32 s73, s73, 0x8000
v_cvt_pk_bf16_f32 v184, v184, v185
MV 116,a,180,v,20
v_exp_f32 v188, v188
MV 124,a,180,v,36
v_exp_f32 v189, v189
MV 116,a,184,v,24
v_cvt_pk_bf16_f32 v185, v186, v187
MV 124,a,184,v,40
v_exp_f32 v190, v190
MV 116,a,188,v,28
v_exp_f32 v191, v191
MV 124,a,188,v,44
v_cvt_pk_bf16_f32 v186, v188, v189
v_cvt_pk_bf16_f32 v187, v190, v191
s_waitcnt vmcnt(16) lgkmcnt(0)
MA 0,a,192,v,144
s_barrier
v_xor_b32 v10, 0x8000, v10
MA 32,a,192,v,152
s_add_u32 m0, s72, 16384
ds_read_b128 a[128:131], v10 offset:0
MA 4,a,196,v,144
v_exp_f32 v80, v80
MA 36,a,196,v,152
ds_read_b128 a[132:135], v10 offset:1024
buffer_load_dwordx4 v12, s[52:55], s71 offen offset:0 sc1 lds
MA 8,a,200,v,144
v_exp_f32 v81, v81
MA 40,a,200,v,152
ds_read_b128 a[136:139], v10 offset:2048
ds_read_b128 a[140:143], v10 offset:3072
MA 12,a,204,v,144
v_exp_f32 v82, v82
MA 44,a,204,v,152
v_exp_f32 v83, v83
MV 164,v,160,v,144
ds_read_b128 a[144:147], v10 offset:4096
buffer_load_dwordx4 v12, s[52:55], s71 offen offset:1024 sc1 lds
MV 168,v,160,v,152
ds_read_b128 a[148:151], v10 offset:5120
v_cvt_pk_bf16_f32 v80, v80, v81
MA 16,a,208,v,144
v_exp_f32 v84, v84
MA 48,a,208,v,152
ds_read_b128 a[152:155], v10 offset:6144
ds_read_b128 a[156:159], v10 offset:7168
MA 20,a,212,v,144
v_exp_f32 v85, v85
MA 52,a,212,v,152
buffer_load_dwordx4 v12, s[52:55], s71 offen offset:2048 sc1 lds
v_cvt_pk_bf16_f32 v81, v82, v83
MA 24,a,216,v,144
v_exp_f32 v86, v86
MA 56,a,216,v,152
ds_read_b128 a[160:163], v10 offset:8192
ds_read_b128 a[164:167], v10 offset:9216
MA 28,a,220,v,144
v_exp_f32 v87, v87
MA 60,a,220,v,152
ds_read_b128 a[168:171], v10 offset:10240
v_cvt_pk_bf16_f32 v82, v84, v85
MA 0,a,224,v,176
v_exp_f32 v88, v88
MA 32,a,224,v,184
ds_read_b128 a[172:175], v10 offset:11264
buffer_load_dwordx4 v12, s[52:55], s71 offen offset:3072 sc1 lds
MA 4,a,228,v,176
v_exp_f32 v89, v89
MA 36,a,228,v,184
ds_read_b128 a[176:179], v10 offset:12288
v_cvt_pk_bf16_f32 v83, v86, v87
MA 8,a,232,v,176
ds_read_b128 a[180:183], v10 offset:13312
ds_read_b128 a[184:187], v10 offset:14336
MA 40,a,232,v,184
v_exp_f32 v90, v90
MA 12,a,236,v,176
v_exp_f32 v91, v91
MA 44,a,236,v,184
ds_read_b128 a[188:191], v10 offset:15360
s_xor_b32 s72, s72, 0x8000
MV 164,v,160,v,176
buffer_store_dword v237, v236, s[8:11], s37 offen offset:1024 sc1
v_cvt_pk_bf16_f32 v88, v88, v89
MV 168,v,160,v,184
v_exp_f32 v92, v92
MA 16,a,240,v,176
v_exp_f32 v93, v93
MA 48,a,240,v,184
v_cvt_pk_bf16_f32 v89, v90, v91
MA 20,a,244,v,176
v_exp_f32 v94, v94
MA 52,a,244,v,184
MA 24,a,248,v,176
v_exp_f32 v95, v95
MA 56,a,248,v,184
MA 28,a,252,v,176
v_cvt_pk_bf16_f32 v90, v92, v93
v_cvt_pk_bf16_f32 v91, v94, v95
MA 60,a,252,v,184
s_branch L_p3_s0_top
L_p3_s1m_top:
s_waitcnt lgkmcnt(0)
v_xor_b32 v11, 0x8000, v11
v_mfma_f32_16x16x32_bf16 v[80:83], a[128:131], v[16:19], 0
s_add_u32 m0, s73, 16384
ds_read_b128 a[192:195], v11 offset:0
v_mfma_f32_16x16x32_bf16 v[88:91], a[128:131], v[32:35], 0
v_exp_f32 v176, v176
MV 80,a,132,v,20
ds_read_b128 a[196:199], v11 offset:1024
buffer_load_dwordx4 v12, s[56:59], s71 offen offset:0 sc1 lds
MV 88,a,132,v,36
v_exp_f32 v177, v177
MV 80,a,136,v,24
ds_read_b128 a[200:203], v11 offset:2048
ds_read_b128 a[204:207], v11 offset:3072
MV 88,a,136,v,40
v_exp_f32 v178, v178
MV 80,a,140,v,28
v_exp_f32 v179, v179
MV 88,a,140,v,44
ds_read_b128 a[208:211], v11 offset:4096
buffer_load_dwordx4 v12, s[56:59], s71 offen offset:1024 sc1 lds
v_mfma_f32_16x16x32_bf16 v[84:87], a[144:147], v[16:19], 0
ds_read_b128 a[212:215], v11 offset:5120
v_cvt_pk_bf16_f32 v176, v176, v177
v_mfma_f32_16x16x32_bf16 v[92:95], a[144:147], v[32:35], 0
v_exp_f32 v180, v180
MV 84,a,148,v,20
v_exp_f32 v181, v181
MV 92,a,148,v,36
ds_read_b128 a[216:219], v11 offset:6144
ds_read_b128 a[220:223], v11 offset:7168
MV 84,a,152,v,24
buffer_load_dwordx4 v12, s[56:59], s71 offen offset:2048 sc1 lds
v_cvt_pk_bf16_f32 v177, v178, v179
MV 92,a,152,v,40
v_exp_f32 v182, v182
MV 84,a,156,v,28
ds_read_b128 a[224:227], v11 offset:8192
ds_read_b128 a[228:231], v11 offset:9216
MV 92,a,156,v,44
v_exp_f32 v183, v183
v_mfma_f32_16x16x32_bf16 v[112:115], a[160:163], v[16:19], 0
ds_read_b128 a[232:235], v11 offset:10240
v_cvt_pk_bf16_f32 v178, v180, v181
v_mfma_f32_16x16x32_bf16 v[120:123], a[160:163], v[32:35], 0
v_exp_f32 v184, v184
MV 112,a,164,v,20
ds_read_b128 a[236:239], v11 offset:11264
buffer_load_dwordx4 v12, s[56:59], s71 offen offset:3072 sc1 lds
MV 120,a,164,v,36
v_exp_f32 v185, v185
MV 112,a,168,v,24
ds_read_b128 a[240:243], v11 offset:12288
v_cvt_pk_bf16_f32 v179, v182, v183
MV 120,a,168,v,40
ds_read_b128 a[244:247], v11 offset:13312
ds_read_b128 a[248:251], v11 offset:14336
MV 112,a,172,v,28
v_exp_f32 v186, v186
MV 120,a,172,v,44
v_exp_f32 v187, v187
v_mfma_f32_16x16x32_bf16 v[116:119], a[176:179], v[16:19], 0
ds_read_b128 a[252:255], v11 offset:15360
s_add_u32 s71, s71, 16384
v_mfma_f32_16x16x32_bf16 v[124:127], a[176:179], v[32:35], 0
v_cvt_pk_bf16_f32 v184, v184, v185
v_add_u32 v246, 0, v13
MV 116,a,180,v,20
v_cmp_gt_i32_e64 s[84:85], 0, v246
v_cmp_gt_i32_e64 s[86:87], 1, v246
MV 124,a,180,v,36
v_cmp_gt_i32_e64 s[88:89], 2, v246
v_cmp_gt_i32_e64 s[90:91], 3, v246
MV 116,a,184,v,24
v_cndmask_b32_e64 v80, v80, v14, s[84:85]
v_cndmask_b32_e64 v81, v81, v14, s[86:87]
MV 124,a,184,v,40
v_cndmask_b32_e64 v82, v82, v14, s[88:89]
v_cndmask_b32_e64 v83, v83, v14, s[90:91]
MV 116,a,188,v,28
v_exp_f32 v188, v188
MV 124,a,188,v,44
s_xor_b32 s73, s73, 0x8000
v_exp_f32 v189, v189
v_add_u32 v247, 16, v13
v_cmp_gt_i32_e64 s[92:93], 0, v247
v_cmp_gt_i32_e64 s[94:95], 1, v247
v_cmp_gt_i32_e64 s[96:97], 2, v247
v_cmp_gt_i32_e64 s[98:99], 3, v247
v_cndmask_b32_e64 v88, v88, v14, s[92:93]
v_cvt_pk_bf16_f32 v185, v186, v187
v_cndmask_b32_e64 v89, v89, v14, s[94:95]
v_cndmask_b32_e64 v90, v90, v14, s[96:97]
v_cndmask_b32_e64 v91, v91, v14, s[98:99]
v_exp_f32 v190, v190
v_add_u32 v246, -16, v13
v_cmp_gt_i32_e64 s[84:85], 0, v246
v_cmp_gt_i32_e64 s[86:87], 1, v246
v_cmp_gt_i32_e64 s[88:89], 2, v246
v_exp_f32 v191, v191
v_cmp_gt_i32_e64 s[90:91], 3, v246
v_cndmask_b32_e64 v84, v84, v14, s[84:85]
v_cndmask_b32_e64 v85, v85, v14, s[86:87]
v_cndmask_b32_e64 v86, v86, v14, s[88:89]
v_cndmask_b32_e64 v87, v87, v14, s[90:91]
v_add_u32 v247, 0, v13
v_cmp_gt_i32_e64 s[92:93], 0, v247
v_cvt_pk_bf16_f32 v186, v188, v189
v_cmp_gt_i32_e64 s[94:95], 1, v247
v_cmp_gt_i32_e64 s[96:97], 2, v247
v_cmp_gt_i32_e64 s[98:99], 3, v247
v_cndmask_b32_e64 v92, v92, v14, s[92:93]
v_cvt_pk_bf16_f32 v187, v190, v191
v_cndmask_b32_e64 v93, v93, v14, s[94:95]
v_cndmask_b32_e64 v94, v94, v14, s[96:97]
v_cndmask_b32_e64 v95, v95, v14, s[98:99]
s_waitcnt vmcnt(16) lgkmcnt(0)
MA 0,a,192,v,144
s_barrier
v_xor_b32 v10, 0x8000, v10
MA 32,a,192,v,152
s_add_u32 m0, s72, 16384
ds_read_b128 a[128:131], v10 offset:0
MA 4,a,196,v,144
v_exp_f32 v80, v80
MA 36,a,196,v,152
ds_read_b128 a[132:135], v10 offset:1024
buffer_load_dwordx4 v12, s[52:55], s71 offen offset:0 sc1 lds
MA 8,a,200,v,144
v_exp_f32 v81, v81
MA 40,a,200,v,152
ds_read_b128 a[136:139], v10 offset:2048
ds_read_b128 a[140:143], v10 offset:3072
MA 12,a,204,v,144
v_exp_f32 v82, v82
MA 44,a,204,v,152
v_add_u32 v246, -32, v13
v_cmp_gt_i32_e64 s[84:85], 0, v246
MV 164,v,160,v,144
v_exp_f32 v83, v83
MV 168,v,160,v,152
ds_read_b128 a[144:147], v10 offset:4096
v_cmp_gt_i32_e64 s[86:87], 1, v246
MA 16,a,208,v,144
buffer_load_dwordx4 v12, s[52:55], s71 offen offset:1024 sc1 lds
v_cvt_pk_bf16_f32 v80, v80, v81
MA 48,a,208,v,152
ds_read_b128 a[148:151], v10 offset:5120
v_cmp_gt_i32_e64 s[88:89], 2, v246
MA 20,a,212,v,144
v_exp_f32 v84, v84
MA 52,a,212,v,152
ds_read_b128 a[152:155], v10 offset:6144
v_cmp_gt_i32_e64 s[90:91], 3, v246
MA 24,a,216,v,144
v_cndmask_b32_e64 v112, v112, v14, s[84:85]
v_cndmask_b32_e64 v113, v113, v14, s[86:87]
MA 56,a,216,v,152
v_exp_f32 v85, v85
MA 28,a,220,v,144
ds_read_b128 a[156:159], v10 offset:7168
v_cndmask_b32_e64 v114, v114, v14, s[88:89]
MA 60,a,220,v,152
v_cvt_pk_bf16_f32 v81, v82, v83
v_cndmask_b32_e64 v115, v115, v14, s[90:91]
MA 0,a,224,v,176
ds_read_b128 a[160:163], v10 offset:8192
v_add_u32 v247, -16, v13
MA 32,a,224,v,184
v_exp_f32 v86, v86
MA 4,a,228,v,176
ds_read_b128 a[164:167], v10 offset:9216
v_cmp_gt_i32_e64 s[92:93], 0, v247
MA 36,a,228,v,184
buffer_load_dwordx4 v12, s[52:55], s71 offen offset:2048 sc1 lds
v_cmp_gt_i32_e64 s[94:95], 1, v247
MA 8,a,232,v,176
v_exp_f32 v87, v87
MA 40,a,232,v,184
v_cvt_pk_bf16_f32 v82, v84, v85
v_cmp_gt_i32_e64 s[96:97], 2, v247
MA 12,a,236,v,176
ds_read_b128 a[168:171], v10 offset:10240
v_cmp_gt_i32_e64 s[98:99], 3, v247
MA 44,a,236,v,184
ds_read_b128 a[172:175], v10 offset:11264
v_cndmask_b32_e64 v120, v120, v14, s[92:93]
MV 164,v,160,v,176
v_exp_f32 v88, v88
MV 168,v,160,v,184
v_cndmask_b32_e64 v121, v121, v14, s[94:95]
v_cndmask_b32_e64 v122, v122, v14, s[96:97]
MA 16,a,240,v,176
v_exp_f32 v89, v89
MA 48,a,240,v,184
ds_read_b128 a[176:179], v10 offset:12288
v_cndmask_b32_e64 v123, v123, v14, s[98:99]
MA 20,a,244,v,176
v_cvt_pk_bf16_f32 v83, v86, v87
v_add_u32 v246, -48, v13
MA 52,a,244,v,184
ds_read_b128 a[180:183], v10 offset:13312
v_cmp_gt_i32_e64 s[84:85], 0, v246
MA 24,a,248,v,176
buffer_load_dwordx4 v12, s[52:55], s71 offen offset:3072 sc1 lds
v_cmp_gt_i32_e64 s[86:87], 1, v246
MA 56,a,248,v,184
v_exp_f32 v90, v90
MA 28,a,252,v,176
ds_read_b128 a[184:187], v10 offset:14336
v_cmp_gt_i32_e64 s[88:89], 2, v246
MA 60,a,252,v,184
ds_read_b128 a[188:191], v10 offset:15360
s_xor_b32 s72, s72, 0x8000
v_exp_f32 v91, v91
v_cmp_gt_i32_e64 s[90:91], 3, v246
v_cvt_pk_bf16_f32 v88, v88, v89
v_cndmask_b32_e64 v116, v116, v14, s[84:85]
v_exp_f32 v92, v92
v_cndmask_b32_e64 v117, v117, v14, s[86:87]
v_cndmask_b32_e64 v118, v118, v14, s[88:89]
v_cndmask_b32_e64 v119, v119, v14, s[90:91]
v_exp_f32 v93, v93
v_add_u32 v247, -32, v13
v_cvt_pk_bf16_f32 v89, v90, v91
v_cmp_gt_i32_e64 s[92:93], 0, v247
v_exp_f32 v94, v94
v_cmp_gt_i32_e64 s[94:95], 1, v247
v_cmp_gt_i32_e64 s[96:97], 2, v247
v_cmp_gt_i32_e64 s[98:99], 3, v247
v_exp_f32 v95, v95
v_cndmask_b32_e64 v124, v124, v14, s[92:93]
v_cndmask_b32_e64 v125, v125, v14, s[94:95]
v_cvt_pk_bf16_f32 v90, v92, v93
v_cndmask_b32_e64 v126, v126, v14, s[96:97]
v_cvt_pk_bf16_f32 v91, v94, v95
v_cndmask_b32_e64 v127, v127, v14, s[98:99]
L_p3_s0m_top:
s_waitcnt lgkmcnt(0)
v_mfma_f32_16x16x32_bf16 v[144:147], a[128:131], v[16:19], 0
s_add_u32 m0, s73, 0
ds_read_b128 a[192:195], v11 offset:16384
v_mfma_f32_16x16x32_bf16 v[152:155], a[128:131], v[32:35], 0
v_exp_f32 v112, v112
MV 144,a,132,v,20
ds_read_b128 a[196:199], v11 offset:17408
buffer_load_dwordx4 v12, s[56:59], s71 offen offset:0 sc1 lds
MV 152,a,132,v,36
v_exp_f32 v113, v113
MV 144,a,136,v,24
ds_read_b128 a[200:203], v11 offset:18432
ds_read_b128 a[204:207], v11 offset:19456
MV 152,a,136,v,40
v_exp_f32 v114, v114
MV 144,a,140,v,28
v_exp_f32 v115, v115
MV 152,a,140,v,44
ds_read_b128 a[208:211], v11 offset:20480
v_cvt_pk_bf16_f32 v112, v112, v113
v_mfma_f32_16x16x32_bf16 v[148:151], a[144:147], v[16:19], 0
ds_read_b128 a[212:215], v11 offset:21504
buffer_load_dwordx4 v12, s[56:59], s71 offen offset:1024 sc1 lds
v_mfma_f32_16x16x32_bf16 v[156:159], a[144:147], v[32:35], 0
v_exp_f32 v116, v116
MV 148,a,148,v,20
v_exp_f32 v117, v117
MV 156,a,148,v,36
ds_read_b128 a[216:219], v11 offset:22528
ds_read_b128 a[220:223], v11 offset:23552
MV 148,a,152,v,24
ds_read_b128 a[224:227], v11 offset:24576
v_cvt_pk_bf16_f32 v113, v114, v115
MV 156,a,152,v,40
v_exp_f32 v118, v118
MV 148,a,156,v,28
v_exp_f32 v119, v119
MV 156,a,156,v,44
ds_read_b128 a[228:231], v11 offset:25600
buffer_load_dwordx4 v12, s[56:59], s71 offen offset:2048 sc1 lds
v_mfma_f32_16x16x32_bf16 v[176:179], a[160:163], v[16:19], 0
ds_read_b128 a[232:235], v11 offset:26624
v_cvt_pk_bf16_f32 v114, v116, v117
v_mfma_f32_16x16x32_bf16 v[184:187], a[160:163], v[32:35], 0
v_exp_f32 v120, v120
MV 176,a,164,v,20
ds_read_b128 a[236:239], v11 offset:27648
ds_read_b128 a[240:243], v11 offset:28672
MV 184,a,164,v,36
v_exp_f32 v121, v121
MV 176,a,168,v,24
ds_read_b128 a[244:247], v11 offset:29696
v_cvt_pk_bf16_f32 v115, v118, v119
MV 184,a,168,v,40
ds_read_b128 a[248:251], v11 offset:30720
buffer_load_dwordx4 v12, s[56:59], s71 offen offset:3072 sc1 lds
MV 176,a,172,v,28
v_exp_f32 v122, v122
MV 184,a,172,v,44
v_exp_f32 v123, v123
v_mfma_f32_16x16x32_bf16 v[180:183], a[176:179], v[16:19], 0
ds_read_b128 a[252:255], v11 offset:31744
v_cvt_pk_bf16_f32 v120, v120, v121
v_mfma_f32_16x16x32_bf16 v[188:191], a[176:179], v[32:35], 0
v_add_u32 v246, -64, v13
v_cmp_gt_i32_e64 s[84:85], 0, v246
MV 180,a,180,v,20
v_cmp_gt_i32_e64 s[86:87], 1, v246
v_cmp_gt_i32_e64 s[88:89], 2, v246
MV 188,a,180,v,36
v_cmp_gt_i32_e64 s[90:91], 3, v246
v_cndmask_b32_e64 v144, v144, v14, s[84:85]
MV 180,a,184,v,24
v_cndmask_b32_e64 v145, v145, v14, s[86:87]
v_cndmask_b32_e64 v146, v146, v14, s[88:89]
MV 188,a,184,v,40
v_exp_f32 v124, v124
MV 180,a,188,v,28
v_cndmask_b32_e64 v147, v147, v14, s[90:91]
v_add_u32 v247, -48, v13
MV 188,a,188,v,44
s_add_u32 s71, s71, 16384
v_exp_f32 v125, v125
v_cmp_gt_i32_e64 s[92:93], 0, v247
v_cmp_gt_i32_e64 s[94:95], 1, v247
v_cmp_gt_i32_e64 s[96:97], 2, v247
v_cmp_gt_i32_e64 s[98:99], 3, v247
v_cndmask_b32_e64 v152, v152, v14, s[92:93]
v_cvt_pk_bf16_f32 v121, v122, v123
v_cndmask_b32_e64 v153, v153, v14, s[94:95]
v_cndmask_b32_e64 v154, v154, v14, s[96:97]
v_cndmask_b32_e64 v155, v155, v14, s[98:99]
v_exp_f32 v126, v126
v_add_u32 v246, -80, v13
v_cmp_gt_i32_e64 s[84:85], 0, v246
v_cmp_gt_i32_e64 s[86:87], 1, v246
v_cmp_gt_i32_e64 s[88:89], 2, v246
v_exp_f32 v127, v127
v_cmp_gt_i32_e64 s[90:91], 3, v246
v_cndmask_b32_e64 v148, v148, v14, s[84:85]
v_cndmask_b32_e64 v149, v149, v14, s[86:87]
v_cndmask_b32_e64 v150, v150, v14, s[88:89]
v_cndmask_b32_e64 v151, v151, v14, s[90:91]
v_add_u32 v247, -64, v13
v_cmp_gt_i32_e64 s[92:93], 0, v247
v_cvt_pk_bf16_f32 v122, v124, v125
v_cmp_gt_i32_e64 s[94:95], 1, v247
v_cmp_gt_i32_e64 s[96:97], 2, v247
v_cmp_gt_i32_e64 s[98:99], 3, v247
v_cndmask_b32_e64 v156, v156, v14, s[92:93]
v_cvt_pk_bf16_f32 v123, v126, v127
v_cndmask_b32_e64 v157, v157, v14, s[94:95]
v_cndmask_b32_e64 v158, v158, v14, s[96:97]
v_cndmask_b32_e64 v159, v159, v14, s[98:99]
s_waitcnt vmcnt(16) lgkmcnt(0)
MA 0,a,192,v,80
s_barrier
MA 32,a,192,v,88
s_add_u32 m0, s72, 0
ds_read_b128 a[128:131], v10 offset:16384
MA 4,a,196,v,80
v_exp_f32 v144, v144
MA 36,a,196,v,88
ds_read_b128 a[132:135], v10 offset:17408
buffer_load_dwordx4 v12, s[52:55], s71 offen offset:0 sc1 lds
MA 8,a,200,v,80
v_exp_f32 v145, v145
MA 40,a,200,v,88
ds_read_b128 a[136:139], v10 offset:18432
ds_read_b128 a[140:143], v10 offset:19456
MA 12,a,204,v,80
v_exp_f32 v146, v146
MA 44,a,204,v,88
buffer_load_dwordx4 v12, s[52:55], s71 offen offset:1024 sc1 lds
v_add_u32 v246, -96, v13
MV 164,v,160,v,80
ds_read_b128 a[144:147], v10 offset:20480
v_cmp_gt_i32_e64 s[84:85], 0, v246
MV 168,v,160,v,88
v_exp_f32 v147, v147
MA 16,a,208,v,80
buffer_load_dwordx4 v12, s[52:55], s71 offen offset:2048 sc1 lds
v_cmp_gt_i32_e64 s[86:87], 1, v246
MA 48,a,208,v,88
v_cvt_pk_bf16_f32 v144, v144, v145
v_cmp_gt_i32_e64 s[88:89], 2, v246
MA 20,a,212,v,80
v_exp_f32 v148, v148
MA 52,a,212,v,88
ds_read_b128 a[148:151], v10 offset:21504
v_cmp_gt_i32_e64 s[90:91], 3, v246
MA 24,a,216,v,80
ds_read_b128 a[152:155], v10 offset:22528
v_cndmask_b32_e64 v176, v176, v14, s[84:85]
MA 56,a,216,v,88
v_exp_f32 v149, v149
MA 28,a,220,v,80
buffer_load_dwordx4 v12, s[52:55], s71 offen offset:3072 sc1 lds
v_cndmask_b32_e64 v177, v177, v14, s[86:87]
MA 60,a,220,v,88
ds_read_b128 a[156:159], v10 offset:23552
v_cndmask_b32_e64 v178, v178, v14, s[88:89]
MA 0,a,224,v,112
v_cvt_pk_bf16_f32 v145, v146, v147
v_cndmask_b32_e64 v179, v179, v14, s[90:91]
MA 32,a,224,v,120
ds_read_b128 a[160:163], v10 offset:24576
v_add_u32 v247, -80, v13
MA 4,a,228,v,112
v_exp_f32 v150, v150
MA 36,a,228,v,120
v_lshlrev_b32 v245, 4, v1
v_cmp_gt_i32_e64 s[92:93], 0, v247
MA 8,a,232,v,112
ds_read_b128 a[164:167], v10 offset:25600
v_cmp_gt_i32_e64 s[94:95], 1, v247
MA 40,a,232,v,120
v_exp_f32 v151, v151
MA 12,a,236,v,112
v_cvt_pk_bf16_f32 v146, v148, v149
v_cmp_gt_i32_e64 s[96:97], 2, v247
MA 44,a,236,v,120
ds_read_b128 a[168:171], v10 offset:26624
v_cmp_gt_i32_e64 s[98:99], 3, v247
MV 164,v,160,v,112
s_mov_b32 m0, s43
v_cndmask_b32_e64 v184, v184, v14, s[92:93]
MV 168,v,160,v,120
v_exp_f32 v152, v152
MA 16,a,240,v,112
ds_read_b128 a[172:175], v10 offset:27648
v_cndmask_b32_e64 v185, v185, v14, s[94:95]
MA 48,a,240,v,120
ds_read_b128 a[176:179], v10 offset:28672
v_cndmask_b32_e64 v186, v186, v14, s[96:97]
MA 20,a,244,v,112
v_exp_f32 v153, v153
MA 52,a,244,v,120
s_nop 0
v_cndmask_b32_e64 v187, v187, v14, s[98:99]
MA 24,a,248,v,112
v_cvt_pk_bf16_f32 v147, v150, v151
v_add_u32 v246, -112, v13
MA 56,a,248,v,120
ds_read_b128 a[180:183], v10 offset:29696
v_cmp_gt_i32_e64 s[84:85], 0, v246
MA 28,a,252,v,112
ds_read_b128 a[184:187], v10 offset:30720
v_cmp_gt_i32_e64 s[86:87], 1, v246
MA 60,a,252,v,120
ds_read_b128 a[188:191], v10 offset:31744
buffer_load_dwordx4 v245, s[20:23], 0 offen offset:0 sc1 lds
buffer_load_dwordx4 v245, s[20:23], 0 offen offset:1024 sc1 lds
buffer_load_dwordx4 v245, s[20:23], 0 offen offset:2048 sc1 lds
buffer_load_dwordx4 v245, s[20:23], 0 offen offset:3072 sc1 lds
v_exp_f32 v154, v154
v_exp_f32 v155, v155
v_cmp_gt_i32_e64 s[88:89], 2, v246
v_cmp_gt_i32_e64 s[90:91], 3, v246
v_cvt_pk_bf16_f32 v152, v152, v153
v_cndmask_b32_e64 v180, v180, v14, s[84:85]
v_exp_f32 v156, v156
v_cndmask_b32_e64 v181, v181, v14, s[86:87]
v_cndmask_b32_e64 v182, v182, v14, s[88:89]
v_cndmask_b32_e64 v183, v183, v14, s[90:91]
v_exp_f32 v157, v157
v_add_u32 v247, -96, v13
v_cvt_pk_bf16_f32 v153, v154, v155
v_cmp_gt_i32_e64 s[92:93], 0, v247
v_exp_f32 v158, v158
v_cmp_gt_i32_e64 s[94:95], 1, v247
v_cmp_gt_i32_e64 s[96:97], 2, v247
v_cmp_gt_i32_e64 s[98:99], 3, v247
v_exp_f32 v159, v159
v_cndmask_b32_e64 v188, v188, v14, s[92:93]
v_cndmask_b32_e64 v189, v189, v14, s[94:95]
v_cvt_pk_bf16_f32 v154, v156, v157
v_cndmask_b32_e64 v190, v190, v14, s[96:97]
v_cvt_pk_bf16_f32 v155, v158, v159
v_cndmask_b32_e64 v191, v191, v14, s[98:99]
s_load_dwordx2 s[88:89], s[0:1], 104
s_waitcnt lgkmcnt(0)
v_xor_b32 v11, 0x8000, v11
ds_read_b128 a[192:195], v11 offset:0
ds_read_b128 a[196:199], v11 offset:1024
ds_read_b128 a[200:203], v11 offset:2048
ds_read_b128 a[204:207], v11 offset:3072
ds_read_b128 a[208:211], v11 offset:4096
ds_read_b128 a[212:215], v11 offset:5120
ds_read_b128 a[216:219], v11 offset:6144
ds_read_b128 a[220:223], v11 offset:7168
ds_read_b128 a[224:227], v11 offset:8192
ds_read_b128 a[228:231], v11 offset:9216
ds_read_b128 a[232:235], v11 offset:10240
ds_read_b128 a[236:239], v11 offset:11264
ds_read_b128 a[240:243], v11 offset:12288
ds_read_b128 a[244:247], v11 offset:13312
ds_read_b128 a[248:251], v11 offset:14336
ds_read_b128 a[252:255], v11 offset:15360
v_exp_f32 v176, v176
v_exp_f32 v177, v177
v_exp_f32 v178, v178
v_exp_f32 v179, v179
v_cvt_pk_bf16_f32 v176, v176, v177
v_exp_f32 v180, v180
v_exp_f32 v181, v181
v_cvt_pk_bf16_f32 v177, v178, v179
v_exp_f32 v182, v182
v_exp_f32 v183, v183
v_cvt_pk_bf16_f32 v178, v180, v181
v_exp_f32 v184, v184
v_exp_f32 v185, v185
v_cvt_pk_bf16_f32 v179, v182, v183
v_exp_f32 v186, v186
v_exp_f32 v187, v187
v_cvt_pk_bf16_f32 v184, v184, v185
v_exp_f32 v188, v188
v_exp_f32 v189, v189
v_cvt_pk_bf16_f32 v185, v186, v187
v_exp_f32 v190, v190
v_exp_f32 v191, v191
v_cvt_pk_bf16_f32 v186, v188, v189
v_cvt_pk_bf16_f32 v187, v190, v191
MV 164,v,160,v,144
MV 168,v,160,v,152
MV 164,v,160,v,176
MV 168,v,160,v,184
v_mov_b32 v240, v2
v_mov_b32 v241, v3
s_nop 0
v_permlane32_swap_b32 v2, v240
v_permlane32_swap_b32 v3, v241
v_add_f32 v2, v2, v240
v_add_f32 v3, v3, v241
v_mov_b32 v240, v2
v_mov_b32 v241, v3
s_nop 0
v_permlane16_swap_b32 v2, v240
v_permlane16_swap_b32 v3, v241
v_add_f32 v2, v2, v240
v_add_f32 v3, v3, v241
v_add_f32 v2, v2, v164
v_add_f32 v3, v3, v168
v_min_f32 v240, v2, v3
v_add_f32 v241, v2, v3
v_cmp_nle_f32 vcc, 0x30800000, v240
s_nop 0
s_or_b64 s[78:79], s[78:79], vcc
v_cmp_nge_f32 vcc, 0x4e800000, v241
s_nop 0
s_or_b64 s[78:79], s[78:79], vcc
s_cmp_lg_u64 s[78:79], 0
s_cselect_b32 s80, 1, 0
v_mov_b32 v240, s80
s_lshl_b32 s80, s3, 2
s_add_u32 s80, s80, 163824
v_mov_b32 v241, s80
ds_write_b32 v241, v240
v_mov_b32 v241, 163824
s_waitcnt vmcnt(0) lgkmcnt(0)
s_barrier
ds_read_b128 v[244:247], v241
buffer_store_dword v237, v236, s[8:11], s37 offen offset:1024 sc1
MA 0,a,192,v,144
MA 32,a,192,v,152
MA 4,a,196,v,144
MA 36,a,196,v,152
MA 8,a,200,v,144
MA 40,a,200,v,152
s_waitcnt lgkmcnt(0)
v_or3_b32 v240, v244, v245, v246
v_or_b32 v240, v240, v247
MA 12,a,204,v,144
v_cmp_ne_u32 vcc, 0, v240
MA 44,a,204,v,152
MA 16,a,208,v,144
s_cbranch_vccnz L_fallback
MA 48,a,208,v,152
s_mul_i32 s36, s3, 16640
v_and_b32 v16, 15, v1
MA 20,a,212,v,144
v_lshrrev_b32 v17, 4, v1
v_add_u32 v18, 13, v16
MA 52,a,212,v,152
v_and_b32 v19, 3, v18
v_cmp_eq_u32 vcc, 0, v19
MA 24,a,216,v,144
v_lshrrev_b32 v18, 2, v18
v_mul_u32_u24 v19, 4160, v19
MA 56,a,216,v,152
v_cndmask_b32 v19, v19, 8, vcc
v_lshl_add_u32 v19, v18, 3, v19
MA 28,a,220,v,144
v_lshl_add_u32 v19, v17, 4, v19
v_add_u32 v4, s36, v19
MA 60,a,220,v,152
v_add_u32 v10, s36, v232
v_lshlrev_b32 v18, 5, v16
MA 0,a,224,v,176
v_lshlrev_b32 v19, 4, v17
v_sub_u32 v19, v19, v18
MA 32,a,224,v,184
s_add_u32 s37, s43, 480
v_add_u32 v5, s37, v19
MA 4,a,228,v,176
v_mul_u32_u24 v18, 136, v16
v_lshl_add_u32 v18, v17, 5, v18
MA 36,a,228,v,184
s_lshl_b32 s37, s3, 1
s_add_u32 s37, s37, 49152
MA 8,a,232,v,176
v_add_u32 v11, s37, v18
v_lshrrev_b32 v18, 3, v1
MA 40,a,232,v,184
v_mul_u32_u24 v18, 136, v18
v_and_b32 v19, 7, v1
MA 12,a,236,v,176
v_lshl_add_u32 v18, v19, 4, v18
s_mul_i32 s37, s3, 4352
MA 44,a,236,v,184
s_add_u32 s37, s37, 49152
v_add_u32 v12, s37, v18
MA 16,a,240,v,176
s_lshl_b32 s37, s3, 12
v_add_u32 v13, s37, v232
MA 48,a,240,v,184
v_lshl_add_u32 v18, v17, 3, v16
v_sub_u32 v235, 15, v18
MA 20,a,244,v,176
v_mov_b32 v20, 0
v_mov_b32 v21, 0
MA 52,a,244,v,184
v_mov_b32 v22, 0
v_mov_b32 v23, 0
MA 24,a,248,v,176
v_and_b32 v16, 3, v1
v_mul_u32_u24 v16, 4160, v16
MA 56,a,248,v,184
v_lshrrev_b32 v17, 2, v1
v_min_u32 v17, 3, v17
MA 28,a,252,v,176
v_lshl_add_u32 v16, v17, 4, v16
v_add_u32 v16, s36, v16
MA 60,a,252,v,184
ds_write_b128 v16, v[20:23]
v_and_b32 v17, 31, v1
v_lshlrev_b32 v17, 4, v17
v_add_u32 v17, s43, v17
ds_write_b128 v17, v[20:23] offset:4096
v_alignbit_b32 v24, v209, v208, 16
v_alignbit_b32 v25, v210, v209, 16
v_alignbit_b32 v26, v211, v210, 16
v_alignbit_b32 v27, v212, v211, 16
v_alignbit_b32 v28, v213, v212, 16
ds_write_b128 v10, v[210:213] offset:64
ds_write_b128 v10, v[24:27] offset:4208
v_mov_b32 v16, v209
v_mov_b32 v17, v210
v_mov_b32 v18, v211
v_mov_b32 v19, v212
ds_write_b128 v10, v[16:19] offset:8368
v_mov_b32 v16, v25
v_mov_b32 v17, v26
v_mov_b32 v18, v27
v_mov_b32 v19, v28
ds_write_b128 v10, v[16:19] offset:12528
v_alignbit_b32 v30, v215, v214, 16
v_alignbit_b32 v31, v216, v215, 16
v_alignbit_b32 v32, v217, v216, 16
v_alignbit_b32 v33, v218, v217, 16
v_alignbit_b32 v34, v219, v218, 16
ds_write_b128 v10, v[216:219] offset:1088
ds_write_b128 v10, v[30:33] offset:5232
v_mov_b32 v16, v215
v_mov_b32 v17, v216
v_mov_b32 v18, v217
v_mov_b32 v19, v218
ds_write_b128 v10, v[16:19] offset:9392
v_mov_b32 v16, v31
v_mov_b32 v17, v32
v_mov_b32 v18, v33
v_mov_b32 v19, v34
ds_write_b128 v10, v[16:19] offset:13552
v_alignbit_b32 v24, v221, v220, 16
v_alignbit_b32 v25, v222, v221, 16
v_alignbit_b32 v26, v223, v222, 16
v_alignbit_b32 v27, v224, v223, 16
v_alignbit_b32 v28, v225, v224, 16
ds_write_b128 v10, v[222:225] offset:2112
ds_write_b128 v10, v[24:27] offset:6256
v_mov_b32 v16, v221
v_mov_b32 v17, v222
v_mov_b32 v18, v223
v_mov_b32 v19, v224
ds_write_b128 v10, v[16:19] offset:10416
v_mov_b32 v16, v25
v_mov_b32 v17, v26
v_mov_b32 v18, v27
v_mov_b32 v19, v28
ds_write_b128 v10, v[16:19] offset:14576
v_alignbit_b32 v30, v227, v226, 16
v_alignbit_b32 v31, v228, v227, 16
v_alignbit_b32 v32, v229, v228, 16
v_alignbit_b32 v33, v230, v229, 16
v_alignbit_b32 v34, v231, v230, 16
ds_write_b128 v10, v[228:231] offset:3136
ds_write_b128 v10, v[30:33] offset:7280
v_mov_b32 v16, v227
v_mov_b32 v17, v228
v_mov_b32 v18, v229
v_mov_b32 v19, v230
ds_write_b128 v10, v[16:19] offset:11440
v_mov_b32 v16, v31
v_mov_b32 v17, v32
v_mov_b32 v18, v33
v_mov_b32 v19, v34
ds_write_b128 v10, v[16:19] offset:15600
v_lshlrev_b32 v16, 16, v234
v_cmp_eq_u32 vcc, 0, v235
s_nop 1
v_cndmask_b32 v44, 0, v234, vcc
v_cmp_eq_u32 vcc, 1, v235
s_nop 1
v_cndmask_b32 v44, v44, v16, vcc
v_cmp_eq_u32 vcc, 2, v235
s_nop 1
v_cndmask_b32 v45, 0, v234, vcc
v_cmp_eq_u32 vcc, 3, v235
s_nop 1
v_cndmask_b32 v45, v45, v16, vcc
v_cmp_eq_u32 vcc, 4, v235
s_nop 1
v_cndmask_b32 v46, 0, v234, vcc
v_cmp_eq_u32 vcc, 5, v235
s_nop 1
v_cndmask_b32 v46, v46, v16, vcc
v_cmp_eq_u32 vcc, 6, v235
s_nop 1
v_cndmask_b32 v47, 0, v234, vcc
v_cmp_eq_u32 vcc, 7, v235
s_nop 1
v_cndmask_b32 v47, v47, v16, vcc
v_rcp_f32 v2, v2
v_rcp_f32 v3, v3
s_add_u32 s80, s100, 0x20000
s_nop 4
v_accvgpr_read_b32 v240, a0
v_accvgpr_read_b32 v241, a1
v_accvgpr_read_b32 v242, a2
v_accvgpr_read_b32 v243, a3
v_accvgpr_read_b32 v244, a4
v_accvgpr_read_b32 v245, a5
v_accvgpr_read_b32 v246, a6
v_accvgpr_read_b32 v247, a7
v_mul_f32 v240, v240, v2
v_mul_f32 v241, v241, v2
v_mul_f32 v242, v242, v2
v_mul_f32 v243, v243, v2
v_mul_f32 v244, v244, v2
v_mul_f32 v245, v245, v2
v_mul_f32 v246, v246, v2
v_mul_f32 v247, v247, v2
v_cvt_pk_bf16_f32 v248, v240, v241
v_cvt_pk_bf16_f32 v249, v242, v243
v_cvt_pk_bf16_f32 v250, v244, v245
v_cvt_pk_bf16_f32 v251, v246, v247
buffer_store_dwordx4 v[248:251], v15, s[60:63], s100 offen offset:0 sc1
v_accvgpr_read_b32 v240, a8
v_accvgpr_read_b32 v241, a9
v_accvgpr_read_b32 v242, a10
v_accvgpr_read_b32 v243, a11
v_accvgpr_read_b32 v244, a12
v_accvgpr_read_b32 v245, a13
v_accvgpr_read_b32 v246, a14
v_accvgpr_read_b32 v247, a15
v_mul_f32 v240, v240, v2
v_mul_f32 v241, v241, v2
v_mul_f32 v242, v242, v2
v_mul_f32 v243, v243, v2
v_mul_f32 v244, v244, v2
v_mul_f32 v245, v245, v2
v_mul_f32 v246, v246, v2
v_mul_f32 v247, v247, v2
v_cvt_pk_bf16_f32 v252, v240, v241
v_cvt_pk_bf16_f32 v253, v242, v243
v_cvt_pk_bf16_f32 v254, v244, v245
v_cvt_pk_bf16_f32 v255, v246, v247
buffer_store_dwordx4 v[252:255], v15, s[60:63], s100 offen offset:1024 sc1
v_accvgpr_read_b32 v240, a16
v_accvgpr_read_b32 v241, a17
v_accvgpr_read_b32 v242, a18
v_accvgpr_read_b32 v243, a19
v_accvgpr_read_b32 v244, a20
v_accvgpr_read_b32 v245, a21
v_accvgpr_read_b32 v246, a22
v_accvgpr_read_b32 v247, a23
v_mul_f32 v240, v240, v2
v_mul_f32 v241, v241, v2
v_mul_f32 v242, v242, v2
v_mul_f32 v243, v243, v2
v_mul_f32 v244, v244, v2
v_mul_f32 v245, v245, v2
v_mul_f32 v246, v246, v2
v_mul_f32 v247, v247, v2
v_cvt_pk_bf16_f32 v248, v240, v241
v_cvt_pk_bf16_f32 v249, v242, v243
v_cvt_pk_bf16_f32 v250, v244, v245
v_cvt_pk_bf16_f32 v251, v246, v247
buffer_store_dwordx4 v[248:251], v15, s[60:63], s100 offen offset:2048 sc1
v_accvgpr_read_b32 v240, a24
v_accvgpr_read_b32 v241, a25
v_accvgpr_read_b32 v242, a26
v_accvgpr_read_b32 v243, a27
v_accvgpr_read_b32 v244, a28
v_accvgpr_read_b32 v245, a29
v_accvgpr_read_b32 v246, a30
v_accvgpr_read_b32 v247, a31
v_mul_f32 v240, v240, v2
v_mul_f32 v241, v241, v2
v_mul_f32 v242, v242, v2
v_mul_f32 v243, v243, v2
v_mul_f32 v244, v244, v2
v_mul_f32 v245, v245, v2
v_mul_f32 v246, v246, v2
v_mul_f32 v247, v247, v2
v_cvt_pk_bf16_f32 v252, v240, v241
v_cvt_pk_bf16_f32 v253, v242, v243
v_cvt_pk_bf16_f32 v254, v244, v245
v_cvt_pk_bf16_f32 v255, v246, v247
buffer_store_dwordx4 v[252:255], v15, s[60:63], s100 offen offset:3072 sc1
v_accvgpr_read_b32 v240, a32
v_accvgpr_read_b32 v241, a33
v_accvgpr_read_b32 v242, a34
v_accvgpr_read_b32 v243, a35
v_accvgpr_read_b32 v244, a36
v_accvgpr_read_b32 v245, a37
v_accvgpr_read_b32 v246, a38
v_accvgpr_read_b32 v247, a39
v_mul_f32 v240, v240, v3
v_mul_f32 v241, v241, v3
v_mul_f32 v242, v242, v3
v_mul_f32 v243, v243, v3
v_mul_f32 v244, v244, v3
v_mul_f32 v245, v245, v3
v_mul_f32 v246, v246, v3
v_mul_f32 v247, v247, v3
v_cvt_pk_bf16_f32 v248, v240, v241
v_cvt_pk_bf16_f32 v249, v242, v243
v_cvt_pk_bf16_f32 v250, v244, v245
v_cvt_pk_bf16_f32 v251, v246, v247
buffer_store_dwordx4 v[248:251], v15, s[60:63], s80 offen offset:0 sc1
v_accvgpr_read_b32 v240, a40
v_accvgpr_read_b32 v241, a41
v_accvgpr_read_b32 v242, a42
v_accvgpr_read_b32 v243, a43
v_accvgpr_read_b32 v244, a44
v_accvgpr_read_b32 v245, a45
v_accvgpr_read_b32 v246, a46
v_accvgpr_read_b32 v247, a47
v_mul_f32 v240, v240, v3
v_mul_f32 v241, v241, v3
v_mul_f32 v242, v242, v3
v_mul_f32 v243, v243, v3
v_mul_f32 v244, v244, v3
v_mul_f32 v245, v245, v3
v_mul_f32 v246, v246, v3
v_mul_f32 v247, v247, v3
v_cvt_pk_bf16_f32 v252, v240, v241
v_cvt_pk_bf16_f32 v253, v242, v243
v_cvt_pk_bf16_f32 v254, v244, v245
v_cvt_pk_bf16_f32 v255, v246, v247
buffer_store_dwordx4 v[252:255], v15, s[60:63], s80 offen offset:1024 sc1
v_accvgpr_read_b32 v240, a48
v_accvgpr_read_b32 v241, a49
v_accvgpr_read_b32 v242, a50
v_accvgpr_read_b32 v243, a51
v_accvgpr_read_b32 v244, a52
v_accvgpr_read_b32 v245, a53
v_accvgpr_read_b32 v246, a54
v_accvgpr_read_b32 v247, a55
v_mul_f32 v240, v240, v3
v_mul_f32 v241, v241, v3
v_mul_f32 v242, v242, v3
v_mul_f32 v243, v243, v3
v_mul_f32 v244, v244, v3
v_mul_f32 v245, v245, v3
v_mul_f32 v246, v246, v3
v_mul_f32 v247, v247, v3
v_cvt_pk_bf16_f32 v248, v240, v241
v_cvt_pk_bf16_f32 v249, v242, v243
v_cvt_pk_bf16_f32 v250, v244, v245
v_cvt_pk_bf16_f32 v251, v246, v247
buffer_store_dwordx4 v[248:251], v15, s[60:63], s80 offen offset:2048 sc1
v_accvgpr_read_b32 v240, a56
v_accvgpr_read_b32 v241, a57
v_accvgpr_read_b32 v242, a58
v_accvgpr_read_b32 v243, a59
v_accvgpr_read_b32 v244, a60
v_accvgpr_read_b32 v245, a61
v_accvgpr_read_b32 v246, a62
v_accvgpr_read_b32 v247, a63
v_mul_f32 v240, v240, v3
v_mul_f32 v241, v241, v3
v_mul_f32 v242, v242, v3
v_mul_f32 v243, v243, v3
v_mul_f32 v244, v244, v3
v_mul_f32 v245, v245, v3
v_mul_f32 v246, v246, v3
v_mul_f32 v247, v247, v3
v_cvt_pk_bf16_f32 v252, v240, v241
v_cvt_pk_bf16_f32 v253, v242, v243
v_cvt_pk_bf16_f32 v254, v244, v245
v_cvt_pk_bf16_f32 v255, v246, v247
buffer_store_dwordx4 v[252:255], v15, s[60:63], s80 offen offset:3072 sc1
L_p3_done:
s_waitcnt lgkmcnt(0)
ds_read_b128 a[160:163], v5 offset:3584
ds_read_b64 a[128:129], v4 offset:0
ds_read_b64 a[130:131], v4 offset:8
ds_read_b128 a[164:167], v5 offset:3072
ds_read_b64 a[132:133], v4 offset:512
ds_read_b64 a[134:135], v4 offset:520
ds_read_b128 a[168:171], v5 offset:2560
ds_read_b64 a[136:137], v4 offset:1024
ds_read_b64 a[138:139], v4 offset:1032
ds_read_b128 a[172:175], v5 offset:2048
ds_read_b64 a[140:141], v4 offset:1536
ds_read_b64 a[142:143], v4 offset:1544
ds_read_b128 a[176:179], v5 offset:1536
ds_read_b64 a[144:145], v4 offset:2048
ds_read_b64 a[146:147], v4 offset:2056
ds_read_b128 a[180:183], v5 offset:1024
ds_read_b64 a[148:149], v4 offset:2560
ds_read_b64 a[150:151], v4 offset:2568
ds_read_b128 a[184:187], v5 offset:512
ds_read_b64 a[152:153], v4 offset:3072
ds_read_b64 a[154:155], v4 offset:3080
ds_read_b128 a[188:191], v5 offset:0
ds_read_b64 a[156:157], v4 offset:3584
ds_read_b64 a[158:159], v4 offset:3592
v_lshlrev_b32 v255, 20, v1
v_mov_b32 v253, 1
s_lshl_b32 s38, s3, 8
s_add_u32 s38, s38, s2
s_lshl_b32 s38, s38, 2
s_add_u32 s38, s38, 4096
s_waitcnt lgkmcnt(15)
v_mfma_f32_16x16x32_bf16 v[76:79], a[128:131], a[160:163], 0
ds_read_b128 a[224:227], v5 offset:3648
s_and_b32 s81, s2, 3
v_mfma_f32_16x16x32_bf16 v[80:83], a[128:131], a[164:167], 0
ds_read_b64 a[192:193], v4 offset:64
s_lshl_b32 s81, s81, 1
v_mfma_f32_16x16x32_bf16 v[84:87], a[128:131], a[168:171], 0
ds_read_b64 a[194:195], v4 offset:72
s_sub_u32 s74, 14, s81
s_waitcnt lgkmcnt(15)
v_mfma_f32_16x16x32_bf16 v[88:91], a[128:131], a[172:175], 0
ds_read_b128 a[228:231], v5 offset:3136
s_waitcnt lgkmcnt(15)
v_mfma_f32_16x16x32_bf16 v[92:95], a[128:131], a[176:179], 0
s_bitcmp1_b32 s2, 4
s_cselect_b32 s81, s74, s81
s_waitcnt lgkmcnt(12)
v_mfma_f32_16x16x32_bf16 v[96:99], a[128:131], a[180:183], 0
ds_read_b64 a[196:197], v4 offset:576
s_waitcnt lgkmcnt(10)
v_mfma_f32_16x16x32_bf16 v[100:103], a[128:131], a[184:187], 0
ds_read_b64 a[198:199], v4 offset:584
s_waitcnt lgkmcnt(8)
v_mfma_f32_16x16x32_bf16 v[104:107], a[128:131], a[188:191], 0
ds_read_b128 a[232:235], v5 offset:2624
s_bfe_u32 s74, s2, 0x10003
MV 76,v,44,a,160
ds_read_b64 a[200:201], v4 offset:1088
s_add_u32 s81, s81, s74
MV 80,v,44,a,164
MV 84,v,44,a,168
ds_read_b64 a[202:203], v4 offset:1096
s_bfe_u32 s82, s2, 0x10002
MV 88,v,44,a,172
ds_read_b128 a[236:239], v5 offset:2112
s_lshr_b32 s74, s2, 5
MV 92,v,44,a,176
ds_read_b64 a[204:205], v4 offset:1600
s_lshl_b32 s74, s74, 1
MV 96,v,44,a,180
ds_read_b64 a[206:207], v4 offset:1608
MV 100,v,44,a,184
s_add_u32 s82, s82, s74
MV 104,v,44,a,188
ds_read_b128 a[240:243], v5 offset:1600
s_mov_b32 s72, s81
MV 80,a,132,a,160
ds_read_b64 a[208:209], v4 offset:2112
MV 84,a,132,a,164
ds_read_b64 a[210:211], v4 offset:2120
s_mov_b32 s73, s82
MV 88,a,132,a,168
ds_read_b128 a[244:247], v5 offset:1088
s_lshl_b32 s74, s72, 2
MV 92,a,132,a,172
MV 96,a,132,a,176
ds_read_b64 a[212:213], v4 offset:2624
s_add_u32 s74, s74, s3
MV 100,a,132,a,180
ds_read_b64 a[214:215], v4 offset:2632
s_lshl_b32 s68, s74, 18
MV 104,a,132,a,184
ds_read_b128 a[248:251], v5 offset:576
s_and_b32 s80, s73, 1
MV 84,a,136,a,160
ds_read_b64 a[216:217], v4 offset:3136
MV 88,a,136,a,164
s_lshl_b32 s75, s80, 16
MV 92,a,136,a,168
ds_read_b64 a[218:219], v4 offset:3144
s_add_u32 s68, s68, s75
MV 96,a,136,a,172
ds_read_b128 a[252:255], v5 offset:64
MV 100,a,136,a,176
ds_read_b64 a[220:221], v4 offset:3648
s_lshl_b32 s69, s73, 19
MV 104,a,136,a,180
ds_read_b64 a[222:223], v4 offset:3656
s_lshl_b32 s75, s73, 7
MV 88,a,140,a,160
MV 92,a,140,a,164
s_lshl_b32 s70, s3, 12
MV 96,a,140,a,168
s_lshl_b32 s78, s74, 16
MV 100,a,140,a,172
s_add_u32 s78, s78, s75
MV 104,a,140,a,176
MV 92,a,144,a,160
s_lshl_b32 s79, s73, 18
MV 96,a,144,a,164
s_lshl_b32 s75, s74, 8
MV 100,a,144,a,168
MV 104,a,144,a,172
s_add_u32 s79, s79, s75
MV 96,a,148,a,160
v_lshlrev_b32 v236, 4, v1
MV 100,a,148,a,164
MV 104,a,148,a,168
v_add_u32 v237, 0x20000, v236
MV 100,a,152,a,160
v_add_u32 v238, s70, v236
MV 104,a,152,a,164
s_waitcnt lgkmcnt(15)
MV 104,a,156,a,160
s_waitcnt vmcnt(0)
buffer_store_dword v253, v255, s[8:11], s38 offen sc1
MV 76,a,192,a,224
ds_read_b128 a[160:163], v5 offset:3712
s_lshl_b32 s75, s80, 12
MV 80,a,192,a,228
ds_read_b64 a[128:129], v4 offset:128
v_add_u32 v244, s75, v236
MV 84,a,192,a,232
ds_read_b64 a[130:131], v4 offset:136
v_xor_b32 v245, 0x1000, v244
s_waitcnt lgkmcnt(15)
MV 88,a,192,a,236
ds_read_b128 a[164:167], v5 offset:3200
v_add_u32 v242, 66560, v244
s_waitcnt lgkmcnt(15)
MV 92,a,192,a,240
v_add_u32 v243, 66560, v245
v_bfe_u32 v38, v1, 4, 1
s_waitcnt lgkmcnt(12)
MV 96,a,192,a,244
ds_read_b64 a[132:133], v4 offset:640
v_lshrrev_b32 v40, 5, v1
s_waitcnt lgkmcnt(10)
MV 100,a,192,a,248
ds_read_b64 a[134:135], v4 offset:648
v_and_b32 v36, 15, v1
s_waitcnt lgkmcnt(8)
MV 104,a,192,a,252
ds_read_b128 a[168:171], v5 offset:2688
v_lshlrev_b32 v41, 5, v38
MV 80,a,196,a,224
ds_read_b64 a[136:137], v4 offset:1152
v_lshl_add_u32 v41, v40, 4, v41
MV 84,a,196,a,228
v_lshl_add_u32 v250, v36, 11, v41
v_lshlrev_b32 v41, 11, v41
MV 88,a,196,a,232
ds_read_b64 a[138:139], v4 offset:1160
v_lshl_add_u32 v251, v36, 3, v41
MV 92,a,196,a,236
ds_read_b128 a[172:175], v5 offset:2176
MV 96,a,196,a,240
ds_read_b64 a[140:141], v4 offset:1664
MV 100,a,196,a,244
ds_read_b64 a[142:143], v4 offset:1672
MV 104,a,196,a,248
s_add_u32 s44, s40, 33554432
s_addc_u32 s45, s41, 0
MV 84,a,200,a,224
ds_read_b128 a[176:179], v5 offset:1664
s_mov_b32 s46, 16777216
MV 88,a,200,a,228
ds_read_b64 a[144:145], v4 offset:2176
s_mov_b32 s47, 0x20000
MV 92,a,200,a,232
ds_read_b64 a[146:147], v4 offset:2184
MV 96,a,200,a,236
ds_read_b128 a[180:183], v5 offset:1152
MV 100,a,200,a,240
s_add_u32 s48, s40, 100663296
s_addc_u32 s49, s41, 0
MV 104,a,200,a,244
ds_read_b64 a[148:149], v4 offset:2688
s_mov_b32 s50, 8388608
MV 88,a,204,a,224
ds_read_b64 a[150:151], v4 offset:2696
s_mov_b32 s51, 0x20000
MV 92,a,204,a,228
ds_read_b128 a[184:187], v5 offset:640
MV 96,a,204,a,232
ds_read_b64 a[152:153], v4 offset:3200
MV 100,a,204,a,236
s_add_u32 s52, s40, 109051904
s_addc_u32 s53, s41, 0
MV 104,a,204,a,240
ds_read_b64 a[154:155], v4 offset:3208
s_mov_b32 s54, 4194304
MV 92,a,208,a,224
ds_read_b128 a[188:191], v5 offset:128
s_mov_b32 s55, 0x20000
MV 96,a,208,a,228
ds_read_b64 a[156:157], v4 offset:3712
MV 100,a,208,a,232
ds_read_b64 a[158:159], v4 offset:3720
MV 104,a,208,a,236
s_add_u32 s56, s40, 54525952
s_addc_u32 s57, s41, 0
MV 96,a,212,a,224
s_mov_b32 s58, 4194304
s_mov_b32 s59, 0x20000
MV 100,a,212,a,228
s_mov_b32 s60, s88
s_mov_b32 s61, s89
MV 104,a,212,a,232
s_mov_b32 s62, 4194304
s_mov_b32 s63, 0x20000
MV 100,a,216,a,224
s_lshr_b32 s36, s82, 1
s_lshl_b32 s37, s80, 7
MV 104,a,216,a,228
s_add_u32 s36, s36, s37
v_lshl_add_u32 v254, v1, 3, s36
s_waitcnt lgkmcnt(15)
MV 104,a,220,a,224
s_xor_b32 s36, s2, 4
v_mov_b32 v253, s36
v_cmp_lt_u32 vcc, 15, v1
s_nop 1
v_cndmask_b32 v254, v254, v253, vcc
v_lshlrev_b32 v254, 2, v254
buffer_load_dword v253, v254, s[8:11], 0 offen offset:1024 sc1
MV 76,a,128,a,160
ds_read_b128 a[224:227], v5 offset:3776
s_sub_u32 s36, 15, s81
MV 80,a,128,a,164
ds_read_b64 a[192:193], v4 offset:192
MV 84,a,128,a,168
ds_read_b64 a[194:195], v4 offset:200
s_min_u32 s36, s36, s81
s_waitcnt lgkmcnt(15)
MV 88,a,128,a,172
ds_read_b128 a[228:231], v5 offset:3264
s_waitcnt lgkmcnt(15)
MV 92,a,128,a,176
s_waitcnt lgkmcnt(12)
MV 96,a,128,a,180
ds_read_b64 a[196:197], v4 offset:704
s_lshl_b32 s36, s36, 5
s_waitcnt lgkmcnt(10)
MV 100,a,128,a,184
ds_read_b64 a[198:199], v4 offset:712
s_waitcnt lgkmcnt(8)
MV 104,a,128,a,188
ds_read_b128 a[232:235], v5 offset:2752
MV 80,a,132,a,160
ds_read_b64 a[200:201], v4 offset:1216
s_lshl_b32 s37, s80, 2
MV 84,a,132,a,164
MV 88,a,132,a,168
ds_read_b64 a[202:203], v4 offset:1224
s_add_u32 s36, s36, s37
MV 92,a,132,a,172
ds_read_b128 a[236:239], v5 offset:2240
MV 96,a,132,a,176
ds_read_b64 a[204:205], v4 offset:1728
MV 100,a,132,a,180
ds_read_b64 a[206:207], v4 offset:1736
s_add_u32 s36, s36, 1024
MV 104,a,132,a,184
MV 84,a,136,a,160
ds_read_b128 a[240:243], v5 offset:1728
MV 88,a,136,a,164
ds_read_b64 a[208:209], v4 offset:2240
s_lshl_b32 s37, s3, 8
MV 92,a,136,a,168
ds_read_b64 a[210:211], v4 offset:2248
MV 96,a,136,a,172
ds_read_b128 a[244:247], v5 offset:1216
s_add_u32 s36, s36, s37
MV 100,a,136,a,176
MV 104,a,136,a,180
ds_read_b64 a[212:213], v4 offset:2752
MV 88,a,140,a,160
ds_read_b64 a[214:215], v4 offset:2760
v_and_b32 v252, 3, v1
MV 92,a,140,a,164
ds_read_b128 a[248:251], v5 offset:704
MV 96,a,140,a,168
ds_read_b64 a[216:217], v4 offset:3264
MV 100,a,140,a,172
v_lshlrev_b32 v252, 3, v252
MV 104,a,140,a,176
ds_read_b64 a[218:219], v4 offset:3272
MV 92,a,144,a,160
ds_read_b128 a[252:255], v5 offset:192
v_bfe_u32 v228, v1, 2, 2
MV 96,a,144,a,164
ds_read_b64 a[220:221], v4 offset:3776
MV 100,a,144,a,168
ds_read_b64 a[222:223], v4 offset:3784
MV 104,a,144,a,172
v_add3_u32 v252, v252, v228, s36
MV 96,a,148,a,160
MV 100,a,148,a,164
MV 104,a,148,a,168
v_lshlrev_b32 v252, 2, v252
MV 100,a,152,a,160
MV 104,a,152,a,164
s_waitcnt lgkmcnt(15)
MV 104,a,156,a,160
s_waitcnt vmcnt(0)
v_cmp_gt_u32 vcc, 1, v253
s_nop 4
s_cbranch_vccnz L_spin_w
L_spin_w_ret:
MV 76,a,192,a,224
ds_read_b128 a[160:163], v5 offset:3840
s_add_u32 m0, s70, 66560
MV 80,a,192,a,228
ds_read_b64 a[128:129], v4 offset:256
v_lshlrev_b32 v255, 20, v1
MV 84,a,192,a,232
ds_read_b64 a[130:131], v4 offset:264
buffer_load_dwordx4 v238, s[48:51], s69 offen offset:0 sc1 lds
s_waitcnt lgkmcnt(15)
MV 88,a,192,a,236
ds_read_b128 a[164:167], v5 offset:3328
s_waitcnt lgkmcnt(15)
MV 92,a,192,a,240
s_waitcnt lgkmcnt(12)
MV 96,a,192,a,244
ds_read_b64 a[132:133], v4 offset:768
buffer_load_dwordx4 v238, s[48:51], s69 offen offset:1024 sc1 lds
s_waitcnt lgkmcnt(10)
MV 100,a,192,a,248
ds_read_b64 a[134:135], v4 offset:776
s_waitcnt lgkmcnt(8)
MV 104,a,192,a,252
ds_read_b128 a[168:171], v5 offset:2816
MV 80,a,196,a,224
ds_read_b64 a[136:137], v4 offset:1280
buffer_load_dwordx4 v238, s[48:51], s69 offen offset:2048 sc1 lds
MV 84,a,196,a,228
MV 88,a,196,a,232
ds_read_b64 a[138:139], v4 offset:1288
MV 92,a,196,a,236
ds_read_b128 a[172:175], v5 offset:2304
buffer_load_dwordx4 v238, s[48:51], s69 offen offset:3072 sc1 lds
MV 96,a,196,a,240
ds_read_b64 a[140:141], v4 offset:1792
s_lshl_b32 s36, s3, 26
MV 100,a,196,a,244
ds_read_b64 a[142:143], v4 offset:1800
MV 104,a,196,a,248
s_add_u32 s69, s69, 16384
MV 84,a,200,a,224
ds_read_b128 a[176:179], v5 offset:1792
MV 88,a,200,a,228
ds_read_b64 a[144:145], v4 offset:2304
MV 92,a,200,a,232
ds_read_b64 a[146:147], v4 offset:2312
s_add_u32 m0, s70, 82944
MV 96,a,200,a,236
ds_read_b128 a[180:183], v5 offset:1280
MV 100,a,200,a,240
MV 104,a,200,a,244
ds_read_b64 a[148:149], v4 offset:2816
buffer_load_dwordx4 v238, s[48:51], s69 offen offset:0 sc1 lds
MV 88,a,204,a,224
ds_read_b64 a[150:151], v4 offset:2824
MV 92,a,204,a,228
ds_read_b128 a[184:187], v5 offset:768
MV 96,a,204,a,232
ds_read_b64 a[152:153], v4 offset:3328
buffer_load_dwordx4 v238, s[48:51], s69 offen offset:1024 sc1 lds
MV 100,a,204,a,236
v_add_u32 v255, s36, v255
MV 104,a,204,a,240
ds_read_b64 a[154:155], v4 offset:3336
MV 92,a,208,a,224
ds_read_b128 a[188:191], v5 offset:256
buffer_load_dwordx4 v238, s[48:51], s69 offen offset:2048 sc1 lds
MV 96,a,208,a,228
ds_read_b64 a[156:157], v4 offset:3840
MV 100,a,208,a,232
ds_read_b64 a[158:159], v4 offset:3848
MV 104,a,208,a,236
buffer_load_dwordx4 v238, s[48:51], s69 offen offset:3072 sc1 lds
MV 96,a,212,a,224
MV 100,a,212,a,228
MV 104,a,212,a,232
s_add_u32 s69, s69, 16384
MV 100,a,216,a,224
MV 104,a,216,a,228
s_waitcnt lgkmcnt(15)
MV 104,a,220,a,224
MV 76,a,128,a,160
ds_read_b128 a[224:227], v5 offset:3904
s_add_u32 m0, s70, 99328
MV 80,a,128,a,164
ds_read_b64 a[192:193], v4 offset:320
MV 84,a,128,a,168
ds_read_b64 a[194:195], v4 offset:328
s_waitcnt lgkmcnt(15)
MV 88,a,128,a,172
ds_read_b128 a[228:231], v5 offset:3392
s_waitcnt lgkmcnt(15)
MV 92,a,128,a,176
s_waitcnt lgkmcnt(12)
MV 96,a,128,a,180
ds_read_b64 a[196:197], v4 offset:832
buffer_load_dwordx4 v238, s[48:51], s69 offen offset:0 sc1 lds
s_waitcnt lgkmcnt(10)
MV 100,a,128,a,184
ds_read_b64 a[198:199], v4 offset:840
s_waitcnt lgkmcnt(8)
MV 104,a,128,a,188
ds_read_b128 a[232:235], v5 offset:2880
MV 80,a,132,a,160
ds_read_b64 a[200:201], v4 offset:1344
MV 84,a,132,a,164
MV 88,a,132,a,168
ds_read_b64 a[202:203], v4 offset:1352
MV 92,a,132,a,172
ds_read_b128 a[236:239], v5 offset:2368
buffer_load_dwordx4 v238, s[48:51], s69 offen offset:1024 sc1 lds
MV 96,a,132,a,176
ds_read_b64 a[204:205], v4 offset:1856
MV 100,a,132,a,180
ds_read_b64 a[206:207], v4 offset:1864
MV 104,a,132,a,184
MV 84,a,136,a,160
ds_read_b128 a[240:243], v5 offset:1856
MV 88,a,136,a,164
ds_read_b64 a[208:209], v4 offset:2368
MV 92,a,136,a,168
ds_read_b64 a[210:211], v4 offset:2376
buffer_load_dwordx4 v238, s[48:51], s69 offen offset:2048 sc1 lds
MV 96,a,136,a,172
ds_read_b128 a[244:247], v5 offset:1344
MV 100,a,136,a,176
MV 104,a,136,a,180
ds_read_b64 a[212:213], v4 offset:2880
MV 88,a,140,a,160
ds_read_b64 a[214:215], v4 offset:2888
MV 92,a,140,a,164
ds_read_b128 a[248:251], v5 offset:832
MV 96,a,140,a,168
ds_read_b64 a[216:217], v4 offset:3392
buffer_load_dwordx4 v238, s[48:51], s69 offen offset:3072 sc1 lds
MV 100,a,140,a,172
MV 104,a,140,a,176
ds_read_b64 a[218:219], v4 offset:3400
MV 92,a,144,a,160
ds_read_b128 a[252:255], v5 offset:320
MV 96,a,144,a,164
ds_read_b64 a[220:221], v4 offset:3904
MV 100,a,144,a,168
ds_read_b64 a[222:223], v4 offset:3912
MV 104,a,144,a,172
s_add_u32 s69, s69, 16384
MV 96,a,148,a,160
MV 100,a,148,a,164
MV 104,a,148,a,168
MV 100,a,152,a,160
MV 104,a,152,a,164
s_waitcnt lgkmcnt(15)
MV 104,a,156,a,160
buffer_load_dword v253, v252, s[8:11], 0 offen sc1
MV 76,a,192,a,224
ds_read_b128 a[160:163], v5 offset:3968
MV 80,a,192,a,228
ds_read_b64 a[128:129], v4 offset:384
MV 84,a,192,a,232
ds_read_b64 a[130:131], v4 offset:392
s_waitcnt lgkmcnt(15)
MV 88,a,192,a,236
ds_read_b128 a[164:167], v5 offset:3456
s_waitcnt lgkmcnt(15)
MV 92,a,192,a,240
s_waitcnt lgkmcnt(12)
MV 96,a,192,a,244
ds_read_b64 a[132:133], v4 offset:896
s_waitcnt lgkmcnt(10)
MV 100,a,192,a,248
ds_read_b64 a[134:135], v4 offset:904
s_waitcnt lgkmcnt(8)
MV 104,a,192,a,252
ds_read_b128 a[168:171], v5 offset:2944
MV 80,a,196,a,224
ds_read_b64 a[136:137], v4 offset:1408
MV 84,a,196,a,228
MV 88,a,196,a,232
ds_read_b64 a[138:139], v4 offset:1416
MV 92,a,196,a,236
ds_read_b128 a[172:175], v5 offset:2432
MV 96,a,196,a,240
ds_read_b64 a[140:141], v4 offset:1920
MV 100,a,196,a,244
ds_read_b64 a[142:143], v4 offset:1928
MV 104,a,196,a,248
MV 84,a,200,a,224
ds_read_b128 a[176:179], v5 offset:1920
MV 88,a,200,a,228
ds_read_b64 a[144:145], v4 offset:2432
MV 92,a,200,a,232
ds_read_b64 a[146:147], v4 offset:2440
MV 96,a,200,a,236
ds_read_b128 a[180:183], v5 offset:1408
MV 100,a,200,a,240
MV 104,a,200,a,244
ds_read_b64 a[148:149], v4 offset:2944
MV 88,a,204,a,224
ds_read_b64 a[150:151], v4 offset:2952
MV 92,a,204,a,228
ds_read_b128 a[184:187], v5 offset:896
MV 96,a,204,a,232
ds_read_b64 a[152:153], v4 offset:3456
MV 100,a,204,a,236
MV 104,a,204,a,240
ds_read_b64 a[154:155], v4 offset:3464
MV 92,a,208,a,224
ds_read_b128 a[188:191], v5 offset:384
MV 96,a,208,a,228
ds_read_b64 a[156:157], v4 offset:3968
MV 100,a,208,a,232
ds_read_b64 a[158:159], v4 offset:3976
MV 104,a,208,a,236
MV 96,a,212,a,224
MV 100,a,212,a,228
MV 104,a,212,a,232
MV 100,a,216,a,224
MV 104,a,216,a,228
s_waitcnt lgkmcnt(15)
MV 104,a,220,a,224
s_waitcnt vmcnt(0)
v_cmp_gt_u32 vcc, 1, v253
s_nop 4
s_cbranch_vccnz L_spin_f2
L_spin_f2_ret:
buffer_load_dwordx4 a[0:3], v236, s[44:47], s68 offen offset:0 sc1
buffer_load_dwordx4 a[4:7], v237, s[44:47], s68 offen offset:0 sc1
buffer_load_dwordx4 a[8:11], v236, s[44:47], s68 offen offset:1024 sc1
buffer_load_dwordx4 a[12:15], v237, s[44:47], s68 offen offset:1024 sc1
s_add_u32 s68, s68, 2048
MV 76,a,128,a,160
ds_read_b128 a[224:227], v5 offset:4032
buffer_load_dwordx4 a[16:19], v236, s[44:47], s68 offen offset:0 sc1
MV 80,a,128,a,164
ds_read_b64 a[192:193], v4 offset:448
MV 84,a,128,a,168
ds_read_b64 a[194:195], v4 offset:456
buffer_load_dwordx4 a[20:23], v237, s[44:47], s68 offen offset:0 sc1
s_waitcnt lgkmcnt(15)
MV 88,a,128,a,172
ds_read_b128 a[228:231], v5 offset:3520
s_waitcnt lgkmcnt(15)
MV 92,a,128,a,176
buffer_load_dwordx4 a[24:27], v236, s[44:47], s68 offen offset:1024 sc1
s_waitcnt lgkmcnt(12)
MV 96,a,128,a,180
ds_read_b64 a[196:197], v4 offset:960
s_waitcnt lgkmcnt(10)
MV 100,a,128,a,184
ds_read_b64 a[198:199], v4 offset:968
s_waitcnt lgkmcnt(8)
MV 104,a,128,a,188
ds_read_b128 a[232:235], v5 offset:3008
buffer_load_dwordx4 a[28:31], v237, s[44:47], s68 offen offset:1024 sc1
MV 80,a,132,a,160
ds_read_b64 a[200:201], v4 offset:1472
MV 84,a,132,a,164
s_add_u32 s68, s68, 2048
MV 88,a,132,a,168
ds_read_b64 a[202:203], v4 offset:1480
MV 92,a,132,a,172
ds_read_b128 a[236:239], v5 offset:2496
buffer_load_dwordx4 a[32:35], v236, s[44:47], s68 offen offset:0 sc1
MV 96,a,132,a,176
ds_read_b64 a[204:205], v4 offset:1984
MV 100,a,132,a,180
ds_read_b64 a[206:207], v4 offset:1992
MV 104,a,132,a,184
buffer_load_dwordx4 a[36:39], v237, s[44:47], s68 offen offset:0 sc1
MV 84,a,136,a,160
ds_read_b128 a[240:243], v5 offset:1984
MV 88,a,136,a,164
ds_read_b64 a[208:209], v4 offset:2496
buffer_load_dwordx4 a[40:43], v236, s[44:47], s68 offen offset:1024 sc1
MV 92,a,136,a,168
ds_read_b64 a[210:211], v4 offset:2504
MV 96,a,136,a,172
ds_read_b128 a[244:247], v5 offset:1472
buffer_load_dwordx4 a[44:47], v237, s[44:47], s68 offen offset:1024 sc1
MV 100,a,136,a,176
MV 104,a,136,a,180
ds_read_b64 a[212:213], v4 offset:3008
MV 88,a,140,a,160
ds_read_b64 a[214:215], v4 offset:3016
s_add_u32 s68, s68, 2048
MV 92,a,140,a,164
ds_read_b128 a[248:251], v5 offset:960
MV 96,a,140,a,168
ds_read_b64 a[216:217], v4 offset:3520
buffer_load_dwordx4 a[48:51], v236, s[44:47], s68 offen offset:0 sc1
MV 100,a,140,a,172
MV 104,a,140,a,176
ds_read_b64 a[218:219], v4 offset:3528
buffer_load_dwordx4 a[52:55], v237, s[44:47], s68 offen offset:0 sc1
MV 92,a,144,a,160
ds_read_b128 a[252:255], v5 offset:448
MV 96,a,144,a,164
ds_read_b64 a[220:221], v4 offset:4032
MV 100,a,144,a,168
ds_read_b64 a[222:223], v4 offset:4040
buffer_load_dwordx4 a[56:59], v236, s[44:47], s68 offen offset:1024 sc1
MV 104,a,144,a,172
MV 96,a,148,a,160
buffer_load_dwordx4 a[60:63], v237, s[44:47], s68 offen offset:1024 sc1
MV 100,a,148,a,164
MV 104,a,148,a,168
s_add_u32 s68, s68, 2048
MV 100,a,152,a,160
MV 104,a,152,a,164
s_waitcnt lgkmcnt(15)
MV 104,a,156,a,160
s_waitcnt lgkmcnt(0)
s_barrier
ds_read_b128 a[64:67], v242 offset:0
ds_read_b128 a[68:71], v242 offset:1024
ds_read_b128 a[72:75], v242 offset:2048
ds_read_b128 a[76:79], v242 offset:3072
ds_read_b128 a[80:83], v243 offset:0
ds_read_b128 a[84:87], v243 offset:1024
ds_read_b128 a[88:91], v243 offset:2048
ds_read_b128 a[92:95], v243 offset:3072
s_waitcnt lgkmcnt(0)
s_waitcnt vmcnt(15)
v_mfma_f32_16x16x32_bf16 v[124:127], a[64:67], a[0:3], 0
ds_read_b128 a[96:99], v242 offset:8192
MV 76,a,192,a,224
s_add_u32 m0, s70, 115712
s_waitcnt vmcnt(14)
v_mfma_f32_16x16x32_bf16 v[128:131], a[64:67], a[4:7], 0
ds_read_b128 a[100:103], v242 offset:9216
MV 80,a,192,a,228
v_mfma_f32_16x16x32_bf16 v[132:135], a[68:71], a[0:3], 0
MV 84,a,192,a,232
ds_read_b128 a[104:107], v242 offset:10240
v_mfma_f32_16x16x32_bf16 v[136:139], a[68:71], a[4:7], 0
v_mfma_f32_16x16x32_bf16 v[140:143], a[72:75], a[0:3], 0
ds_read_b128 a[108:111], v242 offset:11264
MV 88,a,192,a,236
v_mfma_f32_16x16x32_bf16 v[144:147], a[72:75], a[4:7], 0
buffer_load_dwordx4 v238, s[48:51], s69 offen offset:0 sc1 lds
MV 92,a,192,a,240
ds_read_b128 a[112:115], v243 offset:8192
v_mfma_f32_16x16x32_bf16 v[148:151], a[76:79], a[0:3], 0
MV 96,a,192,a,244
v_mfma_f32_16x16x32_bf16 v[152:155], a[76:79], a[4:7], 0
ds_read_b128 a[116:119], v243 offset:9216
v_mfma_f32_16x16x32_bf16 v[156:159], a[80:83], a[0:3], 0
MV 100,a,192,a,248
ds_read_b128 a[120:123], v243 offset:10240
v_mfma_f32_16x16x32_bf16 v[160:163], a[80:83], a[4:7], 0
MV 104,a,192,a,252
buffer_load_dwordx4 v238, s[48:51], s69 offen offset:1024 sc1 lds
v_mfma_f32_16x16x32_bf16 v[164:167], a[84:87], a[0:3], 0
ds_read_b128 a[124:127], v243 offset:11264
MV 80,a,196,a,224
v_mfma_f32_16x16x32_bf16 v[168:171], a[84:87], a[4:7], 0
v_mfma_f32_16x16x32_bf16 v[172:175], a[88:91], a[0:3], 0
MV 84,a,196,a,228
v_mfma_f32_16x16x32_bf16 v[176:179], a[88:91], a[4:7], 0
MV 88,a,196,a,232
v_mfma_f32_16x16x32_bf16 v[180:183], a[92:95], a[0:3], 0
buffer_load_dwordx4 a[0:3], v236, s[44:47], s68 offen offset:0 sc1
MV 92,a,196,a,236
v_mfma_f32_16x16x32_bf16 v[184:187], a[92:95], a[4:7], 0
buffer_load_dwordx4 a[4:7], v237, s[44:47], s68 offen offset:0 sc1
s_waitcnt lgkmcnt(0)
s_barrier
s_waitcnt vmcnt(17)
MV 124,a,96,a,8
ds_read_b128 a[64:67], v242 offset:16384
MV 96,a,196,a,240
buffer_load_dwordx4 v238, s[48:51], s69 offen offset:2048 sc1 lds
s_waitcnt vmcnt(17)
MV 128,a,96,a,12
ds_read_b128 a[68:71], v242 offset:17408
MV 100,a,196,a,244
MV 132,a,100,a,8
MV 104,a,196,a,248
ds_read_b128 a[72:75], v242 offset:18432
MV 136,a,100,a,12
MV 140,a,104,a,8
ds_read_b128 a[76:79], v242 offset:19456
MV 84,a,200,a,224
MV 144,a,104,a,12
buffer_load_dwordx4 v238, s[48:51], s69 offen offset:3072 sc1 lds
MV 88,a,200,a,228
ds_read_b128 a[80:83], v243 offset:16384
MV 148,a,108,a,8
MV 92,a,200,a,232
MV 152,a,108,a,12
ds_read_b128 a[84:87], v243 offset:17408
MV 156,a,112,a,8
MV 96,a,200,a,236
ds_read_b128 a[88:91], v243 offset:18432
MV 160,a,112,a,12
MV 100,a,200,a,240
s_add_u32 s69, s69, 16384
MV 164,a,116,a,8
ds_read_b128 a[92:95], v243 offset:19456
MV 104,a,200,a,244
MV 168,a,116,a,12
MV 172,a,120,a,8
MV 88,a,204,a,224
MV 176,a,120,a,12
MV 92,a,204,a,228
MV 180,a,124,a,8
buffer_load_dwordx4 a[8:11], v236, s[44:47], s68 offen offset:1024 sc1
MV 96,a,204,a,232
MV 184,a,124,a,12
buffer_load_dwordx4 a[12:15], v237, s[44:47], s68 offen offset:1024 sc1
s_add_u32 s68, s68, 2048
s_waitcnt lgkmcnt(0)
s_waitcnt vmcnt(19)
MV 124,a,64,a,16
ds_read_b128 a[96:99], v242 offset:24576
MV 100,a,204,a,236
s_add_u32 m0, s70, 66560
s_waitcnt vmcnt(18)
MV 128,a,64,a,20
ds_read_b128 a[100:103], v242 offset:25600
MV 104,a,204,a,240
MV 132,a,68,a,16
MV 92,a,208,a,224
ds_read_b128 a[104:107], v242 offset:26624
MV 136,a,68,a,20
MV 140,a,72,a,16
ds_read_b128 a[108:111], v242 offset:27648
MV 96,a,208,a,228
MV 144,a,72,a,20
buffer_load_dwordx4 v238, s[48:51], s69 offen offset:0 sc1 lds
MV 100,a,208,a,232
ds_read_b128 a[112:115], v243 offset:24576
MV 148,a,76,a,16
MV 104,a,208,a,236
MV 152,a,76,a,20
ds_read_b128 a[116:119], v243 offset:25600
MV 156,a,80,a,16
MV 96,a,212,a,224
ds_read_b128 a[120:123], v243 offset:26624
MV 160,a,80,a,20
MV 100,a,212,a,228
buffer_load_dwordx4 v238, s[48:51], s69 offen offset:1024 sc1 lds
MV 164,a,84,a,16
ds_read_b128 a[124:127], v243 offset:27648
MV 104,a,212,a,232
MV 168,a,84,a,20
MV 172,a,88,a,16
MV 100,a,216,a,224
MV 176,a,88,a,20
MV 104,a,216,a,228
MV 180,a,92,a,16
buffer_load_dwordx4 a[16:19], v236, s[44:47], s68 offen offset:0 sc1
MV 104,a,220,a,224
MV 184,a,92,a,20
buffer_load_dwordx4 a[20:23], v237, s[44:47], s68 offen offset:0 sc1
s_waitcnt lgkmcnt(0)
s_barrier
s_waitcnt vmcnt(21)
MV 124,a,96,a,24
ds_read_b128 a[64:67], v242 offset:32768
s_waitcnt vmcnt(20)
MV 128,a,96,a,28
ds_read_b128 a[68:71], v242 offset:33792
buffer_load_dwordx4 v238, s[48:51], s69 offen offset:2048 sc1 lds
MV 132,a,100,a,24
MV 136,a,100,a,28
ds_read_b128 a[72:75], v242 offset:34816
MV 140,a,104,a,24
ds_read_b128 a[76:79], v242 offset:35840
MV 144,a,104,a,28
buffer_load_dwordx4 v238, s[48:51], s69 offen offset:3072 sc1 lds
MV 148,a,108,a,24
ds_read_b128 a[80:83], v243 offset:32768
MV 152,a,108,a,28
ds_read_b128 a[84:87], v243 offset:33792
MV 156,a,112,a,24
MV 160,a,112,a,28
ds_read_b128 a[88:91], v243 offset:34816
s_add_u32 s69, s69, 16384
MV 164,a,116,a,24
ds_read_b128 a[92:95], v243 offset:35840
MV 168,a,116,a,28
MV 172,a,120,a,24
MV 176,a,120,a,28
MV 180,a,124,a,24
buffer_load_dwordx4 a[24:27], v236, s[44:47], s68 offen offset:1024 sc1
MV 184,a,124,a,28
buffer_load_dwordx4 a[28:31], v237, s[44:47], s68 offen offset:1024 sc1
s_add_u32 s68, s68, 2048
s_waitcnt lgkmcnt(0)
s_waitcnt vmcnt(23)
MV 124,a,64,a,32
ds_read_b128 a[96:99], v242 offset:40960
v_cvt_pk_bf16_f32 v16, v76, v77
s_waitcnt vmcnt(22)
MV 128,a,64,a,36
ds_read_b128 a[100:103], v242 offset:41984
s_add_u32 m0, s70, 82944
MV 132,a,68,a,32
v_cvt_pk_bf16_f32 v17, v78, v79
MV 136,a,68,a,36
ds_read_b128 a[104:107], v242 offset:43008
ds_write_b16 v11, v16 offset:0
MV 140,a,72,a,32
ds_read_b128 a[108:111], v242 offset:44032
MV 144,a,72,a,36
buffer_load_dwordx4 v238, s[48:51], s69 offen offset:0 sc1 lds
ds_write_b16_d16_hi v11, v16 offset:8
MV 148,a,76,a,32
ds_read_b128 a[112:115], v243 offset:40960
MV 152,a,76,a,36
ds_read_b128 a[116:119], v243 offset:41984
ds_write_b16 v11, v17 offset:16
MV 156,a,80,a,32
ds_write_b16_d16_hi v11, v17 offset:24
MV 160,a,80,a,36
ds_read_b128 a[120:123], v243 offset:43008
buffer_load_dwordx4 v238, s[48:51], s69 offen offset:1024 sc1 lds
MV 164,a,84,a,32
ds_read_b128 a[124:127], v243 offset:44032
v_cvt_pk_bf16_f32 v18, v80, v81
MV 168,a,84,a,36
MV 172,a,88,a,32
v_cvt_pk_bf16_f32 v19, v82, v83
MV 176,a,88,a,36
MV 180,a,92,a,32
buffer_load_dwordx4 a[32:35], v236, s[44:47], s68 offen offset:0 sc1
ds_write_b16 v11, v18 offset:2176
MV 184,a,92,a,36
buffer_load_dwordx4 a[36:39], v237, s[44:47], s68 offen offset:0 sc1
s_waitcnt vmcnt(14) lgkmcnt(0)
s_barrier
MV 124,a,96,a,40
ds_read_b128 a[64:67], v242 offset:49152
ds_write_b16_d16_hi v11, v18 offset:2184
MV 128,a,96,a,44
ds_read_b128 a[68:71], v242 offset:50176
buffer_load_dwordx4 v238, s[48:51], s69 offen offset:2048 sc1 lds
MV 132,a,100,a,40
ds_write_b16 v11, v19 offset:2192
MV 136,a,100,a,44
ds_read_b128 a[72:75], v242 offset:51200
ds_write_b16_d16_hi v11, v19 offset:2200
MV 140,a,104,a,40
ds_read_b128 a[76:79], v242 offset:52224
v_cvt_pk_bf16_f32 v16, v84, v85
MV 144,a,104,a,44
buffer_load_dwordx4 v238, s[48:51], s69 offen offset:3072 sc1 lds
MV 148,a,108,a,40
ds_read_b128 a[80:83], v243 offset:49152
v_cvt_pk_bf16_f32 v17, v86, v87
MV 152,a,108,a,44
ds_read_b128 a[84:87], v243 offset:50176
MV 156,a,112,a,40
ds_write_b16 v11, v16 offset:4352
MV 160,a,112,a,44
ds_read_b128 a[88:91], v243 offset:51200
s_add_u32 s69, s69, 16384
MV 164,a,116,a,40
ds_read_b128 a[92:95], v243 offset:52224
ds_write_b16_d16_hi v11, v16 offset:4360
MV 168,a,116,a,44
ds_write_b16 v11, v17 offset:4368
MV 172,a,120,a,40
ds_write_b16_d16_hi v11, v17 offset:4376
MV 176,a,120,a,44
MV 180,a,124,a,40
buffer_load_dwordx4 a[40:43], v236, s[44:47], s68 offen offset:1024 sc1
v_cvt_pk_bf16_f32 v18, v88, v89
MV 184,a,124,a,44
buffer_load_dwordx4 a[44:47], v237, s[44:47], s68 offen offset:1024 sc1
s_add_u32 s68, s68, 2048
s_waitcnt lgkmcnt(0)
MV 124,a,64,a,48
ds_read_b128 a[96:99], v242 offset:57344
v_cvt_pk_bf16_f32 v19, v90, v91
MV 128,a,64,a,52
ds_read_b128 a[100:103], v242 offset:58368
s_add_u32 m0, s70, 99328
MV 132,a,68,a,48
ds_write_b16 v11, v18 offset:6528
MV 136,a,68,a,52
ds_read_b128 a[104:107], v242 offset:59392
ds_write_b16_d16_hi v11, v18 offset:6536
MV 140,a,72,a,48
ds_read_b128 a[108:111], v242 offset:60416
MV 144,a,72,a,52
buffer_load_dwordx4 v238, s[48:51], s69 offen offset:0 sc1 lds
ds_write_b16 v11, v19 offset:6544
MV 148,a,76,a,48
ds_read_b128 a[112:115], v243 offset:57344
MV 152,a,76,a,52
ds_read_b128 a[116:119], v243 offset:58368
ds_write_b16_d16_hi v11, v19 offset:6552
MV 156,a,80,a,48
v_cvt_pk_bf16_f32 v16, v92, v93
MV 160,a,80,a,52
ds_read_b128 a[120:123], v243 offset:59392
buffer_load_dwordx4 v238, s[48:51], s69 offen offset:1024 sc1 lds
MV 164,a,84,a,48
ds_read_b128 a[124:127], v243 offset:60416
v_cvt_pk_bf16_f32 v17, v94, v95
MV 168,a,84,a,52
MV 172,a,88,a,48
ds_write_b16 v11, v16 offset:8704
MV 176,a,88,a,52
MV 180,a,92,a,48
buffer_load_dwordx4 a[48:51], v236, s[44:47], s68 offen offset:0 sc1
ds_write_b16_d16_hi v11, v16 offset:8712
MV 184,a,92,a,52
buffer_load_dwordx4 a[52:55], v237, s[44:47], s68 offen offset:0 sc1
s_waitcnt vmcnt(14) lgkmcnt(0)
s_barrier
MV 124,a,96,a,56
ds_read_b128 a[64:67], v242 offset:0
ds_write_b16 v11, v17 offset:8720
MV 128,a,96,a,60
ds_read_b128 a[68:71], v242 offset:1024
buffer_load_dwordx4 v238, s[48:51], s69 offen offset:2048 sc1 lds
MV 132,a,100,a,56
ds_write_b16_d16_hi v11, v17 offset:8728
MV 136,a,100,a,60
ds_read_b128 a[72:75], v242 offset:2048
v_cvt_pk_bf16_f32 v18, v96, v97
MV 140,a,104,a,56
ds_read_b128 a[76:79], v242 offset:3072
v_cvt_pk_bf16_f32 v19, v98, v99
MV 144,a,104,a,60
buffer_load_dwordx4 v238, s[48:51], s69 offen offset:3072 sc1 lds
MV 148,a,108,a,56
ds_read_b128 a[80:83], v243 offset:0
ds_write_b16 v11, v18 offset:10880
MV 152,a,108,a,60
ds_read_b128 a[84:87], v243 offset:1024
MV 156,a,112,a,56
ds_write_b16_d16_hi v11, v18 offset:10888
MV 160,a,112,a,60
ds_read_b128 a[88:91], v243 offset:2048
s_add_u32 s69, s69, 16384
MV 164,a,116,a,56
ds_read_b128 a[92:95], v243 offset:3072
ds_write_b16 v11, v19 offset:10896
MV 168,a,116,a,60
ds_write_b16_d16_hi v11, v19 offset:10904
MV 172,a,120,a,56
v_cvt_pk_bf16_f32 v16, v100, v101
MV 176,a,120,a,60
MV 180,a,124,a,56
buffer_load_dwordx4 a[56:59], v236, s[44:47], s68 offen offset:1024 sc1
v_cvt_pk_bf16_f32 v17, v102, v103
MV 184,a,124,a,60
buffer_load_dwordx4 a[60:63], v237, s[44:47], s68 offen offset:1024 sc1
s_add_u32 s68, s68, 2048
s_waitcnt lgkmcnt(0)
MV 124,a,64,a,0
ds_read_b128 a[96:99], v242 offset:8192
ds_write_b16 v11, v16 offset:13056
MV 128,a,64,a,4
ds_read_b128 a[100:103], v242 offset:9216
s_add_u32 m0, s70, 115712
MV 132,a,68,a,0
ds_write_b16_d16_hi v11, v16 offset:13064
MV 136,a,68,a,4
ds_read_b128 a[104:107], v242 offset:10240
ds_write_b16 v11, v17 offset:13072
MV 140,a,72,a,0
ds_read_b128 a[108:111], v242 offset:11264
ds_write_b16_d16_hi v11, v17 offset:13080
MV 144,a,72,a,4
buffer_load_dwordx4 v238, s[48:51], s69 offen offset:0 sc1 lds
MV 148,a,76,a,0
ds_read_b128 a[112:115], v243 offset:8192
v_cvt_pk_bf16_f32 v18, v104, v105
MV 152,a,76,a,4
ds_read_b128 a[116:119], v243 offset:9216
MV 156,a,80,a,0
v_cvt_pk_bf16_f32 v19, v106, v107
MV 160,a,80,a,4
ds_read_b128 a[120:123], v243 offset:10240
buffer_load_dwordx4 v238, s[48:51], s69 offen offset:1024 sc1 lds
MV 164,a,84,a,0
ds_read_b128 a[124:127], v243 offset:11264
ds_write_b16 v11, v18 offset:15232
MV 168,a,84,a,4
ds_write_b16_d16_hi v11, v18 offset:15240
MV 172,a,88,a,0
ds_write_b16 v11, v19 offset:15248
MV 176,a,88,a,4
MV 180,a,92,a,0
buffer_load_dwordx4 a[0:3], v236, s[44:47], s68 offen offset:0 sc1
ds_write_b16_d16_hi v11, v19 offset:15256
MV 184,a,92,a,4
buffer_load_dwordx4 a[4:7], v237, s[44:47], s68 offen offset:0 sc1
s_waitcnt vmcnt(14) lgkmcnt(0)
s_barrier
MV 124,a,96,a,8
ds_read_b128 a[64:67], v242 offset:16384
ds_read_b64 v[108:109], v12 offset:0
MV 128,a,96,a,12
ds_read_b128 a[68:71], v242 offset:17408
buffer_load_dwordx4 v238, s[48:51], s69 offen offset:2048 sc1 lds
MV 132,a,100,a,8
ds_read_b64 v[110:111], v12 offset:8
MV 136,a,100,a,12
ds_read_b128 a[72:75], v242 offset:18432
MV 140,a,104,a,8
ds_read_b128 a[76:79], v242 offset:19456
ds_read_b64 v[112:113], v12 offset:1088
MV 144,a,104,a,12
buffer_load_dwordx4 v238, s[48:51], s69 offen offset:3072 sc1 lds
MV 148,a,108,a,8
ds_read_b128 a[80:83], v243 offset:16384
ds_read_b64 v[114:115], v12 offset:1096
MV 152,a,108,a,12
ds_read_b128 a[84:87], v243 offset:17408
MV 156,a,112,a,8
ds_read_b64 v[116:117], v12 offset:2176
MV 160,a,112,a,12
ds_read_b128 a[88:91], v243 offset:18432
s_add_u32 s69, s69, 16384
MV 164,a,116,a,8
ds_read_b128 a[92:95], v243 offset:19456
ds_read_b64 v[118:119], v12 offset:2184
MV 168,a,116,a,12
MV 172,a,120,a,8
ds_read_b64 v[120:121], v12 offset:3264
MV 176,a,120,a,12
MV 180,a,124,a,8
buffer_load_dwordx4 a[8:11], v236, s[44:47], s68 offen offset:1024 sc1
ds_read_b64 v[122:123], v12 offset:3272
MV 184,a,124,a,12
buffer_load_dwordx4 a[12:15], v237, s[44:47], s68 offen offset:1024 sc1
s_add_u32 s68, s68, 2048
s_waitcnt lgkmcnt(0)
MV 124,a,64,a,16
ds_read_b128 a[96:99], v242 offset:24576
buffer_store_dwordx4 v[108:111], v13, s[24:27], 0 offen offset:0 sc1
MV 128,a,64,a,20
ds_read_b128 a[100:103], v242 offset:25600
s_add_u32 m0, s70, 66560
MV 132,a,68,a,16
MV 136,a,68,a,20
ds_read_b128 a[104:107], v242 offset:26624
MV 140,a,72,a,16
ds_read_b128 a[108:111], v242 offset:27648
MV 144,a,72,a,20
buffer_load_dwordx4 v238, s[48:51], s69 offen offset:0 sc1 lds
MV 148,a,76,a,16
ds_read_b128 a[112:115], v243 offset:24576
MV 152,a,76,a,20
ds_read_b128 a[116:119], v243 offset:25600
MV 156,a,80,a,16
buffer_store_dwordx4 v[112:115], v13, s[24:27], 0 offen offset:1024 sc1
MV 160,a,80,a,20
ds_read_b128 a[120:123], v243 offset:26624
buffer_load_dwordx4 v238, s[48:51], s69 offen offset:1024 sc1 lds
MV 164,a,84,a,16
ds_read_b128 a[124:127], v243 offset:27648
MV 168,a,84,a,20
MV 172,a,88,a,16
MV 176,a,88,a,20
MV 180,a,92,a,16
buffer_load_dwordx4 a[16:19], v236, s[44:47], s68 offen offset:0 sc1
MV 184,a,92,a,20
buffer_load_dwordx4 a[20:23], v237, s[44:47], s68 offen offset:0 sc1
s_waitcnt vmcnt(16) lgkmcnt(0)
s_barrier
MV 124,a,96,a,24
ds_read_b128 a[64:67], v242 offset:32768
buffer_store_dwordx4 v[116:119], v13, s[24:27], 0 offen offset:2048 sc1
MV 128,a,96,a,28
ds_read_b128 a[68:71], v242 offset:33792
buffer_load_dwordx4 v238, s[48:51], s69 offen offset:2048 sc1 lds
MV 132,a,100,a,24
MV 136,a,100,a,28
ds_read_b128 a[72:75], v242 offset:34816
MV 140,a,104,a,24
ds_read_b128 a[76:79], v242 offset:35840
MV 144,a,104,a,28
buffer_load_dwordx4 v238, s[48:51], s69 offen offset:3072 sc1 lds
MV 148,a,108,a,24
ds_read_b128 a[80:83], v243 offset:32768
MV 152,a,108,a,28
ds_read_b128 a[84:87], v243 offset:33792
MV 156,a,112,a,24
buffer_store_dwordx4 v[120:123], v13, s[24:27], 0 offen offset:3072 sc1
MV 160,a,112,a,28
ds_read_b128 a[88:91], v243 offset:34816
s_add_u32 s69, s69, 16384
MV 164,a,116,a,24
ds_read_b128 a[92:95], v243 offset:35840
MV 168,a,116,a,28
MV 172,a,120,a,24
MV 176,a,120,a,28
MV 180,a,124,a,24
buffer_load_dwordx4 a[24:27], v236, s[44:47], s68 offen offset:1024 sc1
MV 184,a,124,a,28
buffer_load_dwordx4 a[28:31], v237, s[44:47], s68 offen offset:1024 sc1
s_add_u32 s68, s68, 2048
s_waitcnt lgkmcnt(0)
MV 124,a,64,a,32
ds_read_b128 a[96:99], v242 offset:40960
MV 128,a,64,a,36
ds_read_b128 a[100:103], v242 offset:41984
s_add_u32 m0, s70, 82944
MV 132,a,68,a,32
MV 136,a,68,a,36
ds_read_b128 a[104:107], v242 offset:43008
MV 140,a,72,a,32
ds_read_b128 a[108:111], v242 offset:44032
MV 144,a,72,a,36
buffer_load_dwordx4 v238, s[48:51], s69 offen offset:0 sc1 lds
MV 148,a,76,a,32
ds_read_b128 a[112:115], v243 offset:40960
MV 152,a,76,a,36
ds_read_b128 a[116:119], v243 offset:41984
MV 156,a,80,a,32
MV 160,a,80,a,36
ds_read_b128 a[120:123], v243 offset:43008
buffer_load_dwordx4 v238, s[48:51], s69 offen offset:1024 sc1 lds
MV 164,a,84,a,32
ds_read_b128 a[124:127], v243 offset:44032
MV 168,a,84,a,36
MV 172,a,88,a,32
MV 176,a,88,a,36
MV 180,a,92,a,32
buffer_load_dwordx4 a[32:35], v236, s[44:47], s68 offen offset:0 sc1
MV 184,a,92,a,36
buffer_load_dwordx4 a[36:39], v237, s[44:47], s68 offen offset:0 sc1
s_waitcnt vmcnt(18) lgkmcnt(0)
s_barrier
MV 124,a,96,a,40
ds_read_b128 a[64:67], v242 offset:49152
MV 128,a,96,a,44
ds_read_b128 a[68:71], v242 offset:50176
buffer_load_dwordx4 v238, s[48:51], s69 offen offset:2048 sc1 lds
MV 132,a,100,a,40
MV 136,a,100,a,44
ds_read_b128 a[72:75], v242 offset:51200
MV 140,a,104,a,40
ds_read_b128 a[76:79], v242 offset:52224
MV 144,a,104,a,44
buffer_load_dwordx4 v238, s[48:51], s69 offen offset:3072 sc1 lds
MV 148,a,108,a,40
ds_read_b128 a[80:83], v243 offset:49152
MV 152,a,108,a,44
ds_read_b128 a[84:87], v243 offset:50176
MV 156,a,112,a,40
MV 160,a,112,a,44
ds_read_b128 a[88:91], v243 offset:51200
s_add_u32 s69, s69, 16384
MV 164,a,116,a,40
ds_read_b128 a[92:95], v243 offset:52224
MV 168,a,116,a,44
MV 172,a,120,a,40
MV 176,a,120,a,44
MV 180,a,124,a,40
buffer_load_dwordx4 a[40:43], v236, s[44:47], s68 offen offset:1024 sc1
MV 184,a,124,a,44
buffer_load_dwordx4 a[44:47], v237, s[44:47], s68 offen offset:1024 sc1
s_add_u32 s68, s68, 2048
s_waitcnt lgkmcnt(0)
MV 124,a,64,a,48
ds_read_b128 a[96:99], v242 offset:57344
MV 128,a,64,a,52
ds_read_b128 a[100:103], v242 offset:58368
s_add_u32 m0, s70, 99328
MV 132,a,68,a,48
MV 136,a,68,a,52
ds_read_b128 a[104:107], v242 offset:59392
MV 140,a,72,a,48
ds_read_b128 a[108:111], v242 offset:60416
MV 144,a,72,a,52
buffer_load_dwordx4 v238, s[48:51], s69 offen offset:0 sc1 lds
MV 148,a,76,a,48
ds_read_b128 a[112:115], v243 offset:57344
MV 152,a,76,a,52
ds_read_b128 a[116:119], v243 offset:58368
MV 156,a,80,a,48
MV 160,a,80,a,52
ds_read_b128 a[120:123], v243 offset:59392
buffer_load_dwordx4 v238, s[48:51], s69 offen offset:1024 sc1 lds
MV 164,a,84,a,48
ds_read_b128 a[124:127], v243 offset:60416
MV 168,a,84,a,52
MV 172,a,88,a,48
MV 176,a,88,a,52
MV 180,a,92,a,48
buffer_load_dwordx4 a[48:51], v236, s[44:47], s68 offen offset:0 sc1
MV 184,a,92,a,52
buffer_load_dwordx4 a[52:55], v237, s[44:47], s68 offen offset:0 sc1
s_waitcnt vmcnt(15) lgkmcnt(0)
s_barrier
MV 124,a,96,a,56
ds_read_b128 a[64:67], v242 offset:0
MV 128,a,96,a,60
ds_read_b128 a[68:71], v242 offset:1024
buffer_load_dwordx4 v238, s[48:51], s69 offen offset:2048 sc1 lds
MV 132,a,100,a,56
MV 136,a,100,a,60
ds_read_b128 a[72:75], v242 offset:2048
MV 140,a,104,a,56
ds_read_b128 a[76:79], v242 offset:3072
MV 144,a,104,a,60
buffer_load_dwordx4 v238, s[48:51], s69 offen offset:3072 sc1 lds
MV 148,a,108,a,56
ds_read_b128 a[80:83], v243 offset:0
MV 152,a,108,a,60
ds_read_b128 a[84:87], v243 offset:1024
MV 156,a,112,a,56
MV 160,a,112,a,60
ds_read_b128 a[88:91], v243 offset:2048
s_add_u32 s69, s69, 16384
MV 164,a,116,a,56
ds_read_b128 a[92:95], v243 offset:3072
MV 168,a,116,a,60
MV 172,a,120,a,56
MV 176,a,120,a,60
MV 180,a,124,a,56
buffer_load_dwordx4 a[56:59], v236, s[44:47], s68 offen offset:1024 sc1
MV 184,a,124,a,60
buffer_load_dwordx4 a[60:63], v237, s[44:47], s68 offen offset:1024 sc1
s_add_u32 s68, s68, 2048
s_waitcnt lgkmcnt(0)
MV 124,a,64,a,0
ds_read_b128 a[96:99], v242 offset:8192
MV 128,a,64,a,4
ds_read_b128 a[100:103], v242 offset:9216
s_add_u32 m0, s70, 115712
MV 132,a,68,a,0
MV 136,a,68,a,4
ds_read_b128 a[104:107], v242 offset:10240
MV 140,a,72,a,0
ds_read_b128 a[108:111], v242 offset:11264
MV 144,a,72,a,4
buffer_load_dwordx4 v238, s[48:51], s69 offen offset:0 sc1 lds
MV 148,a,76,a,0
ds_read_b128 a[112:115], v243 offset:8192
MV 152,a,76,a,4
ds_read_b128 a[116:119], v243 offset:9216
MV 156,a,80,a,0
MV 160,a,80,a,4
ds_read_b128 a[120:123], v243 offset:10240
buffer_load_dwordx4 v238, s[48:51], s69 offen offset:1024 sc1 lds
MV 164,a,84,a,0
ds_read_b128 a[124:127], v243 offset:11264
MV 168,a,84,a,4
MV 172,a,88,a,0
MV 176,a,88,a,4
MV 180,a,92,a,0
buffer_load_dwordx4 a[0:3], v236, s[44:47], s68 offen offset:0 sc1
MV 184,a,92,a,4
buffer_load_dwordx4 a[4:7], v237, s[44:47], s68 offen offset:0 sc1
s_waitcnt vmcnt(14) lgkmcnt(0)
s_barrier
MV 124,a,96,a,8
ds_read_b128 a[64:67], v242 offset:16384
MV 128,a,96,a,12
ds_read_b128 a[68:71], v242 offset:17408
buffer_load_dwordx4 v238, s[48:51], s69 offen offset:2048 sc1 lds
MV 132,a,100,a,8
MV 136,a,100,a,12
ds_read_b128 a[72:75], v242 offset:18432
MV 140,a,104,a,8
ds_read_b128 a[76:79], v242 offset:19456
MV 144,a,104,a,12
buffer_load_dwordx4 v238, s[48:51], s69 offen offset:3072 sc1 lds
MV 148,a,108,a,8
ds_read_b128 a[80:83], v243 offset:16384
MV 152,a,108,a,12
ds_read_b128 a[84:87], v243 offset:17408
MV 156,a,112,a,8
MV 160,a,112,a,12
ds_read_b128 a[88:91], v243 offset:18432
s_add_u32 s69, s69, 16384
MV 164,a,116,a,8
ds_read_b128 a[92:95], v243 offset:19456
MV 168,a,116,a,12
MV 172,a,120,a,8
MV 176,a,120,a,12
MV 180,a,124,a,8
buffer_load_dwordx4 a[8:11], v236, s[44:47], s68 offen offset:1024 sc1
MV 184,a,124,a,12
buffer_load_dwordx4 a[12:15], v237, s[44:47], s68 offen offset:1024 sc1
s_add_u32 s68, s68, 2048
s_waitcnt lgkmcnt(0)
MV 124,a,64,a,16
ds_read_b128 a[96:99], v242 offset:24576
MV 128,a,64,a,20
ds_read_b128 a[100:103], v242 offset:25600
s_add_u32 m0, s70, 66560
MV 132,a,68,a,16
MV 136,a,68,a,20
ds_read_b128 a[104:107], v242 offset:26624
MV 140,a,72,a,16
ds_read_b128 a[108:111], v242 offset:27648
MV 144,a,72,a,20
buffer_load_dwordx4 v238, s[48:51], s69 offen offset:0 sc1 lds
MV 148,a,76,a,16
ds_read_b128 a[112:115], v243 offset:24576
MV 152,a,76,a,20
ds_read_b128 a[116:119], v243 offset:25600
MV 156,a,80,a,16
MV 160,a,80,a,20
ds_read_b128 a[120:123], v243 offset:26624
buffer_load_dwordx4 v238, s[48:51], s69 offen offset:1024 sc1 lds
MV 164,a,84,a,16
ds_read_b128 a[124:127], v243 offset:27648
MV 168,a,84,a,20
MV 172,a,88,a,16
MV 176,a,88,a,20
MV 180,a,92,a,16
buffer_load_dwordx4 a[16:19], v236, s[44:47], s68 offen offset:0 sc1
MV 184,a,92,a,20
buffer_load_dwordx4 a[20:23], v237, s[44:47], s68 offen offset:0 sc1
s_waitcnt vmcnt(14) lgkmcnt(0)
s_barrier
MV 124,a,96,a,24
ds_read_b128 a[64:67], v242 offset:32768
MV 128,a,96,a,28
ds_read_b128 a[68:71], v242 offset:33792
buffer_load_dwordx4 v238, s[48:51], s69 offen offset:2048 sc1 lds
MV 132,a,100,a,24
MV 136,a,100,a,28
ds_read_b128 a[72:75], v242 offset:34816
MV 140,a,104,a,24
ds_read_b128 a[76:79], v242 offset:35840
MV 144,a,104,a,28
buffer_load_dwordx4 v238, s[48:51], s69 offen offset:3072 sc1 lds
MV 148,a,108,a,24
ds_read_b128 a[80:83], v243 offset:32768
MV 152,a,108,a,28
ds_read_b128 a[84:87], v243 offset:33792
MV 156,a,112,a,24
MV 160,a,112,a,28
ds_read_b128 a[88:91], v243 offset:34816
s_add_u32 s69, s69, 16384
MV 164,a,116,a,24
ds_read_b128 a[92:95], v243 offset:35840
MV 168,a,116,a,28
MV 172,a,120,a,24
MV 176,a,120,a,28
MV 180,a,124,a,24
buffer_load_dwordx4 a[24:27], v236, s[44:47], s68 offen offset:1024 sc1
MV 184,a,124,a,28
buffer_load_dwordx4 a[28:31], v237, s[44:47], s68 offen offset:1024 sc1
s_add_u32 s68, s68, 2048
s_waitcnt lgkmcnt(0)
MV 124,a,64,a,32
ds_read_b128 a[96:99], v242 offset:40960
MV 128,a,64,a,36
ds_read_b128 a[100:103], v242 offset:41984
s_add_u32 m0, s70, 82944
MV 132,a,68,a,32
MV 136,a,68,a,36
ds_read_b128 a[104:107], v242 offset:43008
MV 140,a,72,a,32
ds_read_b128 a[108:111], v242 offset:44032
MV 144,a,72,a,36
buffer_load_dwordx4 v238, s[48:51], s69 offen offset:0 sc1 lds
MV 148,a,76,a,32
ds_read_b128 a[112:115], v243 offset:40960
MV 152,a,76,a,36
ds_read_b128 a[116:119], v243 offset:41984
MV 156,a,80,a,32
MV 160,a,80,a,36
ds_read_b128 a[120:123], v243 offset:43008
buffer_load_dwordx4 v238, s[48:51], s69 offen offset:1024 sc1 lds
MV 164,a,84,a,32
ds_read_b128 a[124:127], v243 offset:44032
MV 168,a,84,a,36
MV 172,a,88,a,32
MV 176,a,88,a,36
MV 180,a,92,a,32
buffer_load_dwordx4 a[32:35], v236, s[44:47], s68 offen offset:0 sc1
MV 184,a,92,a,36
buffer_load_dwordx4 a[36:39], v237, s[44:47], s68 offen offset:0 sc1
s_waitcnt vmcnt(14) lgkmcnt(0)
s_barrier
v_mov_b32 v253, 1
s_lshl_b32 s36, s2, 2
buffer_store_dword v253, v255, s[8:11], s36 offen offset:2048 sc1
MV 124,a,96,a,40
ds_read_b128 a[64:67], v242 offset:49152
MV 128,a,96,a,44
ds_read_b128 a[68:71], v242 offset:50176
buffer_load_dwordx4 v238, s[48:51], s69 offen offset:2048 sc1 lds
MV 132,a,100,a,40
MV 136,a,100,a,44
ds_read_b128 a[72:75], v242 offset:51200
MV 140,a,104,a,40
ds_read_b128 a[76:79], v242 offset:52224
MV 144,a,104,a,44
buffer_load_dwordx4 v238, s[48:51], s69 offen offset:3072 sc1 lds
MV 148,a,108,a,40
ds_read_b128 a[80:83], v243 offset:49152
MV 152,a,108,a,44
ds_read_b128 a[84:87], v243 offset:50176
MV 156,a,112,a,40
MV 160,a,112,a,44
ds_read_b128 a[88:91], v243 offset:51200
s_add_u32 s69, s69, 16384
MV 164,a,116,a,40
ds_read_b128 a[92:95], v243 offset:52224
MV 168,a,116,a,44
MV 172,a,120,a,40
MV 176,a,120,a,44
MV 180,a,124,a,40
buffer_load_dwordx4 a[40:43], v236, s[44:47], s68 offen offset:1024 sc1
MV 184,a,124,a,44
buffer_load_dwordx4 a[44:47], v237, s[44:47], s68 offen offset:1024 sc1
s_add_u32 s68, s68, 2048
s_waitcnt lgkmcnt(0)
MV 124,a,64,a,48
ds_read_b128 a[96:99], v242 offset:57344
MV 128,a,64,a,52
ds_read_b128 a[100:103], v242 offset:58368
s_add_u32 m0, s70, 99328
MV 132,a,68,a,48
MV 136,a,68,a,52
ds_read_b128 a[104:107], v242 offset:59392
MV 140,a,72,a,48
ds_read_b128 a[108:111], v242 offset:60416
MV 144,a,72,a,52
buffer_load_dwordx4 v238, s[48:51], s69 offen offset:0 sc1 lds
MV 148,a,76,a,48
ds_read_b128 a[112:115], v243 offset:57344
MV 152,a,76,a,52
ds_read_b128 a[116:119], v243 offset:58368
MV 156,a,80,a,48
MV 160,a,80,a,52
ds_read_b128 a[120:123], v243 offset:59392
buffer_load_dwordx4 v238, s[48:51], s69 offen offset:1024 sc1 lds
MV 164,a,84,a,48
ds_read_b128 a[124:127], v243 offset:60416
MV 168,a,84,a,52
MV 172,a,88,a,48
MV 176,a,88,a,52
MV 180,a,92,a,48
buffer_load_dwordx4 a[48:51], v236, s[44:47], s68 offen offset:0 sc1
MV 184,a,92,a,52
buffer_load_dwordx4 a[52:55], v237, s[44:47], s68 offen offset:0 sc1
s_waitcnt vmcnt(15) lgkmcnt(0)
s_barrier
MV 124,a,96,a,56
ds_read_b128 a[64:67], v242 offset:0
MV 128,a,96,a,60
ds_read_b128 a[68:71], v242 offset:1024
buffer_load_dwordx4 v238, s[48:51], s69 offen offset:2048 sc1 lds
MV 132,a,100,a,56
MV 136,a,100,a,60
ds_read_b128 a[72:75], v242 offset:2048
MV 140,a,104,a,56
ds_read_b128 a[76:79], v242 offset:3072
MV 144,a,104,a,60
buffer_load_dwordx4 v238, s[48:51], s69 offen offset:3072 sc1 lds
MV 148,a,108,a,56
ds_read_b128 a[80:83], v243 offset:0
MV 152,a,108,a,60
ds_read_b128 a[84:87], v243 offset:1024
MV 156,a,112,a,56
MV 160,a,112,a,60
ds_read_b128 a[88:91], v243 offset:2048
s_add_u32 s69, s69, 16384
MV 164,a,116,a,56
ds_read_b128 a[92:95], v243 offset:3072
MV 168,a,116,a,60
MV 172,a,120,a,56
MV 176,a,120,a,60
MV 180,a,124,a,56
buffer_load_dwordx4 a[56:59], v236, s[44:47], s68 offen offset:1024 sc1
MV 184,a,124,a,60
buffer_load_dwordx4 a[60:63], v237, s[44:47], s68 offen offset:1024 sc1
s_add_u32 s68, s68, 2048
s_waitcnt lgkmcnt(0)
MV 124,a,64,a,0
ds_read_b128 a[96:99], v242 offset:8192
MV 128,a,64,a,4
ds_read_b128 a[100:103], v242 offset:9216
s_add_u32 m0, s70, 115712
MV 132,a,68,a,0
MV 136,a,68,a,4
ds_read_b128 a[104:107], v242 offset:10240
MV 140,a,72,a,0
ds_read_b128 a[108:111], v242 offset:11264
MV 144,a,72,a,4
buffer_load_dwordx4 v238, s[48:51], s69 offen offset:0 sc1 lds
MV 148,a,76,a,0
ds_read_b128 a[112:115], v243 offset:8192
MV 152,a,76,a,4
ds_read_b128 a[116:119], v243 offset:9216
MV 156,a,80,a,0
MV 160,a,80,a,4
ds_read_b128 a[120:123], v243 offset:10240
buffer_load_dwordx4 v238, s[48:51], s69 offen offset:1024 sc1 lds
MV 164,a,84,a,0
ds_read_b128 a[124:127], v243 offset:11264
MV 168,a,84,a,4
MV 172,a,88,a,0
MV 176,a,88,a,4
MV 180,a,92,a,0
buffer_load_dwordx4 a[0:3], v236, s[44:47], s68 offen offset:0 sc1
MV 184,a,92,a,4
buffer_load_dwordx4 a[4:7], v237, s[44:47], s68 offen offset:0 sc1
s_waitcnt vmcnt(14) lgkmcnt(0)
s_barrier
MV 124,a,96,a,8
ds_read_b128 a[64:67], v242 offset:16384
MV 128,a,96,a,12
ds_read_b128 a[68:71], v242 offset:17408
buffer_load_dwordx4 v238, s[48:51], s69 offen offset:2048 sc1 lds
MV 132,a,100,a,8
MV 136,a,100,a,12
ds_read_b128 a[72:75], v242 offset:18432
MV 140,a,104,a,8
ds_read_b128 a[76:79], v242 offset:19456
MV 144,a,104,a,12
buffer_load_dwordx4 v238, s[48:51], s69 offen offset:3072 sc1 lds
MV 148,a,108,a,8
ds_read_b128 a[80:83], v243 offset:16384
MV 152,a,108,a,12
ds_read_b128 a[84:87], v243 offset:17408
MV 156,a,112,a,8
MV 160,a,112,a,12
ds_read_b128 a[88:91], v243 offset:18432
s_add_u32 s69, s69, 16384
MV 164,a,116,a,8
ds_read_b128 a[92:95], v243 offset:19456
MV 168,a,116,a,12
MV 172,a,120,a,8
MV 176,a,120,a,12
MV 180,a,124,a,8
buffer_load_dwordx4 a[8:11], v236, s[44:47], s68 offen offset:1024 sc1
MV 184,a,124,a,12
buffer_load_dwordx4 a[12:15], v237, s[44:47], s68 offen offset:1024 sc1
s_add_u32 s68, s68, 2048
s_waitcnt lgkmcnt(0)
MV 124,a,64,a,16
ds_read_b128 a[96:99], v242 offset:24576
MV 128,a,64,a,20
ds_read_b128 a[100:103], v242 offset:25600
s_add_u32 m0, s70, 66560
MV 132,a,68,a,16
MV 136,a,68,a,20
ds_read_b128 a[104:107], v242 offset:26624
MV 140,a,72,a,16
ds_read_b128 a[108:111], v242 offset:27648
MV 144,a,72,a,20
buffer_load_dwordx4 v238, s[48:51], s69 offen offset:0 sc1 lds
MV 148,a,76,a,16
ds_read_b128 a[112:115], v243 offset:24576
MV 152,a,76,a,20
ds_read_b128 a[116:119], v243 offset:25600
MV 156,a,80,a,16
MV 160,a,80,a,20
ds_read_b128 a[120:123], v243 offset:26624
buffer_load_dwordx4 v238, s[48:51], s69 offen offset:1024 sc1 lds
MV 164,a,84,a,16
ds_read_b128 a[124:127], v243 offset:27648
MV 168,a,84,a,20
MV 172,a,88,a,16
MV 176,a,88,a,20
MV 180,a,92,a,16
buffer_load_dwordx4 a[16:19], v236, s[44:47], s68 offen offset:0 sc1
MV 184,a,92,a,20
buffer_load_dwordx4 a[20:23], v237, s[44:47], s68 offen offset:0 sc1
s_waitcnt vmcnt(14) lgkmcnt(0)
s_barrier
MV 124,a,96,a,24
ds_read_b128 a[64:67], v242 offset:32768
MV 128,a,96,a,28
ds_read_b128 a[68:71], v242 offset:33792
buffer_load_dwordx4 v238, s[48:51], s69 offen offset:2048 sc1 lds
MV 132,a,100,a,24
MV 136,a,100,a,28
ds_read_b128 a[72:75], v242 offset:34816
MV 140,a,104,a,24
ds_read_b128 a[76:79], v242 offset:35840
MV 144,a,104,a,28
buffer_load_dwordx4 v238, s[48:51], s69 offen offset:3072 sc1 lds
MV 148,a,108,a,24
ds_read_b128 a[80:83], v243 offset:32768
MV 152,a,108,a,28
ds_read_b128 a[84:87], v243 offset:33792
MV 156,a,112,a,24
MV 160,a,112,a,28
ds_read_b128 a[88:91], v243 offset:34816
s_add_u32 s69, s69, 16384
MV 164,a,116,a,24
ds_read_b128 a[92:95], v243 offset:35840
MV 168,a,116,a,28
MV 172,a,120,a,24
MV 176,a,120,a,28
MV 180,a,124,a,24
buffer_load_dwordx4 a[24:27], v236, s[44:47], s68 offen offset:1024 sc1
MV 184,a,124,a,28
buffer_load_dwordx4 a[28:31], v237, s[44:47], s68 offen offset:1024 sc1
s_add_u32 s68, s68, 2048
s_waitcnt lgkmcnt(0)
MV 124,a,64,a,32
ds_read_b128 a[96:99], v242 offset:40960
MV 128,a,64,a,36
ds_read_b128 a[100:103], v242 offset:41984
s_add_u32 m0, s70, 82944
MV 132,a,68,a,32
MV 136,a,68,a,36
ds_read_b128 a[104:107], v242 offset:43008
MV 140,a,72,a,32
ds_read_b128 a[108:111], v242 offset:44032
MV 144,a,72,a,36
buffer_load_dwordx4 v238, s[48:51], s69 offen offset:0 sc1 lds
MV 148,a,76,a,32
ds_read_b128 a[112:115], v243 offset:40960
MV 152,a,76,a,36
ds_read_b128 a[116:119], v243 offset:41984
MV 156,a,80,a,32
MV 160,a,80,a,36
ds_read_b128 a[120:123], v243 offset:43008
buffer_load_dwordx4 v238, s[48:51], s69 offen offset:1024 sc1 lds
MV 164,a,84,a,32
ds_read_b128 a[124:127], v243 offset:44032
MV 168,a,84,a,36
MV 172,a,88,a,32
MV 176,a,88,a,36
MV 180,a,92,a,32
buffer_load_dwordx4 a[32:35], v236, s[44:47], s68 offen offset:0 sc1
MV 184,a,92,a,36
buffer_load_dwordx4 a[36:39], v237, s[44:47], s68 offen offset:0 sc1
s_waitcnt vmcnt(14) lgkmcnt(0)
s_barrier
MV 124,a,96,a,40
ds_read_b128 a[64:67], v242 offset:49152
MV 128,a,96,a,44
ds_read_b128 a[68:71], v242 offset:50176
buffer_load_dwordx4 v238, s[48:51], s69 offen offset:2048 sc1 lds
MV 132,a,100,a,40
MV 136,a,100,a,44
ds_read_b128 a[72:75], v242 offset:51200
MV 140,a,104,a,40
ds_read_b128 a[76:79], v242 offset:52224
MV 144,a,104,a,44
buffer_load_dwordx4 v238, s[48:51], s69 offen offset:3072 sc1 lds
MV 148,a,108,a,40
ds_read_b128 a[80:83], v243 offset:49152
MV 152,a,108,a,44
ds_read_b128 a[84:87], v243 offset:50176
MV 156,a,112,a,40
MV 160,a,112,a,44
ds_read_b128 a[88:91], v243 offset:51200
s_add_u32 s69, s69, 16384
MV 164,a,116,a,40
ds_read_b128 a[92:95], v243 offset:52224
MV 168,a,116,a,44
MV 172,a,120,a,40
MV 176,a,120,a,44
MV 180,a,124,a,40
buffer_load_dwordx4 a[40:43], v236, s[44:47], s68 offen offset:1024 sc1
MV 184,a,124,a,44
buffer_load_dwordx4 a[44:47], v237, s[44:47], s68 offen offset:1024 sc1
s_add_u32 s68, s68, 2048
s_waitcnt lgkmcnt(0)
MV 124,a,64,a,48
ds_read_b128 a[96:99], v242 offset:57344
v_and_b32 v254, 15, v1
MV 128,a,64,a,52
ds_read_b128 a[100:103], v242 offset:58368
s_add_u32 m0, s70, 99328
MV 132,a,68,a,48
MV 136,a,68,a,52
ds_read_b128 a[104:107], v242 offset:59392
MV 140,a,72,a,48
ds_read_b128 a[108:111], v242 offset:60416
s_lshl_b32 s36, s82, 4
MV 144,a,72,a,52
buffer_load_dwordx4 v238, s[48:51], s69 offen offset:0 sc1 lds
MV 148,a,76,a,48
ds_read_b128 a[112:115], v243 offset:57344
MV 152,a,76,a,52
ds_read_b128 a[116:119], v243 offset:58368
MV 156,a,80,a,48
v_add_u32 v254, s36, v254
MV 160,a,80,a,52
ds_read_b128 a[120:123], v243 offset:59392
buffer_load_dwordx4 v238, s[48:51], s69 offen offset:1024 sc1 lds
MV 164,a,84,a,48
ds_read_b128 a[124:127], v243 offset:60416
MV 168,a,84,a,52
MV 172,a,88,a,48
v_lshlrev_b32 v254, 2, v254
MV 176,a,88,a,52
MV 180,a,92,a,48
buffer_load_dwordx4 a[48:51], v236, s[44:47], s68 offen offset:0 sc1
MV 184,a,92,a,52
buffer_load_dwordx4 a[52:55], v237, s[44:47], s68 offen offset:0 sc1
s_waitcnt vmcnt(14) lgkmcnt(0)
s_barrier
MV 124,a,96,a,56
ds_read_b128 a[64:67], v242 offset:0
buffer_load_dword v253, v254, s[8:11], 0 offen offset:2048 sc1
MV 128,a,96,a,60
ds_read_b128 a[68:71], v242 offset:1024
buffer_load_dwordx4 v238, s[48:51], s69 offen offset:2048 sc1 lds
MV 132,a,100,a,56
MV 136,a,100,a,60
ds_read_b128 a[72:75], v242 offset:2048
MV 140,a,104,a,56
ds_read_b128 a[76:79], v242 offset:3072
MV 144,a,104,a,60
buffer_load_dwordx4 v238, s[48:51], s69 offen offset:3072 sc1 lds
MV 148,a,108,a,56
ds_read_b128 a[80:83], v243 offset:0
MV 152,a,108,a,60
ds_read_b128 a[84:87], v243 offset:1024
MV 156,a,112,a,56
MV 160,a,112,a,60
ds_read_b128 a[88:91], v243 offset:2048
s_add_u32 s69, s69, 16384
MV 164,a,116,a,56
ds_read_b128 a[92:95], v243 offset:3072
MV 168,a,116,a,60
MV 172,a,120,a,56
MV 176,a,120,a,60
MV 180,a,124,a,56
buffer_load_dwordx4 a[56:59], v236, s[44:47], s68 offen offset:1024 sc1
MV 184,a,124,a,60
buffer_load_dwordx4 a[60:63], v237, s[44:47], s68 offen offset:1024 sc1
s_add_u32 s68, s68, 2048
s_waitcnt lgkmcnt(0)
MV 124,a,64,a,0
ds_read_b128 a[96:99], v242 offset:8192
MV 128,a,64,a,4
ds_read_b128 a[100:103], v242 offset:9216
s_add_u32 m0, s70, 115712
MV 132,a,68,a,0
MV 136,a,68,a,4
ds_read_b128 a[104:107], v242 offset:10240
MV 140,a,72,a,0
ds_read_b128 a[108:111], v242 offset:11264
MV 144,a,72,a,4
buffer_load_dwordx4 v238, s[48:51], s69 offen offset:0 sc1 lds
MV 148,a,76,a,0
ds_read_b128 a[112:115], v243 offset:8192
MV 152,a,76,a,4
ds_read_b128 a[116:119], v243 offset:9216
MV 156,a,80,a,0
MV 160,a,80,a,4
ds_read_b128 a[120:123], v243 offset:10240
buffer_load_dwordx4 v238, s[48:51], s69 offen offset:1024 sc1 lds
MV 164,a,84,a,0
ds_read_b128 a[124:127], v243 offset:11264
MV 168,a,84,a,4
MV 172,a,88,a,0
MV 176,a,88,a,4
MV 180,a,92,a,0
buffer_load_dwordx4 a[0:3], v236, s[44:47], s68 offen offset:0 sc1
MV 184,a,92,a,4
buffer_load_dwordx4 a[4:7], v237, s[44:47], s68 offen offset:0 sc1
s_waitcnt vmcnt(15) lgkmcnt(0)
s_barrier
MV 124,a,96,a,8
ds_read_b128 a[64:67], v242 offset:16384
MV 128,a,96,a,12
ds_read_b128 a[68:71], v242 offset:17408
buffer_load_dwordx4 v238, s[48:51], s69 offen offset:2048 sc1 lds
MV 132,a,100,a,8
MV 136,a,100,a,12
ds_read_b128 a[72:75], v242 offset:18432
MV 140,a,104,a,8
ds_read_b128 a[76:79], v242 offset:19456
MV 144,a,104,a,12
buffer_load_dwordx4 v238, s[48:51], s69 offen offset:3072 sc1 lds
MV 148,a,108,a,8
ds_read_b128 a[80:83], v243 offset:16384
MV 152,a,108,a,12
ds_read_b128 a[84:87], v243 offset:17408
MV 156,a,112,a,8
MV 160,a,112,a,12
ds_read_b128 a[88:91], v243 offset:18432
s_add_u32 s69, s69, 16384
MV 164,a,116,a,8
ds_read_b128 a[92:95], v243 offset:19456
MV 168,a,116,a,12
MV 172,a,120,a,8
MV 176,a,120,a,12
MV 180,a,124,a,8
buffer_load_dwordx4 a[8:11], v236, s[44:47], s68 offen offset:1024 sc1
MV 184,a,124,a,12
buffer_load_dwordx4 a[12:15], v237, s[44:47], s68 offen offset:1024 sc1
s_add_u32 s68, s68, 2048
s_waitcnt lgkmcnt(0)
MV 124,a,64,a,16
ds_read_b128 a[96:99], v242 offset:24576
MV 128,a,64,a,20
ds_read_b128 a[100:103], v242 offset:25600
s_add_u32 m0, s70, 66560
MV 132,a,68,a,16
MV 136,a,68,a,20
ds_read_b128 a[104:107], v242 offset:26624
MV 140,a,72,a,16
ds_read_b128 a[108:111], v242 offset:27648
MV 144,a,72,a,20
buffer_load_dwordx4 v238, s[48:51], s69 offen offset:0 sc1 lds
MV 148,a,76,a,16
ds_read_b128 a[112:115], v243 offset:24576
MV 152,a,76,a,20
ds_read_b128 a[116:119], v243 offset:25600
MV 156,a,80,a,16
MV 160,a,80,a,20
ds_read_b128 a[120:123], v243 offset:26624
buffer_load_dwordx4 v238, s[48:51], s69 offen offset:1024 sc1 lds
MV 164,a,84,a,16
ds_read_b128 a[124:127], v243 offset:27648
MV 168,a,84,a,20
MV 172,a,88,a,16
MV 176,a,88,a,20
MV 180,a,92,a,16
buffer_load_dwordx4 a[16:19], v236, s[44:47], s68 offen offset:0 sc1
MV 184,a,92,a,20
buffer_load_dwordx4 a[20:23], v237, s[44:47], s68 offen offset:0 sc1
s_waitcnt vmcnt(14) lgkmcnt(0)
s_barrier
MV 124,a,96,a,24
ds_read_b128 a[64:67], v242 offset:32768
MV 128,a,96,a,28
ds_read_b128 a[68:71], v242 offset:33792
buffer_load_dwordx4 v238, s[48:51], s69 offen offset:2048 sc1 lds
MV 132,a,100,a,24
MV 136,a,100,a,28
ds_read_b128 a[72:75], v242 offset:34816
MV 140,a,104,a,24
ds_read_b128 a[76:79], v242 offset:35840
MV 144,a,104,a,28
buffer_load_dwordx4 v238, s[48:51], s69 offen offset:3072 sc1 lds
MV 148,a,108,a,24
ds_read_b128 a[80:83], v243 offset:32768
MV 152,a,108,a,28
ds_read_b128 a[84:87], v243 offset:33792
MV 156,a,112,a,24
MV 160,a,112,a,28
ds_read_b128 a[88:91], v243 offset:34816
s_add_u32 s69, s69, 16384
MV 164,a,116,a,24
ds_read_b128 a[92:95], v243 offset:35840
MV 168,a,116,a,28
MV 172,a,120,a,24
MV 176,a,120,a,28
MV 180,a,124,a,24
buffer_load_dwordx4 a[24:27], v236, s[44:47], s68 offen offset:1024 sc1
MV 184,a,124,a,28
buffer_load_dwordx4 a[28:31], v237, s[44:47], s68 offen offset:1024 sc1
s_add_u32 s68, s68, 2048
s_waitcnt lgkmcnt(0)
MV 124,a,64,a,32
ds_read_b128 a[96:99], v242 offset:40960
MV 128,a,64,a,36
ds_read_b128 a[100:103], v242 offset:41984
s_add_u32 m0, s70, 82944
MV 132,a,68,a,32
MV 136,a,68,a,36
ds_read_b128 a[104:107], v242 offset:43008
MV 140,a,72,a,32
ds_read_b128 a[108:111], v242 offset:44032
MV 144,a,72,a,36
buffer_load_dwordx4 v238, s[48:51], s69 offen offset:0 sc1 lds
MV 148,a,76,a,32
ds_read_b128 a[112:115], v243 offset:40960
MV 152,a,76,a,36
ds_read_b128 a[116:119], v243 offset:41984
MV 156,a,80,a,32
MV 160,a,80,a,36
ds_read_b128 a[120:123], v243 offset:43008
buffer_load_dwordx4 v238, s[48:51], s69 offen offset:1024 sc1 lds
MV 164,a,84,a,32
ds_read_b128 a[124:127], v243 offset:44032
MV 168,a,84,a,36
MV 172,a,88,a,32
MV 176,a,88,a,36
MV 180,a,92,a,32
buffer_load_dwordx4 a[32:35], v236, s[44:47], s68 offen offset:0 sc1
MV 184,a,92,a,36
buffer_load_dwordx4 a[36:39], v237, s[44:47], s68 offen offset:0 sc1
s_waitcnt vmcnt(14) lgkmcnt(0)
s_barrier
MV 124,a,96,a,40
ds_read_b128 a[64:67], v242 offset:49152
MV 128,a,96,a,44
ds_read_b128 a[68:71], v242 offset:50176
buffer_load_dwordx4 v238, s[48:51], s69 offen offset:2048 sc1 lds
MV 132,a,100,a,40
MV 136,a,100,a,44
ds_read_b128 a[72:75], v242 offset:51200
MV 140,a,104,a,40
ds_read_b128 a[76:79], v242 offset:52224
MV 144,a,104,a,44
buffer_load_dwordx4 v238, s[48:51], s69 offen offset:3072 sc1 lds
MV 148,a,108,a,40
ds_read_b128 a[80:83], v243 offset:49152
MV 152,a,108,a,44
ds_read_b128 a[84:87], v243 offset:50176
MV 156,a,112,a,40
MV 160,a,112,a,44
ds_read_b128 a[88:91], v243 offset:51200
s_add_u32 s69, s69, 16384
MV 164,a,116,a,40
ds_read_b128 a[92:95], v243 offset:52224
MV 168,a,116,a,44
MV 172,a,120,a,40
MV 176,a,120,a,44
MV 180,a,124,a,40
buffer_load_dwordx4 a[40:43], v236, s[44:47], s68 offen offset:1024 sc1
MV 184,a,124,a,44
buffer_load_dwordx4 a[44:47], v237, s[44:47], s68 offen offset:1024 sc1
s_add_u32 s68, s68, 2048
s_waitcnt lgkmcnt(0)
MV 124,a,64,a,48
ds_read_b128 a[96:99], v242 offset:57344
MV 128,a,64,a,52
ds_read_b128 a[100:103], v242 offset:58368
s_add_u32 m0, s70, 99328
MV 132,a,68,a,48
v_cmp_gt_u32 vcc, 1, v253
s_nop 4
s_cbranch_vccnz L_spin_f3
L_spin_f3_ret:
MV 136,a,68,a,52
ds_read_b128 a[104:107], v242 offset:59392
MV 140,a,72,a,48
ds_read_b128 a[108:111], v242 offset:60416
MV 144,a,72,a,52
buffer_load_dwordx4 v238, s[48:51], s69 offen offset:0 sc1 lds
MV 148,a,76,a,48
ds_read_b128 a[112:115], v243 offset:57344
MV 152,a,76,a,52
ds_read_b128 a[116:119], v243 offset:58368
MV 156,a,80,a,48
MV 160,a,80,a,52
ds_read_b128 a[120:123], v243 offset:59392
buffer_load_dwordx4 v238, s[48:51], s69 offen offset:1024 sc1 lds
MV 164,a,84,a,48
ds_read_b128 a[124:127], v243 offset:60416
MV 168,a,84,a,52
MV 172,a,88,a,48
s_add_u32 s72, s79, 0
MV 176,a,88,a,52
MV 180,a,92,a,48
buffer_load_dwordx4 a[48:51], v236, s[44:47], s68 offen offset:0 sc1
buffer_load_dwordx2 v[208:209], v251, s[56:59], s72 offen offset:0 sc1
MV 184,a,92,a,52
buffer_load_dwordx4 a[52:55], v237, s[44:47], s68 offen offset:0 sc1
s_waitcnt vmcnt(15) lgkmcnt(0)
s_barrier
MV 124,a,96,a,56
ds_read_b128 a[64:67], v242 offset:0
s_add_u32 s72, s79, 16384
MV 128,a,96,a,60
ds_read_b128 a[68:71], v242 offset:1024
buffer_load_dwordx4 v238, s[48:51], s69 offen offset:2048 sc1 lds
MV 132,a,100,a,56
MV 136,a,100,a,60
ds_read_b128 a[72:75], v242 offset:2048
MV 140,a,104,a,56
ds_read_b128 a[76:79], v242 offset:3072
MV 144,a,104,a,60
buffer_load_dwordx4 v238, s[48:51], s69 offen offset:3072 sc1 lds
MV 148,a,108,a,56
ds_read_b128 a[80:83], v243 offset:0
MV 152,a,108,a,60
ds_read_b128 a[84:87], v243 offset:1024
MV 156,a,112,a,56
buffer_load_dwordx2 v[210:211], v251, s[56:59], s72 offen offset:0 sc1
MV 160,a,112,a,60
ds_read_b128 a[88:91], v243 offset:2048
s_add_u32 s69, s69, 16384
MV 164,a,116,a,56
ds_read_b128 a[92:95], v243 offset:3072
MV 168,a,116,a,60
MV 172,a,120,a,56
MV 176,a,120,a,60
MV 180,a,124,a,56
buffer_load_dwordx4 a[56:59], v236, s[44:47], s68 offen offset:1024 sc1
MV 184,a,124,a,60
buffer_load_dwordx4 a[60:63], v237, s[44:47], s68 offen offset:1024 sc1
s_add_u32 s68, s68, 2048
s_waitcnt lgkmcnt(0)
MV 124,a,64,a,0
ds_read_b128 a[96:99], v242 offset:8192
s_add_u32 s72, s79, 131072
MV 128,a,64,a,4
ds_read_b128 a[100:103], v242 offset:9216
s_add_u32 m0, s70, 115712
MV 132,a,68,a,0
MV 136,a,68,a,4
ds_read_b128 a[104:107], v242 offset:10240
MV 140,a,72,a,0
ds_read_b128 a[108:111], v242 offset:11264
MV 144,a,72,a,4
buffer_load_dwordx4 v238, s[48:51], s69 offen offset:0 sc1 lds
MV 148,a,76,a,0
ds_read_b128 a[112:115], v243 offset:8192
MV 152,a,76,a,4
ds_read_b128 a[116:119], v243 offset:9216
MV 156,a,80,a,0
buffer_load_dwordx2 v[212:213], v251, s[56:59], s72 offen offset:0 sc1
MV 160,a,80,a,4
ds_read_b128 a[120:123], v243 offset:10240
buffer_load_dwordx4 v238, s[48:51], s69 offen offset:1024 sc1 lds
MV 164,a,84,a,0
ds_read_b128 a[124:127], v243 offset:11264
MV 168,a,84,a,4
MV 172,a,88,a,0
MV 176,a,88,a,4
MV 180,a,92,a,0
buffer_load_dwordx4 a[0:3], v236, s[44:47], s68 offen offset:0 sc1
MV 184,a,92,a,4
buffer_load_dwordx4 a[4:7], v237, s[44:47], s68 offen offset:0 sc1
s_waitcnt vmcnt(17) lgkmcnt(0)
s_barrier
MV 124,a,96,a,8
ds_read_b128 a[64:67], v242 offset:16384
s_add_u32 s72, s79, 147456
MV 128,a,96,a,12
ds_read_b128 a[68:71], v242 offset:17408
buffer_load_dwordx4 v238, s[48:51], s69 offen offset:2048 sc1 lds
MV 132,a,100,a,8
MV 136,a,100,a,12
ds_read_b128 a[72:75], v242 offset:18432
MV 140,a,104,a,8
ds_read_b128 a[76:79], v242 offset:19456
MV 144,a,104,a,12
buffer_load_dwordx4 v238, s[48:51], s69 offen offset:3072 sc1 lds
MV 148,a,108,a,8
ds_read_b128 a[80:83], v243 offset:16384
MV 152,a,108,a,12
ds_read_b128 a[84:87], v243 offset:17408
MV 156,a,112,a,8
buffer_load_dwordx2 v[214:215], v251, s[56:59], s72 offen offset:0 sc1
MV 160,a,112,a,12
ds_read_b128 a[88:91], v243 offset:18432
s_add_u32 s69, s69, 16384
MV 164,a,116,a,8
ds_read_b128 a[92:95], v243 offset:19456
MV 168,a,116,a,12
MV 172,a,120,a,8
MV 176,a,120,a,12
MV 180,a,124,a,8
buffer_load_dwordx4 a[8:11], v236, s[44:47], s68 offen offset:1024 sc1
MV 184,a,124,a,12
buffer_load_dwordx4 a[12:15], v237, s[44:47], s68 offen offset:1024 sc1
s_add_u32 s68, s68, 2048
s_waitcnt lgkmcnt(0)
MV 124,a,64,a,16
ds_read_b128 a[96:99], v242 offset:24576
s_add_u32 s72, s79, 0
MV 128,a,64,a,20
ds_read_b128 a[100:103], v242 offset:25600
s_add_u32 m0, s70, 66560
MV 132,a,68,a,16
MV 136,a,68,a,20
ds_read_b128 a[104:107], v242 offset:26624
MV 140,a,72,a,16
ds_read_b128 a[108:111], v242 offset:27648
MV 144,a,72,a,20
buffer_load_dwordx4 v238, s[48:51], s69 offen offset:0 sc1 lds
MV 148,a,76,a,16
ds_read_b128 a[112:115], v243 offset:24576
MV 152,a,76,a,20
ds_read_b128 a[116:119], v243 offset:25600
MV 156,a,80,a,16
buffer_load_dwordx2 v[216:217], v251, s[56:59], s72 offen offset:128 sc1
MV 160,a,80,a,20
ds_read_b128 a[120:123], v243 offset:26624
buffer_load_dwordx4 v238, s[48:51], s69 offen offset:1024 sc1 lds
MV 164,a,84,a,16
ds_read_b128 a[124:127], v243 offset:27648
MV 168,a,84,a,20
MV 172,a,88,a,16
MV 176,a,88,a,20
MV 180,a,92,a,16
buffer_load_dwordx4 a[16:19], v236, s[44:47], s68 offen offset:0 sc1
MV 184,a,92,a,20
buffer_load_dwordx4 a[20:23], v237, s[44:47], s68 offen offset:0 sc1
s_waitcnt vmcnt(18) lgkmcnt(0)
s_barrier
MV 124,a,96,a,24
ds_read_b128 a[64:67], v242 offset:32768
s_add_u32 s72, s79, 16384
MV 128,a,96,a,28
ds_read_b128 a[68:71], v242 offset:33792
buffer_load_dwordx4 v238, s[48:51], s69 offen offset:2048 sc1 lds
MV 132,a,100,a,24
MV 136,a,100,a,28
ds_read_b128 a[72:75], v242 offset:34816
MV 140,a,104,a,24
ds_read_b128 a[76:79], v242 offset:35840
MV 144,a,104,a,28
buffer_load_dwordx4 v238, s[48:51], s69 offen offset:3072 sc1 lds
MV 148,a,108,a,24
ds_read_b128 a[80:83], v243 offset:32768
MV 152,a,108,a,28
ds_read_b128 a[84:87], v243 offset:33792
MV 156,a,112,a,24
buffer_load_dwordx2 v[218:219], v251, s[56:59], s72 offen offset:128 sc1
MV 160,a,112,a,28
ds_read_b128 a[88:91], v243 offset:34816
s_add_u32 s69, s69, 16384
MV 164,a,116,a,24
ds_read_b128 a[92:95], v243 offset:35840
MV 168,a,116,a,28
MV 172,a,120,a,24
MV 176,a,120,a,28
MV 180,a,124,a,24
buffer_load_dwordx4 a[24:27], v236, s[44:47], s68 offen offset:1024 sc1
MV 184,a,124,a,28
buffer_load_dwordx4 a[28:31], v237, s[44:47], s68 offen offset:1024 sc1
s_add_u32 s68, s68, 2048
s_waitcnt lgkmcnt(0)
MV 124,a,64,a,32
ds_read_b128 a[96:99], v242 offset:40960
s_add_u32 s72, s79, 131072
MV 128,a,64,a,36
ds_read_b128 a[100:103], v242 offset:41984
s_add_u32 m0, s70, 82944
MV 132,a,68,a,32
MV 136,a,68,a,36
ds_read_b128 a[104:107], v242 offset:43008
MV 140,a,72,a,32
ds_read_b128 a[108:111], v242 offset:44032
MV 144,a,72,a,36
buffer_load_dwordx4 v238, s[48:51], s69 offen offset:0 sc1 lds
MV 148,a,76,a,32
ds_read_b128 a[112:115], v243 offset:40960
MV 152,a,76,a,36
ds_read_b128 a[116:119], v243 offset:41984
MV 156,a,80,a,32
buffer_load_dwordx2 v[220:221], v251, s[56:59], s72 offen offset:128 sc1
MV 160,a,80,a,36
ds_read_b128 a[120:123], v243 offset:43008
buffer_load_dwordx4 v238, s[48:51], s69 offen offset:1024 sc1 lds
MV 164,a,84,a,32
ds_read_b128 a[124:127], v243 offset:44032
MV 168,a,84,a,36
MV 172,a,88,a,32
MV 176,a,88,a,36
MV 180,a,92,a,32
buffer_load_dwordx4 a[32:35], v236, s[44:47], s68 offen offset:0 sc1
MV 184,a,92,a,36
buffer_load_dwordx4 a[36:39], v237, s[44:47], s68 offen offset:0 sc1
s_waitcnt vmcnt(18) lgkmcnt(0)
s_barrier
MV 124,a,96,a,40
ds_read_b128 a[64:67], v242 offset:49152
s_add_u32 s72, s79, 147456
MV 128,a,96,a,44
ds_read_b128 a[68:71], v242 offset:50176
buffer_load_dwordx4 v238, s[48:51], s69 offen offset:2048 sc1 lds
MV 132,a,100,a,40
MV 136,a,100,a,44
ds_read_b128 a[72:75], v242 offset:51200
MV 140,a,104,a,40
ds_read_b128 a[76:79], v242 offset:52224
MV 144,a,104,a,44
buffer_load_dwordx4 v238, s[48:51], s69 offen offset:3072 sc1 lds
MV 148,a,108,a,40
ds_read_b128 a[80:83], v243 offset:49152
MV 152,a,108,a,44
ds_read_b128 a[84:87], v243 offset:50176
MV 156,a,112,a,40
buffer_load_dwordx2 v[222:223], v251, s[56:59], s72 offen offset:128 sc1
MV 160,a,112,a,44
ds_read_b128 a[88:91], v243 offset:51200
s_add_u32 s69, s69, 16384
MV 164,a,116,a,40
ds_read_b128 a[92:95], v243 offset:52224
MV 168,a,116,a,44
MV 172,a,120,a,40
MV 176,a,120,a,44
MV 180,a,124,a,40
buffer_load_dwordx4 a[40:43], v236, s[44:47], s68 offen offset:1024 sc1
MV 184,a,124,a,44
buffer_load_dwordx4 a[44:47], v237, s[44:47], s68 offen offset:1024 sc1
s_add_u32 s68, s68, 2048
s_waitcnt lgkmcnt(0)
MV 124,a,64,a,48
ds_read_b128 a[96:99], v242 offset:57344
MV 128,a,64,a,52
ds_read_b128 a[100:103], v242 offset:58368
s_add_u32 m0, s70, 99328
MV 132,a,68,a,48
MV 136,a,68,a,52
ds_read_b128 a[104:107], v242 offset:59392
MV 140,a,72,a,48
ds_read_b128 a[108:111], v242 offset:60416
MV 144,a,72,a,52
buffer_load_dwordx4 v238, s[48:51], s69 offen offset:0 sc1 lds
MV 148,a,76,a,48
ds_read_b128 a[112:115], v243 offset:57344
MV 152,a,76,a,52
ds_read_b128 a[116:119], v243 offset:58368
MV 156,a,80,a,48
MV 160,a,80,a,52
ds_read_b128 a[120:123], v243 offset:59392
buffer_load_dwordx4 v238, s[48:51], s69 offen offset:1024 sc1 lds
MV 164,a,84,a,48
ds_read_b128 a[124:127], v243 offset:60416
MV 168,a,84,a,52
MV 172,a,88,a,48
MV 176,a,88,a,52
MV 180,a,92,a,48
buffer_load_dwordx4 a[48:51], v236, s[44:47], s68 offen offset:0 sc1
MV 184,a,92,a,52
buffer_load_dwordx4 a[52:55], v237, s[44:47], s68 offen offset:0 sc1
s_waitcnt vmcnt(17) lgkmcnt(0)
s_barrier
MV 124,a,96,a,56
ds_read_b128 a[64:67], v242 offset:0
MV 128,a,96,a,60
ds_read_b128 a[68:71], v242 offset:1024
buffer_load_dwordx4 v238, s[48:51], s69 offen offset:2048 sc1 lds
MV 132,a,100,a,56
MV 136,a,100,a,60
ds_read_b128 a[72:75], v242 offset:2048
MV 140,a,104,a,56
ds_read_b128 a[76:79], v242 offset:3072
MV 144,a,104,a,60
buffer_load_dwordx4 v238, s[48:51], s69 offen offset:3072 sc1 lds
MV 148,a,108,a,56
ds_read_b128 a[80:83], v243 offset:0
MV 152,a,108,a,60
ds_read_b128 a[84:87], v243 offset:1024
MV 156,a,112,a,56
MV 160,a,112,a,60
ds_read_b128 a[88:91], v243 offset:2048
s_add_u32 s69, s69, 16384
MV 164,a,116,a,56
ds_read_b128 a[92:95], v243 offset:3072
MV 168,a,116,a,60
MV 172,a,120,a,56
MV 176,a,120,a,60
MV 180,a,124,a,56
buffer_load_dwordx4 a[56:59], v236, s[44:47], s68 offen offset:1024 sc1
MV 184,a,124,a,60
buffer_load_dwordx4 a[60:63], v237, s[44:47], s68 offen offset:1024 sc1
s_add_u32 s68, s68, 2048
s_waitcnt lgkmcnt(0)
MV 124,a,64,a,0
ds_read_b128 a[96:99], v242 offset:8192
MV 128,a,64,a,4
ds_read_b128 a[100:103], v242 offset:9216
s_add_u32 m0, s70, 115712
MV 132,a,68,a,0
MV 136,a,68,a,4
ds_read_b128 a[104:107], v242 offset:10240
MV 140,a,72,a,0
ds_read_b128 a[108:111], v242 offset:11264
MV 144,a,72,a,4
buffer_load_dwordx4 v238, s[48:51], s69 offen offset:0 sc1 lds
MV 148,a,76,a,0
ds_read_b128 a[112:115], v243 offset:8192
MV 152,a,76,a,4
ds_read_b128 a[116:119], v243 offset:9216
MV 156,a,80,a,0
MV 160,a,80,a,4
ds_read_b128 a[120:123], v243 offset:10240
buffer_load_dwordx4 v238, s[48:51], s69 offen offset:1024 sc1 lds
MV 164,a,84,a,0
ds_read_b128 a[124:127], v243 offset:11264
MV 168,a,84,a,4
MV 172,a,88,a,0
MV 176,a,88,a,4
MV 180,a,92,a,0
buffer_load_dwordx4 a[0:3], v236, s[44:47], s68 offen offset:0 sc1
MV 184,a,92,a,4
buffer_load_dwordx4 a[4:7], v237, s[44:47], s68 offen offset:0 sc1
s_waitcnt vmcnt(15) lgkmcnt(0)
s_barrier
MV 124,a,96,a,8
ds_read_b128 a[64:67], v242 offset:16384
MV 128,a,96,a,12
ds_read_b128 a[68:71], v242 offset:17408
buffer_load_dwordx4 v238, s[48:51], s69 offen offset:2048 sc1 lds
MV 132,a,100,a,8
MV 136,a,100,a,12
ds_read_b128 a[72:75], v242 offset:18432
MV 140,a,104,a,8
ds_read_b128 a[76:79], v242 offset:19456
MV 144,a,104,a,12
buffer_load_dwordx4 v238, s[48:51], s69 offen offset:3072 sc1 lds
MV 148,a,108,a,8
ds_read_b128 a[80:83], v243 offset:16384
MV 152,a,108,a,12
ds_read_b128 a[84:87], v243 offset:17408
MV 156,a,112,a,8
MV 160,a,112,a,12
ds_read_b128 a[88:91], v243 offset:18432
s_add_u32 s69, s69, 16384
MV 164,a,116,a,8
ds_read_b128 a[92:95], v243 offset:19456
MV 168,a,116,a,12
MV 172,a,120,a,8
MV 176,a,120,a,12
MV 180,a,124,a,8
buffer_load_dwordx4 a[8:11], v236, s[44:47], s68 offen offset:1024 sc1
MV 184,a,124,a,12
buffer_load_dwordx4 a[12:15], v237, s[44:47], s68 offen offset:1024 sc1
s_add_u32 s68, s68, 2048
s_waitcnt lgkmcnt(0)
MV 124,a,64,a,16
ds_read_b128 a[96:99], v242 offset:24576
v_sub_f32 v8, 1.0, v6
MV 128,a,64,a,20
ds_read_b128 a[100:103], v242 offset:25600
s_add_u32 m0, s70, 66560
MV 132,a,68,a,16
v_lshlrev_b32 v36, 16, v192
v_lshlrev_b32 v228, 16, v208
MV 136,a,68,a,20
ds_read_b128 a[104:107], v242 offset:26624
v_and_b32 v37, 0xffff0000, v192
MV 140,a,72,a,16
ds_read_b128 a[108:111], v242 offset:27648
v_and_b32 v229, 0xffff0000, v208
MV 144,a,72,a,20
buffer_load_dwordx4 v238, s[48:51], s69 offen offset:0 sc1 lds
v_mul_f32 v36, v36, v228
MV 148,a,76,a,16
ds_read_b128 a[112:115], v243 offset:24576
v_mul_f32 v37, v37, v229
MV 152,a,76,a,20
ds_read_b128 a[116:119], v243 offset:25600
v_mul_f32 v36, v36, v6
MV 156,a,80,a,16
v_mul_f32 v37, v37, v6
MV 160,a,80,a,20
ds_read_b128 a[120:123], v243 offset:26624
buffer_load_dwordx4 v238, s[48:51], s69 offen offset:1024 sc1 lds
MV 164,a,84,a,16
ds_read_b128 a[124:127], v243 offset:27648
v_lshlrev_b32 v38, 16, v193
MV 168,a,84,a,20
v_lshlrev_b32 v228, 16, v209
v_and_b32 v39, 0xffff0000, v193
MV 172,a,88,a,16
v_and_b32 v229, 0xffff0000, v209
MV 176,a,88,a,20
v_mul_f32 v38, v38, v228
MV 180,a,92,a,16
buffer_load_dwordx4 a[16:19], v236, s[44:47], s68 offen offset:0 sc1
v_mul_f32 v39, v39, v229
MV 184,a,92,a,20
buffer_load_dwordx4 a[20:23], v237, s[44:47], s68 offen offset:0 sc1
v_mul_f32 v38, v38, v6
s_waitcnt vmcnt(14) lgkmcnt(0)
s_barrier
MV 124,a,96,a,24
ds_read_b128 a[64:67], v242 offset:32768
v_mul_f32 v39, v39, v6
MV 128,a,96,a,28
ds_read_b128 a[68:71], v242 offset:33792
buffer_load_dwordx4 v238, s[48:51], s69 offen offset:2048 sc1 lds
MV 132,a,100,a,24
v_lshlrev_b32 v40, 16, v194
v_lshlrev_b32 v228, 16, v210
MV 136,a,100,a,28
ds_read_b128 a[72:75], v242 offset:34816
v_and_b32 v41, 0xffff0000, v194
MV 140,a,104,a,24
ds_read_b128 a[76:79], v242 offset:35840
v_and_b32 v229, 0xffff0000, v210
MV 144,a,104,a,28
buffer_load_dwordx4 v238, s[48:51], s69 offen offset:3072 sc1 lds
v_mul_f32 v40, v40, v228
MV 148,a,108,a,24
ds_read_b128 a[80:83], v243 offset:32768
v_mul_f32 v41, v41, v229
MV 152,a,108,a,28
ds_read_b128 a[84:87], v243 offset:33792
v_mul_f32 v40, v40, v6
MV 156,a,112,a,24
v_mul_f32 v41, v41, v6
MV 160,a,112,a,28
ds_read_b128 a[88:91], v243 offset:34816
s_add_u32 s69, s69, 16384
MV 164,a,116,a,24
ds_read_b128 a[92:95], v243 offset:35840
v_lshlrev_b32 v42, 16, v195
MV 168,a,116,a,28
v_lshlrev_b32 v228, 16, v211
v_and_b32 v43, 0xffff0000, v195
MV 172,a,120,a,24
v_and_b32 v229, 0xffff0000, v211
MV 176,a,120,a,28
v_mul_f32 v42, v42, v228
MV 180,a,124,a,24
buffer_load_dwordx4 a[24:27], v236, s[44:47], s68 offen offset:1024 sc1
v_mul_f32 v43, v43, v229
MV 184,a,124,a,28
buffer_load_dwordx4 a[28:31], v237, s[44:47], s68 offen offset:1024 sc1
s_add_u32 s68, s68, 2048
v_mul_f32 v42, v42, v6
s_waitcnt lgkmcnt(0)
MV 124,a,64,a,32
ds_read_b128 a[96:99], v242 offset:40960
v_mul_f32 v43, v43, v6
MV 128,a,64,a,36
ds_read_b128 a[100:103], v242 offset:41984
s_add_u32 m0, s70, 82944
MV 132,a,68,a,32
v_lshlrev_b32 v44, 16, v196
v_lshlrev_b32 v228, 16, v212
MV 136,a,68,a,36
ds_read_b128 a[104:107], v242 offset:43008
v_and_b32 v45, 0xffff0000, v196
MV 140,a,72,a,32
ds_read_b128 a[108:111], v242 offset:44032
v_and_b32 v229, 0xffff0000, v212
MV 144,a,72,a,36
buffer_load_dwordx4 v238, s[48:51], s69 offen offset:0 sc1 lds
v_mul_f32 v44, v44, v228
MV 148,a,76,a,32
ds_read_b128 a[112:115], v243 offset:40960
v_mul_f32 v45, v45, v229
MV 152,a,76,a,36
ds_read_b128 a[116:119], v243 offset:41984
v_mul_f32 v44, v44, v6
MV 156,a,80,a,32
v_mul_f32 v45, v45, v6
MV 160,a,80,a,36
ds_read_b128 a[120:123], v243 offset:43008
buffer_load_dwordx4 v238, s[48:51], s69 offen offset:1024 sc1 lds
MV 164,a,84,a,32
ds_read_b128 a[124:127], v243 offset:44032
v_lshlrev_b32 v46, 16, v197
MV 168,a,84,a,36
v_lshlrev_b32 v228, 16, v213
v_and_b32 v47, 0xffff0000, v197
MV 172,a,88,a,32
v_and_b32 v229, 0xffff0000, v213
MV 176,a,88,a,36
v_mul_f32 v46, v46, v228
MV 180,a,92,a,32
buffer_load_dwordx4 a[32:35], v236, s[44:47], s68 offen offset:0 sc1
v_mul_f32 v47, v47, v229
MV 184,a,92,a,36
buffer_load_dwordx4 a[36:39], v237, s[44:47], s68 offen offset:0 sc1
v_mul_f32 v46, v46, v6
s_waitcnt vmcnt(14) lgkmcnt(0)
s_barrier
MV 124,a,96,a,40
ds_read_b128 a[64:67], v242 offset:49152
v_mul_f32 v47, v47, v6
MV 128,a,96,a,44
ds_read_b128 a[68:71], v242 offset:50176
buffer_load_dwordx4 v238, s[48:51], s69 offen offset:2048 sc1 lds
MV 132,a,100,a,40
v_lshlrev_b32 v48, 16, v198
v_lshlrev_b32 v228, 16, v214
MV 136,a,100,a,44
ds_read_b128 a[72:75], v242 offset:51200
v_and_b32 v49, 0xffff0000, v198
MV 140,a,104,a,40
ds_read_b128 a[76:79], v242 offset:52224
v_and_b32 v229, 0xffff0000, v214
MV 144,a,104,a,44
buffer_load_dwordx4 v238, s[48:51], s69 offen offset:3072 sc1 lds
v_mul_f32 v48, v48, v228
MV 148,a,108,a,40
ds_read_b128 a[80:83], v243 offset:49152
v_mul_f32 v49, v49, v229
MV 152,a,108,a,44
ds_read_b128 a[84:87], v243 offset:50176
v_mul_f32 v48, v48, v6
MV 156,a,112,a,40
v_mul_f32 v49, v49, v6
v_lshlrev_b32 v50, 16, v199
MV 160,a,112,a,44
ds_read_b128 a[88:91], v243 offset:51200
s_add_u32 s69, s69, 16384
MV 164,a,116,a,40
ds_read_b128 a[92:95], v243 offset:52224
v_lshlrev_b32 v228, 16, v215
MV 168,a,116,a,44
v_and_b32 v51, 0xffff0000, v199
v_and_b32 v229, 0xffff0000, v215
MV 172,a,120,a,40
v_mul_f32 v50, v50, v228
MV 176,a,120,a,44
v_mul_f32 v51, v51, v229
MV 180,a,124,a,40
buffer_load_dwordx4 a[40:43], v236, s[44:47], s68 offen offset:1024 sc1
v_mul_f32 v50, v50, v6
MV 184,a,124,a,44
buffer_load_dwordx4 a[44:47], v237, s[44:47], s68 offen offset:1024 sc1
s_add_u32 s68, s68, 2048
v_mul_f32 v51, v51, v6
s_waitcnt lgkmcnt(0)
MV 124,a,64,a,48
ds_read_b128 a[96:99], v242 offset:57344
v_sub_f32 v9, 1.0, v7
MV 128,a,64,a,52
ds_read_b128 a[100:103], v242 offset:58368
s_add_u32 m0, s70, 99328
MV 132,a,68,a,48
v_lshlrev_b32 v52, 16, v200
v_lshlrev_b32 v228, 16, v216
MV 136,a,68,a,52
ds_read_b128 a[104:107], v242 offset:59392
v_and_b32 v53, 0xffff0000, v200
MV 140,a,72,a,48
ds_read_b128 a[108:111], v242 offset:60416
v_and_b32 v229, 0xffff0000, v216
MV 144,a,72,a,52
buffer_load_dwordx4 v238, s[48:51], s69 offen offset:0 sc1 lds
v_mul_f32 v52, v52, v228
MV 148,a,76,a,48
ds_read_b128 a[112:115], v243 offset:57344
v_mul_f32 v53, v53, v229
MV 152,a,76,a,52
ds_read_b128 a[116:119], v243 offset:58368
v_mul_f32 v52, v52, v7
MV 156,a,80,a,48
v_mul_f32 v53, v53, v7
MV 160,a,80,a,52
ds_read_b128 a[120:123], v243 offset:59392
buffer_load_dwordx4 v238, s[48:51], s69 offen offset:1024 sc1 lds
MV 164,a,84,a,48
ds_read_b128 a[124:127], v243 offset:60416
v_lshlrev_b32 v54, 16, v201
MV 168,a,84,a,52
v_lshlrev_b32 v228, 16, v217
v_and_b32 v55, 0xffff0000, v201
MV 172,a,88,a,48
v_and_b32 v229, 0xffff0000, v217
MV 176,a,88,a,52
v_mul_f32 v54, v54, v228
MV 180,a,92,a,48
buffer_load_dwordx4 a[48:51], v236, s[44:47], s68 offen offset:0 sc1
v_mul_f32 v55, v55, v229
MV 184,a,92,a,52
buffer_load_dwordx4 a[52:55], v237, s[44:47], s68 offen offset:0 sc1
v_mul_f32 v54, v54, v7
s_waitcnt vmcnt(14) lgkmcnt(0)
s_barrier
MV 124,a,96,a,56
ds_read_b128 a[64:67], v242 offset:0
v_mul_f32 v55, v55, v7
MV 128,a,96,a,60
ds_read_b128 a[68:71], v242 offset:1024
buffer_load_dwordx4 v238, s[48:51], s69 offen offset:2048 sc1 lds
MV 132,a,100,a,56
v_lshlrev_b32 v56, 16, v202
v_lshlrev_b32 v228, 16, v218
MV 136,a,100,a,60
ds_read_b128 a[72:75], v242 offset:2048
v_and_b32 v57, 0xffff0000, v202
MV 140,a,104,a,56
ds_read_b128 a[76:79], v242 offset:3072
v_and_b32 v229, 0xffff0000, v218
MV 144,a,104,a,60
buffer_load_dwordx4 v238, s[48:51], s69 offen offset:3072 sc1 lds
v_mul_f32 v56, v56, v228
MV 148,a,108,a,56
ds_read_b128 a[80:83], v243 offset:0
v_mul_f32 v57, v57, v229
MV 152,a,108,a,60
ds_read_b128 a[84:87], v243 offset:1024
v_mul_f32 v56, v56, v7
MV 156,a,112,a,56
v_mul_f32 v57, v57, v7
MV 160,a,112,a,60
ds_read_b128 a[88:91], v243 offset:2048
s_add_u32 s69, s69, 16384
MV 164,a,116,a,56
ds_read_b128 a[92:95], v243 offset:3072
v_lshlrev_b32 v58, 16, v203
MV 168,a,116,a,60
v_lshlrev_b32 v228, 16, v219
v_and_b32 v59, 0xffff0000, v203
MV 172,a,120,a,56
v_and_b32 v229, 0xffff0000, v219
MV 176,a,120,a,60
v_mul_f32 v58, v58, v228
MV 180,a,124,a,56
buffer_load_dwordx4 a[56:59], v236, s[44:47], s68 offen offset:1024 sc1
v_mul_f32 v59, v59, v229
MV 184,a,124,a,60
buffer_load_dwordx4 a[60:63], v237, s[44:47], s68 offen offset:1024 sc1
s_add_u32 s68, s68, 2048
v_mul_f32 v58, v58, v7
s_waitcnt lgkmcnt(0)
MV 124,a,64,a,0
ds_read_b128 a[96:99], v242 offset:8192
v_mul_f32 v59, v59, v7
MV 128,a,64,a,4
ds_read_b128 a[100:103], v242 offset:9216
s_add_u32 m0, s70, 115712
MV 132,a,68,a,0
v_lshlrev_b32 v60, 16, v204
v_lshlrev_b32 v228, 16, v220
MV 136,a,68,a,4
ds_read_b128 a[104:107], v242 offset:10240
v_and_b32 v61, 0xffff0000, v204
MV 140,a,72,a,0
ds_read_b128 a[108:111], v242 offset:11264
v_and_b32 v229, 0xffff0000, v220
MV 144,a,72,a,4
buffer_load_dwordx4 v238, s[48:51], s69 offen offset:0 sc1 lds
v_mul_f32 v60, v60, v228
MV 148,a,76,a,0
ds_read_b128 a[112:115], v243 offset:8192
v_mul_f32 v61, v61, v229
MV 152,a,76,a,4
ds_read_b128 a[116:119], v243 offset:9216
v_mul_f32 v60, v60, v7
MV 156,a,80,a,0
v_mul_f32 v61, v61, v7
MV 160,a,80,a,4
ds_read_b128 a[120:123], v243 offset:10240
buffer_load_dwordx4 v238, s[48:51], s69 offen offset:1024 sc1 lds
MV 164,a,84,a,0
ds_read_b128 a[124:127], v243 offset:11264
v_lshlrev_b32 v62, 16, v205
MV 168,a,84,a,4
v_lshlrev_b32 v228, 16, v221
v_and_b32 v63, 0xffff0000, v205
MV 172,a,88,a,0
v_and_b32 v229, 0xffff0000, v221
MV 176,a,88,a,4
v_mul_f32 v62, v62, v228
MV 180,a,92,a,0
v_mul_f32 v63, v63, v229
MV 184,a,92,a,4
v_mul_f32 v62, v62, v7
s_waitcnt vmcnt(12) lgkmcnt(0)
s_barrier
MV 124,a,96,a,8
ds_read_b128 a[80:83], v243 offset:16384
v_mul_f32 v63, v63, v7
MV 128,a,96,a,12
buffer_load_dwordx4 v238, s[48:51], s69 offen offset:2048 sc1 lds
v_lshlrev_b32 v64, 16, v206
MV 132,a,100,a,8
v_lshlrev_b32 v228, 16, v222
v_and_b32 v65, 0xffff0000, v206
MV 136,a,100,a,12
ds_read_b128 a[84:87], v243 offset:17408
v_and_b32 v229, 0xffff0000, v222
MV 140,a,104,a,8
v_mul_f32 v64, v64, v228
MV 144,a,104,a,12
buffer_load_dwordx4 v238, s[48:51], s69 offen offset:3072 sc1 lds
v_mul_f32 v65, v65, v229
MV 148,a,108,a,8
ds_read_b128 a[88:91], v243 offset:18432
v_mul_f32 v64, v64, v7
MV 152,a,108,a,12
v_mul_f32 v65, v65, v7
MV 156,a,112,a,8
v_lshlrev_b32 v66, 16, v207
MV 160,a,112,a,12
ds_read_b128 a[92:95], v243 offset:19456
s_add_u32 s69, s69, 16384
MV 164,a,116,a,8
v_lshlrev_b32 v228, 16, v223
v_and_b32 v67, 0xffff0000, v207
MV 168,a,116,a,12
v_and_b32 v229, 0xffff0000, v223
MV 172,a,120,a,8
v_mul_f32 v66, v66, v228
MV 176,a,120,a,12
v_mul_f32 v67, v67, v229
MV 180,a,124,a,8
v_mul_f32 v66, v66, v7
MV 184,a,124,a,12
v_mul_f32 v67, v67, v7
s_waitcnt lgkmcnt(0)
MV 156,a,80,a,16
ds_read_b128 a[112:115], v243 offset:24576
s_xor_b32 s72, s2, 4
MV 160,a,80,a,20
ds_read_b128 a[116:119], v243 offset:25600
s_lshl_b32 s72, s72, 14
MV 164,a,84,a,16
ds_read_b128 a[120:123], v243 offset:26624
MV 168,a,84,a,20
ds_read_b128 a[124:127], v243 offset:27648
MV 172,a,88,a,16
MV 176,a,88,a,20
MV 180,a,92,a,16
MV 184,a,92,a,20
s_waitcnt vmcnt(6)
s_barrier
s_waitcnt lgkmcnt(3)
MV 156,a,112,a,24
ds_read_b128 a[80:83], v243 offset:32768
MV 160,a,112,a,28
ds_read_b128 a[84:87], v243 offset:33792
s_waitcnt lgkmcnt(4)
MV 164,a,116,a,24
ds_read_b128 a[88:91], v243 offset:34816
MV 168,a,116,a,28
ds_read_b128 a[92:95], v243 offset:35840
s_waitcnt lgkmcnt(5)
MV 172,a,120,a,24
MV 176,a,120,a,28
s_waitcnt lgkmcnt(4)
MV 180,a,124,a,24
MV 184,a,124,a,28
s_waitcnt lgkmcnt(3)
MV 156,a,80,a,32
ds_read_b128 a[112:115], v243 offset:40960
MV 160,a,80,a,36
ds_read_b128 a[116:119], v243 offset:41984
s_waitcnt lgkmcnt(4)
MV 164,a,84,a,32
ds_read_b128 a[120:123], v243 offset:43008
MV 168,a,84,a,36
ds_read_b128 a[124:127], v243 offset:44032
s_waitcnt lgkmcnt(5)
MV 172,a,88,a,32
MV 176,a,88,a,36
s_waitcnt lgkmcnt(4)
MV 180,a,92,a,32
MV 184,a,92,a,36
s_waitcnt vmcnt(0)
s_barrier
s_waitcnt lgkmcnt(3)
MV 156,a,112,a,40
ds_read_b128 a[80:83], v243 offset:49152
MV 160,a,112,a,44
ds_read_b128 a[84:87], v243 offset:50176
s_waitcnt lgkmcnt(4)
MV 164,a,116,a,40
ds_read_b128 a[88:91], v243 offset:51200
MV 168,a,116,a,44
ds_read_b128 a[92:95], v243 offset:52224
s_waitcnt lgkmcnt(5)
MV 172,a,120,a,40
MV 176,a,120,a,44
s_waitcnt lgkmcnt(4)
MV 180,a,124,a,40
MV 184,a,124,a,44
s_waitcnt lgkmcnt(3)
MV 156,a,80,a,48
ds_read_b128 a[112:115], v243 offset:57344
MV 160,a,80,a,52
ds_read_b128 a[116:119], v243 offset:58368
s_waitcnt lgkmcnt(4)
MV 164,a,84,a,48
ds_read_b128 a[120:123], v243 offset:59392
MV 168,a,84,a,52
ds_read_b128 a[124:127], v243 offset:60416
s_waitcnt lgkmcnt(5)
MV 172,a,88,a,48
MV 176,a,88,a,52
s_waitcnt lgkmcnt(4)
MV 180,a,92,a,48
MV 184,a,92,a,52
s_waitcnt lgkmcnt(3)
MV 156,a,112,a,56
ds_read_b128 a[64:67], v242 offset:16384
MV 160,a,112,a,60
ds_read_b128 a[68:71], v242 offset:17408
s_waitcnt lgkmcnt(4)
MV 164,a,116,a,56
ds_read_b128 a[72:75], v242 offset:18432
MV 168,a,116,a,60
ds_read_b128 a[76:79], v242 offset:19456
s_waitcnt lgkmcnt(5)
MV 172,a,120,a,56
MV 176,a,120,a,60
s_waitcnt lgkmcnt(4)
MV 180,a,124,a,56
MV 184,a,124,a,60
s_waitcnt lgkmcnt(3)
MV 124,a,64,a,16
ds_read_b128 a[96:99], v242 offset:24576
MV 128,a,64,a,20
ds_read_b128 a[100:103], v242 offset:25600
s_waitcnt lgkmcnt(4)
MV 132,a,68,a,16
ds_read_b128 a[104:107], v242 offset:26624
v_permlane16_swap_b32 v156, v164
MV 136,a,68,a,20
ds_read_b128 a[108:111], v242 offset:27648
v_permlane16_swap_b32 v157, v165
s_waitcnt lgkmcnt(5)
MV 140,a,72,a,16
v_permlane16_swap_b32 v158, v166
v_permlane16_swap_b32 v159, v167
MV 144,a,72,a,20
v_cvt_pk_bf16_f32 v156, v156, v157
v_cvt_pk_bf16_f32 v157, v158, v159
s_waitcnt lgkmcnt(4)
MV 148,a,76,a,16
v_cvt_pk_bf16_f32 v158, v164, v165
v_cvt_pk_bf16_f32 v159, v166, v167
MV 152,a,76,a,20
buffer_store_dwordx4 v[156:159], v238, s[52:55], s72 offen offset:0 sc1
v_permlane16_swap_b32 v172, v180
s_waitcnt lgkmcnt(3)
MV 124,a,96,a,24
ds_read_b128 a[64:67], v242 offset:32768
v_permlane16_swap_b32 v173, v181
MV 128,a,96,a,28
ds_read_b128 a[68:71], v242 offset:33792
v_permlane16_swap_b32 v174, v182
s_waitcnt lgkmcnt(4)
MV 132,a,100,a,24
ds_read_b128 a[72:75], v242 offset:34816
v_permlane16_swap_b32 v175, v183
MV 136,a,100,a,28
ds_read_b128 a[76:79], v242 offset:35840
v_cvt_pk_bf16_f32 v172, v172, v173
s_waitcnt lgkmcnt(5)
MV 140,a,104,a,24
v_cvt_pk_bf16_f32 v173, v174, v175
v_cvt_pk_bf16_f32 v174, v180, v181
MV 144,a,104,a,28
v_cvt_pk_bf16_f32 v175, v182, v183
buffer_store_dwordx4 v[172:175], v238, s[52:55], s72 offen offset:1024 sc1
s_waitcnt lgkmcnt(4)
MV 148,a,108,a,24
v_permlane16_swap_b32 v160, v168
v_permlane16_swap_b32 v161, v169
MV 152,a,108,a,28
v_permlane16_swap_b32 v162, v170
v_permlane16_swap_b32 v163, v171
s_waitcnt lgkmcnt(3)
MV 124,a,64,a,32
ds_read_b128 a[96:99], v242 offset:40960
v_cvt_pk_bf16_f32 v160, v160, v161
MV 128,a,64,a,36
ds_read_b128 a[100:103], v242 offset:41984
v_cvt_pk_bf16_f32 v161, v162, v163
s_waitcnt lgkmcnt(4)
MV 132,a,68,a,32
ds_read_b128 a[104:107], v242 offset:43008
v_cvt_pk_bf16_f32 v162, v168, v169
MV 136,a,68,a,36
ds_read_b128 a[108:111], v242 offset:44032
v_cvt_pk_bf16_f32 v163, v170, v171
s_waitcnt lgkmcnt(5)
MV 140,a,72,a,32
buffer_store_dwordx4 v[160:163], v238, s[52:55], s72 offen offset:2048 sc1
v_permlane16_swap_b32 v176, v184
MV 144,a,72,a,36
v_permlane16_swap_b32 v177, v185
v_permlane16_swap_b32 v178, v186
s_waitcnt lgkmcnt(4)
MV 148,a,76,a,32
v_permlane16_swap_b32 v179, v187
v_cvt_pk_bf16_f32 v176, v176, v177
MV 152,a,76,a,36
v_cvt_pk_bf16_f32 v177, v178, v179
v_cvt_pk_bf16_f32 v178, v184, v185
s_waitcnt lgkmcnt(3)
MV 124,a,96,a,40
ds_read_b128 a[64:67], v242 offset:49152
v_cvt_pk_bf16_f32 v179, v186, v187
MV 128,a,96,a,44
ds_read_b128 a[68:71], v242 offset:50176
buffer_store_dwordx4 v[176:179], v238, s[52:55], s72 offen offset:3072 sc1
s_waitcnt lgkmcnt(4)
MV 132,a,100,a,40
ds_read_b128 a[72:75], v242 offset:51200
MV 136,a,100,a,44
ds_read_b128 a[76:79], v242 offset:52224
s_waitcnt lgkmcnt(5)
MV 140,a,104,a,40
MV 144,a,104,a,44
s_waitcnt lgkmcnt(4)
MV 148,a,108,a,40
MV 152,a,108,a,44
s_waitcnt lgkmcnt(3)
MV 124,a,64,a,48
ds_read_b128 a[96:99], v242 offset:57344
MV 128,a,64,a,52
ds_read_b128 a[100:103], v242 offset:58368
s_waitcnt lgkmcnt(4)
MV 132,a,68,a,48
ds_read_b128 a[104:107], v242 offset:59392
MV 136,a,68,a,52
ds_read_b128 a[108:111], v242 offset:60416
s_waitcnt lgkmcnt(5)
MV 140,a,72,a,48
MV 144,a,72,a,52
s_waitcnt lgkmcnt(4)
MV 148,a,76,a,48
MV 152,a,76,a,52
s_waitcnt lgkmcnt(3)
MV 124,a,96,a,56
MV 128,a,96,a,60
s_waitcnt lgkmcnt(2)
MV 132,a,100,a,56
MV 136,a,100,a,60
s_waitcnt lgkmcnt(1)
MV 140,a,104,a,56
MV 144,a,104,a,60
s_waitcnt lgkmcnt(0)
MV 148,a,108,a,56
MV 152,a,108,a,60
s_nop 0
v_permlane16_swap_b32 v124, v132
v_permlane16_swap_b32 v125, v133
v_permlane16_swap_b32 v126, v134
v_permlane16_swap_b32 v127, v135
s_nop 1
v_permlane16_swap_b32 v140, v148
v_permlane16_swap_b32 v141, v149
v_permlane16_swap_b32 v142, v150
v_permlane16_swap_b32 v143, v151
v_permlane16_swap_b32 v128, v136
v_permlane16_swap_b32 v129, v137
v_permlane16_swap_b32 v130, v138
v_permlane16_swap_b32 v131, v139
v_permlane16_swap_b32 v144, v152
v_permlane16_swap_b32 v145, v153
v_permlane16_swap_b32 v146, v154
v_permlane16_swap_b32 v147, v155
v_fma_f32 v36, v124, v8, v36
v_fma_f32 v37, v125, v8, v37
v_fma_f32 v38, v126, v8, v38
v_fma_f32 v39, v127, v8, v39
v_fma_f32 v40, v132, v8, v40
v_fma_f32 v41, v133, v8, v41
v_fma_f32 v42, v134, v8, v42
v_fma_f32 v43, v135, v8, v43
v_fma_f32 v44, v140, v8, v44
v_fma_f32 v45, v141, v8, v45
v_fma_f32 v46, v142, v8, v46
v_fma_f32 v47, v143, v8, v47
v_fma_f32 v48, v148, v8, v48
v_fma_f32 v49, v149, v8, v49
v_fma_f32 v50, v150, v8, v50
v_fma_f32 v51, v151, v8, v51
v_fma_f32 v52, v128, v9, v52
v_fma_f32 v53, v129, v9, v53
v_fma_f32 v54, v130, v9, v54
v_fma_f32 v55, v131, v9, v55
v_fma_f32 v56, v136, v9, v56
v_fma_f32 v57, v137, v9, v57
v_fma_f32 v58, v138, v9, v58
v_fma_f32 v59, v139, v9, v59
v_fma_f32 v60, v144, v9, v60
v_fma_f32 v61, v145, v9, v61
v_fma_f32 v62, v146, v9, v62
v_fma_f32 v63, v147, v9, v63
v_fma_f32 v64, v152, v9, v64
v_fma_f32 v65, v153, v9, v65
v_fma_f32 v66, v154, v9, v66
v_fma_f32 v67, v155, v9, v67
s_lshl_b32 s72, s2, 14
s_mov_b32 s73, 400000
L_xb:
buffer_load_dwordx4 v[76:79], v238, s[52:55], s72 offen offset:0 sc1
buffer_load_dwordx4 v[80:83], v238, s[52:55], s72 offen offset:1024 sc1
buffer_load_dwordx4 v[84:87], v238, s[52:55], s72 offen offset:2048 sc1
buffer_load_dwordx4 v[88:91], v238, s[52:55], s72 offen offset:3072 sc1
s_sub_u32 s73, s73, 1
s_cbranch_scc1 L_xb_done
s_waitcnt vmcnt(3)
v_max3_u32 v228, v76, v77, v78
s_waitcnt vmcnt(2)
v_max3_u32 v228, v228, v79, v80
v_max3_u32 v228, v228, v81, v82
s_waitcnt vmcnt(1)
v_max3_u32 v228, v228, v83, v84
v_max3_u32 v228, v228, v85, v86
s_waitcnt vmcnt(0)
v_max3_u32 v228, v228, v87, v88
v_max3_u32 v228, v228, v89, v90
v_max_u32 v228, v228, v91
v_cmp_eq_u32 vcc, -1, v228
s_nop 4
s_cbranch_vccnz L_xb
L_xb_done:
s_waitcnt vmcnt(0)
s_add_u32 s72, s78, 0
v_lshlrev_b32 v92, 16, v76
v_and_b32 v93, 0xffff0000, v76
v_fmac_f32 v36, v92, v8
v_fmac_f32 v37, v93, v8
v_cvt_pk_bf16_f32 v192, v36, v37
v_lshlrev_b32 v92, 16, v77
v_and_b32 v93, 0xffff0000, v77
v_fmac_f32 v38, v92, v8
v_fmac_f32 v39, v93, v8
v_cvt_pk_bf16_f32 v193, v38, v39
v_lshlrev_b32 v92, 16, v78
v_and_b32 v93, 0xffff0000, v78
v_fmac_f32 v40, v92, v8
v_fmac_f32 v41, v93, v8
v_cvt_pk_bf16_f32 v194, v40, v41
v_lshlrev_b32 v92, 16, v79
v_and_b32 v93, 0xffff0000, v79
v_fmac_f32 v42, v92, v8
v_fmac_f32 v43, v93, v8
v_cvt_pk_bf16_f32 v195, v42, v43
buffer_store_dwordx4 v[192:195], v250, s[60:63], s72 offen offset:0 sc1
v_lshlrev_b32 v92, 16, v80
v_and_b32 v93, 0xffff0000, v80
v_fmac_f32 v44, v92, v8
v_fmac_f32 v45, v93, v8
v_cvt_pk_bf16_f32 v196, v44, v45
v_lshlrev_b32 v92, 16, v81
v_and_b32 v93, 0xffff0000, v81
v_fmac_f32 v46, v92, v8
v_fmac_f32 v47, v93, v8
v_cvt_pk_bf16_f32 v197, v46, v47
v_lshlrev_b32 v92, 16, v82
v_and_b32 v93, 0xffff0000, v82
v_fmac_f32 v48, v92, v8
v_fmac_f32 v49, v93, v8
v_cvt_pk_bf16_f32 v198, v48, v49
v_lshlrev_b32 v92, 16, v83
v_and_b32 v93, 0xffff0000, v83
v_fmac_f32 v50, v92, v8
v_fmac_f32 v51, v93, v8
v_cvt_pk_bf16_f32 v199, v50, v51
buffer_store_dwordx4 v[196:199], v250, s[60:63], s72 offen offset:64 sc1
s_add_u32 s72, s78, 32768
v_lshlrev_b32 v92, 16, v84
v_and_b32 v93, 0xffff0000, v84
v_fmac_f32 v52, v92, v9
v_fmac_f32 v53, v93, v9
v_cvt_pk_bf16_f32 v200, v52, v53
v_lshlrev_b32 v92, 16, v85
v_and_b32 v93, 0xffff0000, v85
v_fmac_f32 v54, v92, v9
v_fmac_f32 v55, v93, v9
v_cvt_pk_bf16_f32 v201, v54, v55
v_lshlrev_b32 v92, 16, v86
v_and_b32 v93, 0xffff0000, v86
v_fmac_f32 v56, v92, v9
v_fmac_f32 v57, v93, v9
v_cvt_pk_bf16_f32 v202, v56, v57
v_lshlrev_b32 v92, 16, v87
v_and_b32 v93, 0xffff0000, v87
v_fmac_f32 v58, v92, v9
v_fmac_f32 v59, v93, v9
v_cvt_pk_bf16_f32 v203, v58, v59
buffer_store_dwordx4 v[200:203], v250, s[60:63], s72 offen offset:0 sc1
v_lshlrev_b32 v92, 16, v88
v_and_b32 v93, 0xffff0000, v88
v_fmac_f32 v60, v92, v9
v_fmac_f32 v61, v93, v9
v_cvt_pk_bf16_f32 v204, v60, v61
v_lshlrev_b32 v92, 16, v89
v_and_b32 v93, 0xffff0000, v89
v_fmac_f32 v62, v92, v9
v_fmac_f32 v63, v93, v9
v_cvt_pk_bf16_f32 v205, v62, v63
v_lshlrev_b32 v92, 16, v90
v_and_b32 v93, 0xffff0000, v90
v_fmac_f32 v64, v92, v9
v_fmac_f32 v65, v93, v9
v_cvt_pk_bf16_f32 v206, v64, v65
v_lshlrev_b32 v92, 16, v91
v_and_b32 v93, 0xffff0000, v91
v_fmac_f32 v66, v92, v9
v_fmac_f32 v67, v93, v9
v_cvt_pk_bf16_f32 v207, v66, v67
buffer_store_dwordx4 v[204:207], v250, s[60:63], s72 offen offset:64 sc1
L_end:
s_endpgm
L_p3_pmask:
s_nop 7
v_add_u32 v246, 0, v13
v_cmp_gt_i32_e64 s[84:85], 0, v246
v_cmp_gt_i32_e64 s[86:87], 1, v246
v_cmp_gt_i32_e64 s[88:89], 2, v246
v_cmp_gt_i32_e64 s[90:91], 3, v246
v_cndmask_b32_e64 v96, v96, v14, s[84:85]
v_cndmask_b32_e64 v97, v97, v14, s[86:87]
v_cndmask_b32_e64 v98, v98, v14, s[88:89]
v_cndmask_b32_e64 v99, v99, v14, s[90:91]
v_add_u32 v247, 16, v13
v_cmp_gt_i32_e64 s[92:93], 0, v247
v_cmp_gt_i32_e64 s[94:95], 1, v247
v_cmp_gt_i32_e64 s[96:97], 2, v247
v_cmp_gt_i32_e64 s[98:99], 3, v247
v_cndmask_b32_e64 v104, v104, v14, s[92:93]
v_cndmask_b32_e64 v105, v105, v14, s[94:95]
v_cndmask_b32_e64 v106, v106, v14, s[96:97]
v_cndmask_b32_e64 v107, v107, v14, s[98:99]
v_add_u32 v246, -16, v13
v_cmp_gt_i32_e64 s[84:85], 0, v246
v_cmp_gt_i32_e64 s[86:87], 1, v246
v_cmp_gt_i32_e64 s[88:89], 2, v246
v_cmp_gt_i32_e64 s[90:91], 3, v246
v_cndmask_b32_e64 v100, v100, v14, s[84:85]
v_cndmask_b32_e64 v101, v101, v14, s[86:87]
v_cndmask_b32_e64 v102, v102, v14, s[88:89]
v_cndmask_b32_e64 v103, v103, v14, s[90:91]
v_add_u32 v247, 0, v13
v_cmp_gt_i32_e64 s[92:93], 0, v247
v_cmp_gt_i32_e64 s[94:95], 1, v247
v_cmp_gt_i32_e64 s[96:97], 2, v247
v_cmp_gt_i32_e64 s[98:99], 3, v247
v_cndmask_b32_e64 v108, v108, v14, s[92:93]
v_cndmask_b32_e64 v109, v109, v14, s[94:95]
v_cndmask_b32_e64 v110, v110, v14, s[96:97]
v_cndmask_b32_e64 v111, v111, v14, s[98:99]
v_add_u32 v246, -32, v13
v_cmp_gt_i32_e64 s[84:85], 0, v246
v_cmp_gt_i32_e64 s[86:87], 1, v246
v_cmp_gt_i32_e64 s[88:89], 2, v246
v_cmp_gt_i32_e64 s[90:91], 3, v246
v_cndmask_b32_e64 v128, v128, v14, s[84:85]
v_cndmask_b32_e64 v129, v129, v14, s[86:87]
v_cndmask_b32_e64 v130, v130, v14, s[88:89]
v_cndmask_b32_e64 v131, v131, v14, s[90:91]
v_add_u32 v247, -16, v13
v_cmp_gt_i32_e64 s[92:93], 0, v247
v_cmp_gt_i32_e64 s[94:95], 1, v247
v_cmp_gt_i32_e64 s[96:97], 2, v247
v_cmp_gt_i32_e64 s[98:99], 3, v247
v_cndmask_b32_e64 v136, v136, v14, s[92:93]
v_cndmask_b32_e64 v137, v137, v14, s[94:95]
v_cndmask_b32_e64 v138, v138, v14, s[96:97]
v_cndmask_b32_e64 v139, v139, v14, s[98:99]
v_add_u32 v246, -48, v13
v_cmp_gt_i32_e64 s[84:85], 0, v246
v_cmp_gt_i32_e64 s[86:87], 1, v246
v_cmp_gt_i32_e64 s[88:89], 2, v246
v_cmp_gt_i32_e64 s[90:91], 3, v246
v_cndmask_b32_e64 v132, v132, v14, s[84:85]
v_cndmask_b32_e64 v133, v133, v14, s[86:87]
v_cndmask_b32_e64 v134, v134, v14, s[88:89]
v_cndmask_b32_e64 v135, v135, v14, s[90:91]
v_add_u32 v247, -32, v13
v_cmp_gt_i32_e64 s[92:93], 0, v247
v_cmp_gt_i32_e64 s[94:95], 1, v247
v_cmp_gt_i32_e64 s[96:97], 2, v247
v_cmp_gt_i32_e64 s[98:99], 3, v247
v_cndmask_b32_e64 v140, v140, v14, s[92:93]
v_cndmask_b32_e64 v141, v141, v14, s[94:95]
v_cndmask_b32_e64 v142, v142, v14, s[96:97]
v_cndmask_b32_e64 v143, v143, v14, s[98:99]
s_branch L_p3_pmask_ret
L_p3_mxm_top:
s_waitcnt lgkmcnt(0)
v_xor_b32 v11, 0x8000, v11
v_mfma_f32_16x16x32_bf16 v[80:83], a[128:131], v[16:19], 0
s_add_u32 m0, s73, 16384
ds_read_b128 a[192:195], v11 offset:0
v_mfma_f32_16x16x32_bf16 v[88:91], a[128:131], v[32:35], 0
v_exp_f32 v176, v176
MV 80,a,132,v,20
v_exp_f32 v177, v177
MV 88,a,132,v,36
ds_read_b128 a[196:199], v11 offset:1024
buffer_load_dwordx4 v12, s[56:59], s71 offen offset:0 sc1 lds
MV 80,a,136,v,24
v_exp_f32 v178, v178
MV 88,a,136,v,40
v_add_f32 v2, v2, v176
v_add_f32 v2, v2, v177
MV 80,a,140,v,28
v_exp_f32 v179, v179
MV 88,a,140,v,44
ds_read_b128 a[200:203], v11 offset:2048
v_cvt_pk_bf16_f32 v176, v176, v177
v_mfma_f32_16x16x32_bf16 v[84:87], a[144:147], v[16:19], 0
v_exp_f32 v180, v180
v_mfma_f32_16x16x32_bf16 v[92:95], a[144:147], v[32:35], 0
ds_read_b128 a[204:207], v11 offset:3072
v_add_f32 v2, v2, v178
MV 84,a,148,v,20
ds_read_b128 a[208:211], v11 offset:4096
v_add_f32 v2, v2, v179
MV 92,a,148,v,36
v_exp_f32 v181, v181
MV 84,a,152,v,24
buffer_load_dwordx4 v12, s[56:59], s71 offen offset:1024 sc1 lds
v_cvt_pk_bf16_f32 v177, v178, v179
MV 92,a,152,v,40
v_exp_f32 v182, v182
MV 84,a,156,v,28
v_add_f32 v2, v2, v180
v_add_f32 v2, v2, v181
MV 92,a,156,v,44
v_exp_f32 v183, v183
v_mfma_f32_16x16x32_bf16 v[112:115], a[160:163], v[16:19], 0
ds_read_b128 a[212:215], v11 offset:5120
v_cvt_pk_bf16_f32 v178, v180, v181
v_mfma_f32_16x16x32_bf16 v[120:123], a[160:163], v[32:35], 0
v_exp_f32 v184, v184
MV 112,a,164,v,20
v_add_f32 v2, v2, v182
v_add_f32 v2, v2, v183
MV 120,a,164,v,36
v_exp_f32 v185, v185
MV 112,a,168,v,24
ds_read_b128 a[216:219], v11 offset:6144
v_cvt_pk_bf16_f32 v179, v182, v183
MV 120,a,168,v,40
v_exp_f32 v186, v186
MV 112,a,172,v,28
ds_read_b128 a[220:223], v11 offset:7168
v_add_f32 v3, v3, v184
MV 120,a,172,v,44
buffer_load_dwordx4 v12, s[56:59], s71 offen offset:2048 sc1 lds
v_add_f32 v3, v3, v185
v_mfma_f32_16x16x32_bf16 v[116:119], a[176:179], v[16:19], 0
v_exp_f32 v187, v187
v_mfma_f32_16x16x32_bf16 v[124:127], a[176:179], v[32:35], 0
ds_read_b128 a[224:227], v11 offset:8192
v_cvt_pk_bf16_f32 v184, v184, v185
MV 116,a,180,v,20
v_exp_f32 v188, v188
MV 124,a,180,v,36
v_add_f32 v3, v3, v186
v_add_f32 v3, v3, v187
MV 116,a,184,v,24
v_exp_f32 v189, v189
MV 124,a,184,v,40
ds_read_b128 a[228:231], v11 offset:9216
v_cvt_pk_bf16_f32 v185, v186, v187
MV 116,a,188,v,28
v_exp_f32 v190, v190
MV 124,a,188,v,44
ds_read_b128 a[232:235], v11 offset:10240
ds_read_b128 a[236:239], v11 offset:11264
ds_read_b128 a[240:243], v11 offset:12288
ds_read_b128 a[244:247], v11 offset:13312
ds_read_b128 a[248:251], v11 offset:14336
ds_read_b128 a[252:255], v11 offset:15360
buffer_load_dwordx4 v12, s[56:59], s71 offen offset:3072 sc1 lds
s_add_u32 s71, s71, 16384
s_xor_b32 s73, s73, 0x8000
v_add_f32 v3, v3, v188
v_add_f32 v3, v3, v189
v_exp_f32 v191, v191
v_cvt_pk_bf16_f32 v186, v188, v189
v_exp_f32 v192, v192
v_add_f32 v3, v3, v190
v_add_f32 v3, v3, v191
v_exp_f32 v193, v193
v_cvt_pk_bf16_f32 v187, v190, v191
v_exp_f32 v194, v194
v_add_f32 v4, v4, v192
v_add_f32 v4, v4, v193
v_exp_f32 v195, v195
v_cvt_pk_bf16_f32 v192, v192, v193
v_exp_f32 v196, v196
v_add_f32 v4, v4, v194
v_add_f32 v4, v4, v195
v_exp_f32 v197, v197
v_cvt_pk_bf16_f32 v193, v194, v195
v_exp_f32 v198, v198
v_add_f32 v4, v4, v196
v_add_f32 v4, v4, v197
v_exp_f32 v199, v199
v_cvt_pk_bf16_f32 v194, v196, v197
v_add_u32 v246, 0, v13
v_cmp_gt_i32_e64 s[84:85], 0, v246
v_cmp_gt_i32_e64 s[86:87], 1, v246
v_cmp_gt_i32_e64 s[88:89], 2, v246
v_exp_f32 v200, v200
v_add_f32 v4, v4, v198
v_cmp_gt_i32_e64 s[90:91], 3, v246
v_cndmask_b32_e64 v80, v80, v14, s[84:85]
v_cndmask_b32_e64 v81, v81, v14, s[86:87]
v_cndmask_b32_e64 v82, v82, v14, s[88:89]
v_add_f32 v4, v4, v199
v_exp_f32 v201, v201
v_cvt_pk_bf16_f32 v195, v198, v199
v_cndmask_b32_e64 v83, v83, v14, s[90:91]
v_add_u32 v247, 16, v13
v_cmp_gt_i32_e64 s[92:93], 0, v247
v_exp_f32 v202, v202
v_add_f32 v5, v5, v200
v_cmp_gt_i32_e64 s[94:95], 1, v247
v_cmp_gt_i32_e64 s[96:97], 2, v247
v_cmp_gt_i32_e64 s[98:99], 3, v247
v_cndmask_b32_e64 v88, v88, v14, s[92:93]
v_add_f32 v5, v5, v201
v_exp_f32 v203, v203
v_cvt_pk_bf16_f32 v200, v200, v201
v_cndmask_b32_e64 v89, v89, v14, s[94:95]
v_cndmask_b32_e64 v90, v90, v14, s[96:97]
v_cndmask_b32_e64 v91, v91, v14, s[98:99]
v_exp_f32 v204, v204
v_add_f32 v5, v5, v202
v_add_u32 v246, -16, v13
v_cmp_gt_i32_e64 s[84:85], 0, v246
v_cmp_gt_i32_e64 s[86:87], 1, v246
v_cmp_gt_i32_e64 s[88:89], 2, v246
v_add_f32 v5, v5, v203
v_exp_f32 v205, v205
v_cvt_pk_bf16_f32 v201, v202, v203
v_cmp_gt_i32_e64 s[90:91], 3, v246
v_cndmask_b32_e64 v84, v84, v14, s[84:85]
v_cndmask_b32_e64 v85, v85, v14, s[86:87]
v_cndmask_b32_e64 v86, v86, v14, s[88:89]
v_exp_f32 v206, v206
v_add_f32 v5, v5, v204
v_cndmask_b32_e64 v87, v87, v14, s[90:91]
v_add_u32 v247, 0, v13
v_cmp_gt_i32_e64 s[92:93], 0, v247
v_add_f32 v5, v5, v205
v_exp_f32 v207, v207
v_cvt_pk_bf16_f32 v202, v204, v205
v_cmp_gt_i32_e64 s[94:95], 1, v247
v_cmp_gt_i32_e64 s[96:97], 2, v247
v_cmp_gt_i32_e64 s[98:99], 3, v247
v_cndmask_b32_e64 v92, v92, v14, s[92:93]
v_add_f32 v5, v5, v206
v_add_f32 v5, v5, v207
v_cvt_pk_bf16_f32 v203, v206, v207
v_cndmask_b32_e64 v93, v93, v14, s[94:95]
v_cndmask_b32_e64 v94, v94, v14, s[96:97]
v_cndmask_b32_e64 v95, v95, v14, s[98:99]
s_waitcnt vmcnt(16) lgkmcnt(0)
MA 0,a,192,v,144
s_barrier
v_xor_b32 v10, 0x8000, v10
MA 32,a,192,v,152
s_add_u32 m0, s72, 16384
ds_read_b128 a[128:131], v10 offset:0
MA 64,a,192,v,160
v_exp_f32 v80, v80
MA 96,a,192,v,168
buffer_load_dwordx4 v12, s[52:55], s71 offen offset:0 sc1 lds
v_lshrrev_b32 v249, 2, v1
MA 4,a,196,v,144
ds_read_b128 a[132:135], v10 offset:1024
v_and_b32 v248, 7, v249
MA 36,a,196,v,152
v_lshlrev_b32 v249, 8, v249
v_and_b32 v250, 3, v1
MA 68,a,196,v,160
v_lshl_add_u32 v249, v250, 3, v249
s_lshl_b32 s36, s3, 13
MA 100,a,196,v,168
v_exp_f32 v81, v81
MA 8,a,200,v,144
ds_read_b128 a[136:139], v10 offset:2048
v_add_u32 v246, -32, v13
MA 40,a,200,v,152
v_cmp_gt_i32_e64 s[84:85], 0, v246
s_add_u32 s36, s36, 131072
MA 72,a,200,v,160
v_add_u32 v249, s36, v249
s_nop 0
MA 104,a,200,v,168
v_exp_f32 v82, v82
MA 12,a,204,v,144
ds_read_b128 a[140:143], v10 offset:3072
v_xor_b32 v250, 0, v248
MA 44,a,204,v,152
v_cmp_gt_i32_e64 s[86:87], 1, v246
v_lshl_add_u32 v250, v250, 5, v249
MA 76,a,204,v,160
v_cmp_gt_i32_e64 s[88:89], 2, v246
TR 96,250,0
MA 108,a,204,v,168
TR 98,250,4096
v_xor_b32 v250, 1, v248
MA 16,a,208,v,144
v_exp_f32 v83, v83
MA 48,a,208,v,152
ds_read_b128 a[144:147], v10 offset:4096
v_cmp_gt_i32_e64 s[90:91], 3, v246
MA 80,a,208,v,160
v_lshl_add_u32 v250, v250, 5, v249
TR 100,250,0
MA 112,a,208,v,168
v_cvt_pk_bf16_f32 v80, v80, v81
TR 102,250,4096
MA 20,a,212,v,144
buffer_load_dwordx4 v12, s[52:55], s71 offen offset:1024 sc1 lds
v_cndmask_b32_e64 v112, v112, v14, s[84:85]
MA 52,a,212,v,152
v_xor_b32 v250, 2, v248
v_lshl_add_u32 v250, v250, 5, v249
MA 84,a,212,v,160
ds_read_b128 a[148:151], v10 offset:5120
v_cndmask_b32_e64 v113, v113, v14, s[86:87]
MA 116,a,212,v,168
TR 104,250,0
TR 106,250,4096
MA 24,a,216,v,144
v_exp_f32 v84, v84
MA 56,a,216,v,152
v_cndmask_b32_e64 v114, v114, v14, s[88:89]
v_xor_b32 v250, 3, v248
MA 88,a,216,v,160
ds_read_b128 a[152:155], v10 offset:6144
v_lshl_add_u32 v250, v250, 5, v249
MA 120,a,216,v,168
v_cndmask_b32_e64 v115, v115, v14, s[90:91]
TR 108,250,0
MA 28,a,220,v,144
v_exp_f32 v85, v85
MA 60,a,220,v,152
v_add_u32 v247, -16, v13
TR 110,250,4096
MA 92,a,220,v,160
v_xor_b32 v250, 4, v248
v_lshl_add_u32 v250, v250, 5, v249
MA 124,a,220,v,168
ds_read_b128 a[156:159], v10 offset:7168
v_cvt_pk_bf16_f32 v81, v82, v83
MA 0,a,224,v,176
v_cmp_gt_i32_e64 s[92:93], 0, v247
TR 128,250,0
MA 32,a,224,v,184
TR 130,250,4096
v_xor_b32 v250, 5, v248
MA 64,a,224,v,192
v_cmp_gt_i32_e64 s[94:95], 1, v247
v_lshl_add_u32 v250, v250, 5, v249
MA 96,a,224,v,200
v_exp_f32 v86, v86
MA 4,a,228,v,176
ds_read_b128 a[160:163], v10 offset:8192
TR 132,250,0
MA 36,a,228,v,184
v_cmp_gt_i32_e64 s[96:97], 2, v247
TR 134,250,4096
MA 68,a,228,v,192
buffer_load_dwordx4 v12, s[52:55], s71 offen offset:2048 sc1 lds
v_xor_b32 v250, 6, v248
MA 100,a,228,v,200
v_cmp_gt_i32_e64 s[98:99], 3, v247
v_lshl_add_u32 v250, v250, 5, v249
MA 8,a,232,v,176
v_exp_f32 v87, v87
MA 40,a,232,v,184
ds_read_b128 a[164:167], v10 offset:9216
TR 136,250,0
MA 72,a,232,v,192
v_cndmask_b32_e64 v120, v120, v14, s[92:93]
TR 138,250,4096
MA 104,a,232,v,200
v_cvt_pk_bf16_f32 v82, v84, v85
v_xor_b32 v250, 7, v248
MA 12,a,236,v,176
ds_read_b128 a[168:171], v10 offset:10240
v_lshl_add_u32 v250, v250, 5, v249
MA 44,a,236,v,184
v_cndmask_b32_e64 v121, v121, v14, s[94:95]
TR 140,250,0
MA 76,a,236,v,192
v_cndmask_b32_e64 v122, v122, v14, s[96:97]
TR 142,250,4096
MA 108,a,236,v,200
v_exp_f32 v88, v88
MA 16,a,240,v,176
s_add_u32 s32, s40, 100663296
s_addc_u32 s33, s41, 0
MA 48,a,240,v,184
ds_read_b128 a[172:175], v10 offset:11264
v_cndmask_b32_e64 v123, v123, v14, s[98:99]
MA 80,a,240,v,192
s_mov_b32 s34, 8388608
s_mov_b32 s35, 0x20000
MA 112,a,240,v,200
v_add_u32 v246, -48, v13
s_and_b32 s36, s2, 7
MA 20,a,244,v,176
v_exp_f32 v89, v89
MA 52,a,244,v,184
s_lshl_b32 s36, s36, 20
s_lshr_b32 s37, s2, 3
MA 84,a,244,v,192
ds_read_b128 a[176:179], v10 offset:12288
v_cmp_gt_i32_e64 s[84:85], 0, v246
MA 116,a,244,v,200
v_cvt_pk_bf16_f32 v83, v86, v87
s_lshl_b32 s37, s37, 15
MA 24,a,248,v,176
v_cmp_gt_i32_e64 s[86:87], 1, v246
s_add_u32 s36, s36, s37
MA 56,a,248,v,184
s_lshl_b32 s37, s3, 12
s_add_u32 s36, s36, s37
MA 88,a,248,v,192
v_exp_f32 v90, v90
MA 120,a,248,v,200
ds_read_b128 a[180:183], v10 offset:13312
buffer_load_dwordx4 v12, s[52:55], s71 offen offset:3072 sc1 lds
MA 28,a,252,v,176
v_cmp_gt_i32_e64 s[88:89], 2, v246
s_add_u32 s37, s36, 4096
MA 60,a,252,v,184
s_waitcnt lgkmcnt(15)
buffer_store_dwordx4 v[96:99], v12, s[32:35], s36 offen offset:0 sc1
buffer_store_dwordx4 v[100:103], v12, s[32:35], s36 offen offset:1024 sc1
MA 92,a,252,v,192
v_cmp_gt_i32_e64 s[90:91], 3, v246
buffer_store_dwordx4 v[104:107], v12, s[32:35], s36 offen offset:2048 sc1
MA 124,a,252,v,200
ds_read_b128 a[184:187], v10 offset:14336
ds_read_b128 a[188:191], v10 offset:15360
s_xor_b32 s72, s72, 0x8000
v_exp_f32 v91, v91
buffer_store_dwordx4 v[108:111], v12, s[32:35], s36 offen offset:3072 sc1
v_cndmask_b32_e64 v116, v116, v14, s[84:85]
s_waitcnt lgkmcnt(14)
buffer_store_dwordx4 v[128:131], v12, s[32:35], s37 offen offset:0 sc1
s_waitcnt lgkmcnt(11)
buffer_store_dwordx4 v[132:135], v12, s[32:35], s37 offen offset:1024 sc1
v_cndmask_b32_e64 v117, v117, v14, s[86:87]
s_waitcnt lgkmcnt(8)
buffer_store_dwordx4 v[136:139], v12, s[32:35], s37 offen offset:2048 sc1
v_cvt_pk_bf16_f32 v88, v88, v89
s_waitcnt lgkmcnt(5)
buffer_store_dwordx4 v[140:143], v12, s[32:35], s37 offen offset:3072 sc1
s_add_u32 s32, s40, 109051904
s_addc_u32 s33, s41, 0
v_exp_f32 v92, v92
v_cndmask_b32_e64 v118, v118, v14, s[88:89]
v_cndmask_b32_e64 v119, v119, v14, s[90:91]
s_mov_b32 s34, 4194304
s_mov_b32 s35, 0x20000
s_lshl_b32 s36, s2, 14
v_exp_f32 v93, v93
v_add_u32 v247, -32, v13
v_mov_b32 v252, -1
v_mov_b32 v253, -1
v_cmp_gt_i32_e64 s[92:93], 0, v247
v_mov_b32 v254, -1
v_mov_b32 v255, -1
v_cvt_pk_bf16_f32 v89, v90, v91
v_cmp_gt_i32_e64 s[94:95], 1, v247
buffer_store_dwordx4 v[252:255], v12, s[32:35], s36 offen offset:0 sc1
buffer_store_dwordx4 v[252:255], v12, s[32:35], s36 offen offset:1024 sc1
buffer_store_dwordx4 v[252:255], v12, s[32:35], s36 offen offset:2048 sc1
v_exp_f32 v94, v94
v_cmp_gt_i32_e64 s[96:97], 2, v247
buffer_store_dwordx4 v[252:255], v12, s[32:35], s36 offen offset:3072 sc1
v_cmp_gt_i32_e64 s[98:99], 3, v247
v_lshlrev_b32 v232, 4, v1
v_add_u32 v233, -8, v232
v_mov_b32 v235, 0
v_exp_f32 v95, v95
v_cndmask_b32_e64 v124, v124, v14, s[92:93]
buffer_load_ushort v234, v235, s[28:31], s42 offen
buffer_load_dwordx2 v[208:209], v233, s[16:19], 0 offen
buffer_load_dwordx4 v[210:213], v232, s[16:19], 0 offen offset:0
v_cndmask_b32_e64 v125, v125, v14, s[94:95]
buffer_load_dwordx2 v[214:215], v232, s[16:19], 0 offen offset:1016
v_cvt_pk_bf16_f32 v90, v92, v93
v_cndmask_b32_e64 v126, v126, v14, s[96:97]
buffer_load_dwordx4 v[216:219], v232, s[16:19], 0 offen offset:1024
buffer_load_dwordx2 v[220:221], v232, s[16:19], 0 offen offset:2040
buffer_load_dwordx4 v[222:225], v232, s[16:19], 0 offen offset:2048
v_cvt_pk_bf16_f32 v91, v94, v95
v_cndmask_b32_e64 v127, v127, v14, s[98:99]
buffer_load_dwordx2 v[226:227], v232, s[16:19], 0 offen offset:3064
buffer_load_dwordx4 v[228:231], v232, s[16:19], 0 offen offset:3072
s_branch L_p3_eps
L_fallback:
s_mov_b32 s81, 0
s_mov_b32 s74, s77
s_mov_b32 s73, s100
s_sub_u32 s72, 15, s70
v_mov_b32 v10, v15
v_add_u32 v11, 16384, v15
s_nop 15
L_fb_set:
s_lshl_b32 s72, s72, 7
s_mov_b32 s71, 0
v_accvgpr_write_b32 a0, 0
v_accvgpr_write_b32 a1, 0
v_accvgpr_write_b32 a2, 0
v_accvgpr_write_b32 a3, 0
v_accvgpr_write_b32 a4, 0
v_accvgpr_write_b32 a5, 0
v_accvgpr_write_b32 a6, 0
v_accvgpr_write_b32 a7, 0
v_accvgpr_write_b32 a8, 0
v_accvgpr_write_b32 a9, 0
v_accvgpr_write_b32 a10, 0
v_accvgpr_write_b32 a11, 0
v_accvgpr_write_b32 a12, 0
v_accvgpr_write_b32 a13, 0
v_accvgpr_write_b32 a14, 0
v_accvgpr_write_b32 a15, 0
v_accvgpr_write_b32 a16, 0
v_accvgpr_write_b32 a17, 0
v_accvgpr_write_b32 a18, 0
v_accvgpr_write_b32 a19, 0
v_accvgpr_write_b32 a20, 0
v_accvgpr_write_b32 a21, 0
v_accvgpr_write_b32 a22, 0
v_accvgpr_write_b32 a23, 0
v_accvgpr_write_b32 a24, 0
v_accvgpr_write_b32 a25, 0
v_accvgpr_write_b32 a26, 0
v_accvgpr_write_b32 a27, 0
v_accvgpr_write_b32 a28, 0
v_accvgpr_write_b32 a29, 0
v_accvgpr_write_b32 a30, 0
v_accvgpr_write_b32 a31, 0
v_accvgpr_write_b32 a32, 0
v_accvgpr_write_b32 a33, 0
v_accvgpr_write_b32 a34, 0
v_accvgpr_write_b32 a35, 0
v_accvgpr_write_b32 a36, 0
v_accvgpr_write_b32 a37, 0
v_accvgpr_write_b32 a38, 0
v_accvgpr_write_b32 a39, 0
v_accvgpr_write_b32 a40, 0
v_accvgpr_write_b32 a41, 0
v_accvgpr_write_b32 a42, 0
v_accvgpr_write_b32 a43, 0
v_accvgpr_write_b32 a44, 0
v_accvgpr_write_b32 a45, 0
v_accvgpr_write_b32 a46, 0
v_accvgpr_write_b32 a47, 0
v_accvgpr_write_b32 a48, 0
v_accvgpr_write_b32 a49, 0
v_accvgpr_write_b32 a50, 0
v_accvgpr_write_b32 a51, 0
v_accvgpr_write_b32 a52, 0
v_accvgpr_write_b32 a53, 0
v_accvgpr_write_b32 a54, 0
v_accvgpr_write_b32 a55, 0
v_accvgpr_write_b32 a56, 0
v_accvgpr_write_b32 a57, 0
v_accvgpr_write_b32 a58, 0
v_accvgpr_write_b32 a59, 0
v_accvgpr_write_b32 a60, 0
v_accvgpr_write_b32 a61, 0
v_accvgpr_write_b32 a62, 0
v_accvgpr_write_b32 a63, 0
v_mov_b32 v2, 0
v_mov_b32 v96, v14
v_mov_b32 v3, 0
v_mov_b32 v97, v14
L_fb_tile:
s_waitcnt vmcnt(0) lgkmcnt(0)
s_barrier
s_mov_b32 m0, s68
s_add_u32 s80, s71, 16384
buffer_load_dwordx4 v12, s[52:55], s71 offen offset:0 sc1 lds
buffer_load_dwordx4 v12, s[52:55], s71 offen offset:1024 sc1 lds
buffer_load_dwordx4 v12, s[52:55], s71 offen offset:2048 sc1 lds
buffer_load_dwordx4 v12, s[52:55], s71 offen offset:3072 sc1 lds
s_add_u32 m0, s68, 16384
s_nop 0
buffer_load_dwordx4 v12, s[56:59], s80 offen offset:0 sc1 lds
buffer_load_dwordx4 v12, s[56:59], s80 offen offset:1024 sc1 lds
buffer_load_dwordx4 v12, s[56:59], s80 offen offset:2048 sc1 lds
buffer_load_dwordx4 v12, s[56:59], s80 offen offset:3072 sc1 lds
s_waitcnt vmcnt(0)
s_barrier
ds_read_b128 a[128:131], v10 offset:0
ds_read_b128 a[132:135], v10 offset:1024
ds_read_b128 a[136:139], v10 offset:2048
ds_read_b128 a[140:143], v10 offset:3072
ds_read_b128 a[144:147], v10 offset:4096
ds_read_b128 a[148:151], v10 offset:5120
ds_read_b128 a[152:155], v10 offset:6144
ds_read_b128 a[156:159], v10 offset:7168
ds_read_b128 a[160:163], v10 offset:8192
ds_read_b128 a[164:167], v10 offset:9216
ds_read_b128 a[168:171], v10 offset:10240
ds_read_b128 a[172:175], v10 offset:11264
ds_read_b128 a[176:179], v10 offset:12288
ds_read_b128 a[180:183], v10 offset:13312
ds_read_b128 a[184:187], v10 offset:14336
ds_read_b128 a[188:191], v10 offset:15360
s_waitcnt lgkmcnt(0)
ds_read_b128 a[192:195], v11 offset:0
ds_read_b128 a[196:199], v11 offset:1024
ds_read_b128 a[200:203], v11 offset:2048
ds_read_b128 a[204:207], v11 offset:3072
ds_read_b128 a[208:211], v11 offset:4096
ds_read_b128 a[212:215], v11 offset:5120
ds_read_b128 a[216:219], v11 offset:6144
ds_read_b128 a[220:223], v11 offset:7168
ds_read_b128 a[224:227], v11 offset:8192
ds_read_b128 a[228:231], v11 offset:9216
ds_read_b128 a[232:235], v11 offset:10240
ds_read_b128 a[236:239], v11 offset:11264
ds_read_b128 a[240:243], v11 offset:12288
ds_read_b128 a[244:247], v11 offset:13312
ds_read_b128 a[248:251], v11 offset:14336
ds_read_b128 a[252:255], v11 offset:15360
v_mfma_f32_16x16x32_bf16 v[80:83], a[128:131], v[16:19], 0
v_mfma_f32_16x16x32_bf16 v[88:91], a[128:131], v[32:35], 0
MV 80,a,132,v,20
MV 88,a,132,v,36
MV 80,a,136,v,24
MV 88,a,136,v,40
MV 80,a,140,v,28
MV 88,a,140,v,44
v_mfma_f32_16x16x32_bf16 v[84:87], a[144:147], v[16:19], 0
v_mfma_f32_16x16x32_bf16 v[92:95], a[144:147], v[32:35], 0
MV 84,a,148,v,20
MV 92,a,148,v,36
MV 84,a,152,v,24
MV 92,a,152,v,40
MV 84,a,156,v,28
MV 92,a,156,v,44
v_mfma_f32_16x16x32_bf16 v[112:115], a[160:163], v[16:19], 0
v_mfma_f32_16x16x32_bf16 v[120:123], a[160:163], v[32:35], 0
MV 112,a,164,v,20
MV 120,a,164,v,36
MV 112,a,168,v,24
MV 120,a,168,v,40
MV 112,a,172,v,28
MV 120,a,172,v,44
v_mfma_f32_16x16x32_bf16 v[116:119], a[176:179], v[16:19], 0
v_mfma_f32_16x16x32_bf16 v[124:127], a[176:179], v[32:35], 0
MV 116,a,180,v,20
MV 124,a,180,v,36
MV 116,a,184,v,24
MV 124,a,184,v,40
MV 116,a,188,v,28
MV 124,a,188,v,44
v_add_u32 v246, s72, v13
v_add_u32 v246, 0, v246
v_cmp_gt_i32_e64 s[84:85], 0, v246
v_cmp_gt_i32_e64 s[86:87], 1, v246
v_cmp_gt_i32_e64 s[88:89], 2, v246
v_cmp_gt_i32_e64 s[90:91], 3, v246
v_cndmask_b32_e64 v80, v80, v14, s[84:85]
v_cndmask_b32_e64 v81, v81, v14, s[86:87]
v_cndmask_b32_e64 v82, v82, v14, s[88:89]
v_cndmask_b32_e64 v83, v83, v14, s[90:91]
v_add_u32 v247, s72, v13
v_add_u32 v247, 16, v247
v_cmp_gt_i32_e64 s[92:93], 0, v247
v_cmp_gt_i32_e64 s[94:95], 1, v247
v_cmp_gt_i32_e64 s[96:97], 2, v247
v_cmp_gt_i32_e64 s[98:99], 3, v247
v_cndmask_b32_e64 v88, v88, v14, s[92:93]
v_cndmask_b32_e64 v89, v89, v14, s[94:95]
v_cndmask_b32_e64 v90, v90, v14, s[96:97]
v_cndmask_b32_e64 v91, v91, v14, s[98:99]
v_add_u32 v246, s72, v13
v_add_u32 v246, -16, v246
v_cmp_gt_i32_e64 s[84:85], 0, v246
v_cmp_gt_i32_e64 s[86:87], 1, v246
v_cmp_gt_i32_e64 s[88:89], 2, v246
v_cmp_gt_i32_e64 s[90:91], 3, v246
v_cndmask_b32_e64 v84, v84, v14, s[84:85]
v_cndmask_b32_e64 v85, v85, v14, s[86:87]
v_cndmask_b32_e64 v86, v86, v14, s[88:89]
v_cndmask_b32_e64 v87, v87, v14, s[90:91]
v_add_u32 v247, s72, v13
v_add_u32 v247, 0, v247
v_cmp_gt_i32_e64 s[92:93], 0, v247
v_cmp_gt_i32_e64 s[94:95], 1, v247
v_cmp_gt_i32_e64 s[96:97], 2, v247
v_cmp_gt_i32_e64 s[98:99], 3, v247
v_cndmask_b32_e64 v92, v92, v14, s[92:93]
v_cndmask_b32_e64 v93, v93, v14, s[94:95]
v_cndmask_b32_e64 v94, v94, v14, s[96:97]
v_cndmask_b32_e64 v95, v95, v14, s[98:99]
v_add_u32 v246, s72, v13
v_add_u32 v246, -32, v246
v_cmp_gt_i32_e64 s[84:85], 0, v246
v_cmp_gt_i32_e64 s[86:87], 1, v246
v_cmp_gt_i32_e64 s[88:89], 2, v246
v_cmp_gt_i32_e64 s[90:91], 3, v246
v_cndmask_b32_e64 v112, v112, v14, s[84:85]
v_cndmask_b32_e64 v113, v113, v14, s[86:87]
v_cndmask_b32_e64 v114, v114, v14, s[88:89]
v_cndmask_b32_e64 v115, v115, v14, s[90:91]
v_add_u32 v247, s72, v13
v_add_u32 v247, -16, v247
v_cmp_gt_i32_e64 s[92:93], 0, v247
v_cmp_gt_i32_e64 s[94:95], 1, v247
v_cmp_gt_i32_e64 s[96:97], 2, v247
v_cmp_gt_i32_e64 s[98:99], 3, v247
v_cndmask_b32_e64 v120, v120, v14, s[92:93]
v_cndmask_b32_e64 v121, v121, v14, s[94:95]
v_cndmask_b32_e64 v122, v122, v14, s[96:97]
v_cndmask_b32_e64 v123, v123, v14, s[98:99]
v_add_u32 v246, s72, v13
v_add_u32 v246, -48, v246
v_cmp_gt_i32_e64 s[84:85], 0, v246
v_cmp_gt_i32_e64 s[86:87], 1, v246
v_cmp_gt_i32_e64 s[88:89], 2, v246
v_cmp_gt_i32_e64 s[90:91], 3, v246
v_cndmask_b32_e64 v116, v116, v14, s[84:85]
v_cndmask_b32_e64 v117, v117, v14, s[86:87]
v_cndmask_b32_e64 v118, v118, v14, s[88:89]
v_cndmask_b32_e64 v119, v119, v14, s[90:91]
v_add_u32 v247, s72, v13
v_add_u32 v247, -32, v247
v_cmp_gt_i32_e64 s[92:93], 0, v247
v_cmp_gt_i32_e64 s[94:95], 1, v247
v_cmp_gt_i32_e64 s[96:97], 2, v247
v_cmp_gt_i32_e64 s[98:99], 3, v247
v_cndmask_b32_e64 v124, v124, v14, s[92:93]
v_cndmask_b32_e64 v125, v125, v14, s[94:95]
v_cndmask_b32_e64 v126, v126, v14, s[96:97]
v_cndmask_b32_e64 v127, v127, v14, s[98:99]
v_mov_b32 v242, v96
v_max3_f32 v242, v242, v80, v81
v_max3_f32 v242, v242, v82, v83
v_max3_f32 v242, v242, v84, v85
v_max3_f32 v242, v242, v86, v87
v_max3_f32 v242, v242, v112, v113
v_max3_f32 v242, v242, v114, v115
v_max3_f32 v242, v242, v116, v117
v_max3_f32 v242, v242, v118, v119
v_mov_b32 v243, v242
s_nop 1
v_permlane32_swap_b32 v242, v243
v_max_f32 v242, v242, v243
v_mov_b32 v243, v242
s_nop 1
v_permlane16_swap_b32 v242, v243
v_max_f32 v242, v242, v243
v_sub_f32 v98, v96, v242
v_exp_f32 v98, v98
v_mov_b32 v96, v242
v_sub_f32 v80, v80, v242
v_sub_f32 v81, v81, v242
v_sub_f32 v82, v82, v242
v_sub_f32 v83, v83, v242
v_sub_f32 v84, v84, v242
v_sub_f32 v85, v85, v242
v_sub_f32 v86, v86, v242
v_sub_f32 v87, v87, v242
v_sub_f32 v112, v112, v242
v_sub_f32 v113, v113, v242
v_sub_f32 v114, v114, v242
v_sub_f32 v115, v115, v242
v_sub_f32 v116, v116, v242
v_sub_f32 v117, v117, v242
v_sub_f32 v118, v118, v242
v_sub_f32 v119, v119, v242
v_mul_f32 v2, v2, v98
v_accvgpr_read_b32 v243, a0
v_mul_f32 v243, v243, v98
v_accvgpr_write_b32 a0, v243
v_accvgpr_read_b32 v243, a1
v_mul_f32 v243, v243, v98
v_accvgpr_write_b32 a1, v243
v_accvgpr_read_b32 v243, a2
v_mul_f32 v243, v243, v98
v_accvgpr_write_b32 a2, v243
v_accvgpr_read_b32 v243, a3
v_mul_f32 v243, v243, v98
v_accvgpr_write_b32 a3, v243
v_accvgpr_read_b32 v243, a4
v_mul_f32 v243, v243, v98
v_accvgpr_write_b32 a4, v243
v_accvgpr_read_b32 v243, a5
v_mul_f32 v243, v243, v98
v_accvgpr_write_b32 a5, v243
v_accvgpr_read_b32 v243, a6
v_mul_f32 v243, v243, v98
v_accvgpr_write_b32 a6, v243
v_accvgpr_read_b32 v243, a7
v_mul_f32 v243, v243, v98
v_accvgpr_write_b32 a7, v243
v_accvgpr_read_b32 v243, a8
v_mul_f32 v243, v243, v98
v_accvgpr_write_b32 a8, v243
v_accvgpr_read_b32 v243, a9
v_mul_f32 v243, v243, v98
v_accvgpr_write_b32 a9, v243
v_accvgpr_read_b32 v243, a10
v_mul_f32 v243, v243, v98
v_accvgpr_write_b32 a10, v243
v_accvgpr_read_b32 v243, a11
v_mul_f32 v243, v243, v98
v_accvgpr_write_b32 a11, v243
v_accvgpr_read_b32 v243, a12
v_mul_f32 v243, v243, v98
v_accvgpr_write_b32 a12, v243
v_accvgpr_read_b32 v243, a13
v_mul_f32 v243, v243, v98
v_accvgpr_write_b32 a13, v243
v_accvgpr_read_b32 v243, a14
v_mul_f32 v243, v243, v98
v_accvgpr_write_b32 a14, v243
v_accvgpr_read_b32 v243, a15
v_mul_f32 v243, v243, v98
v_accvgpr_write_b32 a15, v243
v_accvgpr_read_b32 v243, a16
v_mul_f32 v243, v243, v98
v_accvgpr_write_b32 a16, v243
v_accvgpr_read_b32 v243, a17
v_mul_f32 v243, v243, v98
v_accvgpr_write_b32 a17, v243
v_accvgpr_read_b32 v243, a18
v_mul_f32 v243, v243, v98
v_accvgpr_write_b32 a18, v243
v_accvgpr_read_b32 v243, a19
v_mul_f32 v243, v243, v98
v_accvgpr_write_b32 a19, v243
v_accvgpr_read_b32 v243, a20
v_mul_f32 v243, v243, v98
v_accvgpr_write_b32 a20, v243
v_accvgpr_read_b32 v243, a21
v_mul_f32 v243, v243, v98
v_accvgpr_write_b32 a21, v243
v_accvgpr_read_b32 v243, a22
v_mul_f32 v243, v243, v98
v_accvgpr_write_b32 a22, v243
v_accvgpr_read_b32 v243, a23
v_mul_f32 v243, v243, v98
v_accvgpr_write_b32 a23, v243
v_accvgpr_read_b32 v243, a24
v_mul_f32 v243, v243, v98
v_accvgpr_write_b32 a24, v243
v_accvgpr_read_b32 v243, a25
v_mul_f32 v243, v243, v98
v_accvgpr_write_b32 a25, v243
v_accvgpr_read_b32 v243, a26
v_mul_f32 v243, v243, v98
v_accvgpr_write_b32 a26, v243
v_accvgpr_read_b32 v243, a27
v_mul_f32 v243, v243, v98
v_accvgpr_write_b32 a27, v243
v_accvgpr_read_b32 v243, a28
v_mul_f32 v243, v243, v98
v_accvgpr_write_b32 a28, v243
v_accvgpr_read_b32 v243, a29
v_mul_f32 v243, v243, v98
v_accvgpr_write_b32 a29, v243
v_accvgpr_read_b32 v243, a30
v_mul_f32 v243, v243, v98
v_accvgpr_write_b32 a30, v243
v_accvgpr_read_b32 v243, a31
v_mul_f32 v243, v243, v98
v_accvgpr_write_b32 a31, v243
v_mov_b32 v242, v97
v_max3_f32 v242, v242, v88, v89
v_max3_f32 v242, v242, v90, v91
v_max3_f32 v242, v242, v92, v93
v_max3_f32 v242, v242, v94, v95
v_max3_f32 v242, v242, v120, v121
v_max3_f32 v242, v242, v122, v123
v_max3_f32 v242, v242, v124, v125
v_max3_f32 v242, v242, v126, v127
v_mov_b32 v243, v242
s_nop 1
v_permlane32_swap_b32 v242, v243
v_max_f32 v242, v242, v243
v_mov_b32 v243, v242
s_nop 1
v_permlane16_swap_b32 v242, v243
v_max_f32 v242, v242, v243
v_sub_f32 v99, v97, v242
v_exp_f32 v99, v99
v_mov_b32 v97, v242
v_sub_f32 v88, v88, v242
v_sub_f32 v89, v89, v242
v_sub_f32 v90, v90, v242
v_sub_f32 v91, v91, v242
v_sub_f32 v92, v92, v242
v_sub_f32 v93, v93, v242
v_sub_f32 v94, v94, v242
v_sub_f32 v95, v95, v242
v_sub_f32 v120, v120, v242
v_sub_f32 v121, v121, v242
v_sub_f32 v122, v122, v242
v_sub_f32 v123, v123, v242
v_sub_f32 v124, v124, v242
v_sub_f32 v125, v125, v242
v_sub_f32 v126, v126, v242
v_sub_f32 v127, v127, v242
v_mul_f32 v3, v3, v99
v_accvgpr_read_b32 v243, a32
v_mul_f32 v243, v243, v99
v_accvgpr_write_b32 a32, v243
v_accvgpr_read_b32 v243, a33
v_mul_f32 v243, v243, v99
v_accvgpr_write_b32 a33, v243
v_accvgpr_read_b32 v243, a34
v_mul_f32 v243, v243, v99
v_accvgpr_write_b32 a34, v243
v_accvgpr_read_b32 v243, a35
v_mul_f32 v243, v243, v99
v_accvgpr_write_b32 a35, v243
v_accvgpr_read_b32 v243, a36
v_mul_f32 v243, v243, v99
v_accvgpr_write_b32 a36, v243
v_accvgpr_read_b32 v243, a37
v_mul_f32 v243, v243, v99
v_accvgpr_write_b32 a37, v243
v_accvgpr_read_b32 v243, a38
v_mul_f32 v243, v243, v99
v_accvgpr_write_b32 a38, v243
v_accvgpr_read_b32 v243, a39
v_mul_f32 v243, v243, v99
v_accvgpr_write_b32 a39, v243
v_accvgpr_read_b32 v243, a40
v_mul_f32 v243, v243, v99
v_accvgpr_write_b32 a40, v243
v_accvgpr_read_b32 v243, a41
v_mul_f32 v243, v243, v99
v_accvgpr_write_b32 a41, v243
v_accvgpr_read_b32 v243, a42
v_mul_f32 v243, v243, v99
v_accvgpr_write_b32 a42, v243
v_accvgpr_read_b32 v243, a43
v_mul_f32 v243, v243, v99
v_accvgpr_write_b32 a43, v243
v_accvgpr_read_b32 v243, a44
v_mul_f32 v243, v243, v99
v_accvgpr_write_b32 a44, v243
v_accvgpr_read_b32 v243, a45
v_mul_f32 v243, v243, v99
v_accvgpr_write_b32 a45, v243
v_accvgpr_read_b32 v243, a46
v_mul_f32 v243, v243, v99
v_accvgpr_write_b32 a46, v243
v_accvgpr_read_b32 v243, a47
v_mul_f32 v243, v243, v99
v_accvgpr_write_b32 a47, v243
v_accvgpr_read_b32 v243, a48
v_mul_f32 v243, v243, v99
v_accvgpr_write_b32 a48, v243
v_accvgpr_read_b32 v243, a49
v_mul_f32 v243, v243, v99
v_accvgpr_write_b32 a49, v243
v_accvgpr_read_b32 v243, a50
v_mul_f32 v243, v243, v99
v_accvgpr_write_b32 a50, v243
v_accvgpr_read_b32 v243, a51
v_mul_f32 v243, v243, v99
v_accvgpr_write_b32 a51, v243
v_accvgpr_read_b32 v243, a52
v_mul_f32 v243, v243, v99
v_accvgpr_write_b32 a52, v243
v_accvgpr_read_b32 v243, a53
v_mul_f32 v243, v243, v99
v_accvgpr_write_b32 a53, v243
v_accvgpr_read_b32 v243, a54
v_mul_f32 v243, v243, v99
v_accvgpr_write_b32 a54, v243
v_accvgpr_read_b32 v243, a55
v_mul_f32 v243, v243, v99
v_accvgpr_write_b32 a55, v243
v_accvgpr_read_b32 v243, a56
v_mul_f32 v243, v243, v99
v_accvgpr_write_b32 a56, v243
v_accvgpr_read_b32 v243, a57
v_mul_f32 v243, v243, v99
v_accvgpr_write_b32 a57, v243
v_accvgpr_read_b32 v243, a58
v_mul_f32 v243, v243, v99
v_accvgpr_write_b32 a58, v243
v_accvgpr_read_b32 v243, a59
v_mul_f32 v243, v243, v99
v_accvgpr_write_b32 a59, v243
v_accvgpr_read_b32 v243, a60
v_mul_f32 v243, v243, v99
v_accvgpr_write_b32 a60, v243
v_accvgpr_read_b32 v243, a61
v_mul_f32 v243, v243, v99
v_accvgpr_write_b32 a61, v243
v_accvgpr_read_b32 v243, a62
v_mul_f32 v243, v243, v99
v_accvgpr_write_b32 a62, v243
v_accvgpr_read_b32 v243, a63
v_mul_f32 v243, v243, v99
v_accvgpr_write_b32 a63, v243
v_exp_f32 v80, v80
v_exp_f32 v81, v81
v_exp_f32 v82, v82
v_add_f32 v2, v2, v80
v_add_f32 v2, v2, v81
v_exp_f32 v83, v83
v_cvt_pk_bf16_f32 v80, v80, v81
v_exp_f32 v84, v84
v_add_f32 v2, v2, v82
v_add_f32 v2, v2, v83
v_exp_f32 v85, v85
v_cvt_pk_bf16_f32 v81, v82, v83
v_exp_f32 v86, v86
v_add_f32 v2, v2, v84
v_add_f32 v2, v2, v85
v_exp_f32 v87, v87
v_cvt_pk_bf16_f32 v82, v84, v85
v_exp_f32 v88, v88
v_add_f32 v2, v2, v86
v_add_f32 v2, v2, v87
v_exp_f32 v89, v89
v_cvt_pk_bf16_f32 v83, v86, v87
v_exp_f32 v90, v90
v_add_f32 v3, v3, v88
v_add_f32 v3, v3, v89
v_exp_f32 v91, v91
v_cvt_pk_bf16_f32 v88, v88, v89
v_exp_f32 v92, v92
v_add_f32 v3, v3, v90
v_add_f32 v3, v3, v91
v_exp_f32 v93, v93
v_cvt_pk_bf16_f32 v89, v90, v91
v_exp_f32 v94, v94
v_add_f32 v3, v3, v92
v_add_f32 v3, v3, v93
v_exp_f32 v95, v95
v_cvt_pk_bf16_f32 v90, v92, v93
v_exp_f32 v112, v112
v_add_f32 v3, v3, v94
v_add_f32 v3, v3, v95
v_exp_f32 v113, v113
v_cvt_pk_bf16_f32 v91, v94, v95
v_exp_f32 v114, v114
v_add_f32 v2, v2, v112
v_add_f32 v2, v2, v113
v_exp_f32 v115, v115
v_cvt_pk_bf16_f32 v112, v112, v113
v_exp_f32 v116, v116
v_add_f32 v2, v2, v114
v_add_f32 v2, v2, v115
v_exp_f32 v117, v117
v_cvt_pk_bf16_f32 v113, v114, v115
v_exp_f32 v118, v118
v_add_f32 v2, v2, v116
v_add_f32 v2, v2, v117
v_exp_f32 v119, v119
v_cvt_pk_bf16_f32 v114, v116, v117
v_exp_f32 v120, v120
v_add_f32 v2, v2, v118
v_add_f32 v2, v2, v119
v_exp_f32 v121, v121
v_cvt_pk_bf16_f32 v115, v118, v119
v_exp_f32 v122, v122
v_add_f32 v3, v3, v120
v_add_f32 v3, v3, v121
v_exp_f32 v123, v123
v_cvt_pk_bf16_f32 v120, v120, v121
v_exp_f32 v124, v124
v_add_f32 v3, v3, v122
v_add_f32 v3, v3, v123
v_exp_f32 v125, v125
v_cvt_pk_bf16_f32 v121, v122, v123
v_exp_f32 v126, v126
v_add_f32 v3, v3, v124
v_add_f32 v3, v3, v125
v_exp_f32 v127, v127
v_cvt_pk_bf16_f32 v122, v124, v125
v_add_f32 v3, v3, v126
v_add_f32 v3, v3, v127
v_cvt_pk_bf16_f32 v123, v126, v127
s_waitcnt lgkmcnt(15)
MA 0,a,192,v,80
MA 32,a,192,v,88
s_waitcnt lgkmcnt(14)
MA 4,a,196,v,80
MA 36,a,196,v,88
s_waitcnt lgkmcnt(13)
MA 8,a,200,v,80
MA 40,a,200,v,88
s_waitcnt lgkmcnt(12)
MA 12,a,204,v,80
MA 44,a,204,v,88
s_waitcnt lgkmcnt(11)
MA 16,a,208,v,80
MA 48,a,208,v,88
s_waitcnt lgkmcnt(10)
MA 20,a,212,v,80
MA 52,a,212,v,88
s_waitcnt lgkmcnt(9)
MA 24,a,216,v,80
MA 56,a,216,v,88
s_waitcnt lgkmcnt(8)
MA 28,a,220,v,80
MA 60,a,220,v,88
s_waitcnt lgkmcnt(7)
MA 0,a,224,v,112
MA 32,a,224,v,120
s_waitcnt lgkmcnt(6)
MA 4,a,228,v,112
MA 36,a,228,v,120
s_waitcnt lgkmcnt(5)
MA 8,a,232,v,112
MA 40,a,232,v,120
s_waitcnt lgkmcnt(4)
MA 12,a,236,v,112
MA 44,a,236,v,120
s_waitcnt lgkmcnt(3)
MA 16,a,240,v,112
MA 48,a,240,v,120
s_waitcnt lgkmcnt(2)
MA 20,a,244,v,112
MA 52,a,244,v,120
s_waitcnt lgkmcnt(1)
MA 24,a,248,v,112
MA 56,a,248,v,120
s_waitcnt lgkmcnt(0)
MA 28,a,252,v,112
MA 60,a,252,v,120
s_add_u32 s71, s71, 16384
s_sub_u32 s72, s72, 64
s_sub_u32 s74, s74, 1
s_nop 15
s_cmp_lg_u32 s74, 0
s_cbranch_scc1 L_fb_tile
v_mov_b32 v240, v2
s_nop 1
v_permlane32_swap_b32 v2, v240
v_add_f32 v2, v2, v240
v_mov_b32 v240, v2
s_nop 1
v_permlane16_swap_b32 v2, v240
v_add_f32 v2, v2, v240
v_mov_b32 v240, v3
s_nop 1
v_permlane32_swap_b32 v3, v240
v_add_f32 v3, v3, v240
v_mov_b32 v240, v3
s_nop 1
v_permlane16_swap_b32 v3, v240
v_add_f32 v3, v3, v240
v_rcp_f32 v2, v2
v_rcp_f32 v3, v3
s_add_u32 s80, s73, 0x20000
s_nop 4
v_accvgpr_read_b32 v240, a0
v_accvgpr_read_b32 v241, a1
v_accvgpr_read_b32 v242, a2
v_accvgpr_read_b32 v243, a3
v_accvgpr_read_b32 v244, a4
v_accvgpr_read_b32 v245, a5
v_accvgpr_read_b32 v246, a6
v_accvgpr_read_b32 v247, a7
v_mul_f32 v240, v240, v2
v_mul_f32 v241, v241, v2
v_mul_f32 v242, v242, v2
v_mul_f32 v243, v243, v2
v_mul_f32 v244, v244, v2
v_mul_f32 v245, v245, v2
v_mul_f32 v246, v246, v2
v_mul_f32 v247, v247, v2
v_cvt_pk_bf16_f32 v248, v240, v241
v_cvt_pk_bf16_f32 v249, v242, v243
v_cvt_pk_bf16_f32 v250, v244, v245
v_cvt_pk_bf16_f32 v251, v246, v247
buffer_store_dwordx4 v[248:251], v15, s[60:63], s73 offen offset:0 sc1
v_accvgpr_read_b32 v240, a8
v_accvgpr_read_b32 v241, a9
v_accvgpr_read_b32 v242, a10
v_accvgpr_read_b32 v243, a11
v_accvgpr_read_b32 v244, a12
v_accvgpr_read_b32 v245, a13
v_accvgpr_read_b32 v246, a14
v_accvgpr_read_b32 v247, a15
v_mul_f32 v240, v240, v2
v_mul_f32 v241, v241, v2
v_mul_f32 v242, v242, v2
v_mul_f32 v243, v243, v2
v_mul_f32 v244, v244, v2
v_mul_f32 v245, v245, v2
v_mul_f32 v246, v246, v2
v_mul_f32 v247, v247, v2
v_cvt_pk_bf16_f32 v252, v240, v241
v_cvt_pk_bf16_f32 v253, v242, v243
v_cvt_pk_bf16_f32 v254, v244, v245
v_cvt_pk_bf16_f32 v255, v246, v247
buffer_store_dwordx4 v[252:255], v15, s[60:63], s73 offen offset:1024 sc1
v_accvgpr_read_b32 v240, a16
v_accvgpr_read_b32 v241, a17
v_accvgpr_read_b32 v242, a18
v_accvgpr_read_b32 v243, a19
v_accvgpr_read_b32 v244, a20
v_accvgpr_read_b32 v245, a21
v_accvgpr_read_b32 v246, a22
v_accvgpr_read_b32 v247, a23
v_mul_f32 v240, v240, v2
v_mul_f32 v241, v241, v2
v_mul_f32 v242, v242, v2
v_mul_f32 v243, v243, v2
v_mul_f32 v244, v244, v2
v_mul_f32 v245, v245, v2
v_mul_f32 v246, v246, v2
v_mul_f32 v247, v247, v2
v_cvt_pk_bf16_f32 v248, v240, v241
v_cvt_pk_bf16_f32 v249, v242, v243
v_cvt_pk_bf16_f32 v250, v244, v245
v_cvt_pk_bf16_f32 v251, v246, v247
buffer_store_dwordx4 v[248:251], v15, s[60:63], s73 offen offset:2048 sc1
v_accvgpr_read_b32 v240, a24
v_accvgpr_read_b32 v241, a25
v_accvgpr_read_b32 v242, a26
v_accvgpr_read_b32 v243, a27
v_accvgpr_read_b32 v244, a28
v_accvgpr_read_b32 v245, a29
v_accvgpr_read_b32 v246, a30
v_accvgpr_read_b32 v247, a31
v_mul_f32 v240, v240, v2
v_mul_f32 v241, v241, v2
v_mul_f32 v242, v242, v2
v_mul_f32 v243, v243, v2
v_mul_f32 v244, v244, v2
v_mul_f32 v245, v245, v2
v_mul_f32 v246, v246, v2
v_mul_f32 v247, v247, v2
v_cvt_pk_bf16_f32 v252, v240, v241
v_cvt_pk_bf16_f32 v253, v242, v243
v_cvt_pk_bf16_f32 v254, v244, v245
v_cvt_pk_bf16_f32 v255, v246, v247
buffer_store_dwordx4 v[252:255], v15, s[60:63], s73 offen offset:3072 sc1
v_accvgpr_read_b32 v240, a32
v_accvgpr_read_b32 v241, a33
v_accvgpr_read_b32 v242, a34
v_accvgpr_read_b32 v243, a35
v_accvgpr_read_b32 v244, a36
v_accvgpr_read_b32 v245, a37
v_accvgpr_read_b32 v246, a38
v_accvgpr_read_b32 v247, a39
v_mul_f32 v240, v240, v3
v_mul_f32 v241, v241, v3
v_mul_f32 v242, v242, v3
v_mul_f32 v243, v243, v3
v_mul_f32 v244, v244, v3
v_mul_f32 v245, v245, v3
v_mul_f32 v246, v246, v3
v_mul_f32 v247, v247, v3
v_cvt_pk_bf16_f32 v248, v240, v241
v_cvt_pk_bf16_f32 v249, v242, v243
v_cvt_pk_bf16_f32 v250, v244, v245
v_cvt_pk_bf16_f32 v251, v246, v247
buffer_store_dwordx4 v[248:251], v15, s[60:63], s80 offen offset:0 sc1
v_accvgpr_read_b32 v240, a40
v_accvgpr_read_b32 v241, a41
v_accvgpr_read_b32 v242, a42
v_accvgpr_read_b32 v243, a43
v_accvgpr_read_b32 v244, a44
v_accvgpr_read_b32 v245, a45
v_accvgpr_read_b32 v246, a46
v_accvgpr_read_b32 v247, a47
v_mul_f32 v240, v240, v3
v_mul_f32 v241, v241, v3
v_mul_f32 v242, v242, v3
v_mul_f32 v243, v243, v3
v_mul_f32 v244, v244, v3
v_mul_f32 v245, v245, v3
v_mul_f32 v246, v246, v3
v_mul_f32 v247, v247, v3
v_cvt_pk_bf16_f32 v252, v240, v241
v_cvt_pk_bf16_f32 v253, v242, v243
v_cvt_pk_bf16_f32 v254, v244, v245
v_cvt_pk_bf16_f32 v255, v246, v247
buffer_store_dwordx4 v[252:255], v15, s[60:63], s80 offen offset:1024 sc1
v_accvgpr_read_b32 v240, a48
v_accvgpr_read_b32 v241, a49
v_accvgpr_read_b32 v242, a50
v_accvgpr_read_b32 v243, a51
v_accvgpr_read_b32 v244, a52
v_accvgpr_read_b32 v245, a53
v_accvgpr_read_b32 v246, a54
v_accvgpr_read_b32 v247, a55
v_mul_f32 v240, v240, v3
v_mul_f32 v241, v241, v3
v_mul_f32 v242, v242, v3
v_mul_f32 v243, v243, v3
v_mul_f32 v244, v244, v3
v_mul_f32 v245, v245, v3
v_mul_f32 v246, v246, v3
v_mul_f32 v247, v247, v3
v_cvt_pk_bf16_f32 v248, v240, v241
v_cvt_pk_bf16_f32 v249, v242, v243
v_cvt_pk_bf16_f32 v250, v244, v245
v_cvt_pk_bf16_f32 v251, v246, v247
buffer_store_dwordx4 v[248:251], v15, s[60:63], s80 offen offset:2048 sc1
v_accvgpr_read_b32 v240, a56
v_accvgpr_read_b32 v241, a57
v_accvgpr_read_b32 v242, a58
v_accvgpr_read_b32 v243, a59
v_accvgpr_read_b32 v244, a60
v_accvgpr_read_b32 v245, a61
v_accvgpr_read_b32 v246, a62
v_accvgpr_read_b32 v247, a63
v_mul_f32 v240, v240, v3
v_mul_f32 v241, v241, v3
v_mul_f32 v242, v242, v3
v_mul_f32 v243, v243, v3
v_mul_f32 v244, v244, v3
v_mul_f32 v245, v245, v3
v_mul_f32 v246, v246, v3
v_mul_f32 v247, v247, v3
v_cvt_pk_bf16_f32 v252, v240, v241
v_cvt_pk_bf16_f32 v253, v242, v243
v_cvt_pk_bf16_f32 v254, v244, v245
v_cvt_pk_bf16_f32 v255, v246, v247
buffer_store_dwordx4 v[252:255], v15, s[60:63], s80 offen offset:3072 sc1
s_cmp_lg_u32 s81, 0
s_cbranch_scc1 L_fb_done
s_mov_b32 s81, 1
s_sub_u32 s74, 34, s77
s_mov_b32 s73, s101
s_mov_b32 s72, s70
v_mov_b32 v16, v48
v_mov_b32 v17, v49
v_mov_b32 v18, v50
v_mov_b32 v19, v51
v_mov_b32 v20, v52
v_mov_b32 v21, v53
v_mov_b32 v22, v54
v_mov_b32 v23, v55
v_mov_b32 v24, v56
v_mov_b32 v25, v57
v_mov_b32 v26, v58
v_mov_b32 v27, v59
v_mov_b32 v28, v60
v_mov_b32 v29, v61
v_mov_b32 v30, v62
v_mov_b32 v31, v63
v_mov_b32 v32, v64
v_mov_b32 v33, v65
v_mov_b32 v34, v66
v_mov_b32 v35, v67
v_mov_b32 v36, v68
v_mov_b32 v37, v69
v_mov_b32 v38, v70
v_mov_b32 v39, v71
v_mov_b32 v40, v72
v_mov_b32 v41, v73
v_mov_b32 v42, v74
v_mov_b32 v43, v75
v_mov_b32 v44, v76
v_mov_b32 v45, v77
v_mov_b32 v46, v78
v_mov_b32 v47, v79
s_branch L_fb_set
L_fb_done:
s_waitcnt vmcnt(0) lgkmcnt(0)
s_barrier
s_load_dwordx2 s[88:89], s[0:1], 104
s_mul_i32 s36, s3, 16640
v_and_b32 v16, 15, v1
v_lshrrev_b32 v17, 4, v1
v_add_u32 v18, 13, v16
v_and_b32 v19, 3, v18
v_cmp_eq_u32 vcc, 0, v19
v_lshrrev_b32 v18, 2, v18
v_mul_u32_u24 v19, 4160, v19
v_cndmask_b32 v19, v19, 8, vcc
v_lshl_add_u32 v19, v18, 3, v19
v_lshl_add_u32 v19, v17, 4, v19
v_add_u32 v4, s36, v19
v_add_u32 v10, s36, v232
v_lshlrev_b32 v18, 5, v16
v_lshlrev_b32 v19, 4, v17
v_sub_u32 v19, v19, v18
s_add_u32 s37, s43, 480
v_add_u32 v5, s37, v19
v_mul_u32_u24 v18, 136, v16
v_lshl_add_u32 v18, v17, 5, v18
s_lshl_b32 s37, s3, 1
s_add_u32 s37, s37, 49152
v_add_u32 v11, s37, v18
v_lshrrev_b32 v18, 3, v1
v_mul_u32_u24 v18, 136, v18
v_and_b32 v19, 7, v1
v_lshl_add_u32 v18, v19, 4, v18
s_mul_i32 s37, s3, 4352
s_add_u32 s37, s37, 49152
v_add_u32 v12, s37, v18
s_lshl_b32 s37, s3, 12
v_add_u32 v13, s37, v232
v_lshl_add_u32 v18, v17, 3, v16
v_sub_u32 v235, 15, v18
v_mov_b32 v20, 0
v_mov_b32 v21, 0
v_mov_b32 v22, 0
v_mov_b32 v23, 0
v_and_b32 v16, 3, v1
v_mul_u32_u24 v16, 4160, v16
v_lshrrev_b32 v17, 2, v1
v_min_u32 v17, 3, v17
v_lshl_add_u32 v16, v17, 4, v16
v_add_u32 v16, s36, v16
ds_write_b128 v16, v[20:23]
v_and_b32 v17, 31, v1
v_lshlrev_b32 v17, 4, v17
v_add_u32 v17, s43, v17
ds_write_b128 v17, v[20:23] offset:4096
v_alignbit_b32 v24, v209, v208, 16
v_alignbit_b32 v25, v210, v209, 16
v_alignbit_b32 v26, v211, v210, 16
v_alignbit_b32 v27, v212, v211, 16
v_alignbit_b32 v28, v213, v212, 16
ds_write_b128 v10, v[210:213] offset:64
ds_write_b128 v10, v[24:27] offset:4208
v_mov_b32 v16, v209
v_mov_b32 v17, v210
v_mov_b32 v18, v211
v_mov_b32 v19, v212
ds_write_b128 v10, v[16:19] offset:8368
v_mov_b32 v16, v25
v_mov_b32 v17, v26
v_mov_b32 v18, v27
v_mov_b32 v19, v28
ds_write_b128 v10, v[16:19] offset:12528
v_alignbit_b32 v30, v215, v214, 16
v_alignbit_b32 v31, v216, v215, 16
v_alignbit_b32 v32, v217, v216, 16
v_alignbit_b32 v33, v218, v217, 16
v_alignbit_b32 v34, v219, v218, 16
ds_write_b128 v10, v[216:219] offset:1088
ds_write_b128 v10, v[30:33] offset:5232
v_mov_b32 v16, v215
v_mov_b32 v17, v216
v_mov_b32 v18, v217
v_mov_b32 v19, v218
ds_write_b128 v10, v[16:19] offset:9392
v_mov_b32 v16, v31
v_mov_b32 v17, v32
v_mov_b32 v18, v33
v_mov_b32 v19, v34
ds_write_b128 v10, v[16:19] offset:13552
v_alignbit_b32 v24, v221, v220, 16
v_alignbit_b32 v25, v222, v221, 16
v_alignbit_b32 v26, v223, v222, 16
v_alignbit_b32 v27, v224, v223, 16
v_alignbit_b32 v28, v225, v224, 16
ds_write_b128 v10, v[222:225] offset:2112
ds_write_b128 v10, v[24:27] offset:6256
v_mov_b32 v16, v221
v_mov_b32 v17, v222
v_mov_b32 v18, v223
v_mov_b32 v19, v224
ds_write_b128 v10, v[16:19] offset:10416
v_mov_b32 v16, v25
v_mov_b32 v17, v26
v_mov_b32 v18, v27
v_mov_b32 v19, v28
ds_write_b128 v10, v[16:19] offset:14576
v_alignbit_b32 v30, v227, v226, 16
v_alignbit_b32 v31, v228, v227, 16
v_alignbit_b32 v32, v229, v228, 16
v_alignbit_b32 v33, v230, v229, 16
v_alignbit_b32 v34, v231, v230, 16
ds_write_b128 v10, v[228:231] offset:3136
ds_write_b128 v10, v[30:33] offset:7280
v_mov_b32 v16, v227
v_mov_b32 v17, v228
v_mov_b32 v18, v229
v_mov_b32 v19, v230
ds_write_b128 v10, v[16:19] offset:11440
v_mov_b32 v16, v31
v_mov_b32 v17, v32
v_mov_b32 v18, v33
v_mov_b32 v19, v34
ds_write_b128 v10, v[16:19] offset:15600
v_lshlrev_b32 v16, 16, v234
v_cmp_eq_u32 vcc, 0, v235
s_nop 1
v_cndmask_b32 v44, 0, v234, vcc
v_cmp_eq_u32 vcc, 1, v235
s_nop 1
v_cndmask_b32 v44, v44, v16, vcc
v_cmp_eq_u32 vcc, 2, v235
s_nop 1
v_cndmask_b32 v45, 0, v234, vcc
v_cmp_eq_u32 vcc, 3, v235
s_nop 1
v_cndmask_b32 v45, v45, v16, vcc
v_cmp_eq_u32 vcc, 4, v235
s_nop 1
v_cndmask_b32 v46, 0, v234, vcc
v_cmp_eq_u32 vcc, 5, v235
s_nop 1
v_cndmask_b32 v46, v46, v16, vcc
v_cmp_eq_u32 vcc, 6, v235
s_nop 1
v_cndmask_b32 v47, 0, v234, vcc
v_cmp_eq_u32 vcc, 7, v235
s_nop 1
v_cndmask_b32 v47, v47, v16, vcc
s_waitcnt lgkmcnt(0)
s_branch L_p3_done
L_spin_go:
s_mov_b32 s36, 400000
L_spin_go_l:
s_sleep 1
buffer_load_dword v254, off, s[12:15], 0 sc1
s_waitcnt vmcnt(0)
v_cmp_gt_u32 vcc, 1, v254
s_nop 4
s_cbranch_vccz L_spin_go_ret
s_sub_u32 s36, s36, 1
s_cmp_lg_u32 s36, 0
s_cbranch_scc1 L_spin_go_l
s_branch L_spin_go_ret
L_spin_f1:
s_mov_b32 s36, 400000
L_spin_f1_l:
s_sleep 1
buffer_load_dword v237, v233, s[8:11], 0 offen offset:0 sc1
s_waitcnt vmcnt(0)
v_cmp_gt_u32 vcc, 1, v237
s_nop 4
s_cbranch_vccz L_spin_f1_ret
s_sub_u32 s36, s36, 1
s_cmp_lg_u32 s36, 0
s_cbranch_scc1 L_spin_f1_l
s_branch L_spin_f1_ret
L_spin_w:
s_mov_b32 s36, 400000
L_spin_w_l:
s_sleep 1
buffer_load_dword v253, v254, s[8:11], 0 offen offset:1024 sc1
s_waitcnt vmcnt(0)
v_cmp_gt_u32 vcc, 1, v253
s_nop 4
s_cbranch_vccz L_spin_w_ret
s_sub_u32 s36, s36, 1
s_cmp_lg_u32 s36, 0
s_cbranch_scc1 L_spin_w_l
s_branch L_spin_w_ret
L_spin_f2:
s_mov_b32 s36, 400000
L_spin_f2_l:
s_sleep 1
buffer_load_dword v253, v252, s[8:11], 0 offen sc1
s_waitcnt vmcnt(0)
v_cmp_gt_u32 vcc, 1, v253
s_nop 4
s_cbranch_vccz L_spin_f2_ret
s_sub_u32 s36, s36, 1
s_cmp_lg_u32 s36, 0
s_cbranch_scc1 L_spin_f2_l
s_branch L_spin_f2_ret
L_spin_f3:
s_mov_b32 s36, 400000
L_spin_f3_l:
s_sleep 1
buffer_load_dword v253, v254, s[8:11], 0 offen offset:2048 sc1
s_waitcnt vmcnt(0)
v_cmp_gt_u32 vcc, 1, v253
s_nop 4
s_cbranch_vccz L_spin_f3_ret
s_sub_u32 s36, s36, 1
s_cmp_lg_u32 s36, 0
s_cbranch_scc1 L_spin_f3_l
s_branch L_spin_f3_ret
L_code_end:
s_endpgm
.section .rodata,"a"
.p2align 6
.amdhsa_kernel gated_mix__ssm_conv_h3__compressed_kv_cla__prompt_kernel
  .amdhsa_next_free_vgpr 512
  .amdhsa_next_free_sgpr 102
  .amdhsa_accum_offset 256
  .amdhsa_group_segment_fixed_size 0
  .amdhsa_kernarg_size 128
  .amdhsa_user_sgpr_count 2
  .amdhsa_user_sgpr_kernarg_segment_ptr 1
  .amdhsa_system_sgpr_workgroup_id_x 1
  .amdhsa_float_denorm_mode_32 3
.end_amdhsa_kernel
.text
```

```asm
; @launch grid=(256,1,1) block=(256,1,1) lds=163840
.amdgcn_target "amdgcn-amd-amdhsa--gfx950"
.text
.macro MA d,x,a,y,b
v_mfma_f32_16x16x32_bf16 a[\d:\d+3], \x[\a:\a+3], \y[\b:\b+3], a[\d:\d+3]
.endm
.macro MV d,x,a,y,b
v_mfma_f32_16x16x32_bf16 v[\d:\d+3], \x[\a:\a+3], \y[\b:\b+3], v[\d:\d+3]
.endm
.macro TR d,a,o
ds_read_b64_tr_b16 v[\d:\d+1], v\a offset:\o
.endm
.globl gated_mix__ssm_conv_h3__compressed_kv_cla__prompt_kernel
.p2align 8
.type gated_mix__ssm_conv_h3__compressed_kv_cla__prompt_kernel,@function
gated_mix__ssm_conv_h3__compressed_kv_cla__prompt_kernel:
s_cmp_ge_u32 s2, 256
s_cbranch_scc1 L_end
s_load_dwordx2 s[44:45], s[0:1], 56
s_load_dwordx4 s[48:51], s[0:1], 72
s_load_dwordx2 s[40:41], s[0:1], 120
s_load_dwordx2 s[52:53], s[0:1], 112
s_load_dwordx2 s[32:33], s[0:1], 0
s_load_dwordx2 s[34:35], s[0:1], 64
v_lshrrev_b32 v2, 6, v0
v_and_b32 v1, 63, v0
v_lshlrev_b32 v3, 4, v0
v_readfirstlane_b32 s3, v2
s_and_b32 s36, s2, 7
s_lshr_b32 s37, s2, 3
s_and_b32 s38, s37, 7
s_lshr_b32 s37, s37, 3
s_lshr_b32 s42, s37, 1
s_and_b32 s37, s37, 1
s_lshl_b32 s36, s36, 1
s_add_u32 s36, s36, s37
s_lshl_b32 s24, s38, 18
s_lshl_b32 s39, s3, 16
s_add_u32 s24, s24, s39
s_lshl_b32 s25, s3, 17
s_lshl_b32 s39, s36, 9
s_add_u32 s25, s25, s39
s_and_b32 s20, s2, 7
s_lshl_b32 s21, s20, 19
s_lshl_b32 s20, s20, 7
s_lshl_b32 s22, s3, 13
s_add_u32 s23, s22, 98304
v_lshrrev_b32 v204, 3, v1
v_lshlrev_b32 v204, 10, v204
v_lshrrev_b32 v205, 4, v1
v_and_b32 v206, 7, v1
v_xor_b32 v206, v206, v205
v_lshl_add_u32 v204, v206, 4, v204
v_xor_b32 v207, 64, v204
v_add_u32 v176, 0, v204
v_add_u32 v177, 7168, v207
v_add_u32 v178, 14336, v204
v_add_u32 v179, 21504, v207
v_add_u32 v180, 32768, v204
v_add_u32 v181, 39936, v207
v_add_u32 v182, 47104, v204
v_add_u32 v183, 54272, v207
v_lshrrev_b32 v204, 5, v1
v_and_b32 v206, 31, v1
v_lshlrev_b32 v207, 1, v204
v_xor_b32 v206, v206, v207
v_lshlrev_b32 v204, 13, v204
v_xor_b32 v207, 0, v206
v_lshl_add_u32 v207, v207, 4, v204
v_add_u32 v184, 0, v207
v_xor_b32 v207, 4, v206
v_lshl_add_u32 v207, v207, 4, v204
v_add_u32 v185, 15360, v207
v_xor_b32 v207, 0, v206
v_lshl_add_u32 v207, v207, 4, v204
v_add_u32 v186, 30720, v207
v_xor_b32 v207, 4, v206
v_lshl_add_u32 v207, v207, 4, v204
v_add_u32 v187, 46080, v207
v_xor_b32 v207, 8, v206
v_lshl_add_u32 v207, v207, 4, v204
v_add_u32 v188, 65536, v207
v_xor_b32 v207, 12, v206
v_lshl_add_u32 v207, v207, 4, v204
v_add_u32 v189, 80896, v207
v_xor_b32 v207, 8, v206
v_lshl_add_u32 v207, v207, 4, v204
v_add_u32 v190, 96256, v207
v_xor_b32 v207, 12, v206
v_lshl_add_u32 v207, v207, 4, v204
v_add_u32 v191, 111616, v207
s_waitcnt lgkmcnt(0)
s_add_u32 s8, s44, s24
s_addc_u32 s9, s45, 0
s_mov_b32 s10, 65536
s_mov_b32 s11, 0x20000
s_cmp_eq_u32 s42, 0
s_cselect_b32 s12, s48, s50
s_cselect_b32 s13, s49, s51
s_add_u32 s12, s12, s25
s_addc_u32 s13, s13, 0
s_sub_u32 s14, 4194304, s25
s_mov_b32 s15, 0x20000
s_add_u32 s4, s40, 59768832
s_addc_u32 s5, s41, 0
s_mov_b32 s6, 8192
s_mov_b32 s7, 0x20000
s_lshl_b32 s43, s2, 20
v_add_u32 v3, s43, v3
v_mov_b32 v4, 0
v_mov_b32 v5, 0
v_mov_b32 v6, 0
v_mov_b32 v7, 0
s_movk_i32 s43, 4096
buffer_store_dwordx4 v[4:7], v3, s[4:7], 0 offen sc1
buffer_store_dwordx4 v[4:7], v3, s[4:7], s43 offen sc1
v_lshlrev_b32 v79, 16, v3
s_add_u32 m0, s23, 0
s_nop 0
buffer_load_dwordx4 v184, s[12:15], s21 offen offset:0 lds
buffer_load_dwordx4 v185, s[12:15], s21 offen offset:1024 lds
buffer_load_dwordx4 v186, s[12:15], s21 offen offset:2048 lds
buffer_load_dwordx4 v187, s[12:15], s21 offen offset:3072 lds
s_add_u32 m0, s23, 4096
s_nop 0
buffer_load_dwordx4 v188, s[12:15], s21 offen offset:0 lds
buffer_load_dwordx4 v189, s[12:15], s21 offen offset:1024 lds
buffer_load_dwordx4 v190, s[12:15], s21 offen offset:2048 lds
buffer_load_dwordx4 v191, s[12:15], s21 offen offset:3072 lds
s_add_u32 s21, s21, 524288
s_and_b32 s21, s21, 4194303
s_add_u32 m0, s22, 0
s_nop 0
buffer_load_dwordx4 v176, s[8:11], s20 offen offset:0 lds
buffer_load_dwordx4 v177, s[8:11], s20 offen offset:1024 lds
buffer_load_dwordx4 v178, s[8:11], s20 offen offset:2048 lds
buffer_load_dwordx4 v179, s[8:11], s20 offen offset:3072 lds
s_add_u32 m0, s22, 4096
s_nop 0
buffer_load_dwordx4 v180, s[8:11], s20 offen offset:0 lds
buffer_load_dwordx4 v181, s[8:11], s20 offen offset:1024 lds
buffer_load_dwordx4 v182, s[8:11], s20 offen offset:2048 lds
buffer_load_dwordx4 v183, s[8:11], s20 offen offset:3072 lds
s_add_u32 s20, s20, 128
s_and_b32 s20, s20, 1023
v_and_b32 v204, 15, v1
v_lshrrev_b32 v206, 1, v204
v_xor_b32 v206, v206, v205
v_lshlrev_b32 v206, 4, v206
v_lshl_add_u32 v206, v204, 7, v206
s_and_b32 s39, s3, 1
s_lshl_b32 s39, s39, 14
v_add_u32 v192, s39, v206
v_xor_b32 v193, 64, v192
v_add_u32 v194, 0x10000, v192
v_add_u32 v195, 0x10000, v193
v_bfe_u32 v204, v1, 2, 2
v_and_b32 v206, 1, v205
v_lshl_or_b32 v206, v206, 2, v204
v_lshl_add_u32 v204, v205, 3, v204
v_lshlrev_b32 v204, 9, v204
v_and_b32 v207, 3, v1
v_lshl_add_u32 v204, v207, 3, v204
s_lshr_b32 s39, s3, 1
s_lshl_b32 s39, s39, 8
s_add_u32 s39, s39, 98304
v_add_u32 v204, s39, v204
v_xor_b32 v207, 0, v206
v_lshl_add_u32 v196, v207, 5, v204
v_xor_b32 v207, 1, v206
v_lshl_add_u32 v197, v207, 5, v204
v_xor_b32 v207, 2, v206
v_lshl_add_u32 v198, v207, 5, v204
v_xor_b32 v207, 3, v206
v_lshl_add_u32 v199, v207, 5, v204
v_xor_b32 v207, 4, v206
v_lshl_add_u32 v200, v207, 5, v204
v_xor_b32 v207, 5, v206
v_lshl_add_u32 v201, v207, 5, v204
v_xor_b32 v207, 6, v206
v_lshl_add_u32 v202, v207, 5, v204
v_xor_b32 v207, 7, v206
v_lshl_add_u32 v203, v207, 5, v204
s_lshl_b32 s36, s36, 1
s_lshr_b32 s39, s3, 1
s_add_u32 s36, s36, s39
s_lshl_b32 s24, s36, 19
s_lshl_b32 s38, s38, 16
s_add_u32 s24, s24, s38
s_and_b32 s39, s3, 1
s_lshl_b32 s39, s39, 15
s_add_u32 s24, s24, s39
s_lshl_b32 s36, s42, 24
s_add_u32 s16, s40, s36
s_addc_u32 s17, s41, 0
s_mov_b32 s18, 16777216
s_mov_b32 s19, 0x20000
s_mov_b32 s54, 256
s_mov_b32 s55, 0x20000
v_mov_b32 v78, 1
s_cmp_lg_u32 s2, 0
s_cselect_b32 s43, 0x10000000, 0
v_or_b32 v79, s43, v79
s_waitcnt vmcnt(0)
s_barrier
buffer_store_dword v78, v79, s[52:55], 0 offen sc1
ds_read_b128 v[80:83], v192 offset:0
ds_read_b128 v[84:87], v192 offset:2048
ds_read_b128 v[88:91], v192 offset:4096
ds_read_b128 v[92:95], v192 offset:6144
ds_read_b128 v[96:99], v192 offset:8192
ds_read_b128 v[100:103], v192 offset:10240
ds_read_b128 v[104:107], v192 offset:12288
ds_read_b128 v[108:111], v192 offset:14336
TR 144,196,0
TR 146,196,2048
TR 148,197,0
TR 150,197,2048
TR 152,198,0
TR 154,198,2048
TR 156,199,0
TR 158,199,2048
TR 160,200,0
TR 162,200,2048
TR 164,201,0
TR 166,201,2048
TR 168,202,0
TR 170,202,2048
TR 172,203,0
TR 174,203,2048
s_cmp_eq_u32 s42, 0
s_cbranch_scc0 L_p1_V
s_waitcnt lgkmcnt(14)
v_mfma_f32_16x16x32_bf16 a[0:3], v[144:147], v[80:83], 0
s_add_u32 m0, s23, 32768
v_lshlrev_b32 v74, 7, v1
v_mfma_f32_16x16x32_bf16 a[32:35], v[144:147], v[84:87], 0
ds_read_b128 v[112:115], v193 offset:0
v_mfma_f32_16x16x32_bf16 a[64:67], v[144:147], v[88:91], 0
buffer_load_dwordx4 v184, s[12:15], s21 offen offset:0 lds
v_mfma_f32_16x16x32_bf16 a[96:99], v[144:147], v[92:95], 0
v_mfma_f32_16x16x32_bf16 a[128:131], v[144:147], v[96:99], 0
s_getpc_b64 s[4:5]
L_pcK:
v_mfma_f32_16x16x32_bf16 a[160:163], v[144:147], v[100:103], 0
buffer_load_dwordx4 v185, s[12:15], s21 offen offset:1024 lds
v_mfma_f32_16x16x32_bf16 a[192:195], v[144:147], v[104:107], 0
v_mfma_f32_16x16x32_bf16 a[224:227], v[144:147], v[108:111], 0
TR 144,196,16384
TR 146,196,18432
s_waitcnt lgkmcnt(15)
v_mfma_f32_16x16x32_bf16 a[4:7], v[148:151], v[80:83], 0
ds_read_b128 v[116:119], v193 offset:2048
buffer_load_dwordx4 v186, s[12:15], s21 offen offset:2048 lds
v_mfma_f32_16x16x32_bf16 a[36:39], v[148:151], v[84:87], 0
s_lshr_b32 s98, s2, 3
v_mfma_f32_16x16x32_bf16 a[68:71], v[148:151], v[88:91], 0
buffer_load_dwordx4 v187, s[12:15], s21 offen offset:3072 lds
v_mfma_f32_16x16x32_bf16 a[100:103], v[148:151], v[92:95], 0
v_mfma_f32_16x16x32_bf16 a[132:135], v[148:151], v[96:99], 0
s_add_u32 m0, s23, 36864
s_lshl_b32 s98, s98, 2
v_mfma_f32_16x16x32_bf16 a[164:167], v[148:151], v[100:103], 0
ds_read_b128 v[120:123], v193 offset:4096
v_mfma_f32_16x16x32_bf16 a[196:199], v[148:151], v[104:107], 0
v_mfma_f32_16x16x32_bf16 a[228:231], v[148:151], v[108:111], 0
TR 148,197,16384
TR 150,197,18432
s_waitcnt lgkmcnt(15)
v_mfma_f32_16x16x32_bf16 a[8:11], v[152:155], v[80:83], 0
buffer_load_dwordx4 v188, s[12:15], s21 offen offset:0 lds
s_add_u32 s98, s98, s3
v_mfma_f32_16x16x32_bf16 a[40:43], v[152:155], v[84:87], 0
v_mfma_f32_16x16x32_bf16 a[72:75], v[152:155], v[88:91], 0
buffer_load_dwordx4 v189, s[12:15], s21 offen offset:1024 lds
v_mfma_f32_16x16x32_bf16 a[104:107], v[152:155], v[92:95], 0
v_mfma_f32_16x16x32_bf16 a[136:139], v[152:155], v[96:99], 0
ds_read_b128 v[124:127], v193 offset:6144
buffer_load_dwordx4 v190, s[12:15], s21 offen offset:2048 lds
v_mfma_f32_16x16x32_bf16 a[168:171], v[152:155], v[100:103], 0
s_lshl_b32 s98, s98, 10
v_mfma_f32_16x16x32_bf16 a[200:203], v[152:155], v[104:107], 0
v_mfma_f32_16x16x32_bf16 a[232:235], v[152:155], v[108:111], 0
TR 152,198,16384
TR 154,198,18432
v_mfma_f32_16x16x32_bf16 a[12:15], v[156:159], v[80:83], 0
buffer_load_dwordx4 v191, s[12:15], s21 offen offset:3072 lds
v_and_b32 v75, 0x380, v74
v_mfma_f32_16x16x32_bf16 a[44:47], v[156:159], v[84:87], 0
s_add_u32 s21, s21, 524288
v_mfma_f32_16x16x32_bf16 a[76:79], v[156:159], v[88:91], 0
ds_read_b128 v[128:131], v193 offset:8192
v_mfma_f32_16x16x32_bf16 a[108:111], v[156:159], v[92:95], 0
v_mfma_f32_16x16x32_bf16 a[140:143], v[156:159], v[96:99], 0
s_and_b32 s21, s21, 4194303
v_add_u32 v75, s98, v75
v_mfma_f32_16x16x32_bf16 a[172:175], v[156:159], v[100:103], 0
v_mfma_f32_16x16x32_bf16 a[204:207], v[156:159], v[104:107], 0
v_mfma_f32_16x16x32_bf16 a[236:239], v[156:159], v[108:111], 0
TR 156,199,16384
TR 158,199,18432
s_waitcnt lgkmcnt(15)
v_mfma_f32_16x16x32_bf16 a[16:19], v[160:163], v[80:83], 0
ds_read_b128 v[132:135], v193 offset:10240
s_add_u32 m0, s22, 32768
v_mfma_f32_16x16x32_bf16 a[48:51], v[160:163], v[84:87], 0
buffer_load_dwordx4 v176, s[8:11], s20 offen offset:0 lds
v_min_u32 v75, L_code_end - L_pcK - 4, v75
v_mfma_f32_16x16x32_bf16 a[80:83], v[160:163], v[88:91], 0
v_mfma_f32_16x16x32_bf16 a[112:115], v[160:163], v[92:95], 0
v_mfma_f32_16x16x32_bf16 a[144:147], v[160:163], v[96:99], 0
buffer_load_dwordx4 v177, s[8:11], s20 offen offset:1024 lds
v_mfma_f32_16x16x32_bf16 a[176:179], v[160:163], v[100:103], 0
v_mov_b32 v77, s5
v_mfma_f32_16x16x32_bf16 a[208:211], v[160:163], v[104:107], 0
buffer_load_dwordx4 v178, s[8:11], s20 offen offset:2048 lds
v_mfma_f32_16x16x32_bf16 a[240:243], v[160:163], v[108:111], 0
TR 160,200,16384
TR 162,200,18432
v_mfma_f32_16x16x32_bf16 a[20:23], v[164:167], v[80:83], 0
ds_read_b128 v[136:139], v193 offset:12288
v_mfma_f32_16x16x32_bf16 a[52:55], v[164:167], v[84:87], 0
buffer_load_dwordx4 v179, s[8:11], s20 offen offset:3072 lds
v_mfma_f32_16x16x32_bf16 a[84:87], v[164:167], v[88:91], 0
v_add_co_u32 v76, vcc, s4, v75
s_nop 1
v_addc_co_u32 v77, vcc, 0, v77, vcc
v_mfma_f32_16x16x32_bf16 a[116:119], v[164:167], v[92:95], 0
s_add_u32 m0, s22, 36864
v_mfma_f32_16x16x32_bf16 a[148:151], v[164:167], v[96:99], 0
v_mfma_f32_16x16x32_bf16 a[180:183], v[164:167], v[100:103], 0
ds_read_b128 v[140:143], v193 offset:14336
v_mfma_f32_16x16x32_bf16 a[212:215], v[164:167], v[104:107], 0
buffer_load_dwordx4 v180, s[8:11], s20 offen offset:0 lds
v_mfma_f32_16x16x32_bf16 a[244:247], v[164:167], v[108:111], 0
TR 164,201,16384
TR 166,201,18432
v_mfma_f32_16x16x32_bf16 a[24:27], v[168:171], v[80:83], 0
v_mfma_f32_16x16x32_bf16 a[56:59], v[168:171], v[84:87], 0
buffer_load_dwordx4 v181, s[8:11], s20 offen offset:1024 lds
v_mfma_f32_16x16x32_bf16 a[88:91], v[168:171], v[88:91], 0
v_mfma_f32_16x16x32_bf16 a[120:123], v[168:171], v[92:95], 0
buffer_load_dwordx4 v182, s[8:11], s20 offen offset:2048 lds
v_mfma_f32_16x16x32_bf16 a[152:155], v[168:171], v[96:99], 0
v_mfma_f32_16x16x32_bf16 a[184:187], v[168:171], v[100:103], 0
v_mfma_f32_16x16x32_bf16 a[216:219], v[168:171], v[104:107], 0
buffer_load_dwordx4 v183, s[8:11], s20 offen offset:3072 lds
v_mfma_f32_16x16x32_bf16 a[248:251], v[168:171], v[108:111], 0
TR 168,202,16384
TR 170,202,18432
s_waitcnt lgkmcnt(15)
v_mfma_f32_16x16x32_bf16 a[28:31], v[172:175], v[80:83], 0
s_add_u32 s20, s20, 128
v_mfma_f32_16x16x32_bf16 a[60:63], v[172:175], v[84:87], 0
global_load_dword v79, v[76:77], off
v_mfma_f32_16x16x32_bf16 a[92:95], v[172:175], v[88:91], 0
v_mfma_f32_16x16x32_bf16 a[124:127], v[172:175], v[92:95], 0
s_and_b32 s20, s20, 1023
v_mfma_f32_16x16x32_bf16 a[156:159], v[172:175], v[96:99], 0
v_mfma_f32_16x16x32_bf16 a[188:191], v[172:175], v[100:103], 0
v_mfma_f32_16x16x32_bf16 a[220:223], v[172:175], v[104:107], 0
v_mfma_f32_16x16x32_bf16 a[252:255], v[172:175], v[108:111], 0
TR 172,203,16384
TR 174,203,18432
s_waitcnt lgkmcnt(2)
MA 0,v,144,v,112
s_add_u32 m0, s22, 65536
MA 32,v,144,v,116
MA 64,v,144,v,120
MA 96,v,144,v,124
buffer_load_dwordx4 v176, s[8:11], s20 offen offset:0 lds
MA 128,v,144,v,128
MA 160,v,144,v,132
MA 192,v,144,v,136
MA 224,v,144,v,140
buffer_load_dwordx4 v177, s[8:11], s20 offen offset:1024 lds
MA 4,v,148,v,112
MA 36,v,148,v,116
MA 68,v,148,v,120
buffer_load_dwordx4 v178, s[8:11], s20 offen offset:2048 lds
MA 100,v,148,v,124
MA 132,v,148,v,128
MA 164,v,148,v,132
MA 196,v,148,v,136
buffer_load_dwordx4 v179, s[8:11], s20 offen offset:3072 lds
MA 228,v,148,v,140
MA 8,v,152,v,112
MA 40,v,152,v,116
s_add_u32 m0, s22, 69632
MA 72,v,152,v,120
MA 104,v,152,v,124
MA 136,v,152,v,128
MA 168,v,152,v,132
buffer_load_dwordx4 v180, s[8:11], s20 offen offset:0 lds
MA 200,v,152,v,136
MA 232,v,152,v,140
MA 12,v,156,v,112
MA 44,v,156,v,116
buffer_load_dwordx4 v181, s[8:11], s20 offen offset:1024 lds
MA 76,v,156,v,120
MA 108,v,156,v,124
MA 140,v,156,v,128
buffer_load_dwordx4 v182, s[8:11], s20 offen offset:2048 lds
MA 172,v,156,v,132
MA 204,v,156,v,136
MA 236,v,156,v,140
MA 16,v,160,v,112
buffer_load_dwordx4 v183, s[8:11], s20 offen offset:3072 lds
MA 48,v,160,v,116
MA 80,v,160,v,120
MA 112,v,160,v,124
s_add_u32 s20, s20, 128
MA 144,v,160,v,128
MA 176,v,160,v,132
MA 208,v,160,v,136
MA 240,v,160,v,140
s_and_b32 s20, s20, 1023
MA 20,v,164,v,112
MA 52,v,164,v,116
MA 84,v,164,v,120
MA 116,v,164,v,124
MA 148,v,164,v,128
s_waitcnt vmcnt(9) lgkmcnt(0)
s_barrier
MA 180,v,164,v,132
TR 144,196,32768
TR 146,196,34816
MA 212,v,164,v,136
ds_read_b128 v[80:83], v192 offset:32768
s_add_u32 m0, s23, 0
MA 244,v,164,v,140
TR 148,197,32768
TR 150,197,34816
MA 24,v,168,v,112
ds_read_b128 v[84:87], v192 offset:34816
ds_read_b128 v[88:91], v192 offset:36864
MA 56,v,168,v,116
TR 152,198,32768
TR 154,198,34816
MA 88,v,168,v,120
ds_read_b128 v[92:95], v192 offset:38912
ds_read_b128 v[96:99], v192 offset:40960
MA 120,v,168,v,124
TR 156,199,32768
TR 158,199,34816
MA 152,v,168,v,128
ds_read_b128 v[100:103], v192 offset:43008
ds_read_b128 v[104:107], v192 offset:45056
MA 184,v,168,v,132
TR 160,200,32768
TR 162,200,34816
MA 216,v,168,v,136
ds_read_b128 v[108:111], v192 offset:47104
buffer_load_dwordx4 v184, s[12:15], s21 offen offset:0 lds
MA 248,v,168,v,140
TR 164,201,32768
TR 166,201,34816
MA 28,v,172,v,112
buffer_load_dwordx4 v185, s[12:15], s21 offen offset:1024 lds
buffer_load_dwordx4 v186, s[12:15], s21 offen offset:2048 lds
MA 60,v,172,v,116
TR 168,202,32768
TR 170,202,34816
MA 92,v,172,v,120
buffer_load_dwordx4 v187, s[12:15], s21 offen offset:3072 lds
s_add_u32 m0, s23, 4096
MA 124,v,172,v,124
buffer_load_dwordx4 v188, s[12:15], s21 offen offset:0 lds
buffer_load_dwordx4 v189, s[12:15], s21 offen offset:1024 lds
MA 156,v,172,v,128
buffer_load_dwordx4 v190, s[12:15], s21 offen offset:2048 lds
buffer_load_dwordx4 v191, s[12:15], s21 offen offset:3072 lds
MA 188,v,172,v,132
s_add_u32 s21, s21, 524288
s_and_b32 s21, s21, 4194303
MA 220,v,172,v,136
s_load_dwordx2 s[84:85], s[0:1], 8
s_load_dwordx2 s[88:89], s[0:1], 16
MA 252,v,172,v,140
TR 172,203,32768
TR 174,203,34816
s_load_dwordx2 s[92:93], s[0:1], 0
s_load_dwordx2 s[96:97], s[0:1], 24
s_load_dwordx2 s[76:77], s[0:1], 96
s_waitcnt lgkmcnt(2)
MA 0,v,144,v,80
s_add_u32 m0, s22, 0
MA 32,v,144,v,84
ds_read_b128 v[112:115], v193 offset:32768
MA 64,v,144,v,88
s_mov_b32 s4, s34
s_mov_b32 s5, s35
MA 96,v,144,v,92
MA 128,v,144,v,96
MA 160,v,144,v,100
buffer_load_dwordx4 v176, s[8:11], s20 offen offset:0 lds
MA 192,v,144,v,104
MA 224,v,144,v,108
TR 144,196,49152
TR 146,196,51200
MA 4,v,148,v,80
ds_read_b128 v[116:119], v193 offset:34816
MA 36,v,148,v,84
s_mov_b32 s6, 8388608
s_mov_b32 s7, 0x20000
MA 68,v,148,v,88
buffer_load_dwordx4 v177, s[8:11], s20 offen offset:1024 lds
MA 100,v,148,v,92
MA 132,v,148,v,96
MA 164,v,148,v,100
ds_read_b128 v[120:123], v193 offset:36864
MA 196,v,148,v,104
MA 228,v,148,v,108
TR 148,197,49152
TR 150,197,51200
MA 8,v,152,v,80
buffer_load_dwordx4 v178, s[8:11], s20 offen offset:2048 lds
s_lshr_b32 s43, s2, 3
MA 40,v,152,v,84
MA 72,v,152,v,88
MA 104,v,152,v,92
s_lshl_b32 s43, s43, 2
MA 136,v,152,v,96
ds_read_b128 v[124:127], v193 offset:38912
buffer_load_dwordx4 v179, s[8:11], s20 offen offset:3072 lds
MA 168,v,152,v,100
MA 200,v,152,v,104
MA 232,v,152,v,108
TR 152,198,49152
TR 154,198,51200
MA 12,v,156,v,80
s_add_u32 s43, s43, s3
MA 44,v,156,v,84
s_add_u32 m0, s22, 4096
MA 76,v,156,v,88
ds_read_b128 v[128:131], v193 offset:40960
MA 108,v,156,v,92
s_lshl_b32 s43, s43, 16
MA 140,v,156,v,96
MA 172,v,156,v,100
MA 204,v,156,v,104
MA 236,v,156,v,108
TR 156,199,49152
TR 158,199,51200
MA 16,v,160,v,80
ds_read_b128 v[132:135], v193 offset:43008
buffer_load_dwordx4 v180, s[8:11], s20 offen offset:0 lds
MA 48,v,160,v,84
s_and_b32 s37, s2, 7
MA 80,v,160,v,88
s_lshl_b32 s37, s37, 10
MA 112,v,160,v,92
MA 144,v,160,v,96
buffer_load_dwordx4 v181, s[8:11], s20 offen offset:1024 lds
MA 176,v,160,v,100
MA 208,v,160,v,104
s_add_u32 s43, s43, s37
MA 240,v,160,v,108
TR 160,200,49152
TR 162,200,51200
MA 20,v,164,v,80
ds_read_b128 v[136:139], v193 offset:45056
MA 52,v,164,v,84
buffer_load_dwordx4 v182, s[8:11], s20 offen offset:2048 lds
MA 84,v,164,v,88
v_lshrrev_b32 v78, 3, v1
MA 116,v,164,v,92
MA 148,v,164,v,96
MA 180,v,164,v,100
ds_read_b128 v[140:143], v193 offset:47104
MA 212,v,164,v,104
buffer_load_dwordx4 v183, s[8:11], s20 offen offset:3072 lds
s_waitcnt vmcnt(24)
v_and_b32 v79, 7, v1
MA 244,v,164,v,108
TR 164,201,49152
TR 166,201,51200
MA 24,v,168,v,80
MA 56,v,168,v,84
MA 88,v,168,v,88
v_lshlrev_b32 v79, 7, v79
MA 120,v,168,v,92
s_add_u32 s20, s20, 128
MA 152,v,168,v,96
MA 184,v,168,v,100
MA 216,v,168,v,104
v_lshl_add_u32 v78, v78, 13, v79
MA 248,v,168,v,108
TR 168,202,49152
TR 170,202,51200
s_waitcnt lgkmcnt(15)
MA 28,v,172,v,80
s_and_b32 s20, s20, 1023
MA 60,v,172,v,84
MA 92,v,172,v,88
v_add_u32 v78, s43, v78
MA 124,v,172,v,92
MA 156,v,172,v,96
MA 188,v,172,v,100
MA 220,v,172,v,104
MA 252,v,172,v,108
TR 172,203,49152
TR 174,203,51200
s_waitcnt lgkmcnt(2)
MA 0,v,144,v,112
MA 32,v,144,v,116
MA 64,v,144,v,120
MA 96,v,144,v,124
MA 128,v,144,v,128
MA 160,v,144,v,132
MA 192,v,144,v,136
MA 224,v,144,v,140
MA 4,v,148,v,112
MA 36,v,148,v,116
s_waitcnt vmcnt(8) lgkmcnt(0)
s_barrier
MA 68,v,148,v,120
TR 144,196,0
TR 146,196,2048
MA 100,v,148,v,124
ds_read_b128 v[80:83], v194 offset:0
s_add_u32 m0, s23, 32768
MA 132,v,148,v,128
s_mov_b32 s86, 4194304
s_mov_b32 s87, 0x20000
MA 164,v,148,v,132
s_mov_b32 s90, 4194304
s_mov_b32 s91, 0x20000
MA 196,v,148,v,136
buffer_load_dwordx4 v184, s[12:15], s21 offen offset:0 lds
MA 228,v,148,v,140
TR 148,197,0
TR 150,197,2048
MA 8,v,152,v,112
ds_read_b128 v[84:87], v194 offset:2048
s_mov_b32 s94, 4194304
MA 40,v,152,v,116
s_mov_b32 s95, 0x20000
s_mov_b32 s98, 8192
MA 72,v,152,v,120
buffer_load_dwordx4 v185, s[12:15], s21 offen offset:1024 lds
s_mov_b32 s99, 0x20000
MA 104,v,152,v,124
MA 136,v,152,v,128
s_mov_b32 s78, 2048
MA 168,v,152,v,132
ds_read_b128 v[88:91], v194 offset:4096
s_mov_b32 s79, 0x20000
MA 200,v,152,v,136
s_and_b32 s36, s2, 15
MA 232,v,152,v,140
TR 152,198,0
TR 154,198,2048
MA 12,v,156,v,112
buffer_load_dwordx4 v186, s[12:15], s21 offen offset:2048 lds
s_lshl_b32 s36, s36, 1
MA 44,v,156,v,116
s_lshr_b32 s37, s3, 1
MA 76,v,156,v,120
ds_read_b128 v[92:95], v194 offset:6144
s_add_u32 s36, s36, s37
MA 108,v,156,v,124
buffer_load_dwordx4 v187, s[12:15], s21 offen offset:3072 lds
s_lshl_b32 s36, s36, 3
MA 140,v,156,v,128
MA 172,v,156,v,132
v_and_b32 v252, 7, v1
MA 204,v,156,v,136
v_add_u32 v252, s36, v252
MA 236,v,156,v,140
TR 156,199,0
TR 158,199,2048
MA 16,v,160,v,112
ds_read_b128 v[96:99], v194 offset:8192
s_add_u32 m0, s23, 36864
MA 48,v,160,v,116
s_lshr_b32 s36, s2, 4
s_lshl_b32 s36, s36, 1
MA 80,v,160,v,120
s_and_b32 s37, s3, 1
MA 112,v,160,v,124
s_add_u32 s36, s36, s37
MA 144,v,160,v,128
ds_read_b128 v[100:103], v194 offset:10240
buffer_load_dwordx4 v188, s[12:15], s21 offen offset:0 lds
MA 176,v,160,v,132
s_lshl_b32 s36, s36, 3
v_lshrrev_b32 v253, 3, v1
MA 208,v,160,v,136
MA 240,v,160,v,140
TR 160,200,0
TR 162,200,2048
MA 20,v,164,v,112
buffer_load_dwordx4 v189, s[12:15], s21 offen offset:1024 lds
v_add_u32 v253, s36, v253
MA 52,v,164,v,116
ds_read_b128 v[104:107], v194 offset:12288
v_lshlrev_b32 v254, 14, v253
MA 84,v,164,v,120
v_lshl_add_u32 v254, v252, 3, v254
v_add_u32 v229, -6144, v254
MA 116,v,164,v,124
MA 148,v,164,v,128
buffer_load_dwordx4 v190, s[12:15], s21 offen offset:2048 lds
v_lshlrev_b32 v62, 5, v252
MA 180,v,164,v,132
v_lshlrev_b32 v254, 4, v253
MA 212,v,164,v,136
ds_read_b128 v[108:111], v194 offset:14336
v_sub_u32 v254, 4080, v254
MA 244,v,164,v,140
TR 164,201,0
TR 166,201,2048
MA 24,v,168,v,112
v_lshl_add_u32 v10, v252, 14, v254
MA 56,v,168,v,116
buffer_load_dwordx4 v191, s[12:15], s21 offen offset:3072 lds
v_and_b32 v252, 31, v1
MA 88,v,168,v,120
v_lshlrev_b32 v64, 4, v252
MA 120,v,168,v,124
s_lshl_b32 s36, s2, 2
MA 152,v,168,v,128
MA 184,v,168,v,132
s_add_u32 s21, s21, 524288
s_add_u32 s36, s36, s3
MA 216,v,168,v,136
s_lshl_b32 s36, s36, 1
MA 248,v,168,v,140
TR 168,202,0
TR 170,202,2048
MA 28,v,172,v,112
v_lshrrev_b32 v253, 5, v1
v_add_u32 v253, s36, v253
MA 60,v,172,v,116
s_and_b32 s21, s21, 4194303
MA 92,v,172,v,120
v_lshl_add_u32 v63, v253, 11, v64
MA 124,v,172,v,124
v_lshlrev_b32 v253, 2, v253
MA 156,v,172,v,128
v_lshl_add_u32 v11, v252, 20, v253
MA 188,v,172,v,132
MA 220,v,172,v,136
MA 252,v,172,v,140
TR 172,203,0
TR 174,203,2048
s_waitcnt lgkmcnt(2)
MA 0,v,144,v,80
s_add_u32 m0, s22, 32768
buffer_load_dwordx4 v[230:233], v63, s[92:95], 0 offen offset:0
MA 32,v,144,v,84
ds_read_b128 v[112:115], v195 offset:0
MA 64,v,144,v,88
MA 96,v,144,v,92
MA 128,v,144,v,96
buffer_load_dwordx4 v[2:5], v64, s[76:79], 0 offen offset:0
MA 160,v,144,v,100
buffer_load_dwordx4 v176, s[8:11], s20 offen offset:0 lds
MA 192,v,144,v,104
MA 224,v,144,v,108
TR 144,196,16384
TR 146,196,18432
MA 4,v,148,v,80
ds_read_b128 v[116:119], v195 offset:2048
MA 36,v,148,v,84
buffer_load_dwordx4 v[234:237], v63, s[92:95], 0 offen offset:512
MA 68,v,148,v,88
buffer_load_dwordx4 v177, s[8:11], s20 offen offset:1024 lds
MA 100,v,148,v,92
MA 132,v,148,v,96
MA 164,v,148,v,100
ds_read_b128 v[120:123], v195 offset:4096
MA 196,v,148,v,104
buffer_load_dwordx4 v[6:9], v64, s[76:79], 0 offen offset:512
MA 228,v,148,v,108
TR 148,197,16384
TR 150,197,18432
MA 8,v,152,v,80
buffer_load_dwordx4 v178, s[8:11], s20 offen offset:2048 lds
MA 40,v,152,v,84
MA 72,v,152,v,88
MA 104,v,152,v,92
buffer_load_dwordx4 v[238:241], v63, s[92:95], 0 offen offset:1024
MA 136,v,152,v,96
ds_read_b128 v[124:127], v195 offset:6144
buffer_load_dwordx4 v179, s[8:11], s20 offen offset:3072 lds
MA 168,v,152,v,100
MA 200,v,152,v,104
MA 232,v,152,v,108
TR 152,198,16384
TR 154,198,18432
MA 12,v,156,v,80
buffer_load_dwordx4 v[12:15], v64, s[76:79], 0 offen offset:1024
MA 44,v,156,v,84
s_add_u32 m0, s22, 36864
MA 76,v,156,v,88
ds_read_b128 v[128:131], v195 offset:8192
MA 108,v,156,v,92
MA 140,v,156,v,96
buffer_load_dwordx4 v[242:245], v63, s[92:95], 0 offen offset:1536
MA 172,v,156,v,100
MA 204,v,156,v,104
MA 236,v,156,v,108
TR 156,199,16384
TR 158,199,18432
MA 16,v,160,v,80
ds_read_b128 v[132:135], v195 offset:10240
buffer_load_dwordx4 v180, s[8:11], s20 offen offset:0 lds
MA 48,v,160,v,84
buffer_load_dwordx4 v[246:249], v64, s[76:79], 0 offen offset:1536
MA 80,v,160,v,88
MA 112,v,160,v,92
MA 144,v,160,v,96
buffer_load_dwordx4 v181, s[8:11], s20 offen offset:1024 lds
MA 176,v,160,v,100
MA 208,v,160,v,104
buffer_load_dwordx4 v[54:57], v62, s[96:99], 0 offen offset:0
MA 240,v,160,v,108
TR 160,200,16384
TR 162,200,18432
MA 20,v,164,v,80
ds_read_b128 v[136:139], v195 offset:12288
MA 52,v,164,v,84
buffer_load_dwordx4 v182, s[8:11], s20 offen offset:2048 lds
MA 84,v,164,v,88
buffer_load_dwordx4 v[58:61], v62, s[96:99], 0 offen offset:16
MA 116,v,164,v,92
MA 148,v,164,v,96
MA 180,v,164,v,100
ds_read_b128 v[140:143], v195 offset:14336
MA 212,v,164,v,104
buffer_load_dwordx4 v183, s[8:11], s20 offen offset:3072 lds
MA 244,v,164,v,108
TR 164,201,16384
TR 166,201,18432
MA 24,v,168,v,80
v_add_u32 v252, 0, v229
MA 56,v,168,v,84
MA 88,v,168,v,88
MA 120,v,168,v,92
s_add_u32 s20, s20, 128
MA 152,v,168,v,96
buffer_load_dwordx2 v[16:17], v252, s[84:87], 0 offen
MA 184,v,168,v,100
MA 216,v,168,v,104
MA 248,v,168,v,108
TR 168,202,16384
TR 170,202,18432
s_waitcnt lgkmcnt(15)
MA 28,v,172,v,80
s_and_b32 s20, s20, 1023
MA 60,v,172,v,84
v_add_u32 v253, 2048, v229
MA 92,v,172,v,88
MA 124,v,172,v,92
MA 156,v,172,v,96
MA 188,v,172,v,100
MA 220,v,172,v,104
MA 252,v,172,v,108
TR 172,203,16384
TR 174,203,18432
s_waitcnt lgkmcnt(2)
MA 0,v,144,v,112
MA 32,v,144,v,116
MA 64,v,144,v,120
MA 96,v,144,v,124
MA 128,v,144,v,128
MA 160,v,144,v,132
MA 192,v,144,v,136
MA 224,v,144,v,140
MA 4,v,148,v,112
MA 36,v,148,v,116
s_waitcnt vmcnt(19) lgkmcnt(0)
s_barrier
MA 68,v,148,v,120
TR 144,196,32768
TR 146,196,34816
MA 100,v,148,v,124
ds_read_b128 v[80:83], v192 offset:0
s_add_u32 m0, s23, 0
MA 132,v,148,v,128
s_bfe_u32 s80, s2, 0x20001
s_bfe_u32 s69, s2, 0x30003
MA 164,v,148,v,132
s_lshl_b32 s80, s80, 3
s_add_u32 s69, s69, s80
MA 196,v,148,v,136
buffer_load_dwordx4 v184, s[12:15], s21 offen offset:0 lds
s_lshr_b32 s80, s2, 6
MA 228,v,148,v,140
TR 148,197,32768
TR 150,197,34816
MA 8,v,152,v,112
ds_read_b128 v[84:87], v192 offset:2048
s_xor_b32 s81, s80, s2
MA 40,v,152,v,116
s_and_b32 s81, s81, 1
s_lshl_b32 s70, s80, 1
MA 72,v,152,v,120
buffer_load_dwordx4 v185, s[12:15], s21 offen offset:1024 lds
s_add_u32 s70, s70, s81
MA 104,v,152,v,124
s_lshl_b32 s80, s3, 1
s_sub_u32 s80, 7, s80
MA 136,v,152,v,128
s_lshl_b32 s76, s80, 17
s_lshl_b32 s80, s3, 15
MA 168,v,152,v,132
ds_read_b128 v[88:91], v192 offset:4096
s_lshl_b32 s65, s70, 18
MA 200,v,152,v,136
s_sub_u32 s64, 3932160, s65
MA 232,v,152,v,140
TR 152,198,32768
TR 154,198,34816
MA 12,v,156,v,112
buffer_load_dwordx4 v186, s[12:15], s21 offen offset:2048 lds
s_add_u32 s65, s65, s80
MA 44,v,156,v,116
s_add_u32 s64, s64, s80
s_lshl_b32 s81, s69, 12
MA 76,v,156,v,120
ds_read_b128 v[92:95], v192 offset:6144
s_lshl_b32 s100, s64, 2
MA 108,v,156,v,124
buffer_load_dwordx4 v187, s[12:15], s21 offen offset:3072 lds
s_add_u32 s100, s100, s81
MA 140,v,156,v,128
s_lshl_b32 s101, s65, 2
MA 172,v,156,v,132
s_add_u32 s101, s101, s81
MA 204,v,156,v,136
s_lshl_b32 s66, s3, 17
s_lshl_b32 s81, s69, 8
MA 236,v,156,v,140
TR 156,199,32768
TR 158,199,34816
MA 16,v,160,v,112
ds_read_b128 v[96:99], v192 offset:8192
s_add_u32 m0, s23, 4096
MA 48,v,160,v,116
s_add_u32 s66, s66, s81
s_and_b32 s74, s2, 7
MA 80,v,160,v,120
s_lshl_b32 s74, s74, 8
s_mov_b32 s82, s66
MA 112,v,160,v,124
s_lshl_b32 s66, s74, 12
MA 144,v,160,v,128
ds_read_b128 v[100:103], v192 offset:10240
buffer_load_dwordx4 v188, s[12:15], s21 offen offset:0 lds
MA 176,v,160,v,132
s_lshl_b32 s67, s3, 13
s_lshl_b32 s68, s3, 12
MA 208,v,160,v,136
s_lshl_b32 s77, s70, 1
MA 240,v,160,v,140
TR 160,200,32768
TR 162,200,34816
MA 20,v,164,v,112
buffer_load_dwordx4 v189, s[12:15], s21 offen offset:1024 lds
s_sub_u32 s77, 32, s77
MA 52,v,164,v,116
ds_read_b128 v[104:107], v192 offset:12288
v_lshrrev_b32 v66, 3, v1
MA 84,v,164,v,120
v_lshlrev_b32 v66, 11, v66
v_lshrrev_b32 v67, 4, v1
MA 116,v,164,v,124
v_and_b32 v68, 7, v1
v_xor_b32 v68, v68, v67
MA 148,v,164,v,128
buffer_load_dwordx4 v190, s[12:15], s21 offen offset:2048 lds
v_lshl_add_u32 v66, v68, 4, v66
MA 180,v,164,v,132
v_xor_b32 v69, 64, v66
MA 212,v,164,v,136
ds_read_b128 v[108:111], v192 offset:14336
s_lshr_b32 s83, s76, 2
MA 244,v,164,v,140
TR 164,201,32768
TR 166,201,34816
MA 24,v,168,v,112
v_add_u32 v208, 0, v66
v_add_u32 v209, 15360, v69
MA 56,v,168,v,116
buffer_load_dwordx4 v191, s[12:15], s21 offen offset:3072 lds
v_add_u32 v210, -2048, v66
MA 88,v,168,v,120
v_add_u32 v210, s83, v210
MA 120,v,168,v,124
v_add_u32 v211, 13312, v69
v_add_u32 v211, s83, v211
MA 152,v,168,v,128
v_and_b32 v68, 15, v1
MA 184,v,168,v,132
s_add_u32 s21, s21, 524288
v_lshlrev_b32 v69, 1, v67
MA 216,v,168,v,136
v_xor_b32 v68, v68, v69
MA 248,v,168,v,140
TR 168,202,32768
TR 170,202,34816
MA 28,v,172,v,112
v_lshlrev_b32 v66, 13, v67
v_xor_b32 v69, 0, v68
MA 60,v,172,v,116
s_and_b32 s21, s21, 4194303
v_lshl_add_u32 v69, v69, 4, v66
MA 92,v,172,v,120
v_add_u32 v212, 0, v69
MA 124,v,172,v,124
v_xor_b32 v69, 0, v68
MA 156,v,172,v,128
v_lshl_add_u32 v69, v69, 4, v66
MA 188,v,172,v,132
v_add_u32 v213, 31744, v69
MA 220,v,172,v,136
MA 252,v,172,v,140
TR 172,203,32768
TR 174,203,34816
s_waitcnt lgkmcnt(2)
MA 0,v,144,v,80
s_add_u32 m0, s22, 65536
buffer_load_dwordx2 v[18:19], v253, s[84:87], 0 offen
MA 32,v,144,v,84
ds_read_b128 v[112:115], v193 offset:0
MA 64,v,144,v,88
MA 96,v,144,v,92
MA 128,v,144,v,96
v_add_u32 v254, 4096, v229
MA 160,v,144,v,100
buffer_load_dwordx4 v176, s[8:11], s20 offen offset:0 lds
MA 192,v,144,v,104
MA 224,v,144,v,108
TR 144,196,49152
TR 146,196,51200
MA 4,v,148,v,80
ds_read_b128 v[116:119], v193 offset:2048
MA 36,v,148,v,84
buffer_load_dwordx2 v[20:21], v254, s[84:87], 0 offen
MA 68,v,148,v,88
buffer_load_dwordx4 v177, s[8:11], s20 offen offset:1024 lds
MA 100,v,148,v,92
MA 132,v,148,v,96
MA 164,v,148,v,100
ds_read_b128 v[120:123], v193 offset:4096
MA 196,v,148,v,104
v_add_u32 v255, 6144, v229
MA 228,v,148,v,108
TR 148,197,49152
TR 150,197,51200
MA 8,v,152,v,80
buffer_load_dwordx4 v178, s[8:11], s20 offen offset:2048 lds
MA 40,v,152,v,84
MA 72,v,152,v,88
MA 104,v,152,v,92
buffer_load_dwordx2 v[22:23], v255, s[84:87], 0 offen
MA 136,v,152,v,96
ds_read_b128 v[124:127], v193 offset:6144
buffer_load_dwordx4 v179, s[8:11], s20 offen offset:3072 lds
MA 168,v,152,v,100
MA 200,v,152,v,104
MA 232,v,152,v,108
TR 152,198,49152
TR 154,198,51200
MA 12,v,156,v,80
buffer_load_dwordx2 v[38:39], v255, s[88:91], 0 offen
MA 44,v,156,v,84
s_add_u32 m0, s22, 69632
MA 76,v,156,v,88
ds_read_b128 v[128:131], v193 offset:8192
MA 108,v,156,v,92
MA 140,v,156,v,96
v_add_u32 v252, 8192, v229
MA 172,v,156,v,100
MA 204,v,156,v,104
MA 236,v,156,v,108
TR 156,199,49152
TR 158,199,51200
MA 16,v,160,v,80
ds_read_b128 v[132:135], v193 offset:10240
buffer_load_dwordx4 v180, s[8:11], s20 offen offset:0 lds
MA 48,v,160,v,84
buffer_load_dwordx2 v[24:25], v252, s[84:87], 0 offen
MA 80,v,160,v,88
MA 112,v,160,v,92
MA 144,v,160,v,96
buffer_load_dwordx4 v181, s[8:11], s20 offen offset:1024 lds
MA 176,v,160,v,100
MA 208,v,160,v,104
buffer_load_dwordx2 v[40:41], v252, s[88:91], 0 offen
MA 240,v,160,v,108
TR 160,200,49152
TR 162,200,51200
MA 20,v,164,v,80
ds_read_b128 v[136:139], v193 offset:12288
MA 52,v,164,v,84
buffer_load_dwordx4 v182, s[8:11], s20 offen offset:2048 lds
MA 84,v,164,v,88
v_add_u32 v253, 10240, v229
MA 116,v,164,v,92
MA 148,v,164,v,96
MA 180,v,164,v,100
ds_read_b128 v[140:143], v193 offset:14336
MA 212,v,164,v,104
buffer_load_dwordx4 v183, s[8:11], s20 offen offset:3072 lds
MA 244,v,164,v,108
TR 164,201,49152
TR 166,201,51200
MA 24,v,168,v,80
buffer_load_dwordx2 v[26:27], v253, s[84:87], 0 offen
MA 56,v,168,v,84
MA 88,v,168,v,88
MA 120,v,168,v,92
s_add_u32 s20, s20, 128
MA 152,v,168,v,96
buffer_load_dwordx2 v[42:43], v253, s[88:91], 0 offen
MA 184,v,168,v,100
MA 216,v,168,v,104
MA 248,v,168,v,108
TR 168,202,49152
TR 170,202,51200
s_waitcnt lgkmcnt(15)
MA 28,v,172,v,80
s_and_b32 s20, s20, 1023
MA 60,v,172,v,84
v_add_u32 v254, 12288, v229
MA 92,v,172,v,88
MA 124,v,172,v,92
MA 156,v,172,v,96
MA 188,v,172,v,100
MA 220,v,172,v,104
MA 252,v,172,v,108
TR 172,203,49152
TR 174,203,51200
s_waitcnt lgkmcnt(2)
MA 0,v,144,v,112
MA 32,v,144,v,116
MA 64,v,144,v,120
MA 96,v,144,v,124
MA 128,v,144,v,128
MA 160,v,144,v,132
MA 192,v,144,v,136
MA 224,v,144,v,140
MA 4,v,148,v,112
MA 36,v,148,v,116
s_waitcnt vmcnt(16) lgkmcnt(0)
s_barrier
MA 68,v,148,v,120
TR 144,196,0
TR 146,196,2048
MA 100,v,148,v,124
ds_read_b128 v[80:83], v192 offset:32768
s_add_u32 m0, s23, 32768
MA 132,v,148,v,128
v_xor_b32 v69, 8, v68
v_lshl_add_u32 v69, v69, 4, v66
MA 164,v,148,v,132
v_add_u32 v214, 63488, v69
v_xor_b32 v69, 8, v68
MA 196,v,148,v,136
buffer_load_dwordx4 v184, s[12:15], s21 offen offset:0 lds
v_lshl_add_u32 v69, v69, 4, v66
MA 228,v,148,v,140
TR 148,197,0
TR 150,197,2048
MA 8,v,152,v,112
ds_read_b128 v[84:87], v192 offset:34816
v_add_u32 v215, 95232, v69
MA 40,v,152,v,116
v_and_b32 v66, 15, v1
v_lshrrev_b32 v68, 1, v66
MA 72,v,152,v,120
buffer_load_dwordx4 v185, s[12:15], s21 offen offset:1024 lds
v_xor_b32 v68, v68, v67
MA 104,v,152,v,124
v_lshlrev_b32 v68, 4, v68
v_lshl_add_u32 v68, v66, 7, v68
MA 136,v,152,v,128
v_add_u32 v224, s67, v68
v_xor_b32 v225, 64, v224
MA 168,v,152,v,132
ds_read_b128 v[88:91], v192 offset:36864
v_add_u32 v226, 0x10000, v224
MA 200,v,152,v,136
v_add_u32 v227, 0x10000, v225
v_bfe_u32 v66, v1, 2, 2
MA 232,v,152,v,140
TR 152,198,0
TR 154,198,2048
MA 12,v,156,v,112
buffer_load_dwordx4 v186, s[12:15], s21 offen offset:2048 lds
v_and_b32 v68, 1, v67
MA 44,v,156,v,116
v_lshl_or_b32 v68, v68, 2, v66
v_lshl_add_u32 v66, v67, 3, v66
MA 76,v,156,v,120
ds_read_b128 v[92:95], v192 offset:38912
v_lshlrev_b32 v66, 8, v66
MA 108,v,156,v,124
buffer_load_dwordx4 v187, s[12:15], s21 offen offset:3072 lds
v_and_b32 v69, 3, v1
MA 140,v,156,v,128
v_lshl_add_u32 v66, v69, 3, v66
v_add_u32 v66, 98304, v66
MA 172,v,156,v,132
v_xor_b32 v69, 0, v68
MA 204,v,156,v,136
v_lshl_add_u32 v216, v69, 5, v66
v_xor_b32 v69, 1, v68
MA 236,v,156,v,140
TR 156,199,0
TR 158,199,2048
MA 16,v,160,v,112
ds_read_b128 v[96:99], v192 offset:40960
s_add_u32 m0, s23, 36864
MA 48,v,160,v,116
v_lshl_add_u32 v217, v69, 5, v66
v_xor_b32 v69, 2, v68
MA 80,v,160,v,120
v_lshl_add_u32 v218, v69, 5, v66
v_xor_b32 v69, 3, v68
MA 112,v,160,v,124
v_lshl_add_u32 v219, v69, 5, v66
MA 144,v,160,v,128
ds_read_b128 v[100:103], v192 offset:43008
buffer_load_dwordx4 v188, s[12:15], s21 offen offset:0 lds
MA 176,v,160,v,132
v_xor_b32 v69, 4, v68
v_lshl_add_u32 v220, v69, 5, v66
MA 208,v,160,v,136
v_xor_b32 v69, 5, v68
v_lshl_add_u32 v221, v69, 5, v66
MA 240,v,160,v,140
TR 160,200,0
TR 162,200,2048
MA 20,v,164,v,112
buffer_load_dwordx4 v189, s[12:15], s21 offen offset:1024 lds
v_xor_b32 v69, 6, v68
MA 52,v,164,v,116
ds_read_b128 v[104:107], v192 offset:45056
v_lshl_add_u32 v222, v69, 5, v66
MA 84,v,164,v,120
v_xor_b32 v69, 7, v68
v_lshl_add_u32 v223, v69, 5, v66
MA 116,v,164,v,124
s_mov_b32 s44, s32
s_mov_b32 s45, s33
MA 148,v,164,v,128
buffer_load_dwordx4 v190, s[12:15], s21 offen offset:2048 lds
s_mov_b32 s46, 4194304
MA 180,v,164,v,132
s_mov_b32 s47, 0x20000
MA 212,v,164,v,136
ds_read_b128 v[108:111], v192 offset:47104
MA 244,v,164,v,140
TR 164,201,0
TR 166,201,2048
MA 24,v,168,v,112
s_add_u32 s48, s34, s82
s_addc_u32 s49, s35, 0
MA 56,v,168,v,116
buffer_load_dwordx4 v191, s[12:15], s21 offen offset:3072 lds
s_sub_u32 s50, 8388608, s82
MA 88,v,168,v,120
s_mov_b32 s51, 0x20000
MA 120,v,168,v,124
s_add_u32 s60, s40, 33554432
s_addc_u32 s61, s41, 0
MA 152,v,168,v,128
s_mov_b32 s62, 16777216
s_mov_b32 s63, 0x20000
MA 184,v,168,v,132
s_add_u32 s21, s21, 524288
s_lshl_b32 s80, s69, 19
MA 216,v,168,v,136
s_add_u32 s52, s40, s80
s_addc_u32 s53, s41, 0
MA 248,v,168,v,140
TR 168,202,0
TR 170,202,2048
MA 28,v,172,v,112
s_lshl_b32 s54, s77, 14
s_mov_b32 s55, 0x20000
MA 60,v,172,v,116
s_and_b32 s21, s21, 4194303
s_add_u32 s80, s80, 16760832
MA 92,v,172,v,120
s_add_u32 s56, s40, s80
s_addc_u32 s57, s41, 0
MA 124,v,172,v,124
s_add_u32 s58, s54, 16384
MA 156,v,172,v,128
s_mov_b32 s59, 0x20000
MA 188,v,172,v,132
s_load_dwordx2 s[38:39], s[0:1], 112
MA 220,v,172,v,136
MA 252,v,172,v,140
TR 172,203,0
TR 174,203,2048
s_waitcnt lgkmcnt(2)
MA 0,v,144,v,80
s_add_u32 m0, s22, 0
buffer_load_dwordx2 v[28:29], v254, s[84:87], 0 offen
MA 32,v,144,v,84
ds_read_b128 v[112:115], v193 offset:32768
MA 64,v,144,v,88
MA 96,v,144,v,92
MA 128,v,144,v,96
buffer_load_dwordx2 v[44:45], v254, s[88:91], 0 offen
MA 160,v,144,v,100
buffer_load_dwordx4 v176, s[8:11], s20 offen offset:0 lds
MA 192,v,144,v,104
MA 224,v,144,v,108
TR 144,196,16384
TR 146,196,18432
MA 4,v,148,v,80
ds_read_b128 v[116:119], v193 offset:34816
v_add_u32 v255, 14336, v229
MA 36,v,148,v,84
MA 68,v,148,v,88
buffer_load_dwordx4 v177, s[8:11], s20 offen offset:1024 lds
MA 100,v,148,v,92
MA 132,v,148,v,96
MA 164,v,148,v,100
ds_read_b128 v[120:123], v193 offset:36864
buffer_load_dwordx2 v[30:31], v255, s[84:87], 0 offen
MA 196,v,148,v,104
MA 228,v,148,v,108
TR 148,197,16384
TR 150,197,18432
MA 8,v,152,v,80
buffer_load_dwordx4 v178, s[8:11], s20 offen offset:2048 lds
MA 40,v,152,v,84
buffer_load_dwordx2 v[46:47], v255, s[88:91], 0 offen
MA 72,v,152,v,88
MA 104,v,152,v,92
MA 136,v,152,v,96
ds_read_b128 v[124:127], v193 offset:38912
buffer_load_dwordx4 v179, s[8:11], s20 offen offset:3072 lds
MA 168,v,152,v,100
MA 200,v,152,v,104
v_add_u32 v252, 16384, v229
MA 232,v,152,v,108
TR 152,198,16384
TR 154,198,18432
MA 12,v,156,v,80
MA 44,v,156,v,84
s_add_u32 m0, s22, 4096
MA 76,v,156,v,88
ds_read_b128 v[128:131], v193 offset:40960
buffer_load_dwordx2 v[32:33], v252, s[84:87], 0 offen
MA 108,v,156,v,92
MA 140,v,156,v,96
MA 172,v,156,v,100
MA 204,v,156,v,104
MA 236,v,156,v,108
TR 156,199,16384
TR 158,199,18432
MA 16,v,160,v,80
ds_read_b128 v[132:135], v193 offset:43008
buffer_load_dwordx4 v180, s[8:11], s20 offen offset:0 lds
MA 48,v,160,v,84
buffer_load_dwordx2 v[48:49], v252, s[88:91], 0 offen
MA 80,v,160,v,88
MA 112,v,160,v,92
v_add_u32 v253, 18432, v229
MA 144,v,160,v,96
buffer_load_dwordx4 v181, s[8:11], s20 offen offset:1024 lds
MA 176,v,160,v,100
MA 208,v,160,v,104
MA 240,v,160,v,108
TR 160,200,16384
TR 162,200,18432
MA 20,v,164,v,80
ds_read_b128 v[136:139], v193 offset:45056
buffer_load_dwordx2 v[34:35], v253, s[84:87], 0 offen
MA 52,v,164,v,84
buffer_load_dwordx4 v182, s[8:11], s20 offen offset:2048 lds
MA 84,v,164,v,88
MA 116,v,164,v,92
MA 148,v,164,v,96
buffer_load_dwordx2 v[50:51], v253, s[88:91], 0 offen
MA 180,v,164,v,100
ds_read_b128 v[140:143], v193 offset:47104
MA 212,v,164,v,104
buffer_load_dwordx4 v183, s[8:11], s20 offen offset:3072 lds
MA 244,v,164,v,108
TR 164,201,16384
TR 166,201,18432
MA 24,v,168,v,80
v_add_u32 v254, 20480, v229
MA 56,v,168,v,84
MA 88,v,168,v,88
MA 120,v,168,v,92
s_add_u32 s20, s20, 128
MA 152,v,168,v,96
MA 184,v,168,v,100
buffer_load_dwordx2 v[36:37], v254, s[84:87], 0 offen
MA 216,v,168,v,104
MA 248,v,168,v,108
TR 168,202,16384
TR 170,202,18432
s_waitcnt lgkmcnt(15)
MA 28,v,172,v,80
s_and_b32 s20, s20, 1023
MA 60,v,172,v,84
buffer_load_dwordx2 v[52:53], v254, s[88:91], 0 offen
MA 92,v,172,v,88
MA 124,v,172,v,92
MA 156,v,172,v,96
MA 188,v,172,v,100
MA 220,v,172,v,104
MA 252,v,172,v,108
TR 172,203,16384
TR 174,203,18432
s_waitcnt lgkmcnt(2)
MA 0,v,144,v,112
MA 32,v,144,v,116
MA 64,v,144,v,120
MA 96,v,144,v,124
MA 128,v,144,v,128
MA 160,v,144,v,132
MA 192,v,144,v,136
MA 224,v,144,v,140
MA 4,v,148,v,112
MA 36,v,148,v,116
s_waitcnt vmcnt(18) lgkmcnt(0)
s_barrier
MA 68,v,148,v,120
TR 144,196,32768
TR 146,196,34816
MA 100,v,148,v,124
ds_read_b128 v[80:83], v194 offset:0
s_add_u32 m0, s23, 0
MA 132,v,148,v,128
MA 164,v,148,v,132
MA 196,v,148,v,136
buffer_load_dwordx4 v184, s[12:15], s21 offen offset:0 lds
MA 228,v,148,v,140
TR 148,197,32768
TR 150,197,34816
MA 8,v,152,v,112
ds_read_b128 v[84:87], v194 offset:2048
MA 40,v,152,v,116
MA 72,v,152,v,120
buffer_load_dwordx4 v185, s[12:15], s21 offen offset:1024 lds
MA 104,v,152,v,124
MA 136,v,152,v,128
MA 168,v,152,v,132
ds_read_b128 v[88:91], v194 offset:4096
MA 200,v,152,v,136
MA 232,v,152,v,140
TR 152,198,32768
TR 154,198,34816
MA 12,v,156,v,112
buffer_load_dwordx4 v186, s[12:15], s21 offen offset:2048 lds
MA 44,v,156,v,116
MA 76,v,156,v,120
ds_read_b128 v[92:95], v194 offset:6144
MA 108,v,156,v,124
buffer_load_dwordx4 v187, s[12:15], s21 offen offset:3072 lds
MA 140,v,156,v,128
MA 172,v,156,v,132
MA 204,v,156,v,136
MA 236,v,156,v,140
TR 156,199,32768
TR 158,199,34816
MA 16,v,160,v,112
ds_read_b128 v[96:99], v194 offset:8192
s_add_u32 m0, s23, 4096
MA 48,v,160,v,116
MA 80,v,160,v,120
MA 112,v,160,v,124
MA 144,v,160,v,128
ds_read_b128 v[100:103], v194 offset:10240
buffer_load_dwordx4 v188, s[12:15], s21 offen offset:0 lds
MA 176,v,160,v,132
MA 208,v,160,v,136
MA 240,v,160,v,140
TR 160,200,32768
TR 162,200,34816
MA 20,v,164,v,112
buffer_load_dwordx4 v189, s[12:15], s21 offen offset:1024 lds
MA 52,v,164,v,116
ds_read_b128 v[104:107], v194 offset:12288
MA 84,v,164,v,120
MA 116,v,164,v,124
MA 148,v,164,v,128
buffer_load_dwordx4 v190, s[12:15], s21 offen offset:2048 lds
MA 180,v,164,v,132
MA 212,v,164,v,136
ds_read_b128 v[108:111], v194 offset:14336
MA 244,v,164,v,140
TR 164,201,32768
TR 166,201,34816
MA 24,v,168,v,112
MA 56,v,168,v,116
buffer_load_dwordx4 v191, s[12:15], s21 offen offset:3072 lds
MA 88,v,168,v,120
MA 120,v,168,v,124
MA 152,v,168,v,128
MA 184,v,168,v,132
s_add_u32 s21, s21, 524288
MA 216,v,168,v,136
MA 248,v,168,v,140
TR 168,202,32768
TR 170,202,34816
MA 28,v,172,v,112
MA 60,v,172,v,116
s_and_b32 s21, s21, 4194303
MA 92,v,172,v,120
MA 124,v,172,v,124
MA 156,v,172,v,128
MA 188,v,172,v,132
MA 220,v,172,v,136
MA 252,v,172,v,140
TR 172,203,32768
TR 174,203,34816
s_waitcnt lgkmcnt(2)
MA 0,v,144,v,80
s_add_u32 m0, s22, 32768
MA 32,v,144,v,84
ds_read_b128 v[112:115], v195 offset:0
MA 64,v,144,v,88
MA 96,v,144,v,92
MA 128,v,144,v,96
MA 160,v,144,v,100
buffer_load_dwordx4 v176, s[8:11], s20 offen offset:0 lds
MA 192,v,144,v,104
MA 224,v,144,v,108
TR 144,196,49152
TR 146,196,51200
MA 4,v,148,v,80
ds_read_b128 v[116:119], v195 offset:2048
MA 36,v,148,v,84
MA 68,v,148,v,88
buffer_load_dwordx4 v177, s[8:11], s20 offen offset:1024 lds
MA 100,v,148,v,92
MA 132,v,148,v,96
MA 164,v,148,v,100
ds_read_b128 v[120:123], v195 offset:4096
MA 196,v,148,v,104
MA 228,v,148,v,108
TR 148,197,49152
TR 150,197,51200
MA 8,v,152,v,80
buffer_load_dwordx4 v178, s[8:11], s20 offen offset:2048 lds
MA 40,v,152,v,84
MA 72,v,152,v,88
MA 104,v,152,v,92
MA 136,v,152,v,96
ds_read_b128 v[124:127], v195 offset:6144
buffer_load_dwordx4 v179, s[8:11], s20 offen offset:3072 lds
MA 168,v,152,v,100
MA 200,v,152,v,104
MA 232,v,152,v,108
TR 152,198,49152
TR 154,198,51200
MA 12,v,156,v,80
MA 44,v,156,v,84
s_add_u32 m0, s22, 36864
MA 76,v,156,v,88
ds_read_b128 v[128:131], v195 offset:8192
MA 108,v,156,v,92
MA 140,v,156,v,96
MA 172,v,156,v,100
MA 204,v,156,v,104
MA 236,v,156,v,108
TR 156,199,49152
TR 158,199,51200
MA 16,v,160,v,80
ds_read_b128 v[132:135], v195 offset:10240
buffer_load_dwordx4 v180, s[8:11], s20 offen offset:0 lds
MA 48,v,160,v,84
MA 80,v,160,v,88
MA 112,v,160,v,92
MA 144,v,160,v,96
buffer_load_dwordx4 v181, s[8:11], s20 offen offset:1024 lds
MA 176,v,160,v,100
MA 208,v,160,v,104
MA 240,v,160,v,108
TR 160,200,49152
TR 162,200,51200
MA 20,v,164,v,80
ds_read_b128 v[136:139], v195 offset:12288
MA 52,v,164,v,84
buffer_load_dwordx4 v182, s[8:11], s20 offen offset:2048 lds
MA 84,v,164,v,88
MA 116,v,164,v,92
MA 148,v,164,v,96
MA 180,v,164,v,100
ds_read_b128 v[140:143], v195 offset:14336
MA 212,v,164,v,104
buffer_load_dwordx4 v183, s[8:11], s20 offen offset:3072 lds
MA 244,v,164,v,108
TR 164,201,49152
TR 166,201,51200
MA 24,v,168,v,80
MA 56,v,168,v,84
MA 88,v,168,v,88
MA 120,v,168,v,92
s_add_u32 s20, s20, 128
MA 152,v,168,v,96
MA 184,v,168,v,100
MA 216,v,168,v,104
MA 248,v,168,v,108
TR 168,202,49152
TR 170,202,51200
s_waitcnt lgkmcnt(15)
MA 28,v,172,v,80
s_and_b32 s20, s20, 1023
MA 60,v,172,v,84
MA 92,v,172,v,88
MA 124,v,172,v,92
MA 156,v,172,v,96
MA 188,v,172,v,100
MA 220,v,172,v,104
MA 252,v,172,v,108
TR 172,203,49152
TR 174,203,51200
s_waitcnt lgkmcnt(2)
MA 0,v,144,v,112
MA 32,v,144,v,116
MA 64,v,144,v,120
MA 96,v,144,v,124
MA 128,v,144,v,128
MA 160,v,144,v,132
MA 192,v,144,v,136
MA 224,v,144,v,140
MA 4,v,148,v,112
MA 36,v,148,v,116
s_waitcnt vmcnt(8) lgkmcnt(0)
s_barrier
MA 68,v,148,v,120
TR 144,196,0
TR 146,196,2048
MA 100,v,148,v,124
ds_read_b128 v[80:83], v192 offset:0
s_add_u32 m0, s23, 32768
MA 132,v,148,v,128
buffer_load_dword v79, v78, s[4:7], 0 offen
MA 164,v,148,v,132
s_add_u32 s84, s40, 50331648
s_addc_u32 s85, s41, 0
MA 196,v,148,v,136
buffer_load_dwordx4 v184, s[12:15], s21 offen offset:0 lds
s_mov_b32 s86, 4194304
MA 228,v,148,v,140
TR 148,197,0
TR 150,197,2048
MA 8,v,152,v,112
ds_read_b128 v[84:87], v192 offset:2048
s_mov_b32 s87, 0x20000
MA 40,v,152,v,116
s_add_u32 s88, s40, 58720256
s_addc_u32 s89, s41, 0
MA 72,v,152,v,120
buffer_load_dwordx4 v185, s[12:15], s21 offen offset:1024 lds
s_mov_b32 s90, 8192
MA 104,v,152,v,124
s_mov_b32 s91, 0x20000
v_mov_b32 v252, 0
MA 136,v,152,v,128
v_mov_b32 v253, 0
v_dot2_f32_bf16 v252, v230, v2, v252
MA 168,v,152,v,132
ds_read_b128 v[88:91], v192 offset:4096
v_dot2_f32_bf16 v253, v231, v3, v253
MA 200,v,152,v,136
v_dot2_f32_bf16 v252, v232, v4, v252
v_dot2_f32_bf16 v253, v233, v5, v253
MA 232,v,152,v,140
TR 152,198,0
TR 154,198,2048
MA 12,v,156,v,112
buffer_load_dwordx4 v186, s[12:15], s21 offen offset:2048 lds
v_dot2_f32_bf16 v252, v234, v6, v252
MA 44,v,156,v,116
v_dot2_f32_bf16 v253, v235, v7, v253
v_dot2_f32_bf16 v252, v236, v8, v252
MA 76,v,156,v,120
ds_read_b128 v[92:95], v192 offset:6144
v_dot2_f32_bf16 v253, v237, v9, v253
MA 108,v,156,v,124
buffer_load_dwordx4 v187, s[12:15], s21 offen offset:3072 lds
v_dot2_f32_bf16 v252, v238, v12, v252
MA 140,v,156,v,128
v_dot2_f32_bf16 v253, v239, v13, v253
v_dot2_f32_bf16 v252, v240, v14, v252
MA 172,v,156,v,132
v_dot2_f32_bf16 v253, v241, v15, v253
v_dot2_f32_bf16 v252, v242, v246, v252
MA 204,v,156,v,136
v_dot2_f32_bf16 v253, v243, v247, v253
v_dot2_f32_bf16 v252, v244, v248, v252
MA 236,v,156,v,140
TR 156,199,0
TR 158,199,2048
MA 16,v,160,v,112
ds_read_b128 v[96:99], v192 offset:8192
s_add_u32 m0, s23, 36864
MA 48,v,160,v,116
v_dot2_f32_bf16 v253, v245, v249, v253
MA 80,v,160,v,120
s_nop 2
v_add_f32 v252, v252, v253
MA 112,v,160,v,124
s_nop 0
v_add_f32_dpp v252, v252, v252 row_ror:8 row_mask:0xf bank_mask:0xf
s_nop 1
v_add_f32_dpp v252, v252, v252 row_ror:4 row_mask:0xf bank_mask:0xf
MA 144,v,160,v,128
ds_read_b128 v[100:103], v192 offset:10240
buffer_load_dwordx4 v188, s[12:15], s21 offen offset:0 lds
MA 176,v,160,v,132
v_add_f32_dpp v252, v252, v252 row_ror:2 row_mask:0xf bank_mask:0xf
s_nop 1
v_add_f32_dpp v252, v252, v252 row_ror:1 row_mask:0xf bank_mask:0xf
MA 208,v,160,v,136
v_mov_b32 v253, v252
s_nop 1
v_permlane16_swap_b32 v252, v253
MA 240,v,160,v,140
TR 160,200,0
TR 162,200,2048
MA 20,v,164,v,112
buffer_load_dwordx4 v189, s[12:15], s21 offen offset:1024 lds
v_add_f32 v252, v252, v253
MA 52,v,164,v,116
ds_read_b128 v[104:107], v192 offset:12288
v_mul_f32 v252, 0xbfb8aa3b, v252
MA 84,v,164,v,120
v_exp_f32 v252, v252
MA 116,v,164,v,124
v_add_f32 v252, 1.0, v252
MA 148,v,164,v,128
buffer_load_dwordx4 v190, s[12:15], s21 offen offset:2048 lds
MA 180,v,164,v,132
v_rcp_f32 v252, v252
MA 212,v,164,v,136
ds_read_b128 v[108:111], v192 offset:14336
MA 244,v,164,v,140
TR 164,201,0
TR 166,201,2048
MA 24,v,168,v,112
s_nop 0
buffer_store_dword v252, v11, s[88:91], 0 offen sc1
MA 56,v,168,v,116
buffer_load_dwordx4 v191, s[12:15], s21 offen offset:3072 lds
v_lshlrev_b32 v2, 16, v54
MA 88,v,168,v,120
v_and_b32 v3, 0xffff0000, v54
v_lshlrev_b32 v4, 16, v55
MA 120,v,168,v,124
v_and_b32 v5, 0xffff0000, v55
v_lshlrev_b32 v6, 16, v56
MA 152,v,168,v,128
v_and_b32 v7, 0xffff0000, v56
v_lshlrev_b32 v8, 16, v57
MA 184,v,168,v,132
s_add_u32 s21, s21, 524288
v_and_b32 v9, 0xffff0000, v57
MA 216,v,168,v,136
v_lshlrev_b32 v230, 16, v16
v_and_b32 v231, 0xffff0000, v16
MA 248,v,168,v,140
TR 168,202,0
TR 170,202,2048
MA 28,v,172,v,112
v_lshlrev_b32 v232, 16, v18
v_and_b32 v233, 0xffff0000, v18
MA 60,v,172,v,116
s_and_b32 s21, s21, 4194303
v_lshlrev_b32 v234, 16, v20
MA 92,v,172,v,120
v_and_b32 v235, 0xffff0000, v20
v_lshlrev_b32 v236, 16, v22
MA 124,v,172,v,124
v_and_b32 v237, 0xffff0000, v22
v_lshlrev_b32 v238, 16, v24
MA 156,v,172,v,128
v_and_b32 v239, 0xffff0000, v24
v_lshlrev_b32 v240, 16, v26
MA 188,v,172,v,132
v_and_b32 v241, 0xffff0000, v26
v_lshlrev_b32 v242, 16, v28
MA 220,v,172,v,136
v_and_b32 v243, 0xffff0000, v28
v_lshlrev_b32 v244, 16, v30
MA 252,v,172,v,140
TR 172,203,0
TR 174,203,2048
v_and_b32 v245, 0xffff0000, v30
v_lshlrev_b32 v246, 16, v32
v_and_b32 v247, 0xffff0000, v32
v_lshlrev_b32 v248, 16, v34
v_and_b32 v249, 0xffff0000, v34
v_lshlrev_b32 v250, 16, v36
v_and_b32 v251, 0xffff0000, v36
v_lshlrev_b32 v254, 16, v38
v_and_b32 v255, 0xffff0000, v38
v_mul_f32 v62, v236, v2
v_mul_f32 v70, v237, v6
v_fmac_f32 v62, v234, v3
v_fmac_f32 v70, v235, v7
v_fmac_f32 v62, v232, v4
v_fmac_f32 v70, v233, v8
v_fmac_f32 v62, v230, v5
v_fmac_f32 v70, v231, v9
v_mul_f32 v62, v62, v254
s_waitcnt lgkmcnt(2)
MA 0,v,144,v,80
s_add_u32 s75, s64, s74
v_mul_f32 v70, v70, v255
MA 32,v,144,v,84
ds_read_b128 v[112:115], v193 offset:0
v_lshlrev_b32 v254, 16, v40
MA 64,v,144,v,88
v_and_b32 v255, 0xffff0000, v40
v_mul_f32 v63, v238, v2
MA 96,v,144,v,92
v_mul_f32 v71, v239, v6
v_fmac_f32 v63, v236, v3
MA 128,v,144,v,96
s_add_u32 m0, s67, 65536
v_fmac_f32 v71, v237, v7
MA 160,v,144,v,100
v_fmac_f32 v63, v234, v4
MA 192,v,144,v,104
v_fmac_f32 v71, v235, v8
MA 224,v,144,v,108
TR 144,196,16384
TR 146,196,18432
MA 4,v,148,v,80
ds_read_b128 v[116:119], v193 offset:2048
buffer_load_dwordx4 v208, s[44:47], s75 offen offset:0 lds
MA 36,v,148,v,84
v_fmac_f32 v63, v232, v5
v_fmac_f32 v71, v233, v9
MA 68,v,148,v,88
v_mul_f32 v63, v63, v254
v_mul_f32 v71, v71, v255
MA 100,v,148,v,92
v_lshlrev_b32 v254, 16, v42
v_and_b32 v255, 0xffff0000, v42
MA 132,v,148,v,96
v_mul_f32 v64, v240, v2
v_mul_f32 v72, v241, v6
MA 164,v,148,v,100
ds_read_b128 v[120:123], v193 offset:4096
buffer_load_dwordx4 v209, s[44:47], s75 offen offset:1024 lds
MA 196,v,148,v,104
v_fmac_f32 v64, v238, v3
v_fmac_f32 v72, v239, v7
MA 228,v,148,v,108
TR 148,197,16384
TR 150,197,18432
MA 8,v,152,v,80
v_fmac_f32 v64, v236, v4
v_fmac_f32 v72, v237, v8
MA 40,v,152,v,84
buffer_load_dwordx4 v210, s[44:47], s75 offen offset:2048 lds
v_fmac_f32 v64, v234, v5
MA 72,v,152,v,88
v_fmac_f32 v72, v235, v9
v_mul_f32 v64, v64, v254
MA 104,v,152,v,92
v_mul_f32 v72, v72, v255
v_lshlrev_b32 v254, 16, v44
MA 136,v,152,v,96
ds_read_b128 v[124:127], v193 offset:6144
v_and_b32 v255, 0xffff0000, v44
MA 168,v,152,v,100
v_mul_f32 v65, v242, v2
MA 200,v,152,v,104
buffer_load_dwordx4 v211, s[44:47], s75 offen offset:3072 lds
v_mul_f32 v73, v243, v6
MA 232,v,152,v,108
TR 152,198,16384
TR 154,198,18432
MA 12,v,156,v,80
v_fmac_f32 v65, v240, v3
v_fmac_f32 v73, v241, v7
MA 44,v,156,v,84
v_fmac_f32 v65, v238, v4
v_fmac_f32 v73, v239, v8
MA 76,v,156,v,88
ds_read_b128 v[128:131], v193 offset:8192
s_add_u32 s75, s65, s74
MA 108,v,156,v,92
v_fmac_f32 v65, v236, v5
v_fmac_f32 v73, v237, v9
MA 140,v,156,v,96
v_mul_f32 v65, v65, v254
v_mul_f32 v73, v73, v255
MA 172,v,156,v,100
v_lshlrev_b32 v254, 16, v46
MA 204,v,156,v,104
v_and_b32 v255, 0xffff0000, v46
MA 236,v,156,v,108
TR 156,199,16384
TR 158,199,18432
MA 16,v,160,v,80
ds_read_b128 v[132:135], v193 offset:10240
s_add_u32 m0, s67, 69632
MA 48,v,160,v,84
v_mul_f32 v66, v244, v2
v_mul_f32 v74, v245, v6
MA 80,v,160,v,88
v_fmac_f32 v66, v242, v3
v_fmac_f32 v74, v243, v7
MA 112,v,160,v,92
buffer_load_dwordx4 v208, s[44:47], s75 offen offset:0 lds
v_fmac_f32 v66, v240, v4
MA 144,v,160,v,96
v_fmac_f32 v74, v241, v8
v_fmac_f32 v66, v238, v5
MA 176,v,160,v,100
v_fmac_f32 v74, v239, v9
v_mul_f32 v66, v66, v254
MA 208,v,160,v,104
v_mul_f32 v74, v74, v255
v_lshlrev_b32 v254, 16, v48
MA 240,v,160,v,108
TR 160,200,16384
TR 162,200,18432
MA 20,v,164,v,80
ds_read_b128 v[136:139], v193 offset:12288
buffer_load_dwordx4 v209, s[44:47], s75 offen offset:1024 lds
MA 52,v,164,v,84
v_and_b32 v255, 0xffff0000, v48
v_mul_f32 v67, v246, v2
MA 84,v,164,v,88
v_mul_f32 v75, v247, v6
v_fmac_f32 v67, v244, v3
MA 116,v,164,v,92
v_fmac_f32 v75, v245, v7
v_fmac_f32 v67, v242, v4
MA 148,v,164,v,96
buffer_load_dwordx4 v210, s[44:47], s75 offen offset:2048 lds
v_fmac_f32 v75, v243, v8
MA 180,v,164,v,100
ds_read_b128 v[140:143], v193 offset:14336
v_fmac_f32 v67, v240, v5
MA 212,v,164,v,104
v_fmac_f32 v75, v241, v9
v_mul_f32 v67, v67, v254
MA 244,v,164,v,108
TR 164,201,16384
TR 166,201,18432
MA 24,v,168,v,80
buffer_load_dwordx4 v211, s[44:47], s75 offen offset:3072 lds
v_mul_f32 v75, v75, v255
MA 56,v,168,v,84
v_lshlrev_b32 v254, 16, v50
v_and_b32 v255, 0xffff0000, v50
MA 88,v,168,v,88
v_mul_f32 v68, v248, v2
v_mul_f32 v76, v249, v6
MA 120,v,168,v,92
v_fmac_f32 v68, v246, v3
MA 152,v,168,v,96
v_fmac_f32 v76, v247, v7
MA 184,v,168,v,100
s_add_u32 s74, s74, 128
v_fmac_f32 v68, v244, v4
MA 216,v,168,v,104
v_fmac_f32 v76, v245, v8
v_fmac_f32 v68, v242, v5
MA 248,v,168,v,108
TR 168,202,16384
TR 170,202,18432
s_waitcnt lgkmcnt(15)
MA 28,v,172,v,80
v_fmac_f32 v76, v243, v9
v_mul_f32 v68, v68, v254
MA 60,v,172,v,84
s_and_b32 s74, s74, 2047
v_mul_f32 v76, v76, v255
MA 92,v,172,v,88
v_lshlrev_b32 v254, 16, v52
v_and_b32 v255, 0xffff0000, v52
MA 124,v,172,v,92
v_mul_f32 v69, v250, v2
MA 156,v,172,v,96
v_mul_f32 v77, v251, v6
MA 188,v,172,v,100
v_fmac_f32 v69, v248, v3
MA 220,v,172,v,104
MA 252,v,172,v,108
TR 172,203,16384
TR 174,203,18432
s_waitcnt lgkmcnt(2)
MA 0,v,144,v,112
MA 32,v,144,v,116
MA 64,v,144,v,120
MA 96,v,144,v,124
MA 128,v,144,v,128
MA 160,v,144,v,132
MA 192,v,144,v,136
MA 224,v,144,v,140
MA 4,v,148,v,112
MA 36,v,148,v,116
s_waitcnt vmcnt(8) lgkmcnt(0)
s_barrier
MA 68,v,148,v,120
TR 144,196,32768
TR 146,196,34816
MA 100,v,148,v,124
ds_read_b128 v[80:83], v192 offset:32768
s_add_u32 m0, s68, 98304
MA 132,v,148,v,128
v_fmac_f32 v77, v249, v7
v_fmac_f32 v69, v246, v4
MA 164,v,148,v,132
buffer_load_dwordx4 v212, s[48:51], s66 offen offset:0 lds
v_fmac_f32 v77, v247, v8
MA 196,v,148,v,136
v_fmac_f32 v69, v244, v5
v_fmac_f32 v77, v245, v9
MA 228,v,148,v,140
TR 148,197,32768
TR 150,197,34816
MA 8,v,152,v,112
ds_read_b128 v[84:87], v192 offset:34816
v_mul_f32 v69, v69, v254
MA 40,v,152,v,116
buffer_load_dwordx4 v213, s[48:51], s66 offen offset:1024 lds
v_mul_f32 v77, v77, v255
MA 72,v,152,v,120
v_cvt_pk_bf16_f32 v12, v69, v68
v_cvt_pk_bf16_f32 v13, v67, v66
MA 104,v,152,v,124
v_cvt_pk_bf16_f32 v14, v65, v64
v_cvt_pk_bf16_f32 v15, v63, v62
MA 136,v,152,v,128
s_mov_b32 s36, 0
buffer_store_dwordx4 v[12:15], v10, s[84:87], s36 offen sc1
MA 168,v,152,v,132
ds_read_b128 v[88:91], v192 offset:36864
buffer_load_dwordx4 v214, s[48:51], s66 offen offset:2048 lds
MA 200,v,152,v,136
v_cvt_pk_bf16_f32 v54, v77, v76
v_cvt_pk_bf16_f32 v55, v75, v74
MA 232,v,152,v,140
TR 152,198,32768
TR 154,198,34816
MA 12,v,156,v,112
buffer_load_dwordx4 v215, s[48:51], s66 offen offset:3072 lds
v_cvt_pk_bf16_f32 v56, v73, v72
MA 44,v,156,v,116
v_cvt_pk_bf16_f32 v57, v71, v70
s_mov_b32 s36, 4096
MA 76,v,156,v,120
ds_read_b128 v[92:95], v192 offset:38912
buffer_store_dwordx4 v[54:57], v10, s[84:87], s36 offen sc1
MA 108,v,156,v,124
v_lshlrev_b32 v2, 16, v58
v_and_b32 v3, 0xffff0000, v58
MA 140,v,156,v,128
s_add_u32 s66, s66, 524288
v_lshlrev_b32 v4, 16, v59
MA 172,v,156,v,132
v_and_b32 v5, 0xffff0000, v59
v_lshlrev_b32 v6, 16, v60
MA 204,v,156,v,136
v_and_b32 v7, 0xffff0000, v60
v_lshlrev_b32 v8, 16, v61
MA 236,v,156,v,140
TR 156,199,32768
TR 158,199,34816
MA 16,v,160,v,112
ds_read_b128 v[96:99], v192 offset:40960
s_and_b32 s66, s66, 8388607
MA 48,v,160,v,116
v_and_b32 v9, 0xffff0000, v61
v_lshlrev_b32 v230, 16, v17
MA 80,v,160,v,120
v_and_b32 v231, 0xffff0000, v17
v_lshlrev_b32 v232, 16, v19
MA 112,v,160,v,124
v_and_b32 v233, 0xffff0000, v19
v_lshlrev_b32 v234, 16, v21
MA 144,v,160,v,128
ds_read_b128 v[100:103], v192 offset:43008
s_add_u32 m0, s68, 114688
MA 176,v,160,v,132
v_and_b32 v235, 0xffff0000, v21
v_lshlrev_b32 v236, 16, v23
MA 208,v,160,v,136
v_and_b32 v237, 0xffff0000, v23
v_lshlrev_b32 v238, 16, v25
MA 240,v,160,v,140
TR 160,200,32768
TR 162,200,34816
MA 20,v,164,v,112
buffer_load_dwordx4 v212, s[48:51], s66 offen offset:0 lds
v_and_b32 v239, 0xffff0000, v25
MA 52,v,164,v,116
ds_read_b128 v[104:107], v192 offset:45056
v_lshlrev_b32 v240, 16, v27
MA 84,v,164,v,120
v_and_b32 v241, 0xffff0000, v27
v_lshlrev_b32 v242, 16, v29
MA 116,v,164,v,124
buffer_load_dwordx4 v213, s[48:51], s66 offen offset:1024 lds
v_and_b32 v243, 0xffff0000, v29
MA 148,v,164,v,128
v_lshlrev_b32 v244, 16, v31
v_and_b32 v245, 0xffff0000, v31
MA 180,v,164,v,132
v_lshlrev_b32 v246, 16, v33
v_and_b32 v247, 0xffff0000, v33
MA 212,v,164,v,136
ds_read_b128 v[108:111], v192 offset:47104
v_lshlrev_b32 v248, 16, v35
MA 244,v,164,v,140
TR 164,201,32768
TR 166,201,34816
MA 24,v,168,v,112
buffer_load_dwordx4 v214, s[48:51], s66 offen offset:2048 lds
v_and_b32 v249, 0xffff0000, v35
MA 56,v,168,v,116
v_lshlrev_b32 v250, 16, v37
v_and_b32 v251, 0xffff0000, v37
MA 88,v,168,v,120
buffer_load_dwordx4 v215, s[48:51], s66 offen offset:3072 lds
v_lshlrev_b32 v254, 16, v39
MA 120,v,168,v,124
v_and_b32 v255, 0xffff0000, v39
v_mul_f32 v62, v236, v2
MA 152,v,168,v,128
v_mul_f32 v70, v237, v6
v_fmac_f32 v62, v234, v3
MA 184,v,168,v,132
v_fmac_f32 v70, v235, v7
v_fmac_f32 v62, v232, v4
MA 216,v,168,v,136
s_add_u32 s66, s66, 524288
v_fmac_f32 v70, v233, v8
MA 248,v,168,v,140
TR 168,202,32768
TR 170,202,34816
MA 28,v,172,v,112
v_fmac_f32 v62, v230, v5
v_fmac_f32 v70, v231, v9
MA 60,v,172,v,116
v_mul_f32 v62, v62, v254
v_mul_f32 v70, v70, v255
MA 92,v,172,v,120
s_and_b32 s66, s66, 8388607
v_lshlrev_b32 v254, 16, v41
MA 124,v,172,v,124
v_and_b32 v255, 0xffff0000, v41
v_mul_f32 v63, v238, v2
MA 156,v,172,v,128
v_mul_f32 v71, v239, v6
v_fmac_f32 v63, v236, v3
MA 188,v,172,v,132
v_fmac_f32 v71, v237, v7
v_fmac_f32 v63, v234, v4
MA 220,v,172,v,136
v_fmac_f32 v71, v235, v8
v_fmac_f32 v63, v232, v5
MA 252,v,172,v,140
TR 172,203,32768
TR 174,203,34816
v_fmac_f32 v71, v233, v9
v_mul_f32 v63, v63, v254
v_mul_f32 v71, v71, v255
v_lshlrev_b32 v254, 16, v43
v_and_b32 v255, 0xffff0000, v43
v_mul_f32 v64, v240, v2
v_mul_f32 v72, v241, v6
v_fmac_f32 v64, v238, v3
s_waitcnt lgkmcnt(2)
MA 0,v,144,v,80
s_add_u32 s75, s64, s74
v_fmac_f32 v72, v239, v7
MA 32,v,144,v,84
ds_read_b128 v[112:115], v193 offset:32768
v_fmac_f32 v64, v236, v4
MA 64,v,144,v,88
v_fmac_f32 v72, v237, v8
v_fmac_f32 v64, v234, v5
MA 96,v,144,v,92
v_fmac_f32 v72, v235, v9
v_mul_f32 v64, v64, v254
MA 128,v,144,v,96
s_add_u32 m0, s67, 0
v_mul_f32 v72, v72, v255
MA 160,v,144,v,100
v_lshlrev_b32 v254, 16, v45
MA 192,v,144,v,104
v_and_b32 v255, 0xffff0000, v45
v_mul_f32 v65, v242, v2
MA 224,v,144,v,108
TR 144,196,49152
TR 146,196,51200
MA 4,v,148,v,80
ds_read_b128 v[116:119], v193 offset:34816
buffer_load_dwordx4 v208, s[44:47], s75 offen offset:0 lds
MA 36,v,148,v,84
v_mul_f32 v73, v243, v6
v_fmac_f32 v65, v240, v3
MA 68,v,148,v,88
v_fmac_f32 v73, v241, v7
v_fmac_f32 v65, v238, v4
MA 100,v,148,v,92
v_fmac_f32 v73, v239, v8
v_fmac_f32 v65, v236, v5
MA 132,v,148,v,96
v_fmac_f32 v73, v237, v9
MA 164,v,148,v,100
ds_read_b128 v[120:123], v193 offset:36864
buffer_load_dwordx4 v209, s[44:47], s75 offen offset:1024 lds
MA 196,v,148,v,104
v_mul_f32 v65, v65, v254
v_mul_f32 v73, v73, v255
MA 228,v,148,v,108
TR 148,197,49152
TR 150,197,51200
MA 8,v,152,v,80
v_lshlrev_b32 v254, 16, v47
v_and_b32 v255, 0xffff0000, v47
MA 40,v,152,v,84
buffer_load_dwordx4 v210, s[44:47], s75 offen offset:2048 lds
v_mul_f32 v66, v244, v2
MA 72,v,152,v,88
v_mul_f32 v74, v245, v6
v_fmac_f32 v66, v242, v3
MA 104,v,152,v,92
v_fmac_f32 v74, v243, v7
v_fmac_f32 v66, v240, v4
MA 136,v,152,v,96
ds_read_b128 v[124:127], v193 offset:38912
v_fmac_f32 v74, v241, v8
MA 168,v,152,v,100
v_fmac_f32 v66, v238, v5
v_fmac_f32 v74, v239, v9
MA 200,v,152,v,104
buffer_load_dwordx4 v211, s[44:47], s75 offen offset:3072 lds
v_mul_f32 v66, v66, v254
MA 232,v,152,v,108
TR 152,198,49152
TR 154,198,51200
MA 12,v,156,v,80
v_mul_f32 v74, v74, v255
v_lshlrev_b32 v254, 16, v49
MA 44,v,156,v,84
v_and_b32 v255, 0xffff0000, v49
v_mul_f32 v67, v246, v2
MA 76,v,156,v,88
ds_read_b128 v[128:131], v193 offset:40960
s_add_u32 s75, s65, s74
MA 108,v,156,v,92
v_mul_f32 v75, v247, v6
v_fmac_f32 v67, v244, v3
MA 140,v,156,v,96
v_fmac_f32 v75, v245, v7
v_fmac_f32 v67, v242, v4
MA 172,v,156,v,100
v_fmac_f32 v75, v243, v8
MA 204,v,156,v,104
v_fmac_f32 v67, v240, v5
MA 236,v,156,v,108
TR 156,199,49152
TR 158,199,51200
MA 16,v,160,v,80
ds_read_b128 v[132:135], v193 offset:43008
s_add_u32 m0, s67, 4096
MA 48,v,160,v,84
v_fmac_f32 v75, v241, v9
v_mul_f32 v67, v67, v254
MA 80,v,160,v,88
v_mul_f32 v75, v75, v255
v_lshlrev_b32 v254, 16, v51
MA 112,v,160,v,92
buffer_load_dwordx4 v208, s[44:47], s75 offen offset:0 lds
v_and_b32 v255, 0xffff0000, v51
MA 144,v,160,v,96
v_mul_f32 v68, v248, v2
v_mul_f32 v76, v249, v6
MA 176,v,160,v,100
v_fmac_f32 v68, v246, v3
v_fmac_f32 v76, v247, v7
MA 208,v,160,v,104
v_fmac_f32 v68, v244, v4
v_fmac_f32 v76, v245, v8
MA 240,v,160,v,108
TR 160,200,49152
TR 162,200,51200
MA 20,v,164,v,80
ds_read_b128 v[136:139], v193 offset:45056
buffer_load_dwordx4 v209, s[44:47], s75 offen offset:1024 lds
MA 52,v,164,v,84
v_fmac_f32 v68, v242, v5
v_fmac_f32 v76, v243, v9
MA 84,v,164,v,88
v_mul_f32 v68, v68, v254
v_mul_f32 v76, v76, v255
MA 116,v,164,v,92
v_lshlrev_b32 v254, 16, v53
v_and_b32 v255, 0xffff0000, v53
MA 148,v,164,v,96
buffer_load_dwordx4 v210, s[44:47], s75 offen offset:2048 lds
v_mul_f32 v69, v250, v2
MA 180,v,164,v,100
ds_read_b128 v[140:143], v193 offset:47104
v_mul_f32 v77, v251, v6
MA 212,v,164,v,104
v_fmac_f32 v69, v248, v3
v_fmac_f32 v77, v249, v7
MA 244,v,164,v,108
TR 164,201,49152
TR 166,201,51200
MA 24,v,168,v,80
buffer_load_dwordx4 v211, s[44:47], s75 offen offset:3072 lds
v_fmac_f32 v69, v246, v4
MA 56,v,168,v,84
v_fmac_f32 v77, v247, v8
v_fmac_f32 v69, v244, v5
MA 88,v,168,v,88
v_fmac_f32 v77, v245, v9
v_mul_f32 v69, v69, v254
MA 120,v,168,v,92
v_mul_f32 v77, v77, v255
v_cvt_pk_bf16_f32 v230, v69, v68
MA 152,v,168,v,96
v_cvt_pk_bf16_f32 v231, v67, v66
MA 184,v,168,v,100
s_add_u32 s74, s74, 128
v_cvt_pk_bf16_f32 v232, v65, v64
MA 216,v,168,v,104
v_cvt_pk_bf16_f32 v233, v63, v62
MA 248,v,168,v,108
TR 168,202,49152
TR 170,202,51200
s_waitcnt lgkmcnt(15)
MA 28,v,172,v,80
s_mov_b32 s36, 8192
buffer_store_dwordx4 v[230:233], v10, s[84:87], s36 offen sc1
MA 60,v,172,v,84
s_and_b32 s74, s74, 2047
v_cvt_pk_bf16_f32 v234, v77, v76
MA 92,v,172,v,88
v_cvt_pk_bf16_f32 v235, v75, v74
v_cvt_pk_bf16_f32 v236, v73, v72
MA 124,v,172,v,92
v_cvt_pk_bf16_f32 v237, v71, v70
s_mov_b32 s36, 12288
MA 156,v,172,v,96
buffer_store_dwordx4 v[234:237], v10, s[84:87], s36 offen sc1
MA 188,v,172,v,100
v_lshlrev_b32 v228, 4, v1
MA 220,v,172,v,104
MA 252,v,172,v,108
TR 172,203,49152
TR 174,203,51200
s_waitcnt lgkmcnt(2)
MA 0,v,144,v,112
MA 32,v,144,v,116
MA 64,v,144,v,120
MA 96,v,144,v,124
MA 128,v,144,v,128
MA 160,v,144,v,132
MA 192,v,144,v,136
MA 224,v,144,v,140
MA 4,v,148,v,112
MA 36,v,148,v,116
s_waitcnt vmcnt(15) lgkmcnt(0)
s_barrier
MA 68,v,148,v,120
ds_read_b128 v[48:51], v226 offset:0
s_add_u32 m0, s68, 131072
MA 100,v,148,v,124
MA 132,v,148,v,128
ds_read_b128 v[52:55], v226 offset:2048
buffer_load_dwordx4 v212, s[48:51], s66 offen offset:0 lds
MA 164,v,148,v,132
MA 196,v,148,v,136
ds_read_b128 v[56:59], v226 offset:4096
buffer_load_dwordx4 v213, s[48:51], s66 offen offset:1024 lds
MA 228,v,148,v,140
MA 8,v,152,v,112
ds_read_b128 v[60:63], v226 offset:6144
MA 40,v,152,v,116
buffer_load_dwordx4 v214, s[48:51], s66 offen offset:2048 lds
MA 72,v,152,v,120
TR 16,216,0
MA 104,v,152,v,124
buffer_load_dwordx4 v215, s[48:51], s66 offen offset:3072 lds
MA 136,v,152,v,128
TR 18,216,1024
MA 168,v,152,v,132
MA 200,v,152,v,136
TR 20,217,0
s_add_u32 s66, s66, 524288
MA 232,v,152,v,140
MA 12,v,156,v,112
TR 22,217,1024
s_and_b32 s66, s66, 8388607
MA 44,v,156,v,116
MA 76,v,156,v,120
TR 24,218,0
MA 108,v,156,v,124
s_add_u32 s75, s64, s74
MA 140,v,156,v,128
TR 26,218,1024
MA 172,v,156,v,132
s_add_u32 m0, s67, 32768
MA 204,v,156,v,136
TR 28,219,0
MA 236,v,156,v,140
MA 16,v,160,v,112
TR 30,219,1024
buffer_load_dwordx4 v208, s[44:47], s75 offen offset:0 lds
MA 48,v,160,v,116
MA 80,v,160,v,120
TR 32,220,0
buffer_load_dwordx4 v209, s[44:47], s75 offen offset:1024 lds
MA 112,v,160,v,124
MA 144,v,160,v,128
TR 34,220,1024
MA 176,v,160,v,132
buffer_load_dwordx4 v210, s[44:47], s75 offen offset:2048 lds
MA 208,v,160,v,136
TR 36,221,0
MA 240,v,160,v,140
buffer_load_dwordx4 v211, s[44:47], s75 offen offset:3072 lds
MA 20,v,164,v,112
TR 38,221,1024
MA 52,v,164,v,116
MA 84,v,164,v,120
TR 40,222,0
s_add_u32 s75, s65, s74
MA 116,v,164,v,124
MA 148,v,164,v,128
TR 42,222,1024
s_add_u32 m0, s67, 36864
MA 180,v,164,v,132
MA 212,v,164,v,136
TR 44,223,0
MA 244,v,164,v,140
buffer_load_dwordx4 v208, s[44:47], s75 offen offset:0 lds
MA 24,v,168,v,112
TR 46,223,1024
MA 56,v,168,v,116
buffer_load_dwordx4 v209, s[44:47], s75 offen offset:1024 lds
MA 88,v,168,v,120
MA 120,v,168,v,124
MA 152,v,168,v,128
buffer_load_dwordx4 v210, s[44:47], s75 offen offset:2048 lds
MA 184,v,168,v,132
MA 216,v,168,v,136
buffer_load_dwordx4 v211, s[44:47], s75 offen offset:3072 lds
MA 248,v,168,v,140
MA 28,v,172,v,112
MA 60,v,172,v,116
s_add_u32 s74, s74, 128
MA 92,v,172,v,120
MA 124,v,172,v,124
s_and_b32 s74, s74, 2047
MA 156,v,172,v,128
MA 188,v,172,v,132
MA 220,v,172,v,136
MA 252,v,172,v,140
s_branch L_p2
L_p1_V:
s_waitcnt lgkmcnt(14)
v_mfma_f32_16x16x32_bf16 a[0:3], v[80:83], v[144:147], 0
s_add_u32 m0, s23, 32768
v_lshlrev_b32 v74, 7, v1
v_mfma_f32_16x16x32_bf16 a[4:7], v[84:87], v[144:147], 0
ds_read_b128 v[112:115], v193 offset:0
v_mfma_f32_16x16x32_bf16 a[64:67], v[88:91], v[144:147], 0
buffer_load_dwordx4 v184, s[12:15], s21 offen offset:0 lds
v_mfma_f32_16x16x32_bf16 a[68:71], v[92:95], v[144:147], 0
v_mfma_f32_16x16x32_bf16 a[128:131], v[96:99], v[144:147], 0
s_getpc_b64 s[4:5]
L_pcV:
v_mfma_f32_16x16x32_bf16 a[132:135], v[100:103], v[144:147], 0
buffer_load_dwordx4 v185, s[12:15], s21 offen offset:1024 lds
v_mfma_f32_16x16x32_bf16 a[192:195], v[104:107], v[144:147], 0
v_mfma_f32_16x16x32_bf16 a[196:199], v[108:111], v[144:147], 0
TR 144,196,16384
TR 146,196,18432
s_waitcnt lgkmcnt(15)
v_mfma_f32_16x16x32_bf16 a[8:11], v[80:83], v[148:151], 0
ds_read_b128 v[116:119], v193 offset:2048
buffer_load_dwordx4 v186, s[12:15], s21 offen offset:2048 lds
v_mfma_f32_16x16x32_bf16 a[12:15], v[84:87], v[148:151], 0
s_lshr_b32 s98, s2, 3
v_mfma_f32_16x16x32_bf16 a[72:75], v[88:91], v[148:151], 0
buffer_load_dwordx4 v187, s[12:15], s21 offen offset:3072 lds
v_mfma_f32_16x16x32_bf16 a[76:79], v[92:95], v[148:151], 0
v_mfma_f32_16x16x32_bf16 a[136:139], v[96:99], v[148:151], 0
s_add_u32 m0, s23, 36864
s_lshl_b32 s98, s98, 2
v_mfma_f32_16x16x32_bf16 a[140:143], v[100:103], v[148:151], 0
ds_read_b128 v[120:123], v193 offset:4096
v_mfma_f32_16x16x32_bf16 a[200:203], v[104:107], v[148:151], 0
v_mfma_f32_16x16x32_bf16 a[204:207], v[108:111], v[148:151], 0
TR 148,197,16384
TR 150,197,18432
s_waitcnt lgkmcnt(15)
v_mfma_f32_16x16x32_bf16 a[16:19], v[80:83], v[152:155], 0
buffer_load_dwordx4 v188, s[12:15], s21 offen offset:0 lds
s_add_u32 s98, s98, s3
v_mfma_f32_16x16x32_bf16 a[20:23], v[84:87], v[152:155], 0
v_mfma_f32_16x16x32_bf16 a[80:83], v[88:91], v[152:155], 0
buffer_load_dwordx4 v189, s[12:15], s21 offen offset:1024 lds
v_mfma_f32_16x16x32_bf16 a[84:87], v[92:95], v[152:155], 0
v_mfma_f32_16x16x32_bf16 a[144:147], v[96:99], v[152:155], 0
ds_read_b128 v[124:127], v193 offset:6144
buffer_load_dwordx4 v190, s[12:15], s21 offen offset:2048 lds
v_mfma_f32_16x16x32_bf16 a[148:151], v[100:103], v[152:155], 0
s_lshl_b32 s98, s98, 10
v_mfma_f32_16x16x32_bf16 a[208:211], v[104:107], v[152:155], 0
v_mfma_f32_16x16x32_bf16 a[212:215], v[108:111], v[152:155], 0
TR 152,198,16384
TR 154,198,18432
v_mfma_f32_16x16x32_bf16 a[24:27], v[80:83], v[156:159], 0
buffer_load_dwordx4 v191, s[12:15], s21 offen offset:3072 lds
v_and_b32 v75, 0x380, v74
v_mfma_f32_16x16x32_bf16 a[28:31], v[84:87], v[156:159], 0
s_add_u32 s21, s21, 524288
v_mfma_f32_16x16x32_bf16 a[88:91], v[88:91], v[156:159], 0
ds_read_b128 v[128:131], v193 offset:8192
v_mfma_f32_16x16x32_bf16 a[92:95], v[92:95], v[156:159], 0
v_mfma_f32_16x16x32_bf16 a[152:155], v[96:99], v[156:159], 0
s_and_b32 s21, s21, 4194303
v_add_u32 v75, s98, v75
v_mfma_f32_16x16x32_bf16 a[156:159], v[100:103], v[156:159], 0
v_mfma_f32_16x16x32_bf16 a[216:219], v[104:107], v[156:159], 0
v_mfma_f32_16x16x32_bf16 a[220:223], v[108:111], v[156:159], 0
TR 156,199,16384
TR 158,199,18432
s_waitcnt lgkmcnt(15)
v_mfma_f32_16x16x32_bf16 a[32:35], v[80:83], v[160:163], 0
ds_read_b128 v[132:135], v193 offset:10240
s_add_u32 m0, s22, 32768
v_mfma_f32_16x16x32_bf16 a[36:39], v[84:87], v[160:163], 0
buffer_load_dwordx4 v176, s[8:11], s20 offen offset:0 lds
v_min_u32 v75, L_code_end - L_pcV - 4, v75
v_mfma_f32_16x16x32_bf16 a[96:99], v[88:91], v[160:163], 0
v_mfma_f32_16x16x32_bf16 a[100:103], v[92:95], v[160:163], 0
v_mfma_f32_16x16x32_bf16 a[160:163], v[96:99], v[160:163], 0
buffer_load_dwordx4 v177, s[8:11], s20 offen offset:1024 lds
v_mfma_f32_16x16x32_bf16 a[164:167], v[100:103], v[160:163], 0
v_mov_b32 v77, s5
v_mfma_f32_16x16x32_bf16 a[224:227], v[104:107], v[160:163], 0
buffer_load_dwordx4 v178, s[8:11], s20 offen offset:2048 lds
v_mfma_f32_16x16x32_bf16 a[228:231], v[108:111], v[160:163], 0
TR 160,200,16384
TR 162,200,18432
v_mfma_f32_16x16x32_bf16 a[40:43], v[80:83], v[164:167], 0
ds_read_b128 v[136:139], v193 offset:12288
v_mfma_f32_16x16x32_bf16 a[44:47], v[84:87], v[164:167], 0
buffer_load_dwordx4 v179, s[8:11], s20 offen offset:3072 lds
v_mfma_f32_16x16x32_bf16 a[104:107], v[88:91], v[164:167], 0
v_add_co_u32 v76, vcc, s4, v75
s_nop 1
v_addc_co_u32 v77, vcc, 0, v77, vcc
v_mfma_f32_16x16x32_bf16 a[108:111], v[92:95], v[164:167], 0
s_add_u32 m0, s22, 36864
v_mfma_f32_16x16x32_bf16 a[168:171], v[96:99], v[164:167], 0
v_mfma_f32_16x16x32_bf16 a[172:175], v[100:103], v[164:167], 0
ds_read_b128 v[140:143], v193 offset:14336
v_mfma_f32_16x16x32_bf16 a[232:235], v[104:107], v[164:167], 0
buffer_load_dwordx4 v180, s[8:11], s20 offen offset:0 lds
v_mfma_f32_16x16x32_bf16 a[236:239], v[108:111], v[164:167], 0
TR 164,201,16384
TR 166,201,18432
v_mfma_f32_16x16x32_bf16 a[48:51], v[80:83], v[168:171], 0
v_mfma_f32_16x16x32_bf16 a[52:55], v[84:87], v[168:171], 0
buffer_load_dwordx4 v181, s[8:11], s20 offen offset:1024 lds
v_mfma_f32_16x16x32_bf16 a[112:115], v[88:91], v[168:171], 0
v_mfma_f32_16x16x32_bf16 a[116:119], v[92:95], v[168:171], 0
buffer_load_dwordx4 v182, s[8:11], s20 offen offset:2048 lds
v_mfma_f32_16x16x32_bf16 a[176:179], v[96:99], v[168:171], 0
v_mfma_f32_16x16x32_bf16 a[180:183], v[100:103], v[168:171], 0
v_mfma_f32_16x16x32_bf16 a[240:243], v[104:107], v[168:171], 0
buffer_load_dwordx4 v183, s[8:11], s20 offen offset:3072 lds
v_mfma_f32_16x16x32_bf16 a[244:247], v[108:111], v[168:171], 0
TR 168,202,16384
TR 170,202,18432
s_waitcnt lgkmcnt(15)
v_mfma_f32_16x16x32_bf16 a[56:59], v[80:83], v[172:175], 0
s_add_u32 s20, s20, 128
v_mfma_f32_16x16x32_bf16 a[60:63], v[84:87], v[172:175], 0
global_load_dword v79, v[76:77], off
v_mfma_f32_16x16x32_bf16 a[120:123], v[88:91], v[172:175], 0
v_mfma_f32_16x16x32_bf16 a[124:127], v[92:95], v[172:175], 0
s_and_b32 s20, s20, 1023
v_mfma_f32_16x16x32_bf16 a[184:187], v[96:99], v[172:175], 0
v_mfma_f32_16x16x32_bf16 a[188:191], v[100:103], v[172:175], 0
v_mfma_f32_16x16x32_bf16 a[248:251], v[104:107], v[172:175], 0
v_mfma_f32_16x16x32_bf16 a[252:255], v[108:111], v[172:175], 0
TR 172,203,16384
TR 174,203,18432
s_waitcnt lgkmcnt(2)
MA 0,v,112,v,144
s_add_u32 m0, s22, 65536
MA 4,v,116,v,144
MA 64,v,120,v,144
MA 68,v,124,v,144
buffer_load_dwordx4 v176, s[8:11], s20 offen offset:0 lds
MA 128,v,128,v,144
MA 132,v,132,v,144
MA 192,v,136,v,144
MA 196,v,140,v,144
buffer_load_dwordx4 v177, s[8:11], s20 offen offset:1024 lds
MA 8,v,112,v,148
MA 12,v,116,v,148
MA 72,v,120,v,148
buffer_load_dwordx4 v178, s[8:11], s20 offen offset:2048 lds
MA 76,v,124,v,148
MA 136,v,128,v,148
MA 140,v,132,v,148
MA 200,v,136,v,148
buffer_load_dwordx4 v179, s[8:11], s20 offen offset:3072 lds
MA 204,v,140,v,148
MA 16,v,112,v,152
MA 20,v,116,v,152
s_add_u32 m0, s22, 69632
MA 80,v,120,v,152
MA 84,v,124,v,152
MA 144,v,128,v,152
MA 148,v,132,v,152
buffer_load_dwordx4 v180, s[8:11], s20 offen offset:0 lds
MA 208,v,136,v,152
MA 212,v,140,v,152
MA 24,v,112,v,156
MA 28,v,116,v,156
buffer_load_dwordx4 v181, s[8:11], s20 offen offset:1024 lds
MA 88,v,120,v,156
MA 92,v,124,v,156
MA 152,v,128,v,156
buffer_load_dwordx4 v182, s[8:11], s20 offen offset:2048 lds
MA 156,v,132,v,156
MA 216,v,136,v,156
MA 220,v,140,v,156
MA 32,v,112,v,160
buffer_load_dwordx4 v183, s[8:11], s20 offen offset:3072 lds
MA 36,v,116,v,160
MA 96,v,120,v,160
MA 100,v,124,v,160
s_add_u32 s20, s20, 128
MA 160,v,128,v,160
MA 164,v,132,v,160
MA 224,v,136,v,160
MA 228,v,140,v,160
s_and_b32 s20, s20, 1023
MA 40,v,112,v,164
MA 44,v,116,v,164
MA 104,v,120,v,164
MA 108,v,124,v,164
MA 168,v,128,v,164
s_waitcnt vmcnt(9) lgkmcnt(0)
s_barrier
MA 172,v,132,v,164
TR 144,196,32768
TR 146,196,34816
MA 232,v,136,v,164
ds_read_b128 v[80:83], v192 offset:32768
s_add_u32 m0, s23, 0
MA 236,v,140,v,164
TR 148,197,32768
TR 150,197,34816
MA 48,v,112,v,168
ds_read_b128 v[84:87], v192 offset:34816
ds_read_b128 v[88:91], v192 offset:36864
MA 52,v,116,v,168
TR 152,198,32768
TR 154,198,34816
MA 112,v,120,v,168
ds_read_b128 v[92:95], v192 offset:38912
ds_read_b128 v[96:99], v192 offset:40960
MA 116,v,124,v,168
TR 156,199,32768
TR 158,199,34816
MA 176,v,128,v,168
ds_read_b128 v[100:103], v192 offset:43008
ds_read_b128 v[104:107], v192 offset:45056
MA 180,v,132,v,168
TR 160,200,32768
TR 162,200,34816
MA 240,v,136,v,168
ds_read_b128 v[108:111], v192 offset:47104
buffer_load_dwordx4 v184, s[12:15], s21 offen offset:0 lds
MA 244,v,140,v,168
TR 164,201,32768
TR 166,201,34816
MA 56,v,112,v,172
buffer_load_dwordx4 v185, s[12:15], s21 offen offset:1024 lds
buffer_load_dwordx4 v186, s[12:15], s21 offen offset:2048 lds
MA 60,v,116,v,172
TR 168,202,32768
TR 170,202,34816
MA 120,v,120,v,172
buffer_load_dwordx4 v187, s[12:15], s21 offen offset:3072 lds
s_add_u32 m0, s23, 4096
MA 124,v,124,v,172
buffer_load_dwordx4 v188, s[12:15], s21 offen offset:0 lds
buffer_load_dwordx4 v189, s[12:15], s21 offen offset:1024 lds
MA 184,v,128,v,172
buffer_load_dwordx4 v190, s[12:15], s21 offen offset:2048 lds
buffer_load_dwordx4 v191, s[12:15], s21 offen offset:3072 lds
MA 188,v,132,v,172
s_add_u32 s21, s21, 524288
s_and_b32 s21, s21, 4194303
MA 248,v,136,v,172
s_load_dwordx2 s[84:85], s[0:1], 8
s_load_dwordx2 s[88:89], s[0:1], 16
MA 252,v,140,v,172
TR 172,203,32768
TR 174,203,34816
s_load_dwordx2 s[92:93], s[0:1], 0
s_load_dwordx2 s[96:97], s[0:1], 24
s_load_dwordx2 s[76:77], s[0:1], 96
s_waitcnt lgkmcnt(2)
MA 0,v,80,v,144
s_add_u32 m0, s22, 0
MA 4,v,84,v,144
ds_read_b128 v[112:115], v193 offset:32768
MA 64,v,88,v,144
s_mov_b32 s4, s34
s_mov_b32 s5, s35
MA 68,v,92,v,144
MA 128,v,96,v,144
MA 132,v,100,v,144
buffer_load_dwordx4 v176, s[8:11], s20 offen offset:0 lds
MA 192,v,104,v,144
MA 196,v,108,v,144
TR 144,196,49152
TR 146,196,51200
MA 8,v,80,v,148
ds_read_b128 v[116:119], v193 offset:34816
MA 12,v,84,v,148
s_mov_b32 s6, 8388608
s_mov_b32 s7, 0x20000
MA 72,v,88,v,148
buffer_load_dwordx4 v177, s[8:11], s20 offen offset:1024 lds
MA 76,v,92,v,148
MA 136,v,96,v,148
MA 140,v,100,v,148
ds_read_b128 v[120:123], v193 offset:36864
MA 200,v,104,v,148
MA 204,v,108,v,148
TR 148,197,49152
TR 150,197,51200
MA 16,v,80,v,152
buffer_load_dwordx4 v178, s[8:11], s20 offen offset:2048 lds
s_lshr_b32 s43, s2, 3
MA 20,v,84,v,152
MA 80,v,88,v,152
MA 84,v,92,v,152
s_lshl_b32 s43, s43, 2
MA 144,v,96,v,152
ds_read_b128 v[124:127], v193 offset:38912
buffer_load_dwordx4 v179, s[8:11], s20 offen offset:3072 lds
MA 148,v,100,v,152
MA 208,v,104,v,152
MA 212,v,108,v,152
TR 152,198,49152
TR 154,198,51200
MA 24,v,80,v,156
s_add_u32 s43, s43, s3
MA 28,v,84,v,156
s_add_u32 m0, s22, 4096
MA 88,v,88,v,156
ds_read_b128 v[128:131], v193 offset:40960
MA 92,v,92,v,156
s_lshl_b32 s43, s43, 16
MA 152,v,96,v,156
MA 156,v,100,v,156
MA 216,v,104,v,156
MA 220,v,108,v,156
TR 156,199,49152
TR 158,199,51200
MA 32,v,80,v,160
ds_read_b128 v[132:135], v193 offset:43008
buffer_load_dwordx4 v180, s[8:11], s20 offen offset:0 lds
MA 36,v,84,v,160
s_and_b32 s37, s2, 7
MA 96,v,88,v,160
s_lshl_b32 s37, s37, 10
MA 100,v,92,v,160
MA 160,v,96,v,160
buffer_load_dwordx4 v181, s[8:11], s20 offen offset:1024 lds
MA 164,v,100,v,160
MA 224,v,104,v,160
s_add_u32 s43, s43, s37
MA 228,v,108,v,160
TR 160,200,49152
TR 162,200,51200
MA 40,v,80,v,164
ds_read_b128 v[136:139], v193 offset:45056
MA 44,v,84,v,164
buffer_load_dwordx4 v182, s[8:11], s20 offen offset:2048 lds
MA 104,v,88,v,164
v_lshrrev_b32 v78, 3, v1
MA 108,v,92,v,164
MA 168,v,96,v,164
MA 172,v,100,v,164
ds_read_b128 v[140:143], v193 offset:47104
MA 232,v,104,v,164
buffer_load_dwordx4 v183, s[8:11], s20 offen offset:3072 lds
s_waitcnt vmcnt(24)
v_and_b32 v79, 7, v1
MA 236,v,108,v,164
TR 164,201,49152
TR 166,201,51200
MA 48,v,80,v,168
MA 52,v,84,v,168
MA 112,v,88,v,168
v_lshlrev_b32 v79, 7, v79
MA 116,v,92,v,168
s_add_u32 s20, s20, 128
MA 176,v,96,v,168
MA 180,v,100,v,168
MA 240,v,104,v,168
v_lshl_add_u32 v78, v78, 13, v79
MA 244,v,108,v,168
TR 168,202,49152
TR 170,202,51200
s_waitcnt lgkmcnt(15)
MA 56,v,80,v,172
s_and_b32 s20, s20, 1023
MA 60,v,84,v,172
MA 120,v,88,v,172
v_add_u32 v78, s43, v78
MA 124,v,92,v,172
MA 184,v,96,v,172
MA 188,v,100,v,172
MA 248,v,104,v,172
MA 252,v,108,v,172
TR 172,203,49152
TR 174,203,51200
s_waitcnt lgkmcnt(2)
MA 0,v,112,v,144
MA 4,v,116,v,144
MA 64,v,120,v,144
MA 68,v,124,v,144
MA 128,v,128,v,144
MA 132,v,132,v,144
MA 192,v,136,v,144
MA 196,v,140,v,144
MA 8,v,112,v,148
MA 12,v,116,v,148
s_waitcnt vmcnt(8) lgkmcnt(0)
s_barrier
MA 72,v,120,v,148
TR 144,196,0
TR 146,196,2048
MA 76,v,124,v,148
ds_read_b128 v[80:83], v194 offset:0
s_add_u32 m0, s23, 32768
MA 136,v,128,v,148
s_mov_b32 s86, 4194304
s_mov_b32 s87, 0x20000
MA 140,v,132,v,148
s_mov_b32 s90, 4194304
s_mov_b32 s91, 0x20000
MA 200,v,136,v,148
buffer_load_dwordx4 v184, s[12:15], s21 offen offset:0 lds
MA 204,v,140,v,148
TR 148,197,0
TR 150,197,2048
MA 16,v,112,v,152
ds_read_b128 v[84:87], v194 offset:2048
s_mov_b32 s94, 4194304
MA 20,v,116,v,152
s_mov_b32 s95, 0x20000
s_mov_b32 s98, 8192
MA 80,v,120,v,152
buffer_load_dwordx4 v185, s[12:15], s21 offen offset:1024 lds
s_mov_b32 s99, 0x20000
MA 84,v,124,v,152
MA 144,v,128,v,152
s_mov_b32 s78, 2048
MA 148,v,132,v,152
ds_read_b128 v[88:91], v194 offset:4096
s_mov_b32 s79, 0x20000
MA 208,v,136,v,152
s_and_b32 s36, s2, 15
MA 212,v,140,v,152
TR 152,198,0
TR 154,198,2048
MA 24,v,112,v,156
buffer_load_dwordx4 v186, s[12:15], s21 offen offset:2048 lds
s_lshl_b32 s36, s36, 1
MA 28,v,116,v,156
s_lshr_b32 s37, s3, 1
MA 88,v,120,v,156
ds_read_b128 v[92:95], v194 offset:6144
s_add_u32 s36, s36, s37
MA 92,v,124,v,156
buffer_load_dwordx4 v187, s[12:15], s21 offen offset:3072 lds
s_lshl_b32 s36, s36, 3
MA 152,v,128,v,156
MA 156,v,132,v,156
v_and_b32 v252, 7, v1
MA 216,v,136,v,156
v_add_u32 v252, s36, v252
MA 220,v,140,v,156
TR 156,199,0
TR 158,199,2048
MA 32,v,112,v,160
ds_read_b128 v[96:99], v194 offset:8192
s_add_u32 m0, s23, 36864
MA 36,v,116,v,160
s_lshr_b32 s36, s2, 4
s_lshl_b32 s36, s36, 1
MA 96,v,120,v,160
s_and_b32 s37, s3, 1
MA 100,v,124,v,160
s_add_u32 s36, s36, s37
MA 160,v,128,v,160
ds_read_b128 v[100:103], v194 offset:10240
buffer_load_dwordx4 v188, s[12:15], s21 offen offset:0 lds
MA 164,v,132,v,160
s_lshl_b32 s36, s36, 3
v_lshrrev_b32 v253, 3, v1
MA 224,v,136,v,160
MA 228,v,140,v,160
TR 160,200,0
TR 162,200,2048
MA 40,v,112,v,164
buffer_load_dwordx4 v189, s[12:15], s21 offen offset:1024 lds
v_add_u32 v253, s36, v253
MA 44,v,116,v,164
ds_read_b128 v[104:107], v194 offset:12288
v_lshlrev_b32 v254, 14, v253
MA 104,v,120,v,164
v_lshl_add_u32 v254, v252, 3, v254
v_add_u32 v229, -6144, v254
MA 108,v,124,v,164
MA 168,v,128,v,164
buffer_load_dwordx4 v190, s[12:15], s21 offen offset:2048 lds
v_lshlrev_b32 v62, 5, v252
MA 172,v,132,v,164
v_lshlrev_b32 v254, 4, v253
MA 232,v,136,v,164
ds_read_b128 v[108:111], v194 offset:14336
v_sub_u32 v254, 4080, v254
MA 236,v,140,v,164
TR 164,201,0
TR 166,201,2048
MA 48,v,112,v,168
v_lshl_add_u32 v10, v252, 14, v254
MA 52,v,116,v,168
buffer_load_dwordx4 v191, s[12:15], s21 offen offset:3072 lds
v_and_b32 v252, 31, v1
MA 112,v,120,v,168
v_lshlrev_b32 v64, 4, v252
MA 116,v,124,v,168
s_lshl_b32 s36, s2, 2
MA 176,v,128,v,168
MA 180,v,132,v,168
s_add_u32 s21, s21, 524288
s_add_u32 s36, s36, s3
MA 240,v,136,v,168
s_lshl_b32 s36, s36, 1
MA 244,v,140,v,168
TR 168,202,0
TR 170,202,2048
MA 56,v,112,v,172
v_lshrrev_b32 v253, 5, v1
v_add_u32 v253, s36, v253
MA 60,v,116,v,172
s_and_b32 s21, s21, 4194303
MA 120,v,120,v,172
v_lshl_add_u32 v63, v253, 11, v64
MA 124,v,124,v,172
v_lshlrev_b32 v253, 2, v253
MA 184,v,128,v,172
v_lshl_add_u32 v11, v252, 20, v253
MA 188,v,132,v,172
MA 248,v,136,v,172
MA 252,v,140,v,172
TR 172,203,0
TR 174,203,2048
s_waitcnt lgkmcnt(2)
MA 0,v,80,v,144
s_add_u32 m0, s22, 32768
buffer_load_dwordx4 v[230:233], v63, s[92:95], 0 offen offset:0
MA 4,v,84,v,144
ds_read_b128 v[112:115], v195 offset:0
MA 64,v,88,v,144
MA 68,v,92,v,144
MA 128,v,96,v,144
buffer_load_dwordx4 v[2:5], v64, s[76:79], 0 offen offset:0
MA 132,v,100,v,144
buffer_load_dwordx4 v176, s[8:11], s20 offen offset:0 lds
MA 192,v,104,v,144
MA 196,v,108,v,144
TR 144,196,16384
TR 146,196,18432
MA 8,v,80,v,148
ds_read_b128 v[116:119], v195 offset:2048
MA 12,v,84,v,148
buffer_load_dwordx4 v[234:237], v63, s[92:95], 0 offen offset:512
MA 72,v,88,v,148
buffer_load_dwordx4 v177, s[8:11], s20 offen offset:1024 lds
MA 76,v,92,v,148
MA 136,v,96,v,148
MA 140,v,100,v,148
ds_read_b128 v[120:123], v195 offset:4096
MA 200,v,104,v,148
buffer_load_dwordx4 v[6:9], v64, s[76:79], 0 offen offset:512
MA 204,v,108,v,148
TR 148,197,16384
TR 150,197,18432
MA 16,v,80,v,152
buffer_load_dwordx4 v178, s[8:11], s20 offen offset:2048 lds
MA 20,v,84,v,152
MA 80,v,88,v,152
MA 84,v,92,v,152
buffer_load_dwordx4 v[238:241], v63, s[92:95], 0 offen offset:1024
MA 144,v,96,v,152
ds_read_b128 v[124:127], v195 offset:6144
buffer_load_dwordx4 v179, s[8:11], s20 offen offset:3072 lds
MA 148,v,100,v,152
MA 208,v,104,v,152
MA 212,v,108,v,152
TR 152,198,16384
TR 154,198,18432
MA 24,v,80,v,156
buffer_load_dwordx4 v[12:15], v64, s[76:79], 0 offen offset:1024
MA 28,v,84,v,156
s_add_u32 m0, s22, 36864
MA 88,v,88,v,156
ds_read_b128 v[128:131], v195 offset:8192
MA 92,v,92,v,156
MA 152,v,96,v,156
buffer_load_dwordx4 v[242:245], v63, s[92:95], 0 offen offset:1536
MA 156,v,100,v,156
MA 216,v,104,v,156
MA 220,v,108,v,156
TR 156,199,16384
TR 158,199,18432
MA 32,v,80,v,160
ds_read_b128 v[132:135], v195 offset:10240
buffer_load_dwordx4 v180, s[8:11], s20 offen offset:0 lds
MA 36,v,84,v,160
buffer_load_dwordx4 v[246:249], v64, s[76:79], 0 offen offset:1536
MA 96,v,88,v,160
MA 100,v,92,v,160
MA 160,v,96,v,160
buffer_load_dwordx4 v181, s[8:11], s20 offen offset:1024 lds
MA 164,v,100,v,160
MA 224,v,104,v,160
buffer_load_dwordx4 v[54:57], v62, s[96:99], 0 offen offset:0
MA 228,v,108,v,160
TR 160,200,16384
TR 162,200,18432
MA 40,v,80,v,164
ds_read_b128 v[136:139], v195 offset:12288
MA 44,v,84,v,164
buffer_load_dwordx4 v182, s[8:11], s20 offen offset:2048 lds
MA 104,v,88,v,164
buffer_load_dwordx4 v[58:61], v62, s[96:99], 0 offen offset:16
MA 108,v,92,v,164
MA 168,v,96,v,164
MA 172,v,100,v,164
ds_read_b128 v[140:143], v195 offset:14336
MA 232,v,104,v,164
buffer_load_dwordx4 v183, s[8:11], s20 offen offset:3072 lds
MA 236,v,108,v,164
TR 164,201,16384
TR 166,201,18432
MA 48,v,80,v,168
v_add_u32 v252, 0, v229
MA 52,v,84,v,168
MA 112,v,88,v,168
MA 116,v,92,v,168
s_add_u32 s20, s20, 128
MA 176,v,96,v,168
buffer_load_dwordx2 v[16:17], v252, s[84:87], 0 offen
MA 180,v,100,v,168
MA 240,v,104,v,168
MA 244,v,108,v,168
TR 168,202,16384
TR 170,202,18432
s_waitcnt lgkmcnt(15)
MA 56,v,80,v,172
s_and_b32 s20, s20, 1023
MA 60,v,84,v,172
v_add_u32 v253, 2048, v229
MA 120,v,88,v,172
MA 124,v,92,v,172
MA 184,v,96,v,172
MA 188,v,100,v,172
MA 248,v,104,v,172
MA 252,v,108,v,172
TR 172,203,16384
TR 174,203,18432
s_waitcnt lgkmcnt(2)
MA 0,v,112,v,144
MA 4,v,116,v,144
MA 64,v,120,v,144
MA 68,v,124,v,144
MA 128,v,128,v,144
MA 132,v,132,v,144
MA 192,v,136,v,144
MA 196,v,140,v,144
MA 8,v,112,v,148
MA 12,v,116,v,148
s_waitcnt vmcnt(19) lgkmcnt(0)
s_barrier
MA 72,v,120,v,148
TR 144,196,32768
TR 146,196,34816
MA 76,v,124,v,148
ds_read_b128 v[80:83], v192 offset:0
s_add_u32 m0, s23, 0
MA 136,v,128,v,148
s_bfe_u32 s80, s2, 0x20001
s_bfe_u32 s69, s2, 0x30003
MA 140,v,132,v,148
s_lshl_b32 s80, s80, 3
s_add_u32 s69, s69, s80
MA 200,v,136,v,148
buffer_load_dwordx4 v184, s[12:15], s21 offen offset:0 lds
s_lshr_b32 s80, s2, 6
MA 204,v,140,v,148
TR 148,197,32768
TR 150,197,34816
MA 16,v,112,v,152
ds_read_b128 v[84:87], v192 offset:2048
s_xor_b32 s81, s80, s2
MA 20,v,116,v,152
s_and_b32 s81, s81, 1
s_lshl_b32 s70, s80, 1
MA 80,v,120,v,152
buffer_load_dwordx4 v185, s[12:15], s21 offen offset:1024 lds
s_add_u32 s70, s70, s81
MA 84,v,124,v,152
s_lshl_b32 s80, s3, 1
s_sub_u32 s80, 7, s80
MA 144,v,128,v,152
s_lshl_b32 s76, s80, 17
s_lshl_b32 s80, s3, 15
MA 148,v,132,v,152
ds_read_b128 v[88:91], v192 offset:4096
s_lshl_b32 s65, s70, 18
MA 208,v,136,v,152
s_sub_u32 s64, 3932160, s65
MA 212,v,140,v,152
TR 152,198,32768
TR 154,198,34816
MA 24,v,112,v,156
buffer_load_dwordx4 v186, s[12:15], s21 offen offset:2048 lds
s_add_u32 s65, s65, s80
MA 28,v,116,v,156
s_add_u32 s64, s64, s80
s_lshl_b32 s81, s69, 12
MA 88,v,120,v,156
ds_read_b128 v[92:95], v192 offset:6144
s_lshl_b32 s100, s64, 2
MA 92,v,124,v,156
buffer_load_dwordx4 v187, s[12:15], s21 offen offset:3072 lds
s_add_u32 s100, s100, s81
MA 152,v,128,v,156
s_lshl_b32 s101, s65, 2
MA 156,v,132,v,156
s_add_u32 s101, s101, s81
MA 216,v,136,v,156
s_lshl_b32 s66, s3, 17
s_lshl_b32 s81, s69, 8
MA 220,v,140,v,156
TR 156,199,32768
TR 158,199,34816
MA 32,v,112,v,160
ds_read_b128 v[96:99], v192 offset:8192
s_add_u32 m0, s23, 4096
MA 36,v,116,v,160
s_add_u32 s66, s66, s81
s_and_b32 s74, s2, 7
MA 96,v,120,v,160
s_lshl_b32 s74, s74, 8
s_mov_b32 s82, s66
MA 100,v,124,v,160
s_lshl_b32 s66, s74, 12
MA 160,v,128,v,160
ds_read_b128 v[100:103], v192 offset:10240
buffer_load_dwordx4 v188, s[12:15], s21 offen offset:0 lds
MA 164,v,132,v,160
s_lshl_b32 s67, s3, 13
s_lshl_b32 s68, s3, 12
MA 224,v,136,v,160
s_lshl_b32 s77, s70, 1
MA 228,v,140,v,160
TR 160,200,32768
TR 162,200,34816
MA 40,v,112,v,164
buffer_load_dwordx4 v189, s[12:15], s21 offen offset:1024 lds
s_sub_u32 s77, 32, s77
MA 44,v,116,v,164
ds_read_b128 v[104:107], v192 offset:12288
v_lshrrev_b32 v66, 3, v1
MA 104,v,120,v,164
v_lshlrev_b32 v66, 11, v66
v_lshrrev_b32 v67, 4, v1
MA 108,v,124,v,164
v_and_b32 v68, 7, v1
v_xor_b32 v68, v68, v67
MA 168,v,128,v,164
buffer_load_dwordx4 v190, s[12:15], s21 offen offset:2048 lds
v_lshl_add_u32 v66, v68, 4, v66
MA 172,v,132,v,164
v_xor_b32 v69, 64, v66
MA 232,v,136,v,164
ds_read_b128 v[108:111], v192 offset:14336
s_lshr_b32 s83, s76, 2
MA 236,v,140,v,164
TR 164,201,32768
TR 166,201,34816
MA 48,v,112,v,168
v_add_u32 v208, 0, v66
v_add_u32 v209, 15360, v69
MA 52,v,116,v,168
buffer_load_dwordx4 v191, s[12:15], s21 offen offset:3072 lds
v_add_u32 v210, -2048, v66
MA 112,v,120,v,168
v_add_u32 v210, s83, v210
MA 116,v,124,v,168
v_add_u32 v211, 13312, v69
v_add_u32 v211, s83, v211
MA 176,v,128,v,168
v_and_b32 v68, 15, v1
MA 180,v,132,v,168
s_add_u32 s21, s21, 524288
v_lshlrev_b32 v69, 1, v67
MA 240,v,136,v,168
v_xor_b32 v68, v68, v69
MA 244,v,140,v,168
TR 168,202,32768
TR 170,202,34816
MA 56,v,112,v,172
v_lshlrev_b32 v66, 13, v67
v_xor_b32 v69, 0, v68
MA 60,v,116,v,172
s_and_b32 s21, s21, 4194303
v_lshl_add_u32 v69, v69, 4, v66
MA 120,v,120,v,172
v_add_u32 v212, 0, v69
MA 124,v,124,v,172
v_xor_b32 v69, 0, v68
MA 184,v,128,v,172
v_lshl_add_u32 v69, v69, 4, v66
MA 188,v,132,v,172
v_add_u32 v213, 31744, v69
MA 248,v,136,v,172
MA 252,v,140,v,172
TR 172,203,32768
TR 174,203,34816
s_waitcnt lgkmcnt(2)
MA 0,v,80,v,144
s_add_u32 m0, s22, 65536
buffer_load_dwordx2 v[18:19], v253, s[84:87], 0 offen
MA 4,v,84,v,144
ds_read_b128 v[112:115], v193 offset:0
MA 64,v,88,v,144
MA 68,v,92,v,144
MA 128,v,96,v,144
v_add_u32 v254, 4096, v229
MA 132,v,100,v,144
buffer_load_dwordx4 v176, s[8:11], s20 offen offset:0 lds
MA 192,v,104,v,144
MA 196,v,108,v,144
TR 144,196,49152
TR 146,196,51200
MA 8,v,80,v,148
ds_read_b128 v[116:119], v193 offset:2048
MA 12,v,84,v,148
buffer_load_dwordx2 v[20:21], v254, s[84:87], 0 offen
MA 72,v,88,v,148
buffer_load_dwordx4 v177, s[8:11], s20 offen offset:1024 lds
MA 76,v,92,v,148
MA 136,v,96,v,148
MA 140,v,100,v,148
ds_read_b128 v[120:123], v193 offset:4096
MA 200,v,104,v,148
v_add_u32 v255, 6144, v229
MA 204,v,108,v,148
TR 148,197,49152
TR 150,197,51200
MA 16,v,80,v,152
buffer_load_dwordx4 v178, s[8:11], s20 offen offset:2048 lds
MA 20,v,84,v,152
MA 80,v,88,v,152
MA 84,v,92,v,152
buffer_load_dwordx2 v[22:23], v255, s[84:87], 0 offen
MA 144,v,96,v,152
ds_read_b128 v[124:127], v193 offset:6144
buffer_load_dwordx4 v179, s[8:11], s20 offen offset:3072 lds
MA 148,v,100,v,152
MA 208,v,104,v,152
MA 212,v,108,v,152
TR 152,198,49152
TR 154,198,51200
MA 24,v,80,v,156
buffer_load_dwordx2 v[38:39], v255, s[88:91], 0 offen
MA 28,v,84,v,156
s_add_u32 m0, s22, 69632
MA 88,v,88,v,156
ds_read_b128 v[128:131], v193 offset:8192
MA 92,v,92,v,156
MA 152,v,96,v,156
v_add_u32 v252, 8192, v229
MA 156,v,100,v,156
MA 216,v,104,v,156
MA 220,v,108,v,156
TR 156,199,49152
TR 158,199,51200
MA 32,v,80,v,160
ds_read_b128 v[132:135], v193 offset:10240
buffer_load_dwordx4 v180, s[8:11], s20 offen offset:0 lds
MA 36,v,84,v,160
buffer_load_dwordx2 v[24:25], v252, s[84:87], 0 offen
MA 96,v,88,v,160
MA 100,v,92,v,160
MA 160,v,96,v,160
buffer_load_dwordx4 v181, s[8:11], s20 offen offset:1024 lds
MA 164,v,100,v,160
MA 224,v,104,v,160
buffer_load_dwordx2 v[40:41], v252, s[88:91], 0 offen
MA 228,v,108,v,160
TR 160,200,49152
TR 162,200,51200
MA 40,v,80,v,164
ds_read_b128 v[136:139], v193 offset:12288
MA 44,v,84,v,164
buffer_load_dwordx4 v182, s[8:11], s20 offen offset:2048 lds
MA 104,v,88,v,164
v_add_u32 v253, 10240, v229
MA 108,v,92,v,164
MA 168,v,96,v,164
MA 172,v,100,v,164
ds_read_b128 v[140:143], v193 offset:14336
MA 232,v,104,v,164
buffer_load_dwordx4 v183, s[8:11], s20 offen offset:3072 lds
MA 236,v,108,v,164
TR 164,201,49152
TR 166,201,51200
MA 48,v,80,v,168
buffer_load_dwordx2 v[26:27], v253, s[84:87], 0 offen
MA 52,v,84,v,168
MA 112,v,88,v,168
MA 116,v,92,v,168
s_add_u32 s20, s20, 128
MA 176,v,96,v,168
buffer_load_dwordx2 v[42:43], v253, s[88:91], 0 offen
MA 180,v,100,v,168
MA 240,v,104,v,168
MA 244,v,108,v,168
TR 168,202,49152
TR 170,202,51200
s_waitcnt lgkmcnt(15)
MA 56,v,80,v,172
s_and_b32 s20, s20, 1023
MA 60,v,84,v,172
v_add_u32 v254, 12288, v229
MA 120,v,88,v,172
MA 124,v,92,v,172
MA 184,v,96,v,172
MA 188,v,100,v,172
MA 248,v,104,v,172
MA 252,v,108,v,172
TR 172,203,49152
TR 174,203,51200
s_waitcnt lgkmcnt(2)
MA 0,v,112,v,144
MA 4,v,116,v,144
MA 64,v,120,v,144
MA 68,v,124,v,144
MA 128,v,128,v,144
MA 132,v,132,v,144
MA 192,v,136,v,144
MA 196,v,140,v,144
MA 8,v,112,v,148
MA 12,v,116,v,148
s_waitcnt vmcnt(16) lgkmcnt(0)
s_barrier
MA 72,v,120,v,148
TR 144,196,0
TR 146,196,2048
MA 76,v,124,v,148
ds_read_b128 v[80:83], v192 offset:32768
s_add_u32 m0, s23, 32768
MA 136,v,128,v,148
v_xor_b32 v69, 8, v68
v_lshl_add_u32 v69, v69, 4, v66
MA 140,v,132,v,148
v_add_u32 v214, 63488, v69
v_xor_b32 v69, 8, v68
MA 200,v,136,v,148
buffer_load_dwordx4 v184, s[12:15], s21 offen offset:0 lds
v_lshl_add_u32 v69, v69, 4, v66
MA 204,v,140,v,148
TR 148,197,0
TR 150,197,2048
MA 16,v,112,v,152
ds_read_b128 v[84:87], v192 offset:34816
v_add_u32 v215, 95232, v69
MA 20,v,116,v,152
v_and_b32 v66, 15, v1
v_lshrrev_b32 v68, 1, v66
MA 80,v,120,v,152
buffer_load_dwordx4 v185, s[12:15], s21 offen offset:1024 lds
v_xor_b32 v68, v68, v67
MA 84,v,124,v,152
v_lshlrev_b32 v68, 4, v68
v_lshl_add_u32 v68, v66, 7, v68
MA 144,v,128,v,152
v_add_u32 v224, s67, v68
v_xor_b32 v225, 64, v224
MA 148,v,132,v,152
ds_read_b128 v[88:91], v192 offset:36864
v_add_u32 v226, 0x10000, v224
MA 208,v,136,v,152
v_add_u32 v227, 0x10000, v225
v_bfe_u32 v66, v1, 2, 2
MA 212,v,140,v,152
TR 152,198,0
TR 154,198,2048
MA 24,v,112,v,156
buffer_load_dwordx4 v186, s[12:15], s21 offen offset:2048 lds
v_and_b32 v68, 1, v67
MA 28,v,116,v,156
v_lshl_or_b32 v68, v68, 2, v66
v_lshl_add_u32 v66, v67, 3, v66
MA 88,v,120,v,156
ds_read_b128 v[92:95], v192 offset:38912
v_lshlrev_b32 v66, 8, v66
MA 92,v,124,v,156
buffer_load_dwordx4 v187, s[12:15], s21 offen offset:3072 lds
v_and_b32 v69, 3, v1
MA 152,v,128,v,156
v_lshl_add_u32 v66, v69, 3, v66
v_add_u32 v66, 98304, v66
MA 156,v,132,v,156
v_xor_b32 v69, 0, v68
MA 216,v,136,v,156
v_lshl_add_u32 v216, v69, 5, v66
v_xor_b32 v69, 1, v68
MA 220,v,140,v,156
TR 156,199,0
TR 158,199,2048
MA 32,v,112,v,160
ds_read_b128 v[96:99], v192 offset:40960
s_add_u32 m0, s23, 36864
MA 36,v,116,v,160
v_lshl_add_u32 v217, v69, 5, v66
v_xor_b32 v69, 2, v68
MA 96,v,120,v,160
v_lshl_add_u32 v218, v69, 5, v66
v_xor_b32 v69, 3, v68
MA 100,v,124,v,160
v_lshl_add_u32 v219, v69, 5, v66
MA 160,v,128,v,160
ds_read_b128 v[100:103], v192 offset:43008
buffer_load_dwordx4 v188, s[12:15], s21 offen offset:0 lds
MA 164,v,132,v,160
v_xor_b32 v69, 4, v68
v_lshl_add_u32 v220, v69, 5, v66
MA 224,v,136,v,160
v_xor_b32 v69, 5, v68
v_lshl_add_u32 v221, v69, 5, v66
MA 228,v,140,v,160
TR 160,200,0
TR 162,200,2048
MA 40,v,112,v,164
buffer_load_dwordx4 v189, s[12:15], s21 offen offset:1024 lds
v_xor_b32 v69, 6, v68
MA 44,v,116,v,164
ds_read_b128 v[104:107], v192 offset:45056
v_lshl_add_u32 v222, v69, 5, v66
MA 104,v,120,v,164
v_xor_b32 v69, 7, v68
v_lshl_add_u32 v223, v69, 5, v66
MA 108,v,124,v,164
s_mov_b32 s44, s32
s_mov_b32 s45, s33
MA 168,v,128,v,164
buffer_load_dwordx4 v190, s[12:15], s21 offen offset:2048 lds
s_mov_b32 s46, 4194304
MA 172,v,132,v,164
s_mov_b32 s47, 0x20000
MA 232,v,136,v,164
ds_read_b128 v[108:111], v192 offset:47104
MA 236,v,140,v,164
TR 164,201,0
TR 166,201,2048
MA 48,v,112,v,168
s_add_u32 s48, s34, s82
s_addc_u32 s49, s35, 0
MA 52,v,116,v,168
buffer_load_dwordx4 v191, s[12:15], s21 offen offset:3072 lds
s_sub_u32 s50, 8388608, s82
MA 112,v,120,v,168
s_mov_b32 s51, 0x20000
MA 116,v,124,v,168
s_add_u32 s60, s40, 33554432
s_addc_u32 s61, s41, 0
MA 176,v,128,v,168
s_mov_b32 s62, 16777216
s_mov_b32 s63, 0x20000
MA 180,v,132,v,168
s_add_u32 s21, s21, 524288
s_lshl_b32 s80, s69, 19
MA 240,v,136,v,168
s_add_u32 s52, s40, s80
s_addc_u32 s53, s41, 0
MA 244,v,140,v,168
TR 168,202,0
TR 170,202,2048
MA 56,v,112,v,172
s_lshl_b32 s54, s77, 14
s_mov_b32 s55, 0x20000
MA 60,v,116,v,172
s_and_b32 s21, s21, 4194303
s_add_u32 s80, s80, 16760832
MA 120,v,120,v,172
s_add_u32 s56, s40, s80
s_addc_u32 s57, s41, 0
MA 124,v,124,v,172
s_add_u32 s58, s54, 16384
MA 184,v,128,v,172
s_mov_b32 s59, 0x20000
MA 188,v,132,v,172
s_load_dwordx2 s[38:39], s[0:1], 112
MA 248,v,136,v,172
MA 252,v,140,v,172
TR 172,203,0
TR 174,203,2048
s_waitcnt lgkmcnt(2)
MA 0,v,80,v,144
s_add_u32 m0, s22, 0
buffer_load_dwordx2 v[28:29], v254, s[84:87], 0 offen
MA 4,v,84,v,144
ds_read_b128 v[112:115], v193 offset:32768
MA 64,v,88,v,144
MA 68,v,92,v,144
MA 128,v,96,v,144
buffer_load_dwordx2 v[44:45], v254, s[88:91], 0 offen
MA 132,v,100,v,144
buffer_load_dwordx4 v176, s[8:11], s20 offen offset:0 lds
MA 192,v,104,v,144
MA 196,v,108,v,144
TR 144,196,16384
TR 146,196,18432
MA 8,v,80,v,148
ds_read_b128 v[116:119], v193 offset:34816
v_add_u32 v255, 14336, v229
MA 12,v,84,v,148
MA 72,v,88,v,148
buffer_load_dwordx4 v177, s[8:11], s20 offen offset:1024 lds
MA 76,v,92,v,148
MA 136,v,96,v,148
MA 140,v,100,v,148
ds_read_b128 v[120:123], v193 offset:36864
buffer_load_dwordx2 v[30:31], v255, s[84:87], 0 offen
MA 200,v,104,v,148
MA 204,v,108,v,148
TR 148,197,16384
TR 150,197,18432
MA 16,v,80,v,152
buffer_load_dwordx4 v178, s[8:11], s20 offen offset:2048 lds
MA 20,v,84,v,152
buffer_load_dwordx2 v[46:47], v255, s[88:91], 0 offen
MA 80,v,88,v,152
MA 84,v,92,v,152
MA 144,v,96,v,152
ds_read_b128 v[124:127], v193 offset:38912
buffer_load_dwordx4 v179, s[8:11], s20 offen offset:3072 lds
MA 148,v,100,v,152
MA 208,v,104,v,152
v_add_u32 v252, 16384, v229
MA 212,v,108,v,152
TR 152,198,16384
TR 154,198,18432
MA 24,v,80,v,156
MA 28,v,84,v,156
s_add_u32 m0, s22, 4096
MA 88,v,88,v,156
ds_read_b128 v[128:131], v193 offset:40960
buffer_load_dwordx2 v[32:33], v252, s[84:87], 0 offen
MA 92,v,92,v,156
MA 152,v,96,v,156
MA 156,v,100,v,156
MA 216,v,104,v,156
MA 220,v,108,v,156
TR 156,199,16384
TR 158,199,18432
MA 32,v,80,v,160
ds_read_b128 v[132:135], v193 offset:43008
buffer_load_dwordx4 v180, s[8:11], s20 offen offset:0 lds
MA 36,v,84,v,160
buffer_load_dwordx2 v[48:49], v252, s[88:91], 0 offen
MA 96,v,88,v,160
MA 100,v,92,v,160
v_add_u32 v253, 18432, v229
MA 160,v,96,v,160
buffer_load_dwordx4 v181, s[8:11], s20 offen offset:1024 lds
MA 164,v,100,v,160
MA 224,v,104,v,160
MA 228,v,108,v,160
TR 160,200,16384
TR 162,200,18432
MA 40,v,80,v,164
ds_read_b128 v[136:139], v193 offset:45056
buffer_load_dwordx2 v[34:35], v253, s[84:87], 0 offen
MA 44,v,84,v,164
buffer_load_dwordx4 v182, s[8:11], s20 offen offset:2048 lds
MA 104,v,88,v,164
MA 108,v,92,v,164
MA 168,v,96,v,164
buffer_load_dwordx2 v[50:51], v253, s[88:91], 0 offen
MA 172,v,100,v,164
ds_read_b128 v[140:143], v193 offset:47104
MA 232,v,104,v,164
buffer_load_dwordx4 v183, s[8:11], s20 offen offset:3072 lds
MA 236,v,108,v,164
TR 164,201,16384
TR 166,201,18432
MA 48,v,80,v,168
v_add_u32 v254, 20480, v229
MA 52,v,84,v,168
MA 112,v,88,v,168
MA 116,v,92,v,168
s_add_u32 s20, s20, 128
MA 176,v,96,v,168
MA 180,v,100,v,168
buffer_load_dwordx2 v[36:37], v254, s[84:87], 0 offen
MA 240,v,104,v,168
MA 244,v,108,v,168
TR 168,202,16384
TR 170,202,18432
s_waitcnt lgkmcnt(15)
MA 56,v,80,v,172
s_and_b32 s20, s20, 1023
MA 60,v,84,v,172
buffer_load_dwordx2 v[52:53], v254, s[88:91], 0 offen
MA 120,v,88,v,172
MA 124,v,92,v,172
MA 184,v,96,v,172
MA 188,v,100,v,172
MA 248,v,104,v,172
MA 252,v,108,v,172
TR 172,203,16384
TR 174,203,18432
s_waitcnt lgkmcnt(2)
MA 0,v,112,v,144
MA 4,v,116,v,144
MA 64,v,120,v,144
MA 68,v,124,v,144
MA 128,v,128,v,144
MA 132,v,132,v,144
MA 192,v,136,v,144
MA 196,v,140,v,144
MA 8,v,112,v,148
MA 12,v,116,v,148
s_waitcnt vmcnt(18) lgkmcnt(0)
s_barrier
MA 72,v,120,v,148
TR 144,196,32768
TR 146,196,34816
MA 76,v,124,v,148
ds_read_b128 v[80:83], v194 offset:0
s_add_u32 m0, s23, 0
MA 136,v,128,v,148
MA 140,v,132,v,148
MA 200,v,136,v,148
buffer_load_dwordx4 v184, s[12:15], s21 offen offset:0 lds
MA 204,v,140,v,148
TR 148,197,32768
TR 150,197,34816
MA 16,v,112,v,152
ds_read_b128 v[84:87], v194 offset:2048
MA 20,v,116,v,152
MA 80,v,120,v,152
buffer_load_dwordx4 v185, s[12:15], s21 offen offset:1024 lds
MA 84,v,124,v,152
MA 144,v,128,v,152
MA 148,v,132,v,152
ds_read_b128 v[88:91], v194 offset:4096
MA 208,v,136,v,152
MA 212,v,140,v,152
TR 152,198,32768
TR 154,198,34816
MA 24,v,112,v,156
buffer_load_dwordx4 v186, s[12:15], s21 offen offset:2048 lds
MA 28,v,116,v,156
MA 88,v,120,v,156
ds_read_b128 v[92:95], v194 offset:6144
MA 92,v,124,v,156
buffer_load_dwordx4 v187, s[12:15], s21 offen offset:3072 lds
MA 152,v,128,v,156
MA 156,v,132,v,156
MA 216,v,136,v,156
MA 220,v,140,v,156
TR 156,199,32768
TR 158,199,34816
MA 32,v,112,v,160
ds_read_b128 v[96:99], v194 offset:8192
s_add_u32 m0, s23, 4096
MA 36,v,116,v,160
MA 96,v,120,v,160
MA 100,v,124,v,160
MA 160,v,128,v,160
ds_read_b128 v[100:103], v194 offset:10240
buffer_load_dwordx4 v188, s[12:15], s21 offen offset:0 lds
MA 164,v,132,v,160
MA 224,v,136,v,160
MA 228,v,140,v,160
TR 160,200,32768
TR 162,200,34816
MA 40,v,112,v,164
buffer_load_dwordx4 v189, s[12:15], s21 offen offset:1024 lds
MA 44,v,116,v,164
ds_read_b128 v[104:107], v194 offset:12288
MA 104,v,120,v,164
MA 108,v,124,v,164
MA 168,v,128,v,164
buffer_load_dwordx4 v190, s[12:15], s21 offen offset:2048 lds
MA 172,v,132,v,164
MA 232,v,136,v,164
ds_read_b128 v[108:111], v194 offset:14336
MA 236,v,140,v,164
TR 164,201,32768
TR 166,201,34816
MA 48,v,112,v,168
MA 52,v,116,v,168
buffer_load_dwordx4 v191, s[12:15], s21 offen offset:3072 lds
MA 112,v,120,v,168
MA 116,v,124,v,168
MA 176,v,128,v,168
MA 180,v,132,v,168
s_add_u32 s21, s21, 524288
MA 240,v,136,v,168
MA 244,v,140,v,168
TR 168,202,32768
TR 170,202,34816
MA 56,v,112,v,172
MA 60,v,116,v,172
s_and_b32 s21, s21, 4194303
MA 120,v,120,v,172
MA 124,v,124,v,172
MA 184,v,128,v,172
MA 188,v,132,v,172
MA 248,v,136,v,172
MA 252,v,140,v,172
TR 172,203,32768
TR 174,203,34816
s_waitcnt lgkmcnt(2)
MA 0,v,80,v,144
s_add_u32 m0, s22, 32768
MA 4,v,84,v,144
ds_read_b128 v[112:115], v195 offset:0
MA 64,v,88,v,144
MA 68,v,92,v,144
MA 128,v,96,v,144
MA 132,v,100,v,144
buffer_load_dwordx4 v176, s[8:11], s20 offen offset:0 lds
MA 192,v,104,v,144
MA 196,v,108,v,144
TR 144,196,49152
TR 146,196,51200
MA 8,v,80,v,148
ds_read_b128 v[116:119], v195 offset:2048
MA 12,v,84,v,148
MA 72,v,88,v,148
buffer_load_dwordx4 v177, s[8:11], s20 offen offset:1024 lds
MA 76,v,92,v,148
MA 136,v,96,v,148
MA 140,v,100,v,148
ds_read_b128 v[120:123], v195 offset:4096
MA 200,v,104,v,148
MA 204,v,108,v,148
TR 148,197,49152
TR 150,197,51200
MA 16,v,80,v,152
buffer_load_dwordx4 v178, s[8:11], s20 offen offset:2048 lds
MA 20,v,84,v,152
MA 80,v,88,v,152
MA 84,v,92,v,152
MA 144,v,96,v,152
ds_read_b128 v[124:127], v195 offset:6144
buffer_load_dwordx4 v179, s[8:11], s20 offen offset:3072 lds
MA 148,v,100,v,152
MA 208,v,104,v,152
MA 212,v,108,v,152
TR 152,198,49152
TR 154,198,51200
MA 24,v,80,v,156
MA 28,v,84,v,156
s_add_u32 m0, s22, 36864
MA 88,v,88,v,156
ds_read_b128 v[128:131], v195 offset:8192
MA 92,v,92,v,156
MA 152,v,96,v,156
MA 156,v,100,v,156
MA 216,v,104,v,156
MA 220,v,108,v,156
TR 156,199,49152
TR 158,199,51200
MA 32,v,80,v,160
ds_read_b128 v[132:135], v195 offset:10240
buffer_load_dwordx4 v180, s[8:11], s20 offen offset:0 lds
MA 36,v,84,v,160
MA 96,v,88,v,160
MA 100,v,92,v,160
MA 160,v,96,v,160
buffer_load_dwordx4 v181, s[8:11], s20 offen offset:1024 lds
MA 164,v,100,v,160
MA 224,v,104,v,160
MA 228,v,108,v,160
TR 160,200,49152
TR 162,200,51200
MA 40,v,80,v,164
ds_read_b128 v[136:139], v195 offset:12288
MA 44,v,84,v,164
buffer_load_dwordx4 v182, s[8:11], s20 offen offset:2048 lds
MA 104,v,88,v,164
MA 108,v,92,v,164
MA 168,v,96,v,164
MA 172,v,100,v,164
ds_read_b128 v[140:143], v195 offset:14336
MA 232,v,104,v,164
buffer_load_dwordx4 v183, s[8:11], s20 offen offset:3072 lds
MA 236,v,108,v,164
TR 164,201,49152
TR 166,201,51200
MA 48,v,80,v,168
MA 52,v,84,v,168
MA 112,v,88,v,168
MA 116,v,92,v,168
s_add_u32 s20, s20, 128
MA 176,v,96,v,168
MA 180,v,100,v,168
MA 240,v,104,v,168
MA 244,v,108,v,168
TR 168,202,49152
TR 170,202,51200
s_waitcnt lgkmcnt(15)
MA 56,v,80,v,172
s_and_b32 s20, s20, 1023
MA 60,v,84,v,172
MA 120,v,88,v,172
MA 124,v,92,v,172
MA 184,v,96,v,172
MA 188,v,100,v,172
MA 248,v,104,v,172
MA 252,v,108,v,172
TR 172,203,49152
TR 174,203,51200
s_waitcnt lgkmcnt(2)
MA 0,v,112,v,144
MA 4,v,116,v,144
MA 64,v,120,v,144
MA 68,v,124,v,144
MA 128,v,128,v,144
MA 132,v,132,v,144
MA 192,v,136,v,144
MA 196,v,140,v,144
MA 8,v,112,v,148
MA 12,v,116,v,148
s_waitcnt vmcnt(8) lgkmcnt(0)
s_barrier
MA 72,v,120,v,148
TR 144,196,0
TR 146,196,2048
MA 76,v,124,v,148
ds_read_b128 v[80:83], v192 offset:0
s_add_u32 m0, s23, 32768
MA 136,v,128,v,148
buffer_load_dword v79, v78, s[4:7], 0 offen
MA 140,v,132,v,148
s_add_u32 s84, s40, 50331648
s_addc_u32 s85, s41, 0
MA 200,v,136,v,148
buffer_load_dwordx4 v184, s[12:15], s21 offen offset:0 lds
s_mov_b32 s86, 4194304
MA 204,v,140,v,148
TR 148,197,0
TR 150,197,2048
MA 16,v,112,v,152
ds_read_b128 v[84:87], v192 offset:2048
s_mov_b32 s87, 0x20000
MA 20,v,116,v,152
s_add_u32 s88, s40, 58720256
s_addc_u32 s89, s41, 0
MA 80,v,120,v,152
buffer_load_dwordx4 v185, s[12:15], s21 offen offset:1024 lds
s_mov_b32 s90, 8192
MA 84,v,124,v,152
s_mov_b32 s91, 0x20000
v_mov_b32 v252, 0
MA 144,v,128,v,152
v_mov_b32 v253, 0
v_dot2_f32_bf16 v252, v230, v2, v252
MA 148,v,132,v,152
ds_read_b128 v[88:91], v192 offset:4096
v_dot2_f32_bf16 v253, v231, v3, v253
MA 208,v,136,v,152
v_dot2_f32_bf16 v252, v232, v4, v252
v_dot2_f32_bf16 v253, v233, v5, v253
MA 212,v,140,v,152
TR 152,198,0
TR 154,198,2048
MA 24,v,112,v,156
buffer_load_dwordx4 v186, s[12:15], s21 offen offset:2048 lds
v_dot2_f32_bf16 v252, v234, v6, v252
MA 28,v,116,v,156
v_dot2_f32_bf16 v253, v235, v7, v253
v_dot2_f32_bf16 v252, v236, v8, v252
MA 88,v,120,v,156
ds_read_b128 v[92:95], v192 offset:6144
v_dot2_f32_bf16 v253, v237, v9, v253
MA 92,v,124,v,156
buffer_load_dwordx4 v187, s[12:15], s21 offen offset:3072 lds
v_dot2_f32_bf16 v252, v238, v12, v252
MA 152,v,128,v,156
v_dot2_f32_bf16 v253, v239, v13, v253
v_dot2_f32_bf16 v252, v240, v14, v252
MA 156,v,132,v,156
v_dot2_f32_bf16 v253, v241, v15, v253
v_dot2_f32_bf16 v252, v242, v246, v252
MA 216,v,136,v,156
v_dot2_f32_bf16 v253, v243, v247, v253
v_dot2_f32_bf16 v252, v244, v248, v252
MA 220,v,140,v,156
TR 156,199,0
TR 158,199,2048
MA 32,v,112,v,160
ds_read_b128 v[96:99], v192 offset:8192
s_add_u32 m0, s23, 36864
MA 36,v,116,v,160
v_dot2_f32_bf16 v253, v245, v249, v253
MA 96,v,120,v,160
s_nop 2
v_add_f32 v252, v252, v253
MA 100,v,124,v,160
s_nop 0
v_add_f32_dpp v252, v252, v252 row_ror:8 row_mask:0xf bank_mask:0xf
s_nop 1
v_add_f32_dpp v252, v252, v252 row_ror:4 row_mask:0xf bank_mask:0xf
MA 160,v,128,v,160
ds_read_b128 v[100:103], v192 offset:10240
buffer_load_dwordx4 v188, s[12:15], s21 offen offset:0 lds
MA 164,v,132,v,160
v_add_f32_dpp v252, v252, v252 row_ror:2 row_mask:0xf bank_mask:0xf
s_nop 1
v_add_f32_dpp v252, v252, v252 row_ror:1 row_mask:0xf bank_mask:0xf
MA 224,v,136,v,160
v_mov_b32 v253, v252
s_nop 1
v_permlane16_swap_b32 v252, v253
MA 228,v,140,v,160
TR 160,200,0
TR 162,200,2048
MA 40,v,112,v,164
buffer_load_dwordx4 v189, s[12:15], s21 offen offset:1024 lds
v_add_f32 v252, v252, v253
MA 44,v,116,v,164
ds_read_b128 v[104:107], v192 offset:12288
v_mul_f32 v252, 0xbfb8aa3b, v252
MA 104,v,120,v,164
v_exp_f32 v252, v252
MA 108,v,124,v,164
v_add_f32 v252, 1.0, v252
MA 168,v,128,v,164
buffer_load_dwordx4 v190, s[12:15], s21 offen offset:2048 lds
MA 172,v,132,v,164
v_rcp_f32 v252, v252
MA 232,v,136,v,164
ds_read_b128 v[108:111], v192 offset:14336
MA 236,v,140,v,164
TR 164,201,0
TR 166,201,2048
MA 48,v,112,v,168
s_nop 0
buffer_store_dword v252, v11, s[88:91], 0 offen sc1
MA 52,v,116,v,168
buffer_load_dwordx4 v191, s[12:15], s21 offen offset:3072 lds
v_lshlrev_b32 v2, 16, v54
MA 112,v,120,v,168
v_and_b32 v3, 0xffff0000, v54
v_lshlrev_b32 v4, 16, v55
MA 116,v,124,v,168
v_and_b32 v5, 0xffff0000, v55
v_lshlrev_b32 v6, 16, v56
MA 176,v,128,v,168
v_and_b32 v7, 0xffff0000, v56
v_lshlrev_b32 v8, 16, v57
MA 180,v,132,v,168
s_add_u32 s21, s21, 524288
v_and_b32 v9, 0xffff0000, v57
MA 240,v,136,v,168
v_lshlrev_b32 v230, 16, v16
v_and_b32 v231, 0xffff0000, v16
MA 244,v,140,v,168
TR 168,202,0
TR 170,202,2048
MA 56,v,112,v,172
v_lshlrev_b32 v232, 16, v18
v_and_b32 v233, 0xffff0000, v18
MA 60,v,116,v,172
s_and_b32 s21, s21, 4194303
v_lshlrev_b32 v234, 16, v20
MA 120,v,120,v,172
v_and_b32 v235, 0xffff0000, v20
v_lshlrev_b32 v236, 16, v22
MA 124,v,124,v,172
v_and_b32 v237, 0xffff0000, v22
v_lshlrev_b32 v238, 16, v24
MA 184,v,128,v,172
v_and_b32 v239, 0xffff0000, v24
v_lshlrev_b32 v240, 16, v26
MA 188,v,132,v,172
v_and_b32 v241, 0xffff0000, v26
v_lshlrev_b32 v242, 16, v28
MA 248,v,136,v,172
v_and_b32 v243, 0xffff0000, v28
v_lshlrev_b32 v244, 16, v30
MA 252,v,140,v,172
TR 172,203,0
TR 174,203,2048
v_and_b32 v245, 0xffff0000, v30
v_lshlrev_b32 v246, 16, v32
v_and_b32 v247, 0xffff0000, v32
v_lshlrev_b32 v248, 16, v34
v_and_b32 v249, 0xffff0000, v34
v_lshlrev_b32 v250, 16, v36
v_and_b32 v251, 0xffff0000, v36
v_lshlrev_b32 v254, 16, v38
v_and_b32 v255, 0xffff0000, v38
v_mul_f32 v62, v236, v2
v_mul_f32 v70, v237, v6
v_fmac_f32 v62, v234, v3
v_fmac_f32 v70, v235, v7
v_fmac_f32 v62, v232, v4
v_fmac_f32 v70, v233, v8
v_fmac_f32 v62, v230, v5
v_fmac_f32 v70, v231, v9
v_mul_f32 v62, v62, v254
s_waitcnt lgkmcnt(2)
MA 0,v,80,v,144
s_add_u32 s75, s64, s74
v_mul_f32 v70, v70, v255
MA 4,v,84,v,144
ds_read_b128 v[112:115], v193 offset:0
v_lshlrev_b32 v254, 16, v40
MA 64,v,88,v,144
v_and_b32 v255, 0xffff0000, v40
v_mul_f32 v63, v238, v2
MA 68,v,92,v,144
v_mul_f32 v71, v239, v6
v_fmac_f32 v63, v236, v3
MA 128,v,96,v,144
s_add_u32 m0, s67, 65536
v_fmac_f32 v71, v237, v7
MA 132,v,100,v,144
v_fmac_f32 v63, v234, v4
MA 192,v,104,v,144
v_fmac_f32 v71, v235, v8
MA 196,v,108,v,144
TR 144,196,16384
TR 146,196,18432
MA 8,v,80,v,148
ds_read_b128 v[116:119], v193 offset:2048
buffer_load_dwordx4 v208, s[44:47], s75 offen offset:0 lds
MA 12,v,84,v,148
v_fmac_f32 v63, v232, v5
v_fmac_f32 v71, v233, v9
MA 72,v,88,v,148
v_mul_f32 v63, v63, v254
v_mul_f32 v71, v71, v255
MA 76,v,92,v,148
v_lshlrev_b32 v254, 16, v42
v_and_b32 v255, 0xffff0000, v42
MA 136,v,96,v,148
v_mul_f32 v64, v240, v2
v_mul_f32 v72, v241, v6
MA 140,v,100,v,148
ds_read_b128 v[120:123], v193 offset:4096
buffer_load_dwordx4 v209, s[44:47], s75 offen offset:1024 lds
MA 200,v,104,v,148
v_fmac_f32 v64, v238, v3
v_fmac_f32 v72, v239, v7
MA 204,v,108,v,148
TR 148,197,16384
TR 150,197,18432
MA 16,v,80,v,152
v_fmac_f32 v64, v236, v4
v_fmac_f32 v72, v237, v8
MA 20,v,84,v,152
buffer_load_dwordx4 v210, s[44:47], s75 offen offset:2048 lds
v_fmac_f32 v64, v234, v5
MA 80,v,88,v,152
v_fmac_f32 v72, v235, v9
v_mul_f32 v64, v64, v254
MA 84,v,92,v,152
v_mul_f32 v72, v72, v255
v_lshlrev_b32 v254, 16, v44
MA 144,v,96,v,152
ds_read_b128 v[124:127], v193 offset:6144
v_and_b32 v255, 0xffff0000, v44
MA 148,v,100,v,152
v_mul_f32 v65, v242, v2
MA 208,v,104,v,152
buffer_load_dwordx4 v211, s[44:47], s75 offen offset:3072 lds
v_mul_f32 v73, v243, v6
MA 212,v,108,v,152
TR 152,198,16384
TR 154,198,18432
MA 24,v,80,v,156
v_fmac_f32 v65, v240, v3
v_fmac_f32 v73, v241, v7
MA 28,v,84,v,156
v_fmac_f32 v65, v238, v4
v_fmac_f32 v73, v239, v8
MA 88,v,88,v,156
ds_read_b128 v[128:131], v193 offset:8192
s_add_u32 s75, s65, s74
MA 92,v,92,v,156
v_fmac_f32 v65, v236, v5
v_fmac_f32 v73, v237, v9
MA 152,v,96,v,156
v_mul_f32 v65, v65, v254
v_mul_f32 v73, v73, v255
MA 156,v,100,v,156
v_lshlrev_b32 v254, 16, v46
MA 216,v,104,v,156
v_and_b32 v255, 0xffff0000, v46
MA 220,v,108,v,156
TR 156,199,16384
TR 158,199,18432
MA 32,v,80,v,160
ds_read_b128 v[132:135], v193 offset:10240
s_add_u32 m0, s67, 69632
MA 36,v,84,v,160
v_mul_f32 v66, v244, v2
v_mul_f32 v74, v245, v6
MA 96,v,88,v,160
v_fmac_f32 v66, v242, v3
v_fmac_f32 v74, v243, v7
MA 100,v,92,v,160
buffer_load_dwordx4 v208, s[44:47], s75 offen offset:0 lds
v_fmac_f32 v66, v240, v4
MA 160,v,96,v,160
v_fmac_f32 v74, v241, v8
v_fmac_f32 v66, v238, v5
MA 164,v,100,v,160
v_fmac_f32 v74, v239, v9
v_mul_f32 v66, v66, v254
MA 224,v,104,v,160
v_mul_f32 v74, v74, v255
v_lshlrev_b32 v254, 16, v48
MA 228,v,108,v,160
TR 160,200,16384
TR 162,200,18432
MA 40,v,80,v,164
ds_read_b128 v[136:139], v193 offset:12288
buffer_load_dwordx4 v209, s[44:47], s75 offen offset:1024 lds
MA 44,v,84,v,164
v_and_b32 v255, 0xffff0000, v48
v_mul_f32 v67, v246, v2
MA 104,v,88,v,164
v_mul_f32 v75, v247, v6
v_fmac_f32 v67, v244, v3
MA 108,v,92,v,164
v_fmac_f32 v75, v245, v7
v_fmac_f32 v67, v242, v4
MA 168,v,96,v,164
buffer_load_dwordx4 v210, s[44:47], s75 offen offset:2048 lds
v_fmac_f32 v75, v243, v8
MA 172,v,100,v,164
ds_read_b128 v[140:143], v193 offset:14336
v_fmac_f32 v67, v240, v5
MA 232,v,104,v,164
v_fmac_f32 v75, v241, v9
v_mul_f32 v67, v67, v254
MA 236,v,108,v,164
TR 164,201,16384
TR 166,201,18432
MA 48,v,80,v,168
buffer_load_dwordx4 v211, s[44:47], s75 offen offset:3072 lds
v_mul_f32 v75, v75, v255
MA 52,v,84,v,168
v_lshlrev_b32 v254, 16, v50
v_and_b32 v255, 0xffff0000, v50
MA 112,v,88,v,168
v_mul_f32 v68, v248, v2
v_mul_f32 v76, v249, v6
MA 116,v,92,v,168
v_fmac_f32 v68, v246, v3
MA 176,v,96,v,168
v_fmac_f32 v76, v247, v7
MA 180,v,100,v,168
s_add_u32 s74, s74, 128
v_fmac_f32 v68, v244, v4
MA 240,v,104,v,168
v_fmac_f32 v76, v245, v8
v_fmac_f32 v68, v242, v5
MA 244,v,108,v,168
TR 168,202,16384
TR 170,202,18432
s_waitcnt lgkmcnt(15)
MA 56,v,80,v,172
v_fmac_f32 v76, v243, v9
v_mul_f32 v68, v68, v254
MA 60,v,84,v,172
s_and_b32 s74, s74, 2047
v_mul_f32 v76, v76, v255
MA 120,v,88,v,172
v_lshlrev_b32 v254, 16, v52
v_and_b32 v255, 0xffff0000, v52
MA 124,v,92,v,172
v_mul_f32 v69, v250, v2
MA 184,v,96,v,172
v_mul_f32 v77, v251, v6
MA 188,v,100,v,172
v_fmac_f32 v69, v248, v3
MA 248,v,104,v,172
MA 252,v,108,v,172
TR 172,203,16384
TR 174,203,18432
s_waitcnt lgkmcnt(2)
MA 0,v,112,v,144
MA 4,v,116,v,144
MA 64,v,120,v,144
MA 68,v,124,v,144
MA 128,v,128,v,144
MA 132,v,132,v,144
MA 192,v,136,v,144
MA 196,v,140,v,144
MA 8,v,112,v,148
MA 12,v,116,v,148
s_waitcnt vmcnt(8) lgkmcnt(0)
s_barrier
MA 72,v,120,v,148
TR 144,196,32768
TR 146,196,34816
MA 76,v,124,v,148
ds_read_b128 v[80:83], v192 offset:32768
s_add_u32 m0, s68, 98304
MA 136,v,128,v,148
v_fmac_f32 v77, v249, v7
v_fmac_f32 v69, v246, v4
MA 140,v,132,v,148
buffer_load_dwordx4 v212, s[48:51], s66 offen offset:0 lds
v_fmac_f32 v77, v247, v8
MA 200,v,136,v,148
v_fmac_f32 v69, v244, v5
v_fmac_f32 v77, v245, v9
MA 204,v,140,v,148
TR 148,197,32768
TR 150,197,34816
MA 16,v,112,v,152
ds_read_b128 v[84:87], v192 offset:34816
v_mul_f32 v69, v69, v254
MA 20,v,116,v,152
buffer_load_dwordx4 v213, s[48:51], s66 offen offset:1024 lds
v_mul_f32 v77, v77, v255
MA 80,v,120,v,152
v_cvt_pk_bf16_f32 v12, v69, v68
v_cvt_pk_bf16_f32 v13, v67, v66
MA 84,v,124,v,152
v_cvt_pk_bf16_f32 v14, v65, v64
v_cvt_pk_bf16_f32 v15, v63, v62
MA 144,v,128,v,152
s_mov_b32 s36, 0
buffer_store_dwordx4 v[12:15], v10, s[84:87], s36 offen sc1
MA 148,v,132,v,152
ds_read_b128 v[88:91], v192 offset:36864
buffer_load_dwordx4 v214, s[48:51], s66 offen offset:2048 lds
MA 208,v,136,v,152
v_cvt_pk_bf16_f32 v54, v77, v76
v_cvt_pk_bf16_f32 v55, v75, v74
MA 212,v,140,v,152
TR 152,198,32768
TR 154,198,34816
MA 24,v,112,v,156
buffer_load_dwordx4 v215, s[48:51], s66 offen offset:3072 lds
v_cvt_pk_bf16_f32 v56, v73, v72
MA 28,v,116,v,156
v_cvt_pk_bf16_f32 v57, v71, v70
s_mov_b32 s36, 4096
MA 88,v,120,v,156
ds_read_b128 v[92:95], v192 offset:38912
buffer_store_dwordx4 v[54:57], v10, s[84:87], s36 offen sc1
MA 92,v,124,v,156
v_lshlrev_b32 v2, 16, v58
v_and_b32 v3, 0xffff0000, v58
MA 152,v,128,v,156
s_add_u32 s66, s66, 524288
v_lshlrev_b32 v4, 16, v59
MA 156,v,132,v,156
v_and_b32 v5, 0xffff0000, v59
v_lshlrev_b32 v6, 16, v60
MA 216,v,136,v,156
v_and_b32 v7, 0xffff0000, v60
v_lshlrev_b32 v8, 16, v61
MA 220,v,140,v,156
TR 156,199,32768
TR 158,199,34816
MA 32,v,112,v,160
ds_read_b128 v[96:99], v192 offset:40960
s_and_b32 s66, s66, 8388607
MA 36,v,116,v,160
v_and_b32 v9, 0xffff0000, v61
v_lshlrev_b32 v230, 16, v17
MA 96,v,120,v,160
v_and_b32 v231, 0xffff0000, v17
v_lshlrev_b32 v232, 16, v19
MA 100,v,124,v,160
v_and_b32 v233, 0xffff0000, v19
v_lshlrev_b32 v234, 16, v21
MA 160,v,128,v,160
ds_read_b128 v[100:103], v192 offset:43008
s_add_u32 m0, s68, 114688
MA 164,v,132,v,160
v_and_b32 v235, 0xffff0000, v21
v_lshlrev_b32 v236, 16, v23
MA 224,v,136,v,160
v_and_b32 v237, 0xffff0000, v23
v_lshlrev_b32 v238, 16, v25
MA 228,v,140,v,160
TR 160,200,32768
TR 162,200,34816
MA 40,v,112,v,164
buffer_load_dwordx4 v212, s[48:51], s66 offen offset:0 lds
v_and_b32 v239, 0xffff0000, v25
MA 44,v,116,v,164
ds_read_b128 v[104:107], v192 offset:45056
v_lshlrev_b32 v240, 16, v27
MA 104,v,120,v,164
v_and_b32 v241, 0xffff0000, v27
v_lshlrev_b32 v242, 16, v29
MA 108,v,124,v,164
buffer_load_dwordx4 v213, s[48:51], s66 offen offset:1024 lds
v_and_b32 v243, 0xffff0000, v29
MA 168,v,128,v,164
v_lshlrev_b32 v244, 16, v31
v_and_b32 v245, 0xffff0000, v31
MA 172,v,132,v,164
v_lshlrev_b32 v246, 16, v33
v_and_b32 v247, 0xffff0000, v33
MA 232,v,136,v,164
ds_read_b128 v[108:111], v192 offset:47104
v_lshlrev_b32 v248, 16, v35
MA 236,v,140,v,164
TR 164,201,32768
TR 166,201,34816
MA 48,v,112,v,168
buffer_load_dwordx4 v214, s[48:51], s66 offen offset:2048 lds
v_and_b32 v249, 0xffff0000, v35
MA 52,v,116,v,168
v_lshlrev_b32 v250, 16, v37
v_and_b32 v251, 0xffff0000, v37
MA 112,v,120,v,168
buffer_load_dwordx4 v215, s[48:51], s66 offen offset:3072 lds
v_lshlrev_b32 v254, 16, v39
MA 116,v,124,v,168
v_and_b32 v255, 0xffff0000, v39
v_mul_f32 v62, v236, v2
MA 176,v,128,v,168
v_mul_f32 v70, v237, v6
v_fmac_f32 v62, v234, v3
MA 180,v,132,v,168
v_fmac_f32 v70, v235, v7
v_fmac_f32 v62, v232, v4
MA 240,v,136,v,168
s_add_u32 s66, s66, 524288
v_fmac_f32 v70, v233, v8
MA 244,v,140,v,168
TR 168,202,32768
TR 170,202,34816
MA 56,v,112,v,172
v_fmac_f32 v62, v230, v5
v_fmac_f32 v70, v231, v9
MA 60,v,116,v,172
v_mul_f32 v62, v62, v254
v_mul_f32 v70, v70, v255
MA 120,v,120,v,172
s_and_b32 s66, s66, 8388607
v_lshlrev_b32 v254, 16, v41
MA 124,v,124,v,172
v_and_b32 v255, 0xffff0000, v41
v_mul_f32 v63, v238, v2
MA 184,v,128,v,172
v_mul_f32 v71, v239, v6
v_fmac_f32 v63, v236, v3
MA 188,v,132,v,172
v_fmac_f32 v71, v237, v7
v_fmac_f32 v63, v234, v4
MA 248,v,136,v,172
v_fmac_f32 v71, v235, v8
v_fmac_f32 v63, v232, v5
MA 252,v,140,v,172
TR 172,203,32768
TR 174,203,34816
v_fmac_f32 v71, v233, v9
v_mul_f32 v63, v63, v254
v_mul_f32 v71, v71, v255
v_lshlrev_b32 v254, 16, v43
v_and_b32 v255, 0xffff0000, v43
v_mul_f32 v64, v240, v2
v_mul_f32 v72, v241, v6
v_fmac_f32 v64, v238, v3
s_waitcnt lgkmcnt(2)
MA 0,v,80,v,144
s_add_u32 s75, s64, s74
v_fmac_f32 v72, v239, v7
MA 4,v,84,v,144
ds_read_b128 v[112:115], v193 offset:32768
v_fmac_f32 v64, v236, v4
MA 64,v,88,v,144
v_fmac_f32 v72, v237, v8
v_fmac_f32 v64, v234, v5
MA 68,v,92,v,144
v_fmac_f32 v72, v235, v9
v_mul_f32 v64, v64, v254
MA 128,v,96,v,144
s_add_u32 m0, s67, 0
v_mul_f32 v72, v72, v255
MA 132,v,100,v,144
v_lshlrev_b32 v254, 16, v45
MA 192,v,104,v,144
v_and_b32 v255, 0xffff0000, v45
v_mul_f32 v65, v242, v2
MA 196,v,108,v,144
TR 144,196,49152
TR 146,196,51200
MA 8,v,80,v,148
ds_read_b128 v[116:119], v193 offset:34816
buffer_load_dwordx4 v208, s[44:47], s75 offen offset:0 lds
MA 12,v,84,v,148
v_mul_f32 v73, v243, v6
v_fmac_f32 v65, v240, v3
MA 72,v,88,v,148
v_fmac_f32 v73, v241, v7
v_fmac_f32 v65, v238, v4
MA 76,v,92,v,148
v_fmac_f32 v73, v239, v8
v_fmac_f32 v65, v236, v5
MA 136,v,96,v,148
v_fmac_f32 v73, v237, v9
MA 140,v,100,v,148
ds_read_b128 v[120:123], v193 offset:36864
buffer_load_dwordx4 v209, s[44:47], s75 offen offset:1024 lds
MA 200,v,104,v,148
v_mul_f32 v65, v65, v254
v_mul_f32 v73, v73, v255
MA 204,v,108,v,148
TR 148,197,49152
TR 150,197,51200
MA 16,v,80,v,152
v_lshlrev_b32 v254, 16, v47
v_and_b32 v255, 0xffff0000, v47
MA 20,v,84,v,152
buffer_load_dwordx4 v210, s[44:47], s75 offen offset:2048 lds
v_mul_f32 v66, v244, v2
MA 80,v,88,v,152
v_mul_f32 v74, v245, v6
v_fmac_f32 v66, v242, v3
MA 84,v,92,v,152
v_fmac_f32 v74, v243, v7
v_fmac_f32 v66, v240, v4
MA 144,v,96,v,152
ds_read_b128 v[124:127], v193 offset:38912
v_fmac_f32 v74, v241, v8
MA 148,v,100,v,152
v_fmac_f32 v66, v238, v5
v_fmac_f32 v74, v239, v9
MA 208,v,104,v,152
buffer_load_dwordx4 v211, s[44:47], s75 offen offset:3072 lds
v_mul_f32 v66, v66, v254
MA 212,v,108,v,152
TR 152,198,49152
TR 154,198,51200
MA 24,v,80,v,156
v_mul_f32 v74, v74, v255
v_lshlrev_b32 v254, 16, v49
MA 28,v,84,v,156
v_and_b32 v255, 0xffff0000, v49
v_mul_f32 v67, v246, v2
MA 88,v,88,v,156
ds_read_b128 v[128:131], v193 offset:40960
s_add_u32 s75, s65, s74
MA 92,v,92,v,156
v_mul_f32 v75, v247, v6
v_fmac_f32 v67, v244, v3
MA 152,v,96,v,156
v_fmac_f32 v75, v245, v7
v_fmac_f32 v67, v242, v4
MA 156,v,100,v,156
v_fmac_f32 v75, v243, v8
MA 216,v,104,v,156
v_fmac_f32 v67, v240, v5
MA 220,v,108,v,156
TR 156,199,49152
TR 158,199,51200
MA 32,v,80,v,160
ds_read_b128 v[132:135], v193 offset:43008
s_add_u32 m0, s67, 4096
MA 36,v,84,v,160
v_fmac_f32 v75, v241, v9
v_mul_f32 v67, v67, v254
MA 96,v,88,v,160
v_mul_f32 v75, v75, v255
v_lshlrev_b32 v254, 16, v51
MA 100,v,92,v,160
buffer_load_dwordx4 v208, s[44:47], s75 offen offset:0 lds
v_and_b32 v255, 0xffff0000, v51
MA 160,v,96,v,160
v_mul_f32 v68, v248, v2
v_mul_f32 v76, v249, v6
MA 164,v,100,v,160
v_fmac_f32 v68, v246, v3
v_fmac_f32 v76, v247, v7
MA 224,v,104,v,160
v_fmac_f32 v68, v244, v4
v_fmac_f32 v76, v245, v8
MA 228,v,108,v,160
TR 160,200,49152
TR 162,200,51200
MA 40,v,80,v,164
ds_read_b128 v[136:139], v193 offset:45056
buffer_load_dwordx4 v209, s[44:47], s75 offen offset:1024 lds
MA 44,v,84,v,164
v_fmac_f32 v68, v242, v5
v_fmac_f32 v76, v243, v9
MA 104,v,88,v,164
v_mul_f32 v68, v68, v254
v_mul_f32 v76, v76, v255
MA 108,v,92,v,164
v_lshlrev_b32 v254, 16, v53
v_and_b32 v255, 0xffff0000, v53
MA 168,v,96,v,164
buffer_load_dwordx4 v210, s[44:47], s75 offen offset:2048 lds
v_mul_f32 v69, v250, v2
MA 172,v,100,v,164
ds_read_b128 v[140:143], v193 offset:47104
v_mul_f32 v77, v251, v6
MA 232,v,104,v,164
v_fmac_f32 v69, v248, v3
v_fmac_f32 v77, v249, v7
MA 236,v,108,v,164
TR 164,201,49152
TR 166,201,51200
MA 48,v,80,v,168
buffer_load_dwordx4 v211, s[44:47], s75 offen offset:3072 lds
v_fmac_f32 v69, v246, v4
MA 52,v,84,v,168
v_fmac_f32 v77, v247, v8
v_fmac_f32 v69, v244, v5
MA 112,v,88,v,168
v_fmac_f32 v77, v245, v9
v_mul_f32 v69, v69, v254
MA 116,v,92,v,168
v_mul_f32 v77, v77, v255
v_cvt_pk_bf16_f32 v230, v69, v68
MA 176,v,96,v,168
v_cvt_pk_bf16_f32 v231, v67, v66
MA 180,v,100,v,168
s_add_u32 s74, s74, 128
v_cvt_pk_bf16_f32 v232, v65, v64
MA 240,v,104,v,168
v_cvt_pk_bf16_f32 v233, v63, v62
MA 244,v,108,v,168
TR 168,202,49152
TR 170,202,51200
s_waitcnt lgkmcnt(15)
MA 56,v,80,v,172
s_mov_b32 s36, 8192
buffer_store_dwordx4 v[230:233], v10, s[84:87], s36 offen sc1
MA 60,v,84,v,172
s_and_b32 s74, s74, 2047
v_cvt_pk_bf16_f32 v234, v77, v76
MA 120,v,88,v,172
v_cvt_pk_bf16_f32 v235, v75, v74
v_cvt_pk_bf16_f32 v236, v73, v72
MA 124,v,92,v,172
v_cvt_pk_bf16_f32 v237, v71, v70
s_mov_b32 s36, 12288
MA 184,v,96,v,172
buffer_store_dwordx4 v[234:237], v10, s[84:87], s36 offen sc1
MA 188,v,100,v,172
v_lshlrev_b32 v228, 4, v1
MA 248,v,104,v,172
MA 252,v,108,v,172
TR 172,203,49152
TR 174,203,51200
s_waitcnt lgkmcnt(2)
MA 0,v,112,v,144
MA 4,v,116,v,144
MA 64,v,120,v,144
MA 68,v,124,v,144
MA 128,v,128,v,144
MA 132,v,132,v,144
MA 192,v,136,v,144
MA 196,v,140,v,144
MA 8,v,112,v,148
MA 12,v,116,v,148
s_waitcnt vmcnt(15) lgkmcnt(0)
s_barrier
MA 72,v,120,v,148
ds_read_b128 v[48:51], v226 offset:0
s_add_u32 m0, s68, 131072
MA 76,v,124,v,148
MA 136,v,128,v,148
ds_read_b128 v[52:55], v226 offset:2048
buffer_load_dwordx4 v212, s[48:51], s66 offen offset:0 lds
MA 140,v,132,v,148
MA 200,v,136,v,148
ds_read_b128 v[56:59], v226 offset:4096
buffer_load_dwordx4 v213, s[48:51], s66 offen offset:1024 lds
MA 204,v,140,v,148
MA 16,v,112,v,152
ds_read_b128 v[60:63], v226 offset:6144
MA 20,v,116,v,152
buffer_load_dwordx4 v214, s[48:51], s66 offen offset:2048 lds
MA 80,v,120,v,152
TR 16,216,0
MA 84,v,124,v,152
buffer_load_dwordx4 v215, s[48:51], s66 offen offset:3072 lds
MA 144,v,128,v,152
TR 18,216,1024
MA 148,v,132,v,152
MA 208,v,136,v,152
TR 20,217,0
s_add_u32 s66, s66, 524288
MA 212,v,140,v,152
MA 24,v,112,v,156
TR 22,217,1024
s_and_b32 s66, s66, 8388607
MA 28,v,116,v,156
MA 88,v,120,v,156
TR 24,218,0
MA 92,v,124,v,156
s_add_u32 s75, s64, s74
MA 152,v,128,v,156
TR 26,218,1024
MA 156,v,132,v,156
s_add_u32 m0, s67, 32768
MA 216,v,136,v,156
TR 28,219,0
MA 220,v,140,v,156
MA 32,v,112,v,160
TR 30,219,1024
buffer_load_dwordx4 v208, s[44:47], s75 offen offset:0 lds
MA 36,v,116,v,160
MA 96,v,120,v,160
TR 32,220,0
buffer_load_dwordx4 v209, s[44:47], s75 offen offset:1024 lds
MA 100,v,124,v,160
MA 160,v,128,v,160
TR 34,220,1024
MA 164,v,132,v,160
buffer_load_dwordx4 v210, s[44:47], s75 offen offset:2048 lds
MA 224,v,136,v,160
TR 36,221,0
MA 228,v,140,v,160
buffer_load_dwordx4 v211, s[44:47], s75 offen offset:3072 lds
MA 40,v,112,v,164
TR 38,221,1024
MA 44,v,116,v,164
MA 104,v,120,v,164
TR 40,222,0
s_add_u32 s75, s65, s74
MA 108,v,124,v,164
MA 168,v,128,v,164
TR 42,222,1024
s_add_u32 m0, s67, 36864
MA 172,v,132,v,164
MA 232,v,136,v,164
TR 44,223,0
MA 236,v,140,v,164
buffer_load_dwordx4 v208, s[44:47], s75 offen offset:0 lds
MA 48,v,112,v,168
TR 46,223,1024
MA 52,v,116,v,168
buffer_load_dwordx4 v209, s[44:47], s75 offen offset:1024 lds
MA 112,v,120,v,168
MA 116,v,124,v,168
MA 176,v,128,v,168
buffer_load_dwordx4 v210, s[44:47], s75 offen offset:2048 lds
MA 180,v,132,v,168
MA 240,v,136,v,168
buffer_load_dwordx4 v211, s[44:47], s75 offen offset:3072 lds
MA 244,v,140,v,168
MA 56,v,112,v,172
MA 60,v,116,v,172
s_add_u32 s74, s74, 128
MA 120,v,120,v,172
MA 124,v,124,v,172
s_and_b32 s74, s74, 2047
MA 184,v,128,v,172
MA 188,v,132,v,172
MA 248,v,136,v,172
MA 252,v,140,v,172
L_p2:
s_waitcnt lgkmcnt(4)
v_mfma_f32_16x16x32_bf16 v[80:83], v[16:19], v[48:51], 0
s_add_u32 s8, s40, 59768832
s_addc_u32 s9, s41, 0
v_mfma_f32_16x16x32_bf16 v[84:87], v[16:19], v[52:55], 0
ds_read_b128 v[64:67], v227 offset:0
v_mfma_f32_16x16x32_bf16 v[88:91], v[16:19], v[56:59], 0
s_mov_b32 s10, 8192
v_mfma_f32_16x16x32_bf16 v[92:95], v[16:19], v[60:63], 0
TR 16,216,8192
TR 18,216,9216
v_mfma_f32_16x16x32_bf16 v[96:99], v[20:23], v[48:51], 0
s_mov_b32 s11, 0x20000
s_mov_b32 s12, s38
v_mfma_f32_16x16x32_bf16 v[100:103], v[20:23], v[52:55], 0
s_mov_b32 s13, s39
v_mfma_f32_16x16x32_bf16 v[104:107], v[20:23], v[56:59], 0
ds_read_b128 v[68:71], v227 offset:2048
s_mov_b32 s14, 256
v_mfma_f32_16x16x32_bf16 v[108:111], v[20:23], v[60:63], 0
TR 20,217,8192
TR 22,217,9216
v_mfma_f32_16x16x32_bf16 v[112:115], v[24:27], v[48:51], 0
s_mov_b32 s15, 0x20000
v_accvgpr_read_b32 v234, a0
v_mfma_f32_16x16x32_bf16 v[116:119], v[24:27], v[52:55], 0
v_accvgpr_read_b32 v235, a1
v_mfma_f32_16x16x32_bf16 v[120:123], v[24:27], v[56:59], 0
v_accvgpr_read_b32 v236, a2
v_mfma_f32_16x16x32_bf16 v[124:127], v[24:27], v[60:63], 0
TR 24,218,8192
TR 26,218,9216
v_mfma_f32_16x16x32_bf16 v[128:131], v[28:31], v[48:51], 0
ds_read_b128 v[72:75], v227 offset:4096
v_accvgpr_read_b32 v237, a3
v_mfma_f32_16x16x32_bf16 v[132:135], v[28:31], v[52:55], 0
v_accvgpr_read_b32 v238, a4
v_accvgpr_read_b32 v239, a5
v_mfma_f32_16x16x32_bf16 v[136:139], v[28:31], v[56:59], 0
v_accvgpr_read_b32 v240, a6
v_mfma_f32_16x16x32_bf16 v[140:143], v[28:31], v[60:63], 0
TR 28,219,8192
TR 30,219,9216
v_mfma_f32_16x16x32_bf16 v[144:147], v[32:35], v[48:51], 0
v_accvgpr_read_b32 v241, a7
v_cvt_pk_bf16_f32 v230, v234, v235
v_mfma_f32_16x16x32_bf16 v[148:151], v[32:35], v[52:55], 0
v_cvt_pk_bf16_f32 v231, v236, v237
v_mfma_f32_16x16x32_bf16 v[152:155], v[32:35], v[56:59], 0
ds_read_b128 v[76:79], v227 offset:6144
v_cvt_pk_bf16_f32 v232, v238, v239
v_mfma_f32_16x16x32_bf16 v[156:159], v[32:35], v[60:63], 0
TR 32,220,8192
TR 34,220,9216
v_mfma_f32_16x16x32_bf16 v[160:163], v[36:39], v[48:51], 0
v_cvt_pk_bf16_f32 v233, v240, v241
buffer_store_dwordx4 v[230:233], v228, s[16:19], s24 offen offset:0 sc1
v_mfma_f32_16x16x32_bf16 v[164:167], v[36:39], v[52:55], 0
v_accvgpr_read_b32 v246, a8
v_mfma_f32_16x16x32_bf16 v[168:171], v[36:39], v[56:59], 0
v_accvgpr_read_b32 v247, a9
v_mfma_f32_16x16x32_bf16 v[172:175], v[36:39], v[60:63], 0
TR 36,221,8192
TR 38,221,9216
s_waitcnt lgkmcnt(15)
v_mfma_f32_16x16x32_bf16 v[176:179], v[40:43], v[48:51], 0
v_accvgpr_read_b32 v248, a10
v_accvgpr_read_b32 v249, a11
v_mfma_f32_16x16x32_bf16 v[180:183], v[40:43], v[52:55], 0
v_accvgpr_read_b32 v250, a12
v_mfma_f32_16x16x32_bf16 v[184:187], v[40:43], v[56:59], 0
v_accvgpr_read_b32 v251, a13
v_mfma_f32_16x16x32_bf16 v[188:191], v[40:43], v[60:63], 0
TR 40,222,8192
TR 42,222,9216
v_mfma_f32_16x16x32_bf16 v[192:195], v[44:47], v[48:51], 0
v_accvgpr_read_b32 v252, a14
v_accvgpr_read_b32 v253, a15
v_mfma_f32_16x16x32_bf16 v[196:199], v[44:47], v[52:55], 0
v_mfma_f32_16x16x32_bf16 v[200:203], v[44:47], v[56:59], 0
v_mfma_f32_16x16x32_bf16 v[204:207], v[44:47], v[60:63], 0
TR 44,223,8192
TR 46,223,9216
s_waitcnt lgkmcnt(4)
MV 80,v,16,v,64
v_cvt_pk_bf16_f32 v242, v246, v247
MV 84,v,16,v,68
v_cvt_pk_bf16_f32 v243, v248, v249
MV 88,v,16,v,72
v_cvt_pk_bf16_f32 v244, v250, v251
MV 92,v,16,v,76
MV 96,v,20,v,64
v_cvt_pk_bf16_f32 v245, v252, v253
MV 100,v,20,v,68
buffer_store_dwordx4 v[242:245], v228, s[16:19], s24 offen offset:1024 sc1
MV 104,v,20,v,72
MV 108,v,20,v,76
s_waitcnt vmcnt(16) lgkmcnt(0)
s_barrier
MV 112,v,24,v,64
TR 16,216,16384
TR 18,216,17408
MV 116,v,24,v,68
ds_read_b128 v[48:51], v224 offset:0
s_add_u32 m0, s68, 98304
MV 120,v,24,v,72
TR 20,217,16384
TR 22,217,17408
MV 124,v,24,v,76
buffer_load_dwordx4 v212, s[48:51], s66 offen offset:0 lds
v_accvgpr_read_b32 v234, a16
MV 128,v,28,v,64
TR 24,218,16384
TR 26,218,17408
MV 132,v,28,v,68
ds_read_b128 v[52:55], v224 offset:2048
buffer_load_dwordx4 v213, s[48:51], s66 offen offset:1024 lds
MV 136,v,28,v,72
buffer_load_dwordx4 v214, s[48:51], s66 offen offset:2048 lds
v_accvgpr_read_b32 v235, a17
MV 140,v,28,v,76
TR 28,219,16384
TR 30,219,17408
MV 144,v,32,v,64
ds_read_b128 v[56:59], v224 offset:4096
v_accvgpr_read_b32 v236, a18
MV 148,v,32,v,68
buffer_load_dwordx4 v215, s[48:51], s66 offen offset:3072 lds
v_accvgpr_read_b32 v237, a19
MV 152,v,32,v,72
v_accvgpr_read_b32 v238, a20
v_accvgpr_read_b32 v239, a21
MV 156,v,32,v,76
TR 32,220,16384
TR 34,220,17408
MV 160,v,36,v,64
ds_read_b128 v[60:63], v224 offset:6144
s_add_u32 s66, s66, 524288
MV 164,v,36,v,68
s_and_b32 s66, s66, 8388607
v_accvgpr_read_b32 v240, a22
MV 168,v,36,v,72
v_accvgpr_read_b32 v241, a23
v_cvt_pk_bf16_f32 v230, v234, v235
MV 172,v,36,v,76
TR 36,221,16384
TR 38,221,17408
MV 176,v,40,v,64
s_add_u32 s75, s64, s74
v_cvt_pk_bf16_f32 v231, v236, v237
MV 180,v,40,v,68
v_cvt_pk_bf16_f32 v232, v238, v239
v_cvt_pk_bf16_f32 v233, v240, v241
MV 184,v,40,v,72
s_add_u32 m0, s67, 65536
buffer_store_dwordx4 v[230:233], v228, s[16:19], s24 offen offset:2048 sc1
MV 188,v,40,v,76
TR 40,222,16384
TR 42,222,17408
MV 192,v,44,v,64
buffer_load_dwordx4 v208, s[44:47], s75 offen offset:0 lds
v_accvgpr_read_b32 v246, a24
MV 196,v,44,v,68
v_accvgpr_read_b32 v247, a25
v_accvgpr_read_b32 v248, a26
MV 200,v,44,v,72
MV 204,v,44,v,76
TR 44,223,16384
TR 46,223,17408
s_waitcnt lgkmcnt(4)
MV 80,v,16,v,48
buffer_load_dwordx4 v209, s[44:47], s75 offen offset:1024 lds
v_accvgpr_read_b32 v249, a27
MV 84,v,16,v,52
ds_read_b128 v[64:67], v225 offset:0
v_accvgpr_read_b32 v250, a28
MV 88,v,16,v,56
buffer_load_dwordx4 v210, s[44:47], s75 offen offset:2048 lds
v_accvgpr_read_b32 v251, a29
MV 92,v,16,v,60
TR 16,216,24576
TR 18,216,25600
MV 96,v,20,v,48
v_accvgpr_read_b32 v252, a30
MV 100,v,20,v,52
buffer_load_dwordx4 v211, s[44:47], s75 offen offset:3072 lds
v_accvgpr_read_b32 v253, a31
MV 104,v,20,v,56
ds_read_b128 v[68:71], v225 offset:2048
MV 108,v,20,v,60
TR 20,217,24576
TR 22,217,25600
MV 112,v,24,v,48
s_add_u32 s75, s65, s74
v_cvt_pk_bf16_f32 v242, v246, v247
MV 116,v,24,v,52
v_cvt_pk_bf16_f32 v243, v248, v249
MV 120,v,24,v,56
v_cvt_pk_bf16_f32 v244, v250, v251
MV 124,v,24,v,60
TR 24,218,24576
TR 26,218,25600
MV 128,v,28,v,48
ds_read_b128 v[72:75], v225 offset:4096
s_add_u32 m0, s67, 69632
MV 132,v,28,v,52
v_cvt_pk_bf16_f32 v245, v252, v253
buffer_store_dwordx4 v[242:245], v228, s[16:19], s24 offen offset:3072 sc1
MV 136,v,28,v,56
buffer_load_dwordx4 v208, s[44:47], s75 offen offset:0 lds
v_accvgpr_read_b32 v234, a32
MV 140,v,28,v,60
TR 28,219,24576
TR 30,219,25600
MV 144,v,32,v,48
buffer_load_dwordx4 v209, s[44:47], s75 offen offset:1024 lds
v_accvgpr_read_b32 v235, a33
MV 148,v,32,v,52
v_accvgpr_read_b32 v236, a34
MV 152,v,32,v,56
ds_read_b128 v[76:79], v225 offset:6144
v_accvgpr_read_b32 v237, a35
MV 156,v,32,v,60
TR 32,220,24576
TR 34,220,25600
MV 160,v,36,v,48
buffer_load_dwordx4 v210, s[44:47], s75 offen offset:2048 lds
v_accvgpr_read_b32 v238, a36
MV 164,v,36,v,52
v_accvgpr_read_b32 v239, a37
MV 168,v,36,v,56
buffer_load_dwordx4 v211, s[44:47], s75 offen offset:3072 lds
v_accvgpr_read_b32 v240, a38
MV 172,v,36,v,60
TR 36,221,24576
TR 38,221,25600
s_waitcnt lgkmcnt(15)
MV 176,v,40,v,48
v_accvgpr_read_b32 v241, a39
MV 180,v,40,v,52
s_add_u32 s74, s74, 128
v_cvt_pk_bf16_f32 v230, v234, v235
MV 184,v,40,v,56
MV 188,v,40,v,60
TR 40,222,24576
TR 42,222,25600
MV 192,v,44,v,48
s_and_b32 s74, s74, 2047
v_cvt_pk_bf16_f32 v231, v236, v237
MV 196,v,44,v,52
v_cvt_pk_bf16_f32 v232, v238, v239
MV 200,v,44,v,56
MV 204,v,44,v,60
TR 44,223,24576
TR 46,223,25600
s_waitcnt lgkmcnt(4)
MV 80,v,16,v,64
v_cvt_pk_bf16_f32 v233, v240, v241
MV 84,v,16,v,68
s_add_u32 s24, s24, 4096
MV 88,v,16,v,72
buffer_store_dwordx4 v[230:233], v228, s[16:19], s24 offen offset:0 sc1
MV 92,v,16,v,76
MV 96,v,20,v,64
v_accvgpr_read_b32 v246, a40
MV 100,v,20,v,68
v_accvgpr_read_b32 v247, a41
MV 104,v,20,v,72
MV 108,v,20,v,76
s_waitcnt vmcnt(17) lgkmcnt(0)
s_barrier
MV 112,v,24,v,64
TR 16,216,32768
TR 18,216,33792
MV 116,v,24,v,68
ds_read_b128 v[48:51], v224 offset:32768
s_add_u32 m0, s68, 114688
MV 120,v,24,v,72
TR 20,217,32768
TR 22,217,33792
MV 124,v,24,v,76
buffer_load_dwordx4 v212, s[48:51], s66 offen offset:0 lds
v_accvgpr_read_b32 v248, a42
MV 128,v,28,v,64
TR 24,218,32768
TR 26,218,33792
MV 132,v,28,v,68
ds_read_b128 v[52:55], v224 offset:34816
buffer_load_dwordx4 v213, s[48:51], s66 offen offset:1024 lds
MV 136,v,28,v,72
buffer_load_dwordx4 v214, s[48:51], s66 offen offset:2048 lds
v_accvgpr_read_b32 v249, a43
MV 140,v,28,v,76
TR 28,219,32768
TR 30,219,33792
MV 144,v,32,v,64
ds_read_b128 v[56:59], v224 offset:36864
v_accvgpr_read_b32 v250, a44
MV 148,v,32,v,68
buffer_load_dwordx4 v215, s[48:51], s66 offen offset:3072 lds
v_accvgpr_read_b32 v251, a45
MV 152,v,32,v,72
v_accvgpr_read_b32 v252, a46
v_accvgpr_read_b32 v253, a47
MV 156,v,32,v,76
TR 32,220,32768
TR 34,220,33792
MV 160,v,36,v,64
ds_read_b128 v[60:63], v224 offset:38912
s_add_u32 s66, s66, 524288
MV 164,v,36,v,68
s_and_b32 s66, s66, 8388607
v_cvt_pk_bf16_f32 v242, v246, v247
MV 168,v,36,v,72
v_cvt_pk_bf16_f32 v243, v248, v249
v_cvt_pk_bf16_f32 v244, v250, v251
MV 172,v,36,v,76
TR 36,221,32768
TR 38,221,33792
MV 176,v,40,v,64
s_add_u32 s75, s64, s74
v_cvt_pk_bf16_f32 v245, v252, v253
MV 180,v,40,v,68
buffer_store_dwordx4 v[242:245], v228, s[16:19], s24 offen offset:1024 sc1
v_accvgpr_read_b32 v234, a48
MV 184,v,40,v,72
s_add_u32 m0, s67, 0
v_accvgpr_read_b32 v235, a49
MV 188,v,40,v,76
TR 40,222,32768
TR 42,222,33792
MV 192,v,44,v,64
buffer_load_dwordx4 v208, s[44:47], s75 offen offset:0 lds
v_accvgpr_read_b32 v236, a50
MV 196,v,44,v,68
v_accvgpr_read_b32 v237, a51
v_accvgpr_read_b32 v238, a52
MV 200,v,44,v,72
MV 204,v,44,v,76
TR 44,223,32768
TR 46,223,33792
s_waitcnt lgkmcnt(4)
MV 80,v,16,v,48
buffer_load_dwordx4 v209, s[44:47], s75 offen offset:1024 lds
v_accvgpr_read_b32 v239, a53
MV 84,v,16,v,52
ds_read_b128 v[64:67], v225 offset:32768
v_accvgpr_read_b32 v240, a54
MV 88,v,16,v,56
buffer_load_dwordx4 v210, s[44:47], s75 offen offset:2048 lds
v_accvgpr_read_b32 v241, a55
MV 92,v,16,v,60
TR 16,216,40960
TR 18,216,41984
MV 96,v,20,v,48
v_cvt_pk_bf16_f32 v230, v234, v235
MV 100,v,20,v,52
buffer_load_dwordx4 v211, s[44:47], s75 offen offset:3072 lds
v_cvt_pk_bf16_f32 v231, v236, v237
MV 104,v,20,v,56
ds_read_b128 v[68:71], v225 offset:34816
MV 108,v,20,v,60
TR 20,217,40960
TR 22,217,41984
MV 112,v,24,v,48
s_add_u32 s75, s65, s74
v_cvt_pk_bf16_f32 v232, v238, v239
MV 116,v,24,v,52
v_cvt_pk_bf16_f32 v233, v240, v241
MV 120,v,24,v,56
buffer_store_dwordx4 v[230:233], v228, s[16:19], s24 offen offset:2048 sc1
MV 124,v,24,v,60
TR 24,218,40960
TR 26,218,41984
MV 128,v,28,v,48
ds_read_b128 v[72:75], v225 offset:36864
s_add_u32 m0, s67, 4096
MV 132,v,28,v,52
v_accvgpr_read_b32 v246, a56
v_accvgpr_read_b32 v247, a57
MV 136,v,28,v,56
buffer_load_dwordx4 v208, s[44:47], s75 offen offset:0 lds
v_accvgpr_read_b32 v248, a58
MV 140,v,28,v,60
TR 28,219,40960
TR 30,219,41984
MV 144,v,32,v,48
buffer_load_dwordx4 v209, s[44:47], s75 offen offset:1024 lds
v_accvgpr_read_b32 v249, a59
MV 148,v,32,v,52
v_accvgpr_read_b32 v250, a60
MV 152,v,32,v,56
ds_read_b128 v[76:79], v225 offset:38912
v_accvgpr_read_b32 v251, a61
MV 156,v,32,v,60
TR 32,220,40960
TR 34,220,41984
MV 160,v,36,v,48
buffer_load_dwordx4 v210, s[44:47], s75 offen offset:2048 lds
v_accvgpr_read_b32 v252, a62
MV 164,v,36,v,52
v_accvgpr_read_b32 v253, a63
MV 168,v,36,v,56
buffer_load_dwordx4 v211, s[44:47], s75 offen offset:3072 lds
v_cvt_pk_bf16_f32 v242, v246, v247
MV 172,v,36,v,60
TR 36,221,40960
TR 38,221,41984
s_waitcnt lgkmcnt(15)
MV 176,v,40,v,48
v_cvt_pk_bf16_f32 v243, v248, v249
MV 180,v,40,v,52
s_add_u32 s74, s74, 128
v_cvt_pk_bf16_f32 v244, v250, v251
MV 184,v,40,v,56
MV 188,v,40,v,60
TR 40,222,40960
TR 42,222,41984
MV 192,v,44,v,48
s_and_b32 s74, s74, 2047
v_cvt_pk_bf16_f32 v245, v252, v253
MV 196,v,44,v,52
buffer_store_dwordx4 v[242:245], v228, s[16:19], s24 offen offset:3072 sc1
MV 200,v,44,v,56
MV 204,v,44,v,60
TR 44,223,40960
TR 46,223,41984
s_waitcnt lgkmcnt(4)
MV 80,v,16,v,64
v_accvgpr_read_b32 v234, a64
MV 84,v,16,v,68
v_accvgpr_read_b32 v235, a65
MV 88,v,16,v,72
v_accvgpr_read_b32 v236, a66
MV 92,v,16,v,76
MV 96,v,20,v,64
v_accvgpr_read_b32 v237, a67
MV 100,v,20,v,68
v_accvgpr_read_b32 v238, a68
MV 104,v,20,v,72
MV 108,v,20,v,76
s_waitcnt vmcnt(16) lgkmcnt(0)
s_barrier
MV 112,v,24,v,64
TR 16,216,0
TR 18,216,1024
MV 116,v,24,v,68
ds_read_b128 v[48:51], v226 offset:0
s_add_u32 m0, s68, 131072
MV 120,v,24,v,72
TR 20,217,0
TR 22,217,1024
MV 124,v,24,v,76
buffer_load_dwordx4 v212, s[48:51], s66 offen offset:0 lds
v_accvgpr_read_b32 v239, a69
MV 128,v,28,v,64
TR 24,218,0
TR 26,218,1024
MV 132,v,28,v,68
ds_read_b128 v[52:55], v226 offset:2048
buffer_load_dwordx4 v213, s[48:51], s66 offen offset:1024 lds
MV 136,v,28,v,72
buffer_load_dwordx4 v214, s[48:51], s66 offen offset:2048 lds
v_accvgpr_read_b32 v240, a70
MV 140,v,28,v,76
TR 28,219,0
TR 30,219,1024
MV 144,v,32,v,64
ds_read_b128 v[56:59], v226 offset:4096
v_accvgpr_read_b32 v241, a71
MV 148,v,32,v,68
buffer_load_dwordx4 v215, s[48:51], s66 offen offset:3072 lds
v_cvt_pk_bf16_f32 v230, v234, v235
MV 152,v,32,v,72
v_cvt_pk_bf16_f32 v231, v236, v237
v_cvt_pk_bf16_f32 v232, v238, v239
MV 156,v,32,v,76
TR 32,220,0
TR 34,220,1024
MV 160,v,36,v,64
ds_read_b128 v[60:63], v226 offset:6144
s_add_u32 s66, s66, 524288
MV 164,v,36,v,68
s_and_b32 s66, s66, 8388607
v_cvt_pk_bf16_f32 v233, v240, v241
MV 168,v,36,v,72
s_add_u32 s24, s24, 4096
buffer_store_dwordx4 v[230:233], v228, s[16:19], s24 offen offset:0 sc1
MV 172,v,36,v,76
TR 36,221,0
TR 38,221,1024
MV 176,v,40,v,64
s_add_u32 s75, s64, s74
v_accvgpr_read_b32 v246, a72
MV 180,v,40,v,68
v_accvgpr_read_b32 v247, a73
v_accvgpr_read_b32 v248, a74
MV 184,v,40,v,72
s_add_u32 m0, s67, 32768
v_accvgpr_read_b32 v249, a75
MV 188,v,40,v,76
TR 40,222,0
TR 42,222,1024
MV 192,v,44,v,64
buffer_load_dwordx4 v208, s[44:47], s75 offen offset:0 lds
v_accvgpr_read_b32 v250, a76
MV 196,v,44,v,68
v_accvgpr_read_b32 v251, a77
v_accvgpr_read_b32 v252, a78
MV 200,v,44,v,72
MV 204,v,44,v,76
TR 44,223,0
TR 46,223,1024
s_waitcnt lgkmcnt(4)
MV 80,v,16,v,48
buffer_load_dwordx4 v209, s[44:47], s75 offen offset:1024 lds
v_accvgpr_read_b32 v253, a79
MV 84,v,16,v,52
ds_read_b128 v[64:67], v227 offset:0
v_cvt_pk_bf16_f32 v242, v246, v247
MV 88,v,16,v,56
buffer_load_dwordx4 v210, s[44:47], s75 offen offset:2048 lds
v_cvt_pk_bf16_f32 v243, v248, v249
MV 92,v,16,v,60
TR 16,216,8192
TR 18,216,9216
MV 96,v,20,v,48
v_cvt_pk_bf16_f32 v244, v250, v251
MV 100,v,20,v,52
buffer_load_dwordx4 v211, s[44:47], s75 offen offset:3072 lds
v_cvt_pk_bf16_f32 v245, v252, v253
MV 104,v,20,v,56
ds_read_b128 v[68:71], v227 offset:2048
buffer_store_dwordx4 v[242:245], v228, s[16:19], s24 offen offset:1024 sc1
MV 108,v,20,v,60
TR 20,217,8192
TR 22,217,9216
MV 112,v,24,v,48
s_add_u32 s75, s65, s74
v_accvgpr_read_b32 v234, a80
MV 116,v,24,v,52
v_accvgpr_read_b32 v235, a81
MV 120,v,24,v,56
v_accvgpr_read_b32 v236, a82
MV 124,v,24,v,60
TR 24,218,8192
TR 26,218,9216
MV 128,v,28,v,48
ds_read_b128 v[72:75], v227 offset:4096
s_add_u32 m0, s67, 36864
MV 132,v,28,v,52
v_accvgpr_read_b32 v237, a83
v_accvgpr_read_b32 v238, a84
MV 136,v,28,v,56
buffer_load_dwordx4 v208, s[44:47], s75 offen offset:0 lds
MV 140,v,28,v,60
TR 28,219,8192
TR 30,219,9216
MV 144,v,32,v,48
buffer_load_dwordx4 v209, s[44:47], s75 offen offset:1024 lds
v_accvgpr_read_b32 v239, a85
MV 148,v,32,v,52
v_accvgpr_read_b32 v240, a86
v_accvgpr_read_b32 v241, a87
MV 152,v,32,v,56
ds_read_b128 v[76:79], v227 offset:6144
MV 156,v,32,v,60
TR 32,220,8192
TR 34,220,9216
MV 160,v,36,v,48
buffer_load_dwordx4 v210, s[44:47], s75 offen offset:2048 lds
v_cvt_pk_bf16_f32 v230, v234, v235
MV 164,v,36,v,52
v_cvt_pk_bf16_f32 v231, v236, v237
v_cvt_pk_bf16_f32 v232, v238, v239
MV 168,v,36,v,56
buffer_load_dwordx4 v211, s[44:47], s75 offen offset:3072 lds
MV 172,v,36,v,60
TR 36,221,8192
TR 38,221,9216
s_waitcnt lgkmcnt(15)
MV 176,v,40,v,48
v_cvt_pk_bf16_f32 v233, v240, v241
buffer_store_dwordx4 v[230:233], v228, s[16:19], s24 offen offset:2048 sc1
MV 180,v,40,v,52
s_add_u32 s74, s74, 128
v_accvgpr_read_b32 v246, a88
MV 184,v,40,v,56
MV 188,v,40,v,60
TR 40,222,8192
TR 42,222,9216
MV 192,v,44,v,48
s_and_b32 s74, s74, 2047
v_accvgpr_read_b32 v247, a89
MV 196,v,44,v,52
v_accvgpr_read_b32 v248, a90
MV 200,v,44,v,56
MV 204,v,44,v,60
TR 44,223,8192
TR 46,223,9216
s_waitcnt lgkmcnt(4)
MV 80,v,16,v,64
v_accvgpr_read_b32 v249, a91
MV 84,v,16,v,68
v_accvgpr_read_b32 v250, a92
MV 88,v,16,v,72
v_accvgpr_read_b32 v251, a93
MV 92,v,16,v,76
MV 96,v,20,v,64
v_accvgpr_read_b32 v252, a94
MV 100,v,20,v,68
v_accvgpr_read_b32 v253, a95
MV 104,v,20,v,72
MV 108,v,20,v,76
s_waitcnt vmcnt(16) lgkmcnt(0)
s_barrier
MV 112,v,24,v,64
TR 16,216,16384
TR 18,216,17408
MV 116,v,24,v,68
ds_read_b128 v[48:51], v224 offset:0
s_add_u32 m0, s68, 98304
MV 120,v,24,v,72
TR 20,217,16384
TR 22,217,17408
MV 124,v,24,v,76
buffer_load_dwordx4 v212, s[48:51], s66 offen offset:0 lds
v_cvt_pk_bf16_f32 v242, v246, v247
MV 128,v,28,v,64
TR 24,218,16384
TR 26,218,17408
MV 132,v,28,v,68
ds_read_b128 v[52:55], v224 offset:2048
buffer_load_dwordx4 v213, s[48:51], s66 offen offset:1024 lds
MV 136,v,28,v,72
buffer_load_dwordx4 v214, s[48:51], s66 offen offset:2048 lds
v_cvt_pk_bf16_f32 v243, v248, v249
MV 140,v,28,v,76
TR 28,219,16384
TR 30,219,17408
MV 144,v,32,v,64
ds_read_b128 v[56:59], v224 offset:4096
v_cvt_pk_bf16_f32 v244, v250, v251
MV 148,v,32,v,68
buffer_load_dwordx4 v215, s[48:51], s66 offen offset:3072 lds
v_cvt_pk_bf16_f32 v245, v252, v253
MV 152,v,32,v,72
buffer_store_dwordx4 v[242:245], v228, s[16:19], s24 offen offset:3072 sc1
v_accvgpr_read_b32 v234, a96
MV 156,v,32,v,76
TR 32,220,16384
TR 34,220,17408
MV 160,v,36,v,64
ds_read_b128 v[60:63], v224 offset:6144
s_add_u32 s66, s66, 524288
MV 164,v,36,v,68
s_and_b32 s66, s66, 8388607
v_accvgpr_read_b32 v235, a97
MV 168,v,36,v,72
v_accvgpr_read_b32 v236, a98
v_accvgpr_read_b32 v237, a99
MV 172,v,36,v,76
TR 36,221,16384
TR 38,221,17408
MV 176,v,40,v,64
s_add_u32 s75, s64, s74
v_accvgpr_read_b32 v238, a100
MV 180,v,40,v,68
v_accvgpr_read_b32 v239, a101
v_accvgpr_read_b32 v240, a102
MV 184,v,40,v,72
s_add_u32 m0, s67, 65536
v_accvgpr_read_b32 v241, a103
MV 188,v,40,v,76
TR 40,222,16384
TR 42,222,17408
MV 192,v,44,v,64
buffer_load_dwordx4 v208, s[44:47], s75 offen offset:0 lds
v_cvt_pk_bf16_f32 v230, v234, v235
MV 196,v,44,v,68
v_cvt_pk_bf16_f32 v231, v236, v237
v_cvt_pk_bf16_f32 v232, v238, v239
MV 200,v,44,v,72
MV 204,v,44,v,76
TR 44,223,16384
TR 46,223,17408
s_waitcnt lgkmcnt(4)
MV 80,v,16,v,48
buffer_load_dwordx4 v209, s[44:47], s75 offen offset:1024 lds
v_cvt_pk_bf16_f32 v233, v240, v241
MV 84,v,16,v,52
ds_read_b128 v[64:67], v225 offset:0
s_add_u32 s24, s24, 4096
MV 88,v,16,v,56
buffer_load_dwordx4 v210, s[44:47], s75 offen offset:2048 lds
buffer_store_dwordx4 v[230:233], v228, s[16:19], s24 offen offset:0 sc1
MV 92,v,16,v,60
TR 16,216,24576
TR 18,216,25600
MV 96,v,20,v,48
v_accvgpr_read_b32 v246, a104
MV 100,v,20,v,52
buffer_load_dwordx4 v211, s[44:47], s75 offen offset:3072 lds
v_accvgpr_read_b32 v247, a105
MV 104,v,20,v,56
ds_read_b128 v[68:71], v225 offset:2048
MV 108,v,20,v,60
TR 20,217,24576
TR 22,217,25600
MV 112,v,24,v,48
s_add_u32 s75, s65, s74
v_accvgpr_read_b32 v248, a106
MV 116,v,24,v,52
v_accvgpr_read_b32 v249, a107
MV 120,v,24,v,56
v_accvgpr_read_b32 v250, a108
MV 124,v,24,v,60
TR 24,218,24576
TR 26,218,25600
MV 128,v,28,v,48
ds_read_b128 v[72:75], v225 offset:4096
s_add_u32 m0, s67, 69632
MV 132,v,28,v,52
v_accvgpr_read_b32 v251, a109
v_accvgpr_read_b32 v252, a110
MV 136,v,28,v,56
buffer_load_dwordx4 v208, s[44:47], s75 offen offset:0 lds
v_accvgpr_read_b32 v253, a111
MV 140,v,28,v,60
TR 28,219,24576
TR 30,219,25600
MV 144,v,32,v,48
buffer_load_dwordx4 v209, s[44:47], s75 offen offset:1024 lds
v_cvt_pk_bf16_f32 v242, v246, v247
MV 148,v,32,v,52
v_cvt_pk_bf16_f32 v243, v248, v249
MV 152,v,32,v,56
ds_read_b128 v[76:79], v225 offset:6144
v_cvt_pk_bf16_f32 v244, v250, v251
MV 156,v,32,v,60
TR 32,220,24576
TR 34,220,25600
MV 160,v,36,v,48
buffer_load_dwordx4 v210, s[44:47], s75 offen offset:2048 lds
v_cvt_pk_bf16_f32 v245, v252, v253
MV 164,v,36,v,52
buffer_store_dwordx4 v[242:245], v228, s[16:19], s24 offen offset:1024 sc1
MV 168,v,36,v,56
buffer_load_dwordx4 v211, s[44:47], s75 offen offset:3072 lds
v_accvgpr_read_b32 v234, a112
MV 172,v,36,v,60
TR 36,221,24576
TR 38,221,25600
s_waitcnt lgkmcnt(15)
MV 176,v,40,v,48
v_accvgpr_read_b32 v235, a113
MV 180,v,40,v,52
s_add_u32 s74, s74, 128
v_accvgpr_read_b32 v236, a114
MV 184,v,40,v,56
MV 188,v,40,v,60
TR 40,222,24576
TR 42,222,25600
MV 192,v,44,v,48
s_and_b32 s74, s74, 2047
v_accvgpr_read_b32 v237, a115
MV 196,v,44,v,52
v_accvgpr_read_b32 v238, a116
MV 200,v,44,v,56
MV 204,v,44,v,60
TR 44,223,24576
TR 46,223,25600
s_waitcnt lgkmcnt(4)
MV 80,v,16,v,64
v_accvgpr_read_b32 v239, a117
MV 84,v,16,v,68
v_accvgpr_read_b32 v240, a118
MV 88,v,16,v,72
v_accvgpr_read_b32 v241, a119
MV 92,v,16,v,76
MV 96,v,20,v,64
v_cvt_pk_bf16_f32 v230, v234, v235
MV 100,v,20,v,68
v_cvt_pk_bf16_f32 v231, v236, v237
MV 104,v,20,v,72
MV 108,v,20,v,76
s_waitcnt vmcnt(16) lgkmcnt(0)
s_barrier
MV 112,v,24,v,64
TR 16,216,32768
TR 18,216,33792
MV 116,v,24,v,68
ds_read_b128 v[48:51], v224 offset:32768
s_add_u32 m0, s68, 114688
MV 120,v,24,v,72
TR 20,217,32768
TR 22,217,33792
MV 124,v,24,v,76
buffer_load_dwordx4 v212, s[48:51], s66 offen offset:0 lds
v_cvt_pk_bf16_f32 v232, v238, v239
MV 128,v,28,v,64
TR 24,218,32768
TR 26,218,33792
MV 132,v,28,v,68
ds_read_b128 v[52:55], v224 offset:34816
buffer_load_dwordx4 v213, s[48:51], s66 offen offset:1024 lds
MV 136,v,28,v,72
buffer_load_dwordx4 v214, s[48:51], s66 offen offset:2048 lds
v_cvt_pk_bf16_f32 v233, v240, v241
MV 140,v,28,v,76
TR 28,219,32768
TR 30,219,33792
MV 144,v,32,v,64
ds_read_b128 v[56:59], v224 offset:36864
buffer_store_dwordx4 v[230:233], v228, s[16:19], s24 offen offset:2048 sc1
MV 148,v,32,v,68
buffer_load_dwordx4 v215, s[48:51], s66 offen offset:3072 lds
v_accvgpr_read_b32 v246, a120
MV 152,v,32,v,72
v_accvgpr_read_b32 v247, a121
v_accvgpr_read_b32 v248, a122
MV 156,v,32,v,76
TR 32,220,32768
TR 34,220,33792
MV 160,v,36,v,64
ds_read_b128 v[60:63], v224 offset:38912
s_add_u32 s66, s66, 524288
MV 164,v,36,v,68
s_and_b32 s66, s66, 8388607
v_accvgpr_read_b32 v249, a123
MV 168,v,36,v,72
v_accvgpr_read_b32 v250, a124
v_accvgpr_read_b32 v251, a125
MV 172,v,36,v,76
TR 36,221,32768
TR 38,221,33792
MV 176,v,40,v,64
s_add_u32 s75, s64, s74
v_accvgpr_read_b32 v252, a126
MV 180,v,40,v,68
v_accvgpr_read_b32 v253, a127
v_cvt_pk_bf16_f32 v242, v246, v247
MV 184,v,40,v,72
s_add_u32 m0, s67, 0
v_cvt_pk_bf16_f32 v243, v248, v249
MV 188,v,40,v,76
TR 40,222,32768
TR 42,222,33792
MV 192,v,44,v,64
buffer_load_dwordx4 v208, s[44:47], s75 offen offset:0 lds
v_cvt_pk_bf16_f32 v244, v250, v251
MV 196,v,44,v,68
v_cvt_pk_bf16_f32 v245, v252, v253
buffer_store_dwordx4 v[242:245], v228, s[16:19], s24 offen offset:3072 sc1
MV 200,v,44,v,72
MV 204,v,44,v,76
TR 44,223,32768
TR 46,223,33792
s_waitcnt lgkmcnt(4)
MV 80,v,16,v,48
buffer_load_dwordx4 v209, s[44:47], s75 offen offset:1024 lds
v_accvgpr_read_b32 v234, a128
MV 84,v,16,v,52
ds_read_b128 v[64:67], v225 offset:32768
v_accvgpr_read_b32 v235, a129
MV 88,v,16,v,56
buffer_load_dwordx4 v210, s[44:47], s75 offen offset:2048 lds
v_accvgpr_read_b32 v236, a130
MV 92,v,16,v,60
TR 16,216,40960
TR 18,216,41984
MV 96,v,20,v,48
v_accvgpr_read_b32 v237, a131
MV 100,v,20,v,52
buffer_load_dwordx4 v211, s[44:47], s75 offen offset:3072 lds
v_accvgpr_read_b32 v238, a132
MV 104,v,20,v,56
ds_read_b128 v[68:71], v225 offset:34816
MV 108,v,20,v,60
TR 20,217,40960
TR 22,217,41984
MV 112,v,24,v,48
s_add_u32 s75, s65, s74
v_accvgpr_read_b32 v239, a133
MV 116,v,24,v,52
v_accvgpr_read_b32 v240, a134
MV 120,v,24,v,56
v_accvgpr_read_b32 v241, a135
MV 124,v,24,v,60
TR 24,218,40960
TR 26,218,41984
MV 128,v,28,v,48
ds_read_b128 v[72:75], v225 offset:36864
s_add_u32 m0, s67, 4096
MV 132,v,28,v,52
v_cvt_pk_bf16_f32 v230, v234, v235
v_cvt_pk_bf16_f32 v231, v236, v237
MV 136,v,28,v,56
buffer_load_dwordx4 v208, s[44:47], s75 offen offset:0 lds
v_cvt_pk_bf16_f32 v232, v238, v239
MV 140,v,28,v,60
TR 28,219,40960
TR 30,219,41984
MV 144,v,32,v,48
buffer_load_dwordx4 v209, s[44:47], s75 offen offset:1024 lds
v_cvt_pk_bf16_f32 v233, v240, v241
MV 148,v,32,v,52
s_add_u32 s24, s24, 4096
MV 152,v,32,v,56
ds_read_b128 v[76:79], v225 offset:38912
buffer_store_dwordx4 v[230:233], v228, s[16:19], s24 offen offset:0 sc1
MV 156,v,32,v,60
TR 32,220,40960
TR 34,220,41984
MV 160,v,36,v,48
buffer_load_dwordx4 v210, s[44:47], s75 offen offset:2048 lds
v_accvgpr_read_b32 v246, a136
MV 164,v,36,v,52
v_accvgpr_read_b32 v247, a137
MV 168,v,36,v,56
buffer_load_dwordx4 v211, s[44:47], s75 offen offset:3072 lds
v_accvgpr_read_b32 v248, a138
MV 172,v,36,v,60
TR 36,221,40960
TR 38,221,41984
s_waitcnt lgkmcnt(15)
MV 176,v,40,v,48
v_accvgpr_read_b32 v249, a139
MV 180,v,40,v,52
s_add_u32 s74, s74, 128
v_accvgpr_read_b32 v250, a140
MV 184,v,40,v,56
MV 188,v,40,v,60
TR 40,222,40960
TR 42,222,41984
MV 192,v,44,v,48
s_and_b32 s74, s74, 2047
v_accvgpr_read_b32 v251, a141
MV 196,v,44,v,52
v_accvgpr_read_b32 v252, a142
MV 200,v,44,v,56
MV 204,v,44,v,60
TR 44,223,40960
TR 46,223,41984
s_waitcnt lgkmcnt(4)
MV 80,v,16,v,64
v_accvgpr_read_b32 v253, a143
MV 84,v,16,v,68
v_cvt_pk_bf16_f32 v242, v246, v247
MV 88,v,16,v,72
v_cvt_pk_bf16_f32 v243, v248, v249
MV 92,v,16,v,76
MV 96,v,20,v,64
v_cvt_pk_bf16_f32 v244, v250, v251
MV 100,v,20,v,68
v_cvt_pk_bf16_f32 v245, v252, v253
MV 104,v,20,v,72
MV 108,v,20,v,76
s_waitcnt vmcnt(15) lgkmcnt(0)
s_barrier
MV 112,v,24,v,64
TR 16,216,0
TR 18,216,1024
MV 116,v,24,v,68
ds_read_b128 v[48:51], v226 offset:0
s_add_u32 m0, s68, 131072
MV 120,v,24,v,72
TR 20,217,0
TR 22,217,1024
MV 124,v,24,v,76
buffer_load_dwordx4 v212, s[48:51], s66 offen offset:0 lds
buffer_store_dwordx4 v[242:245], v228, s[16:19], s24 offen offset:1024 sc1
MV 128,v,28,v,64
TR 24,218,0
TR 26,218,1024
MV 132,v,28,v,68
ds_read_b128 v[52:55], v226 offset:2048
buffer_load_dwordx4 v213, s[48:51], s66 offen offset:1024 lds
MV 136,v,28,v,72
buffer_load_dwordx4 v214, s[48:51], s66 offen offset:2048 lds
v_accvgpr_read_b32 v234, a144
MV 140,v,28,v,76
TR 28,219,0
TR 30,219,1024
MV 144,v,32,v,64
ds_read_b128 v[56:59], v226 offset:4096
v_accvgpr_read_b32 v235, a145
MV 148,v,32,v,68
buffer_load_dwordx4 v215, s[48:51], s66 offen offset:3072 lds
v_accvgpr_read_b32 v236, a146
MV 152,v,32,v,72
v_accvgpr_read_b32 v237, a147
v_accvgpr_read_b32 v238, a148
MV 156,v,32,v,76
TR 32,220,0
TR 34,220,1024
MV 160,v,36,v,64
ds_read_b128 v[60:63], v226 offset:6144
s_add_u32 s66, s66, 524288
MV 164,v,36,v,68
s_and_b32 s66, s66, 8388607
v_accvgpr_read_b32 v239, a149
MV 168,v,36,v,72
v_accvgpr_read_b32 v240, a150
v_accvgpr_read_b32 v241, a151
MV 172,v,36,v,76
TR 36,221,0
TR 38,221,1024
MV 176,v,40,v,64
s_add_u32 s75, s64, s74
v_cvt_pk_bf16_f32 v230, v234, v235
MV 180,v,40,v,68
v_cvt_pk_bf16_f32 v231, v236, v237
v_cvt_pk_bf16_f32 v232, v238, v239
MV 184,v,40,v,72
s_add_u32 m0, s67, 32768
v_cvt_pk_bf16_f32 v233, v240, v241
MV 188,v,40,v,76
TR 40,222,0
TR 42,222,1024
MV 192,v,44,v,64
buffer_load_dwordx4 v208, s[44:47], s75 offen offset:0 lds
buffer_store_dwordx4 v[230:233], v228, s[16:19], s24 offen offset:2048 sc1
MV 196,v,44,v,68
v_accvgpr_read_b32 v246, a152
v_accvgpr_read_b32 v247, a153
MV 200,v,44,v,72
MV 204,v,44,v,76
TR 44,223,0
TR 46,223,1024
s_waitcnt lgkmcnt(4)
MV 80,v,16,v,48
buffer_load_dwordx4 v209, s[44:47], s75 offen offset:1024 lds
v_accvgpr_read_b32 v248, a154
MV 84,v,16,v,52
ds_read_b128 v[64:67], v227 offset:0
v_accvgpr_read_b32 v249, a155
MV 88,v,16,v,56
buffer_load_dwordx4 v210, s[44:47], s75 offen offset:2048 lds
v_accvgpr_read_b32 v250, a156
MV 92,v,16,v,60
TR 16,216,8192
TR 18,216,9216
MV 96,v,20,v,48
v_accvgpr_read_b32 v251, a157
MV 100,v,20,v,52
buffer_load_dwordx4 v211, s[44:47], s75 offen offset:3072 lds
v_accvgpr_read_b32 v252, a158
MV 104,v,20,v,56
ds_read_b128 v[68:71], v227 offset:2048
MV 108,v,20,v,60
TR 20,217,8192
TR 22,217,9216
MV 112,v,24,v,48
s_add_u32 s75, s65, s74
v_accvgpr_read_b32 v253, a159
MV 116,v,24,v,52
v_cvt_pk_bf16_f32 v242, v246, v247
MV 120,v,24,v,56
v_cvt_pk_bf16_f32 v243, v248, v249
MV 124,v,24,v,60
TR 24,218,8192
TR 26,218,9216
MV 128,v,28,v,48
ds_read_b128 v[72:75], v227 offset:4096
s_add_u32 m0, s67, 36864
MV 132,v,28,v,52
v_cvt_pk_bf16_f32 v244, v250, v251
v_cvt_pk_bf16_f32 v245, v252, v253
MV 136,v,28,v,56
buffer_load_dwordx4 v208, s[44:47], s75 offen offset:0 lds
buffer_store_dwordx4 v[242:245], v228, s[16:19], s24 offen offset:3072 sc1
MV 140,v,28,v,60
TR 28,219,8192
TR 30,219,9216
MV 144,v,32,v,48
buffer_load_dwordx4 v209, s[44:47], s75 offen offset:1024 lds
v_accvgpr_read_b32 v234, a160
MV 148,v,32,v,52
v_accvgpr_read_b32 v235, a161
MV 152,v,32,v,56
ds_read_b128 v[76:79], v227 offset:6144
v_accvgpr_read_b32 v236, a162
MV 156,v,32,v,60
TR 32,220,8192
TR 34,220,9216
MV 160,v,36,v,48
buffer_load_dwordx4 v210, s[44:47], s75 offen offset:2048 lds
v_accvgpr_read_b32 v237, a163
MV 164,v,36,v,52
v_accvgpr_read_b32 v238, a164
MV 168,v,36,v,56
buffer_load_dwordx4 v211, s[44:47], s75 offen offset:3072 lds
v_accvgpr_read_b32 v239, a165
MV 172,v,36,v,60
TR 36,221,8192
TR 38,221,9216
s_waitcnt lgkmcnt(15)
MV 176,v,40,v,48
v_accvgpr_read_b32 v240, a166
MV 180,v,40,v,52
s_add_u32 s74, s74, 128
v_accvgpr_read_b32 v241, a167
MV 184,v,40,v,56
MV 188,v,40,v,60
TR 40,222,8192
TR 42,222,9216
MV 192,v,44,v,48
s_and_b32 s74, s74, 2047
v_cvt_pk_bf16_f32 v230, v234, v235
MV 196,v,44,v,52
v_cvt_pk_bf16_f32 v231, v236, v237
MV 200,v,44,v,56
MV 204,v,44,v,60
TR 44,223,8192
TR 46,223,9216
s_waitcnt lgkmcnt(4)
MV 80,v,16,v,64
v_cvt_pk_bf16_f32 v232, v238, v239
MV 84,v,16,v,68
v_cvt_pk_bf16_f32 v233, v240, v241
MV 88,v,16,v,72
s_add_u32 s24, s24, 4096
MV 92,v,16,v,76
MV 96,v,20,v,64
buffer_store_dwordx4 v[230:233], v228, s[16:19], s24 offen offset:0 sc1
MV 100,v,20,v,68
v_accvgpr_read_b32 v246, a168
MV 104,v,20,v,72
v_accvgpr_read_b32 v247, a169
MV 108,v,20,v,76
s_waitcnt vmcnt(16) lgkmcnt(0)
s_barrier
MV 112,v,24,v,64
TR 16,216,16384
TR 18,216,17408
MV 116,v,24,v,68
ds_read_b128 v[48:51], v224 offset:0
s_add_u32 m0, s68, 98304
MV 120,v,24,v,72
TR 20,217,16384
TR 22,217,17408
MV 124,v,24,v,76
buffer_load_dwordx4 v212, s[48:51], s66 offen offset:0 lds
v_accvgpr_read_b32 v248, a170
MV 128,v,28,v,64
TR 24,218,16384
TR 26,218,17408
MV 132,v,28,v,68
ds_read_b128 v[52:55], v224 offset:2048
buffer_load_dwordx4 v213, s[48:51], s66 offen offset:1024 lds
MV 136,v,28,v,72
buffer_load_dwordx4 v214, s[48:51], s66 offen offset:2048 lds
v_accvgpr_read_b32 v249, a171
MV 140,v,28,v,76
TR 28,219,16384
TR 30,219,17408
MV 144,v,32,v,64
ds_read_b128 v[56:59], v224 offset:4096
v_accvgpr_read_b32 v250, a172
MV 148,v,32,v,68
buffer_load_dwordx4 v215, s[48:51], s66 offen offset:3072 lds
v_accvgpr_read_b32 v251, a173
MV 152,v,32,v,72
v_accvgpr_read_b32 v252, a174
v_accvgpr_read_b32 v253, a175
MV 156,v,32,v,76
TR 32,220,16384
TR 34,220,17408
MV 160,v,36,v,64
ds_read_b128 v[60:63], v224 offset:6144
s_add_u32 s66, s66, 524288
MV 164,v,36,v,68
s_and_b32 s66, s66, 8388607
v_cvt_pk_bf16_f32 v242, v246, v247
MV 168,v,36,v,72
v_cvt_pk_bf16_f32 v243, v248, v249
v_cvt_pk_bf16_f32 v244, v250, v251
MV 172,v,36,v,76
TR 36,221,16384
TR 38,221,17408
MV 176,v,40,v,64
s_add_u32 s75, s64, s74
v_cvt_pk_bf16_f32 v245, v252, v253
MV 180,v,40,v,68
buffer_store_dwordx4 v[242:245], v228, s[16:19], s24 offen offset:1024 sc1
v_accvgpr_read_b32 v234, a176
MV 184,v,40,v,72
s_add_u32 m0, s67, 65536
v_accvgpr_read_b32 v235, a177
MV 188,v,40,v,76
TR 40,222,16384
TR 42,222,17408
MV 192,v,44,v,64
buffer_load_dwordx4 v208, s[44:47], s75 offen offset:0 lds
v_accvgpr_read_b32 v236, a178
MV 196,v,44,v,68
v_accvgpr_read_b32 v237, a179
v_accvgpr_read_b32 v238, a180
MV 200,v,44,v,72
MV 204,v,44,v,76
TR 44,223,16384
TR 46,223,17408
s_waitcnt lgkmcnt(4)
MV 80,v,16,v,48
buffer_load_dwordx4 v209, s[44:47], s75 offen offset:1024 lds
v_accvgpr_read_b32 v239, a181
MV 84,v,16,v,52
ds_read_b128 v[64:67], v225 offset:0
v_accvgpr_read_b32 v240, a182
MV 88,v,16,v,56
buffer_load_dwordx4 v210, s[44:47], s75 offen offset:2048 lds
v_accvgpr_read_b32 v241, a183
MV 92,v,16,v,60
TR 16,216,24576
TR 18,216,25600
MV 96,v,20,v,48
v_cvt_pk_bf16_f32 v230, v234, v235
MV 100,v,20,v,52
buffer_load_dwordx4 v211, s[44:47], s75 offen offset:3072 lds
v_cvt_pk_bf16_f32 v231, v236, v237
MV 104,v,20,v,56
ds_read_b128 v[68:71], v225 offset:2048
v_cvt_pk_bf16_f32 v232, v238, v239
MV 108,v,20,v,60
TR 20,217,24576
TR 22,217,25600
MV 112,v,24,v,48
s_add_u32 s75, s65, s74
v_cvt_pk_bf16_f32 v233, v240, v241
MV 116,v,24,v,52
buffer_store_dwordx4 v[230:233], v228, s[16:19], s24 offen offset:2048 sc1
MV 120,v,24,v,56
v_accvgpr_read_b32 v246, a184
MV 124,v,24,v,60
TR 24,218,24576
TR 26,218,25600
MV 128,v,28,v,48
ds_read_b128 v[72:75], v225 offset:4096
s_add_u32 m0, s67, 69632
MV 132,v,28,v,52
v_accvgpr_read_b32 v247, a185
v_accvgpr_read_b32 v248, a186
MV 136,v,28,v,56
buffer_load_dwordx4 v208, s[44:47], s75 offen offset:0 lds
MV 140,v,28,v,60
TR 28,219,24576
TR 30,219,25600
MV 144,v,32,v,48
buffer_load_dwordx4 v209, s[44:47], s75 offen offset:1024 lds
v_accvgpr_read_b32 v249, a187
MV 148,v,32,v,52
v_accvgpr_read_b32 v250, a188
v_accvgpr_read_b32 v251, a189
MV 152,v,32,v,56
ds_read_b128 v[76:79], v225 offset:6144
MV 156,v,32,v,60
TR 32,220,24576
TR 34,220,25600
MV 160,v,36,v,48
buffer_load_dwordx4 v210, s[44:47], s75 offen offset:2048 lds
v_accvgpr_read_b32 v252, a190
MV 164,v,36,v,52
v_accvgpr_read_b32 v253, a191
v_cvt_pk_bf16_f32 v242, v246, v247
MV 168,v,36,v,56
buffer_load_dwordx4 v211, s[44:47], s75 offen offset:3072 lds
MV 172,v,36,v,60
TR 36,221,24576
TR 38,221,25600
s_waitcnt lgkmcnt(15)
MV 176,v,40,v,48
v_cvt_pk_bf16_f32 v243, v248, v249
v_cvt_pk_bf16_f32 v244, v250, v251
MV 180,v,40,v,52
s_add_u32 s74, s74, 128
v_cvt_pk_bf16_f32 v245, v252, v253
MV 184,v,40,v,56
MV 188,v,40,v,60
TR 40,222,24576
TR 42,222,25600
MV 192,v,44,v,48
s_and_b32 s74, s74, 2047
buffer_store_dwordx4 v[242:245], v228, s[16:19], s24 offen offset:3072 sc1
MV 196,v,44,v,52
buffer_load_dword v254, off, s[12:15], 0 sc1
MV 200,v,44,v,56
MV 204,v,44,v,60
TR 44,223,24576
TR 46,223,25600
s_waitcnt lgkmcnt(4)
MV 80,v,16,v,64
v_accvgpr_read_b32 v234, a192
MV 84,v,16,v,68
v_accvgpr_read_b32 v235, a193
MV 88,v,16,v,72
v_accvgpr_read_b32 v236, a194
MV 92,v,16,v,76
MV 96,v,20,v,64
v_accvgpr_read_b32 v237, a195
MV 100,v,20,v,68
v_accvgpr_read_b32 v238, a196
MV 104,v,20,v,72
MV 108,v,20,v,76
s_waitcnt vmcnt(17) lgkmcnt(0)
s_barrier
MV 112,v,24,v,64
TR 16,216,32768
TR 18,216,33792
MV 116,v,24,v,68
ds_read_b128 v[48:51], v224 offset:32768
s_add_u32 m0, s68, 114688
MV 120,v,24,v,72
TR 20,217,32768
TR 22,217,33792
MV 124,v,24,v,76
buffer_load_dwordx4 v212, s[48:51], s66 offen offset:0 lds
v_accvgpr_read_b32 v239, a197
MV 128,v,28,v,64
TR 24,218,32768
TR 26,218,33792
MV 132,v,28,v,68
ds_read_b128 v[52:55], v224 offset:34816
buffer_load_dwordx4 v213, s[48:51], s66 offen offset:1024 lds
MV 136,v,28,v,72
buffer_load_dwordx4 v214, s[48:51], s66 offen offset:2048 lds
v_accvgpr_read_b32 v240, a198
MV 140,v,28,v,76
TR 28,219,32768
TR 30,219,33792
MV 144,v,32,v,64
ds_read_b128 v[56:59], v224 offset:36864
v_accvgpr_read_b32 v241, a199
MV 148,v,32,v,68
buffer_load_dwordx4 v215, s[48:51], s66 offen offset:3072 lds
v_cvt_pk_bf16_f32 v230, v234, v235
MV 152,v,32,v,72
v_cvt_pk_bf16_f32 v231, v236, v237
v_cvt_pk_bf16_f32 v232, v238, v239
MV 156,v,32,v,76
TR 32,220,32768
TR 34,220,33792
MV 160,v,36,v,64
ds_read_b128 v[60:63], v224 offset:38912
s_add_u32 s66, s66, 524288
MV 164,v,36,v,68
s_and_b32 s66, s66, 8388607
v_cvt_pk_bf16_f32 v233, v240, v241
MV 168,v,36,v,72
s_add_u32 s24, s24, 4096
buffer_store_dwordx4 v[230:233], v228, s[16:19], s24 offen offset:0 sc1
MV 172,v,36,v,76
TR 36,221,32768
TR 38,221,33792
MV 176,v,40,v,64
s_add_u32 s75, s64, s74
v_accvgpr_read_b32 v246, a200
MV 180,v,40,v,68
v_accvgpr_read_b32 v247, a201
v_accvgpr_read_b32 v248, a202
MV 184,v,40,v,72
s_add_u32 m0, s67, 0
v_accvgpr_read_b32 v249, a203
MV 188,v,40,v,76
TR 40,222,32768
TR 42,222,33792
MV 192,v,44,v,64
buffer_load_dwordx4 v208, s[44:47], s75 offen offset:0 lds
v_accvgpr_read_b32 v250, a204
MV 196,v,44,v,68
v_accvgpr_read_b32 v251, a205
v_accvgpr_read_b32 v252, a206
MV 200,v,44,v,72
MV 204,v,44,v,76
TR 44,223,32768
TR 46,223,33792
s_waitcnt lgkmcnt(4)
MV 80,v,16,v,48
buffer_load_dwordx4 v209, s[44:47], s75 offen offset:1024 lds
v_accvgpr_read_b32 v253, a207
MV 84,v,16,v,52
ds_read_b128 v[64:67], v225 offset:32768
v_cvt_pk_bf16_f32 v242, v246, v247
MV 88,v,16,v,56
buffer_load_dwordx4 v210, s[44:47], s75 offen offset:2048 lds
v_cvt_pk_bf16_f32 v243, v248, v249
MV 92,v,16,v,60
TR 16,216,40960
TR 18,216,41984
MV 96,v,20,v,48
v_cvt_pk_bf16_f32 v244, v250, v251
MV 100,v,20,v,52
buffer_load_dwordx4 v211, s[44:47], s75 offen offset:3072 lds
v_cvt_pk_bf16_f32 v245, v252, v253
MV 104,v,20,v,56
ds_read_b128 v[68:71], v225 offset:34816
MV 108,v,20,v,60
TR 20,217,40960
TR 22,217,41984
MV 112,v,24,v,48
s_add_u32 s75, s65, s74
buffer_store_dwordx4 v[242:245], v228, s[16:19], s24 offen offset:1024 sc1
MV 116,v,24,v,52
v_accvgpr_read_b32 v234, a208
MV 120,v,24,v,56
v_accvgpr_read_b32 v235, a209
MV 124,v,24,v,60
TR 24,218,40960
TR 26,218,41984
MV 128,v,28,v,48
ds_read_b128 v[72:75], v225 offset:36864
s_add_u32 m0, s67, 4096
MV 132,v,28,v,52
v_accvgpr_read_b32 v236, a210
v_accvgpr_read_b32 v237, a211
MV 136,v,28,v,56
buffer_load_dwordx4 v208, s[44:47], s75 offen offset:0 lds
v_accvgpr_read_b32 v238, a212
MV 140,v,28,v,60
TR 28,219,40960
TR 30,219,41984
MV 144,v,32,v,48
buffer_load_dwordx4 v209, s[44:47], s75 offen offset:1024 lds
v_accvgpr_read_b32 v239, a213
MV 148,v,32,v,52
v_accvgpr_read_b32 v240, a214
MV 152,v,32,v,56
ds_read_b128 v[76:79], v225 offset:38912
v_accvgpr_read_b32 v241, a215
MV 156,v,32,v,60
TR 32,220,40960
TR 34,220,41984
MV 160,v,36,v,48
buffer_load_dwordx4 v210, s[44:47], s75 offen offset:2048 lds
v_cvt_pk_bf16_f32 v230, v234, v235
MV 164,v,36,v,52
v_cvt_pk_bf16_f32 v231, v236, v237
MV 168,v,36,v,56
buffer_load_dwordx4 v211, s[44:47], s75 offen offset:3072 lds
v_cvt_pk_bf16_f32 v232, v238, v239
MV 172,v,36,v,60
TR 36,221,40960
TR 38,221,41984
s_waitcnt lgkmcnt(15)
MV 176,v,40,v,48
v_cvt_pk_bf16_f32 v233, v240, v241
MV 180,v,40,v,52
s_add_u32 s74, s74, 128
buffer_store_dwordx4 v[230:233], v228, s[16:19], s24 offen offset:2048 sc1
MV 184,v,40,v,56
MV 188,v,40,v,60
TR 40,222,40960
TR 42,222,41984
MV 192,v,44,v,48
s_and_b32 s74, s74, 2047
v_accvgpr_read_b32 v246, a216
MV 196,v,44,v,52
v_accvgpr_read_b32 v247, a217
MV 200,v,44,v,56
MV 204,v,44,v,60
TR 44,223,40960
TR 46,223,41984
s_waitcnt lgkmcnt(4)
MV 80,v,16,v,64
v_accvgpr_read_b32 v248, a218
MV 84,v,16,v,68
v_accvgpr_read_b32 v249, a219
MV 88,v,16,v,72
v_accvgpr_read_b32 v250, a220
MV 92,v,16,v,76
MV 96,v,20,v,64
v_accvgpr_read_b32 v251, a221
MV 100,v,20,v,68
v_accvgpr_read_b32 v252, a222
MV 104,v,20,v,72
MV 108,v,20,v,76
s_waitcnt vmcnt(17) lgkmcnt(0)
s_barrier
MV 112,v,24,v,64
TR 16,216,0
TR 18,216,1024
MV 116,v,24,v,68
ds_read_b128 v[48:51], v226 offset:0
s_add_u32 m0, s68, 131072
MV 120,v,24,v,72
TR 20,217,0
TR 22,217,1024
MV 124,v,24,v,76
buffer_load_dwordx4 v212, s[48:51], s66 offen offset:0 lds
v_accvgpr_read_b32 v253, a223
MV 128,v,28,v,64
TR 24,218,0
TR 26,218,1024
MV 132,v,28,v,68
ds_read_b128 v[52:55], v226 offset:2048
buffer_load_dwordx4 v213, s[48:51], s66 offen offset:1024 lds
MV 136,v,28,v,72
buffer_load_dwordx4 v214, s[48:51], s66 offen offset:2048 lds
v_cvt_pk_bf16_f32 v242, v246, v247
MV 140,v,28,v,76
TR 28,219,0
TR 30,219,1024
MV 144,v,32,v,64
ds_read_b128 v[56:59], v226 offset:4096
v_cvt_pk_bf16_f32 v243, v248, v249
MV 148,v,32,v,68
buffer_load_dwordx4 v215, s[48:51], s66 offen offset:3072 lds
v_cvt_pk_bf16_f32 v244, v250, v251
MV 152,v,32,v,72
v_cvt_pk_bf16_f32 v245, v252, v253
buffer_store_dwordx4 v[242:245], v228, s[16:19], s24 offen offset:3072 sc1
MV 156,v,32,v,76
TR 32,220,0
TR 34,220,1024
MV 160,v,36,v,64
ds_read_b128 v[60:63], v226 offset:6144
s_add_u32 s66, s66, 524288
MV 164,v,36,v,68
s_and_b32 s66, s66, 8388607
v_accvgpr_read_b32 v234, a224
MV 168,v,36,v,72
v_accvgpr_read_b32 v235, a225
v_accvgpr_read_b32 v236, a226
MV 172,v,36,v,76
TR 36,221,0
TR 38,221,1024
MV 176,v,40,v,64
s_add_u32 s75, s64, s74
v_accvgpr_read_b32 v237, a227
MV 180,v,40,v,68
v_accvgpr_read_b32 v238, a228
v_accvgpr_read_b32 v239, a229
MV 184,v,40,v,72
s_add_u32 m0, s67, 32768
v_accvgpr_read_b32 v240, a230
MV 188,v,40,v,76
TR 40,222,0
TR 42,222,1024
MV 192,v,44,v,64
buffer_load_dwordx4 v208, s[44:47], s75 offen offset:0 lds
v_accvgpr_read_b32 v241, a231
MV 196,v,44,v,68
v_cvt_pk_bf16_f32 v230, v234, v235
v_cvt_pk_bf16_f32 v231, v236, v237
MV 200,v,44,v,72
MV 204,v,44,v,76
TR 44,223,0
TR 46,223,1024
s_waitcnt lgkmcnt(4)
MV 80,v,16,v,48
buffer_load_dwordx4 v209, s[44:47], s75 offen offset:1024 lds
v_cvt_pk_bf16_f32 v232, v238, v239
MV 84,v,16,v,52
ds_read_b128 v[64:67], v227 offset:0
v_cvt_pk_bf16_f32 v233, v240, v241
MV 88,v,16,v,56
buffer_load_dwordx4 v210, s[44:47], s75 offen offset:2048 lds
s_add_u32 s24, s24, 4096
MV 92,v,16,v,60
TR 16,216,8192
TR 18,216,9216
MV 96,v,20,v,48
buffer_store_dwordx4 v[230:233], v228, s[16:19], s24 offen offset:0 sc1
MV 100,v,20,v,52
buffer_load_dwordx4 v211, s[44:47], s75 offen offset:3072 lds
v_accvgpr_read_b32 v246, a232
MV 104,v,20,v,56
ds_read_b128 v[68:71], v227 offset:2048
MV 108,v,20,v,60
TR 20,217,8192
TR 22,217,9216
MV 112,v,24,v,48
s_add_u32 s75, s65, s74
v_accvgpr_read_b32 v247, a233
MV 116,v,24,v,52
v_accvgpr_read_b32 v248, a234
MV 120,v,24,v,56
v_accvgpr_read_b32 v249, a235
MV 124,v,24,v,60
TR 24,218,8192
TR 26,218,9216
MV 128,v,28,v,48
ds_read_b128 v[72:75], v227 offset:4096
s_add_u32 m0, s67, 36864
MV 132,v,28,v,52
v_accvgpr_read_b32 v250, a236
v_accvgpr_read_b32 v251, a237
MV 136,v,28,v,56
buffer_load_dwordx4 v208, s[44:47], s75 offen offset:0 lds
v_accvgpr_read_b32 v252, a238
MV 140,v,28,v,60
TR 28,219,8192
TR 30,219,9216
MV 144,v,32,v,48
buffer_load_dwordx4 v209, s[44:47], s75 offen offset:1024 lds
v_accvgpr_read_b32 v253, a239
MV 148,v,32,v,52
v_cvt_pk_bf16_f32 v242, v246, v247
MV 152,v,32,v,56
ds_read_b128 v[76:79], v227 offset:6144
v_cvt_pk_bf16_f32 v243, v248, v249
MV 156,v,32,v,60
TR 32,220,8192
TR 34,220,9216
MV 160,v,36,v,48
buffer_load_dwordx4 v210, s[44:47], s75 offen offset:2048 lds
v_cvt_pk_bf16_f32 v244, v250, v251
MV 164,v,36,v,52
v_cvt_pk_bf16_f32 v245, v252, v253
MV 168,v,36,v,56
buffer_load_dwordx4 v211, s[44:47], s75 offen offset:3072 lds
buffer_store_dwordx4 v[242:245], v228, s[16:19], s24 offen offset:1024 sc1
MV 172,v,36,v,60
TR 36,221,8192
TR 38,221,9216
s_waitcnt lgkmcnt(15)
MV 176,v,40,v,48
v_accvgpr_read_b32 v234, a240
MV 180,v,40,v,52
s_add_u32 s74, s74, 128
v_accvgpr_read_b32 v235, a241
MV 184,v,40,v,56
MV 188,v,40,v,60
TR 40,222,8192
TR 42,222,9216
MV 192,v,44,v,48
s_and_b32 s74, s74, 2047
v_accvgpr_read_b32 v236, a242
MV 196,v,44,v,52
v_accvgpr_read_b32 v237, a243
MV 200,v,44,v,56
MV 204,v,44,v,60
TR 44,223,8192
TR 46,223,9216
s_waitcnt lgkmcnt(4)
MV 80,v,16,v,64
v_accvgpr_read_b32 v238, a244
MV 84,v,16,v,68
v_accvgpr_read_b32 v239, a245
MV 88,v,16,v,72
v_accvgpr_read_b32 v240, a246
MV 92,v,16,v,76
MV 96,v,20,v,64
v_accvgpr_read_b32 v241, a247
MV 100,v,20,v,68
v_cvt_pk_bf16_f32 v230, v234, v235
MV 104,v,20,v,72
v_cvt_pk_bf16_f32 v231, v236, v237
MV 108,v,20,v,76
s_waitcnt vmcnt(16) lgkmcnt(0)
s_barrier
MV 112,v,24,v,64
TR 16,216,16384
TR 18,216,17408
MV 116,v,24,v,68
ds_read_b128 v[48:51], v224 offset:0
s_add_u32 m0, s68, 98304
MV 120,v,24,v,72
TR 20,217,16384
TR 22,217,17408
MV 124,v,24,v,76
buffer_load_dwordx4 v212, s[48:51], s66 offen offset:0 lds
v_cvt_pk_bf16_f32 v232, v238, v239
MV 128,v,28,v,64
TR 24,218,16384
TR 26,218,17408
MV 132,v,28,v,68
ds_read_b128 v[52:55], v224 offset:2048
buffer_load_dwordx4 v213, s[48:51], s66 offen offset:1024 lds
MV 136,v,28,v,72
buffer_load_dwordx4 v214, s[48:51], s66 offen offset:2048 lds
v_cvt_pk_bf16_f32 v233, v240, v241
MV 140,v,28,v,76
TR 28,219,16384
TR 30,219,17408
MV 144,v,32,v,64
ds_read_b128 v[56:59], v224 offset:4096
buffer_store_dwordx4 v[230:233], v228, s[16:19], s24 offen offset:2048 sc1
MV 148,v,32,v,68
buffer_load_dwordx4 v215, s[48:51], s66 offen offset:3072 lds
v_accvgpr_read_b32 v246, a248
MV 152,v,32,v,72
v_accvgpr_read_b32 v247, a249
v_accvgpr_read_b32 v248, a250
MV 156,v,32,v,76
TR 32,220,16384
TR 34,220,17408
MV 160,v,36,v,64
ds_read_b128 v[60:63], v224 offset:6144
s_add_u32 s66, s66, 524288
MV 164,v,36,v,68
s_and_b32 s66, s66, 8388607
v_accvgpr_read_b32 v249, a251
MV 168,v,36,v,72
v_accvgpr_read_b32 v250, a252
v_accvgpr_read_b32 v251, a253
MV 172,v,36,v,76
TR 36,221,16384
TR 38,221,17408
MV 176,v,40,v,64
s_add_u32 s75, s64, s74
v_accvgpr_read_b32 v252, a254
MV 180,v,40,v,68
v_accvgpr_read_b32 v253, a255
v_cvt_pk_bf16_f32 v242, v246, v247
MV 184,v,40,v,72
s_add_u32 m0, s67, 65536
v_cvt_pk_bf16_f32 v243, v248, v249
MV 188,v,40,v,76
TR 40,222,16384
TR 42,222,17408
MV 192,v,44,v,64
buffer_load_dwordx4 v208, s[44:47], s75 offen offset:0 lds
v_cvt_pk_bf16_f32 v244, v250, v251
MV 196,v,44,v,68
v_cvt_pk_bf16_f32 v245, v252, v253
buffer_store_dwordx4 v[242:245], v228, s[16:19], s24 offen offset:3072 sc1
MV 200,v,44,v,72
MV 204,v,44,v,76
TR 44,223,16384
TR 46,223,17408
s_waitcnt lgkmcnt(4)
MV 80,v,16,v,48
buffer_load_dwordx4 v209, s[44:47], s75 offen offset:1024 lds
v_lshlrev_b32 v255, 20, v1
MV 84,v,16,v,52
ds_read_b128 v[64:67], v225 offset:0
MV 88,v,16,v,56
buffer_load_dwordx4 v210, s[44:47], s75 offen offset:2048 lds
MV 92,v,16,v,60
TR 16,216,24576
TR 18,216,25600
MV 96,v,20,v,48
MV 100,v,20,v,52
buffer_load_dwordx4 v211, s[44:47], s75 offen offset:3072 lds
MV 104,v,20,v,56
ds_read_b128 v[68:71], v225 offset:2048
MV 108,v,20,v,60
TR 20,217,24576
TR 22,217,25600
MV 112,v,24,v,48
s_add_u32 s75, s65, s74
MV 116,v,24,v,52
MV 120,v,24,v,56
s_lshl_b32 s36, s3, 26
MV 124,v,24,v,60
TR 24,218,24576
TR 26,218,25600
MV 128,v,28,v,48
ds_read_b128 v[72:75], v225 offset:4096
s_add_u32 m0, s67, 69632
MV 132,v,28,v,52
MV 136,v,28,v,56
buffer_load_dwordx4 v208, s[44:47], s75 offen offset:0 lds
MV 140,v,28,v,60
TR 28,219,24576
TR 30,219,25600
MV 144,v,32,v,48
buffer_load_dwordx4 v209, s[44:47], s75 offen offset:1024 lds
MV 148,v,32,v,52
MV 152,v,32,v,56
ds_read_b128 v[76:79], v225 offset:6144
MV 156,v,32,v,60
TR 32,220,24576
TR 34,220,25600
MV 160,v,36,v,48
buffer_load_dwordx4 v210, s[44:47], s75 offen offset:2048 lds
v_add_u32 v255, s36, v255
MV 164,v,36,v,52
MV 168,v,36,v,56
buffer_load_dwordx4 v211, s[44:47], s75 offen offset:3072 lds
MV 172,v,36,v,60
TR 36,221,24576
TR 38,221,25600
s_waitcnt lgkmcnt(15)
MV 176,v,40,v,48
MV 180,v,40,v,52
s_add_u32 s74, s74, 128
MV 184,v,40,v,56
MV 188,v,40,v,60
TR 40,222,24576
TR 42,222,25600
MV 192,v,44,v,48
s_and_b32 s74, s74, 2047
MV 196,v,44,v,52
MV 200,v,44,v,56
MV 204,v,44,v,60
TR 44,223,24576
TR 46,223,25600
s_waitcnt lgkmcnt(4)
MV 80,v,16,v,64
v_lshlrev_b32 v230, 4, v1
MV 84,v,16,v,68
s_lshl_b32 s80, s3, 12
MV 88,v,16,v,72
MV 92,v,16,v,76
v_add_u32 v12, s80, v230
MV 96,v,20,v,64
MV 100,v,20,v,68
v_add_u32 v10, 0x8000, v230
MV 104,v,20,v,72
MV 108,v,20,v,76
s_waitcnt vmcnt(15) lgkmcnt(0)
s_barrier
MV 112,v,24,v,64
TR 16,216,32768
TR 18,216,33792
MV 116,v,24,v,68
ds_read_b128 v[48:51], v224 offset:32768
s_add_u32 m0, s68, 114688
MV 120,v,24,v,72
TR 20,217,32768
TR 22,217,33792
MV 124,v,24,v,76
buffer_load_dwordx4 v212, s[48:51], s66 offen offset:0 lds
v_add_u32 v11, 0x10000, v230
MV 128,v,28,v,64
TR 24,218,32768
TR 26,218,33792
MV 132,v,28,v,68
ds_read_b128 v[52:55], v224 offset:34816
buffer_load_dwordx4 v213, s[48:51], s66 offen offset:1024 lds
MV 136,v,28,v,72
buffer_load_dwordx4 v214, s[48:51], s66 offen offset:2048 lds
s_add_u32 s72, s80, 0x8000
MV 140,v,28,v,76
TR 28,219,32768
TR 30,219,33792
MV 144,v,32,v,64
ds_read_b128 v[56:59], v224 offset:36864
s_add_u32 s73, s80, 0x10000
MV 148,v,32,v,68
buffer_load_dwordx4 v215, s[48:51], s66 offen offset:3072 lds
v_mov_b32 v15, v230
MV 152,v,32,v,72
v_and_b32 v230, 15, v1
v_lshrrev_b32 v232, 4, v1
MV 156,v,32,v,76
TR 32,220,32768
TR 34,220,33792
MV 160,v,36,v,64
ds_read_b128 v[60:63], v224 offset:38912
s_add_u32 s66, s66, 524288
MV 164,v,36,v,68
s_and_b32 s66, s66, 8388607
v_lshlrev_b32 v232, 2, v232
MV 168,v,36,v,72
v_sub_u32 v230, v230, v232
s_lshl_b32 s81, s3, 4
MV 172,v,36,v,76
TR 36,221,32768
TR 38,221,33792
MV 176,v,40,v,64
s_add_u32 s75, s64, s74
v_add_u32 v13, s81, v230
MV 180,v,40,v,68
s_sub_u32 s81, 112, s81
MV 184,v,40,v,72
s_add_u32 m0, s67, 0
v_add_u32 v239, s81, v230
MV 188,v,40,v,76
TR 40,222,32768
TR 42,222,33792
MV 192,v,44,v,64
buffer_load_dwordx4 v208, s[44:47], s75 offen offset:0 lds
v_mov_b32 v14, 0xff800000
MV 196,v,44,v,68
MV 200,v,44,v,72
MV 204,v,44,v,76
TR 44,223,32768
TR 46,223,33792
s_waitcnt lgkmcnt(4)
MV 80,v,16,v,48
buffer_load_dwordx4 v209, s[44:47], s75 offen offset:1024 lds
s_getpc_b64 s[38:39]
L_ct_a:
MV 84,v,16,v,52
ds_read_b128 v[64:67], v225 offset:32768
MV 88,v,16,v,56
buffer_load_dwordx4 v210, s[44:47], s75 offen offset:2048 lds
MV 92,v,16,v,60
TR 16,216,40960
TR 18,216,41984
MV 96,v,20,v,48
s_add_u32 s38, s38, L_p3_begin - L_ct_a
s_addc_u32 s39, s39, 0
MV 100,v,20,v,52
buffer_load_dwordx4 v211, s[44:47], s75 offen offset:3072 lds
v_mov_b32 v243, s39
MV 104,v,20,v,56
ds_read_b128 v[68:71], v225 offset:34816
v_mov_b32 v242, s38
MV 108,v,20,v,60
TR 20,217,40960
TR 22,217,41984
MV 112,v,24,v,48
s_add_u32 s75, s65, s74
s_lshr_b32 s38, s2, 3
MV 116,v,24,v,52
MV 120,v,24,v,56
s_lshl_b32 s38, s38, 2
MV 124,v,24,v,60
TR 24,218,40960
TR 26,218,41984
MV 128,v,28,v,48
ds_read_b128 v[72:75], v225 offset:36864
s_add_u32 m0, s67, 4096
MV 132,v,28,v,52
s_add_u32 s38, s38, s3
s_lshl_b32 s38, s38, 7
MV 136,v,28,v,56
buffer_load_dwordx4 v208, s[44:47], s75 offen offset:0 lds
MV 140,v,28,v,60
TR 28,219,40960
TR 30,219,41984
MV 144,v,32,v,48
buffer_load_dwordx4 v209, s[44:47], s75 offen offset:1024 lds
v_and_b32 v244, 3, v1
MV 148,v,32,v,52
v_lshlrev_b32 v244, 14, v244
MV 152,v,32,v,56
ds_read_b128 v[76:79], v225 offset:38912
v_add_u32 v244, s38, v244
MV 156,v,32,v,60
TR 32,220,40960
TR 34,220,41984
MV 160,v,36,v,48
buffer_load_dwordx4 v210, s[44:47], s75 offen offset:2048 lds
v_min_u32 v244, L_p3_s1m_top - L_p3_begin - 4, v244
MV 164,v,36,v,52
v_add_co_u32 v242, vcc, v242, v244
s_nop 1
v_addc_co_u32 v243, vcc, 0, v243, vcc
MV 168,v,36,v,56
buffer_load_dwordx4 v211, s[44:47], s75 offen offset:3072 lds
MV 172,v,36,v,60
TR 36,221,40960
TR 38,221,41984
s_waitcnt lgkmcnt(15)
MV 176,v,40,v,48
MV 180,v,40,v,52
s_add_u32 s74, s74, 128
MV 184,v,40,v,56
MV 188,v,40,v,60
TR 40,222,40960
TR 42,222,41984
MV 192,v,44,v,48
s_and_b32 s74, s74, 2047
global_load_dword v244, v[242:243], off
MV 196,v,44,v,52
MV 200,v,44,v,56
MV 204,v,44,v,60
TR 44,223,40960
TR 46,223,41984
s_waitcnt lgkmcnt(4)
MV 80,v,16,v,64
MV 84,v,16,v,68
MV 88,v,16,v,72
MV 92,v,16,v,76
MV 96,v,20,v,64
MV 100,v,20,v,68
MV 104,v,20,v,72
MV 108,v,20,v,76
s_waitcnt vmcnt(13) lgkmcnt(0)
s_barrier
MV 112,v,24,v,64
v_cmp_gt_u32 vcc, 1, v254
s_nop 4
s_cbranch_vccnz L_spin_go
L_spin_go_ret:
v_mov_b32 v254, 1
s_lshl_b32 s36, s2, 2
buffer_store_dword v254, v255, s[8:11], s36 offen offset:0 sc1
s_load_dwordx4 s[32:35], s[0:1], 32
MV 116,v,24,v,68
TR 16,216,0
TR 18,216,1024
MV 120,v,24,v,72
TR 20,217,0
TR 22,217,1024
MV 124,v,24,v,76
ds_read_b128 v[48:51], v226 offset:0
s_add_u32 m0, s68, 131072
MV 128,v,28,v,64
TR 24,218,0
TR 26,218,1024
MV 132,v,28,v,68
ds_read_b128 v[52:55], v226 offset:2048
buffer_load_dwordx4 v212, s[48:51], s66 offen offset:0 lds
MV 136,v,28,v,72
buffer_load_dwordx4 v213, s[48:51], s66 offen offset:1024 lds
buffer_load_dwordx4 v214, s[48:51], s66 offen offset:2048 lds
MV 140,v,28,v,76
TR 28,219,0
TR 30,219,1024
MV 144,v,32,v,64
ds_read_b128 v[56:59], v226 offset:4096
MV 148,v,32,v,68
buffer_load_dwordx4 v215, s[48:51], s66 offen offset:3072 lds
MV 152,v,32,v,72
MV 156,v,32,v,76
TR 32,220,0
TR 34,220,1024
MV 160,v,36,v,64
ds_read_b128 v[60:63], v226 offset:6144
s_add_u32 s66, s66, 524288
MV 164,v,36,v,68
s_and_b32 s66, s66, 8388607
MV 168,v,36,v,72
MV 172,v,36,v,76
TR 36,221,0
TR 38,221,1024
MV 176,v,40,v,64
s_add_u32 s75, s64, s74
MV 180,v,40,v,68
MV 184,v,40,v,72
s_add_u32 m0, s67, 32768
MV 188,v,40,v,76
TR 40,222,0
TR 42,222,1024
MV 192,v,44,v,64
buffer_load_dwordx4 v208, s[44:47], s75 offen offset:0 lds
MV 196,v,44,v,68
MV 200,v,44,v,72
MV 204,v,44,v,76
TR 44,223,0
TR 46,223,1024
s_waitcnt lgkmcnt(4)
MV 80,v,16,v,48
buffer_load_dwordx4 v209, s[44:47], s75 offen offset:1024 lds
s_and_b32 s36, s2, 3
MV 84,v,16,v,52
ds_read_b128 v[64:67], v227 offset:0
s_lshl_b32 s36, s36, 1
MV 88,v,16,v,56
buffer_load_dwordx4 v210, s[44:47], s75 offen offset:2048 lds
s_sub_u32 s43, 14, s36
MV 92,v,16,v,60
TR 16,216,8192
TR 18,216,9216
MV 96,v,20,v,48
s_bitcmp1_b32 s2, 4
s_cselect_b32 s36, s43, s36
MV 100,v,20,v,52
buffer_load_dwordx4 v211, s[44:47], s75 offen offset:3072 lds
s_bfe_u32 s43, s2, 0x10003
MV 104,v,20,v,56
ds_read_b128 v[68:71], v227 offset:2048
s_add_u32 s36, s36, s43
MV 108,v,20,v,60
TR 20,217,8192
TR 22,217,9216
MV 112,v,24,v,48
s_add_u32 s75, s65, s74
s_bfe_u32 s37, s2, 0x10002
MV 116,v,24,v,52
s_lshr_b32 s43, s2, 5
s_lshl_b32 s43, s43, 1
MV 120,v,24,v,56
s_add_u32 s37, s37, s43
v_and_b32 v230, 15, v1
MV 124,v,24,v,60
TR 24,218,8192
TR 26,218,9216
MV 128,v,28,v,48
ds_read_b128 v[72:75], v227 offset:4096
s_add_u32 m0, s67, 36864
MV 132,v,28,v,52
s_lshl_b32 s36, s36, 4
v_add_u32 v231, s36, v230
MV 136,v,28,v,56
buffer_load_dwordx4 v208, s[44:47], s75 offen offset:0 lds
s_lshr_b32 s36, s2, 4
MV 140,v,28,v,60
TR 28,219,8192
TR 30,219,9216
MV 144,v,32,v,48
buffer_load_dwordx4 v209, s[44:47], s75 offen offset:1024 lds
v_lshl_add_u32 v232, v230, 4, s36
MV 148,v,32,v,52
v_and_b32 v233, 7, v1
v_bfe_u32 v234, v1, 3, 1
MV 152,v,32,v,56
ds_read_b128 v[76:79], v227 offset:6144
v_lshlrev_b32 v233, 3, v233
MV 156,v,32,v,60
TR 32,220,8192
TR 34,220,9216
MV 160,v,36,v,48
buffer_load_dwordx4 v210, s[44:47], s75 offen offset:2048 lds
v_lshl_add_u32 v233, v234, 7, v233
MV 164,v,36,v,52
s_bfe_u32 s36, s69, 0x10001
s_lshl_b32 s36, s36, 6
MV 168,v,36,v,56
buffer_load_dwordx4 v211, s[44:47], s75 offen offset:3072 lds
s_lshr_b32 s37, s69, 2
MV 172,v,36,v,60
TR 36,221,8192
TR 38,221,9216
s_waitcnt lgkmcnt(15)
MV 176,v,40,v,48
s_add_u32 s36, s36, s37
v_add_u32 v233, s36, v233
MV 180,v,40,v,52
s_add_u32 s74, s74, 128
v_lshrrev_b32 v234, 4, v1
MV 184,v,40,v,56
v_cmp_eq_u32 vcc, 1, v234
s_nop 1
v_cndmask_b32 v233, v233, v232, vcc
MV 188,v,40,v,60
TR 40,222,8192
TR 42,222,9216
MV 192,v,44,v,48
s_and_b32 s74, s74, 2047
MV 196,v,44,v,52
v_cmp_eq_u32 vcc, 2, v234
s_nop 1
v_cndmask_b32 v233, v233, v231, vcc
MV 200,v,44,v,56
v_lshlrev_b32 v233, 2, v233
MV 204,v,44,v,60
TR 44,223,8192
TR 46,223,9216
s_waitcnt lgkmcnt(4)
MV 80,v,16,v,64
MV 84,v,16,v,68
MV 88,v,16,v,72
MV 92,v,16,v,76
MV 96,v,20,v,64
MV 100,v,20,v,68
MV 104,v,20,v,72
MV 108,v,20,v,76
s_waitcnt vmcnt(14) lgkmcnt(0)
s_barrier
MV 112,v,24,v,64
TR 16,216,16384
TR 18,216,17408
MV 116,v,24,v,68
ds_read_b128 v[48:51], v224 offset:0
s_add_u32 m0, s68, 98304
MV 120,v,24,v,72
TR 20,217,16384
TR 22,217,17408
MV 124,v,24,v,76
buffer_load_dwordx4 v212, s[48:51], s66 offen offset:0 lds
MV 128,v,28,v,64
TR 24,218,16384
TR 26,218,17408
MV 132,v,28,v,68
ds_read_b128 v[52:55], v224 offset:2048
buffer_load_dwordx4 v213, s[48:51], s66 offen offset:1024 lds
MV 136,v,28,v,72
buffer_load_dwordx4 v214, s[48:51], s66 offen offset:2048 lds
MV 140,v,28,v,76
TR 28,219,16384
TR 30,219,17408
MV 144,v,32,v,64
ds_read_b128 v[56:59], v224 offset:4096
MV 148,v,32,v,68
buffer_load_dwordx4 v215, s[48:51], s66 offen offset:3072 lds
MV 152,v,32,v,72
MV 156,v,32,v,76
TR 32,220,16384
TR 34,220,17408
MV 160,v,36,v,64
ds_read_b128 v[60:63], v224 offset:6144
s_add_u32 s66, s66, 524288
MV 164,v,36,v,68
s_and_b32 s66, s66, 8388607
MV 168,v,36,v,72
MV 172,v,36,v,76
TR 36,221,16384
TR 38,221,17408
MV 176,v,40,v,64
s_add_u32 s75, s64, s74
MV 180,v,40,v,68
MV 184,v,40,v,72
s_add_u32 m0, s67, 65536
MV 188,v,40,v,76
TR 40,222,16384
TR 42,222,17408
MV 192,v,44,v,64
buffer_load_dwordx4 v208, s[44:47], s75 offen offset:0 lds
MV 196,v,44,v,68
MV 200,v,44,v,72
MV 204,v,44,v,76
TR 44,223,16384
TR 46,223,17408
s_waitcnt lgkmcnt(4)
MV 80,v,16,v,48
buffer_load_dwordx4 v209, s[44:47], s75 offen offset:1024 lds
s_lshl_b32 s36, s2, 2
MV 84,v,16,v,52
ds_read_b128 v[64:67], v225 offset:0
s_add_u32 s36, s36, s3
MV 88,v,16,v,56
buffer_load_dwordx4 v210, s[44:47], s75 offen offset:2048 lds
s_lshl_b32 s42, s36, 1
MV 92,v,16,v,60
TR 16,216,24576
TR 18,216,25600
MV 96,v,20,v,48
s_lshl_b32 s37, s36, 12
MV 100,v,20,v,52
buffer_load_dwordx4 v211, s[44:47], s75 offen offset:3072 lds
MV 104,v,20,v,56
ds_read_b128 v[68:71], v225 offset:2048
MV 108,v,20,v,60
TR 20,217,24576
TR 22,217,25600
MV 112,v,24,v,48
s_add_u32 s75, s65, s74
MV 116,v,24,v,52
s_add_u32 s16, s32, s37
s_addc_u32 s17, s33, 0
MV 120,v,24,v,56
s_mov_b32 s18, 4096
s_mov_b32 s19, 0x20000
MV 124,v,24,v,60
TR 24,218,24576
TR 26,218,25600
MV 128,v,28,v,48
ds_read_b128 v[72:75], v225 offset:4096
s_add_u32 m0, s67, 69632
MV 132,v,28,v,52
s_add_u32 s37, s37, 50331648
MV 136,v,28,v,56
buffer_load_dwordx4 v208, s[44:47], s75 offen offset:0 lds
MV 140,v,28,v,60
TR 28,219,24576
TR 30,219,25600
MV 144,v,32,v,48
buffer_load_dwordx4 v209, s[44:47], s75 offen offset:1024 lds
MV 148,v,32,v,52
s_add_u32 s20, s40, s37
s_addc_u32 s21, s41, 0
MV 152,v,32,v,56
ds_read_b128 v[76:79], v225 offset:6144
s_mov_b32 s22, 4096
MV 156,v,32,v,60
TR 32,220,24576
TR 34,220,25600
MV 160,v,36,v,48
buffer_load_dwordx4 v210, s[44:47], s75 offen offset:2048 lds
s_mov_b32 s23, 0x20000
MV 164,v,36,v,52
s_lshl_b32 s37, s2, 14
s_add_u32 s37, s37, 54525952
MV 168,v,36,v,56
buffer_load_dwordx4 v211, s[44:47], s75 offen offset:3072 lds
MV 172,v,36,v,60
TR 36,221,24576
TR 38,221,25600
s_waitcnt lgkmcnt(15)
MV 176,v,40,v,48
s_add_u32 s24, s40, s37
s_addc_u32 s25, s41, 0
MV 180,v,40,v,52
s_add_u32 s74, s74, 128
s_mov_b32 s26, 16384
MV 184,v,40,v,56
s_mov_b32 s27, 0x20000
s_mov_b32 s28, s34
MV 188,v,40,v,60
TR 40,222,24576
TR 42,222,25600
MV 192,v,44,v,48
s_and_b32 s74, s74, 2047
s_mov_b32 s29, s35
MV 196,v,44,v,52
s_mov_b32 s30, 2048
s_mov_b32 s31, 0x20000
MV 200,v,44,v,56
s_mul_i32 s43, s3, 4608
s_add_u32 s43, s43, 132096
MV 204,v,44,v,60
TR 44,223,24576
TR 46,223,25600
s_waitcnt lgkmcnt(4)
MV 80,v,16,v,64
v_mov_b32 v229, 0x40000000
MV 84,v,16,v,68
MV 88,v,16,v,72
buffer_load_dwordx4 a[0:3], v229, s[8:11], 0 offen
MV 92,v,16,v,76
MV 96,v,20,v,64
MV 100,v,20,v,68
buffer_load_dwordx4 a[4:7], v229, s[8:11], 0 offen
MV 104,v,20,v,72
MV 108,v,20,v,76
s_waitcnt vmcnt(14) lgkmcnt(0)
s_barrier
MV 112,v,24,v,64
s_load_dwordx2 s[32:33], s[0:1], 88
TR 16,216,32768
MV 116,v,24,v,68
TR 18,216,33792
ds_read_b128 v[48:51], v224 offset:32768
MV 120,v,24,v,72
TR 20,217,32768
TR 22,217,33792
MV 124,v,24,v,76
buffer_load_dwordx4 a[8:11], v229, s[8:11], 0 offen
buffer_load_dwordx4 a[12:15], v229, s[8:11], 0 offen
MV 128,v,28,v,64
TR 24,218,32768
TR 26,218,33792
MV 132,v,28,v,68
ds_read_b128 v[52:55], v224 offset:34816
buffer_load_dwordx4 a[16:19], v229, s[8:11], 0 offen
MV 136,v,28,v,72
MV 140,v,28,v,76
TR 28,219,32768
TR 30,219,33792
MV 144,v,32,v,64
ds_read_b128 v[56:59], v224 offset:36864
buffer_load_dwordx4 a[20:23], v229, s[8:11], 0 offen
MV 148,v,32,v,68
MV 152,v,32,v,72
MV 156,v,32,v,76
TR 32,220,32768
TR 34,220,33792
MV 160,v,36,v,64
ds_read_b128 v[60:63], v224 offset:38912
buffer_load_dwordx4 a[24:27], v229, s[8:11], 0 offen
MV 164,v,36,v,68
buffer_load_dwordx4 a[28:31], v229, s[8:11], 0 offen
MV 168,v,36,v,72
MV 172,v,36,v,76
TR 36,221,32768
TR 38,221,33792
MV 176,v,40,v,64
buffer_load_dwordx4 a[32:35], v229, s[8:11], 0 offen
MV 180,v,40,v,68
MV 184,v,40,v,72
MV 188,v,40,v,76
TR 40,222,32768
TR 42,222,33792
MV 192,v,44,v,64
buffer_load_dwordx4 a[36:39], v229, s[8:11], 0 offen
MV 196,v,44,v,68
MV 200,v,44,v,72
MV 204,v,44,v,76
TR 44,223,32768
TR 46,223,33792
s_waitcnt lgkmcnt(4)
MV 80,v,16,v,48
buffer_load_dwordx4 a[40:43], v229, s[8:11], 0 offen
MV 84,v,16,v,52
ds_read_b128 v[64:67], v225 offset:32768
MV 88,v,16,v,56
buffer_load_dwordx4 a[44:47], v229, s[8:11], 0 offen
MV 92,v,16,v,60
TR 16,216,40960
TR 18,216,41984
MV 96,v,20,v,48
MV 100,v,20,v,52
buffer_load_dwordx4 a[48:51], v229, s[8:11], 0 offen
MV 104,v,20,v,56
ds_read_b128 v[68:71], v225 offset:34816
MV 108,v,20,v,60
TR 20,217,40960
TR 22,217,41984
MV 112,v,24,v,48
buffer_load_dwordx4 a[52:55], v229, s[8:11], 0 offen
MV 116,v,24,v,52
MV 120,v,24,v,56
buffer_load_dwordx4 a[56:59], v229, s[8:11], 0 offen
MV 124,v,24,v,60
TR 24,218,40960
TR 26,218,41984
MV 128,v,28,v,48
ds_read_b128 v[72:75], v225 offset:36864
MV 132,v,28,v,52
buffer_load_dwordx4 a[60:63], v229, s[8:11], 0 offen
MV 136,v,28,v,56
MV 140,v,28,v,60
TR 28,219,40960
TR 30,219,41984
MV 144,v,32,v,48
buffer_load_dwordx4 a[64:67], v229, s[8:11], 0 offen
MV 148,v,32,v,52
MV 152,v,32,v,56
ds_read_b128 v[76:79], v225 offset:38912
MV 156,v,32,v,60
TR 32,220,40960
TR 34,220,41984
MV 160,v,36,v,48
buffer_load_dwordx4 a[68:71], v229, s[8:11], 0 offen
MV 164,v,36,v,52
buffer_load_dwordx4 a[72:75], v229, s[8:11], 0 offen
MV 168,v,36,v,56
MV 172,v,36,v,60
TR 36,221,40960
TR 38,221,41984
s_waitcnt lgkmcnt(15)
MV 176,v,40,v,48
buffer_load_dwordx4 a[76:79], v229, s[8:11], 0 offen
MV 180,v,40,v,52
MV 184,v,40,v,56
MV 188,v,40,v,60
TR 40,222,40960
TR 42,222,41984
MV 192,v,44,v,48
buffer_load_dwordx4 a[80:83], v229, s[8:11], 0 offen
MV 196,v,44,v,52
MV 200,v,44,v,56
MV 204,v,44,v,60
TR 44,223,40960
TR 46,223,41984
s_waitcnt lgkmcnt(4)
MV 80,v,16,v,64
buffer_load_dwordx4 a[84:87], v229, s[8:11], 0 offen
MV 84,v,16,v,68
MV 88,v,16,v,72
buffer_load_dwordx4 a[88:91], v229, s[8:11], 0 offen
MV 92,v,16,v,76
MV 96,v,20,v,64
MV 100,v,20,v,68
buffer_load_dwordx4 a[92:95], v229, s[8:11], 0 offen
MV 104,v,20,v,72
MV 108,v,20,v,76
s_waitcnt vmcnt(24) lgkmcnt(0)
s_barrier
MV 112,v,24,v,64
TR 16,216,0
TR 18,216,1024
MV 116,v,24,v,68
ds_read_b128 v[48:51], v226 offset:0
buffer_load_dwordx4 a[96:99], v229, s[8:11], 0 offen
MV 120,v,24,v,72
TR 20,217,0
TR 22,217,1024
MV 124,v,24,v,76
buffer_load_dwordx4 a[100:103], v229, s[8:11], 0 offen
MV 128,v,28,v,64
TR 24,218,0
TR 26,218,1024
MV 132,v,28,v,68
ds_read_b128 v[52:55], v226 offset:2048
buffer_load_dwordx4 a[104:107], v229, s[8:11], 0 offen
MV 136,v,28,v,72
MV 140,v,28,v,76
TR 28,219,0
TR 30,219,1024
MV 144,v,32,v,64
ds_read_b128 v[56:59], v226 offset:4096
buffer_load_dwordx4 a[108:111], v229, s[8:11], 0 offen
MV 148,v,32,v,68
MV 152,v,32,v,72
MV 156,v,32,v,76
TR 32,220,0
TR 34,220,1024
MV 160,v,36,v,64
ds_read_b128 v[60:63], v226 offset:6144
buffer_load_dwordx4 a[112:115], v229, s[8:11], 0 offen
MV 164,v,36,v,68
buffer_load_dwordx4 a[116:119], v229, s[8:11], 0 offen
MV 168,v,36,v,72
MV 172,v,36,v,76
TR 36,221,0
TR 38,221,1024
MV 176,v,40,v,64
buffer_load_dwordx4 a[120:123], v229, s[8:11], 0 offen
MV 180,v,40,v,68
MV 184,v,40,v,72
MV 188,v,40,v,76
TR 40,222,0
TR 42,222,1024
MV 192,v,44,v,64
buffer_load_dwordx4 a[124:127], v229, s[8:11], 0 offen
MV 196,v,44,v,68
MV 200,v,44,v,72
MV 204,v,44,v,76
TR 44,223,0
TR 46,223,1024
s_waitcnt lgkmcnt(4)
MV 80,v,16,v,48
buffer_load_dword v237, v233, s[8:11], 0 offen offset:0 sc1
MV 84,v,16,v,52
ds_read_b128 v[64:67], v227 offset:0
MV 88,v,16,v,56
s_lshr_b32 s36, s2, 3
MV 92,v,16,v,60
TR 16,216,8192
TR 18,216,9216
MV 96,v,20,v,48
MV 100,v,20,v,52
s_lshl_b32 s36, s36, 18
MV 104,v,20,v,56
ds_read_b128 v[68:71], v227 offset:2048
MV 108,v,20,v,60
TR 20,217,8192
TR 22,217,9216
MV 112,v,24,v,48
s_and_b32 s37, s2, 7
MV 116,v,24,v,52
MV 120,v,24,v,56
s_lshl_b32 s37, s37, 8
MV 124,v,24,v,60
TR 24,218,8192
TR 26,218,9216
MV 128,v,28,v,48
ds_read_b128 v[72:75], v227 offset:4096
s_add_u32 s36, s36, s37
MV 132,v,28,v,52
MV 136,v,28,v,56
MV 140,v,28,v,60
TR 28,219,8192
TR 30,219,9216
MV 144,v,32,v,48
s_lshl_b32 s37, s3, 16
MV 148,v,32,v,52
s_add_u32 s36, s36, s37
MV 152,v,32,v,56
ds_read_b128 v[76:79], v227 offset:6144
MV 156,v,32,v,60
TR 32,220,8192
TR 34,220,9216
MV 160,v,36,v,48
s_add_u32 s32, s32, s36
s_addc_u32 s33, s33, 0
MV 164,v,36,v,52
MV 168,v,36,v,56
MV 172,v,36,v,60
TR 36,221,8192
TR 38,221,9216
s_waitcnt lgkmcnt(15)
MV 176,v,40,v,48
MV 180,v,40,v,52
s_mov_b32 s34, 65536
MV 184,v,40,v,56
MV 188,v,40,v,60
TR 40,222,8192
TR 42,222,9216
MV 192,v,44,v,48
s_mov_b32 s35, 0x20000
MV 196,v,44,v,52
MV 200,v,44,v,56
MV 204,v,44,v,60
TR 44,223,8192
TR 46,223,9216
s_waitcnt lgkmcnt(4)
MV 80,v,16,v,64
MV 84,v,16,v,68
MV 88,v,16,v,72
MV 92,v,16,v,76
MV 96,v,20,v,64
MV 100,v,20,v,68
MV 104,v,20,v,72
MV 108,v,20,v,76
MV 112,v,24,v,64
MV 116,v,24,v,68
MV 120,v,24,v,72
MV 124,v,24,v,76
MV 128,v,28,v,64
MV 132,v,28,v,68
MV 136,v,28,v,72
MV 140,v,28,v,76
MV 144,v,32,v,64
MV 148,v,32,v,68
MV 152,v,32,v,72
MV 156,v,32,v,76
MV 160,v,36,v,64
MV 164,v,36,v,68
MV 168,v,36,v,72
MV 172,v,36,v,76
s_waitcnt lgkmcnt(2)
MV 176,v,40,v,64
MV 180,v,40,v,68
MV 184,v,40,v,72
MV 188,v,40,v,76
s_waitcnt lgkmcnt(0)
MV 192,v,44,v,64
MV 196,v,44,v,68
MV 200,v,44,v,72
MV 204,v,44,v,76
s_waitcnt vmcnt(0)
v_cmp_gt_u32 vcc, 1, v237
s_nop 4
s_cbranch_vccnz L_spin_f1
L_spin_f1_ret:
L_p3_begin:
s_waitcnt lgkmcnt(0)
s_barrier
s_add_u32 m0, s68, 16384
s_mov_b32 s80, 0
buffer_load_dwordx4 v12, s[52:55], s80 offen offset:0 sc1 lds
buffer_load_dwordx4 v12, s[52:55], s80 offen offset:1024 sc1 lds
buffer_load_dwordx4 v12, s[52:55], s80 offen offset:2048 sc1 lds
buffer_load_dwordx4 v12, s[52:55], s80 offen offset:3072 sc1 lds
s_add_u32 m0, s68, 32768
s_mov_b32 s80, 16384
buffer_load_dwordx4 v12, s[52:55], s80 offen offset:0 sc1 lds
buffer_load_dwordx4 v12, s[52:55], s80 offen offset:1024 sc1 lds
buffer_load_dwordx4 v12, s[52:55], s80 offen offset:2048 sc1 lds
buffer_load_dwordx4 v12, s[52:55], s80 offen offset:3072 sc1 lds
s_mov_b32 s82, 0x3e0293ee
s_mov_b32 s83, 0x3e0293ee
v_pk_mul_f32 v[80:81], v[80:81], s[82:83]
v_pk_mul_f32 v[82:83], v[82:83], s[82:83]
v_pk_mul_f32 v[84:85], v[84:85], s[82:83]
v_pk_mul_f32 v[86:87], v[86:87], s[82:83]
v_pk_mul_f32 v[88:89], v[88:89], s[82:83]
s_add_u32 m0, s68, 81920
v_pk_mul_f32 v[90:91], v[90:91], s[82:83]
v_pk_mul_f32 v[92:93], v[92:93], s[82:83]
v_pk_mul_f32 v[94:95], v[94:95], s[82:83]
v_pk_mul_f32 v[96:97], v[96:97], s[82:83]
v_pk_mul_f32 v[98:99], v[98:99], s[82:83]
v_pk_mul_f32 v[100:101], v[100:101], s[82:83]
v_pk_mul_f32 v[102:103], v[102:103], s[82:83]
v_pk_mul_f32 v[104:105], v[104:105], s[82:83]
s_mov_b32 s80, 16384
v_pk_mul_f32 v[106:107], v[106:107], s[82:83]
v_pk_mul_f32 v[108:109], v[108:109], s[82:83]
v_pk_mul_f32 v[110:111], v[110:111], s[82:83]
v_cvt_pk_bf16_f32 v16, v80, v81
v_cvt_pk_bf16_f32 v17, v82, v83
v_cvt_pk_bf16_f32 v18, v96, v97
v_cvt_pk_bf16_f32 v19, v98, v99
buffer_load_dwordx4 v12, s[56:59], s80 offen offset:0 sc1 lds
v_cvt_pk_bf16_f32 v32, v84, v85
v_cvt_pk_bf16_f32 v33, v86, v87
v_cvt_pk_bf16_f32 v34, v100, v101
v_cvt_pk_bf16_f32 v35, v102, v103
v_cvt_pk_bf16_f32 v48, v88, v89
v_cvt_pk_bf16_f32 v49, v90, v91
v_cvt_pk_bf16_f32 v50, v104, v105
v_cvt_pk_bf16_f32 v51, v106, v107
buffer_load_dwordx4 v12, s[56:59], s80 offen offset:1024 sc1 lds
v_cvt_pk_bf16_f32 v64, v92, v93
v_cvt_pk_bf16_f32 v65, v94, v95
v_cvt_pk_bf16_f32 v66, v108, v109
v_cvt_pk_bf16_f32 v67, v110, v111
v_pk_mul_f32 v[112:113], v[112:113], s[82:83]
v_pk_mul_f32 v[114:115], v[114:115], s[82:83]
v_pk_mul_f32 v[116:117], v[116:117], s[82:83]
buffer_load_dwordx4 v12, s[56:59], s80 offen offset:2048 sc1 lds
v_pk_mul_f32 v[118:119], v[118:119], s[82:83]
v_pk_mul_f32 v[120:121], v[120:121], s[82:83]
v_pk_mul_f32 v[122:123], v[122:123], s[82:83]
v_pk_mul_f32 v[124:125], v[124:125], s[82:83]
v_pk_mul_f32 v[126:127], v[126:127], s[82:83]
v_pk_mul_f32 v[128:129], v[128:129], s[82:83]
v_pk_mul_f32 v[130:131], v[130:131], s[82:83]
v_pk_mul_f32 v[132:133], v[132:133], s[82:83]
buffer_load_dwordx4 v12, s[56:59], s80 offen offset:3072 sc1 lds
v_pk_mul_f32 v[134:135], v[134:135], s[82:83]
v_pk_mul_f32 v[136:137], v[136:137], s[82:83]
v_pk_mul_f32 v[138:139], v[138:139], s[82:83]
v_pk_mul_f32 v[140:141], v[140:141], s[82:83]
v_pk_mul_f32 v[142:143], v[142:143], s[82:83]
v_cvt_pk_bf16_f32 v20, v112, v113
v_cvt_pk_bf16_f32 v21, v114, v115
s_add_u32 m0, s68, 49152
v_cvt_pk_bf16_f32 v22, v128, v129
v_cvt_pk_bf16_f32 v23, v130, v131
v_cvt_pk_bf16_f32 v36, v116, v117
v_cvt_pk_bf16_f32 v37, v118, v119
v_cvt_pk_bf16_f32 v38, v132, v133
v_cvt_pk_bf16_f32 v39, v134, v135
v_cvt_pk_bf16_f32 v52, v120, v121
v_cvt_pk_bf16_f32 v53, v122, v123
s_mov_b32 s80, 32768
v_cvt_pk_bf16_f32 v54, v136, v137
v_cvt_pk_bf16_f32 v55, v138, v139
v_cvt_pk_bf16_f32 v68, v124, v125
v_cvt_pk_bf16_f32 v69, v126, v127
v_cvt_pk_bf16_f32 v70, v140, v141
v_cvt_pk_bf16_f32 v71, v142, v143
v_pk_mul_f32 v[144:145], v[144:145], s[82:83]
buffer_load_dwordx4 v12, s[52:55], s80 offen offset:0 sc1 lds
v_pk_mul_f32 v[146:147], v[146:147], s[82:83]
v_pk_mul_f32 v[148:149], v[148:149], s[82:83]
v_pk_mul_f32 v[150:151], v[150:151], s[82:83]
v_pk_mul_f32 v[152:153], v[152:153], s[82:83]
v_pk_mul_f32 v[154:155], v[154:155], s[82:83]
v_pk_mul_f32 v[156:157], v[156:157], s[82:83]
v_pk_mul_f32 v[158:159], v[158:159], s[82:83]
v_pk_mul_f32 v[160:161], v[160:161], s[82:83]
buffer_load_dwordx4 v12, s[52:55], s80 offen offset:1024 sc1 lds
v_pk_mul_f32 v[162:163], v[162:163], s[82:83]
v_pk_mul_f32 v[164:165], v[164:165], s[82:83]
v_pk_mul_f32 v[166:167], v[166:167], s[82:83]
v_pk_mul_f32 v[168:169], v[168:169], s[82:83]
v_pk_mul_f32 v[170:171], v[170:171], s[82:83]
v_pk_mul_f32 v[172:173], v[172:173], s[82:83]
v_pk_mul_f32 v[174:175], v[174:175], s[82:83]
buffer_load_dwordx4 v12, s[52:55], s80 offen offset:2048 sc1 lds
v_cvt_pk_bf16_f32 v24, v144, v145
v_cvt_pk_bf16_f32 v25, v146, v147
v_cvt_pk_bf16_f32 v26, v160, v161
v_cvt_pk_bf16_f32 v27, v162, v163
v_cvt_pk_bf16_f32 v40, v148, v149
v_cvt_pk_bf16_f32 v41, v150, v151
v_cvt_pk_bf16_f32 v42, v164, v165
v_cvt_pk_bf16_f32 v43, v166, v167
buffer_load_dwordx4 v12, s[52:55], s80 offen offset:3072 sc1 lds
v_cvt_pk_bf16_f32 v56, v152, v153
v_cvt_pk_bf16_f32 v57, v154, v155
v_cvt_pk_bf16_f32 v58, v168, v169
v_cvt_pk_bf16_f32 v59, v170, v171
v_cvt_pk_bf16_f32 v72, v156, v157
v_cvt_pk_bf16_f32 v73, v158, v159
v_cvt_pk_bf16_f32 v74, v172, v173
s_add_u32 m0, s68, 98304
v_cvt_pk_bf16_f32 v75, v174, v175
v_pk_mul_f32 v[176:177], v[176:177], s[82:83]
v_pk_mul_f32 v[178:179], v[178:179], s[82:83]
v_pk_mul_f32 v[180:181], v[180:181], s[82:83]
v_pk_mul_f32 v[182:183], v[182:183], s[82:83]
v_pk_mul_f32 v[184:185], v[184:185], s[82:83]
v_pk_mul_f32 v[186:187], v[186:187], s[82:83]
v_pk_mul_f32 v[188:189], v[188:189], s[82:83]
s_mov_b32 s80, 32768
v_pk_mul_f32 v[190:191], v[190:191], s[82:83]
v_pk_mul_f32 v[192:193], v[192:193], s[82:83]
v_pk_mul_f32 v[194:195], v[194:195], s[82:83]
v_pk_mul_f32 v[196:197], v[196:197], s[82:83]
v_pk_mul_f32 v[198:199], v[198:199], s[82:83]
v_pk_mul_f32 v[200:201], v[200:201], s[82:83]
v_pk_mul_f32 v[202:203], v[202:203], s[82:83]
buffer_load_dwordx4 v12, s[56:59], s80 offen offset:0 sc1 lds
v_pk_mul_f32 v[204:205], v[204:205], s[82:83]
v_pk_mul_f32 v[206:207], v[206:207], s[82:83]
v_cvt_pk_bf16_f32 v28, v176, v177
v_cvt_pk_bf16_f32 v29, v178, v179
v_cvt_pk_bf16_f32 v30, v192, v193
v_cvt_pk_bf16_f32 v31, v194, v195
v_cvt_pk_bf16_f32 v44, v180, v181
v_cvt_pk_bf16_f32 v45, v182, v183
buffer_load_dwordx4 v12, s[56:59], s80 offen offset:1024 sc1 lds
v_cvt_pk_bf16_f32 v46, v196, v197
v_cvt_pk_bf16_f32 v47, v198, v199
v_cvt_pk_bf16_f32 v60, v184, v185
v_cvt_pk_bf16_f32 v61, v186, v187
v_cvt_pk_bf16_f32 v62, v200, v201
v_cvt_pk_bf16_f32 v63, v202, v203
v_cvt_pk_bf16_f32 v76, v188, v189
buffer_load_dwordx4 v12, s[56:59], s80 offen offset:2048 sc1 lds
v_cvt_pk_bf16_f32 v77, v190, v191
v_cvt_pk_bf16_f32 v78, v204, v205
v_cvt_pk_bf16_f32 v79, v206, v207
v_mov_b32 v2, 0
v_mov_b32 v3, 0
v_mov_b32 v4, 0
v_mov_b32 v5, 0
v_xor_b32 v244, 0x8000, v10
buffer_load_dwordx4 v12, s[56:59], s80 offen offset:3072 sc1 lds
s_waitcnt vmcnt(16)
s_barrier
ds_read_b128 a[128:131], v244 offset:16384
ds_read_b128 a[132:135], v244 offset:17408
ds_read_b128 a[136:139], v244 offset:18432
ds_read_b128 a[140:143], v244 offset:19456
ds_read_b128 a[144:147], v244 offset:20480
ds_read_b128 a[148:151], v244 offset:21504
ds_read_b128 a[152:155], v244 offset:22528
ds_read_b128 a[156:159], v244 offset:23552
ds_read_b128 a[160:163], v244 offset:24576
ds_read_b128 a[164:167], v244 offset:25600
ds_read_b128 a[168:171], v244 offset:26624
ds_read_b128 a[172:175], v244 offset:27648
ds_read_b128 a[176:179], v244 offset:28672
ds_read_b128 a[180:183], v244 offset:29696
ds_read_b128 a[184:187], v244 offset:30720
ds_read_b128 a[188:191], v244 offset:31744
s_waitcnt lgkmcnt(15)
v_mfma_f32_16x16x32_bf16 v[80:83], a[128:131], v[16:19], 0
s_add_u32 m0, s68, 0
v_mfma_f32_16x16x32_bf16 v[88:91], a[128:131], v[32:35], 0
s_mov_b32 s80, 49152
v_mfma_f32_16x16x32_bf16 v[96:99], a[128:131], v[48:51], 0
v_mfma_f32_16x16x32_bf16 v[104:107], a[128:131], v[64:67], 0
buffer_load_dwordx4 v12, s[52:55], s80 offen offset:0 sc1 lds
s_waitcnt lgkmcnt(14)
MV 80,a,132,v,20
MV 88,a,132,v,36
buffer_load_dwordx4 v12, s[52:55], s80 offen offset:1024 sc1 lds
MV 96,a,132,v,52
MV 104,a,132,v,68
buffer_load_dwordx4 v12, s[52:55], s80 offen offset:2048 sc1 lds
s_waitcnt lgkmcnt(13)
MV 80,a,136,v,24
MV 88,a,136,v,40
buffer_load_dwordx4 v12, s[52:55], s80 offen offset:3072 sc1 lds
MV 96,a,136,v,56
MV 104,a,136,v,72
s_add_u32 m0, s68, 114688
s_waitcnt lgkmcnt(12)
MV 80,a,140,v,28
s_mov_b32 s80, 49152
MV 88,a,140,v,44
MV 96,a,140,v,60
buffer_load_dwordx4 v12, s[56:59], s80 offen offset:0 sc1 lds
MV 104,a,140,v,76
s_waitcnt lgkmcnt(11)
v_mfma_f32_16x16x32_bf16 v[84:87], a[144:147], v[16:19], 0
buffer_load_dwordx4 v12, s[56:59], s80 offen offset:1024 sc1 lds
v_mfma_f32_16x16x32_bf16 v[92:95], a[144:147], v[32:35], 0
v_mfma_f32_16x16x32_bf16 v[100:103], a[144:147], v[48:51], 0
buffer_load_dwordx4 v12, s[56:59], s80 offen offset:2048 sc1 lds
v_mfma_f32_16x16x32_bf16 v[108:111], a[144:147], v[64:67], 0
s_waitcnt lgkmcnt(10)
MV 84,a,148,v,20
buffer_load_dwordx4 v12, s[56:59], s80 offen offset:3072 sc1 lds
MV 92,a,148,v,36
MV 100,a,148,v,52
MV 108,a,148,v,68
s_waitcnt lgkmcnt(9)
MV 84,a,152,v,24
s_waitcnt vmcnt(16) lgkmcnt(0)
s_barrier
MV 92,a,152,v,40
ds_read_b128 a[128:131], v10 offset:0
s_add_u32 m0, s68, 16384
MV 100,a,152,v,56
ds_read_b128 a[132:135], v10 offset:1024
s_mov_b32 s80, 65536
MV 108,a,152,v,72
ds_read_b128 a[136:139], v10 offset:2048
buffer_load_dwordx4 v12, s[52:55], s80 offen offset:0 sc1 lds
MV 84,a,156,v,28
ds_read_b128 a[140:143], v10 offset:3072
buffer_load_dwordx4 v12, s[52:55], s80 offen offset:1024 sc1 lds
MV 92,a,156,v,44
ds_read_b128 a[144:147], v10 offset:4096
buffer_load_dwordx4 v12, s[52:55], s80 offen offset:2048 sc1 lds
MV 100,a,156,v,60
ds_read_b128 a[148:151], v10 offset:5120
buffer_load_dwordx4 v12, s[52:55], s80 offen offset:3072 sc1 lds
MV 108,a,156,v,76
ds_read_b128 a[152:155], v10 offset:6144
s_mov_b32 s71, 65536
v_mfma_f32_16x16x32_bf16 v[112:115], a[160:163], v[16:19], 0
ds_read_b128 a[156:159], v10 offset:7168
v_mfma_f32_16x16x32_bf16 v[120:123], a[160:163], v[32:35], 0
v_lshrrev_b32 v245, 4, v1
v_mfma_f32_16x16x32_bf16 v[128:131], a[160:163], v[48:51], 0
v_and_b32 v246, 15, v1
v_mfma_f32_16x16x32_bf16 v[136:139], a[160:163], v[64:67], 0
ds_read_b128 a[160:163], v10 offset:8192
v_lshlrev_b32 v247, 1, v245
MV 112,a,164,v,20
v_xor_b32 v246, v246, v247
MV 120,a,164,v,36
v_lshlrev_b32 v245, 11, v245
MV 128,a,164,v,52
v_lshl_add_u32 v245, v246, 4, v245
MV 136,a,164,v,68
ds_read_b128 a[164:167], v10 offset:9216
v_xor_b32 v246, 128, v245
MV 112,a,168,v,24
MV 120,a,168,v,40
s_lshl_b32 s36, s3, 13
MV 128,a,168,v,56
s_add_u32 m0, s36, 131072
MV 136,a,168,v,72
ds_read_b128 a[168:171], v10 offset:10240
s_mov_b32 s37, 0
MV 112,a,172,v,28
buffer_load_dwordx4 v245, s[32:35], s37 offen offset:0 lds
MV 120,a,172,v,44
s_mov_b32 s37, 7168
MV 128,a,172,v,60
buffer_load_dwordx4 v246, s[32:35], s37 offen offset:1024 lds
MV 136,a,172,v,76
ds_read_b128 a[172:175], v10 offset:11264
v_mfma_f32_16x16x32_bf16 v[116:119], a[176:179], v[16:19], 0
s_mov_b32 s37, 14336
v_mfma_f32_16x16x32_bf16 v[124:127], a[176:179], v[32:35], 0
buffer_load_dwordx4 v245, s[32:35], s37 offen offset:2048 lds
v_mfma_f32_16x16x32_bf16 v[132:135], a[176:179], v[48:51], 0
s_mov_b32 s37, 21504
v_mfma_f32_16x16x32_bf16 v[140:143], a[176:179], v[64:67], 0
ds_read_b128 a[176:179], v10 offset:12288
buffer_load_dwordx4 v246, s[32:35], s37 offen offset:3072 lds
MV 116,a,180,v,20
s_add_u32 m0, s36, 135168
MV 124,a,180,v,36
s_mov_b32 s37, 32768
MV 132,a,180,v,52
buffer_load_dwordx4 v245, s[32:35], s37 offen offset:0 lds
MV 140,a,180,v,68
ds_read_b128 a[180:183], v10 offset:13312
MV 116,a,184,v,24
s_mov_b32 s37, 39936
MV 124,a,184,v,40
buffer_load_dwordx4 v246, s[32:35], s37 offen offset:1024 lds
MV 132,a,184,v,56
s_mov_b32 s37, 47104
MV 140,a,184,v,72
ds_read_b128 a[184:187], v10 offset:14336
buffer_load_dwordx4 v245, s[32:35], s37 offen offset:2048 lds
MV 116,a,188,v,28
s_mov_b32 s37, 54272
MV 124,a,188,v,44
buffer_load_dwordx4 v246, s[32:35], s37 offen offset:3072 lds
MV 132,a,188,v,60
MV 140,a,188,v,76
ds_read_b128 a[188:191], v10 offset:15360
s_cmp_eq_u32 s70, 0
s_cbranch_scc1 L_p3_pmask
L_p3_pmask_ret:
v_exp_f32 v80, v80
v_exp_f32 v81, v81
v_exp_f32 v82, v82
v_add_f32 v2, v2, v80
v_add_f32 v2, v2, v81
v_exp_f32 v83, v83
v_cvt_pk_bf16_f32 v80, v80, v81
v_exp_f32 v84, v84
v_add_f32 v2, v2, v82
v_add_f32 v2, v2, v83
v_exp_f32 v85, v85
v_cvt_pk_bf16_f32 v81, v82, v83
v_exp_f32 v86, v86
v_add_f32 v2, v2, v84
v_add_f32 v2, v2, v85
v_exp_f32 v87, v87
v_cvt_pk_bf16_f32 v82, v84, v85
v_exp_f32 v88, v88
v_add_f32 v2, v2, v86
v_add_f32 v2, v2, v87
v_exp_f32 v89, v89
v_cvt_pk_bf16_f32 v83, v86, v87
v_exp_f32 v90, v90
v_add_f32 v3, v3, v88
v_add_f32 v3, v3, v89
v_exp_f32 v91, v91
v_cvt_pk_bf16_f32 v88, v88, v89
v_exp_f32 v92, v92
v_add_f32 v3, v3, v90
v_add_f32 v3, v3, v91
v_exp_f32 v93, v93
v_cvt_pk_bf16_f32 v89, v90, v91
v_exp_f32 v94, v94
v_add_f32 v3, v3, v92
v_add_f32 v3, v3, v93
v_exp_f32 v95, v95
v_cvt_pk_bf16_f32 v90, v92, v93
v_exp_f32 v96, v96
v_add_f32 v3, v3, v94
v_add_f32 v3, v3, v95
v_exp_f32 v97, v97
v_cvt_pk_bf16_f32 v91, v94, v95
v_exp_f32 v98, v98
v_add_f32 v4, v4, v96
v_add_f32 v4, v4, v97
v_exp_f32 v99, v99
v_cvt_pk_bf16_f32 v96, v96, v97
v_exp_f32 v100, v100
v_add_f32 v4, v4, v98
v_add_f32 v4, v4, v99
v_exp_f32 v101, v101
v_cvt_pk_bf16_f32 v97, v98, v99
v_exp_f32 v102, v102
v_add_f32 v4, v4, v100
v_add_f32 v4, v4, v101
v_exp_f32 v103, v103
v_cvt_pk_bf16_f32 v98, v100, v101
v_exp_f32 v104, v104
v_add_f32 v4, v4, v102
v_add_f32 v4, v4, v103
v_exp_f32 v105, v105
v_cvt_pk_bf16_f32 v99, v102, v103
v_exp_f32 v106, v106
v_add_f32 v5, v5, v104
v_add_f32 v5, v5, v105
v_exp_f32 v107, v107
v_cvt_pk_bf16_f32 v104, v104, v105
v_exp_f32 v108, v108
v_add_f32 v5, v5, v106
v_add_f32 v5, v5, v107
v_exp_f32 v109, v109
v_cvt_pk_bf16_f32 v105, v106, v107
v_exp_f32 v110, v110
v_add_f32 v5, v5, v108
v_add_f32 v5, v5, v109
v_exp_f32 v111, v111
v_cvt_pk_bf16_f32 v106, v108, v109
v_add_f32 v5, v5, v110
v_add_f32 v5, v5, v111
v_cvt_pk_bf16_f32 v107, v110, v111
s_sub_u32 s74, s70, 1
s_cbranch_scc1 L_p3_d0m_top
.p2align 5
L_p3_d0_top:
s_waitcnt lgkmcnt(0)
v_mfma_f32_16x16x32_bf16 v[144:147], a[128:131], v[16:19], 0
s_add_u32 m0, s73, 0
ds_read_b128 a[192:195], v11 offset:16384
v_mfma_f32_16x16x32_bf16 v[152:155], a[128:131], v[32:35], 0
v_exp_f32 v112, v112
v_mfma_f32_16x16x32_bf16 v[160:163], a[128:131], v[48:51], 0
ds_read_b128 a[196:199], v11 offset:17408
buffer_load_dwordx4 v12, s[56:59], s71 offen offset:0 sc1 lds
v_mfma_f32_16x16x32_bf16 v[168:171], a[128:131], v[64:67], 0
v_exp_f32 v113, v113
MV 144,a,132,v,20
v_exp_f32 v114, v114
MV 152,a,132,v,36
v_add_f32 v2, v2, v112
v_add_f32 v2, v2, v113
MV 160,a,132,v,52
v_exp_f32 v115, v115
MV 168,a,132,v,68
ds_read_b128 a[200:203], v11 offset:18432
v_cvt_pk_bf16_f32 v112, v112, v113
MV 144,a,136,v,24
v_exp_f32 v116, v116
MV 152,a,136,v,40
v_add_f32 v2, v2, v114
v_add_f32 v2, v2, v115
MV 160,a,136,v,56
v_exp_f32 v117, v117
MV 168,a,136,v,72
ds_read_b128 a[204:207], v11 offset:19456
v_cvt_pk_bf16_f32 v113, v114, v115
MV 144,a,140,v,28
v_exp_f32 v118, v118
MV 152,a,140,v,44
ds_read_b128 a[208:211], v11 offset:20480
v_add_f32 v2, v2, v116
MV 160,a,140,v,60
buffer_load_dwordx4 v12, s[56:59], s71 offen offset:1024 sc1 lds
v_add_f32 v2, v2, v117
MV 168,a,140,v,76
v_exp_f32 v119, v119
v_mfma_f32_16x16x32_bf16 v[148:151], a[144:147], v[16:19], 0
ds_read_b128 a[212:215], v11 offset:21504
v_cvt_pk_bf16_f32 v114, v116, v117
v_mfma_f32_16x16x32_bf16 v[156:159], a[144:147], v[32:35], 0
v_exp_f32 v120, v120
v_mfma_f32_16x16x32_bf16 v[164:167], a[144:147], v[48:51], 0
v_add_f32 v2, v2, v118
v_add_f32 v2, v2, v119
v_mfma_f32_16x16x32_bf16 v[172:175], a[144:147], v[64:67], 0
v_exp_f32 v121, v121
MV 148,a,148,v,20
ds_read_b128 a[216:219], v11 offset:22528
v_cvt_pk_bf16_f32 v115, v118, v119
MV 156,a,148,v,36
v_exp_f32 v122, v122
MV 164,a,148,v,52
v_add_f32 v3, v3, v120
v_add_f32 v3, v3, v121
MV 172,a,148,v,68
v_exp_f32 v123, v123
MV 148,a,152,v,24
ds_read_b128 a[220:223], v11 offset:23552
v_cvt_pk_bf16_f32 v120, v120, v121
MV 156,a,152,v,40
v_exp_f32 v124, v124
MV 164,a,152,v,56
ds_read_b128 a[224:227], v11 offset:24576
v_add_f32 v3, v3, v122
MV 172,a,152,v,72
buffer_load_dwordx4 v12, s[56:59], s71 offen offset:2048 sc1 lds
v_add_f32 v3, v3, v123
MV 148,a,156,v,28
v_exp_f32 v125, v125
MV 156,a,156,v,44
ds_read_b128 a[228:231], v11 offset:25600
v_cvt_pk_bf16_f32 v121, v122, v123
MV 164,a,156,v,60
v_exp_f32 v126, v126
MV 172,a,156,v,76
v_add_f32 v3, v3, v124
v_add_f32 v3, v3, v125
v_mfma_f32_16x16x32_bf16 v[176:179], a[160:163], v[16:19], 0
v_exp_f32 v127, v127
v_mfma_f32_16x16x32_bf16 v[184:187], a[160:163], v[32:35], 0
ds_read_b128 a[232:235], v11 offset:26624
v_cvt_pk_bf16_f32 v122, v124, v125
v_mfma_f32_16x16x32_bf16 v[192:195], a[160:163], v[48:51], 0
v_exp_f32 v128, v128
v_mfma_f32_16x16x32_bf16 v[200:203], a[160:163], v[64:67], 0
v_add_f32 v3, v3, v126
v_add_f32 v3, v3, v127
MV 176,a,164,v,20
v_exp_f32 v129, v129
MV 184,a,164,v,36
ds_read_b128 a[236:239], v11 offset:27648
v_cvt_pk_bf16_f32 v123, v126, v127
MV 192,a,164,v,52
v_exp_f32 v130, v130
MV 200,a,164,v,68
ds_read_b128 a[240:243], v11 offset:28672
v_add_f32 v4, v4, v128
MV 176,a,168,v,24
buffer_load_dwordx4 v12, s[56:59], s71 offen offset:3072 sc1 lds
v_add_f32 v4, v4, v129
MV 184,a,168,v,40
v_exp_f32 v131, v131
MV 192,a,168,v,56
ds_read_b128 a[244:247], v11 offset:29696
v_cvt_pk_bf16_f32 v128, v128, v129
MV 200,a,168,v,72
v_exp_f32 v132, v132
MV 176,a,172,v,28
v_add_f32 v4, v4, v130
v_add_f32 v4, v4, v131
MV 184,a,172,v,44
v_exp_f32 v133, v133
MV 192,a,172,v,60
ds_read_b128 a[248:251], v11 offset:30720
v_cvt_pk_bf16_f32 v129, v130, v131
MV 200,a,172,v,76
v_exp_f32 v134, v134
v_mfma_f32_16x16x32_bf16 v[180:183], a[176:179], v[16:19], 0
v_add_f32 v4, v4, v132
v_add_f32 v4, v4, v133
v_mfma_f32_16x16x32_bf16 v[188:191], a[176:179], v[32:35], 0
v_exp_f32 v135, v135
v_mfma_f32_16x16x32_bf16 v[196:199], a[176:179], v[48:51], 0
ds_read_b128 a[252:255], v11 offset:31744
v_cvt_pk_bf16_f32 v130, v132, v133
v_mfma_f32_16x16x32_bf16 v[204:207], a[176:179], v[64:67], 0
v_exp_f32 v136, v136
MV 180,a,180,v,20
v_add_f32 v4, v4, v134
v_add_f32 v4, v4, v135
MV 188,a,180,v,36
v_exp_f32 v137, v137
MV 196,a,180,v,52
s_add_u32 s71, s71, 16384
v_cvt_pk_bf16_f32 v131, v134, v135
MV 204,a,180,v,68
v_exp_f32 v138, v138
MV 180,a,184,v,24
v_add_f32 v5, v5, v136
v_add_f32 v5, v5, v137
MV 188,a,184,v,40
v_exp_f32 v139, v139
MV 196,a,184,v,56
v_cvt_pk_bf16_f32 v136, v136, v137
MV 204,a,184,v,72
v_exp_f32 v140, v140
MV 180,a,188,v,28
v_add_f32 v5, v5, v138
v_add_f32 v5, v5, v139
MV 188,a,188,v,44
v_exp_f32 v141, v141
MV 196,a,188,v,60
v_cvt_pk_bf16_f32 v137, v138, v139
MV 204,a,188,v,76
v_exp_f32 v142, v142
v_add_f32 v5, v5, v140
v_add_f32 v5, v5, v141
v_exp_f32 v143, v143
v_cvt_pk_bf16_f32 v138, v140, v141
v_add_f32 v5, v5, v142
v_add_f32 v5, v5, v143
v_cvt_pk_bf16_f32 v139, v142, v143
s_waitcnt vmcnt(16) lgkmcnt(0)
MA 0,a,192,v,80
s_barrier
MA 32,a,192,v,88
s_add_u32 m0, s72, 0
ds_read_b128 a[128:131], v10 offset:16384
MA 64,a,192,v,96
v_exp_f32 v144, v144
MA 96,a,192,v,104
ds_read_b128 a[132:135], v10 offset:17408
buffer_load_dwordx4 v12, s[52:55], s71 offen offset:0 sc1 lds
MA 4,a,196,v,80
v_exp_f32 v145, v145
MA 36,a,196,v,88
v_exp_f32 v146, v146
MA 68,a,196,v,96
v_add_f32 v2, v2, v144
v_add_f32 v2, v2, v145
MA 100,a,196,v,104
v_exp_f32 v147, v147
MA 8,a,200,v,80
ds_read_b128 a[136:139], v10 offset:18432
v_cvt_pk_bf16_f32 v144, v144, v145
MA 40,a,200,v,88
v_exp_f32 v148, v148
MA 72,a,200,v,96
v_add_f32 v2, v2, v146
v_add_f32 v2, v2, v147
MA 104,a,200,v,104
ds_read_b128 a[140:143], v10 offset:19456
ds_read_b128 a[144:147], v10 offset:20480
MA 12,a,204,v,80
v_exp_f32 v149, v149
MA 44,a,204,v,88
buffer_load_dwordx4 v12, s[52:55], s71 offen offset:1024 sc1 lds
v_cvt_pk_bf16_f32 v145, v146, v147
MA 76,a,204,v,96
v_exp_f32 v150, v150
MA 108,a,204,v,104
v_add_f32 v2, v2, v148
v_add_f32 v2, v2, v149
MA 16,a,208,v,80
v_exp_f32 v151, v151
MA 48,a,208,v,88
ds_read_b128 a[148:151], v10 offset:21504
v_cvt_pk_bf16_f32 v146, v148, v149
MA 80,a,208,v,96
v_exp_f32 v152, v152
MA 112,a,208,v,104
v_add_f32 v2, v2, v150
v_add_f32 v2, v2, v151
MA 20,a,212,v,80
v_exp_f32 v153, v153
MA 52,a,212,v,88
ds_read_b128 a[152:155], v10 offset:22528
v_cvt_pk_bf16_f32 v147, v150, v151
MA 84,a,212,v,96
v_exp_f32 v154, v154
MA 116,a,212,v,104
v_add_f32 v3, v3, v152
v_add_f32 v3, v3, v153
MA 24,a,216,v,80
ds_read_b128 a[156:159], v10 offset:23552
ds_read_b128 a[160:163], v10 offset:24576
MA 56,a,216,v,88
v_exp_f32 v155, v155
MA 88,a,216,v,96
buffer_load_dwordx4 v12, s[52:55], s71 offen offset:2048 sc1 lds
v_cvt_pk_bf16_f32 v152, v152, v153
MA 120,a,216,v,104
v_exp_f32 v156, v156
MA 28,a,220,v,80
v_add_f32 v3, v3, v154
v_add_f32 v3, v3, v155
MA 60,a,220,v,88
v_exp_f32 v157, v157
MA 92,a,220,v,96
ds_read_b128 a[164:167], v10 offset:25600
v_cvt_pk_bf16_f32 v153, v154, v155
MA 124,a,220,v,104
v_exp_f32 v158, v158
MA 0,a,224,v,112
v_add_f32 v3, v3, v156
v_add_f32 v3, v3, v157
MA 32,a,224,v,120
v_exp_f32 v159, v159
MA 64,a,224,v,128
ds_read_b128 a[168:171], v10 offset:26624
v_cvt_pk_bf16_f32 v154, v156, v157
MA 96,a,224,v,136
v_exp_f32 v160, v160
MA 4,a,228,v,112
v_add_f32 v3, v3, v158
v_add_f32 v3, v3, v159
MA 36,a,228,v,120
ds_read_b128 a[172:175], v10 offset:27648
ds_read_b128 a[176:179], v10 offset:28672
MA 68,a,228,v,128
v_exp_f32 v161, v161
MA 100,a,228,v,136
ds_read_b128 a[180:183], v10 offset:29696
v_cvt_pk_bf16_f32 v155, v158, v159
MA 8,a,232,v,112
v_exp_f32 v162, v162
MA 40,a,232,v,120
v_add_f32 v4, v4, v160
v_add_f32 v4, v4, v161
MA 72,a,232,v,128
v_exp_f32 v163, v163
MA 104,a,232,v,136
buffer_load_dwordx4 v12, s[52:55], s71 offen offset:3072 sc1 lds
v_cvt_pk_bf16_f32 v160, v160, v161
MA 12,a,236,v,112
v_exp_f32 v164, v164
MA 44,a,236,v,120
v_add_f32 v4, v4, v162
v_add_f32 v4, v4, v163
MA 76,a,236,v,128
v_exp_f32 v165, v165
MA 108,a,236,v,136
ds_read_b128 a[184:187], v10 offset:30720
v_cvt_pk_bf16_f32 v161, v162, v163
MA 16,a,240,v,112
v_exp_f32 v166, v166
MA 48,a,240,v,120
v_add_f32 v4, v4, v164
v_add_f32 v4, v4, v165
MA 80,a,240,v,128
v_exp_f32 v167, v167
MA 112,a,240,v,136
ds_read_b128 a[188:191], v10 offset:31744
v_cvt_pk_bf16_f32 v162, v164, v165
MA 20,a,244,v,112
v_exp_f32 v168, v168
MA 52,a,244,v,120
v_add_f32 v4, v4, v166
v_add_f32 v4, v4, v167
MA 84,a,244,v,128
v_exp_f32 v169, v169
MA 116,a,244,v,136
s_sub_u32 s74, s74, 1
v_cvt_pk_bf16_f32 v163, v166, v167
MA 24,a,248,v,112
v_exp_f32 v170, v170
MA 56,a,248,v,120
v_add_f32 v5, v5, v168
v_add_f32 v5, v5, v169
MA 88,a,248,v,128
v_exp_f32 v171, v171
MA 120,a,248,v,136
v_cvt_pk_bf16_f32 v168, v168, v169
MA 28,a,252,v,112
v_exp_f32 v172, v172
MA 60,a,252,v,120
v_add_f32 v5, v5, v170
v_add_f32 v5, v5, v171
MA 92,a,252,v,128
v_exp_f32 v173, v173
MA 124,a,252,v,136
v_cvt_pk_bf16_f32 v169, v170, v171
v_exp_f32 v174, v174
v_add_f32 v5, v5, v172
v_add_f32 v5, v5, v173
v_exp_f32 v175, v175
v_cvt_pk_bf16_f32 v170, v172, v173
v_add_f32 v5, v5, v174
v_add_f32 v5, v5, v175
v_cvt_pk_bf16_f32 v171, v174, v175
s_cbranch_scc1 L_p3_d1m_top
s_waitcnt lgkmcnt(0)
v_xor_b32 v11, 0x8000, v11
v_mfma_f32_16x16x32_bf16 v[80:83], a[128:131], v[16:19], 0
s_add_u32 m0, s73, 16384
ds_read_b128 a[192:195], v11 offset:0
v_mfma_f32_16x16x32_bf16 v[88:91], a[128:131], v[32:35], 0
v_exp_f32 v176, v176
v_mfma_f32_16x16x32_bf16 v[96:99], a[128:131], v[48:51], 0
ds_read_b128 a[196:199], v11 offset:1024
buffer_load_dwordx4 v12, s[56:59], s71 offen offset:0 sc1 lds
v_mfma_f32_16x16x32_bf16 v[104:107], a[128:131], v[64:67], 0
v_exp_f32 v177, v177
MV 80,a,132,v,20
v_exp_f32 v178, v178
MV 88,a,132,v,36
v_add_f32 v2, v2, v176
v_add_f32 v2, v2, v177
MV 96,a,132,v,52
v_exp_f32 v179, v179
MV 104,a,132,v,68
ds_read_b128 a[200:203], v11 offset:2048
v_cvt_pk_bf16_f32 v176, v176, v177
MV 80,a,136,v,24
v_exp_f32 v180, v180
MV 88,a,136,v,40
v_add_f32 v2, v2, v178
v_add_f32 v2, v2, v179
MV 96,a,136,v,56
v_exp_f32 v181, v181
MV 104,a,136,v,72
ds_read_b128 a[204:207], v11 offset:3072
v_cvt_pk_bf16_f32 v177, v178, v179
MV 80,a,140,v,28
v_exp_f32 v182, v182
MV 88,a,140,v,44
buffer_load_dwordx4 v12, s[56:59], s71 offen offset:1024 sc1 lds
v_add_f32 v2, v2, v180
MV 96,a,140,v,60
ds_read_b128 a[208:211], v11 offset:4096
v_add_f32 v2, v2, v181
MV 104,a,140,v,76
v_exp_f32 v183, v183
v_mfma_f32_16x16x32_bf16 v[84:87], a[144:147], v[16:19], 0
ds_read_b128 a[212:215], v11 offset:5120
v_cvt_pk_bf16_f32 v178, v180, v181
v_mfma_f32_16x16x32_bf16 v[92:95], a[144:147], v[32:35], 0
v_exp_f32 v184, v184
v_mfma_f32_16x16x32_bf16 v[100:103], a[144:147], v[48:51], 0
v_add_f32 v2, v2, v182
v_add_f32 v2, v2, v183
v_mfma_f32_16x16x32_bf16 v[108:111], a[144:147], v[64:67], 0
v_exp_f32 v185, v185
MV 84,a,148,v,20
ds_read_b128 a[216:219], v11 offset:6144
v_cvt_pk_bf16_f32 v179, v182, v183
MV 92,a,148,v,36
v_exp_f32 v186, v186
MV 100,a,148,v,52
v_add_f32 v3, v3, v184
v_add_f32 v3, v3, v185
MV 108,a,148,v,68
v_exp_f32 v187, v187
MV 84,a,152,v,24
ds_read_b128 a[220:223], v11 offset:7168
v_cvt_pk_bf16_f32 v184, v184, v185
MV 92,a,152,v,40
ds_read_b128 a[224:227], v11 offset:8192
buffer_load_dwordx4 v12, s[56:59], s71 offen offset:2048 sc1 lds
MV 100,a,152,v,56
v_exp_f32 v188, v188
MV 108,a,152,v,72
v_add_f32 v3, v3, v186
v_add_f32 v3, v3, v187
MV 84,a,156,v,28
v_exp_f32 v189, v189
MV 92,a,156,v,44
ds_read_b128 a[228:231], v11 offset:9216
v_cvt_pk_bf16_f32 v185, v186, v187
MV 100,a,156,v,60
v_exp_f32 v190, v190
MV 108,a,156,v,76
v_add_f32 v3, v3, v188
v_add_f32 v3, v3, v189
v_mfma_f32_16x16x32_bf16 v[112:115], a[160:163], v[16:19], 0
v_exp_f32 v191, v191
v_mfma_f32_16x16x32_bf16 v[120:123], a[160:163], v[32:35], 0
ds_read_b128 a[232:235], v11 offset:10240
v_cvt_pk_bf16_f32 v186, v188, v189
v_mfma_f32_16x16x32_bf16 v[128:131], a[160:163], v[48:51], 0
v_exp_f32 v192, v192
v_mfma_f32_16x16x32_bf16 v[136:139], a[160:163], v[64:67], 0
buffer_load_dwordx4 v12, s[56:59], s71 offen offset:3072 sc1 lds
v_add_f32 v3, v3, v190
MV 112,a,164,v,20
ds_read_b128 a[236:239], v11 offset:11264
v_add_f32 v3, v3, v191
MV 120,a,164,v,36
v_exp_f32 v193, v193
MV 128,a,164,v,52
ds_read_b128 a[240:243], v11 offset:12288
v_cvt_pk_bf16_f32 v187, v190, v191
MV 136,a,164,v,68
v_exp_f32 v194, v194
MV 112,a,168,v,24
v_add_f32 v4, v4, v192
v_add_f32 v4, v4, v193
MV 120,a,168,v,40
v_exp_f32 v195, v195
MV 128,a,168,v,56
ds_read_b128 a[244:247], v11 offset:13312
v_cvt_pk_bf16_f32 v192, v192, v193
MV 136,a,168,v,72
v_exp_f32 v196, v196
MV 112,a,172,v,28
v_add_f32 v4, v4, v194
v_add_f32 v4, v4, v195
MV 120,a,172,v,44
v_exp_f32 v197, v197
MV 128,a,172,v,60
ds_read_b128 a[248:251], v11 offset:14336
v_cvt_pk_bf16_f32 v193, v194, v195
MV 136,a,172,v,76
v_exp_f32 v198, v198
v_mfma_f32_16x16x32_bf16 v[116:119], a[176:179], v[16:19], 0
s_add_u32 s71, s71, 16384
v_add_f32 v4, v4, v196
v_mfma_f32_16x16x32_bf16 v[124:127], a[176:179], v[32:35], 0
ds_read_b128 a[252:255], v11 offset:15360
v_add_f32 v4, v4, v197
v_mfma_f32_16x16x32_bf16 v[132:135], a[176:179], v[48:51], 0
v_exp_f32 v199, v199
v_mfma_f32_16x16x32_bf16 v[140:143], a[176:179], v[64:67], 0
s_xor_b32 s73, s73, 0x8000
v_cvt_pk_bf16_f32 v194, v196, v197
MV 116,a,180,v,20
v_exp_f32 v200, v200
MV 124,a,180,v,36
v_add_f32 v4, v4, v198
v_add_f32 v4, v4, v199
MV 132,a,180,v,52
v_exp_f32 v201, v201
MV 140,a,180,v,68
v_cvt_pk_bf16_f32 v195, v198, v199
MV 116,a,184,v,24
v_exp_f32 v202, v202
MV 124,a,184,v,40
v_add_f32 v5, v5, v200
v_add_f32 v5, v5, v201
MV 132,a,184,v,56
v_exp_f32 v203, v203
MV 140,a,184,v,72
v_cvt_pk_bf16_f32 v200, v200, v201
MV 116,a,188,v,28
v_exp_f32 v204, v204
MV 124,a,188,v,44
v_add_f32 v5, v5, v202
v_add_f32 v5, v5, v203
MV 132,a,188,v,60
v_exp_f32 v205, v205
MV 140,a,188,v,76
v_cvt_pk_bf16_f32 v201, v202, v203
v_exp_f32 v206, v206
v_add_f32 v5, v5, v204
v_add_f32 v5, v5, v205
v_exp_f32 v207, v207
v_cvt_pk_bf16_f32 v202, v204, v205
v_add_f32 v5, v5, v206
v_add_f32 v5, v5, v207
v_cvt_pk_bf16_f32 v203, v206, v207
s_waitcnt vmcnt(16) lgkmcnt(0)
MA 0,a,192,v,144
s_barrier
v_xor_b32 v10, 0x8000, v10
MA 32,a,192,v,152
s_add_u32 m0, s72, 16384
ds_read_b128 a[128:131], v10 offset:0
MA 64,a,192,v,160
v_exp_f32 v80, v80
MA 96,a,192,v,168
ds_read_b128 a[132:135], v10 offset:1024
buffer_load_dwordx4 v12, s[52:55], s71 offen offset:0 sc1 lds
MA 4,a,196,v,144
v_exp_f32 v81, v81
MA 36,a,196,v,152
v_exp_f32 v82, v82
MA 68,a,196,v,160
v_add_f32 v2, v2, v80
v_add_f32 v2, v2, v81
MA 100,a,196,v,168
v_exp_f32 v83, v83
MA 8,a,200,v,144
ds_read_b128 a[136:139], v10 offset:2048
v_cvt_pk_bf16_f32 v80, v80, v81
MA 40,a,200,v,152
v_exp_f32 v84, v84
MA 72,a,200,v,160
v_add_f32 v2, v2, v82
v_add_f32 v2, v2, v83
MA 104,a,200,v,168
ds_read_b128 a[140:143], v10 offset:3072
ds_read_b128 a[144:147], v10 offset:4096
MA 12,a,204,v,144
v_exp_f32 v85, v85
MA 44,a,204,v,152
buffer_load_dwordx4 v12, s[52:55], s71 offen offset:1024 sc1 lds
v_cvt_pk_bf16_f32 v81, v82, v83
MA 76,a,204,v,160
v_exp_f32 v86, v86
MA 108,a,204,v,168
v_add_f32 v2, v2, v84
v_add_f32 v2, v2, v85
MA 16,a,208,v,144
v_exp_f32 v87, v87
MA 48,a,208,v,152
ds_read_b128 a[148:151], v10 offset:5120
v_cvt_pk_bf16_f32 v82, v84, v85
MA 80,a,208,v,160
v_exp_f32 v88, v88
MA 112,a,208,v,168
v_add_f32 v2, v2, v86
v_add_f32 v2, v2, v87
MA 20,a,212,v,144
v_exp_f32 v89, v89
MA 52,a,212,v,152
ds_read_b128 a[152:155], v10 offset:6144
v_cvt_pk_bf16_f32 v83, v86, v87
MA 84,a,212,v,160
v_exp_f32 v90, v90
MA 116,a,212,v,168
v_add_f32 v3, v3, v88
v_add_f32 v3, v3, v89
MA 24,a,216,v,144
ds_read_b128 a[156:159], v10 offset:7168
ds_read_b128 a[160:163], v10 offset:8192
MA 56,a,216,v,152
v_exp_f32 v91, v91
MA 88,a,216,v,160
buffer_load_dwordx4 v12, s[52:55], s71 offen offset:2048 sc1 lds
v_cvt_pk_bf16_f32 v88, v88, v89
MA 120,a,216,v,168
v_exp_f32 v92, v92
MA 28,a,220,v,144
v_add_f32 v3, v3, v90
v_add_f32 v3, v3, v91
MA 60,a,220,v,152
v_exp_f32 v93, v93
MA 92,a,220,v,160
ds_read_b128 a[164:167], v10 offset:9216
v_cvt_pk_bf16_f32 v89, v90, v91
MA 124,a,220,v,168
v_exp_f32 v94, v94
MA 0,a,224,v,176
v_add_f32 v3, v3, v92
v_add_f32 v3, v3, v93
MA 32,a,224,v,184
v_exp_f32 v95, v95
MA 64,a,224,v,192
ds_read_b128 a[168:171], v10 offset:10240
v_cvt_pk_bf16_f32 v90, v92, v93
MA 96,a,224,v,200
v_exp_f32 v96, v96
MA 4,a,228,v,176
v_add_f32 v3, v3, v94
v_add_f32 v3, v3, v95
MA 36,a,228,v,184
ds_read_b128 a[172:175], v10 offset:11264
ds_read_b128 a[176:179], v10 offset:12288
MA 68,a,228,v,192
v_exp_f32 v97, v97
MA 100,a,228,v,200
ds_read_b128 a[180:183], v10 offset:13312
v_cvt_pk_bf16_f32 v91, v94, v95
MA 8,a,232,v,176
v_exp_f32 v98, v98
MA 40,a,232,v,184
v_add_f32 v4, v4, v96
v_add_f32 v4, v4, v97
MA 72,a,232,v,192
v_exp_f32 v99, v99
MA 104,a,232,v,200
buffer_load_dwordx4 v12, s[52:55], s71 offen offset:3072 sc1 lds
v_cvt_pk_bf16_f32 v96, v96, v97
MA 12,a,236,v,176
v_exp_f32 v100, v100
MA 44,a,236,v,184
v_add_f32 v4, v4, v98
v_add_f32 v4, v4, v99
MA 76,a,236,v,192
v_exp_f32 v101, v101
MA 108,a,236,v,200
ds_read_b128 a[184:187], v10 offset:14336
v_cvt_pk_bf16_f32 v97, v98, v99
MA 16,a,240,v,176
v_exp_f32 v102, v102
MA 48,a,240,v,184
v_add_f32 v4, v4, v100
v_add_f32 v4, v4, v101
MA 80,a,240,v,192
v_exp_f32 v103, v103
MA 112,a,240,v,200
ds_read_b128 a[188:191], v10 offset:15360
v_cvt_pk_bf16_f32 v98, v100, v101
MA 20,a,244,v,176
v_exp_f32 v104, v104
MA 52,a,244,v,184
v_add_f32 v4, v4, v102
v_add_f32 v4, v4, v103
MA 84,a,244,v,192
v_exp_f32 v105, v105
MA 116,a,244,v,200
s_xor_b32 s72, s72, 0x8000
v_cvt_pk_bf16_f32 v99, v102, v103
MA 24,a,248,v,176
v_exp_f32 v106, v106
MA 56,a,248,v,184
v_add_f32 v5, v5, v104
v_add_f32 v5, v5, v105
MA 88,a,248,v,192
v_exp_f32 v107, v107
MA 120,a,248,v,200
v_cvt_pk_bf16_f32 v104, v104, v105
MA 28,a,252,v,176
v_exp_f32 v108, v108
MA 60,a,252,v,184
v_add_f32 v5, v5, v106
v_add_f32 v5, v5, v107
MA 92,a,252,v,192
v_exp_f32 v109, v109
MA 124,a,252,v,200
v_cvt_pk_bf16_f32 v105, v106, v107
v_exp_f32 v110, v110
v_add_f32 v5, v5, v108
v_add_f32 v5, v5, v109
v_exp_f32 v111, v111
v_cvt_pk_bf16_f32 v106, v108, v109
v_add_f32 v5, v5, v110
v_add_f32 v5, v5, v111
v_cvt_pk_bf16_f32 v107, v110, v111
s_branch L_p3_d0_top
L_p3_d1m_top:
s_waitcnt lgkmcnt(0)
v_xor_b32 v11, 0x8000, v11
v_mfma_f32_16x16x32_bf16 v[80:83], a[128:131], v[16:19], 0
s_add_u32 m0, s73, 16384
ds_read_b128 a[192:195], v11 offset:0
v_mfma_f32_16x16x32_bf16 v[88:91], a[128:131], v[32:35], 0
v_exp_f32 v176, v176
v_mfma_f32_16x16x32_bf16 v[96:99], a[128:131], v[48:51], 0
ds_read_b128 a[196:199], v11 offset:1024
buffer_load_dwordx4 v12, s[56:59], s71 offen offset:0 sc1 lds
v_mfma_f32_16x16x32_bf16 v[104:107], a[128:131], v[64:67], 0
v_exp_f32 v177, v177
MV 80,a,132,v,20
v_exp_f32 v178, v178
MV 88,a,132,v,36
v_add_f32 v2, v2, v176
v_add_f32 v2, v2, v177
MV 96,a,132,v,52
v_exp_f32 v179, v179
MV 104,a,132,v,68
ds_read_b128 a[200:203], v11 offset:2048
v_cvt_pk_bf16_f32 v176, v176, v177
MV 80,a,136,v,24
v_exp_f32 v180, v180
MV 88,a,136,v,40
v_add_f32 v2, v2, v178
v_add_f32 v2, v2, v179
MV 96,a,136,v,56
v_exp_f32 v181, v181
MV 104,a,136,v,72
ds_read_b128 a[204:207], v11 offset:3072
v_cvt_pk_bf16_f32 v177, v178, v179
MV 80,a,140,v,28
v_exp_f32 v182, v182
MV 88,a,140,v,44
buffer_load_dwordx4 v12, s[56:59], s71 offen offset:1024 sc1 lds
v_add_f32 v2, v2, v180
MV 96,a,140,v,60
ds_read_b128 a[208:211], v11 offset:4096
v_add_f32 v2, v2, v181
MV 104,a,140,v,76
v_exp_f32 v183, v183
v_mfma_f32_16x16x32_bf16 v[84:87], a[144:147], v[16:19], 0
ds_read_b128 a[212:215], v11 offset:5120
v_cvt_pk_bf16_f32 v178, v180, v181
v_mfma_f32_16x16x32_bf16 v[92:95], a[144:147], v[32:35], 0
v_exp_f32 v184, v184
v_mfma_f32_16x16x32_bf16 v[100:103], a[144:147], v[48:51], 0
v_add_f32 v2, v2, v182
v_add_f32 v2, v2, v183
v_mfma_f32_16x16x32_bf16 v[108:111], a[144:147], v[64:67], 0
v_exp_f32 v185, v185
MV 84,a,148,v,20
ds_read_b128 a[216:219], v11 offset:6144
v_cvt_pk_bf16_f32 v179, v182, v183
MV 92,a,148,v,36
v_exp_f32 v186, v186
MV 100,a,148,v,52
v_add_f32 v3, v3, v184
v_add_f32 v3, v3, v185
MV 108,a,148,v,68
v_exp_f32 v187, v187
MV 84,a,152,v,24
ds_read_b128 a[220:223], v11 offset:7168
v_cvt_pk_bf16_f32 v184, v184, v185
MV 92,a,152,v,40
ds_read_b128 a[224:227], v11 offset:8192
buffer_load_dwordx4 v12, s[56:59], s71 offen offset:2048 sc1 lds
MV 100,a,152,v,56
v_exp_f32 v188, v188
MV 108,a,152,v,72
v_add_f32 v3, v3, v186
v_add_f32 v3, v3, v187
MV 84,a,156,v,28
v_exp_f32 v189, v189
MV 92,a,156,v,44
ds_read_b128 a[228:231], v11 offset:9216
v_cvt_pk_bf16_f32 v185, v186, v187
MV 100,a,156,v,60
v_exp_f32 v190, v190
MV 108,a,156,v,76
v_add_f32 v3, v3, v188
v_add_f32 v3, v3, v189
v_mfma_f32_16x16x32_bf16 v[112:115], a[160:163], v[16:19], 0
v_exp_f32 v191, v191
v_mfma_f32_16x16x32_bf16 v[120:123], a[160:163], v[32:35], 0
ds_read_b128 a[232:235], v11 offset:10240
v_cvt_pk_bf16_f32 v186, v188, v189
v_mfma_f32_16x16x32_bf16 v[128:131], a[160:163], v[48:51], 0
v_exp_f32 v192, v192
v_mfma_f32_16x16x32_bf16 v[136:139], a[160:163], v[64:67], 0
buffer_load_dwordx4 v12, s[56:59], s71 offen offset:3072 sc1 lds
v_add_f32 v3, v3, v190
MV 112,a,164,v,20
ds_read_b128 a[236:239], v11 offset:11264
v_add_f32 v3, v3, v191
MV 120,a,164,v,36
v_exp_f32 v193, v193
MV 128,a,164,v,52
ds_read_b128 a[240:243], v11 offset:12288
v_cvt_pk_bf16_f32 v187, v190, v191
MV 136,a,164,v,68
v_exp_f32 v194, v194
MV 112,a,168,v,24
v_add_f32 v4, v4, v192
v_add_f32 v4, v4, v193
MV 120,a,168,v,40
v_exp_f32 v195, v195
MV 128,a,168,v,56
v_cvt_pk_bf16_f32 v192, v192, v193
v_add_u32 v246, 0, v13
MV 136,a,168,v,72
v_exp_f32 v196, v196
MV 112,a,172,v,28
ds_read_b128 a[244:247], v11 offset:13312
v_add_f32 v4, v4, v194
MV 120,a,172,v,44
v_add_f32 v4, v4, v195
v_cmp_gt_i32_e64 s[84:85], 0, v246
MV 128,a,172,v,60
ds_read_b128 a[248:251], v11 offset:14336
v_cmp_gt_i32_e64 s[86:87], 1, v246
MV 136,a,172,v,76
v_exp_f32 v197, v197
v_mfma_f32_16x16x32_bf16 v[116:119], a[176:179], v[16:19], 0
v_cvt_pk_bf16_f32 v193, v194, v195
v_cmp_gt_i32_e64 s[88:89], 2, v246
v_mfma_f32_16x16x32_bf16 v[124:127], a[176:179], v[32:35], 0
v_exp_f32 v198, v198
v_mfma_f32_16x16x32_bf16 v[132:135], a[176:179], v[48:51], 0
s_add_u32 s71, s71, 16384
v_add_f32 v4, v4, v196
v_mfma_f32_16x16x32_bf16 v[140:143], a[176:179], v[64:67], 0
v_add_f32 v4, v4, v197
v_cmp_gt_i32_e64 s[90:91], 3, v246
MV 116,a,180,v,20
v_exp_f32 v199, v199
MV 124,a,180,v,36
ds_read_b128 a[252:255], v11 offset:15360
v_cvt_pk_bf16_f32 v194, v196, v197
MV 132,a,180,v,52
v_cndmask_b32_e64 v96, v96, v14, s[84:85]
v_cndmask_b32_e64 v97, v97, v14, s[86:87]
MV 140,a,180,v,68
v_exp_f32 v200, v200
MV 116,a,184,v,24
v_add_f32 v4, v4, v198
v_add_f32 v4, v4, v199
MV 124,a,184,v,40
v_cndmask_b32_e64 v98, v98, v14, s[88:89]
v_cndmask_b32_e64 v99, v99, v14, s[90:91]
MV 132,a,184,v,56
v_exp_f32 v201, v201
MV 140,a,184,v,72
v_cvt_pk_bf16_f32 v195, v198, v199
v_add_u32 v247, -16, v13
MV 116,a,188,v,28
v_exp_f32 v202, v202
MV 124,a,188,v,44
v_add_f32 v5, v5, v200
v_add_f32 v5, v5, v201
MV 132,a,188,v,60
s_xor_b32 s73, s73, 0x8000
v_cmp_gt_i32_e64 s[92:93], 0, v247
MV 140,a,188,v,76
v_exp_f32 v203, v203
v_cvt_pk_bf16_f32 v200, v200, v201
v_cmp_gt_i32_e64 s[94:95], 1, v247
v_exp_f32 v204, v204
v_add_f32 v5, v5, v202
v_cmp_gt_i32_e64 s[96:97], 2, v247
v_add_f32 v5, v5, v203
v_exp_f32 v205, v205
v_cmp_gt_i32_e64 s[98:99], 3, v247
v_cvt_pk_bf16_f32 v201, v202, v203
v_exp_f32 v206, v206
v_cndmask_b32_e64 v100, v100, v14, s[92:93]
v_add_f32 v5, v5, v204
v_cndmask_b32_e64 v101, v101, v14, s[94:95]
v_add_f32 v5, v5, v205
v_exp_f32 v207, v207
v_cvt_pk_bf16_f32 v202, v204, v205
v_cndmask_b32_e64 v102, v102, v14, s[96:97]
v_add_f32 v5, v5, v206
v_add_f32 v5, v5, v207
v_cndmask_b32_e64 v103, v103, v14, s[98:99]
v_cvt_pk_bf16_f32 v203, v206, v207
s_waitcnt vmcnt(16) lgkmcnt(0)
MA 0,a,192,v,144
s_barrier
v_xor_b32 v10, 0x8000, v10
MA 32,a,192,v,152
s_add_u32 m0, s72, 16384
ds_read_b128 a[128:131], v10 offset:0
MA 64,a,192,v,160
v_exp_f32 v80, v80
MA 96,a,192,v,168
ds_read_b128 a[132:135], v10 offset:1024
buffer_load_dwordx4 v12, s[52:55], s71 offen offset:0 sc1 lds
MA 4,a,196,v,144
v_exp_f32 v81, v81
MA 36,a,196,v,152
v_exp_f32 v82, v82
MA 68,a,196,v,160
v_add_f32 v2, v2, v80
v_add_f32 v2, v2, v81
MA 100,a,196,v,168
v_exp_f32 v83, v83
MA 8,a,200,v,144
ds_read_b128 a[136:139], v10 offset:2048
v_cvt_pk_bf16_f32 v80, v80, v81
MA 40,a,200,v,152
ds_read_b128 a[140:143], v10 offset:3072
v_add_u32 v246, -32, v13
MA 72,a,200,v,160
v_exp_f32 v84, v84
MA 104,a,200,v,168
v_add_f32 v2, v2, v82
v_add_f32 v2, v2, v83
MA 12,a,204,v,144
ds_read_b128 a[144:147], v10 offset:4096
v_cmp_gt_i32_e64 s[84:85], 0, v246
MA 44,a,204,v,152
v_exp_f32 v85, v85
MA 76,a,204,v,160
v_cvt_pk_bf16_f32 v81, v82, v83
v_cmp_gt_i32_e64 s[86:87], 1, v246
MA 108,a,204,v,168
v_exp_f32 v86, v86
MA 16,a,208,v,144
v_add_f32 v2, v2, v84
v_add_f32 v2, v2, v85
MA 48,a,208,v,152
v_exp_f32 v87, v87
MA 80,a,208,v,160
buffer_load_dwordx4 v12, s[52:55], s71 offen offset:1024 sc1 lds
v_cvt_pk_bf16_f32 v82, v84, v85
MA 112,a,208,v,168
ds_read_b128 a[148:151], v10 offset:5120
v_cmp_gt_i32_e64 s[88:89], 2, v246
MA 20,a,212,v,144
v_exp_f32 v88, v88
MA 52,a,212,v,152
v_add_f32 v2, v2, v86
v_add_f32 v2, v2, v87
MA 84,a,212,v,160
v_exp_f32 v89, v89
MA 116,a,212,v,168
ds_read_b128 a[152:155], v10 offset:6144
v_cvt_pk_bf16_f32 v83, v86, v87
MA 24,a,216,v,144
ds_read_b128 a[156:159], v10 offset:7168
v_cmp_gt_i32_e64 s[90:91], 3, v246
MA 56,a,216,v,152
v_exp_f32 v90, v90
MA 88,a,216,v,160
v_add_f32 v3, v3, v88
v_add_f32 v3, v3, v89
MA 120,a,216,v,168
v_exp_f32 v91, v91
MA 28,a,220,v,144
v_cvt_pk_bf16_f32 v88, v88, v89
v_cndmask_b32_e64 v128, v128, v14, s[84:85]
MA 60,a,220,v,152
v_exp_f32 v92, v92
MA 92,a,220,v,160
ds_read_b128 a[160:163], v10 offset:8192
v_add_f32 v3, v3, v90
MA 124,a,220,v,168
v_add_f32 v3, v3, v91
v_cndmask_b32_e64 v129, v129, v14, s[86:87]
MA 0,a,224,v,176
v_exp_f32 v93, v93
MA 32,a,224,v,184
buffer_load_dwordx4 v12, s[52:55], s71 offen offset:2048 sc1 lds
v_cvt_pk_bf16_f32 v89, v90, v91
MA 64,a,224,v,192
v_exp_f32 v94, v94
MA 96,a,224,v,200
ds_read_b128 a[164:167], v10 offset:9216
v_add_f32 v3, v3, v92
MA 4,a,228,v,176
v_add_f32 v3, v3, v93
v_cndmask_b32_e64 v130, v130, v14, s[88:89]
MA 36,a,228,v,184
v_exp_f32 v95, v95
MA 68,a,228,v,192
ds_read_b128 a[168:171], v10 offset:10240
v_cvt_pk_bf16_f32 v90, v92, v93
MA 100,a,228,v,200
v_exp_f32 v96, v96
MA 8,a,232,v,176
v_add_f32 v3, v3, v94
v_cndmask_b32_e64 v131, v131, v14, s[90:91]
MA 40,a,232,v,184
ds_read_b128 a[172:175], v10 offset:11264
v_add_f32 v3, v3, v95
MA 72,a,232,v,192
v_exp_f32 v97, v97
MA 104,a,232,v,200
v_cvt_pk_bf16_f32 v91, v94, v95
v_add_u32 v247, -48, v13
MA 12,a,236,v,176
v_exp_f32 v98, v98
MA 44,a,236,v,184
ds_read_b128 a[176:179], v10 offset:12288
v_add_f32 v4, v4, v96
MA 76,a,236,v,192
v_add_f32 v4, v4, v97
v_cmp_gt_i32_e64 s[92:93], 0, v247
MA 108,a,236,v,200
v_exp_f32 v99, v99
MA 16,a,240,v,176
ds_read_b128 a[180:183], v10 offset:13312
v_cvt_pk_bf16_f32 v96, v96, v97
MA 48,a,240,v,184
v_exp_f32 v100, v100
MA 80,a,240,v,192
buffer_load_dwordx4 v12, s[52:55], s71 offen offset:3072 sc1 lds
v_add_f32 v4, v4, v98
MA 112,a,240,v,200
v_add_f32 v4, v4, v99
v_cmp_gt_i32_e64 s[94:95], 1, v247
MA 20,a,244,v,176
v_exp_f32 v101, v101
MA 52,a,244,v,184
ds_read_b128 a[184:187], v10 offset:14336
v_cvt_pk_bf16_f32 v97, v98, v99
MA 84,a,244,v,192
v_exp_f32 v102, v102
MA 116,a,244,v,200
v_add_f32 v4, v4, v100
v_add_f32 v4, v4, v101
MA 24,a,248,v,176
ds_read_b128 a[188:191], v10 offset:15360
v_cmp_gt_i32_e64 s[96:97], 2, v247
MA 56,a,248,v,184
v_exp_f32 v103, v103
MA 88,a,248,v,192
v_cvt_pk_bf16_f32 v98, v100, v101
v_cmp_gt_i32_e64 s[98:99], 3, v247
MA 120,a,248,v,200
v_exp_f32 v104, v104
MA 28,a,252,v,176
v_add_f32 v4, v4, v102
v_add_f32 v4, v4, v103
MA 60,a,252,v,184
v_exp_f32 v105, v105
MA 92,a,252,v,192
s_xor_b32 s72, s72, 0x8000
v_cvt_pk_bf16_f32 v99, v102, v103
MA 124,a,252,v,200
v_exp_f32 v106, v106
v_add_f32 v5, v5, v104
v_cndmask_b32_e64 v132, v132, v14, s[92:93]
v_add_f32 v5, v5, v105
v_exp_f32 v107, v107
v_cvt_pk_bf16_f32 v104, v104, v105
v_exp_f32 v108, v108
v_cndmask_b32_e64 v133, v133, v14, s[94:95]
v_add_f32 v5, v5, v106
v_add_f32 v5, v5, v107
v_exp_f32 v109, v109
v_cvt_pk_bf16_f32 v105, v106, v107
v_cndmask_b32_e64 v134, v134, v14, s[96:97]
v_exp_f32 v110, v110
v_add_f32 v5, v5, v108
v_add_f32 v5, v5, v109
v_exp_f32 v111, v111
v_cndmask_b32_e64 v135, v135, v14, s[98:99]
v_cvt_pk_bf16_f32 v106, v108, v109
v_add_f32 v5, v5, v110
v_add_f32 v5, v5, v111
v_cvt_pk_bf16_f32 v107, v110, v111
L_p3_d0m_top:
s_waitcnt lgkmcnt(0)
v_mfma_f32_16x16x32_bf16 v[144:147], a[128:131], v[16:19], 0
s_add_u32 m0, s73, 0
ds_read_b128 a[192:195], v11 offset:16384
v_mfma_f32_16x16x32_bf16 v[152:155], a[128:131], v[32:35], 0
v_exp_f32 v112, v112
v_mfma_f32_16x16x32_bf16 v[168:171], a[128:131], v[64:67], 0
v_exp_f32 v113, v113
MV 144,a,132,v,20
ds_read_b128 a[196:199], v11 offset:17408
buffer_load_dwordx4 v12, s[56:59], s71 offen offset:0 sc1 lds
MV 152,a,132,v,36
v_exp_f32 v114, v114
MV 168,a,132,v,68
v_add_f32 v2, v2, v112
v_add_f32 v2, v2, v113
MV 144,a,136,v,24
v_exp_f32 v115, v115
MV 152,a,136,v,40
ds_read_b128 a[200:203], v11 offset:18432
v_cvt_pk_bf16_f32 v112, v112, v113
MV 168,a,136,v,72
v_exp_f32 v116, v116
MV 144,a,140,v,28
ds_read_b128 a[204:207], v11 offset:19456
v_add_f32 v2, v2, v114
MV 152,a,140,v,44
ds_read_b128 a[208:211], v11 offset:20480
v_add_f32 v2, v2, v115
MV 168,a,140,v,76
v_exp_f32 v117, v117
v_mfma_f32_16x16x32_bf16 v[148:151], a[144:147], v[16:19], 0
buffer_load_dwordx4 v12, s[56:59], s71 offen offset:1024 sc1 lds
v_cvt_pk_bf16_f32 v113, v114, v115
v_mfma_f32_16x16x32_bf16 v[156:159], a[144:147], v[32:35], 0
v_exp_f32 v118, v118
v_mfma_f32_16x16x32_bf16 v[172:175], a[144:147], v[64:67], 0
v_add_f32 v2, v2, v116
v_add_f32 v2, v2, v117
MV 148,a,148,v,20
v_exp_f32 v119, v119
MV 156,a,148,v,36
ds_read_b128 a[212:215], v11 offset:21504
v_cvt_pk_bf16_f32 v114, v116, v117
MV 172,a,148,v,68
v_exp_f32 v120, v120
MV 148,a,152,v,24
v_add_f32 v2, v2, v118
v_add_f32 v2, v2, v119
MV 156,a,152,v,40
v_exp_f32 v121, v121
MV 172,a,152,v,72
ds_read_b128 a[216:219], v11 offset:22528
v_cvt_pk_bf16_f32 v115, v118, v119
MV 148,a,156,v,28
v_exp_f32 v122, v122
MV 156,a,156,v,44
ds_read_b128 a[220:223], v11 offset:23552
v_add_f32 v3, v3, v120
MV 172,a,156,v,76
ds_read_b128 a[224:227], v11 offset:24576
v_add_f32 v3, v3, v121
v_mfma_f32_16x16x32_bf16 v[176:179], a[160:163], v[16:19], 0
v_exp_f32 v123, v123
v_mfma_f32_16x16x32_bf16 v[184:187], a[160:163], v[32:35], 0
buffer_load_dwordx4 v12, s[56:59], s71 offen offset:2048 sc1 lds
v_cvt_pk_bf16_f32 v120, v120, v121
v_mfma_f32_16x16x32_bf16 v[200:203], a[160:163], v[64:67], 0
v_exp_f32 v124, v124
MV 176,a,164,v,20
v_add_f32 v3, v3, v122
v_add_f32 v3, v3, v123
MV 184,a,164,v,36
v_exp_f32 v125, v125
MV 200,a,164,v,68
ds_read_b128 a[228:231], v11 offset:25600
v_cvt_pk_bf16_f32 v121, v122, v123
MV 176,a,168,v,24
v_exp_f32 v126, v126
MV 184,a,168,v,40
v_add_f32 v3, v3, v124
v_add_f32 v3, v3, v125
MV 200,a,168,v,72
v_exp_f32 v127, v127
MV 176,a,172,v,28
ds_read_b128 a[232:235], v11 offset:26624
v_cvt_pk_bf16_f32 v122, v124, v125
MV 184,a,172,v,44
v_exp_f32 v128, v128
MV 200,a,172,v,76
ds_read_b128 a[236:239], v11 offset:27648
v_add_f32 v3, v3, v126
v_mfma_f32_16x16x32_bf16 v[180:183], a[176:179], v[16:19], 0
ds_read_b128 a[240:243], v11 offset:28672
v_add_f32 v3, v3, v127
v_mfma_f32_16x16x32_bf16 v[188:191], a[176:179], v[32:35], 0
v_exp_f32 v129, v129
v_mfma_f32_16x16x32_bf16 v[204:207], a[176:179], v[64:67], 0
ds_read_b128 a[244:247], v11 offset:29696
v_cvt_pk_bf16_f32 v123, v126, v127
MV 180,a,180,v,20
v_exp_f32 v130, v130
MV 188,a,180,v,36
v_add_f32 v4, v4, v128
v_add_f32 v4, v4, v129
MV 204,a,180,v,68
v_exp_f32 v131, v131
MV 180,a,184,v,24
buffer_load_dwordx4 v12, s[56:59], s71 offen offset:3072 sc1 lds
v_cvt_pk_bf16_f32 v128, v128, v129
MV 188,a,184,v,40
v_exp_f32 v132, v132
MV 204,a,184,v,72
v_add_f32 v4, v4, v130
v_add_f32 v4, v4, v131
MV 180,a,188,v,28
ds_read_b128 a[248:251], v11 offset:30720
v_add_u32 v246, -64, v239
MV 188,a,188,v,44
v_exp_f32 v133, v133
MV 204,a,188,v,76
ds_read_b128 a[252:255], v11 offset:31744
s_add_u32 s71, s71, 16384
v_cvt_pk_bf16_f32 v129, v130, v131
v_exp_f32 v134, v134
v_cmp_gt_i32_e64 s[84:85], 0, v246
v_add_f32 v4, v4, v132
v_cmp_gt_i32_e64 s[86:87], 1, v246
v_add_f32 v4, v4, v133
v_exp_f32 v135, v135
v_cmp_gt_i32_e64 s[88:89], 2, v246
v_cvt_pk_bf16_f32 v130, v132, v133
v_exp_f32 v136, v136
v_cmp_gt_i32_e64 s[90:91], 3, v246
v_add_f32 v4, v4, v134
v_cndmask_b32_e64 v168, v168, v14, s[84:85]
v_add_f32 v4, v4, v135
v_exp_f32 v137, v137
v_cndmask_b32_e64 v169, v169, v14, s[86:87]
v_cvt_pk_bf16_f32 v131, v134, v135
v_exp_f32 v138, v138
v_cndmask_b32_e64 v170, v170, v14, s[88:89]
v_add_f32 v5, v5, v136
v_cndmask_b32_e64 v171, v171, v14, s[90:91]
v_add_f32 v5, v5, v137
v_exp_f32 v139, v139
v_add_u32 v247, -80, v239
v_cvt_pk_bf16_f32 v136, v136, v137
v_exp_f32 v140, v140
v_cmp_gt_i32_e64 s[92:93], 0, v247
v_add_f32 v5, v5, v138
v_cmp_gt_i32_e64 s[94:95], 1, v247
v_add_f32 v5, v5, v139
v_exp_f32 v141, v141
v_cmp_gt_i32_e64 s[96:97], 2, v247
v_cvt_pk_bf16_f32 v137, v138, v139
v_exp_f32 v142, v142
v_cmp_gt_i32_e64 s[98:99], 3, v247
v_add_f32 v5, v5, v140
v_cndmask_b32_e64 v172, v172, v14, s[92:93]
v_add_f32 v5, v5, v141
v_exp_f32 v143, v143
v_cndmask_b32_e64 v173, v173, v14, s[94:95]
v_cvt_pk_bf16_f32 v138, v140, v141
v_add_f32 v5, v5, v142
v_cndmask_b32_e64 v174, v174, v14, s[96:97]
v_add_f32 v5, v5, v143
v_cvt_pk_bf16_f32 v139, v142, v143
v_cndmask_b32_e64 v175, v175, v14, s[98:99]
s_waitcnt vmcnt(16) lgkmcnt(0)
MA 0,a,192,v,80
s_barrier
MA 32,a,192,v,88
s_add_u32 m0, s72, 0
ds_read_b128 a[128:131], v10 offset:16384
MA 64,a,192,v,96
v_exp_f32 v144, v144
MA 96,a,192,v,104
ds_read_b128 a[132:135], v10 offset:17408
buffer_load_dwordx4 v12, s[52:55], s71 offen offset:0 sc1 lds
MA 4,a,196,v,80
v_exp_f32 v145, v145
MA 36,a,196,v,88
v_exp_f32 v146, v146
MA 68,a,196,v,96
ds_read_b128 a[136:139], v10 offset:18432
v_add_f32 v2, v2, v144
MA 100,a,196,v,104
v_add_f32 v2, v2, v145
v_add_u32 v246, -96, v239
MA 8,a,200,v,80
v_exp_f32 v147, v147
MA 40,a,200,v,88
ds_read_b128 a[140:143], v10 offset:19456
v_cvt_pk_bf16_f32 v144, v144, v145
MA 72,a,200,v,96
v_exp_f32 v148, v148
MA 104,a,200,v,104
v_add_f32 v2, v2, v146
v_cmp_gt_i32_e64 s[84:85], 0, v246
MA 12,a,204,v,80
ds_read_b128 a[144:147], v10 offset:20480
v_add_f32 v2, v2, v147
MA 44,a,204,v,88
v_exp_f32 v149, v149
MA 76,a,204,v,96
v_cvt_pk_bf16_f32 v145, v146, v147
v_cmp_gt_i32_e64 s[86:87], 1, v246
MA 108,a,204,v,104
ds_read_b128 a[148:151], v10 offset:21504
buffer_load_dwordx4 v12, s[52:55], s71 offen offset:1024 sc1 lds
MA 16,a,208,v,80
v_exp_f32 v150, v150
MA 48,a,208,v,88
v_add_f32 v2, v2, v148
v_cmp_gt_i32_e64 s[88:89], 2, v246
MA 80,a,208,v,96
ds_read_b128 a[152:155], v10 offset:22528
v_add_f32 v2, v2, v149
MA 112,a,208,v,104
v_exp_f32 v151, v151
MA 20,a,212,v,80
v_cvt_pk_bf16_f32 v146, v148, v149
v_cmp_gt_i32_e64 s[90:91], 3, v246
MA 52,a,212,v,88
v_exp_f32 v152, v152
MA 84,a,212,v,96
ds_read_b128 a[156:159], v10 offset:23552
v_add_f32 v2, v2, v150
MA 116,a,212,v,104
v_add_f32 v2, v2, v151
v_cndmask_b32_e64 v200, v200, v14, s[84:85]
MA 24,a,216,v,80
v_exp_f32 v153, v153
MA 56,a,216,v,88
ds_read_b128 a[160:163], v10 offset:24576
v_cvt_pk_bf16_f32 v147, v150, v151
MA 88,a,216,v,96
buffer_load_dwordx4 v12, s[52:55], s71 offen offset:2048 sc1 lds
v_cndmask_b32_e64 v201, v201, v14, s[86:87]
MA 120,a,216,v,104
v_exp_f32 v154, v154
MA 28,a,220,v,80
ds_read_b128 a[164:167], v10 offset:25600
v_add_f32 v3, v3, v152
MA 60,a,220,v,88
v_add_f32 v3, v3, v153
v_cndmask_b32_e64 v202, v202, v14, s[88:89]
MA 92,a,220,v,96
v_exp_f32 v155, v155
MA 124,a,220,v,104
ds_read_b128 a[168:171], v10 offset:26624
v_cvt_pk_bf16_f32 v152, v152, v153
MA 0,a,224,v,112
v_exp_f32 v156, v156
MA 32,a,224,v,120
v_add_f32 v3, v3, v154
v_cndmask_b32_e64 v203, v203, v14, s[90:91]
MA 64,a,224,v,128
ds_read_b128 a[172:175], v10 offset:27648
v_add_f32 v3, v3, v155
MA 96,a,224,v,136
v_exp_f32 v157, v157
MA 4,a,228,v,112
v_cvt_pk_bf16_f32 v153, v154, v155
v_add_u32 v247, -112, v239
MA 36,a,228,v,120
v_exp_f32 v158, v158
MA 68,a,228,v,128
ds_read_b128 a[176:179], v10 offset:28672
v_add_f32 v3, v3, v156
MA 100,a,228,v,136
v_add_f32 v3, v3, v157
v_cmp_gt_i32_e64 s[92:93], 0, v247
MA 8,a,232,v,112
v_exp_f32 v159, v159
MA 40,a,232,v,120
ds_read_b128 a[180:183], v10 offset:29696
buffer_load_dwordx4 v12, s[52:55], s71 offen offset:3072 sc1 lds
MA 72,a,232,v,128
v_cvt_pk_bf16_f32 v154, v156, v157
v_cmp_gt_i32_e64 s[94:95], 1, v247
MA 104,a,232,v,136
v_exp_f32 v168, v168
MA 12,a,236,v,112
ds_read_b128 a[184:187], v10 offset:30720
v_add_f32 v3, v3, v158
MA 44,a,236,v,120
v_add_f32 v3, v3, v159
v_cmp_gt_i32_e64 s[96:97], 2, v247
MA 76,a,236,v,128
v_exp_f32 v169, v169
MA 108,a,236,v,136
ds_read_b128 a[188:191], v10 offset:31744
v_cvt_pk_bf16_f32 v155, v158, v159
MA 16,a,240,v,112
v_exp_f32 v170, v170
MA 48,a,240,v,120
v_add_f32 v5, v5, v168
v_cmp_gt_i32_e64 s[98:99], 3, v247
MA 80,a,240,v,128
s_cmp_eq_u32 s70, 7
v_add_f32 v5, v5, v169
MA 112,a,240,v,136
v_exp_f32 v171, v171
MA 20,a,244,v,112
v_cvt_pk_bf16_f32 v168, v168, v169
v_cndmask_b32_e64 v204, v204, v14, s[92:93]
MA 52,a,244,v,120
v_exp_f32 v172, v172
MA 84,a,244,v,128
v_add_f32 v5, v5, v170
v_add_f32 v5, v5, v171
MA 116,a,244,v,136
v_exp_f32 v173, v173
MA 24,a,248,v,112
v_cvt_pk_bf16_f32 v169, v170, v171
v_cndmask_b32_e64 v205, v205, v14, s[94:95]
MA 56,a,248,v,120
v_exp_f32 v174, v174
MA 88,a,248,v,128
v_add_f32 v5, v5, v172
v_cndmask_b32_e64 v206, v206, v14, s[96:97]
MA 120,a,248,v,136
v_add_f32 v5, v5, v173
v_cndmask_b32_e64 v207, v207, v14, s[98:99]
MA 28,a,252,v,112
v_exp_f32 v175, v175
MA 60,a,252,v,120
v_cvt_pk_bf16_f32 v170, v172, v173
v_add_f32 v5, v5, v174
MA 92,a,252,v,128
v_add_f32 v5, v5, v175
v_cvt_pk_bf16_f32 v171, v174, v175
MA 124,a,252,v,136
s_cbranch_scc1 L_p3_mxm_top
s_waitcnt lgkmcnt(0)
v_xor_b32 v11, 0x8000, v11
v_mfma_f32_16x16x32_bf16 v[80:83], a[128:131], v[16:19], 0
s_add_u32 m0, s73, 16384
ds_read_b128 a[192:195], v11 offset:0
v_mfma_f32_16x16x32_bf16 v[88:91], a[128:131], v[32:35], 0
v_exp_f32 v176, v176
MV 80,a,132,v,20
v_exp_f32 v177, v177
MV 88,a,132,v,36
ds_read_b128 a[196:199], v11 offset:1024
buffer_load_dwordx4 v12, s[56:59], s71 offen offset:0 sc1 lds
MV 80,a,136,v,24
v_exp_f32 v178, v178
MV 88,a,136,v,40
v_add_f32 v2, v2, v176
v_add_f32 v2, v2, v177
MV 80,a,140,v,28
ds_read_b128 a[200:203], v11 offset:2048
ds_read_b128 a[204:207], v11 offset:3072
MV 88,a,140,v,44
v_exp_f32 v179, v179
v_mfma_f32_16x16x32_bf16 v[84:87], a[144:147], v[16:19], 0
ds_read_b128 a[208:211], v11 offset:4096
v_cvt_pk_bf16_f32 v176, v176, v177
v_mfma_f32_16x16x32_bf16 v[92:95], a[144:147], v[32:35], 0
v_exp_f32 v180, v180
MV 84,a,148,v,20
v_add_f32 v2, v2, v178
v_add_f32 v2, v2, v179
MV 92,a,148,v,36
v_exp_f32 v181, v181
MV 84,a,152,v,24
buffer_load_dwordx4 v12, s[56:59], s71 offen offset:1024 sc1 lds
v_cvt_pk_bf16_f32 v177, v178, v179
MV 92,a,152,v,40
v_exp_f32 v182, v182
MV 84,a,156,v,28
ds_read_b128 a[212:215], v11 offset:5120
v_add_f32 v2, v2, v180
MV 92,a,156,v,44
ds_read_b128 a[216:219], v11 offset:6144
v_add_f32 v2, v2, v181
v_mfma_f32_16x16x32_bf16 v[112:115], a[160:163], v[16:19], 0
v_exp_f32 v183, v183
v_mfma_f32_16x16x32_bf16 v[120:123], a[160:163], v[32:35], 0
ds_read_b128 a[220:223], v11 offset:7168
v_cvt_pk_bf16_f32 v178, v180, v181
MV 112,a,164,v,20
v_exp_f32 v184, v184
MV 120,a,164,v,36
v_add_f32 v2, v2, v182
v_add_f32 v2, v2, v183
MV 112,a,168,v,24
ds_read_b128 a[224:227], v11 offset:8192
buffer_load_dwordx4 v12, s[56:59], s71 offen offset:2048 sc1 lds
MV 120,a,168,v,40
v_exp_f32 v185, v185
MV 112,a,172,v,28
ds_read_b128 a[228:231], v11 offset:9216
v_cvt_pk_bf16_f32 v179, v182, v183
MV 120,a,172,v,44
v_exp_f32 v186, v186
v_mfma_f32_16x16x32_bf16 v[116:119], a[176:179], v[16:19], 0
v_add_f32 v3, v3, v184
v_add_f32 v3, v3, v185
v_mfma_f32_16x16x32_bf16 v[124:127], a[176:179], v[32:35], 0
v_exp_f32 v187, v187
MV 116,a,180,v,20
ds_read_b128 a[232:235], v11 offset:10240
v_cvt_pk_bf16_f32 v184, v184, v185
MV 124,a,180,v,36
v_exp_f32 v188, v188
MV 116,a,184,v,24
ds_read_b128 a[236:239], v11 offset:11264
v_add_f32 v3, v3, v186
MV 124,a,184,v,40
buffer_load_dwordx4 v12, s[56:59], s71 offen offset:3072 sc1 lds
v_add_f32 v3, v3, v187
MV 116,a,188,v,28
v_exp_f32 v189, v189
MV 124,a,188,v,44
ds_read_b128 a[240:243], v11 offset:12288
ds_read_b128 a[244:247], v11 offset:13312
ds_read_b128 a[248:251], v11 offset:14336
ds_read_b128 a[252:255], v11 offset:15360
s_add_u32 s71, s71, 16384
s_xor_b32 s73, s73, 0x8000
v_cvt_pk_bf16_f32 v185, v186, v187
v_exp_f32 v190, v190
v_add_f32 v3, v3, v188
v_add_f32 v3, v3, v189
v_exp_f32 v191, v191
v_cvt_pk_bf16_f32 v186, v188, v189
v_exp_f32 v200, v200
v_add_f32 v3, v3, v190
v_add_f32 v3, v3, v191
v_exp_f32 v201, v201
v_cvt_pk_bf16_f32 v187, v190, v191
v_exp_f32 v202, v202
v_add_f32 v5, v5, v200
v_add_f32 v5, v5, v201
v_exp_f32 v203, v203
v_cvt_pk_bf16_f32 v200, v200, v201
v_exp_f32 v204, v204
v_add_f32 v5, v5, v202
v_add_f32 v5, v5, v203
v_exp_f32 v205, v205
v_cvt_pk_bf16_f32 v201, v202, v203
v_exp_f32 v206, v206
v_add_f32 v5, v5, v204
v_add_f32 v5, v5, v205
v_exp_f32 v207, v207
v_cvt_pk_bf16_f32 v202, v204, v205
v_add_f32 v5, v5, v206
v_add_f32 v5, v5, v207
v_cvt_pk_bf16_f32 v203, v206, v207
s_waitcnt vmcnt(16) lgkmcnt(0)
MA 0,a,192,v,144
s_barrier
v_xor_b32 v10, 0x8000, v10
MA 32,a,192,v,152
s_add_u32 m0, s72, 16384
ds_read_b128 a[128:131], v10 offset:0
MA 96,a,192,v,168
v_exp_f32 v80, v80
MA 4,a,196,v,144
buffer_load_dwordx4 v12, s[52:55], s71 offen offset:0 sc1 lds
v_lshrrev_b32 v249, 2, v1
MA 36,a,196,v,152
ds_read_b128 a[132:135], v10 offset:1024
v_and_b32 v248, 7, v249
MA 100,a,196,v,168
v_lshlrev_b32 v249, 8, v249
v_and_b32 v250, 3, v1
MA 8,a,200,v,144
v_exp_f32 v81, v81
MA 40,a,200,v,152
v_lshl_add_u32 v249, v250, 3, v249
s_lshl_b32 s36, s3, 13
MA 104,a,200,v,168
ds_read_b128 a[136:139], v10 offset:2048
s_add_u32 s36, s36, 131072
MA 12,a,204,v,144
v_add_u32 v249, s36, v249
s_waitcnt vmcnt(13)
MA 44,a,204,v,152
v_exp_f32 v82, v82
MA 108,a,204,v,168
ds_read_b128 a[140:143], v10 offset:3072
v_xor_b32 v250, 0, v248
MA 16,a,208,v,144
v_lshl_add_u32 v250, v250, 5, v249
TR 96,250,0
MA 48,a,208,v,152
TR 98,250,4096
v_xor_b32 v250, 1, v248
MA 112,a,208,v,168
v_exp_f32 v83, v83
MA 20,a,212,v,144
ds_read_b128 a[144:147], v10 offset:4096
v_lshl_add_u32 v250, v250, 5, v249
MA 52,a,212,v,152
v_cvt_pk_bf16_f32 v80, v80, v81
TR 100,250,0
MA 116,a,212,v,168
ds_read_b128 a[148:151], v10 offset:5120
TR 102,250,4096
MA 24,a,216,v,144
buffer_load_dwordx4 v12, s[52:55], s71 offen offset:1024 sc1 lds
v_xor_b32 v250, 2, v248
MA 56,a,216,v,152
v_lshl_add_u32 v250, v250, 5, v249
TR 104,250,0
MA 120,a,216,v,168
v_exp_f32 v84, v84
MA 28,a,220,v,144
TR 106,250,4096
v_xor_b32 v250, 3, v248
MA 60,a,220,v,152
ds_read_b128 a[152:155], v10 offset:6144
v_lshl_add_u32 v250, v250, 5, v249
MA 124,a,220,v,168
v_exp_f32 v85, v85
MA 0,a,224,v,176
TR 108,250,0
TR 110,250,4096
MA 32,a,224,v,184
v_xor_b32 v250, 4, v248
v_lshl_add_u32 v250, v250, 5, v249
MA 96,a,224,v,200
ds_read_b128 a[156:159], v10 offset:7168
v_cvt_pk_bf16_f32 v81, v82, v83
MA 4,a,228,v,176
TR 128,250,0
TR 130,250,4096
MA 36,a,228,v,184
ds_read_b128 a[160:163], v10 offset:8192
v_xor_b32 v250, 5, v248
MA 100,a,228,v,200
v_exp_f32 v86, v86
MA 8,a,232,v,176
v_lshl_add_u32 v250, v250, 5, v249
TR 132,250,0
MA 40,a,232,v,184
TR 134,250,4096
v_xor_b32 v250, 6, v248
MA 104,a,232,v,200
v_exp_f32 v87, v87
MA 12,a,236,v,176
ds_read_b128 a[164:167], v10 offset:9216
buffer_load_dwordx4 v12, s[52:55], s71 offen offset:2048 sc1 lds
MA 44,a,236,v,184
v_lshl_add_u32 v250, v250, 5, v249
TR 136,250,0
MA 108,a,236,v,200
TR 138,250,4096
v_xor_b32 v250, 7, v248
MA 16,a,240,v,176
ds_read_b128 a[168:171], v10 offset:10240
v_cvt_pk_bf16_f32 v82, v84, v85
MA 48,a,240,v,184
v_lshl_add_u32 v250, v250, 5, v249
TR 140,250,0
MA 112,a,240,v,200
ds_read_b128 a[172:175], v10 offset:11264
TR 142,250,4096
MA 20,a,244,v,176
v_exp_f32 v88, v88
MA 52,a,244,v,184
s_add_u32 s32, s40, 100663296
s_addc_u32 s33, s41, 0
MA 116,a,244,v,200
s_mov_b32 s34, 8388608
s_mov_b32 s35, 0x20000
MA 24,a,248,v,176
v_exp_f32 v89, v89
MA 56,a,248,v,184
s_and_b32 s36, s2, 7
s_lshl_b32 s36, s36, 20
MA 120,a,248,v,200
ds_read_b128 a[176:179], v10 offset:12288
s_lshr_b32 s37, s2, 3
MA 28,a,252,v,176
v_cvt_pk_bf16_f32 v83, v86, v87
s_lshl_b32 s37, s37, 15
MA 60,a,252,v,184
s_add_u32 s36, s36, s37
s_lshl_b32 s37, s3, 12
MA 124,a,252,v,200
ds_read_b128 a[180:183], v10 offset:13312
ds_read_b128 a[184:187], v10 offset:14336
ds_read_b128 a[188:191], v10 offset:15360
buffer_load_dwordx4 v12, s[52:55], s71 offen offset:3072 sc1 lds
s_xor_b32 s72, s72, 0x8000
v_exp_f32 v90, v90
s_add_u32 s36, s36, s37
s_add_u32 s37, s36, 4096
s_waitcnt lgkmcnt(15)
buffer_store_dwordx4 v[96:99], v12, s[32:35], s36 offen offset:0 sc1
buffer_store_dwordx4 v[100:103], v12, s[32:35], s36 offen offset:1024 sc1
v_exp_f32 v91, v91
buffer_store_dwordx4 v[104:107], v12, s[32:35], s36 offen offset:2048 sc1
buffer_store_dwordx4 v[108:111], v12, s[32:35], s36 offen offset:3072 sc1
s_waitcnt lgkmcnt(14)
buffer_store_dwordx4 v[128:131], v12, s[32:35], s37 offen offset:0 sc1
v_cvt_pk_bf16_f32 v88, v88, v89
s_waitcnt lgkmcnt(11)
buffer_store_dwordx4 v[132:135], v12, s[32:35], s37 offen offset:1024 sc1
s_waitcnt lgkmcnt(8)
buffer_store_dwordx4 v[136:139], v12, s[32:35], s37 offen offset:2048 sc1
s_waitcnt lgkmcnt(4)
buffer_store_dwordx4 v[140:143], v12, s[32:35], s37 offen offset:3072 sc1
s_add_u32 s32, s40, 109051904
s_addc_u32 s33, s41, 0
v_exp_f32 v92, v92
s_mov_b32 s34, 4194304
s_mov_b32 s35, 0x20000
s_lshl_b32 s36, s2, 14
v_exp_f32 v93, v93
v_mov_b32 v252, -1
v_mov_b32 v253, -1
v_mov_b32 v254, -1
v_mov_b32 v255, -1
v_cvt_pk_bf16_f32 v89, v90, v91
buffer_store_dwordx4 v[252:255], v12, s[32:35], s36 offen offset:0 sc1
buffer_store_dwordx4 v[252:255], v12, s[32:35], s36 offen offset:1024 sc1
v_exp_f32 v94, v94
buffer_store_dwordx4 v[252:255], v12, s[32:35], s36 offen offset:2048 sc1
buffer_store_dwordx4 v[252:255], v12, s[32:35], s36 offen offset:3072 sc1
v_lshlrev_b32 v232, 4, v1
v_add_u32 v233, -4, v232
v_mov_b32 v235, 0
v_exp_f32 v95, v95
buffer_load_ushort v234, v235, s[28:31], s42 offen
buffer_load_dword v209, v233, s[16:19], 0 offen
buffer_load_dwordx4 v[210:213], v232, s[16:19], 0 offen offset:0
buffer_load_dword v215, v232, s[16:19], 0 offen offset:1020
v_cvt_pk_bf16_f32 v90, v92, v93
buffer_load_dwordx4 v[216:219], v232, s[16:19], 0 offen offset:1024
buffer_load_dword v221, v232, s[16:19], 0 offen offset:2044
v_cvt_pk_bf16_f32 v91, v94, v95
buffer_load_dwordx4 v[222:225], v232, s[16:19], 0 offen offset:2048
buffer_load_dword v227, v232, s[16:19], 0 offen offset:3068
buffer_load_dwordx4 v[228:231], v232, s[16:19], 0 offen offset:3072
L_p3_eps:
v_mov_b32 v240, v4
v_mov_b32 v241, v5
s_nop 0
v_permlane32_swap_b32 v4, v240
v_permlane32_swap_b32 v5, v241
v_add_f32 v4, v4, v240
v_add_f32 v5, v5, v241
v_mov_b32 v240, v4
v_mov_b32 v241, v5
s_nop 0
v_permlane16_swap_b32 v4, v240
v_permlane16_swap_b32 v5, v241
v_add_f32 v4, v4, v240
v_add_f32 v5, v5, v241
v_cmp_nle_f32 vcc, 0x30800000, v4
s_nop 0
s_mov_b64 s[78:79], vcc
v_cmp_nge_f32 vcc, 0x4e800000, v4
s_nop 0
s_or_b64 s[78:79], s[78:79], vcc
v_cmp_nle_f32 vcc, 0x30800000, v5
s_nop 0
s_or_b64 s[78:79], s[78:79], vcc
v_cmp_nge_f32 vcc, 0x4e800000, v5
s_nop 0
s_or_b64 s[78:79], s[78:79], vcc
v_rcp_f32 v4, v4
v_rcp_f32 v5, v5
s_add_u32 s80, s101, s76
s_nop 4
v_accvgpr_read_b32 v240, a64
v_accvgpr_read_b32 v241, a65
v_accvgpr_read_b32 v242, a66
v_accvgpr_read_b32 v243, a67
v_accvgpr_read_b32 v244, a68
v_accvgpr_read_b32 v245, a69
v_accvgpr_read_b32 v246, a70
v_accvgpr_read_b32 v247, a71
v_mul_f32 v240, v240, v4
v_mul_f32 v241, v241, v4
v_mul_f32 v242, v242, v4
v_mul_f32 v243, v243, v4
v_mul_f32 v244, v244, v4
v_mul_f32 v245, v245, v4
v_mul_f32 v246, v246, v4
v_mul_f32 v247, v247, v4
v_cvt_pk_bf16_f32 v248, v240, v241
v_cvt_pk_bf16_f32 v249, v242, v243
v_cvt_pk_bf16_f32 v250, v244, v245
v_cvt_pk_bf16_f32 v251, v246, v247
buffer_store_dwordx4 v[248:251], v15, s[60:63], s101 offen offset:0 sc1
v_accvgpr_read_b32 v240, a72
v_accvgpr_read_b32 v241, a73
v_accvgpr_read_b32 v242, a74
v_accvgpr_read_b32 v243, a75
v_accvgpr_read_b32 v244, a76
v_accvgpr_read_b32 v245, a77
v_accvgpr_read_b32 v246, a78
v_accvgpr_read_b32 v247, a79
v_mul_f32 v240, v240, v4
v_mul_f32 v241, v241, v4
v_mul_f32 v242, v242, v4
v_mul_f32 v243, v243, v4
v_mul_f32 v244, v244, v4
v_mul_f32 v245, v245, v4
v_mul_f32 v246, v246, v4
v_mul_f32 v247, v247, v4
v_cvt_pk_bf16_f32 v252, v240, v241
v_cvt_pk_bf16_f32 v253, v242, v243
v_cvt_pk_bf16_f32 v254, v244, v245
v_cvt_pk_bf16_f32 v255, v246, v247
buffer_store_dwordx4 v[252:255], v15, s[60:63], s101 offen offset:1024 sc1
v_accvgpr_read_b32 v240, a80
v_accvgpr_read_b32 v241, a81
v_accvgpr_read_b32 v242, a82
v_accvgpr_read_b32 v243, a83
v_accvgpr_read_b32 v244, a84
v_accvgpr_read_b32 v245, a85
v_accvgpr_read_b32 v246, a86
v_accvgpr_read_b32 v247, a87
v_mul_f32 v240, v240, v4
v_mul_f32 v241, v241, v4
v_mul_f32 v242, v242, v4
v_mul_f32 v243, v243, v4
v_mul_f32 v244, v244, v4
v_mul_f32 v245, v245, v4
v_mul_f32 v246, v246, v4
v_mul_f32 v247, v247, v4
v_cvt_pk_bf16_f32 v248, v240, v241
v_cvt_pk_bf16_f32 v249, v242, v243
v_cvt_pk_bf16_f32 v250, v244, v245
v_cvt_pk_bf16_f32 v251, v246, v247
buffer_store_dwordx4 v[248:251], v15, s[60:63], s101 offen offset:2048 sc1
v_accvgpr_read_b32 v240, a88
v_accvgpr_read_b32 v241, a89
v_accvgpr_read_b32 v242, a90
v_accvgpr_read_b32 v243, a91
v_accvgpr_read_b32 v244, a92
v_accvgpr_read_b32 v245, a93
v_accvgpr_read_b32 v246, a94
v_accvgpr_read_b32 v247, a95
v_mul_f32 v240, v240, v4
v_mul_f32 v241, v241, v4
v_mul_f32 v242, v242, v4
v_mul_f32 v243, v243, v4
v_mul_f32 v244, v244, v4
v_mul_f32 v245, v245, v4
v_mul_f32 v246, v246, v4
v_mul_f32 v247, v247, v4
v_cvt_pk_bf16_f32 v252, v240, v241
v_cvt_pk_bf16_f32 v253, v242, v243
v_cvt_pk_bf16_f32 v254, v244, v245
v_cvt_pk_bf16_f32 v255, v246, v247
buffer_store_dwordx4 v[252:255], v15, s[60:63], s101 offen offset:3072 sc1
v_accvgpr_read_b32 v240, a96
v_accvgpr_read_b32 v241, a97
v_accvgpr_read_b32 v242, a98
v_accvgpr_read_b32 v243, a99
v_accvgpr_read_b32 v244, a100
v_accvgpr_read_b32 v245, a101
v_accvgpr_read_b32 v246, a102
v_accvgpr_read_b32 v247, a103
v_mul_f32 v240, v240, v5
v_mul_f32 v241, v241, v5
v_mul_f32 v242, v242, v5
v_mul_f32 v243, v243, v5
v_mul_f32 v244, v244, v5
v_mul_f32 v245, v245, v5
v_mul_f32 v246, v246, v5
v_mul_f32 v247, v247, v5
v_cvt_pk_bf16_f32 v248, v240, v241
v_cvt_pk_bf16_f32 v249, v242, v243
v_cvt_pk_bf16_f32 v250, v244, v245
v_cvt_pk_bf16_f32 v251, v246, v247
buffer_store_dwordx4 v[248:251], v15, s[60:63], s80 offen offset:0 sc1
v_accvgpr_read_b32 v240, a104
v_accvgpr_read_b32 v241, a105
v_accvgpr_read_b32 v242, a106
v_accvgpr_read_b32 v243, a107
v_accvgpr_read_b32 v244, a108
v_accvgpr_read_b32 v245, a109
v_accvgpr_read_b32 v246, a110
v_accvgpr_read_b32 v247, a111
v_mul_f32 v240, v240, v5
v_mul_f32 v241, v241, v5
v_mul_f32 v242, v242, v5
v_mul_f32 v243, v243, v5
v_mul_f32 v244, v244, v5
v_mul_f32 v245, v245, v5
v_mul_f32 v246, v246, v5
v_mul_f32 v247, v247, v5
v_cvt_pk_bf16_f32 v252, v240, v241
v_cvt_pk_bf16_f32 v253, v242, v243
v_cvt_pk_bf16_f32 v254, v244, v245
v_cvt_pk_bf16_f32 v255, v246, v247
buffer_store_dwordx4 v[252:255], v15, s[60:63], s80 offen offset:1024 sc1
v_accvgpr_read_b32 v240, a112
v_accvgpr_read_b32 v241, a113
v_accvgpr_read_b32 v242, a114
v_accvgpr_read_b32 v243, a115
v_accvgpr_read_b32 v244, a116
v_accvgpr_read_b32 v245, a117
v_accvgpr_read_b32 v246, a118
v_accvgpr_read_b32 v247, a119
v_mul_f32 v240, v240, v5
v_mul_f32 v241, v241, v5
v_mul_f32 v242, v242, v5
v_mul_f32 v243, v243, v5
v_mul_f32 v244, v244, v5
v_mul_f32 v245, v245, v5
v_mul_f32 v246, v246, v5
v_mul_f32 v247, v247, v5
v_cvt_pk_bf16_f32 v248, v240, v241
v_cvt_pk_bf16_f32 v249, v242, v243
v_cvt_pk_bf16_f32 v250, v244, v245
v_cvt_pk_bf16_f32 v251, v246, v247
buffer_store_dwordx4 v[248:251], v15, s[60:63], s80 offen offset:2048 sc1
v_accvgpr_read_b32 v240, a120
v_accvgpr_read_b32 v241, a121
v_accvgpr_read_b32 v242, a122
v_accvgpr_read_b32 v243, a123
v_accvgpr_read_b32 v244, a124
v_accvgpr_read_b32 v245, a125
v_accvgpr_read_b32 v246, a126
v_accvgpr_read_b32 v247, a127
v_mul_f32 v240, v240, v5
v_mul_f32 v241, v241, v5
v_mul_f32 v242, v242, v5
v_mul_f32 v243, v243, v5
v_mul_f32 v244, v244, v5
v_mul_f32 v245, v245, v5
v_mul_f32 v246, v246, v5
v_mul_f32 v247, v247, v5
v_cvt_pk_bf16_f32 v252, v240, v241
v_cvt_pk_bf16_f32 v253, v242, v243
v_cvt_pk_bf16_f32 v254, v244, v245
v_cvt_pk_bf16_f32 v255, v246, v247
buffer_store_dwordx4 v[252:255], v15, s[60:63], s80 offen offset:3072 sc1
v_mov_b32 v160, 0x3f803f80
v_mov_b32 v161, 0x3f803f80
v_mov_b32 v162, 0x3f803f80
v_mov_b32 v163, 0x3f803f80
v_mov_b32 v164, 0
v_mov_b32 v165, 0
v_mov_b32 v166, 0
v_mov_b32 v167, 0
v_mov_b32 v168, 0
v_mov_b32 v169, 0
v_mov_b32 v170, 0
v_mov_b32 v171, 0
s_and_b32 s36, s2, 3
s_lshl_b32 s36, s36, 1
s_sub_u32 s32, 14, s36
s_bitcmp1_b32 s2, 4
s_cselect_b32 s36, s32, s36
s_bfe_u32 s32, s2, 0x10003
s_add_u32 s36, s36, s32
s_bfe_u32 s37, s2, 0x10002
s_lshr_b32 s32, s2, 5
s_lshl_b32 s32, s32, 1
s_add_u32 s37, s37, s32
s_lshl_b32 s36, s36, 2
s_add_u32 s36, s36, s3
s_lshl_b32 s37, s37, 7
s_lshl_b32 s32, s36, 16
s_add_u32 s37, s37, s32
s_lshl_b32 s36, s36, 7
v_and_b32 v240, 15, v1
v_bfe_u32 v241, v1, 4, 1
v_lshlrev_b32 v241, 5, v241
v_lshrrev_b32 v242, 5, v1
v_lshl_add_u32 v241, v242, 4, v241
v_lshl_add_u32 v241, v240, 11, v241
v_lshlrev_b32 v240, 2, v240
s_add_u32 s32, s40, 58720256
s_addc_u32 s33, s41, 0
s_mov_b32 s34, 8192
s_mov_b32 s35, 0x20000
buffer_load_dwordx4 v[192:195], v241, s[44:47], s37 offen offset:0
buffer_load_dwordx4 v[196:199], v241, s[44:47], s37 offen offset:64
buffer_load_dword v6, v240, s[32:35], s36 offen offset:0 sc1
s_add_u32 s37, s37, 32768
buffer_load_dwordx4 v[200:203], v241, s[44:47], s37 offen offset:0
buffer_load_dwordx4 v[204:207], v241, s[44:47], s37 offen offset:64
buffer_load_dword v7, v240, s[32:35], s36 offen offset:64 sc1
v_lshlrev_b32 v236, 20, v1
s_lshl_b32 s36, s3, 26
v_add_u32 v236, s36, v236
v_mov_b32 v237, 1
s_lshl_b32 s37, s2, 2
s_getpc_b64 s[38:39]
L_ct_b:
s_add_u32 s38, s38, L_p3_s1m_top - L_ct_b
s_addc_u32 s39, s39, 0
v_mov_b32 v173, s39
v_mov_b32 v172, s38
s_lshr_b32 s38, s2, 3
s_lshl_b32 s38, s38, 2
s_add_u32 s38, s38, s3
s_lshl_b32 s38, s38, 7
v_and_b32 v174, 3, v1
v_lshlrev_b32 v174, 14, v174
v_add_u32 v174, s38, v174
v_min_u32 v174, L_end - L_p3_s1m_top - 4, v174
v_add_co_u32 v172, vcc, v172, v174
s_nop 1
v_addc_co_u32 v173, vcc, 0, v173, vcc
global_load_dword v174, v[172:173], off
s_lshl_b32 s74, s70, 1
s_sub_u32 s74, 13, s74
s_cbranch_scc1 L_p3_s0m_top
.p2align 5
L_p3_s0_top:
s_waitcnt lgkmcnt(0)
v_mfma_f32_16x16x32_bf16 v[144:147], a[128:131], v[16:19], 0
s_add_u32 m0, s73, 0
ds_read_b128 a[192:195], v11 offset:16384
v_mfma_f32_16x16x32_bf16 v[152:155], a[128:131], v[32:35], 0
v_exp_f32 v112, v112
MV 144,a,132,v,20
ds_read_b128 a[196:199], v11 offset:17408
buffer_load_dwordx4 v12, s[56:59], s71 offen offset:0 sc1 lds
MV 152,a,132,v,36
v_exp_f32 v113, v113
MV 144,a,136,v,24
ds_read_b128 a[200:203], v11 offset:18432
ds_read_b128 a[204:207], v11 offset:19456
MV 152,a,136,v,40
v_exp_f32 v114, v114
MV 144,a,140,v,28
v_exp_f32 v115, v115
MV 152,a,140,v,44
ds_read_b128 a[208:211], v11 offset:20480
v_cvt_pk_bf16_f32 v112, v112, v113
v_mfma_f32_16x16x32_bf16 v[148:151], a[144:147], v[16:19], 0
ds_read_b128 a[212:215], v11 offset:21504
buffer_load_dwordx4 v12, s[56:59], s71 offen offset:1024 sc1 lds
v_mfma_f32_16x16x32_bf16 v[156:159], a[144:147], v[32:35], 0
v_exp_f32 v116, v116
MV 148,a,148,v,20
v_exp_f32 v117, v117
MV 156,a,148,v,36
ds_read_b128 a[216:219], v11 offset:22528
ds_read_b128 a[220:223], v11 offset:23552
MV 148,a,152,v,24
ds_read_b128 a[224:227], v11 offset:24576
v_cvt_pk_bf16_f32 v113, v114, v115
MV 156,a,152,v,40
v_exp_f32 v118, v118
MV 148,a,156,v,28
v_exp_f32 v119, v119
MV 156,a,156,v,44
ds_read_b128 a[228:231], v11 offset:25600
buffer_load_dwordx4 v12, s[56:59], s71 offen offset:2048 sc1 lds
v_mfma_f32_16x16x32_bf16 v[176:179], a[160:163], v[16:19], 0
ds_read_b128 a[232:235], v11 offset:26624
v_cvt_pk_bf16_f32 v114, v116, v117
v_mfma_f32_16x16x32_bf16 v[184:187], a[160:163], v[32:35], 0
v_exp_f32 v120, v120
MV 176,a,164,v,20
ds_read_b128 a[236:239], v11 offset:27648
ds_read_b128 a[240:243], v11 offset:28672
MV 184,a,164,v,36
v_exp_f32 v121, v121
MV 176,a,168,v,24
ds_read_b128 a[244:247], v11 offset:29696
v_cvt_pk_bf16_f32 v115, v118, v119
MV 184,a,168,v,40
ds_read_b128 a[248:251], v11 offset:30720
buffer_load_dwordx4 v12, s[56:59], s71 offen offset:3072 sc1 lds
MV 176,a,172,v,28
v_exp_f32 v122, v122
MV 184,a,172,v,44
v_exp_f32 v123, v123
v_mfma_f32_16x16x32_bf16 v[180:183], a[176:179], v[16:19], 0
ds_read_b128 a[252:255], v11 offset:31744
v_cvt_pk_bf16_f32 v120, v120, v121
v_mfma_f32_16x16x32_bf16 v[188:191], a[176:179], v[32:35], 0
v_exp_f32 v124, v124
MV 180,a,180,v,20
v_exp_f32 v125, v125
MV 188,a,180,v,36
s_add_u32 s71, s71, 16384
v_cvt_pk_bf16_f32 v121, v122, v123
MV 180,a,184,v,24
v_exp_f32 v126, v126
MV 188,a,184,v,40
v_exp_f32 v127, v127
MV 180,a,188,v,28
v_cvt_pk_bf16_f32 v122, v124, v125
v_cvt_pk_bf16_f32 v123, v126, v127
MV 188,a,188,v,44
s_waitcnt vmcnt(16) lgkmcnt(0)
MA 0,a,192,v,80
s_barrier
MA 32,a,192,v,88
s_add_u32 m0, s72, 0
ds_read_b128 a[128:131], v10 offset:16384
MA 4,a,196,v,80
v_exp_f32 v144, v144
MA 36,a,196,v,88
ds_read_b128 a[132:135], v10 offset:17408
buffer_load_dwordx4 v12, s[52:55], s71 offen offset:0 sc1 lds
MA 8,a,200,v,80
v_exp_f32 v145, v145
MA 40,a,200,v,88
ds_read_b128 a[136:139], v10 offset:18432
ds_read_b128 a[140:143], v10 offset:19456
MA 12,a,204,v,80
v_exp_f32 v146, v146
MA 44,a,204,v,88
v_exp_f32 v147, v147
MV 164,v,160,v,80
ds_read_b128 a[144:147], v10 offset:20480
buffer_load_dwordx4 v12, s[52:55], s71 offen offset:1024 sc1 lds
MV 168,v,160,v,88
ds_read_b128 a[148:151], v10 offset:21504
v_cvt_pk_bf16_f32 v144, v144, v145
MA 16,a,208,v,80
v_exp_f32 v148, v148
MA 48,a,208,v,88
ds_read_b128 a[152:155], v10 offset:22528
ds_read_b128 a[156:159], v10 offset:23552
MA 20,a,212,v,80
v_exp_f32 v149, v149
MA 52,a,212,v,88
ds_read_b128 a[160:163], v10 offset:24576
v_cvt_pk_bf16_f32 v145, v146, v147
MA 24,a,216,v,80
v_exp_f32 v150, v150
MA 56,a,216,v,88
ds_read_b128 a[164:167], v10 offset:25600
buffer_load_dwordx4 v12, s[52:55], s71 offen offset:2048 sc1 lds
MA 28,a,220,v,80
v_exp_f32 v151, v151
MA 60,a,220,v,88
ds_read_b128 a[168:171], v10 offset:26624
v_cvt_pk_bf16_f32 v146, v148, v149
MA 0,a,224,v,112
v_exp_f32 v152, v152
MA 32,a,224,v,120
ds_read_b128 a[172:175], v10 offset:27648
ds_read_b128 a[176:179], v10 offset:28672
MA 4,a,228,v,112
v_exp_f32 v153, v153
MA 36,a,228,v,120
ds_read_b128 a[180:183], v10 offset:29696
v_cvt_pk_bf16_f32 v147, v150, v151
MA 8,a,232,v,112
ds_read_b128 a[184:187], v10 offset:30720
buffer_load_dwordx4 v12, s[52:55], s71 offen offset:3072 sc1 lds
MA 40,a,232,v,120
v_exp_f32 v154, v154
MA 12,a,236,v,112
v_exp_f32 v155, v155
MA 44,a,236,v,120
ds_read_b128 a[188:191], v10 offset:31744
v_cvt_pk_bf16_f32 v152, v152, v153
MV 164,v,160,v,112
v_exp_f32 v156, v156
MV 168,v,160,v,120
MA 16,a,240,v,112
v_exp_f32 v157, v157
MA 48,a,240,v,120
s_sub_u32 s74, s74, 1
v_cvt_pk_bf16_f32 v153, v154, v155
MA 20,a,244,v,112
v_exp_f32 v158, v158
MA 52,a,244,v,120
MA 24,a,248,v,112
v_exp_f32 v159, v159
MA 56,a,248,v,120
MA 28,a,252,v,112
v_cvt_pk_bf16_f32 v154, v156, v157
v_cvt_pk_bf16_f32 v155, v158, v159
MA 60,a,252,v,120
s_cbranch_scc1 L_p3_s1m_top
s_waitcnt lgkmcnt(0)
v_xor_b32 v11, 0x8000, v11
v_mfma_f32_16x16x32_bf16 v[80:83], a[128:131], v[16:19], 0
s_add_u32 m0, s73, 16384
ds_read_b128 a[192:195], v11 offset:0
v_mfma_f32_16x16x32_bf16 v[88:91], a[128:131], v[32:35], 0
v_exp_f32 v176, v176
MV 80,a,132,v,20
ds_read_b128 a[196:199], v11 offset:1024
buffer_load_dwordx4 v12, s[56:59], s71 offen offset:0 sc1 lds
MV 88,a,132,v,36
v_exp_f32 v177, v177
MV 80,a,136,v,24
ds_read_b128 a[200:203], v11 offset:2048
ds_read_b128 a[204:207], v11 offset:3072
MV 88,a,136,v,40
v_exp_f32 v178, v178
MV 80,a,140,v,28
v_exp_f32 v179, v179
MV 88,a,140,v,44
ds_read_b128 a[208:211], v11 offset:4096
buffer_load_dwordx4 v12, s[56:59], s71 offen offset:1024 sc1 lds
v_mfma_f32_16x16x32_bf16 v[84:87], a[144:147], v[16:19], 0
ds_read_b128 a[212:215], v11 offset:5120
v_cvt_pk_bf16_f32 v176, v176, v177
v_mfma_f32_16x16x32_bf16 v[92:95], a[144:147], v[32:35], 0
v_exp_f32 v180, v180
MV 84,a,148,v,20
v_exp_f32 v181, v181
MV 92,a,148,v,36
ds_read_b128 a[216:219], v11 offset:6144
ds_read_b128 a[220:223], v11 offset:7168
MV 84,a,152,v,24
buffer_load_dwordx4 v12, s[56:59], s71 offen offset:2048 sc1 lds
v_cvt_pk_bf16_f32 v177, v178, v179
MV 92,a,152,v,40
v_exp_f32 v182, v182
MV 84,a,156,v,28
ds_read_b128 a[224:227], v11 offset:8192
ds_read_b128 a[228:231], v11 offset:9216
MV 92,a,156,v,44
v_exp_f32 v183, v183
v_mfma_f32_16x16x32_bf16 v[112:115], a[160:163], v[16:19], 0
ds_read_b128 a[232:235], v11 offset:10240
v_cvt_pk_bf16_f32 v178, v180, v181
v_mfma_f32_16x16x32_bf16 v[120:123], a[160:163], v[32:35], 0
v_exp_f32 v184, v184
MV 112,a,164,v,20
ds_read_b128 a[236:239], v11 offset:11264
buffer_load_dwordx4 v12, s[56:59], s71 offen offset:3072 sc1 lds
MV 120,a,164,v,36
v_exp_f32 v185, v185
MV 112,a,168,v,24
ds_read_b128 a[240:243], v11 offset:12288
v_cvt_pk_bf16_f32 v179, v182, v183
MV 120,a,168,v,40
ds_read_b128 a[244:247], v11 offset:13312
ds_read_b128 a[248:251], v11 offset:14336
MV 112,a,172,v,28
v_exp_f32 v186, v186
MV 120,a,172,v,44
v_exp_f32 v187, v187
v_mfma_f32_16x16x32_bf16 v[116:119], a[176:179], v[16:19], 0
ds_read_b128 a[252:255], v11 offset:15360
s_add_u32 s71, s71, 16384
v_mfma_f32_16x16x32_bf16 v[124:127], a[176:179], v[32:35], 0
s_xor_b32 s73, s73, 0x8000
v_cvt_pk_bf16_f32 v184, v184, v185
MV 116,a,180,v,20
v_exp_f32 v188, v188
MV 124,a,180,v,36
v_exp_f32 v189, v189
MV 116,a,184,v,24
v_cvt_pk_bf16_f32 v185, v186, v187
MV 124,a,184,v,40
v_exp_f32 v190, v190
MV 116,a,188,v,28
v_exp_f32 v191, v191
MV 124,a,188,v,44
v_cvt_pk_bf16_f32 v186, v188, v189
v_cvt_pk_bf16_f32 v187, v190, v191
s_waitcnt vmcnt(16) lgkmcnt(0)
MA 0,a,192,v,144
s_barrier
v_xor_b32 v10, 0x8000, v10
MA 32,a,192,v,152
s_add_u32 m0, s72, 16384
ds_read_b128 a[128:131], v10 offset:0
MA 4,a,196,v,144
v_exp_f32 v80, v80
MA 36,a,196,v,152
ds_read_b128 a[132:135], v10 offset:1024
buffer_load_dwordx4 v12, s[52:55], s71 offen offset:0 sc1 lds
MA 8,a,200,v,144
v_exp_f32 v81, v81
MA 40,a,200,v,152
ds_read_b128 a[136:139], v10 offset:2048
ds_read_b128 a[140:143], v10 offset:3072
MA 12,a,204,v,144
v_exp_f32 v82, v82
MA 44,a,204,v,152
ds_read_b128 a[144:147], v10 offset:4096
buffer_load_dwordx4 v12, s[52:55], s71 offen offset:1024 sc1 lds
MV 164,v,160,v,144
v_exp_f32 v83, v83
MV 168,v,160,v,152
ds_read_b128 a[148:151], v10 offset:5120
v_cvt_pk_bf16_f32 v80, v80, v81
MA 16,a,208,v,144
v_exp_f32 v84, v84
MA 48,a,208,v,152
ds_read_b128 a[152:155], v10 offset:6144
buffer_load_dwordx4 v12, s[52:55], s71 offen offset:2048 sc1 lds
MA 20,a,212,v,144
v_exp_f32 v85, v85
MA 52,a,212,v,152
ds_read_b128 a[156:159], v10 offset:7168
v_cvt_pk_bf16_f32 v81, v82, v83
MA 24,a,216,v,144
v_exp_f32 v86, v86
MA 56,a,216,v,152
ds_read_b128 a[160:163], v10 offset:8192
ds_read_b128 a[164:167], v10 offset:9216
MA 28,a,220,v,144
v_exp_f32 v87, v87
MA 60,a,220,v,152
buffer_load_dwordx4 v12, s[52:55], s71 offen offset:3072 sc1 lds
v_cvt_pk_bf16_f32 v82, v84, v85
MA 0,a,224,v,176
ds_read_b128 a[168:171], v10 offset:10240
ds_read_b128 a[172:175], v10 offset:11264
MA 32,a,224,v,184
v_exp_f32 v88, v88
MA 4,a,228,v,176
v_exp_f32 v89, v89
MA 36,a,228,v,184
ds_read_b128 a[176:179], v10 offset:12288
s_xor_b32 s72, s72, 0x8000
MA 8,a,232,v,176
ds_read_b128 a[180:183], v10 offset:13312
v_cvt_pk_bf16_f32 v83, v86, v87
MA 40,a,232,v,184
v_exp_f32 v90, v90
MA 12,a,236,v,176
ds_read_b128 a[184:187], v10 offset:14336
ds_read_b128 a[188:191], v10 offset:15360
MA 44,a,236,v,184
v_exp_f32 v91, v91
MV 164,v,160,v,176
buffer_store_dword v237, v236, s[8:11], s37 offen offset:1024 sc1
v_cvt_pk_bf16_f32 v88, v88, v89
MV 168,v,160,v,184
v_exp_f32 v92, v92
MA 16,a,240,v,176
v_exp_f32 v93, v93
MA 48,a,240,v,184
global_load_dword v174, v[172:173], off
v_cvt_pk_bf16_f32 v89, v90, v91
MA 20,a,244,v,176
v_exp_f32 v94, v94
MA 52,a,244,v,184
MA 24,a,248,v,176
v_exp_f32 v95, v95
MA 56,a,248,v,184
MA 28,a,252,v,176
v_cvt_pk_bf16_f32 v90, v92, v93
v_cvt_pk_bf16_f32 v91, v94, v95
MA 60,a,252,v,184
s_branch L_p3_s0_top
L_p3_s1m_top:
s_waitcnt lgkmcnt(0)
v_xor_b32 v11, 0x8000, v11
v_mfma_f32_16x16x32_bf16 v[80:83], a[128:131], v[16:19], 0
ds_read_b128 a[192:195], v11 offset:0
ds_read_b128 a[196:199], v11 offset:1024
v_mfma_f32_16x16x32_bf16 v[88:91], a[128:131], v[32:35], 0
v_exp_f32 v176, v176
MV 80,a,132,v,20
v_exp_f32 v177, v177
MV 88,a,132,v,36
ds_read_b128 a[200:203], v11 offset:2048
ds_read_b128 a[204:207], v11 offset:3072
MV 80,a,136,v,24
v_exp_f32 v178, v178
MV 88,a,136,v,40
v_exp_f32 v179, v179
MV 80,a,140,v,28
ds_read_b128 a[208:211], v11 offset:4096
v_cvt_pk_bf16_f32 v176, v176, v177
MV 88,a,140,v,44
ds_read_b128 a[212:215], v11 offset:5120
ds_read_b128 a[216:219], v11 offset:6144
v_mfma_f32_16x16x32_bf16 v[84:87], a[144:147], v[16:19], 0
v_exp_f32 v180, v180
v_mfma_f32_16x16x32_bf16 v[92:95], a[144:147], v[32:35], 0
v_exp_f32 v181, v181
MV 84,a,148,v,20
ds_read_b128 a[220:223], v11 offset:7168
v_cvt_pk_bf16_f32 v177, v178, v179
MV 92,a,148,v,36
v_exp_f32 v182, v182
MV 84,a,152,v,24
ds_read_b128 a[224:227], v11 offset:8192
ds_read_b128 a[228:231], v11 offset:9216
MV 92,a,152,v,40
v_exp_f32 v183, v183
MV 84,a,156,v,28
ds_read_b128 a[232:235], v11 offset:10240
v_cvt_pk_bf16_f32 v178, v180, v181
MV 92,a,156,v,44
v_exp_f32 v184, v184
v_mfma_f32_16x16x32_bf16 v[112:115], a[160:163], v[16:19], 0
ds_read_b128 a[236:239], v11 offset:11264
ds_read_b128 a[240:243], v11 offset:12288
v_mfma_f32_16x16x32_bf16 v[120:123], a[160:163], v[32:35], 0
v_exp_f32 v185, v185
MV 112,a,164,v,20
ds_read_b128 a[244:247], v11 offset:13312
v_cvt_pk_bf16_f32 v179, v182, v183
MV 120,a,164,v,36
v_exp_f32 v186, v186
MV 112,a,168,v,24
v_exp_f32 v187, v187
MV 120,a,168,v,40
ds_read_b128 a[248:251], v11 offset:14336
ds_read_b128 a[252:255], v11 offset:15360
MV 112,a,172,v,28
v_cvt_pk_bf16_f32 v184, v184, v185
v_add_u32 v246, 0, v13
MV 120,a,172,v,44
v_cmp_gt_i32_e64 s[84:85], 0, v246
v_cmp_gt_i32_e64 s[86:87], 1, v246
v_mfma_f32_16x16x32_bf16 v[116:119], a[176:179], v[16:19], 0
v_exp_f32 v188, v188
v_mfma_f32_16x16x32_bf16 v[124:127], a[176:179], v[32:35], 0
v_cmp_gt_i32_e64 s[88:89], 2, v246
v_cmp_gt_i32_e64 s[90:91], 3, v246
MV 116,a,180,v,20
v_cndmask_b32_e64 v80, v80, v14, s[84:85]
v_cndmask_b32_e64 v81, v81, v14, s[86:87]
MV 124,a,180,v,36
v_exp_f32 v189, v189
MV 116,a,184,v,24
v_cvt_pk_bf16_f32 v185, v186, v187
v_cndmask_b32_e64 v82, v82, v14, s[88:89]
MV 124,a,184,v,40
v_cndmask_b32_e64 v83, v83, v14, s[90:91]
v_add_u32 v247, -16, v13
MV 116,a,188,v,28
v_cmp_gt_i32_e64 s[92:93], 0, v247
v_cmp_gt_i32_e64 s[94:95], 1, v247
MV 124,a,188,v,44
v_exp_f32 v190, v190
v_exp_f32 v191, v191
v_cmp_gt_i32_e64 s[96:97], 2, v247
v_cmp_gt_i32_e64 s[98:99], 3, v247
v_cndmask_b32_e64 v84, v84, v14, s[92:93]
v_cvt_pk_bf16_f32 v186, v188, v189
v_cndmask_b32_e64 v85, v85, v14, s[94:95]
v_cndmask_b32_e64 v86, v86, v14, s[96:97]
v_cvt_pk_bf16_f32 v187, v190, v191
v_cndmask_b32_e64 v87, v87, v14, s[98:99]
s_waitcnt vmcnt(12) lgkmcnt(0)
MA 0,a,192,v,144
s_barrier
v_xor_b32 v10, 0x8000, v10
MA 32,a,192,v,152
ds_read_b128 a[128:131], v10 offset:0
ds_read_b128 a[132:135], v10 offset:1024
MA 4,a,196,v,144
v_exp_f32 v80, v80
MA 36,a,196,v,152
v_exp_f32 v81, v81
MA 8,a,200,v,144
ds_read_b128 a[136:139], v10 offset:2048
ds_read_b128 a[140:143], v10 offset:3072
MA 40,a,200,v,152
v_exp_f32 v82, v82
MA 12,a,204,v,144
v_exp_f32 v83, v83
MA 44,a,204,v,152
ds_read_b128 a[144:147], v10 offset:4096
v_add_u32 v246, -32, v13
MV 164,v,160,v,144
v_cvt_pk_bf16_f32 v80, v80, v81
v_cmp_gt_i32_e64 s[84:85], 0, v246
MV 168,v,160,v,152
v_exp_f32 v84, v84
MA 16,a,208,v,144
ds_read_b128 a[148:151], v10 offset:5120
v_cmp_gt_i32_e64 s[86:87], 1, v246
MA 48,a,208,v,152
ds_read_b128 a[152:155], v10 offset:6144
v_cmp_gt_i32_e64 s[88:89], 2, v246
MA 20,a,212,v,144
v_exp_f32 v85, v85
MA 52,a,212,v,152
ds_read_b128 a[156:159], v10 offset:7168
v_cvt_pk_bf16_f32 v81, v82, v83
MA 24,a,216,v,144
ds_read_b128 a[160:163], v10 offset:8192
v_cmp_gt_i32_e64 s[90:91], 3, v246
MA 56,a,216,v,152
v_exp_f32 v86, v86
MA 28,a,220,v,144
ds_read_b128 a[164:167], v10 offset:9216
v_cndmask_b32_e64 v112, v112, v14, s[84:85]
MA 60,a,220,v,152
v_exp_f32 v87, v87
MA 0,a,224,v,176
v_cvt_pk_bf16_f32 v82, v84, v85
v_cndmask_b32_e64 v113, v113, v14, s[86:87]
MA 32,a,224,v,184
ds_read_b128 a[168:171], v10 offset:10240
v_cndmask_b32_e64 v114, v114, v14, s[88:89]
MA 4,a,228,v,176
v_exp_f32 v88, v88
MA 36,a,228,v,184
ds_read_b128 a[172:175], v10 offset:11264
v_cndmask_b32_e64 v115, v115, v14, s[90:91]
MA 8,a,232,v,176
v_exp_f32 v89, v89
MA 40,a,232,v,184
ds_read_b128 a[176:179], v10 offset:12288
v_cvt_pk_bf16_f32 v83, v86, v87
MA 12,a,236,v,176
ds_read_b128 a[180:183], v10 offset:13312
v_add_u32 v247, -48, v13
MA 44,a,236,v,184
ds_read_b128 a[184:187], v10 offset:14336
v_cmp_gt_i32_e64 s[92:93], 0, v247
MV 164,v,160,v,176
v_exp_f32 v90, v90
MV 168,v,160,v,184
v_exp_f32 v91, v91
MA 16,a,240,v,176
ds_read_b128 a[188:191], v10 offset:15360
v_cmp_gt_i32_e64 s[94:95], 1, v247
MA 48,a,240,v,184
v_cvt_pk_bf16_f32 v88, v88, v89
v_cmp_gt_i32_e64 s[96:97], 2, v247
MA 20,a,244,v,176
v_exp_f32 v92, v92
MA 52,a,244,v,184
v_cmp_gt_i32_e64 s[98:99], 3, v247
v_cndmask_b32_e64 v116, v116, v14, s[92:93]
MA 24,a,248,v,176
v_exp_f32 v93, v93
MA 56,a,248,v,184
v_cvt_pk_bf16_f32 v89, v90, v91
v_cndmask_b32_e64 v117, v117, v14, s[94:95]
MA 28,a,252,v,176
v_exp_f32 v94, v94
MA 60,a,252,v,184
v_exp_f32 v95, v95
v_cndmask_b32_e64 v118, v118, v14, s[96:97]
v_cvt_pk_bf16_f32 v90, v92, v93
v_cndmask_b32_e64 v119, v119, v14, s[98:99]
v_cvt_pk_bf16_f32 v91, v94, v95
L_p3_s0m_top:
s_waitcnt lgkmcnt(0)
v_mfma_f32_16x16x32_bf16 v[152:155], a[128:131], v[32:35], 0
ds_read_b128 a[192:195], v11 offset:16384
ds_read_b128 a[196:199], v11 offset:17408
MV 152,a,132,v,36
v_exp_f32 v112, v112
MV 152,a,136,v,40
v_exp_f32 v113, v113
MV 152,a,140,v,44
ds_read_b128 a[200:203], v11 offset:18432
ds_read_b128 a[204:207], v11 offset:19456
v_mfma_f32_16x16x32_bf16 v[156:159], a[144:147], v[32:35], 0
v_exp_f32 v114, v114
MV 156,a,148,v,36
v_exp_f32 v115, v115
MV 156,a,152,v,40
ds_read_b128 a[208:211], v11 offset:20480
ds_read_b128 a[212:215], v11 offset:21504
MV 156,a,156,v,44
ds_read_b128 a[216:219], v11 offset:22528
v_cvt_pk_bf16_f32 v112, v112, v113
v_mfma_f32_16x16x32_bf16 v[184:187], a[160:163], v[32:35], 0
v_exp_f32 v116, v116
MV 184,a,164,v,36
v_exp_f32 v117, v117
MV 184,a,168,v,40
ds_read_b128 a[220:223], v11 offset:23552
v_cvt_pk_bf16_f32 v113, v114, v115
MV 184,a,172,v,44
v_exp_f32 v118, v118
v_mfma_f32_16x16x32_bf16 v[188:191], a[176:179], v[32:35], 0
ds_read_b128 a[224:227], v11 offset:24576
ds_read_b128 a[228:231], v11 offset:25600
MV 188,a,180,v,36
v_exp_f32 v119, v119
MV 188,a,184,v,40
ds_read_b128 a[232:235], v11 offset:26624
v_cvt_pk_bf16_f32 v114, v116, v117
MV 188,a,188,v,44
ds_read_b128 a[236:239], v11 offset:27648
ds_read_b128 a[240:243], v11 offset:28672
ds_read_b128 a[244:247], v11 offset:29696
ds_read_b128 a[248:251], v11 offset:30720
ds_read_b128 a[252:255], v11 offset:31744
v_exp_f32 v120, v120
v_exp_f32 v121, v121
v_cvt_pk_bf16_f32 v115, v118, v119
v_exp_f32 v122, v122
v_exp_f32 v123, v123
v_cvt_pk_bf16_f32 v120, v120, v121
v_exp_f32 v124, v124
v_exp_f32 v125, v125
v_cvt_pk_bf16_f32 v121, v122, v123
v_exp_f32 v126, v126
v_exp_f32 v127, v127
v_add_u32 v246, -64, v239
v_cmp_gt_i32_e64 s[84:85], 0, v246
v_cmp_gt_i32_e64 s[86:87], 1, v246
v_cmp_gt_i32_e64 s[88:89], 2, v246
v_cmp_gt_i32_e64 s[90:91], 3, v246
v_cndmask_b32_e64 v152, v152, v14, s[84:85]
v_cndmask_b32_e64 v153, v153, v14, s[86:87]
v_cndmask_b32_e64 v154, v154, v14, s[88:89]
v_cndmask_b32_e64 v155, v155, v14, s[90:91]
v_cvt_pk_bf16_f32 v122, v124, v125
v_cvt_pk_bf16_f32 v123, v126, v127
v_add_u32 v247, -80, v239
v_cmp_gt_i32_e64 s[92:93], 0, v247
v_cmp_gt_i32_e64 s[94:95], 1, v247
v_cmp_gt_i32_e64 s[96:97], 2, v247
v_cmp_gt_i32_e64 s[98:99], 3, v247
v_cndmask_b32_e64 v156, v156, v14, s[92:93]
v_cndmask_b32_e64 v157, v157, v14, s[94:95]
v_cndmask_b32_e64 v158, v158, v14, s[96:97]
v_cndmask_b32_e64 v159, v159, v14, s[98:99]
s_waitcnt vmcnt(4) lgkmcnt(0)
MA 0,a,192,v,80
s_barrier
MA 32,a,192,v,88
v_exp_f32 v152, v152
MA 4,a,196,v,80
v_lshlrev_b32 v245, 4, v1
s_mov_b32 m0, s43
MA 36,a,196,v,88
MA 8,a,200,v,80
v_exp_f32 v153, v153
MA 40,a,200,v,88
MA 12,a,204,v,80
v_add_u32 v246, -96, v239
v_cmp_gt_i32_e64 s[84:85], 0, v246
MA 44,a,204,v,88
MV 164,v,160,v,80
v_exp_f32 v154, v154
MV 168,v,160,v,88
s_nop 0
v_cmp_gt_i32_e64 s[86:87], 1, v246
MA 16,a,208,v,80
MA 48,a,208,v,88
v_exp_f32 v155, v155
MA 20,a,212,v,80
v_cmp_gt_i32_e64 s[88:89], 2, v246
v_cmp_gt_i32_e64 s[90:91], 3, v246
MA 52,a,212,v,88
MA 24,a,216,v,80
v_cvt_pk_bf16_f32 v152, v152, v153
v_cndmask_b32_e64 v184, v184, v14, s[84:85]
MA 56,a,216,v,88
MA 28,a,220,v,80
buffer_load_dwordx4 v245, s[20:23], 0 offen offset:0 sc1 lds
v_cndmask_b32_e64 v185, v185, v14, s[86:87]
MA 60,a,220,v,88
v_exp_f32 v156, v156
MA 0,a,224,v,112
v_cndmask_b32_e64 v186, v186, v14, s[88:89]
v_cndmask_b32_e64 v187, v187, v14, s[90:91]
MA 32,a,224,v,120
MA 4,a,228,v,112
v_exp_f32 v157, v157
MA 36,a,228,v,120
buffer_load_dwordx4 v245, s[20:23], 0 offen offset:1024 sc1 lds
v_add_u32 v247, -112, v239
MA 8,a,232,v,112
v_cvt_pk_bf16_f32 v153, v154, v155
v_cmp_gt_i32_e64 s[92:93], 0, v247
MA 40,a,232,v,120
MA 12,a,236,v,112
buffer_load_dwordx4 v245, s[20:23], 0 offen offset:2048 sc1 lds
v_cmp_gt_i32_e64 s[94:95], 1, v247
MA 44,a,236,v,120
v_exp_f32 v158, v158
MV 164,v,160,v,112
v_cmp_gt_i32_e64 s[96:97], 2, v247
v_cmp_gt_i32_e64 s[98:99], 3, v247
MV 168,v,160,v,120
MA 16,a,240,v,112
MA 48,a,240,v,120
v_exp_f32 v159, v159
MA 20,a,244,v,112
buffer_load_dwordx4 v245, s[20:23], 0 offen offset:3072 sc1 lds
v_cndmask_b32_e64 v188, v188, v14, s[92:93]
MA 52,a,244,v,120
v_cvt_pk_bf16_f32 v154, v156, v157
v_cndmask_b32_e64 v189, v189, v14, s[94:95]
MA 24,a,248,v,112
v_cvt_pk_bf16_f32 v155, v158, v159
v_cndmask_b32_e64 v190, v190, v14, s[96:97]
MA 56,a,248,v,120
MA 28,a,252,v,112
v_cndmask_b32_e64 v191, v191, v14, s[98:99]
MA 60,a,252,v,120
s_load_dwordx2 s[88:89], s[0:1], 104
s_waitcnt lgkmcnt(0)
v_xor_b32 v11, 0x8000, v11
ds_read_b128 a[192:195], v11 offset:0
ds_read_b128 a[196:199], v11 offset:1024
ds_read_b128 a[200:203], v11 offset:2048
ds_read_b128 a[204:207], v11 offset:3072
ds_read_b128 a[208:211], v11 offset:4096
ds_read_b128 a[212:215], v11 offset:5120
ds_read_b128 a[216:219], v11 offset:6144
ds_read_b128 a[220:223], v11 offset:7168
ds_read_b128 a[224:227], v11 offset:8192
ds_read_b128 a[228:231], v11 offset:9216
ds_read_b128 a[232:235], v11 offset:10240
ds_read_b128 a[236:239], v11 offset:11264
ds_read_b128 a[240:243], v11 offset:12288
ds_read_b128 a[244:247], v11 offset:13312
ds_read_b128 a[248:251], v11 offset:14336
ds_read_b128 a[252:255], v11 offset:15360
v_exp_f32 v184, v184
v_exp_f32 v185, v185
v_exp_f32 v186, v186
v_exp_f32 v187, v187
v_cvt_pk_bf16_f32 v184, v184, v185
v_exp_f32 v188, v188
v_exp_f32 v189, v189
v_cvt_pk_bf16_f32 v185, v186, v187
v_exp_f32 v190, v190
v_exp_f32 v191, v191
v_cvt_pk_bf16_f32 v186, v188, v189
v_cvt_pk_bf16_f32 v187, v190, v191
MV 168,v,160,v,152
s_nop 0
MV 168,v,160,v,184
v_mov_b32 v240, v2
v_mov_b32 v241, v3
s_nop 0
v_permlane32_swap_b32 v2, v240
v_permlane32_swap_b32 v3, v241
v_add_f32 v2, v2, v240
v_add_f32 v3, v3, v241
v_mov_b32 v240, v2
v_mov_b32 v241, v3
s_nop 0
v_permlane16_swap_b32 v2, v240
v_permlane16_swap_b32 v3, v241
v_add_f32 v2, v2, v240
v_add_f32 v3, v3, v241
v_add_f32 v2, v2, v164
v_cmp_nle_f32 vcc, 0x30800000, v2
s_nop 0
s_or_b64 s[78:79], s[78:79], vcc
v_cmp_nge_f32 vcc, 0x4e800000, v2
s_nop 0
s_or_b64 s[78:79], s[78:79], vcc
v_add_f32 v3, v3, v168
v_cmp_nle_f32 vcc, 0x30800000, v3
s_nop 0
s_or_b64 s[78:79], s[78:79], vcc
v_cmp_nge_f32 vcc, 0x4e800000, v3
s_nop 0
s_or_b64 s[78:79], s[78:79], vcc
s_cmp_lg_u64 s[78:79], 0
s_cselect_b32 s80, 1, 0
v_mov_b32 v240, s80
s_lshl_b32 s80, s3, 2
s_add_u32 s80, s80, 163824
v_mov_b32 v241, s80
ds_write_b32 v241, v240
v_mov_b32 v241, 163824
s_waitcnt vmcnt(0) lgkmcnt(0)
s_barrier
ds_read_b128 v[244:247], v241
buffer_store_dword v237, v236, s[8:11], s37 offen offset:1024 sc1
MA 32,a,192,v,152
MA 36,a,196,v,152
MA 40,a,200,v,152
MA 44,a,204,v,152
MA 48,a,208,v,152
MA 52,a,212,v,152
s_waitcnt lgkmcnt(0)
v_or3_b32 v240, v244, v245, v246
v_or_b32 v240, v240, v247
MA 56,a,216,v,152
v_cmp_ne_u32 vcc, 0, v240
MA 60,a,220,v,152
MA 32,a,224,v,184
s_cbranch_vccnz L_fallback
MA 36,a,228,v,184
s_mul_i32 s36, s3, 8320
v_and_b32 v16, 15, v1
MA 40,a,232,v,184
v_lshrrev_b32 v17, 4, v1
v_add_u32 v18, 1, v16
MA 44,a,236,v,184
v_and_b32 v19, 1, v18
v_mul_u32_u24 v19, 4160, v19
MA 48,a,240,v,184
v_add_u32 v18, 2, v16
v_lshrrev_b32 v18, 1, v18
MA 52,a,244,v,184
v_lshl_add_u32 v19, v18, 2, v19
v_lshl_add_u32 v19, v17, 4, v19
MA 56,a,248,v,184
v_add_u32 v40, s36, v19
v_add_u32 v41, 1024, v40
MA 60,a,252,v,184
v_add_u32 v42, 2048, v40
v_add_u32 v43, 3072, v40
v_add_u32 v10, s36, v232
v_lshlrev_b32 v18, 5, v16
v_lshlrev_b32 v19, 4, v17
v_sub_u32 v19, v19, v18
s_add_u32 s37, s43, 480
v_add_u32 v5, s37, v19
v_mov_b32 v20, 0
v_mov_b32 v21, 0
v_mov_b32 v22, 0
v_mov_b32 v23, 0
v_and_b32 v16, 1, v1
v_mul_u32_u24 v16, 4160, v16
v_and_b32 v17, 2, v1
v_lshl_add_u32 v16, v17, 3, v16
v_add_u32 v16, s36, v16
ds_write_b128 v16, v[20:23]
v_and_b32 v17, 31, v1
v_lshlrev_b32 v17, 4, v17
v_add_u32 v17, s43, v17
ds_write_b128 v17, v[20:23] offset:4096
ds_write_b128 v10, v[210:213] offset:32
v_alignbit_b32 v24, v210, v209, 16
v_alignbit_b32 v25, v211, v210, 16
v_alignbit_b32 v26, v212, v211, 16
v_alignbit_b32 v27, v213, v212, 16
ds_write_b128 v10, v[24:27] offset:4192
ds_write_b128 v10, v[216:219] offset:1056
v_alignbit_b32 v28, v216, v215, 16
v_alignbit_b32 v29, v217, v216, 16
v_alignbit_b32 v30, v218, v217, 16
v_alignbit_b32 v31, v219, v218, 16
ds_write_b128 v10, v[28:31] offset:5216
ds_write_b128 v10, v[222:225] offset:2080
v_alignbit_b32 v24, v222, v221, 16
v_alignbit_b32 v25, v223, v222, 16
v_alignbit_b32 v26, v224, v223, 16
v_alignbit_b32 v27, v225, v224, 16
ds_write_b128 v10, v[24:27] offset:6240
ds_write_b128 v10, v[228:231] offset:3104
v_alignbit_b32 v28, v228, v227, 16
v_alignbit_b32 v29, v229, v228, 16
v_alignbit_b32 v30, v230, v229, 16
v_alignbit_b32 v31, v231, v230, 16
ds_write_b128 v10, v[28:31] offset:7264
v_rcp_f32 v2, v2
v_rcp_f32 v3, v3
s_add_u32 s80, s100, s76
s_nop 4
v_accvgpr_read_b32 v240, a0
v_accvgpr_read_b32 v241, a1
v_accvgpr_read_b32 v242, a2
v_accvgpr_read_b32 v243, a3
v_accvgpr_read_b32 v244, a4
v_accvgpr_read_b32 v245, a5
v_accvgpr_read_b32 v246, a6
v_accvgpr_read_b32 v247, a7
v_mul_f32 v240, v240, v2
v_mul_f32 v241, v241, v2
v_mul_f32 v242, v242, v2
v_mul_f32 v243, v243, v2
v_mul_f32 v244, v244, v2
v_mul_f32 v245, v245, v2
v_mul_f32 v246, v246, v2
v_mul_f32 v247, v247, v2
v_cvt_pk_bf16_f32 v248, v240, v241
v_cvt_pk_bf16_f32 v249, v242, v243
v_cvt_pk_bf16_f32 v250, v244, v245
v_cvt_pk_bf16_f32 v251, v246, v247
buffer_store_dwordx4 v[248:251], v15, s[60:63], s100 offen offset:0 sc1
v_accvgpr_read_b32 v240, a8
v_accvgpr_read_b32 v241, a9
v_accvgpr_read_b32 v242, a10
v_accvgpr_read_b32 v243, a11
v_accvgpr_read_b32 v244, a12
v_accvgpr_read_b32 v245, a13
v_accvgpr_read_b32 v246, a14
v_accvgpr_read_b32 v247, a15
v_mul_f32 v240, v240, v2
v_mul_f32 v241, v241, v2
v_mul_f32 v242, v242, v2
v_mul_f32 v243, v243, v2
v_mul_f32 v244, v244, v2
v_mul_f32 v245, v245, v2
v_mul_f32 v246, v246, v2
v_mul_f32 v247, v247, v2
v_cvt_pk_bf16_f32 v252, v240, v241
v_cvt_pk_bf16_f32 v253, v242, v243
v_cvt_pk_bf16_f32 v254, v244, v245
v_cvt_pk_bf16_f32 v255, v246, v247
buffer_store_dwordx4 v[252:255], v15, s[60:63], s100 offen offset:1024 sc1
v_accvgpr_read_b32 v240, a16
v_accvgpr_read_b32 v241, a17
v_accvgpr_read_b32 v242, a18
v_accvgpr_read_b32 v243, a19
v_accvgpr_read_b32 v244, a20
v_accvgpr_read_b32 v245, a21
v_accvgpr_read_b32 v246, a22
v_accvgpr_read_b32 v247, a23
v_mul_f32 v240, v240, v2
v_mul_f32 v241, v241, v2
v_mul_f32 v242, v242, v2
v_mul_f32 v243, v243, v2
v_mul_f32 v244, v244, v2
v_mul_f32 v245, v245, v2
v_mul_f32 v246, v246, v2
v_mul_f32 v247, v247, v2
v_cvt_pk_bf16_f32 v248, v240, v241
v_cvt_pk_bf16_f32 v249, v242, v243
v_cvt_pk_bf16_f32 v250, v244, v245
v_cvt_pk_bf16_f32 v251, v246, v247
buffer_store_dwordx4 v[248:251], v15, s[60:63], s100 offen offset:2048 sc1
v_accvgpr_read_b32 v240, a24
v_accvgpr_read_b32 v241, a25
v_accvgpr_read_b32 v242, a26
v_accvgpr_read_b32 v243, a27
v_accvgpr_read_b32 v244, a28
v_accvgpr_read_b32 v245, a29
v_accvgpr_read_b32 v246, a30
v_accvgpr_read_b32 v247, a31
v_mul_f32 v240, v240, v2
v_mul_f32 v241, v241, v2
v_mul_f32 v242, v242, v2
v_mul_f32 v243, v243, v2
v_mul_f32 v244, v244, v2
v_mul_f32 v245, v245, v2
v_mul_f32 v246, v246, v2
v_mul_f32 v247, v247, v2
v_cvt_pk_bf16_f32 v252, v240, v241
v_cvt_pk_bf16_f32 v253, v242, v243
v_cvt_pk_bf16_f32 v254, v244, v245
v_cvt_pk_bf16_f32 v255, v246, v247
buffer_store_dwordx4 v[252:255], v15, s[60:63], s100 offen offset:3072 sc1
v_accvgpr_read_b32 v240, a32
v_accvgpr_read_b32 v241, a33
v_accvgpr_read_b32 v242, a34
v_accvgpr_read_b32 v243, a35
v_accvgpr_read_b32 v244, a36
v_accvgpr_read_b32 v245, a37
v_accvgpr_read_b32 v246, a38
v_accvgpr_read_b32 v247, a39
v_mul_f32 v240, v240, v3
v_mul_f32 v241, v241, v3
v_mul_f32 v242, v242, v3
v_mul_f32 v243, v243, v3
v_mul_f32 v244, v244, v3
v_mul_f32 v245, v245, v3
v_mul_f32 v246, v246, v3
v_mul_f32 v247, v247, v3
v_cvt_pk_bf16_f32 v248, v240, v241
v_cvt_pk_bf16_f32 v249, v242, v243
v_cvt_pk_bf16_f32 v250, v244, v245
v_cvt_pk_bf16_f32 v251, v246, v247
buffer_store_dwordx4 v[248:251], v15, s[60:63], s80 offen offset:0 sc1
v_accvgpr_read_b32 v240, a40
v_accvgpr_read_b32 v241, a41
v_accvgpr_read_b32 v242, a42
v_accvgpr_read_b32 v243, a43
v_accvgpr_read_b32 v244, a44
v_accvgpr_read_b32 v245, a45
v_accvgpr_read_b32 v246, a46
v_accvgpr_read_b32 v247, a47
v_mul_f32 v240, v240, v3
v_mul_f32 v241, v241, v3
v_mul_f32 v242, v242, v3
v_mul_f32 v243, v243, v3
v_mul_f32 v244, v244, v3
v_mul_f32 v245, v245, v3
v_mul_f32 v246, v246, v3
v_mul_f32 v247, v247, v3
v_cvt_pk_bf16_f32 v252, v240, v241
v_cvt_pk_bf16_f32 v253, v242, v243
v_cvt_pk_bf16_f32 v254, v244, v245
v_cvt_pk_bf16_f32 v255, v246, v247
buffer_store_dwordx4 v[252:255], v15, s[60:63], s80 offen offset:1024 sc1
v_accvgpr_read_b32 v240, a48
v_accvgpr_read_b32 v241, a49
v_accvgpr_read_b32 v242, a50
v_accvgpr_read_b32 v243, a51
v_accvgpr_read_b32 v244, a52
v_accvgpr_read_b32 v245, a53
v_accvgpr_read_b32 v246, a54
v_accvgpr_read_b32 v247, a55
v_mul_f32 v240, v240, v3
v_mul_f32 v241, v241, v3
v_mul_f32 v242, v242, v3
v_mul_f32 v243, v243, v3
v_mul_f32 v244, v244, v3
v_mul_f32 v245, v245, v3
v_mul_f32 v246, v246, v3
v_mul_f32 v247, v247, v3
v_cvt_pk_bf16_f32 v248, v240, v241
v_cvt_pk_bf16_f32 v249, v242, v243
v_cvt_pk_bf16_f32 v250, v244, v245
v_cvt_pk_bf16_f32 v251, v246, v247
buffer_store_dwordx4 v[248:251], v15, s[60:63], s80 offen offset:2048 sc1
v_accvgpr_read_b32 v240, a56
v_accvgpr_read_b32 v241, a57
v_accvgpr_read_b32 v242, a58
v_accvgpr_read_b32 v243, a59
v_accvgpr_read_b32 v244, a60
v_accvgpr_read_b32 v245, a61
v_accvgpr_read_b32 v246, a62
v_accvgpr_read_b32 v247, a63
v_mul_f32 v240, v240, v3
v_mul_f32 v241, v241, v3
v_mul_f32 v242, v242, v3
v_mul_f32 v243, v243, v3
v_mul_f32 v244, v244, v3
v_mul_f32 v245, v245, v3
v_mul_f32 v246, v246, v3
v_mul_f32 v247, v247, v3
v_cvt_pk_bf16_f32 v252, v240, v241
v_cvt_pk_bf16_f32 v253, v242, v243
v_cvt_pk_bf16_f32 v254, v244, v245
v_cvt_pk_bf16_f32 v255, v246, v247
buffer_store_dwordx4 v[252:255], v15, s[60:63], s80 offen offset:3072 sc1
L_p3_done:
s_waitcnt lgkmcnt(0)
ds_read_b128 a[160:163], v5 offset:3584
ds_read2_b32 a[128:129], v40 offset0:0 offset1:1
ds_read2_b32 a[130:131], v40 offset0:2 offset1:3
ds_read_b128 a[164:167], v5 offset:3072
ds_read2_b32 a[132:133], v40 offset0:128 offset1:129
ds_read2_b32 a[134:135], v40 offset0:130 offset1:131
ds_read_b128 a[168:171], v5 offset:2560
ds_read2_b32 a[136:137], v41 offset0:0 offset1:1
ds_read2_b32 a[138:139], v41 offset0:2 offset1:3
ds_read_b128 a[172:175], v5 offset:2048
ds_read2_b32 a[140:141], v41 offset0:128 offset1:129
ds_read2_b32 a[142:143], v41 offset0:130 offset1:131
ds_read_b128 a[176:179], v5 offset:1536
ds_read2_b32 a[144:145], v42 offset0:0 offset1:1
ds_read2_b32 a[146:147], v42 offset0:2 offset1:3
ds_read_b128 a[180:183], v5 offset:1024
ds_read2_b32 a[148:149], v42 offset0:128 offset1:129
ds_read2_b32 a[150:151], v42 offset0:130 offset1:131
ds_read_b128 a[184:187], v5 offset:512
ds_read2_b32 a[152:153], v43 offset0:0 offset1:1
ds_read2_b32 a[154:155], v43 offset0:2 offset1:3
ds_read_b128 a[188:191], v5 offset:0
ds_read2_b32 a[156:157], v43 offset0:128 offset1:129
ds_read2_b32 a[158:159], v43 offset0:130 offset1:131
v_lshlrev_b32 v255, 20, v1
v_mov_b32 v253, 1
s_lshl_b32 s83, s3, 8
s_add_u32 s83, s83, s2
s_lshl_b32 s83, s83, 2
s_add_u32 s83, s83, 4096
s_waitcnt lgkmcnt(15)
v_mfma_f32_16x16x32_bf16 v[76:79], a[128:131], a[160:163], 0
v_and_b32 v16, 15, v1
v_lshrrev_b32 v17, 4, v1
v_mfma_f32_16x16x32_bf16 v[80:83], a[128:131], a[164:167], 0
v_lshl_add_u32 v18, v17, 3, v16
ds_read_b128 a[224:227], v5 offset:3648
v_mfma_f32_16x16x32_bf16 v[84:87], a[128:131], a[168:171], 0
v_sub_u32 v235, 15, v18
ds_read2_b32 a[192:193], v40 offset0:16 offset1:17
s_waitcnt lgkmcnt(15)
v_mfma_f32_16x16x32_bf16 v[88:91], a[128:131], a[172:175], 0
v_lshlrev_b32 v18, 16, v234
ds_read2_b32 a[194:195], v40 offset0:18 offset1:19
s_waitcnt lgkmcnt(14)
v_mfma_f32_16x16x32_bf16 v[92:95], a[128:131], a[176:179], 0
v_cmp_eq_u32 vcc, 0, v235
v_cmp_eq_u32_e64 s[38:39], 1, v235
s_waitcnt lgkmcnt(11)
v_mfma_f32_16x16x32_bf16 v[96:99], a[128:131], a[180:183], 0
ds_read_b128 a[228:231], v5 offset:3136
ds_read2_b32 a[196:197], v40 offset0:144 offset1:145
s_waitcnt lgkmcnt(10)
v_mfma_f32_16x16x32_bf16 v[100:103], a[128:131], a[184:187], 0
s_nop 0
v_cndmask_b32 v44, 0, v234, vcc
s_waitcnt lgkmcnt(7)
v_mfma_f32_16x16x32_bf16 v[104:107], a[128:131], a[188:191], 0
ds_read2_b32 a[198:199], v40 offset0:146 offset1:147
ds_read_b128 a[232:235], v5 offset:2624
MV 80,a,132,a,160
v_cndmask_b32_e64 v44, v44, v18, s[38:39]
ds_read2_b32 a[200:201], v41 offset0:16 offset1:17
MV 84,a,132,a,164
v_cmp_eq_u32 vcc, 2, v235
v_cmp_eq_u32_e64 s[38:39], 3, v235
MV 88,a,132,a,168
ds_read2_b32 a[202:203], v41 offset0:18 offset1:19
s_and_b32 s81, s2, 3
MV 92,a,132,a,172
s_nop 0
v_cndmask_b32 v45, 0, v234, vcc
MV 96,a,132,a,176
ds_read_b128 a[236:239], v5 offset:2112
ds_read2_b32 a[204:205], v41 offset0:144 offset1:145
MV 100,a,132,a,180
v_cndmask_b32_e64 v45, v45, v18, s[38:39]
ds_read2_b32 a[206:207], v41 offset0:146 offset1:147
MV 104,a,132,a,184
v_cmp_eq_u32 vcc, 4, v235
v_cmp_eq_u32_e64 s[38:39], 5, v235
MV 84,a,136,a,160
ds_read_b128 a[240:243], v5 offset:1600
s_lshl_b32 s81, s81, 1
MV 88,a,136,a,164
s_nop 0
v_cndmask_b32 v46, 0, v234, vcc
MV 92,a,136,a,168
ds_read2_b32 a[208:209], v42 offset0:16 offset1:17
ds_read2_b32 a[210:211], v42 offset0:18 offset1:19
MV 96,a,136,a,172
v_cndmask_b32_e64 v46, v46, v18, s[38:39]
ds_read_b128 a[244:247], v5 offset:1088
MV 100,a,136,a,176
v_cmp_eq_u32 vcc, 6, v235
v_cmp_eq_u32_e64 s[38:39], 7, v235
MV 104,a,136,a,180
ds_read2_b32 a[212:213], v42 offset0:144 offset1:145
s_sub_u32 s74, 14, s81
MV 88,a,140,a,160
s_nop 0
v_cndmask_b32 v47, 0, v234, vcc
MV 92,a,140,a,164
ds_read2_b32 a[214:215], v42 offset0:146 offset1:147
ds_read_b128 a[248:251], v5 offset:576
MV 96,a,140,a,168
v_cndmask_b32_e64 v47, v47, v18, s[38:39]
ds_read2_b32 a[216:217], v43 offset0:16 offset1:17
MV 100,a,140,a,172
s_bitcmp1_b32 s2, 4
s_cselect_b32 s81, s74, s81
MV 104,a,140,a,176
ds_read2_b32 a[218:219], v43 offset0:18 offset1:19
s_bfe_u32 s74, s2, 0x10003
MV 92,a,144,a,160
ds_read_b128 a[252:255], v5 offset:64
s_add_u32 s81, s81, s74
MV 96,a,144,a,164
ds_read2_b32 a[220:221], v43 offset0:144 offset1:145
s_bfe_u32 s82, s2, 0x10002
MV 100,a,144,a,168
ds_read2_b32 a[222:223], v43 offset0:146 offset1:147
s_lshr_b32 s74, s2, 5
MV 104,a,144,a,172
s_lshl_b32 s74, s74, 1
s_add_u32 s82, s82, s74
MV 96,a,148,a,160
s_mov_b32 s72, s81
s_mov_b32 s73, s82
MV 100,a,148,a,164
s_lshl_b32 s74, s72, 2
s_add_u32 s74, s74, s3
MV 104,a,148,a,168
s_lshl_b32 s68, s74, 18
MV 100,a,152,a,160
MV 104,a,152,a,164
s_and_b32 s80, s73, 1
s_waitcnt lgkmcnt(15)
MV 104,a,156,a,160
MV 76,v,44,a,160
s_lshl_b32 s75, s80, 16
MV 80,v,44,a,164
MV 84,v,44,a,168
s_add_u32 s68, s68, s75
MV 88,v,44,a,172
MV 92,v,44,a,176
s_lshl_b32 s69, s73, 19
MV 96,v,44,a,180
MV 100,v,44,a,184
MV 104,v,44,a,188
s_waitcnt vmcnt(0)
buffer_store_dword v253, v255, s[8:11], s83 offen sc1
MV 76,a,192,a,224
ds_read_b128 a[160:163], v5 offset:3712
s_lshl_b32 s75, s73, 7
MV 80,a,192,a,228
ds_read2_b32 a[128:129], v40 offset0:32 offset1:33
s_lshl_b32 s70, s3, 12
MV 84,a,192,a,232
ds_read2_b32 a[130:131], v40 offset0:34 offset1:35
s_lshl_b32 s78, s74, 16
s_waitcnt lgkmcnt(15)
MV 88,a,192,a,236
ds_read_b128 a[164:167], v5 offset:3200
s_add_u32 s78, s78, s75
s_waitcnt lgkmcnt(15)
MV 92,a,192,a,240
s_lshl_b32 s79, s73, 18
s_lshl_b32 s75, s74, 8
s_waitcnt lgkmcnt(12)
MV 96,a,192,a,244
ds_read2_b32 a[132:133], v40 offset0:160 offset1:161
s_add_u32 s79, s79, s75
s_waitcnt lgkmcnt(10)
MV 100,a,192,a,248
ds_read2_b32 a[134:135], v40 offset0:162 offset1:163
v_lshlrev_b32 v236, 4, v1
s_waitcnt lgkmcnt(8)
MV 104,a,192,a,252
ds_read_b128 a[168:171], v5 offset:2688
v_add_u32 v237, 0x20000, v236
MV 80,a,196,a,224
ds_read2_b32 a[136:137], v41 offset0:32 offset1:33
v_add_u32 v238, s70, v236
MV 84,a,196,a,228
s_lshl_b32 s75, s80, 12
v_add_u32 v244, s75, v236
MV 88,a,196,a,232
ds_read2_b32 a[138:139], v41 offset0:34 offset1:35
v_xor_b32 v245, 0x1000, v244
MV 92,a,196,a,236
ds_read_b128 a[172:175], v5 offset:2176
v_add_u32 v242, 66560, v244
MV 96,a,196,a,240
ds_read2_b32 a[140:141], v41 offset0:160 offset1:161
v_add_u32 v243, 66560, v245
MV 100,a,196,a,244
ds_read2_b32 a[142:143], v41 offset0:162 offset1:163
v_bfe_u32 v50, v1, 4, 1
MV 104,a,196,a,248
v_lshrrev_b32 v52, 5, v1
v_and_b32 v48, 15, v1
MV 84,a,200,a,224
ds_read_b128 a[176:179], v5 offset:1664
v_lshlrev_b32 v53, 5, v50
MV 88,a,200,a,228
ds_read2_b32 a[144:145], v42 offset0:32 offset1:33
v_lshl_add_u32 v53, v52, 4, v53
MV 92,a,200,a,232
ds_read2_b32 a[146:147], v42 offset0:34 offset1:35
v_lshl_add_u32 v250, v48, 11, v53
MV 96,a,200,a,236
ds_read_b128 a[180:183], v5 offset:1152
v_lshlrev_b32 v53, 11, v53
MV 100,a,200,a,240
v_lshl_add_u32 v251, v48, 3, v53
MV 104,a,200,a,244
ds_read2_b32 a[148:149], v42 offset0:160 offset1:161
MV 88,a,204,a,224
ds_read2_b32 a[150:151], v42 offset0:162 offset1:163
MV 92,a,204,a,228
ds_read_b128 a[184:187], v5 offset:640
MV 96,a,204,a,232
ds_read2_b32 a[152:153], v43 offset0:32 offset1:33
MV 100,a,204,a,236
s_add_u32 s44, s40, 33554432
s_addc_u32 s45, s41, 0
MV 104,a,204,a,240
ds_read2_b32 a[154:155], v43 offset0:34 offset1:35
s_mov_b32 s46, 16777216
MV 92,a,208,a,224
ds_read_b128 a[188:191], v5 offset:128
s_mov_b32 s47, 0x20000
MV 96,a,208,a,228
ds_read2_b32 a[156:157], v43 offset0:160 offset1:161
MV 100,a,208,a,232
ds_read2_b32 a[158:159], v43 offset0:162 offset1:163
MV 104,a,208,a,236
s_add_u32 s48, s40, 100663296
s_addc_u32 s49, s41, 0
MV 96,a,212,a,224
s_mov_b32 s50, 8388608
s_mov_b32 s51, 0x20000
MV 100,a,212,a,228
s_add_u32 s52, s40, 109051904
s_addc_u32 s53, s41, 0
MV 104,a,212,a,232
s_mov_b32 s54, 4194304
s_mov_b32 s55, 0x20000
MV 100,a,216,a,224
s_add_u32 s56, s40, 54525952
s_addc_u32 s57, s41, 0
MV 104,a,216,a,228
s_mov_b32 s58, 4194304
s_mov_b32 s59, 0x20000
s_waitcnt lgkmcnt(15)
MV 104,a,220,a,224
s_mov_b32 s60, s88
s_mov_b32 s61, s89
s_mov_b32 s62, 4194304
s_mov_b32 s63, 0x20000
s_lshr_b32 s36, s82, 1
s_lshl_b32 s37, s80, 7
s_add_u32 s36, s36, s37
v_lshl_add_u32 v254, v1, 3, s36
s_xor_b32 s36, s2, 4
v_mov_b32 v253, s36
v_cmp_lt_u32 vcc, 15, v1
s_nop 1
v_cndmask_b32 v254, v254, v253, vcc
v_lshlrev_b32 v254, 2, v254
buffer_load_dword v253, v254, s[8:11], 0 offen offset:1024 sc1
MV 76,a,128,a,160
ds_read_b128 a[224:227], v5 offset:3776
s_sub_u32 s36, 15, s81
MV 80,a,128,a,164
ds_read2_b32 a[192:193], v40 offset0:48 offset1:49
s_min_u32 s36, s36, s81
MV 84,a,128,a,168
ds_read2_b32 a[194:195], v40 offset0:50 offset1:51
s_waitcnt lgkmcnt(15)
MV 88,a,128,a,172
ds_read_b128 a[228:231], v5 offset:3264
s_lshr_b32 s37, s36, 1
s_waitcnt lgkmcnt(15)
MV 92,a,128,a,176
s_waitcnt lgkmcnt(12)
MV 96,a,128,a,180
ds_read2_b32 a[196:197], v40 offset0:176 offset1:177
s_xor_b32 s36, s36, s37
s_waitcnt lgkmcnt(10)
MV 100,a,128,a,184
ds_read2_b32 a[198:199], v40 offset0:178 offset1:179
s_and_b32 s36, s36, 1
s_waitcnt lgkmcnt(8)
MV 104,a,128,a,188
ds_read_b128 a[232:235], v5 offset:2752
MV 80,a,132,a,160
ds_read2_b32 a[200:201], v41 offset0:48 offset1:49
s_lshl_b32 s37, s37, 6
MV 84,a,132,a,164
MV 88,a,132,a,168
ds_read2_b32 a[202:203], v41 offset0:50 offset1:51
s_add_u32 s36, s36, s37
MV 92,a,132,a,172
ds_read_b128 a[236:239], v5 offset:2240
s_lshl_b32 s37, s80, 2
MV 96,a,132,a,176
ds_read2_b32 a[204:205], v41 offset0:176 offset1:177
MV 100,a,132,a,180
ds_read2_b32 a[206:207], v41 offset0:178 offset1:179
s_add_u32 s36, s36, s37
MV 104,a,132,a,184
MV 84,a,136,a,160
ds_read_b128 a[240:243], v5 offset:1728
s_add_u32 s36, s36, 1024
MV 88,a,136,a,164
ds_read2_b32 a[208:209], v42 offset0:48 offset1:49
v_bfe_u32 v228, v1, 4, 1
MV 92,a,136,a,168
ds_read2_b32 a[210:211], v42 offset0:50 offset1:51
MV 96,a,136,a,172
ds_read_b128 a[244:247], v5 offset:1216
v_lshl_add_u32 v228, s3, 1, v228
MV 100,a,136,a,176
MV 104,a,136,a,180
ds_read2_b32 a[212:213], v42 offset0:176 offset1:177
v_sub_u32 v229, 7, v228
MV 88,a,140,a,160
ds_read2_b32 a[214:215], v42 offset0:178 offset1:179
v_min_u32 v228, v228, v229
MV 92,a,140,a,164
ds_read_b128 a[248:251], v5 offset:704
MV 96,a,140,a,168
ds_read2_b32 a[216:217], v43 offset0:48 offset1:49
v_lshl_add_u32 v229, v228, 8, s36
MV 100,a,140,a,172
MV 104,a,140,a,176
ds_read2_b32 a[218:219], v43 offset0:50 offset1:51
v_and_b32 v252, 7, v1
MV 92,a,144,a,160
ds_read_b128 a[252:255], v5 offset:192
v_lshlrev_b32 v252, 3, v252
MV 96,a,144,a,164
ds_read2_b32 a[220:221], v43 offset0:176 offset1:177
MV 100,a,144,a,168
ds_read2_b32 a[222:223], v43 offset0:178 offset1:179
v_bfe_u32 v228, v1, 3, 1
MV 104,a,144,a,172
MV 96,a,148,a,160
v_lshlrev_b32 v228, 1, v228
MV 100,a,148,a,164
v_add3_u32 v252, v252, v228, v229
MV 104,a,148,a,168
MV 100,a,152,a,160
v_lshlrev_b32 v252, 2, v252
MV 104,a,152,a,164
s_waitcnt lgkmcnt(15)
MV 104,a,156,a,160
s_waitcnt vmcnt(0)
v_cmp_gt_u32 vcc, 1, v253
s_nop 4
s_cbranch_vccnz L_spin_w
L_spin_w_ret:
MV 76,a,192,a,224
ds_read_b128 a[160:163], v5 offset:3840
s_add_u32 m0, s70, 66560
MV 80,a,192,a,228
ds_read2_b32 a[128:129], v40 offset0:64 offset1:65
v_lshlrev_b32 v255, 20, v1
MV 84,a,192,a,232
ds_read2_b32 a[130:131], v40 offset0:66 offset1:67
buffer_load_dwordx4 v238, s[48:51], s69 offen offset:0 sc1 lds
s_waitcnt lgkmcnt(15)
MV 88,a,192,a,236
ds_read_b128 a[164:167], v5 offset:3328
s_waitcnt lgkmcnt(15)
MV 92,a,192,a,240
s_waitcnt lgkmcnt(12)
MV 96,a,192,a,244
ds_read2_b32 a[132:133], v40 offset0:192 offset1:193
buffer_load_dwordx4 v238, s[48:51], s69 offen offset:1024 sc1 lds
s_waitcnt lgkmcnt(10)
MV 100,a,192,a,248
ds_read2_b32 a[134:135], v40 offset0:194 offset1:195
s_waitcnt lgkmcnt(8)
MV 104,a,192,a,252
ds_read_b128 a[168:171], v5 offset:2816
MV 80,a,196,a,224
ds_read2_b32 a[136:137], v41 offset0:64 offset1:65
buffer_load_dwordx4 v238, s[48:51], s69 offen offset:2048 sc1 lds
MV 84,a,196,a,228
MV 88,a,196,a,232
ds_read2_b32 a[138:139], v41 offset0:66 offset1:67
MV 92,a,196,a,236
ds_read_b128 a[172:175], v5 offset:2304
buffer_load_dwordx4 v238, s[48:51], s69 offen offset:3072 sc1 lds
MV 96,a,196,a,240
ds_read2_b32 a[140:141], v41 offset0:192 offset1:193
s_lshl_b32 s36, s3, 26
MV 100,a,196,a,244
ds_read2_b32 a[142:143], v41 offset0:194 offset1:195
MV 104,a,196,a,248
s_add_u32 s69, s69, 16384
MV 84,a,200,a,224
ds_read_b128 a[176:179], v5 offset:1792
MV 88,a,200,a,228
ds_read2_b32 a[144:145], v42 offset0:64 offset1:65
MV 92,a,200,a,232
ds_read2_b32 a[146:147], v42 offset0:66 offset1:67
s_add_u32 m0, s70, 82944
MV 96,a,200,a,236
ds_read_b128 a[180:183], v5 offset:1280
MV 100,a,200,a,240
MV 104,a,200,a,244
ds_read2_b32 a[148:149], v42 offset0:192 offset1:193
buffer_load_dwordx4 v238, s[48:51], s69 offen offset:0 sc1 lds
MV 88,a,204,a,224
ds_read2_b32 a[150:151], v42 offset0:194 offset1:195
MV 92,a,204,a,228
ds_read_b128 a[184:187], v5 offset:768
MV 96,a,204,a,232
ds_read2_b32 a[152:153], v43 offset0:64 offset1:65
buffer_load_dwordx4 v238, s[48:51], s69 offen offset:1024 sc1 lds
MV 100,a,204,a,236
v_add_u32 v255, s36, v255
MV 104,a,204,a,240
ds_read2_b32 a[154:155], v43 offset0:66 offset1:67
MV 92,a,208,a,224
ds_read_b128 a[188:191], v5 offset:256
buffer_load_dwordx4 v238, s[48:51], s69 offen offset:2048 sc1 lds
MV 96,a,208,a,228
ds_read2_b32 a[156:157], v43 offset0:192 offset1:193
MV 100,a,208,a,232
ds_read2_b32 a[158:159], v43 offset0:194 offset1:195
MV 104,a,208,a,236
buffer_load_dwordx4 v238, s[48:51], s69 offen offset:3072 sc1 lds
MV 96,a,212,a,224
MV 100,a,212,a,228
MV 104,a,212,a,232
s_add_u32 s69, s69, 16384
MV 100,a,216,a,224
MV 104,a,216,a,228
s_waitcnt lgkmcnt(15)
MV 104,a,220,a,224
MV 76,a,128,a,160
ds_read_b128 a[224:227], v5 offset:3904
s_add_u32 m0, s70, 99328
MV 80,a,128,a,164
ds_read2_b32 a[192:193], v40 offset0:80 offset1:81
v_mul_u32_u24 v18, 136, v16
MV 84,a,128,a,168
ds_read2_b32 a[194:195], v40 offset0:82 offset1:83
v_lshl_add_u32 v18, v17, 5, v18
s_waitcnt lgkmcnt(15)
MV 88,a,128,a,172
ds_read_b128 a[228:231], v5 offset:3392
s_waitcnt lgkmcnt(15)
MV 92,a,128,a,176
s_waitcnt lgkmcnt(12)
MV 96,a,128,a,180
ds_read2_b32 a[196:197], v40 offset0:208 offset1:209
buffer_load_dwordx4 v238, s[48:51], s69 offen offset:0 sc1 lds
s_waitcnt lgkmcnt(10)
MV 100,a,128,a,184
ds_read2_b32 a[198:199], v40 offset0:210 offset1:211
s_lshl_b32 s37, s3, 1
s_waitcnt lgkmcnt(8)
MV 104,a,128,a,188
ds_read_b128 a[232:235], v5 offset:2880
s_add_u32 s37, s37, 49152
MV 80,a,132,a,160
ds_read2_b32 a[200:201], v41 offset0:80 offset1:81
MV 84,a,132,a,164
MV 88,a,132,a,168
ds_read2_b32 a[202:203], v41 offset0:82 offset1:83
v_add_u32 v11, s37, v18
MV 92,a,132,a,172
ds_read_b128 a[236:239], v5 offset:2368
buffer_load_dwordx4 v238, s[48:51], s69 offen offset:1024 sc1 lds
MV 96,a,132,a,176
ds_read2_b32 a[204:205], v41 offset0:208 offset1:209
v_lshrrev_b32 v18, 3, v1
MV 100,a,132,a,180
ds_read2_b32 a[206:207], v41 offset0:210 offset1:211
MV 104,a,132,a,184
MV 84,a,136,a,160
ds_read_b128 a[240:243], v5 offset:1856
v_mul_u32_u24 v18, 136, v18
MV 88,a,136,a,164
ds_read2_b32 a[208:209], v42 offset0:80 offset1:81
MV 92,a,136,a,168
ds_read2_b32 a[210:211], v42 offset0:82 offset1:83
buffer_load_dwordx4 v238, s[48:51], s69 offen offset:2048 sc1 lds
MV 96,a,136,a,172
ds_read_b128 a[244:247], v5 offset:1344
v_and_b32 v19, 7, v1
MV 100,a,136,a,176
MV 104,a,136,a,180
ds_read2_b32 a[212:213], v42 offset0:208 offset1:209
v_lshl_add_u32 v18, v19, 4, v18
MV 88,a,140,a,160
ds_read2_b32 a[214:215], v42 offset0:210 offset1:211
MV 92,a,140,a,164
ds_read_b128 a[248:251], v5 offset:832
s_mul_i32 s37, s3, 4352
MV 96,a,140,a,168
ds_read2_b32 a[216:217], v43 offset0:80 offset1:81
buffer_load_dwordx4 v238, s[48:51], s69 offen offset:3072 sc1 lds
MV 100,a,140,a,172
MV 104,a,140,a,176
ds_read2_b32 a[218:219], v43 offset0:82 offset1:83
s_add_u32 s37, s37, 49152
MV 92,a,144,a,160
ds_read_b128 a[252:255], v5 offset:320
MV 96,a,144,a,164
ds_read2_b32 a[220:221], v43 offset0:208 offset1:209
v_add_u32 v12, s37, v18
MV 100,a,144,a,168
ds_read2_b32 a[222:223], v43 offset0:210 offset1:211
MV 104,a,144,a,172
s_add_u32 s69, s69, 16384
MV 96,a,148,a,160
s_lshl_b32 s37, s3, 12
MV 100,a,148,a,164
MV 104,a,148,a,168
v_add_u32 v13, s37, v232
MV 100,a,152,a,160
MV 104,a,152,a,164
s_waitcnt lgkmcnt(15)
MV 104,a,156,a,160
buffer_load_dword v253, v252, s[8:11], 0 offen sc1
MV 76,a,192,a,224
ds_read_b128 a[160:163], v5 offset:3968
MV 80,a,192,a,228
ds_read2_b32 a[128:129], v40 offset0:96 offset1:97
MV 84,a,192,a,232
ds_read2_b32 a[130:131], v40 offset0:98 offset1:99
s_waitcnt lgkmcnt(15)
MV 88,a,192,a,236
ds_read_b128 a[164:167], v5 offset:3456
s_waitcnt lgkmcnt(15)
MV 92,a,192,a,240
s_waitcnt lgkmcnt(12)
MV 96,a,192,a,244
ds_read2_b32 a[132:133], v40 offset0:224 offset1:225
s_waitcnt lgkmcnt(10)
MV 100,a,192,a,248
ds_read2_b32 a[134:135], v40 offset0:226 offset1:227
s_waitcnt lgkmcnt(8)
MV 104,a,192,a,252
ds_read_b128 a[168:171], v5 offset:2944
MV 80,a,196,a,224
ds_read2_b32 a[136:137], v41 offset0:96 offset1:97
MV 84,a,196,a,228
MV 88,a,196,a,232
ds_read2_b32 a[138:139], v41 offset0:98 offset1:99
MV 92,a,196,a,236
ds_read_b128 a[172:175], v5 offset:2432
MV 96,a,196,a,240
ds_read2_b32 a[140:141], v41 offset0:224 offset1:225
MV 100,a,196,a,244
ds_read2_b32 a[142:143], v41 offset0:226 offset1:227
MV 104,a,196,a,248
MV 84,a,200,a,224
ds_read_b128 a[176:179], v5 offset:1920
MV 88,a,200,a,228
ds_read2_b32 a[144:145], v42 offset0:96 offset1:97
MV 92,a,200,a,232
ds_read2_b32 a[146:147], v42 offset0:98 offset1:99
MV 96,a,200,a,236
ds_read_b128 a[180:183], v5 offset:1408
MV 100,a,200,a,240
MV 104,a,200,a,244
ds_read2_b32 a[148:149], v42 offset0:224 offset1:225
MV 88,a,204,a,224
ds_read2_b32 a[150:151], v42 offset0:226 offset1:227
MV 92,a,204,a,228
ds_read_b128 a[184:187], v5 offset:896
MV 96,a,204,a,232
ds_read2_b32 a[152:153], v43 offset0:96 offset1:97
MV 100,a,204,a,236
MV 104,a,204,a,240
ds_read2_b32 a[154:155], v43 offset0:98 offset1:99
MV 92,a,208,a,224
ds_read_b128 a[188:191], v5 offset:384
MV 96,a,208,a,228
ds_read2_b32 a[156:157], v43 offset0:224 offset1:225
MV 100,a,208,a,232
ds_read2_b32 a[158:159], v43 offset0:226 offset1:227
MV 104,a,208,a,236
MV 96,a,212,a,224
MV 100,a,212,a,228
MV 104,a,212,a,232
MV 100,a,216,a,224
MV 104,a,216,a,228
s_waitcnt lgkmcnt(15)
MV 104,a,220,a,224
s_waitcnt vmcnt(0)
v_cmp_gt_u32 vcc, 1, v253
s_nop 4
s_cbranch_vccnz L_spin_f2
L_spin_f2_ret:
buffer_load_dwordx4 a[0:3], v236, s[44:47], s68 offen offset:0 sc1
buffer_load_dwordx4 a[4:7], v237, s[44:47], s68 offen offset:0 sc1
buffer_load_dwordx4 a[8:11], v236, s[44:47], s68 offen offset:1024 sc1
buffer_load_dwordx4 a[12:15], v237, s[44:47], s68 offen offset:1024 sc1
s_add_u32 s68, s68, 2048
MV 76,a,128,a,160
ds_read_b128 a[224:227], v5 offset:4032
buffer_load_dwordx4 a[16:19], v236, s[44:47], s68 offen offset:0 sc1
MV 80,a,128,a,164
ds_read2_b32 a[192:193], v40 offset0:112 offset1:113
MV 84,a,128,a,168
ds_read2_b32 a[194:195], v40 offset0:114 offset1:115
buffer_load_dwordx4 a[20:23], v237, s[44:47], s68 offen offset:0 sc1
s_waitcnt lgkmcnt(15)
MV 88,a,128,a,172
ds_read_b128 a[228:231], v5 offset:3520
s_waitcnt lgkmcnt(15)
MV 92,a,128,a,176
buffer_load_dwordx4 a[24:27], v236, s[44:47], s68 offen offset:1024 sc1
s_waitcnt lgkmcnt(12)
MV 96,a,128,a,180
ds_read2_b32 a[196:197], v40 offset0:240 offset1:241
s_waitcnt lgkmcnt(10)
MV 100,a,128,a,184
ds_read2_b32 a[198:199], v40 offset0:242 offset1:243
s_waitcnt lgkmcnt(8)
MV 104,a,128,a,188
ds_read_b128 a[232:235], v5 offset:3008
buffer_load_dwordx4 a[28:31], v237, s[44:47], s68 offen offset:1024 sc1
MV 80,a,132,a,160
ds_read2_b32 a[200:201], v41 offset0:112 offset1:113
MV 84,a,132,a,164
s_add_u32 s68, s68, 2048
MV 88,a,132,a,168
ds_read2_b32 a[202:203], v41 offset0:114 offset1:115
MV 92,a,132,a,172
ds_read_b128 a[236:239], v5 offset:2496
buffer_load_dwordx4 a[32:35], v236, s[44:47], s68 offen offset:0 sc1
MV 96,a,132,a,176
ds_read2_b32 a[204:205], v41 offset0:240 offset1:241
MV 100,a,132,a,180
ds_read2_b32 a[206:207], v41 offset0:242 offset1:243
MV 104,a,132,a,184
buffer_load_dwordx4 a[36:39], v237, s[44:47], s68 offen offset:0 sc1
MV 84,a,136,a,160
ds_read_b128 a[240:243], v5 offset:1984
MV 88,a,136,a,164
ds_read2_b32 a[208:209], v42 offset0:112 offset1:113
buffer_load_dwordx4 a[40:43], v236, s[44:47], s68 offen offset:1024 sc1
MV 92,a,136,a,168
ds_read2_b32 a[210:211], v42 offset0:114 offset1:115
MV 96,a,136,a,172
ds_read_b128 a[244:247], v5 offset:1472
buffer_load_dwordx4 a[44:47], v237, s[44:47], s68 offen offset:1024 sc1
MV 100,a,136,a,176
MV 104,a,136,a,180
ds_read2_b32 a[212:213], v42 offset0:240 offset1:241
MV 88,a,140,a,160
ds_read2_b32 a[214:215], v42 offset0:242 offset1:243
s_add_u32 s68, s68, 2048
MV 92,a,140,a,164
ds_read_b128 a[248:251], v5 offset:960
MV 96,a,140,a,168
ds_read2_b32 a[216:217], v43 offset0:112 offset1:113
buffer_load_dwordx4 a[48:51], v236, s[44:47], s68 offen offset:0 sc1
MV 100,a,140,a,172
MV 104,a,140,a,176
ds_read2_b32 a[218:219], v43 offset0:114 offset1:115
buffer_load_dwordx4 a[52:55], v237, s[44:47], s68 offen offset:0 sc1
MV 92,a,144,a,160
ds_read_b128 a[252:255], v5 offset:448
MV 96,a,144,a,164
ds_read2_b32 a[220:221], v43 offset0:240 offset1:241
MV 100,a,144,a,168
ds_read2_b32 a[222:223], v43 offset0:242 offset1:243
buffer_load_dwordx4 a[56:59], v236, s[44:47], s68 offen offset:1024 sc1
MV 104,a,144,a,172
MV 96,a,148,a,160
buffer_load_dwordx4 a[60:63], v237, s[44:47], s68 offen offset:1024 sc1
MV 100,a,148,a,164
MV 104,a,148,a,168
s_add_u32 s68, s68, 2048
MV 100,a,152,a,160
MV 104,a,152,a,164
s_waitcnt lgkmcnt(15)
MV 104,a,156,a,160
s_waitcnt lgkmcnt(0)
s_barrier
ds_read_b128 a[64:67], v242 offset:0
ds_read_b128 a[68:71], v242 offset:1024
ds_read_b128 a[72:75], v242 offset:2048
ds_read_b128 a[76:79], v242 offset:3072
ds_read_b128 a[80:83], v243 offset:0
ds_read_b128 a[84:87], v243 offset:1024
ds_read_b128 a[88:91], v243 offset:2048
ds_read_b128 a[92:95], v243 offset:3072
s_waitcnt lgkmcnt(0)
s_waitcnt vmcnt(15)
v_mfma_f32_16x16x32_bf16 v[124:127], a[64:67], a[0:3], 0
ds_read_b128 a[96:99], v242 offset:8192
MV 76,a,192,a,224
s_add_u32 m0, s70, 115712
s_waitcnt vmcnt(14)
v_mfma_f32_16x16x32_bf16 v[128:131], a[64:67], a[4:7], 0
ds_read_b128 a[100:103], v242 offset:9216
MV 80,a,192,a,228
v_mfma_f32_16x16x32_bf16 v[132:135], a[68:71], a[0:3], 0
MV 84,a,192,a,232
ds_read_b128 a[104:107], v242 offset:10240
v_mfma_f32_16x16x32_bf16 v[136:139], a[68:71], a[4:7], 0
v_mfma_f32_16x16x32_bf16 v[140:143], a[72:75], a[0:3], 0
ds_read_b128 a[108:111], v242 offset:11264
MV 88,a,192,a,236
v_mfma_f32_16x16x32_bf16 v[144:147], a[72:75], a[4:7], 0
buffer_load_dwordx4 v238, s[48:51], s69 offen offset:0 sc1 lds
MV 92,a,192,a,240
ds_read_b128 a[112:115], v243 offset:8192
v_mfma_f32_16x16x32_bf16 v[148:151], a[76:79], a[0:3], 0
MV 96,a,192,a,244
v_mfma_f32_16x16x32_bf16 v[152:155], a[76:79], a[4:7], 0
ds_read_b128 a[116:119], v243 offset:9216
v_mfma_f32_16x16x32_bf16 v[156:159], a[80:83], a[0:3], 0
MV 100,a,192,a,248
ds_read_b128 a[120:123], v243 offset:10240
v_mfma_f32_16x16x32_bf16 v[160:163], a[80:83], a[4:7], 0
MV 104,a,192,a,252
buffer_load_dwordx4 v238, s[48:51], s69 offen offset:1024 sc1 lds
v_mfma_f32_16x16x32_bf16 v[164:167], a[84:87], a[0:3], 0
ds_read_b128 a[124:127], v243 offset:11264
MV 80,a,196,a,224
v_mfma_f32_16x16x32_bf16 v[168:171], a[84:87], a[4:7], 0
v_mfma_f32_16x16x32_bf16 v[172:175], a[88:91], a[0:3], 0
MV 84,a,196,a,228
v_mfma_f32_16x16x32_bf16 v[176:179], a[88:91], a[4:7], 0
MV 88,a,196,a,232
v_mfma_f32_16x16x32_bf16 v[180:183], a[92:95], a[0:3], 0
buffer_load_dwordx4 a[0:3], v236, s[44:47], s68 offen offset:0 sc1
MV 92,a,196,a,236
v_mfma_f32_16x16x32_bf16 v[184:187], a[92:95], a[4:7], 0
buffer_load_dwordx4 a[4:7], v237, s[44:47], s68 offen offset:0 sc1
s_waitcnt lgkmcnt(0)
s_barrier
s_waitcnt vmcnt(17)
MV 124,a,96,a,8
ds_read_b128 a[64:67], v242 offset:16384
MV 96,a,196,a,240
buffer_load_dwordx4 v238, s[48:51], s69 offen offset:2048 sc1 lds
s_waitcnt vmcnt(17)
MV 128,a,96,a,12
ds_read_b128 a[68:71], v242 offset:17408
MV 100,a,196,a,244
MV 132,a,100,a,8
MV 104,a,196,a,248
ds_read_b128 a[72:75], v242 offset:18432
MV 136,a,100,a,12
MV 140,a,104,a,8
ds_read_b128 a[76:79], v242 offset:19456
MV 84,a,200,a,224
MV 144,a,104,a,12
buffer_load_dwordx4 v238, s[48:51], s69 offen offset:3072 sc1 lds
MV 88,a,200,a,228
ds_read_b128 a[80:83], v243 offset:16384
MV 148,a,108,a,8
MV 92,a,200,a,232
MV 152,a,108,a,12
ds_read_b128 a[84:87], v243 offset:17408
MV 156,a,112,a,8
MV 96,a,200,a,236
ds_read_b128 a[88:91], v243 offset:18432
MV 160,a,112,a,12
MV 100,a,200,a,240
s_add_u32 s69, s69, 16384
MV 164,a,116,a,8
ds_read_b128 a[92:95], v243 offset:19456
MV 104,a,200,a,244
MV 168,a,116,a,12
MV 172,a,120,a,8
MV 88,a,204,a,224
MV 176,a,120,a,12
MV 92,a,204,a,228
MV 180,a,124,a,8
buffer_load_dwordx4 a[8:11], v236, s[44:47], s68 offen offset:1024 sc1
MV 96,a,204,a,232
MV 184,a,124,a,12
buffer_load_dwordx4 a[12:15], v237, s[44:47], s68 offen offset:1024 sc1
s_add_u32 s68, s68, 2048
s_waitcnt lgkmcnt(0)
s_waitcnt vmcnt(19)
MV 124,a,64,a,16
ds_read_b128 a[96:99], v242 offset:24576
MV 100,a,204,a,236
s_add_u32 m0, s70, 66560
s_waitcnt vmcnt(18)
MV 128,a,64,a,20
ds_read_b128 a[100:103], v242 offset:25600
MV 104,a,204,a,240
MV 132,a,68,a,16
MV 92,a,208,a,224
ds_read_b128 a[104:107], v242 offset:26624
MV 136,a,68,a,20
MV 140,a,72,a,16
ds_read_b128 a[108:111], v242 offset:27648
MV 96,a,208,a,228
MV 144,a,72,a,20
buffer_load_dwordx4 v238, s[48:51], s69 offen offset:0 sc1 lds
MV 100,a,208,a,232
ds_read_b128 a[112:115], v243 offset:24576
MV 148,a,76,a,16
MV 104,a,208,a,236
MV 152,a,76,a,20
ds_read_b128 a[116:119], v243 offset:25600
MV 156,a,80,a,16
MV 96,a,212,a,224
ds_read_b128 a[120:123], v243 offset:26624
MV 160,a,80,a,20
MV 100,a,212,a,228
buffer_load_dwordx4 v238, s[48:51], s69 offen offset:1024 sc1 lds
MV 164,a,84,a,16
ds_read_b128 a[124:127], v243 offset:27648
MV 104,a,212,a,232
MV 168,a,84,a,20
MV 172,a,88,a,16
MV 100,a,216,a,224
MV 176,a,88,a,20
MV 104,a,216,a,228
MV 180,a,92,a,16
buffer_load_dwordx4 a[16:19], v236, s[44:47], s68 offen offset:0 sc1
MV 104,a,220,a,224
MV 184,a,92,a,20
buffer_load_dwordx4 a[20:23], v237, s[44:47], s68 offen offset:0 sc1
s_waitcnt lgkmcnt(0)
s_barrier
s_waitcnt vmcnt(21)
MV 124,a,96,a,24
ds_read_b128 a[64:67], v242 offset:32768
s_waitcnt vmcnt(20)
MV 128,a,96,a,28
ds_read_b128 a[68:71], v242 offset:33792
buffer_load_dwordx4 v238, s[48:51], s69 offen offset:2048 sc1 lds
MV 132,a,100,a,24
MV 136,a,100,a,28
ds_read_b128 a[72:75], v242 offset:34816
MV 140,a,104,a,24
ds_read_b128 a[76:79], v242 offset:35840
MV 144,a,104,a,28
buffer_load_dwordx4 v238, s[48:51], s69 offen offset:3072 sc1 lds
MV 148,a,108,a,24
ds_read_b128 a[80:83], v243 offset:32768
MV 152,a,108,a,28
ds_read_b128 a[84:87], v243 offset:33792
MV 156,a,112,a,24
MV 160,a,112,a,28
ds_read_b128 a[88:91], v243 offset:34816
s_add_u32 s69, s69, 16384
MV 164,a,116,a,24
ds_read_b128 a[92:95], v243 offset:35840
MV 168,a,116,a,28
MV 172,a,120,a,24
MV 176,a,120,a,28
MV 180,a,124,a,24
buffer_load_dwordx4 a[24:27], v236, s[44:47], s68 offen offset:1024 sc1
MV 184,a,124,a,28
buffer_load_dwordx4 a[28:31], v237, s[44:47], s68 offen offset:1024 sc1
s_add_u32 s68, s68, 2048
s_waitcnt lgkmcnt(0)
s_waitcnt vmcnt(23)
MV 124,a,64,a,32
ds_read_b128 a[96:99], v242 offset:40960
v_cvt_pk_bf16_f32 v16, v76, v77
s_waitcnt vmcnt(22)
MV 128,a,64,a,36
ds_read_b128 a[100:103], v242 offset:41984
s_add_u32 m0, s70, 82944
MV 132,a,68,a,32
v_cvt_pk_bf16_f32 v17, v78, v79
MV 136,a,68,a,36
ds_read_b128 a[104:107], v242 offset:43008
ds_write_b16 v11, v16 offset:0
MV 140,a,72,a,32
ds_read_b128 a[108:111], v242 offset:44032
MV 144,a,72,a,36
buffer_load_dwordx4 v238, s[48:51], s69 offen offset:0 sc1 lds
ds_write_b16_d16_hi v11, v16 offset:8
MV 148,a,76,a,32
ds_read_b128 a[112:115], v243 offset:40960
MV 152,a,76,a,36
ds_read_b128 a[116:119], v243 offset:41984
ds_write_b16 v11, v17 offset:16
MV 156,a,80,a,32
ds_write_b16_d16_hi v11, v17 offset:24
MV 160,a,80,a,36
ds_read_b128 a[120:123], v243 offset:43008
buffer_load_dwordx4 v238, s[48:51], s69 offen offset:1024 sc1 lds
MV 164,a,84,a,32
ds_read_b128 a[124:127], v243 offset:44032
v_cvt_pk_bf16_f32 v18, v80, v81
MV 168,a,84,a,36
MV 172,a,88,a,32
v_cvt_pk_bf16_f32 v19, v82, v83
MV 176,a,88,a,36
MV 180,a,92,a,32
buffer_load_dwordx4 a[32:35], v236, s[44:47], s68 offen offset:0 sc1
ds_write_b16 v11, v18 offset:2176
MV 184,a,92,a,36
buffer_load_dwordx4 a[36:39], v237, s[44:47], s68 offen offset:0 sc1
s_waitcnt vmcnt(14) lgkmcnt(0)
s_barrier
MV 124,a,96,a,40
ds_read_b128 a[64:67], v242 offset:49152
ds_write_b16_d16_hi v11, v18 offset:2184
MV 128,a,96,a,44
ds_read_b128 a[68:71], v242 offset:50176
buffer_load_dwordx4 v238, s[48:51], s69 offen offset:2048 sc1 lds
MV 132,a,100,a,40
ds_write_b16 v11, v19 offset:2192
MV 136,a,100,a,44
ds_read_b128 a[72:75], v242 offset:51200
ds_write_b16_d16_hi v11, v19 offset:2200
MV 140,a,104,a,40
ds_read_b128 a[76:79], v242 offset:52224
v_cvt_pk_bf16_f32 v16, v84, v85
MV 144,a,104,a,44
buffer_load_dwordx4 v238, s[48:51], s69 offen offset:3072 sc1 lds
MV 148,a,108,a,40
ds_read_b128 a[80:83], v243 offset:49152
v_cvt_pk_bf16_f32 v17, v86, v87
MV 152,a,108,a,44
ds_read_b128 a[84:87], v243 offset:50176
MV 156,a,112,a,40
ds_write_b16 v11, v16 offset:4352
MV 160,a,112,a,44
ds_read_b128 a[88:91], v243 offset:51200
s_add_u32 s69, s69, 16384
MV 164,a,116,a,40
ds_read_b128 a[92:95], v243 offset:52224
ds_write_b16_d16_hi v11, v16 offset:4360
MV 168,a,116,a,44
ds_write_b16 v11, v17 offset:4368
MV 172,a,120,a,40
ds_write_b16_d16_hi v11, v17 offset:4376
MV 176,a,120,a,44
MV 180,a,124,a,40
buffer_load_dwordx4 a[40:43], v236, s[44:47], s68 offen offset:1024 sc1
v_cvt_pk_bf16_f32 v18, v88, v89
MV 184,a,124,a,44
buffer_load_dwordx4 a[44:47], v237, s[44:47], s68 offen offset:1024 sc1
s_add_u32 s68, s68, 2048
s_waitcnt lgkmcnt(0)
MV 124,a,64,a,48
ds_read_b128 a[96:99], v242 offset:57344
v_cvt_pk_bf16_f32 v19, v90, v91
MV 128,a,64,a,52
ds_read_b128 a[100:103], v242 offset:58368
s_add_u32 m0, s70, 99328
MV 132,a,68,a,48
ds_write_b16 v11, v18 offset:6528
MV 136,a,68,a,52
ds_read_b128 a[104:107], v242 offset:59392
ds_write_b16_d16_hi v11, v18 offset:6536
MV 140,a,72,a,48
ds_read_b128 a[108:111], v242 offset:60416
MV 144,a,72,a,52
buffer_load_dwordx4 v238, s[48:51], s69 offen offset:0 sc1 lds
ds_write_b16 v11, v19 offset:6544
MV 148,a,76,a,48
ds_read_b128 a[112:115], v243 offset:57344
MV 152,a,76,a,52
ds_read_b128 a[116:119], v243 offset:58368
ds_write_b16_d16_hi v11, v19 offset:6552
MV 156,a,80,a,48
v_cvt_pk_bf16_f32 v16, v92, v93
MV 160,a,80,a,52
ds_read_b128 a[120:123], v243 offset:59392
buffer_load_dwordx4 v238, s[48:51], s69 offen offset:1024 sc1 lds
MV 164,a,84,a,48
ds_read_b128 a[124:127], v243 offset:60416
v_cvt_pk_bf16_f32 v17, v94, v95
MV 168,a,84,a,52
MV 172,a,88,a,48
ds_write_b16 v11, v16 offset:8704
MV 176,a,88,a,52
MV 180,a,92,a,48
buffer_load_dwordx4 a[48:51], v236, s[44:47], s68 offen offset:0 sc1
ds_write_b16_d16_hi v11, v16 offset:8712
MV 184,a,92,a,52
buffer_load_dwordx4 a[52:55], v237, s[44:47], s68 offen offset:0 sc1
s_waitcnt vmcnt(14) lgkmcnt(0)
s_barrier
MV 124,a,96,a,56
ds_read_b128 a[64:67], v242 offset:0
ds_write_b16 v11, v17 offset:8720
MV 128,a,96,a,60
ds_read_b128 a[68:71], v242 offset:1024
buffer_load_dwordx4 v238, s[48:51], s69 offen offset:2048 sc1 lds
MV 132,a,100,a,56
ds_write_b16_d16_hi v11, v17 offset:8728
MV 136,a,100,a,60
ds_read_b128 a[72:75], v242 offset:2048
v_cvt_pk_bf16_f32 v18, v96, v97
MV 140,a,104,a,56
ds_read_b128 a[76:79], v242 offset:3072
v_cvt_pk_bf16_f32 v19, v98, v99
MV 144,a,104,a,60
buffer_load_dwordx4 v238, s[48:51], s69 offen offset:3072 sc1 lds
MV 148,a,108,a,56
ds_read_b128 a[80:83], v243 offset:0
ds_write_b16 v11, v18 offset:10880
MV 152,a,108,a,60
ds_read_b128 a[84:87], v243 offset:1024
MV 156,a,112,a,56
ds_write_b16_d16_hi v11, v18 offset:10888
MV 160,a,112,a,60
ds_read_b128 a[88:91], v243 offset:2048
s_add_u32 s69, s69, 16384
MV 164,a,116,a,56
ds_read_b128 a[92:95], v243 offset:3072
ds_write_b16 v11, v19 offset:10896
MV 168,a,116,a,60
ds_write_b16_d16_hi v11, v19 offset:10904
MV 172,a,120,a,56
v_cvt_pk_bf16_f32 v16, v100, v101
MV 176,a,120,a,60
MV 180,a,124,a,56
buffer_load_dwordx4 a[56:59], v236, s[44:47], s68 offen offset:1024 sc1
v_cvt_pk_bf16_f32 v17, v102, v103
MV 184,a,124,a,60
buffer_load_dwordx4 a[60:63], v237, s[44:47], s68 offen offset:1024 sc1
s_add_u32 s68, s68, 2048
s_waitcnt lgkmcnt(0)
MV 124,a,64,a,0
ds_read_b128 a[96:99], v242 offset:8192
ds_write_b16 v11, v16 offset:13056
MV 128,a,64,a,4
ds_read_b128 a[100:103], v242 offset:9216
s_add_u32 m0, s70, 115712
MV 132,a,68,a,0
ds_write_b16_d16_hi v11, v16 offset:13064
MV 136,a,68,a,4
ds_read_b128 a[104:107], v242 offset:10240
ds_write_b16 v11, v17 offset:13072
MV 140,a,72,a,0
ds_read_b128 a[108:111], v242 offset:11264
ds_write_b16_d16_hi v11, v17 offset:13080
MV 144,a,72,a,4
buffer_load_dwordx4 v238, s[48:51], s69 offen offset:0 sc1 lds
MV 148,a,76,a,0
ds_read_b128 a[112:115], v243 offset:8192
v_cvt_pk_bf16_f32 v18, v104, v105
MV 152,a,76,a,4
ds_read_b128 a[116:119], v243 offset:9216
MV 156,a,80,a,0
v_cvt_pk_bf16_f32 v19, v106, v107
MV 160,a,80,a,4
ds_read_b128 a[120:123], v243 offset:10240
buffer_load_dwordx4 v238, s[48:51], s69 offen offset:1024 sc1 lds
MV 164,a,84,a,0
ds_read_b128 a[124:127], v243 offset:11264
ds_write_b16 v11, v18 offset:15232
MV 168,a,84,a,4
ds_write_b16_d16_hi v11, v18 offset:15240
MV 172,a,88,a,0
ds_write_b16 v11, v19 offset:15248
MV 176,a,88,a,4
MV 180,a,92,a,0
buffer_load_dwordx4 a[0:3], v236, s[44:47], s68 offen offset:0 sc1
ds_write_b16_d16_hi v11, v19 offset:15256
MV 184,a,92,a,4
buffer_load_dwordx4 a[4:7], v237, s[44:47], s68 offen offset:0 sc1
s_waitcnt vmcnt(14) lgkmcnt(0)
s_barrier
MV 124,a,96,a,8
ds_read_b128 a[64:67], v242 offset:16384
ds_read_b64 v[108:109], v12 offset:0
MV 128,a,96,a,12
ds_read_b128 a[68:71], v242 offset:17408
buffer_load_dwordx4 v238, s[48:51], s69 offen offset:2048 sc1 lds
MV 132,a,100,a,8
ds_read_b64 v[110:111], v12 offset:8
MV 136,a,100,a,12
ds_read_b128 a[72:75], v242 offset:18432
MV 140,a,104,a,8
ds_read_b128 a[76:79], v242 offset:19456
ds_read_b64 v[112:113], v12 offset:1088
MV 144,a,104,a,12
buffer_load_dwordx4 v238, s[48:51], s69 offen offset:3072 sc1 lds
MV 148,a,108,a,8
ds_read_b128 a[80:83], v243 offset:16384
ds_read_b64 v[114:115], v12 offset:1096
MV 152,a,108,a,12
ds_read_b128 a[84:87], v243 offset:17408
MV 156,a,112,a,8
ds_read_b64 v[116:117], v12 offset:2176
MV 160,a,112,a,12
ds_read_b128 a[88:91], v243 offset:18432
s_add_u32 s69, s69, 16384
MV 164,a,116,a,8
ds_read_b128 a[92:95], v243 offset:19456
ds_read_b64 v[118:119], v12 offset:2184
MV 168,a,116,a,12
MV 172,a,120,a,8
ds_read_b64 v[120:121], v12 offset:3264
MV 176,a,120,a,12
MV 180,a,124,a,8
buffer_load_dwordx4 a[8:11], v236, s[44:47], s68 offen offset:1024 sc1
ds_read_b64 v[122:123], v12 offset:3272
MV 184,a,124,a,12
buffer_load_dwordx4 a[12:15], v237, s[44:47], s68 offen offset:1024 sc1
s_add_u32 s68, s68, 2048
s_waitcnt lgkmcnt(0)
MV 124,a,64,a,16
ds_read_b128 a[96:99], v242 offset:24576
buffer_store_dwordx4 v[108:111], v13, s[24:27], 0 offen offset:0 sc1
MV 128,a,64,a,20
ds_read_b128 a[100:103], v242 offset:25600
s_add_u32 m0, s70, 66560
MV 132,a,68,a,16
MV 136,a,68,a,20
ds_read_b128 a[104:107], v242 offset:26624
MV 140,a,72,a,16
ds_read_b128 a[108:111], v242 offset:27648
MV 144,a,72,a,20
buffer_load_dwordx4 v238, s[48:51], s69 offen offset:0 sc1 lds
MV 148,a,76,a,16
ds_read_b128 a[112:115], v243 offset:24576
MV 152,a,76,a,20
ds_read_b128 a[116:119], v243 offset:25600
MV 156,a,80,a,16
buffer_store_dwordx4 v[112:115], v13, s[24:27], 0 offen offset:1024 sc1
MV 160,a,80,a,20
ds_read_b128 a[120:123], v243 offset:26624
buffer_load_dwordx4 v238, s[48:51], s69 offen offset:1024 sc1 lds
MV 164,a,84,a,16
ds_read_b128 a[124:127], v243 offset:27648
MV 168,a,84,a,20
MV 172,a,88,a,16
MV 176,a,88,a,20
MV 180,a,92,a,16
buffer_load_dwordx4 a[16:19], v236, s[44:47], s68 offen offset:0 sc1
MV 184,a,92,a,20
buffer_load_dwordx4 a[20:23], v237, s[44:47], s68 offen offset:0 sc1
s_waitcnt vmcnt(16) lgkmcnt(0)
s_barrier
MV 124,a,96,a,24
ds_read_b128 a[64:67], v242 offset:32768
buffer_store_dwordx4 v[116:119], v13, s[24:27], 0 offen offset:2048 sc1
MV 128,a,96,a,28
ds_read_b128 a[68:71], v242 offset:33792
buffer_load_dwordx4 v238, s[48:51], s69 offen offset:2048 sc1 lds
MV 132,a,100,a,24
MV 136,a,100,a,28
ds_read_b128 a[72:75], v242 offset:34816
MV 140,a,104,a,24
ds_read_b128 a[76:79], v242 offset:35840
MV 144,a,104,a,28
buffer_load_dwordx4 v238, s[48:51], s69 offen offset:3072 sc1 lds
MV 148,a,108,a,24
ds_read_b128 a[80:83], v243 offset:32768
MV 152,a,108,a,28
ds_read_b128 a[84:87], v243 offset:33792
MV 156,a,112,a,24
buffer_store_dwordx4 v[120:123], v13, s[24:27], 0 offen offset:3072 sc1
MV 160,a,112,a,28
ds_read_b128 a[88:91], v243 offset:34816
s_add_u32 s69, s69, 16384
MV 164,a,116,a,24
ds_read_b128 a[92:95], v243 offset:35840
MV 168,a,116,a,28
MV 172,a,120,a,24
MV 176,a,120,a,28
MV 180,a,124,a,24
buffer_load_dwordx4 a[24:27], v236, s[44:47], s68 offen offset:1024 sc1
MV 184,a,124,a,28
buffer_load_dwordx4 a[28:31], v237, s[44:47], s68 offen offset:1024 sc1
s_add_u32 s68, s68, 2048
s_waitcnt lgkmcnt(0)
MV 124,a,64,a,32
ds_read_b128 a[96:99], v242 offset:40960
MV 128,a,64,a,36
ds_read_b128 a[100:103], v242 offset:41984
s_add_u32 m0, s70, 82944
MV 132,a,68,a,32
MV 136,a,68,a,36
ds_read_b128 a[104:107], v242 offset:43008
MV 140,a,72,a,32
ds_read_b128 a[108:111], v242 offset:44032
MV 144,a,72,a,36
buffer_load_dwordx4 v238, s[48:51], s69 offen offset:0 sc1 lds
MV 148,a,76,a,32
ds_read_b128 a[112:115], v243 offset:40960
MV 152,a,76,a,36
ds_read_b128 a[116:119], v243 offset:41984
MV 156,a,80,a,32
MV 160,a,80,a,36
ds_read_b128 a[120:123], v243 offset:43008
buffer_load_dwordx4 v238, s[48:51], s69 offen offset:1024 sc1 lds
MV 164,a,84,a,32
ds_read_b128 a[124:127], v243 offset:44032
MV 168,a,84,a,36
MV 172,a,88,a,32
MV 176,a,88,a,36
MV 180,a,92,a,32
buffer_load_dwordx4 a[32:35], v236, s[44:47], s68 offen offset:0 sc1
MV 184,a,92,a,36
buffer_load_dwordx4 a[36:39], v237, s[44:47], s68 offen offset:0 sc1
s_waitcnt vmcnt(18) lgkmcnt(0)
s_barrier
MV 124,a,96,a,40
ds_read_b128 a[64:67], v242 offset:49152
MV 128,a,96,a,44
ds_read_b128 a[68:71], v242 offset:50176
buffer_load_dwordx4 v238, s[48:51], s69 offen offset:2048 sc1 lds
MV 132,a,100,a,40
MV 136,a,100,a,44
ds_read_b128 a[72:75], v242 offset:51200
MV 140,a,104,a,40
ds_read_b128 a[76:79], v242 offset:52224
MV 144,a,104,a,44
buffer_load_dwordx4 v238, s[48:51], s69 offen offset:3072 sc1 lds
MV 148,a,108,a,40
ds_read_b128 a[80:83], v243 offset:49152
MV 152,a,108,a,44
ds_read_b128 a[84:87], v243 offset:50176
MV 156,a,112,a,40
MV 160,a,112,a,44
ds_read_b128 a[88:91], v243 offset:51200
s_add_u32 s69, s69, 16384
MV 164,a,116,a,40
ds_read_b128 a[92:95], v243 offset:52224
MV 168,a,116,a,44
MV 172,a,120,a,40
MV 176,a,120,a,44
MV 180,a,124,a,40
buffer_load_dwordx4 a[40:43], v236, s[44:47], s68 offen offset:1024 sc1
MV 184,a,124,a,44
buffer_load_dwordx4 a[44:47], v237, s[44:47], s68 offen offset:1024 sc1
s_add_u32 s68, s68, 2048
s_waitcnt lgkmcnt(0)
MV 124,a,64,a,48
ds_read_b128 a[96:99], v242 offset:57344
MV 128,a,64,a,52
ds_read_b128 a[100:103], v242 offset:58368
s_add_u32 m0, s70, 99328
MV 132,a,68,a,48
MV 136,a,68,a,52
ds_read_b128 a[104:107], v242 offset:59392
MV 140,a,72,a,48
ds_read_b128 a[108:111], v242 offset:60416
MV 144,a,72,a,52
buffer_load_dwordx4 v238, s[48:51], s69 offen offset:0 sc1 lds
MV 148,a,76,a,48
ds_read_b128 a[112:115], v243 offset:57344
MV 152,a,76,a,52
ds_read_b128 a[116:119], v243 offset:58368
MV 156,a,80,a,48
MV 160,a,80,a,52
ds_read_b128 a[120:123], v243 offset:59392
buffer_load_dwordx4 v238, s[48:51], s69 offen offset:1024 sc1 lds
MV 164,a,84,a,48
ds_read_b128 a[124:127], v243 offset:60416
MV 168,a,84,a,52
MV 172,a,88,a,48
MV 176,a,88,a,52
MV 180,a,92,a,48
buffer_load_dwordx4 a[48:51], v236, s[44:47], s68 offen offset:0 sc1
MV 184,a,92,a,52
buffer_load_dwordx4 a[52:55], v237, s[44:47], s68 offen offset:0 sc1
s_waitcnt vmcnt(15) lgkmcnt(0)
s_barrier
MV 124,a,96,a,56
ds_read_b128 a[64:67], v242 offset:0
MV 128,a,96,a,60
ds_read_b128 a[68:71], v242 offset:1024
buffer_load_dwordx4 v238, s[48:51], s69 offen offset:2048 sc1 lds
MV 132,a,100,a,56
MV 136,a,100,a,60
ds_read_b128 a[72:75], v242 offset:2048
MV 140,a,104,a,56
ds_read_b128 a[76:79], v242 offset:3072
MV 144,a,104,a,60
buffer_load_dwordx4 v238, s[48:51], s69 offen offset:3072 sc1 lds
MV 148,a,108,a,56
ds_read_b128 a[80:83], v243 offset:0
MV 152,a,108,a,60
ds_read_b128 a[84:87], v243 offset:1024
MV 156,a,112,a,56
MV 160,a,112,a,60
ds_read_b128 a[88:91], v243 offset:2048
s_add_u32 s69, s69, 16384
MV 164,a,116,a,56
ds_read_b128 a[92:95], v243 offset:3072
MV 168,a,116,a,60
MV 172,a,120,a,56
MV 176,a,120,a,60
MV 180,a,124,a,56
buffer_load_dwordx4 a[56:59], v236, s[44:47], s68 offen offset:1024 sc1
MV 184,a,124,a,60
buffer_load_dwordx4 a[60:63], v237, s[44:47], s68 offen offset:1024 sc1
s_add_u32 s68, s68, 2048
s_waitcnt lgkmcnt(0)
MV 124,a,64,a,0
ds_read_b128 a[96:99], v242 offset:8192
MV 128,a,64,a,4
ds_read_b128 a[100:103], v242 offset:9216
s_add_u32 m0, s70, 115712
MV 132,a,68,a,0
MV 136,a,68,a,4
ds_read_b128 a[104:107], v242 offset:10240
MV 140,a,72,a,0
ds_read_b128 a[108:111], v242 offset:11264
MV 144,a,72,a,4
buffer_load_dwordx4 v238, s[48:51], s69 offen offset:0 sc1 lds
MV 148,a,76,a,0
ds_read_b128 a[112:115], v243 offset:8192
MV 152,a,76,a,4
ds_read_b128 a[116:119], v243 offset:9216
MV 156,a,80,a,0
MV 160,a,80,a,4
ds_read_b128 a[120:123], v243 offset:10240
buffer_load_dwordx4 v238, s[48:51], s69 offen offset:1024 sc1 lds
MV 164,a,84,a,0
ds_read_b128 a[124:127], v243 offset:11264
MV 168,a,84,a,4
MV 172,a,88,a,0
MV 176,a,88,a,4
MV 180,a,92,a,0
buffer_load_dwordx4 a[0:3], v236, s[44:47], s68 offen offset:0 sc1
MV 184,a,92,a,4
buffer_load_dwordx4 a[4:7], v237, s[44:47], s68 offen offset:0 sc1
s_waitcnt vmcnt(14) lgkmcnt(0)
s_barrier
MV 124,a,96,a,8
ds_read_b128 a[64:67], v242 offset:16384
MV 128,a,96,a,12
ds_read_b128 a[68:71], v242 offset:17408
buffer_load_dwordx4 v238, s[48:51], s69 offen offset:2048 sc1 lds
MV 132,a,100,a,8
MV 136,a,100,a,12
ds_read_b128 a[72:75], v242 offset:18432
MV 140,a,104,a,8
ds_read_b128 a[76:79], v242 offset:19456
MV 144,a,104,a,12
buffer_load_dwordx4 v238, s[48:51], s69 offen offset:3072 sc1 lds
MV 148,a,108,a,8
ds_read_b128 a[80:83], v243 offset:16384
MV 152,a,108,a,12
ds_read_b128 a[84:87], v243 offset:17408
MV 156,a,112,a,8
MV 160,a,112,a,12
ds_read_b128 a[88:91], v243 offset:18432
s_add_u32 s69, s69, 16384
MV 164,a,116,a,8
ds_read_b128 a[92:95], v243 offset:19456
MV 168,a,116,a,12
MV 172,a,120,a,8
MV 176,a,120,a,12
MV 180,a,124,a,8
buffer_load_dwordx4 a[8:11], v236, s[44:47], s68 offen offset:1024 sc1
MV 184,a,124,a,12
buffer_load_dwordx4 a[12:15], v237, s[44:47], s68 offen offset:1024 sc1
s_add_u32 s68, s68, 2048
s_waitcnt lgkmcnt(0)
MV 124,a,64,a,16
ds_read_b128 a[96:99], v242 offset:24576
MV 128,a,64,a,20
ds_read_b128 a[100:103], v242 offset:25600
s_add_u32 m0, s70, 66560
MV 132,a,68,a,16
MV 136,a,68,a,20
ds_read_b128 a[104:107], v242 offset:26624
MV 140,a,72,a,16
ds_read_b128 a[108:111], v242 offset:27648
MV 144,a,72,a,20
buffer_load_dwordx4 v238, s[48:51], s69 offen offset:0 sc1 lds
MV 148,a,76,a,16
ds_read_b128 a[112:115], v243 offset:24576
MV 152,a,76,a,20
ds_read_b128 a[116:119], v243 offset:25600
MV 156,a,80,a,16
MV 160,a,80,a,20
ds_read_b128 a[120:123], v243 offset:26624
buffer_load_dwordx4 v238, s[48:51], s69 offen offset:1024 sc1 lds
MV 164,a,84,a,16
ds_read_b128 a[124:127], v243 offset:27648
MV 168,a,84,a,20
MV 172,a,88,a,16
MV 176,a,88,a,20
MV 180,a,92,a,16
buffer_load_dwordx4 a[16:19], v236, s[44:47], s68 offen offset:0 sc1
MV 184,a,92,a,20
buffer_load_dwordx4 a[20:23], v237, s[44:47], s68 offen offset:0 sc1
s_waitcnt vmcnt(14) lgkmcnt(0)
s_barrier
MV 124,a,96,a,24
ds_read_b128 a[64:67], v242 offset:32768
MV 128,a,96,a,28
ds_read_b128 a[68:71], v242 offset:33792
buffer_load_dwordx4 v238, s[48:51], s69 offen offset:2048 sc1 lds
MV 132,a,100,a,24
MV 136,a,100,a,28
ds_read_b128 a[72:75], v242 offset:34816
MV 140,a,104,a,24
ds_read_b128 a[76:79], v242 offset:35840
MV 144,a,104,a,28
buffer_load_dwordx4 v238, s[48:51], s69 offen offset:3072 sc1 lds
MV 148,a,108,a,24
ds_read_b128 a[80:83], v243 offset:32768
MV 152,a,108,a,28
ds_read_b128 a[84:87], v243 offset:33792
MV 156,a,112,a,24
MV 160,a,112,a,28
ds_read_b128 a[88:91], v243 offset:34816
s_add_u32 s69, s69, 16384
MV 164,a,116,a,24
ds_read_b128 a[92:95], v243 offset:35840
MV 168,a,116,a,28
MV 172,a,120,a,24
MV 176,a,120,a,28
MV 180,a,124,a,24
buffer_load_dwordx4 a[24:27], v236, s[44:47], s68 offen offset:1024 sc1
MV 184,a,124,a,28
buffer_load_dwordx4 a[28:31], v237, s[44:47], s68 offen offset:1024 sc1
s_add_u32 s68, s68, 2048
s_waitcnt lgkmcnt(0)
MV 124,a,64,a,32
ds_read_b128 a[96:99], v242 offset:40960
MV 128,a,64,a,36
ds_read_b128 a[100:103], v242 offset:41984
s_add_u32 m0, s70, 82944
MV 132,a,68,a,32
MV 136,a,68,a,36
ds_read_b128 a[104:107], v242 offset:43008
MV 140,a,72,a,32
ds_read_b128 a[108:111], v242 offset:44032
MV 144,a,72,a,36
buffer_load_dwordx4 v238, s[48:51], s69 offen offset:0 sc1 lds
MV 148,a,76,a,32
ds_read_b128 a[112:115], v243 offset:40960
MV 152,a,76,a,36
ds_read_b128 a[116:119], v243 offset:41984
MV 156,a,80,a,32
MV 160,a,80,a,36
ds_read_b128 a[120:123], v243 offset:43008
buffer_load_dwordx4 v238, s[48:51], s69 offen offset:1024 sc1 lds
MV 164,a,84,a,32
ds_read_b128 a[124:127], v243 offset:44032
MV 168,a,84,a,36
MV 172,a,88,a,32
MV 176,a,88,a,36
MV 180,a,92,a,32
buffer_load_dwordx4 a[32:35], v236, s[44:47], s68 offen offset:0 sc1
MV 184,a,92,a,36
buffer_load_dwordx4 a[36:39], v237, s[44:47], s68 offen offset:0 sc1
s_waitcnt vmcnt(14) lgkmcnt(0)
s_barrier
v_mov_b32 v253, 1
s_lshl_b32 s36, s2, 2
buffer_store_dword v253, v255, s[8:11], s36 offen offset:2048 sc1
MV 124,a,96,a,40
ds_read_b128 a[64:67], v242 offset:49152
MV 128,a,96,a,44
ds_read_b128 a[68:71], v242 offset:50176
buffer_load_dwordx4 v238, s[48:51], s69 offen offset:2048 sc1 lds
MV 132,a,100,a,40
MV 136,a,100,a,44
ds_read_b128 a[72:75], v242 offset:51200
MV 140,a,104,a,40
ds_read_b128 a[76:79], v242 offset:52224
MV 144,a,104,a,44
buffer_load_dwordx4 v238, s[48:51], s69 offen offset:3072 sc1 lds
MV 148,a,108,a,40
ds_read_b128 a[80:83], v243 offset:49152
MV 152,a,108,a,44
ds_read_b128 a[84:87], v243 offset:50176
MV 156,a,112,a,40
MV 160,a,112,a,44
ds_read_b128 a[88:91], v243 offset:51200
s_add_u32 s69, s69, 16384
MV 164,a,116,a,40
ds_read_b128 a[92:95], v243 offset:52224
MV 168,a,116,a,44
MV 172,a,120,a,40
MV 176,a,120,a,44
MV 180,a,124,a,40
buffer_load_dwordx4 a[40:43], v236, s[44:47], s68 offen offset:1024 sc1
MV 184,a,124,a,44
buffer_load_dwordx4 a[44:47], v237, s[44:47], s68 offen offset:1024 sc1
s_add_u32 s68, s68, 2048
s_waitcnt lgkmcnt(0)
MV 124,a,64,a,48
ds_read_b128 a[96:99], v242 offset:57344
MV 128,a,64,a,52
ds_read_b128 a[100:103], v242 offset:58368
s_add_u32 m0, s70, 99328
MV 132,a,68,a,48
MV 136,a,68,a,52
ds_read_b128 a[104:107], v242 offset:59392
MV 140,a,72,a,48
ds_read_b128 a[108:111], v242 offset:60416
MV 144,a,72,a,52
buffer_load_dwordx4 v238, s[48:51], s69 offen offset:0 sc1 lds
MV 148,a,76,a,48
ds_read_b128 a[112:115], v243 offset:57344
MV 152,a,76,a,52
ds_read_b128 a[116:119], v243 offset:58368
MV 156,a,80,a,48
MV 160,a,80,a,52
ds_read_b128 a[120:123], v243 offset:59392
buffer_load_dwordx4 v238, s[48:51], s69 offen offset:1024 sc1 lds
MV 164,a,84,a,48
ds_read_b128 a[124:127], v243 offset:60416
MV 168,a,84,a,52
MV 172,a,88,a,48
MV 176,a,88,a,52
MV 180,a,92,a,48
buffer_load_dwordx4 a[48:51], v236, s[44:47], s68 offen offset:0 sc1
MV 184,a,92,a,52
buffer_load_dwordx4 a[52:55], v237, s[44:47], s68 offen offset:0 sc1
s_waitcnt vmcnt(15) lgkmcnt(0)
s_barrier
MV 124,a,96,a,56
ds_read_b128 a[64:67], v242 offset:0
MV 128,a,96,a,60
ds_read_b128 a[68:71], v242 offset:1024
buffer_load_dwordx4 v238, s[48:51], s69 offen offset:2048 sc1 lds
MV 132,a,100,a,56
MV 136,a,100,a,60
ds_read_b128 a[72:75], v242 offset:2048
MV 140,a,104,a,56
ds_read_b128 a[76:79], v242 offset:3072
MV 144,a,104,a,60
buffer_load_dwordx4 v238, s[48:51], s69 offen offset:3072 sc1 lds
MV 148,a,108,a,56
ds_read_b128 a[80:83], v243 offset:0
MV 152,a,108,a,60
ds_read_b128 a[84:87], v243 offset:1024
MV 156,a,112,a,56
MV 160,a,112,a,60
ds_read_b128 a[88:91], v243 offset:2048
s_add_u32 s69, s69, 16384
MV 164,a,116,a,56
ds_read_b128 a[92:95], v243 offset:3072
MV 168,a,116,a,60
MV 172,a,120,a,56
MV 176,a,120,a,60
MV 180,a,124,a,56
buffer_load_dwordx4 a[56:59], v236, s[44:47], s68 offen offset:1024 sc1
MV 184,a,124,a,60
buffer_load_dwordx4 a[60:63], v237, s[44:47], s68 offen offset:1024 sc1
s_add_u32 s68, s68, 2048
s_waitcnt lgkmcnt(0)
MV 124,a,64,a,0
ds_read_b128 a[96:99], v242 offset:8192
MV 128,a,64,a,4
ds_read_b128 a[100:103], v242 offset:9216
s_add_u32 m0, s70, 115712
MV 132,a,68,a,0
MV 136,a,68,a,4
ds_read_b128 a[104:107], v242 offset:10240
MV 140,a,72,a,0
ds_read_b128 a[108:111], v242 offset:11264
MV 144,a,72,a,4
buffer_load_dwordx4 v238, s[48:51], s69 offen offset:0 sc1 lds
MV 148,a,76,a,0
ds_read_b128 a[112:115], v243 offset:8192
MV 152,a,76,a,4
ds_read_b128 a[116:119], v243 offset:9216
MV 156,a,80,a,0
MV 160,a,80,a,4
ds_read_b128 a[120:123], v243 offset:10240
buffer_load_dwordx4 v238, s[48:51], s69 offen offset:1024 sc1 lds
MV 164,a,84,a,0
ds_read_b128 a[124:127], v243 offset:11264
MV 168,a,84,a,4
MV 172,a,88,a,0
MV 176,a,88,a,4
MV 180,a,92,a,0
buffer_load_dwordx4 a[0:3], v236, s[44:47], s68 offen offset:0 sc1
MV 184,a,92,a,4
buffer_load_dwordx4 a[4:7], v237, s[44:47], s68 offen offset:0 sc1
s_waitcnt vmcnt(14) lgkmcnt(0)
s_barrier
MV 124,a,96,a,8
ds_read_b128 a[64:67], v242 offset:16384
MV 128,a,96,a,12
ds_read_b128 a[68:71], v242 offset:17408
buffer_load_dwordx4 v238, s[48:51], s69 offen offset:2048 sc1 lds
MV 132,a,100,a,8
MV 136,a,100,a,12
ds_read_b128 a[72:75], v242 offset:18432
MV 140,a,104,a,8
ds_read_b128 a[76:79], v242 offset:19456
MV 144,a,104,a,12
buffer_load_dwordx4 v238, s[48:51], s69 offen offset:3072 sc1 lds
MV 148,a,108,a,8
ds_read_b128 a[80:83], v243 offset:16384
MV 152,a,108,a,12
ds_read_b128 a[84:87], v243 offset:17408
MV 156,a,112,a,8
MV 160,a,112,a,12
ds_read_b128 a[88:91], v243 offset:18432
s_add_u32 s69, s69, 16384
MV 164,a,116,a,8
ds_read_b128 a[92:95], v243 offset:19456
MV 168,a,116,a,12
MV 172,a,120,a,8
MV 176,a,120,a,12
MV 180,a,124,a,8
buffer_load_dwordx4 a[8:11], v236, s[44:47], s68 offen offset:1024 sc1
MV 184,a,124,a,12
buffer_load_dwordx4 a[12:15], v237, s[44:47], s68 offen offset:1024 sc1
s_add_u32 s68, s68, 2048
s_waitcnt lgkmcnt(0)
MV 124,a,64,a,16
ds_read_b128 a[96:99], v242 offset:24576
MV 128,a,64,a,20
ds_read_b128 a[100:103], v242 offset:25600
s_add_u32 m0, s70, 66560
MV 132,a,68,a,16
MV 136,a,68,a,20
ds_read_b128 a[104:107], v242 offset:26624
MV 140,a,72,a,16
ds_read_b128 a[108:111], v242 offset:27648
MV 144,a,72,a,20
buffer_load_dwordx4 v238, s[48:51], s69 offen offset:0 sc1 lds
MV 148,a,76,a,16
ds_read_b128 a[112:115], v243 offset:24576
MV 152,a,76,a,20
ds_read_b128 a[116:119], v243 offset:25600
MV 156,a,80,a,16
MV 160,a,80,a,20
ds_read_b128 a[120:123], v243 offset:26624
buffer_load_dwordx4 v238, s[48:51], s69 offen offset:1024 sc1 lds
MV 164,a,84,a,16
ds_read_b128 a[124:127], v243 offset:27648
MV 168,a,84,a,20
MV 172,a,88,a,16
MV 176,a,88,a,20
MV 180,a,92,a,16
buffer_load_dwordx4 a[16:19], v236, s[44:47], s68 offen offset:0 sc1
MV 184,a,92,a,20
buffer_load_dwordx4 a[20:23], v237, s[44:47], s68 offen offset:0 sc1
s_waitcnt vmcnt(14) lgkmcnt(0)
s_barrier
MV 124,a,96,a,24
ds_read_b128 a[64:67], v242 offset:32768
MV 128,a,96,a,28
ds_read_b128 a[68:71], v242 offset:33792
buffer_load_dwordx4 v238, s[48:51], s69 offen offset:2048 sc1 lds
MV 132,a,100,a,24
MV 136,a,100,a,28
ds_read_b128 a[72:75], v242 offset:34816
MV 140,a,104,a,24
ds_read_b128 a[76:79], v242 offset:35840
MV 144,a,104,a,28
buffer_load_dwordx4 v238, s[48:51], s69 offen offset:3072 sc1 lds
MV 148,a,108,a,24
ds_read_b128 a[80:83], v243 offset:32768
MV 152,a,108,a,28
ds_read_b128 a[84:87], v243 offset:33792
MV 156,a,112,a,24
MV 160,a,112,a,28
ds_read_b128 a[88:91], v243 offset:34816
s_add_u32 s69, s69, 16384
MV 164,a,116,a,24
ds_read_b128 a[92:95], v243 offset:35840
MV 168,a,116,a,28
MV 172,a,120,a,24
MV 176,a,120,a,28
MV 180,a,124,a,24
buffer_load_dwordx4 a[24:27], v236, s[44:47], s68 offen offset:1024 sc1
MV 184,a,124,a,28
buffer_load_dwordx4 a[28:31], v237, s[44:47], s68 offen offset:1024 sc1
s_add_u32 s68, s68, 2048
s_waitcnt lgkmcnt(0)
MV 124,a,64,a,32
ds_read_b128 a[96:99], v242 offset:40960
MV 128,a,64,a,36
ds_read_b128 a[100:103], v242 offset:41984
s_add_u32 m0, s70, 82944
MV 132,a,68,a,32
MV 136,a,68,a,36
ds_read_b128 a[104:107], v242 offset:43008
MV 140,a,72,a,32
ds_read_b128 a[108:111], v242 offset:44032
MV 144,a,72,a,36
buffer_load_dwordx4 v238, s[48:51], s69 offen offset:0 sc1 lds
MV 148,a,76,a,32
ds_read_b128 a[112:115], v243 offset:40960
MV 152,a,76,a,36
ds_read_b128 a[116:119], v243 offset:41984
MV 156,a,80,a,32
MV 160,a,80,a,36
ds_read_b128 a[120:123], v243 offset:43008
buffer_load_dwordx4 v238, s[48:51], s69 offen offset:1024 sc1 lds
MV 164,a,84,a,32
ds_read_b128 a[124:127], v243 offset:44032
MV 168,a,84,a,36
MV 172,a,88,a,32
MV 176,a,88,a,36
MV 180,a,92,a,32
buffer_load_dwordx4 a[32:35], v236, s[44:47], s68 offen offset:0 sc1
MV 184,a,92,a,36
buffer_load_dwordx4 a[36:39], v237, s[44:47], s68 offen offset:0 sc1
s_waitcnt vmcnt(14) lgkmcnt(0)
s_barrier
MV 124,a,96,a,40
ds_read_b128 a[64:67], v242 offset:49152
MV 128,a,96,a,44
ds_read_b128 a[68:71], v242 offset:50176
buffer_load_dwordx4 v238, s[48:51], s69 offen offset:2048 sc1 lds
MV 132,a,100,a,40
MV 136,a,100,a,44
ds_read_b128 a[72:75], v242 offset:51200
MV 140,a,104,a,40
ds_read_b128 a[76:79], v242 offset:52224
MV 144,a,104,a,44
buffer_load_dwordx4 v238, s[48:51], s69 offen offset:3072 sc1 lds
MV 148,a,108,a,40
ds_read_b128 a[80:83], v243 offset:49152
MV 152,a,108,a,44
ds_read_b128 a[84:87], v243 offset:50176
MV 156,a,112,a,40
MV 160,a,112,a,44
ds_read_b128 a[88:91], v243 offset:51200
s_add_u32 s69, s69, 16384
MV 164,a,116,a,40
ds_read_b128 a[92:95], v243 offset:52224
MV 168,a,116,a,44
MV 172,a,120,a,40
MV 176,a,120,a,44
MV 180,a,124,a,40
buffer_load_dwordx4 a[40:43], v236, s[44:47], s68 offen offset:1024 sc1
MV 184,a,124,a,44
buffer_load_dwordx4 a[44:47], v237, s[44:47], s68 offen offset:1024 sc1
s_add_u32 s68, s68, 2048
s_waitcnt lgkmcnt(0)
MV 124,a,64,a,48
ds_read_b128 a[96:99], v242 offset:57344
v_and_b32 v254, 15, v1
MV 128,a,64,a,52
ds_read_b128 a[100:103], v242 offset:58368
s_add_u32 m0, s70, 99328
MV 132,a,68,a,48
MV 136,a,68,a,52
ds_read_b128 a[104:107], v242 offset:59392
MV 140,a,72,a,48
ds_read_b128 a[108:111], v242 offset:60416
s_lshl_b32 s36, s82, 4
MV 144,a,72,a,52
buffer_load_dwordx4 v238, s[48:51], s69 offen offset:0 sc1 lds
MV 148,a,76,a,48
ds_read_b128 a[112:115], v243 offset:57344
MV 152,a,76,a,52
ds_read_b128 a[116:119], v243 offset:58368
MV 156,a,80,a,48
v_add_u32 v254, s36, v254
MV 160,a,80,a,52
ds_read_b128 a[120:123], v243 offset:59392
buffer_load_dwordx4 v238, s[48:51], s69 offen offset:1024 sc1 lds
MV 164,a,84,a,48
ds_read_b128 a[124:127], v243 offset:60416
MV 168,a,84,a,52
MV 172,a,88,a,48
v_lshlrev_b32 v254, 2, v254
MV 176,a,88,a,52
MV 180,a,92,a,48
buffer_load_dwordx4 a[48:51], v236, s[44:47], s68 offen offset:0 sc1
MV 184,a,92,a,52
buffer_load_dwordx4 a[52:55], v237, s[44:47], s68 offen offset:0 sc1
s_waitcnt vmcnt(14) lgkmcnt(0)
s_barrier
MV 124,a,96,a,56
ds_read_b128 a[64:67], v242 offset:0
buffer_load_dword v253, v254, s[8:11], 0 offen offset:2048 sc1
MV 128,a,96,a,60
ds_read_b128 a[68:71], v242 offset:1024
buffer_load_dwordx4 v238, s[48:51], s69 offen offset:2048 sc1 lds
MV 132,a,100,a,56
MV 136,a,100,a,60
ds_read_b128 a[72:75], v242 offset:2048
MV 140,a,104,a,56
ds_read_b128 a[76:79], v242 offset:3072
MV 144,a,104,a,60
buffer_load_dwordx4 v238, s[48:51], s69 offen offset:3072 sc1 lds
MV 148,a,108,a,56
ds_read_b128 a[80:83], v243 offset:0
MV 152,a,108,a,60
ds_read_b128 a[84:87], v243 offset:1024
MV 156,a,112,a,56
MV 160,a,112,a,60
ds_read_b128 a[88:91], v243 offset:2048
s_add_u32 s69, s69, 16384
MV 164,a,116,a,56
ds_read_b128 a[92:95], v243 offset:3072
MV 168,a,116,a,60
MV 172,a,120,a,56
MV 176,a,120,a,60
MV 180,a,124,a,56
buffer_load_dwordx4 a[56:59], v236, s[44:47], s68 offen offset:1024 sc1
MV 184,a,124,a,60
buffer_load_dwordx4 a[60:63], v237, s[44:47], s68 offen offset:1024 sc1
s_add_u32 s68, s68, 2048
s_waitcnt lgkmcnt(0)
MV 124,a,64,a,0
ds_read_b128 a[96:99], v242 offset:8192
MV 128,a,64,a,4
ds_read_b128 a[100:103], v242 offset:9216
s_add_u32 m0, s70, 115712
MV 132,a,68,a,0
MV 136,a,68,a,4
ds_read_b128 a[104:107], v242 offset:10240
MV 140,a,72,a,0
ds_read_b128 a[108:111], v242 offset:11264
MV 144,a,72,a,4
buffer_load_dwordx4 v238, s[48:51], s69 offen offset:0 sc1 lds
MV 148,a,76,a,0
ds_read_b128 a[112:115], v243 offset:8192
MV 152,a,76,a,4
ds_read_b128 a[116:119], v243 offset:9216
MV 156,a,80,a,0
MV 160,a,80,a,4
ds_read_b128 a[120:123], v243 offset:10240
buffer_load_dwordx4 v238, s[48:51], s69 offen offset:1024 sc1 lds
MV 164,a,84,a,0
ds_read_b128 a[124:127], v243 offset:11264
MV 168,a,84,a,4
MV 172,a,88,a,0
MV 176,a,88,a,4
MV 180,a,92,a,0
buffer_load_dwordx4 a[0:3], v236, s[44:47], s68 offen offset:0 sc1
MV 184,a,92,a,4
buffer_load_dwordx4 a[4:7], v237, s[44:47], s68 offen offset:0 sc1
s_waitcnt vmcnt(15) lgkmcnt(0)
s_barrier
MV 124,a,96,a,8
ds_read_b128 a[64:67], v242 offset:16384
MV 128,a,96,a,12
ds_read_b128 a[68:71], v242 offset:17408
buffer_load_dwordx4 v238, s[48:51], s69 offen offset:2048 sc1 lds
MV 132,a,100,a,8
MV 136,a,100,a,12
ds_read_b128 a[72:75], v242 offset:18432
MV 140,a,104,a,8
ds_read_b128 a[76:79], v242 offset:19456
MV 144,a,104,a,12
buffer_load_dwordx4 v238, s[48:51], s69 offen offset:3072 sc1 lds
MV 148,a,108,a,8
ds_read_b128 a[80:83], v243 offset:16384
MV 152,a,108,a,12
ds_read_b128 a[84:87], v243 offset:17408
MV 156,a,112,a,8
MV 160,a,112,a,12
ds_read_b128 a[88:91], v243 offset:18432
s_add_u32 s69, s69, 16384
MV 164,a,116,a,8
ds_read_b128 a[92:95], v243 offset:19456
MV 168,a,116,a,12
MV 172,a,120,a,8
MV 176,a,120,a,12
MV 180,a,124,a,8
buffer_load_dwordx4 a[8:11], v236, s[44:47], s68 offen offset:1024 sc1
MV 184,a,124,a,12
buffer_load_dwordx4 a[12:15], v237, s[44:47], s68 offen offset:1024 sc1
s_add_u32 s68, s68, 2048
s_waitcnt lgkmcnt(0)
MV 124,a,64,a,16
ds_read_b128 a[96:99], v242 offset:24576
MV 128,a,64,a,20
ds_read_b128 a[100:103], v242 offset:25600
s_add_u32 m0, s70, 66560
MV 132,a,68,a,16
MV 136,a,68,a,20
ds_read_b128 a[104:107], v242 offset:26624
MV 140,a,72,a,16
ds_read_b128 a[108:111], v242 offset:27648
MV 144,a,72,a,20
buffer_load_dwordx4 v238, s[48:51], s69 offen offset:0 sc1 lds
MV 148,a,76,a,16
ds_read_b128 a[112:115], v243 offset:24576
MV 152,a,76,a,20
ds_read_b128 a[116:119], v243 offset:25600
MV 156,a,80,a,16
MV 160,a,80,a,20
ds_read_b128 a[120:123], v243 offset:26624
buffer_load_dwordx4 v238, s[48:51], s69 offen offset:1024 sc1 lds
MV 164,a,84,a,16
ds_read_b128 a[124:127], v243 offset:27648
MV 168,a,84,a,20
MV 172,a,88,a,16
MV 176,a,88,a,20
MV 180,a,92,a,16
buffer_load_dwordx4 a[16:19], v236, s[44:47], s68 offen offset:0 sc1
MV 184,a,92,a,20
buffer_load_dwordx4 a[20:23], v237, s[44:47], s68 offen offset:0 sc1
s_waitcnt vmcnt(14) lgkmcnt(0)
s_barrier
MV 124,a,96,a,24
ds_read_b128 a[64:67], v242 offset:32768
MV 128,a,96,a,28
ds_read_b128 a[68:71], v242 offset:33792
buffer_load_dwordx4 v238, s[48:51], s69 offen offset:2048 sc1 lds
MV 132,a,100,a,24
MV 136,a,100,a,28
ds_read_b128 a[72:75], v242 offset:34816
MV 140,a,104,a,24
ds_read_b128 a[76:79], v242 offset:35840
MV 144,a,104,a,28
buffer_load_dwordx4 v238, s[48:51], s69 offen offset:3072 sc1 lds
MV 148,a,108,a,24
ds_read_b128 a[80:83], v243 offset:32768
MV 152,a,108,a,28
ds_read_b128 a[84:87], v243 offset:33792
MV 156,a,112,a,24
MV 160,a,112,a,28
ds_read_b128 a[88:91], v243 offset:34816
s_add_u32 s69, s69, 16384
MV 164,a,116,a,24
ds_read_b128 a[92:95], v243 offset:35840
MV 168,a,116,a,28
MV 172,a,120,a,24
MV 176,a,120,a,28
MV 180,a,124,a,24
buffer_load_dwordx4 a[24:27], v236, s[44:47], s68 offen offset:1024 sc1
MV 184,a,124,a,28
buffer_load_dwordx4 a[28:31], v237, s[44:47], s68 offen offset:1024 sc1
s_add_u32 s68, s68, 2048
s_waitcnt lgkmcnt(0)
MV 124,a,64,a,32
ds_read_b128 a[96:99], v242 offset:40960
MV 128,a,64,a,36
ds_read_b128 a[100:103], v242 offset:41984
s_add_u32 m0, s70, 82944
MV 132,a,68,a,32
MV 136,a,68,a,36
ds_read_b128 a[104:107], v242 offset:43008
MV 140,a,72,a,32
ds_read_b128 a[108:111], v242 offset:44032
MV 144,a,72,a,36
buffer_load_dwordx4 v238, s[48:51], s69 offen offset:0 sc1 lds
MV 148,a,76,a,32
ds_read_b128 a[112:115], v243 offset:40960
MV 152,a,76,a,36
ds_read_b128 a[116:119], v243 offset:41984
MV 156,a,80,a,32
MV 160,a,80,a,36
ds_read_b128 a[120:123], v243 offset:43008
buffer_load_dwordx4 v238, s[48:51], s69 offen offset:1024 sc1 lds
MV 164,a,84,a,32
ds_read_b128 a[124:127], v243 offset:44032
MV 168,a,84,a,36
MV 172,a,88,a,32
MV 176,a,88,a,36
MV 180,a,92,a,32
buffer_load_dwordx4 a[32:35], v236, s[44:47], s68 offen offset:0 sc1
MV 184,a,92,a,36
buffer_load_dwordx4 a[36:39], v237, s[44:47], s68 offen offset:0 sc1
s_waitcnt vmcnt(14) lgkmcnt(0)
s_barrier
MV 124,a,96,a,40
ds_read_b128 a[64:67], v242 offset:49152
MV 128,a,96,a,44
ds_read_b128 a[68:71], v242 offset:50176
buffer_load_dwordx4 v238, s[48:51], s69 offen offset:2048 sc1 lds
MV 132,a,100,a,40
MV 136,a,100,a,44
ds_read_b128 a[72:75], v242 offset:51200
MV 140,a,104,a,40
ds_read_b128 a[76:79], v242 offset:52224
MV 144,a,104,a,44
buffer_load_dwordx4 v238, s[48:51], s69 offen offset:3072 sc1 lds
MV 148,a,108,a,40
ds_read_b128 a[80:83], v243 offset:49152
MV 152,a,108,a,44
ds_read_b128 a[84:87], v243 offset:50176
MV 156,a,112,a,40
MV 160,a,112,a,44
ds_read_b128 a[88:91], v243 offset:51200
s_add_u32 s69, s69, 16384
MV 164,a,116,a,40
ds_read_b128 a[92:95], v243 offset:52224
MV 168,a,116,a,44
MV 172,a,120,a,40
MV 176,a,120,a,44
MV 180,a,124,a,40
buffer_load_dwordx4 a[40:43], v236, s[44:47], s68 offen offset:1024 sc1
MV 184,a,124,a,44
buffer_load_dwordx4 a[44:47], v237, s[44:47], s68 offen offset:1024 sc1
s_add_u32 s68, s68, 2048
s_waitcnt lgkmcnt(0)
MV 124,a,64,a,48
ds_read_b128 a[96:99], v242 offset:57344
MV 128,a,64,a,52
ds_read_b128 a[100:103], v242 offset:58368
s_add_u32 m0, s70, 99328
MV 132,a,68,a,48
v_cmp_gt_u32 vcc, 1, v253
s_nop 4
s_cbranch_vccnz L_spin_f3
L_spin_f3_ret:
MV 136,a,68,a,52
ds_read_b128 a[104:107], v242 offset:59392
MV 140,a,72,a,48
ds_read_b128 a[108:111], v242 offset:60416
MV 144,a,72,a,52
buffer_load_dwordx4 v238, s[48:51], s69 offen offset:0 sc1 lds
MV 148,a,76,a,48
ds_read_b128 a[112:115], v243 offset:57344
MV 152,a,76,a,52
ds_read_b128 a[116:119], v243 offset:58368
MV 156,a,80,a,48
MV 160,a,80,a,52
ds_read_b128 a[120:123], v243 offset:59392
buffer_load_dwordx4 v238, s[48:51], s69 offen offset:1024 sc1 lds
MV 164,a,84,a,48
ds_read_b128 a[124:127], v243 offset:60416
MV 168,a,84,a,52
MV 172,a,88,a,48
s_add_u32 s72, s79, 0
MV 176,a,88,a,52
MV 180,a,92,a,48
buffer_load_dwordx4 a[48:51], v236, s[44:47], s68 offen offset:0 sc1
buffer_load_dwordx2 v[208:209], v251, s[56:59], s72 offen offset:0 sc1
MV 184,a,92,a,52
buffer_load_dwordx4 a[52:55], v237, s[44:47], s68 offen offset:0 sc1
s_waitcnt vmcnt(15) lgkmcnt(0)
s_barrier
MV 124,a,96,a,56
ds_read_b128 a[64:67], v242 offset:0
s_add_u32 s72, s79, 16384
MV 128,a,96,a,60
ds_read_b128 a[68:71], v242 offset:1024
buffer_load_dwordx4 v238, s[48:51], s69 offen offset:2048 sc1 lds
MV 132,a,100,a,56
MV 136,a,100,a,60
ds_read_b128 a[72:75], v242 offset:2048
MV 140,a,104,a,56
ds_read_b128 a[76:79], v242 offset:3072
MV 144,a,104,a,60
buffer_load_dwordx4 v238, s[48:51], s69 offen offset:3072 sc1 lds
MV 148,a,108,a,56
ds_read_b128 a[80:83], v243 offset:0
MV 152,a,108,a,60
ds_read_b128 a[84:87], v243 offset:1024
MV 156,a,112,a,56
buffer_load_dwordx2 v[210:211], v251, s[56:59], s72 offen offset:0 sc1
MV 160,a,112,a,60
ds_read_b128 a[88:91], v243 offset:2048
s_add_u32 s69, s69, 16384
MV 164,a,116,a,56
ds_read_b128 a[92:95], v243 offset:3072
MV 168,a,116,a,60
MV 172,a,120,a,56
MV 176,a,120,a,60
MV 180,a,124,a,56
buffer_load_dwordx4 a[56:59], v236, s[44:47], s68 offen offset:1024 sc1
MV 184,a,124,a,60
buffer_load_dwordx4 a[60:63], v237, s[44:47], s68 offen offset:1024 sc1
s_add_u32 s68, s68, 2048
s_waitcnt lgkmcnt(0)
MV 124,a,64,a,0
ds_read_b128 a[96:99], v242 offset:8192
s_add_u32 s72, s79, 131072
MV 128,a,64,a,4
ds_read_b128 a[100:103], v242 offset:9216
s_add_u32 m0, s70, 115712
MV 132,a,68,a,0
MV 136,a,68,a,4
ds_read_b128 a[104:107], v242 offset:10240
MV 140,a,72,a,0
ds_read_b128 a[108:111], v242 offset:11264
MV 144,a,72,a,4
buffer_load_dwordx4 v238, s[48:51], s69 offen offset:0 sc1 lds
MV 148,a,76,a,0
ds_read_b128 a[112:115], v243 offset:8192
MV 152,a,76,a,4
ds_read_b128 a[116:119], v243 offset:9216
MV 156,a,80,a,0
buffer_load_dwordx2 v[212:213], v251, s[56:59], s72 offen offset:0 sc1
MV 160,a,80,a,4
ds_read_b128 a[120:123], v243 offset:10240
buffer_load_dwordx4 v238, s[48:51], s69 offen offset:1024 sc1 lds
MV 164,a,84,a,0
ds_read_b128 a[124:127], v243 offset:11264
MV 168,a,84,a,4
MV 172,a,88,a,0
MV 176,a,88,a,4
MV 180,a,92,a,0
buffer_load_dwordx4 a[0:3], v236, s[44:47], s68 offen offset:0 sc1
MV 184,a,92,a,4
buffer_load_dwordx4 a[4:7], v237, s[44:47], s68 offen offset:0 sc1
s_waitcnt vmcnt(17) lgkmcnt(0)
s_barrier
MV 124,a,96,a,8
ds_read_b128 a[64:67], v242 offset:16384
s_add_u32 s72, s79, 147456
MV 128,a,96,a,12
ds_read_b128 a[68:71], v242 offset:17408
buffer_load_dwordx4 v238, s[48:51], s69 offen offset:2048 sc1 lds
MV 132,a,100,a,8
MV 136,a,100,a,12
ds_read_b128 a[72:75], v242 offset:18432
MV 140,a,104,a,8
ds_read_b128 a[76:79], v242 offset:19456
MV 144,a,104,a,12
buffer_load_dwordx4 v238, s[48:51], s69 offen offset:3072 sc1 lds
MV 148,a,108,a,8
ds_read_b128 a[80:83], v243 offset:16384
MV 152,a,108,a,12
ds_read_b128 a[84:87], v243 offset:17408
MV 156,a,112,a,8
buffer_load_dwordx2 v[214:215], v251, s[56:59], s72 offen offset:0 sc1
MV 160,a,112,a,12
ds_read_b128 a[88:91], v243 offset:18432
s_add_u32 s69, s69, 16384
MV 164,a,116,a,8
ds_read_b128 a[92:95], v243 offset:19456
MV 168,a,116,a,12
MV 172,a,120,a,8
MV 176,a,120,a,12
MV 180,a,124,a,8
buffer_load_dwordx4 a[8:11], v236, s[44:47], s68 offen offset:1024 sc1
MV 184,a,124,a,12
buffer_load_dwordx4 a[12:15], v237, s[44:47], s68 offen offset:1024 sc1
s_add_u32 s68, s68, 2048
s_waitcnt lgkmcnt(0)
MV 124,a,64,a,16
ds_read_b128 a[96:99], v242 offset:24576
s_add_u32 s72, s79, 0
MV 128,a,64,a,20
ds_read_b128 a[100:103], v242 offset:25600
s_add_u32 m0, s70, 66560
MV 132,a,68,a,16
MV 136,a,68,a,20
ds_read_b128 a[104:107], v242 offset:26624
MV 140,a,72,a,16
ds_read_b128 a[108:111], v242 offset:27648
MV 144,a,72,a,20
buffer_load_dwordx4 v238, s[48:51], s69 offen offset:0 sc1 lds
MV 148,a,76,a,16
ds_read_b128 a[112:115], v243 offset:24576
MV 152,a,76,a,20
ds_read_b128 a[116:119], v243 offset:25600
MV 156,a,80,a,16
buffer_load_dwordx2 v[216:217], v251, s[56:59], s72 offen offset:128 sc1
MV 160,a,80,a,20
ds_read_b128 a[120:123], v243 offset:26624
buffer_load_dwordx4 v238, s[48:51], s69 offen offset:1024 sc1 lds
MV 164,a,84,a,16
ds_read_b128 a[124:127], v243 offset:27648
MV 168,a,84,a,20
MV 172,a,88,a,16
MV 176,a,88,a,20
MV 180,a,92,a,16
buffer_load_dwordx4 a[16:19], v236, s[44:47], s68 offen offset:0 sc1
MV 184,a,92,a,20
buffer_load_dwordx4 a[20:23], v237, s[44:47], s68 offen offset:0 sc1
s_waitcnt vmcnt(18) lgkmcnt(0)
s_barrier
MV 124,a,96,a,24
ds_read_b128 a[64:67], v242 offset:32768
s_add_u32 s72, s79, 16384
MV 128,a,96,a,28
ds_read_b128 a[68:71], v242 offset:33792
buffer_load_dwordx4 v238, s[48:51], s69 offen offset:2048 sc1 lds
MV 132,a,100,a,24
MV 136,a,100,a,28
ds_read_b128 a[72:75], v242 offset:34816
MV 140,a,104,a,24
ds_read_b128 a[76:79], v242 offset:35840
MV 144,a,104,a,28
buffer_load_dwordx4 v238, s[48:51], s69 offen offset:3072 sc1 lds
MV 148,a,108,a,24
ds_read_b128 a[80:83], v243 offset:32768
MV 152,a,108,a,28
ds_read_b128 a[84:87], v243 offset:33792
MV 156,a,112,a,24
buffer_load_dwordx2 v[218:219], v251, s[56:59], s72 offen offset:128 sc1
MV 160,a,112,a,28
ds_read_b128 a[88:91], v243 offset:34816
s_add_u32 s69, s69, 16384
MV 164,a,116,a,24
ds_read_b128 a[92:95], v243 offset:35840
MV 168,a,116,a,28
MV 172,a,120,a,24
MV 176,a,120,a,28
MV 180,a,124,a,24
buffer_load_dwordx4 a[24:27], v236, s[44:47], s68 offen offset:1024 sc1
MV 184,a,124,a,28
buffer_load_dwordx4 a[28:31], v237, s[44:47], s68 offen offset:1024 sc1
s_add_u32 s68, s68, 2048
s_waitcnt lgkmcnt(0)
MV 124,a,64,a,32
ds_read_b128 a[96:99], v242 offset:40960
s_add_u32 s72, s79, 131072
MV 128,a,64,a,36
ds_read_b128 a[100:103], v242 offset:41984
s_add_u32 m0, s70, 82944
MV 132,a,68,a,32
MV 136,a,68,a,36
ds_read_b128 a[104:107], v242 offset:43008
MV 140,a,72,a,32
ds_read_b128 a[108:111], v242 offset:44032
MV 144,a,72,a,36
buffer_load_dwordx4 v238, s[48:51], s69 offen offset:0 sc1 lds
MV 148,a,76,a,32
ds_read_b128 a[112:115], v243 offset:40960
MV 152,a,76,a,36
ds_read_b128 a[116:119], v243 offset:41984
MV 156,a,80,a,32
buffer_load_dwordx2 v[220:221], v251, s[56:59], s72 offen offset:128 sc1
MV 160,a,80,a,36
ds_read_b128 a[120:123], v243 offset:43008
buffer_load_dwordx4 v238, s[48:51], s69 offen offset:1024 sc1 lds
MV 164,a,84,a,32
ds_read_b128 a[124:127], v243 offset:44032
MV 168,a,84,a,36
MV 172,a,88,a,32
MV 176,a,88,a,36
MV 180,a,92,a,32
buffer_load_dwordx4 a[32:35], v236, s[44:47], s68 offen offset:0 sc1
MV 184,a,92,a,36
buffer_load_dwordx4 a[36:39], v237, s[44:47], s68 offen offset:0 sc1
s_waitcnt vmcnt(18) lgkmcnt(0)
s_barrier
MV 124,a,96,a,40
ds_read_b128 a[64:67], v242 offset:49152
s_add_u32 s72, s79, 147456
MV 128,a,96,a,44
ds_read_b128 a[68:71], v242 offset:50176
buffer_load_dwordx4 v238, s[48:51], s69 offen offset:2048 sc1 lds
MV 132,a,100,a,40
MV 136,a,100,a,44
ds_read_b128 a[72:75], v242 offset:51200
MV 140,a,104,a,40
ds_read_b128 a[76:79], v242 offset:52224
MV 144,a,104,a,44
buffer_load_dwordx4 v238, s[48:51], s69 offen offset:3072 sc1 lds
MV 148,a,108,a,40
ds_read_b128 a[80:83], v243 offset:49152
MV 152,a,108,a,44
ds_read_b128 a[84:87], v243 offset:50176
MV 156,a,112,a,40
buffer_load_dwordx2 v[222:223], v251, s[56:59], s72 offen offset:128 sc1
MV 160,a,112,a,44
ds_read_b128 a[88:91], v243 offset:51200
s_add_u32 s69, s69, 16384
MV 164,a,116,a,40
ds_read_b128 a[92:95], v243 offset:52224
MV 168,a,116,a,44
MV 172,a,120,a,40
MV 176,a,120,a,44
MV 180,a,124,a,40
buffer_load_dwordx4 a[40:43], v236, s[44:47], s68 offen offset:1024 sc1
MV 184,a,124,a,44
buffer_load_dwordx4 a[44:47], v237, s[44:47], s68 offen offset:1024 sc1
s_add_u32 s68, s68, 2048
s_waitcnt lgkmcnt(0)
MV 124,a,64,a,48
ds_read_b128 a[96:99], v242 offset:57344
MV 128,a,64,a,52
ds_read_b128 a[100:103], v242 offset:58368
s_add_u32 m0, s70, 99328
MV 132,a,68,a,48
MV 136,a,68,a,52
ds_read_b128 a[104:107], v242 offset:59392
MV 140,a,72,a,48
ds_read_b128 a[108:111], v242 offset:60416
MV 144,a,72,a,52
buffer_load_dwordx4 v238, s[48:51], s69 offen offset:0 sc1 lds
MV 148,a,76,a,48
ds_read_b128 a[112:115], v243 offset:57344
MV 152,a,76,a,52
ds_read_b128 a[116:119], v243 offset:58368
MV 156,a,80,a,48
MV 160,a,80,a,52
ds_read_b128 a[120:123], v243 offset:59392
buffer_load_dwordx4 v238, s[48:51], s69 offen offset:1024 sc1 lds
MV 164,a,84,a,48
ds_read_b128 a[124:127], v243 offset:60416
MV 168,a,84,a,52
MV 172,a,88,a,48
MV 176,a,88,a,52
MV 180,a,92,a,48
buffer_load_dwordx4 a[48:51], v236, s[44:47], s68 offen offset:0 sc1
MV 184,a,92,a,52
buffer_load_dwordx4 a[52:55], v237, s[44:47], s68 offen offset:0 sc1
s_waitcnt vmcnt(17) lgkmcnt(0)
s_barrier
MV 124,a,96,a,56
ds_read_b128 a[64:67], v242 offset:0
MV 128,a,96,a,60
ds_read_b128 a[68:71], v242 offset:1024
buffer_load_dwordx4 v238, s[48:51], s69 offen offset:2048 sc1 lds
MV 132,a,100,a,56
MV 136,a,100,a,60
ds_read_b128 a[72:75], v242 offset:2048
MV 140,a,104,a,56
ds_read_b128 a[76:79], v242 offset:3072
MV 144,a,104,a,60
buffer_load_dwordx4 v238, s[48:51], s69 offen offset:3072 sc1 lds
MV 148,a,108,a,56
ds_read_b128 a[80:83], v243 offset:0
MV 152,a,108,a,60
ds_read_b128 a[84:87], v243 offset:1024
MV 156,a,112,a,56
MV 160,a,112,a,60
ds_read_b128 a[88:91], v243 offset:2048
s_add_u32 s69, s69, 16384
MV 164,a,116,a,56
ds_read_b128 a[92:95], v243 offset:3072
MV 168,a,116,a,60
MV 172,a,120,a,56
MV 176,a,120,a,60
MV 180,a,124,a,56
buffer_load_dwordx4 a[56:59], v236, s[44:47], s68 offen offset:1024 sc1
MV 184,a,124,a,60
buffer_load_dwordx4 a[60:63], v237, s[44:47], s68 offen offset:1024 sc1
s_add_u32 s68, s68, 2048
s_waitcnt lgkmcnt(0)
MV 124,a,64,a,0
ds_read_b128 a[96:99], v242 offset:8192
MV 128,a,64,a,4
ds_read_b128 a[100:103], v242 offset:9216
s_add_u32 m0, s70, 115712
MV 132,a,68,a,0
MV 136,a,68,a,4
ds_read_b128 a[104:107], v242 offset:10240
MV 140,a,72,a,0
ds_read_b128 a[108:111], v242 offset:11264
MV 144,a,72,a,4
buffer_load_dwordx4 v238, s[48:51], s69 offen offset:0 sc1 lds
MV 148,a,76,a,0
ds_read_b128 a[112:115], v243 offset:8192
MV 152,a,76,a,4
ds_read_b128 a[116:119], v243 offset:9216
MV 156,a,80,a,0
MV 160,a,80,a,4
ds_read_b128 a[120:123], v243 offset:10240
buffer_load_dwordx4 v238, s[48:51], s69 offen offset:1024 sc1 lds
MV 164,a,84,a,0
ds_read_b128 a[124:127], v243 offset:11264
MV 168,a,84,a,4
MV 172,a,88,a,0
MV 176,a,88,a,4
MV 180,a,92,a,0
buffer_load_dwordx4 a[0:3], v236, s[44:47], s68 offen offset:0 sc1
MV 184,a,92,a,4
buffer_load_dwordx4 a[4:7], v237, s[44:47], s68 offen offset:0 sc1
s_waitcnt vmcnt(15) lgkmcnt(0)
s_barrier
MV 124,a,96,a,8
ds_read_b128 a[64:67], v242 offset:16384
MV 128,a,96,a,12
ds_read_b128 a[68:71], v242 offset:17408
buffer_load_dwordx4 v238, s[48:51], s69 offen offset:2048 sc1 lds
MV 132,a,100,a,8
MV 136,a,100,a,12
ds_read_b128 a[72:75], v242 offset:18432
MV 140,a,104,a,8
ds_read_b128 a[76:79], v242 offset:19456
MV 144,a,104,a,12
buffer_load_dwordx4 v238, s[48:51], s69 offen offset:3072 sc1 lds
MV 148,a,108,a,8
ds_read_b128 a[80:83], v243 offset:16384
MV 152,a,108,a,12
ds_read_b128 a[84:87], v243 offset:17408
MV 156,a,112,a,8
MV 160,a,112,a,12
ds_read_b128 a[88:91], v243 offset:18432
s_add_u32 s69, s69, 16384
MV 164,a,116,a,8
ds_read_b128 a[92:95], v243 offset:19456
MV 168,a,116,a,12
MV 172,a,120,a,8
MV 176,a,120,a,12
MV 180,a,124,a,8
buffer_load_dwordx4 a[8:11], v236, s[44:47], s68 offen offset:1024 sc1
MV 184,a,124,a,12
buffer_load_dwordx4 a[12:15], v237, s[44:47], s68 offen offset:1024 sc1
s_add_u32 s68, s68, 2048
s_waitcnt lgkmcnt(0)
MV 124,a,64,a,16
ds_read_b128 a[96:99], v242 offset:24576
v_sub_f32 v8, 1.0, v6
MV 128,a,64,a,20
ds_read_b128 a[100:103], v242 offset:25600
s_add_u32 m0, s70, 66560
MV 132,a,68,a,16
v_lshlrev_b32 v36, 16, v192
v_lshlrev_b32 v228, 16, v208
MV 136,a,68,a,20
ds_read_b128 a[104:107], v242 offset:26624
v_and_b32 v37, 0xffff0000, v192
MV 140,a,72,a,16
ds_read_b128 a[108:111], v242 offset:27648
v_and_b32 v229, 0xffff0000, v208
MV 144,a,72,a,20
buffer_load_dwordx4 v238, s[48:51], s69 offen offset:0 sc1 lds
v_mul_f32 v36, v36, v228
MV 148,a,76,a,16
ds_read_b128 a[112:115], v243 offset:24576
v_mul_f32 v37, v37, v229
MV 152,a,76,a,20
ds_read_b128 a[116:119], v243 offset:25600
v_mul_f32 v36, v36, v6
MV 156,a,80,a,16
v_mul_f32 v37, v37, v6
MV 160,a,80,a,20
ds_read_b128 a[120:123], v243 offset:26624
buffer_load_dwordx4 v238, s[48:51], s69 offen offset:1024 sc1 lds
MV 164,a,84,a,16
ds_read_b128 a[124:127], v243 offset:27648
v_lshlrev_b32 v38, 16, v193
MV 168,a,84,a,20
v_lshlrev_b32 v228, 16, v209
v_and_b32 v39, 0xffff0000, v193
MV 172,a,88,a,16
v_and_b32 v229, 0xffff0000, v209
MV 176,a,88,a,20
v_mul_f32 v38, v38, v228
MV 180,a,92,a,16
buffer_load_dwordx4 a[16:19], v236, s[44:47], s68 offen offset:0 sc1
v_mul_f32 v39, v39, v229
MV 184,a,92,a,20
buffer_load_dwordx4 a[20:23], v237, s[44:47], s68 offen offset:0 sc1
v_mul_f32 v38, v38, v6
s_waitcnt vmcnt(14) lgkmcnt(0)
s_barrier
MV 124,a,96,a,24
ds_read_b128 a[64:67], v242 offset:32768
v_mul_f32 v39, v39, v6
MV 128,a,96,a,28
ds_read_b128 a[68:71], v242 offset:33792
buffer_load_dwordx4 v238, s[48:51], s69 offen offset:2048 sc1 lds
MV 132,a,100,a,24
v_lshlrev_b32 v40, 16, v194
v_lshlrev_b32 v228, 16, v210
MV 136,a,100,a,28
ds_read_b128 a[72:75], v242 offset:34816
v_and_b32 v41, 0xffff0000, v194
MV 140,a,104,a,24
ds_read_b128 a[76:79], v242 offset:35840
v_and_b32 v229, 0xffff0000, v210
MV 144,a,104,a,28
buffer_load_dwordx4 v238, s[48:51], s69 offen offset:3072 sc1 lds
v_mul_f32 v40, v40, v228
MV 148,a,108,a,24
ds_read_b128 a[80:83], v243 offset:32768
v_mul_f32 v41, v41, v229
MV 152,a,108,a,28
ds_read_b128 a[84:87], v243 offset:33792
v_mul_f32 v40, v40, v6
MV 156,a,112,a,24
v_mul_f32 v41, v41, v6
MV 160,a,112,a,28
ds_read_b128 a[88:91], v243 offset:34816
s_add_u32 s69, s69, 16384
MV 164,a,116,a,24
ds_read_b128 a[92:95], v243 offset:35840
v_lshlrev_b32 v42, 16, v195
MV 168,a,116,a,28
v_lshlrev_b32 v228, 16, v211
v_and_b32 v43, 0xffff0000, v195
MV 172,a,120,a,24
v_and_b32 v229, 0xffff0000, v211
MV 176,a,120,a,28
v_mul_f32 v42, v42, v228
MV 180,a,124,a,24
buffer_load_dwordx4 a[24:27], v236, s[44:47], s68 offen offset:1024 sc1
v_mul_f32 v43, v43, v229
MV 184,a,124,a,28
buffer_load_dwordx4 a[28:31], v237, s[44:47], s68 offen offset:1024 sc1
s_add_u32 s68, s68, 2048
v_mul_f32 v42, v42, v6
s_waitcnt lgkmcnt(0)
MV 124,a,64,a,32
ds_read_b128 a[96:99], v242 offset:40960
v_mul_f32 v43, v43, v6
MV 128,a,64,a,36
ds_read_b128 a[100:103], v242 offset:41984
s_add_u32 m0, s70, 82944
MV 132,a,68,a,32
v_lshlrev_b32 v44, 16, v196
v_lshlrev_b32 v228, 16, v212
MV 136,a,68,a,36
ds_read_b128 a[104:107], v242 offset:43008
v_and_b32 v45, 0xffff0000, v196
MV 140,a,72,a,32
ds_read_b128 a[108:111], v242 offset:44032
v_and_b32 v229, 0xffff0000, v212
MV 144,a,72,a,36
buffer_load_dwordx4 v238, s[48:51], s69 offen offset:0 sc1 lds
v_mul_f32 v44, v44, v228
MV 148,a,76,a,32
ds_read_b128 a[112:115], v243 offset:40960
v_mul_f32 v45, v45, v229
MV 152,a,76,a,36
ds_read_b128 a[116:119], v243 offset:41984
v_mul_f32 v44, v44, v6
MV 156,a,80,a,32
v_mul_f32 v45, v45, v6
MV 160,a,80,a,36
ds_read_b128 a[120:123], v243 offset:43008
buffer_load_dwordx4 v238, s[48:51], s69 offen offset:1024 sc1 lds
MV 164,a,84,a,32
ds_read_b128 a[124:127], v243 offset:44032
v_lshlrev_b32 v46, 16, v197
MV 168,a,84,a,36
v_lshlrev_b32 v228, 16, v213
v_and_b32 v47, 0xffff0000, v197
MV 172,a,88,a,32
v_and_b32 v229, 0xffff0000, v213
MV 176,a,88,a,36
v_mul_f32 v46, v46, v228
MV 180,a,92,a,32
buffer_load_dwordx4 a[32:35], v236, s[44:47], s68 offen offset:0 sc1
v_mul_f32 v47, v47, v229
MV 184,a,92,a,36
buffer_load_dwordx4 a[36:39], v237, s[44:47], s68 offen offset:0 sc1
v_mul_f32 v46, v46, v6
s_waitcnt vmcnt(14) lgkmcnt(0)
s_barrier
MV 124,a,96,a,40
ds_read_b128 a[64:67], v242 offset:49152
v_mul_f32 v47, v47, v6
MV 128,a,96,a,44
ds_read_b128 a[68:71], v242 offset:50176
buffer_load_dwordx4 v238, s[48:51], s69 offen offset:2048 sc1 lds
MV 132,a,100,a,40
v_lshlrev_b32 v48, 16, v198
v_lshlrev_b32 v228, 16, v214
MV 136,a,100,a,44
ds_read_b128 a[72:75], v242 offset:51200
v_and_b32 v49, 0xffff0000, v198
MV 140,a,104,a,40
ds_read_b128 a[76:79], v242 offset:52224
v_and_b32 v229, 0xffff0000, v214
MV 144,a,104,a,44
buffer_load_dwordx4 v238, s[48:51], s69 offen offset:3072 sc1 lds
v_mul_f32 v48, v48, v228
MV 148,a,108,a,40
ds_read_b128 a[80:83], v243 offset:49152
v_mul_f32 v49, v49, v229
MV 152,a,108,a,44
ds_read_b128 a[84:87], v243 offset:50176
v_mul_f32 v48, v48, v6
MV 156,a,112,a,40
v_mul_f32 v49, v49, v6
v_lshlrev_b32 v50, 16, v199
MV 160,a,112,a,44
ds_read_b128 a[88:91], v243 offset:51200
s_add_u32 s69, s69, 16384
MV 164,a,116,a,40
ds_read_b128 a[92:95], v243 offset:52224
v_lshlrev_b32 v228, 16, v215
MV 168,a,116,a,44
v_and_b32 v51, 0xffff0000, v199
v_and_b32 v229, 0xffff0000, v215
MV 172,a,120,a,40
v_mul_f32 v50, v50, v228
MV 176,a,120,a,44
v_mul_f32 v51, v51, v229
MV 180,a,124,a,40
buffer_load_dwordx4 a[40:43], v236, s[44:47], s68 offen offset:1024 sc1
v_mul_f32 v50, v50, v6
MV 184,a,124,a,44
buffer_load_dwordx4 a[44:47], v237, s[44:47], s68 offen offset:1024 sc1
s_add_u32 s68, s68, 2048
v_mul_f32 v51, v51, v6
s_waitcnt lgkmcnt(0)
MV 124,a,64,a,48
ds_read_b128 a[96:99], v242 offset:57344
v_sub_f32 v9, 1.0, v7
MV 128,a,64,a,52
ds_read_b128 a[100:103], v242 offset:58368
s_add_u32 m0, s70, 99328
MV 132,a,68,a,48
v_lshlrev_b32 v52, 16, v200
v_lshlrev_b32 v228, 16, v216
MV 136,a,68,a,52
ds_read_b128 a[104:107], v242 offset:59392
v_and_b32 v53, 0xffff0000, v200
MV 140,a,72,a,48
ds_read_b128 a[108:111], v242 offset:60416
v_and_b32 v229, 0xffff0000, v216
MV 144,a,72,a,52
buffer_load_dwordx4 v238, s[48:51], s69 offen offset:0 sc1 lds
v_mul_f32 v52, v52, v228
MV 148,a,76,a,48
ds_read_b128 a[112:115], v243 offset:57344
v_mul_f32 v53, v53, v229
MV 152,a,76,a,52
ds_read_b128 a[116:119], v243 offset:58368
v_mul_f32 v52, v52, v7
MV 156,a,80,a,48
v_mul_f32 v53, v53, v7
MV 160,a,80,a,52
ds_read_b128 a[120:123], v243 offset:59392
buffer_load_dwordx4 v238, s[48:51], s69 offen offset:1024 sc1 lds
MV 164,a,84,a,48
ds_read_b128 a[124:127], v243 offset:60416
v_lshlrev_b32 v54, 16, v201
MV 168,a,84,a,52
v_lshlrev_b32 v228, 16, v217
v_and_b32 v55, 0xffff0000, v201
MV 172,a,88,a,48
v_and_b32 v229, 0xffff0000, v217
MV 176,a,88,a,52
v_mul_f32 v54, v54, v228
MV 180,a,92,a,48
buffer_load_dwordx4 a[48:51], v236, s[44:47], s68 offen offset:0 sc1
v_mul_f32 v55, v55, v229
MV 184,a,92,a,52
buffer_load_dwordx4 a[52:55], v237, s[44:47], s68 offen offset:0 sc1
v_mul_f32 v54, v54, v7
s_waitcnt vmcnt(14) lgkmcnt(0)
s_barrier
MV 124,a,96,a,56
ds_read_b128 a[64:67], v242 offset:0
v_mul_f32 v55, v55, v7
MV 128,a,96,a,60
ds_read_b128 a[68:71], v242 offset:1024
buffer_load_dwordx4 v238, s[48:51], s69 offen offset:2048 sc1 lds
MV 132,a,100,a,56
v_lshlrev_b32 v56, 16, v202
v_lshlrev_b32 v228, 16, v218
MV 136,a,100,a,60
ds_read_b128 a[72:75], v242 offset:2048
v_and_b32 v57, 0xffff0000, v202
MV 140,a,104,a,56
ds_read_b128 a[76:79], v242 offset:3072
v_and_b32 v229, 0xffff0000, v218
MV 144,a,104,a,60
buffer_load_dwordx4 v238, s[48:51], s69 offen offset:3072 sc1 lds
v_mul_f32 v56, v56, v228
MV 148,a,108,a,56
ds_read_b128 a[80:83], v243 offset:0
v_mul_f32 v57, v57, v229
MV 152,a,108,a,60
ds_read_b128 a[84:87], v243 offset:1024
v_mul_f32 v56, v56, v7
MV 156,a,112,a,56
v_mul_f32 v57, v57, v7
MV 160,a,112,a,60
ds_read_b128 a[88:91], v243 offset:2048
s_add_u32 s69, s69, 16384
MV 164,a,116,a,56
ds_read_b128 a[92:95], v243 offset:3072
v_lshlrev_b32 v58, 16, v203
MV 168,a,116,a,60
v_lshlrev_b32 v228, 16, v219
v_and_b32 v59, 0xffff0000, v203
MV 172,a,120,a,56
v_and_b32 v229, 0xffff0000, v219
MV 176,a,120,a,60
v_mul_f32 v58, v58, v228
MV 180,a,124,a,56
buffer_load_dwordx4 a[56:59], v236, s[44:47], s68 offen offset:1024 sc1
v_mul_f32 v59, v59, v229
MV 184,a,124,a,60
buffer_load_dwordx4 a[60:63], v237, s[44:47], s68 offen offset:1024 sc1
s_add_u32 s68, s68, 2048
v_mul_f32 v58, v58, v7
s_waitcnt lgkmcnt(0)
MV 124,a,64,a,0
ds_read_b128 a[96:99], v242 offset:8192
v_mul_f32 v59, v59, v7
MV 128,a,64,a,4
ds_read_b128 a[100:103], v242 offset:9216
s_add_u32 m0, s70, 115712
MV 132,a,68,a,0
v_lshlrev_b32 v60, 16, v204
v_lshlrev_b32 v228, 16, v220
MV 136,a,68,a,4
ds_read_b128 a[104:107], v242 offset:10240
v_and_b32 v61, 0xffff0000, v204
MV 140,a,72,a,0
ds_read_b128 a[108:111], v242 offset:11264
v_and_b32 v229, 0xffff0000, v220
MV 144,a,72,a,4
buffer_load_dwordx4 v238, s[48:51], s69 offen offset:0 sc1 lds
v_mul_f32 v60, v60, v228
MV 148,a,76,a,0
ds_read_b128 a[112:115], v243 offset:8192
v_mul_f32 v61, v61, v229
MV 152,a,76,a,4
ds_read_b128 a[116:119], v243 offset:9216
v_mul_f32 v60, v60, v7
MV 156,a,80,a,0
v_mul_f32 v61, v61, v7
MV 160,a,80,a,4
ds_read_b128 a[120:123], v243 offset:10240
buffer_load_dwordx4 v238, s[48:51], s69 offen offset:1024 sc1 lds
MV 164,a,84,a,0
ds_read_b128 a[124:127], v243 offset:11264
v_lshlrev_b32 v62, 16, v205
MV 168,a,84,a,4
v_lshlrev_b32 v228, 16, v221
v_and_b32 v63, 0xffff0000, v205
MV 172,a,88,a,0
v_and_b32 v229, 0xffff0000, v221
MV 176,a,88,a,4
v_mul_f32 v62, v62, v228
MV 180,a,92,a,0
v_mul_f32 v63, v63, v229
MV 184,a,92,a,4
v_mul_f32 v62, v62, v7
s_waitcnt vmcnt(12) lgkmcnt(0)
s_barrier
MV 124,a,96,a,8
ds_read_b128 a[80:83], v243 offset:16384
v_mul_f32 v63, v63, v7
MV 128,a,96,a,12
buffer_load_dwordx4 v238, s[48:51], s69 offen offset:2048 sc1 lds
v_lshlrev_b32 v64, 16, v206
MV 132,a,100,a,8
v_lshlrev_b32 v228, 16, v222
v_and_b32 v65, 0xffff0000, v206
MV 136,a,100,a,12
ds_read_b128 a[84:87], v243 offset:17408
v_and_b32 v229, 0xffff0000, v222
MV 140,a,104,a,8
v_mul_f32 v64, v64, v228
MV 144,a,104,a,12
buffer_load_dwordx4 v238, s[48:51], s69 offen offset:3072 sc1 lds
v_mul_f32 v65, v65, v229
MV 148,a,108,a,8
ds_read_b128 a[88:91], v243 offset:18432
v_mul_f32 v64, v64, v7
MV 152,a,108,a,12
v_mul_f32 v65, v65, v7
MV 156,a,112,a,8
v_lshlrev_b32 v66, 16, v207
MV 160,a,112,a,12
ds_read_b128 a[92:95], v243 offset:19456
s_add_u32 s69, s69, 16384
MV 164,a,116,a,8
v_lshlrev_b32 v228, 16, v223
v_and_b32 v67, 0xffff0000, v207
MV 168,a,116,a,12
v_and_b32 v229, 0xffff0000, v223
MV 172,a,120,a,8
v_mul_f32 v66, v66, v228
MV 176,a,120,a,12
v_mul_f32 v67, v67, v229
MV 180,a,124,a,8
v_mul_f32 v66, v66, v7
MV 184,a,124,a,12
v_mul_f32 v67, v67, v7
s_waitcnt lgkmcnt(0)
MV 156,a,80,a,16
ds_read_b128 a[112:115], v243 offset:24576
s_xor_b32 s72, s2, 4
MV 160,a,80,a,20
ds_read_b128 a[116:119], v243 offset:25600
s_lshl_b32 s72, s72, 14
MV 164,a,84,a,16
ds_read_b128 a[120:123], v243 offset:26624
MV 168,a,84,a,20
ds_read_b128 a[124:127], v243 offset:27648
MV 172,a,88,a,16
MV 176,a,88,a,20
MV 180,a,92,a,16
MV 184,a,92,a,20
s_waitcnt vmcnt(6)
s_barrier
s_waitcnt lgkmcnt(3)
MV 156,a,112,a,24
ds_read_b128 a[80:83], v243 offset:32768
MV 160,a,112,a,28
ds_read_b128 a[84:87], v243 offset:33792
s_waitcnt lgkmcnt(4)
MV 164,a,116,a,24
ds_read_b128 a[88:91], v243 offset:34816
MV 168,a,116,a,28
ds_read_b128 a[92:95], v243 offset:35840
s_waitcnt lgkmcnt(5)
MV 172,a,120,a,24
MV 176,a,120,a,28
s_waitcnt lgkmcnt(4)
MV 180,a,124,a,24
MV 184,a,124,a,28
s_waitcnt lgkmcnt(3)
MV 156,a,80,a,32
ds_read_b128 a[112:115], v243 offset:40960
MV 160,a,80,a,36
ds_read_b128 a[116:119], v243 offset:41984
s_waitcnt lgkmcnt(4)
MV 164,a,84,a,32
ds_read_b128 a[120:123], v243 offset:43008
MV 168,a,84,a,36
ds_read_b128 a[124:127], v243 offset:44032
s_waitcnt lgkmcnt(5)
MV 172,a,88,a,32
MV 176,a,88,a,36
s_waitcnt lgkmcnt(4)
MV 180,a,92,a,32
MV 184,a,92,a,36
s_waitcnt vmcnt(0)
s_barrier
s_waitcnt lgkmcnt(3)
MV 156,a,112,a,40
ds_read_b128 a[80:83], v243 offset:49152
MV 160,a,112,a,44
ds_read_b128 a[84:87], v243 offset:50176
s_waitcnt lgkmcnt(4)
MV 164,a,116,a,40
ds_read_b128 a[88:91], v243 offset:51200
MV 168,a,116,a,44
ds_read_b128 a[92:95], v243 offset:52224
s_waitcnt lgkmcnt(5)
MV 172,a,120,a,40
MV 176,a,120,a,44
s_waitcnt lgkmcnt(4)
MV 180,a,124,a,40
MV 184,a,124,a,44
s_waitcnt lgkmcnt(3)
MV 156,a,80,a,48
ds_read_b128 a[112:115], v243 offset:57344
MV 160,a,80,a,52
ds_read_b128 a[116:119], v243 offset:58368
s_waitcnt lgkmcnt(4)
MV 164,a,84,a,48
ds_read_b128 a[120:123], v243 offset:59392
MV 168,a,84,a,52
ds_read_b128 a[124:127], v243 offset:60416
s_waitcnt lgkmcnt(5)
MV 172,a,88,a,48
MV 176,a,88,a,52
s_waitcnt lgkmcnt(4)
MV 180,a,92,a,48
MV 184,a,92,a,52
s_waitcnt lgkmcnt(3)
MV 156,a,112,a,56
ds_read_b128 a[64:67], v242 offset:16384
MV 160,a,112,a,60
ds_read_b128 a[68:71], v242 offset:17408
s_waitcnt lgkmcnt(4)
MV 164,a,116,a,56
ds_read_b128 a[72:75], v242 offset:18432
MV 168,a,116,a,60
ds_read_b128 a[76:79], v242 offset:19456
s_waitcnt lgkmcnt(5)
MV 172,a,120,a,56
MV 176,a,120,a,60
s_waitcnt lgkmcnt(4)
MV 180,a,124,a,56
MV 184,a,124,a,60
s_waitcnt lgkmcnt(3)
MV 124,a,64,a,16
ds_read_b128 a[96:99], v242 offset:24576
MV 128,a,64,a,20
ds_read_b128 a[100:103], v242 offset:25600
s_waitcnt lgkmcnt(4)
MV 132,a,68,a,16
ds_read_b128 a[104:107], v242 offset:26624
v_permlane16_swap_b32 v156, v164
MV 136,a,68,a,20
ds_read_b128 a[108:111], v242 offset:27648
v_permlane16_swap_b32 v157, v165
s_waitcnt lgkmcnt(5)
MV 140,a,72,a,16
v_permlane16_swap_b32 v158, v166
v_permlane16_swap_b32 v159, v167
MV 144,a,72,a,20
v_cvt_pk_bf16_f32 v156, v156, v157
v_cvt_pk_bf16_f32 v157, v158, v159
s_waitcnt lgkmcnt(4)
MV 148,a,76,a,16
v_cvt_pk_bf16_f32 v158, v164, v165
v_cvt_pk_bf16_f32 v159, v166, v167
MV 152,a,76,a,20
buffer_store_dwordx4 v[156:159], v238, s[52:55], s72 offen offset:0 sc1
v_permlane16_swap_b32 v172, v180
s_waitcnt lgkmcnt(3)
MV 124,a,96,a,24
ds_read_b128 a[64:67], v242 offset:32768
v_permlane16_swap_b32 v173, v181
MV 128,a,96,a,28
ds_read_b128 a[68:71], v242 offset:33792
v_permlane16_swap_b32 v174, v182
s_waitcnt lgkmcnt(4)
MV 132,a,100,a,24
ds_read_b128 a[72:75], v242 offset:34816
v_permlane16_swap_b32 v175, v183
MV 136,a,100,a,28
ds_read_b128 a[76:79], v242 offset:35840
v_cvt_pk_bf16_f32 v172, v172, v173
s_waitcnt lgkmcnt(5)
MV 140,a,104,a,24
v_cvt_pk_bf16_f32 v173, v174, v175
v_cvt_pk_bf16_f32 v174, v180, v181
MV 144,a,104,a,28
v_cvt_pk_bf16_f32 v175, v182, v183
buffer_store_dwordx4 v[172:175], v238, s[52:55], s72 offen offset:1024 sc1
s_waitcnt lgkmcnt(4)
MV 148,a,108,a,24
v_permlane16_swap_b32 v160, v168
v_permlane16_swap_b32 v161, v169
MV 152,a,108,a,28
v_permlane16_swap_b32 v162, v170
v_permlane16_swap_b32 v163, v171
s_waitcnt lgkmcnt(3)
MV 124,a,64,a,32
ds_read_b128 a[96:99], v242 offset:40960
v_cvt_pk_bf16_f32 v160, v160, v161
MV 128,a,64,a,36
ds_read_b128 a[100:103], v242 offset:41984
v_cvt_pk_bf16_f32 v161, v162, v163
s_waitcnt lgkmcnt(4)
MV 132,a,68,a,32
ds_read_b128 a[104:107], v242 offset:43008
v_cvt_pk_bf16_f32 v162, v168, v169
MV 136,a,68,a,36
ds_read_b128 a[108:111], v242 offset:44032
v_cvt_pk_bf16_f32 v163, v170, v171
s_waitcnt lgkmcnt(5)
MV 140,a,72,a,32
buffer_store_dwordx4 v[160:163], v238, s[52:55], s72 offen offset:2048 sc1
v_permlane16_swap_b32 v176, v184
MV 144,a,72,a,36
v_permlane16_swap_b32 v177, v185
v_permlane16_swap_b32 v178, v186
s_waitcnt lgkmcnt(4)
MV 148,a,76,a,32
v_permlane16_swap_b32 v179, v187
v_cvt_pk_bf16_f32 v176, v176, v177
MV 152,a,76,a,36
v_cvt_pk_bf16_f32 v177, v178, v179
v_cvt_pk_bf16_f32 v178, v184, v185
s_waitcnt lgkmcnt(3)
MV 124,a,96,a,40
ds_read_b128 a[64:67], v242 offset:49152
v_cvt_pk_bf16_f32 v179, v186, v187
MV 128,a,96,a,44
ds_read_b128 a[68:71], v242 offset:50176
buffer_store_dwordx4 v[176:179], v238, s[52:55], s72 offen offset:3072 sc1
s_waitcnt lgkmcnt(4)
MV 132,a,100,a,40
ds_read_b128 a[72:75], v242 offset:51200
MV 136,a,100,a,44
ds_read_b128 a[76:79], v242 offset:52224
s_waitcnt lgkmcnt(5)
MV 140,a,104,a,40
MV 144,a,104,a,44
s_waitcnt lgkmcnt(4)
MV 148,a,108,a,40
MV 152,a,108,a,44
s_waitcnt lgkmcnt(3)
MV 124,a,64,a,48
ds_read_b128 a[96:99], v242 offset:57344
MV 128,a,64,a,52
ds_read_b128 a[100:103], v242 offset:58368
s_waitcnt lgkmcnt(4)
MV 132,a,68,a,48
ds_read_b128 a[104:107], v242 offset:59392
MV 136,a,68,a,52
ds_read_b128 a[108:111], v242 offset:60416
s_waitcnt lgkmcnt(5)
MV 140,a,72,a,48
MV 144,a,72,a,52
s_waitcnt lgkmcnt(4)
MV 148,a,76,a,48
MV 152,a,76,a,52
s_waitcnt lgkmcnt(3)
MV 124,a,96,a,56
MV 128,a,96,a,60
s_waitcnt lgkmcnt(2)
MV 132,a,100,a,56
MV 136,a,100,a,60
s_waitcnt lgkmcnt(1)
MV 140,a,104,a,56
MV 144,a,104,a,60
s_waitcnt lgkmcnt(0)
MV 148,a,108,a,56
MV 152,a,108,a,60
s_nop 0
v_permlane16_swap_b32 v124, v132
v_permlane16_swap_b32 v125, v133
v_permlane16_swap_b32 v126, v134
v_permlane16_swap_b32 v127, v135
s_nop 1
v_permlane16_swap_b32 v140, v148
v_permlane16_swap_b32 v141, v149
v_permlane16_swap_b32 v142, v150
v_permlane16_swap_b32 v143, v151
v_permlane16_swap_b32 v128, v136
v_permlane16_swap_b32 v129, v137
v_permlane16_swap_b32 v130, v138
v_permlane16_swap_b32 v131, v139
v_permlane16_swap_b32 v144, v152
v_permlane16_swap_b32 v145, v153
v_permlane16_swap_b32 v146, v154
v_permlane16_swap_b32 v147, v155
v_fma_f32 v36, v124, v8, v36
v_fma_f32 v37, v125, v8, v37
v_fma_f32 v38, v126, v8, v38
v_fma_f32 v39, v127, v8, v39
v_fma_f32 v40, v132, v8, v40
v_fma_f32 v41, v133, v8, v41
v_fma_f32 v42, v134, v8, v42
v_fma_f32 v43, v135, v8, v43
v_fma_f32 v44, v140, v8, v44
v_fma_f32 v45, v141, v8, v45
v_fma_f32 v46, v142, v8, v46
v_fma_f32 v47, v143, v8, v47
v_fma_f32 v48, v148, v8, v48
v_fma_f32 v49, v149, v8, v49
v_fma_f32 v50, v150, v8, v50
v_fma_f32 v51, v151, v8, v51
v_fma_f32 v52, v128, v9, v52
v_fma_f32 v53, v129, v9, v53
v_fma_f32 v54, v130, v9, v54
v_fma_f32 v55, v131, v9, v55
v_fma_f32 v56, v136, v9, v56
v_fma_f32 v57, v137, v9, v57
v_fma_f32 v58, v138, v9, v58
v_fma_f32 v59, v139, v9, v59
v_fma_f32 v60, v144, v9, v60
v_fma_f32 v61, v145, v9, v61
v_fma_f32 v62, v146, v9, v62
v_fma_f32 v63, v147, v9, v63
v_fma_f32 v64, v152, v9, v64
v_fma_f32 v65, v153, v9, v65
v_fma_f32 v66, v154, v9, v66
v_fma_f32 v67, v155, v9, v67
s_lshl_b32 s72, s2, 14
s_mov_b32 s73, 400000
L_xb:
buffer_load_dwordx4 v[76:79], v238, s[52:55], s72 offen offset:0 sc1
buffer_load_dwordx4 v[80:83], v238, s[52:55], s72 offen offset:1024 sc1
buffer_load_dwordx4 v[84:87], v238, s[52:55], s72 offen offset:2048 sc1
buffer_load_dwordx4 v[88:91], v238, s[52:55], s72 offen offset:3072 sc1
s_sub_u32 s73, s73, 1
s_cbranch_scc1 L_xb_done
s_waitcnt vmcnt(3)
v_max3_u32 v228, v76, v77, v78
s_waitcnt vmcnt(2)
v_max3_u32 v228, v228, v79, v80
v_max3_u32 v228, v228, v81, v82
s_waitcnt vmcnt(1)
v_max3_u32 v228, v228, v83, v84
v_max3_u32 v228, v228, v85, v86
s_waitcnt vmcnt(0)
v_max3_u32 v228, v228, v87, v88
v_max3_u32 v228, v228, v89, v90
v_max_u32 v228, v228, v91
v_cmp_eq_u32 vcc, -1, v228
s_nop 4
s_cbranch_vccnz L_xb
L_xb_done:
s_waitcnt vmcnt(0)
s_add_u32 s72, s78, 0
v_lshlrev_b32 v92, 16, v76
v_and_b32 v93, 0xffff0000, v76
v_fmac_f32 v36, v92, v8
v_fmac_f32 v37, v93, v8
v_cvt_pk_bf16_f32 v192, v36, v37
v_lshlrev_b32 v92, 16, v77
v_and_b32 v93, 0xffff0000, v77
v_fmac_f32 v38, v92, v8
v_fmac_f32 v39, v93, v8
v_cvt_pk_bf16_f32 v193, v38, v39
v_lshlrev_b32 v92, 16, v78
v_and_b32 v93, 0xffff0000, v78
v_fmac_f32 v40, v92, v8
v_fmac_f32 v41, v93, v8
v_cvt_pk_bf16_f32 v194, v40, v41
v_lshlrev_b32 v92, 16, v79
v_and_b32 v93, 0xffff0000, v79
v_fmac_f32 v42, v92, v8
v_fmac_f32 v43, v93, v8
v_cvt_pk_bf16_f32 v195, v42, v43
buffer_store_dwordx4 v[192:195], v250, s[60:63], s72 offen offset:0 sc1
v_lshlrev_b32 v92, 16, v80
v_and_b32 v93, 0xffff0000, v80
v_fmac_f32 v44, v92, v8
v_fmac_f32 v45, v93, v8
v_cvt_pk_bf16_f32 v196, v44, v45
v_lshlrev_b32 v92, 16, v81
v_and_b32 v93, 0xffff0000, v81
v_fmac_f32 v46, v92, v8
v_fmac_f32 v47, v93, v8
v_cvt_pk_bf16_f32 v197, v46, v47
v_lshlrev_b32 v92, 16, v82
v_and_b32 v93, 0xffff0000, v82
v_fmac_f32 v48, v92, v8
v_fmac_f32 v49, v93, v8
v_cvt_pk_bf16_f32 v198, v48, v49
v_lshlrev_b32 v92, 16, v83
v_and_b32 v93, 0xffff0000, v83
v_fmac_f32 v50, v92, v8
v_fmac_f32 v51, v93, v8
v_cvt_pk_bf16_f32 v199, v50, v51
buffer_store_dwordx4 v[196:199], v250, s[60:63], s72 offen offset:64 sc1
s_add_u32 s72, s78, 32768
v_lshlrev_b32 v92, 16, v84
v_and_b32 v93, 0xffff0000, v84
v_fmac_f32 v52, v92, v9
v_fmac_f32 v53, v93, v9
v_cvt_pk_bf16_f32 v200, v52, v53
v_lshlrev_b32 v92, 16, v85
v_and_b32 v93, 0xffff0000, v85
v_fmac_f32 v54, v92, v9
v_fmac_f32 v55, v93, v9
v_cvt_pk_bf16_f32 v201, v54, v55
v_lshlrev_b32 v92, 16, v86
v_and_b32 v93, 0xffff0000, v86
v_fmac_f32 v56, v92, v9
v_fmac_f32 v57, v93, v9
v_cvt_pk_bf16_f32 v202, v56, v57
v_lshlrev_b32 v92, 16, v87
v_and_b32 v93, 0xffff0000, v87
v_fmac_f32 v58, v92, v9
v_fmac_f32 v59, v93, v9
v_cvt_pk_bf16_f32 v203, v58, v59
buffer_store_dwordx4 v[200:203], v250, s[60:63], s72 offen offset:0 sc1
v_lshlrev_b32 v92, 16, v88
v_and_b32 v93, 0xffff0000, v88
v_fmac_f32 v60, v92, v9
v_fmac_f32 v61, v93, v9
v_cvt_pk_bf16_f32 v204, v60, v61
v_lshlrev_b32 v92, 16, v89
v_and_b32 v93, 0xffff0000, v89
v_fmac_f32 v62, v92, v9
v_fmac_f32 v63, v93, v9
v_cvt_pk_bf16_f32 v205, v62, v63
v_lshlrev_b32 v92, 16, v90
v_and_b32 v93, 0xffff0000, v90
v_fmac_f32 v64, v92, v9
v_fmac_f32 v65, v93, v9
v_cvt_pk_bf16_f32 v206, v64, v65
v_lshlrev_b32 v92, 16, v91
v_and_b32 v93, 0xffff0000, v91
v_fmac_f32 v66, v92, v9
v_fmac_f32 v67, v93, v9
v_cvt_pk_bf16_f32 v207, v66, v67
buffer_store_dwordx4 v[204:207], v250, s[60:63], s72 offen offset:64 sc1
L_end:
s_endpgm
L_p3_pmask:
s_nop 7
v_add_u32 v246, 0, v13
v_cmp_gt_i32_e64 s[84:85], 0, v246
v_cmp_gt_i32_e64 s[86:87], 1, v246
v_cmp_gt_i32_e64 s[88:89], 2, v246
v_cmp_gt_i32_e64 s[90:91], 3, v246
v_cndmask_b32_e64 v96, v96, v14, s[84:85]
v_cndmask_b32_e64 v97, v97, v14, s[86:87]
v_cndmask_b32_e64 v98, v98, v14, s[88:89]
v_cndmask_b32_e64 v99, v99, v14, s[90:91]
v_add_u32 v247, -16, v13
v_cmp_gt_i32_e64 s[92:93], 0, v247
v_cmp_gt_i32_e64 s[94:95], 1, v247
v_cmp_gt_i32_e64 s[96:97], 2, v247
v_cmp_gt_i32_e64 s[98:99], 3, v247
v_cndmask_b32_e64 v100, v100, v14, s[92:93]
v_cndmask_b32_e64 v101, v101, v14, s[94:95]
v_cndmask_b32_e64 v102, v102, v14, s[96:97]
v_cndmask_b32_e64 v103, v103, v14, s[98:99]
v_add_u32 v246, -32, v13
v_cmp_gt_i32_e64 s[84:85], 0, v246
v_cmp_gt_i32_e64 s[86:87], 1, v246
v_cmp_gt_i32_e64 s[88:89], 2, v246
v_cmp_gt_i32_e64 s[90:91], 3, v246
v_cndmask_b32_e64 v128, v128, v14, s[84:85]
v_cndmask_b32_e64 v129, v129, v14, s[86:87]
v_cndmask_b32_e64 v130, v130, v14, s[88:89]
v_cndmask_b32_e64 v131, v131, v14, s[90:91]
v_add_u32 v247, -48, v13
v_cmp_gt_i32_e64 s[92:93], 0, v247
v_cmp_gt_i32_e64 s[94:95], 1, v247
v_cmp_gt_i32_e64 s[96:97], 2, v247
v_cmp_gt_i32_e64 s[98:99], 3, v247
v_cndmask_b32_e64 v132, v132, v14, s[92:93]
v_cndmask_b32_e64 v133, v133, v14, s[94:95]
v_cndmask_b32_e64 v134, v134, v14, s[96:97]
v_cndmask_b32_e64 v135, v135, v14, s[98:99]
s_branch L_p3_pmask_ret
L_p3_mxm_top:
s_waitcnt lgkmcnt(0)
v_xor_b32 v11, 0x8000, v11
v_mfma_f32_16x16x32_bf16 v[80:83], a[128:131], v[16:19], 0
s_add_u32 m0, s73, 16384
ds_read_b128 a[192:195], v11 offset:0
v_mfma_f32_16x16x32_bf16 v[88:91], a[128:131], v[32:35], 0
v_exp_f32 v176, v176
MV 80,a,132,v,20
v_exp_f32 v177, v177
MV 88,a,132,v,36
ds_read_b128 a[196:199], v11 offset:1024
buffer_load_dwordx4 v12, s[56:59], s71 offen offset:0 sc1 lds
MV 80,a,136,v,24
v_exp_f32 v178, v178
MV 88,a,136,v,40
v_add_f32 v2, v2, v176
v_add_f32 v2, v2, v177
MV 80,a,140,v,28
ds_read_b128 a[200:203], v11 offset:2048
ds_read_b128 a[204:207], v11 offset:3072
MV 88,a,140,v,44
v_exp_f32 v179, v179
v_mfma_f32_16x16x32_bf16 v[84:87], a[144:147], v[16:19], 0
ds_read_b128 a[208:211], v11 offset:4096
v_cvt_pk_bf16_f32 v176, v176, v177
v_mfma_f32_16x16x32_bf16 v[92:95], a[144:147], v[32:35], 0
v_exp_f32 v180, v180
MV 84,a,148,v,20
v_add_f32 v2, v2, v178
v_add_f32 v2, v2, v179
MV 92,a,148,v,36
v_exp_f32 v181, v181
MV 84,a,152,v,24
buffer_load_dwordx4 v12, s[56:59], s71 offen offset:1024 sc1 lds
v_cvt_pk_bf16_f32 v177, v178, v179
MV 92,a,152,v,40
v_exp_f32 v182, v182
MV 84,a,156,v,28
ds_read_b128 a[212:215], v11 offset:5120
v_add_f32 v2, v2, v180
MV 92,a,156,v,44
ds_read_b128 a[216:219], v11 offset:6144
v_add_f32 v2, v2, v181
v_mfma_f32_16x16x32_bf16 v[112:115], a[160:163], v[16:19], 0
v_exp_f32 v183, v183
v_mfma_f32_16x16x32_bf16 v[120:123], a[160:163], v[32:35], 0
ds_read_b128 a[220:223], v11 offset:7168
v_cvt_pk_bf16_f32 v178, v180, v181
MV 112,a,164,v,20
v_exp_f32 v184, v184
MV 120,a,164,v,36
v_add_f32 v2, v2, v182
v_add_f32 v2, v2, v183
MV 112,a,168,v,24
ds_read_b128 a[224:227], v11 offset:8192
buffer_load_dwordx4 v12, s[56:59], s71 offen offset:2048 sc1 lds
MV 120,a,168,v,40
v_exp_f32 v185, v185
MV 112,a,172,v,28
ds_read_b128 a[228:231], v11 offset:9216
v_cvt_pk_bf16_f32 v179, v182, v183
MV 120,a,172,v,44
v_exp_f32 v186, v186
v_mfma_f32_16x16x32_bf16 v[116:119], a[176:179], v[16:19], 0
v_add_f32 v3, v3, v184
v_add_f32 v3, v3, v185
v_mfma_f32_16x16x32_bf16 v[124:127], a[176:179], v[32:35], 0
v_exp_f32 v187, v187
MV 116,a,180,v,20
ds_read_b128 a[232:235], v11 offset:10240
v_cvt_pk_bf16_f32 v184, v184, v185
MV 124,a,180,v,36
v_exp_f32 v188, v188
MV 116,a,184,v,24
ds_read_b128 a[236:239], v11 offset:11264
v_add_f32 v3, v3, v186
MV 124,a,184,v,40
buffer_load_dwordx4 v12, s[56:59], s71 offen offset:3072 sc1 lds
v_add_f32 v3, v3, v187
MV 116,a,188,v,28
v_exp_f32 v189, v189
MV 124,a,188,v,44
ds_read_b128 a[240:243], v11 offset:12288
ds_read_b128 a[244:247], v11 offset:13312
ds_read_b128 a[248:251], v11 offset:14336
ds_read_b128 a[252:255], v11 offset:15360
s_add_u32 s71, s71, 16384
s_xor_b32 s73, s73, 0x8000
v_cvt_pk_bf16_f32 v185, v186, v187
v_exp_f32 v190, v190
v_add_f32 v3, v3, v188
v_add_f32 v3, v3, v189
v_exp_f32 v191, v191
v_cvt_pk_bf16_f32 v186, v188, v189
v_exp_f32 v200, v200
v_add_f32 v3, v3, v190
v_add_f32 v3, v3, v191
v_exp_f32 v201, v201
v_cvt_pk_bf16_f32 v187, v190, v191
v_exp_f32 v202, v202
v_add_u32 v246, 0, v13
v_cmp_gt_i32_e64 s[84:85], 0, v246
v_add_f32 v5, v5, v200
v_cmp_gt_i32_e64 s[86:87], 1, v246
v_cmp_gt_i32_e64 s[88:89], 2, v246
v_add_f32 v5, v5, v201
v_exp_f32 v203, v203
v_cmp_gt_i32_e64 s[90:91], 3, v246
v_cndmask_b32_e64 v80, v80, v14, s[84:85]
v_cvt_pk_bf16_f32 v200, v200, v201
v_exp_f32 v204, v204
v_cndmask_b32_e64 v81, v81, v14, s[86:87]
v_cndmask_b32_e64 v82, v82, v14, s[88:89]
v_add_f32 v5, v5, v202
v_add_f32 v5, v5, v203
v_cndmask_b32_e64 v83, v83, v14, s[90:91]
v_exp_f32 v205, v205
v_cvt_pk_bf16_f32 v201, v202, v203
v_add_u32 v247, -16, v13
v_cmp_gt_i32_e64 s[92:93], 0, v247
v_exp_f32 v206, v206
v_add_f32 v5, v5, v204
v_cmp_gt_i32_e64 s[94:95], 1, v247
v_cmp_gt_i32_e64 s[96:97], 2, v247
v_add_f32 v5, v5, v205
v_exp_f32 v207, v207
v_cmp_gt_i32_e64 s[98:99], 3, v247
v_cndmask_b32_e64 v84, v84, v14, s[92:93]
v_cvt_pk_bf16_f32 v202, v204, v205
v_add_f32 v5, v5, v206
v_cndmask_b32_e64 v85, v85, v14, s[94:95]
v_cndmask_b32_e64 v86, v86, v14, s[96:97]
v_add_f32 v5, v5, v207
v_cvt_pk_bf16_f32 v203, v206, v207
v_cndmask_b32_e64 v87, v87, v14, s[98:99]
s_waitcnt vmcnt(16) lgkmcnt(0)
MA 0,a,192,v,144
s_barrier
v_xor_b32 v10, 0x8000, v10
MA 32,a,192,v,152
s_add_u32 m0, s72, 16384
ds_read_b128 a[128:131], v10 offset:0
MA 96,a,192,v,168
v_exp_f32 v80, v80
MA 4,a,196,v,144
buffer_load_dwordx4 v12, s[52:55], s71 offen offset:0 sc1 lds
v_lshrrev_b32 v249, 2, v1
MA 36,a,196,v,152
ds_read_b128 a[132:135], v10 offset:1024
v_and_b32 v248, 7, v249
MA 100,a,196,v,168
v_lshlrev_b32 v249, 8, v249
v_and_b32 v250, 3, v1
MA 8,a,200,v,144
v_exp_f32 v81, v81
MA 40,a,200,v,152
v_lshl_add_u32 v249, v250, 3, v249
s_lshl_b32 s36, s3, 13
MA 104,a,200,v,168
ds_read_b128 a[136:139], v10 offset:2048
s_add_u32 s36, s36, 131072
MA 12,a,204,v,144
v_add_u32 v246, -32, v13
v_add_u32 v249, s36, v249
MA 44,a,204,v,152
v_exp_f32 v82, v82
MA 108,a,204,v,168
s_nop 0
v_xor_b32 v250, 0, v248
MA 16,a,208,v,144
ds_read_b128 a[140:143], v10 offset:3072
v_lshl_add_u32 v250, v250, 5, v249
MA 48,a,208,v,152
v_cmp_gt_i32_e64 s[84:85], 0, v246
TR 96,250,0
MA 112,a,208,v,168
TR 98,250,4096
v_xor_b32 v250, 1, v248
MA 20,a,212,v,144
v_exp_f32 v83, v83
MA 52,a,212,v,152
ds_read_b128 a[144:147], v10 offset:4096
v_lshl_add_u32 v250, v250, 5, v249
MA 116,a,212,v,168
v_cvt_pk_bf16_f32 v80, v80, v81
v_cmp_gt_i32_e64 s[86:87], 1, v246
MA 24,a,216,v,144
TR 100,250,0
TR 102,250,4096
MA 56,a,216,v,152
ds_read_b128 a[148:151], v10 offset:5120
buffer_load_dwordx4 v12, s[52:55], s71 offen offset:1024 sc1 lds
MA 120,a,216,v,168
v_xor_b32 v250, 2, v248
v_lshl_add_u32 v250, v250, 5, v249
MA 28,a,220,v,144
v_exp_f32 v84, v84
MA 60,a,220,v,152
TR 104,250,0
TR 106,250,4096
MA 124,a,220,v,168
v_cmp_gt_i32_e64 s[88:89], 2, v246
v_xor_b32 v250, 3, v248
MA 0,a,224,v,176
ds_read_b128 a[152:155], v10 offset:6144
v_lshl_add_u32 v250, v250, 5, v249
MA 32,a,224,v,184
v_exp_f32 v85, v85
MA 96,a,224,v,200
TR 108,250,0
TR 110,250,4096
MA 4,a,228,v,176
v_cmp_gt_i32_e64 s[90:91], 3, v246
v_xor_b32 v250, 4, v248
MA 36,a,228,v,184
ds_read_b128 a[156:159], v10 offset:7168
v_lshl_add_u32 v250, v250, 5, v249
MA 100,a,228,v,200
v_cvt_pk_bf16_f32 v81, v82, v83
TR 128,250,0
MA 8,a,232,v,176
v_cndmask_b32_e64 v112, v112, v14, s[84:85]
TR 130,250,4096
MA 40,a,232,v,184
ds_read_b128 a[160:163], v10 offset:8192
v_xor_b32 v250, 5, v248
MA 104,a,232,v,200
v_exp_f32 v86, v86
MA 12,a,236,v,176
v_lshl_add_u32 v250, v250, 5, v249
TR 132,250,0
MA 44,a,236,v,184
TR 134,250,4096
v_xor_b32 v250, 6, v248
MA 108,a,236,v,200
v_exp_f32 v87, v87
MA 16,a,240,v,176
ds_read_b128 a[164:167], v10 offset:9216
buffer_load_dwordx4 v12, s[52:55], s71 offen offset:2048 sc1 lds
MA 48,a,240,v,184
v_cndmask_b32_e64 v113, v113, v14, s[86:87]
v_lshl_add_u32 v250, v250, 5, v249
MA 112,a,240,v,200
TR 136,250,0
TR 138,250,4096
MA 20,a,244,v,176
ds_read_b128 a[168:171], v10 offset:10240
v_xor_b32 v250, 7, v248
MA 52,a,244,v,184
v_cvt_pk_bf16_f32 v82, v84, v85
v_cndmask_b32_e64 v114, v114, v14, s[88:89]
MA 116,a,244,v,200
v_lshl_add_u32 v250, v250, 5, v249
TR 140,250,0
MA 24,a,248,v,176
v_cndmask_b32_e64 v115, v115, v14, s[90:91]
TR 142,250,4096
MA 56,a,248,v,184
v_exp_f32 v88, v88
MA 120,a,248,v,200
s_add_u32 s32, s40, 100663296
s_addc_u32 s33, s41, 0
MA 28,a,252,v,176
ds_read_b128 a[172:175], v10 offset:11264
s_mov_b32 s34, 8388608
MA 60,a,252,v,184
s_mov_b32 s35, 0x20000
s_and_b32 s36, s2, 7
MA 124,a,252,v,200
ds_read_b128 a[176:179], v10 offset:12288
ds_read_b128 a[180:183], v10 offset:13312
ds_read_b128 a[184:187], v10 offset:14336
ds_read_b128 a[188:191], v10 offset:15360
buffer_load_dwordx4 v12, s[52:55], s71 offen offset:3072 sc1 lds
s_xor_b32 s72, s72, 0x8000
v_exp_f32 v89, v89
s_lshl_b32 s36, s36, 20
v_add_u32 v247, -48, v13
s_lshr_b32 s37, s2, 3
s_lshl_b32 s37, s37, 15
v_cvt_pk_bf16_f32 v83, v86, v87
s_add_u32 s36, s36, s37
s_lshl_b32 s37, s3, 12
v_exp_f32 v90, v90
v_cmp_gt_i32_e64 s[92:93], 0, v247
s_add_u32 s36, s36, s37
s_add_u32 s37, s36, 4096
s_waitcnt lgkmcnt(15)
buffer_store_dwordx4 v[96:99], v12, s[32:35], s36 offen offset:0 sc1
buffer_store_dwordx4 v[100:103], v12, s[32:35], s36 offen offset:1024 sc1
v_exp_f32 v91, v91
v_cmp_gt_i32_e64 s[94:95], 1, v247
buffer_store_dwordx4 v[104:107], v12, s[32:35], s36 offen offset:2048 sc1
buffer_store_dwordx4 v[108:111], v12, s[32:35], s36 offen offset:3072 sc1
s_waitcnt lgkmcnt(14)
buffer_store_dwordx4 v[128:131], v12, s[32:35], s37 offen offset:0 sc1
v_cvt_pk_bf16_f32 v88, v88, v89
s_waitcnt lgkmcnt(11)
buffer_store_dwordx4 v[132:135], v12, s[32:35], s37 offen offset:1024 sc1
s_waitcnt lgkmcnt(8)
buffer_store_dwordx4 v[136:139], v12, s[32:35], s37 offen offset:2048 sc1
v_cmp_gt_i32_e64 s[96:97], 2, v247
s_waitcnt lgkmcnt(5)
buffer_store_dwordx4 v[140:143], v12, s[32:35], s37 offen offset:3072 sc1
s_add_u32 s32, s40, 109051904
s_addc_u32 s33, s41, 0
v_exp_f32 v92, v92
s_mov_b32 s34, 4194304
v_cmp_gt_i32_e64 s[98:99], 3, v247
s_mov_b32 s35, 0x20000
s_lshl_b32 s36, s2, 14
v_exp_f32 v93, v93
v_mov_b32 v252, -1
v_mov_b32 v253, -1
v_cndmask_b32_e64 v116, v116, v14, s[92:93]
v_mov_b32 v254, -1
v_mov_b32 v255, -1
v_cvt_pk_bf16_f32 v89, v90, v91
buffer_store_dwordx4 v[252:255], v12, s[32:35], s36 offen offset:0 sc1
buffer_store_dwordx4 v[252:255], v12, s[32:35], s36 offen offset:1024 sc1
v_exp_f32 v94, v94
buffer_store_dwordx4 v[252:255], v12, s[32:35], s36 offen offset:2048 sc1
v_cndmask_b32_e64 v117, v117, v14, s[94:95]
buffer_store_dwordx4 v[252:255], v12, s[32:35], s36 offen offset:3072 sc1
v_lshlrev_b32 v232, 4, v1
v_add_u32 v233, -4, v232
v_mov_b32 v235, 0
v_exp_f32 v95, v95
v_cndmask_b32_e64 v118, v118, v14, s[96:97]
buffer_load_ushort v234, v235, s[28:31], s42 offen
buffer_load_dword v209, v233, s[16:19], 0 offen
buffer_load_dwordx4 v[210:213], v232, s[16:19], 0 offen offset:0
buffer_load_dword v215, v232, s[16:19], 0 offen offset:1020
v_cvt_pk_bf16_f32 v90, v92, v93
v_cndmask_b32_e64 v119, v119, v14, s[98:99]
buffer_load_dwordx4 v[216:219], v232, s[16:19], 0 offen offset:1024
buffer_load_dword v221, v232, s[16:19], 0 offen offset:2044
v_cvt_pk_bf16_f32 v91, v94, v95
buffer_load_dwordx4 v[222:225], v232, s[16:19], 0 offen offset:2048
buffer_load_dword v227, v232, s[16:19], 0 offen offset:3068
buffer_load_dwordx4 v[228:231], v232, s[16:19], 0 offen offset:3072
s_branch L_p3_eps
L_fallback:
s_mov_b32 s81, 0
s_mov_b32 s74, s77
s_mov_b32 s73, s100
s_sub_u32 s72, 15, s70
v_mov_b32 v10, v15
v_add_u32 v11, 16384, v15
s_nop 15
L_fb_set:
s_lshl_b32 s72, s72, 7
s_mov_b32 s71, 0
v_accvgpr_write_b32 a0, 0
v_accvgpr_write_b32 a1, 0
v_accvgpr_write_b32 a2, 0
v_accvgpr_write_b32 a3, 0
v_accvgpr_write_b32 a4, 0
v_accvgpr_write_b32 a5, 0
v_accvgpr_write_b32 a6, 0
v_accvgpr_write_b32 a7, 0
v_accvgpr_write_b32 a8, 0
v_accvgpr_write_b32 a9, 0
v_accvgpr_write_b32 a10, 0
v_accvgpr_write_b32 a11, 0
v_accvgpr_write_b32 a12, 0
v_accvgpr_write_b32 a13, 0
v_accvgpr_write_b32 a14, 0
v_accvgpr_write_b32 a15, 0
v_accvgpr_write_b32 a16, 0
v_accvgpr_write_b32 a17, 0
v_accvgpr_write_b32 a18, 0
v_accvgpr_write_b32 a19, 0
v_accvgpr_write_b32 a20, 0
v_accvgpr_write_b32 a21, 0
v_accvgpr_write_b32 a22, 0
v_accvgpr_write_b32 a23, 0
v_accvgpr_write_b32 a24, 0
v_accvgpr_write_b32 a25, 0
v_accvgpr_write_b32 a26, 0
v_accvgpr_write_b32 a27, 0
v_accvgpr_write_b32 a28, 0
v_accvgpr_write_b32 a29, 0
v_accvgpr_write_b32 a30, 0
v_accvgpr_write_b32 a31, 0
v_accvgpr_write_b32 a32, 0
v_accvgpr_write_b32 a33, 0
v_accvgpr_write_b32 a34, 0
v_accvgpr_write_b32 a35, 0
v_accvgpr_write_b32 a36, 0
v_accvgpr_write_b32 a37, 0
v_accvgpr_write_b32 a38, 0
v_accvgpr_write_b32 a39, 0
v_accvgpr_write_b32 a40, 0
v_accvgpr_write_b32 a41, 0
v_accvgpr_write_b32 a42, 0
v_accvgpr_write_b32 a43, 0
v_accvgpr_write_b32 a44, 0
v_accvgpr_write_b32 a45, 0
v_accvgpr_write_b32 a46, 0
v_accvgpr_write_b32 a47, 0
v_accvgpr_write_b32 a48, 0
v_accvgpr_write_b32 a49, 0
v_accvgpr_write_b32 a50, 0
v_accvgpr_write_b32 a51, 0
v_accvgpr_write_b32 a52, 0
v_accvgpr_write_b32 a53, 0
v_accvgpr_write_b32 a54, 0
v_accvgpr_write_b32 a55, 0
v_accvgpr_write_b32 a56, 0
v_accvgpr_write_b32 a57, 0
v_accvgpr_write_b32 a58, 0
v_accvgpr_write_b32 a59, 0
v_accvgpr_write_b32 a60, 0
v_accvgpr_write_b32 a61, 0
v_accvgpr_write_b32 a62, 0
v_accvgpr_write_b32 a63, 0
v_mov_b32 v2, 0
v_mov_b32 v96, v14
v_mov_b32 v3, 0
v_mov_b32 v97, v14
L_fb_tile:
s_waitcnt vmcnt(0) lgkmcnt(0)
s_barrier
s_mov_b32 m0, s68
s_add_u32 s80, s71, 16384
buffer_load_dwordx4 v12, s[52:55], s71 offen offset:0 sc1 lds
buffer_load_dwordx4 v12, s[52:55], s71 offen offset:1024 sc1 lds
buffer_load_dwordx4 v12, s[52:55], s71 offen offset:2048 sc1 lds
buffer_load_dwordx4 v12, s[52:55], s71 offen offset:3072 sc1 lds
s_add_u32 m0, s68, 16384
s_nop 0
buffer_load_dwordx4 v12, s[56:59], s80 offen offset:0 sc1 lds
buffer_load_dwordx4 v12, s[56:59], s80 offen offset:1024 sc1 lds
buffer_load_dwordx4 v12, s[56:59], s80 offen offset:2048 sc1 lds
buffer_load_dwordx4 v12, s[56:59], s80 offen offset:3072 sc1 lds
s_waitcnt vmcnt(0)
s_barrier
ds_read_b128 a[128:131], v10 offset:0
ds_read_b128 a[132:135], v10 offset:1024
ds_read_b128 a[136:139], v10 offset:2048
ds_read_b128 a[140:143], v10 offset:3072
ds_read_b128 a[144:147], v10 offset:4096
ds_read_b128 a[148:151], v10 offset:5120
ds_read_b128 a[152:155], v10 offset:6144
ds_read_b128 a[156:159], v10 offset:7168
ds_read_b128 a[160:163], v10 offset:8192
ds_read_b128 a[164:167], v10 offset:9216
ds_read_b128 a[168:171], v10 offset:10240
ds_read_b128 a[172:175], v10 offset:11264
ds_read_b128 a[176:179], v10 offset:12288
ds_read_b128 a[180:183], v10 offset:13312
ds_read_b128 a[184:187], v10 offset:14336
ds_read_b128 a[188:191], v10 offset:15360
s_waitcnt lgkmcnt(0)
ds_read_b128 a[192:195], v11 offset:0
ds_read_b128 a[196:199], v11 offset:1024
ds_read_b128 a[200:203], v11 offset:2048
ds_read_b128 a[204:207], v11 offset:3072
ds_read_b128 a[208:211], v11 offset:4096
ds_read_b128 a[212:215], v11 offset:5120
ds_read_b128 a[216:219], v11 offset:6144
ds_read_b128 a[220:223], v11 offset:7168
ds_read_b128 a[224:227], v11 offset:8192
ds_read_b128 a[228:231], v11 offset:9216
ds_read_b128 a[232:235], v11 offset:10240
ds_read_b128 a[236:239], v11 offset:11264
ds_read_b128 a[240:243], v11 offset:12288
ds_read_b128 a[244:247], v11 offset:13312
ds_read_b128 a[248:251], v11 offset:14336
ds_read_b128 a[252:255], v11 offset:15360
v_mfma_f32_16x16x32_bf16 v[80:83], a[128:131], v[16:19], 0
v_mfma_f32_16x16x32_bf16 v[88:91], a[128:131], v[32:35], 0
MV 80,a,132,v,20
MV 88,a,132,v,36
MV 80,a,136,v,24
MV 88,a,136,v,40
MV 80,a,140,v,28
MV 88,a,140,v,44
v_mfma_f32_16x16x32_bf16 v[84:87], a[144:147], v[16:19], 0
v_mfma_f32_16x16x32_bf16 v[92:95], a[144:147], v[32:35], 0
MV 84,a,148,v,20
MV 92,a,148,v,36
MV 84,a,152,v,24
MV 92,a,152,v,40
MV 84,a,156,v,28
MV 92,a,156,v,44
v_mfma_f32_16x16x32_bf16 v[112:115], a[160:163], v[16:19], 0
v_mfma_f32_16x16x32_bf16 v[120:123], a[160:163], v[32:35], 0
MV 112,a,164,v,20
MV 120,a,164,v,36
MV 112,a,168,v,24
MV 120,a,168,v,40
MV 112,a,172,v,28
MV 120,a,172,v,44
v_mfma_f32_16x16x32_bf16 v[116:119], a[176:179], v[16:19], 0
v_mfma_f32_16x16x32_bf16 v[124:127], a[176:179], v[32:35], 0
MV 116,a,180,v,20
MV 124,a,180,v,36
MV 116,a,184,v,24
MV 124,a,184,v,40
MV 116,a,188,v,28
MV 124,a,188,v,44
v_add_u32 v246, s72, v13
v_add_u32 v246, 0, v246
v_cmp_gt_i32_e64 s[84:85], 0, v246
v_cmp_gt_i32_e64 s[86:87], 1, v246
v_cmp_gt_i32_e64 s[88:89], 2, v246
v_cmp_gt_i32_e64 s[90:91], 3, v246
v_cndmask_b32_e64 v80, v80, v14, s[84:85]
v_cndmask_b32_e64 v81, v81, v14, s[86:87]
v_cndmask_b32_e64 v82, v82, v14, s[88:89]
v_cndmask_b32_e64 v83, v83, v14, s[90:91]
v_add_u32 v247, s72, v239
v_add_u32 v247, 0, v247
v_cmp_gt_i32_e64 s[92:93], 0, v247
v_cmp_gt_i32_e64 s[94:95], 1, v247
v_cmp_gt_i32_e64 s[96:97], 2, v247
v_cmp_gt_i32_e64 s[98:99], 3, v247
v_cndmask_b32_e64 v88, v88, v14, s[92:93]
v_cndmask_b32_e64 v89, v89, v14, s[94:95]
v_cndmask_b32_e64 v90, v90, v14, s[96:97]
v_cndmask_b32_e64 v91, v91, v14, s[98:99]
v_add_u32 v246, s72, v13
v_add_u32 v246, -16, v246
v_cmp_gt_i32_e64 s[84:85], 0, v246
v_cmp_gt_i32_e64 s[86:87], 1, v246
v_cmp_gt_i32_e64 s[88:89], 2, v246
v_cmp_gt_i32_e64 s[90:91], 3, v246
v_cndmask_b32_e64 v84, v84, v14, s[84:85]
v_cndmask_b32_e64 v85, v85, v14, s[86:87]
v_cndmask_b32_e64 v86, v86, v14, s[88:89]
v_cndmask_b32_e64 v87, v87, v14, s[90:91]
v_add_u32 v247, s72, v239
v_add_u32 v247, -16, v247
v_cmp_gt_i32_e64 s[92:93], 0, v247
v_cmp_gt_i32_e64 s[94:95], 1, v247
v_cmp_gt_i32_e64 s[96:97], 2, v247
v_cmp_gt_i32_e64 s[98:99], 3, v247
v_cndmask_b32_e64 v92, v92, v14, s[92:93]
v_cndmask_b32_e64 v93, v93, v14, s[94:95]
v_cndmask_b32_e64 v94, v94, v14, s[96:97]
v_cndmask_b32_e64 v95, v95, v14, s[98:99]
v_add_u32 v246, s72, v13
v_add_u32 v246, -32, v246
v_cmp_gt_i32_e64 s[84:85], 0, v246
v_cmp_gt_i32_e64 s[86:87], 1, v246
v_cmp_gt_i32_e64 s[88:89], 2, v246
v_cmp_gt_i32_e64 s[90:91], 3, v246
v_cndmask_b32_e64 v112, v112, v14, s[84:85]
v_cndmask_b32_e64 v113, v113, v14, s[86:87]
v_cndmask_b32_e64 v114, v114, v14, s[88:89]
v_cndmask_b32_e64 v115, v115, v14, s[90:91]
v_add_u32 v247, s72, v239
v_add_u32 v247, -32, v247
v_cmp_gt_i32_e64 s[92:93], 0, v247
v_cmp_gt_i32_e64 s[94:95], 1, v247
v_cmp_gt_i32_e64 s[96:97], 2, v247
v_cmp_gt_i32_e64 s[98:99], 3, v247
v_cndmask_b32_e64 v120, v120, v14, s[92:93]
v_cndmask_b32_e64 v121, v121, v14, s[94:95]
v_cndmask_b32_e64 v122, v122, v14, s[96:97]
v_cndmask_b32_e64 v123, v123, v14, s[98:99]
v_add_u32 v246, s72, v13
v_add_u32 v246, -48, v246
v_cmp_gt_i32_e64 s[84:85], 0, v246
v_cmp_gt_i32_e64 s[86:87], 1, v246
v_cmp_gt_i32_e64 s[88:89], 2, v246
v_cmp_gt_i32_e64 s[90:91], 3, v246
v_cndmask_b32_e64 v116, v116, v14, s[84:85]
v_cndmask_b32_e64 v117, v117, v14, s[86:87]
v_cndmask_b32_e64 v118, v118, v14, s[88:89]
v_cndmask_b32_e64 v119, v119, v14, s[90:91]
v_add_u32 v247, s72, v239
v_add_u32 v247, -48, v247
v_cmp_gt_i32_e64 s[92:93], 0, v247
v_cmp_gt_i32_e64 s[94:95], 1, v247
v_cmp_gt_i32_e64 s[96:97], 2, v247
v_cmp_gt_i32_e64 s[98:99], 3, v247
v_cndmask_b32_e64 v124, v124, v14, s[92:93]
v_cndmask_b32_e64 v125, v125, v14, s[94:95]
v_cndmask_b32_e64 v126, v126, v14, s[96:97]
v_cndmask_b32_e64 v127, v127, v14, s[98:99]
v_mov_b32 v242, v96
v_max3_f32 v242, v242, v80, v81
v_max3_f32 v242, v242, v82, v83
v_max3_f32 v242, v242, v84, v85
v_max3_f32 v242, v242, v86, v87
v_max3_f32 v242, v242, v112, v113
v_max3_f32 v242, v242, v114, v115
v_max3_f32 v242, v242, v116, v117
v_max3_f32 v242, v242, v118, v119
v_mov_b32 v243, v242
s_nop 1
v_permlane32_swap_b32 v242, v243
v_max_f32 v242, v242, v243
v_mov_b32 v243, v242
s_nop 1
v_permlane16_swap_b32 v242, v243
v_max_f32 v242, v242, v243
v_sub_f32 v98, v96, v242
v_exp_f32 v98, v98
v_mov_b32 v96, v242
v_sub_f32 v80, v80, v242
v_sub_f32 v81, v81, v242
v_sub_f32 v82, v82, v242
v_sub_f32 v83, v83, v242
v_sub_f32 v84, v84, v242
v_sub_f32 v85, v85, v242
v_sub_f32 v86, v86, v242
v_sub_f32 v87, v87, v242
v_sub_f32 v112, v112, v242
v_sub_f32 v113, v113, v242
v_sub_f32 v114, v114, v242
v_sub_f32 v115, v115, v242
v_sub_f32 v116, v116, v242
v_sub_f32 v117, v117, v242
v_sub_f32 v118, v118, v242
v_sub_f32 v119, v119, v242
v_mul_f32 v2, v2, v98
v_accvgpr_read_b32 v243, a0
v_mul_f32 v243, v243, v98
v_accvgpr_write_b32 a0, v243
v_accvgpr_read_b32 v243, a1
v_mul_f32 v243, v243, v98
v_accvgpr_write_b32 a1, v243
v_accvgpr_read_b32 v243, a2
v_mul_f32 v243, v243, v98
v_accvgpr_write_b32 a2, v243
v_accvgpr_read_b32 v243, a3
v_mul_f32 v243, v243, v98
v_accvgpr_write_b32 a3, v243
v_accvgpr_read_b32 v243, a4
v_mul_f32 v243, v243, v98
v_accvgpr_write_b32 a4, v243
v_accvgpr_read_b32 v243, a5
v_mul_f32 v243, v243, v98
v_accvgpr_write_b32 a5, v243
v_accvgpr_read_b32 v243, a6
v_mul_f32 v243, v243, v98
v_accvgpr_write_b32 a6, v243
v_accvgpr_read_b32 v243, a7
v_mul_f32 v243, v243, v98
v_accvgpr_write_b32 a7, v243
v_accvgpr_read_b32 v243, a8
v_mul_f32 v243, v243, v98
v_accvgpr_write_b32 a8, v243
v_accvgpr_read_b32 v243, a9
v_mul_f32 v243, v243, v98
v_accvgpr_write_b32 a9, v243
v_accvgpr_read_b32 v243, a10
v_mul_f32 v243, v243, v98
v_accvgpr_write_b32 a10, v243
v_accvgpr_read_b32 v243, a11
v_mul_f32 v243, v243, v98
v_accvgpr_write_b32 a11, v243
v_accvgpr_read_b32 v243, a12
v_mul_f32 v243, v243, v98
v_accvgpr_write_b32 a12, v243
v_accvgpr_read_b32 v243, a13
v_mul_f32 v243, v243, v98
v_accvgpr_write_b32 a13, v243
v_accvgpr_read_b32 v243, a14
v_mul_f32 v243, v243, v98
v_accvgpr_write_b32 a14, v243
v_accvgpr_read_b32 v243, a15
v_mul_f32 v243, v243, v98
v_accvgpr_write_b32 a15, v243
v_accvgpr_read_b32 v243, a16
v_mul_f32 v243, v243, v98
v_accvgpr_write_b32 a16, v243
v_accvgpr_read_b32 v243, a17
v_mul_f32 v243, v243, v98
v_accvgpr_write_b32 a17, v243
v_accvgpr_read_b32 v243, a18
v_mul_f32 v243, v243, v98
v_accvgpr_write_b32 a18, v243
v_accvgpr_read_b32 v243, a19
v_mul_f32 v243, v243, v98
v_accvgpr_write_b32 a19, v243
v_accvgpr_read_b32 v243, a20
v_mul_f32 v243, v243, v98
v_accvgpr_write_b32 a20, v243
v_accvgpr_read_b32 v243, a21
v_mul_f32 v243, v243, v98
v_accvgpr_write_b32 a21, v243
v_accvgpr_read_b32 v243, a22
v_mul_f32 v243, v243, v98
v_accvgpr_write_b32 a22, v243
v_accvgpr_read_b32 v243, a23
v_mul_f32 v243, v243, v98
v_accvgpr_write_b32 a23, v243
v_accvgpr_read_b32 v243, a24
v_mul_f32 v243, v243, v98
v_accvgpr_write_b32 a24, v243
v_accvgpr_read_b32 v243, a25
v_mul_f32 v243, v243, v98
v_accvgpr_write_b32 a25, v243
v_accvgpr_read_b32 v243, a26
v_mul_f32 v243, v243, v98
v_accvgpr_write_b32 a26, v243
v_accvgpr_read_b32 v243, a27
v_mul_f32 v243, v243, v98
v_accvgpr_write_b32 a27, v243
v_accvgpr_read_b32 v243, a28
v_mul_f32 v243, v243, v98
v_accvgpr_write_b32 a28, v243
v_accvgpr_read_b32 v243, a29
v_mul_f32 v243, v243, v98
v_accvgpr_write_b32 a29, v243
v_accvgpr_read_b32 v243, a30
v_mul_f32 v243, v243, v98
v_accvgpr_write_b32 a30, v243
v_accvgpr_read_b32 v243, a31
v_mul_f32 v243, v243, v98
v_accvgpr_write_b32 a31, v243
v_mov_b32 v242, v97
v_max3_f32 v242, v242, v88, v89
v_max3_f32 v242, v242, v90, v91
v_max3_f32 v242, v242, v92, v93
v_max3_f32 v242, v242, v94, v95
v_max3_f32 v242, v242, v120, v121
v_max3_f32 v242, v242, v122, v123
v_max3_f32 v242, v242, v124, v125
v_max3_f32 v242, v242, v126, v127
v_mov_b32 v243, v242
s_nop 1
v_permlane32_swap_b32 v242, v243
v_max_f32 v242, v242, v243
v_mov_b32 v243, v242
s_nop 1
v_permlane16_swap_b32 v242, v243
v_max_f32 v242, v242, v243
v_sub_f32 v99, v97, v242
v_exp_f32 v99, v99
v_mov_b32 v97, v242
v_sub_f32 v88, v88, v242
v_sub_f32 v89, v89, v242
v_sub_f32 v90, v90, v242
v_sub_f32 v91, v91, v242
v_sub_f32 v92, v92, v242
v_sub_f32 v93, v93, v242
v_sub_f32 v94, v94, v242
v_sub_f32 v95, v95, v242
v_sub_f32 v120, v120, v242
v_sub_f32 v121, v121, v242
v_sub_f32 v122, v122, v242
v_sub_f32 v123, v123, v242
v_sub_f32 v124, v124, v242
v_sub_f32 v125, v125, v242
v_sub_f32 v126, v126, v242
v_sub_f32 v127, v127, v242
v_mul_f32 v3, v3, v99
v_accvgpr_read_b32 v243, a32
v_mul_f32 v243, v243, v99
v_accvgpr_write_b32 a32, v243
v_accvgpr_read_b32 v243, a33
v_mul_f32 v243, v243, v99
v_accvgpr_write_b32 a33, v243
v_accvgpr_read_b32 v243, a34
v_mul_f32 v243, v243, v99
v_accvgpr_write_b32 a34, v243
v_accvgpr_read_b32 v243, a35
v_mul_f32 v243, v243, v99
v_accvgpr_write_b32 a35, v243
v_accvgpr_read_b32 v243, a36
v_mul_f32 v243, v243, v99
v_accvgpr_write_b32 a36, v243
v_accvgpr_read_b32 v243, a37
v_mul_f32 v243, v243, v99
v_accvgpr_write_b32 a37, v243
v_accvgpr_read_b32 v243, a38
v_mul_f32 v243, v243, v99
v_accvgpr_write_b32 a38, v243
v_accvgpr_read_b32 v243, a39
v_mul_f32 v243, v243, v99
v_accvgpr_write_b32 a39, v243
v_accvgpr_read_b32 v243, a40
v_mul_f32 v243, v243, v99
v_accvgpr_write_b32 a40, v243
v_accvgpr_read_b32 v243, a41
v_mul_f32 v243, v243, v99
v_accvgpr_write_b32 a41, v243
v_accvgpr_read_b32 v243, a42
v_mul_f32 v243, v243, v99
v_accvgpr_write_b32 a42, v243
v_accvgpr_read_b32 v243, a43
v_mul_f32 v243, v243, v99
v_accvgpr_write_b32 a43, v243
v_accvgpr_read_b32 v243, a44
v_mul_f32 v243, v243, v99
v_accvgpr_write_b32 a44, v243
v_accvgpr_read_b32 v243, a45
v_mul_f32 v243, v243, v99
v_accvgpr_write_b32 a45, v243
v_accvgpr_read_b32 v243, a46
v_mul_f32 v243, v243, v99
v_accvgpr_write_b32 a46, v243
v_accvgpr_read_b32 v243, a47
v_mul_f32 v243, v243, v99
v_accvgpr_write_b32 a47, v243
v_accvgpr_read_b32 v243, a48
v_mul_f32 v243, v243, v99
v_accvgpr_write_b32 a48, v243
v_accvgpr_read_b32 v243, a49
v_mul_f32 v243, v243, v99
v_accvgpr_write_b32 a49, v243
v_accvgpr_read_b32 v243, a50
v_mul_f32 v243, v243, v99
v_accvgpr_write_b32 a50, v243
v_accvgpr_read_b32 v243, a51
v_mul_f32 v243, v243, v99
v_accvgpr_write_b32 a51, v243
v_accvgpr_read_b32 v243, a52
v_mul_f32 v243, v243, v99
v_accvgpr_write_b32 a52, v243
v_accvgpr_read_b32 v243, a53
v_mul_f32 v243, v243, v99
v_accvgpr_write_b32 a53, v243
v_accvgpr_read_b32 v243, a54
v_mul_f32 v243, v243, v99
v_accvgpr_write_b32 a54, v243
v_accvgpr_read_b32 v243, a55
v_mul_f32 v243, v243, v99
v_accvgpr_write_b32 a55, v243
v_accvgpr_read_b32 v243, a56
v_mul_f32 v243, v243, v99
v_accvgpr_write_b32 a56, v243
v_accvgpr_read_b32 v243, a57
v_mul_f32 v243, v243, v99
v_accvgpr_write_b32 a57, v243
v_accvgpr_read_b32 v243, a58
v_mul_f32 v243, v243, v99
v_accvgpr_write_b32 a58, v243
v_accvgpr_read_b32 v243, a59
v_mul_f32 v243, v243, v99
v_accvgpr_write_b32 a59, v243
v_accvgpr_read_b32 v243, a60
v_mul_f32 v243, v243, v99
v_accvgpr_write_b32 a60, v243
v_accvgpr_read_b32 v243, a61
v_mul_f32 v243, v243, v99
v_accvgpr_write_b32 a61, v243
v_accvgpr_read_b32 v243, a62
v_mul_f32 v243, v243, v99
v_accvgpr_write_b32 a62, v243
v_accvgpr_read_b32 v243, a63
v_mul_f32 v243, v243, v99
v_accvgpr_write_b32 a63, v243
v_exp_f32 v80, v80
v_exp_f32 v81, v81
v_exp_f32 v82, v82
v_add_f32 v2, v2, v80
v_add_f32 v2, v2, v81
v_exp_f32 v83, v83
v_cvt_pk_bf16_f32 v80, v80, v81
v_exp_f32 v84, v84
v_add_f32 v2, v2, v82
v_add_f32 v2, v2, v83
v_exp_f32 v85, v85
v_cvt_pk_bf16_f32 v81, v82, v83
v_exp_f32 v86, v86
v_add_f32 v2, v2, v84
v_add_f32 v2, v2, v85
v_exp_f32 v87, v87
v_cvt_pk_bf16_f32 v82, v84, v85
v_exp_f32 v88, v88
v_add_f32 v2, v2, v86
v_add_f32 v2, v2, v87
v_exp_f32 v89, v89
v_cvt_pk_bf16_f32 v83, v86, v87
v_exp_f32 v90, v90
v_add_f32 v3, v3, v88
v_add_f32 v3, v3, v89
v_exp_f32 v91, v91
v_cvt_pk_bf16_f32 v88, v88, v89
v_exp_f32 v92, v92
v_add_f32 v3, v3, v90
v_add_f32 v3, v3, v91
v_exp_f32 v93, v93
v_cvt_pk_bf16_f32 v89, v90, v91
v_exp_f32 v94, v94
v_add_f32 v3, v3, v92
v_add_f32 v3, v3, v93
v_exp_f32 v95, v95
v_cvt_pk_bf16_f32 v90, v92, v93
v_exp_f32 v112, v112
v_add_f32 v3, v3, v94
v_add_f32 v3, v3, v95
v_exp_f32 v113, v113
v_cvt_pk_bf16_f32 v91, v94, v95
v_exp_f32 v114, v114
v_add_f32 v2, v2, v112
v_add_f32 v2, v2, v113
v_exp_f32 v115, v115
v_cvt_pk_bf16_f32 v112, v112, v113
v_exp_f32 v116, v116
v_add_f32 v2, v2, v114
v_add_f32 v2, v2, v115
v_exp_f32 v117, v117
v_cvt_pk_bf16_f32 v113, v114, v115
v_exp_f32 v118, v118
v_add_f32 v2, v2, v116
v_add_f32 v2, v2, v117
v_exp_f32 v119, v119
v_cvt_pk_bf16_f32 v114, v116, v117
v_exp_f32 v120, v120
v_add_f32 v2, v2, v118
v_add_f32 v2, v2, v119
v_exp_f32 v121, v121
v_cvt_pk_bf16_f32 v115, v118, v119
v_exp_f32 v122, v122
v_add_f32 v3, v3, v120
v_add_f32 v3, v3, v121
v_exp_f32 v123, v123
v_cvt_pk_bf16_f32 v120, v120, v121
v_exp_f32 v124, v124
v_add_f32 v3, v3, v122
v_add_f32 v3, v3, v123
v_exp_f32 v125, v125
v_cvt_pk_bf16_f32 v121, v122, v123
v_exp_f32 v126, v126
v_add_f32 v3, v3, v124
v_add_f32 v3, v3, v125
v_exp_f32 v127, v127
v_cvt_pk_bf16_f32 v122, v124, v125
v_add_f32 v3, v3, v126
v_add_f32 v3, v3, v127
v_cvt_pk_bf16_f32 v123, v126, v127
s_waitcnt lgkmcnt(15)
MA 0,a,192,v,80
MA 32,a,192,v,88
s_waitcnt lgkmcnt(14)
MA 4,a,196,v,80
MA 36,a,196,v,88
s_waitcnt lgkmcnt(13)
MA 8,a,200,v,80
MA 40,a,200,v,88
s_waitcnt lgkmcnt(12)
MA 12,a,204,v,80
MA 44,a,204,v,88
s_waitcnt lgkmcnt(11)
MA 16,a,208,v,80
MA 48,a,208,v,88
s_waitcnt lgkmcnt(10)
MA 20,a,212,v,80
MA 52,a,212,v,88
s_waitcnt lgkmcnt(9)
MA 24,a,216,v,80
MA 56,a,216,v,88
s_waitcnt lgkmcnt(8)
MA 28,a,220,v,80
MA 60,a,220,v,88
s_waitcnt lgkmcnt(7)
MA 0,a,224,v,112
MA 32,a,224,v,120
s_waitcnt lgkmcnt(6)
MA 4,a,228,v,112
MA 36,a,228,v,120
s_waitcnt lgkmcnt(5)
MA 8,a,232,v,112
MA 40,a,232,v,120
s_waitcnt lgkmcnt(4)
MA 12,a,236,v,112
MA 44,a,236,v,120
s_waitcnt lgkmcnt(3)
MA 16,a,240,v,112
MA 48,a,240,v,120
s_waitcnt lgkmcnt(2)
MA 20,a,244,v,112
MA 52,a,244,v,120
s_waitcnt lgkmcnt(1)
MA 24,a,248,v,112
MA 56,a,248,v,120
s_waitcnt lgkmcnt(0)
MA 28,a,252,v,112
MA 60,a,252,v,120
s_add_u32 s71, s71, 16384
s_sub_u32 s72, s72, 64
s_sub_u32 s74, s74, 1
s_nop 15
s_cmp_lg_u32 s74, 0
s_cbranch_scc1 L_fb_tile
v_mov_b32 v240, v2
s_nop 1
v_permlane32_swap_b32 v2, v240
v_add_f32 v2, v2, v240
v_mov_b32 v240, v2
s_nop 1
v_permlane16_swap_b32 v2, v240
v_add_f32 v2, v2, v240
v_mov_b32 v240, v3
s_nop 1
v_permlane32_swap_b32 v3, v240
v_add_f32 v3, v3, v240
v_mov_b32 v240, v3
s_nop 1
v_permlane16_swap_b32 v3, v240
v_add_f32 v3, v3, v240
v_rcp_f32 v2, v2
v_rcp_f32 v3, v3
s_add_u32 s80, s73, s76
s_nop 4
v_accvgpr_read_b32 v240, a0
v_accvgpr_read_b32 v241, a1
v_accvgpr_read_b32 v242, a2
v_accvgpr_read_b32 v243, a3
v_accvgpr_read_b32 v244, a4
v_accvgpr_read_b32 v245, a5
v_accvgpr_read_b32 v246, a6
v_accvgpr_read_b32 v247, a7
v_mul_f32 v240, v240, v2
v_mul_f32 v241, v241, v2
v_mul_f32 v242, v242, v2
v_mul_f32 v243, v243, v2
v_mul_f32 v244, v244, v2
v_mul_f32 v245, v245, v2
v_mul_f32 v246, v246, v2
v_mul_f32 v247, v247, v2
v_cvt_pk_bf16_f32 v248, v240, v241
v_cvt_pk_bf16_f32 v249, v242, v243
v_cvt_pk_bf16_f32 v250, v244, v245
v_cvt_pk_bf16_f32 v251, v246, v247
buffer_store_dwordx4 v[248:251], v15, s[60:63], s73 offen offset:0 sc1
v_accvgpr_read_b32 v240, a8
v_accvgpr_read_b32 v241, a9
v_accvgpr_read_b32 v242, a10
v_accvgpr_read_b32 v243, a11
v_accvgpr_read_b32 v244, a12
v_accvgpr_read_b32 v245, a13
v_accvgpr_read_b32 v246, a14
v_accvgpr_read_b32 v247, a15
v_mul_f32 v240, v240, v2
v_mul_f32 v241, v241, v2
v_mul_f32 v242, v242, v2
v_mul_f32 v243, v243, v2
v_mul_f32 v244, v244, v2
v_mul_f32 v245, v245, v2
v_mul_f32 v246, v246, v2
v_mul_f32 v247, v247, v2
v_cvt_pk_bf16_f32 v252, v240, v241
v_cvt_pk_bf16_f32 v253, v242, v243
v_cvt_pk_bf16_f32 v254, v244, v245
v_cvt_pk_bf16_f32 v255, v246, v247
buffer_store_dwordx4 v[252:255], v15, s[60:63], s73 offen offset:1024 sc1
v_accvgpr_read_b32 v240, a16
v_accvgpr_read_b32 v241, a17
v_accvgpr_read_b32 v242, a18
v_accvgpr_read_b32 v243, a19
v_accvgpr_read_b32 v244, a20
v_accvgpr_read_b32 v245, a21
v_accvgpr_read_b32 v246, a22
v_accvgpr_read_b32 v247, a23
v_mul_f32 v240, v240, v2
v_mul_f32 v241, v241, v2
v_mul_f32 v242, v242, v2
v_mul_f32 v243, v243, v2
v_mul_f32 v244, v244, v2
v_mul_f32 v245, v245, v2
v_mul_f32 v246, v246, v2
v_mul_f32 v247, v247, v2
v_cvt_pk_bf16_f32 v248, v240, v241
v_cvt_pk_bf16_f32 v249, v242, v243
v_cvt_pk_bf16_f32 v250, v244, v245
v_cvt_pk_bf16_f32 v251, v246, v247
buffer_store_dwordx4 v[248:251], v15, s[60:63], s73 offen offset:2048 sc1
v_accvgpr_read_b32 v240, a24
v_accvgpr_read_b32 v241, a25
v_accvgpr_read_b32 v242, a26
v_accvgpr_read_b32 v243, a27
v_accvgpr_read_b32 v244, a28
v_accvgpr_read_b32 v245, a29
v_accvgpr_read_b32 v246, a30
v_accvgpr_read_b32 v247, a31
v_mul_f32 v240, v240, v2
v_mul_f32 v241, v241, v2
v_mul_f32 v242, v242, v2
v_mul_f32 v243, v243, v2
v_mul_f32 v244, v244, v2
v_mul_f32 v245, v245, v2
v_mul_f32 v246, v246, v2
v_mul_f32 v247, v247, v2
v_cvt_pk_bf16_f32 v252, v240, v241
v_cvt_pk_bf16_f32 v253, v242, v243
v_cvt_pk_bf16_f32 v254, v244, v245
v_cvt_pk_bf16_f32 v255, v246, v247
buffer_store_dwordx4 v[252:255], v15, s[60:63], s73 offen offset:3072 sc1
v_accvgpr_read_b32 v240, a32
v_accvgpr_read_b32 v241, a33
v_accvgpr_read_b32 v242, a34
v_accvgpr_read_b32 v243, a35
v_accvgpr_read_b32 v244, a36
v_accvgpr_read_b32 v245, a37
v_accvgpr_read_b32 v246, a38
v_accvgpr_read_b32 v247, a39
v_mul_f32 v240, v240, v3
v_mul_f32 v241, v241, v3
v_mul_f32 v242, v242, v3
v_mul_f32 v243, v243, v3
v_mul_f32 v244, v244, v3
v_mul_f32 v245, v245, v3
v_mul_f32 v246, v246, v3
v_mul_f32 v247, v247, v3
v_cvt_pk_bf16_f32 v248, v240, v241
v_cvt_pk_bf16_f32 v249, v242, v243
v_cvt_pk_bf16_f32 v250, v244, v245
v_cvt_pk_bf16_f32 v251, v246, v247
buffer_store_dwordx4 v[248:251], v15, s[60:63], s80 offen offset:0 sc1
v_accvgpr_read_b32 v240, a40
v_accvgpr_read_b32 v241, a41
v_accvgpr_read_b32 v242, a42
v_accvgpr_read_b32 v243, a43
v_accvgpr_read_b32 v244, a44
v_accvgpr_read_b32 v245, a45
v_accvgpr_read_b32 v246, a46
v_accvgpr_read_b32 v247, a47
v_mul_f32 v240, v240, v3
v_mul_f32 v241, v241, v3
v_mul_f32 v242, v242, v3
v_mul_f32 v243, v243, v3
v_mul_f32 v244, v244, v3
v_mul_f32 v245, v245, v3
v_mul_f32 v246, v246, v3
v_mul_f32 v247, v247, v3
v_cvt_pk_bf16_f32 v252, v240, v241
v_cvt_pk_bf16_f32 v253, v242, v243
v_cvt_pk_bf16_f32 v254, v244, v245
v_cvt_pk_bf16_f32 v255, v246, v247
buffer_store_dwordx4 v[252:255], v15, s[60:63], s80 offen offset:1024 sc1
v_accvgpr_read_b32 v240, a48
v_accvgpr_read_b32 v241, a49
v_accvgpr_read_b32 v242, a50
v_accvgpr_read_b32 v243, a51
v_accvgpr_read_b32 v244, a52
v_accvgpr_read_b32 v245, a53
v_accvgpr_read_b32 v246, a54
v_accvgpr_read_b32 v247, a55
v_mul_f32 v240, v240, v3
v_mul_f32 v241, v241, v3
v_mul_f32 v242, v242, v3
v_mul_f32 v243, v243, v3
v_mul_f32 v244, v244, v3
v_mul_f32 v245, v245, v3
v_mul_f32 v246, v246, v3
v_mul_f32 v247, v247, v3
v_cvt_pk_bf16_f32 v248, v240, v241
v_cvt_pk_bf16_f32 v249, v242, v243
v_cvt_pk_bf16_f32 v250, v244, v245
v_cvt_pk_bf16_f32 v251, v246, v247
buffer_store_dwordx4 v[248:251], v15, s[60:63], s80 offen offset:2048 sc1
v_accvgpr_read_b32 v240, a56
v_accvgpr_read_b32 v241, a57
v_accvgpr_read_b32 v242, a58
v_accvgpr_read_b32 v243, a59
v_accvgpr_read_b32 v244, a60
v_accvgpr_read_b32 v245, a61
v_accvgpr_read_b32 v246, a62
v_accvgpr_read_b32 v247, a63
v_mul_f32 v240, v240, v3
v_mul_f32 v241, v241, v3
v_mul_f32 v242, v242, v3
v_mul_f32 v243, v243, v3
v_mul_f32 v244, v244, v3
v_mul_f32 v245, v245, v3
v_mul_f32 v246, v246, v3
v_mul_f32 v247, v247, v3
v_cvt_pk_bf16_f32 v252, v240, v241
v_cvt_pk_bf16_f32 v253, v242, v243
v_cvt_pk_bf16_f32 v254, v244, v245
v_cvt_pk_bf16_f32 v255, v246, v247
buffer_store_dwordx4 v[252:255], v15, s[60:63], s80 offen offset:3072 sc1
s_cmp_lg_u32 s81, 0
s_cbranch_scc1 L_fb_done
s_mov_b32 s81, 1
s_sub_u32 s74, 34, s77
s_mov_b32 s73, s101
s_mov_b32 s72, s70
v_mov_b32 v16, v48
v_mov_b32 v17, v49
v_mov_b32 v18, v50
v_mov_b32 v19, v51
v_mov_b32 v20, v52
v_mov_b32 v21, v53
v_mov_b32 v22, v54
v_mov_b32 v23, v55
v_mov_b32 v24, v56
v_mov_b32 v25, v57
v_mov_b32 v26, v58
v_mov_b32 v27, v59
v_mov_b32 v28, v60
v_mov_b32 v29, v61
v_mov_b32 v30, v62
v_mov_b32 v31, v63
v_mov_b32 v32, v64
v_mov_b32 v33, v65
v_mov_b32 v34, v66
v_mov_b32 v35, v67
v_mov_b32 v36, v68
v_mov_b32 v37, v69
v_mov_b32 v38, v70
v_mov_b32 v39, v71
v_mov_b32 v40, v72
v_mov_b32 v41, v73
v_mov_b32 v42, v74
v_mov_b32 v43, v75
v_mov_b32 v44, v76
v_mov_b32 v45, v77
v_mov_b32 v46, v78
v_mov_b32 v47, v79
s_branch L_fb_set
L_fb_done:
s_waitcnt vmcnt(0) lgkmcnt(0)
s_barrier
s_load_dwordx2 s[88:89], s[0:1], 104
s_mul_i32 s36, s3, 8320
v_and_b32 v16, 15, v1
v_lshrrev_b32 v17, 4, v1
v_add_u32 v18, 1, v16
v_and_b32 v19, 1, v18
v_mul_u32_u24 v19, 4160, v19
v_add_u32 v18, 2, v16
v_lshrrev_b32 v18, 1, v18
v_lshl_add_u32 v19, v18, 2, v19
v_lshl_add_u32 v19, v17, 4, v19
v_add_u32 v40, s36, v19
v_add_u32 v41, 1024, v40
v_add_u32 v42, 2048, v40
v_add_u32 v43, 3072, v40
v_add_u32 v10, s36, v232
v_lshlrev_b32 v18, 5, v16
v_lshlrev_b32 v19, 4, v17
v_sub_u32 v19, v19, v18
s_add_u32 s37, s43, 480
v_add_u32 v5, s37, v19
v_mov_b32 v20, 0
v_mov_b32 v21, 0
v_mov_b32 v22, 0
v_mov_b32 v23, 0
v_and_b32 v16, 1, v1
v_mul_u32_u24 v16, 4160, v16
v_and_b32 v17, 2, v1
v_lshl_add_u32 v16, v17, 3, v16
v_add_u32 v16, s36, v16
ds_write_b128 v16, v[20:23]
v_and_b32 v17, 31, v1
v_lshlrev_b32 v17, 4, v17
v_add_u32 v17, s43, v17
ds_write_b128 v17, v[20:23] offset:4096
ds_write_b128 v10, v[210:213] offset:32
v_alignbit_b32 v24, v210, v209, 16
v_alignbit_b32 v25, v211, v210, 16
v_alignbit_b32 v26, v212, v211, 16
v_alignbit_b32 v27, v213, v212, 16
ds_write_b128 v10, v[24:27] offset:4192
ds_write_b128 v10, v[216:219] offset:1056
v_alignbit_b32 v28, v216, v215, 16
v_alignbit_b32 v29, v217, v216, 16
v_alignbit_b32 v30, v218, v217, 16
v_alignbit_b32 v31, v219, v218, 16
ds_write_b128 v10, v[28:31] offset:5216
ds_write_b128 v10, v[222:225] offset:2080
v_alignbit_b32 v24, v222, v221, 16
v_alignbit_b32 v25, v223, v222, 16
v_alignbit_b32 v26, v224, v223, 16
v_alignbit_b32 v27, v225, v224, 16
ds_write_b128 v10, v[24:27] offset:6240
ds_write_b128 v10, v[228:231] offset:3104
v_alignbit_b32 v28, v228, v227, 16
v_alignbit_b32 v29, v229, v228, 16
v_alignbit_b32 v30, v230, v229, 16
v_alignbit_b32 v31, v231, v230, 16
ds_write_b128 v10, v[28:31] offset:7264
s_waitcnt lgkmcnt(0)
s_branch L_p3_done
L_spin_go:
s_mov_b32 s36, 400000
L_spin_go_l:
s_sleep 1
buffer_load_dword v254, off, s[12:15], 0 sc1
s_waitcnt vmcnt(0)
v_cmp_gt_u32 vcc, 1, v254
s_nop 4
s_cbranch_vccz L_spin_go_ret
s_sub_u32 s36, s36, 1
s_cmp_lg_u32 s36, 0
s_cbranch_scc1 L_spin_go_l
s_branch L_spin_go_ret
L_spin_f1:
s_mov_b32 s36, 400000
L_spin_f1_l:
s_sleep 1
buffer_load_dword v237, v233, s[8:11], 0 offen offset:0 sc1
s_waitcnt vmcnt(0)
v_cmp_gt_u32 vcc, 1, v237
s_nop 4
s_cbranch_vccz L_spin_f1_ret
s_sub_u32 s36, s36, 1
s_cmp_lg_u32 s36, 0
s_cbranch_scc1 L_spin_f1_l
s_branch L_spin_f1_ret
L_spin_w:
s_mov_b32 s36, 400000
L_spin_w_l:
s_sleep 1
buffer_load_dword v253, v254, s[8:11], 0 offen offset:1024 sc1
s_waitcnt vmcnt(0)
v_cmp_gt_u32 vcc, 1, v253
s_nop 4
s_cbranch_vccz L_spin_w_ret
s_sub_u32 s36, s36, 1
s_cmp_lg_u32 s36, 0
s_cbranch_scc1 L_spin_w_l
s_branch L_spin_w_ret
L_spin_f2:
s_mov_b32 s36, 400000
L_spin_f2_l:
s_sleep 1
buffer_load_dword v253, v252, s[8:11], 0 offen sc1
s_waitcnt vmcnt(0)
v_cmp_gt_u32 vcc, 1, v253
s_nop 4
s_cbranch_vccz L_spin_f2_ret
s_sub_u32 s36, s36, 1
s_cmp_lg_u32 s36, 0
s_cbranch_scc1 L_spin_f2_l
s_branch L_spin_f2_ret
L_spin_f3:
s_mov_b32 s36, 400000
L_spin_f3_l:
s_sleep 1
buffer_load_dword v253, v254, s[8:11], 0 offen offset:2048 sc1
s_waitcnt vmcnt(0)
v_cmp_gt_u32 vcc, 1, v253
s_nop 4
s_cbranch_vccz L_spin_f3_ret
s_sub_u32 s36, s36, 1
s_cmp_lg_u32 s36, 0
s_cbranch_scc1 L_spin_f3_l
s_branch L_spin_f3_ret
L_code_end:
s_endpgm
.section .rodata,"a"
.p2align 6
.amdhsa_kernel gated_mix__ssm_conv_h3__compressed_kv_cla__prompt_kernel
  .amdhsa_next_free_vgpr 512
  .amdhsa_next_free_sgpr 102
  .amdhsa_accum_offset 256
  .amdhsa_group_segment_fixed_size 0
  .amdhsa_kernarg_size 128
  .amdhsa_user_sgpr_count 2
  .amdhsa_user_sgpr_kernarg_segment_ptr 1
  .amdhsa_system_sgpr_workgroup_id_x 1
  .amdhsa_float_denorm_mode_32 3
.end_amdhsa_kernel
.text
```

```asm
; @launch grid=(256,1,1) block=(256,1,1) lds=163840
.amdgcn_target "amdgcn-amd-amdhsa--gfx950"
.text
.macro MA d,x,a,y,b
v_mfma_f32_16x16x32_bf16 a[\d:\d+3], \x[\a:\a+3], \y[\b:\b+3], a[\d:\d+3]
.endm
.macro MV d,x,a,y,b
v_mfma_f32_16x16x32_bf16 v[\d:\d+3], \x[\a:\a+3], \y[\b:\b+3], v[\d:\d+3]
.endm
.macro TR d,a,o
ds_read_b64_tr_b16 v[\d:\d+1], v\a offset:\o
.endm
.globl gated_mix__ssm_conv_h3__compressed_kv_cla__prompt_kernel
.p2align 8
.type gated_mix__ssm_conv_h3__compressed_kv_cla__prompt_kernel,@function
gated_mix__ssm_conv_h3__compressed_kv_cla__prompt_kernel:
s_cmp_ge_u32 s2, 256
s_cbranch_scc1 L_end
s_load_dwordx2 s[44:45], s[0:1], 56
s_load_dwordx4 s[48:51], s[0:1], 72
s_load_dwordx2 s[40:41], s[0:1], 120
s_load_dwordx2 s[52:53], s[0:1], 112
s_load_dwordx2 s[32:33], s[0:1], 0
s_load_dwordx2 s[34:35], s[0:1], 64
v_lshrrev_b32 v2, 6, v0
v_and_b32 v1, 63, v0
v_lshlrev_b32 v3, 4, v0
v_readfirstlane_b32 s3, v2
s_getpc_b64 s[4:5]
L_ct_e:
s_add_u32 s4, s4, L_p1_K - L_ct_e
s_addc_u32 s5, s5, 0
v_mov_b32 v77, s5
v_mov_b32 v76, s4
s_lshr_b32 s4, s2, 3
s_lshl_b32 s4, s4, 2
s_add_u32 s4, s4, s3
s_lshl_b32 s4, s4, 7
v_and_b32 v79, 3, v1
v_lshlrev_b32 v79, 14, v79
v_add_u32 v79, s4, v79
v_min_u32 v79, L_p3_begin - L_p1_K - 4, v79
v_add_co_u32 v76, vcc, v76, v79
s_nop 1
v_addc_co_u32 v77, vcc, 0, v77, vcc
global_load_dword v79, v[76:77], off
s_and_b32 s36, s2, 7
s_lshr_b32 s37, s2, 3
s_and_b32 s38, s37, 7
s_lshr_b32 s37, s37, 3
s_lshr_b32 s42, s37, 1
s_and_b32 s37, s37, 1
s_lshl_b32 s36, s36, 1
s_add_u32 s36, s36, s37
s_lshl_b32 s24, s38, 18
s_lshl_b32 s39, s3, 16
s_add_u32 s24, s24, s39
s_lshl_b32 s25, s3, 17
s_lshl_b32 s39, s36, 9
s_add_u32 s25, s25, s39
s_and_b32 s20, s2, 7
s_lshl_b32 s21, s20, 19
s_lshl_b32 s20, s20, 7
s_lshl_b32 s22, s3, 13
s_add_u32 s23, s22, 98304
v_lshrrev_b32 v204, 3, v1
v_lshlrev_b32 v204, 10, v204
v_lshrrev_b32 v205, 4, v1
v_and_b32 v206, 7, v1
v_xor_b32 v206, v206, v205
v_lshl_add_u32 v204, v206, 4, v204
v_xor_b32 v207, 64, v204
v_add_u32 v176, 0, v204
v_add_u32 v177, 7168, v207
v_add_u32 v178, 14336, v204
v_add_u32 v179, 21504, v207
v_add_u32 v180, 32768, v204
v_add_u32 v181, 39936, v207
v_add_u32 v182, 47104, v204
v_add_u32 v183, 54272, v207
v_lshrrev_b32 v204, 5, v1
v_and_b32 v206, 31, v1
v_lshlrev_b32 v207, 1, v204
v_xor_b32 v206, v206, v207
v_lshlrev_b32 v204, 13, v204
v_xor_b32 v207, 0, v206
v_lshl_add_u32 v207, v207, 4, v204
v_add_u32 v184, 0, v207
v_xor_b32 v207, 4, v206
v_lshl_add_u32 v207, v207, 4, v204
v_add_u32 v185, 15360, v207
v_xor_b32 v207, 0, v206
v_lshl_add_u32 v207, v207, 4, v204
v_add_u32 v186, 30720, v207
v_xor_b32 v207, 4, v206
v_lshl_add_u32 v207, v207, 4, v204
v_add_u32 v187, 46080, v207
v_xor_b32 v207, 8, v206
v_lshl_add_u32 v207, v207, 4, v204
v_add_u32 v188, 65536, v207
v_xor_b32 v207, 12, v206
v_lshl_add_u32 v207, v207, 4, v204
v_add_u32 v189, 80896, v207
v_xor_b32 v207, 8, v206
v_lshl_add_u32 v207, v207, 4, v204
v_add_u32 v190, 96256, v207
v_xor_b32 v207, 12, v206
v_lshl_add_u32 v207, v207, 4, v204
v_add_u32 v191, 111616, v207
s_waitcnt lgkmcnt(0)
s_add_u32 s8, s44, s24
s_addc_u32 s9, s45, 0
s_mov_b32 s10, 65536
s_mov_b32 s11, 0x20000
s_cmp_eq_u32 s42, 0
s_cselect_b32 s12, s48, s50
s_cselect_b32 s13, s49, s51
s_add_u32 s12, s12, s25
s_addc_u32 s13, s13, 0
s_sub_u32 s14, 4194304, s25
s_mov_b32 s15, 0x20000
s_add_u32 s4, s40, 59768832
s_addc_u32 s5, s41, 0
s_mov_b32 s6, 8192
s_mov_b32 s7, 0x20000
s_lshl_b32 s43, s2, 20
v_add_u32 v3, s43, v3
v_mov_b32 v4, 0
v_mov_b32 v5, 0
v_mov_b32 v6, 0
v_mov_b32 v7, 0
s_movk_i32 s43, 4096
buffer_store_dwordx4 v[4:7], v3, s[4:7], 0 offen sc1
buffer_store_dwordx4 v[4:7], v3, s[4:7], s43 offen sc1
s_waitcnt vmcnt(2)
v_lshlrev_b32 v79, 16, v3
s_add_u32 m0, s23, 0
s_nop 0
buffer_load_dwordx4 v184, s[12:15], s21 offen offset:0 lds
buffer_load_dwordx4 v185, s[12:15], s21 offen offset:1024 lds
buffer_load_dwordx4 v186, s[12:15], s21 offen offset:2048 lds
buffer_load_dwordx4 v187, s[12:15], s21 offen offset:3072 lds
s_add_u32 m0, s23, 4096
s_nop 0
buffer_load_dwordx4 v188, s[12:15], s21 offen offset:0 lds
buffer_load_dwordx4 v189, s[12:15], s21 offen offset:1024 lds
buffer_load_dwordx4 v190, s[12:15], s21 offen offset:2048 lds
buffer_load_dwordx4 v191, s[12:15], s21 offen offset:3072 lds
s_add_u32 s21, s21, 524288
s_and_b32 s21, s21, 4194303
s_add_u32 m0, s22, 0
s_nop 0
buffer_load_dwordx4 v176, s[8:11], s20 offen offset:0 lds
buffer_load_dwordx4 v177, s[8:11], s20 offen offset:1024 lds
buffer_load_dwordx4 v178, s[8:11], s20 offen offset:2048 lds
buffer_load_dwordx4 v179, s[8:11], s20 offen offset:3072 lds
s_add_u32 m0, s22, 4096
s_nop 0
buffer_load_dwordx4 v180, s[8:11], s20 offen offset:0 lds
buffer_load_dwordx4 v181, s[8:11], s20 offen offset:1024 lds
buffer_load_dwordx4 v182, s[8:11], s20 offen offset:2048 lds
buffer_load_dwordx4 v183, s[8:11], s20 offen offset:3072 lds
s_add_u32 s20, s20, 128
s_and_b32 s20, s20, 1023
v_and_b32 v204, 15, v1
v_lshrrev_b32 v206, 1, v204
v_xor_b32 v206, v206, v205
v_lshlrev_b32 v206, 4, v206
v_lshl_add_u32 v206, v204, 7, v206
s_and_b32 s39, s3, 1
s_lshl_b32 s39, s39, 14
v_add_u32 v192, s39, v206
v_xor_b32 v193, 64, v192
v_add_u32 v194, 0x10000, v192
v_add_u32 v195, 0x10000, v193
v_bfe_u32 v204, v1, 2, 2
v_and_b32 v206, 1, v205
v_lshl_or_b32 v206, v206, 2, v204
v_lshl_add_u32 v204, v205, 3, v204
v_lshlrev_b32 v204, 9, v204
v_and_b32 v207, 3, v1
v_lshl_add_u32 v204, v207, 3, v204
s_lshr_b32 s39, s3, 1
s_lshl_b32 s39, s39, 8
s_add_u32 s39, s39, 98304
v_add_u32 v204, s39, v204
v_xor_b32 v207, 0, v206
v_lshl_add_u32 v196, v207, 5, v204
v_xor_b32 v207, 1, v206
v_lshl_add_u32 v197, v207, 5, v204
v_xor_b32 v207, 2, v206
v_lshl_add_u32 v198, v207, 5, v204
v_xor_b32 v207, 3, v206
v_lshl_add_u32 v199, v207, 5, v204
v_xor_b32 v207, 4, v206
v_lshl_add_u32 v200, v207, 5, v204
v_xor_b32 v207, 5, v206
v_lshl_add_u32 v201, v207, 5, v204
v_xor_b32 v207, 6, v206
v_lshl_add_u32 v202, v207, 5, v204
v_xor_b32 v207, 7, v206
v_lshl_add_u32 v203, v207, 5, v204
s_lshl_b32 s36, s36, 1
s_lshr_b32 s39, s3, 1
s_add_u32 s36, s36, s39
s_lshl_b32 s24, s36, 19
s_lshl_b32 s38, s38, 16
s_add_u32 s24, s24, s38
s_and_b32 s39, s3, 1
s_lshl_b32 s39, s39, 15
s_add_u32 s24, s24, s39
s_lshl_b32 s36, s42, 24
s_add_u32 s16, s40, s36
s_addc_u32 s17, s41, 0
s_mov_b32 s18, 16777216
s_mov_b32 s19, 0x20000
s_mov_b32 s54, 256
s_mov_b32 s55, 0x20000
v_mov_b32 v78, 1
s_cmp_lg_u32 s2, 0
s_cselect_b32 s43, 0x10000000, 0
v_or_b32 v79, s43, v79
s_waitcnt vmcnt(0)
s_barrier
buffer_store_dword v78, v79, s[52:55], 0 offen sc1
ds_read_b128 v[80:83], v192 offset:0
ds_read_b128 v[84:87], v192 offset:2048
ds_read_b128 v[88:91], v192 offset:4096
ds_read_b128 v[92:95], v192 offset:6144
ds_read_b128 v[96:99], v192 offset:8192
ds_read_b128 v[100:103], v192 offset:10240
ds_read_b128 v[104:107], v192 offset:12288
ds_read_b128 v[108:111], v192 offset:14336
TR 144,196,0
TR 146,196,2048
TR 148,197,0
TR 150,197,2048
TR 152,198,0
TR 154,198,2048
TR 156,199,0
TR 158,199,2048
TR 160,200,0
TR 162,200,2048
TR 164,201,0
TR 166,201,2048
TR 168,202,0
TR 170,202,2048
TR 172,203,0
TR 174,203,2048
s_cmp_eq_u32 s42, 0
s_cbranch_scc0 L_p1_V
L_p1_K:
s_waitcnt lgkmcnt(14)
v_mfma_f32_16x16x32_bf16 a[0:3], v[144:147], v[80:83], 0
s_add_u32 m0, s23, 32768
v_mfma_f32_16x16x32_bf16 a[32:35], v[144:147], v[84:87], 0
ds_read_b128 v[112:115], v193 offset:0
v_mfma_f32_16x16x32_bf16 a[64:67], v[144:147], v[88:91], 0
buffer_load_dwordx4 v184, s[12:15], s21 offen offset:0 lds
v_mfma_f32_16x16x32_bf16 a[96:99], v[144:147], v[92:95], 0
v_mfma_f32_16x16x32_bf16 a[128:131], v[144:147], v[96:99], 0
v_mfma_f32_16x16x32_bf16 a[160:163], v[144:147], v[100:103], 0
buffer_load_dwordx4 v185, s[12:15], s21 offen offset:1024 lds
v_mfma_f32_16x16x32_bf16 a[192:195], v[144:147], v[104:107], 0
v_mfma_f32_16x16x32_bf16 a[224:227], v[144:147], v[108:111], 0
TR 144,196,16384
TR 146,196,18432
s_waitcnt lgkmcnt(15)
v_mfma_f32_16x16x32_bf16 a[4:7], v[148:151], v[80:83], 0
ds_read_b128 v[116:119], v193 offset:2048
buffer_load_dwordx4 v186, s[12:15], s21 offen offset:2048 lds
v_mfma_f32_16x16x32_bf16 a[36:39], v[148:151], v[84:87], 0
v_mfma_f32_16x16x32_bf16 a[68:71], v[148:151], v[88:91], 0
buffer_load_dwordx4 v187, s[12:15], s21 offen offset:3072 lds
v_mfma_f32_16x16x32_bf16 a[100:103], v[148:151], v[92:95], 0
v_mfma_f32_16x16x32_bf16 a[132:135], v[148:151], v[96:99], 0
s_add_u32 m0, s23, 36864
v_mfma_f32_16x16x32_bf16 a[164:167], v[148:151], v[100:103], 0
ds_read_b128 v[120:123], v193 offset:4096
v_mfma_f32_16x16x32_bf16 a[196:199], v[148:151], v[104:107], 0
v_mfma_f32_16x16x32_bf16 a[228:231], v[148:151], v[108:111], 0
TR 148,197,16384
TR 150,197,18432
s_waitcnt lgkmcnt(15)
v_mfma_f32_16x16x32_bf16 a[8:11], v[152:155], v[80:83], 0
buffer_load_dwordx4 v188, s[12:15], s21 offen offset:0 lds
v_mfma_f32_16x16x32_bf16 a[40:43], v[152:155], v[84:87], 0
v_mfma_f32_16x16x32_bf16 a[72:75], v[152:155], v[88:91], 0
buffer_load_dwordx4 v189, s[12:15], s21 offen offset:1024 lds
v_mfma_f32_16x16x32_bf16 a[104:107], v[152:155], v[92:95], 0
v_mfma_f32_16x16x32_bf16 a[136:139], v[152:155], v[96:99], 0
ds_read_b128 v[124:127], v193 offset:6144
buffer_load_dwordx4 v190, s[12:15], s21 offen offset:2048 lds
v_mfma_f32_16x16x32_bf16 a[168:171], v[152:155], v[100:103], 0
v_mfma_f32_16x16x32_bf16 a[200:203], v[152:155], v[104:107], 0
v_mfma_f32_16x16x32_bf16 a[232:235], v[152:155], v[108:111], 0
TR 152,198,16384
TR 154,198,18432
v_mfma_f32_16x16x32_bf16 a[12:15], v[156:159], v[80:83], 0
buffer_load_dwordx4 v191, s[12:15], s21 offen offset:3072 lds
v_mfma_f32_16x16x32_bf16 a[44:47], v[156:159], v[84:87], 0
s_add_u32 s21, s21, 524288
v_mfma_f32_16x16x32_bf16 a[76:79], v[156:159], v[88:91], 0
ds_read_b128 v[128:131], v193 offset:8192
v_mfma_f32_16x16x32_bf16 a[108:111], v[156:159], v[92:95], 0
v_mfma_f32_16x16x32_bf16 a[140:143], v[156:159], v[96:99], 0
s_and_b32 s21, s21, 4194303
v_mfma_f32_16x16x32_bf16 a[172:175], v[156:159], v[100:103], 0
v_mfma_f32_16x16x32_bf16 a[204:207], v[156:159], v[104:107], 0
v_mfma_f32_16x16x32_bf16 a[236:239], v[156:159], v[108:111], 0
TR 156,199,16384
TR 158,199,18432
s_waitcnt lgkmcnt(15)
v_mfma_f32_16x16x32_bf16 a[16:19], v[160:163], v[80:83], 0
ds_read_b128 v[132:135], v193 offset:10240
s_add_u32 m0, s22, 32768
v_mfma_f32_16x16x32_bf16 a[48:51], v[160:163], v[84:87], 0
buffer_load_dwordx4 v176, s[8:11], s20 offen offset:0 lds
v_mfma_f32_16x16x32_bf16 a[80:83], v[160:163], v[88:91], 0
v_mfma_f32_16x16x32_bf16 a[112:115], v[160:163], v[92:95], 0
v_mfma_f32_16x16x32_bf16 a[144:147], v[160:163], v[96:99], 0
buffer_load_dwordx4 v177, s[8:11], s20 offen offset:1024 lds
v_mfma_f32_16x16x32_bf16 a[176:179], v[160:163], v[100:103], 0
v_mfma_f32_16x16x32_bf16 a[208:211], v[160:163], v[104:107], 0
buffer_load_dwordx4 v178, s[8:11], s20 offen offset:2048 lds
v_mfma_f32_16x16x32_bf16 a[240:243], v[160:163], v[108:111], 0
TR 160,200,16384
TR 162,200,18432
v_mfma_f32_16x16x32_bf16 a[20:23], v[164:167], v[80:83], 0
ds_read_b128 v[136:139], v193 offset:12288
v_mfma_f32_16x16x32_bf16 a[52:55], v[164:167], v[84:87], 0
buffer_load_dwordx4 v179, s[8:11], s20 offen offset:3072 lds
v_mfma_f32_16x16x32_bf16 a[84:87], v[164:167], v[88:91], 0
v_mfma_f32_16x16x32_bf16 a[116:119], v[164:167], v[92:95], 0
s_add_u32 m0, s22, 36864
v_mfma_f32_16x16x32_bf16 a[148:151], v[164:167], v[96:99], 0
v_mfma_f32_16x16x32_bf16 a[180:183], v[164:167], v[100:103], 0
ds_read_b128 v[140:143], v193 offset:14336
v_mfma_f32_16x16x32_bf16 a[212:215], v[164:167], v[104:107], 0
buffer_load_dwordx4 v180, s[8:11], s20 offen offset:0 lds
v_mfma_f32_16x16x32_bf16 a[244:247], v[164:167], v[108:111], 0
TR 164,201,16384
TR 166,201,18432
v_mfma_f32_16x16x32_bf16 a[24:27], v[168:171], v[80:83], 0
v_mfma_f32_16x16x32_bf16 a[56:59], v[168:171], v[84:87], 0
buffer_load_dwordx4 v181, s[8:11], s20 offen offset:1024 lds
v_mfma_f32_16x16x32_bf16 a[88:91], v[168:171], v[88:91], 0
v_mfma_f32_16x16x32_bf16 a[120:123], v[168:171], v[92:95], 0
buffer_load_dwordx4 v182, s[8:11], s20 offen offset:2048 lds
v_mfma_f32_16x16x32_bf16 a[152:155], v[168:171], v[96:99], 0
v_mfma_f32_16x16x32_bf16 a[184:187], v[168:171], v[100:103], 0
v_mfma_f32_16x16x32_bf16 a[216:219], v[168:171], v[104:107], 0
buffer_load_dwordx4 v183, s[8:11], s20 offen offset:3072 lds
v_mfma_f32_16x16x32_bf16 a[248:251], v[168:171], v[108:111], 0
TR 168,202,16384
TR 170,202,18432
s_waitcnt lgkmcnt(15)
v_mfma_f32_16x16x32_bf16 a[28:31], v[172:175], v[80:83], 0
s_add_u32 s20, s20, 128
v_mfma_f32_16x16x32_bf16 a[60:63], v[172:175], v[84:87], 0
v_mfma_f32_16x16x32_bf16 a[92:95], v[172:175], v[88:91], 0
v_mfma_f32_16x16x32_bf16 a[124:127], v[172:175], v[92:95], 0
s_and_b32 s20, s20, 1023
v_mfma_f32_16x16x32_bf16 a[156:159], v[172:175], v[96:99], 0
v_mfma_f32_16x16x32_bf16 a[188:191], v[172:175], v[100:103], 0
v_mfma_f32_16x16x32_bf16 a[220:223], v[172:175], v[104:107], 0
v_mfma_f32_16x16x32_bf16 a[252:255], v[172:175], v[108:111], 0
TR 172,203,16384
TR 174,203,18432
s_waitcnt lgkmcnt(2)
MA 0,v,144,v,112
s_add_u32 m0, s22, 65536
MA 32,v,144,v,116
MA 64,v,144,v,120
MA 96,v,144,v,124
buffer_load_dwordx4 v176, s[8:11], s20 offen offset:0 lds
MA 128,v,144,v,128
MA 160,v,144,v,132
MA 192,v,144,v,136
MA 224,v,144,v,140
buffer_load_dwordx4 v177, s[8:11], s20 offen offset:1024 lds
MA 4,v,148,v,112
MA 36,v,148,v,116
MA 68,v,148,v,120
buffer_load_dwordx4 v178, s[8:11], s20 offen offset:2048 lds
MA 100,v,148,v,124
MA 132,v,148,v,128
MA 164,v,148,v,132
MA 196,v,148,v,136
buffer_load_dwordx4 v179, s[8:11], s20 offen offset:3072 lds
MA 228,v,148,v,140
MA 8,v,152,v,112
MA 40,v,152,v,116
s_add_u32 m0, s22, 69632
MA 72,v,152,v,120
MA 104,v,152,v,124
MA 136,v,152,v,128
MA 168,v,152,v,132
buffer_load_dwordx4 v180, s[8:11], s20 offen offset:0 lds
MA 200,v,152,v,136
MA 232,v,152,v,140
MA 12,v,156,v,112
MA 44,v,156,v,116
buffer_load_dwordx4 v181, s[8:11], s20 offen offset:1024 lds
MA 76,v,156,v,120
MA 108,v,156,v,124
MA 140,v,156,v,128
buffer_load_dwordx4 v182, s[8:11], s20 offen offset:2048 lds
MA 172,v,156,v,132
MA 204,v,156,v,136
MA 236,v,156,v,140
MA 16,v,160,v,112
buffer_load_dwordx4 v183, s[8:11], s20 offen offset:3072 lds
MA 48,v,160,v,116
MA 80,v,160,v,120
MA 112,v,160,v,124
s_add_u32 s20, s20, 128
MA 144,v,160,v,128
MA 176,v,160,v,132
MA 208,v,160,v,136
MA 240,v,160,v,140
s_and_b32 s20, s20, 1023
MA 20,v,164,v,112
MA 52,v,164,v,116
MA 84,v,164,v,120
MA 116,v,164,v,124
MA 148,v,164,v,128
s_waitcnt vmcnt(8) lgkmcnt(0)
s_barrier
MA 180,v,164,v,132
TR 144,196,32768
TR 146,196,34816
MA 212,v,164,v,136
ds_read_b128 v[80:83], v192 offset:32768
s_add_u32 m0, s23, 0
MA 244,v,164,v,140
TR 148,197,32768
TR 150,197,34816
MA 24,v,168,v,112
ds_read_b128 v[84:87], v192 offset:34816
ds_read_b128 v[88:91], v192 offset:36864
MA 56,v,168,v,116
TR 152,198,32768
TR 154,198,34816
MA 88,v,168,v,120
ds_read_b128 v[92:95], v192 offset:38912
ds_read_b128 v[96:99], v192 offset:40960
MA 120,v,168,v,124
TR 156,199,32768
TR 158,199,34816
MA 152,v,168,v,128
ds_read_b128 v[100:103], v192 offset:43008
ds_read_b128 v[104:107], v192 offset:45056
MA 184,v,168,v,132
TR 160,200,32768
TR 162,200,34816
MA 216,v,168,v,136
ds_read_b128 v[108:111], v192 offset:47104
buffer_load_dwordx4 v184, s[12:15], s21 offen offset:0 lds
MA 248,v,168,v,140
TR 164,201,32768
TR 166,201,34816
MA 28,v,172,v,112
buffer_load_dwordx4 v185, s[12:15], s21 offen offset:1024 lds
buffer_load_dwordx4 v186, s[12:15], s21 offen offset:2048 lds
MA 60,v,172,v,116
TR 168,202,32768
TR 170,202,34816
MA 92,v,172,v,120
buffer_load_dwordx4 v187, s[12:15], s21 offen offset:3072 lds
s_add_u32 m0, s23, 4096
MA 124,v,172,v,124
buffer_load_dwordx4 v188, s[12:15], s21 offen offset:0 lds
buffer_load_dwordx4 v189, s[12:15], s21 offen offset:1024 lds
MA 156,v,172,v,128
buffer_load_dwordx4 v190, s[12:15], s21 offen offset:2048 lds
buffer_load_dwordx4 v191, s[12:15], s21 offen offset:3072 lds
MA 188,v,172,v,132
s_add_u32 s21, s21, 524288
s_and_b32 s21, s21, 4194303
MA 220,v,172,v,136
s_load_dwordx2 s[84:85], s[0:1], 8
s_load_dwordx2 s[88:89], s[0:1], 16
MA 252,v,172,v,140
TR 172,203,32768
TR 174,203,34816
s_load_dwordx2 s[92:93], s[0:1], 0
s_load_dwordx2 s[96:97], s[0:1], 24
s_load_dwordx2 s[76:77], s[0:1], 96
s_waitcnt lgkmcnt(2)
MA 0,v,144,v,80
s_add_u32 m0, s22, 0
MA 32,v,144,v,84
ds_read_b128 v[112:115], v193 offset:32768
MA 64,v,144,v,88
s_mov_b32 s4, s34
s_mov_b32 s5, s35
MA 96,v,144,v,92
MA 128,v,144,v,96
MA 160,v,144,v,100
buffer_load_dwordx4 v176, s[8:11], s20 offen offset:0 lds
MA 192,v,144,v,104
MA 224,v,144,v,108
TR 144,196,49152
TR 146,196,51200
MA 4,v,148,v,80
ds_read_b128 v[116:119], v193 offset:34816
MA 36,v,148,v,84
s_mov_b32 s6, 8388608
s_mov_b32 s7, 0x20000
MA 68,v,148,v,88
buffer_load_dwordx4 v177, s[8:11], s20 offen offset:1024 lds
MA 100,v,148,v,92
MA 132,v,148,v,96
MA 164,v,148,v,100
ds_read_b128 v[120:123], v193 offset:36864
MA 196,v,148,v,104
MA 228,v,148,v,108
TR 148,197,49152
TR 150,197,51200
MA 8,v,152,v,80
buffer_load_dwordx4 v178, s[8:11], s20 offen offset:2048 lds
s_lshr_b32 s43, s2, 3
MA 40,v,152,v,84
MA 72,v,152,v,88
MA 104,v,152,v,92
s_lshl_b32 s43, s43, 2
MA 136,v,152,v,96
ds_read_b128 v[124:127], v193 offset:38912
buffer_load_dwordx4 v179, s[8:11], s20 offen offset:3072 lds
MA 168,v,152,v,100
MA 200,v,152,v,104
MA 232,v,152,v,108
TR 152,198,49152
TR 154,198,51200
MA 12,v,156,v,80
s_add_u32 s43, s43, s3
MA 44,v,156,v,84
s_add_u32 m0, s22, 4096
MA 76,v,156,v,88
ds_read_b128 v[128:131], v193 offset:40960
MA 108,v,156,v,92
s_lshl_b32 s43, s43, 16
MA 140,v,156,v,96
MA 172,v,156,v,100
MA 204,v,156,v,104
MA 236,v,156,v,108
TR 156,199,49152
TR 158,199,51200
MA 16,v,160,v,80
ds_read_b128 v[132:135], v193 offset:43008
buffer_load_dwordx4 v180, s[8:11], s20 offen offset:0 lds
MA 48,v,160,v,84
s_and_b32 s37, s2, 7
MA 80,v,160,v,88
s_lshl_b32 s37, s37, 10
MA 112,v,160,v,92
MA 144,v,160,v,96
buffer_load_dwordx4 v181, s[8:11], s20 offen offset:1024 lds
MA 176,v,160,v,100
MA 208,v,160,v,104
s_add_u32 s43, s43, s37
MA 240,v,160,v,108
TR 160,200,49152
TR 162,200,51200
MA 20,v,164,v,80
ds_read_b128 v[136:139], v193 offset:45056
MA 52,v,164,v,84
buffer_load_dwordx4 v182, s[8:11], s20 offen offset:2048 lds
MA 84,v,164,v,88
v_lshrrev_b32 v78, 3, v1
MA 116,v,164,v,92
MA 148,v,164,v,96
MA 180,v,164,v,100
ds_read_b128 v[140:143], v193 offset:47104
MA 212,v,164,v,104
buffer_load_dwordx4 v183, s[8:11], s20 offen offset:3072 lds
v_and_b32 v79, 7, v1
MA 244,v,164,v,108
TR 164,201,49152
TR 166,201,51200
MA 24,v,168,v,80
MA 56,v,168,v,84
MA 88,v,168,v,88
v_lshlrev_b32 v79, 7, v79
MA 120,v,168,v,92
s_add_u32 s20, s20, 128
MA 152,v,168,v,96
MA 184,v,168,v,100
MA 216,v,168,v,104
v_lshl_add_u32 v78, v78, 13, v79
MA 248,v,168,v,108
TR 168,202,49152
TR 170,202,51200
s_waitcnt lgkmcnt(15)
MA 28,v,172,v,80
s_and_b32 s20, s20, 1023
MA 60,v,172,v,84
MA 92,v,172,v,88
v_add_u32 v78, s43, v78
MA 124,v,172,v,92
MA 156,v,172,v,96
MA 188,v,172,v,100
MA 220,v,172,v,104
MA 252,v,172,v,108
TR 172,203,49152
TR 174,203,51200
s_waitcnt lgkmcnt(2)
MA 0,v,144,v,112
MA 32,v,144,v,116
MA 64,v,144,v,120
MA 96,v,144,v,124
MA 128,v,144,v,128
MA 160,v,144,v,132
MA 192,v,144,v,136
MA 224,v,144,v,140
MA 4,v,148,v,112
MA 36,v,148,v,116
s_waitcnt vmcnt(8) lgkmcnt(0)
s_barrier
MA 68,v,148,v,120
TR 144,196,0
TR 146,196,2048
MA 100,v,148,v,124
ds_read_b128 v[80:83], v194 offset:0
s_add_u32 m0, s23, 32768
MA 132,v,148,v,128
s_mov_b32 s86, 4194304
s_mov_b32 s87, 0x20000
MA 164,v,148,v,132
s_mov_b32 s90, 4194304
s_mov_b32 s91, 0x20000
MA 196,v,148,v,136
buffer_load_dwordx4 v184, s[12:15], s21 offen offset:0 lds
MA 228,v,148,v,140
TR 148,197,0
TR 150,197,2048
MA 8,v,152,v,112
ds_read_b128 v[84:87], v194 offset:2048
s_mov_b32 s94, 4194304
MA 40,v,152,v,116
s_mov_b32 s95, 0x20000
s_mov_b32 s98, 8192
MA 72,v,152,v,120
buffer_load_dwordx4 v185, s[12:15], s21 offen offset:1024 lds
s_mov_b32 s99, 0x20000
MA 104,v,152,v,124
MA 136,v,152,v,128
s_mov_b32 s78, 2048
MA 168,v,152,v,132
ds_read_b128 v[88:91], v194 offset:4096
s_mov_b32 s79, 0x20000
MA 200,v,152,v,136
s_and_b32 s36, s2, 15
MA 232,v,152,v,140
TR 152,198,0
TR 154,198,2048
MA 12,v,156,v,112
buffer_load_dwordx4 v186, s[12:15], s21 offen offset:2048 lds
s_lshl_b32 s36, s36, 1
MA 44,v,156,v,116
s_lshr_b32 s37, s3, 1
MA 76,v,156,v,120
ds_read_b128 v[92:95], v194 offset:6144
s_add_u32 s36, s36, s37
MA 108,v,156,v,124
buffer_load_dwordx4 v187, s[12:15], s21 offen offset:3072 lds
s_lshl_b32 s36, s36, 3
MA 140,v,156,v,128
MA 172,v,156,v,132
v_and_b32 v252, 7, v1
MA 204,v,156,v,136
v_add_u32 v252, s36, v252
MA 236,v,156,v,140
TR 156,199,0
TR 158,199,2048
MA 16,v,160,v,112
ds_read_b128 v[96:99], v194 offset:8192
s_add_u32 m0, s23, 36864
MA 48,v,160,v,116
s_lshr_b32 s36, s2, 4
s_lshl_b32 s36, s36, 1
MA 80,v,160,v,120
s_and_b32 s37, s3, 1
MA 112,v,160,v,124
s_add_u32 s36, s36, s37
MA 144,v,160,v,128
ds_read_b128 v[100:103], v194 offset:10240
buffer_load_dwordx4 v188, s[12:15], s21 offen offset:0 lds
MA 176,v,160,v,132
s_lshl_b32 s36, s36, 3
v_lshrrev_b32 v253, 3, v1
MA 208,v,160,v,136
MA 240,v,160,v,140
TR 160,200,0
TR 162,200,2048
MA 20,v,164,v,112
buffer_load_dwordx4 v189, s[12:15], s21 offen offset:1024 lds
v_add_u32 v253, s36, v253
MA 52,v,164,v,116
ds_read_b128 v[104:107], v194 offset:12288
v_lshlrev_b32 v254, 14, v253
MA 84,v,164,v,120
v_lshl_add_u32 v254, v252, 3, v254
v_add_u32 v229, -6144, v254
MA 116,v,164,v,124
MA 148,v,164,v,128
buffer_load_dwordx4 v190, s[12:15], s21 offen offset:2048 lds
v_lshlrev_b32 v62, 5, v252
MA 180,v,164,v,132
v_lshlrev_b32 v254, 4, v253
MA 212,v,164,v,136
ds_read_b128 v[108:111], v194 offset:14336
v_sub_u32 v254, 4080, v254
MA 244,v,164,v,140
TR 164,201,0
TR 166,201,2048
MA 24,v,168,v,112
v_lshl_add_u32 v10, v252, 14, v254
MA 56,v,168,v,116
buffer_load_dwordx4 v191, s[12:15], s21 offen offset:3072 lds
v_and_b32 v252, 31, v1
MA 88,v,168,v,120
v_lshlrev_b32 v64, 4, v252
MA 120,v,168,v,124
s_lshl_b32 s36, s2, 2
MA 152,v,168,v,128
MA 184,v,168,v,132
s_add_u32 s21, s21, 524288
s_add_u32 s36, s36, s3
MA 216,v,168,v,136
s_lshl_b32 s36, s36, 1
MA 248,v,168,v,140
TR 168,202,0
TR 170,202,2048
MA 28,v,172,v,112
v_lshrrev_b32 v253, 5, v1
v_add_u32 v253, s36, v253
MA 60,v,172,v,116
s_and_b32 s21, s21, 4194303
MA 92,v,172,v,120
v_lshl_add_u32 v63, v253, 11, v64
MA 124,v,172,v,124
v_lshlrev_b32 v253, 2, v253
MA 156,v,172,v,128
v_lshl_add_u32 v11, v252, 20, v253
MA 188,v,172,v,132
MA 220,v,172,v,136
MA 252,v,172,v,140
TR 172,203,0
TR 174,203,2048
s_waitcnt lgkmcnt(2)
MA 0,v,144,v,80
s_add_u32 m0, s22, 32768
buffer_load_dwordx4 v[230:233], v63, s[92:95], 0 offen offset:0
MA 32,v,144,v,84
ds_read_b128 v[112:115], v195 offset:0
MA 64,v,144,v,88
MA 96,v,144,v,92
MA 128,v,144,v,96
buffer_load_dwordx4 v[2:5], v64, s[76:79], 0 offen offset:0
MA 160,v,144,v,100
buffer_load_dwordx4 v176, s[8:11], s20 offen offset:0 lds
MA 192,v,144,v,104
MA 224,v,144,v,108
TR 144,196,16384
TR 146,196,18432
MA 4,v,148,v,80
ds_read_b128 v[116:119], v195 offset:2048
MA 36,v,148,v,84
buffer_load_dwordx4 v[234:237], v63, s[92:95], 0 offen offset:512
MA 68,v,148,v,88
buffer_load_dwordx4 v177, s[8:11], s20 offen offset:1024 lds
MA 100,v,148,v,92
MA 132,v,148,v,96
MA 164,v,148,v,100
ds_read_b128 v[120:123], v195 offset:4096
MA 196,v,148,v,104
buffer_load_dwordx4 v[6:9], v64, s[76:79], 0 offen offset:512
MA 228,v,148,v,108
TR 148,197,16384
TR 150,197,18432
MA 8,v,152,v,80
buffer_load_dwordx4 v178, s[8:11], s20 offen offset:2048 lds
MA 40,v,152,v,84
MA 72,v,152,v,88
MA 104,v,152,v,92
buffer_load_dwordx4 v[238:241], v63, s[92:95], 0 offen offset:1024
MA 136,v,152,v,96
ds_read_b128 v[124:127], v195 offset:6144
buffer_load_dwordx4 v179, s[8:11], s20 offen offset:3072 lds
MA 168,v,152,v,100
MA 200,v,152,v,104
MA 232,v,152,v,108
TR 152,198,16384
TR 154,198,18432
MA 12,v,156,v,80
buffer_load_dwordx4 v[12:15], v64, s[76:79], 0 offen offset:1024
MA 44,v,156,v,84
s_add_u32 m0, s22, 36864
MA 76,v,156,v,88
ds_read_b128 v[128:131], v195 offset:8192
MA 108,v,156,v,92
MA 140,v,156,v,96
buffer_load_dwordx4 v[242:245], v63, s[92:95], 0 offen offset:1536
MA 172,v,156,v,100
MA 204,v,156,v,104
MA 236,v,156,v,108
TR 156,199,16384
TR 158,199,18432
MA 16,v,160,v,80
ds_read_b128 v[132:135], v195 offset:10240
buffer_load_dwordx4 v180, s[8:11], s20 offen offset:0 lds
MA 48,v,160,v,84
buffer_load_dwordx4 v[246:249], v64, s[76:79], 0 offen offset:1536
MA 80,v,160,v,88
MA 112,v,160,v,92
MA 144,v,160,v,96
buffer_load_dwordx4 v181, s[8:11], s20 offen offset:1024 lds
MA 176,v,160,v,100
MA 208,v,160,v,104
buffer_load_dwordx4 v[54:57], v62, s[96:99], 0 offen offset:0
MA 240,v,160,v,108
TR 160,200,16384
TR 162,200,18432
MA 20,v,164,v,80
ds_read_b128 v[136:139], v195 offset:12288
MA 52,v,164,v,84
buffer_load_dwordx4 v182, s[8:11], s20 offen offset:2048 lds
MA 84,v,164,v,88
buffer_load_dwordx4 v[58:61], v62, s[96:99], 0 offen offset:16
MA 116,v,164,v,92
MA 148,v,164,v,96
MA 180,v,164,v,100
ds_read_b128 v[140:143], v195 offset:14336
MA 212,v,164,v,104
buffer_load_dwordx4 v183, s[8:11], s20 offen offset:3072 lds
MA 244,v,164,v,108
TR 164,201,16384
TR 166,201,18432
MA 24,v,168,v,80
v_add_u32 v252, 0, v229
MA 56,v,168,v,84
MA 88,v,168,v,88
MA 120,v,168,v,92
s_add_u32 s20, s20, 128
MA 152,v,168,v,96
buffer_load_dwordx2 v[16:17], v252, s[84:87], 0 offen
MA 184,v,168,v,100
MA 216,v,168,v,104
MA 248,v,168,v,108
TR 168,202,16384
TR 170,202,18432
s_waitcnt lgkmcnt(15)
MA 28,v,172,v,80
s_and_b32 s20, s20, 1023
MA 60,v,172,v,84
v_add_u32 v253, 2048, v229
MA 92,v,172,v,88
MA 124,v,172,v,92
MA 156,v,172,v,96
MA 188,v,172,v,100
MA 220,v,172,v,104
MA 252,v,172,v,108
TR 172,203,16384
TR 174,203,18432
s_waitcnt lgkmcnt(2)
MA 0,v,144,v,112
MA 32,v,144,v,116
MA 64,v,144,v,120
MA 96,v,144,v,124
MA 128,v,144,v,128
MA 160,v,144,v,132
MA 192,v,144,v,136
MA 224,v,144,v,140
MA 4,v,148,v,112
MA 36,v,148,v,116
s_waitcnt vmcnt(19) lgkmcnt(0)
s_barrier
MA 68,v,148,v,120
TR 144,196,32768
TR 146,196,34816
MA 100,v,148,v,124
ds_read_b128 v[80:83], v192 offset:0
s_add_u32 m0, s23, 0
MA 132,v,148,v,128
s_bfe_u32 s80, s2, 0x20001
s_bfe_u32 s69, s2, 0x30003
MA 164,v,148,v,132
s_lshl_b32 s80, s80, 3
s_add_u32 s69, s69, s80
MA 196,v,148,v,136
buffer_load_dwordx4 v184, s[12:15], s21 offen offset:0 lds
s_lshr_b32 s80, s2, 6
MA 228,v,148,v,140
TR 148,197,32768
TR 150,197,34816
MA 8,v,152,v,112
ds_read_b128 v[84:87], v192 offset:2048
s_xor_b32 s81, s80, s2
MA 40,v,152,v,116
s_and_b32 s81, s81, 1
s_lshl_b32 s70, s80, 1
MA 72,v,152,v,120
buffer_load_dwordx4 v185, s[12:15], s21 offen offset:1024 lds
s_add_u32 s70, s70, s81
MA 104,v,152,v,124
s_lshl_b32 s80, s3, 1
s_sub_u32 s80, 7, s80
MA 136,v,152,v,128
s_lshl_b32 s76, s80, 17
s_lshl_b32 s80, s3, 15
MA 168,v,152,v,132
ds_read_b128 v[88:91], v192 offset:4096
s_lshl_b32 s65, s70, 18
MA 200,v,152,v,136
s_sub_u32 s64, 3932160, s65
MA 232,v,152,v,140
TR 152,198,32768
TR 154,198,34816
MA 12,v,156,v,112
buffer_load_dwordx4 v186, s[12:15], s21 offen offset:2048 lds
s_add_u32 s65, s65, s80
MA 44,v,156,v,116
s_add_u32 s64, s64, s80
s_lshl_b32 s81, s69, 12
MA 76,v,156,v,120
ds_read_b128 v[92:95], v192 offset:6144
s_lshl_b32 s100, s64, 2
MA 108,v,156,v,124
buffer_load_dwordx4 v187, s[12:15], s21 offen offset:3072 lds
s_add_u32 s100, s100, s81
MA 140,v,156,v,128
s_lshl_b32 s101, s65, 2
MA 172,v,156,v,132
s_add_u32 s101, s101, s81
MA 204,v,156,v,136
s_lshl_b32 s66, s3, 17
s_lshl_b32 s81, s69, 8
MA 236,v,156,v,140
TR 156,199,32768
TR 158,199,34816
MA 16,v,160,v,112
ds_read_b128 v[96:99], v192 offset:8192
s_add_u32 m0, s23, 4096
MA 48,v,160,v,116
s_add_u32 s66, s66, s81
s_and_b32 s74, s2, 7
MA 80,v,160,v,120
s_lshl_b32 s74, s74, 8
s_mov_b32 s82, s66
MA 112,v,160,v,124
s_lshl_b32 s66, s74, 12
MA 144,v,160,v,128
ds_read_b128 v[100:103], v192 offset:10240
buffer_load_dwordx4 v188, s[12:15], s21 offen offset:0 lds
MA 176,v,160,v,132
s_lshl_b32 s67, s3, 13
s_lshl_b32 s68, s3, 12
MA 208,v,160,v,136
s_lshl_b32 s77, s70, 1
MA 240,v,160,v,140
TR 160,200,32768
TR 162,200,34816
MA 20,v,164,v,112
buffer_load_dwordx4 v189, s[12:15], s21 offen offset:1024 lds
s_sub_u32 s77, 32, s77
MA 52,v,164,v,116
ds_read_b128 v[104:107], v192 offset:12288
v_lshrrev_b32 v66, 3, v1
MA 84,v,164,v,120
v_lshlrev_b32 v66, 11, v66
v_lshrrev_b32 v67, 4, v1
MA 116,v,164,v,124
v_and_b32 v68, 7, v1
v_xor_b32 v68, v68, v67
MA 148,v,164,v,128
buffer_load_dwordx4 v190, s[12:15], s21 offen offset:2048 lds
v_lshl_add_u32 v66, v68, 4, v66
MA 180,v,164,v,132
v_xor_b32 v69, 64, v66
MA 212,v,164,v,136
ds_read_b128 v[108:111], v192 offset:14336
s_lshr_b32 s83, s76, 2
MA 244,v,164,v,140
TR 164,201,32768
TR 166,201,34816
MA 24,v,168,v,112
v_add_u32 v208, 0, v66
v_add_u32 v209, 15360, v69
MA 56,v,168,v,116
buffer_load_dwordx4 v191, s[12:15], s21 offen offset:3072 lds
v_add_u32 v210, -2048, v66
MA 88,v,168,v,120
v_add_u32 v210, s83, v210
MA 120,v,168,v,124
v_add_u32 v211, 13312, v69
v_add_u32 v211, s83, v211
MA 152,v,168,v,128
v_and_b32 v68, 15, v1
MA 184,v,168,v,132
s_add_u32 s21, s21, 524288
v_lshlrev_b32 v69, 1, v67
MA 216,v,168,v,136
v_xor_b32 v68, v68, v69
MA 248,v,168,v,140
TR 168,202,32768
TR 170,202,34816
MA 28,v,172,v,112
v_lshlrev_b32 v66, 13, v67
v_xor_b32 v69, 0, v68
MA 60,v,172,v,116
s_and_b32 s21, s21, 4194303
v_lshl_add_u32 v69, v69, 4, v66
MA 92,v,172,v,120
v_add_u32 v212, 0, v69
MA 124,v,172,v,124
v_xor_b32 v69, 0, v68
MA 156,v,172,v,128
v_lshl_add_u32 v69, v69, 4, v66
MA 188,v,172,v,132
v_add_u32 v213, 31744, v69
MA 220,v,172,v,136
MA 252,v,172,v,140
TR 172,203,32768
TR 174,203,34816
s_waitcnt lgkmcnt(2)
MA 0,v,144,v,80
s_add_u32 m0, s22, 65536
buffer_load_dwordx2 v[18:19], v253, s[84:87], 0 offen
MA 32,v,144,v,84
ds_read_b128 v[112:115], v193 offset:0
MA 64,v,144,v,88
MA 96,v,144,v,92
MA 128,v,144,v,96
v_add_u32 v254, 4096, v229
MA 160,v,144,v,100
buffer_load_dwordx4 v176, s[8:11], s20 offen offset:0 lds
MA 192,v,144,v,104
MA 224,v,144,v,108
TR 144,196,49152
TR 146,196,51200
MA 4,v,148,v,80
ds_read_b128 v[116:119], v193 offset:2048
MA 36,v,148,v,84
buffer_load_dwordx2 v[20:21], v254, s[84:87], 0 offen
MA 68,v,148,v,88
buffer_load_dwordx4 v177, s[8:11], s20 offen offset:1024 lds
MA 100,v,148,v,92
MA 132,v,148,v,96
MA 164,v,148,v,100
ds_read_b128 v[120:123], v193 offset:4096
MA 196,v,148,v,104
v_add_u32 v255, 6144, v229
MA 228,v,148,v,108
TR 148,197,49152
TR 150,197,51200
MA 8,v,152,v,80
buffer_load_dwordx4 v178, s[8:11], s20 offen offset:2048 lds
MA 40,v,152,v,84
MA 72,v,152,v,88
MA 104,v,152,v,92
buffer_load_dwordx2 v[22:23], v255, s[84:87], 0 offen
MA 136,v,152,v,96
ds_read_b128 v[124:127], v193 offset:6144
buffer_load_dwordx4 v179, s[8:11], s20 offen offset:3072 lds
MA 168,v,152,v,100
MA 200,v,152,v,104
MA 232,v,152,v,108
TR 152,198,49152
TR 154,198,51200
MA 12,v,156,v,80
buffer_load_dwordx2 v[38:39], v255, s[88:91], 0 offen
MA 44,v,156,v,84
s_add_u32 m0, s22, 69632
MA 76,v,156,v,88
ds_read_b128 v[128:131], v193 offset:8192
MA 108,v,156,v,92
MA 140,v,156,v,96
v_add_u32 v252, 8192, v229
MA 172,v,156,v,100
MA 204,v,156,v,104
MA 236,v,156,v,108
TR 156,199,49152
TR 158,199,51200
MA 16,v,160,v,80
ds_read_b128 v[132:135], v193 offset:10240
buffer_load_dwordx4 v180, s[8:11], s20 offen offset:0 lds
MA 48,v,160,v,84
buffer_load_dwordx2 v[24:25], v252, s[84:87], 0 offen
MA 80,v,160,v,88
MA 112,v,160,v,92
MA 144,v,160,v,96
buffer_load_dwordx4 v181, s[8:11], s20 offen offset:1024 lds
MA 176,v,160,v,100
MA 208,v,160,v,104
buffer_load_dwordx2 v[40:41], v252, s[88:91], 0 offen
MA 240,v,160,v,108
TR 160,200,49152
TR 162,200,51200
MA 20,v,164,v,80
ds_read_b128 v[136:139], v193 offset:12288
MA 52,v,164,v,84
buffer_load_dwordx4 v182, s[8:11], s20 offen offset:2048 lds
MA 84,v,164,v,88
v_add_u32 v253, 10240, v229
MA 116,v,164,v,92
MA 148,v,164,v,96
MA 180,v,164,v,100
ds_read_b128 v[140:143], v193 offset:14336
MA 212,v,164,v,104
buffer_load_dwordx4 v183, s[8:11], s20 offen offset:3072 lds
MA 244,v,164,v,108
TR 164,201,49152
TR 166,201,51200
MA 24,v,168,v,80
buffer_load_dwordx2 v[26:27], v253, s[84:87], 0 offen
MA 56,v,168,v,84
MA 88,v,168,v,88
MA 120,v,168,v,92
s_add_u32 s20, s20, 128
MA 152,v,168,v,96
buffer_load_dwordx2 v[42:43], v253, s[88:91], 0 offen
MA 184,v,168,v,100
MA 216,v,168,v,104
MA 248,v,168,v,108
TR 168,202,49152
TR 170,202,51200
s_waitcnt lgkmcnt(15)
MA 28,v,172,v,80
s_and_b32 s20, s20, 1023
MA 60,v,172,v,84
v_add_u32 v254, 12288, v229
MA 92,v,172,v,88
MA 124,v,172,v,92
MA 156,v,172,v,96
MA 188,v,172,v,100
MA 220,v,172,v,104
MA 252,v,172,v,108
TR 172,203,49152
TR 174,203,51200
s_waitcnt lgkmcnt(2)
MA 0,v,144,v,112
MA 32,v,144,v,116
MA 64,v,144,v,120
MA 96,v,144,v,124
MA 128,v,144,v,128
MA 160,v,144,v,132
MA 192,v,144,v,136
MA 224,v,144,v,140
MA 4,v,148,v,112
MA 36,v,148,v,116
s_waitcnt vmcnt(16) lgkmcnt(0)
s_barrier
MA 68,v,148,v,120
TR 144,196,0
TR 146,196,2048
MA 100,v,148,v,124
ds_read_b128 v[80:83], v192 offset:32768
s_add_u32 m0, s23, 32768
MA 132,v,148,v,128
v_xor_b32 v69, 8, v68
v_lshl_add_u32 v69, v69, 4, v66
MA 164,v,148,v,132
v_add_u32 v214, 63488, v69
v_xor_b32 v69, 8, v68
MA 196,v,148,v,136
buffer_load_dwordx4 v184, s[12:15], s21 offen offset:0 lds
v_lshl_add_u32 v69, v69, 4, v66
MA 228,v,148,v,140
TR 148,197,0
TR 150,197,2048
MA 8,v,152,v,112
ds_read_b128 v[84:87], v192 offset:34816
v_add_u32 v215, 95232, v69
MA 40,v,152,v,116
v_and_b32 v66, 15, v1
v_lshrrev_b32 v68, 1, v66
MA 72,v,152,v,120
buffer_load_dwordx4 v185, s[12:15], s21 offen offset:1024 lds
v_xor_b32 v68, v68, v67
MA 104,v,152,v,124
v_lshlrev_b32 v68, 4, v68
v_lshl_add_u32 v68, v66, 7, v68
MA 136,v,152,v,128
v_add_u32 v224, s67, v68
v_xor_b32 v225, 64, v224
MA 168,v,152,v,132
ds_read_b128 v[88:91], v192 offset:36864
v_add_u32 v226, 0x10000, v224
MA 200,v,152,v,136
v_add_u32 v227, 0x10000, v225
v_bfe_u32 v66, v1, 2, 2
MA 232,v,152,v,140
TR 152,198,0
TR 154,198,2048
MA 12,v,156,v,112
buffer_load_dwordx4 v186, s[12:15], s21 offen offset:2048 lds
v_and_b32 v68, 1, v67
MA 44,v,156,v,116
v_lshl_or_b32 v68, v68, 2, v66
v_lshl_add_u32 v66, v67, 3, v66
MA 76,v,156,v,120
ds_read_b128 v[92:95], v192 offset:38912
v_lshlrev_b32 v66, 8, v66
MA 108,v,156,v,124
buffer_load_dwordx4 v187, s[12:15], s21 offen offset:3072 lds
v_and_b32 v69, 3, v1
MA 140,v,156,v,128
v_lshl_add_u32 v66, v69, 3, v66
v_add_u32 v66, 98304, v66
MA 172,v,156,v,132
v_xor_b32 v69, 0, v68
MA 204,v,156,v,136
v_lshl_add_u32 v216, v69, 5, v66
v_xor_b32 v69, 1, v68
MA 236,v,156,v,140
TR 156,199,0
TR 158,199,2048
MA 16,v,160,v,112
ds_read_b128 v[96:99], v192 offset:40960
s_add_u32 m0, s23, 36864
MA 48,v,160,v,116
v_lshl_add_u32 v217, v69, 5, v66
v_xor_b32 v69, 2, v68
MA 80,v,160,v,120
v_lshl_add_u32 v218, v69, 5, v66
v_xor_b32 v69, 3, v68
MA 112,v,160,v,124
v_lshl_add_u32 v219, v69, 5, v66
MA 144,v,160,v,128
ds_read_b128 v[100:103], v192 offset:43008
buffer_load_dwordx4 v188, s[12:15], s21 offen offset:0 lds
MA 176,v,160,v,132
v_xor_b32 v69, 4, v68
v_lshl_add_u32 v220, v69, 5, v66
MA 208,v,160,v,136
v_xor_b32 v69, 5, v68
v_lshl_add_u32 v221, v69, 5, v66
MA 240,v,160,v,140
TR 160,200,0
TR 162,200,2048
MA 20,v,164,v,112
buffer_load_dwordx4 v189, s[12:15], s21 offen offset:1024 lds
v_xor_b32 v69, 6, v68
MA 52,v,164,v,116
ds_read_b128 v[104:107], v192 offset:45056
v_lshl_add_u32 v222, v69, 5, v66
MA 84,v,164,v,120
v_xor_b32 v69, 7, v68
v_lshl_add_u32 v223, v69, 5, v66
MA 116,v,164,v,124
s_mov_b32 s44, s32
s_mov_b32 s45, s33
MA 148,v,164,v,128
buffer_load_dwordx4 v190, s[12:15], s21 offen offset:2048 lds
s_mov_b32 s46, 4194304
MA 180,v,164,v,132
s_mov_b32 s47, 0x20000
MA 212,v,164,v,136
ds_read_b128 v[108:111], v192 offset:47104
MA 244,v,164,v,140
TR 164,201,0
TR 166,201,2048
MA 24,v,168,v,112
s_add_u32 s48, s34, s82
s_addc_u32 s49, s35, 0
MA 56,v,168,v,116
buffer_load_dwordx4 v191, s[12:15], s21 offen offset:3072 lds
s_sub_u32 s50, 8388608, s82
MA 88,v,168,v,120
s_mov_b32 s51, 0x20000
MA 120,v,168,v,124
s_add_u32 s60, s40, 33554432
s_addc_u32 s61, s41, 0
MA 152,v,168,v,128
s_mov_b32 s62, 16777216
s_mov_b32 s63, 0x20000
MA 184,v,168,v,132
s_add_u32 s21, s21, 524288
s_lshl_b32 s80, s69, 19
MA 216,v,168,v,136
s_add_u32 s52, s40, s80
s_addc_u32 s53, s41, 0
MA 248,v,168,v,140
TR 168,202,0
TR 170,202,2048
MA 28,v,172,v,112
s_lshl_b32 s54, s77, 14
s_mov_b32 s55, 0x20000
MA 60,v,172,v,116
s_and_b32 s21, s21, 4194303
s_add_u32 s80, s80, 16760832
MA 92,v,172,v,120
s_add_u32 s56, s40, s80
s_addc_u32 s57, s41, 0
MA 124,v,172,v,124
s_add_u32 s58, s54, 16384
MA 156,v,172,v,128
s_mov_b32 s59, 0x20000
MA 188,v,172,v,132
s_load_dwordx2 s[38:39], s[0:1], 112
MA 220,v,172,v,136
MA 252,v,172,v,140
TR 172,203,0
TR 174,203,2048
s_waitcnt lgkmcnt(2)
MA 0,v,144,v,80
s_add_u32 m0, s22, 0
buffer_load_dwordx2 v[28:29], v254, s[84:87], 0 offen
MA 32,v,144,v,84
ds_read_b128 v[112:115], v193 offset:32768
MA 64,v,144,v,88
MA 96,v,144,v,92
MA 128,v,144,v,96
buffer_load_dwordx2 v[44:45], v254, s[88:91], 0 offen
MA 160,v,144,v,100
buffer_load_dwordx4 v176, s[8:11], s20 offen offset:0 lds
MA 192,v,144,v,104
MA 224,v,144,v,108
TR 144,196,16384
TR 146,196,18432
MA 4,v,148,v,80
ds_read_b128 v[116:119], v193 offset:34816
v_add_u32 v255, 14336, v229
MA 36,v,148,v,84
MA 68,v,148,v,88
buffer_load_dwordx4 v177, s[8:11], s20 offen offset:1024 lds
MA 100,v,148,v,92
MA 132,v,148,v,96
MA 164,v,148,v,100
ds_read_b128 v[120:123], v193 offset:36864
buffer_load_dwordx2 v[30:31], v255, s[84:87], 0 offen
MA 196,v,148,v,104
MA 228,v,148,v,108
TR 148,197,16384
TR 150,197,18432
MA 8,v,152,v,80
buffer_load_dwordx4 v178, s[8:11], s20 offen offset:2048 lds
MA 40,v,152,v,84
buffer_load_dwordx2 v[46:47], v255, s[88:91], 0 offen
MA 72,v,152,v,88
MA 104,v,152,v,92
MA 136,v,152,v,96
ds_read_b128 v[124:127], v193 offset:38912
buffer_load_dwordx4 v179, s[8:11], s20 offen offset:3072 lds
MA 168,v,152,v,100
MA 200,v,152,v,104
v_add_u32 v252, 16384, v229
MA 232,v,152,v,108
TR 152,198,16384
TR 154,198,18432
MA 12,v,156,v,80
MA 44,v,156,v,84
s_add_u32 m0, s22, 4096
MA 76,v,156,v,88
ds_read_b128 v[128:131], v193 offset:40960
buffer_load_dwordx2 v[32:33], v252, s[84:87], 0 offen
MA 108,v,156,v,92
MA 140,v,156,v,96
MA 172,v,156,v,100
MA 204,v,156,v,104
MA 236,v,156,v,108
TR 156,199,16384
TR 158,199,18432
MA 16,v,160,v,80
ds_read_b128 v[132:135], v193 offset:43008
buffer_load_dwordx4 v180, s[8:11], s20 offen offset:0 lds
MA 48,v,160,v,84
buffer_load_dwordx2 v[48:49], v252, s[88:91], 0 offen
MA 80,v,160,v,88
MA 112,v,160,v,92
v_add_u32 v253, 18432, v229
MA 144,v,160,v,96
buffer_load_dwordx4 v181, s[8:11], s20 offen offset:1024 lds
MA 176,v,160,v,100
MA 208,v,160,v,104
MA 240,v,160,v,108
TR 160,200,16384
TR 162,200,18432
MA 20,v,164,v,80
ds_read_b128 v[136:139], v193 offset:45056
buffer_load_dwordx2 v[34:35], v253, s[84:87], 0 offen
MA 52,v,164,v,84
buffer_load_dwordx4 v182, s[8:11], s20 offen offset:2048 lds
MA 84,v,164,v,88
MA 116,v,164,v,92
MA 148,v,164,v,96
buffer_load_dwordx2 v[50:51], v253, s[88:91], 0 offen
MA 180,v,164,v,100
ds_read_b128 v[140:143], v193 offset:47104
MA 212,v,164,v,104
buffer_load_dwordx4 v183, s[8:11], s20 offen offset:3072 lds
MA 244,v,164,v,108
TR 164,201,16384
TR 166,201,18432
MA 24,v,168,v,80
v_add_u32 v254, 20480, v229
MA 56,v,168,v,84
MA 88,v,168,v,88
MA 120,v,168,v,92
s_add_u32 s20, s20, 128
MA 152,v,168,v,96
MA 184,v,168,v,100
buffer_load_dwordx2 v[36:37], v254, s[84:87], 0 offen
MA 216,v,168,v,104
MA 248,v,168,v,108
TR 168,202,16384
TR 170,202,18432
s_waitcnt lgkmcnt(15)
MA 28,v,172,v,80
s_and_b32 s20, s20, 1023
MA 60,v,172,v,84
buffer_load_dwordx2 v[52:53], v254, s[88:91], 0 offen
MA 92,v,172,v,88
MA 124,v,172,v,92
MA 156,v,172,v,96
MA 188,v,172,v,100
MA 220,v,172,v,104
MA 252,v,172,v,108
TR 172,203,16384
TR 174,203,18432
s_waitcnt lgkmcnt(2)
MA 0,v,144,v,112
MA 32,v,144,v,116
MA 64,v,144,v,120
MA 96,v,144,v,124
MA 128,v,144,v,128
MA 160,v,144,v,132
MA 192,v,144,v,136
MA 224,v,144,v,140
MA 4,v,148,v,112
MA 36,v,148,v,116
s_waitcnt vmcnt(18) lgkmcnt(0)
s_barrier
MA 68,v,148,v,120
TR 144,196,32768
TR 146,196,34816
MA 100,v,148,v,124
ds_read_b128 v[80:83], v194 offset:0
s_add_u32 m0, s23, 0
MA 132,v,148,v,128
s_and_b32 s37, s3, 3
MA 164,v,148,v,132
s_cmp_eq_u32 s37, 0
s_cselect_b32 s37, 0, 0x40000000
MA 196,v,148,v,136
buffer_load_dwordx4 v184, s[12:15], s21 offen offset:0 lds
MA 228,v,148,v,140
TR 148,197,32768
TR 150,197,34816
MA 8,v,152,v,112
ds_read_b128 v[84:87], v194 offset:2048
v_add_u32 v229, s37, v78
MA 40,v,152,v,116
MA 72,v,152,v,120
buffer_load_dwordx4 v185, s[12:15], s21 offen offset:1024 lds
MA 104,v,152,v,124
buffer_load_dword v79, v229, s[4:7], 0 offen
MA 136,v,152,v,128
MA 168,v,152,v,132
ds_read_b128 v[88:91], v194 offset:4096
s_getpc_b64 s[82:83]
L_ct_fK:
MA 200,v,152,v,136
MA 232,v,152,v,140
TR 152,198,32768
TR 154,198,34816
MA 12,v,156,v,112
buffer_load_dwordx4 v186, s[12:15], s21 offen offset:2048 lds
MA 44,v,156,v,116
s_add_u32 s82, s82, L_p2 - L_ct_fK
s_addc_u32 s83, s83, 0
MA 76,v,156,v,120
ds_read_b128 v[92:95], v194 offset:6144
MA 108,v,156,v,124
buffer_load_dwordx4 v187, s[12:15], s21 offen offset:3072 lds
MA 140,v,156,v,128
v_mov_b32 v67, s83
MA 172,v,156,v,132
MA 204,v,156,v,136
v_mov_b32 v66, s82
MA 236,v,156,v,140
TR 156,199,32768
TR 158,199,34816
MA 16,v,160,v,112
ds_read_b128 v[96:99], v194 offset:8192
s_add_u32 m0, s23, 4096
MA 48,v,160,v,116
s_lshr_b32 s82, s2, 3
MA 80,v,160,v,120
s_lshl_b32 s82, s82, 2
MA 112,v,160,v,124
MA 144,v,160,v,128
ds_read_b128 v[100:103], v194 offset:10240
buffer_load_dwordx4 v188, s[12:15], s21 offen offset:0 lds
MA 176,v,160,v,132
s_add_u32 s82, s82, s3
MA 208,v,160,v,136
MA 240,v,160,v,140
TR 160,200,32768
TR 162,200,34816
MA 20,v,164,v,112
buffer_load_dwordx4 v189, s[12:15], s21 offen offset:1024 lds
s_lshl_b32 s82, s82, 7
MA 52,v,164,v,116
ds_read_b128 v[104:107], v194 offset:12288
v_and_b32 v68, 3, v1
MA 84,v,164,v,120
MA 116,v,164,v,124
v_lshlrev_b32 v68, 14, v68
MA 148,v,164,v,128
buffer_load_dwordx4 v190, s[12:15], s21 offen offset:2048 lds
MA 180,v,164,v,132
MA 212,v,164,v,136
ds_read_b128 v[108:111], v194 offset:14336
v_add_u32 v68, s82, v68
MA 244,v,164,v,140
TR 164,201,32768
TR 166,201,34816
MA 24,v,168,v,112
v_min_u32 v68, L_p3_begin - L_p2 - 4, v68
MA 56,v,168,v,116
buffer_load_dwordx4 v191, s[12:15], s21 offen offset:3072 lds
MA 88,v,168,v,120
v_add_co_u32 v66, vcc, v66, v68
s_nop 1
v_addc_co_u32 v67, vcc, 0, v67, vcc
MA 120,v,168,v,124
MA 152,v,168,v,128
MA 184,v,168,v,132
s_add_u32 s21, s21, 524288
MA 216,v,168,v,136
MA 248,v,168,v,140
TR 168,202,32768
TR 170,202,34816
MA 28,v,172,v,112
MA 60,v,172,v,116
s_and_b32 s21, s21, 4194303
MA 92,v,172,v,120
MA 124,v,172,v,124
global_load_dword v68, v[66:67], off
MA 156,v,172,v,128
MA 188,v,172,v,132
MA 220,v,172,v,136
MA 252,v,172,v,140
TR 172,203,32768
TR 174,203,34816
s_waitcnt lgkmcnt(2)
MA 0,v,144,v,80
s_add_u32 m0, s22, 32768
s_and_b32 s37, s3, 3
MA 32,v,144,v,84
ds_read_b128 v[112:115], v195 offset:0
MA 64,v,144,v,88
MA 96,v,144,v,92
MA 128,v,144,v,96
MA 160,v,144,v,100
buffer_load_dwordx4 v176, s[8:11], s20 offen offset:0 lds
MA 192,v,144,v,104
MA 224,v,144,v,108
TR 144,196,49152
TR 146,196,51200
MA 4,v,148,v,80
ds_read_b128 v[116:119], v195 offset:2048
MA 36,v,148,v,84
MA 68,v,148,v,88
buffer_load_dwordx4 v177, s[8:11], s20 offen offset:1024 lds
MA 100,v,148,v,92
MA 132,v,148,v,96
s_cmp_eq_u32 s37, 1
s_cselect_b32 s37, 0, 0x40000000
MA 164,v,148,v,100
ds_read_b128 v[120:123], v195 offset:4096
MA 196,v,148,v,104
MA 228,v,148,v,108
TR 148,197,49152
TR 150,197,51200
MA 8,v,152,v,80
buffer_load_dwordx4 v178, s[8:11], s20 offen offset:2048 lds
MA 40,v,152,v,84
MA 72,v,152,v,88
MA 104,v,152,v,92
MA 136,v,152,v,96
ds_read_b128 v[124:127], v195 offset:6144
buffer_load_dwordx4 v179, s[8:11], s20 offen offset:3072 lds
MA 168,v,152,v,100
MA 200,v,152,v,104
MA 232,v,152,v,108
TR 152,198,49152
TR 154,198,51200
MA 12,v,156,v,80
MA 44,v,156,v,84
s_add_u32 m0, s22, 36864
MA 76,v,156,v,88
ds_read_b128 v[128:131], v195 offset:8192
MA 108,v,156,v,92
MA 140,v,156,v,96
MA 172,v,156,v,100
MA 204,v,156,v,104
MA 236,v,156,v,108
TR 156,199,49152
TR 158,199,51200
MA 16,v,160,v,80
ds_read_b128 v[132:135], v195 offset:10240
buffer_load_dwordx4 v180, s[8:11], s20 offen offset:0 lds
MA 48,v,160,v,84
MA 80,v,160,v,88
MA 112,v,160,v,92
MA 144,v,160,v,96
buffer_load_dwordx4 v181, s[8:11], s20 offen offset:1024 lds
MA 176,v,160,v,100
v_add_u32 v229, s37, v78
MA 208,v,160,v,104
MA 240,v,160,v,108
TR 160,200,49152
TR 162,200,51200
MA 20,v,164,v,80
ds_read_b128 v[136:139], v195 offset:12288
MA 52,v,164,v,84
buffer_load_dwordx4 v182, s[8:11], s20 offen offset:2048 lds
MA 84,v,164,v,88
MA 116,v,164,v,92
MA 148,v,164,v,96
MA 180,v,164,v,100
ds_read_b128 v[140:143], v195 offset:14336
MA 212,v,164,v,104
buffer_load_dwordx4 v183, s[8:11], s20 offen offset:3072 lds
MA 244,v,164,v,108
TR 164,201,49152
TR 166,201,51200
MA 24,v,168,v,80
MA 56,v,168,v,84
buffer_load_dword v79, v229, s[4:7], 0 offen
MA 88,v,168,v,88
MA 120,v,168,v,92
s_add_u32 s20, s20, 128
MA 152,v,168,v,96
MA 184,v,168,v,100
MA 216,v,168,v,104
MA 248,v,168,v,108
TR 168,202,49152
TR 170,202,51200
s_waitcnt lgkmcnt(15)
MA 28,v,172,v,80
s_and_b32 s20, s20, 1023
MA 60,v,172,v,84
MA 92,v,172,v,88
MA 124,v,172,v,92
MA 156,v,172,v,96
MA 188,v,172,v,100
MA 220,v,172,v,104
MA 252,v,172,v,108
TR 172,203,49152
TR 174,203,51200
s_waitcnt lgkmcnt(2)
MA 0,v,144,v,112
MA 32,v,144,v,116
MA 64,v,144,v,120
MA 96,v,144,v,124
MA 128,v,144,v,128
MA 160,v,144,v,132
MA 192,v,144,v,136
MA 224,v,144,v,140
MA 4,v,148,v,112
MA 36,v,148,v,116
s_waitcnt vmcnt(10) lgkmcnt(0)
s_barrier
MA 68,v,148,v,120
TR 144,196,0
TR 146,196,2048
MA 100,v,148,v,124
ds_read_b128 v[80:83], v192 offset:0
s_add_u32 m0, s23, 32768
MA 132,v,148,v,128
s_and_b32 s37, s3, 3
MA 164,v,148,v,132
s_cmp_eq_u32 s37, 2
s_cselect_b32 s37, 0, 0x40000000
MA 196,v,148,v,136
buffer_load_dwordx4 v184, s[12:15], s21 offen offset:0 lds
v_add_u32 v229, s37, v78
MA 228,v,148,v,140
TR 148,197,0
TR 150,197,2048
MA 8,v,152,v,112
ds_read_b128 v[84:87], v192 offset:2048
buffer_load_dword v79, v229, s[4:7], 0 offen
MA 40,v,152,v,116
s_add_u32 s84, s40, 50331648
s_addc_u32 s85, s41, 0
MA 72,v,152,v,120
buffer_load_dwordx4 v185, s[12:15], s21 offen offset:1024 lds
s_mov_b32 s86, 4194304
MA 104,v,152,v,124
s_mov_b32 s87, 0x20000
MA 136,v,152,v,128
s_add_u32 s88, s40, 58720256
s_addc_u32 s89, s41, 0
MA 168,v,152,v,132
ds_read_b128 v[88:91], v192 offset:4096
s_mov_b32 s90, 8192
MA 200,v,152,v,136
s_mov_b32 s91, 0x20000
v_mov_b32 v252, 0
MA 232,v,152,v,140
TR 152,198,0
TR 154,198,2048
MA 12,v,156,v,112
buffer_load_dwordx4 v186, s[12:15], s21 offen offset:2048 lds
v_mov_b32 v253, 0
MA 44,v,156,v,116
v_dot2_f32_bf16 v252, v230, v2, v252
v_dot2_f32_bf16 v253, v231, v3, v253
MA 76,v,156,v,120
ds_read_b128 v[92:95], v192 offset:6144
v_dot2_f32_bf16 v252, v232, v4, v252
MA 108,v,156,v,124
buffer_load_dwordx4 v187, s[12:15], s21 offen offset:3072 lds
v_dot2_f32_bf16 v253, v233, v5, v253
MA 140,v,156,v,128
v_dot2_f32_bf16 v252, v234, v6, v252
v_dot2_f32_bf16 v253, v235, v7, v253
MA 172,v,156,v,132
v_dot2_f32_bf16 v252, v236, v8, v252
v_dot2_f32_bf16 v253, v237, v9, v253
MA 204,v,156,v,136
v_dot2_f32_bf16 v252, v238, v12, v252
v_dot2_f32_bf16 v253, v239, v13, v253
MA 236,v,156,v,140
TR 156,199,0
TR 158,199,2048
MA 16,v,160,v,112
ds_read_b128 v[96:99], v192 offset:8192
s_add_u32 m0, s23, 36864
MA 48,v,160,v,116
v_dot2_f32_bf16 v252, v240, v14, v252
v_dot2_f32_bf16 v253, v241, v15, v253
MA 80,v,160,v,120
v_dot2_f32_bf16 v252, v242, v246, v252
v_dot2_f32_bf16 v253, v243, v247, v253
MA 112,v,160,v,124
v_dot2_f32_bf16 v252, v244, v248, v252
v_dot2_f32_bf16 v253, v245, v249, v253
MA 144,v,160,v,128
ds_read_b128 v[100:103], v192 offset:10240
buffer_load_dwordx4 v188, s[12:15], s21 offen offset:0 lds
MA 176,v,160,v,132
s_nop 2
v_add_f32 v252, v252, v253
MA 208,v,160,v,136
s_nop 0
v_add_f32_dpp v252, v252, v252 row_ror:8 row_mask:0xf bank_mask:0xf
s_nop 1
v_add_f32_dpp v252, v252, v252 row_ror:4 row_mask:0xf bank_mask:0xf
MA 240,v,160,v,140
TR 160,200,0
TR 162,200,2048
MA 20,v,164,v,112
buffer_load_dwordx4 v189, s[12:15], s21 offen offset:1024 lds
v_add_f32_dpp v252, v252, v252 row_ror:2 row_mask:0xf bank_mask:0xf
MA 52,v,164,v,116
ds_read_b128 v[104:107], v192 offset:12288
v_add_f32_dpp v252, v252, v252 row_ror:1 row_mask:0xf bank_mask:0xf
MA 84,v,164,v,120
v_mov_b32 v253, v252
s_nop 1
v_permlane16_swap_b32 v252, v253
MA 116,v,164,v,124
v_add_f32 v252, v252, v253
v_mul_f32 v252, 0xbfb8aa3b, v252
MA 148,v,164,v,128
buffer_load_dwordx4 v190, s[12:15], s21 offen offset:2048 lds
MA 180,v,164,v,132
v_exp_f32 v252, v252
MA 212,v,164,v,136
ds_read_b128 v[108:111], v192 offset:14336
v_add_f32 v252, 1.0, v252
MA 244,v,164,v,140
TR 164,201,0
TR 166,201,2048
MA 24,v,168,v,112
v_rcp_f32 v252, v252
MA 56,v,168,v,116
buffer_load_dwordx4 v191, s[12:15], s21 offen offset:3072 lds
MA 88,v,168,v,120
s_nop 0
buffer_store_dword v252, v11, s[88:91], 0 offen sc1
MA 120,v,168,v,124
v_lshlrev_b32 v2, 16, v54
v_and_b32 v3, 0xffff0000, v54
MA 152,v,168,v,128
v_lshlrev_b32 v4, 16, v55
v_and_b32 v5, 0xffff0000, v55
MA 184,v,168,v,132
s_add_u32 s21, s21, 524288
v_lshlrev_b32 v6, 16, v56
MA 216,v,168,v,136
v_and_b32 v7, 0xffff0000, v56
v_lshlrev_b32 v8, 16, v57
MA 248,v,168,v,140
TR 168,202,0
TR 170,202,2048
MA 28,v,172,v,112
v_and_b32 v9, 0xffff0000, v57
v_lshlrev_b32 v230, 16, v16
MA 60,v,172,v,116
s_and_b32 s21, s21, 4194303
v_and_b32 v231, 0xffff0000, v16
MA 92,v,172,v,120
v_lshlrev_b32 v232, 16, v18
v_and_b32 v233, 0xffff0000, v18
MA 124,v,172,v,124
v_lshlrev_b32 v234, 16, v20
v_and_b32 v235, 0xffff0000, v20
MA 156,v,172,v,128
v_lshlrev_b32 v236, 16, v22
v_and_b32 v237, 0xffff0000, v22
MA 188,v,172,v,132
v_lshlrev_b32 v238, 16, v24
v_and_b32 v239, 0xffff0000, v24
MA 220,v,172,v,136
v_lshlrev_b32 v240, 16, v26
v_and_b32 v241, 0xffff0000, v26
MA 252,v,172,v,140
TR 172,203,0
TR 174,203,2048
v_lshlrev_b32 v242, 16, v28
v_and_b32 v243, 0xffff0000, v28
v_lshlrev_b32 v244, 16, v30
v_and_b32 v245, 0xffff0000, v30
v_lshlrev_b32 v246, 16, v32
v_and_b32 v247, 0xffff0000, v32
v_lshlrev_b32 v248, 16, v34
v_and_b32 v249, 0xffff0000, v34
v_lshlrev_b32 v250, 16, v36
v_and_b32 v251, 0xffff0000, v36
v_lshlrev_b32 v254, 16, v38
v_and_b32 v255, 0xffff0000, v38
v_mul_f32 v62, v236, v2
v_mul_f32 v70, v237, v6
v_fmac_f32 v62, v234, v3
v_fmac_f32 v70, v235, v7
v_fmac_f32 v62, v232, v4
v_fmac_f32 v70, v233, v8
v_fmac_f32 v62, v230, v5
v_fmac_f32 v70, v231, v9
v_mul_f32 v62, v62, v254
s_waitcnt lgkmcnt(2)
MA 0,v,144,v,80
s_add_u32 s75, s64, s74
s_and_b32 s37, s3, 3
MA 32,v,144,v,84
ds_read_b128 v[112:115], v193 offset:0
MA 64,v,144,v,88
s_cmp_eq_u32 s37, 3
s_cselect_b32 s37, 0, 0x40000000
MA 96,v,144,v,92
v_add_u32 v229, s37, v78
buffer_load_dword v79, v229, s[4:7], 0 offen
MA 128,v,144,v,96
s_add_u32 m0, s67, 65536
v_mul_f32 v70, v70, v255
MA 160,v,144,v,100
v_lshlrev_b32 v254, 16, v40
v_and_b32 v255, 0xffff0000, v40
MA 192,v,144,v,104
v_mul_f32 v63, v238, v2
v_mul_f32 v71, v239, v6
MA 224,v,144,v,108
TR 144,196,16384
TR 146,196,18432
MA 4,v,148,v,80
ds_read_b128 v[116:119], v193 offset:2048
buffer_load_dwordx4 v208, s[44:47], s75 offen offset:0 lds
MA 36,v,148,v,84
v_fmac_f32 v63, v236, v3
v_fmac_f32 v71, v237, v7
MA 68,v,148,v,88
v_fmac_f32 v63, v234, v4
v_fmac_f32 v71, v235, v8
MA 100,v,148,v,92
v_fmac_f32 v63, v232, v5
v_fmac_f32 v71, v233, v9
MA 132,v,148,v,96
v_mul_f32 v63, v63, v254
v_mul_f32 v71, v71, v255
MA 164,v,148,v,100
ds_read_b128 v[120:123], v193 offset:4096
buffer_load_dwordx4 v209, s[44:47], s75 offen offset:1024 lds
MA 196,v,148,v,104
v_lshlrev_b32 v254, 16, v42
v_and_b32 v255, 0xffff0000, v42
MA 228,v,148,v,108
TR 148,197,16384
TR 150,197,18432
MA 8,v,152,v,80
v_mul_f32 v64, v240, v2
v_mul_f32 v72, v241, v6
MA 40,v,152,v,84
buffer_load_dwordx4 v210, s[44:47], s75 offen offset:2048 lds
v_fmac_f32 v64, v238, v3
MA 72,v,152,v,88
v_fmac_f32 v72, v239, v7
v_fmac_f32 v64, v236, v4
MA 104,v,152,v,92
v_fmac_f32 v72, v237, v8
v_fmac_f32 v64, v234, v5
MA 136,v,152,v,96
ds_read_b128 v[124:127], v193 offset:6144
v_fmac_f32 v72, v235, v9
MA 168,v,152,v,100
v_mul_f32 v64, v64, v254
v_mul_f32 v72, v72, v255
MA 200,v,152,v,104
buffer_load_dwordx4 v211, s[44:47], s75 offen offset:3072 lds
v_lshlrev_b32 v254, 16, v44
MA 232,v,152,v,108
TR 152,198,16384
TR 154,198,18432
MA 12,v,156,v,80
v_and_b32 v255, 0xffff0000, v44
v_mul_f32 v65, v242, v2
MA 44,v,156,v,84
v_mul_f32 v73, v243, v6
v_fmac_f32 v65, v240, v3
MA 76,v,156,v,88
ds_read_b128 v[128:131], v193 offset:8192
s_add_u32 s75, s65, s74
MA 108,v,156,v,92
v_fmac_f32 v73, v241, v7
v_fmac_f32 v65, v238, v4
MA 140,v,156,v,96
v_fmac_f32 v73, v239, v8
v_fmac_f32 v65, v236, v5
MA 172,v,156,v,100
v_fmac_f32 v73, v237, v9
v_mul_f32 v65, v65, v254
MA 204,v,156,v,104
v_mul_f32 v73, v73, v255
MA 236,v,156,v,108
TR 156,199,16384
TR 158,199,18432
MA 16,v,160,v,80
ds_read_b128 v[132:135], v193 offset:10240
s_add_u32 m0, s67, 69632
MA 48,v,160,v,84
v_lshlrev_b32 v254, 16, v46
v_and_b32 v255, 0xffff0000, v46
MA 80,v,160,v,88
v_mul_f32 v66, v244, v2
v_mul_f32 v74, v245, v6
MA 112,v,160,v,92
buffer_load_dwordx4 v208, s[44:47], s75 offen offset:0 lds
v_fmac_f32 v66, v242, v3
MA 144,v,160,v,96
v_fmac_f32 v74, v243, v7
v_fmac_f32 v66, v240, v4
MA 176,v,160,v,100
v_fmac_f32 v74, v241, v8
v_fmac_f32 v66, v238, v5
MA 208,v,160,v,104
v_fmac_f32 v74, v239, v9
v_mul_f32 v66, v66, v254
MA 240,v,160,v,108
TR 160,200,16384
TR 162,200,18432
MA 20,v,164,v,80
ds_read_b128 v[136:139], v193 offset:12288
buffer_load_dwordx4 v209, s[44:47], s75 offen offset:1024 lds
MA 52,v,164,v,84
v_mul_f32 v74, v74, v255
v_lshlrev_b32 v254, 16, v48
MA 84,v,164,v,88
v_and_b32 v255, 0xffff0000, v48
v_mul_f32 v67, v246, v2
MA 116,v,164,v,92
v_mul_f32 v75, v247, v6
v_fmac_f32 v67, v244, v3
MA 148,v,164,v,96
buffer_load_dwordx4 v210, s[44:47], s75 offen offset:2048 lds
v_fmac_f32 v75, v245, v7
MA 180,v,164,v,100
ds_read_b128 v[140:143], v193 offset:14336
v_fmac_f32 v67, v242, v4
MA 212,v,164,v,104
v_fmac_f32 v75, v243, v8
v_fmac_f32 v67, v240, v5
MA 244,v,164,v,108
TR 164,201,16384
TR 166,201,18432
MA 24,v,168,v,80
buffer_load_dwordx4 v211, s[44:47], s75 offen offset:3072 lds
v_fmac_f32 v75, v241, v9
MA 56,v,168,v,84
v_mul_f32 v67, v67, v254
v_mul_f32 v75, v75, v255
MA 88,v,168,v,88
v_lshlrev_b32 v254, 16, v50
v_and_b32 v255, 0xffff0000, v50
MA 120,v,168,v,92
s_waitcnt vmcnt(28)
v_mul_f32 v68, v248, v2
v_mul_f32 v76, v249, v6
MA 152,v,168,v,96
v_fmac_f32 v68, v246, v3
MA 184,v,168,v,100
s_add_u32 s74, s74, 128
v_fmac_f32 v76, v247, v7
MA 216,v,168,v,104
v_fmac_f32 v68, v244, v4
v_fmac_f32 v76, v245, v8
MA 248,v,168,v,108
TR 168,202,16384
TR 170,202,18432
s_waitcnt lgkmcnt(15)
MA 28,v,172,v,80
v_fmac_f32 v68, v242, v5
v_fmac_f32 v76, v243, v9
MA 60,v,172,v,84
s_and_b32 s74, s74, 2047
v_mul_f32 v68, v68, v254
MA 92,v,172,v,88
v_mul_f32 v76, v76, v255
v_lshlrev_b32 v254, 16, v52
MA 124,v,172,v,92
v_and_b32 v255, 0xffff0000, v52
v_mul_f32 v69, v250, v2
MA 156,v,172,v,96
v_mul_f32 v77, v251, v6
MA 188,v,172,v,100
v_fmac_f32 v69, v248, v3
MA 220,v,172,v,104
MA 252,v,172,v,108
TR 172,203,16384
TR 174,203,18432
s_waitcnt lgkmcnt(2)
MA 0,v,144,v,112
MA 32,v,144,v,116
MA 64,v,144,v,120
MA 96,v,144,v,124
MA 128,v,144,v,128
MA 160,v,144,v,132
MA 192,v,144,v,136
MA 224,v,144,v,140
MA 4,v,148,v,112
MA 36,v,148,v,116
s_waitcnt vmcnt(10) lgkmcnt(0)
s_barrier
MA 68,v,148,v,120
TR 144,196,32768
TR 146,196,34816
MA 100,v,148,v,124
ds_read_b128 v[80:83], v192 offset:32768
s_add_u32 m0, s68, 98304
MA 132,v,148,v,128
v_fmac_f32 v77, v249, v7
v_fmac_f32 v69, v246, v4
MA 164,v,148,v,132
buffer_load_dwordx4 v212, s[48:51], s66 offen offset:0 lds
v_fmac_f32 v77, v247, v8
MA 196,v,148,v,136
v_fmac_f32 v69, v244, v5
v_fmac_f32 v77, v245, v9
MA 228,v,148,v,140
TR 148,197,32768
TR 150,197,34816
MA 8,v,152,v,112
ds_read_b128 v[84:87], v192 offset:34816
v_mul_f32 v69, v69, v254
MA 40,v,152,v,116
buffer_load_dwordx4 v213, s[48:51], s66 offen offset:1024 lds
v_mul_f32 v77, v77, v255
MA 72,v,152,v,120
v_cvt_pk_bf16_f32 v12, v69, v68
v_cvt_pk_bf16_f32 v13, v67, v66
MA 104,v,152,v,124
v_cvt_pk_bf16_f32 v14, v65, v64
v_cvt_pk_bf16_f32 v15, v63, v62
MA 136,v,152,v,128
s_mov_b32 s36, 0
buffer_store_dwordx4 v[12:15], v10, s[84:87], s36 offen sc1
MA 168,v,152,v,132
ds_read_b128 v[88:91], v192 offset:36864
buffer_load_dwordx4 v214, s[48:51], s66 offen offset:2048 lds
MA 200,v,152,v,136
v_cvt_pk_bf16_f32 v54, v77, v76
v_cvt_pk_bf16_f32 v55, v75, v74
MA 232,v,152,v,140
TR 152,198,32768
TR 154,198,34816
MA 12,v,156,v,112
buffer_load_dwordx4 v215, s[48:51], s66 offen offset:3072 lds
v_cvt_pk_bf16_f32 v56, v73, v72
MA 44,v,156,v,116
v_cvt_pk_bf16_f32 v57, v71, v70
s_mov_b32 s36, 4096
MA 76,v,156,v,120
ds_read_b128 v[92:95], v192 offset:38912
buffer_store_dwordx4 v[54:57], v10, s[84:87], s36 offen sc1
MA 108,v,156,v,124
v_lshlrev_b32 v2, 16, v58
v_and_b32 v3, 0xffff0000, v58
MA 140,v,156,v,128
s_add_u32 s66, s66, 524288
v_lshlrev_b32 v4, 16, v59
MA 172,v,156,v,132
v_and_b32 v5, 0xffff0000, v59
v_lshlrev_b32 v6, 16, v60
MA 204,v,156,v,136
v_and_b32 v7, 0xffff0000, v60
v_lshlrev_b32 v8, 16, v61
MA 236,v,156,v,140
TR 156,199,32768
TR 158,199,34816
MA 16,v,160,v,112
ds_read_b128 v[96:99], v192 offset:40960
s_and_b32 s66, s66, 8388607
MA 48,v,160,v,116
v_and_b32 v9, 0xffff0000, v61
v_lshlrev_b32 v230, 16, v17
MA 80,v,160,v,120
v_and_b32 v231, 0xffff0000, v17
v_lshlrev_b32 v232, 16, v19
MA 112,v,160,v,124
v_and_b32 v233, 0xffff0000, v19
v_lshlrev_b32 v234, 16, v21
MA 144,v,160,v,128
ds_read_b128 v[100:103], v192 offset:43008
s_add_u32 m0, s68, 114688
MA 176,v,160,v,132
v_and_b32 v235, 0xffff0000, v21
v_lshlrev_b32 v236, 16, v23
MA 208,v,160,v,136
v_and_b32 v237, 0xffff0000, v23
v_lshlrev_b32 v238, 16, v25
MA 240,v,160,v,140
TR 160,200,32768
TR 162,200,34816
MA 20,v,164,v,112
buffer_load_dwordx4 v212, s[48:51], s66 offen offset:0 lds
v_and_b32 v239, 0xffff0000, v25
MA 52,v,164,v,116
ds_read_b128 v[104:107], v192 offset:45056
v_lshlrev_b32 v240, 16, v27
MA 84,v,164,v,120
v_and_b32 v241, 0xffff0000, v27
v_lshlrev_b32 v242, 16, v29
MA 116,v,164,v,124
buffer_load_dwordx4 v213, s[48:51], s66 offen offset:1024 lds
v_and_b32 v243, 0xffff0000, v29
MA 148,v,164,v,128
v_lshlrev_b32 v244, 16, v31
v_and_b32 v245, 0xffff0000, v31
MA 180,v,164,v,132
v_lshlrev_b32 v246, 16, v33
v_and_b32 v247, 0xffff0000, v33
MA 212,v,164,v,136
ds_read_b128 v[108:111], v192 offset:47104
v_lshlrev_b32 v248, 16, v35
MA 244,v,164,v,140
TR 164,201,32768
TR 166,201,34816
MA 24,v,168,v,112
buffer_load_dwordx4 v214, s[48:51], s66 offen offset:2048 lds
v_and_b32 v249, 0xffff0000, v35
MA 56,v,168,v,116
v_lshlrev_b32 v250, 16, v37
v_and_b32 v251, 0xffff0000, v37
MA 88,v,168,v,120
buffer_load_dwordx4 v215, s[48:51], s66 offen offset:3072 lds
v_lshlrev_b32 v254, 16, v39
MA 120,v,168,v,124
v_and_b32 v255, 0xffff0000, v39
v_mul_f32 v62, v236, v2
MA 152,v,168,v,128
v_mul_f32 v70, v237, v6
v_fmac_f32 v62, v234, v3
MA 184,v,168,v,132
v_fmac_f32 v70, v235, v7
v_fmac_f32 v62, v232, v4
MA 216,v,168,v,136
s_add_u32 s66, s66, 524288
v_fmac_f32 v70, v233, v8
MA 248,v,168,v,140
TR 168,202,32768
TR 170,202,34816
MA 28,v,172,v,112
v_fmac_f32 v62, v230, v5
v_fmac_f32 v70, v231, v9
MA 60,v,172,v,116
v_mul_f32 v62, v62, v254
v_mul_f32 v70, v70, v255
MA 92,v,172,v,120
s_and_b32 s66, s66, 8388607
v_lshlrev_b32 v254, 16, v41
MA 124,v,172,v,124
v_and_b32 v255, 0xffff0000, v41
v_mul_f32 v63, v238, v2
MA 156,v,172,v,128
v_mul_f32 v71, v239, v6
v_fmac_f32 v63, v236, v3
MA 188,v,172,v,132
v_fmac_f32 v71, v237, v7
v_fmac_f32 v63, v234, v4
MA 220,v,172,v,136
v_fmac_f32 v71, v235, v8
v_fmac_f32 v63, v232, v5
MA 252,v,172,v,140
TR 172,203,32768
TR 174,203,34816
v_fmac_f32 v71, v233, v9
v_mul_f32 v63, v63, v254
v_mul_f32 v71, v71, v255
v_lshlrev_b32 v254, 16, v43
v_and_b32 v255, 0xffff0000, v43
v_mul_f32 v64, v240, v2
v_mul_f32 v72, v241, v6
v_fmac_f32 v64, v238, v3
s_waitcnt lgkmcnt(2)
MA 0,v,144,v,80
s_add_u32 s75, s64, s74
v_fmac_f32 v72, v239, v7
MA 32,v,144,v,84
ds_read_b128 v[112:115], v193 offset:32768
v_fmac_f32 v64, v236, v4
MA 64,v,144,v,88
v_fmac_f32 v72, v237, v8
v_fmac_f32 v64, v234, v5
MA 96,v,144,v,92
v_fmac_f32 v72, v235, v9
v_mul_f32 v64, v64, v254
MA 128,v,144,v,96
s_add_u32 m0, s67, 0
v_mul_f32 v72, v72, v255
MA 160,v,144,v,100
v_lshlrev_b32 v254, 16, v45
MA 192,v,144,v,104
v_and_b32 v255, 0xffff0000, v45
v_mul_f32 v65, v242, v2
MA 224,v,144,v,108
TR 144,196,49152
TR 146,196,51200
MA 4,v,148,v,80
ds_read_b128 v[116:119], v193 offset:34816
buffer_load_dwordx4 v208, s[44:47], s75 offen offset:0 lds
MA 36,v,148,v,84
v_mul_f32 v73, v243, v6
v_fmac_f32 v65, v240, v3
MA 68,v,148,v,88
v_fmac_f32 v73, v241, v7
v_fmac_f32 v65, v238, v4
MA 100,v,148,v,92
v_fmac_f32 v73, v239, v8
v_fmac_f32 v65, v236, v5
MA 132,v,148,v,96
v_fmac_f32 v73, v237, v9
MA 164,v,148,v,100
ds_read_b128 v[120:123], v193 offset:36864
buffer_load_dwordx4 v209, s[44:47], s75 offen offset:1024 lds
MA 196,v,148,v,104
v_mul_f32 v65, v65, v254
v_mul_f32 v73, v73, v255
MA 228,v,148,v,108
TR 148,197,49152
TR 150,197,51200
MA 8,v,152,v,80
v_lshlrev_b32 v254, 16, v47
v_and_b32 v255, 0xffff0000, v47
MA 40,v,152,v,84
buffer_load_dwordx4 v210, s[44:47], s75 offen offset:2048 lds
v_mul_f32 v66, v244, v2
MA 72,v,152,v,88
v_mul_f32 v74, v245, v6
v_fmac_f32 v66, v242, v3
MA 104,v,152,v,92
v_fmac_f32 v74, v243, v7
v_fmac_f32 v66, v240, v4
MA 136,v,152,v,96
ds_read_b128 v[124:127], v193 offset:38912
v_fmac_f32 v74, v241, v8
MA 168,v,152,v,100
v_fmac_f32 v66, v238, v5
v_fmac_f32 v74, v239, v9
MA 200,v,152,v,104
buffer_load_dwordx4 v211, s[44:47], s75 offen offset:3072 lds
v_mul_f32 v66, v66, v254
MA 232,v,152,v,108
TR 152,198,49152
TR 154,198,51200
MA 12,v,156,v,80
v_mul_f32 v74, v74, v255
v_lshlrev_b32 v254, 16, v49
MA 44,v,156,v,84
v_and_b32 v255, 0xffff0000, v49
v_mul_f32 v67, v246, v2
MA 76,v,156,v,88
ds_read_b128 v[128:131], v193 offset:40960
s_add_u32 s75, s65, s74
MA 108,v,156,v,92
v_mul_f32 v75, v247, v6
v_fmac_f32 v67, v244, v3
MA 140,v,156,v,96
v_fmac_f32 v75, v245, v7
v_fmac_f32 v67, v242, v4
MA 172,v,156,v,100
v_fmac_f32 v75, v243, v8
MA 204,v,156,v,104
v_fmac_f32 v67, v240, v5
MA 236,v,156,v,108
TR 156,199,49152
TR 158,199,51200
MA 16,v,160,v,80
ds_read_b128 v[132:135], v193 offset:43008
s_add_u32 m0, s67, 4096
MA 48,v,160,v,84
v_fmac_f32 v75, v241, v9
v_mul_f32 v67, v67, v254
MA 80,v,160,v,88
v_mul_f32 v75, v75, v255
v_lshlrev_b32 v254, 16, v51
MA 112,v,160,v,92
buffer_load_dwordx4 v208, s[44:47], s75 offen offset:0 lds
v_and_b32 v255, 0xffff0000, v51
MA 144,v,160,v,96
v_mul_f32 v68, v248, v2
v_mul_f32 v76, v249, v6
MA 176,v,160,v,100
v_fmac_f32 v68, v246, v3
v_fmac_f32 v76, v247, v7
MA 208,v,160,v,104
v_fmac_f32 v68, v244, v4
v_fmac_f32 v76, v245, v8
MA 240,v,160,v,108
TR 160,200,49152
TR 162,200,51200
MA 20,v,164,v,80
ds_read_b128 v[136:139], v193 offset:45056
buffer_load_dwordx4 v209, s[44:47], s75 offen offset:1024 lds
MA 52,v,164,v,84
v_fmac_f32 v68, v242, v5
v_fmac_f32 v76, v243, v9
MA 84,v,164,v,88
v_mul_f32 v68, v68, v254
v_mul_f32 v76, v76, v255
MA 116,v,164,v,92
v_lshlrev_b32 v254, 16, v53
v_and_b32 v255, 0xffff0000, v53
MA 148,v,164,v,96
buffer_load_dwordx4 v210, s[44:47], s75 offen offset:2048 lds
v_mul_f32 v69, v250, v2
MA 180,v,164,v,100
ds_read_b128 v[140:143], v193 offset:47104
v_mul_f32 v77, v251, v6
MA 212,v,164,v,104
v_fmac_f32 v69, v248, v3
v_fmac_f32 v77, v249, v7
MA 244,v,164,v,108
TR 164,201,49152
TR 166,201,51200
MA 24,v,168,v,80
buffer_load_dwordx4 v211, s[44:47], s75 offen offset:3072 lds
v_fmac_f32 v69, v246, v4
MA 56,v,168,v,84
v_fmac_f32 v77, v247, v8
v_fmac_f32 v69, v244, v5
MA 88,v,168,v,88
v_fmac_f32 v77, v245, v9
v_mul_f32 v69, v69, v254
MA 120,v,168,v,92
v_mul_f32 v77, v77, v255
v_cvt_pk_bf16_f32 v230, v69, v68
MA 152,v,168,v,96
v_cvt_pk_bf16_f32 v231, v67, v66
MA 184,v,168,v,100
s_add_u32 s74, s74, 128
v_cvt_pk_bf16_f32 v232, v65, v64
MA 216,v,168,v,104
v_cvt_pk_bf16_f32 v233, v63, v62
MA 248,v,168,v,108
TR 168,202,49152
TR 170,202,51200
s_waitcnt lgkmcnt(15)
MA 28,v,172,v,80
s_mov_b32 s36, 8192
buffer_store_dwordx4 v[230:233], v10, s[84:87], s36 offen sc1
MA 60,v,172,v,84
s_and_b32 s74, s74, 2047
v_cvt_pk_bf16_f32 v234, v77, v76
MA 92,v,172,v,88
v_cvt_pk_bf16_f32 v235, v75, v74
v_cvt_pk_bf16_f32 v236, v73, v72
MA 124,v,172,v,92
v_cvt_pk_bf16_f32 v237, v71, v70
s_mov_b32 s36, 12288
MA 156,v,172,v,96
buffer_store_dwordx4 v[234:237], v10, s[84:87], s36 offen sc1
MA 188,v,172,v,100
v_lshlrev_b32 v228, 4, v1
MA 220,v,172,v,104
MA 252,v,172,v,108
TR 172,203,49152
TR 174,203,51200
s_waitcnt lgkmcnt(2)
MA 0,v,144,v,112
MA 32,v,144,v,116
MA 64,v,144,v,120
MA 96,v,144,v,124
MA 128,v,144,v,128
MA 160,v,144,v,132
MA 192,v,144,v,136
MA 224,v,144,v,140
MA 4,v,148,v,112
MA 36,v,148,v,116
s_waitcnt vmcnt(15) lgkmcnt(0)
s_barrier
MA 68,v,148,v,120
ds_read_b128 v[48:51], v226 offset:0
s_add_u32 m0, s68, 131072
MA 100,v,148,v,124
MA 132,v,148,v,128
ds_read_b128 v[52:55], v226 offset:2048
buffer_load_dwordx4 v212, s[48:51], s66 offen offset:0 lds
MA 164,v,148,v,132
MA 196,v,148,v,136
ds_read_b128 v[56:59], v226 offset:4096
buffer_load_dwordx4 v213, s[48:51], s66 offen offset:1024 lds
MA 228,v,148,v,140
MA 8,v,152,v,112
ds_read_b128 v[60:63], v226 offset:6144
MA 40,v,152,v,116
buffer_load_dwordx4 v214, s[48:51], s66 offen offset:2048 lds
MA 72,v,152,v,120
TR 16,216,0
MA 104,v,152,v,124
buffer_load_dwordx4 v215, s[48:51], s66 offen offset:3072 lds
MA 136,v,152,v,128
TR 18,216,1024
MA 168,v,152,v,132
MA 200,v,152,v,136
TR 20,217,0
s_add_u32 s66, s66, 524288
MA 232,v,152,v,140
MA 12,v,156,v,112
TR 22,217,1024
s_and_b32 s66, s66, 8388607
MA 44,v,156,v,116
MA 76,v,156,v,120
TR 24,218,0
MA 108,v,156,v,124
s_add_u32 s75, s64, s74
MA 140,v,156,v,128
TR 26,218,1024
MA 172,v,156,v,132
s_add_u32 m0, s67, 32768
MA 204,v,156,v,136
TR 28,219,0
MA 236,v,156,v,140
MA 16,v,160,v,112
TR 30,219,1024
buffer_load_dwordx4 v208, s[44:47], s75 offen offset:0 lds
MA 48,v,160,v,116
MA 80,v,160,v,120
TR 32,220,0
buffer_load_dwordx4 v209, s[44:47], s75 offen offset:1024 lds
MA 112,v,160,v,124
MA 144,v,160,v,128
TR 34,220,1024
MA 176,v,160,v,132
buffer_load_dwordx4 v210, s[44:47], s75 offen offset:2048 lds
MA 208,v,160,v,136
TR 36,221,0
MA 240,v,160,v,140
buffer_load_dwordx4 v211, s[44:47], s75 offen offset:3072 lds
MA 20,v,164,v,112
TR 38,221,1024
MA 52,v,164,v,116
MA 84,v,164,v,120
TR 40,222,0
s_add_u32 s75, s65, s74
MA 116,v,164,v,124
MA 148,v,164,v,128
TR 42,222,1024
s_add_u32 m0, s67, 36864
MA 180,v,164,v,132
MA 212,v,164,v,136
TR 44,223,0
MA 244,v,164,v,140
buffer_load_dwordx4 v208, s[44:47], s75 offen offset:0 lds
MA 24,v,168,v,112
TR 46,223,1024
MA 56,v,168,v,116
buffer_load_dwordx4 v209, s[44:47], s75 offen offset:1024 lds
MA 88,v,168,v,120
MA 120,v,168,v,124
MA 152,v,168,v,128
buffer_load_dwordx4 v210, s[44:47], s75 offen offset:2048 lds
MA 184,v,168,v,132
MA 216,v,168,v,136
buffer_load_dwordx4 v211, s[44:47], s75 offen offset:3072 lds
MA 248,v,168,v,140
MA 28,v,172,v,112
MA 60,v,172,v,116
s_add_u32 s74, s74, 128
MA 92,v,172,v,120
MA 124,v,172,v,124
s_and_b32 s74, s74, 2047
MA 156,v,172,v,128
MA 188,v,172,v,132
MA 220,v,172,v,136
MA 252,v,172,v,140
s_branch L_p2
L_p1_V:
s_waitcnt lgkmcnt(14)
v_mfma_f32_16x16x32_bf16 a[0:3], v[80:83], v[144:147], 0
s_add_u32 m0, s23, 32768
v_mfma_f32_16x16x32_bf16 a[4:7], v[84:87], v[144:147], 0
ds_read_b128 v[112:115], v193 offset:0
v_mfma_f32_16x16x32_bf16 a[64:67], v[88:91], v[144:147], 0
buffer_load_dwordx4 v184, s[12:15], s21 offen offset:0 lds
v_mfma_f32_16x16x32_bf16 a[68:71], v[92:95], v[144:147], 0
v_mfma_f32_16x16x32_bf16 a[128:131], v[96:99], v[144:147], 0
v_mfma_f32_16x16x32_bf16 a[132:135], v[100:103], v[144:147], 0
buffer_load_dwordx4 v185, s[12:15], s21 offen offset:1024 lds
v_mfma_f32_16x16x32_bf16 a[192:195], v[104:107], v[144:147], 0
v_mfma_f32_16x16x32_bf16 a[196:199], v[108:111], v[144:147], 0
TR 144,196,16384
TR 146,196,18432
s_waitcnt lgkmcnt(15)
v_mfma_f32_16x16x32_bf16 a[8:11], v[80:83], v[148:151], 0
ds_read_b128 v[116:119], v193 offset:2048
buffer_load_dwordx4 v186, s[12:15], s21 offen offset:2048 lds
v_mfma_f32_16x16x32_bf16 a[12:15], v[84:87], v[148:151], 0
v_mfma_f32_16x16x32_bf16 a[72:75], v[88:91], v[148:151], 0
buffer_load_dwordx4 v187, s[12:15], s21 offen offset:3072 lds
v_mfma_f32_16x16x32_bf16 a[76:79], v[92:95], v[148:151], 0
v_mfma_f32_16x16x32_bf16 a[136:139], v[96:99], v[148:151], 0
s_add_u32 m0, s23, 36864
v_mfma_f32_16x16x32_bf16 a[140:143], v[100:103], v[148:151], 0
ds_read_b128 v[120:123], v193 offset:4096
v_mfma_f32_16x16x32_bf16 a[200:203], v[104:107], v[148:151], 0
v_mfma_f32_16x16x32_bf16 a[204:207], v[108:111], v[148:151], 0
TR 148,197,16384
TR 150,197,18432
s_waitcnt lgkmcnt(15)
v_mfma_f32_16x16x32_bf16 a[16:19], v[80:83], v[152:155], 0
buffer_load_dwordx4 v188, s[12:15], s21 offen offset:0 lds
v_mfma_f32_16x16x32_bf16 a[20:23], v[84:87], v[152:155], 0
v_mfma_f32_16x16x32_bf16 a[80:83], v[88:91], v[152:155], 0
buffer_load_dwordx4 v189, s[12:15], s21 offen offset:1024 lds
v_mfma_f32_16x16x32_bf16 a[84:87], v[92:95], v[152:155], 0
v_mfma_f32_16x16x32_bf16 a[144:147], v[96:99], v[152:155], 0
ds_read_b128 v[124:127], v193 offset:6144
buffer_load_dwordx4 v190, s[12:15], s21 offen offset:2048 lds
v_mfma_f32_16x16x32_bf16 a[148:151], v[100:103], v[152:155], 0
v_mfma_f32_16x16x32_bf16 a[208:211], v[104:107], v[152:155], 0
v_mfma_f32_16x16x32_bf16 a[212:215], v[108:111], v[152:155], 0
TR 152,198,16384
TR 154,198,18432
v_mfma_f32_16x16x32_bf16 a[24:27], v[80:83], v[156:159], 0
buffer_load_dwordx4 v191, s[12:15], s21 offen offset:3072 lds
v_mfma_f32_16x16x32_bf16 a[28:31], v[84:87], v[156:159], 0
s_add_u32 s21, s21, 524288
v_mfma_f32_16x16x32_bf16 a[88:91], v[88:91], v[156:159], 0
ds_read_b128 v[128:131], v193 offset:8192
v_mfma_f32_16x16x32_bf16 a[92:95], v[92:95], v[156:159], 0
v_mfma_f32_16x16x32_bf16 a[152:155], v[96:99], v[156:159], 0
s_and_b32 s21, s21, 4194303
v_mfma_f32_16x16x32_bf16 a[156:159], v[100:103], v[156:159], 0
v_mfma_f32_16x16x32_bf16 a[216:219], v[104:107], v[156:159], 0
v_mfma_f32_16x16x32_bf16 a[220:223], v[108:111], v[156:159], 0
TR 156,199,16384
TR 158,199,18432
s_waitcnt lgkmcnt(15)
v_mfma_f32_16x16x32_bf16 a[32:35], v[80:83], v[160:163], 0
ds_read_b128 v[132:135], v193 offset:10240
s_add_u32 m0, s22, 32768
v_mfma_f32_16x16x32_bf16 a[36:39], v[84:87], v[160:163], 0
buffer_load_dwordx4 v176, s[8:11], s20 offen offset:0 lds
v_mfma_f32_16x16x32_bf16 a[96:99], v[88:91], v[160:163], 0
v_mfma_f32_16x16x32_bf16 a[100:103], v[92:95], v[160:163], 0
v_mfma_f32_16x16x32_bf16 a[160:163], v[96:99], v[160:163], 0
buffer_load_dwordx4 v177, s[8:11], s20 offen offset:1024 lds
v_mfma_f32_16x16x32_bf16 a[164:167], v[100:103], v[160:163], 0
v_mfma_f32_16x16x32_bf16 a[224:227], v[104:107], v[160:163], 0
buffer_load_dwordx4 v178, s[8:11], s20 offen offset:2048 lds
v_mfma_f32_16x16x32_bf16 a[228:231], v[108:111], v[160:163], 0
TR 160,200,16384
TR 162,200,18432
v_mfma_f32_16x16x32_bf16 a[40:43], v[80:83], v[164:167], 0
ds_read_b128 v[136:139], v193 offset:12288
v_mfma_f32_16x16x32_bf16 a[44:47], v[84:87], v[164:167], 0
buffer_load_dwordx4 v179, s[8:11], s20 offen offset:3072 lds
v_mfma_f32_16x16x32_bf16 a[104:107], v[88:91], v[164:167], 0
v_mfma_f32_16x16x32_bf16 a[108:111], v[92:95], v[164:167], 0
s_add_u32 m0, s22, 36864
v_mfma_f32_16x16x32_bf16 a[168:171], v[96:99], v[164:167], 0
v_mfma_f32_16x16x32_bf16 a[172:175], v[100:103], v[164:167], 0
ds_read_b128 v[140:143], v193 offset:14336
v_mfma_f32_16x16x32_bf16 a[232:235], v[104:107], v[164:167], 0
buffer_load_dwordx4 v180, s[8:11], s20 offen offset:0 lds
v_mfma_f32_16x16x32_bf16 a[236:239], v[108:111], v[164:167], 0
TR 164,201,16384
TR 166,201,18432
v_mfma_f32_16x16x32_bf16 a[48:51], v[80:83], v[168:171], 0
v_mfma_f32_16x16x32_bf16 a[52:55], v[84:87], v[168:171], 0
buffer_load_dwordx4 v181, s[8:11], s20 offen offset:1024 lds
v_mfma_f32_16x16x32_bf16 a[112:115], v[88:91], v[168:171], 0
v_mfma_f32_16x16x32_bf16 a[116:119], v[92:95], v[168:171], 0
buffer_load_dwordx4 v182, s[8:11], s20 offen offset:2048 lds
v_mfma_f32_16x16x32_bf16 a[176:179], v[96:99], v[168:171], 0
v_mfma_f32_16x16x32_bf16 a[180:183], v[100:103], v[168:171], 0
v_mfma_f32_16x16x32_bf16 a[240:243], v[104:107], v[168:171], 0
buffer_load_dwordx4 v183, s[8:11], s20 offen offset:3072 lds
v_mfma_f32_16x16x32_bf16 a[244:247], v[108:111], v[168:171], 0
TR 168,202,16384
TR 170,202,18432
s_waitcnt lgkmcnt(15)
v_mfma_f32_16x16x32_bf16 a[56:59], v[80:83], v[172:175], 0
s_add_u32 s20, s20, 128
v_mfma_f32_16x16x32_bf16 a[60:63], v[84:87], v[172:175], 0
v_mfma_f32_16x16x32_bf16 a[120:123], v[88:91], v[172:175], 0
v_mfma_f32_16x16x32_bf16 a[124:127], v[92:95], v[172:175], 0
s_and_b32 s20, s20, 1023
v_mfma_f32_16x16x32_bf16 a[184:187], v[96:99], v[172:175], 0
v_mfma_f32_16x16x32_bf16 a[188:191], v[100:103], v[172:175], 0
v_mfma_f32_16x16x32_bf16 a[248:251], v[104:107], v[172:175], 0
v_mfma_f32_16x16x32_bf16 a[252:255], v[108:111], v[172:175], 0
TR 172,203,16384
TR 174,203,18432
s_waitcnt lgkmcnt(2)
MA 0,v,112,v,144
s_add_u32 m0, s22, 65536
MA 4,v,116,v,144
MA 64,v,120,v,144
MA 68,v,124,v,144
buffer_load_dwordx4 v176, s[8:11], s20 offen offset:0 lds
MA 128,v,128,v,144
MA 132,v,132,v,144
MA 192,v,136,v,144
MA 196,v,140,v,144
buffer_load_dwordx4 v177, s[8:11], s20 offen offset:1024 lds
MA 8,v,112,v,148
MA 12,v,116,v,148
MA 72,v,120,v,148
buffer_load_dwordx4 v178, s[8:11], s20 offen offset:2048 lds
MA 76,v,124,v,148
MA 136,v,128,v,148
MA 140,v,132,v,148
MA 200,v,136,v,148
buffer_load_dwordx4 v179, s[8:11], s20 offen offset:3072 lds
MA 204,v,140,v,148
MA 16,v,112,v,152
MA 20,v,116,v,152
s_add_u32 m0, s22, 69632
MA 80,v,120,v,152
MA 84,v,124,v,152
MA 144,v,128,v,152
MA 148,v,132,v,152
buffer_load_dwordx4 v180, s[8:11], s20 offen offset:0 lds
MA 208,v,136,v,152
MA 212,v,140,v,152
MA 24,v,112,v,156
MA 28,v,116,v,156
buffer_load_dwordx4 v181, s[8:11], s20 offen offset:1024 lds
MA 88,v,120,v,156
MA 92,v,124,v,156
MA 152,v,128,v,156
buffer_load_dwordx4 v182, s[8:11], s20 offen offset:2048 lds
MA 156,v,132,v,156
MA 216,v,136,v,156
MA 220,v,140,v,156
MA 32,v,112,v,160
buffer_load_dwordx4 v183, s[8:11], s20 offen offset:3072 lds
MA 36,v,116,v,160
MA 96,v,120,v,160
MA 100,v,124,v,160
s_add_u32 s20, s20, 128
MA 160,v,128,v,160
MA 164,v,132,v,160
MA 224,v,136,v,160
MA 228,v,140,v,160
s_and_b32 s20, s20, 1023
MA 40,v,112,v,164
MA 44,v,116,v,164
MA 104,v,120,v,164
MA 108,v,124,v,164
MA 168,v,128,v,164
s_waitcnt vmcnt(8) lgkmcnt(0)
s_barrier
MA 172,v,132,v,164
TR 144,196,32768
TR 146,196,34816
MA 232,v,136,v,164
ds_read_b128 v[80:83], v192 offset:32768
s_add_u32 m0, s23, 0
MA 236,v,140,v,164
TR 148,197,32768
TR 150,197,34816
MA 48,v,112,v,168
ds_read_b128 v[84:87], v192 offset:34816
ds_read_b128 v[88:91], v192 offset:36864
MA 52,v,116,v,168
TR 152,198,32768
TR 154,198,34816
MA 112,v,120,v,168
ds_read_b128 v[92:95], v192 offset:38912
ds_read_b128 v[96:99], v192 offset:40960
MA 116,v,124,v,168
TR 156,199,32768
TR 158,199,34816
MA 176,v,128,v,168
ds_read_b128 v[100:103], v192 offset:43008
ds_read_b128 v[104:107], v192 offset:45056
MA 180,v,132,v,168
TR 160,200,32768
TR 162,200,34816
MA 240,v,136,v,168
ds_read_b128 v[108:111], v192 offset:47104
buffer_load_dwordx4 v184, s[12:15], s21 offen offset:0 lds
MA 244,v,140,v,168
TR 164,201,32768
TR 166,201,34816
MA 56,v,112,v,172
buffer_load_dwordx4 v185, s[12:15], s21 offen offset:1024 lds
buffer_load_dwordx4 v186, s[12:15], s21 offen offset:2048 lds
MA 60,v,116,v,172
TR 168,202,32768
TR 170,202,34816
MA 120,v,120,v,172
buffer_load_dwordx4 v187, s[12:15], s21 offen offset:3072 lds
s_add_u32 m0, s23, 4096
MA 124,v,124,v,172
buffer_load_dwordx4 v188, s[12:15], s21 offen offset:0 lds
buffer_load_dwordx4 v189, s[12:15], s21 offen offset:1024 lds
MA 184,v,128,v,172
buffer_load_dwordx4 v190, s[12:15], s21 offen offset:2048 lds
buffer_load_dwordx4 v191, s[12:15], s21 offen offset:3072 lds
MA 188,v,132,v,172
s_add_u32 s21, s21, 524288
s_and_b32 s21, s21, 4194303
MA 248,v,136,v,172
s_load_dwordx2 s[84:85], s[0:1], 8
s_load_dwordx2 s[88:89], s[0:1], 16
MA 252,v,140,v,172
TR 172,203,32768
TR 174,203,34816
s_load_dwordx2 s[92:93], s[0:1], 0
s_load_dwordx2 s[96:97], s[0:1], 24
s_load_dwordx2 s[76:77], s[0:1], 96
s_waitcnt lgkmcnt(2)
MA 0,v,80,v,144
s_add_u32 m0, s22, 0
MA 4,v,84,v,144
ds_read_b128 v[112:115], v193 offset:32768
MA 64,v,88,v,144
s_mov_b32 s4, s34
s_mov_b32 s5, s35
MA 68,v,92,v,144
MA 128,v,96,v,144
MA 132,v,100,v,144
buffer_load_dwordx4 v176, s[8:11], s20 offen offset:0 lds
MA 192,v,104,v,144
MA 196,v,108,v,144
TR 144,196,49152
TR 146,196,51200
MA 8,v,80,v,148
ds_read_b128 v[116:119], v193 offset:34816
MA 12,v,84,v,148
s_mov_b32 s6, 8388608
s_mov_b32 s7, 0x20000
MA 72,v,88,v,148
buffer_load_dwordx4 v177, s[8:11], s20 offen offset:1024 lds
MA 76,v,92,v,148
MA 136,v,96,v,148
MA 140,v,100,v,148
ds_read_b128 v[120:123], v193 offset:36864
MA 200,v,104,v,148
MA 204,v,108,v,148
TR 148,197,49152
TR 150,197,51200
MA 16,v,80,v,152
buffer_load_dwordx4 v178, s[8:11], s20 offen offset:2048 lds
s_lshr_b32 s43, s2, 3
MA 20,v,84,v,152
MA 80,v,88,v,152
MA 84,v,92,v,152
s_lshl_b32 s43, s43, 2
MA 144,v,96,v,152
ds_read_b128 v[124:127], v193 offset:38912
buffer_load_dwordx4 v179, s[8:11], s20 offen offset:3072 lds
MA 148,v,100,v,152
MA 208,v,104,v,152
MA 212,v,108,v,152
TR 152,198,49152
TR 154,198,51200
MA 24,v,80,v,156
s_add_u32 s43, s43, s3
MA 28,v,84,v,156
s_add_u32 m0, s22, 4096
MA 88,v,88,v,156
ds_read_b128 v[128:131], v193 offset:40960
MA 92,v,92,v,156
s_lshl_b32 s43, s43, 16
MA 152,v,96,v,156
MA 156,v,100,v,156
MA 216,v,104,v,156
MA 220,v,108,v,156
TR 156,199,49152
TR 158,199,51200
MA 32,v,80,v,160
ds_read_b128 v[132:135], v193 offset:43008
buffer_load_dwordx4 v180, s[8:11], s20 offen offset:0 lds
MA 36,v,84,v,160
s_and_b32 s37, s2, 7
MA 96,v,88,v,160
s_lshl_b32 s37, s37, 10
MA 100,v,92,v,160
MA 160,v,96,v,160
buffer_load_dwordx4 v181, s[8:11], s20 offen offset:1024 lds
MA 164,v,100,v,160
MA 224,v,104,v,160
s_add_u32 s43, s43, s37
MA 228,v,108,v,160
TR 160,200,49152
TR 162,200,51200
MA 40,v,80,v,164
ds_read_b128 v[136:139], v193 offset:45056
MA 44,v,84,v,164
buffer_load_dwordx4 v182, s[8:11], s20 offen offset:2048 lds
MA 104,v,88,v,164
v_lshrrev_b32 v78, 3, v1
MA 108,v,92,v,164
MA 168,v,96,v,164
MA 172,v,100,v,164
ds_read_b128 v[140:143], v193 offset:47104
MA 232,v,104,v,164
buffer_load_dwordx4 v183, s[8:11], s20 offen offset:3072 lds
v_and_b32 v79, 7, v1
MA 236,v,108,v,164
TR 164,201,49152
TR 166,201,51200
MA 48,v,80,v,168
MA 52,v,84,v,168
MA 112,v,88,v,168
v_lshlrev_b32 v79, 7, v79
MA 116,v,92,v,168
s_add_u32 s20, s20, 128
MA 176,v,96,v,168
MA 180,v,100,v,168
MA 240,v,104,v,168
v_lshl_add_u32 v78, v78, 13, v79
MA 244,v,108,v,168
TR 168,202,49152
TR 170,202,51200
s_waitcnt lgkmcnt(15)
MA 56,v,80,v,172
s_and_b32 s20, s20, 1023
MA 60,v,84,v,172
MA 120,v,88,v,172
v_add_u32 v78, s43, v78
MA 124,v,92,v,172
MA 184,v,96,v,172
MA 188,v,100,v,172
MA 248,v,104,v,172
MA 252,v,108,v,172
TR 172,203,49152
TR 174,203,51200
s_waitcnt lgkmcnt(2)
MA 0,v,112,v,144
MA 4,v,116,v,144
MA 64,v,120,v,144
MA 68,v,124,v,144
MA 128,v,128,v,144
MA 132,v,132,v,144
MA 192,v,136,v,144
MA 196,v,140,v,144
MA 8,v,112,v,148
MA 12,v,116,v,148
s_waitcnt vmcnt(8) lgkmcnt(0)
s_barrier
MA 72,v,120,v,148
TR 144,196,0
TR 146,196,2048
MA 76,v,124,v,148
ds_read_b128 v[80:83], v194 offset:0
s_add_u32 m0, s23, 32768
MA 136,v,128,v,148
s_mov_b32 s86, 4194304
s_mov_b32 s87, 0x20000
MA 140,v,132,v,148
s_mov_b32 s90, 4194304
s_mov_b32 s91, 0x20000
MA 200,v,136,v,148
buffer_load_dwordx4 v184, s[12:15], s21 offen offset:0 lds
MA 204,v,140,v,148
TR 148,197,0
TR 150,197,2048
MA 16,v,112,v,152
ds_read_b128 v[84:87], v194 offset:2048
s_mov_b32 s94, 4194304
MA 20,v,116,v,152
s_mov_b32 s95, 0x20000
s_mov_b32 s98, 8192
MA 80,v,120,v,152
buffer_load_dwordx4 v185, s[12:15], s21 offen offset:1024 lds
s_mov_b32 s99, 0x20000
MA 84,v,124,v,152
MA 144,v,128,v,152
s_mov_b32 s78, 2048
MA 148,v,132,v,152
ds_read_b128 v[88:91], v194 offset:4096
s_mov_b32 s79, 0x20000
MA 208,v,136,v,152
s_and_b32 s36, s2, 15
MA 212,v,140,v,152
TR 152,198,0
TR 154,198,2048
MA 24,v,112,v,156
buffer_load_dwordx4 v186, s[12:15], s21 offen offset:2048 lds
s_lshl_b32 s36, s36, 1
MA 28,v,116,v,156
s_lshr_b32 s37, s3, 1
MA 88,v,120,v,156
ds_read_b128 v[92:95], v194 offset:6144
s_add_u32 s36, s36, s37
MA 92,v,124,v,156
buffer_load_dwordx4 v187, s[12:15], s21 offen offset:3072 lds
s_lshl_b32 s36, s36, 3
MA 152,v,128,v,156
MA 156,v,132,v,156
v_and_b32 v252, 7, v1
MA 216,v,136,v,156
v_add_u32 v252, s36, v252
MA 220,v,140,v,156
TR 156,199,0
TR 158,199,2048
MA 32,v,112,v,160
ds_read_b128 v[96:99], v194 offset:8192
s_add_u32 m0, s23, 36864
MA 36,v,116,v,160
s_lshr_b32 s36, s2, 4
s_lshl_b32 s36, s36, 1
MA 96,v,120,v,160
s_and_b32 s37, s3, 1
MA 100,v,124,v,160
s_add_u32 s36, s36, s37
MA 160,v,128,v,160
ds_read_b128 v[100:103], v194 offset:10240
buffer_load_dwordx4 v188, s[12:15], s21 offen offset:0 lds
MA 164,v,132,v,160
s_lshl_b32 s36, s36, 3
v_lshrrev_b32 v253, 3, v1
MA 224,v,136,v,160
MA 228,v,140,v,160
TR 160,200,0
TR 162,200,2048
MA 40,v,112,v,164
buffer_load_dwordx4 v189, s[12:15], s21 offen offset:1024 lds
v_add_u32 v253, s36, v253
MA 44,v,116,v,164
ds_read_b128 v[104:107], v194 offset:12288
v_lshlrev_b32 v254, 14, v253
MA 104,v,120,v,164
v_lshl_add_u32 v254, v252, 3, v254
v_add_u32 v229, -6144, v254
MA 108,v,124,v,164
MA 168,v,128,v,164
buffer_load_dwordx4 v190, s[12:15], s21 offen offset:2048 lds
v_lshlrev_b32 v62, 5, v252
MA 172,v,132,v,164
v_lshlrev_b32 v254, 4, v253
MA 232,v,136,v,164
ds_read_b128 v[108:111], v194 offset:14336
v_sub_u32 v254, 4080, v254
MA 236,v,140,v,164
TR 164,201,0
TR 166,201,2048
MA 48,v,112,v,168
v_lshl_add_u32 v10, v252, 14, v254
MA 52,v,116,v,168
buffer_load_dwordx4 v191, s[12:15], s21 offen offset:3072 lds
v_and_b32 v252, 31, v1
MA 112,v,120,v,168
v_lshlrev_b32 v64, 4, v252
MA 116,v,124,v,168
s_lshl_b32 s36, s2, 2
MA 176,v,128,v,168
MA 180,v,132,v,168
s_add_u32 s21, s21, 524288
s_add_u32 s36, s36, s3
MA 240,v,136,v,168
s_lshl_b32 s36, s36, 1
MA 244,v,140,v,168
TR 168,202,0
TR 170,202,2048
MA 56,v,112,v,172
v_lshrrev_b32 v253, 5, v1
v_add_u32 v253, s36, v253
MA 60,v,116,v,172
s_and_b32 s21, s21, 4194303
MA 120,v,120,v,172
v_lshl_add_u32 v63, v253, 11, v64
MA 124,v,124,v,172
v_lshlrev_b32 v253, 2, v253
MA 184,v,128,v,172
v_lshl_add_u32 v11, v252, 20, v253
MA 188,v,132,v,172
MA 248,v,136,v,172
MA 252,v,140,v,172
TR 172,203,0
TR 174,203,2048
s_waitcnt lgkmcnt(2)
MA 0,v,80,v,144
s_add_u32 m0, s22, 32768
buffer_load_dwordx4 v[230:233], v63, s[92:95], 0 offen offset:0
MA 4,v,84,v,144
ds_read_b128 v[112:115], v195 offset:0
MA 64,v,88,v,144
MA 68,v,92,v,144
MA 128,v,96,v,144
buffer_load_dwordx4 v[2:5], v64, s[76:79], 0 offen offset:0
MA 132,v,100,v,144
buffer_load_dwordx4 v176, s[8:11], s20 offen offset:0 lds
MA 192,v,104,v,144
MA 196,v,108,v,144
TR 144,196,16384
TR 146,196,18432
MA 8,v,80,v,148
ds_read_b128 v[116:119], v195 offset:2048
MA 12,v,84,v,148
buffer_load_dwordx4 v[234:237], v63, s[92:95], 0 offen offset:512
MA 72,v,88,v,148
buffer_load_dwordx4 v177, s[8:11], s20 offen offset:1024 lds
MA 76,v,92,v,148
MA 136,v,96,v,148
MA 140,v,100,v,148
ds_read_b128 v[120:123], v195 offset:4096
MA 200,v,104,v,148
buffer_load_dwordx4 v[6:9], v64, s[76:79], 0 offen offset:512
MA 204,v,108,v,148
TR 148,197,16384
TR 150,197,18432
MA 16,v,80,v,152
buffer_load_dwordx4 v178, s[8:11], s20 offen offset:2048 lds
MA 20,v,84,v,152
MA 80,v,88,v,152
MA 84,v,92,v,152
buffer_load_dwordx4 v[238:241], v63, s[92:95], 0 offen offset:1024
MA 144,v,96,v,152
ds_read_b128 v[124:127], v195 offset:6144
buffer_load_dwordx4 v179, s[8:11], s20 offen offset:3072 lds
MA 148,v,100,v,152
MA 208,v,104,v,152
MA 212,v,108,v,152
TR 152,198,16384
TR 154,198,18432
MA 24,v,80,v,156
buffer_load_dwordx4 v[12:15], v64, s[76:79], 0 offen offset:1024
MA 28,v,84,v,156
s_add_u32 m0, s22, 36864
MA 88,v,88,v,156
ds_read_b128 v[128:131], v195 offset:8192
MA 92,v,92,v,156
MA 152,v,96,v,156
buffer_load_dwordx4 v[242:245], v63, s[92:95], 0 offen offset:1536
MA 156,v,100,v,156
MA 216,v,104,v,156
MA 220,v,108,v,156
TR 156,199,16384
TR 158,199,18432
MA 32,v,80,v,160
ds_read_b128 v[132:135], v195 offset:10240
buffer_load_dwordx4 v180, s[8:11], s20 offen offset:0 lds
MA 36,v,84,v,160
buffer_load_dwordx4 v[246:249], v64, s[76:79], 0 offen offset:1536
MA 96,v,88,v,160
MA 100,v,92,v,160
MA 160,v,96,v,160
buffer_load_dwordx4 v181, s[8:11], s20 offen offset:1024 lds
MA 164,v,100,v,160
MA 224,v,104,v,160
buffer_load_dwordx4 v[54:57], v62, s[96:99], 0 offen offset:0
MA 228,v,108,v,160
TR 160,200,16384
TR 162,200,18432
MA 40,v,80,v,164
ds_read_b128 v[136:139], v195 offset:12288
MA 44,v,84,v,164
buffer_load_dwordx4 v182, s[8:11], s20 offen offset:2048 lds
MA 104,v,88,v,164
buffer_load_dwordx4 v[58:61], v62, s[96:99], 0 offen offset:16
MA 108,v,92,v,164
MA 168,v,96,v,164
MA 172,v,100,v,164
ds_read_b128 v[140:143], v195 offset:14336
MA 232,v,104,v,164
buffer_load_dwordx4 v183, s[8:11], s20 offen offset:3072 lds
MA 236,v,108,v,164
TR 164,201,16384
TR 166,201,18432
MA 48,v,80,v,168
v_add_u32 v252, 0, v229
MA 52,v,84,v,168
MA 112,v,88,v,168
MA 116,v,92,v,168
s_add_u32 s20, s20, 128
MA 176,v,96,v,168
buffer_load_dwordx2 v[16:17], v252, s[84:87], 0 offen
MA 180,v,100,v,168
MA 240,v,104,v,168
MA 244,v,108,v,168
TR 168,202,16384
TR 170,202,18432
s_waitcnt lgkmcnt(15)
MA 56,v,80,v,172
s_and_b32 s20, s20, 1023
MA 60,v,84,v,172
v_add_u32 v253, 2048, v229
MA 120,v,88,v,172
MA 124,v,92,v,172
MA 184,v,96,v,172
MA 188,v,100,v,172
MA 248,v,104,v,172
MA 252,v,108,v,172
TR 172,203,16384
TR 174,203,18432
s_waitcnt lgkmcnt(2)
MA 0,v,112,v,144
MA 4,v,116,v,144
MA 64,v,120,v,144
MA 68,v,124,v,144
MA 128,v,128,v,144
MA 132,v,132,v,144
MA 192,v,136,v,144
MA 196,v,140,v,144
MA 8,v,112,v,148
MA 12,v,116,v,148
s_waitcnt vmcnt(19) lgkmcnt(0)
s_barrier
MA 72,v,120,v,148
TR 144,196,32768
TR 146,196,34816
MA 76,v,124,v,148
ds_read_b128 v[80:83], v192 offset:0
s_add_u32 m0, s23, 0
MA 136,v,128,v,148
s_bfe_u32 s80, s2, 0x20001
s_bfe_u32 s69, s2, 0x30003
MA 140,v,132,v,148
s_lshl_b32 s80, s80, 3
s_add_u32 s69, s69, s80
MA 200,v,136,v,148
buffer_load_dwordx4 v184, s[12:15], s21 offen offset:0 lds
s_lshr_b32 s80, s2, 6
MA 204,v,140,v,148
TR 148,197,32768
TR 150,197,34816
MA 16,v,112,v,152
ds_read_b128 v[84:87], v192 offset:2048
s_xor_b32 s81, s80, s2
MA 20,v,116,v,152
s_and_b32 s81, s81, 1
s_lshl_b32 s70, s80, 1
MA 80,v,120,v,152
buffer_load_dwordx4 v185, s[12:15], s21 offen offset:1024 lds
s_add_u32 s70, s70, s81
MA 84,v,124,v,152
s_lshl_b32 s80, s3, 1
s_sub_u32 s80, 7, s80
MA 144,v,128,v,152
s_lshl_b32 s76, s80, 17
s_lshl_b32 s80, s3, 15
MA 148,v,132,v,152
ds_read_b128 v[88:91], v192 offset:4096
s_lshl_b32 s65, s70, 18
MA 208,v,136,v,152
s_sub_u32 s64, 3932160, s65
MA 212,v,140,v,152
TR 152,198,32768
TR 154,198,34816
MA 24,v,112,v,156
buffer_load_dwordx4 v186, s[12:15], s21 offen offset:2048 lds
s_add_u32 s65, s65, s80
MA 28,v,116,v,156
s_add_u32 s64, s64, s80
s_lshl_b32 s81, s69, 12
MA 88,v,120,v,156
ds_read_b128 v[92:95], v192 offset:6144
s_lshl_b32 s100, s64, 2
MA 92,v,124,v,156
buffer_load_dwordx4 v187, s[12:15], s21 offen offset:3072 lds
s_add_u32 s100, s100, s81
MA 152,v,128,v,156
s_lshl_b32 s101, s65, 2
MA 156,v,132,v,156
s_add_u32 s101, s101, s81
MA 216,v,136,v,156
s_lshl_b32 s66, s3, 17
s_lshl_b32 s81, s69, 8
MA 220,v,140,v,156
TR 156,199,32768
TR 158,199,34816
MA 32,v,112,v,160
ds_read_b128 v[96:99], v192 offset:8192
s_add_u32 m0, s23, 4096
MA 36,v,116,v,160
s_add_u32 s66, s66, s81
s_and_b32 s74, s2, 7
MA 96,v,120,v,160
s_lshl_b32 s74, s74, 8
s_mov_b32 s82, s66
MA 100,v,124,v,160
s_lshl_b32 s66, s74, 12
MA 160,v,128,v,160
ds_read_b128 v[100:103], v192 offset:10240
buffer_load_dwordx4 v188, s[12:15], s21 offen offset:0 lds
MA 164,v,132,v,160
s_lshl_b32 s67, s3, 13
s_lshl_b32 s68, s3, 12
MA 224,v,136,v,160
s_lshl_b32 s77, s70, 1
MA 228,v,140,v,160
TR 160,200,32768
TR 162,200,34816
MA 40,v,112,v,164
buffer_load_dwordx4 v189, s[12:15], s21 offen offset:1024 lds
s_sub_u32 s77, 32, s77
MA 44,v,116,v,164
ds_read_b128 v[104:107], v192 offset:12288
v_lshrrev_b32 v66, 3, v1
MA 104,v,120,v,164
v_lshlrev_b32 v66, 11, v66
v_lshrrev_b32 v67, 4, v1
MA 108,v,124,v,164
v_and_b32 v68, 7, v1
v_xor_b32 v68, v68, v67
MA 168,v,128,v,164
buffer_load_dwordx4 v190, s[12:15], s21 offen offset:2048 lds
v_lshl_add_u32 v66, v68, 4, v66
MA 172,v,132,v,164
v_xor_b32 v69, 64, v66
MA 232,v,136,v,164
ds_read_b128 v[108:111], v192 offset:14336
s_lshr_b32 s83, s76, 2
MA 236,v,140,v,164
TR 164,201,32768
TR 166,201,34816
MA 48,v,112,v,168
v_add_u32 v208, 0, v66
v_add_u32 v209, 15360, v69
MA 52,v,116,v,168
buffer_load_dwordx4 v191, s[12:15], s21 offen offset:3072 lds
v_add_u32 v210, -2048, v66
MA 112,v,120,v,168
v_add_u32 v210, s83, v210
MA 116,v,124,v,168
v_add_u32 v211, 13312, v69
v_add_u32 v211, s83, v211
MA 176,v,128,v,168
v_and_b32 v68, 15, v1
MA 180,v,132,v,168
s_add_u32 s21, s21, 524288
v_lshlrev_b32 v69, 1, v67
MA 240,v,136,v,168
v_xor_b32 v68, v68, v69
MA 244,v,140,v,168
TR 168,202,32768
TR 170,202,34816
MA 56,v,112,v,172
v_lshlrev_b32 v66, 13, v67
v_xor_b32 v69, 0, v68
MA 60,v,116,v,172
s_and_b32 s21, s21, 4194303
v_lshl_add_u32 v69, v69, 4, v66
MA 120,v,120,v,172
v_add_u32 v212, 0, v69
MA 124,v,124,v,172
v_xor_b32 v69, 0, v68
MA 184,v,128,v,172
v_lshl_add_u32 v69, v69, 4, v66
MA 188,v,132,v,172
v_add_u32 v213, 31744, v69
MA 248,v,136,v,172
MA 252,v,140,v,172
TR 172,203,32768
TR 174,203,34816
s_waitcnt lgkmcnt(2)
MA 0,v,80,v,144
s_add_u32 m0, s22, 65536
buffer_load_dwordx2 v[18:19], v253, s[84:87], 0 offen
MA 4,v,84,v,144
ds_read_b128 v[112:115], v193 offset:0
MA 64,v,88,v,144
MA 68,v,92,v,144
MA 128,v,96,v,144
v_add_u32 v254, 4096, v229
MA 132,v,100,v,144
buffer_load_dwordx4 v176, s[8:11], s20 offen offset:0 lds
MA 192,v,104,v,144
MA 196,v,108,v,144
TR 144,196,49152
TR 146,196,51200
MA 8,v,80,v,148
ds_read_b128 v[116:119], v193 offset:2048
MA 12,v,84,v,148
buffer_load_dwordx2 v[20:21], v254, s[84:87], 0 offen
MA 72,v,88,v,148
buffer_load_dwordx4 v177, s[8:11], s20 offen offset:1024 lds
MA 76,v,92,v,148
MA 136,v,96,v,148
MA 140,v,100,v,148
ds_read_b128 v[120:123], v193 offset:4096
MA 200,v,104,v,148
v_add_u32 v255, 6144, v229
MA 204,v,108,v,148
TR 148,197,49152
TR 150,197,51200
MA 16,v,80,v,152
buffer_load_dwordx4 v178, s[8:11], s20 offen offset:2048 lds
MA 20,v,84,v,152
MA 80,v,88,v,152
MA 84,v,92,v,152
buffer_load_dwordx2 v[22:23], v255, s[84:87], 0 offen
MA 144,v,96,v,152
ds_read_b128 v[124:127], v193 offset:6144
buffer_load_dwordx4 v179, s[8:11], s20 offen offset:3072 lds
MA 148,v,100,v,152
MA 208,v,104,v,152
MA 212,v,108,v,152
TR 152,198,49152
TR 154,198,51200
MA 24,v,80,v,156
buffer_load_dwordx2 v[38:39], v255, s[88:91], 0 offen
MA 28,v,84,v,156
s_add_u32 m0, s22, 69632
MA 88,v,88,v,156
ds_read_b128 v[128:131], v193 offset:8192
MA 92,v,92,v,156
MA 152,v,96,v,156
v_add_u32 v252, 8192, v229
MA 156,v,100,v,156
MA 216,v,104,v,156
MA 220,v,108,v,156
TR 156,199,49152
TR 158,199,51200
MA 32,v,80,v,160
ds_read_b128 v[132:135], v193 offset:10240
buffer_load_dwordx4 v180, s[8:11], s20 offen offset:0 lds
MA 36,v,84,v,160
buffer_load_dwordx2 v[24:25], v252, s[84:87], 0 offen
MA 96,v,88,v,160
MA 100,v,92,v,160
MA 160,v,96,v,160
buffer_load_dwordx4 v181, s[8:11], s20 offen offset:1024 lds
MA 164,v,100,v,160
MA 224,v,104,v,160
buffer_load_dwordx2 v[40:41], v252, s[88:91], 0 offen
MA 228,v,108,v,160
TR 160,200,49152
TR 162,200,51200
MA 40,v,80,v,164
ds_read_b128 v[136:139], v193 offset:12288
MA 44,v,84,v,164
buffer_load_dwordx4 v182, s[8:11], s20 offen offset:2048 lds
MA 104,v,88,v,164
v_add_u32 v253, 10240, v229
MA 108,v,92,v,164
MA 168,v,96,v,164
MA 172,v,100,v,164
ds_read_b128 v[140:143], v193 offset:14336
MA 232,v,104,v,164
buffer_load_dwordx4 v183, s[8:11], s20 offen offset:3072 lds
MA 236,v,108,v,164
TR 164,201,49152
TR 166,201,51200
MA 48,v,80,v,168
buffer_load_dwordx2 v[26:27], v253, s[84:87], 0 offen
MA 52,v,84,v,168
MA 112,v,88,v,168
MA 116,v,92,v,168
s_add_u32 s20, s20, 128
MA 176,v,96,v,168
buffer_load_dwordx2 v[42:43], v253, s[88:91], 0 offen
MA 180,v,100,v,168
MA 240,v,104,v,168
MA 244,v,108,v,168
TR 168,202,49152
TR 170,202,51200
s_waitcnt lgkmcnt(15)
MA 56,v,80,v,172
s_and_b32 s20, s20, 1023
MA 60,v,84,v,172
v_add_u32 v254, 12288, v229
MA 120,v,88,v,172
MA 124,v,92,v,172
MA 184,v,96,v,172
MA 188,v,100,v,172
MA 248,v,104,v,172
MA 252,v,108,v,172
TR 172,203,49152
TR 174,203,51200
s_waitcnt lgkmcnt(2)
MA 0,v,112,v,144
MA 4,v,116,v,144
MA 64,v,120,v,144
MA 68,v,124,v,144
MA 128,v,128,v,144
MA 132,v,132,v,144
MA 192,v,136,v,144
MA 196,v,140,v,144
MA 8,v,112,v,148
MA 12,v,116,v,148
s_waitcnt vmcnt(16) lgkmcnt(0)
s_barrier
MA 72,v,120,v,148
TR 144,196,0
TR 146,196,2048
MA 76,v,124,v,148
ds_read_b128 v[80:83], v192 offset:32768
s_add_u32 m0, s23, 32768
MA 136,v,128,v,148
v_xor_b32 v69, 8, v68
v_lshl_add_u32 v69, v69, 4, v66
MA 140,v,132,v,148
v_add_u32 v214, 63488, v69
v_xor_b32 v69, 8, v68
MA 200,v,136,v,148
buffer_load_dwordx4 v184, s[12:15], s21 offen offset:0 lds
v_lshl_add_u32 v69, v69, 4, v66
MA 204,v,140,v,148
TR 148,197,0
TR 150,197,2048
MA 16,v,112,v,152
ds_read_b128 v[84:87], v192 offset:34816
v_add_u32 v215, 95232, v69
MA 20,v,116,v,152
v_and_b32 v66, 15, v1
v_lshrrev_b32 v68, 1, v66
MA 80,v,120,v,152
buffer_load_dwordx4 v185, s[12:15], s21 offen offset:1024 lds
v_xor_b32 v68, v68, v67
MA 84,v,124,v,152
v_lshlrev_b32 v68, 4, v68
v_lshl_add_u32 v68, v66, 7, v68
MA 144,v,128,v,152
v_add_u32 v224, s67, v68
v_xor_b32 v225, 64, v224
MA 148,v,132,v,152
ds_read_b128 v[88:91], v192 offset:36864
v_add_u32 v226, 0x10000, v224
MA 208,v,136,v,152
v_add_u32 v227, 0x10000, v225
v_bfe_u32 v66, v1, 2, 2
MA 212,v,140,v,152
TR 152,198,0
TR 154,198,2048
MA 24,v,112,v,156
buffer_load_dwordx4 v186, s[12:15], s21 offen offset:2048 lds
v_and_b32 v68, 1, v67
MA 28,v,116,v,156
v_lshl_or_b32 v68, v68, 2, v66
v_lshl_add_u32 v66, v67, 3, v66
MA 88,v,120,v,156
ds_read_b128 v[92:95], v192 offset:38912
v_lshlrev_b32 v66, 8, v66
MA 92,v,124,v,156
buffer_load_dwordx4 v187, s[12:15], s21 offen offset:3072 lds
v_and_b32 v69, 3, v1
MA 152,v,128,v,156
v_lshl_add_u32 v66, v69, 3, v66
v_add_u32 v66, 98304, v66
MA 156,v,132,v,156
v_xor_b32 v69, 0, v68
MA 216,v,136,v,156
v_lshl_add_u32 v216, v69, 5, v66
v_xor_b32 v69, 1, v68
MA 220,v,140,v,156
TR 156,199,0
TR 158,199,2048
MA 32,v,112,v,160
ds_read_b128 v[96:99], v192 offset:40960
s_add_u32 m0, s23, 36864
MA 36,v,116,v,160
v_lshl_add_u32 v217, v69, 5, v66
v_xor_b32 v69, 2, v68
MA 96,v,120,v,160
v_lshl_add_u32 v218, v69, 5, v66
v_xor_b32 v69, 3, v68
MA 100,v,124,v,160
v_lshl_add_u32 v219, v69, 5, v66
MA 160,v,128,v,160
ds_read_b128 v[100:103], v192 offset:43008
buffer_load_dwordx4 v188, s[12:15], s21 offen offset:0 lds
MA 164,v,132,v,160
v_xor_b32 v69, 4, v68
v_lshl_add_u32 v220, v69, 5, v66
MA 224,v,136,v,160
v_xor_b32 v69, 5, v68
v_lshl_add_u32 v221, v69, 5, v66
MA 228,v,140,v,160
TR 160,200,0
TR 162,200,2048
MA 40,v,112,v,164
buffer_load_dwordx4 v189, s[12:15], s21 offen offset:1024 lds
v_xor_b32 v69, 6, v68
MA 44,v,116,v,164
ds_read_b128 v[104:107], v192 offset:45056
v_lshl_add_u32 v222, v69, 5, v66
MA 104,v,120,v,164
v_xor_b32 v69, 7, v68
v_lshl_add_u32 v223, v69, 5, v66
MA 108,v,124,v,164
s_mov_b32 s44, s32
s_mov_b32 s45, s33
MA 168,v,128,v,164
buffer_load_dwordx4 v190, s[12:15], s21 offen offset:2048 lds
s_mov_b32 s46, 4194304
MA 172,v,132,v,164
s_mov_b32 s47, 0x20000
MA 232,v,136,v,164
ds_read_b128 v[108:111], v192 offset:47104
MA 236,v,140,v,164
TR 164,201,0
TR 166,201,2048
MA 48,v,112,v,168
s_add_u32 s48, s34, s82
s_addc_u32 s49, s35, 0
MA 52,v,116,v,168
buffer_load_dwordx4 v191, s[12:15], s21 offen offset:3072 lds
s_sub_u32 s50, 8388608, s82
MA 112,v,120,v,168
s_mov_b32 s51, 0x20000
MA 116,v,124,v,168
s_add_u32 s60, s40, 33554432
s_addc_u32 s61, s41, 0
MA 176,v,128,v,168
s_mov_b32 s62, 16777216
s_mov_b32 s63, 0x20000
MA 180,v,132,v,168
s_add_u32 s21, s21, 524288
s_lshl_b32 s80, s69, 19
MA 240,v,136,v,168
s_add_u32 s52, s40, s80
s_addc_u32 s53, s41, 0
MA 244,v,140,v,168
TR 168,202,0
TR 170,202,2048
MA 56,v,112,v,172
s_lshl_b32 s54, s77, 14
s_mov_b32 s55, 0x20000
MA 60,v,116,v,172
s_and_b32 s21, s21, 4194303
s_add_u32 s80, s80, 16760832
MA 120,v,120,v,172
s_add_u32 s56, s40, s80
s_addc_u32 s57, s41, 0
MA 124,v,124,v,172
s_add_u32 s58, s54, 16384
MA 184,v,128,v,172
s_mov_b32 s59, 0x20000
MA 188,v,132,v,172
s_load_dwordx2 s[38:39], s[0:1], 112
MA 248,v,136,v,172
MA 252,v,140,v,172
TR 172,203,0
TR 174,203,2048
s_waitcnt lgkmcnt(2)
MA 0,v,80,v,144
s_add_u32 m0, s22, 0
buffer_load_dwordx2 v[28:29], v254, s[84:87], 0 offen
MA 4,v,84,v,144
ds_read_b128 v[112:115], v193 offset:32768
MA 64,v,88,v,144
MA 68,v,92,v,144
MA 128,v,96,v,144
buffer_load_dwordx2 v[44:45], v254, s[88:91], 0 offen
MA 132,v,100,v,144
buffer_load_dwordx4 v176, s[8:11], s20 offen offset:0 lds
MA 192,v,104,v,144
MA 196,v,108,v,144
TR 144,196,16384
TR 146,196,18432
MA 8,v,80,v,148
ds_read_b128 v[116:119], v193 offset:34816
v_add_u32 v255, 14336, v229
MA 12,v,84,v,148
MA 72,v,88,v,148
buffer_load_dwordx4 v177, s[8:11], s20 offen offset:1024 lds
MA 76,v,92,v,148
MA 136,v,96,v,148
MA 140,v,100,v,148
ds_read_b128 v[120:123], v193 offset:36864
buffer_load_dwordx2 v[30:31], v255, s[84:87], 0 offen
MA 200,v,104,v,148
MA 204,v,108,v,148
TR 148,197,16384
TR 150,197,18432
MA 16,v,80,v,152
buffer_load_dwordx4 v178, s[8:11], s20 offen offset:2048 lds
MA 20,v,84,v,152
buffer_load_dwordx2 v[46:47], v255, s[88:91], 0 offen
MA 80,v,88,v,152
MA 84,v,92,v,152
MA 144,v,96,v,152
ds_read_b128 v[124:127], v193 offset:38912
buffer_load_dwordx4 v179, s[8:11], s20 offen offset:3072 lds
MA 148,v,100,v,152
MA 208,v,104,v,152
v_add_u32 v252, 16384, v229
MA 212,v,108,v,152
TR 152,198,16384
TR 154,198,18432
MA 24,v,80,v,156
MA 28,v,84,v,156
s_add_u32 m0, s22, 4096
MA 88,v,88,v,156
ds_read_b128 v[128:131], v193 offset:40960
buffer_load_dwordx2 v[32:33], v252, s[84:87], 0 offen
MA 92,v,92,v,156
MA 152,v,96,v,156
MA 156,v,100,v,156
MA 216,v,104,v,156
MA 220,v,108,v,156
TR 156,199,16384
TR 158,199,18432
MA 32,v,80,v,160
ds_read_b128 v[132:135], v193 offset:43008
buffer_load_dwordx4 v180, s[8:11], s20 offen offset:0 lds
MA 36,v,84,v,160
buffer_load_dwordx2 v[48:49], v252, s[88:91], 0 offen
MA 96,v,88,v,160
MA 100,v,92,v,160
v_add_u32 v253, 18432, v229
MA 160,v,96,v,160
buffer_load_dwordx4 v181, s[8:11], s20 offen offset:1024 lds
MA 164,v,100,v,160
MA 224,v,104,v,160
MA 228,v,108,v,160
TR 160,200,16384
TR 162,200,18432
MA 40,v,80,v,164
ds_read_b128 v[136:139], v193 offset:45056
buffer_load_dwordx2 v[34:35], v253, s[84:87], 0 offen
MA 44,v,84,v,164
buffer_load_dwordx4 v182, s[8:11], s20 offen offset:2048 lds
MA 104,v,88,v,164
MA 108,v,92,v,164
MA 168,v,96,v,164
buffer_load_dwordx2 v[50:51], v253, s[88:91], 0 offen
MA 172,v,100,v,164
ds_read_b128 v[140:143], v193 offset:47104
MA 232,v,104,v,164
buffer_load_dwordx4 v183, s[8:11], s20 offen offset:3072 lds
MA 236,v,108,v,164
TR 164,201,16384
TR 166,201,18432
MA 48,v,80,v,168
v_add_u32 v254, 20480, v229
MA 52,v,84,v,168
MA 112,v,88,v,168
MA 116,v,92,v,168
s_add_u32 s20, s20, 128
MA 176,v,96,v,168
MA 180,v,100,v,168
buffer_load_dwordx2 v[36:37], v254, s[84:87], 0 offen
MA 240,v,104,v,168
MA 244,v,108,v,168
TR 168,202,16384
TR 170,202,18432
s_waitcnt lgkmcnt(15)
MA 56,v,80,v,172
s_and_b32 s20, s20, 1023
MA 60,v,84,v,172
buffer_load_dwordx2 v[52:53], v254, s[88:91], 0 offen
MA 120,v,88,v,172
MA 124,v,92,v,172
MA 184,v,96,v,172
MA 188,v,100,v,172
MA 248,v,104,v,172
MA 252,v,108,v,172
TR 172,203,16384
TR 174,203,18432
s_waitcnt lgkmcnt(2)
MA 0,v,112,v,144
MA 4,v,116,v,144
MA 64,v,120,v,144
MA 68,v,124,v,144
MA 128,v,128,v,144
MA 132,v,132,v,144
MA 192,v,136,v,144
MA 196,v,140,v,144
MA 8,v,112,v,148
MA 12,v,116,v,148
s_waitcnt vmcnt(18) lgkmcnt(0)
s_barrier
MA 72,v,120,v,148
TR 144,196,32768
TR 146,196,34816
MA 76,v,124,v,148
ds_read_b128 v[80:83], v194 offset:0
s_add_u32 m0, s23, 0
MA 136,v,128,v,148
s_and_b32 s37, s3, 3
MA 140,v,132,v,148
s_cmp_eq_u32 s37, 0
s_cselect_b32 s37, 0, 0x40000000
MA 200,v,136,v,148
buffer_load_dwordx4 v184, s[12:15], s21 offen offset:0 lds
MA 204,v,140,v,148
TR 148,197,32768
TR 150,197,34816
MA 16,v,112,v,152
ds_read_b128 v[84:87], v194 offset:2048
v_add_u32 v229, s37, v78
MA 20,v,116,v,152
MA 80,v,120,v,152
buffer_load_dwordx4 v185, s[12:15], s21 offen offset:1024 lds
MA 84,v,124,v,152
buffer_load_dword v79, v229, s[4:7], 0 offen
MA 144,v,128,v,152
MA 148,v,132,v,152
ds_read_b128 v[88:91], v194 offset:4096
s_getpc_b64 s[82:83]
L_ct_fV:
MA 208,v,136,v,152
MA 212,v,140,v,152
TR 152,198,32768
TR 154,198,34816
MA 24,v,112,v,156
buffer_load_dwordx4 v186, s[12:15], s21 offen offset:2048 lds
MA 28,v,116,v,156
s_add_u32 s82, s82, L_p2 - L_ct_fV
s_addc_u32 s83, s83, 0
MA 88,v,120,v,156
ds_read_b128 v[92:95], v194 offset:6144
MA 92,v,124,v,156
buffer_load_dwordx4 v187, s[12:15], s21 offen offset:3072 lds
MA 152,v,128,v,156
v_mov_b32 v67, s83
MA 156,v,132,v,156
MA 216,v,136,v,156
v_mov_b32 v66, s82
MA 220,v,140,v,156
TR 156,199,32768
TR 158,199,34816
MA 32,v,112,v,160
ds_read_b128 v[96:99], v194 offset:8192
s_add_u32 m0, s23, 4096
MA 36,v,116,v,160
s_lshr_b32 s82, s2, 3
MA 96,v,120,v,160
s_lshl_b32 s82, s82, 2
MA 100,v,124,v,160
MA 160,v,128,v,160
ds_read_b128 v[100:103], v194 offset:10240
buffer_load_dwordx4 v188, s[12:15], s21 offen offset:0 lds
MA 164,v,132,v,160
s_add_u32 s82, s82, s3
MA 224,v,136,v,160
MA 228,v,140,v,160
TR 160,200,32768
TR 162,200,34816
MA 40,v,112,v,164
buffer_load_dwordx4 v189, s[12:15], s21 offen offset:1024 lds
s_lshl_b32 s82, s82, 7
MA 44,v,116,v,164
ds_read_b128 v[104:107], v194 offset:12288
v_and_b32 v68, 3, v1
MA 104,v,120,v,164
MA 108,v,124,v,164
v_lshlrev_b32 v68, 14, v68
MA 168,v,128,v,164
buffer_load_dwordx4 v190, s[12:15], s21 offen offset:2048 lds
MA 172,v,132,v,164
MA 232,v,136,v,164
ds_read_b128 v[108:111], v194 offset:14336
v_add_u32 v68, s82, v68
MA 236,v,140,v,164
TR 164,201,32768
TR 166,201,34816
MA 48,v,112,v,168
v_min_u32 v68, L_p3_begin - L_p2 - 4, v68
MA 52,v,116,v,168
buffer_load_dwordx4 v191, s[12:15], s21 offen offset:3072 lds
MA 112,v,120,v,168
v_add_co_u32 v66, vcc, v66, v68
s_nop 1
v_addc_co_u32 v67, vcc, 0, v67, vcc
MA 116,v,124,v,168
MA 176,v,128,v,168
MA 180,v,132,v,168
s_add_u32 s21, s21, 524288
MA 240,v,136,v,168
MA 244,v,140,v,168
TR 168,202,32768
TR 170,202,34816
MA 56,v,112,v,172
MA 60,v,116,v,172
s_and_b32 s21, s21, 4194303
MA 120,v,120,v,172
MA 124,v,124,v,172
global_load_dword v68, v[66:67], off
MA 184,v,128,v,172
MA 188,v,132,v,172
MA 248,v,136,v,172
MA 252,v,140,v,172
TR 172,203,32768
TR 174,203,34816
s_waitcnt lgkmcnt(2)
MA 0,v,80,v,144
s_add_u32 m0, s22, 32768
s_and_b32 s37, s3, 3
MA 4,v,84,v,144
ds_read_b128 v[112:115], v195 offset:0
MA 64,v,88,v,144
MA 68,v,92,v,144
MA 128,v,96,v,144
MA 132,v,100,v,144
buffer_load_dwordx4 v176, s[8:11], s20 offen offset:0 lds
MA 192,v,104,v,144
MA 196,v,108,v,144
TR 144,196,49152
TR 146,196,51200
MA 8,v,80,v,148
ds_read_b128 v[116:119], v195 offset:2048
MA 12,v,84,v,148
MA 72,v,88,v,148
buffer_load_dwordx4 v177, s[8:11], s20 offen offset:1024 lds
MA 76,v,92,v,148
MA 136,v,96,v,148
s_cmp_eq_u32 s37, 1
s_cselect_b32 s37, 0, 0x40000000
MA 140,v,100,v,148
ds_read_b128 v[120:123], v195 offset:4096
MA 200,v,104,v,148
MA 204,v,108,v,148
TR 148,197,49152
TR 150,197,51200
MA 16,v,80,v,152
buffer_load_dwordx4 v178, s[8:11], s20 offen offset:2048 lds
MA 20,v,84,v,152
MA 80,v,88,v,152
MA 84,v,92,v,152
MA 144,v,96,v,152
ds_read_b128 v[124:127], v195 offset:6144
buffer_load_dwordx4 v179, s[8:11], s20 offen offset:3072 lds
MA 148,v,100,v,152
MA 208,v,104,v,152
MA 212,v,108,v,152
TR 152,198,49152
TR 154,198,51200
MA 24,v,80,v,156
MA 28,v,84,v,156
s_add_u32 m0, s22, 36864
MA 88,v,88,v,156
ds_read_b128 v[128:131], v195 offset:8192
MA 92,v,92,v,156
MA 152,v,96,v,156
MA 156,v,100,v,156
MA 216,v,104,v,156
MA 220,v,108,v,156
TR 156,199,49152
TR 158,199,51200
MA 32,v,80,v,160
ds_read_b128 v[132:135], v195 offset:10240
buffer_load_dwordx4 v180, s[8:11], s20 offen offset:0 lds
MA 36,v,84,v,160
MA 96,v,88,v,160
MA 100,v,92,v,160
MA 160,v,96,v,160
buffer_load_dwordx4 v181, s[8:11], s20 offen offset:1024 lds
MA 164,v,100,v,160
v_add_u32 v229, s37, v78
MA 224,v,104,v,160
MA 228,v,108,v,160
TR 160,200,49152
TR 162,200,51200
MA 40,v,80,v,164
ds_read_b128 v[136:139], v195 offset:12288
MA 44,v,84,v,164
buffer_load_dwordx4 v182, s[8:11], s20 offen offset:2048 lds
MA 104,v,88,v,164
MA 108,v,92,v,164
MA 168,v,96,v,164
MA 172,v,100,v,164
ds_read_b128 v[140:143], v195 offset:14336
MA 232,v,104,v,164
buffer_load_dwordx4 v183, s[8:11], s20 offen offset:3072 lds
MA 236,v,108,v,164
TR 164,201,49152
TR 166,201,51200
MA 48,v,80,v,168
MA 52,v,84,v,168
buffer_load_dword v79, v229, s[4:7], 0 offen
MA 112,v,88,v,168
MA 116,v,92,v,168
s_add_u32 s20, s20, 128
MA 176,v,96,v,168
MA 180,v,100,v,168
MA 240,v,104,v,168
MA 244,v,108,v,168
TR 168,202,49152
TR 170,202,51200
s_waitcnt lgkmcnt(15)
MA 56,v,80,v,172
s_and_b32 s20, s20, 1023
MA 60,v,84,v,172
MA 120,v,88,v,172
MA 124,v,92,v,172
MA 184,v,96,v,172
MA 188,v,100,v,172
MA 248,v,104,v,172
MA 252,v,108,v,172
TR 172,203,49152
TR 174,203,51200
s_waitcnt lgkmcnt(2)
MA 0,v,112,v,144
MA 4,v,116,v,144
MA 64,v,120,v,144
MA 68,v,124,v,144
MA 128,v,128,v,144
MA 132,v,132,v,144
MA 192,v,136,v,144
MA 196,v,140,v,144
MA 8,v,112,v,148
MA 12,v,116,v,148
s_waitcnt vmcnt(10) lgkmcnt(0)
s_barrier
MA 72,v,120,v,148
TR 144,196,0
TR 146,196,2048
MA 76,v,124,v,148
ds_read_b128 v[80:83], v192 offset:0
s_add_u32 m0, s23, 32768
MA 136,v,128,v,148
s_and_b32 s37, s3, 3
MA 140,v,132,v,148
s_cmp_eq_u32 s37, 2
s_cselect_b32 s37, 0, 0x40000000
MA 200,v,136,v,148
buffer_load_dwordx4 v184, s[12:15], s21 offen offset:0 lds
v_add_u32 v229, s37, v78
MA 204,v,140,v,148
TR 148,197,0
TR 150,197,2048
MA 16,v,112,v,152
ds_read_b128 v[84:87], v192 offset:2048
buffer_load_dword v79, v229, s[4:7], 0 offen
MA 20,v,116,v,152
s_add_u32 s84, s40, 50331648
s_addc_u32 s85, s41, 0
MA 80,v,120,v,152
buffer_load_dwordx4 v185, s[12:15], s21 offen offset:1024 lds
s_mov_b32 s86, 4194304
MA 84,v,124,v,152
s_mov_b32 s87, 0x20000
MA 144,v,128,v,152
s_add_u32 s88, s40, 58720256
s_addc_u32 s89, s41, 0
MA 148,v,132,v,152
ds_read_b128 v[88:91], v192 offset:4096
s_mov_b32 s90, 8192
MA 208,v,136,v,152
s_mov_b32 s91, 0x20000
v_mov_b32 v252, 0
MA 212,v,140,v,152
TR 152,198,0
TR 154,198,2048
MA 24,v,112,v,156
buffer_load_dwordx4 v186, s[12:15], s21 offen offset:2048 lds
v_mov_b32 v253, 0
MA 28,v,116,v,156
v_dot2_f32_bf16 v252, v230, v2, v252
v_dot2_f32_bf16 v253, v231, v3, v253
MA 88,v,120,v,156
ds_read_b128 v[92:95], v192 offset:6144
v_dot2_f32_bf16 v252, v232, v4, v252
MA 92,v,124,v,156
buffer_load_dwordx4 v187, s[12:15], s21 offen offset:3072 lds
v_dot2_f32_bf16 v253, v233, v5, v253
MA 152,v,128,v,156
v_dot2_f32_bf16 v252, v234, v6, v252
v_dot2_f32_bf16 v253, v235, v7, v253
MA 156,v,132,v,156
v_dot2_f32_bf16 v252, v236, v8, v252
v_dot2_f32_bf16 v253, v237, v9, v253
MA 216,v,136,v,156
v_dot2_f32_bf16 v252, v238, v12, v252
v_dot2_f32_bf16 v253, v239, v13, v253
MA 220,v,140,v,156
TR 156,199,0
TR 158,199,2048
MA 32,v,112,v,160
ds_read_b128 v[96:99], v192 offset:8192
s_add_u32 m0, s23, 36864
MA 36,v,116,v,160
v_dot2_f32_bf16 v252, v240, v14, v252
v_dot2_f32_bf16 v253, v241, v15, v253
MA 96,v,120,v,160
v_dot2_f32_bf16 v252, v242, v246, v252
v_dot2_f32_bf16 v253, v243, v247, v253
MA 100,v,124,v,160
v_dot2_f32_bf16 v252, v244, v248, v252
v_dot2_f32_bf16 v253, v245, v249, v253
MA 160,v,128,v,160
ds_read_b128 v[100:103], v192 offset:10240
buffer_load_dwordx4 v188, s[12:15], s21 offen offset:0 lds
MA 164,v,132,v,160
s_nop 2
v_add_f32 v252, v252, v253
MA 224,v,136,v,160
s_nop 0
v_add_f32_dpp v252, v252, v252 row_ror:8 row_mask:0xf bank_mask:0xf
s_nop 1
v_add_f32_dpp v252, v252, v252 row_ror:4 row_mask:0xf bank_mask:0xf
MA 228,v,140,v,160
TR 160,200,0
TR 162,200,2048
MA 40,v,112,v,164
buffer_load_dwordx4 v189, s[12:15], s21 offen offset:1024 lds
v_add_f32_dpp v252, v252, v252 row_ror:2 row_mask:0xf bank_mask:0xf
MA 44,v,116,v,164
ds_read_b128 v[104:107], v192 offset:12288
v_add_f32_dpp v252, v252, v252 row_ror:1 row_mask:0xf bank_mask:0xf
MA 104,v,120,v,164
v_mov_b32 v253, v252
s_nop 1
v_permlane16_swap_b32 v252, v253
MA 108,v,124,v,164
v_add_f32 v252, v252, v253
v_mul_f32 v252, 0xbfb8aa3b, v252
MA 168,v,128,v,164
buffer_load_dwordx4 v190, s[12:15], s21 offen offset:2048 lds
MA 172,v,132,v,164
v_exp_f32 v252, v252
MA 232,v,136,v,164
ds_read_b128 v[108:111], v192 offset:14336
v_add_f32 v252, 1.0, v252
MA 236,v,140,v,164
TR 164,201,0
TR 166,201,2048
MA 48,v,112,v,168
v_rcp_f32 v252, v252
MA 52,v,116,v,168
buffer_load_dwordx4 v191, s[12:15], s21 offen offset:3072 lds
MA 112,v,120,v,168
s_nop 0
buffer_store_dword v252, v11, s[88:91], 0 offen sc1
MA 116,v,124,v,168
v_lshlrev_b32 v2, 16, v54
v_and_b32 v3, 0xffff0000, v54
MA 176,v,128,v,168
v_lshlrev_b32 v4, 16, v55
v_and_b32 v5, 0xffff0000, v55
MA 180,v,132,v,168
s_add_u32 s21, s21, 524288
v_lshlrev_b32 v6, 16, v56
MA 240,v,136,v,168
v_and_b32 v7, 0xffff0000, v56
v_lshlrev_b32 v8, 16, v57
MA 244,v,140,v,168
TR 168,202,0
TR 170,202,2048
MA 56,v,112,v,172
v_and_b32 v9, 0xffff0000, v57
v_lshlrev_b32 v230, 16, v16
MA 60,v,116,v,172
s_and_b32 s21, s21, 4194303
v_and_b32 v231, 0xffff0000, v16
MA 120,v,120,v,172
v_lshlrev_b32 v232, 16, v18
v_and_b32 v233, 0xffff0000, v18
MA 124,v,124,v,172
v_lshlrev_b32 v234, 16, v20
v_and_b32 v235, 0xffff0000, v20
MA 184,v,128,v,172
v_lshlrev_b32 v236, 16, v22
v_and_b32 v237, 0xffff0000, v22
MA 188,v,132,v,172
v_lshlrev_b32 v238, 16, v24
v_and_b32 v239, 0xffff0000, v24
MA 248,v,136,v,172
v_lshlrev_b32 v240, 16, v26
v_and_b32 v241, 0xffff0000, v26
MA 252,v,140,v,172
TR 172,203,0
TR 174,203,2048
v_lshlrev_b32 v242, 16, v28
v_and_b32 v243, 0xffff0000, v28
v_lshlrev_b32 v244, 16, v30
v_and_b32 v245, 0xffff0000, v30
v_lshlrev_b32 v246, 16, v32
v_and_b32 v247, 0xffff0000, v32
v_lshlrev_b32 v248, 16, v34
v_and_b32 v249, 0xffff0000, v34
v_lshlrev_b32 v250, 16, v36
v_and_b32 v251, 0xffff0000, v36
v_lshlrev_b32 v254, 16, v38
v_and_b32 v255, 0xffff0000, v38
v_mul_f32 v62, v236, v2
v_mul_f32 v70, v237, v6
v_fmac_f32 v62, v234, v3
v_fmac_f32 v70, v235, v7
v_fmac_f32 v62, v232, v4
v_fmac_f32 v70, v233, v8
v_fmac_f32 v62, v230, v5
v_fmac_f32 v70, v231, v9
v_mul_f32 v62, v62, v254
s_waitcnt lgkmcnt(2)
MA 0,v,80,v,144
s_add_u32 s75, s64, s74
s_and_b32 s37, s3, 3
MA 4,v,84,v,144
ds_read_b128 v[112:115], v193 offset:0
MA 64,v,88,v,144
s_cmp_eq_u32 s37, 3
s_cselect_b32 s37, 0, 0x40000000
MA 68,v,92,v,144
v_add_u32 v229, s37, v78
buffer_load_dword v79, v229, s[4:7], 0 offen
MA 128,v,96,v,144
s_add_u32 m0, s67, 65536
v_mul_f32 v70, v70, v255
MA 132,v,100,v,144
v_lshlrev_b32 v254, 16, v40
v_and_b32 v255, 0xffff0000, v40
MA 192,v,104,v,144
v_mul_f32 v63, v238, v2
v_mul_f32 v71, v239, v6
MA 196,v,108,v,144
TR 144,196,16384
TR 146,196,18432
MA 8,v,80,v,148
ds_read_b128 v[116:119], v193 offset:2048
buffer_load_dwordx4 v208, s[44:47], s75 offen offset:0 lds
MA 12,v,84,v,148
v_fmac_f32 v63, v236, v3
v_fmac_f32 v71, v237, v7
MA 72,v,88,v,148
v_fmac_f32 v63, v234, v4
v_fmac_f32 v71, v235, v8
MA 76,v,92,v,148
v_fmac_f32 v63, v232, v5
v_fmac_f32 v71, v233, v9
MA 136,v,96,v,148
v_mul_f32 v63, v63, v254
v_mul_f32 v71, v71, v255
MA 140,v,100,v,148
ds_read_b128 v[120:123], v193 offset:4096
buffer_load_dwordx4 v209, s[44:47], s75 offen offset:1024 lds
MA 200,v,104,v,148
v_lshlrev_b32 v254, 16, v42
v_and_b32 v255, 0xffff0000, v42
MA 204,v,108,v,148
TR 148,197,16384
TR 150,197,18432
MA 16,v,80,v,152
v_mul_f32 v64, v240, v2
v_mul_f32 v72, v241, v6
MA 20,v,84,v,152
buffer_load_dwordx4 v210, s[44:47], s75 offen offset:2048 lds
v_fmac_f32 v64, v238, v3
MA 80,v,88,v,152
v_fmac_f32 v72, v239, v7
v_fmac_f32 v64, v236, v4
MA 84,v,92,v,152
v_fmac_f32 v72, v237, v8
v_fmac_f32 v64, v234, v5
MA 144,v,96,v,152
ds_read_b128 v[124:127], v193 offset:6144
v_fmac_f32 v72, v235, v9
MA 148,v,100,v,152
v_mul_f32 v64, v64, v254
v_mul_f32 v72, v72, v255
MA 208,v,104,v,152
buffer_load_dwordx4 v211, s[44:47], s75 offen offset:3072 lds
v_lshlrev_b32 v254, 16, v44
MA 212,v,108,v,152
TR 152,198,16384
TR 154,198,18432
MA 24,v,80,v,156
v_and_b32 v255, 0xffff0000, v44
v_mul_f32 v65, v242, v2
MA 28,v,84,v,156
v_mul_f32 v73, v243, v6
v_fmac_f32 v65, v240, v3
MA 88,v,88,v,156
ds_read_b128 v[128:131], v193 offset:8192
s_add_u32 s75, s65, s74
MA 92,v,92,v,156
v_fmac_f32 v73, v241, v7
v_fmac_f32 v65, v238, v4
MA 152,v,96,v,156
v_fmac_f32 v73, v239, v8
v_fmac_f32 v65, v236, v5
MA 156,v,100,v,156
v_fmac_f32 v73, v237, v9
v_mul_f32 v65, v65, v254
MA 216,v,104,v,156
v_mul_f32 v73, v73, v255
MA 220,v,108,v,156
TR 156,199,16384
TR 158,199,18432
MA 32,v,80,v,160
ds_read_b128 v[132:135], v193 offset:10240
s_add_u32 m0, s67, 69632
MA 36,v,84,v,160
v_lshlrev_b32 v254, 16, v46
v_and_b32 v255, 0xffff0000, v46
MA 96,v,88,v,160
v_mul_f32 v66, v244, v2
v_mul_f32 v74, v245, v6
MA 100,v,92,v,160
buffer_load_dwordx4 v208, s[44:47], s75 offen offset:0 lds
v_fmac_f32 v66, v242, v3
MA 160,v,96,v,160
v_fmac_f32 v74, v243, v7
v_fmac_f32 v66, v240, v4
MA 164,v,100,v,160
v_fmac_f32 v74, v241, v8
v_fmac_f32 v66, v238, v5
MA 224,v,104,v,160
v_fmac_f32 v74, v239, v9
v_mul_f32 v66, v66, v254
MA 228,v,108,v,160
TR 160,200,16384
TR 162,200,18432
MA 40,v,80,v,164
ds_read_b128 v[136:139], v193 offset:12288
buffer_load_dwordx4 v209, s[44:47], s75 offen offset:1024 lds
MA 44,v,84,v,164
v_mul_f32 v74, v74, v255
v_lshlrev_b32 v254, 16, v48
MA 104,v,88,v,164
v_and_b32 v255, 0xffff0000, v48
v_mul_f32 v67, v246, v2
MA 108,v,92,v,164
v_mul_f32 v75, v247, v6
v_fmac_f32 v67, v244, v3
MA 168,v,96,v,164
buffer_load_dwordx4 v210, s[44:47], s75 offen offset:2048 lds
v_fmac_f32 v75, v245, v7
MA 172,v,100,v,164
ds_read_b128 v[140:143], v193 offset:14336
v_fmac_f32 v67, v242, v4
MA 232,v,104,v,164
v_fmac_f32 v75, v243, v8
v_fmac_f32 v67, v240, v5
MA 236,v,108,v,164
TR 164,201,16384
TR 166,201,18432
MA 48,v,80,v,168
buffer_load_dwordx4 v211, s[44:47], s75 offen offset:3072 lds
v_fmac_f32 v75, v241, v9
MA 52,v,84,v,168
v_mul_f32 v67, v67, v254
v_mul_f32 v75, v75, v255
MA 112,v,88,v,168
v_lshlrev_b32 v254, 16, v50
v_and_b32 v255, 0xffff0000, v50
MA 116,v,92,v,168
s_waitcnt vmcnt(28)
v_mul_f32 v68, v248, v2
v_mul_f32 v76, v249, v6
MA 176,v,96,v,168
v_fmac_f32 v68, v246, v3
MA 180,v,100,v,168
s_add_u32 s74, s74, 128
v_fmac_f32 v76, v247, v7
MA 240,v,104,v,168
v_fmac_f32 v68, v244, v4
v_fmac_f32 v76, v245, v8
MA 244,v,108,v,168
TR 168,202,16384
TR 170,202,18432
s_waitcnt lgkmcnt(15)
MA 56,v,80,v,172
v_fmac_f32 v68, v242, v5
v_fmac_f32 v76, v243, v9
MA 60,v,84,v,172
s_and_b32 s74, s74, 2047
v_mul_f32 v68, v68, v254
MA 120,v,88,v,172
v_mul_f32 v76, v76, v255
v_lshlrev_b32 v254, 16, v52
MA 124,v,92,v,172
v_and_b32 v255, 0xffff0000, v52
v_mul_f32 v69, v250, v2
MA 184,v,96,v,172
v_mul_f32 v77, v251, v6
MA 188,v,100,v,172
v_fmac_f32 v69, v248, v3
MA 248,v,104,v,172
MA 252,v,108,v,172
TR 172,203,16384
TR 174,203,18432
s_waitcnt lgkmcnt(2)
MA 0,v,112,v,144
MA 4,v,116,v,144
MA 64,v,120,v,144
MA 68,v,124,v,144
MA 128,v,128,v,144
MA 132,v,132,v,144
MA 192,v,136,v,144
MA 196,v,140,v,144
MA 8,v,112,v,148
MA 12,v,116,v,148
s_waitcnt vmcnt(10) lgkmcnt(0)
s_barrier
MA 72,v,120,v,148
TR 144,196,32768
TR 146,196,34816
MA 76,v,124,v,148
ds_read_b128 v[80:83], v192 offset:32768
s_add_u32 m0, s68, 98304
MA 136,v,128,v,148
v_fmac_f32 v77, v249, v7
v_fmac_f32 v69, v246, v4
MA 140,v,132,v,148
buffer_load_dwordx4 v212, s[48:51], s66 offen offset:0 lds
v_fmac_f32 v77, v247, v8
MA 200,v,136,v,148
v_fmac_f32 v69, v244, v5
v_fmac_f32 v77, v245, v9
MA 204,v,140,v,148
TR 148,197,32768
TR 150,197,34816
MA 16,v,112,v,152
ds_read_b128 v[84:87], v192 offset:34816
v_mul_f32 v69, v69, v254
MA 20,v,116,v,152
buffer_load_dwordx4 v213, s[48:51], s66 offen offset:1024 lds
v_mul_f32 v77, v77, v255
MA 80,v,120,v,152
v_cvt_pk_bf16_f32 v12, v69, v68
v_cvt_pk_bf16_f32 v13, v67, v66
MA 84,v,124,v,152
v_cvt_pk_bf16_f32 v14, v65, v64
v_cvt_pk_bf16_f32 v15, v63, v62
MA 144,v,128,v,152
s_mov_b32 s36, 0
buffer_store_dwordx4 v[12:15], v10, s[84:87], s36 offen sc1
MA 148,v,132,v,152
ds_read_b128 v[88:91], v192 offset:36864
buffer_load_dwordx4 v214, s[48:51], s66 offen offset:2048 lds
MA 208,v,136,v,152
v_cvt_pk_bf16_f32 v54, v77, v76
v_cvt_pk_bf16_f32 v55, v75, v74
MA 212,v,140,v,152
TR 152,198,32768
TR 154,198,34816
MA 24,v,112,v,156
buffer_load_dwordx4 v215, s[48:51], s66 offen offset:3072 lds
v_cvt_pk_bf16_f32 v56, v73, v72
MA 28,v,116,v,156
v_cvt_pk_bf16_f32 v57, v71, v70
s_mov_b32 s36, 4096
MA 88,v,120,v,156
ds_read_b128 v[92:95], v192 offset:38912
buffer_store_dwordx4 v[54:57], v10, s[84:87], s36 offen sc1
MA 92,v,124,v,156
v_lshlrev_b32 v2, 16, v58
v_and_b32 v3, 0xffff0000, v58
MA 152,v,128,v,156
s_add_u32 s66, s66, 524288
v_lshlrev_b32 v4, 16, v59
MA 156,v,132,v,156
v_and_b32 v5, 0xffff0000, v59
v_lshlrev_b32 v6, 16, v60
MA 216,v,136,v,156
v_and_b32 v7, 0xffff0000, v60
v_lshlrev_b32 v8, 16, v61
MA 220,v,140,v,156
TR 156,199,32768
TR 158,199,34816
MA 32,v,112,v,160
ds_read_b128 v[96:99], v192 offset:40960
s_and_b32 s66, s66, 8388607
MA 36,v,116,v,160
v_and_b32 v9, 0xffff0000, v61
v_lshlrev_b32 v230, 16, v17
MA 96,v,120,v,160
v_and_b32 v231, 0xffff0000, v17
v_lshlrev_b32 v232, 16, v19
MA 100,v,124,v,160
v_and_b32 v233, 0xffff0000, v19
v_lshlrev_b32 v234, 16, v21
MA 160,v,128,v,160
ds_read_b128 v[100:103], v192 offset:43008
s_add_u32 m0, s68, 114688
MA 164,v,132,v,160
v_and_b32 v235, 0xffff0000, v21
v_lshlrev_b32 v236, 16, v23
MA 224,v,136,v,160
v_and_b32 v237, 0xffff0000, v23
v_lshlrev_b32 v238, 16, v25
MA 228,v,140,v,160
TR 160,200,32768
TR 162,200,34816
MA 40,v,112,v,164
buffer_load_dwordx4 v212, s[48:51], s66 offen offset:0 lds
v_and_b32 v239, 0xffff0000, v25
MA 44,v,116,v,164
ds_read_b128 v[104:107], v192 offset:45056
v_lshlrev_b32 v240, 16, v27
MA 104,v,120,v,164
v_and_b32 v241, 0xffff0000, v27
v_lshlrev_b32 v242, 16, v29
MA 108,v,124,v,164
buffer_load_dwordx4 v213, s[48:51], s66 offen offset:1024 lds
v_and_b32 v243, 0xffff0000, v29
MA 168,v,128,v,164
v_lshlrev_b32 v244, 16, v31
v_and_b32 v245, 0xffff0000, v31
MA 172,v,132,v,164
v_lshlrev_b32 v246, 16, v33
v_and_b32 v247, 0xffff0000, v33
MA 232,v,136,v,164
ds_read_b128 v[108:111], v192 offset:47104
v_lshlrev_b32 v248, 16, v35
MA 236,v,140,v,164
TR 164,201,32768
TR 166,201,34816
MA 48,v,112,v,168
buffer_load_dwordx4 v214, s[48:51], s66 offen offset:2048 lds
v_and_b32 v249, 0xffff0000, v35
MA 52,v,116,v,168
v_lshlrev_b32 v250, 16, v37
v_and_b32 v251, 0xffff0000, v37
MA 112,v,120,v,168
buffer_load_dwordx4 v215, s[48:51], s66 offen offset:3072 lds
v_lshlrev_b32 v254, 16, v39
MA 116,v,124,v,168
v_and_b32 v255, 0xffff0000, v39
v_mul_f32 v62, v236, v2
MA 176,v,128,v,168
v_mul_f32 v70, v237, v6
v_fmac_f32 v62, v234, v3
MA 180,v,132,v,168
v_fmac_f32 v70, v235, v7
v_fmac_f32 v62, v232, v4
MA 240,v,136,v,168
s_add_u32 s66, s66, 524288
v_fmac_f32 v70, v233, v8
MA 244,v,140,v,168
TR 168,202,32768
TR 170,202,34816
MA 56,v,112,v,172
v_fmac_f32 v62, v230, v5
v_fmac_f32 v70, v231, v9
MA 60,v,116,v,172
v_mul_f32 v62, v62, v254
v_mul_f32 v70, v70, v255
MA 120,v,120,v,172
s_and_b32 s66, s66, 8388607
v_lshlrev_b32 v254, 16, v41
MA 124,v,124,v,172
v_and_b32 v255, 0xffff0000, v41
v_mul_f32 v63, v238, v2
MA 184,v,128,v,172
v_mul_f32 v71, v239, v6
v_fmac_f32 v63, v236, v3
MA 188,v,132,v,172
v_fmac_f32 v71, v237, v7
v_fmac_f32 v63, v234, v4
MA 248,v,136,v,172
v_fmac_f32 v71, v235, v8
v_fmac_f32 v63, v232, v5
MA 252,v,140,v,172
TR 172,203,32768
TR 174,203,34816
v_fmac_f32 v71, v233, v9
v_mul_f32 v63, v63, v254
v_mul_f32 v71, v71, v255
v_lshlrev_b32 v254, 16, v43
v_and_b32 v255, 0xffff0000, v43
v_mul_f32 v64, v240, v2
v_mul_f32 v72, v241, v6
v_fmac_f32 v64, v238, v3
s_waitcnt lgkmcnt(2)
MA 0,v,80,v,144
s_add_u32 s75, s64, s74
v_fmac_f32 v72, v239, v7
MA 4,v,84,v,144
ds_read_b128 v[112:115], v193 offset:32768
v_fmac_f32 v64, v236, v4
MA 64,v,88,v,144
v_fmac_f32 v72, v237, v8
v_fmac_f32 v64, v234, v5
MA 68,v,92,v,144
v_fmac_f32 v72, v235, v9
v_mul_f32 v64, v64, v254
MA 128,v,96,v,144
s_add_u32 m0, s67, 0
v_mul_f32 v72, v72, v255
MA 132,v,100,v,144
v_lshlrev_b32 v254, 16, v45
MA 192,v,104,v,144
v_and_b32 v255, 0xffff0000, v45
v_mul_f32 v65, v242, v2
MA 196,v,108,v,144
TR 144,196,49152
TR 146,196,51200
MA 8,v,80,v,148
ds_read_b128 v[116:119], v193 offset:34816
buffer_load_dwordx4 v208, s[44:47], s75 offen offset:0 lds
MA 12,v,84,v,148
v_mul_f32 v73, v243, v6
v_fmac_f32 v65, v240, v3
MA 72,v,88,v,148
v_fmac_f32 v73, v241, v7
v_fmac_f32 v65, v238, v4
MA 76,v,92,v,148
v_fmac_f32 v73, v239, v8
v_fmac_f32 v65, v236, v5
MA 136,v,96,v,148
v_fmac_f32 v73, v237, v9
MA 140,v,100,v,148
ds_read_b128 v[120:123], v193 offset:36864
buffer_load_dwordx4 v209, s[44:47], s75 offen offset:1024 lds
MA 200,v,104,v,148
v_mul_f32 v65, v65, v254
v_mul_f32 v73, v73, v255
MA 204,v,108,v,148
TR 148,197,49152
TR 150,197,51200
MA 16,v,80,v,152
v_lshlrev_b32 v254, 16, v47
v_and_b32 v255, 0xffff0000, v47
MA 20,v,84,v,152
buffer_load_dwordx4 v210, s[44:47], s75 offen offset:2048 lds
v_mul_f32 v66, v244, v2
MA 80,v,88,v,152
v_mul_f32 v74, v245, v6
v_fmac_f32 v66, v242, v3
MA 84,v,92,v,152
v_fmac_f32 v74, v243, v7
v_fmac_f32 v66, v240, v4
MA 144,v,96,v,152
ds_read_b128 v[124:127], v193 offset:38912
v_fmac_f32 v74, v241, v8
MA 148,v,100,v,152
v_fmac_f32 v66, v238, v5
v_fmac_f32 v74, v239, v9
MA 208,v,104,v,152
buffer_load_dwordx4 v211, s[44:47], s75 offen offset:3072 lds
v_mul_f32 v66, v66, v254
MA 212,v,108,v,152
TR 152,198,49152
TR 154,198,51200
MA 24,v,80,v,156
v_mul_f32 v74, v74, v255
v_lshlrev_b32 v254, 16, v49
MA 28,v,84,v,156
v_and_b32 v255, 0xffff0000, v49
v_mul_f32 v67, v246, v2
MA 88,v,88,v,156
ds_read_b128 v[128:131], v193 offset:40960
s_add_u32 s75, s65, s74
MA 92,v,92,v,156
v_mul_f32 v75, v247, v6
v_fmac_f32 v67, v244, v3
MA 152,v,96,v,156
v_fmac_f32 v75, v245, v7
v_fmac_f32 v67, v242, v4
MA 156,v,100,v,156
v_fmac_f32 v75, v243, v8
MA 216,v,104,v,156
v_fmac_f32 v67, v240, v5
MA 220,v,108,v,156
TR 156,199,49152
TR 158,199,51200
MA 32,v,80,v,160
ds_read_b128 v[132:135], v193 offset:43008
s_add_u32 m0, s67, 4096
MA 36,v,84,v,160
v_fmac_f32 v75, v241, v9
v_mul_f32 v67, v67, v254
MA 96,v,88,v,160
v_mul_f32 v75, v75, v255
v_lshlrev_b32 v254, 16, v51
MA 100,v,92,v,160
buffer_load_dwordx4 v208, s[44:47], s75 offen offset:0 lds
v_and_b32 v255, 0xffff0000, v51
MA 160,v,96,v,160
v_mul_f32 v68, v248, v2
v_mul_f32 v76, v249, v6
MA 164,v,100,v,160
v_fmac_f32 v68, v246, v3
v_fmac_f32 v76, v247, v7
MA 224,v,104,v,160
v_fmac_f32 v68, v244, v4
v_fmac_f32 v76, v245, v8
MA 228,v,108,v,160
TR 160,200,49152
TR 162,200,51200
MA 40,v,80,v,164
ds_read_b128 v[136:139], v193 offset:45056
buffer_load_dwordx4 v209, s[44:47], s75 offen offset:1024 lds
MA 44,v,84,v,164
v_fmac_f32 v68, v242, v5
v_fmac_f32 v76, v243, v9
MA 104,v,88,v,164
v_mul_f32 v68, v68, v254
v_mul_f32 v76, v76, v255
MA 108,v,92,v,164
v_lshlrev_b32 v254, 16, v53
v_and_b32 v255, 0xffff0000, v53
MA 168,v,96,v,164
buffer_load_dwordx4 v210, s[44:47], s75 offen offset:2048 lds
v_mul_f32 v69, v250, v2
MA 172,v,100,v,164
ds_read_b128 v[140:143], v193 offset:47104
v_mul_f32 v77, v251, v6
MA 232,v,104,v,164
v_fmac_f32 v69, v248, v3
v_fmac_f32 v77, v249, v7
MA 236,v,108,v,164
TR 164,201,49152
TR 166,201,51200
MA 48,v,80,v,168
buffer_load_dwordx4 v211, s[44:47], s75 offen offset:3072 lds
v_fmac_f32 v69, v246, v4
MA 52,v,84,v,168
v_fmac_f32 v77, v247, v8
v_fmac_f32 v69, v244, v5
MA 112,v,88,v,168
v_fmac_f32 v77, v245, v9
v_mul_f32 v69, v69, v254
MA 116,v,92,v,168
v_mul_f32 v77, v77, v255
v_cvt_pk_bf16_f32 v230, v69, v68
MA 176,v,96,v,168
v_cvt_pk_bf16_f32 v231, v67, v66
MA 180,v,100,v,168
s_add_u32 s74, s74, 128
v_cvt_pk_bf16_f32 v232, v65, v64
MA 240,v,104,v,168
v_cvt_pk_bf16_f32 v233, v63, v62
MA 244,v,108,v,168
TR 168,202,49152
TR 170,202,51200
s_waitcnt lgkmcnt(15)
MA 56,v,80,v,172
s_mov_b32 s36, 8192
buffer_store_dwordx4 v[230:233], v10, s[84:87], s36 offen sc1
MA 60,v,84,v,172
s_and_b32 s74, s74, 2047
v_cvt_pk_bf16_f32 v234, v77, v76
MA 120,v,88,v,172
v_cvt_pk_bf16_f32 v235, v75, v74
v_cvt_pk_bf16_f32 v236, v73, v72
MA 124,v,92,v,172
v_cvt_pk_bf16_f32 v237, v71, v70
s_mov_b32 s36, 12288
MA 184,v,96,v,172
buffer_store_dwordx4 v[234:237], v10, s[84:87], s36 offen sc1
MA 188,v,100,v,172
v_lshlrev_b32 v228, 4, v1
MA 248,v,104,v,172
MA 252,v,108,v,172
TR 172,203,49152
TR 174,203,51200
s_waitcnt lgkmcnt(2)
MA 0,v,112,v,144
MA 4,v,116,v,144
MA 64,v,120,v,144
MA 68,v,124,v,144
MA 128,v,128,v,144
MA 132,v,132,v,144
MA 192,v,136,v,144
MA 196,v,140,v,144
MA 8,v,112,v,148
MA 12,v,116,v,148
s_waitcnt vmcnt(15) lgkmcnt(0)
s_barrier
MA 72,v,120,v,148
ds_read_b128 v[48:51], v226 offset:0
s_add_u32 m0, s68, 131072
MA 76,v,124,v,148
MA 136,v,128,v,148
ds_read_b128 v[52:55], v226 offset:2048
buffer_load_dwordx4 v212, s[48:51], s66 offen offset:0 lds
MA 140,v,132,v,148
MA 200,v,136,v,148
ds_read_b128 v[56:59], v226 offset:4096
buffer_load_dwordx4 v213, s[48:51], s66 offen offset:1024 lds
MA 204,v,140,v,148
MA 16,v,112,v,152
ds_read_b128 v[60:63], v226 offset:6144
MA 20,v,116,v,152
buffer_load_dwordx4 v214, s[48:51], s66 offen offset:2048 lds
MA 80,v,120,v,152
TR 16,216,0
MA 84,v,124,v,152
buffer_load_dwordx4 v215, s[48:51], s66 offen offset:3072 lds
MA 144,v,128,v,152
TR 18,216,1024
MA 148,v,132,v,152
MA 208,v,136,v,152
TR 20,217,0
s_add_u32 s66, s66, 524288
MA 212,v,140,v,152
MA 24,v,112,v,156
TR 22,217,1024
s_and_b32 s66, s66, 8388607
MA 28,v,116,v,156
MA 88,v,120,v,156
TR 24,218,0
MA 92,v,124,v,156
s_add_u32 s75, s64, s74
MA 152,v,128,v,156
TR 26,218,1024
MA 156,v,132,v,156
s_add_u32 m0, s67, 32768
MA 216,v,136,v,156
TR 28,219,0
MA 220,v,140,v,156
MA 32,v,112,v,160
TR 30,219,1024
buffer_load_dwordx4 v208, s[44:47], s75 offen offset:0 lds
MA 36,v,116,v,160
MA 96,v,120,v,160
TR 32,220,0
buffer_load_dwordx4 v209, s[44:47], s75 offen offset:1024 lds
MA 100,v,124,v,160
MA 160,v,128,v,160
TR 34,220,1024
MA 164,v,132,v,160
buffer_load_dwordx4 v210, s[44:47], s75 offen offset:2048 lds
MA 224,v,136,v,160
TR 36,221,0
MA 228,v,140,v,160
buffer_load_dwordx4 v211, s[44:47], s75 offen offset:3072 lds
MA 40,v,112,v,164
TR 38,221,1024
MA 44,v,116,v,164
MA 104,v,120,v,164
TR 40,222,0
s_add_u32 s75, s65, s74
MA 108,v,124,v,164
MA 168,v,128,v,164
TR 42,222,1024
s_add_u32 m0, s67, 36864
MA 172,v,132,v,164
MA 232,v,136,v,164
TR 44,223,0
MA 236,v,140,v,164
buffer_load_dwordx4 v208, s[44:47], s75 offen offset:0 lds
MA 48,v,112,v,168
TR 46,223,1024
MA 52,v,116,v,168
buffer_load_dwordx4 v209, s[44:47], s75 offen offset:1024 lds
MA 112,v,120,v,168
MA 116,v,124,v,168
MA 176,v,128,v,168
buffer_load_dwordx4 v210, s[44:47], s75 offen offset:2048 lds
MA 180,v,132,v,168
MA 240,v,136,v,168
buffer_load_dwordx4 v211, s[44:47], s75 offen offset:3072 lds
MA 244,v,140,v,168
MA 56,v,112,v,172
MA 60,v,116,v,172
s_add_u32 s74, s74, 128
MA 120,v,120,v,172
MA 124,v,124,v,172
s_and_b32 s74, s74, 2047
MA 184,v,128,v,172
MA 188,v,132,v,172
MA 248,v,136,v,172
MA 252,v,140,v,172
L_p2:
s_waitcnt lgkmcnt(4)
v_mfma_f32_16x16x32_bf16 v[80:83], v[16:19], v[48:51], 0
s_add_u32 s8, s40, 59768832
s_addc_u32 s9, s41, 0
v_mfma_f32_16x16x32_bf16 v[84:87], v[16:19], v[52:55], 0
ds_read_b128 v[64:67], v227 offset:0
v_mfma_f32_16x16x32_bf16 v[88:91], v[16:19], v[56:59], 0
s_mov_b32 s10, 8192
v_mfma_f32_16x16x32_bf16 v[92:95], v[16:19], v[60:63], 0
TR 16,216,8192
TR 18,216,9216
v_mfma_f32_16x16x32_bf16 v[96:99], v[20:23], v[48:51], 0
s_mov_b32 s11, 0x20000
s_mov_b32 s12, s38
v_mfma_f32_16x16x32_bf16 v[100:103], v[20:23], v[52:55], 0
s_mov_b32 s13, s39
v_mfma_f32_16x16x32_bf16 v[104:107], v[20:23], v[56:59], 0
ds_read_b128 v[68:71], v227 offset:2048
s_mov_b32 s14, 256
v_mfma_f32_16x16x32_bf16 v[108:111], v[20:23], v[60:63], 0
TR 20,217,8192
TR 22,217,9216
v_mfma_f32_16x16x32_bf16 v[112:115], v[24:27], v[48:51], 0
s_mov_b32 s15, 0x20000
v_accvgpr_read_b32 v234, a0
v_mfma_f32_16x16x32_bf16 v[116:119], v[24:27], v[52:55], 0
v_accvgpr_read_b32 v235, a1
v_mfma_f32_16x16x32_bf16 v[120:123], v[24:27], v[56:59], 0
v_accvgpr_read_b32 v236, a2
v_mfma_f32_16x16x32_bf16 v[124:127], v[24:27], v[60:63], 0
TR 24,218,8192
TR 26,218,9216
v_mfma_f32_16x16x32_bf16 v[128:131], v[28:31], v[48:51], 0
ds_read_b128 v[72:75], v227 offset:4096
v_accvgpr_read_b32 v237, a3
v_mfma_f32_16x16x32_bf16 v[132:135], v[28:31], v[52:55], 0
v_accvgpr_read_b32 v238, a4
v_accvgpr_read_b32 v239, a5
v_mfma_f32_16x16x32_bf16 v[136:139], v[28:31], v[56:59], 0
v_accvgpr_read_b32 v240, a6
v_mfma_f32_16x16x32_bf16 v[140:143], v[28:31], v[60:63], 0
TR 28,219,8192
TR 30,219,9216
v_mfma_f32_16x16x32_bf16 v[144:147], v[32:35], v[48:51], 0
v_accvgpr_read_b32 v241, a7
v_cvt_pk_bf16_f32 v230, v234, v235
v_mfma_f32_16x16x32_bf16 v[148:151], v[32:35], v[52:55], 0
v_cvt_pk_bf16_f32 v231, v236, v237
v_mfma_f32_16x16x32_bf16 v[152:155], v[32:35], v[56:59], 0
ds_read_b128 v[76:79], v227 offset:6144
v_cvt_pk_bf16_f32 v232, v238, v239
v_mfma_f32_16x16x32_bf16 v[156:159], v[32:35], v[60:63], 0
TR 32,220,8192
TR 34,220,9216
v_mfma_f32_16x16x32_bf16 v[160:163], v[36:39], v[48:51], 0
v_cvt_pk_bf16_f32 v233, v240, v241
buffer_store_dwordx4 v[230:233], v228, s[16:19], s24 offen offset:0 sc1
v_mfma_f32_16x16x32_bf16 v[164:167], v[36:39], v[52:55], 0
v_accvgpr_read_b32 v246, a8
v_mfma_f32_16x16x32_bf16 v[168:171], v[36:39], v[56:59], 0
v_accvgpr_read_b32 v247, a9
v_mfma_f32_16x16x32_bf16 v[172:175], v[36:39], v[60:63], 0
TR 36,221,8192
TR 38,221,9216
s_waitcnt lgkmcnt(15)
v_mfma_f32_16x16x32_bf16 v[176:179], v[40:43], v[48:51], 0
v_accvgpr_read_b32 v248, a10
v_accvgpr_read_b32 v249, a11
v_mfma_f32_16x16x32_bf16 v[180:183], v[40:43], v[52:55], 0
v_accvgpr_read_b32 v250, a12
v_mfma_f32_16x16x32_bf16 v[184:187], v[40:43], v[56:59], 0
v_accvgpr_read_b32 v251, a13
v_mfma_f32_16x16x32_bf16 v[188:191], v[40:43], v[60:63], 0
TR 40,222,8192
TR 42,222,9216
v_mfma_f32_16x16x32_bf16 v[192:195], v[44:47], v[48:51], 0
v_accvgpr_read_b32 v252, a14
v_accvgpr_read_b32 v253, a15
v_mfma_f32_16x16x32_bf16 v[196:199], v[44:47], v[52:55], 0
v_mfma_f32_16x16x32_bf16 v[200:203], v[44:47], v[56:59], 0
v_mfma_f32_16x16x32_bf16 v[204:207], v[44:47], v[60:63], 0
TR 44,223,8192
TR 46,223,9216
s_waitcnt lgkmcnt(4)
MV 80,v,16,v,64
v_cvt_pk_bf16_f32 v242, v246, v247
MV 84,v,16,v,68
v_cvt_pk_bf16_f32 v243, v248, v249
MV 88,v,16,v,72
v_cvt_pk_bf16_f32 v244, v250, v251
MV 92,v,16,v,76
MV 96,v,20,v,64
v_cvt_pk_bf16_f32 v245, v252, v253
MV 100,v,20,v,68
buffer_store_dwordx4 v[242:245], v228, s[16:19], s24 offen offset:1024 sc1
MV 104,v,20,v,72
MV 108,v,20,v,76
s_waitcnt vmcnt(16) lgkmcnt(0)
s_barrier
MV 112,v,24,v,64
TR 16,216,16384
TR 18,216,17408
MV 116,v,24,v,68
ds_read_b128 v[48:51], v224 offset:0
s_add_u32 m0, s68, 98304
MV 120,v,24,v,72
TR 20,217,16384
TR 22,217,17408
MV 124,v,24,v,76
buffer_load_dwordx4 v212, s[48:51], s66 offen offset:0 lds
v_accvgpr_read_b32 v234, a16
MV 128,v,28,v,64
TR 24,218,16384
TR 26,218,17408
MV 132,v,28,v,68
ds_read_b128 v[52:55], v224 offset:2048
buffer_load_dwordx4 v213, s[48:51], s66 offen offset:1024 lds
MV 136,v,28,v,72
buffer_load_dwordx4 v214, s[48:51], s66 offen offset:2048 lds
v_accvgpr_read_b32 v235, a17
MV 140,v,28,v,76
TR 28,219,16384
TR 30,219,17408
MV 144,v,32,v,64
ds_read_b128 v[56:59], v224 offset:4096
v_accvgpr_read_b32 v236, a18
MV 148,v,32,v,68
buffer_load_dwordx4 v215, s[48:51], s66 offen offset:3072 lds
v_accvgpr_read_b32 v237, a19
MV 152,v,32,v,72
v_accvgpr_read_b32 v238, a20
v_accvgpr_read_b32 v239, a21
MV 156,v,32,v,76
TR 32,220,16384
TR 34,220,17408
MV 160,v,36,v,64
ds_read_b128 v[60:63], v224 offset:6144
s_add_u32 s66, s66, 524288
MV 164,v,36,v,68
s_and_b32 s66, s66, 8388607
v_accvgpr_read_b32 v240, a22
MV 168,v,36,v,72
v_accvgpr_read_b32 v241, a23
v_cvt_pk_bf16_f32 v230, v234, v235
MV 172,v,36,v,76
TR 36,221,16384
TR 38,221,17408
MV 176,v,40,v,64
s_add_u32 s75, s64, s74
v_cvt_pk_bf16_f32 v231, v236, v237
MV 180,v,40,v,68
v_cvt_pk_bf16_f32 v232, v238, v239
v_cvt_pk_bf16_f32 v233, v240, v241
MV 184,v,40,v,72
s_add_u32 m0, s67, 65536
buffer_store_dwordx4 v[230:233], v228, s[16:19], s24 offen offset:2048 sc1
MV 188,v,40,v,76
TR 40,222,16384
TR 42,222,17408
MV 192,v,44,v,64
buffer_load_dwordx4 v208, s[44:47], s75 offen offset:0 lds
v_accvgpr_read_b32 v246, a24
MV 196,v,44,v,68
v_accvgpr_read_b32 v247, a25
v_accvgpr_read_b32 v248, a26
MV 200,v,44,v,72
MV 204,v,44,v,76
TR 44,223,16384
TR 46,223,17408
s_waitcnt lgkmcnt(4)
MV 80,v,16,v,48
buffer_load_dwordx4 v209, s[44:47], s75 offen offset:1024 lds
v_accvgpr_read_b32 v249, a27
MV 84,v,16,v,52
ds_read_b128 v[64:67], v225 offset:0
v_accvgpr_read_b32 v250, a28
MV 88,v,16,v,56
buffer_load_dwordx4 v210, s[44:47], s75 offen offset:2048 lds
v_accvgpr_read_b32 v251, a29
MV 92,v,16,v,60
TR 16,216,24576
TR 18,216,25600
MV 96,v,20,v,48
v_accvgpr_read_b32 v252, a30
MV 100,v,20,v,52
buffer_load_dwordx4 v211, s[44:47], s75 offen offset:3072 lds
v_accvgpr_read_b32 v253, a31
MV 104,v,20,v,56
ds_read_b128 v[68:71], v225 offset:2048
MV 108,v,20,v,60
TR 20,217,24576
TR 22,217,25600
MV 112,v,24,v,48
s_add_u32 s75, s65, s74
v_cvt_pk_bf16_f32 v242, v246, v247
MV 116,v,24,v,52
v_cvt_pk_bf16_f32 v243, v248, v249
MV 120,v,24,v,56
v_cvt_pk_bf16_f32 v244, v250, v251
MV 124,v,24,v,60
TR 24,218,24576
TR 26,218,25600
MV 128,v,28,v,48
ds_read_b128 v[72:75], v225 offset:4096
s_add_u32 m0, s67, 69632
MV 132,v,28,v,52
v_cvt_pk_bf16_f32 v245, v252, v253
buffer_store_dwordx4 v[242:245], v228, s[16:19], s24 offen offset:3072 sc1
MV 136,v,28,v,56
buffer_load_dwordx4 v208, s[44:47], s75 offen offset:0 lds
v_accvgpr_read_b32 v234, a32
MV 140,v,28,v,60
TR 28,219,24576
TR 30,219,25600
MV 144,v,32,v,48
buffer_load_dwordx4 v209, s[44:47], s75 offen offset:1024 lds
v_accvgpr_read_b32 v235, a33
MV 148,v,32,v,52
v_accvgpr_read_b32 v236, a34
MV 152,v,32,v,56
ds_read_b128 v[76:79], v225 offset:6144
v_accvgpr_read_b32 v237, a35
MV 156,v,32,v,60
TR 32,220,24576
TR 34,220,25600
MV 160,v,36,v,48
buffer_load_dwordx4 v210, s[44:47], s75 offen offset:2048 lds
v_accvgpr_read_b32 v238, a36
MV 164,v,36,v,52
v_accvgpr_read_b32 v239, a37
MV 168,v,36,v,56
buffer_load_dwordx4 v211, s[44:47], s75 offen offset:3072 lds
v_accvgpr_read_b32 v240, a38
MV 172,v,36,v,60
TR 36,221,24576
TR 38,221,25600
s_waitcnt lgkmcnt(15)
MV 176,v,40,v,48
v_accvgpr_read_b32 v241, a39
MV 180,v,40,v,52
s_add_u32 s74, s74, 128
v_cvt_pk_bf16_f32 v230, v234, v235
MV 184,v,40,v,56
MV 188,v,40,v,60
TR 40,222,24576
TR 42,222,25600
MV 192,v,44,v,48
s_and_b32 s74, s74, 2047
v_cvt_pk_bf16_f32 v231, v236, v237
MV 196,v,44,v,52
v_cvt_pk_bf16_f32 v232, v238, v239
MV 200,v,44,v,56
MV 204,v,44,v,60
TR 44,223,24576
TR 46,223,25600
s_waitcnt lgkmcnt(4)
MV 80,v,16,v,64
v_cvt_pk_bf16_f32 v233, v240, v241
MV 84,v,16,v,68
s_add_u32 s24, s24, 4096
MV 88,v,16,v,72
buffer_store_dwordx4 v[230:233], v228, s[16:19], s24 offen offset:0 sc1
MV 92,v,16,v,76
MV 96,v,20,v,64
v_accvgpr_read_b32 v246, a40
MV 100,v,20,v,68
v_accvgpr_read_b32 v247, a41
MV 104,v,20,v,72
MV 108,v,20,v,76
s_waitcnt vmcnt(17) lgkmcnt(0)
s_barrier
MV 112,v,24,v,64
TR 16,216,32768
TR 18,216,33792
MV 116,v,24,v,68
ds_read_b128 v[48:51], v224 offset:32768
s_add_u32 m0, s68, 114688
MV 120,v,24,v,72
TR 20,217,32768
TR 22,217,33792
MV 124,v,24,v,76
buffer_load_dwordx4 v212, s[48:51], s66 offen offset:0 lds
v_accvgpr_read_b32 v248, a42
MV 128,v,28,v,64
TR 24,218,32768
TR 26,218,33792
MV 132,v,28,v,68
ds_read_b128 v[52:55], v224 offset:34816
buffer_load_dwordx4 v213, s[48:51], s66 offen offset:1024 lds
MV 136,v,28,v,72
buffer_load_dwordx4 v214, s[48:51], s66 offen offset:2048 lds
v_accvgpr_read_b32 v249, a43
MV 140,v,28,v,76
TR 28,219,32768
TR 30,219,33792
MV 144,v,32,v,64
ds_read_b128 v[56:59], v224 offset:36864
v_accvgpr_read_b32 v250, a44
MV 148,v,32,v,68
buffer_load_dwordx4 v215, s[48:51], s66 offen offset:3072 lds
v_accvgpr_read_b32 v251, a45
MV 152,v,32,v,72
v_accvgpr_read_b32 v252, a46
v_accvgpr_read_b32 v253, a47
MV 156,v,32,v,76
TR 32,220,32768
TR 34,220,33792
MV 160,v,36,v,64
ds_read_b128 v[60:63], v224 offset:38912
s_add_u32 s66, s66, 524288
MV 164,v,36,v,68
s_and_b32 s66, s66, 8388607
v_cvt_pk_bf16_f32 v242, v246, v247
MV 168,v,36,v,72
v_cvt_pk_bf16_f32 v243, v248, v249
v_cvt_pk_bf16_f32 v244, v250, v251
MV 172,v,36,v,76
TR 36,221,32768
TR 38,221,33792
MV 176,v,40,v,64
s_add_u32 s75, s64, s74
v_cvt_pk_bf16_f32 v245, v252, v253
MV 180,v,40,v,68
buffer_store_dwordx4 v[242:245], v228, s[16:19], s24 offen offset:1024 sc1
v_accvgpr_read_b32 v234, a48
MV 184,v,40,v,72
s_add_u32 m0, s67, 0
v_accvgpr_read_b32 v235, a49
MV 188,v,40,v,76
TR 40,222,32768
TR 42,222,33792
MV 192,v,44,v,64
buffer_load_dwordx4 v208, s[44:47], s75 offen offset:0 lds
v_accvgpr_read_b32 v236, a50
MV 196,v,44,v,68
v_accvgpr_read_b32 v237, a51
v_accvgpr_read_b32 v238, a52
MV 200,v,44,v,72
MV 204,v,44,v,76
TR 44,223,32768
TR 46,223,33792
s_waitcnt lgkmcnt(4)
MV 80,v,16,v,48
buffer_load_dwordx4 v209, s[44:47], s75 offen offset:1024 lds
v_accvgpr_read_b32 v239, a53
MV 84,v,16,v,52
ds_read_b128 v[64:67], v225 offset:32768
v_accvgpr_read_b32 v240, a54
MV 88,v,16,v,56
buffer_load_dwordx4 v210, s[44:47], s75 offen offset:2048 lds
v_accvgpr_read_b32 v241, a55
MV 92,v,16,v,60
TR 16,216,40960
TR 18,216,41984
MV 96,v,20,v,48
v_cvt_pk_bf16_f32 v230, v234, v235
MV 100,v,20,v,52
buffer_load_dwordx4 v211, s[44:47], s75 offen offset:3072 lds
v_cvt_pk_bf16_f32 v231, v236, v237
MV 104,v,20,v,56
ds_read_b128 v[68:71], v225 offset:34816
MV 108,v,20,v,60
TR 20,217,40960
TR 22,217,41984
MV 112,v,24,v,48
s_add_u32 s75, s65, s74
v_cvt_pk_bf16_f32 v232, v238, v239
MV 116,v,24,v,52
v_cvt_pk_bf16_f32 v233, v240, v241
MV 120,v,24,v,56
buffer_store_dwordx4 v[230:233], v228, s[16:19], s24 offen offset:2048 sc1
MV 124,v,24,v,60
TR 24,218,40960
TR 26,218,41984
MV 128,v,28,v,48
ds_read_b128 v[72:75], v225 offset:36864
s_add_u32 m0, s67, 4096
MV 132,v,28,v,52
v_accvgpr_read_b32 v246, a56
v_accvgpr_read_b32 v247, a57
MV 136,v,28,v,56
buffer_load_dwordx4 v208, s[44:47], s75 offen offset:0 lds
v_accvgpr_read_b32 v248, a58
MV 140,v,28,v,60
TR 28,219,40960
TR 30,219,41984
MV 144,v,32,v,48
buffer_load_dwordx4 v209, s[44:47], s75 offen offset:1024 lds
v_accvgpr_read_b32 v249, a59
MV 148,v,32,v,52
v_accvgpr_read_b32 v250, a60
MV 152,v,32,v,56
ds_read_b128 v[76:79], v225 offset:38912
v_accvgpr_read_b32 v251, a61
MV 156,v,32,v,60
TR 32,220,40960
TR 34,220,41984
MV 160,v,36,v,48
buffer_load_dwordx4 v210, s[44:47], s75 offen offset:2048 lds
v_accvgpr_read_b32 v252, a62
MV 164,v,36,v,52
v_accvgpr_read_b32 v253, a63
MV 168,v,36,v,56
buffer_load_dwordx4 v211, s[44:47], s75 offen offset:3072 lds
v_cvt_pk_bf16_f32 v242, v246, v247
MV 172,v,36,v,60
TR 36,221,40960
TR 38,221,41984
s_waitcnt lgkmcnt(15)
MV 176,v,40,v,48
v_cvt_pk_bf16_f32 v243, v248, v249
MV 180,v,40,v,52
s_add_u32 s74, s74, 128
v_cvt_pk_bf16_f32 v244, v250, v251
MV 184,v,40,v,56
MV 188,v,40,v,60
TR 40,222,40960
TR 42,222,41984
MV 192,v,44,v,48
s_and_b32 s74, s74, 2047
v_cvt_pk_bf16_f32 v245, v252, v253
MV 196,v,44,v,52
buffer_store_dwordx4 v[242:245], v228, s[16:19], s24 offen offset:3072 sc1
MV 200,v,44,v,56
MV 204,v,44,v,60
TR 44,223,40960
TR 46,223,41984
s_waitcnt lgkmcnt(4)
MV 80,v,16,v,64
v_accvgpr_read_b32 v234, a64
MV 84,v,16,v,68
v_accvgpr_read_b32 v235, a65
MV 88,v,16,v,72
v_accvgpr_read_b32 v236, a66
MV 92,v,16,v,76
MV 96,v,20,v,64
v_accvgpr_read_b32 v237, a67
MV 100,v,20,v,68
v_accvgpr_read_b32 v238, a68
MV 104,v,20,v,72
MV 108,v,20,v,76
s_waitcnt vmcnt(16) lgkmcnt(0)
s_barrier
MV 112,v,24,v,64
TR 16,216,0
TR 18,216,1024
MV 116,v,24,v,68
ds_read_b128 v[48:51], v226 offset:0
s_add_u32 m0, s68, 131072
MV 120,v,24,v,72
TR 20,217,0
TR 22,217,1024
MV 124,v,24,v,76
buffer_load_dwordx4 v212, s[48:51], s66 offen offset:0 lds
v_accvgpr_read_b32 v239, a69
MV 128,v,28,v,64
TR 24,218,0
TR 26,218,1024
MV 132,v,28,v,68
ds_read_b128 v[52:55], v226 offset:2048
buffer_load_dwordx4 v213, s[48:51], s66 offen offset:1024 lds
MV 136,v,28,v,72
buffer_load_dwordx4 v214, s[48:51], s66 offen offset:2048 lds
v_accvgpr_read_b32 v240, a70
MV 140,v,28,v,76
TR 28,219,0
TR 30,219,1024
MV 144,v,32,v,64
ds_read_b128 v[56:59], v226 offset:4096
v_accvgpr_read_b32 v241, a71
MV 148,v,32,v,68
buffer_load_dwordx4 v215, s[48:51], s66 offen offset:3072 lds
v_cvt_pk_bf16_f32 v230, v234, v235
MV 152,v,32,v,72
v_cvt_pk_bf16_f32 v231, v236, v237
v_cvt_pk_bf16_f32 v232, v238, v239
MV 156,v,32,v,76
TR 32,220,0
TR 34,220,1024
MV 160,v,36,v,64
ds_read_b128 v[60:63], v226 offset:6144
s_add_u32 s66, s66, 524288
MV 164,v,36,v,68
s_and_b32 s66, s66, 8388607
v_cvt_pk_bf16_f32 v233, v240, v241
MV 168,v,36,v,72
s_add_u32 s24, s24, 4096
buffer_store_dwordx4 v[230:233], v228, s[16:19], s24 offen offset:0 sc1
MV 172,v,36,v,76
TR 36,221,0
TR 38,221,1024
MV 176,v,40,v,64
s_add_u32 s75, s64, s74
v_accvgpr_read_b32 v246, a72
MV 180,v,40,v,68
v_accvgpr_read_b32 v247, a73
v_accvgpr_read_b32 v248, a74
MV 184,v,40,v,72
s_add_u32 m0, s67, 32768
v_accvgpr_read_b32 v249, a75
MV 188,v,40,v,76
TR 40,222,0
TR 42,222,1024
MV 192,v,44,v,64
buffer_load_dwordx4 v208, s[44:47], s75 offen offset:0 lds
v_accvgpr_read_b32 v250, a76
MV 196,v,44,v,68
v_accvgpr_read_b32 v251, a77
v_accvgpr_read_b32 v252, a78
MV 200,v,44,v,72
MV 204,v,44,v,76
TR 44,223,0
TR 46,223,1024
s_waitcnt lgkmcnt(4)
MV 80,v,16,v,48
buffer_load_dwordx4 v209, s[44:47], s75 offen offset:1024 lds
v_accvgpr_read_b32 v253, a79
MV 84,v,16,v,52
ds_read_b128 v[64:67], v227 offset:0
v_cvt_pk_bf16_f32 v242, v246, v247
MV 88,v,16,v,56
buffer_load_dwordx4 v210, s[44:47], s75 offen offset:2048 lds
v_cvt_pk_bf16_f32 v243, v248, v249
MV 92,v,16,v,60
TR 16,216,8192
TR 18,216,9216
MV 96,v,20,v,48
v_cvt_pk_bf16_f32 v244, v250, v251
MV 100,v,20,v,52
buffer_load_dwordx4 v211, s[44:47], s75 offen offset:3072 lds
v_cvt_pk_bf16_f32 v245, v252, v253
MV 104,v,20,v,56
ds_read_b128 v[68:71], v227 offset:2048
buffer_store_dwordx4 v[242:245], v228, s[16:19], s24 offen offset:1024 sc1
MV 108,v,20,v,60
TR 20,217,8192
TR 22,217,9216
MV 112,v,24,v,48
s_add_u32 s75, s65, s74
v_accvgpr_read_b32 v234, a80
MV 116,v,24,v,52
v_accvgpr_read_b32 v235, a81
MV 120,v,24,v,56
v_accvgpr_read_b32 v236, a82
MV 124,v,24,v,60
TR 24,218,8192
TR 26,218,9216
MV 128,v,28,v,48
ds_read_b128 v[72:75], v227 offset:4096
s_add_u32 m0, s67, 36864
MV 132,v,28,v,52
v_accvgpr_read_b32 v237, a83
v_accvgpr_read_b32 v238, a84
MV 136,v,28,v,56
buffer_load_dwordx4 v208, s[44:47], s75 offen offset:0 lds
MV 140,v,28,v,60
TR 28,219,8192
TR 30,219,9216
MV 144,v,32,v,48
buffer_load_dwordx4 v209, s[44:47], s75 offen offset:1024 lds
v_accvgpr_read_b32 v239, a85
MV 148,v,32,v,52
v_accvgpr_read_b32 v240, a86
v_accvgpr_read_b32 v241, a87
MV 152,v,32,v,56
ds_read_b128 v[76:79], v227 offset:6144
MV 156,v,32,v,60
TR 32,220,8192
TR 34,220,9216
MV 160,v,36,v,48
buffer_load_dwordx4 v210, s[44:47], s75 offen offset:2048 lds
v_cvt_pk_bf16_f32 v230, v234, v235
MV 164,v,36,v,52
v_cvt_pk_bf16_f32 v231, v236, v237
v_cvt_pk_bf16_f32 v232, v238, v239
MV 168,v,36,v,56
buffer_load_dwordx4 v211, s[44:47], s75 offen offset:3072 lds
MV 172,v,36,v,60
TR 36,221,8192
TR 38,221,9216
s_waitcnt lgkmcnt(15)
MV 176,v,40,v,48
v_cvt_pk_bf16_f32 v233, v240, v241
buffer_store_dwordx4 v[230:233], v228, s[16:19], s24 offen offset:2048 sc1
MV 180,v,40,v,52
s_add_u32 s74, s74, 128
v_accvgpr_read_b32 v246, a88
MV 184,v,40,v,56
MV 188,v,40,v,60
TR 40,222,8192
TR 42,222,9216
MV 192,v,44,v,48
s_and_b32 s74, s74, 2047
v_accvgpr_read_b32 v247, a89
MV 196,v,44,v,52
v_accvgpr_read_b32 v248, a90
MV 200,v,44,v,56
MV 204,v,44,v,60
TR 44,223,8192
TR 46,223,9216
s_waitcnt lgkmcnt(4)
MV 80,v,16,v,64
v_accvgpr_read_b32 v249, a91
MV 84,v,16,v,68
v_accvgpr_read_b32 v250, a92
MV 88,v,16,v,72
v_accvgpr_read_b32 v251, a93
MV 92,v,16,v,76
MV 96,v,20,v,64
v_accvgpr_read_b32 v252, a94
MV 100,v,20,v,68
v_accvgpr_read_b32 v253, a95
MV 104,v,20,v,72
MV 108,v,20,v,76
s_waitcnt vmcnt(16) lgkmcnt(0)
s_barrier
MV 112,v,24,v,64
TR 16,216,16384
TR 18,216,17408
MV 116,v,24,v,68
ds_read_b128 v[48:51], v224 offset:0
s_add_u32 m0, s68, 98304
MV 120,v,24,v,72
TR 20,217,16384
TR 22,217,17408
MV 124,v,24,v,76
buffer_load_dwordx4 v212, s[48:51], s66 offen offset:0 lds
v_cvt_pk_bf16_f32 v242, v246, v247
MV 128,v,28,v,64
TR 24,218,16384
TR 26,218,17408
MV 132,v,28,v,68
ds_read_b128 v[52:55], v224 offset:2048
buffer_load_dwordx4 v213, s[48:51], s66 offen offset:1024 lds
MV 136,v,28,v,72
buffer_load_dwordx4 v214, s[48:51], s66 offen offset:2048 lds
v_cvt_pk_bf16_f32 v243, v248, v249
MV 140,v,28,v,76
TR 28,219,16384
TR 30,219,17408
MV 144,v,32,v,64
ds_read_b128 v[56:59], v224 offset:4096
v_cvt_pk_bf16_f32 v244, v250, v251
MV 148,v,32,v,68
buffer_load_dwordx4 v215, s[48:51], s66 offen offset:3072 lds
v_cvt_pk_bf16_f32 v245, v252, v253
MV 152,v,32,v,72
buffer_store_dwordx4 v[242:245], v228, s[16:19], s24 offen offset:3072 sc1
v_accvgpr_read_b32 v234, a96
MV 156,v,32,v,76
TR 32,220,16384
TR 34,220,17408
MV 160,v,36,v,64
ds_read_b128 v[60:63], v224 offset:6144
s_add_u32 s66, s66, 524288
MV 164,v,36,v,68
s_and_b32 s66, s66, 8388607
v_accvgpr_read_b32 v235, a97
MV 168,v,36,v,72
v_accvgpr_read_b32 v236, a98
v_accvgpr_read_b32 v237, a99
MV 172,v,36,v,76
TR 36,221,16384
TR 38,221,17408
MV 176,v,40,v,64
s_add_u32 s75, s64, s74
v_accvgpr_read_b32 v238, a100
MV 180,v,40,v,68
v_accvgpr_read_b32 v239, a101
v_accvgpr_read_b32 v240, a102
MV 184,v,40,v,72
s_add_u32 m0, s67, 65536
v_accvgpr_read_b32 v241, a103
MV 188,v,40,v,76
TR 40,222,16384
TR 42,222,17408
MV 192,v,44,v,64
buffer_load_dwordx4 v208, s[44:47], s75 offen offset:0 lds
v_cvt_pk_bf16_f32 v230, v234, v235
MV 196,v,44,v,68
v_cvt_pk_bf16_f32 v231, v236, v237
v_cvt_pk_bf16_f32 v232, v238, v239
MV 200,v,44,v,72
MV 204,v,44,v,76
TR 44,223,16384
TR 46,223,17408
s_waitcnt lgkmcnt(4)
MV 80,v,16,v,48
buffer_load_dwordx4 v209, s[44:47], s75 offen offset:1024 lds
v_cvt_pk_bf16_f32 v233, v240, v241
MV 84,v,16,v,52
ds_read_b128 v[64:67], v225 offset:0
s_add_u32 s24, s24, 4096
MV 88,v,16,v,56
buffer_load_dwordx4 v210, s[44:47], s75 offen offset:2048 lds
buffer_store_dwordx4 v[230:233], v228, s[16:19], s24 offen offset:0 sc1
MV 92,v,16,v,60
TR 16,216,24576
TR 18,216,25600
MV 96,v,20,v,48
v_accvgpr_read_b32 v246, a104
MV 100,v,20,v,52
buffer_load_dwordx4 v211, s[44:47], s75 offen offset:3072 lds
v_accvgpr_read_b32 v247, a105
MV 104,v,20,v,56
ds_read_b128 v[68:71], v225 offset:2048
MV 108,v,20,v,60
TR 20,217,24576
TR 22,217,25600
MV 112,v,24,v,48
s_add_u32 s75, s65, s74
v_accvgpr_read_b32 v248, a106
MV 116,v,24,v,52
v_accvgpr_read_b32 v249, a107
MV 120,v,24,v,56
v_accvgpr_read_b32 v250, a108
MV 124,v,24,v,60
TR 24,218,24576
TR 26,218,25600
MV 128,v,28,v,48
ds_read_b128 v[72:75], v225 offset:4096
s_add_u32 m0, s67, 69632
MV 132,v,28,v,52
v_accvgpr_read_b32 v251, a109
v_accvgpr_read_b32 v252, a110
MV 136,v,28,v,56
buffer_load_dwordx4 v208, s[44:47], s75 offen offset:0 lds
v_accvgpr_read_b32 v253, a111
MV 140,v,28,v,60
TR 28,219,24576
TR 30,219,25600
MV 144,v,32,v,48
buffer_load_dwordx4 v209, s[44:47], s75 offen offset:1024 lds
v_cvt_pk_bf16_f32 v242, v246, v247
MV 148,v,32,v,52
v_cvt_pk_bf16_f32 v243, v248, v249
MV 152,v,32,v,56
ds_read_b128 v[76:79], v225 offset:6144
v_cvt_pk_bf16_f32 v244, v250, v251
MV 156,v,32,v,60
TR 32,220,24576
TR 34,220,25600
MV 160,v,36,v,48
buffer_load_dwordx4 v210, s[44:47], s75 offen offset:2048 lds
v_cvt_pk_bf16_f32 v245, v252, v253
MV 164,v,36,v,52
buffer_store_dwordx4 v[242:245], v228, s[16:19], s24 offen offset:1024 sc1
MV 168,v,36,v,56
buffer_load_dwordx4 v211, s[44:47], s75 offen offset:3072 lds
v_accvgpr_read_b32 v234, a112
MV 172,v,36,v,60
TR 36,221,24576
TR 38,221,25600
s_waitcnt lgkmcnt(15)
MV 176,v,40,v,48
v_accvgpr_read_b32 v235, a113
MV 180,v,40,v,52
s_add_u32 s74, s74, 128
v_accvgpr_read_b32 v236, a114
MV 184,v,40,v,56
MV 188,v,40,v,60
TR 40,222,24576
TR 42,222,25600
MV 192,v,44,v,48
s_and_b32 s74, s74, 2047
v_accvgpr_read_b32 v237, a115
MV 196,v,44,v,52
v_accvgpr_read_b32 v238, a116
MV 200,v,44,v,56
MV 204,v,44,v,60
TR 44,223,24576
TR 46,223,25600
s_waitcnt lgkmcnt(4)
MV 80,v,16,v,64
v_accvgpr_read_b32 v239, a117
MV 84,v,16,v,68
v_accvgpr_read_b32 v240, a118
MV 88,v,16,v,72
v_accvgpr_read_b32 v241, a119
MV 92,v,16,v,76
MV 96,v,20,v,64
v_cvt_pk_bf16_f32 v230, v234, v235
MV 100,v,20,v,68
v_cvt_pk_bf16_f32 v231, v236, v237
MV 104,v,20,v,72
MV 108,v,20,v,76
s_waitcnt vmcnt(16) lgkmcnt(0)
s_barrier
MV 112,v,24,v,64
TR 16,216,32768
TR 18,216,33792
MV 116,v,24,v,68
ds_read_b128 v[48:51], v224 offset:32768
s_add_u32 m0, s68, 114688
MV 120,v,24,v,72
TR 20,217,32768
TR 22,217,33792
MV 124,v,24,v,76
buffer_load_dwordx4 v212, s[48:51], s66 offen offset:0 lds
v_cvt_pk_bf16_f32 v232, v238, v239
MV 128,v,28,v,64
TR 24,218,32768
TR 26,218,33792
MV 132,v,28,v,68
ds_read_b128 v[52:55], v224 offset:34816
buffer_load_dwordx4 v213, s[48:51], s66 offen offset:1024 lds
MV 136,v,28,v,72
buffer_load_dwordx4 v214, s[48:51], s66 offen offset:2048 lds
v_cvt_pk_bf16_f32 v233, v240, v241
MV 140,v,28,v,76
TR 28,219,32768
TR 30,219,33792
MV 144,v,32,v,64
ds_read_b128 v[56:59], v224 offset:36864
buffer_store_dwordx4 v[230:233], v228, s[16:19], s24 offen offset:2048 sc1
MV 148,v,32,v,68
buffer_load_dwordx4 v215, s[48:51], s66 offen offset:3072 lds
v_accvgpr_read_b32 v246, a120
MV 152,v,32,v,72
v_accvgpr_read_b32 v247, a121
v_accvgpr_read_b32 v248, a122
MV 156,v,32,v,76
TR 32,220,32768
TR 34,220,33792
MV 160,v,36,v,64
ds_read_b128 v[60:63], v224 offset:38912
s_add_u32 s66, s66, 524288
MV 164,v,36,v,68
s_and_b32 s66, s66, 8388607
v_accvgpr_read_b32 v249, a123
MV 168,v,36,v,72
v_accvgpr_read_b32 v250, a124
v_accvgpr_read_b32 v251, a125
MV 172,v,36,v,76
TR 36,221,32768
TR 38,221,33792
MV 176,v,40,v,64
s_add_u32 s75, s64, s74
v_accvgpr_read_b32 v252, a126
MV 180,v,40,v,68
v_accvgpr_read_b32 v253, a127
v_cvt_pk_bf16_f32 v242, v246, v247
MV 184,v,40,v,72
s_add_u32 m0, s67, 0
v_cvt_pk_bf16_f32 v243, v248, v249
MV 188,v,40,v,76
TR 40,222,32768
TR 42,222,33792
MV 192,v,44,v,64
buffer_load_dwordx4 v208, s[44:47], s75 offen offset:0 lds
v_cvt_pk_bf16_f32 v244, v250, v251
MV 196,v,44,v,68
v_cvt_pk_bf16_f32 v245, v252, v253
buffer_store_dwordx4 v[242:245], v228, s[16:19], s24 offen offset:3072 sc1
MV 200,v,44,v,72
MV 204,v,44,v,76
TR 44,223,32768
TR 46,223,33792
s_waitcnt lgkmcnt(4)
MV 80,v,16,v,48
buffer_load_dwordx4 v209, s[44:47], s75 offen offset:1024 lds
v_accvgpr_read_b32 v234, a128
MV 84,v,16,v,52
ds_read_b128 v[64:67], v225 offset:32768
v_accvgpr_read_b32 v235, a129
MV 88,v,16,v,56
buffer_load_dwordx4 v210, s[44:47], s75 offen offset:2048 lds
v_accvgpr_read_b32 v236, a130
MV 92,v,16,v,60
TR 16,216,40960
TR 18,216,41984
MV 96,v,20,v,48
v_accvgpr_read_b32 v237, a131
MV 100,v,20,v,52
buffer_load_dwordx4 v211, s[44:47], s75 offen offset:3072 lds
v_accvgpr_read_b32 v238, a132
MV 104,v,20,v,56
ds_read_b128 v[68:71], v225 offset:34816
MV 108,v,20,v,60
TR 20,217,40960
TR 22,217,41984
MV 112,v,24,v,48
s_add_u32 s75, s65, s74
v_accvgpr_read_b32 v239, a133
MV 116,v,24,v,52
v_accvgpr_read_b32 v240, a134
MV 120,v,24,v,56
v_accvgpr_read_b32 v241, a135
MV 124,v,24,v,60
TR 24,218,40960
TR 26,218,41984
MV 128,v,28,v,48
ds_read_b128 v[72:75], v225 offset:36864
s_add_u32 m0, s67, 4096
MV 132,v,28,v,52
v_cvt_pk_bf16_f32 v230, v234, v235
v_cvt_pk_bf16_f32 v231, v236, v237
MV 136,v,28,v,56
buffer_load_dwordx4 v208, s[44:47], s75 offen offset:0 lds
v_cvt_pk_bf16_f32 v232, v238, v239
MV 140,v,28,v,60
TR 28,219,40960
TR 30,219,41984
MV 144,v,32,v,48
buffer_load_dwordx4 v209, s[44:47], s75 offen offset:1024 lds
v_cvt_pk_bf16_f32 v233, v240, v241
MV 148,v,32,v,52
s_add_u32 s24, s24, 4096
MV 152,v,32,v,56
ds_read_b128 v[76:79], v225 offset:38912
buffer_store_dwordx4 v[230:233], v228, s[16:19], s24 offen offset:0 sc1
MV 156,v,32,v,60
TR 32,220,40960
TR 34,220,41984
MV 160,v,36,v,48
buffer_load_dwordx4 v210, s[44:47], s75 offen offset:2048 lds
v_accvgpr_read_b32 v246, a136
MV 164,v,36,v,52
v_accvgpr_read_b32 v247, a137
MV 168,v,36,v,56
buffer_load_dwordx4 v211, s[44:47], s75 offen offset:3072 lds
v_accvgpr_read_b32 v248, a138
MV 172,v,36,v,60
TR 36,221,40960
TR 38,221,41984
s_waitcnt lgkmcnt(15)
MV 176,v,40,v,48
v_accvgpr_read_b32 v249, a139
MV 180,v,40,v,52
s_add_u32 s74, s74, 128
v_accvgpr_read_b32 v250, a140
MV 184,v,40,v,56
MV 188,v,40,v,60
TR 40,222,40960
TR 42,222,41984
MV 192,v,44,v,48
s_and_b32 s74, s74, 2047
v_accvgpr_read_b32 v251, a141
MV 196,v,44,v,52
v_accvgpr_read_b32 v252, a142
MV 200,v,44,v,56
MV 204,v,44,v,60
TR 44,223,40960
TR 46,223,41984
s_waitcnt lgkmcnt(4)
MV 80,v,16,v,64
v_accvgpr_read_b32 v253, a143
MV 84,v,16,v,68
v_cvt_pk_bf16_f32 v242, v246, v247
MV 88,v,16,v,72
v_cvt_pk_bf16_f32 v243, v248, v249
MV 92,v,16,v,76
MV 96,v,20,v,64
v_cvt_pk_bf16_f32 v244, v250, v251
MV 100,v,20,v,68
v_cvt_pk_bf16_f32 v245, v252, v253
MV 104,v,20,v,72
MV 108,v,20,v,76
s_waitcnt vmcnt(15) lgkmcnt(0)
s_barrier
MV 112,v,24,v,64
TR 16,216,0
TR 18,216,1024
MV 116,v,24,v,68
ds_read_b128 v[48:51], v226 offset:0
s_add_u32 m0, s68, 131072
MV 120,v,24,v,72
TR 20,217,0
TR 22,217,1024
MV 124,v,24,v,76
buffer_load_dwordx4 v212, s[48:51], s66 offen offset:0 lds
buffer_store_dwordx4 v[242:245], v228, s[16:19], s24 offen offset:1024 sc1
MV 128,v,28,v,64
TR 24,218,0
TR 26,218,1024
MV 132,v,28,v,68
ds_read_b128 v[52:55], v226 offset:2048
buffer_load_dwordx4 v213, s[48:51], s66 offen offset:1024 lds
MV 136,v,28,v,72
buffer_load_dwordx4 v214, s[48:51], s66 offen offset:2048 lds
v_accvgpr_read_b32 v234, a144
MV 140,v,28,v,76
TR 28,219,0
TR 30,219,1024
MV 144,v,32,v,64
ds_read_b128 v[56:59], v226 offset:4096
v_accvgpr_read_b32 v235, a145
MV 148,v,32,v,68
buffer_load_dwordx4 v215, s[48:51], s66 offen offset:3072 lds
v_accvgpr_read_b32 v236, a146
MV 152,v,32,v,72
v_accvgpr_read_b32 v237, a147
v_accvgpr_read_b32 v238, a148
MV 156,v,32,v,76
TR 32,220,0
TR 34,220,1024
MV 160,v,36,v,64
ds_read_b128 v[60:63], v226 offset:6144
s_add_u32 s66, s66, 524288
MV 164,v,36,v,68
s_and_b32 s66, s66, 8388607
v_accvgpr_read_b32 v239, a149
MV 168,v,36,v,72
v_accvgpr_read_b32 v240, a150
v_accvgpr_read_b32 v241, a151
MV 172,v,36,v,76
TR 36,221,0
TR 38,221,1024
MV 176,v,40,v,64
s_add_u32 s75, s64, s74
v_cvt_pk_bf16_f32 v230, v234, v235
MV 180,v,40,v,68
v_cvt_pk_bf16_f32 v231, v236, v237
v_cvt_pk_bf16_f32 v232, v238, v239
MV 184,v,40,v,72
s_add_u32 m0, s67, 32768
v_cvt_pk_bf16_f32 v233, v240, v241
MV 188,v,40,v,76
TR 40,222,0
TR 42,222,1024
MV 192,v,44,v,64
buffer_load_dwordx4 v208, s[44:47], s75 offen offset:0 lds
buffer_store_dwordx4 v[230:233], v228, s[16:19], s24 offen offset:2048 sc1
MV 196,v,44,v,68
v_accvgpr_read_b32 v246, a152
v_accvgpr_read_b32 v247, a153
MV 200,v,44,v,72
MV 204,v,44,v,76
TR 44,223,0
TR 46,223,1024
s_waitcnt lgkmcnt(4)
MV 80,v,16,v,48
buffer_load_dwordx4 v209, s[44:47], s75 offen offset:1024 lds
v_accvgpr_read_b32 v248, a154
MV 84,v,16,v,52
ds_read_b128 v[64:67], v227 offset:0
v_accvgpr_read_b32 v249, a155
MV 88,v,16,v,56
buffer_load_dwordx4 v210, s[44:47], s75 offen offset:2048 lds
v_accvgpr_read_b32 v250, a156
MV 92,v,16,v,60
TR 16,216,8192
TR 18,216,9216
MV 96,v,20,v,48
v_accvgpr_read_b32 v251, a157
MV 100,v,20,v,52
buffer_load_dwordx4 v211, s[44:47], s75 offen offset:3072 lds
v_accvgpr_read_b32 v252, a158
MV 104,v,20,v,56
ds_read_b128 v[68:71], v227 offset:2048
MV 108,v,20,v,60
TR 20,217,8192
TR 22,217,9216
MV 112,v,24,v,48
s_add_u32 s75, s65, s74
v_accvgpr_read_b32 v253, a159
MV 116,v,24,v,52
v_cvt_pk_bf16_f32 v242, v246, v247
MV 120,v,24,v,56
v_cvt_pk_bf16_f32 v243, v248, v249
MV 124,v,24,v,60
TR 24,218,8192
TR 26,218,9216
MV 128,v,28,v,48
ds_read_b128 v[72:75], v227 offset:4096
s_add_u32 m0, s67, 36864
MV 132,v,28,v,52
v_cvt_pk_bf16_f32 v244, v250, v251
v_cvt_pk_bf16_f32 v245, v252, v253
MV 136,v,28,v,56
buffer_load_dwordx4 v208, s[44:47], s75 offen offset:0 lds
buffer_store_dwordx4 v[242:245], v228, s[16:19], s24 offen offset:3072 sc1
MV 140,v,28,v,60
TR 28,219,8192
TR 30,219,9216
MV 144,v,32,v,48
buffer_load_dwordx4 v209, s[44:47], s75 offen offset:1024 lds
v_accvgpr_read_b32 v234, a160
MV 148,v,32,v,52
v_accvgpr_read_b32 v235, a161
MV 152,v,32,v,56
ds_read_b128 v[76:79], v227 offset:6144
v_accvgpr_read_b32 v236, a162
MV 156,v,32,v,60
TR 32,220,8192
TR 34,220,9216
MV 160,v,36,v,48
buffer_load_dwordx4 v210, s[44:47], s75 offen offset:2048 lds
v_accvgpr_read_b32 v237, a163
MV 164,v,36,v,52
v_accvgpr_read_b32 v238, a164
MV 168,v,36,v,56
buffer_load_dwordx4 v211, s[44:47], s75 offen offset:3072 lds
v_accvgpr_read_b32 v239, a165
MV 172,v,36,v,60
TR 36,221,8192
TR 38,221,9216
s_waitcnt lgkmcnt(15)
MV 176,v,40,v,48
v_accvgpr_read_b32 v240, a166
MV 180,v,40,v,52
s_add_u32 s74, s74, 128
v_accvgpr_read_b32 v241, a167
MV 184,v,40,v,56
MV 188,v,40,v,60
TR 40,222,8192
TR 42,222,9216
MV 192,v,44,v,48
s_and_b32 s74, s74, 2047
v_cvt_pk_bf16_f32 v230, v234, v235
MV 196,v,44,v,52
v_cvt_pk_bf16_f32 v231, v236, v237
MV 200,v,44,v,56
MV 204,v,44,v,60
TR 44,223,8192
TR 46,223,9216
s_waitcnt lgkmcnt(4)
MV 80,v,16,v,64
v_cvt_pk_bf16_f32 v232, v238, v239
MV 84,v,16,v,68
v_cvt_pk_bf16_f32 v233, v240, v241
MV 88,v,16,v,72
s_add_u32 s24, s24, 4096
MV 92,v,16,v,76
MV 96,v,20,v,64
buffer_store_dwordx4 v[230:233], v228, s[16:19], s24 offen offset:0 sc1
MV 100,v,20,v,68
v_accvgpr_read_b32 v246, a168
MV 104,v,20,v,72
v_accvgpr_read_b32 v247, a169
MV 108,v,20,v,76
s_waitcnt vmcnt(16) lgkmcnt(0)
s_barrier
MV 112,v,24,v,64
TR 16,216,16384
TR 18,216,17408
MV 116,v,24,v,68
ds_read_b128 v[48:51], v224 offset:0
s_add_u32 m0, s68, 98304
MV 120,v,24,v,72
TR 20,217,16384
TR 22,217,17408
MV 124,v,24,v,76
buffer_load_dwordx4 v212, s[48:51], s66 offen offset:0 lds
v_accvgpr_read_b32 v248, a170
MV 128,v,28,v,64
TR 24,218,16384
TR 26,218,17408
MV 132,v,28,v,68
ds_read_b128 v[52:55], v224 offset:2048
buffer_load_dwordx4 v213, s[48:51], s66 offen offset:1024 lds
MV 136,v,28,v,72
buffer_load_dwordx4 v214, s[48:51], s66 offen offset:2048 lds
v_accvgpr_read_b32 v249, a171
MV 140,v,28,v,76
TR 28,219,16384
TR 30,219,17408
MV 144,v,32,v,64
ds_read_b128 v[56:59], v224 offset:4096
v_accvgpr_read_b32 v250, a172
MV 148,v,32,v,68
buffer_load_dwordx4 v215, s[48:51], s66 offen offset:3072 lds
v_accvgpr_read_b32 v251, a173
MV 152,v,32,v,72
v_accvgpr_read_b32 v252, a174
v_accvgpr_read_b32 v253, a175
MV 156,v,32,v,76
TR 32,220,16384
TR 34,220,17408
MV 160,v,36,v,64
ds_read_b128 v[60:63], v224 offset:6144
s_add_u32 s66, s66, 524288
MV 164,v,36,v,68
s_and_b32 s66, s66, 8388607
v_cvt_pk_bf16_f32 v242, v246, v247
MV 168,v,36,v,72
v_cvt_pk_bf16_f32 v243, v248, v249
v_cvt_pk_bf16_f32 v244, v250, v251
MV 172,v,36,v,76
TR 36,221,16384
TR 38,221,17408
MV 176,v,40,v,64
s_add_u32 s75, s64, s74
v_cvt_pk_bf16_f32 v245, v252, v253
MV 180,v,40,v,68
buffer_store_dwordx4 v[242:245], v228, s[16:19], s24 offen offset:1024 sc1
v_accvgpr_read_b32 v234, a176
MV 184,v,40,v,72
s_add_u32 m0, s67, 65536
v_accvgpr_read_b32 v235, a177
MV 188,v,40,v,76
TR 40,222,16384
TR 42,222,17408
MV 192,v,44,v,64
buffer_load_dwordx4 v208, s[44:47], s75 offen offset:0 lds
v_accvgpr_read_b32 v236, a178
MV 196,v,44,v,68
v_accvgpr_read_b32 v237, a179
v_accvgpr_read_b32 v238, a180
MV 200,v,44,v,72
MV 204,v,44,v,76
TR 44,223,16384
TR 46,223,17408
s_waitcnt lgkmcnt(4)
MV 80,v,16,v,48
buffer_load_dwordx4 v209, s[44:47], s75 offen offset:1024 lds
v_accvgpr_read_b32 v239, a181
MV 84,v,16,v,52
ds_read_b128 v[64:67], v225 offset:0
v_accvgpr_read_b32 v240, a182
MV 88,v,16,v,56
buffer_load_dwordx4 v210, s[44:47], s75 offen offset:2048 lds
v_accvgpr_read_b32 v241, a183
MV 92,v,16,v,60
TR 16,216,24576
TR 18,216,25600
MV 96,v,20,v,48
v_cvt_pk_bf16_f32 v230, v234, v235
MV 100,v,20,v,52
buffer_load_dwordx4 v211, s[44:47], s75 offen offset:3072 lds
v_cvt_pk_bf16_f32 v231, v236, v237
MV 104,v,20,v,56
ds_read_b128 v[68:71], v225 offset:2048
v_cvt_pk_bf16_f32 v232, v238, v239
MV 108,v,20,v,60
TR 20,217,24576
TR 22,217,25600
MV 112,v,24,v,48
s_add_u32 s75, s65, s74
v_cvt_pk_bf16_f32 v233, v240, v241
MV 116,v,24,v,52
buffer_store_dwordx4 v[230:233], v228, s[16:19], s24 offen offset:2048 sc1
MV 120,v,24,v,56
v_accvgpr_read_b32 v246, a184
MV 124,v,24,v,60
TR 24,218,24576
TR 26,218,25600
MV 128,v,28,v,48
ds_read_b128 v[72:75], v225 offset:4096
s_add_u32 m0, s67, 69632
MV 132,v,28,v,52
v_accvgpr_read_b32 v247, a185
v_accvgpr_read_b32 v248, a186
MV 136,v,28,v,56
buffer_load_dwordx4 v208, s[44:47], s75 offen offset:0 lds
MV 140,v,28,v,60
TR 28,219,24576
TR 30,219,25600
MV 144,v,32,v,48
buffer_load_dwordx4 v209, s[44:47], s75 offen offset:1024 lds
v_accvgpr_read_b32 v249, a187
MV 148,v,32,v,52
v_accvgpr_read_b32 v250, a188
v_accvgpr_read_b32 v251, a189
MV 152,v,32,v,56
ds_read_b128 v[76:79], v225 offset:6144
MV 156,v,32,v,60
TR 32,220,24576
TR 34,220,25600
MV 160,v,36,v,48
buffer_load_dwordx4 v210, s[44:47], s75 offen offset:2048 lds
v_accvgpr_read_b32 v252, a190
MV 164,v,36,v,52
v_accvgpr_read_b32 v253, a191
v_cvt_pk_bf16_f32 v242, v246, v247
MV 168,v,36,v,56
buffer_load_dwordx4 v211, s[44:47], s75 offen offset:3072 lds
MV 172,v,36,v,60
TR 36,221,24576
TR 38,221,25600
s_waitcnt lgkmcnt(15)
MV 176,v,40,v,48
v_cvt_pk_bf16_f32 v243, v248, v249
v_cvt_pk_bf16_f32 v244, v250, v251
MV 180,v,40,v,52
s_add_u32 s74, s74, 128
v_cvt_pk_bf16_f32 v245, v252, v253
MV 184,v,40,v,56
MV 188,v,40,v,60
TR 40,222,24576
TR 42,222,25600
MV 192,v,44,v,48
s_and_b32 s74, s74, 2047
buffer_store_dwordx4 v[242:245], v228, s[16:19], s24 offen offset:3072 sc1
MV 196,v,44,v,52
buffer_load_dword v254, off, s[12:15], 0 sc1
MV 200,v,44,v,56
MV 204,v,44,v,60
TR 44,223,24576
TR 46,223,25600
s_waitcnt lgkmcnt(4)
MV 80,v,16,v,64
v_accvgpr_read_b32 v234, a192
MV 84,v,16,v,68
v_accvgpr_read_b32 v235, a193
MV 88,v,16,v,72
v_accvgpr_read_b32 v236, a194
MV 92,v,16,v,76
MV 96,v,20,v,64
v_accvgpr_read_b32 v237, a195
MV 100,v,20,v,68
v_accvgpr_read_b32 v238, a196
MV 104,v,20,v,72
MV 108,v,20,v,76
s_waitcnt vmcnt(17) lgkmcnt(0)
s_barrier
MV 112,v,24,v,64
TR 16,216,32768
TR 18,216,33792
MV 116,v,24,v,68
ds_read_b128 v[48:51], v224 offset:32768
s_add_u32 m0, s68, 114688
MV 120,v,24,v,72
TR 20,217,32768
TR 22,217,33792
MV 124,v,24,v,76
buffer_load_dwordx4 v212, s[48:51], s66 offen offset:0 lds
v_accvgpr_read_b32 v239, a197
MV 128,v,28,v,64
TR 24,218,32768
TR 26,218,33792
MV 132,v,28,v,68
ds_read_b128 v[52:55], v224 offset:34816
buffer_load_dwordx4 v213, s[48:51], s66 offen offset:1024 lds
MV 136,v,28,v,72
buffer_load_dwordx4 v214, s[48:51], s66 offen offset:2048 lds
v_accvgpr_read_b32 v240, a198
MV 140,v,28,v,76
TR 28,219,32768
TR 30,219,33792
MV 144,v,32,v,64
ds_read_b128 v[56:59], v224 offset:36864
v_accvgpr_read_b32 v241, a199
MV 148,v,32,v,68
buffer_load_dwordx4 v215, s[48:51], s66 offen offset:3072 lds
v_cvt_pk_bf16_f32 v230, v234, v235
MV 152,v,32,v,72
v_cvt_pk_bf16_f32 v231, v236, v237
v_cvt_pk_bf16_f32 v232, v238, v239
MV 156,v,32,v,76
TR 32,220,32768
TR 34,220,33792
MV 160,v,36,v,64
ds_read_b128 v[60:63], v224 offset:38912
s_add_u32 s66, s66, 524288
MV 164,v,36,v,68
s_and_b32 s66, s66, 8388607
v_cvt_pk_bf16_f32 v233, v240, v241
MV 168,v,36,v,72
s_add_u32 s24, s24, 4096
buffer_store_dwordx4 v[230:233], v228, s[16:19], s24 offen offset:0 sc1
MV 172,v,36,v,76
TR 36,221,32768
TR 38,221,33792
MV 176,v,40,v,64
s_add_u32 s75, s64, s74
v_accvgpr_read_b32 v246, a200
MV 180,v,40,v,68
v_accvgpr_read_b32 v247, a201
v_accvgpr_read_b32 v248, a202
MV 184,v,40,v,72
s_add_u32 m0, s67, 0
v_accvgpr_read_b32 v249, a203
MV 188,v,40,v,76
TR 40,222,32768
TR 42,222,33792
MV 192,v,44,v,64
buffer_load_dwordx4 v208, s[44:47], s75 offen offset:0 lds
v_accvgpr_read_b32 v250, a204
MV 196,v,44,v,68
v_accvgpr_read_b32 v251, a205
v_accvgpr_read_b32 v252, a206
MV 200,v,44,v,72
MV 204,v,44,v,76
TR 44,223,32768
TR 46,223,33792
s_waitcnt lgkmcnt(4)
MV 80,v,16,v,48
buffer_load_dwordx4 v209, s[44:47], s75 offen offset:1024 lds
v_accvgpr_read_b32 v253, a207
MV 84,v,16,v,52
ds_read_b128 v[64:67], v225 offset:32768
v_cvt_pk_bf16_f32 v242, v246, v247
MV 88,v,16,v,56
buffer_load_dwordx4 v210, s[44:47], s75 offen offset:2048 lds
v_cvt_pk_bf16_f32 v243, v248, v249
MV 92,v,16,v,60
TR 16,216,40960
TR 18,216,41984
MV 96,v,20,v,48
v_cvt_pk_bf16_f32 v244, v250, v251
MV 100,v,20,v,52
buffer_load_dwordx4 v211, s[44:47], s75 offen offset:3072 lds
v_cvt_pk_bf16_f32 v245, v252, v253
MV 104,v,20,v,56
ds_read_b128 v[68:71], v225 offset:34816
MV 108,v,20,v,60
TR 20,217,40960
TR 22,217,41984
MV 112,v,24,v,48
s_add_u32 s75, s65, s74
buffer_store_dwordx4 v[242:245], v228, s[16:19], s24 offen offset:1024 sc1
MV 116,v,24,v,52
v_accvgpr_read_b32 v234, a208
MV 120,v,24,v,56
v_accvgpr_read_b32 v235, a209
MV 124,v,24,v,60
TR 24,218,40960
TR 26,218,41984
MV 128,v,28,v,48
ds_read_b128 v[72:75], v225 offset:36864
s_add_u32 m0, s67, 4096
MV 132,v,28,v,52
v_accvgpr_read_b32 v236, a210
v_accvgpr_read_b32 v237, a211
MV 136,v,28,v,56
buffer_load_dwordx4 v208, s[44:47], s75 offen offset:0 lds
v_accvgpr_read_b32 v238, a212
MV 140,v,28,v,60
TR 28,219,40960
TR 30,219,41984
MV 144,v,32,v,48
buffer_load_dwordx4 v209, s[44:47], s75 offen offset:1024 lds
v_accvgpr_read_b32 v239, a213
MV 148,v,32,v,52
v_accvgpr_read_b32 v240, a214
MV 152,v,32,v,56
ds_read_b128 v[76:79], v225 offset:38912
v_accvgpr_read_b32 v241, a215
MV 156,v,32,v,60
TR 32,220,40960
TR 34,220,41984
MV 160,v,36,v,48
buffer_load_dwordx4 v210, s[44:47], s75 offen offset:2048 lds
v_cvt_pk_bf16_f32 v230, v234, v235
MV 164,v,36,v,52
v_cvt_pk_bf16_f32 v231, v236, v237
MV 168,v,36,v,56
buffer_load_dwordx4 v211, s[44:47], s75 offen offset:3072 lds
v_cvt_pk_bf16_f32 v232, v238, v239
MV 172,v,36,v,60
TR 36,221,40960
TR 38,221,41984
s_waitcnt lgkmcnt(15)
MV 176,v,40,v,48
v_cvt_pk_bf16_f32 v233, v240, v241
MV 180,v,40,v,52
s_add_u32 s74, s74, 128
buffer_store_dwordx4 v[230:233], v228, s[16:19], s24 offen offset:2048 sc1
MV 184,v,40,v,56
MV 188,v,40,v,60
TR 40,222,40960
TR 42,222,41984
MV 192,v,44,v,48
s_and_b32 s74, s74, 2047
v_accvgpr_read_b32 v246, a216
MV 196,v,44,v,52
v_accvgpr_read_b32 v247, a217
MV 200,v,44,v,56
MV 204,v,44,v,60
TR 44,223,40960
TR 46,223,41984
s_waitcnt lgkmcnt(4)
MV 80,v,16,v,64
v_accvgpr_read_b32 v248, a218
MV 84,v,16,v,68
v_accvgpr_read_b32 v249, a219
MV 88,v,16,v,72
v_accvgpr_read_b32 v250, a220
MV 92,v,16,v,76
MV 96,v,20,v,64
v_accvgpr_read_b32 v251, a221
MV 100,v,20,v,68
v_accvgpr_read_b32 v252, a222
MV 104,v,20,v,72
MV 108,v,20,v,76
s_waitcnt vmcnt(17) lgkmcnt(0)
s_barrier
MV 112,v,24,v,64
TR 16,216,0
TR 18,216,1024
MV 116,v,24,v,68
ds_read_b128 v[48:51], v226 offset:0
s_add_u32 m0, s68, 131072
MV 120,v,24,v,72
TR 20,217,0
TR 22,217,1024
MV 124,v,24,v,76
buffer_load_dwordx4 v212, s[48:51], s66 offen offset:0 lds
v_accvgpr_read_b32 v253, a223
MV 128,v,28,v,64
TR 24,218,0
TR 26,218,1024
MV 132,v,28,v,68
ds_read_b128 v[52:55], v226 offset:2048
buffer_load_dwordx4 v213, s[48:51], s66 offen offset:1024 lds
MV 136,v,28,v,72
buffer_load_dwordx4 v214, s[48:51], s66 offen offset:2048 lds
v_cvt_pk_bf16_f32 v242, v246, v247
MV 140,v,28,v,76
TR 28,219,0
TR 30,219,1024
MV 144,v,32,v,64
ds_read_b128 v[56:59], v226 offset:4096
v_cvt_pk_bf16_f32 v243, v248, v249
MV 148,v,32,v,68
buffer_load_dwordx4 v215, s[48:51], s66 offen offset:3072 lds
v_cvt_pk_bf16_f32 v244, v250, v251
MV 152,v,32,v,72
v_cvt_pk_bf16_f32 v245, v252, v253
buffer_store_dwordx4 v[242:245], v228, s[16:19], s24 offen offset:3072 sc1
MV 156,v,32,v,76
TR 32,220,0
TR 34,220,1024
MV 160,v,36,v,64
ds_read_b128 v[60:63], v226 offset:6144
s_add_u32 s66, s66, 524288
MV 164,v,36,v,68
s_and_b32 s66, s66, 8388607
v_accvgpr_read_b32 v234, a224
MV 168,v,36,v,72
v_accvgpr_read_b32 v235, a225
v_accvgpr_read_b32 v236, a226
MV 172,v,36,v,76
TR 36,221,0
TR 38,221,1024
MV 176,v,40,v,64
s_add_u32 s75, s64, s74
v_accvgpr_read_b32 v237, a227
MV 180,v,40,v,68
v_accvgpr_read_b32 v238, a228
v_accvgpr_read_b32 v239, a229
MV 184,v,40,v,72
s_add_u32 m0, s67, 32768
v_accvgpr_read_b32 v240, a230
MV 188,v,40,v,76
TR 40,222,0
TR 42,222,1024
MV 192,v,44,v,64
buffer_load_dwordx4 v208, s[44:47], s75 offen offset:0 lds
v_accvgpr_read_b32 v241, a231
MV 196,v,44,v,68
v_cvt_pk_bf16_f32 v230, v234, v235
v_cvt_pk_bf16_f32 v231, v236, v237
MV 200,v,44,v,72
MV 204,v,44,v,76
TR 44,223,0
TR 46,223,1024
s_waitcnt lgkmcnt(4)
MV 80,v,16,v,48
buffer_load_dwordx4 v209, s[44:47], s75 offen offset:1024 lds
v_cvt_pk_bf16_f32 v232, v238, v239
MV 84,v,16,v,52
ds_read_b128 v[64:67], v227 offset:0
v_cvt_pk_bf16_f32 v233, v240, v241
MV 88,v,16,v,56
buffer_load_dwordx4 v210, s[44:47], s75 offen offset:2048 lds
s_add_u32 s24, s24, 4096
MV 92,v,16,v,60
TR 16,216,8192
TR 18,216,9216
MV 96,v,20,v,48
buffer_store_dwordx4 v[230:233], v228, s[16:19], s24 offen offset:0 sc1
MV 100,v,20,v,52
buffer_load_dwordx4 v211, s[44:47], s75 offen offset:3072 lds
v_accvgpr_read_b32 v246, a232
MV 104,v,20,v,56
ds_read_b128 v[68:71], v227 offset:2048
MV 108,v,20,v,60
TR 20,217,8192
TR 22,217,9216
MV 112,v,24,v,48
s_add_u32 s75, s65, s74
v_accvgpr_read_b32 v247, a233
MV 116,v,24,v,52
v_accvgpr_read_b32 v248, a234
MV 120,v,24,v,56
v_accvgpr_read_b32 v249, a235
MV 124,v,24,v,60
TR 24,218,8192
TR 26,218,9216
MV 128,v,28,v,48
ds_read_b128 v[72:75], v227 offset:4096
s_add_u32 m0, s67, 36864
MV 132,v,28,v,52
v_accvgpr_read_b32 v250, a236
v_accvgpr_read_b32 v251, a237
MV 136,v,28,v,56
buffer_load_dwordx4 v208, s[44:47], s75 offen offset:0 lds
v_accvgpr_read_b32 v252, a238
MV 140,v,28,v,60
TR 28,219,8192
TR 30,219,9216
MV 144,v,32,v,48
buffer_load_dwordx4 v209, s[44:47], s75 offen offset:1024 lds
v_accvgpr_read_b32 v253, a239
MV 148,v,32,v,52
v_cvt_pk_bf16_f32 v242, v246, v247
MV 152,v,32,v,56
ds_read_b128 v[76:79], v227 offset:6144
v_cvt_pk_bf16_f32 v243, v248, v249
MV 156,v,32,v,60
TR 32,220,8192
TR 34,220,9216
MV 160,v,36,v,48
buffer_load_dwordx4 v210, s[44:47], s75 offen offset:2048 lds
v_cvt_pk_bf16_f32 v244, v250, v251
MV 164,v,36,v,52
v_cvt_pk_bf16_f32 v245, v252, v253
MV 168,v,36,v,56
buffer_load_dwordx4 v211, s[44:47], s75 offen offset:3072 lds
buffer_store_dwordx4 v[242:245], v228, s[16:19], s24 offen offset:1024 sc1
MV 172,v,36,v,60
TR 36,221,8192
TR 38,221,9216
s_waitcnt lgkmcnt(15)
MV 176,v,40,v,48
v_accvgpr_read_b32 v234, a240
MV 180,v,40,v,52
s_add_u32 s74, s74, 128
v_accvgpr_read_b32 v235, a241
MV 184,v,40,v,56
MV 188,v,40,v,60
TR 40,222,8192
TR 42,222,9216
MV 192,v,44,v,48
s_and_b32 s74, s74, 2047
v_accvgpr_read_b32 v236, a242
MV 196,v,44,v,52
v_accvgpr_read_b32 v237, a243
MV 200,v,44,v,56
MV 204,v,44,v,60
TR 44,223,8192
TR 46,223,9216
s_waitcnt lgkmcnt(4)
MV 80,v,16,v,64
v_accvgpr_read_b32 v238, a244
MV 84,v,16,v,68
v_accvgpr_read_b32 v239, a245
MV 88,v,16,v,72
v_accvgpr_read_b32 v240, a246
MV 92,v,16,v,76
MV 96,v,20,v,64
v_accvgpr_read_b32 v241, a247
MV 100,v,20,v,68
v_cvt_pk_bf16_f32 v230, v234, v235
MV 104,v,20,v,72
v_cvt_pk_bf16_f32 v231, v236, v237
MV 108,v,20,v,76
s_waitcnt vmcnt(16) lgkmcnt(0)
s_barrier
MV 112,v,24,v,64
TR 16,216,16384
TR 18,216,17408
MV 116,v,24,v,68
ds_read_b128 v[48:51], v224 offset:0
s_add_u32 m0, s68, 98304
MV 120,v,24,v,72
TR 20,217,16384
TR 22,217,17408
MV 124,v,24,v,76
buffer_load_dwordx4 v212, s[48:51], s66 offen offset:0 lds
v_cvt_pk_bf16_f32 v232, v238, v239
MV 128,v,28,v,64
TR 24,218,16384
TR 26,218,17408
MV 132,v,28,v,68
ds_read_b128 v[52:55], v224 offset:2048
buffer_load_dwordx4 v213, s[48:51], s66 offen offset:1024 lds
MV 136,v,28,v,72
buffer_load_dwordx4 v214, s[48:51], s66 offen offset:2048 lds
v_cvt_pk_bf16_f32 v233, v240, v241
MV 140,v,28,v,76
TR 28,219,16384
TR 30,219,17408
MV 144,v,32,v,64
ds_read_b128 v[56:59], v224 offset:4096
buffer_store_dwordx4 v[230:233], v228, s[16:19], s24 offen offset:2048 sc1
MV 148,v,32,v,68
buffer_load_dwordx4 v215, s[48:51], s66 offen offset:3072 lds
v_accvgpr_read_b32 v246, a248
MV 152,v,32,v,72
v_accvgpr_read_b32 v247, a249
v_accvgpr_read_b32 v248, a250
MV 156,v,32,v,76
TR 32,220,16384
TR 34,220,17408
MV 160,v,36,v,64
ds_read_b128 v[60:63], v224 offset:6144
s_add_u32 s66, s66, 524288
MV 164,v,36,v,68
s_and_b32 s66, s66, 8388607
v_accvgpr_read_b32 v249, a251
MV 168,v,36,v,72
v_accvgpr_read_b32 v250, a252
v_accvgpr_read_b32 v251, a253
MV 172,v,36,v,76
TR 36,221,16384
TR 38,221,17408
MV 176,v,40,v,64
s_add_u32 s75, s64, s74
v_accvgpr_read_b32 v252, a254
MV 180,v,40,v,68
v_accvgpr_read_b32 v253, a255
v_cvt_pk_bf16_f32 v242, v246, v247
MV 184,v,40,v,72
s_add_u32 m0, s67, 65536
v_cvt_pk_bf16_f32 v243, v248, v249
MV 188,v,40,v,76
TR 40,222,16384
TR 42,222,17408
MV 192,v,44,v,64
buffer_load_dwordx4 v208, s[44:47], s75 offen offset:0 lds
v_cvt_pk_bf16_f32 v244, v250, v251
MV 196,v,44,v,68
v_cvt_pk_bf16_f32 v245, v252, v253
buffer_store_dwordx4 v[242:245], v228, s[16:19], s24 offen offset:3072 sc1
MV 200,v,44,v,72
MV 204,v,44,v,76
TR 44,223,16384
TR 46,223,17408
s_waitcnt lgkmcnt(4)
MV 80,v,16,v,48
buffer_load_dwordx4 v209, s[44:47], s75 offen offset:1024 lds
v_lshlrev_b32 v255, 20, v1
MV 84,v,16,v,52
ds_read_b128 v[64:67], v225 offset:0
MV 88,v,16,v,56
buffer_load_dwordx4 v210, s[44:47], s75 offen offset:2048 lds
MV 92,v,16,v,60
TR 16,216,24576
TR 18,216,25600
MV 96,v,20,v,48
MV 100,v,20,v,52
buffer_load_dwordx4 v211, s[44:47], s75 offen offset:3072 lds
MV 104,v,20,v,56
ds_read_b128 v[68:71], v225 offset:2048
MV 108,v,20,v,60
TR 20,217,24576
TR 22,217,25600
MV 112,v,24,v,48
s_add_u32 s75, s65, s74
MV 116,v,24,v,52
MV 120,v,24,v,56
s_lshl_b32 s36, s3, 26
MV 124,v,24,v,60
TR 24,218,24576
TR 26,218,25600
MV 128,v,28,v,48
ds_read_b128 v[72:75], v225 offset:4096
s_add_u32 m0, s67, 69632
MV 132,v,28,v,52
MV 136,v,28,v,56
buffer_load_dwordx4 v208, s[44:47], s75 offen offset:0 lds
MV 140,v,28,v,60
TR 28,219,24576
TR 30,219,25600
MV 144,v,32,v,48
buffer_load_dwordx4 v209, s[44:47], s75 offen offset:1024 lds
MV 148,v,32,v,52
MV 152,v,32,v,56
ds_read_b128 v[76:79], v225 offset:6144
MV 156,v,32,v,60
TR 32,220,24576
TR 34,220,25600
MV 160,v,36,v,48
buffer_load_dwordx4 v210, s[44:47], s75 offen offset:2048 lds
v_add_u32 v255, s36, v255
MV 164,v,36,v,52
MV 168,v,36,v,56
buffer_load_dwordx4 v211, s[44:47], s75 offen offset:3072 lds
MV 172,v,36,v,60
TR 36,221,24576
TR 38,221,25600
s_waitcnt lgkmcnt(15)
MV 176,v,40,v,48
MV 180,v,40,v,52
s_add_u32 s74, s74, 128
MV 184,v,40,v,56
MV 188,v,40,v,60
TR 40,222,24576
TR 42,222,25600
MV 192,v,44,v,48
s_and_b32 s74, s74, 2047
MV 196,v,44,v,52
MV 200,v,44,v,56
MV 204,v,44,v,60
TR 44,223,24576
TR 46,223,25600
s_waitcnt lgkmcnt(4)
MV 80,v,16,v,64
v_lshlrev_b32 v230, 4, v1
MV 84,v,16,v,68
s_lshl_b32 s80, s3, 12
MV 88,v,16,v,72
MV 92,v,16,v,76
v_add_u32 v12, s80, v230
MV 96,v,20,v,64
MV 100,v,20,v,68
v_add_u32 v10, 0x8000, v230
MV 104,v,20,v,72
MV 108,v,20,v,76
s_waitcnt vmcnt(15) lgkmcnt(0)
s_barrier
MV 112,v,24,v,64
TR 16,216,32768
TR 18,216,33792
MV 116,v,24,v,68
ds_read_b128 v[48:51], v224 offset:32768
s_add_u32 m0, s68, 114688
MV 120,v,24,v,72
TR 20,217,32768
TR 22,217,33792
MV 124,v,24,v,76
buffer_load_dwordx4 v212, s[48:51], s66 offen offset:0 lds
v_add_u32 v11, 0x10000, v230
MV 128,v,28,v,64
TR 24,218,32768
TR 26,218,33792
MV 132,v,28,v,68
ds_read_b128 v[52:55], v224 offset:34816
buffer_load_dwordx4 v213, s[48:51], s66 offen offset:1024 lds
MV 136,v,28,v,72
buffer_load_dwordx4 v214, s[48:51], s66 offen offset:2048 lds
s_add_u32 s72, s80, 0x8000
MV 140,v,28,v,76
TR 28,219,32768
TR 30,219,33792
MV 144,v,32,v,64
ds_read_b128 v[56:59], v224 offset:36864
s_add_u32 s73, s80, 0x10000
MV 148,v,32,v,68
buffer_load_dwordx4 v215, s[48:51], s66 offen offset:3072 lds
v_mov_b32 v15, v230
MV 152,v,32,v,72
v_and_b32 v230, 15, v1
v_lshrrev_b32 v232, 4, v1
MV 156,v,32,v,76
TR 32,220,32768
TR 34,220,33792
MV 160,v,36,v,64
ds_read_b128 v[60:63], v224 offset:38912
s_add_u32 s66, s66, 524288
MV 164,v,36,v,68
s_and_b32 s66, s66, 8388607
v_lshlrev_b32 v232, 2, v232
MV 168,v,36,v,72
v_sub_u32 v230, v230, v232
s_lshl_b32 s81, s3, 4
MV 172,v,36,v,76
TR 36,221,32768
TR 38,221,33792
MV 176,v,40,v,64
s_add_u32 s75, s64, s74
v_add_u32 v13, s81, v230
MV 180,v,40,v,68
s_sub_u32 s81, 112, s81
MV 184,v,40,v,72
s_add_u32 m0, s67, 0
v_add_u32 v239, s81, v230
MV 188,v,40,v,76
TR 40,222,32768
TR 42,222,33792
MV 192,v,44,v,64
buffer_load_dwordx4 v208, s[44:47], s75 offen offset:0 lds
v_mov_b32 v14, 0xff800000
MV 196,v,44,v,68
MV 200,v,44,v,72
MV 204,v,44,v,76
TR 44,223,32768
TR 46,223,33792
s_waitcnt lgkmcnt(4)
MV 80,v,16,v,48
buffer_load_dwordx4 v209, s[44:47], s75 offen offset:1024 lds
s_getpc_b64 s[38:39]
L_ct_a:
MV 84,v,16,v,52
ds_read_b128 v[64:67], v225 offset:32768
MV 88,v,16,v,56
buffer_load_dwordx4 v210, s[44:47], s75 offen offset:2048 lds
MV 92,v,16,v,60
TR 16,216,40960
TR 18,216,41984
MV 96,v,20,v,48
s_add_u32 s38, s38, L_p3_begin - L_ct_a
s_addc_u32 s39, s39, 0
MV 100,v,20,v,52
buffer_load_dwordx4 v211, s[44:47], s75 offen offset:3072 lds
v_mov_b32 v229, s39
MV 104,v,20,v,56
ds_read_b128 v[68:71], v225 offset:34816
v_mov_b32 v228, s38
MV 108,v,20,v,60
TR 20,217,40960
TR 22,217,41984
MV 112,v,24,v,48
s_add_u32 s75, s65, s74
s_lshr_b32 s38, s2, 3
MV 116,v,24,v,52
MV 120,v,24,v,56
s_lshl_b32 s38, s38, 2
MV 124,v,24,v,60
TR 24,218,40960
TR 26,218,41984
MV 128,v,28,v,48
ds_read_b128 v[72:75], v225 offset:36864
s_add_u32 m0, s67, 4096
MV 132,v,28,v,52
s_add_u32 s38, s38, s3
s_lshl_b32 s38, s38, 7
MV 136,v,28,v,56
buffer_load_dwordx4 v208, s[44:47], s75 offen offset:0 lds
MV 140,v,28,v,60
TR 28,219,40960
TR 30,219,41984
MV 144,v,32,v,48
buffer_load_dwordx4 v209, s[44:47], s75 offen offset:1024 lds
v_and_b32 v238, 3, v1
MV 148,v,32,v,52
v_lshlrev_b32 v238, 14, v238
MV 152,v,32,v,56
ds_read_b128 v[76:79], v225 offset:38912
v_add_u32 v238, s38, v238
MV 156,v,32,v,60
TR 32,220,40960
TR 34,220,41984
MV 160,v,36,v,48
buffer_load_dwordx4 v210, s[44:47], s75 offen offset:2048 lds
v_min_u32 v238, L_p3_s1m_top - L_p3_begin - 4, v238
MV 164,v,36,v,52
v_add_co_u32 v228, vcc, v228, v238
s_nop 1
v_addc_co_u32 v229, vcc, 0, v229, vcc
MV 168,v,36,v,56
buffer_load_dwordx4 v211, s[44:47], s75 offen offset:3072 lds
MV 172,v,36,v,60
TR 36,221,40960
TR 38,221,41984
s_waitcnt lgkmcnt(15)
MV 176,v,40,v,48
MV 180,v,40,v,52
s_add_u32 s74, s74, 128
MV 184,v,40,v,56
MV 188,v,40,v,60
TR 40,222,40960
TR 42,222,41984
MV 192,v,44,v,48
s_and_b32 s74, s74, 2047
global_load_dword v238, v[228:229], off
MV 196,v,44,v,52
MV 200,v,44,v,56
MV 204,v,44,v,60
TR 44,223,40960
TR 46,223,41984
s_waitcnt lgkmcnt(4)
MV 80,v,16,v,64
MV 84,v,16,v,68
MV 88,v,16,v,72
MV 92,v,16,v,76
MV 96,v,20,v,64
MV 100,v,20,v,68
MV 104,v,20,v,72
MV 108,v,20,v,76
s_waitcnt vmcnt(13) lgkmcnt(0)
s_barrier
MV 112,v,24,v,64
v_cmp_gt_u32 vcc, 1, v254
s_nop 4
s_cbranch_vccnz L_spin_go
L_spin_go_ret:
v_mov_b32 v254, 1
s_lshl_b32 s36, s2, 2
buffer_store_dword v254, v255, s[8:11], s36 offen offset:0 sc1
s_load_dwordx4 s[32:35], s[0:1], 32
MV 116,v,24,v,68
TR 16,216,0
TR 18,216,1024
MV 120,v,24,v,72
TR 20,217,0
TR 22,217,1024
MV 124,v,24,v,76
ds_read_b128 v[48:51], v226 offset:0
s_add_u32 m0, s68, 131072
MV 128,v,28,v,64
TR 24,218,0
TR 26,218,1024
MV 132,v,28,v,68
ds_read_b128 v[52:55], v226 offset:2048
buffer_load_dwordx4 v212, s[48:51], s66 offen offset:0 lds
MV 136,v,28,v,72
buffer_load_dwordx4 v213, s[48:51], s66 offen offset:1024 lds
buffer_load_dwordx4 v214, s[48:51], s66 offen offset:2048 lds
MV 140,v,28,v,76
TR 28,219,0
TR 30,219,1024
MV 144,v,32,v,64
ds_read_b128 v[56:59], v226 offset:4096
MV 148,v,32,v,68
buffer_load_dwordx4 v215, s[48:51], s66 offen offset:3072 lds
MV 152,v,32,v,72
MV 156,v,32,v,76
TR 32,220,0
TR 34,220,1024
MV 160,v,36,v,64
ds_read_b128 v[60:63], v226 offset:6144
s_add_u32 s66, s66, 524288
MV 164,v,36,v,68
s_and_b32 s66, s66, 8388607
MV 168,v,36,v,72
MV 172,v,36,v,76
TR 36,221,0
TR 38,221,1024
MV 176,v,40,v,64
s_add_u32 s75, s64, s74
MV 180,v,40,v,68
MV 184,v,40,v,72
s_add_u32 m0, s67, 32768
MV 188,v,40,v,76
TR 40,222,0
TR 42,222,1024
MV 192,v,44,v,64
buffer_load_dwordx4 v208, s[44:47], s75 offen offset:0 lds
MV 196,v,44,v,68
MV 200,v,44,v,72
MV 204,v,44,v,76
TR 44,223,0
TR 46,223,1024
s_waitcnt lgkmcnt(4)
MV 80,v,16,v,48
buffer_load_dwordx4 v209, s[44:47], s75 offen offset:1024 lds
s_and_b32 s36, s2, 3
MV 84,v,16,v,52
ds_read_b128 v[64:67], v227 offset:0
s_lshl_b32 s36, s36, 1
MV 88,v,16,v,56
buffer_load_dwordx4 v210, s[44:47], s75 offen offset:2048 lds
s_sub_u32 s43, 14, s36
MV 92,v,16,v,60
TR 16,216,8192
TR 18,216,9216
MV 96,v,20,v,48
s_bitcmp1_b32 s2, 4
s_cselect_b32 s36, s43, s36
MV 100,v,20,v,52
buffer_load_dwordx4 v211, s[44:47], s75 offen offset:3072 lds
s_bfe_u32 s43, s2, 0x10003
MV 104,v,20,v,56
ds_read_b128 v[68:71], v227 offset:2048
s_add_u32 s36, s36, s43
MV 108,v,20,v,60
TR 20,217,8192
TR 22,217,9216
MV 112,v,24,v,48
s_add_u32 s75, s65, s74
s_bfe_u32 s37, s2, 0x10002
MV 116,v,24,v,52
s_lshr_b32 s43, s2, 5
s_lshl_b32 s43, s43, 1
MV 120,v,24,v,56
s_add_u32 s37, s37, s43
v_and_b32 v230, 15, v1
MV 124,v,24,v,60
TR 24,218,8192
TR 26,218,9216
MV 128,v,28,v,48
ds_read_b128 v[72:75], v227 offset:4096
s_add_u32 m0, s67, 36864
MV 132,v,28,v,52
s_lshl_b32 s36, s36, 4
v_add_u32 v231, s36, v230
MV 136,v,28,v,56
buffer_load_dwordx4 v208, s[44:47], s75 offen offset:0 lds
s_lshr_b32 s36, s2, 4
MV 140,v,28,v,60
TR 28,219,8192
TR 30,219,9216
MV 144,v,32,v,48
buffer_load_dwordx4 v209, s[44:47], s75 offen offset:1024 lds
v_lshl_add_u32 v232, v230, 4, s36
MV 148,v,32,v,52
v_and_b32 v233, 7, v1
v_bfe_u32 v234, v1, 3, 1
MV 152,v,32,v,56
ds_read_b128 v[76:79], v227 offset:6144
v_lshlrev_b32 v233, 3, v233
MV 156,v,32,v,60
TR 32,220,8192
TR 34,220,9216
MV 160,v,36,v,48
buffer_load_dwordx4 v210, s[44:47], s75 offen offset:2048 lds
v_lshl_add_u32 v233, v234, 7, v233
MV 164,v,36,v,52
s_bfe_u32 s36, s69, 0x10001
s_lshl_b32 s36, s36, 6
MV 168,v,36,v,56
buffer_load_dwordx4 v211, s[44:47], s75 offen offset:3072 lds
s_lshr_b32 s37, s69, 2
MV 172,v,36,v,60
TR 36,221,8192
TR 38,221,9216
s_waitcnt lgkmcnt(15)
MV 176,v,40,v,48
s_add_u32 s36, s36, s37
v_add_u32 v233, s36, v233
MV 180,v,40,v,52
s_add_u32 s74, s74, 128
v_lshrrev_b32 v234, 4, v1
MV 184,v,40,v,56
v_cmp_eq_u32 vcc, 1, v234
s_nop 1
v_cndmask_b32 v233, v233, v232, vcc
MV 188,v,40,v,60
TR 40,222,8192
TR 42,222,9216
MV 192,v,44,v,48
s_and_b32 s74, s74, 2047
MV 196,v,44,v,52
v_cmp_eq_u32 vcc, 2, v234
s_nop 1
v_cndmask_b32 v233, v233, v231, vcc
MV 200,v,44,v,56
v_lshlrev_b32 v233, 2, v233
MV 204,v,44,v,60
TR 44,223,8192
TR 46,223,9216
s_waitcnt lgkmcnt(4)
MV 80,v,16,v,64
MV 84,v,16,v,68
MV 88,v,16,v,72
MV 92,v,16,v,76
MV 96,v,20,v,64
MV 100,v,20,v,68
MV 104,v,20,v,72
MV 108,v,20,v,76
s_waitcnt vmcnt(14) lgkmcnt(0)
s_barrier
MV 112,v,24,v,64
TR 16,216,16384
TR 18,216,17408
MV 116,v,24,v,68
ds_read_b128 v[48:51], v224 offset:0
s_add_u32 m0, s68, 98304
MV 120,v,24,v,72
TR 20,217,16384
TR 22,217,17408
MV 124,v,24,v,76
buffer_load_dwordx4 v212, s[48:51], s66 offen offset:0 lds
MV 128,v,28,v,64
TR 24,218,16384
TR 26,218,17408
MV 132,v,28,v,68
ds_read_b128 v[52:55], v224 offset:2048
buffer_load_dwordx4 v213, s[48:51], s66 offen offset:1024 lds
MV 136,v,28,v,72
buffer_load_dwordx4 v214, s[48:51], s66 offen offset:2048 lds
MV 140,v,28,v,76
TR 28,219,16384
TR 30,219,17408
MV 144,v,32,v,64
ds_read_b128 v[56:59], v224 offset:4096
MV 148,v,32,v,68
buffer_load_dwordx4 v215, s[48:51], s66 offen offset:3072 lds
MV 152,v,32,v,72
MV 156,v,32,v,76
TR 32,220,16384
TR 34,220,17408
MV 160,v,36,v,64
ds_read_b128 v[60:63], v224 offset:6144
s_add_u32 s66, s66, 524288
MV 164,v,36,v,68
s_and_b32 s66, s66, 8388607
MV 168,v,36,v,72
MV 172,v,36,v,76
TR 36,221,16384
TR 38,221,17408
MV 176,v,40,v,64
s_add_u32 s75, s64, s74
MV 180,v,40,v,68
MV 184,v,40,v,72
s_add_u32 m0, s67, 65536
MV 188,v,40,v,76
TR 40,222,16384
TR 42,222,17408
MV 192,v,44,v,64
buffer_load_dwordx4 v208, s[44:47], s75 offen offset:0 lds
MV 196,v,44,v,68
MV 200,v,44,v,72
MV 204,v,44,v,76
TR 44,223,16384
TR 46,223,17408
s_waitcnt lgkmcnt(4)
MV 80,v,16,v,48
buffer_load_dwordx4 v209, s[44:47], s75 offen offset:1024 lds
s_lshl_b32 s36, s2, 2
MV 84,v,16,v,52
ds_read_b128 v[64:67], v225 offset:0
s_add_u32 s36, s36, s3
MV 88,v,16,v,56
buffer_load_dwordx4 v210, s[44:47], s75 offen offset:2048 lds
s_lshl_b32 s42, s36, 1
MV 92,v,16,v,60
TR 16,216,24576
TR 18,216,25600
MV 96,v,20,v,48
s_lshl_b32 s37, s36, 12
MV 100,v,20,v,52
buffer_load_dwordx4 v211, s[44:47], s75 offen offset:3072 lds
MV 104,v,20,v,56
ds_read_b128 v[68:71], v225 offset:2048
MV 108,v,20,v,60
TR 20,217,24576
TR 22,217,25600
MV 112,v,24,v,48
s_add_u32 s75, s65, s74
MV 116,v,24,v,52
s_add_u32 s16, s32, s37
s_addc_u32 s17, s33, 0
MV 120,v,24,v,56
s_mov_b32 s18, 4096
s_mov_b32 s19, 0x20000
MV 124,v,24,v,60
TR 24,218,24576
TR 26,218,25600
MV 128,v,28,v,48
ds_read_b128 v[72:75], v225 offset:4096
s_add_u32 m0, s67, 69632
MV 132,v,28,v,52
s_add_u32 s37, s37, 50331648
MV 136,v,28,v,56
buffer_load_dwordx4 v208, s[44:47], s75 offen offset:0 lds
MV 140,v,28,v,60
TR 28,219,24576
TR 30,219,25600
MV 144,v,32,v,48
buffer_load_dwordx4 v209, s[44:47], s75 offen offset:1024 lds
MV 148,v,32,v,52
s_add_u32 s20, s40, s37
s_addc_u32 s21, s41, 0
MV 152,v,32,v,56
ds_read_b128 v[76:79], v225 offset:6144
s_mov_b32 s22, 4096
MV 156,v,32,v,60
TR 32,220,24576
TR 34,220,25600
MV 160,v,36,v,48
buffer_load_dwordx4 v210, s[44:47], s75 offen offset:2048 lds
s_mov_b32 s23, 0x20000
MV 164,v,36,v,52
s_lshl_b32 s37, s2, 14
s_add_u32 s37, s37, 54525952
MV 168,v,36,v,56
buffer_load_dwordx4 v211, s[44:47], s75 offen offset:3072 lds
MV 172,v,36,v,60
TR 36,221,24576
TR 38,221,25600
s_waitcnt lgkmcnt(15)
MV 176,v,40,v,48
s_add_u32 s24, s40, s37
s_addc_u32 s25, s41, 0
MV 180,v,40,v,52
s_add_u32 s74, s74, 128
s_mov_b32 s26, 16384
MV 184,v,40,v,56
s_mov_b32 s27, 0x20000
s_mov_b32 s28, s34
MV 188,v,40,v,60
TR 40,222,24576
TR 42,222,25600
MV 192,v,44,v,48
s_and_b32 s74, s74, 2047
s_mov_b32 s29, s35
MV 196,v,44,v,52
s_mov_b32 s30, 2048
s_mov_b32 s31, 0x20000
MV 200,v,44,v,56
s_mul_i32 s43, s3, 4608
s_add_u32 s43, s43, 132096
MV 204,v,44,v,60
TR 44,223,24576
TR 46,223,25600
s_waitcnt lgkmcnt(4)
MV 80,v,16,v,64
MV 84,v,16,v,68
MV 88,v,16,v,72
MV 92,v,16,v,76
MV 96,v,20,v,64
MV 100,v,20,v,68
MV 104,v,20,v,72
MV 108,v,20,v,76
s_waitcnt vmcnt(12) lgkmcnt(0)
s_barrier
MV 112,v,24,v,64
s_load_dwordx2 s[32:33], s[0:1], 88
TR 16,216,32768
MV 116,v,24,v,68
TR 18,216,33792
ds_read_b128 v[48:51], v224 offset:32768
MV 120,v,24,v,72
TR 20,217,32768
TR 22,217,33792
MV 124,v,24,v,76
MV 128,v,28,v,64
TR 24,218,32768
TR 26,218,33792
MV 132,v,28,v,68
ds_read_b128 v[52:55], v224 offset:34816
MV 136,v,28,v,72
MV 140,v,28,v,76
TR 28,219,32768
TR 30,219,33792
MV 144,v,32,v,64
ds_read_b128 v[56:59], v224 offset:36864
MV 148,v,32,v,68
MV 152,v,32,v,72
MV 156,v,32,v,76
TR 32,220,32768
TR 34,220,33792
MV 160,v,36,v,64
ds_read_b128 v[60:63], v224 offset:38912
MV 164,v,36,v,68
MV 168,v,36,v,72
MV 172,v,36,v,76
TR 36,221,32768
TR 38,221,33792
MV 176,v,40,v,64
MV 180,v,40,v,68
MV 184,v,40,v,72
MV 188,v,40,v,76
TR 40,222,32768
TR 42,222,33792
MV 192,v,44,v,64
MV 196,v,44,v,68
MV 200,v,44,v,72
MV 204,v,44,v,76
TR 44,223,32768
TR 46,223,33792
s_waitcnt lgkmcnt(4)
MV 80,v,16,v,48
MV 84,v,16,v,52
ds_read_b128 v[64:67], v225 offset:32768
MV 88,v,16,v,56
MV 92,v,16,v,60
TR 16,216,40960
TR 18,216,41984
MV 96,v,20,v,48
MV 100,v,20,v,52
MV 104,v,20,v,56
ds_read_b128 v[68:71], v225 offset:34816
MV 108,v,20,v,60
TR 20,217,40960
TR 22,217,41984
MV 112,v,24,v,48
MV 116,v,24,v,52
MV 120,v,24,v,56
MV 124,v,24,v,60
TR 24,218,40960
TR 26,218,41984
MV 128,v,28,v,48
ds_read_b128 v[72:75], v225 offset:36864
MV 132,v,28,v,52
MV 136,v,28,v,56
MV 140,v,28,v,60
TR 28,219,40960
TR 30,219,41984
MV 144,v,32,v,48
MV 148,v,32,v,52
MV 152,v,32,v,56
ds_read_b128 v[76:79], v225 offset:38912
MV 156,v,32,v,60
TR 32,220,40960
TR 34,220,41984
MV 160,v,36,v,48
MV 164,v,36,v,52
MV 168,v,36,v,56
MV 172,v,36,v,60
TR 36,221,40960
TR 38,221,41984
s_waitcnt lgkmcnt(15)
MV 176,v,40,v,48
MV 180,v,40,v,52
MV 184,v,40,v,56
MV 188,v,40,v,60
TR 40,222,40960
TR 42,222,41984
MV 192,v,44,v,48
MV 196,v,44,v,52
MV 200,v,44,v,56
MV 204,v,44,v,60
TR 44,223,40960
TR 46,223,41984
s_waitcnt lgkmcnt(4)
MV 80,v,16,v,64
MV 84,v,16,v,68
MV 88,v,16,v,72
MV 92,v,16,v,76
MV 96,v,20,v,64
MV 100,v,20,v,68
MV 104,v,20,v,72
MV 108,v,20,v,76
s_waitcnt vmcnt(0) lgkmcnt(0)
s_barrier
MV 112,v,24,v,64
TR 16,216,0
TR 18,216,1024
MV 116,v,24,v,68
ds_read_b128 v[48:51], v226 offset:0
MV 120,v,24,v,72
TR 20,217,0
TR 22,217,1024
MV 124,v,24,v,76
MV 128,v,28,v,64
TR 24,218,0
TR 26,218,1024
MV 132,v,28,v,68
ds_read_b128 v[52:55], v226 offset:2048
MV 136,v,28,v,72
MV 140,v,28,v,76
TR 28,219,0
TR 30,219,1024
MV 144,v,32,v,64
ds_read_b128 v[56:59], v226 offset:4096
MV 148,v,32,v,68
MV 152,v,32,v,72
MV 156,v,32,v,76
TR 32,220,0
TR 34,220,1024
MV 160,v,36,v,64
ds_read_b128 v[60:63], v226 offset:6144
MV 164,v,36,v,68
MV 168,v,36,v,72
MV 172,v,36,v,76
TR 36,221,0
TR 38,221,1024
MV 176,v,40,v,64
MV 180,v,40,v,68
MV 184,v,40,v,72
MV 188,v,40,v,76
TR 40,222,0
TR 42,222,1024
MV 192,v,44,v,64
MV 196,v,44,v,68
MV 200,v,44,v,72
MV 204,v,44,v,76
TR 44,223,0
TR 46,223,1024
s_waitcnt lgkmcnt(4)
MV 80,v,16,v,48
buffer_load_dword v237, v233, s[8:11], 0 offen offset:0 sc1
MV 84,v,16,v,52
ds_read_b128 v[64:67], v227 offset:0
MV 88,v,16,v,56
s_lshr_b32 s36, s2, 3
MV 92,v,16,v,60
TR 16,216,8192
TR 18,216,9216
MV 96,v,20,v,48
MV 100,v,20,v,52
s_lshl_b32 s36, s36, 18
MV 104,v,20,v,56
ds_read_b128 v[68:71], v227 offset:2048
MV 108,v,20,v,60
TR 20,217,8192
TR 22,217,9216
MV 112,v,24,v,48
s_and_b32 s37, s2, 7
MV 116,v,24,v,52
MV 120,v,24,v,56
s_lshl_b32 s37, s37, 8
MV 124,v,24,v,60
TR 24,218,8192
TR 26,218,9216
MV 128,v,28,v,48
ds_read_b128 v[72:75], v227 offset:4096
s_add_u32 s36, s36, s37
MV 132,v,28,v,52
MV 136,v,28,v,56
MV 140,v,28,v,60
TR 28,219,8192
TR 30,219,9216
MV 144,v,32,v,48
s_lshl_b32 s37, s3, 16
MV 148,v,32,v,52
s_add_u32 s36, s36, s37
MV 152,v,32,v,56
ds_read_b128 v[76:79], v227 offset:6144
MV 156,v,32,v,60
TR 32,220,8192
TR 34,220,9216
MV 160,v,36,v,48
s_add_u32 s32, s32, s36
s_addc_u32 s33, s33, 0
MV 164,v,36,v,52
MV 168,v,36,v,56
MV 172,v,36,v,60
TR 36,221,8192
TR 38,221,9216
s_waitcnt lgkmcnt(15)
MV 176,v,40,v,48
MV 180,v,40,v,52
s_mov_b32 s34, 65536
MV 184,v,40,v,56
MV 188,v,40,v,60
TR 40,222,8192
TR 42,222,9216
MV 192,v,44,v,48
s_mov_b32 s35, 0x20000
MV 196,v,44,v,52
MV 200,v,44,v,56
MV 204,v,44,v,60
TR 44,223,8192
TR 46,223,9216
s_waitcnt lgkmcnt(4)
MV 80,v,16,v,64
MV 84,v,16,v,68
MV 88,v,16,v,72
MV 92,v,16,v,76
MV 96,v,20,v,64
MV 100,v,20,v,68
MV 104,v,20,v,72
MV 108,v,20,v,76
MV 112,v,24,v,64
MV 116,v,24,v,68
MV 120,v,24,v,72
MV 124,v,24,v,76
MV 128,v,28,v,64
MV 132,v,28,v,68
MV 136,v,28,v,72
MV 140,v,28,v,76
MV 144,v,32,v,64
MV 148,v,32,v,68
MV 152,v,32,v,72
MV 156,v,32,v,76
MV 160,v,36,v,64
MV 164,v,36,v,68
MV 168,v,36,v,72
MV 172,v,36,v,76
s_waitcnt lgkmcnt(2)
MV 176,v,40,v,64
MV 180,v,40,v,68
MV 184,v,40,v,72
MV 188,v,40,v,76
s_waitcnt lgkmcnt(0)
MV 192,v,44,v,64
MV 196,v,44,v,68
MV 200,v,44,v,72
MV 204,v,44,v,76
s_waitcnt vmcnt(0)
v_cmp_gt_u32 vcc, 1, v237
s_nop 4
s_cbranch_vccnz L_spin_f1
L_spin_f1_ret:
L_p3_begin:
s_waitcnt lgkmcnt(0)
s_barrier
s_add_u32 m0, s68, 16384
s_mov_b32 s80, 0
buffer_load_dwordx4 v12, s[52:55], s80 offen offset:0 sc1 lds
buffer_load_dwordx4 v12, s[52:55], s80 offen offset:1024 sc1 lds
buffer_load_dwordx4 v12, s[52:55], s80 offen offset:2048 sc1 lds
buffer_load_dwordx4 v12, s[52:55], s80 offen offset:3072 sc1 lds
s_mov_b32 s82, 0x3e0293ee
s_mov_b32 s83, 0x3e0293ee
v_pk_mul_f32 v[80:81], v[80:81], s[82:83]
v_pk_mul_f32 v[82:83], v[82:83], s[82:83]
v_pk_mul_f32 v[84:85], v[84:85], s[82:83]
v_pk_mul_f32 v[86:87], v[86:87], s[82:83]
v_pk_mul_f32 v[88:89], v[88:89], s[82:83]
v_pk_mul_f32 v[90:91], v[90:91], s[82:83]
v_pk_mul_f32 v[92:93], v[92:93], s[82:83]
v_pk_mul_f32 v[94:95], v[94:95], s[82:83]
s_add_u32 m0, s68, 32768
v_pk_mul_f32 v[96:97], v[96:97], s[82:83]
v_pk_mul_f32 v[98:99], v[98:99], s[82:83]
v_pk_mul_f32 v[100:101], v[100:101], s[82:83]
v_pk_mul_f32 v[102:103], v[102:103], s[82:83]
v_pk_mul_f32 v[104:105], v[104:105], s[82:83]
v_pk_mul_f32 v[106:107], v[106:107], s[82:83]
v_pk_mul_f32 v[108:109], v[108:109], s[82:83]
v_pk_mul_f32 v[110:111], v[110:111], s[82:83]
v_cvt_pk_bf16_f32 v16, v80, v81
v_cvt_pk_bf16_f32 v17, v82, v83
v_cvt_pk_bf16_f32 v18, v96, v97
s_mov_b32 s80, 16384
v_cvt_pk_bf16_f32 v19, v98, v99
v_cvt_pk_bf16_f32 v32, v84, v85
v_cvt_pk_bf16_f32 v33, v86, v87
v_cvt_pk_bf16_f32 v34, v100, v101
v_cvt_pk_bf16_f32 v35, v102, v103
v_cvt_pk_bf16_f32 v48, v88, v89
v_cvt_pk_bf16_f32 v49, v90, v91
v_cvt_pk_bf16_f32 v50, v104, v105
v_cvt_pk_bf16_f32 v51, v106, v107
v_cvt_pk_bf16_f32 v64, v92, v93
v_cvt_pk_bf16_f32 v65, v94, v95
buffer_load_dwordx4 v12, s[52:55], s80 offen offset:0 sc1 lds
v_cvt_pk_bf16_f32 v66, v108, v109
v_cvt_pk_bf16_f32 v67, v110, v111
v_pk_mul_f32 v[112:113], v[112:113], s[82:83]
v_pk_mul_f32 v[114:115], v[114:115], s[82:83]
v_pk_mul_f32 v[116:117], v[116:117], s[82:83]
v_pk_mul_f32 v[118:119], v[118:119], s[82:83]
v_pk_mul_f32 v[120:121], v[120:121], s[82:83]
v_pk_mul_f32 v[122:123], v[122:123], s[82:83]
v_pk_mul_f32 v[124:125], v[124:125], s[82:83]
v_pk_mul_f32 v[126:127], v[126:127], s[82:83]
v_pk_mul_f32 v[128:129], v[128:129], s[82:83]
buffer_load_dwordx4 v12, s[52:55], s80 offen offset:1024 sc1 lds
v_pk_mul_f32 v[130:131], v[130:131], s[82:83]
v_pk_mul_f32 v[132:133], v[132:133], s[82:83]
v_pk_mul_f32 v[134:135], v[134:135], s[82:83]
v_pk_mul_f32 v[136:137], v[136:137], s[82:83]
v_pk_mul_f32 v[138:139], v[138:139], s[82:83]
v_pk_mul_f32 v[140:141], v[140:141], s[82:83]
v_pk_mul_f32 v[142:143], v[142:143], s[82:83]
v_cvt_pk_bf16_f32 v20, v112, v113
v_cvt_pk_bf16_f32 v21, v114, v115
v_cvt_pk_bf16_f32 v22, v128, v129
v_cvt_pk_bf16_f32 v23, v130, v131
buffer_load_dwordx4 v12, s[52:55], s80 offen offset:2048 sc1 lds
v_cvt_pk_bf16_f32 v36, v116, v117
v_cvt_pk_bf16_f32 v37, v118, v119
v_cvt_pk_bf16_f32 v38, v132, v133
v_cvt_pk_bf16_f32 v39, v134, v135
v_cvt_pk_bf16_f32 v52, v120, v121
v_cvt_pk_bf16_f32 v53, v122, v123
v_cvt_pk_bf16_f32 v54, v136, v137
v_cvt_pk_bf16_f32 v55, v138, v139
v_cvt_pk_bf16_f32 v68, v124, v125
v_cvt_pk_bf16_f32 v69, v126, v127
v_cvt_pk_bf16_f32 v70, v140, v141
buffer_load_dwordx4 v12, s[52:55], s80 offen offset:3072 sc1 lds
v_cvt_pk_bf16_f32 v71, v142, v143
v_pk_mul_f32 v[144:145], v[144:145], s[82:83]
v_pk_mul_f32 v[146:147], v[146:147], s[82:83]
v_pk_mul_f32 v[148:149], v[148:149], s[82:83]
v_pk_mul_f32 v[150:151], v[150:151], s[82:83]
v_pk_mul_f32 v[152:153], v[152:153], s[82:83]
v_pk_mul_f32 v[154:155], v[154:155], s[82:83]
v_pk_mul_f32 v[156:157], v[156:157], s[82:83]
v_pk_mul_f32 v[158:159], v[158:159], s[82:83]
v_pk_mul_f32 v[160:161], v[160:161], s[82:83]
v_pk_mul_f32 v[162:163], v[162:163], s[82:83]
s_add_u32 m0, s68, 81920
v_pk_mul_f32 v[164:165], v[164:165], s[82:83]
v_pk_mul_f32 v[166:167], v[166:167], s[82:83]
v_pk_mul_f32 v[168:169], v[168:169], s[82:83]
v_pk_mul_f32 v[170:171], v[170:171], s[82:83]
v_pk_mul_f32 v[172:173], v[172:173], s[82:83]
v_pk_mul_f32 v[174:175], v[174:175], s[82:83]
v_cvt_pk_bf16_f32 v24, v144, v145
v_cvt_pk_bf16_f32 v25, v146, v147
v_cvt_pk_bf16_f32 v26, v160, v161
v_cvt_pk_bf16_f32 v27, v162, v163
v_cvt_pk_bf16_f32 v40, v148, v149
s_mov_b32 s80, 16384
v_cvt_pk_bf16_f32 v41, v150, v151
v_cvt_pk_bf16_f32 v42, v164, v165
v_cvt_pk_bf16_f32 v43, v166, v167
v_cvt_pk_bf16_f32 v56, v152, v153
v_cvt_pk_bf16_f32 v57, v154, v155
v_cvt_pk_bf16_f32 v58, v168, v169
v_cvt_pk_bf16_f32 v59, v170, v171
v_cvt_pk_bf16_f32 v72, v156, v157
v_cvt_pk_bf16_f32 v73, v158, v159
v_cvt_pk_bf16_f32 v74, v172, v173
v_cvt_pk_bf16_f32 v75, v174, v175
buffer_load_dwordx4 v12, s[56:59], s80 offen offset:0 sc1 lds
v_pk_mul_f32 v[176:177], v[176:177], s[82:83]
v_pk_mul_f32 v[178:179], v[178:179], s[82:83]
v_pk_mul_f32 v[180:181], v[180:181], s[82:83]
v_pk_mul_f32 v[182:183], v[182:183], s[82:83]
v_pk_mul_f32 v[184:185], v[184:185], s[82:83]
v_pk_mul_f32 v[186:187], v[186:187], s[82:83]
v_pk_mul_f32 v[188:189], v[188:189], s[82:83]
v_pk_mul_f32 v[190:191], v[190:191], s[82:83]
v_pk_mul_f32 v[192:193], v[192:193], s[82:83]
v_pk_mul_f32 v[194:195], v[194:195], s[82:83]
v_pk_mul_f32 v[196:197], v[196:197], s[82:83]
buffer_load_dwordx4 v12, s[56:59], s80 offen offset:1024 sc1 lds
v_pk_mul_f32 v[198:199], v[198:199], s[82:83]
v_pk_mul_f32 v[200:201], v[200:201], s[82:83]
v_pk_mul_f32 v[202:203], v[202:203], s[82:83]
v_pk_mul_f32 v[204:205], v[204:205], s[82:83]
v_pk_mul_f32 v[206:207], v[206:207], s[82:83]
v_cvt_pk_bf16_f32 v28, v176, v177
v_cvt_pk_bf16_f32 v29, v178, v179
v_cvt_pk_bf16_f32 v30, v192, v193
v_cvt_pk_bf16_f32 v31, v194, v195
v_cvt_pk_bf16_f32 v44, v180, v181
v_cvt_pk_bf16_f32 v45, v182, v183
buffer_load_dwordx4 v12, s[56:59], s80 offen offset:2048 sc1 lds
v_cvt_pk_bf16_f32 v46, v196, v197
v_cvt_pk_bf16_f32 v47, v198, v199
v_cvt_pk_bf16_f32 v60, v184, v185
v_cvt_pk_bf16_f32 v61, v186, v187
v_cvt_pk_bf16_f32 v62, v200, v201
v_cvt_pk_bf16_f32 v63, v202, v203
v_cvt_pk_bf16_f32 v76, v188, v189
v_cvt_pk_bf16_f32 v77, v190, v191
v_cvt_pk_bf16_f32 v78, v204, v205
v_cvt_pk_bf16_f32 v79, v206, v207
v_mov_b32 v2, 0
buffer_load_dwordx4 v12, s[56:59], s80 offen offset:3072 sc1 lds
v_mov_b32 v3, 0
v_mov_b32 v4, 0
v_mov_b32 v5, 0
v_accvgpr_write_b32 a0, 0
v_accvgpr_write_b32 a1, 0
v_accvgpr_write_b32 a2, 0
v_accvgpr_write_b32 a3, 0
v_accvgpr_write_b32 a4, 0
v_accvgpr_write_b32 a5, 0
v_accvgpr_write_b32 a6, 0
v_accvgpr_write_b32 a7, 0
s_add_u32 m0, s68, 49152
v_accvgpr_write_b32 a8, 0
v_accvgpr_write_b32 a9, 0
v_accvgpr_write_b32 a10, 0
v_accvgpr_write_b32 a11, 0
v_accvgpr_write_b32 a12, 0
v_accvgpr_write_b32 a13, 0
v_accvgpr_write_b32 a14, 0
v_accvgpr_write_b32 a15, 0
v_accvgpr_write_b32 a16, 0
v_accvgpr_write_b32 a17, 0
v_accvgpr_write_b32 a18, 0
s_mov_b32 s80, 32768
v_accvgpr_write_b32 a19, 0
v_accvgpr_write_b32 a20, 0
v_accvgpr_write_b32 a21, 0
v_accvgpr_write_b32 a22, 0
v_accvgpr_write_b32 a23, 0
v_accvgpr_write_b32 a24, 0
v_accvgpr_write_b32 a25, 0
v_accvgpr_write_b32 a26, 0
v_accvgpr_write_b32 a27, 0
v_accvgpr_write_b32 a28, 0
v_accvgpr_write_b32 a29, 0
buffer_load_dwordx4 v12, s[52:55], s80 offen offset:0 sc1 lds
v_accvgpr_write_b32 a30, 0
v_accvgpr_write_b32 a31, 0
v_accvgpr_write_b32 a32, 0
v_accvgpr_write_b32 a33, 0
v_accvgpr_write_b32 a34, 0
v_accvgpr_write_b32 a35, 0
v_accvgpr_write_b32 a36, 0
v_accvgpr_write_b32 a37, 0
v_accvgpr_write_b32 a38, 0
v_accvgpr_write_b32 a39, 0
v_accvgpr_write_b32 a40, 0
buffer_load_dwordx4 v12, s[52:55], s80 offen offset:1024 sc1 lds
v_accvgpr_write_b32 a41, 0
v_accvgpr_write_b32 a42, 0
v_accvgpr_write_b32 a43, 0
v_accvgpr_write_b32 a44, 0
v_accvgpr_write_b32 a45, 0
v_accvgpr_write_b32 a46, 0
v_accvgpr_write_b32 a47, 0
v_accvgpr_write_b32 a48, 0
v_accvgpr_write_b32 a49, 0
v_accvgpr_write_b32 a50, 0
v_accvgpr_write_b32 a51, 0
buffer_load_dwordx4 v12, s[52:55], s80 offen offset:2048 sc1 lds
v_accvgpr_write_b32 a52, 0
v_accvgpr_write_b32 a53, 0
v_accvgpr_write_b32 a54, 0
v_accvgpr_write_b32 a55, 0
v_accvgpr_write_b32 a56, 0
v_accvgpr_write_b32 a57, 0
v_accvgpr_write_b32 a58, 0
v_accvgpr_write_b32 a59, 0
v_accvgpr_write_b32 a60, 0
v_accvgpr_write_b32 a61, 0
v_accvgpr_write_b32 a62, 0
buffer_load_dwordx4 v12, s[52:55], s80 offen offset:3072 sc1 lds
v_accvgpr_write_b32 a63, 0
v_accvgpr_write_b32 a64, 0
v_accvgpr_write_b32 a65, 0
v_accvgpr_write_b32 a66, 0
v_accvgpr_write_b32 a67, 0
v_accvgpr_write_b32 a68, 0
v_accvgpr_write_b32 a69, 0
v_accvgpr_write_b32 a70, 0
v_accvgpr_write_b32 a71, 0
v_accvgpr_write_b32 a72, 0
v_accvgpr_write_b32 a73, 0
s_add_u32 m0, s68, 98304
v_accvgpr_write_b32 a74, 0
v_accvgpr_write_b32 a75, 0
v_accvgpr_write_b32 a76, 0
v_accvgpr_write_b32 a77, 0
v_accvgpr_write_b32 a78, 0
v_accvgpr_write_b32 a79, 0
v_accvgpr_write_b32 a80, 0
v_accvgpr_write_b32 a81, 0
v_accvgpr_write_b32 a82, 0
v_accvgpr_write_b32 a83, 0
v_accvgpr_write_b32 a84, 0
s_mov_b32 s80, 32768
v_accvgpr_write_b32 a85, 0
v_accvgpr_write_b32 a86, 0
v_accvgpr_write_b32 a87, 0
v_accvgpr_write_b32 a88, 0
v_accvgpr_write_b32 a89, 0
v_accvgpr_write_b32 a90, 0
v_accvgpr_write_b32 a91, 0
v_accvgpr_write_b32 a92, 0
v_accvgpr_write_b32 a93, 0
v_accvgpr_write_b32 a94, 0
v_accvgpr_write_b32 a95, 0
buffer_load_dwordx4 v12, s[56:59], s80 offen offset:0 sc1 lds
v_accvgpr_write_b32 a96, 0
v_accvgpr_write_b32 a97, 0
v_accvgpr_write_b32 a98, 0
v_accvgpr_write_b32 a99, 0
v_accvgpr_write_b32 a100, 0
v_accvgpr_write_b32 a101, 0
v_accvgpr_write_b32 a102, 0
v_accvgpr_write_b32 a103, 0
v_accvgpr_write_b32 a104, 0
v_accvgpr_write_b32 a105, 0
v_accvgpr_write_b32 a106, 0
buffer_load_dwordx4 v12, s[56:59], s80 offen offset:1024 sc1 lds
v_accvgpr_write_b32 a107, 0
v_accvgpr_write_b32 a108, 0
v_accvgpr_write_b32 a109, 0
v_accvgpr_write_b32 a110, 0
v_accvgpr_write_b32 a111, 0
v_accvgpr_write_b32 a112, 0
v_accvgpr_write_b32 a113, 0
v_accvgpr_write_b32 a114, 0
v_accvgpr_write_b32 a115, 0
v_accvgpr_write_b32 a116, 0
v_accvgpr_write_b32 a117, 0
buffer_load_dwordx4 v12, s[56:59], s80 offen offset:2048 sc1 lds
v_accvgpr_write_b32 a118, 0
v_accvgpr_write_b32 a119, 0
v_accvgpr_write_b32 a120, 0
v_accvgpr_write_b32 a121, 0
v_accvgpr_write_b32 a122, 0
v_accvgpr_write_b32 a123, 0
v_accvgpr_write_b32 a124, 0
v_accvgpr_write_b32 a125, 0
v_accvgpr_write_b32 a126, 0
v_accvgpr_write_b32 a127, 0
v_xor_b32 v244, 0x8000, v10
buffer_load_dwordx4 v12, s[56:59], s80 offen offset:3072 sc1 lds
s_waitcnt vmcnt(16)
s_barrier
ds_read_b128 a[128:131], v244 offset:16384
ds_read_b128 a[132:135], v244 offset:17408
ds_read_b128 a[136:139], v244 offset:18432
ds_read_b128 a[140:143], v244 offset:19456
ds_read_b128 a[144:147], v244 offset:20480
ds_read_b128 a[148:151], v244 offset:21504
ds_read_b128 a[152:155], v244 offset:22528
ds_read_b128 a[156:159], v244 offset:23552
ds_read_b128 a[160:163], v244 offset:24576
ds_read_b128 a[164:167], v244 offset:25600
ds_read_b128 a[168:171], v244 offset:26624
ds_read_b128 a[172:175], v244 offset:27648
ds_read_b128 a[176:179], v244 offset:28672
ds_read_b128 a[180:183], v244 offset:29696
ds_read_b128 a[184:187], v244 offset:30720
ds_read_b128 a[188:191], v244 offset:31744
s_waitcnt lgkmcnt(15)
v_mfma_f32_16x16x32_bf16 v[80:83], a[128:131], v[16:19], 0
s_add_u32 m0, s68, 0
v_mfma_f32_16x16x32_bf16 v[88:91], a[128:131], v[32:35], 0
s_mov_b32 s80, 49152
v_mfma_f32_16x16x32_bf16 v[96:99], a[128:131], v[48:51], 0
v_mfma_f32_16x16x32_bf16 v[104:107], a[128:131], v[64:67], 0
buffer_load_dwordx4 v12, s[52:55], s80 offen offset:0 sc1 lds
s_waitcnt lgkmcnt(14)
MV 80,a,132,v,20
MV 88,a,132,v,36
buffer_load_dwordx4 v12, s[52:55], s80 offen offset:1024 sc1 lds
MV 96,a,132,v,52
MV 104,a,132,v,68
buffer_load_dwordx4 v12, s[52:55], s80 offen offset:2048 sc1 lds
s_waitcnt lgkmcnt(13)
MV 80,a,136,v,24
MV 88,a,136,v,40
buffer_load_dwordx4 v12, s[52:55], s80 offen offset:3072 sc1 lds
MV 96,a,136,v,56
MV 104,a,136,v,72
s_add_u32 m0, s68, 114688
s_waitcnt lgkmcnt(12)
MV 80,a,140,v,28
s_mov_b32 s80, 49152
MV 88,a,140,v,44
MV 96,a,140,v,60
buffer_load_dwordx4 v12, s[56:59], s80 offen offset:0 sc1 lds
MV 104,a,140,v,76
s_waitcnt lgkmcnt(11)
v_mfma_f32_16x16x32_bf16 v[84:87], a[144:147], v[16:19], 0
buffer_load_dwordx4 v12, s[56:59], s80 offen offset:1024 sc1 lds
v_mfma_f32_16x16x32_bf16 v[92:95], a[144:147], v[32:35], 0
v_mfma_f32_16x16x32_bf16 v[100:103], a[144:147], v[48:51], 0
buffer_load_dwordx4 v12, s[56:59], s80 offen offset:2048 sc1 lds
v_mfma_f32_16x16x32_bf16 v[108:111], a[144:147], v[64:67], 0
s_waitcnt lgkmcnt(10)
MV 84,a,148,v,20
buffer_load_dwordx4 v12, s[56:59], s80 offen offset:3072 sc1 lds
MV 92,a,148,v,36
MV 100,a,148,v,52
MV 108,a,148,v,68
s_waitcnt lgkmcnt(9)
MV 84,a,152,v,24
s_waitcnt vmcnt(16) lgkmcnt(0)
s_barrier
MV 92,a,152,v,40
ds_read_b128 a[128:131], v10 offset:0
s_add_u32 m0, s68, 16384
MV 100,a,152,v,56
ds_read_b128 a[132:135], v10 offset:1024
s_mov_b32 s80, 65536
MV 108,a,152,v,72
ds_read_b128 a[136:139], v10 offset:2048
buffer_load_dwordx4 v12, s[52:55], s80 offen offset:0 sc1 lds
MV 84,a,156,v,28
ds_read_b128 a[140:143], v10 offset:3072
buffer_load_dwordx4 v12, s[52:55], s80 offen offset:1024 sc1 lds
MV 92,a,156,v,44
ds_read_b128 a[144:147], v10 offset:4096
buffer_load_dwordx4 v12, s[52:55], s80 offen offset:2048 sc1 lds
MV 100,a,156,v,60
ds_read_b128 a[148:151], v10 offset:5120
buffer_load_dwordx4 v12, s[52:55], s80 offen offset:3072 sc1 lds
MV 108,a,156,v,76
ds_read_b128 a[152:155], v10 offset:6144
s_mov_b32 s71, 65536
v_mfma_f32_16x16x32_bf16 v[112:115], a[160:163], v[16:19], 0
ds_read_b128 a[156:159], v10 offset:7168
v_mfma_f32_16x16x32_bf16 v[120:123], a[160:163], v[32:35], 0
v_lshrrev_b32 v245, 4, v1
v_mfma_f32_16x16x32_bf16 v[128:131], a[160:163], v[48:51], 0
v_and_b32 v246, 15, v1
v_mfma_f32_16x16x32_bf16 v[136:139], a[160:163], v[64:67], 0
ds_read_b128 a[160:163], v10 offset:8192
v_lshlrev_b32 v247, 1, v245
MV 112,a,164,v,20
v_xor_b32 v246, v246, v247
MV 120,a,164,v,36
v_lshlrev_b32 v245, 11, v245
MV 128,a,164,v,52
v_lshl_add_u32 v245, v246, 4, v245
MV 136,a,164,v,68
ds_read_b128 a[164:167], v10 offset:9216
v_xor_b32 v246, 128, v245
MV 112,a,168,v,24
MV 120,a,168,v,40
s_lshl_b32 s36, s3, 13
MV 128,a,168,v,56
s_add_u32 m0, s36, 131072
MV 136,a,168,v,72
ds_read_b128 a[168:171], v10 offset:10240
s_mov_b32 s37, 0
MV 112,a,172,v,28
buffer_load_dwordx4 v245, s[32:35], s37 offen offset:0 lds
MV 120,a,172,v,44
s_mov_b32 s37, 7168
MV 128,a,172,v,60
buffer_load_dwordx4 v246, s[32:35], s37 offen offset:1024 lds
MV 136,a,172,v,76
ds_read_b128 a[172:175], v10 offset:11264
v_mfma_f32_16x16x32_bf16 v[116:119], a[176:179], v[16:19], 0
s_mov_b32 s37, 14336
v_mfma_f32_16x16x32_bf16 v[124:127], a[176:179], v[32:35], 0
buffer_load_dwordx4 v245, s[32:35], s37 offen offset:2048 lds
v_mfma_f32_16x16x32_bf16 v[132:135], a[176:179], v[48:51], 0
s_mov_b32 s37, 21504
v_mfma_f32_16x16x32_bf16 v[140:143], a[176:179], v[64:67], 0
ds_read_b128 a[176:179], v10 offset:12288
buffer_load_dwordx4 v246, s[32:35], s37 offen offset:3072 lds
MV 116,a,180,v,20
s_add_u32 m0, s36, 135168
MV 124,a,180,v,36
s_mov_b32 s37, 32768
MV 132,a,180,v,52
buffer_load_dwordx4 v245, s[32:35], s37 offen offset:0 lds
MV 140,a,180,v,68
ds_read_b128 a[180:183], v10 offset:13312
MV 116,a,184,v,24
s_mov_b32 s37, 39936
MV 124,a,184,v,40
buffer_load_dwordx4 v246, s[32:35], s37 offen offset:1024 lds
MV 132,a,184,v,56
s_mov_b32 s37, 47104
MV 140,a,184,v,72
ds_read_b128 a[184:187], v10 offset:14336
buffer_load_dwordx4 v245, s[32:35], s37 offen offset:2048 lds
MV 116,a,188,v,28
s_mov_b32 s37, 54272
MV 124,a,188,v,44
buffer_load_dwordx4 v246, s[32:35], s37 offen offset:3072 lds
MV 132,a,188,v,60
MV 140,a,188,v,76
ds_read_b128 a[188:191], v10 offset:15360
s_cmp_eq_u32 s70, 0
s_cbranch_scc1 L_p3_pmask
L_p3_pmask_ret:
v_exp_f32 v80, v80
v_exp_f32 v81, v81
v_exp_f32 v82, v82
v_add_f32 v2, v2, v80
v_add_f32 v2, v2, v81
v_exp_f32 v83, v83
v_cvt_pk_bf16_f32 v80, v80, v81
v_exp_f32 v84, v84
v_add_f32 v2, v2, v82
v_add_f32 v2, v2, v83
v_exp_f32 v85, v85
v_cvt_pk_bf16_f32 v81, v82, v83
v_exp_f32 v86, v86
v_add_f32 v2, v2, v84
v_add_f32 v2, v2, v85
v_exp_f32 v87, v87
v_cvt_pk_bf16_f32 v82, v84, v85
v_exp_f32 v88, v88
v_add_f32 v2, v2, v86
v_add_f32 v2, v2, v87
v_exp_f32 v89, v89
v_cvt_pk_bf16_f32 v83, v86, v87
v_exp_f32 v90, v90
v_add_f32 v3, v3, v88
v_add_f32 v3, v3, v89
v_exp_f32 v91, v91
v_cvt_pk_bf16_f32 v88, v88, v89
v_exp_f32 v92, v92
v_add_f32 v3, v3, v90
v_add_f32 v3, v3, v91
v_exp_f32 v93, v93
v_cvt_pk_bf16_f32 v89, v90, v91
v_exp_f32 v94, v94
v_add_f32 v3, v3, v92
v_add_f32 v3, v3, v93
v_exp_f32 v95, v95
v_cvt_pk_bf16_f32 v90, v92, v93
v_exp_f32 v96, v96
v_add_f32 v3, v3, v94
v_add_f32 v3, v3, v95
v_exp_f32 v97, v97
v_cvt_pk_bf16_f32 v91, v94, v95
v_exp_f32 v98, v98
v_add_f32 v4, v4, v96
v_add_f32 v4, v4, v97
v_exp_f32 v99, v99
v_cvt_pk_bf16_f32 v96, v96, v97
v_exp_f32 v100, v100
v_add_f32 v4, v4, v98
v_add_f32 v4, v4, v99
v_exp_f32 v101, v101
v_cvt_pk_bf16_f32 v97, v98, v99
v_exp_f32 v102, v102
v_add_f32 v4, v4, v100
v_add_f32 v4, v4, v101
v_exp_f32 v103, v103
v_cvt_pk_bf16_f32 v98, v100, v101
v_exp_f32 v104, v104
v_add_f32 v4, v4, v102
v_add_f32 v4, v4, v103
v_exp_f32 v105, v105
v_cvt_pk_bf16_f32 v99, v102, v103
v_exp_f32 v106, v106
v_add_f32 v5, v5, v104
v_add_f32 v5, v5, v105
v_exp_f32 v107, v107
v_cvt_pk_bf16_f32 v104, v104, v105
v_exp_f32 v108, v108
v_add_f32 v5, v5, v106
v_add_f32 v5, v5, v107
v_exp_f32 v109, v109
v_cvt_pk_bf16_f32 v105, v106, v107
v_exp_f32 v110, v110
v_add_f32 v5, v5, v108
v_add_f32 v5, v5, v109
v_exp_f32 v111, v111
v_cvt_pk_bf16_f32 v106, v108, v109
v_add_f32 v5, v5, v110
v_add_f32 v5, v5, v111
v_cvt_pk_bf16_f32 v107, v110, v111
s_sub_u32 s74, s70, 1
s_cbranch_scc1 L_p3_d0m_top
.p2align 5
L_p3_d0_top:
s_waitcnt lgkmcnt(0)
v_mfma_f32_16x16x32_bf16 v[144:147], a[128:131], v[16:19], 0
s_add_u32 m0, s73, 0
ds_read_b128 a[192:195], v11 offset:16384
v_mfma_f32_16x16x32_bf16 v[152:155], a[128:131], v[32:35], 0
v_exp_f32 v112, v112
v_mfma_f32_16x16x32_bf16 v[160:163], a[128:131], v[48:51], 0
ds_read_b128 a[196:199], v11 offset:17408
buffer_load_dwordx4 v12, s[56:59], s71 offen offset:0 sc1 lds
v_mfma_f32_16x16x32_bf16 v[168:171], a[128:131], v[64:67], 0
v_exp_f32 v113, v113
MV 144,a,132,v,20
v_exp_f32 v114, v114
MV 152,a,132,v,36
v_add_f32 v2, v2, v112
v_add_f32 v2, v2, v113
MV 160,a,132,v,52
v_exp_f32 v115, v115
MV 168,a,132,v,68
ds_read_b128 a[200:203], v11 offset:18432
v_cvt_pk_bf16_f32 v112, v112, v113
MV 144,a,136,v,24
v_exp_f32 v116, v116
MV 152,a,136,v,40
v_add_f32 v2, v2, v114
v_add_f32 v2, v2, v115
MV 160,a,136,v,56
v_exp_f32 v117, v117
MV 168,a,136,v,72
ds_read_b128 a[204:207], v11 offset:19456
v_cvt_pk_bf16_f32 v113, v114, v115
MV 144,a,140,v,28
v_exp_f32 v118, v118
MV 152,a,140,v,44
ds_read_b128 a[208:211], v11 offset:20480
v_add_f32 v2, v2, v116
MV 160,a,140,v,60
buffer_load_dwordx4 v12, s[56:59], s71 offen offset:1024 sc1 lds
v_add_f32 v2, v2, v117
MV 168,a,140,v,76
v_exp_f32 v119, v119
v_mfma_f32_16x16x32_bf16 v[148:151], a[144:147], v[16:19], 0
ds_read_b128 a[212:215], v11 offset:21504
v_cvt_pk_bf16_f32 v114, v116, v117
v_mfma_f32_16x16x32_bf16 v[156:159], a[144:147], v[32:35], 0
v_exp_f32 v120, v120
v_mfma_f32_16x16x32_bf16 v[164:167], a[144:147], v[48:51], 0
v_add_f32 v2, v2, v118
v_add_f32 v2, v2, v119
v_mfma_f32_16x16x32_bf16 v[172:175], a[144:147], v[64:67], 0
v_exp_f32 v121, v121
MV 148,a,148,v,20
ds_read_b128 a[216:219], v11 offset:22528
v_cvt_pk_bf16_f32 v115, v118, v119
MV 156,a,148,v,36
v_exp_f32 v122, v122
MV 164,a,148,v,52
v_add_f32 v3, v3, v120
v_add_f32 v3, v3, v121
MV 172,a,148,v,68
v_exp_f32 v123, v123
MV 148,a,152,v,24
ds_read_b128 a[220:223], v11 offset:23552
v_cvt_pk_bf16_f32 v120, v120, v121
MV 156,a,152,v,40
v_exp_f32 v124, v124
MV 164,a,152,v,56
ds_read_b128 a[224:227], v11 offset:24576
v_add_f32 v3, v3, v122
MV 172,a,152,v,72
buffer_load_dwordx4 v12, s[56:59], s71 offen offset:2048 sc1 lds
v_add_f32 v3, v3, v123
MV 148,a,156,v,28
v_exp_f32 v125, v125
MV 156,a,156,v,44
ds_read_b128 a[228:231], v11 offset:25600
v_cvt_pk_bf16_f32 v121, v122, v123
MV 164,a,156,v,60
v_exp_f32 v126, v126
MV 172,a,156,v,76
v_add_f32 v3, v3, v124
v_add_f32 v3, v3, v125
v_mfma_f32_16x16x32_bf16 v[176:179], a[160:163], v[16:19], 0
v_exp_f32 v127, v127
v_mfma_f32_16x16x32_bf16 v[184:187], a[160:163], v[32:35], 0
ds_read_b128 a[232:235], v11 offset:26624
v_cvt_pk_bf16_f32 v122, v124, v125
v_mfma_f32_16x16x32_bf16 v[192:195], a[160:163], v[48:51], 0
v_exp_f32 v128, v128
v_mfma_f32_16x16x32_bf16 v[200:203], a[160:163], v[64:67], 0
v_add_f32 v3, v3, v126
v_add_f32 v3, v3, v127
MV 176,a,164,v,20
v_exp_f32 v129, v129
MV 184,a,164,v,36
ds_read_b128 a[236:239], v11 offset:27648
v_cvt_pk_bf16_f32 v123, v126, v127
MV 192,a,164,v,52
v_exp_f32 v130, v130
MV 200,a,164,v,68
ds_read_b128 a[240:243], v11 offset:28672
v_add_f32 v4, v4, v128
MV 176,a,168,v,24
buffer_load_dwordx4 v12, s[56:59], s71 offen offset:3072 sc1 lds
v_add_f32 v4, v4, v129
MV 184,a,168,v,40
v_exp_f32 v131, v131
MV 192,a,168,v,56
ds_read_b128 a[244:247], v11 offset:29696
v_cvt_pk_bf16_f32 v128, v128, v129
MV 200,a,168,v,72
v_exp_f32 v132, v132
MV 176,a,172,v,28
v_add_f32 v4, v4, v130
v_add_f32 v4, v4, v131
MV 184,a,172,v,44
v_exp_f32 v133, v133
MV 192,a,172,v,60
ds_read_b128 a[248:251], v11 offset:30720
v_cvt_pk_bf16_f32 v129, v130, v131
MV 200,a,172,v,76
v_exp_f32 v134, v134
v_mfma_f32_16x16x32_bf16 v[180:183], a[176:179], v[16:19], 0
v_add_f32 v4, v4, v132
v_add_f32 v4, v4, v133
v_mfma_f32_16x16x32_bf16 v[188:191], a[176:179], v[32:35], 0
v_exp_f32 v135, v135
v_mfma_f32_16x16x32_bf16 v[196:199], a[176:179], v[48:51], 0
ds_read_b128 a[252:255], v11 offset:31744
v_cvt_pk_bf16_f32 v130, v132, v133
v_mfma_f32_16x16x32_bf16 v[204:207], a[176:179], v[64:67], 0
v_exp_f32 v136, v136
MV 180,a,180,v,20
v_add_f32 v4, v4, v134
v_add_f32 v4, v4, v135
MV 188,a,180,v,36
v_exp_f32 v137, v137
MV 196,a,180,v,52
s_add_u32 s71, s71, 16384
v_cvt_pk_bf16_f32 v131, v134, v135
MV 204,a,180,v,68
v_exp_f32 v138, v138
MV 180,a,184,v,24
v_add_f32 v5, v5, v136
v_add_f32 v5, v5, v137
MV 188,a,184,v,40
v_exp_f32 v139, v139
MV 196,a,184,v,56
v_cvt_pk_bf16_f32 v136, v136, v137
MV 204,a,184,v,72
v_exp_f32 v140, v140
MV 180,a,188,v,28
v_add_f32 v5, v5, v138
v_add_f32 v5, v5, v139
MV 188,a,188,v,44
v_exp_f32 v141, v141
MV 196,a,188,v,60
v_cvt_pk_bf16_f32 v137, v138, v139
MV 204,a,188,v,76
v_exp_f32 v142, v142
v_add_f32 v5, v5, v140
v_add_f32 v5, v5, v141
v_exp_f32 v143, v143
v_cvt_pk_bf16_f32 v138, v140, v141
v_add_f32 v5, v5, v142
v_add_f32 v5, v5, v143
v_cvt_pk_bf16_f32 v139, v142, v143
s_waitcnt vmcnt(16) lgkmcnt(0)
MA 0,a,192,v,80
s_barrier
MA 32,a,192,v,88
s_add_u32 m0, s72, 0
ds_read_b128 a[128:131], v10 offset:16384
MA 64,a,192,v,96
v_exp_f32 v144, v144
MA 96,a,192,v,104
ds_read_b128 a[132:135], v10 offset:17408
buffer_load_dwordx4 v12, s[52:55], s71 offen offset:0 sc1 lds
MA 4,a,196,v,80
v_exp_f32 v145, v145
MA 36,a,196,v,88
v_exp_f32 v146, v146
MA 68,a,196,v,96
v_add_f32 v2, v2, v144
v_add_f32 v2, v2, v145
MA 100,a,196,v,104
v_exp_f32 v147, v147
MA 8,a,200,v,80
ds_read_b128 a[136:139], v10 offset:18432
v_cvt_pk_bf16_f32 v144, v144, v145
MA 40,a,200,v,88
v_exp_f32 v148, v148
MA 72,a,200,v,96
v_add_f32 v2, v2, v146
v_add_f32 v2, v2, v147
MA 104,a,200,v,104
ds_read_b128 a[140:143], v10 offset:19456
ds_read_b128 a[144:147], v10 offset:20480
MA 12,a,204,v,80
v_exp_f32 v149, v149
MA 44,a,204,v,88
buffer_load_dwordx4 v12, s[52:55], s71 offen offset:1024 sc1 lds
v_cvt_pk_bf16_f32 v145, v146, v147
MA 76,a,204,v,96
v_exp_f32 v150, v150
MA 108,a,204,v,104
v_add_f32 v2, v2, v148
v_add_f32 v2, v2, v149
MA 16,a,208,v,80
v_exp_f32 v151, v151
MA 48,a,208,v,88
ds_read_b128 a[148:151], v10 offset:21504
v_cvt_pk_bf16_f32 v146, v148, v149
MA 80,a,208,v,96
v_exp_f32 v152, v152
MA 112,a,208,v,104
v_add_f32 v2, v2, v150
v_add_f32 v2, v2, v151
MA 20,a,212,v,80
v_exp_f32 v153, v153
MA 52,a,212,v,88
ds_read_b128 a[152:155], v10 offset:22528
v_cvt_pk_bf16_f32 v147, v150, v151
MA 84,a,212,v,96
v_exp_f32 v154, v154
MA 116,a,212,v,104
v_add_f32 v3, v3, v152
v_add_f32 v3, v3, v153
MA 24,a,216,v,80
ds_read_b128 a[156:159], v10 offset:23552
ds_read_b128 a[160:163], v10 offset:24576
MA 56,a,216,v,88
v_exp_f32 v155, v155
MA 88,a,216,v,96
buffer_load_dwordx4 v12, s[52:55], s71 offen offset:2048 sc1 lds
v_cvt_pk_bf16_f32 v152, v152, v153
MA 120,a,216,v,104
v_exp_f32 v156, v156
MA 28,a,220,v,80
v_add_f32 v3, v3, v154
v_add_f32 v3, v3, v155
MA 60,a,220,v,88
v_exp_f32 v157, v157
MA 92,a,220,v,96
ds_read_b128 a[164:167], v10 offset:25600
v_cvt_pk_bf16_f32 v153, v154, v155
MA 124,a,220,v,104
v_exp_f32 v158, v158
MA 0,a,224,v,112
v_add_f32 v3, v3, v156
v_add_f32 v3, v3, v157
MA 32,a,224,v,120
v_exp_f32 v159, v159
MA 64,a,224,v,128
ds_read_b128 a[168:171], v10 offset:26624
v_cvt_pk_bf16_f32 v154, v156, v157
MA 96,a,224,v,136
v_exp_f32 v160, v160
MA 4,a,228,v,112
v_add_f32 v3, v3, v158
v_add_f32 v3, v3, v159
MA 36,a,228,v,120
ds_read_b128 a[172:175], v10 offset:27648
ds_read_b128 a[176:179], v10 offset:28672
MA 68,a,228,v,128
v_exp_f32 v161, v161
MA 100,a,228,v,136
ds_read_b128 a[180:183], v10 offset:29696
v_cvt_pk_bf16_f32 v155, v158, v159
MA 8,a,232,v,112
v_exp_f32 v162, v162
MA 40,a,232,v,120
v_add_f32 v4, v4, v160
v_add_f32 v4, v4, v161
MA 72,a,232,v,128
v_exp_f32 v163, v163
MA 104,a,232,v,136
buffer_load_dwordx4 v12, s[52:55], s71 offen offset:3072 sc1 lds
v_cvt_pk_bf16_f32 v160, v160, v161
MA 12,a,236,v,112
v_exp_f32 v164, v164
MA 44,a,236,v,120
v_add_f32 v4, v4, v162
v_add_f32 v4, v4, v163
MA 76,a,236,v,128
v_exp_f32 v165, v165
MA 108,a,236,v,136
ds_read_b128 a[184:187], v10 offset:30720
v_cvt_pk_bf16_f32 v161, v162, v163
MA 16,a,240,v,112
v_exp_f32 v166, v166
MA 48,a,240,v,120
v_add_f32 v4, v4, v164
v_add_f32 v4, v4, v165
MA 80,a,240,v,128
v_exp_f32 v167, v167
MA 112,a,240,v,136
ds_read_b128 a[188:191], v10 offset:31744
v_cvt_pk_bf16_f32 v162, v164, v165
MA 20,a,244,v,112
v_exp_f32 v168, v168
MA 52,a,244,v,120
v_add_f32 v4, v4, v166
v_add_f32 v4, v4, v167
MA 84,a,244,v,128
v_exp_f32 v169, v169
MA 116,a,244,v,136
s_sub_u32 s74, s74, 1
v_cvt_pk_bf16_f32 v163, v166, v167
MA 24,a,248,v,112
v_exp_f32 v170, v170
MA 56,a,248,v,120
v_add_f32 v5, v5, v168
v_add_f32 v5, v5, v169
MA 88,a,248,v,128
v_exp_f32 v171, v171
MA 120,a,248,v,136
v_cvt_pk_bf16_f32 v168, v168, v169
MA 28,a,252,v,112
v_exp_f32 v172, v172
MA 60,a,252,v,120
v_add_f32 v5, v5, v170
v_add_f32 v5, v5, v171
MA 92,a,252,v,128
v_exp_f32 v173, v173
MA 124,a,252,v,136
v_cvt_pk_bf16_f32 v169, v170, v171
v_exp_f32 v174, v174
v_add_f32 v5, v5, v172
v_add_f32 v5, v5, v173
v_exp_f32 v175, v175
v_cvt_pk_bf16_f32 v170, v172, v173
v_add_f32 v5, v5, v174
v_add_f32 v5, v5, v175
v_cvt_pk_bf16_f32 v171, v174, v175
s_cbranch_scc1 L_p3_d1m_top
s_waitcnt lgkmcnt(0)
v_xor_b32 v11, 0x8000, v11
v_mfma_f32_16x16x32_bf16 v[80:83], a[128:131], v[16:19], 0
s_add_u32 m0, s73, 16384
ds_read_b128 a[192:195], v11 offset:0
v_mfma_f32_16x16x32_bf16 v[88:91], a[128:131], v[32:35], 0
v_exp_f32 v176, v176
v_mfma_f32_16x16x32_bf16 v[96:99], a[128:131], v[48:51], 0
ds_read_b128 a[196:199], v11 offset:1024
buffer_load_dwordx4 v12, s[56:59], s71 offen offset:0 sc1 lds
v_mfma_f32_16x16x32_bf16 v[104:107], a[128:131], v[64:67], 0
v_exp_f32 v177, v177
MV 80,a,132,v,20
v_exp_f32 v178, v178
MV 88,a,132,v,36
v_add_f32 v2, v2, v176
v_add_f32 v2, v2, v177
MV 96,a,132,v,52
v_exp_f32 v179, v179
MV 104,a,132,v,68
ds_read_b128 a[200:203], v11 offset:2048
v_cvt_pk_bf16_f32 v176, v176, v177
MV 80,a,136,v,24
v_exp_f32 v180, v180
MV 88,a,136,v,40
v_add_f32 v2, v2, v178
v_add_f32 v2, v2, v179
MV 96,a,136,v,56
v_exp_f32 v181, v181
MV 104,a,136,v,72
ds_read_b128 a[204:207], v11 offset:3072
v_cvt_pk_bf16_f32 v177, v178, v179
MV 80,a,140,v,28
v_exp_f32 v182, v182
MV 88,a,140,v,44
buffer_load_dwordx4 v12, s[56:59], s71 offen offset:1024 sc1 lds
v_add_f32 v2, v2, v180
MV 96,a,140,v,60
ds_read_b128 a[208:211], v11 offset:4096
v_add_f32 v2, v2, v181
MV 104,a,140,v,76
v_exp_f32 v183, v183
v_mfma_f32_16x16x32_bf16 v[84:87], a[144:147], v[16:19], 0
ds_read_b128 a[212:215], v11 offset:5120
v_cvt_pk_bf16_f32 v178, v180, v181
v_mfma_f32_16x16x32_bf16 v[92:95], a[144:147], v[32:35], 0
v_exp_f32 v184, v184
v_mfma_f32_16x16x32_bf16 v[100:103], a[144:147], v[48:51], 0
v_add_f32 v2, v2, v182
v_add_f32 v2, v2, v183
v_mfma_f32_16x16x32_bf16 v[108:111], a[144:147], v[64:67], 0
v_exp_f32 v185, v185
MV 84,a,148,v,20
ds_read_b128 a[216:219], v11 offset:6144
v_cvt_pk_bf16_f32 v179, v182, v183
MV 92,a,148,v,36
v_exp_f32 v186, v186
MV 100,a,148,v,52
v_add_f32 v3, v3, v184
v_add_f32 v3, v3, v185
MV 108,a,148,v,68
v_exp_f32 v187, v187
MV 84,a,152,v,24
ds_read_b128 a[220:223], v11 offset:7168
v_cvt_pk_bf16_f32 v184, v184, v185
MV 92,a,152,v,40
ds_read_b128 a[224:227], v11 offset:8192
buffer_load_dwordx4 v12, s[56:59], s71 offen offset:2048 sc1 lds
MV 100,a,152,v,56
v_exp_f32 v188, v188
MV 108,a,152,v,72
v_add_f32 v3, v3, v186
v_add_f32 v3, v3, v187
MV 84,a,156,v,28
v_exp_f32 v189, v189
MV 92,a,156,v,44
ds_read_b128 a[228:231], v11 offset:9216
v_cvt_pk_bf16_f32 v185, v186, v187
MV 100,a,156,v,60
v_exp_f32 v190, v190
MV 108,a,156,v,76
v_add_f32 v3, v3, v188
v_add_f32 v3, v3, v189
v_mfma_f32_16x16x32_bf16 v[112:115], a[160:163], v[16:19], 0
v_exp_f32 v191, v191
v_mfma_f32_16x16x32_bf16 v[120:123], a[160:163], v[32:35], 0
ds_read_b128 a[232:235], v11 offset:10240
v_cvt_pk_bf16_f32 v186, v188, v189
v_mfma_f32_16x16x32_bf16 v[128:131], a[160:163], v[48:51], 0
v_exp_f32 v192, v192
v_mfma_f32_16x16x32_bf16 v[136:139], a[160:163], v[64:67], 0
buffer_load_dwordx4 v12, s[56:59], s71 offen offset:3072 sc1 lds
v_add_f32 v3, v3, v190
MV 112,a,164,v,20
ds_read_b128 a[236:239], v11 offset:11264
v_add_f32 v3, v3, v191
MV 120,a,164,v,36
v_exp_f32 v193, v193
MV 128,a,164,v,52
ds_read_b128 a[240:243], v11 offset:12288
v_cvt_pk_bf16_f32 v187, v190, v191
MV 136,a,164,v,68
v_exp_f32 v194, v194
MV 112,a,168,v,24
v_add_f32 v4, v4, v192
v_add_f32 v4, v4, v193
MV 120,a,168,v,40
v_exp_f32 v195, v195
MV 128,a,168,v,56
ds_read_b128 a[244:247], v11 offset:13312
v_cvt_pk_bf16_f32 v192, v192, v193
MV 136,a,168,v,72
v_exp_f32 v196, v196
MV 112,a,172,v,28
v_add_f32 v4, v4, v194
v_add_f32 v4, v4, v195
MV 120,a,172,v,44
v_exp_f32 v197, v197
MV 128,a,172,v,60
ds_read_b128 a[248:251], v11 offset:14336
v_cvt_pk_bf16_f32 v193, v194, v195
MV 136,a,172,v,76
v_exp_f32 v198, v198
v_mfma_f32_16x16x32_bf16 v[116:119], a[176:179], v[16:19], 0
s_add_u32 s71, s71, 16384
v_add_f32 v4, v4, v196
v_mfma_f32_16x16x32_bf16 v[124:127], a[176:179], v[32:35], 0
ds_read_b128 a[252:255], v11 offset:15360
v_add_f32 v4, v4, v197
v_mfma_f32_16x16x32_bf16 v[132:135], a[176:179], v[48:51], 0
v_exp_f32 v199, v199
v_mfma_f32_16x16x32_bf16 v[140:143], a[176:179], v[64:67], 0
s_xor_b32 s73, s73, 0x8000
v_cvt_pk_bf16_f32 v194, v196, v197
MV 116,a,180,v,20
v_exp_f32 v200, v200
MV 124,a,180,v,36
v_add_f32 v4, v4, v198
v_add_f32 v4, v4, v199
MV 132,a,180,v,52
v_exp_f32 v201, v201
MV 140,a,180,v,68
v_cvt_pk_bf16_f32 v195, v198, v199
MV 116,a,184,v,24
v_exp_f32 v202, v202
MV 124,a,184,v,40
v_add_f32 v5, v5, v200
v_add_f32 v5, v5, v201
MV 132,a,184,v,56
v_exp_f32 v203, v203
MV 140,a,184,v,72
v_cvt_pk_bf16_f32 v200, v200, v201
MV 116,a,188,v,28
v_exp_f32 v204, v204
MV 124,a,188,v,44
v_add_f32 v5, v5, v202
v_add_f32 v5, v5, v203
MV 132,a,188,v,60
v_exp_f32 v205, v205
MV 140,a,188,v,76
v_cvt_pk_bf16_f32 v201, v202, v203
v_exp_f32 v206, v206
v_add_f32 v5, v5, v204
v_add_f32 v5, v5, v205
v_exp_f32 v207, v207
v_cvt_pk_bf16_f32 v202, v204, v205
v_add_f32 v5, v5, v206
v_add_f32 v5, v5, v207
v_cvt_pk_bf16_f32 v203, v206, v207
s_waitcnt vmcnt(16) lgkmcnt(0)
MA 0,a,192,v,144
s_barrier
v_xor_b32 v10, 0x8000, v10
MA 32,a,192,v,152
s_add_u32 m0, s72, 16384
ds_read_b128 a[128:131], v10 offset:0
MA 64,a,192,v,160
v_exp_f32 v80, v80
MA 96,a,192,v,168
ds_read_b128 a[132:135], v10 offset:1024
buffer_load_dwordx4 v12, s[52:55], s71 offen offset:0 sc1 lds
MA 4,a,196,v,144
v_exp_f32 v81, v81
MA 36,a,196,v,152
v_exp_f32 v82, v82
MA 68,a,196,v,160
v_add_f32 v2, v2, v80
v_add_f32 v2, v2, v81
MA 100,a,196,v,168
v_exp_f32 v83, v83
MA 8,a,200,v,144
ds_read_b128 a[136:139], v10 offset:2048
v_cvt_pk_bf16_f32 v80, v80, v81
MA 40,a,200,v,152
v_exp_f32 v84, v84
MA 72,a,200,v,160
v_add_f32 v2, v2, v82
v_add_f32 v2, v2, v83
MA 104,a,200,v,168
ds_read_b128 a[140:143], v10 offset:3072
ds_read_b128 a[144:147], v10 offset:4096
MA 12,a,204,v,144
v_exp_f32 v85, v85
MA 44,a,204,v,152
buffer_load_dwordx4 v12, s[52:55], s71 offen offset:1024 sc1 lds
v_cvt_pk_bf16_f32 v81, v82, v83
MA 76,a,204,v,160
v_exp_f32 v86, v86
MA 108,a,204,v,168
v_add_f32 v2, v2, v84
v_add_f32 v2, v2, v85
MA 16,a,208,v,144
v_exp_f32 v87, v87
MA 48,a,208,v,152
ds_read_b128 a[148:151], v10 offset:5120
v_cvt_pk_bf16_f32 v82, v84, v85
MA 80,a,208,v,160
v_exp_f32 v88, v88
MA 112,a,208,v,168
v_add_f32 v2, v2, v86
v_add_f32 v2, v2, v87
MA 20,a,212,v,144
v_exp_f32 v89, v89
MA 52,a,212,v,152
ds_read_b128 a[152:155], v10 offset:6144
v_cvt_pk_bf16_f32 v83, v86, v87
MA 84,a,212,v,160
v_exp_f32 v90, v90
MA 116,a,212,v,168
v_add_f32 v3, v3, v88
v_add_f32 v3, v3, v89
MA 24,a,216,v,144
ds_read_b128 a[156:159], v10 offset:7168
ds_read_b128 a[160:163], v10 offset:8192
MA 56,a,216,v,152
v_exp_f32 v91, v91
MA 88,a,216,v,160
buffer_load_dwordx4 v12, s[52:55], s71 offen offset:2048 sc1 lds
v_cvt_pk_bf16_f32 v88, v88, v89
MA 120,a,216,v,168
v_exp_f32 v92, v92
MA 28,a,220,v,144
v_add_f32 v3, v3, v90
v_add_f32 v3, v3, v91
MA 60,a,220,v,152
v_exp_f32 v93, v93
MA 92,a,220,v,160
ds_read_b128 a[164:167], v10 offset:9216
v_cvt_pk_bf16_f32 v89, v90, v91
MA 124,a,220,v,168
v_exp_f32 v94, v94
MA 0,a,224,v,176
v_add_f32 v3, v3, v92
v_add_f32 v3, v3, v93
MA 32,a,224,v,184
v_exp_f32 v95, v95
MA 64,a,224,v,192
ds_read_b128 a[168:171], v10 offset:10240
v_cvt_pk_bf16_f32 v90, v92, v93
MA 96,a,224,v,200
v_exp_f32 v96, v96
MA 4,a,228,v,176
v_add_f32 v3, v3, v94
v_add_f32 v3, v3, v95
MA 36,a,228,v,184
ds_read_b128 a[172:175], v10 offset:11264
ds_read_b128 a[176:179], v10 offset:12288
MA 68,a,228,v,192
v_exp_f32 v97, v97
MA 100,a,228,v,200
ds_read_b128 a[180:183], v10 offset:13312
v_cvt_pk_bf16_f32 v91, v94, v95
MA 8,a,232,v,176
v_exp_f32 v98, v98
MA 40,a,232,v,184
v_add_f32 v4, v4, v96
v_add_f32 v4, v4, v97
MA 72,a,232,v,192
v_exp_f32 v99, v99
MA 104,a,232,v,200
buffer_load_dwordx4 v12, s[52:55], s71 offen offset:3072 sc1 lds
v_cvt_pk_bf16_f32 v96, v96, v97
MA 12,a,236,v,176
v_exp_f32 v100, v100
MA 44,a,236,v,184
v_add_f32 v4, v4, v98
v_add_f32 v4, v4, v99
MA 76,a,236,v,192
v_exp_f32 v101, v101
MA 108,a,236,v,200
ds_read_b128 a[184:187], v10 offset:14336
v_cvt_pk_bf16_f32 v97, v98, v99
MA 16,a,240,v,176
v_exp_f32 v102, v102
MA 48,a,240,v,184
v_add_f32 v4, v4, v100
v_add_f32 v4, v4, v101
MA 80,a,240,v,192
v_exp_f32 v103, v103
MA 112,a,240,v,200
ds_read_b128 a[188:191], v10 offset:15360
v_cvt_pk_bf16_f32 v98, v100, v101
MA 20,a,244,v,176
v_exp_f32 v104, v104
MA 52,a,244,v,184
v_add_f32 v4, v4, v102
v_add_f32 v4, v4, v103
MA 84,a,244,v,192
v_exp_f32 v105, v105
MA 116,a,244,v,200
s_xor_b32 s72, s72, 0x8000
v_cvt_pk_bf16_f32 v99, v102, v103
MA 24,a,248,v,176
v_exp_f32 v106, v106
MA 56,a,248,v,184
v_add_f32 v5, v5, v104
v_add_f32 v5, v5, v105
MA 88,a,248,v,192
v_exp_f32 v107, v107
MA 120,a,248,v,200
v_cvt_pk_bf16_f32 v104, v104, v105
MA 28,a,252,v,176
v_exp_f32 v108, v108
MA 60,a,252,v,184
v_add_f32 v5, v5, v106
v_add_f32 v5, v5, v107
MA 92,a,252,v,192
v_exp_f32 v109, v109
MA 124,a,252,v,200
v_cvt_pk_bf16_f32 v105, v106, v107
v_exp_f32 v110, v110
v_add_f32 v5, v5, v108
v_add_f32 v5, v5, v109
v_exp_f32 v111, v111
v_cvt_pk_bf16_f32 v106, v108, v109
v_add_f32 v5, v5, v110
v_add_f32 v5, v5, v111
v_cvt_pk_bf16_f32 v107, v110, v111
s_branch L_p3_d0_top
L_p3_d1m_top:
s_waitcnt lgkmcnt(0)
v_xor_b32 v11, 0x8000, v11
v_mfma_f32_16x16x32_bf16 v[80:83], a[128:131], v[16:19], 0
s_add_u32 m0, s73, 16384
ds_read_b128 a[192:195], v11 offset:0
v_mfma_f32_16x16x32_bf16 v[88:91], a[128:131], v[32:35], 0
v_exp_f32 v176, v176
v_mfma_f32_16x16x32_bf16 v[96:99], a[128:131], v[48:51], 0
ds_read_b128 a[196:199], v11 offset:1024
buffer_load_dwordx4 v12, s[56:59], s71 offen offset:0 sc1 lds
v_mfma_f32_16x16x32_bf16 v[104:107], a[128:131], v[64:67], 0
v_exp_f32 v177, v177
MV 80,a,132,v,20
v_exp_f32 v178, v178
MV 88,a,132,v,36
v_add_f32 v2, v2, v176
v_add_f32 v2, v2, v177
MV 96,a,132,v,52
v_exp_f32 v179, v179
MV 104,a,132,v,68
ds_read_b128 a[200:203], v11 offset:2048
v_cvt_pk_bf16_f32 v176, v176, v177
MV 80,a,136,v,24
v_exp_f32 v180, v180
MV 88,a,136,v,40
v_add_f32 v2, v2, v178
v_add_f32 v2, v2, v179
MV 96,a,136,v,56
v_exp_f32 v181, v181
MV 104,a,136,v,72
ds_read_b128 a[204:207], v11 offset:3072
v_cvt_pk_bf16_f32 v177, v178, v179
MV 80,a,140,v,28
v_exp_f32 v182, v182
MV 88,a,140,v,44
buffer_load_dwordx4 v12, s[56:59], s71 offen offset:1024 sc1 lds
v_add_f32 v2, v2, v180
MV 96,a,140,v,60
ds_read_b128 a[208:211], v11 offset:4096
v_add_f32 v2, v2, v181
MV 104,a,140,v,76
v_exp_f32 v183, v183
v_mfma_f32_16x16x32_bf16 v[84:87], a[144:147], v[16:19], 0
ds_read_b128 a[212:215], v11 offset:5120
v_cvt_pk_bf16_f32 v178, v180, v181
v_mfma_f32_16x16x32_bf16 v[92:95], a[144:147], v[32:35], 0
v_exp_f32 v184, v184
v_mfma_f32_16x16x32_bf16 v[100:103], a[144:147], v[48:51], 0
v_add_f32 v2, v2, v182
v_add_f32 v2, v2, v183
v_mfma_f32_16x16x32_bf16 v[108:111], a[144:147], v[64:67], 0
v_exp_f32 v185, v185
MV 84,a,148,v,20
ds_read_b128 a[216:219], v11 offset:6144
v_cvt_pk_bf16_f32 v179, v182, v183
MV 92,a,148,v,36
v_exp_f32 v186, v186
MV 100,a,148,v,52
v_add_f32 v3, v3, v184
v_add_f32 v3, v3, v185
MV 108,a,148,v,68
v_exp_f32 v187, v187
MV 84,a,152,v,24
ds_read_b128 a[220:223], v11 offset:7168
v_cvt_pk_bf16_f32 v184, v184, v185
MV 92,a,152,v,40
ds_read_b128 a[224:227], v11 offset:8192
buffer_load_dwordx4 v12, s[56:59], s71 offen offset:2048 sc1 lds
MV 100,a,152,v,56
v_exp_f32 v188, v188
MV 108,a,152,v,72
v_add_f32 v3, v3, v186
v_add_f32 v3, v3, v187
MV 84,a,156,v,28
v_exp_f32 v189, v189
MV 92,a,156,v,44
ds_read_b128 a[228:231], v11 offset:9216
v_cvt_pk_bf16_f32 v185, v186, v187
MV 100,a,156,v,60
v_exp_f32 v190, v190
MV 108,a,156,v,76
v_add_f32 v3, v3, v188
v_add_f32 v3, v3, v189
v_mfma_f32_16x16x32_bf16 v[112:115], a[160:163], v[16:19], 0
v_exp_f32 v191, v191
v_mfma_f32_16x16x32_bf16 v[120:123], a[160:163], v[32:35], 0
ds_read_b128 a[232:235], v11 offset:10240
v_cvt_pk_bf16_f32 v186, v188, v189
v_mfma_f32_16x16x32_bf16 v[128:131], a[160:163], v[48:51], 0
v_exp_f32 v192, v192
v_mfma_f32_16x16x32_bf16 v[136:139], a[160:163], v[64:67], 0
buffer_load_dwordx4 v12, s[56:59], s71 offen offset:3072 sc1 lds
v_add_f32 v3, v3, v190
MV 112,a,164,v,20
ds_read_b128 a[236:239], v11 offset:11264
v_add_f32 v3, v3, v191
MV 120,a,164,v,36
v_exp_f32 v193, v193
MV 128,a,164,v,52
ds_read_b128 a[240:243], v11 offset:12288
v_cvt_pk_bf16_f32 v187, v190, v191
MV 136,a,164,v,68
v_exp_f32 v194, v194
MV 112,a,168,v,24
v_add_f32 v4, v4, v192
v_add_f32 v4, v4, v193
MV 120,a,168,v,40
v_exp_f32 v195, v195
MV 128,a,168,v,56
v_cvt_pk_bf16_f32 v192, v192, v193
v_add_u32 v246, 0, v13
MV 136,a,168,v,72
v_exp_f32 v196, v196
MV 112,a,172,v,28
ds_read_b128 a[244:247], v11 offset:13312
v_add_f32 v4, v4, v194
MV 120,a,172,v,44
v_add_f32 v4, v4, v195
v_cmp_gt_i32_e64 s[84:85], 0, v246
MV 128,a,172,v,60
ds_read_b128 a[248:251], v11 offset:14336
v_cmp_gt_i32_e64 s[86:87], 1, v246
MV 136,a,172,v,76
v_exp_f32 v197, v197
v_mfma_f32_16x16x32_bf16 v[116:119], a[176:179], v[16:19], 0
v_cvt_pk_bf16_f32 v193, v194, v195
v_cmp_gt_i32_e64 s[88:89], 2, v246
v_mfma_f32_16x16x32_bf16 v[124:127], a[176:179], v[32:35], 0
v_exp_f32 v198, v198
v_mfma_f32_16x16x32_bf16 v[132:135], a[176:179], v[48:51], 0
s_add_u32 s71, s71, 16384
v_add_f32 v4, v4, v196
v_mfma_f32_16x16x32_bf16 v[140:143], a[176:179], v[64:67], 0
v_add_f32 v4, v4, v197
v_cmp_gt_i32_e64 s[90:91], 3, v246
MV 116,a,180,v,20
v_exp_f32 v199, v199
MV 124,a,180,v,36
ds_read_b128 a[252:255], v11 offset:15360
v_cvt_pk_bf16_f32 v194, v196, v197
MV 132,a,180,v,52
v_cndmask_b32_e64 v96, v96, v14, s[84:85]
v_cndmask_b32_e64 v97, v97, v14, s[86:87]
MV 140,a,180,v,68
v_exp_f32 v200, v200
MV 116,a,184,v,24
v_add_f32 v4, v4, v198
v_add_f32 v4, v4, v199
MV 124,a,184,v,40
v_cndmask_b32_e64 v98, v98, v14, s[88:89]
v_cndmask_b32_e64 v99, v99, v14, s[90:91]
MV 132,a,184,v,56
v_exp_f32 v201, v201
MV 140,a,184,v,72
v_cvt_pk_bf16_f32 v195, v198, v199
v_add_u32 v247, -16, v13
MV 116,a,188,v,28
v_exp_f32 v202, v202
MV 124,a,188,v,44
v_add_f32 v5, v5, v200
v_add_f32 v5, v5, v201
MV 132,a,188,v,60
s_xor_b32 s73, s73, 0x8000
v_cmp_gt_i32_e64 s[92:93], 0, v247
MV 140,a,188,v,76
v_exp_f32 v203, v203
v_cvt_pk_bf16_f32 v200, v200, v201
v_cmp_gt_i32_e64 s[94:95], 1, v247
v_exp_f32 v204, v204
v_add_f32 v5, v5, v202
v_cmp_gt_i32_e64 s[96:97], 2, v247
v_add_f32 v5, v5, v203
v_exp_f32 v205, v205
v_cmp_gt_i32_e64 s[98:99], 3, v247
v_cvt_pk_bf16_f32 v201, v202, v203
v_exp_f32 v206, v206
v_cndmask_b32_e64 v100, v100, v14, s[92:93]
v_add_f32 v5, v5, v204
v_cndmask_b32_e64 v101, v101, v14, s[94:95]
v_add_f32 v5, v5, v205
v_exp_f32 v207, v207
v_cvt_pk_bf16_f32 v202, v204, v205
v_cndmask_b32_e64 v102, v102, v14, s[96:97]
v_add_f32 v5, v5, v206
v_add_f32 v5, v5, v207
v_cndmask_b32_e64 v103, v103, v14, s[98:99]
v_cvt_pk_bf16_f32 v203, v206, v207
s_waitcnt vmcnt(16) lgkmcnt(0)
MA 0,a,192,v,144
s_barrier
v_xor_b32 v10, 0x8000, v10
MA 32,a,192,v,152
s_add_u32 m0, s72, 16384
ds_read_b128 a[128:131], v10 offset:0
MA 64,a,192,v,160
v_exp_f32 v80, v80
MA 96,a,192,v,168
ds_read_b128 a[132:135], v10 offset:1024
buffer_load_dwordx4 v12, s[52:55], s71 offen offset:0 sc1 lds
MA 4,a,196,v,144
v_exp_f32 v81, v81
MA 36,a,196,v,152
v_exp_f32 v82, v82
MA 68,a,196,v,160
v_add_f32 v2, v2, v80
v_add_f32 v2, v2, v81
MA 100,a,196,v,168
v_exp_f32 v83, v83
MA 8,a,200,v,144
ds_read_b128 a[136:139], v10 offset:2048
v_cvt_pk_bf16_f32 v80, v80, v81
MA 40,a,200,v,152
ds_read_b128 a[140:143], v10 offset:3072
v_add_u32 v246, -32, v13
MA 72,a,200,v,160
v_exp_f32 v84, v84
MA 104,a,200,v,168
v_add_f32 v2, v2, v82
v_add_f32 v2, v2, v83
MA 12,a,204,v,144
ds_read_b128 a[144:147], v10 offset:4096
v_cmp_gt_i32_e64 s[84:85], 0, v246
MA 44,a,204,v,152
v_exp_f32 v85, v85
MA 76,a,204,v,160
v_cvt_pk_bf16_f32 v81, v82, v83
v_cmp_gt_i32_e64 s[86:87], 1, v246
MA 108,a,204,v,168
v_exp_f32 v86, v86
MA 16,a,208,v,144
v_add_f32 v2, v2, v84
v_add_f32 v2, v2, v85
MA 48,a,208,v,152
v_exp_f32 v87, v87
MA 80,a,208,v,160
buffer_load_dwordx4 v12, s[52:55], s71 offen offset:1024 sc1 lds
v_cvt_pk_bf16_f32 v82, v84, v85
MA 112,a,208,v,168
ds_read_b128 a[148:151], v10 offset:5120
v_cmp_gt_i32_e64 s[88:89], 2, v246
MA 20,a,212,v,144
v_exp_f32 v88, v88
MA 52,a,212,v,152
v_add_f32 v2, v2, v86
v_add_f32 v2, v2, v87
MA 84,a,212,v,160
v_exp_f32 v89, v89
MA 116,a,212,v,168
ds_read_b128 a[152:155], v10 offset:6144
v_cvt_pk_bf16_f32 v83, v86, v87
MA 24,a,216,v,144
ds_read_b128 a[156:159], v10 offset:7168
v_cmp_gt_i32_e64 s[90:91], 3, v246
MA 56,a,216,v,152
v_exp_f32 v90, v90
MA 88,a,216,v,160
v_add_f32 v3, v3, v88
v_add_f32 v3, v3, v89
MA 120,a,216,v,168
v_exp_f32 v91, v91
MA 28,a,220,v,144
v_cvt_pk_bf16_f32 v88, v88, v89
v_cndmask_b32_e64 v128, v128, v14, s[84:85]
MA 60,a,220,v,152
v_exp_f32 v92, v92
MA 92,a,220,v,160
ds_read_b128 a[160:163], v10 offset:8192
v_add_f32 v3, v3, v90
MA 124,a,220,v,168
v_add_f32 v3, v3, v91
v_cndmask_b32_e64 v129, v129, v14, s[86:87]
MA 0,a,224,v,176
v_exp_f32 v93, v93
MA 32,a,224,v,184
buffer_load_dwordx4 v12, s[52:55], s71 offen offset:2048 sc1 lds
v_cvt_pk_bf16_f32 v89, v90, v91
MA 64,a,224,v,192
v_exp_f32 v94, v94
MA 96,a,224,v,200
ds_read_b128 a[164:167], v10 offset:9216
v_add_f32 v3, v3, v92
MA 4,a,228,v,176
v_add_f32 v3, v3, v93
v_cndmask_b32_e64 v130, v130, v14, s[88:89]
MA 36,a,228,v,184
v_exp_f32 v95, v95
MA 68,a,228,v,192
ds_read_b128 a[168:171], v10 offset:10240
v_cvt_pk_bf16_f32 v90, v92, v93
MA 100,a,228,v,200
v_exp_f32 v96, v96
MA 8,a,232,v,176
v_add_f32 v3, v3, v94
v_cndmask_b32_e64 v131, v131, v14, s[90:91]
MA 40,a,232,v,184
ds_read_b128 a[172:175], v10 offset:11264
v_add_f32 v3, v3, v95
MA 72,a,232,v,192
v_exp_f32 v97, v97
MA 104,a,232,v,200
v_cvt_pk_bf16_f32 v91, v94, v95
v_add_u32 v247, -48, v13
MA 12,a,236,v,176
v_exp_f32 v98, v98
MA 44,a,236,v,184
ds_read_b128 a[176:179], v10 offset:12288
v_add_f32 v4, v4, v96
MA 76,a,236,v,192
v_add_f32 v4, v4, v97
v_cmp_gt_i32_e64 s[92:93], 0, v247
MA 108,a,236,v,200
v_exp_f32 v99, v99
MA 16,a,240,v,176
ds_read_b128 a[180:183], v10 offset:13312
v_cvt_pk_bf16_f32 v96, v96, v97
MA 48,a,240,v,184
v_exp_f32 v100, v100
MA 80,a,240,v,192
buffer_load_dwordx4 v12, s[52:55], s71 offen offset:3072 sc1 lds
v_add_f32 v4, v4, v98
MA 112,a,240,v,200
v_add_f32 v4, v4, v99
v_cmp_gt_i32_e64 s[94:95], 1, v247
MA 20,a,244,v,176
v_exp_f32 v101, v101
MA 52,a,244,v,184
ds_read_b128 a[184:187], v10 offset:14336
v_cvt_pk_bf16_f32 v97, v98, v99
MA 84,a,244,v,192
v_exp_f32 v102, v102
MA 116,a,244,v,200
v_add_f32 v4, v4, v100
v_add_f32 v4, v4, v101
MA 24,a,248,v,176
ds_read_b128 a[188:191], v10 offset:15360
v_cmp_gt_i32_e64 s[96:97], 2, v247
MA 56,a,248,v,184
v_exp_f32 v103, v103
MA 88,a,248,v,192
v_cvt_pk_bf16_f32 v98, v100, v101
v_cmp_gt_i32_e64 s[98:99], 3, v247
MA 120,a,248,v,200
v_exp_f32 v104, v104
MA 28,a,252,v,176
v_add_f32 v4, v4, v102
v_add_f32 v4, v4, v103
MA 60,a,252,v,184
v_exp_f32 v105, v105
MA 92,a,252,v,192
s_xor_b32 s72, s72, 0x8000
v_cvt_pk_bf16_f32 v99, v102, v103
MA 124,a,252,v,200
v_exp_f32 v106, v106
v_add_f32 v5, v5, v104
v_cndmask_b32_e64 v132, v132, v14, s[92:93]
v_add_f32 v5, v5, v105
v_exp_f32 v107, v107
v_cvt_pk_bf16_f32 v104, v104, v105
v_exp_f32 v108, v108
v_cndmask_b32_e64 v133, v133, v14, s[94:95]
v_add_f32 v5, v5, v106
v_add_f32 v5, v5, v107
v_exp_f32 v109, v109
v_cvt_pk_bf16_f32 v105, v106, v107
v_cndmask_b32_e64 v134, v134, v14, s[96:97]
v_exp_f32 v110, v110
v_add_f32 v5, v5, v108
v_add_f32 v5, v5, v109
v_exp_f32 v111, v111
v_cndmask_b32_e64 v135, v135, v14, s[98:99]
v_cvt_pk_bf16_f32 v106, v108, v109
v_add_f32 v5, v5, v110
v_add_f32 v5, v5, v111
v_cvt_pk_bf16_f32 v107, v110, v111
L_p3_d0m_top:
s_waitcnt lgkmcnt(0)
v_mfma_f32_16x16x32_bf16 v[144:147], a[128:131], v[16:19], 0
s_add_u32 m0, s73, 0
ds_read_b128 a[192:195], v11 offset:16384
v_mfma_f32_16x16x32_bf16 v[152:155], a[128:131], v[32:35], 0
v_exp_f32 v112, v112
v_mfma_f32_16x16x32_bf16 v[168:171], a[128:131], v[64:67], 0
v_exp_f32 v113, v113
MV 144,a,132,v,20
ds_read_b128 a[196:199], v11 offset:17408
buffer_load_dwordx4 v12, s[56:59], s71 offen offset:0 sc1 lds
MV 152,a,132,v,36
v_exp_f32 v114, v114
MV 168,a,132,v,68
v_add_f32 v2, v2, v112
v_add_f32 v2, v2, v113
MV 144,a,136,v,24
v_exp_f32 v115, v115
MV 152,a,136,v,40
ds_read_b128 a[200:203], v11 offset:18432
v_cvt_pk_bf16_f32 v112, v112, v113
MV 168,a,136,v,72
v_exp_f32 v116, v116
MV 144,a,140,v,28
ds_read_b128 a[204:207], v11 offset:19456
v_add_f32 v2, v2, v114
MV 152,a,140,v,44
ds_read_b128 a[208:211], v11 offset:20480
v_add_f32 v2, v2, v115
MV 168,a,140,v,76
v_exp_f32 v117, v117
v_mfma_f32_16x16x32_bf16 v[148:151], a[144:147], v[16:19], 0
buffer_load_dwordx4 v12, s[56:59], s71 offen offset:1024 sc1 lds
v_cvt_pk_bf16_f32 v113, v114, v115
v_mfma_f32_16x16x32_bf16 v[156:159], a[144:147], v[32:35], 0
v_exp_f32 v118, v118
v_mfma_f32_16x16x32_bf16 v[172:175], a[144:147], v[64:67], 0
v_add_f32 v2, v2, v116
v_add_f32 v2, v2, v117
MV 148,a,148,v,20
v_exp_f32 v119, v119
MV 156,a,148,v,36
ds_read_b128 a[212:215], v11 offset:21504
v_cvt_pk_bf16_f32 v114, v116, v117
MV 172,a,148,v,68
v_exp_f32 v120, v120
MV 148,a,152,v,24
v_add_f32 v2, v2, v118
v_add_f32 v2, v2, v119
MV 156,a,152,v,40
v_exp_f32 v121, v121
MV 172,a,152,v,72
ds_read_b128 a[216:219], v11 offset:22528
v_cvt_pk_bf16_f32 v115, v118, v119
MV 148,a,156,v,28
v_exp_f32 v122, v122
MV 156,a,156,v,44
ds_read_b128 a[220:223], v11 offset:23552
v_add_f32 v3, v3, v120
MV 172,a,156,v,76
ds_read_b128 a[224:227], v11 offset:24576
v_add_f32 v3, v3, v121
v_mfma_f32_16x16x32_bf16 v[176:179], a[160:163], v[16:19], 0
v_exp_f32 v123, v123
v_mfma_f32_16x16x32_bf16 v[184:187], a[160:163], v[32:35], 0
buffer_load_dwordx4 v12, s[56:59], s71 offen offset:2048 sc1 lds
v_cvt_pk_bf16_f32 v120, v120, v121
v_mfma_f32_16x16x32_bf16 v[200:203], a[160:163], v[64:67], 0
v_exp_f32 v124, v124
MV 176,a,164,v,20
v_add_f32 v3, v3, v122
v_add_f32 v3, v3, v123
MV 184,a,164,v,36
v_exp_f32 v125, v125
MV 200,a,164,v,68
ds_read_b128 a[228:231], v11 offset:25600
v_cvt_pk_bf16_f32 v121, v122, v123
MV 176,a,168,v,24
v_exp_f32 v126, v126
MV 184,a,168,v,40
v_add_f32 v3, v3, v124
v_add_f32 v3, v3, v125
MV 200,a,168,v,72
v_exp_f32 v127, v127
MV 176,a,172,v,28
ds_read_b128 a[232:235], v11 offset:26624
v_cvt_pk_bf16_f32 v122, v124, v125
MV 184,a,172,v,44
v_exp_f32 v128, v128
MV 200,a,172,v,76
ds_read_b128 a[236:239], v11 offset:27648
v_add_f32 v3, v3, v126
v_mfma_f32_16x16x32_bf16 v[180:183], a[176:179], v[16:19], 0
ds_read_b128 a[240:243], v11 offset:28672
v_add_f32 v3, v3, v127
v_mfma_f32_16x16x32_bf16 v[188:191], a[176:179], v[32:35], 0
v_exp_f32 v129, v129
v_mfma_f32_16x16x32_bf16 v[204:207], a[176:179], v[64:67], 0
ds_read_b128 a[244:247], v11 offset:29696
v_cvt_pk_bf16_f32 v123, v126, v127
MV 180,a,180,v,20
v_exp_f32 v130, v130
MV 188,a,180,v,36
v_add_f32 v4, v4, v128
v_add_f32 v4, v4, v129
MV 204,a,180,v,68
v_exp_f32 v131, v131
MV 180,a,184,v,24
buffer_load_dwordx4 v12, s[56:59], s71 offen offset:3072 sc1 lds
v_cvt_pk_bf16_f32 v128, v128, v129
MV 188,a,184,v,40
v_exp_f32 v132, v132
MV 204,a,184,v,72
v_add_f32 v4, v4, v130
v_add_f32 v4, v4, v131
MV 180,a,188,v,28
ds_read_b128 a[248:251], v11 offset:30720
v_add_u32 v246, -64, v239
MV 188,a,188,v,44
v_exp_f32 v133, v133
MV 204,a,188,v,76
ds_read_b128 a[252:255], v11 offset:31744
s_add_u32 s71, s71, 16384
v_cvt_pk_bf16_f32 v129, v130, v131
v_exp_f32 v134, v134
v_cmp_gt_i32_e64 s[84:85], 0, v246
v_add_f32 v4, v4, v132
v_cmp_gt_i32_e64 s[86:87], 1, v246
v_add_f32 v4, v4, v133
v_exp_f32 v135, v135
v_cmp_gt_i32_e64 s[88:89], 2, v246
v_cvt_pk_bf16_f32 v130, v132, v133
v_exp_f32 v136, v136
v_cmp_gt_i32_e64 s[90:91], 3, v246
v_add_f32 v4, v4, v134
v_cndmask_b32_e64 v168, v168, v14, s[84:85]
v_add_f32 v4, v4, v135
v_exp_f32 v137, v137
v_cndmask_b32_e64 v169, v169, v14, s[86:87]
v_cvt_pk_bf16_f32 v131, v134, v135
v_exp_f32 v138, v138
v_cndmask_b32_e64 v170, v170, v14, s[88:89]
v_add_f32 v5, v5, v136
v_cndmask_b32_e64 v171, v171, v14, s[90:91]
v_add_f32 v5, v5, v137
v_exp_f32 v139, v139
v_add_u32 v247, -80, v239
v_cvt_pk_bf16_f32 v136, v136, v137
v_exp_f32 v140, v140
v_cmp_gt_i32_e64 s[92:93], 0, v247
v_add_f32 v5, v5, v138
v_cmp_gt_i32_e64 s[94:95], 1, v247
v_add_f32 v5, v5, v139
v_exp_f32 v141, v141
v_cmp_gt_i32_e64 s[96:97], 2, v247
v_cvt_pk_bf16_f32 v137, v138, v139
v_exp_f32 v142, v142
v_cmp_gt_i32_e64 s[98:99], 3, v247
v_add_f32 v5, v5, v140
v_cndmask_b32_e64 v172, v172, v14, s[92:93]
v_add_f32 v5, v5, v141
v_exp_f32 v143, v143
v_cndmask_b32_e64 v173, v173, v14, s[94:95]
v_cvt_pk_bf16_f32 v138, v140, v141
v_add_f32 v5, v5, v142
v_cndmask_b32_e64 v174, v174, v14, s[96:97]
v_add_f32 v5, v5, v143
v_cvt_pk_bf16_f32 v139, v142, v143
v_cndmask_b32_e64 v175, v175, v14, s[98:99]
s_waitcnt vmcnt(16) lgkmcnt(0)
MA 0,a,192,v,80
s_barrier
MA 32,a,192,v,88
s_add_u32 m0, s72, 0
ds_read_b128 a[128:131], v10 offset:16384
MA 64,a,192,v,96
v_exp_f32 v144, v144
MA 96,a,192,v,104
ds_read_b128 a[132:135], v10 offset:17408
buffer_load_dwordx4 v12, s[52:55], s71 offen offset:0 sc1 lds
MA 4,a,196,v,80
v_exp_f32 v145, v145
MA 36,a,196,v,88
v_exp_f32 v146, v146
MA 68,a,196,v,96
ds_read_b128 a[136:139], v10 offset:18432
v_add_f32 v2, v2, v144
MA 100,a,196,v,104
v_add_f32 v2, v2, v145
v_add_u32 v246, -96, v239
MA 8,a,200,v,80
v_exp_f32 v147, v147
MA 40,a,200,v,88
ds_read_b128 a[140:143], v10 offset:19456
v_cvt_pk_bf16_f32 v144, v144, v145
MA 72,a,200,v,96
v_exp_f32 v148, v148
MA 104,a,200,v,104
v_add_f32 v2, v2, v146
v_cmp_gt_i32_e64 s[84:85], 0, v246
MA 12,a,204,v,80
ds_read_b128 a[144:147], v10 offset:20480
v_add_f32 v2, v2, v147
MA 44,a,204,v,88
v_exp_f32 v149, v149
MA 76,a,204,v,96
v_cvt_pk_bf16_f32 v145, v146, v147
v_cmp_gt_i32_e64 s[86:87], 1, v246
MA 108,a,204,v,104
ds_read_b128 a[148:151], v10 offset:21504
buffer_load_dwordx4 v12, s[52:55], s71 offen offset:1024 sc1 lds
MA 16,a,208,v,80
v_exp_f32 v150, v150
MA 48,a,208,v,88
v_add_f32 v2, v2, v148
v_cmp_gt_i32_e64 s[88:89], 2, v246
MA 80,a,208,v,96
ds_read_b128 a[152:155], v10 offset:22528
v_add_f32 v2, v2, v149
MA 112,a,208,v,104
v_exp_f32 v151, v151
MA 20,a,212,v,80
v_cvt_pk_bf16_f32 v146, v148, v149
v_cmp_gt_i32_e64 s[90:91], 3, v246
MA 52,a,212,v,88
v_exp_f32 v152, v152
MA 84,a,212,v,96
ds_read_b128 a[156:159], v10 offset:23552
v_add_f32 v2, v2, v150
MA 116,a,212,v,104
v_add_f32 v2, v2, v151
v_cndmask_b32_e64 v200, v200, v14, s[84:85]
MA 24,a,216,v,80
v_exp_f32 v153, v153
MA 56,a,216,v,88
ds_read_b128 a[160:163], v10 offset:24576
v_cvt_pk_bf16_f32 v147, v150, v151
MA 88,a,216,v,96
buffer_load_dwordx4 v12, s[52:55], s71 offen offset:2048 sc1 lds
v_cndmask_b32_e64 v201, v201, v14, s[86:87]
MA 120,a,216,v,104
v_exp_f32 v154, v154
MA 28,a,220,v,80
ds_read_b128 a[164:167], v10 offset:25600
v_add_f32 v3, v3, v152
MA 60,a,220,v,88
v_add_f32 v3, v3, v153
v_cndmask_b32_e64 v202, v202, v14, s[88:89]
MA 92,a,220,v,96
v_exp_f32 v155, v155
MA 124,a,220,v,104
ds_read_b128 a[168:171], v10 offset:26624
v_cvt_pk_bf16_f32 v152, v152, v153
MA 0,a,224,v,112
v_exp_f32 v156, v156
MA 32,a,224,v,120
v_add_f32 v3, v3, v154
v_cndmask_b32_e64 v203, v203, v14, s[90:91]
MA 64,a,224,v,128
ds_read_b128 a[172:175], v10 offset:27648
v_add_f32 v3, v3, v155
MA 96,a,224,v,136
v_exp_f32 v157, v157
MA 4,a,228,v,112
v_cvt_pk_bf16_f32 v153, v154, v155
v_add_u32 v247, -112, v239
MA 36,a,228,v,120
v_exp_f32 v158, v158
MA 68,a,228,v,128
ds_read_b128 a[176:179], v10 offset:28672
v_add_f32 v3, v3, v156
MA 100,a,228,v,136
v_add_f32 v3, v3, v157
v_cmp_gt_i32_e64 s[92:93], 0, v247
MA 8,a,232,v,112
v_exp_f32 v159, v159
MA 40,a,232,v,120
ds_read_b128 a[180:183], v10 offset:29696
buffer_load_dwordx4 v12, s[52:55], s71 offen offset:3072 sc1 lds
MA 72,a,232,v,128
v_cvt_pk_bf16_f32 v154, v156, v157
v_cmp_gt_i32_e64 s[94:95], 1, v247
MA 104,a,232,v,136
v_exp_f32 v168, v168
MA 12,a,236,v,112
ds_read_b128 a[184:187], v10 offset:30720
v_add_f32 v3, v3, v158
MA 44,a,236,v,120
v_add_f32 v3, v3, v159
v_cmp_gt_i32_e64 s[96:97], 2, v247
MA 76,a,236,v,128
v_exp_f32 v169, v169
MA 108,a,236,v,136
ds_read_b128 a[188:191], v10 offset:31744
v_cvt_pk_bf16_f32 v155, v158, v159
MA 16,a,240,v,112
v_exp_f32 v170, v170
MA 48,a,240,v,120
v_add_f32 v5, v5, v168
v_cmp_gt_i32_e64 s[98:99], 3, v247
MA 80,a,240,v,128
s_cmp_eq_u32 s70, 7
v_add_f32 v5, v5, v169
MA 112,a,240,v,136
v_exp_f32 v171, v171
MA 20,a,244,v,112
v_cvt_pk_bf16_f32 v168, v168, v169
v_cndmask_b32_e64 v204, v204, v14, s[92:93]
MA 52,a,244,v,120
v_exp_f32 v172, v172
MA 84,a,244,v,128
v_add_f32 v5, v5, v170
v_add_f32 v5, v5, v171
MA 116,a,244,v,136
v_exp_f32 v173, v173
MA 24,a,248,v,112
v_cvt_pk_bf16_f32 v169, v170, v171
v_cndmask_b32_e64 v205, v205, v14, s[94:95]
MA 56,a,248,v,120
v_exp_f32 v174, v174
MA 88,a,248,v,128
v_add_f32 v5, v5, v172
v_cndmask_b32_e64 v206, v206, v14, s[96:97]
MA 120,a,248,v,136
v_add_f32 v5, v5, v173
v_cndmask_b32_e64 v207, v207, v14, s[98:99]
MA 28,a,252,v,112
v_exp_f32 v175, v175
MA 60,a,252,v,120
v_cvt_pk_bf16_f32 v170, v172, v173
v_add_f32 v5, v5, v174
MA 92,a,252,v,128
v_add_f32 v5, v5, v175
v_cvt_pk_bf16_f32 v171, v174, v175
MA 124,a,252,v,136
s_cbranch_scc1 L_p3_mxm_top
s_waitcnt lgkmcnt(0)
v_xor_b32 v11, 0x8000, v11
v_mfma_f32_16x16x32_bf16 v[80:83], a[128:131], v[16:19], 0
s_add_u32 m0, s73, 16384
ds_read_b128 a[192:195], v11 offset:0
v_mfma_f32_16x16x32_bf16 v[88:91], a[128:131], v[32:35], 0
v_exp_f32 v176, v176
MV 80,a,132,v,20
v_exp_f32 v177, v177
MV 88,a,132,v,36
ds_read_b128 a[196:199], v11 offset:1024
buffer_load_dwordx4 v12, s[56:59], s71 offen offset:0 sc1 lds
MV 80,a,136,v,24
v_exp_f32 v178, v178
MV 88,a,136,v,40
v_add_f32 v2, v2, v176
v_add_f32 v2, v2, v177
MV 80,a,140,v,28
ds_read_b128 a[200:203], v11 offset:2048
ds_read_b128 a[204:207], v11 offset:3072
MV 88,a,140,v,44
v_exp_f32 v179, v179
v_mfma_f32_16x16x32_bf16 v[84:87], a[144:147], v[16:19], 0
ds_read_b128 a[208:211], v11 offset:4096
v_cvt_pk_bf16_f32 v176, v176, v177
v_mfma_f32_16x16x32_bf16 v[92:95], a[144:147], v[32:35], 0
v_exp_f32 v180, v180
MV 84,a,148,v,20
v_add_f32 v2, v2, v178
v_add_f32 v2, v2, v179
MV 92,a,148,v,36
v_exp_f32 v181, v181
MV 84,a,152,v,24
buffer_load_dwordx4 v12, s[56:59], s71 offen offset:1024 sc1 lds
v_cvt_pk_bf16_f32 v177, v178, v179
MV 92,a,152,v,40
v_exp_f32 v182, v182
MV 84,a,156,v,28
ds_read_b128 a[212:215], v11 offset:5120
v_add_f32 v2, v2, v180
MV 92,a,156,v,44
ds_read_b128 a[216:219], v11 offset:6144
v_add_f32 v2, v2, v181
v_mfma_f32_16x16x32_bf16 v[112:115], a[160:163], v[16:19], 0
v_exp_f32 v183, v183
v_mfma_f32_16x16x32_bf16 v[120:123], a[160:163], v[32:35], 0
ds_read_b128 a[220:223], v11 offset:7168
v_cvt_pk_bf16_f32 v178, v180, v181
MV 112,a,164,v,20
v_exp_f32 v184, v184
MV 120,a,164,v,36
v_add_f32 v2, v2, v182
v_add_f32 v2, v2, v183
MV 112,a,168,v,24
ds_read_b128 a[224:227], v11 offset:8192
buffer_load_dwordx4 v12, s[56:59], s71 offen offset:2048 sc1 lds
MV 120,a,168,v,40
v_exp_f32 v185, v185
MV 112,a,172,v,28
ds_read_b128 a[228:231], v11 offset:9216
v_cvt_pk_bf16_f32 v179, v182, v183
MV 120,a,172,v,44
v_exp_f32 v186, v186
v_mfma_f32_16x16x32_bf16 v[116:119], a[176:179], v[16:19], 0
v_add_f32 v3, v3, v184
v_add_f32 v3, v3, v185
v_mfma_f32_16x16x32_bf16 v[124:127], a[176:179], v[32:35], 0
v_exp_f32 v187, v187
MV 116,a,180,v,20
ds_read_b128 a[232:235], v11 offset:10240
v_cvt_pk_bf16_f32 v184, v184, v185
MV 124,a,180,v,36
v_exp_f32 v188, v188
MV 116,a,184,v,24
ds_read_b128 a[236:239], v11 offset:11264
v_add_f32 v3, v3, v186
MV 124,a,184,v,40
buffer_load_dwordx4 v12, s[56:59], s71 offen offset:3072 sc1 lds
v_add_f32 v3, v3, v187
MV 116,a,188,v,28
v_exp_f32 v189, v189
MV 124,a,188,v,44
ds_read_b128 a[240:243], v11 offset:12288
ds_read_b128 a[244:247], v11 offset:13312
ds_read_b128 a[248:251], v11 offset:14336
ds_read_b128 a[252:255], v11 offset:15360
s_add_u32 s71, s71, 16384
s_xor_b32 s73, s73, 0x8000
v_cvt_pk_bf16_f32 v185, v186, v187
v_exp_f32 v190, v190
v_add_f32 v3, v3, v188
v_add_f32 v3, v3, v189
v_exp_f32 v191, v191
v_cvt_pk_bf16_f32 v186, v188, v189
v_exp_f32 v200, v200
v_add_f32 v3, v3, v190
v_add_f32 v3, v3, v191
v_exp_f32 v201, v201
v_cvt_pk_bf16_f32 v187, v190, v191
v_exp_f32 v202, v202
v_add_f32 v5, v5, v200
v_add_f32 v5, v5, v201
v_exp_f32 v203, v203
v_cvt_pk_bf16_f32 v200, v200, v201
v_exp_f32 v204, v204
v_add_f32 v5, v5, v202
v_add_f32 v5, v5, v203
v_exp_f32 v205, v205
v_cvt_pk_bf16_f32 v201, v202, v203
v_exp_f32 v206, v206
v_add_f32 v5, v5, v204
v_add_f32 v5, v5, v205
v_exp_f32 v207, v207
v_cvt_pk_bf16_f32 v202, v204, v205
v_add_f32 v5, v5, v206
v_add_f32 v5, v5, v207
v_cvt_pk_bf16_f32 v203, v206, v207
s_waitcnt vmcnt(16) lgkmcnt(0)
MA 0,a,192,v,144
s_barrier
v_xor_b32 v10, 0x8000, v10
MA 32,a,192,v,152
s_add_u32 m0, s72, 16384
ds_read_b128 a[128:131], v10 offset:0
MA 96,a,192,v,168
v_exp_f32 v80, v80
MA 4,a,196,v,144
buffer_load_dwordx4 v12, s[52:55], s71 offen offset:0 sc1 lds
v_lshrrev_b32 v249, 2, v1
MA 36,a,196,v,152
ds_read_b128 a[132:135], v10 offset:1024
v_and_b32 v248, 7, v249
MA 100,a,196,v,168
v_lshlrev_b32 v249, 8, v249
v_and_b32 v250, 3, v1
MA 8,a,200,v,144
v_exp_f32 v81, v81
MA 40,a,200,v,152
v_lshl_add_u32 v249, v250, 3, v249
s_lshl_b32 s36, s3, 13
MA 104,a,200,v,168
ds_read_b128 a[136:139], v10 offset:2048
s_add_u32 s36, s36, 131072
MA 12,a,204,v,144
v_add_u32 v249, s36, v249
s_waitcnt vmcnt(13)
MA 44,a,204,v,152
v_exp_f32 v82, v82
MA 108,a,204,v,168
ds_read_b128 a[140:143], v10 offset:3072
v_xor_b32 v250, 0, v248
MA 16,a,208,v,144
v_lshl_add_u32 v250, v250, 5, v249
TR 96,250,0
MA 48,a,208,v,152
TR 98,250,4096
v_xor_b32 v250, 1, v248
MA 112,a,208,v,168
v_exp_f32 v83, v83
MA 20,a,212,v,144
ds_read_b128 a[144:147], v10 offset:4096
v_lshl_add_u32 v250, v250, 5, v249
MA 52,a,212,v,152
v_cvt_pk_bf16_f32 v80, v80, v81
TR 100,250,0
MA 116,a,212,v,168
ds_read_b128 a[148:151], v10 offset:5120
TR 102,250,4096
MA 24,a,216,v,144
buffer_load_dwordx4 v12, s[52:55], s71 offen offset:1024 sc1 lds
v_xor_b32 v250, 2, v248
MA 56,a,216,v,152
v_lshl_add_u32 v250, v250, 5, v249
TR 104,250,0
MA 120,a,216,v,168
v_exp_f32 v84, v84
MA 28,a,220,v,144
TR 106,250,4096
v_xor_b32 v250, 3, v248
MA 60,a,220,v,152
ds_read_b128 a[152:155], v10 offset:6144
v_lshl_add_u32 v250, v250, 5, v249
MA 124,a,220,v,168
v_exp_f32 v85, v85
MA 0,a,224,v,176
TR 108,250,0
TR 110,250,4096
MA 32,a,224,v,184
v_xor_b32 v250, 4, v248
v_lshl_add_u32 v250, v250, 5, v249
MA 96,a,224,v,200
ds_read_b128 a[156:159], v10 offset:7168
v_cvt_pk_bf16_f32 v81, v82, v83
MA 4,a,228,v,176
TR 128,250,0
TR 130,250,4096
MA 36,a,228,v,184
ds_read_b128 a[160:163], v10 offset:8192
v_xor_b32 v250, 5, v248
MA 100,a,228,v,200
v_exp_f32 v86, v86
MA 8,a,232,v,176
v_lshl_add_u32 v250, v250, 5, v249
TR 132,250,0
MA 40,a,232,v,184
TR 134,250,4096
v_xor_b32 v250, 6, v248
MA 104,a,232,v,200
v_exp_f32 v87, v87
MA 12,a,236,v,176
ds_read_b128 a[164:167], v10 offset:9216
buffer_load_dwordx4 v12, s[52:55], s71 offen offset:2048 sc1 lds
MA 44,a,236,v,184
v_lshl_add_u32 v250, v250, 5, v249
TR 136,250,0
MA 108,a,236,v,200
TR 138,250,4096
v_xor_b32 v250, 7, v248
MA 16,a,240,v,176
ds_read_b128 a[168:171], v10 offset:10240
v_cvt_pk_bf16_f32 v82, v84, v85
MA 48,a,240,v,184
v_lshl_add_u32 v250, v250, 5, v249
TR 140,250,0
MA 112,a,240,v,200
ds_read_b128 a[172:175], v10 offset:11264
TR 142,250,4096
MA 20,a,244,v,176
v_exp_f32 v88, v88
MA 52,a,244,v,184
s_add_u32 s32, s40, 100663296
s_addc_u32 s33, s41, 0
MA 116,a,244,v,200
s_mov_b32 s34, 8388608
s_mov_b32 s35, 0x20000
MA 24,a,248,v,176
v_exp_f32 v89, v89
MA 56,a,248,v,184
s_and_b32 s36, s2, 7
s_lshl_b32 s36, s36, 20
MA 120,a,248,v,200
ds_read_b128 a[176:179], v10 offset:12288
s_lshr_b32 s37, s2, 3
MA 28,a,252,v,176
v_cvt_pk_bf16_f32 v83, v86, v87
s_lshl_b32 s37, s37, 15
MA 60,a,252,v,184
s_add_u32 s36, s36, s37
s_lshl_b32 s37, s3, 12
MA 124,a,252,v,200
ds_read_b128 a[180:183], v10 offset:13312
ds_read_b128 a[184:187], v10 offset:14336
ds_read_b128 a[188:191], v10 offset:15360
buffer_load_dwordx4 v12, s[52:55], s71 offen offset:3072 sc1 lds
s_xor_b32 s72, s72, 0x8000
v_exp_f32 v90, v90
s_add_u32 s36, s36, s37
s_add_u32 s37, s36, 4096
s_waitcnt lgkmcnt(15)
buffer_store_dwordx4 v[96:99], v12, s[32:35], s36 offen offset:0 sc1
buffer_store_dwordx4 v[100:103], v12, s[32:35], s36 offen offset:1024 sc1
v_exp_f32 v91, v91
buffer_store_dwordx4 v[104:107], v12, s[32:35], s36 offen offset:2048 sc1
buffer_store_dwordx4 v[108:111], v12, s[32:35], s36 offen offset:3072 sc1
s_waitcnt lgkmcnt(14)
buffer_store_dwordx4 v[128:131], v12, s[32:35], s37 offen offset:0 sc1
v_cvt_pk_bf16_f32 v88, v88, v89
s_waitcnt lgkmcnt(11)
buffer_store_dwordx4 v[132:135], v12, s[32:35], s37 offen offset:1024 sc1
s_waitcnt lgkmcnt(8)
buffer_store_dwordx4 v[136:139], v12, s[32:35], s37 offen offset:2048 sc1
s_waitcnt lgkmcnt(4)
buffer_store_dwordx4 v[140:143], v12, s[32:35], s37 offen offset:3072 sc1
s_add_u32 s32, s40, 109051904
s_addc_u32 s33, s41, 0
v_exp_f32 v92, v92
s_mov_b32 s34, 4194304
s_mov_b32 s35, 0x20000
s_lshl_b32 s36, s2, 14
v_exp_f32 v93, v93
v_mov_b32 v252, -1
v_mov_b32 v253, -1
v_mov_b32 v254, -1
v_mov_b32 v255, -1
v_cvt_pk_bf16_f32 v89, v90, v91
buffer_store_dwordx4 v[252:255], v12, s[32:35], s36 offen offset:0 sc1
buffer_store_dwordx4 v[252:255], v12, s[32:35], s36 offen offset:1024 sc1
v_exp_f32 v94, v94
buffer_store_dwordx4 v[252:255], v12, s[32:35], s36 offen offset:2048 sc1
buffer_store_dwordx4 v[252:255], v12, s[32:35], s36 offen offset:3072 sc1
v_lshlrev_b32 v232, 4, v1
v_add_u32 v233, -4, v232
v_mov_b32 v235, 0
v_exp_f32 v95, v95
buffer_load_ushort v234, v235, s[28:31], s42 offen
buffer_load_dword v209, v233, s[16:19], 0 offen
buffer_load_dwordx4 v[210:213], v232, s[16:19], 0 offen offset:0
buffer_load_dword v215, v232, s[16:19], 0 offen offset:1020
v_cvt_pk_bf16_f32 v90, v92, v93
buffer_load_dwordx4 v[216:219], v232, s[16:19], 0 offen offset:1024
buffer_load_dword v221, v232, s[16:19], 0 offen offset:2044
v_cvt_pk_bf16_f32 v91, v94, v95
buffer_load_dwordx4 v[222:225], v232, s[16:19], 0 offen offset:2048
buffer_load_dword v227, v232, s[16:19], 0 offen offset:3068
buffer_load_dwordx4 v[228:231], v232, s[16:19], 0 offen offset:3072
L_p3_eps:
v_mov_b32 v240, v4
v_mov_b32 v241, v5
s_nop 0
v_permlane32_swap_b32 v4, v240
v_permlane32_swap_b32 v5, v241
v_add_f32 v4, v4, v240
v_add_f32 v5, v5, v241
v_mov_b32 v240, v4
v_mov_b32 v241, v5
s_nop 0
v_permlane16_swap_b32 v4, v240
v_permlane16_swap_b32 v5, v241
v_add_f32 v4, v4, v240
v_add_f32 v5, v5, v241
v_cmp_nle_f32 vcc, 0x30800000, v4
s_nop 0
s_mov_b64 s[78:79], vcc
v_cmp_nge_f32 vcc, 0x4e800000, v4
s_nop 0
s_or_b64 s[78:79], s[78:79], vcc
v_cmp_nle_f32 vcc, 0x30800000, v5
s_nop 0
s_or_b64 s[78:79], s[78:79], vcc
v_cmp_nge_f32 vcc, 0x4e800000, v5
s_nop 0
s_or_b64 s[78:79], s[78:79], vcc
v_rcp_f32 v4, v4
v_rcp_f32 v5, v5
s_add_u32 s80, s101, s76
s_nop 4
v_accvgpr_read_b32 v240, a64
v_accvgpr_read_b32 v241, a65
v_accvgpr_read_b32 v242, a66
v_accvgpr_read_b32 v243, a67
v_accvgpr_read_b32 v244, a68
v_accvgpr_read_b32 v245, a69
v_accvgpr_read_b32 v246, a70
v_accvgpr_read_b32 v247, a71
v_mul_f32 v240, v240, v4
v_mul_f32 v241, v241, v4
v_mul_f32 v242, v242, v4
v_mul_f32 v243, v243, v4
v_mul_f32 v244, v244, v4
v_mul_f32 v245, v245, v4
v_mul_f32 v246, v246, v4
v_mul_f32 v247, v247, v4
v_cvt_pk_bf16_f32 v248, v240, v241
v_cvt_pk_bf16_f32 v249, v242, v243
v_cvt_pk_bf16_f32 v250, v244, v245
v_cvt_pk_bf16_f32 v251, v246, v247
buffer_store_dwordx4 v[248:251], v15, s[60:63], s101 offen offset:0 sc1
v_accvgpr_read_b32 v240, a72
v_accvgpr_read_b32 v241, a73
v_accvgpr_read_b32 v242, a74
v_accvgpr_read_b32 v243, a75
v_accvgpr_read_b32 v244, a76
v_accvgpr_read_b32 v245, a77
v_accvgpr_read_b32 v246, a78
v_accvgpr_read_b32 v247, a79
v_mul_f32 v240, v240, v4
v_mul_f32 v241, v241, v4
v_mul_f32 v242, v242, v4
v_mul_f32 v243, v243, v4
v_mul_f32 v244, v244, v4
v_mul_f32 v245, v245, v4
v_mul_f32 v246, v246, v4
v_mul_f32 v247, v247, v4
v_cvt_pk_bf16_f32 v252, v240, v241
v_cvt_pk_bf16_f32 v253, v242, v243
v_cvt_pk_bf16_f32 v254, v244, v245
v_cvt_pk_bf16_f32 v255, v246, v247
buffer_store_dwordx4 v[252:255], v15, s[60:63], s101 offen offset:1024 sc1
v_accvgpr_read_b32 v240, a80
v_accvgpr_read_b32 v241, a81
v_accvgpr_read_b32 v242, a82
v_accvgpr_read_b32 v243, a83
v_accvgpr_read_b32 v244, a84
v_accvgpr_read_b32 v245, a85
v_accvgpr_read_b32 v246, a86
v_accvgpr_read_b32 v247, a87
v_mul_f32 v240, v240, v4
v_mul_f32 v241, v241, v4
v_mul_f32 v242, v242, v4
v_mul_f32 v243, v243, v4
v_mul_f32 v244, v244, v4
v_mul_f32 v245, v245, v4
v_mul_f32 v246, v246, v4
v_mul_f32 v247, v247, v4
v_cvt_pk_bf16_f32 v248, v240, v241
v_cvt_pk_bf16_f32 v249, v242, v243
v_cvt_pk_bf16_f32 v250, v244, v245
v_cvt_pk_bf16_f32 v251, v246, v247
buffer_store_dwordx4 v[248:251], v15, s[60:63], s101 offen offset:2048 sc1
v_accvgpr_read_b32 v240, a88
v_accvgpr_read_b32 v241, a89
v_accvgpr_read_b32 v242, a90
v_accvgpr_read_b32 v243, a91
v_accvgpr_read_b32 v244, a92
v_accvgpr_read_b32 v245, a93
v_accvgpr_read_b32 v246, a94
v_accvgpr_read_b32 v247, a95
v_mul_f32 v240, v240, v4
v_mul_f32 v241, v241, v4
v_mul_f32 v242, v242, v4
v_mul_f32 v243, v243, v4
v_mul_f32 v244, v244, v4
v_mul_f32 v245, v245, v4
v_mul_f32 v246, v246, v4
v_mul_f32 v247, v247, v4
v_cvt_pk_bf16_f32 v252, v240, v241
v_cvt_pk_bf16_f32 v253, v242, v243
v_cvt_pk_bf16_f32 v254, v244, v245
v_cvt_pk_bf16_f32 v255, v246, v247
buffer_store_dwordx4 v[252:255], v15, s[60:63], s101 offen offset:3072 sc1
v_accvgpr_read_b32 v240, a96
v_accvgpr_read_b32 v241, a97
v_accvgpr_read_b32 v242, a98
v_accvgpr_read_b32 v243, a99
v_accvgpr_read_b32 v244, a100
v_accvgpr_read_b32 v245, a101
v_accvgpr_read_b32 v246, a102
v_accvgpr_read_b32 v247, a103
v_mul_f32 v240, v240, v5
v_mul_f32 v241, v241, v5
v_mul_f32 v242, v242, v5
v_mul_f32 v243, v243, v5
v_mul_f32 v244, v244, v5
v_mul_f32 v245, v245, v5
v_mul_f32 v246, v246, v5
v_mul_f32 v247, v247, v5
v_cvt_pk_bf16_f32 v248, v240, v241
v_cvt_pk_bf16_f32 v249, v242, v243
v_cvt_pk_bf16_f32 v250, v244, v245
v_cvt_pk_bf16_f32 v251, v246, v247
buffer_store_dwordx4 v[248:251], v15, s[60:63], s80 offen offset:0 sc1
v_accvgpr_read_b32 v240, a104
v_accvgpr_read_b32 v241, a105
v_accvgpr_read_b32 v242, a106
v_accvgpr_read_b32 v243, a107
v_accvgpr_read_b32 v244, a108
v_accvgpr_read_b32 v245, a109
v_accvgpr_read_b32 v246, a110
v_accvgpr_read_b32 v247, a111
v_mul_f32 v240, v240, v5
v_mul_f32 v241, v241, v5
v_mul_f32 v242, v242, v5
v_mul_f32 v243, v243, v5
v_mul_f32 v244, v244, v5
v_mul_f32 v245, v245, v5
v_mul_f32 v246, v246, v5
v_mul_f32 v247, v247, v5
v_cvt_pk_bf16_f32 v252, v240, v241
v_cvt_pk_bf16_f32 v253, v242, v243
v_cvt_pk_bf16_f32 v254, v244, v245
v_cvt_pk_bf16_f32 v255, v246, v247
buffer_store_dwordx4 v[252:255], v15, s[60:63], s80 offen offset:1024 sc1
v_accvgpr_read_b32 v240, a112
v_accvgpr_read_b32 v241, a113
v_accvgpr_read_b32 v242, a114
v_accvgpr_read_b32 v243, a115
v_accvgpr_read_b32 v244, a116
v_accvgpr_read_b32 v245, a117
v_accvgpr_read_b32 v246, a118
v_accvgpr_read_b32 v247, a119
v_mul_f32 v240, v240, v5
v_mul_f32 v241, v241, v5
v_mul_f32 v242, v242, v5
v_mul_f32 v243, v243, v5
v_mul_f32 v244, v244, v5
v_mul_f32 v245, v245, v5
v_mul_f32 v246, v246, v5
v_mul_f32 v247, v247, v5
v_cvt_pk_bf16_f32 v248, v240, v241
v_cvt_pk_bf16_f32 v249, v242, v243
v_cvt_pk_bf16_f32 v250, v244, v245
v_cvt_pk_bf16_f32 v251, v246, v247
buffer_store_dwordx4 v[248:251], v15, s[60:63], s80 offen offset:2048 sc1
v_accvgpr_read_b32 v240, a120
v_accvgpr_read_b32 v241, a121
v_accvgpr_read_b32 v242, a122
v_accvgpr_read_b32 v243, a123
v_accvgpr_read_b32 v244, a124
v_accvgpr_read_b32 v245, a125
v_accvgpr_read_b32 v246, a126
v_accvgpr_read_b32 v247, a127
v_mul_f32 v240, v240, v5
v_mul_f32 v241, v241, v5
v_mul_f32 v242, v242, v5
v_mul_f32 v243, v243, v5
v_mul_f32 v244, v244, v5
v_mul_f32 v245, v245, v5
v_mul_f32 v246, v246, v5
v_mul_f32 v247, v247, v5
v_cvt_pk_bf16_f32 v252, v240, v241
v_cvt_pk_bf16_f32 v253, v242, v243
v_cvt_pk_bf16_f32 v254, v244, v245
v_cvt_pk_bf16_f32 v255, v246, v247
buffer_store_dwordx4 v[252:255], v15, s[60:63], s80 offen offset:3072 sc1
v_mov_b32 v160, 0x3f803f80
v_mov_b32 v161, 0x3f803f80
v_mov_b32 v162, 0x3f803f80
v_mov_b32 v163, 0x3f803f80
v_mov_b32 v164, 0
v_mov_b32 v165, 0
v_mov_b32 v166, 0
v_mov_b32 v167, 0
v_mov_b32 v168, 0
v_mov_b32 v169, 0
v_mov_b32 v170, 0
v_mov_b32 v171, 0
s_and_b32 s36, s2, 3
s_lshl_b32 s36, s36, 1
s_sub_u32 s32, 14, s36
s_bitcmp1_b32 s2, 4
s_cselect_b32 s36, s32, s36
s_bfe_u32 s32, s2, 0x10003
s_add_u32 s36, s36, s32
s_bfe_u32 s37, s2, 0x10002
s_lshr_b32 s32, s2, 5
s_lshl_b32 s32, s32, 1
s_add_u32 s37, s37, s32
s_lshl_b32 s36, s36, 2
s_add_u32 s36, s36, s3
s_lshl_b32 s37, s37, 7
s_lshl_b32 s32, s36, 16
s_add_u32 s37, s37, s32
s_lshl_b32 s36, s36, 7
v_and_b32 v240, 15, v1
v_bfe_u32 v241, v1, 4, 1
v_lshlrev_b32 v241, 5, v241
v_lshrrev_b32 v242, 5, v1
v_lshl_add_u32 v241, v242, 4, v241
v_lshl_add_u32 v241, v240, 11, v241
v_lshlrev_b32 v240, 2, v240
s_add_u32 s32, s40, 58720256
s_addc_u32 s33, s41, 0
s_mov_b32 s34, 8192
s_mov_b32 s35, 0x20000
buffer_load_dwordx4 v[192:195], v241, s[44:47], s37 offen offset:0
buffer_load_dwordx4 v[196:199], v241, s[44:47], s37 offen offset:64
buffer_load_dword v6, v240, s[32:35], s36 offen offset:0 sc1
s_add_u32 s37, s37, 32768
buffer_load_dwordx4 v[200:203], v241, s[44:47], s37 offen offset:0
buffer_load_dwordx4 v[204:207], v241, s[44:47], s37 offen offset:64
buffer_load_dword v7, v240, s[32:35], s36 offen offset:64 sc1
v_lshlrev_b32 v236, 20, v1
s_lshl_b32 s36, s3, 26
v_add_u32 v236, s36, v236
v_mov_b32 v237, 1
s_lshl_b32 s37, s2, 2
s_getpc_b64 s[38:39]
L_ct_b:
s_add_u32 s38, s38, L_p3_s1m_top - L_ct_b
s_addc_u32 s39, s39, 0
v_mov_b32 v173, s39
v_mov_b32 v172, s38
s_lshr_b32 s38, s2, 3
s_lshl_b32 s38, s38, 2
s_add_u32 s38, s38, s3
s_lshl_b32 s38, s38, 7
v_and_b32 v174, 3, v1
v_lshlrev_b32 v174, 14, v174
v_add_u32 v174, s38, v174
v_min_u32 v174, L_end - L_p3_s1m_top - 4, v174
v_add_co_u32 v172, vcc, v172, v174
s_nop 1
v_addc_co_u32 v173, vcc, 0, v173, vcc
global_load_dword v174, v[172:173], off
s_lshl_b32 s74, s70, 1
s_sub_u32 s74, 13, s74
s_cbranch_scc1 L_p3_s0m_top
.p2align 5
L_p3_s0_top:
s_waitcnt lgkmcnt(0)
v_mfma_f32_16x16x32_bf16 v[144:147], a[128:131], v[16:19], 0
s_add_u32 m0, s73, 0
ds_read_b128 a[192:195], v11 offset:16384
v_mfma_f32_16x16x32_bf16 v[152:155], a[128:131], v[32:35], 0
v_exp_f32 v112, v112
MV 144,a,132,v,20
ds_read_b128 a[196:199], v11 offset:17408
buffer_load_dwordx4 v12, s[56:59], s71 offen offset:0 sc1 lds
MV 152,a,132,v,36
v_exp_f32 v113, v113
MV 144,a,136,v,24
ds_read_b128 a[200:203], v11 offset:18432
ds_read_b128 a[204:207], v11 offset:19456
MV 152,a,136,v,40
v_exp_f32 v114, v114
MV 144,a,140,v,28
v_exp_f32 v115, v115
MV 152,a,140,v,44
ds_read_b128 a[208:211], v11 offset:20480
v_cvt_pk_bf16_f32 v112, v112, v113
v_mfma_f32_16x16x32_bf16 v[148:151], a[144:147], v[16:19], 0
ds_read_b128 a[212:215], v11 offset:21504
buffer_load_dwordx4 v12, s[56:59], s71 offen offset:1024 sc1 lds
v_mfma_f32_16x16x32_bf16 v[156:159], a[144:147], v[32:35], 0
v_exp_f32 v116, v116
MV 148,a,148,v,20
v_exp_f32 v117, v117
MV 156,a,148,v,36
ds_read_b128 a[216:219], v11 offset:22528
ds_read_b128 a[220:223], v11 offset:23552
MV 148,a,152,v,24
ds_read_b128 a[224:227], v11 offset:24576
v_cvt_pk_bf16_f32 v113, v114, v115
MV 156,a,152,v,40
v_exp_f32 v118, v118
MV 148,a,156,v,28
v_exp_f32 v119, v119
MV 156,a,156,v,44
ds_read_b128 a[228:231], v11 offset:25600
buffer_load_dwordx4 v12, s[56:59], s71 offen offset:2048 sc1 lds
v_mfma_f32_16x16x32_bf16 v[176:179], a[160:163], v[16:19], 0
ds_read_b128 a[232:235], v11 offset:26624
v_cvt_pk_bf16_f32 v114, v116, v117
v_mfma_f32_16x16x32_bf16 v[184:187], a[160:163], v[32:35], 0
v_exp_f32 v120, v120
MV 176,a,164,v,20
ds_read_b128 a[236:239], v11 offset:27648
ds_read_b128 a[240:243], v11 offset:28672
MV 184,a,164,v,36
v_exp_f32 v121, v121
MV 176,a,168,v,24
ds_read_b128 a[244:247], v11 offset:29696
v_cvt_pk_bf16_f32 v115, v118, v119
MV 184,a,168,v,40
ds_read_b128 a[248:251], v11 offset:30720
buffer_load_dwordx4 v12, s[56:59], s71 offen offset:3072 sc1 lds
MV 176,a,172,v,28
v_exp_f32 v122, v122
MV 184,a,172,v,44
v_exp_f32 v123, v123
v_mfma_f32_16x16x32_bf16 v[180:183], a[176:179], v[16:19], 0
ds_read_b128 a[252:255], v11 offset:31744
v_cvt_pk_bf16_f32 v120, v120, v121
v_mfma_f32_16x16x32_bf16 v[188:191], a[176:179], v[32:35], 0
v_exp_f32 v124, v124
MV 180,a,180,v,20
v_exp_f32 v125, v125
MV 188,a,180,v,36
s_add_u32 s71, s71, 16384
v_cvt_pk_bf16_f32 v121, v122, v123
MV 180,a,184,v,24
v_exp_f32 v126, v126
MV 188,a,184,v,40
v_exp_f32 v127, v127
MV 180,a,188,v,28
v_cvt_pk_bf16_f32 v122, v124, v125
v_cvt_pk_bf16_f32 v123, v126, v127
MV 188,a,188,v,44
s_waitcnt vmcnt(16) lgkmcnt(0)
MA 0,a,192,v,80
s_barrier
MA 32,a,192,v,88
s_add_u32 m0, s72, 0
ds_read_b128 a[128:131], v10 offset:16384
MA 4,a,196,v,80
v_exp_f32 v144, v144
MA 36,a,196,v,88
ds_read_b128 a[132:135], v10 offset:17408
buffer_load_dwordx4 v12, s[52:55], s71 offen offset:0 sc1 lds
MA 8,a,200,v,80
v_exp_f32 v145, v145
MA 40,a,200,v,88
ds_read_b128 a[136:139], v10 offset:18432
ds_read_b128 a[140:143], v10 offset:19456
MA 12,a,204,v,80
v_exp_f32 v146, v146
MA 44,a,204,v,88
v_exp_f32 v147, v147
MV 164,v,160,v,80
ds_read_b128 a[144:147], v10 offset:20480
buffer_load_dwordx4 v12, s[52:55], s71 offen offset:1024 sc1 lds
MV 168,v,160,v,88
ds_read_b128 a[148:151], v10 offset:21504
v_cvt_pk_bf16_f32 v144, v144, v145
MA 16,a,208,v,80
v_exp_f32 v148, v148
MA 48,a,208,v,88
ds_read_b128 a[152:155], v10 offset:22528
ds_read_b128 a[156:159], v10 offset:23552
MA 20,a,212,v,80
v_exp_f32 v149, v149
MA 52,a,212,v,88
ds_read_b128 a[160:163], v10 offset:24576
v_cvt_pk_bf16_f32 v145, v146, v147
MA 24,a,216,v,80
v_exp_f32 v150, v150
MA 56,a,216,v,88
ds_read_b128 a[164:167], v10 offset:25600
buffer_load_dwordx4 v12, s[52:55], s71 offen offset:2048 sc1 lds
MA 28,a,220,v,80
v_exp_f32 v151, v151
MA 60,a,220,v,88
ds_read_b128 a[168:171], v10 offset:26624
v_cvt_pk_bf16_f32 v146, v148, v149
MA 0,a,224,v,112
v_exp_f32 v152, v152
MA 32,a,224,v,120
ds_read_b128 a[172:175], v10 offset:27648
ds_read_b128 a[176:179], v10 offset:28672
MA 4,a,228,v,112
v_exp_f32 v153, v153
MA 36,a,228,v,120
ds_read_b128 a[180:183], v10 offset:29696
v_cvt_pk_bf16_f32 v147, v150, v151
MA 8,a,232,v,112
ds_read_b128 a[184:187], v10 offset:30720
buffer_load_dwordx4 v12, s[52:55], s71 offen offset:3072 sc1 lds
MA 40,a,232,v,120
v_exp_f32 v154, v154
MA 12,a,236,v,112
v_exp_f32 v155, v155
MA 44,a,236,v,120
ds_read_b128 a[188:191], v10 offset:31744
v_cvt_pk_bf16_f32 v152, v152, v153
MV 164,v,160,v,112
v_exp_f32 v156, v156
MV 168,v,160,v,120
MA 16,a,240,v,112
v_exp_f32 v157, v157
MA 48,a,240,v,120
s_sub_u32 s74, s74, 1
v_cvt_pk_bf16_f32 v153, v154, v155
MA 20,a,244,v,112
v_exp_f32 v158, v158
MA 52,a,244,v,120
MA 24,a,248,v,112
v_exp_f32 v159, v159
MA 56,a,248,v,120
MA 28,a,252,v,112
v_cvt_pk_bf16_f32 v154, v156, v157
v_cvt_pk_bf16_f32 v155, v158, v159
MA 60,a,252,v,120
s_cbranch_scc1 L_p3_s1m_top
s_waitcnt lgkmcnt(0)
v_xor_b32 v11, 0x8000, v11
v_mfma_f32_16x16x32_bf16 v[80:83], a[128:131], v[16:19], 0
s_add_u32 m0, s73, 16384
ds_read_b128 a[192:195], v11 offset:0
v_mfma_f32_16x16x32_bf16 v[88:91], a[128:131], v[32:35], 0
v_exp_f32 v176, v176
MV 80,a,132,v,20
ds_read_b128 a[196:199], v11 offset:1024
buffer_load_dwordx4 v12, s[56:59], s71 offen offset:0 sc1 lds
MV 88,a,132,v,36
v_exp_f32 v177, v177
MV 80,a,136,v,24
ds_read_b128 a[200:203], v11 offset:2048
ds_read_b128 a[204:207], v11 offset:3072
MV 88,a,136,v,40
v_exp_f32 v178, v178
MV 80,a,140,v,28
v_exp_f32 v179, v179
MV 88,a,140,v,44
ds_read_b128 a[208:211], v11 offset:4096
buffer_load_dwordx4 v12, s[56:59], s71 offen offset:1024 sc1 lds
v_mfma_f32_16x16x32_bf16 v[84:87], a[144:147], v[16:19], 0
ds_read_b128 a[212:215], v11 offset:5120
v_cvt_pk_bf16_f32 v176, v176, v177
v_mfma_f32_16x16x32_bf16 v[92:95], a[144:147], v[32:35], 0
v_exp_f32 v180, v180
MV 84,a,148,v,20
v_exp_f32 v181, v181
MV 92,a,148,v,36
ds_read_b128 a[216:219], v11 offset:6144
ds_read_b128 a[220:223], v11 offset:7168
MV 84,a,152,v,24
buffer_load_dwordx4 v12, s[56:59], s71 offen offset:2048 sc1 lds
v_cvt_pk_bf16_f32 v177, v178, v179
MV 92,a,152,v,40
v_exp_f32 v182, v182
MV 84,a,156,v,28
ds_read_b128 a[224:227], v11 offset:8192
ds_read_b128 a[228:231], v11 offset:9216
MV 92,a,156,v,44
v_exp_f32 v183, v183
v_mfma_f32_16x16x32_bf16 v[112:115], a[160:163], v[16:19], 0
ds_read_b128 a[232:235], v11 offset:10240
v_cvt_pk_bf16_f32 v178, v180, v181
v_mfma_f32_16x16x32_bf16 v[120:123], a[160:163], v[32:35], 0
v_exp_f32 v184, v184
MV 112,a,164,v,20
ds_read_b128 a[236:239], v11 offset:11264
buffer_load_dwordx4 v12, s[56:59], s71 offen offset:3072 sc1 lds
MV 120,a,164,v,36
v_exp_f32 v185, v185
MV 112,a,168,v,24
ds_read_b128 a[240:243], v11 offset:12288
v_cvt_pk_bf16_f32 v179, v182, v183
MV 120,a,168,v,40
ds_read_b128 a[244:247], v11 offset:13312
ds_read_b128 a[248:251], v11 offset:14336
MV 112,a,172,v,28
v_exp_f32 v186, v186
MV 120,a,172,v,44
v_exp_f32 v187, v187
v_mfma_f32_16x16x32_bf16 v[116:119], a[176:179], v[16:19], 0
ds_read_b128 a[252:255], v11 offset:15360
s_add_u32 s71, s71, 16384
v_mfma_f32_16x16x32_bf16 v[124:127], a[176:179], v[32:35], 0
s_xor_b32 s73, s73, 0x8000
v_cvt_pk_bf16_f32 v184, v184, v185
MV 116,a,180,v,20
v_exp_f32 v188, v188
MV 124,a,180,v,36
v_exp_f32 v189, v189
MV 116,a,184,v,24
v_cvt_pk_bf16_f32 v185, v186, v187
MV 124,a,184,v,40
v_exp_f32 v190, v190
MV 116,a,188,v,28
v_exp_f32 v191, v191
MV 124,a,188,v,44
v_cvt_pk_bf16_f32 v186, v188, v189
v_cvt_pk_bf16_f32 v187, v190, v191
s_waitcnt vmcnt(16) lgkmcnt(0)
MA 0,a,192,v,144
s_barrier
v_xor_b32 v10, 0x8000, v10
MA 32,a,192,v,152
s_add_u32 m0, s72, 16384
ds_read_b128 a[128:131], v10 offset:0
MA 4,a,196,v,144
v_exp_f32 v80, v80
MA 36,a,196,v,152
ds_read_b128 a[132:135], v10 offset:1024
buffer_load_dwordx4 v12, s[52:55], s71 offen offset:0 sc1 lds
MA 8,a,200,v,144
v_exp_f32 v81, v81
MA 40,a,200,v,152
ds_read_b128 a[136:139], v10 offset:2048
ds_read_b128 a[140:143], v10 offset:3072
MA 12,a,204,v,144
v_exp_f32 v82, v82
MA 44,a,204,v,152
ds_read_b128 a[144:147], v10 offset:4096
buffer_load_dwordx4 v12, s[52:55], s71 offen offset:1024 sc1 lds
MV 164,v,160,v,144
v_exp_f32 v83, v83
MV 168,v,160,v,152
ds_read_b128 a[148:151], v10 offset:5120
v_cvt_pk_bf16_f32 v80, v80, v81
MA 16,a,208,v,144
v_exp_f32 v84, v84
MA 48,a,208,v,152
ds_read_b128 a[152:155], v10 offset:6144
buffer_load_dwordx4 v12, s[52:55], s71 offen offset:2048 sc1 lds
MA 20,a,212,v,144
v_exp_f32 v85, v85
MA 52,a,212,v,152
ds_read_b128 a[156:159], v10 offset:7168
v_cvt_pk_bf16_f32 v81, v82, v83
MA 24,a,216,v,144
v_exp_f32 v86, v86
MA 56,a,216,v,152
ds_read_b128 a[160:163], v10 offset:8192
ds_read_b128 a[164:167], v10 offset:9216
MA 28,a,220,v,144
v_exp_f32 v87, v87
MA 60,a,220,v,152
buffer_load_dwordx4 v12, s[52:55], s71 offen offset:3072 sc1 lds
v_cvt_pk_bf16_f32 v82, v84, v85
MA 0,a,224,v,176
ds_read_b128 a[168:171], v10 offset:10240
ds_read_b128 a[172:175], v10 offset:11264
MA 32,a,224,v,184
v_exp_f32 v88, v88
MA 4,a,228,v,176
v_exp_f32 v89, v89
MA 36,a,228,v,184
ds_read_b128 a[176:179], v10 offset:12288
s_xor_b32 s72, s72, 0x8000
MA 8,a,232,v,176
ds_read_b128 a[180:183], v10 offset:13312
v_cvt_pk_bf16_f32 v83, v86, v87
MA 40,a,232,v,184
v_exp_f32 v90, v90
MA 12,a,236,v,176
ds_read_b128 a[184:187], v10 offset:14336
ds_read_b128 a[188:191], v10 offset:15360
MA 44,a,236,v,184
v_exp_f32 v91, v91
MV 164,v,160,v,176
buffer_store_dword v237, v236, s[8:11], s37 offen offset:1024 sc1
v_cvt_pk_bf16_f32 v88, v88, v89
MV 168,v,160,v,184
v_exp_f32 v92, v92
MA 16,a,240,v,176
v_exp_f32 v93, v93
MA 48,a,240,v,184
global_load_dword v174, v[172:173], off
v_cvt_pk_bf16_f32 v89, v90, v91
MA 20,a,244,v,176
v_exp_f32 v94, v94
MA 52,a,244,v,184
MA 24,a,248,v,176
v_exp_f32 v95, v95
MA 56,a,248,v,184
MA 28,a,252,v,176
v_cvt_pk_bf16_f32 v90, v92, v93
v_cvt_pk_bf16_f32 v91, v94, v95
MA 60,a,252,v,184
s_branch L_p3_s0_top
L_p3_s1m_top:
s_waitcnt lgkmcnt(0)
v_xor_b32 v11, 0x8000, v11
v_mfma_f32_16x16x32_bf16 v[80:83], a[128:131], v[16:19], 0
ds_read_b128 a[192:195], v11 offset:0
ds_read_b128 a[196:199], v11 offset:1024
v_mfma_f32_16x16x32_bf16 v[88:91], a[128:131], v[32:35], 0
v_exp_f32 v176, v176
MV 80,a,132,v,20
v_exp_f32 v177, v177
MV 88,a,132,v,36
ds_read_b128 a[200:203], v11 offset:2048
ds_read_b128 a[204:207], v11 offset:3072
MV 80,a,136,v,24
v_exp_f32 v178, v178
MV 88,a,136,v,40
v_exp_f32 v179, v179
MV 80,a,140,v,28
ds_read_b128 a[208:211], v11 offset:4096
v_cvt_pk_bf16_f32 v176, v176, v177
MV 88,a,140,v,44
ds_read_b128 a[212:215], v11 offset:5120
ds_read_b128 a[216:219], v11 offset:6144
v_mfma_f32_16x16x32_bf16 v[84:87], a[144:147], v[16:19], 0
v_exp_f32 v180, v180
v_mfma_f32_16x16x32_bf16 v[92:95], a[144:147], v[32:35], 0
v_exp_f32 v181, v181
MV 84,a,148,v,20
ds_read_b128 a[220:223], v11 offset:7168
v_cvt_pk_bf16_f32 v177, v178, v179
MV 92,a,148,v,36
v_exp_f32 v182, v182
MV 84,a,152,v,24
ds_read_b128 a[224:227], v11 offset:8192
ds_read_b128 a[228:231], v11 offset:9216
MV 92,a,152,v,40
v_exp_f32 v183, v183
MV 84,a,156,v,28
ds_read_b128 a[232:235], v11 offset:10240
v_cvt_pk_bf16_f32 v178, v180, v181
MV 92,a,156,v,44
v_exp_f32 v184, v184
v_mfma_f32_16x16x32_bf16 v[112:115], a[160:163], v[16:19], 0
ds_read_b128 a[236:239], v11 offset:11264
ds_read_b128 a[240:243], v11 offset:12288
v_mfma_f32_16x16x32_bf16 v[120:123], a[160:163], v[32:35], 0
v_exp_f32 v185, v185
MV 112,a,164,v,20
ds_read_b128 a[244:247], v11 offset:13312
v_cvt_pk_bf16_f32 v179, v182, v183
MV 120,a,164,v,36
v_exp_f32 v186, v186
MV 112,a,168,v,24
v_exp_f32 v187, v187
MV 120,a,168,v,40
ds_read_b128 a[248:251], v11 offset:14336
ds_read_b128 a[252:255], v11 offset:15360
MV 112,a,172,v,28
v_cvt_pk_bf16_f32 v184, v184, v185
v_add_u32 v246, 0, v13
MV 120,a,172,v,44
v_cmp_gt_i32_e64 s[84:85], 0, v246
v_cmp_gt_i32_e64 s[86:87], 1, v246
v_mfma_f32_16x16x32_bf16 v[116:119], a[176:179], v[16:19], 0
v_exp_f32 v188, v188
v_mfma_f32_16x16x32_bf16 v[124:127], a[176:179], v[32:35], 0
v_cmp_gt_i32_e64 s[88:89], 2, v246
v_cmp_gt_i32_e64 s[90:91], 3, v246
MV 116,a,180,v,20
v_cndmask_b32_e64 v80, v80, v14, s[84:85]
v_cndmask_b32_e64 v81, v81, v14, s[86:87]
MV 124,a,180,v,36
v_exp_f32 v189, v189
MV 116,a,184,v,24
v_cvt_pk_bf16_f32 v185, v186, v187
v_cndmask_b32_e64 v82, v82, v14, s[88:89]
MV 124,a,184,v,40
v_cndmask_b32_e64 v83, v83, v14, s[90:91]
v_add_u32 v247, -16, v13
MV 116,a,188,v,28
v_cmp_gt_i32_e64 s[92:93], 0, v247
v_cmp_gt_i32_e64 s[94:95], 1, v247
MV 124,a,188,v,44
v_exp_f32 v190, v190
v_exp_f32 v191, v191
v_cmp_gt_i32_e64 s[96:97], 2, v247
v_cmp_gt_i32_e64 s[98:99], 3, v247
v_cndmask_b32_e64 v84, v84, v14, s[92:93]
v_cvt_pk_bf16_f32 v186, v188, v189
v_cndmask_b32_e64 v85, v85, v14, s[94:95]
v_cndmask_b32_e64 v86, v86, v14, s[96:97]
v_cvt_pk_bf16_f32 v187, v190, v191
v_cndmask_b32_e64 v87, v87, v14, s[98:99]
s_waitcnt vmcnt(12) lgkmcnt(0)
MA 0,a,192,v,144
s_barrier
v_xor_b32 v10, 0x8000, v10
MA 32,a,192,v,152
ds_read_b128 a[128:131], v10 offset:0
ds_read_b128 a[132:135], v10 offset:1024
MA 4,a,196,v,144
v_exp_f32 v80, v80
MA 36,a,196,v,152
v_exp_f32 v81, v81
MA 8,a,200,v,144
ds_read_b128 a[136:139], v10 offset:2048
ds_read_b128 a[140:143], v10 offset:3072
MA 40,a,200,v,152
v_exp_f32 v82, v82
MA 12,a,204,v,144
v_exp_f32 v83, v83
MA 44,a,204,v,152
ds_read_b128 a[144:147], v10 offset:4096
v_add_u32 v246, -32, v13
MV 164,v,160,v,144
v_cvt_pk_bf16_f32 v80, v80, v81
v_cmp_gt_i32_e64 s[84:85], 0, v246
MV 168,v,160,v,152
v_exp_f32 v84, v84
MA 16,a,208,v,144
ds_read_b128 a[148:151], v10 offset:5120
v_cmp_gt_i32_e64 s[86:87], 1, v246
MA 48,a,208,v,152
ds_read_b128 a[152:155], v10 offset:6144
v_cmp_gt_i32_e64 s[88:89], 2, v246
MA 20,a,212,v,144
v_exp_f32 v85, v85
MA 52,a,212,v,152
ds_read_b128 a[156:159], v10 offset:7168
v_cvt_pk_bf16_f32 v81, v82, v83
MA 24,a,216,v,144
ds_read_b128 a[160:163], v10 offset:8192
v_cmp_gt_i32_e64 s[90:91], 3, v246
MA 56,a,216,v,152
v_exp_f32 v86, v86
MA 28,a,220,v,144
ds_read_b128 a[164:167], v10 offset:9216
v_cndmask_b32_e64 v112, v112, v14, s[84:85]
MA 60,a,220,v,152
v_exp_f32 v87, v87
MA 0,a,224,v,176
v_cvt_pk_bf16_f32 v82, v84, v85
v_cndmask_b32_e64 v113, v113, v14, s[86:87]
MA 32,a,224,v,184
ds_read_b128 a[168:171], v10 offset:10240
v_cndmask_b32_e64 v114, v114, v14, s[88:89]
MA 4,a,228,v,176
v_exp_f32 v88, v88
MA 36,a,228,v,184
ds_read_b128 a[172:175], v10 offset:11264
v_cndmask_b32_e64 v115, v115, v14, s[90:91]
MA 8,a,232,v,176
v_exp_f32 v89, v89
MA 40,a,232,v,184
ds_read_b128 a[176:179], v10 offset:12288
v_cvt_pk_bf16_f32 v83, v86, v87
MA 12,a,236,v,176
ds_read_b128 a[180:183], v10 offset:13312
v_add_u32 v247, -48, v13
MA 44,a,236,v,184
ds_read_b128 a[184:187], v10 offset:14336
v_cmp_gt_i32_e64 s[92:93], 0, v247
MV 164,v,160,v,176
v_exp_f32 v90, v90
MV 168,v,160,v,184
v_exp_f32 v91, v91
MA 16,a,240,v,176
ds_read_b128 a[188:191], v10 offset:15360
v_cmp_gt_i32_e64 s[94:95], 1, v247
MA 48,a,240,v,184
v_cvt_pk_bf16_f32 v88, v88, v89
v_cmp_gt_i32_e64 s[96:97], 2, v247
MA 20,a,244,v,176
v_exp_f32 v92, v92
MA 52,a,244,v,184
v_cmp_gt_i32_e64 s[98:99], 3, v247
v_cndmask_b32_e64 v116, v116, v14, s[92:93]
MA 24,a,248,v,176
v_exp_f32 v93, v93
MA 56,a,248,v,184
v_cvt_pk_bf16_f32 v89, v90, v91
v_cndmask_b32_e64 v117, v117, v14, s[94:95]
MA 28,a,252,v,176
v_exp_f32 v94, v94
MA 60,a,252,v,184
v_exp_f32 v95, v95
v_cndmask_b32_e64 v118, v118, v14, s[96:97]
v_cvt_pk_bf16_f32 v90, v92, v93
v_cndmask_b32_e64 v119, v119, v14, s[98:99]
v_cvt_pk_bf16_f32 v91, v94, v95
L_p3_s0m_top:
s_waitcnt lgkmcnt(0)
v_mfma_f32_16x16x32_bf16 v[152:155], a[128:131], v[32:35], 0
ds_read_b128 a[192:195], v11 offset:16384
ds_read_b128 a[196:199], v11 offset:17408
MV 152,a,132,v,36
v_exp_f32 v112, v112
MV 152,a,136,v,40
v_exp_f32 v113, v113
MV 152,a,140,v,44
ds_read_b128 a[200:203], v11 offset:18432
ds_read_b128 a[204:207], v11 offset:19456
v_mfma_f32_16x16x32_bf16 v[156:159], a[144:147], v[32:35], 0
v_exp_f32 v114, v114
MV 156,a,148,v,36
v_exp_f32 v115, v115
MV 156,a,152,v,40
ds_read_b128 a[208:211], v11 offset:20480
ds_read_b128 a[212:215], v11 offset:21504
MV 156,a,156,v,44
ds_read_b128 a[216:219], v11 offset:22528
v_cvt_pk_bf16_f32 v112, v112, v113
v_mfma_f32_16x16x32_bf16 v[184:187], a[160:163], v[32:35], 0
v_exp_f32 v116, v116
MV 184,a,164,v,36
v_exp_f32 v117, v117
MV 184,a,168,v,40
ds_read_b128 a[220:223], v11 offset:23552
v_cvt_pk_bf16_f32 v113, v114, v115
MV 184,a,172,v,44
v_exp_f32 v118, v118
v_mfma_f32_16x16x32_bf16 v[188:191], a[176:179], v[32:35], 0
ds_read_b128 a[224:227], v11 offset:24576
ds_read_b128 a[228:231], v11 offset:25600
MV 188,a,180,v,36
v_exp_f32 v119, v119
MV 188,a,184,v,40
ds_read_b128 a[232:235], v11 offset:26624
v_cvt_pk_bf16_f32 v114, v116, v117
MV 188,a,188,v,44
ds_read_b128 a[236:239], v11 offset:27648
ds_read_b128 a[240:243], v11 offset:28672
ds_read_b128 a[244:247], v11 offset:29696
ds_read_b128 a[248:251], v11 offset:30720
ds_read_b128 a[252:255], v11 offset:31744
v_exp_f32 v120, v120
v_exp_f32 v121, v121
v_cvt_pk_bf16_f32 v115, v118, v119
v_exp_f32 v122, v122
v_exp_f32 v123, v123
v_cvt_pk_bf16_f32 v120, v120, v121
v_exp_f32 v124, v124
v_exp_f32 v125, v125
v_cvt_pk_bf16_f32 v121, v122, v123
v_exp_f32 v126, v126
v_exp_f32 v127, v127
v_add_u32 v246, -64, v239
v_cmp_gt_i32_e64 s[84:85], 0, v246
v_cmp_gt_i32_e64 s[86:87], 1, v246
v_cmp_gt_i32_e64 s[88:89], 2, v246
v_cmp_gt_i32_e64 s[90:91], 3, v246
v_cndmask_b32_e64 v152, v152, v14, s[84:85]
v_cndmask_b32_e64 v153, v153, v14, s[86:87]
v_cndmask_b32_e64 v154, v154, v14, s[88:89]
v_cndmask_b32_e64 v155, v155, v14, s[90:91]
v_cvt_pk_bf16_f32 v122, v124, v125
v_cvt_pk_bf16_f32 v123, v126, v127
v_add_u32 v247, -80, v239
v_cmp_gt_i32_e64 s[92:93], 0, v247
v_cmp_gt_i32_e64 s[94:95], 1, v247
v_cmp_gt_i32_e64 s[96:97], 2, v247
v_cmp_gt_i32_e64 s[98:99], 3, v247
v_cndmask_b32_e64 v156, v156, v14, s[92:93]
v_cndmask_b32_e64 v157, v157, v14, s[94:95]
v_cndmask_b32_e64 v158, v158, v14, s[96:97]
v_cndmask_b32_e64 v159, v159, v14, s[98:99]
s_waitcnt vmcnt(4) lgkmcnt(0)
MA 0,a,192,v,80
s_barrier
MA 32,a,192,v,88
v_exp_f32 v152, v152
MA 4,a,196,v,80
v_lshlrev_b32 v245, 4, v1
s_mov_b32 m0, s43
MA 36,a,196,v,88
MA 8,a,200,v,80
v_exp_f32 v153, v153
MA 40,a,200,v,88
MA 12,a,204,v,80
v_add_u32 v246, -96, v239
v_cmp_gt_i32_e64 s[84:85], 0, v246
MA 44,a,204,v,88
MV 164,v,160,v,80
v_exp_f32 v154, v154
MV 168,v,160,v,88
s_nop 0
v_cmp_gt_i32_e64 s[86:87], 1, v246
MA 16,a,208,v,80
MA 48,a,208,v,88
v_exp_f32 v155, v155
MA 20,a,212,v,80
v_cmp_gt_i32_e64 s[88:89], 2, v246
v_cmp_gt_i32_e64 s[90:91], 3, v246
MA 52,a,212,v,88
MA 24,a,216,v,80
v_cvt_pk_bf16_f32 v152, v152, v153
v_cndmask_b32_e64 v184, v184, v14, s[84:85]
MA 56,a,216,v,88
MA 28,a,220,v,80
buffer_load_dwordx4 v245, s[20:23], 0 offen offset:0 sc1 lds
v_cndmask_b32_e64 v185, v185, v14, s[86:87]
MA 60,a,220,v,88
v_exp_f32 v156, v156
MA 0,a,224,v,112
v_cndmask_b32_e64 v186, v186, v14, s[88:89]
v_cndmask_b32_e64 v187, v187, v14, s[90:91]
MA 32,a,224,v,120
MA 4,a,228,v,112
v_exp_f32 v157, v157
MA 36,a,228,v,120
buffer_load_dwordx4 v245, s[20:23], 0 offen offset:1024 sc1 lds
v_add_u32 v247, -112, v239
MA 8,a,232,v,112
v_cvt_pk_bf16_f32 v153, v154, v155
v_cmp_gt_i32_e64 s[92:93], 0, v247
MA 40,a,232,v,120
MA 12,a,236,v,112
buffer_load_dwordx4 v245, s[20:23], 0 offen offset:2048 sc1 lds
v_cmp_gt_i32_e64 s[94:95], 1, v247
MA 44,a,236,v,120
v_exp_f32 v158, v158
MV 164,v,160,v,112
v_cmp_gt_i32_e64 s[96:97], 2, v247
v_cmp_gt_i32_e64 s[98:99], 3, v247
MV 168,v,160,v,120
MA 16,a,240,v,112
MA 48,a,240,v,120
v_exp_f32 v159, v159
MA 20,a,244,v,112
buffer_load_dwordx4 v245, s[20:23], 0 offen offset:3072 sc1 lds
v_cndmask_b32_e64 v188, v188, v14, s[92:93]
MA 52,a,244,v,120
v_cvt_pk_bf16_f32 v154, v156, v157
v_cndmask_b32_e64 v189, v189, v14, s[94:95]
MA 24,a,248,v,112
v_cvt_pk_bf16_f32 v155, v158, v159
v_cndmask_b32_e64 v190, v190, v14, s[96:97]
MA 56,a,248,v,120
MA 28,a,252,v,112
v_cndmask_b32_e64 v191, v191, v14, s[98:99]
MA 60,a,252,v,120
s_load_dwordx2 s[88:89], s[0:1], 104
s_waitcnt lgkmcnt(0)
v_xor_b32 v11, 0x8000, v11
ds_read_b128 a[192:195], v11 offset:0
ds_read_b128 a[196:199], v11 offset:1024
ds_read_b128 a[200:203], v11 offset:2048
ds_read_b128 a[204:207], v11 offset:3072
ds_read_b128 a[208:211], v11 offset:4096
ds_read_b128 a[212:215], v11 offset:5120
ds_read_b128 a[216:219], v11 offset:6144
ds_read_b128 a[220:223], v11 offset:7168
ds_read_b128 a[224:227], v11 offset:8192
ds_read_b128 a[228:231], v11 offset:9216
ds_read_b128 a[232:235], v11 offset:10240
ds_read_b128 a[236:239], v11 offset:11264
ds_read_b128 a[240:243], v11 offset:12288
ds_read_b128 a[244:247], v11 offset:13312
ds_read_b128 a[248:251], v11 offset:14336
ds_read_b128 a[252:255], v11 offset:15360
v_exp_f32 v184, v184
v_exp_f32 v185, v185
v_exp_f32 v186, v186
v_exp_f32 v187, v187
v_cvt_pk_bf16_f32 v184, v184, v185
v_exp_f32 v188, v188
v_exp_f32 v189, v189
v_cvt_pk_bf16_f32 v185, v186, v187
v_exp_f32 v190, v190
v_exp_f32 v191, v191
v_cvt_pk_bf16_f32 v186, v188, v189
v_cvt_pk_bf16_f32 v187, v190, v191
MV 168,v,160,v,152
s_nop 0
MV 168,v,160,v,184
v_mov_b32 v240, v2
v_mov_b32 v241, v3
s_nop 0
v_permlane32_swap_b32 v2, v240
v_permlane32_swap_b32 v3, v241
v_add_f32 v2, v2, v240
v_add_f32 v3, v3, v241
v_mov_b32 v240, v2
v_mov_b32 v241, v3
s_nop 0
v_permlane16_swap_b32 v2, v240
v_permlane16_swap_b32 v3, v241
v_add_f32 v2, v2, v240
v_add_f32 v3, v3, v241
v_add_f32 v2, v2, v164
v_cmp_nle_f32 vcc, 0x30800000, v2
s_nop 0
s_or_b64 s[78:79], s[78:79], vcc
v_cmp_nge_f32 vcc, 0x4e800000, v2
s_nop 0
s_or_b64 s[78:79], s[78:79], vcc
v_add_f32 v3, v3, v168
v_cmp_nle_f32 vcc, 0x30800000, v3
s_nop 0
s_or_b64 s[78:79], s[78:79], vcc
v_cmp_nge_f32 vcc, 0x4e800000, v3
s_nop 0
s_or_b64 s[78:79], s[78:79], vcc
s_cmp_lg_u64 s[78:79], 0
s_cselect_b32 s80, 1, 0
v_mov_b32 v240, s80
s_lshl_b32 s80, s3, 2
s_add_u32 s80, s80, 163824
v_mov_b32 v241, s80
ds_write_b32 v241, v240
v_mov_b32 v241, 163824
s_waitcnt vmcnt(0) lgkmcnt(0)
s_barrier
ds_read_b128 v[244:247], v241
buffer_store_dword v237, v236, s[8:11], s37 offen offset:1024 sc1
MA 32,a,192,v,152
MA 36,a,196,v,152
MA 40,a,200,v,152
MA 44,a,204,v,152
MA 48,a,208,v,152
MA 52,a,212,v,152
s_waitcnt lgkmcnt(0)
v_or3_b32 v240, v244, v245, v246
v_or_b32 v240, v240, v247
MA 56,a,216,v,152
v_cmp_ne_u32 vcc, 0, v240
MA 60,a,220,v,152
MA 32,a,224,v,184
s_cbranch_vccnz L_fallback
MA 36,a,228,v,184
s_mul_i32 s36, s3, 8320
v_and_b32 v16, 15, v1
MA 40,a,232,v,184
v_lshrrev_b32 v17, 4, v1
v_add_u32 v18, 1, v16
MA 44,a,236,v,184
v_and_b32 v19, 1, v18
v_mul_u32_u24 v19, 4160, v19
MA 48,a,240,v,184
v_add_u32 v18, 2, v16
v_lshrrev_b32 v18, 1, v18
MA 52,a,244,v,184
v_lshl_add_u32 v19, v18, 2, v19
v_lshl_add_u32 v19, v17, 4, v19
MA 56,a,248,v,184
v_add_u32 v40, s36, v19
v_add_u32 v41, 1024, v40
MA 60,a,252,v,184
v_add_u32 v42, 2048, v40
v_add_u32 v43, 3072, v40
v_add_u32 v10, s36, v232
v_lshlrev_b32 v18, 5, v16
v_lshlrev_b32 v19, 4, v17
v_sub_u32 v19, v19, v18
s_add_u32 s37, s43, 480
v_add_u32 v5, s37, v19
v_mov_b32 v20, 0
v_mov_b32 v21, 0
v_mov_b32 v22, 0
v_mov_b32 v23, 0
v_and_b32 v16, 1, v1
v_mul_u32_u24 v16, 4160, v16
v_and_b32 v17, 2, v1
v_lshl_add_u32 v16, v17, 3, v16
v_add_u32 v16, s36, v16
ds_write_b128 v16, v[20:23]
v_and_b32 v17, 31, v1
v_lshlrev_b32 v17, 4, v17
v_add_u32 v17, s43, v17
ds_write_b128 v17, v[20:23] offset:4096
ds_write_b128 v10, v[210:213] offset:32
v_alignbit_b32 v24, v210, v209, 16
v_alignbit_b32 v25, v211, v210, 16
v_alignbit_b32 v26, v212, v211, 16
v_alignbit_b32 v27, v213, v212, 16
ds_write_b128 v10, v[24:27] offset:4192
ds_write_b128 v10, v[216:219] offset:1056
v_alignbit_b32 v28, v216, v215, 16
v_alignbit_b32 v29, v217, v216, 16
v_alignbit_b32 v30, v218, v217, 16
v_alignbit_b32 v31, v219, v218, 16
ds_write_b128 v10, v[28:31] offset:5216
ds_write_b128 v10, v[222:225] offset:2080
v_alignbit_b32 v24, v222, v221, 16
v_alignbit_b32 v25, v223, v222, 16
v_alignbit_b32 v26, v224, v223, 16
v_alignbit_b32 v27, v225, v224, 16
ds_write_b128 v10, v[24:27] offset:6240
ds_write_b128 v10, v[228:231] offset:3104
v_alignbit_b32 v28, v228, v227, 16
v_alignbit_b32 v29, v229, v228, 16
v_alignbit_b32 v30, v230, v229, 16
v_alignbit_b32 v31, v231, v230, 16
ds_write_b128 v10, v[28:31] offset:7264
v_rcp_f32 v2, v2
v_rcp_f32 v3, v3
s_add_u32 s80, s100, s76
s_nop 4
v_accvgpr_read_b32 v240, a0
v_accvgpr_read_b32 v241, a1
v_accvgpr_read_b32 v242, a2
v_accvgpr_read_b32 v243, a3
v_accvgpr_read_b32 v244, a4
v_accvgpr_read_b32 v245, a5
v_accvgpr_read_b32 v246, a6
v_accvgpr_read_b32 v247, a7
v_mul_f32 v240, v240, v2
v_mul_f32 v241, v241, v2
v_mul_f32 v242, v242, v2
v_mul_f32 v243, v243, v2
v_mul_f32 v244, v244, v2
v_mul_f32 v245, v245, v2
v_mul_f32 v246, v246, v2
v_mul_f32 v247, v247, v2
v_cvt_pk_bf16_f32 v248, v240, v241
v_cvt_pk_bf16_f32 v249, v242, v243
v_cvt_pk_bf16_f32 v250, v244, v245
v_cvt_pk_bf16_f32 v251, v246, v247
buffer_store_dwordx4 v[248:251], v15, s[60:63], s100 offen offset:0 sc1
v_accvgpr_read_b32 v240, a8
v_accvgpr_read_b32 v241, a9
v_accvgpr_read_b32 v242, a10
v_accvgpr_read_b32 v243, a11
v_accvgpr_read_b32 v244, a12
v_accvgpr_read_b32 v245, a13
v_accvgpr_read_b32 v246, a14
v_accvgpr_read_b32 v247, a15
v_mul_f32 v240, v240, v2
v_mul_f32 v241, v241, v2
v_mul_f32 v242, v242, v2
v_mul_f32 v243, v243, v2
v_mul_f32 v244, v244, v2
v_mul_f32 v245, v245, v2
v_mul_f32 v246, v246, v2
v_mul_f32 v247, v247, v2
v_cvt_pk_bf16_f32 v252, v240, v241
v_cvt_pk_bf16_f32 v253, v242, v243
v_cvt_pk_bf16_f32 v254, v244, v245
v_cvt_pk_bf16_f32 v255, v246, v247
buffer_store_dwordx4 v[252:255], v15, s[60:63], s100 offen offset:1024 sc1
v_accvgpr_read_b32 v240, a16
v_accvgpr_read_b32 v241, a17
v_accvgpr_read_b32 v242, a18
v_accvgpr_read_b32 v243, a19
v_accvgpr_read_b32 v244, a20
v_accvgpr_read_b32 v245, a21
v_accvgpr_read_b32 v246, a22
v_accvgpr_read_b32 v247, a23
v_mul_f32 v240, v240, v2
v_mul_f32 v241, v241, v2
v_mul_f32 v242, v242, v2
v_mul_f32 v243, v243, v2
v_mul_f32 v244, v244, v2
v_mul_f32 v245, v245, v2
v_mul_f32 v246, v246, v2
v_mul_f32 v247, v247, v2
v_cvt_pk_bf16_f32 v248, v240, v241
v_cvt_pk_bf16_f32 v249, v242, v243
v_cvt_pk_bf16_f32 v250, v244, v245
v_cvt_pk_bf16_f32 v251, v246, v247
buffer_store_dwordx4 v[248:251], v15, s[60:63], s100 offen offset:2048 sc1
v_accvgpr_read_b32 v240, a24
v_accvgpr_read_b32 v241, a25
v_accvgpr_read_b32 v242, a26
v_accvgpr_read_b32 v243, a27
v_accvgpr_read_b32 v244, a28
v_accvgpr_read_b32 v245, a29
v_accvgpr_read_b32 v246, a30
v_accvgpr_read_b32 v247, a31
v_mul_f32 v240, v240, v2
v_mul_f32 v241, v241, v2
v_mul_f32 v242, v242, v2
v_mul_f32 v243, v243, v2
v_mul_f32 v244, v244, v2
v_mul_f32 v245, v245, v2
v_mul_f32 v246, v246, v2
v_mul_f32 v247, v247, v2
v_cvt_pk_bf16_f32 v252, v240, v241
v_cvt_pk_bf16_f32 v253, v242, v243
v_cvt_pk_bf16_f32 v254, v244, v245
v_cvt_pk_bf16_f32 v255, v246, v247
buffer_store_dwordx4 v[252:255], v15, s[60:63], s100 offen offset:3072 sc1
v_accvgpr_read_b32 v240, a32
v_accvgpr_read_b32 v241, a33
v_accvgpr_read_b32 v242, a34
v_accvgpr_read_b32 v243, a35
v_accvgpr_read_b32 v244, a36
v_accvgpr_read_b32 v245, a37
v_accvgpr_read_b32 v246, a38
v_accvgpr_read_b32 v247, a39
v_mul_f32 v240, v240, v3
v_mul_f32 v241, v241, v3
v_mul_f32 v242, v242, v3
v_mul_f32 v243, v243, v3
v_mul_f32 v244, v244, v3
v_mul_f32 v245, v245, v3
v_mul_f32 v246, v246, v3
v_mul_f32 v247, v247, v3
v_cvt_pk_bf16_f32 v248, v240, v241
v_cvt_pk_bf16_f32 v249, v242, v243
v_cvt_pk_bf16_f32 v250, v244, v245
v_cvt_pk_bf16_f32 v251, v246, v247
buffer_store_dwordx4 v[248:251], v15, s[60:63], s80 offen offset:0 sc1
v_accvgpr_read_b32 v240, a40
v_accvgpr_read_b32 v241, a41
v_accvgpr_read_b32 v242, a42
v_accvgpr_read_b32 v243, a43
v_accvgpr_read_b32 v244, a44
v_accvgpr_read_b32 v245, a45
v_accvgpr_read_b32 v246, a46
v_accvgpr_read_b32 v247, a47
v_mul_f32 v240, v240, v3
v_mul_f32 v241, v241, v3
v_mul_f32 v242, v242, v3
v_mul_f32 v243, v243, v3
v_mul_f32 v244, v244, v3
v_mul_f32 v245, v245, v3
v_mul_f32 v246, v246, v3
v_mul_f32 v247, v247, v3
v_cvt_pk_bf16_f32 v252, v240, v241
v_cvt_pk_bf16_f32 v253, v242, v243
v_cvt_pk_bf16_f32 v254, v244, v245
v_cvt_pk_bf16_f32 v255, v246, v247
buffer_store_dwordx4 v[252:255], v15, s[60:63], s80 offen offset:1024 sc1
v_accvgpr_read_b32 v240, a48
v_accvgpr_read_b32 v241, a49
v_accvgpr_read_b32 v242, a50
v_accvgpr_read_b32 v243, a51
v_accvgpr_read_b32 v244, a52
v_accvgpr_read_b32 v245, a53
v_accvgpr_read_b32 v246, a54
v_accvgpr_read_b32 v247, a55
v_mul_f32 v240, v240, v3
v_mul_f32 v241, v241, v3
v_mul_f32 v242, v242, v3
v_mul_f32 v243, v243, v3
v_mul_f32 v244, v244, v3
v_mul_f32 v245, v245, v3
v_mul_f32 v246, v246, v3
v_mul_f32 v247, v247, v3
v_cvt_pk_bf16_f32 v248, v240, v241
v_cvt_pk_bf16_f32 v249, v242, v243
v_cvt_pk_bf16_f32 v250, v244, v245
v_cvt_pk_bf16_f32 v251, v246, v247
buffer_store_dwordx4 v[248:251], v15, s[60:63], s80 offen offset:2048 sc1
v_accvgpr_read_b32 v240, a56
v_accvgpr_read_b32 v241, a57
v_accvgpr_read_b32 v242, a58
v_accvgpr_read_b32 v243, a59
v_accvgpr_read_b32 v244, a60
v_accvgpr_read_b32 v245, a61
v_accvgpr_read_b32 v246, a62
v_accvgpr_read_b32 v247, a63
v_mul_f32 v240, v240, v3
v_mul_f32 v241, v241, v3
v_mul_f32 v242, v242, v3
v_mul_f32 v243, v243, v3
v_mul_f32 v244, v244, v3
v_mul_f32 v245, v245, v3
v_mul_f32 v246, v246, v3
v_mul_f32 v247, v247, v3
v_cvt_pk_bf16_f32 v252, v240, v241
v_cvt_pk_bf16_f32 v253, v242, v243
v_cvt_pk_bf16_f32 v254, v244, v245
v_cvt_pk_bf16_f32 v255, v246, v247
buffer_store_dwordx4 v[252:255], v15, s[60:63], s80 offen offset:3072 sc1
L_p3_done:
s_waitcnt lgkmcnt(0)
ds_read_b128 a[160:163], v5 offset:3584
ds_read2_b32 a[128:129], v40 offset0:0 offset1:1
ds_read2_b32 a[130:131], v40 offset0:2 offset1:3
ds_read_b128 a[164:167], v5 offset:3072
ds_read2_b32 a[132:133], v40 offset0:128 offset1:129
ds_read2_b32 a[134:135], v40 offset0:130 offset1:131
ds_read_b128 a[168:171], v5 offset:2560
ds_read2_b32 a[136:137], v41 offset0:0 offset1:1
ds_read2_b32 a[138:139], v41 offset0:2 offset1:3
ds_read_b128 a[172:175], v5 offset:2048
ds_read2_b32 a[140:141], v41 offset0:128 offset1:129
ds_read2_b32 a[142:143], v41 offset0:130 offset1:131
ds_read_b128 a[176:179], v5 offset:1536
ds_read2_b32 a[144:145], v42 offset0:0 offset1:1
ds_read2_b32 a[146:147], v42 offset0:2 offset1:3
ds_read_b128 a[180:183], v5 offset:1024
ds_read2_b32 a[148:149], v42 offset0:128 offset1:129
ds_read2_b32 a[150:151], v42 offset0:130 offset1:131
ds_read_b128 a[184:187], v5 offset:512
ds_read2_b32 a[152:153], v43 offset0:0 offset1:1
ds_read2_b32 a[154:155], v43 offset0:2 offset1:3
ds_read_b128 a[188:191], v5 offset:0
ds_read2_b32 a[156:157], v43 offset0:128 offset1:129
ds_read2_b32 a[158:159], v43 offset0:130 offset1:131
v_lshlrev_b32 v255, 20, v1
v_mov_b32 v253, 1
s_lshl_b32 s83, s3, 8
s_add_u32 s83, s83, s2
s_lshl_b32 s83, s83, 2
s_add_u32 s83, s83, 4096
s_waitcnt lgkmcnt(15)
v_mfma_f32_16x16x32_bf16 v[76:79], a[128:131], a[160:163], 0
v_and_b32 v16, 15, v1
v_lshrrev_b32 v17, 4, v1
v_mfma_f32_16x16x32_bf16 v[80:83], a[128:131], a[164:167], 0
v_lshl_add_u32 v18, v17, 3, v16
ds_read_b128 a[224:227], v5 offset:3648
v_mfma_f32_16x16x32_bf16 v[84:87], a[128:131], a[168:171], 0
v_sub_u32 v235, 15, v18
ds_read2_b32 a[192:193], v40 offset0:16 offset1:17
s_waitcnt lgkmcnt(15)
v_mfma_f32_16x16x32_bf16 v[88:91], a[128:131], a[172:175], 0
v_lshlrev_b32 v18, 16, v234
ds_read2_b32 a[194:195], v40 offset0:18 offset1:19
s_waitcnt lgkmcnt(14)
v_mfma_f32_16x16x32_bf16 v[92:95], a[128:131], a[176:179], 0
v_cmp_eq_u32 vcc, 0, v235
v_cmp_eq_u32_e64 s[38:39], 1, v235
s_waitcnt lgkmcnt(11)
v_mfma_f32_16x16x32_bf16 v[96:99], a[128:131], a[180:183], 0
ds_read_b128 a[228:231], v5 offset:3136
ds_read2_b32 a[196:197], v40 offset0:144 offset1:145
s_waitcnt lgkmcnt(10)
v_mfma_f32_16x16x32_bf16 v[100:103], a[128:131], a[184:187], 0
s_nop 0
v_cndmask_b32 v44, 0, v234, vcc
s_waitcnt lgkmcnt(7)
v_mfma_f32_16x16x32_bf16 v[104:107], a[128:131], a[188:191], 0
ds_read2_b32 a[198:199], v40 offset0:146 offset1:147
ds_read_b128 a[232:235], v5 offset:2624
MV 80,a,132,a,160
v_cndmask_b32_e64 v44, v44, v18, s[38:39]
ds_read2_b32 a[200:201], v41 offset0:16 offset1:17
MV 84,a,132,a,164
v_cmp_eq_u32 vcc, 2, v235
v_cmp_eq_u32_e64 s[38:39], 3, v235
MV 88,a,132,a,168
ds_read2_b32 a[202:203], v41 offset0:18 offset1:19
s_and_b32 s81, s2, 3
MV 92,a,132,a,172
s_nop 0
v_cndmask_b32 v45, 0, v234, vcc
MV 96,a,132,a,176
ds_read_b128 a[236:239], v5 offset:2112
ds_read2_b32 a[204:205], v41 offset0:144 offset1:145
MV 100,a,132,a,180
v_cndmask_b32_e64 v45, v45, v18, s[38:39]
ds_read2_b32 a[206:207], v41 offset0:146 offset1:147
MV 104,a,132,a,184
v_cmp_eq_u32 vcc, 4, v235
v_cmp_eq_u32_e64 s[38:39], 5, v235
MV 84,a,136,a,160
ds_read_b128 a[240:243], v5 offset:1600
s_lshl_b32 s81, s81, 1
MV 88,a,136,a,164
s_nop 0
v_cndmask_b32 v46, 0, v234, vcc
MV 92,a,136,a,168
ds_read2_b32 a[208:209], v42 offset0:16 offset1:17
ds_read2_b32 a[210:211], v42 offset0:18 offset1:19
MV 96,a,136,a,172
v_cndmask_b32_e64 v46, v46, v18, s[38:39]
ds_read_b128 a[244:247], v5 offset:1088
MV 100,a,136,a,176
v_cmp_eq_u32 vcc, 6, v235
v_cmp_eq_u32_e64 s[38:39], 7, v235
MV 104,a,136,a,180
ds_read2_b32 a[212:213], v42 offset0:144 offset1:145
s_sub_u32 s74, 14, s81
MV 88,a,140,a,160
s_nop 0
v_cndmask_b32 v47, 0, v234, vcc
MV 92,a,140,a,164
ds_read2_b32 a[214:215], v42 offset0:146 offset1:147
ds_read_b128 a[248:251], v5 offset:576
MV 96,a,140,a,168
v_cndmask_b32_e64 v47, v47, v18, s[38:39]
ds_read2_b32 a[216:217], v43 offset0:16 offset1:17
MV 100,a,140,a,172
s_bitcmp1_b32 s2, 4
s_cselect_b32 s81, s74, s81
MV 104,a,140,a,176
ds_read2_b32 a[218:219], v43 offset0:18 offset1:19
s_bfe_u32 s74, s2, 0x10003
MV 92,a,144,a,160
ds_read_b128 a[252:255], v5 offset:64
s_add_u32 s81, s81, s74
MV 96,a,144,a,164
ds_read2_b32 a[220:221], v43 offset0:144 offset1:145
s_bfe_u32 s82, s2, 0x10002
MV 100,a,144,a,168
ds_read2_b32 a[222:223], v43 offset0:146 offset1:147
s_lshr_b32 s74, s2, 5
MV 104,a,144,a,172
s_lshl_b32 s74, s74, 1
s_add_u32 s82, s82, s74
MV 96,a,148,a,160
s_mov_b32 s72, s81
s_mov_b32 s73, s82
MV 100,a,148,a,164
s_lshl_b32 s74, s72, 2
s_add_u32 s74, s74, s3
MV 104,a,148,a,168
s_lshl_b32 s68, s74, 18
MV 100,a,152,a,160
MV 104,a,152,a,164
s_and_b32 s80, s73, 1
s_waitcnt lgkmcnt(15)
MV 104,a,156,a,160
MV 76,v,44,a,160
s_lshl_b32 s75, s80, 16
MV 80,v,44,a,164
MV 84,v,44,a,168
s_add_u32 s68, s68, s75
MV 88,v,44,a,172
MV 92,v,44,a,176
s_lshl_b32 s69, s73, 19
MV 96,v,44,a,180
MV 100,v,44,a,184
MV 104,v,44,a,188
s_waitcnt vmcnt(0)
buffer_store_dword v253, v255, s[8:11], s83 offen sc1
MV 76,a,192,a,224
ds_read_b128 a[160:163], v5 offset:3712
s_lshl_b32 s75, s73, 7
MV 80,a,192,a,228
ds_read2_b32 a[128:129], v40 offset0:32 offset1:33
s_lshl_b32 s70, s3, 12
MV 84,a,192,a,232
ds_read2_b32 a[130:131], v40 offset0:34 offset1:35
s_lshl_b32 s78, s74, 16
s_waitcnt lgkmcnt(15)
MV 88,a,192,a,236
ds_read_b128 a[164:167], v5 offset:3200
s_add_u32 s78, s78, s75
s_waitcnt lgkmcnt(15)
MV 92,a,192,a,240
s_lshl_b32 s79, s73, 18
s_lshl_b32 s75, s74, 8
s_waitcnt lgkmcnt(12)
MV 96,a,192,a,244
ds_read2_b32 a[132:133], v40 offset0:160 offset1:161
s_add_u32 s79, s79, s75
s_waitcnt lgkmcnt(10)
MV 100,a,192,a,248
ds_read2_b32 a[134:135], v40 offset0:162 offset1:163
v_lshlrev_b32 v236, 4, v1
s_waitcnt lgkmcnt(8)
MV 104,a,192,a,252
ds_read_b128 a[168:171], v5 offset:2688
v_add_u32 v237, 0x20000, v236
MV 80,a,196,a,224
ds_read2_b32 a[136:137], v41 offset0:32 offset1:33
v_add_u32 v238, s70, v236
MV 84,a,196,a,228
s_lshl_b32 s75, s80, 12
v_add_u32 v244, s75, v236
MV 88,a,196,a,232
ds_read2_b32 a[138:139], v41 offset0:34 offset1:35
v_xor_b32 v245, 0x1000, v244
MV 92,a,196,a,236
ds_read_b128 a[172:175], v5 offset:2176
v_add_u32 v242, 66560, v244
MV 96,a,196,a,240
ds_read2_b32 a[140:141], v41 offset0:160 offset1:161
v_add_u32 v243, 66560, v245
MV 100,a,196,a,244
ds_read2_b32 a[142:143], v41 offset0:162 offset1:163
v_bfe_u32 v50, v1, 4, 1
MV 104,a,196,a,248
v_lshrrev_b32 v52, 5, v1
v_and_b32 v48, 15, v1
MV 84,a,200,a,224
ds_read_b128 a[176:179], v5 offset:1664
v_lshlrev_b32 v53, 5, v50
MV 88,a,200,a,228
ds_read2_b32 a[144:145], v42 offset0:32 offset1:33
v_lshl_add_u32 v53, v52, 4, v53
MV 92,a,200,a,232
ds_read2_b32 a[146:147], v42 offset0:34 offset1:35
v_lshl_add_u32 v250, v48, 11, v53
MV 96,a,200,a,236
ds_read_b128 a[180:183], v5 offset:1152
v_lshlrev_b32 v53, 11, v53
MV 100,a,200,a,240
v_lshl_add_u32 v251, v48, 3, v53
MV 104,a,200,a,244
ds_read2_b32 a[148:149], v42 offset0:160 offset1:161
MV 88,a,204,a,224
ds_read2_b32 a[150:151], v42 offset0:162 offset1:163
MV 92,a,204,a,228
ds_read_b128 a[184:187], v5 offset:640
MV 96,a,204,a,232
ds_read2_b32 a[152:153], v43 offset0:32 offset1:33
MV 100,a,204,a,236
s_add_u32 s44, s40, 33554432
s_addc_u32 s45, s41, 0
MV 104,a,204,a,240
ds_read2_b32 a[154:155], v43 offset0:34 offset1:35
s_mov_b32 s46, 16777216
MV 92,a,208,a,224
ds_read_b128 a[188:191], v5 offset:128
s_mov_b32 s47, 0x20000
MV 96,a,208,a,228
ds_read2_b32 a[156:157], v43 offset0:160 offset1:161
MV 100,a,208,a,232
ds_read2_b32 a[158:159], v43 offset0:162 offset1:163
MV 104,a,208,a,236
s_add_u32 s48, s40, 100663296
s_addc_u32 s49, s41, 0
MV 96,a,212,a,224
s_mov_b32 s50, 8388608
s_mov_b32 s51, 0x20000
MV 100,a,212,a,228
s_add_u32 s52, s40, 109051904
s_addc_u32 s53, s41, 0
MV 104,a,212,a,232
s_mov_b32 s54, 4194304
s_mov_b32 s55, 0x20000
MV 100,a,216,a,224
s_add_u32 s56, s40, 54525952
s_addc_u32 s57, s41, 0
MV 104,a,216,a,228
s_mov_b32 s58, 4194304
s_mov_b32 s59, 0x20000
s_waitcnt lgkmcnt(15)
MV 104,a,220,a,224
s_mov_b32 s60, s88
s_mov_b32 s61, s89
s_mov_b32 s62, 4194304
s_mov_b32 s63, 0x20000
s_lshr_b32 s36, s82, 1
s_lshl_b32 s37, s80, 7
s_add_u32 s36, s36, s37
v_lshl_add_u32 v254, v1, 3, s36
s_xor_b32 s36, s2, 4
v_mov_b32 v253, s36
v_cmp_lt_u32 vcc, 15, v1
s_nop 1
v_cndmask_b32 v254, v254, v253, vcc
v_lshlrev_b32 v254, 2, v254
buffer_load_dword v253, v254, s[8:11], 0 offen offset:1024 sc1
MV 76,a,128,a,160
ds_read_b128 a[224:227], v5 offset:3776
s_sub_u32 s36, 15, s81
MV 80,a,128,a,164
ds_read2_b32 a[192:193], v40 offset0:48 offset1:49
s_min_u32 s36, s36, s81
MV 84,a,128,a,168
ds_read2_b32 a[194:195], v40 offset0:50 offset1:51
s_waitcnt lgkmcnt(15)
MV 88,a,128,a,172
ds_read_b128 a[228:231], v5 offset:3264
s_lshr_b32 s37, s36, 1
s_waitcnt lgkmcnt(15)
MV 92,a,128,a,176
s_waitcnt lgkmcnt(12)
MV 96,a,128,a,180
ds_read2_b32 a[196:197], v40 offset0:176 offset1:177
s_xor_b32 s36, s36, s37
s_waitcnt lgkmcnt(10)
MV 100,a,128,a,184
ds_read2_b32 a[198:199], v40 offset0:178 offset1:179
s_and_b32 s36, s36, 1
s_waitcnt lgkmcnt(8)
MV 104,a,128,a,188
ds_read_b128 a[232:235], v5 offset:2752
MV 80,a,132,a,160
ds_read2_b32 a[200:201], v41 offset0:48 offset1:49
s_lshl_b32 s37, s37, 6
MV 84,a,132,a,164
MV 88,a,132,a,168
ds_read2_b32 a[202:203], v41 offset0:50 offset1:51
s_add_u32 s36, s36, s37
MV 92,a,132,a,172
ds_read_b128 a[236:239], v5 offset:2240
s_lshl_b32 s37, s80, 2
MV 96,a,132,a,176
ds_read2_b32 a[204:205], v41 offset0:176 offset1:177
MV 100,a,132,a,180
ds_read2_b32 a[206:207], v41 offset0:178 offset1:179
s_add_u32 s36, s36, s37
MV 104,a,132,a,184
MV 84,a,136,a,160
ds_read_b128 a[240:243], v5 offset:1728
s_add_u32 s36, s36, 1024
MV 88,a,136,a,164
ds_read2_b32 a[208:209], v42 offset0:48 offset1:49
v_bfe_u32 v228, v1, 4, 1
MV 92,a,136,a,168
ds_read2_b32 a[210:211], v42 offset0:50 offset1:51
MV 96,a,136,a,172
ds_read_b128 a[244:247], v5 offset:1216
v_lshl_add_u32 v228, s3, 1, v228
MV 100,a,136,a,176
MV 104,a,136,a,180
ds_read2_b32 a[212:213], v42 offset0:176 offset1:177
v_sub_u32 v229, 7, v228
MV 88,a,140,a,160
ds_read2_b32 a[214:215], v42 offset0:178 offset1:179
v_min_u32 v228, v228, v229
MV 92,a,140,a,164
ds_read_b128 a[248:251], v5 offset:704
MV 96,a,140,a,168
ds_read2_b32 a[216:217], v43 offset0:48 offset1:49
v_lshl_add_u32 v229, v228, 8, s36
MV 100,a,140,a,172
MV 104,a,140,a,176
ds_read2_b32 a[218:219], v43 offset0:50 offset1:51
v_and_b32 v252, 7, v1
MV 92,a,144,a,160
ds_read_b128 a[252:255], v5 offset:192
v_lshlrev_b32 v252, 3, v252
MV 96,a,144,a,164
ds_read2_b32 a[220:221], v43 offset0:176 offset1:177
MV 100,a,144,a,168
ds_read2_b32 a[222:223], v43 offset0:178 offset1:179
v_bfe_u32 v228, v1, 3, 1
MV 104,a,144,a,172
MV 96,a,148,a,160
v_lshlrev_b32 v228, 1, v228
MV 100,a,148,a,164
v_add3_u32 v252, v252, v228, v229
MV 104,a,148,a,168
MV 100,a,152,a,160
v_lshlrev_b32 v252, 2, v252
MV 104,a,152,a,164
s_waitcnt lgkmcnt(15)
MV 104,a,156,a,160
s_waitcnt vmcnt(0)
v_cmp_gt_u32 vcc, 1, v253
s_nop 4
s_cbranch_vccnz L_spin_w
L_spin_w_ret:
MV 76,a,192,a,224
ds_read_b128 a[160:163], v5 offset:3840
s_add_u32 m0, s70, 66560
MV 80,a,192,a,228
ds_read2_b32 a[128:129], v40 offset0:64 offset1:65
v_lshlrev_b32 v255, 20, v1
MV 84,a,192,a,232
ds_read2_b32 a[130:131], v40 offset0:66 offset1:67
buffer_load_dwordx4 v238, s[48:51], s69 offen offset:0 sc1 lds
s_waitcnt lgkmcnt(15)
MV 88,a,192,a,236
ds_read_b128 a[164:167], v5 offset:3328
s_waitcnt lgkmcnt(15)
MV 92,a,192,a,240
s_waitcnt lgkmcnt(12)
MV 96,a,192,a,244
ds_read2_b32 a[132:133], v40 offset0:192 offset1:193
buffer_load_dwordx4 v238, s[48:51], s69 offen offset:1024 sc1 lds
s_waitcnt lgkmcnt(10)
MV 100,a,192,a,248
ds_read2_b32 a[134:135], v40 offset0:194 offset1:195
s_waitcnt lgkmcnt(8)
MV 104,a,192,a,252
ds_read_b128 a[168:171], v5 offset:2816
MV 80,a,196,a,224
ds_read2_b32 a[136:137], v41 offset0:64 offset1:65
buffer_load_dwordx4 v238, s[48:51], s69 offen offset:2048 sc1 lds
MV 84,a,196,a,228
MV 88,a,196,a,232
ds_read2_b32 a[138:139], v41 offset0:66 offset1:67
MV 92,a,196,a,236
ds_read_b128 a[172:175], v5 offset:2304
buffer_load_dwordx4 v238, s[48:51], s69 offen offset:3072 sc1 lds
MV 96,a,196,a,240
ds_read2_b32 a[140:141], v41 offset0:192 offset1:193
s_lshl_b32 s36, s3, 26
MV 100,a,196,a,244
ds_read2_b32 a[142:143], v41 offset0:194 offset1:195
MV 104,a,196,a,248
s_add_u32 s69, s69, 16384
MV 84,a,200,a,224
ds_read_b128 a[176:179], v5 offset:1792
MV 88,a,200,a,228
ds_read2_b32 a[144:145], v42 offset0:64 offset1:65
MV 92,a,200,a,232
ds_read2_b32 a[146:147], v42 offset0:66 offset1:67
s_add_u32 m0, s70, 82944
MV 96,a,200,a,236
ds_read_b128 a[180:183], v5 offset:1280
MV 100,a,200,a,240
MV 104,a,200,a,244
ds_read2_b32 a[148:149], v42 offset0:192 offset1:193
buffer_load_dwordx4 v238, s[48:51], s69 offen offset:0 sc1 lds
MV 88,a,204,a,224
ds_read2_b32 a[150:151], v42 offset0:194 offset1:195
MV 92,a,204,a,228
ds_read_b128 a[184:187], v5 offset:768
MV 96,a,204,a,232
ds_read2_b32 a[152:153], v43 offset0:64 offset1:65
buffer_load_dwordx4 v238, s[48:51], s69 offen offset:1024 sc1 lds
MV 100,a,204,a,236
v_add_u32 v255, s36, v255
MV 104,a,204,a,240
ds_read2_b32 a[154:155], v43 offset0:66 offset1:67
MV 92,a,208,a,224
ds_read_b128 a[188:191], v5 offset:256
buffer_load_dwordx4 v238, s[48:51], s69 offen offset:2048 sc1 lds
MV 96,a,208,a,228
ds_read2_b32 a[156:157], v43 offset0:192 offset1:193
MV 100,a,208,a,232
ds_read2_b32 a[158:159], v43 offset0:194 offset1:195
MV 104,a,208,a,236
buffer_load_dwordx4 v238, s[48:51], s69 offen offset:3072 sc1 lds
MV 96,a,212,a,224
MV 100,a,212,a,228
MV 104,a,212,a,232
s_add_u32 s69, s69, 16384
MV 100,a,216,a,224
MV 104,a,216,a,228
s_waitcnt lgkmcnt(15)
MV 104,a,220,a,224
MV 76,a,128,a,160
ds_read_b128 a[224:227], v5 offset:3904
s_add_u32 m0, s70, 99328
MV 80,a,128,a,164
ds_read2_b32 a[192:193], v40 offset0:80 offset1:81
v_mul_u32_u24 v18, 136, v16
MV 84,a,128,a,168
ds_read2_b32 a[194:195], v40 offset0:82 offset1:83
v_lshl_add_u32 v18, v17, 5, v18
s_waitcnt lgkmcnt(15)
MV 88,a,128,a,172
ds_read_b128 a[228:231], v5 offset:3392
s_waitcnt lgkmcnt(15)
MV 92,a,128,a,176
s_waitcnt lgkmcnt(12)
MV 96,a,128,a,180
ds_read2_b32 a[196:197], v40 offset0:208 offset1:209
buffer_load_dwordx4 v238, s[48:51], s69 offen offset:0 sc1 lds
s_waitcnt lgkmcnt(10)
MV 100,a,128,a,184
ds_read2_b32 a[198:199], v40 offset0:210 offset1:211
s_lshl_b32 s37, s3, 1
s_waitcnt lgkmcnt(8)
MV 104,a,128,a,188
ds_read_b128 a[232:235], v5 offset:2880
s_add_u32 s37, s37, 49152
MV 80,a,132,a,160
ds_read2_b32 a[200:201], v41 offset0:80 offset1:81
MV 84,a,132,a,164
MV 88,a,132,a,168
ds_read2_b32 a[202:203], v41 offset0:82 offset1:83
v_add_u32 v11, s37, v18
MV 92,a,132,a,172
ds_read_b128 a[236:239], v5 offset:2368
buffer_load_dwordx4 v238, s[48:51], s69 offen offset:1024 sc1 lds
MV 96,a,132,a,176
ds_read2_b32 a[204:205], v41 offset0:208 offset1:209
v_lshrrev_b32 v18, 3, v1
MV 100,a,132,a,180
ds_read2_b32 a[206:207], v41 offset0:210 offset1:211
MV 104,a,132,a,184
MV 84,a,136,a,160
ds_read_b128 a[240:243], v5 offset:1856
v_mul_u32_u24 v18, 136, v18
MV 88,a,136,a,164
ds_read2_b32 a[208:209], v42 offset0:80 offset1:81
MV 92,a,136,a,168
ds_read2_b32 a[210:211], v42 offset0:82 offset1:83
buffer_load_dwordx4 v238, s[48:51], s69 offen offset:2048 sc1 lds
MV 96,a,136,a,172
ds_read_b128 a[244:247], v5 offset:1344
v_and_b32 v19, 7, v1
MV 100,a,136,a,176
MV 104,a,136,a,180
ds_read2_b32 a[212:213], v42 offset0:208 offset1:209
v_lshl_add_u32 v18, v19, 4, v18
MV 88,a,140,a,160
ds_read2_b32 a[214:215], v42 offset0:210 offset1:211
MV 92,a,140,a,164
ds_read_b128 a[248:251], v5 offset:832
s_mul_i32 s37, s3, 4352
MV 96,a,140,a,168
ds_read2_b32 a[216:217], v43 offset0:80 offset1:81
buffer_load_dwordx4 v238, s[48:51], s69 offen offset:3072 sc1 lds
MV 100,a,140,a,172
MV 104,a,140,a,176
ds_read2_b32 a[218:219], v43 offset0:82 offset1:83
s_add_u32 s37, s37, 49152
MV 92,a,144,a,160
ds_read_b128 a[252:255], v5 offset:320
MV 96,a,144,a,164
ds_read2_b32 a[220:221], v43 offset0:208 offset1:209
v_add_u32 v12, s37, v18
MV 100,a,144,a,168
ds_read2_b32 a[222:223], v43 offset0:210 offset1:211
MV 104,a,144,a,172
s_add_u32 s69, s69, 16384
MV 96,a,148,a,160
s_lshl_b32 s37, s3, 12
MV 100,a,148,a,164
MV 104,a,148,a,168
v_add_u32 v13, s37, v232
MV 100,a,152,a,160
MV 104,a,152,a,164
s_waitcnt lgkmcnt(15)
MV 104,a,156,a,160
buffer_load_dword v253, v252, s[8:11], 0 offen sc1
MV 76,a,192,a,224
ds_read_b128 a[160:163], v5 offset:3968
MV 80,a,192,a,228
ds_read2_b32 a[128:129], v40 offset0:96 offset1:97
MV 84,a,192,a,232
ds_read2_b32 a[130:131], v40 offset0:98 offset1:99
s_waitcnt lgkmcnt(15)
MV 88,a,192,a,236
ds_read_b128 a[164:167], v5 offset:3456
s_waitcnt lgkmcnt(15)
MV 92,a,192,a,240
s_waitcnt lgkmcnt(12)
MV 96,a,192,a,244
ds_read2_b32 a[132:133], v40 offset0:224 offset1:225
s_waitcnt lgkmcnt(10)
MV 100,a,192,a,248
ds_read2_b32 a[134:135], v40 offset0:226 offset1:227
s_waitcnt lgkmcnt(8)
MV 104,a,192,a,252
ds_read_b128 a[168:171], v5 offset:2944
MV 80,a,196,a,224
ds_read2_b32 a[136:137], v41 offset0:96 offset1:97
MV 84,a,196,a,228
MV 88,a,196,a,232
ds_read2_b32 a[138:139], v41 offset0:98 offset1:99
MV 92,a,196,a,236
ds_read_b128 a[172:175], v5 offset:2432
MV 96,a,196,a,240
ds_read2_b32 a[140:141], v41 offset0:224 offset1:225
MV 100,a,196,a,244
ds_read2_b32 a[142:143], v41 offset0:226 offset1:227
MV 104,a,196,a,248
MV 84,a,200,a,224
ds_read_b128 a[176:179], v5 offset:1920
MV 88,a,200,a,228
ds_read2_b32 a[144:145], v42 offset0:96 offset1:97
MV 92,a,200,a,232
ds_read2_b32 a[146:147], v42 offset0:98 offset1:99
MV 96,a,200,a,236
ds_read_b128 a[180:183], v5 offset:1408
MV 100,a,200,a,240
MV 104,a,200,a,244
ds_read2_b32 a[148:149], v42 offset0:224 offset1:225
MV 88,a,204,a,224
ds_read2_b32 a[150:151], v42 offset0:226 offset1:227
MV 92,a,204,a,228
ds_read_b128 a[184:187], v5 offset:896
MV 96,a,204,a,232
ds_read2_b32 a[152:153], v43 offset0:96 offset1:97
MV 100,a,204,a,236
MV 104,a,204,a,240
ds_read2_b32 a[154:155], v43 offset0:98 offset1:99
MV 92,a,208,a,224
ds_read_b128 a[188:191], v5 offset:384
MV 96,a,208,a,228
ds_read2_b32 a[156:157], v43 offset0:224 offset1:225
MV 100,a,208,a,232
ds_read2_b32 a[158:159], v43 offset0:226 offset1:227
MV 104,a,208,a,236
MV 96,a,212,a,224
MV 100,a,212,a,228
MV 104,a,212,a,232
MV 100,a,216,a,224
MV 104,a,216,a,228
s_waitcnt lgkmcnt(15)
MV 104,a,220,a,224
s_waitcnt vmcnt(0)
v_cmp_gt_u32 vcc, 1, v253
s_nop 4
s_cbranch_vccnz L_spin_f2
L_spin_f2_ret:
buffer_load_dwordx4 a[0:3], v236, s[44:47], s68 offen offset:0 sc1
buffer_load_dwordx4 a[4:7], v237, s[44:47], s68 offen offset:0 sc1
buffer_load_dwordx4 a[8:11], v236, s[44:47], s68 offen offset:1024 sc1
buffer_load_dwordx4 a[12:15], v237, s[44:47], s68 offen offset:1024 sc1
s_add_u32 s68, s68, 2048
MV 76,a,128,a,160
ds_read_b128 a[224:227], v5 offset:4032
buffer_load_dwordx4 a[16:19], v236, s[44:47], s68 offen offset:0 sc1
MV 80,a,128,a,164
ds_read2_b32 a[192:193], v40 offset0:112 offset1:113
MV 84,a,128,a,168
ds_read2_b32 a[194:195], v40 offset0:114 offset1:115
buffer_load_dwordx4 a[20:23], v237, s[44:47], s68 offen offset:0 sc1
s_waitcnt lgkmcnt(15)
MV 88,a,128,a,172
ds_read_b128 a[228:231], v5 offset:3520
s_waitcnt lgkmcnt(15)
MV 92,a,128,a,176
buffer_load_dwordx4 a[24:27], v236, s[44:47], s68 offen offset:1024 sc1
s_waitcnt lgkmcnt(12)
MV 96,a,128,a,180
ds_read2_b32 a[196:197], v40 offset0:240 offset1:241
s_waitcnt lgkmcnt(10)
MV 100,a,128,a,184
ds_read2_b32 a[198:199], v40 offset0:242 offset1:243
s_waitcnt lgkmcnt(8)
MV 104,a,128,a,188
ds_read_b128 a[232:235], v5 offset:3008
buffer_load_dwordx4 a[28:31], v237, s[44:47], s68 offen offset:1024 sc1
MV 80,a,132,a,160
ds_read2_b32 a[200:201], v41 offset0:112 offset1:113
MV 84,a,132,a,164
s_add_u32 s68, s68, 2048
MV 88,a,132,a,168
ds_read2_b32 a[202:203], v41 offset0:114 offset1:115
MV 92,a,132,a,172
ds_read_b128 a[236:239], v5 offset:2496
buffer_load_dwordx4 a[32:35], v236, s[44:47], s68 offen offset:0 sc1
MV 96,a,132,a,176
ds_read2_b32 a[204:205], v41 offset0:240 offset1:241
MV 100,a,132,a,180
ds_read2_b32 a[206:207], v41 offset0:242 offset1:243
MV 104,a,132,a,184
buffer_load_dwordx4 a[36:39], v237, s[44:47], s68 offen offset:0 sc1
MV 84,a,136,a,160
ds_read_b128 a[240:243], v5 offset:1984
MV 88,a,136,a,164
ds_read2_b32 a[208:209], v42 offset0:112 offset1:113
buffer_load_dwordx4 a[40:43], v236, s[44:47], s68 offen offset:1024 sc1
MV 92,a,136,a,168
ds_read2_b32 a[210:211], v42 offset0:114 offset1:115
MV 96,a,136,a,172
ds_read_b128 a[244:247], v5 offset:1472
buffer_load_dwordx4 a[44:47], v237, s[44:47], s68 offen offset:1024 sc1
MV 100,a,136,a,176
MV 104,a,136,a,180
ds_read2_b32 a[212:213], v42 offset0:240 offset1:241
MV 88,a,140,a,160
ds_read2_b32 a[214:215], v42 offset0:242 offset1:243
s_add_u32 s68, s68, 2048
MV 92,a,140,a,164
ds_read_b128 a[248:251], v5 offset:960
MV 96,a,140,a,168
ds_read2_b32 a[216:217], v43 offset0:112 offset1:113
buffer_load_dwordx4 a[48:51], v236, s[44:47], s68 offen offset:0 sc1
MV 100,a,140,a,172
MV 104,a,140,a,176
ds_read2_b32 a[218:219], v43 offset0:114 offset1:115
buffer_load_dwordx4 a[52:55], v237, s[44:47], s68 offen offset:0 sc1
MV 92,a,144,a,160
ds_read_b128 a[252:255], v5 offset:448
MV 96,a,144,a,164
ds_read2_b32 a[220:221], v43 offset0:240 offset1:241
MV 100,a,144,a,168
ds_read2_b32 a[222:223], v43 offset0:242 offset1:243
buffer_load_dwordx4 a[56:59], v236, s[44:47], s68 offen offset:1024 sc1
MV 104,a,144,a,172
MV 96,a,148,a,160
buffer_load_dwordx4 a[60:63], v237, s[44:47], s68 offen offset:1024 sc1
MV 100,a,148,a,164
MV 104,a,148,a,168
s_add_u32 s68, s68, 2048
MV 100,a,152,a,160
MV 104,a,152,a,164
s_waitcnt lgkmcnt(15)
MV 104,a,156,a,160
s_waitcnt lgkmcnt(0)
s_barrier
ds_read_b128 a[64:67], v242 offset:0
ds_read_b128 a[68:71], v242 offset:1024
ds_read_b128 a[72:75], v242 offset:2048
ds_read_b128 a[76:79], v242 offset:3072
ds_read_b128 a[80:83], v243 offset:0
ds_read_b128 a[84:87], v243 offset:1024
ds_read_b128 a[88:91], v243 offset:2048
ds_read_b128 a[92:95], v243 offset:3072
s_waitcnt lgkmcnt(0)
s_waitcnt vmcnt(15)
v_mfma_f32_16x16x32_bf16 v[124:127], a[64:67], a[0:3], 0
ds_read_b128 a[96:99], v242 offset:8192
MV 76,a,192,a,224
s_add_u32 m0, s70, 115712
s_waitcnt vmcnt(14)
v_mfma_f32_16x16x32_bf16 v[128:131], a[64:67], a[4:7], 0
ds_read_b128 a[100:103], v242 offset:9216
MV 80,a,192,a,228
v_mfma_f32_16x16x32_bf16 v[132:135], a[68:71], a[0:3], 0
MV 84,a,192,a,232
ds_read_b128 a[104:107], v242 offset:10240
v_mfma_f32_16x16x32_bf16 v[136:139], a[68:71], a[4:7], 0
v_mfma_f32_16x16x32_bf16 v[140:143], a[72:75], a[0:3], 0
ds_read_b128 a[108:111], v242 offset:11264
MV 88,a,192,a,236
v_mfma_f32_16x16x32_bf16 v[144:147], a[72:75], a[4:7], 0
buffer_load_dwordx4 v238, s[48:51], s69 offen offset:0 sc1 lds
MV 92,a,192,a,240
ds_read_b128 a[112:115], v243 offset:8192
v_mfma_f32_16x16x32_bf16 v[148:151], a[76:79], a[0:3], 0
MV 96,a,192,a,244
v_mfma_f32_16x16x32_bf16 v[152:155], a[76:79], a[4:7], 0
ds_read_b128 a[116:119], v243 offset:9216
v_mfma_f32_16x16x32_bf16 v[156:159], a[80:83], a[0:3], 0
MV 100,a,192,a,248
ds_read_b128 a[120:123], v243 offset:10240
v_mfma_f32_16x16x32_bf16 v[160:163], a[80:83], a[4:7], 0
MV 104,a,192,a,252
buffer_load_dwordx4 v238, s[48:51], s69 offen offset:1024 sc1 lds
v_mfma_f32_16x16x32_bf16 v[164:167], a[84:87], a[0:3], 0
ds_read_b128 a[124:127], v243 offset:11264
MV 80,a,196,a,224
v_mfma_f32_16x16x32_bf16 v[168:171], a[84:87], a[4:7], 0
v_mfma_f32_16x16x32_bf16 v[172:175], a[88:91], a[0:3], 0
MV 84,a,196,a,228
v_mfma_f32_16x16x32_bf16 v[176:179], a[88:91], a[4:7], 0
MV 88,a,196,a,232
v_mfma_f32_16x16x32_bf16 v[180:183], a[92:95], a[0:3], 0
buffer_load_dwordx4 a[0:3], v236, s[44:47], s68 offen offset:0 sc1
MV 92,a,196,a,236
v_mfma_f32_16x16x32_bf16 v[184:187], a[92:95], a[4:7], 0
buffer_load_dwordx4 a[4:7], v237, s[44:47], s68 offen offset:0 sc1
s_waitcnt lgkmcnt(0)
s_barrier
s_waitcnt vmcnt(17)
MV 124,a,96,a,8
ds_read_b128 a[64:67], v242 offset:16384
MV 96,a,196,a,240
buffer_load_dwordx4 v238, s[48:51], s69 offen offset:2048 sc1 lds
s_waitcnt vmcnt(17)
MV 128,a,96,a,12
ds_read_b128 a[68:71], v242 offset:17408
MV 100,a,196,a,244
MV 132,a,100,a,8
MV 104,a,196,a,248
ds_read_b128 a[72:75], v242 offset:18432
MV 136,a,100,a,12
MV 140,a,104,a,8
ds_read_b128 a[76:79], v242 offset:19456
MV 84,a,200,a,224
MV 144,a,104,a,12
buffer_load_dwordx4 v238, s[48:51], s69 offen offset:3072 sc1 lds
MV 88,a,200,a,228
ds_read_b128 a[80:83], v243 offset:16384
MV 148,a,108,a,8
MV 92,a,200,a,232
MV 152,a,108,a,12
ds_read_b128 a[84:87], v243 offset:17408
MV 156,a,112,a,8
MV 96,a,200,a,236
ds_read_b128 a[88:91], v243 offset:18432
MV 160,a,112,a,12
MV 100,a,200,a,240
s_add_u32 s69, s69, 16384
MV 164,a,116,a,8
ds_read_b128 a[92:95], v243 offset:19456
MV 104,a,200,a,244
MV 168,a,116,a,12
MV 172,a,120,a,8
MV 88,a,204,a,224
MV 176,a,120,a,12
MV 92,a,204,a,228
MV 180,a,124,a,8
buffer_load_dwordx4 a[8:11], v236, s[44:47], s68 offen offset:1024 sc1
MV 96,a,204,a,232
MV 184,a,124,a,12
buffer_load_dwordx4 a[12:15], v237, s[44:47], s68 offen offset:1024 sc1
s_add_u32 s68, s68, 2048
s_waitcnt lgkmcnt(0)
s_waitcnt vmcnt(19)
MV 124,a,64,a,16
ds_read_b128 a[96:99], v242 offset:24576
MV 100,a,204,a,236
s_add_u32 m0, s70, 66560
s_waitcnt vmcnt(18)
MV 128,a,64,a,20
ds_read_b128 a[100:103], v242 offset:25600
MV 104,a,204,a,240
MV 132,a,68,a,16
MV 92,a,208,a,224
ds_read_b128 a[104:107], v242 offset:26624
MV 136,a,68,a,20
MV 140,a,72,a,16
ds_read_b128 a[108:111], v242 offset:27648
MV 96,a,208,a,228
MV 144,a,72,a,20
buffer_load_dwordx4 v238, s[48:51], s69 offen offset:0 sc1 lds
MV 100,a,208,a,232
ds_read_b128 a[112:115], v243 offset:24576
MV 148,a,76,a,16
MV 104,a,208,a,236
MV 152,a,76,a,20
ds_read_b128 a[116:119], v243 offset:25600
MV 156,a,80,a,16
MV 96,a,212,a,224
ds_read_b128 a[120:123], v243 offset:26624
MV 160,a,80,a,20
MV 100,a,212,a,228
buffer_load_dwordx4 v238, s[48:51], s69 offen offset:1024 sc1 lds
MV 164,a,84,a,16
ds_read_b128 a[124:127], v243 offset:27648
MV 104,a,212,a,232
MV 168,a,84,a,20
MV 172,a,88,a,16
MV 100,a,216,a,224
MV 176,a,88,a,20
MV 104,a,216,a,228
MV 180,a,92,a,16
buffer_load_dwordx4 a[16:19], v236, s[44:47], s68 offen offset:0 sc1
MV 104,a,220,a,224
MV 184,a,92,a,20
buffer_load_dwordx4 a[20:23], v237, s[44:47], s68 offen offset:0 sc1
s_waitcnt lgkmcnt(0)
s_barrier
s_waitcnt vmcnt(21)
MV 124,a,96,a,24
ds_read_b128 a[64:67], v242 offset:32768
s_waitcnt vmcnt(20)
MV 128,a,96,a,28
ds_read_b128 a[68:71], v242 offset:33792
buffer_load_dwordx4 v238, s[48:51], s69 offen offset:2048 sc1 lds
MV 132,a,100,a,24
MV 136,a,100,a,28
ds_read_b128 a[72:75], v242 offset:34816
MV 140,a,104,a,24
ds_read_b128 a[76:79], v242 offset:35840
MV 144,a,104,a,28
buffer_load_dwordx4 v238, s[48:51], s69 offen offset:3072 sc1 lds
MV 148,a,108,a,24
ds_read_b128 a[80:83], v243 offset:32768
MV 152,a,108,a,28
ds_read_b128 a[84:87], v243 offset:33792
MV 156,a,112,a,24
MV 160,a,112,a,28
ds_read_b128 a[88:91], v243 offset:34816
s_add_u32 s69, s69, 16384
MV 164,a,116,a,24
ds_read_b128 a[92:95], v243 offset:35840
MV 168,a,116,a,28
MV 172,a,120,a,24
MV 176,a,120,a,28
MV 180,a,124,a,24
buffer_load_dwordx4 a[24:27], v236, s[44:47], s68 offen offset:1024 sc1
MV 184,a,124,a,28
buffer_load_dwordx4 a[28:31], v237, s[44:47], s68 offen offset:1024 sc1
s_add_u32 s68, s68, 2048
s_waitcnt lgkmcnt(0)
s_waitcnt vmcnt(23)
MV 124,a,64,a,32
ds_read_b128 a[96:99], v242 offset:40960
v_cvt_pk_bf16_f32 v16, v76, v77
s_waitcnt vmcnt(22)
MV 128,a,64,a,36
ds_read_b128 a[100:103], v242 offset:41984
s_add_u32 m0, s70, 82944
MV 132,a,68,a,32
v_cvt_pk_bf16_f32 v17, v78, v79
MV 136,a,68,a,36
ds_read_b128 a[104:107], v242 offset:43008
ds_write_b16 v11, v16 offset:0
MV 140,a,72,a,32
ds_read_b128 a[108:111], v242 offset:44032
MV 144,a,72,a,36
buffer_load_dwordx4 v238, s[48:51], s69 offen offset:0 sc1 lds
ds_write_b16_d16_hi v11, v16 offset:8
MV 148,a,76,a,32
ds_read_b128 a[112:115], v243 offset:40960
MV 152,a,76,a,36
ds_read_b128 a[116:119], v243 offset:41984
ds_write_b16 v11, v17 offset:16
MV 156,a,80,a,32
ds_write_b16_d16_hi v11, v17 offset:24
MV 160,a,80,a,36
ds_read_b128 a[120:123], v243 offset:43008
buffer_load_dwordx4 v238, s[48:51], s69 offen offset:1024 sc1 lds
MV 164,a,84,a,32
ds_read_b128 a[124:127], v243 offset:44032
v_cvt_pk_bf16_f32 v18, v80, v81
MV 168,a,84,a,36
MV 172,a,88,a,32
v_cvt_pk_bf16_f32 v19, v82, v83
MV 176,a,88,a,36
MV 180,a,92,a,32
buffer_load_dwordx4 a[32:35], v236, s[44:47], s68 offen offset:0 sc1
ds_write_b16 v11, v18 offset:2176
MV 184,a,92,a,36
buffer_load_dwordx4 a[36:39], v237, s[44:47], s68 offen offset:0 sc1
s_waitcnt vmcnt(14) lgkmcnt(0)
s_barrier
MV 124,a,96,a,40
ds_read_b128 a[64:67], v242 offset:49152
ds_write_b16_d16_hi v11, v18 offset:2184
MV 128,a,96,a,44
ds_read_b128 a[68:71], v242 offset:50176
buffer_load_dwordx4 v238, s[48:51], s69 offen offset:2048 sc1 lds
MV 132,a,100,a,40
ds_write_b16 v11, v19 offset:2192
MV 136,a,100,a,44
ds_read_b128 a[72:75], v242 offset:51200
ds_write_b16_d16_hi v11, v19 offset:2200
MV 140,a,104,a,40
ds_read_b128 a[76:79], v242 offset:52224
v_cvt_pk_bf16_f32 v16, v84, v85
MV 144,a,104,a,44
buffer_load_dwordx4 v238, s[48:51], s69 offen offset:3072 sc1 lds
MV 148,a,108,a,40
ds_read_b128 a[80:83], v243 offset:49152
v_cvt_pk_bf16_f32 v17, v86, v87
MV 152,a,108,a,44
ds_read_b128 a[84:87], v243 offset:50176
MV 156,a,112,a,40
ds_write_b16 v11, v16 offset:4352
MV 160,a,112,a,44
ds_read_b128 a[88:91], v243 offset:51200
s_add_u32 s69, s69, 16384
MV 164,a,116,a,40
ds_read_b128 a[92:95], v243 offset:52224
ds_write_b16_d16_hi v11, v16 offset:4360
MV 168,a,116,a,44
ds_write_b16 v11, v17 offset:4368
MV 172,a,120,a,40
ds_write_b16_d16_hi v11, v17 offset:4376
MV 176,a,120,a,44
MV 180,a,124,a,40
buffer_load_dwordx4 a[40:43], v236, s[44:47], s68 offen offset:1024 sc1
v_cvt_pk_bf16_f32 v18, v88, v89
MV 184,a,124,a,44
buffer_load_dwordx4 a[44:47], v237, s[44:47], s68 offen offset:1024 sc1
s_add_u32 s68, s68, 2048
s_waitcnt lgkmcnt(0)
MV 124,a,64,a,48
ds_read_b128 a[96:99], v242 offset:57344
v_cvt_pk_bf16_f32 v19, v90, v91
MV 128,a,64,a,52
ds_read_b128 a[100:103], v242 offset:58368
s_add_u32 m0, s70, 99328
MV 132,a,68,a,48
ds_write_b16 v11, v18 offset:6528
MV 136,a,68,a,52
ds_read_b128 a[104:107], v242 offset:59392
ds_write_b16_d16_hi v11, v18 offset:6536
MV 140,a,72,a,48
ds_read_b128 a[108:111], v242 offset:60416
MV 144,a,72,a,52
buffer_load_dwordx4 v238, s[48:51], s69 offen offset:0 sc1 lds
ds_write_b16 v11, v19 offset:6544
MV 148,a,76,a,48
ds_read_b128 a[112:115], v243 offset:57344
MV 152,a,76,a,52
ds_read_b128 a[116:119], v243 offset:58368
ds_write_b16_d16_hi v11, v19 offset:6552
MV 156,a,80,a,48
v_cvt_pk_bf16_f32 v16, v92, v93
MV 160,a,80,a,52
ds_read_b128 a[120:123], v243 offset:59392
buffer_load_dwordx4 v238, s[48:51], s69 offen offset:1024 sc1 lds
MV 164,a,84,a,48
ds_read_b128 a[124:127], v243 offset:60416
v_cvt_pk_bf16_f32 v17, v94, v95
MV 168,a,84,a,52
MV 172,a,88,a,48
ds_write_b16 v11, v16 offset:8704
MV 176,a,88,a,52
MV 180,a,92,a,48
buffer_load_dwordx4 a[48:51], v236, s[44:47], s68 offen offset:0 sc1
ds_write_b16_d16_hi v11, v16 offset:8712
MV 184,a,92,a,52
buffer_load_dwordx4 a[52:55], v237, s[44:47], s68 offen offset:0 sc1
s_waitcnt vmcnt(14) lgkmcnt(0)
s_barrier
MV 124,a,96,a,56
ds_read_b128 a[64:67], v242 offset:0
ds_write_b16 v11, v17 offset:8720
MV 128,a,96,a,60
ds_read_b128 a[68:71], v242 offset:1024
buffer_load_dwordx4 v238, s[48:51], s69 offen offset:2048 sc1 lds
MV 132,a,100,a,56
ds_write_b16_d16_hi v11, v17 offset:8728
MV 136,a,100,a,60
ds_read_b128 a[72:75], v242 offset:2048
v_cvt_pk_bf16_f32 v18, v96, v97
MV 140,a,104,a,56
ds_read_b128 a[76:79], v242 offset:3072
v_cvt_pk_bf16_f32 v19, v98, v99
MV 144,a,104,a,60
buffer_load_dwordx4 v238, s[48:51], s69 offen offset:3072 sc1 lds
MV 148,a,108,a,56
ds_read_b128 a[80:83], v243 offset:0
ds_write_b16 v11, v18 offset:10880
MV 152,a,108,a,60
ds_read_b128 a[84:87], v243 offset:1024
MV 156,a,112,a,56
ds_write_b16_d16_hi v11, v18 offset:10888
MV 160,a,112,a,60
ds_read_b128 a[88:91], v243 offset:2048
s_add_u32 s69, s69, 16384
MV 164,a,116,a,56
ds_read_b128 a[92:95], v243 offset:3072
ds_write_b16 v11, v19 offset:10896
MV 168,a,116,a,60
ds_write_b16_d16_hi v11, v19 offset:10904
MV 172,a,120,a,56
v_cvt_pk_bf16_f32 v16, v100, v101
MV 176,a,120,a,60
MV 180,a,124,a,56
buffer_load_dwordx4 a[56:59], v236, s[44:47], s68 offen offset:1024 sc1
v_cvt_pk_bf16_f32 v17, v102, v103
MV 184,a,124,a,60
buffer_load_dwordx4 a[60:63], v237, s[44:47], s68 offen offset:1024 sc1
s_add_u32 s68, s68, 2048
s_waitcnt lgkmcnt(0)
MV 124,a,64,a,0
ds_read_b128 a[96:99], v242 offset:8192
ds_write_b16 v11, v16 offset:13056
MV 128,a,64,a,4
ds_read_b128 a[100:103], v242 offset:9216
s_add_u32 m0, s70, 115712
MV 132,a,68,a,0
ds_write_b16_d16_hi v11, v16 offset:13064
MV 136,a,68,a,4
ds_read_b128 a[104:107], v242 offset:10240
ds_write_b16 v11, v17 offset:13072
MV 140,a,72,a,0
ds_read_b128 a[108:111], v242 offset:11264
ds_write_b16_d16_hi v11, v17 offset:13080
MV 144,a,72,a,4
buffer_load_dwordx4 v238, s[48:51], s69 offen offset:0 sc1 lds
MV 148,a,76,a,0
ds_read_b128 a[112:115], v243 offset:8192
v_cvt_pk_bf16_f32 v18, v104, v105
MV 152,a,76,a,4
ds_read_b128 a[116:119], v243 offset:9216
MV 156,a,80,a,0
v_cvt_pk_bf16_f32 v19, v106, v107
MV 160,a,80,a,4
ds_read_b128 a[120:123], v243 offset:10240
buffer_load_dwordx4 v238, s[48:51], s69 offen offset:1024 sc1 lds
MV 164,a,84,a,0
ds_read_b128 a[124:127], v243 offset:11264
ds_write_b16 v11, v18 offset:15232
MV 168,a,84,a,4
ds_write_b16_d16_hi v11, v18 offset:15240
MV 172,a,88,a,0
ds_write_b16 v11, v19 offset:15248
MV 176,a,88,a,4
MV 180,a,92,a,0
buffer_load_dwordx4 a[0:3], v236, s[44:47], s68 offen offset:0 sc1
ds_write_b16_d16_hi v11, v19 offset:15256
MV 184,a,92,a,4
buffer_load_dwordx4 a[4:7], v237, s[44:47], s68 offen offset:0 sc1
s_waitcnt vmcnt(14) lgkmcnt(0)
s_barrier
MV 124,a,96,a,8
ds_read_b128 a[64:67], v242 offset:16384
ds_read_b64 v[108:109], v12 offset:0
MV 128,a,96,a,12
ds_read_b128 a[68:71], v242 offset:17408
buffer_load_dwordx4 v238, s[48:51], s69 offen offset:2048 sc1 lds
MV 132,a,100,a,8
ds_read_b64 v[110:111], v12 offset:8
MV 136,a,100,a,12
ds_read_b128 a[72:75], v242 offset:18432
MV 140,a,104,a,8
ds_read_b128 a[76:79], v242 offset:19456
ds_read_b64 v[112:113], v12 offset:1088
MV 144,a,104,a,12
buffer_load_dwordx4 v238, s[48:51], s69 offen offset:3072 sc1 lds
MV 148,a,108,a,8
ds_read_b128 a[80:83], v243 offset:16384
ds_read_b64 v[114:115], v12 offset:1096
MV 152,a,108,a,12
ds_read_b128 a[84:87], v243 offset:17408
MV 156,a,112,a,8
ds_read_b64 v[116:117], v12 offset:2176
MV 160,a,112,a,12
ds_read_b128 a[88:91], v243 offset:18432
s_add_u32 s69, s69, 16384
MV 164,a,116,a,8
ds_read_b128 a[92:95], v243 offset:19456
ds_read_b64 v[118:119], v12 offset:2184
MV 168,a,116,a,12
MV 172,a,120,a,8
ds_read_b64 v[120:121], v12 offset:3264
MV 176,a,120,a,12
MV 180,a,124,a,8
buffer_load_dwordx4 a[8:11], v236, s[44:47], s68 offen offset:1024 sc1
ds_read_b64 v[122:123], v12 offset:3272
MV 184,a,124,a,12
buffer_load_dwordx4 a[12:15], v237, s[44:47], s68 offen offset:1024 sc1
s_add_u32 s68, s68, 2048
s_waitcnt lgkmcnt(0)
MV 124,a,64,a,16
ds_read_b128 a[96:99], v242 offset:24576
buffer_store_dwordx4 v[108:111], v13, s[24:27], 0 offen offset:0 sc1
MV 128,a,64,a,20
ds_read_b128 a[100:103], v242 offset:25600
s_add_u32 m0, s70, 66560
MV 132,a,68,a,16
MV 136,a,68,a,20
ds_read_b128 a[104:107], v242 offset:26624
MV 140,a,72,a,16
ds_read_b128 a[108:111], v242 offset:27648
MV 144,a,72,a,20
buffer_load_dwordx4 v238, s[48:51], s69 offen offset:0 sc1 lds
MV 148,a,76,a,16
ds_read_b128 a[112:115], v243 offset:24576
MV 152,a,76,a,20
ds_read_b128 a[116:119], v243 offset:25600
MV 156,a,80,a,16
buffer_store_dwordx4 v[112:115], v13, s[24:27], 0 offen offset:1024 sc1
MV 160,a,80,a,20
ds_read_b128 a[120:123], v243 offset:26624
buffer_load_dwordx4 v238, s[48:51], s69 offen offset:1024 sc1 lds
MV 164,a,84,a,16
ds_read_b128 a[124:127], v243 offset:27648
MV 168,a,84,a,20
MV 172,a,88,a,16
MV 176,a,88,a,20
MV 180,a,92,a,16
buffer_load_dwordx4 a[16:19], v236, s[44:47], s68 offen offset:0 sc1
MV 184,a,92,a,20
buffer_load_dwordx4 a[20:23], v237, s[44:47], s68 offen offset:0 sc1
s_waitcnt vmcnt(16) lgkmcnt(0)
s_barrier
MV 124,a,96,a,24
ds_read_b128 a[64:67], v242 offset:32768
buffer_store_dwordx4 v[116:119], v13, s[24:27], 0 offen offset:2048 sc1
MV 128,a,96,a,28
ds_read_b128 a[68:71], v242 offset:33792
buffer_load_dwordx4 v238, s[48:51], s69 offen offset:2048 sc1 lds
MV 132,a,100,a,24
MV 136,a,100,a,28
ds_read_b128 a[72:75], v242 offset:34816
MV 140,a,104,a,24
ds_read_b128 a[76:79], v242 offset:35840
MV 144,a,104,a,28
buffer_load_dwordx4 v238, s[48:51], s69 offen offset:3072 sc1 lds
MV 148,a,108,a,24
ds_read_b128 a[80:83], v243 offset:32768
MV 152,a,108,a,28
ds_read_b128 a[84:87], v243 offset:33792
MV 156,a,112,a,24
buffer_store_dwordx4 v[120:123], v13, s[24:27], 0 offen offset:3072 sc1
MV 160,a,112,a,28
ds_read_b128 a[88:91], v243 offset:34816
s_add_u32 s69, s69, 16384
MV 164,a,116,a,24
ds_read_b128 a[92:95], v243 offset:35840
MV 168,a,116,a,28
MV 172,a,120,a,24
MV 176,a,120,a,28
MV 180,a,124,a,24
buffer_load_dwordx4 a[24:27], v236, s[44:47], s68 offen offset:1024 sc1
MV 184,a,124,a,28
buffer_load_dwordx4 a[28:31], v237, s[44:47], s68 offen offset:1024 sc1
s_add_u32 s68, s68, 2048
s_mov_b32 s71, 3
.p2align 5
L_p5_loop:
s_waitcnt lgkmcnt(0)
MV 124,a,64,a,32
ds_read_b128 a[96:99], v242 offset:40960
MV 128,a,64,a,36
ds_read_b128 a[100:103], v242 offset:41984
s_add_u32 m0, s70, 82944
MV 132,a,68,a,32
MV 136,a,68,a,36
ds_read_b128 a[104:107], v242 offset:43008
MV 140,a,72,a,32
ds_read_b128 a[108:111], v242 offset:44032
MV 144,a,72,a,36
buffer_load_dwordx4 v238, s[48:51], s69 offen offset:0 sc1 lds
MV 148,a,76,a,32
ds_read_b128 a[112:115], v243 offset:40960
MV 152,a,76,a,36
ds_read_b128 a[116:119], v243 offset:41984
MV 156,a,80,a,32
MV 160,a,80,a,36
ds_read_b128 a[120:123], v243 offset:43008
buffer_load_dwordx4 v238, s[48:51], s69 offen offset:1024 sc1 lds
MV 164,a,84,a,32
ds_read_b128 a[124:127], v243 offset:44032
MV 168,a,84,a,36
MV 172,a,88,a,32
MV 176,a,88,a,36
MV 180,a,92,a,32
buffer_load_dwordx4 a[32:35], v236, s[44:47], s68 offen offset:0 sc1
MV 184,a,92,a,36
buffer_load_dwordx4 a[36:39], v237, s[44:47], s68 offen offset:0 sc1
s_waitcnt vmcnt(14) lgkmcnt(0)
s_barrier
MV 124,a,96,a,40
ds_read_b128 a[64:67], v242 offset:49152
MV 128,a,96,a,44
ds_read_b128 a[68:71], v242 offset:50176
buffer_load_dwordx4 v238, s[48:51], s69 offen offset:2048 sc1 lds
MV 132,a,100,a,40
MV 136,a,100,a,44
ds_read_b128 a[72:75], v242 offset:51200
MV 140,a,104,a,40
ds_read_b128 a[76:79], v242 offset:52224
MV 144,a,104,a,44
buffer_load_dwordx4 v238, s[48:51], s69 offen offset:3072 sc1 lds
MV 148,a,108,a,40
ds_read_b128 a[80:83], v243 offset:49152
MV 152,a,108,a,44
ds_read_b128 a[84:87], v243 offset:50176
MV 156,a,112,a,40
MV 160,a,112,a,44
ds_read_b128 a[88:91], v243 offset:51200
s_add_u32 s69, s69, 16384
MV 164,a,116,a,40
ds_read_b128 a[92:95], v243 offset:52224
MV 168,a,116,a,44
MV 172,a,120,a,40
MV 176,a,120,a,44
MV 180,a,124,a,40
buffer_load_dwordx4 a[40:43], v236, s[44:47], s68 offen offset:1024 sc1
MV 184,a,124,a,44
buffer_load_dwordx4 a[44:47], v237, s[44:47], s68 offen offset:1024 sc1
s_add_u32 s68, s68, 2048
s_waitcnt lgkmcnt(0)
MV 124,a,64,a,48
ds_read_b128 a[96:99], v242 offset:57344
MV 128,a,64,a,52
ds_read_b128 a[100:103], v242 offset:58368
s_add_u32 m0, s70, 99328
MV 132,a,68,a,48
MV 136,a,68,a,52
ds_read_b128 a[104:107], v242 offset:59392
MV 140,a,72,a,48
ds_read_b128 a[108:111], v242 offset:60416
MV 144,a,72,a,52
buffer_load_dwordx4 v238, s[48:51], s69 offen offset:0 sc1 lds
MV 148,a,76,a,48
ds_read_b128 a[112:115], v243 offset:57344
MV 152,a,76,a,52
ds_read_b128 a[116:119], v243 offset:58368
MV 156,a,80,a,48
MV 160,a,80,a,52
ds_read_b128 a[120:123], v243 offset:59392
buffer_load_dwordx4 v238, s[48:51], s69 offen offset:1024 sc1 lds
MV 164,a,84,a,48
ds_read_b128 a[124:127], v243 offset:60416
MV 168,a,84,a,52
MV 172,a,88,a,48
MV 176,a,88,a,52
MV 180,a,92,a,48
buffer_load_dwordx4 a[48:51], v236, s[44:47], s68 offen offset:0 sc1
MV 184,a,92,a,52
buffer_load_dwordx4 a[52:55], v237, s[44:47], s68 offen offset:0 sc1
s_waitcnt vmcnt(14) lgkmcnt(0)
s_barrier
MV 124,a,96,a,56
ds_read_b128 a[64:67], v242 offset:0
MV 128,a,96,a,60
ds_read_b128 a[68:71], v242 offset:1024
buffer_load_dwordx4 v238, s[48:51], s69 offen offset:2048 sc1 lds
MV 132,a,100,a,56
MV 136,a,100,a,60
ds_read_b128 a[72:75], v242 offset:2048
MV 140,a,104,a,56
ds_read_b128 a[76:79], v242 offset:3072
MV 144,a,104,a,60
buffer_load_dwordx4 v238, s[48:51], s69 offen offset:3072 sc1 lds
MV 148,a,108,a,56
ds_read_b128 a[80:83], v243 offset:0
MV 152,a,108,a,60
ds_read_b128 a[84:87], v243 offset:1024
MV 156,a,112,a,56
MV 160,a,112,a,60
ds_read_b128 a[88:91], v243 offset:2048
s_add_u32 s69, s69, 16384
MV 164,a,116,a,56
ds_read_b128 a[92:95], v243 offset:3072
MV 168,a,116,a,60
MV 172,a,120,a,56
MV 176,a,120,a,60
MV 180,a,124,a,56
buffer_load_dwordx4 a[56:59], v236, s[44:47], s68 offen offset:1024 sc1
MV 184,a,124,a,60
buffer_load_dwordx4 a[60:63], v237, s[44:47], s68 offen offset:1024 sc1
s_add_u32 s68, s68, 2048
s_waitcnt lgkmcnt(0)
MV 124,a,64,a,0
ds_read_b128 a[96:99], v242 offset:8192
MV 128,a,64,a,4
ds_read_b128 a[100:103], v242 offset:9216
s_add_u32 m0, s70, 115712
MV 132,a,68,a,0
MV 136,a,68,a,4
ds_read_b128 a[104:107], v242 offset:10240
MV 140,a,72,a,0
ds_read_b128 a[108:111], v242 offset:11264
MV 144,a,72,a,4
buffer_load_dwordx4 v238, s[48:51], s69 offen offset:0 sc1 lds
MV 148,a,76,a,0
ds_read_b128 a[112:115], v243 offset:8192
MV 152,a,76,a,4
ds_read_b128 a[116:119], v243 offset:9216
MV 156,a,80,a,0
MV 160,a,80,a,4
ds_read_b128 a[120:123], v243 offset:10240
buffer_load_dwordx4 v238, s[48:51], s69 offen offset:1024 sc1 lds
MV 164,a,84,a,0
ds_read_b128 a[124:127], v243 offset:11264
MV 168,a,84,a,4
MV 172,a,88,a,0
MV 176,a,88,a,4
MV 180,a,92,a,0
buffer_load_dwordx4 a[0:3], v236, s[44:47], s68 offen offset:0 sc1
MV 184,a,92,a,4
buffer_load_dwordx4 a[4:7], v237, s[44:47], s68 offen offset:0 sc1
s_waitcnt vmcnt(14) lgkmcnt(0)
s_barrier
MV 124,a,96,a,8
ds_read_b128 a[64:67], v242 offset:16384
MV 128,a,96,a,12
ds_read_b128 a[68:71], v242 offset:17408
buffer_load_dwordx4 v238, s[48:51], s69 offen offset:2048 sc1 lds
MV 132,a,100,a,8
MV 136,a,100,a,12
ds_read_b128 a[72:75], v242 offset:18432
MV 140,a,104,a,8
ds_read_b128 a[76:79], v242 offset:19456
MV 144,a,104,a,12
buffer_load_dwordx4 v238, s[48:51], s69 offen offset:3072 sc1 lds
MV 148,a,108,a,8
ds_read_b128 a[80:83], v243 offset:16384
MV 152,a,108,a,12
ds_read_b128 a[84:87], v243 offset:17408
MV 156,a,112,a,8
MV 160,a,112,a,12
ds_read_b128 a[88:91], v243 offset:18432
s_add_u32 s69, s69, 16384
MV 164,a,116,a,8
ds_read_b128 a[92:95], v243 offset:19456
MV 168,a,116,a,12
MV 172,a,120,a,8
MV 176,a,120,a,12
MV 180,a,124,a,8
buffer_load_dwordx4 a[8:11], v236, s[44:47], s68 offen offset:1024 sc1
MV 184,a,124,a,12
buffer_load_dwordx4 a[12:15], v237, s[44:47], s68 offen offset:1024 sc1
s_add_u32 s68, s68, 2048
s_waitcnt lgkmcnt(0)
MV 124,a,64,a,16
ds_read_b128 a[96:99], v242 offset:24576
MV 128,a,64,a,20
ds_read_b128 a[100:103], v242 offset:25600
s_add_u32 m0, s70, 66560
MV 132,a,68,a,16
MV 136,a,68,a,20
ds_read_b128 a[104:107], v242 offset:26624
MV 140,a,72,a,16
ds_read_b128 a[108:111], v242 offset:27648
MV 144,a,72,a,20
buffer_load_dwordx4 v238, s[48:51], s69 offen offset:0 sc1 lds
MV 148,a,76,a,16
ds_read_b128 a[112:115], v243 offset:24576
MV 152,a,76,a,20
ds_read_b128 a[116:119], v243 offset:25600
MV 156,a,80,a,16
MV 160,a,80,a,20
ds_read_b128 a[120:123], v243 offset:26624
buffer_load_dwordx4 v238, s[48:51], s69 offen offset:1024 sc1 lds
MV 164,a,84,a,16
ds_read_b128 a[124:127], v243 offset:27648
MV 168,a,84,a,20
MV 172,a,88,a,16
MV 176,a,88,a,20
MV 180,a,92,a,16
buffer_load_dwordx4 a[16:19], v236, s[44:47], s68 offen offset:0 sc1
MV 184,a,92,a,20
buffer_load_dwordx4 a[20:23], v237, s[44:47], s68 offen offset:0 sc1
s_waitcnt vmcnt(14) lgkmcnt(0)
s_barrier
MV 124,a,96,a,24
ds_read_b128 a[64:67], v242 offset:32768
MV 128,a,96,a,28
ds_read_b128 a[68:71], v242 offset:33792
buffer_load_dwordx4 v238, s[48:51], s69 offen offset:2048 sc1 lds
MV 132,a,100,a,24
MV 136,a,100,a,28
ds_read_b128 a[72:75], v242 offset:34816
MV 140,a,104,a,24
ds_read_b128 a[76:79], v242 offset:35840
MV 144,a,104,a,28
buffer_load_dwordx4 v238, s[48:51], s69 offen offset:3072 sc1 lds
MV 148,a,108,a,24
ds_read_b128 a[80:83], v243 offset:32768
MV 152,a,108,a,28
ds_read_b128 a[84:87], v243 offset:33792
MV 156,a,112,a,24
MV 160,a,112,a,28
ds_read_b128 a[88:91], v243 offset:34816
s_add_u32 s69, s69, 16384
MV 164,a,116,a,24
ds_read_b128 a[92:95], v243 offset:35840
MV 168,a,116,a,28
MV 172,a,120,a,24
MV 176,a,120,a,28
MV 180,a,124,a,24
buffer_load_dwordx4 a[24:27], v236, s[44:47], s68 offen offset:1024 sc1
MV 184,a,124,a,28
buffer_load_dwordx4 a[28:31], v237, s[44:47], s68 offen offset:1024 sc1
s_add_u32 s68, s68, 2048
s_sub_u32 s71, s71, 1
s_cbranch_scc1 L_p5_out
s_cmp_eq_u32 s71, 2
s_cbranch_scc1 L_p5_x1
s_cmp_eq_u32 s71, 0
s_cbranch_scc1 L_p5_x2
s_branch L_p5_loop
L_p5_out:
s_waitcnt lgkmcnt(0)
MV 124,a,64,a,32
ds_read_b128 a[96:99], v242 offset:40960
MV 128,a,64,a,36
ds_read_b128 a[100:103], v242 offset:41984
s_add_u32 m0, s70, 82944
MV 132,a,68,a,32
v_cmp_gt_u32 vcc, 1, v253
s_nop 4
s_cbranch_vccnz L_spin_f3
L_spin_f3_ret:
MV 136,a,68,a,36
ds_read_b128 a[104:107], v242 offset:43008
MV 140,a,72,a,32
ds_read_b128 a[108:111], v242 offset:44032
MV 144,a,72,a,36
buffer_load_dwordx4 v238, s[48:51], s69 offen offset:0 sc1 lds
MV 148,a,76,a,32
ds_read_b128 a[112:115], v243 offset:40960
MV 152,a,76,a,36
ds_read_b128 a[116:119], v243 offset:41984
MV 156,a,80,a,32
MV 160,a,80,a,36
ds_read_b128 a[120:123], v243 offset:43008
buffer_load_dwordx4 v238, s[48:51], s69 offen offset:1024 sc1 lds
MV 164,a,84,a,32
ds_read_b128 a[124:127], v243 offset:44032
MV 168,a,84,a,36
MV 172,a,88,a,32
s_add_u32 s72, s79, 0
MV 176,a,88,a,36
MV 180,a,92,a,32
buffer_load_dwordx4 a[32:35], v236, s[44:47], s68 offen offset:0 sc1
buffer_load_dwordx2 v[208:209], v251, s[56:59], s72 offen offset:0 sc1
MV 184,a,92,a,36
buffer_load_dwordx4 a[36:39], v237, s[44:47], s68 offen offset:0 sc1
s_waitcnt vmcnt(15) lgkmcnt(0)
s_barrier
MV 124,a,96,a,40
ds_read_b128 a[64:67], v242 offset:49152
s_add_u32 s72, s79, 16384
MV 128,a,96,a,44
ds_read_b128 a[68:71], v242 offset:50176
buffer_load_dwordx4 v238, s[48:51], s69 offen offset:2048 sc1 lds
MV 132,a,100,a,40
MV 136,a,100,a,44
ds_read_b128 a[72:75], v242 offset:51200
MV 140,a,104,a,40
ds_read_b128 a[76:79], v242 offset:52224
MV 144,a,104,a,44
buffer_load_dwordx4 v238, s[48:51], s69 offen offset:3072 sc1 lds
MV 148,a,108,a,40
ds_read_b128 a[80:83], v243 offset:49152
MV 152,a,108,a,44
ds_read_b128 a[84:87], v243 offset:50176
MV 156,a,112,a,40
buffer_load_dwordx2 v[210:211], v251, s[56:59], s72 offen offset:0 sc1
MV 160,a,112,a,44
ds_read_b128 a[88:91], v243 offset:51200
s_add_u32 s69, s69, 16384
MV 164,a,116,a,40
ds_read_b128 a[92:95], v243 offset:52224
MV 168,a,116,a,44
MV 172,a,120,a,40
MV 176,a,120,a,44
MV 180,a,124,a,40
buffer_load_dwordx4 a[40:43], v236, s[44:47], s68 offen offset:1024 sc1
MV 184,a,124,a,44
buffer_load_dwordx4 a[44:47], v237, s[44:47], s68 offen offset:1024 sc1
s_add_u32 s68, s68, 2048
s_waitcnt lgkmcnt(0)
MV 124,a,64,a,48
ds_read_b128 a[96:99], v242 offset:57344
s_add_u32 s72, s79, 131072
MV 128,a,64,a,52
ds_read_b128 a[100:103], v242 offset:58368
s_add_u32 m0, s70, 99328
MV 132,a,68,a,48
MV 136,a,68,a,52
ds_read_b128 a[104:107], v242 offset:59392
MV 140,a,72,a,48
ds_read_b128 a[108:111], v242 offset:60416
buffer_load_dwordx2 v[212:213], v251, s[56:59], s72 offen offset:0 sc1
MV 144,a,72,a,52
buffer_load_dwordx4 v238, s[48:51], s69 offen offset:0 sc1 lds
MV 148,a,76,a,48
ds_read_b128 a[112:115], v243 offset:57344
MV 152,a,76,a,52
ds_read_b128 a[116:119], v243 offset:58368
MV 156,a,80,a,48
s_add_u32 s72, s79, 147456
MV 160,a,80,a,52
ds_read_b128 a[120:123], v243 offset:59392
buffer_load_dwordx4 v238, s[48:51], s69 offen offset:1024 sc1 lds
MV 164,a,84,a,48
ds_read_b128 a[124:127], v243 offset:60416
MV 168,a,84,a,52
MV 172,a,88,a,48
buffer_load_dwordx2 v[214:215], v251, s[56:59], s72 offen offset:0 sc1
MV 176,a,88,a,52
MV 180,a,92,a,48
buffer_load_dwordx4 a[48:51], v236, s[44:47], s68 offen offset:0 sc1
MV 184,a,92,a,52
buffer_load_dwordx4 a[52:55], v237, s[44:47], s68 offen offset:0 sc1
s_waitcnt vmcnt(18) lgkmcnt(0)
s_barrier
MV 124,a,96,a,56
ds_read_b128 a[64:67], v242 offset:0
s_add_u32 s72, s79, 0
MV 128,a,96,a,60
ds_read_b128 a[68:71], v242 offset:1024
buffer_load_dwordx4 v238, s[48:51], s69 offen offset:2048 sc1 lds
MV 132,a,100,a,56
MV 136,a,100,a,60
ds_read_b128 a[72:75], v242 offset:2048
MV 140,a,104,a,56
ds_read_b128 a[76:79], v242 offset:3072
MV 144,a,104,a,60
buffer_load_dwordx4 v238, s[48:51], s69 offen offset:3072 sc1 lds
MV 148,a,108,a,56
ds_read_b128 a[80:83], v243 offset:0
MV 152,a,108,a,60
ds_read_b128 a[84:87], v243 offset:1024
MV 156,a,112,a,56
buffer_load_dwordx2 v[216:217], v251, s[56:59], s72 offen offset:128 sc1
MV 160,a,112,a,60
ds_read_b128 a[88:91], v243 offset:2048
s_add_u32 s69, s69, 16384
MV 164,a,116,a,56
ds_read_b128 a[92:95], v243 offset:3072
MV 168,a,116,a,60
MV 172,a,120,a,56
MV 176,a,120,a,60
MV 180,a,124,a,56
buffer_load_dwordx4 a[56:59], v236, s[44:47], s68 offen offset:1024 sc1
MV 184,a,124,a,60
buffer_load_dwordx4 a[60:63], v237, s[44:47], s68 offen offset:1024 sc1
s_add_u32 s68, s68, 2048
s_waitcnt lgkmcnt(0)
MV 124,a,64,a,0
ds_read_b128 a[96:99], v242 offset:8192
s_add_u32 s72, s79, 16384
MV 128,a,64,a,4
ds_read_b128 a[100:103], v242 offset:9216
s_add_u32 m0, s70, 115712
MV 132,a,68,a,0
MV 136,a,68,a,4
ds_read_b128 a[104:107], v242 offset:10240
MV 140,a,72,a,0
ds_read_b128 a[108:111], v242 offset:11264
MV 144,a,72,a,4
buffer_load_dwordx4 v238, s[48:51], s69 offen offset:0 sc1 lds
MV 148,a,76,a,0
ds_read_b128 a[112:115], v243 offset:8192
MV 152,a,76,a,4
ds_read_b128 a[116:119], v243 offset:9216
MV 156,a,80,a,0
buffer_load_dwordx2 v[218:219], v251, s[56:59], s72 offen offset:128 sc1
MV 160,a,80,a,4
ds_read_b128 a[120:123], v243 offset:10240
buffer_load_dwordx4 v238, s[48:51], s69 offen offset:1024 sc1 lds
MV 164,a,84,a,0
ds_read_b128 a[124:127], v243 offset:11264
MV 168,a,84,a,4
MV 172,a,88,a,0
MV 176,a,88,a,4
MV 180,a,92,a,0
buffer_load_dwordx4 a[0:3], v236, s[44:47], s68 offen offset:0 sc1
MV 184,a,92,a,4
buffer_load_dwordx4 a[4:7], v237, s[44:47], s68 offen offset:0 sc1
s_waitcnt vmcnt(19) lgkmcnt(0)
s_barrier
MV 124,a,96,a,8
ds_read_b128 a[64:67], v242 offset:16384
s_add_u32 s72, s79, 131072
MV 128,a,96,a,12
ds_read_b128 a[68:71], v242 offset:17408
buffer_load_dwordx4 v238, s[48:51], s69 offen offset:2048 sc1 lds
MV 132,a,100,a,8
MV 136,a,100,a,12
ds_read_b128 a[72:75], v242 offset:18432
MV 140,a,104,a,8
ds_read_b128 a[76:79], v242 offset:19456
buffer_load_dwordx2 v[220:221], v251, s[56:59], s72 offen offset:128 sc1
MV 144,a,104,a,12
buffer_load_dwordx4 v238, s[48:51], s69 offen offset:3072 sc1 lds
MV 148,a,108,a,8
ds_read_b128 a[80:83], v243 offset:16384
MV 152,a,108,a,12
ds_read_b128 a[84:87], v243 offset:17408
MV 156,a,112,a,8
s_add_u32 s72, s79, 147456
MV 160,a,112,a,12
ds_read_b128 a[88:91], v243 offset:18432
s_add_u32 s69, s69, 16384
MV 164,a,116,a,8
ds_read_b128 a[92:95], v243 offset:19456
MV 168,a,116,a,12
MV 172,a,120,a,8
buffer_load_dwordx2 v[222:223], v251, s[56:59], s72 offen offset:128 sc1
MV 176,a,120,a,12
MV 180,a,124,a,8
buffer_load_dwordx4 a[8:11], v236, s[44:47], s68 offen offset:1024 sc1
MV 184,a,124,a,12
buffer_load_dwordx4 a[12:15], v237, s[44:47], s68 offen offset:1024 sc1
s_add_u32 s68, s68, 2048
s_waitcnt lgkmcnt(0)
MV 124,a,64,a,16
ds_read_b128 a[96:99], v242 offset:24576
MV 128,a,64,a,20
ds_read_b128 a[100:103], v242 offset:25600
s_add_u32 m0, s70, 66560
MV 132,a,68,a,16
MV 136,a,68,a,20
ds_read_b128 a[104:107], v242 offset:26624
MV 140,a,72,a,16
ds_read_b128 a[108:111], v242 offset:27648
MV 144,a,72,a,20
buffer_load_dwordx4 v238, s[48:51], s69 offen offset:0 sc1 lds
MV 148,a,76,a,16
ds_read_b128 a[112:115], v243 offset:24576
MV 152,a,76,a,20
ds_read_b128 a[116:119], v243 offset:25600
MV 156,a,80,a,16
MV 160,a,80,a,20
ds_read_b128 a[120:123], v243 offset:26624
buffer_load_dwordx4 v238, s[48:51], s69 offen offset:1024 sc1 lds
MV 164,a,84,a,16
ds_read_b128 a[124:127], v243 offset:27648
MV 168,a,84,a,20
MV 172,a,88,a,16
MV 176,a,88,a,20
MV 180,a,92,a,16
buffer_load_dwordx4 a[16:19], v236, s[44:47], s68 offen offset:0 sc1
MV 184,a,92,a,20
buffer_load_dwordx4 a[20:23], v237, s[44:47], s68 offen offset:0 sc1
s_waitcnt vmcnt(18) lgkmcnt(0)
s_barrier
MV 124,a,96,a,24
ds_read_b128 a[64:67], v242 offset:32768
MV 128,a,96,a,28
ds_read_b128 a[68:71], v242 offset:33792
buffer_load_dwordx4 v238, s[48:51], s69 offen offset:2048 sc1 lds
MV 132,a,100,a,24
MV 136,a,100,a,28
ds_read_b128 a[72:75], v242 offset:34816
MV 140,a,104,a,24
ds_read_b128 a[76:79], v242 offset:35840
MV 144,a,104,a,28
buffer_load_dwordx4 v238, s[48:51], s69 offen offset:3072 sc1 lds
MV 148,a,108,a,24
ds_read_b128 a[80:83], v243 offset:32768
MV 152,a,108,a,28
ds_read_b128 a[84:87], v243 offset:33792
MV 156,a,112,a,24
MV 160,a,112,a,28
ds_read_b128 a[88:91], v243 offset:34816
s_add_u32 s69, s69, 16384
MV 164,a,116,a,24
ds_read_b128 a[92:95], v243 offset:35840
MV 168,a,116,a,28
MV 172,a,120,a,24
MV 176,a,120,a,28
MV 180,a,124,a,24
buffer_load_dwordx4 a[24:27], v236, s[44:47], s68 offen offset:1024 sc1
MV 184,a,124,a,28
buffer_load_dwordx4 a[28:31], v237, s[44:47], s68 offen offset:1024 sc1
s_add_u32 s68, s68, 2048
s_waitcnt lgkmcnt(0)
MV 124,a,64,a,32
ds_read_b128 a[96:99], v242 offset:40960
v_sub_f32 v8, 1.0, v6
MV 128,a,64,a,36
ds_read_b128 a[100:103], v242 offset:41984
s_add_u32 m0, s70, 82944
MV 132,a,68,a,32
v_lshlrev_b32 v36, 16, v192
v_lshlrev_b32 v228, 16, v208
MV 136,a,68,a,36
ds_read_b128 a[104:107], v242 offset:43008
v_and_b32 v37, 0xffff0000, v192
MV 140,a,72,a,32
ds_read_b128 a[108:111], v242 offset:44032
v_and_b32 v229, 0xffff0000, v208
MV 144,a,72,a,36
buffer_load_dwordx4 v238, s[48:51], s69 offen offset:0 sc1 lds
v_mul_f32 v36, v36, v228
MV 148,a,76,a,32
ds_read_b128 a[112:115], v243 offset:40960
v_mul_f32 v37, v37, v229
MV 152,a,76,a,36
ds_read_b128 a[116:119], v243 offset:41984
v_mul_f32 v36, v36, v6
MV 156,a,80,a,32
v_mul_f32 v37, v37, v6
v_lshlrev_b32 v38, 16, v193
MV 160,a,80,a,36
ds_read_b128 a[120:123], v243 offset:43008
buffer_load_dwordx4 v238, s[48:51], s69 offen offset:1024 sc1 lds
MV 164,a,84,a,32
ds_read_b128 a[124:127], v243 offset:44032
v_lshlrev_b32 v228, 16, v209
MV 168,a,84,a,36
v_and_b32 v39, 0xffff0000, v193
v_and_b32 v229, 0xffff0000, v209
MV 172,a,88,a,32
v_mul_f32 v38, v38, v228
v_mul_f32 v39, v39, v229
MV 176,a,88,a,36
v_mul_f32 v38, v38, v6
v_mul_f32 v39, v39, v6
MV 180,a,92,a,32
buffer_load_dwordx4 a[32:35], v236, s[44:47], s68 offen offset:0 sc1
v_lshlrev_b32 v40, 16, v194
MV 184,a,92,a,36
buffer_load_dwordx4 a[36:39], v237, s[44:47], s68 offen offset:0 sc1
v_lshlrev_b32 v228, 16, v210
v_and_b32 v41, 0xffff0000, v194
v_and_b32 v229, 0xffff0000, v210
s_waitcnt vmcnt(15) lgkmcnt(0)
s_barrier
MV 124,a,96,a,40
ds_read_b128 a[64:67], v242 offset:49152
v_mul_f32 v40, v40, v228
MV 128,a,96,a,44
ds_read_b128 a[68:71], v242 offset:50176
buffer_load_dwordx4 v238, s[48:51], s69 offen offset:2048 sc1 lds
MV 132,a,100,a,40
v_mul_f32 v41, v41, v229
v_mul_f32 v40, v40, v6
MV 136,a,100,a,44
ds_read_b128 a[72:75], v242 offset:51200
v_mul_f32 v41, v41, v6
MV 140,a,104,a,40
ds_read_b128 a[76:79], v242 offset:52224
v_lshlrev_b32 v42, 16, v195
MV 144,a,104,a,44
buffer_load_dwordx4 v238, s[48:51], s69 offen offset:3072 sc1 lds
v_lshlrev_b32 v228, 16, v211
MV 148,a,108,a,40
ds_read_b128 a[80:83], v243 offset:49152
v_and_b32 v43, 0xffff0000, v195
MV 152,a,108,a,44
ds_read_b128 a[84:87], v243 offset:50176
v_and_b32 v229, 0xffff0000, v211
MV 156,a,112,a,40
v_mul_f32 v42, v42, v228
v_mul_f32 v43, v43, v229
MV 160,a,112,a,44
ds_read_b128 a[88:91], v243 offset:51200
s_add_u32 s69, s69, 16384
MV 164,a,116,a,40
ds_read_b128 a[92:95], v243 offset:52224
v_mul_f32 v42, v42, v6
MV 168,a,116,a,44
v_mul_f32 v43, v43, v6
v_lshlrev_b32 v44, 16, v196
MV 172,a,120,a,40
v_lshlrev_b32 v228, 16, v212
v_and_b32 v45, 0xffff0000, v196
MV 176,a,120,a,44
v_and_b32 v229, 0xffff0000, v212
v_mul_f32 v44, v44, v228
MV 180,a,124,a,40
buffer_load_dwordx4 a[40:43], v236, s[44:47], s68 offen offset:1024 sc1
v_mul_f32 v45, v45, v229
MV 184,a,124,a,44
buffer_load_dwordx4 a[44:47], v237, s[44:47], s68 offen offset:1024 sc1
s_add_u32 s68, s68, 2048
v_mul_f32 v44, v44, v6
v_mul_f32 v45, v45, v6
v_lshlrev_b32 v46, 16, v197
v_lshlrev_b32 v228, 16, v213
s_waitcnt lgkmcnt(0)
MV 124,a,64,a,48
ds_read_b128 a[96:99], v242 offset:57344
v_and_b32 v47, 0xffff0000, v197
MV 128,a,64,a,52
ds_read_b128 a[100:103], v242 offset:58368
s_add_u32 m0, s70, 99328
MV 132,a,68,a,48
v_and_b32 v229, 0xffff0000, v213
v_mul_f32 v46, v46, v228
MV 136,a,68,a,52
ds_read_b128 a[104:107], v242 offset:59392
v_mul_f32 v47, v47, v229
MV 140,a,72,a,48
ds_read_b128 a[108:111], v242 offset:60416
v_mul_f32 v46, v46, v6
MV 144,a,72,a,52
buffer_load_dwordx4 v238, s[48:51], s69 offen offset:0 sc1 lds
v_mul_f32 v47, v47, v6
MV 148,a,76,a,48
ds_read_b128 a[112:115], v243 offset:57344
v_lshlrev_b32 v48, 16, v198
MV 152,a,76,a,52
ds_read_b128 a[116:119], v243 offset:58368
v_lshlrev_b32 v228, 16, v214
MV 156,a,80,a,48
v_and_b32 v49, 0xffff0000, v198
v_and_b32 v229, 0xffff0000, v214
MV 160,a,80,a,52
ds_read_b128 a[120:123], v243 offset:59392
buffer_load_dwordx4 v238, s[48:51], s69 offen offset:1024 sc1 lds
MV 164,a,84,a,48
ds_read_b128 a[124:127], v243 offset:60416
v_mul_f32 v48, v48, v228
MV 168,a,84,a,52
v_mul_f32 v49, v49, v229
v_mul_f32 v48, v48, v6
MV 172,a,88,a,48
v_mul_f32 v49, v49, v6
v_lshlrev_b32 v50, 16, v199
MV 176,a,88,a,52
v_lshlrev_b32 v228, 16, v215
v_and_b32 v51, 0xffff0000, v199
MV 180,a,92,a,48
buffer_load_dwordx4 a[48:51], v236, s[44:47], s68 offen offset:0 sc1
v_and_b32 v229, 0xffff0000, v215
MV 184,a,92,a,52
buffer_load_dwordx4 a[52:55], v237, s[44:47], s68 offen offset:0 sc1
v_mul_f32 v50, v50, v228
v_mul_f32 v51, v51, v229
v_mul_f32 v50, v50, v6
v_mul_f32 v51, v51, v6
s_waitcnt vmcnt(14) lgkmcnt(0)
s_barrier
MV 124,a,96,a,56
ds_read_b128 a[64:67], v242 offset:0
v_sub_f32 v9, 1.0, v7
MV 128,a,96,a,60
ds_read_b128 a[68:71], v242 offset:1024
buffer_load_dwordx4 v238, s[48:51], s69 offen offset:2048 sc1 lds
MV 132,a,100,a,56
v_lshlrev_b32 v52, 16, v200
v_lshlrev_b32 v228, 16, v216
MV 136,a,100,a,60
ds_read_b128 a[72:75], v242 offset:2048
v_and_b32 v53, 0xffff0000, v200
MV 140,a,104,a,56
ds_read_b128 a[76:79], v242 offset:3072
v_and_b32 v229, 0xffff0000, v216
MV 144,a,104,a,60
buffer_load_dwordx4 v238, s[48:51], s69 offen offset:3072 sc1 lds
v_mul_f32 v52, v52, v228
MV 148,a,108,a,56
ds_read_b128 a[80:83], v243 offset:0
v_mul_f32 v53, v53, v229
MV 152,a,108,a,60
ds_read_b128 a[84:87], v243 offset:1024
v_mul_f32 v52, v52, v7
MV 156,a,112,a,56
v_mul_f32 v53, v53, v7
v_lshlrev_b32 v54, 16, v201
MV 160,a,112,a,60
ds_read_b128 a[88:91], v243 offset:2048
s_add_u32 s69, s69, 16384
MV 164,a,116,a,56
ds_read_b128 a[92:95], v243 offset:3072
v_lshlrev_b32 v228, 16, v217
MV 168,a,116,a,60
v_and_b32 v55, 0xffff0000, v201
v_and_b32 v229, 0xffff0000, v217
MV 172,a,120,a,56
v_mul_f32 v54, v54, v228
v_mul_f32 v55, v55, v229
MV 176,a,120,a,60
v_mul_f32 v54, v54, v7
v_mul_f32 v55, v55, v7
MV 180,a,124,a,56
buffer_load_dwordx4 a[56:59], v236, s[44:47], s68 offen offset:1024 sc1
v_lshlrev_b32 v56, 16, v202
MV 184,a,124,a,60
buffer_load_dwordx4 a[60:63], v237, s[44:47], s68 offen offset:1024 sc1
s_add_u32 s68, s68, 2048
v_lshlrev_b32 v228, 16, v218
v_and_b32 v57, 0xffff0000, v202
v_and_b32 v229, 0xffff0000, v218
s_waitcnt lgkmcnt(0)
MV 124,a,64,a,0
ds_read_b128 a[96:99], v242 offset:8192
v_mul_f32 v56, v56, v228
MV 128,a,64,a,4
ds_read_b128 a[100:103], v242 offset:9216
s_add_u32 m0, s70, 115712
MV 132,a,68,a,0
v_mul_f32 v57, v57, v229
v_mul_f32 v56, v56, v7
MV 136,a,68,a,4
ds_read_b128 a[104:107], v242 offset:10240
v_mul_f32 v57, v57, v7
MV 140,a,72,a,0
ds_read_b128 a[108:111], v242 offset:11264
v_lshlrev_b32 v58, 16, v203
MV 144,a,72,a,4
buffer_load_dwordx4 v238, s[48:51], s69 offen offset:0 sc1 lds
v_lshlrev_b32 v228, 16, v219
MV 148,a,76,a,0
ds_read_b128 a[112:115], v243 offset:8192
v_and_b32 v59, 0xffff0000, v203
MV 152,a,76,a,4
ds_read_b128 a[116:119], v243 offset:9216
v_and_b32 v229, 0xffff0000, v219
MV 156,a,80,a,0
v_mul_f32 v58, v58, v228
v_mul_f32 v59, v59, v229
MV 160,a,80,a,4
ds_read_b128 a[120:123], v243 offset:10240
buffer_load_dwordx4 v238, s[48:51], s69 offen offset:1024 sc1 lds
MV 164,a,84,a,0
ds_read_b128 a[124:127], v243 offset:11264
v_mul_f32 v58, v58, v7
MV 168,a,84,a,4
v_mul_f32 v59, v59, v7
v_lshlrev_b32 v60, 16, v204
MV 172,a,88,a,0
v_lshlrev_b32 v228, 16, v220
v_and_b32 v61, 0xffff0000, v204
MV 176,a,88,a,4
v_and_b32 v229, 0xffff0000, v220
v_mul_f32 v60, v60, v228
MV 180,a,92,a,0
v_mul_f32 v61, v61, v229
v_mul_f32 v60, v60, v7
MV 184,a,92,a,4
v_mul_f32 v61, v61, v7
v_lshlrev_b32 v62, 16, v205
v_lshlrev_b32 v228, 16, v221
s_waitcnt vmcnt(12) lgkmcnt(0)
s_barrier
MV 124,a,96,a,8
ds_read_b128 a[80:83], v243 offset:16384
v_and_b32 v63, 0xffff0000, v205
MV 128,a,96,a,12
buffer_load_dwordx4 v238, s[48:51], s69 offen offset:2048 sc1 lds
v_and_b32 v229, 0xffff0000, v221
MV 132,a,100,a,8
v_mul_f32 v62, v62, v228
v_mul_f32 v63, v63, v229
MV 136,a,100,a,12
ds_read_b128 a[84:87], v243 offset:17408
v_mul_f32 v62, v62, v7
MV 140,a,104,a,8
v_mul_f32 v63, v63, v7
v_lshlrev_b32 v64, 16, v206
MV 144,a,104,a,12
buffer_load_dwordx4 v238, s[48:51], s69 offen offset:3072 sc1 lds
v_lshlrev_b32 v228, 16, v222
MV 148,a,108,a,8
ds_read_b128 a[88:91], v243 offset:18432
v_and_b32 v65, 0xffff0000, v206
MV 152,a,108,a,12
v_and_b32 v229, 0xffff0000, v222
v_mul_f32 v64, v64, v228
MV 156,a,112,a,8
v_mul_f32 v65, v65, v229
v_mul_f32 v64, v64, v7
MV 160,a,112,a,12
ds_read_b128 a[92:95], v243 offset:19456
s_add_u32 s69, s69, 16384
MV 164,a,116,a,8
v_mul_f32 v65, v65, v7
v_lshlrev_b32 v66, 16, v207
MV 168,a,116,a,12
v_lshlrev_b32 v228, 16, v223
v_and_b32 v67, 0xffff0000, v207
MV 172,a,120,a,8
v_and_b32 v229, 0xffff0000, v223
MV 176,a,120,a,12
v_mul_f32 v66, v66, v228
v_mul_f32 v67, v67, v229
MV 180,a,124,a,8
v_mul_f32 v66, v66, v7
MV 184,a,124,a,12
v_mul_f32 v67, v67, v7
s_waitcnt lgkmcnt(0)
MV 156,a,80,a,16
ds_read_b128 a[112:115], v243 offset:24576
s_xor_b32 s72, s2, 4
MV 160,a,80,a,20
ds_read_b128 a[116:119], v243 offset:25600
s_lshl_b32 s72, s72, 14
MV 164,a,84,a,16
ds_read_b128 a[120:123], v243 offset:26624
MV 168,a,84,a,20
ds_read_b128 a[124:127], v243 offset:27648
MV 172,a,88,a,16
MV 176,a,88,a,20
MV 180,a,92,a,16
MV 184,a,92,a,20
s_waitcnt vmcnt(6)
s_barrier
s_waitcnt lgkmcnt(3)
MV 156,a,112,a,24
ds_read_b128 a[80:83], v243 offset:32768
MV 160,a,112,a,28
ds_read_b128 a[84:87], v243 offset:33792
s_waitcnt lgkmcnt(4)
MV 164,a,116,a,24
ds_read_b128 a[88:91], v243 offset:34816
MV 168,a,116,a,28
ds_read_b128 a[92:95], v243 offset:35840
s_waitcnt lgkmcnt(5)
MV 172,a,120,a,24
MV 176,a,120,a,28
s_waitcnt lgkmcnt(4)
MV 180,a,124,a,24
MV 184,a,124,a,28
s_waitcnt lgkmcnt(3)
MV 156,a,80,a,32
ds_read_b128 a[112:115], v243 offset:40960
MV 160,a,80,a,36
ds_read_b128 a[116:119], v243 offset:41984
s_waitcnt lgkmcnt(4)
MV 164,a,84,a,32
ds_read_b128 a[120:123], v243 offset:43008
MV 168,a,84,a,36
ds_read_b128 a[124:127], v243 offset:44032
s_waitcnt lgkmcnt(5)
MV 172,a,88,a,32
MV 176,a,88,a,36
s_waitcnt lgkmcnt(4)
MV 180,a,92,a,32
MV 184,a,92,a,36
s_waitcnt vmcnt(0)
s_barrier
s_waitcnt lgkmcnt(3)
MV 156,a,112,a,40
ds_read_b128 a[80:83], v243 offset:49152
MV 160,a,112,a,44
ds_read_b128 a[84:87], v243 offset:50176
s_waitcnt lgkmcnt(4)
MV 164,a,116,a,40
ds_read_b128 a[88:91], v243 offset:51200
MV 168,a,116,a,44
ds_read_b128 a[92:95], v243 offset:52224
s_waitcnt lgkmcnt(5)
MV 172,a,120,a,40
MV 176,a,120,a,44
s_waitcnt lgkmcnt(4)
MV 180,a,124,a,40
MV 184,a,124,a,44
s_waitcnt lgkmcnt(3)
MV 156,a,80,a,48
ds_read_b128 a[112:115], v243 offset:57344
MV 160,a,80,a,52
ds_read_b128 a[116:119], v243 offset:58368
s_waitcnt lgkmcnt(4)
MV 164,a,84,a,48
ds_read_b128 a[120:123], v243 offset:59392
MV 168,a,84,a,52
ds_read_b128 a[124:127], v243 offset:60416
s_waitcnt lgkmcnt(5)
MV 172,a,88,a,48
MV 176,a,88,a,52
s_waitcnt lgkmcnt(4)
MV 180,a,92,a,48
MV 184,a,92,a,52
s_waitcnt lgkmcnt(3)
MV 156,a,112,a,56
ds_read_b128 a[64:67], v242 offset:16384
MV 160,a,112,a,60
ds_read_b128 a[68:71], v242 offset:17408
s_waitcnt lgkmcnt(4)
MV 164,a,116,a,56
ds_read_b128 a[72:75], v242 offset:18432
MV 168,a,116,a,60
ds_read_b128 a[76:79], v242 offset:19456
s_waitcnt lgkmcnt(5)
MV 172,a,120,a,56
MV 176,a,120,a,60
s_waitcnt lgkmcnt(4)
MV 180,a,124,a,56
MV 184,a,124,a,60
s_waitcnt lgkmcnt(3)
MV 124,a,64,a,16
ds_read_b128 a[96:99], v242 offset:24576
MV 128,a,64,a,20
ds_read_b128 a[100:103], v242 offset:25600
s_waitcnt lgkmcnt(4)
MV 132,a,68,a,16
ds_read_b128 a[104:107], v242 offset:26624
v_permlane16_swap_b32 v156, v164
MV 136,a,68,a,20
ds_read_b128 a[108:111], v242 offset:27648
v_permlane16_swap_b32 v157, v165
s_waitcnt lgkmcnt(5)
MV 140,a,72,a,16
v_permlane16_swap_b32 v158, v166
v_permlane16_swap_b32 v159, v167
MV 144,a,72,a,20
v_cvt_pk_bf16_f32 v156, v156, v157
v_cvt_pk_bf16_f32 v157, v158, v159
s_waitcnt lgkmcnt(4)
MV 148,a,76,a,16
v_cvt_pk_bf16_f32 v158, v164, v165
v_cvt_pk_bf16_f32 v159, v166, v167
MV 152,a,76,a,20
buffer_store_dwordx4 v[156:159], v238, s[52:55], s72 offen offset:0 sc1
v_permlane16_swap_b32 v172, v180
s_waitcnt lgkmcnt(3)
MV 124,a,96,a,24
ds_read_b128 a[64:67], v242 offset:32768
v_permlane16_swap_b32 v173, v181
MV 128,a,96,a,28
ds_read_b128 a[68:71], v242 offset:33792
v_permlane16_swap_b32 v174, v182
s_waitcnt lgkmcnt(4)
MV 132,a,100,a,24
ds_read_b128 a[72:75], v242 offset:34816
v_permlane16_swap_b32 v175, v183
MV 136,a,100,a,28
ds_read_b128 a[76:79], v242 offset:35840
v_cvt_pk_bf16_f32 v172, v172, v173
s_waitcnt lgkmcnt(5)
MV 140,a,104,a,24
v_cvt_pk_bf16_f32 v173, v174, v175
v_cvt_pk_bf16_f32 v174, v180, v181
MV 144,a,104,a,28
v_cvt_pk_bf16_f32 v175, v182, v183
buffer_store_dwordx4 v[172:175], v238, s[52:55], s72 offen offset:1024 sc1
s_waitcnt lgkmcnt(4)
MV 148,a,108,a,24
v_permlane16_swap_b32 v160, v168
v_permlane16_swap_b32 v161, v169
MV 152,a,108,a,28
v_permlane16_swap_b32 v162, v170
v_permlane16_swap_b32 v163, v171
s_waitcnt lgkmcnt(3)
MV 124,a,64,a,32
ds_read_b128 a[96:99], v242 offset:40960
v_cvt_pk_bf16_f32 v160, v160, v161
MV 128,a,64,a,36
ds_read_b128 a[100:103], v242 offset:41984
v_cvt_pk_bf16_f32 v161, v162, v163
s_waitcnt lgkmcnt(4)
MV 132,a,68,a,32
ds_read_b128 a[104:107], v242 offset:43008
v_cvt_pk_bf16_f32 v162, v168, v169
MV 136,a,68,a,36
ds_read_b128 a[108:111], v242 offset:44032
v_cvt_pk_bf16_f32 v163, v170, v171
s_waitcnt lgkmcnt(5)
MV 140,a,72,a,32
buffer_store_dwordx4 v[160:163], v238, s[52:55], s72 offen offset:2048 sc1
v_permlane16_swap_b32 v176, v184
MV 144,a,72,a,36
v_permlane16_swap_b32 v177, v185
v_permlane16_swap_b32 v178, v186
s_waitcnt lgkmcnt(4)
MV 148,a,76,a,32
v_permlane16_swap_b32 v179, v187
v_cvt_pk_bf16_f32 v176, v176, v177
MV 152,a,76,a,36
v_cvt_pk_bf16_f32 v177, v178, v179
v_cvt_pk_bf16_f32 v178, v184, v185
s_waitcnt lgkmcnt(3)
MV 124,a,96,a,40
ds_read_b128 a[64:67], v242 offset:49152
v_cvt_pk_bf16_f32 v179, v186, v187
MV 128,a,96,a,44
ds_read_b128 a[68:71], v242 offset:50176
buffer_store_dwordx4 v[176:179], v238, s[52:55], s72 offen offset:3072 sc1
s_waitcnt lgkmcnt(4)
MV 132,a,100,a,40
ds_read_b128 a[72:75], v242 offset:51200
MV 136,a,100,a,44
ds_read_b128 a[76:79], v242 offset:52224
s_waitcnt lgkmcnt(5)
MV 140,a,104,a,40
MV 144,a,104,a,44
s_waitcnt lgkmcnt(4)
MV 148,a,108,a,40
MV 152,a,108,a,44
s_waitcnt lgkmcnt(3)
MV 124,a,64,a,48
ds_read_b128 a[96:99], v242 offset:57344
MV 128,a,64,a,52
ds_read_b128 a[100:103], v242 offset:58368
s_waitcnt lgkmcnt(4)
MV 132,a,68,a,48
ds_read_b128 a[104:107], v242 offset:59392
MV 136,a,68,a,52
ds_read_b128 a[108:111], v242 offset:60416
s_waitcnt lgkmcnt(5)
MV 140,a,72,a,48
MV 144,a,72,a,52
s_waitcnt lgkmcnt(4)
MV 148,a,76,a,48
MV 152,a,76,a,52
s_waitcnt lgkmcnt(3)
MV 124,a,96,a,56
MV 128,a,96,a,60
s_waitcnt lgkmcnt(2)
MV 132,a,100,a,56
MV 136,a,100,a,60
s_waitcnt lgkmcnt(1)
MV 140,a,104,a,56
MV 144,a,104,a,60
s_waitcnt lgkmcnt(0)
MV 148,a,108,a,56
MV 152,a,108,a,60
s_nop 0
v_permlane16_swap_b32 v124, v132
v_permlane16_swap_b32 v125, v133
v_permlane16_swap_b32 v126, v134
v_permlane16_swap_b32 v127, v135
s_nop 1
v_permlane16_swap_b32 v140, v148
v_permlane16_swap_b32 v141, v149
v_permlane16_swap_b32 v142, v150
v_permlane16_swap_b32 v143, v151
v_permlane16_swap_b32 v128, v136
v_permlane16_swap_b32 v129, v137
v_permlane16_swap_b32 v130, v138
v_permlane16_swap_b32 v131, v139
v_permlane16_swap_b32 v144, v152
v_permlane16_swap_b32 v145, v153
v_permlane16_swap_b32 v146, v154
v_permlane16_swap_b32 v147, v155
v_fma_f32 v36, v124, v8, v36
v_fma_f32 v37, v125, v8, v37
v_fma_f32 v38, v126, v8, v38
v_fma_f32 v39, v127, v8, v39
v_fma_f32 v40, v132, v8, v40
v_fma_f32 v41, v133, v8, v41
v_fma_f32 v42, v134, v8, v42
v_fma_f32 v43, v135, v8, v43
v_fma_f32 v44, v140, v8, v44
v_fma_f32 v45, v141, v8, v45
v_fma_f32 v46, v142, v8, v46
v_fma_f32 v47, v143, v8, v47
v_fma_f32 v48, v148, v8, v48
v_fma_f32 v49, v149, v8, v49
v_fma_f32 v50, v150, v8, v50
v_fma_f32 v51, v151, v8, v51
v_fma_f32 v52, v128, v9, v52
v_fma_f32 v53, v129, v9, v53
v_fma_f32 v54, v130, v9, v54
v_fma_f32 v55, v131, v9, v55
v_fma_f32 v56, v136, v9, v56
v_fma_f32 v57, v137, v9, v57
v_fma_f32 v58, v138, v9, v58
v_fma_f32 v59, v139, v9, v59
v_fma_f32 v60, v144, v9, v60
v_fma_f32 v61, v145, v9, v61
v_fma_f32 v62, v146, v9, v62
v_fma_f32 v63, v147, v9, v63
v_fma_f32 v64, v152, v9, v64
v_fma_f32 v65, v153, v9, v65
v_fma_f32 v66, v154, v9, v66
v_fma_f32 v67, v155, v9, v67
s_lshl_b32 s72, s2, 14
s_mov_b32 s73, 400000
L_xb:
buffer_load_dwordx4 v[76:79], v238, s[52:55], s72 offen offset:0 sc1
buffer_load_dwordx4 v[80:83], v238, s[52:55], s72 offen offset:1024 sc1
buffer_load_dwordx4 v[84:87], v238, s[52:55], s72 offen offset:2048 sc1
buffer_load_dwordx4 v[88:91], v238, s[52:55], s72 offen offset:3072 sc1
s_sub_u32 s73, s73, 1
s_cbranch_scc1 L_xb_done
s_waitcnt vmcnt(3)
v_max3_u32 v228, v76, v77, v78
s_waitcnt vmcnt(2)
v_max3_u32 v228, v228, v79, v80
v_max3_u32 v228, v228, v81, v82
s_waitcnt vmcnt(1)
v_max3_u32 v228, v228, v83, v84
v_max3_u32 v228, v228, v85, v86
s_waitcnt vmcnt(0)
v_max3_u32 v228, v228, v87, v88
v_max3_u32 v228, v228, v89, v90
v_max_u32 v228, v228, v91
v_cmp_eq_u32 vcc, -1, v228
s_nop 4
s_cbranch_vccnz L_xb
L_xb_done:
s_waitcnt vmcnt(0)
s_add_u32 s72, s78, 0
v_lshlrev_b32 v92, 16, v76
v_and_b32 v93, 0xffff0000, v76
v_fmac_f32 v36, v92, v8
v_fmac_f32 v37, v93, v8
v_cvt_pk_bf16_f32 v192, v36, v37
v_lshlrev_b32 v92, 16, v77
v_and_b32 v93, 0xffff0000, v77
v_fmac_f32 v38, v92, v8
v_fmac_f32 v39, v93, v8
v_cvt_pk_bf16_f32 v193, v38, v39
v_lshlrev_b32 v92, 16, v78
v_and_b32 v93, 0xffff0000, v78
v_fmac_f32 v40, v92, v8
v_fmac_f32 v41, v93, v8
v_cvt_pk_bf16_f32 v194, v40, v41
v_lshlrev_b32 v92, 16, v79
v_and_b32 v93, 0xffff0000, v79
v_fmac_f32 v42, v92, v8
v_fmac_f32 v43, v93, v8
v_cvt_pk_bf16_f32 v195, v42, v43
buffer_store_dwordx4 v[192:195], v250, s[60:63], s72 offen offset:0 sc1
v_lshlrev_b32 v92, 16, v80
v_and_b32 v93, 0xffff0000, v80
v_fmac_f32 v44, v92, v8
v_fmac_f32 v45, v93, v8
v_cvt_pk_bf16_f32 v196, v44, v45
v_lshlrev_b32 v92, 16, v81
v_and_b32 v93, 0xffff0000, v81
v_fmac_f32 v46, v92, v8
v_fmac_f32 v47, v93, v8
v_cvt_pk_bf16_f32 v197, v46, v47
v_lshlrev_b32 v92, 16, v82
v_and_b32 v93, 0xffff0000, v82
v_fmac_f32 v48, v92, v8
v_fmac_f32 v49, v93, v8
v_cvt_pk_bf16_f32 v198, v48, v49
v_lshlrev_b32 v92, 16, v83
v_and_b32 v93, 0xffff0000, v83
v_fmac_f32 v50, v92, v8
v_fmac_f32 v51, v93, v8
v_cvt_pk_bf16_f32 v199, v50, v51
buffer_store_dwordx4 v[196:199], v250, s[60:63], s72 offen offset:64 sc1
s_add_u32 s72, s78, 32768
v_lshlrev_b32 v92, 16, v84
v_and_b32 v93, 0xffff0000, v84
v_fmac_f32 v52, v92, v9
v_fmac_f32 v53, v93, v9
v_cvt_pk_bf16_f32 v200, v52, v53
v_lshlrev_b32 v92, 16, v85
v_and_b32 v93, 0xffff0000, v85
v_fmac_f32 v54, v92, v9
v_fmac_f32 v55, v93, v9
v_cvt_pk_bf16_f32 v201, v54, v55
v_lshlrev_b32 v92, 16, v86
v_and_b32 v93, 0xffff0000, v86
v_fmac_f32 v56, v92, v9
v_fmac_f32 v57, v93, v9
v_cvt_pk_bf16_f32 v202, v56, v57
v_lshlrev_b32 v92, 16, v87
v_and_b32 v93, 0xffff0000, v87
v_fmac_f32 v58, v92, v9
v_fmac_f32 v59, v93, v9
v_cvt_pk_bf16_f32 v203, v58, v59
buffer_store_dwordx4 v[200:203], v250, s[60:63], s72 offen offset:0 sc1
v_lshlrev_b32 v92, 16, v88
v_and_b32 v93, 0xffff0000, v88
v_fmac_f32 v60, v92, v9
v_fmac_f32 v61, v93, v9
v_cvt_pk_bf16_f32 v204, v60, v61
v_lshlrev_b32 v92, 16, v89
v_and_b32 v93, 0xffff0000, v89
v_fmac_f32 v62, v92, v9
v_fmac_f32 v63, v93, v9
v_cvt_pk_bf16_f32 v205, v62, v63
v_lshlrev_b32 v92, 16, v90
v_and_b32 v93, 0xffff0000, v90
v_fmac_f32 v64, v92, v9
v_fmac_f32 v65, v93, v9
v_cvt_pk_bf16_f32 v206, v64, v65
v_lshlrev_b32 v92, 16, v91
v_and_b32 v93, 0xffff0000, v91
v_fmac_f32 v66, v92, v9
v_fmac_f32 v67, v93, v9
v_cvt_pk_bf16_f32 v207, v66, v67
buffer_store_dwordx4 v[204:207], v250, s[60:63], s72 offen offset:64 sc1
L_end:
s_endpgm
L_p3_pmask:
s_nop 7
v_add_u32 v246, 0, v13
v_cmp_gt_i32_e64 s[84:85], 0, v246
v_cmp_gt_i32_e64 s[86:87], 1, v246
v_cmp_gt_i32_e64 s[88:89], 2, v246
v_cmp_gt_i32_e64 s[90:91], 3, v246
v_cndmask_b32_e64 v96, v96, v14, s[84:85]
v_cndmask_b32_e64 v97, v97, v14, s[86:87]
v_cndmask_b32_e64 v98, v98, v14, s[88:89]
v_cndmask_b32_e64 v99, v99, v14, s[90:91]
v_add_u32 v247, -16, v13
v_cmp_gt_i32_e64 s[92:93], 0, v247
v_cmp_gt_i32_e64 s[94:95], 1, v247
v_cmp_gt_i32_e64 s[96:97], 2, v247
v_cmp_gt_i32_e64 s[98:99], 3, v247
v_cndmask_b32_e64 v100, v100, v14, s[92:93]
v_cndmask_b32_e64 v101, v101, v14, s[94:95]
v_cndmask_b32_e64 v102, v102, v14, s[96:97]
v_cndmask_b32_e64 v103, v103, v14, s[98:99]
v_add_u32 v246, -32, v13
v_cmp_gt_i32_e64 s[84:85], 0, v246
v_cmp_gt_i32_e64 s[86:87], 1, v246
v_cmp_gt_i32_e64 s[88:89], 2, v246
v_cmp_gt_i32_e64 s[90:91], 3, v246
v_cndmask_b32_e64 v128, v128, v14, s[84:85]
v_cndmask_b32_e64 v129, v129, v14, s[86:87]
v_cndmask_b32_e64 v130, v130, v14, s[88:89]
v_cndmask_b32_e64 v131, v131, v14, s[90:91]
v_add_u32 v247, -48, v13
v_cmp_gt_i32_e64 s[92:93], 0, v247
v_cmp_gt_i32_e64 s[94:95], 1, v247
v_cmp_gt_i32_e64 s[96:97], 2, v247
v_cmp_gt_i32_e64 s[98:99], 3, v247
v_cndmask_b32_e64 v132, v132, v14, s[92:93]
v_cndmask_b32_e64 v133, v133, v14, s[94:95]
v_cndmask_b32_e64 v134, v134, v14, s[96:97]
v_cndmask_b32_e64 v135, v135, v14, s[98:99]
s_branch L_p3_pmask_ret
L_p3_mxm_top:
s_waitcnt lgkmcnt(0)
v_xor_b32 v11, 0x8000, v11
v_mfma_f32_16x16x32_bf16 v[80:83], a[128:131], v[16:19], 0
s_add_u32 m0, s73, 16384
ds_read_b128 a[192:195], v11 offset:0
v_mfma_f32_16x16x32_bf16 v[88:91], a[128:131], v[32:35], 0
v_exp_f32 v176, v176
MV 80,a,132,v,20
v_exp_f32 v177, v177
MV 88,a,132,v,36
ds_read_b128 a[196:199], v11 offset:1024
buffer_load_dwordx4 v12, s[56:59], s71 offen offset:0 sc1 lds
MV 80,a,136,v,24
v_exp_f32 v178, v178
MV 88,a,136,v,40
v_add_f32 v2, v2, v176
v_add_f32 v2, v2, v177
MV 80,a,140,v,28
ds_read_b128 a[200:203], v11 offset:2048
ds_read_b128 a[204:207], v11 offset:3072
MV 88,a,140,v,44
v_exp_f32 v179, v179
v_mfma_f32_16x16x32_bf16 v[84:87], a[144:147], v[16:19], 0
ds_read_b128 a[208:211], v11 offset:4096
v_cvt_pk_bf16_f32 v176, v176, v177
v_mfma_f32_16x16x32_bf16 v[92:95], a[144:147], v[32:35], 0
v_exp_f32 v180, v180
MV 84,a,148,v,20
v_add_f32 v2, v2, v178
v_add_f32 v2, v2, v179
MV 92,a,148,v,36
v_exp_f32 v181, v181
MV 84,a,152,v,24
buffer_load_dwordx4 v12, s[56:59], s71 offen offset:1024 sc1 lds
v_cvt_pk_bf16_f32 v177, v178, v179
MV 92,a,152,v,40
v_exp_f32 v182, v182
MV 84,a,156,v,28
ds_read_b128 a[212:215], v11 offset:5120
v_add_f32 v2, v2, v180
MV 92,a,156,v,44
ds_read_b128 a[216:219], v11 offset:6144
v_add_f32 v2, v2, v181
v_mfma_f32_16x16x32_bf16 v[112:115], a[160:163], v[16:19], 0
v_exp_f32 v183, v183
v_mfma_f32_16x16x32_bf16 v[120:123], a[160:163], v[32:35], 0
ds_read_b128 a[220:223], v11 offset:7168
v_cvt_pk_bf16_f32 v178, v180, v181
MV 112,a,164,v,20
v_exp_f32 v184, v184
MV 120,a,164,v,36
v_add_f32 v2, v2, v182
v_add_f32 v2, v2, v183
MV 112,a,168,v,24
ds_read_b128 a[224:227], v11 offset:8192
buffer_load_dwordx4 v12, s[56:59], s71 offen offset:2048 sc1 lds
MV 120,a,168,v,40
v_exp_f32 v185, v185
MV 112,a,172,v,28
ds_read_b128 a[228:231], v11 offset:9216
v_cvt_pk_bf16_f32 v179, v182, v183
MV 120,a,172,v,44
v_exp_f32 v186, v186
v_mfma_f32_16x16x32_bf16 v[116:119], a[176:179], v[16:19], 0
v_add_f32 v3, v3, v184
v_add_f32 v3, v3, v185
v_mfma_f32_16x16x32_bf16 v[124:127], a[176:179], v[32:35], 0
v_exp_f32 v187, v187
MV 116,a,180,v,20
ds_read_b128 a[232:235], v11 offset:10240
v_cvt_pk_bf16_f32 v184, v184, v185
MV 124,a,180,v,36
v_exp_f32 v188, v188
MV 116,a,184,v,24
ds_read_b128 a[236:239], v11 offset:11264
v_add_f32 v3, v3, v186
MV 124,a,184,v,40
buffer_load_dwordx4 v12, s[56:59], s71 offen offset:3072 sc1 lds
v_add_f32 v3, v3, v187
MV 116,a,188,v,28
v_exp_f32 v189, v189
MV 124,a,188,v,44
ds_read_b128 a[240:243], v11 offset:12288
ds_read_b128 a[244:247], v11 offset:13312
ds_read_b128 a[248:251], v11 offset:14336
ds_read_b128 a[252:255], v11 offset:15360
s_add_u32 s71, s71, 16384
s_xor_b32 s73, s73, 0x8000
v_cvt_pk_bf16_f32 v185, v186, v187
v_exp_f32 v190, v190
v_add_f32 v3, v3, v188
v_add_f32 v3, v3, v189
v_exp_f32 v191, v191
v_cvt_pk_bf16_f32 v186, v188, v189
v_exp_f32 v200, v200
v_add_f32 v3, v3, v190
v_add_f32 v3, v3, v191
v_exp_f32 v201, v201
v_cvt_pk_bf16_f32 v187, v190, v191
v_exp_f32 v202, v202
v_add_u32 v246, 0, v13
v_cmp_gt_i32_e64 s[84:85], 0, v246
v_add_f32 v5, v5, v200
v_cmp_gt_i32_e64 s[86:87], 1, v246
v_cmp_gt_i32_e64 s[88:89], 2, v246
v_add_f32 v5, v5, v201
v_exp_f32 v203, v203
v_cmp_gt_i32_e64 s[90:91], 3, v246
v_cndmask_b32_e64 v80, v80, v14, s[84:85]
v_cvt_pk_bf16_f32 v200, v200, v201
v_exp_f32 v204, v204
v_cndmask_b32_e64 v81, v81, v14, s[86:87]
v_cndmask_b32_e64 v82, v82, v14, s[88:89]
v_add_f32 v5, v5, v202
v_add_f32 v5, v5, v203
v_cndmask_b32_e64 v83, v83, v14, s[90:91]
v_exp_f32 v205, v205
v_cvt_pk_bf16_f32 v201, v202, v203
v_add_u32 v247, -16, v13
v_cmp_gt_i32_e64 s[92:93], 0, v247
v_exp_f32 v206, v206
v_add_f32 v5, v5, v204
v_cmp_gt_i32_e64 s[94:95], 1, v247
v_cmp_gt_i32_e64 s[96:97], 2, v247
v_add_f32 v5, v5, v205
v_exp_f32 v207, v207
v_cmp_gt_i32_e64 s[98:99], 3, v247
v_cndmask_b32_e64 v84, v84, v14, s[92:93]
v_cvt_pk_bf16_f32 v202, v204, v205
v_add_f32 v5, v5, v206
v_cndmask_b32_e64 v85, v85, v14, s[94:95]
v_cndmask_b32_e64 v86, v86, v14, s[96:97]
v_add_f32 v5, v5, v207
v_cvt_pk_bf16_f32 v203, v206, v207
v_cndmask_b32_e64 v87, v87, v14, s[98:99]
s_waitcnt vmcnt(16) lgkmcnt(0)
MA 0,a,192,v,144
s_barrier
v_xor_b32 v10, 0x8000, v10
MA 32,a,192,v,152
s_add_u32 m0, s72, 16384
ds_read_b128 a[128:131], v10 offset:0
MA 96,a,192,v,168
v_exp_f32 v80, v80
MA 4,a,196,v,144
buffer_load_dwordx4 v12, s[52:55], s71 offen offset:0 sc1 lds
v_lshrrev_b32 v249, 2, v1
MA 36,a,196,v,152
ds_read_b128 a[132:135], v10 offset:1024
v_and_b32 v248, 7, v249
MA 100,a,196,v,168
v_lshlrev_b32 v249, 8, v249
v_and_b32 v250, 3, v1
MA 8,a,200,v,144
v_exp_f32 v81, v81
MA 40,a,200,v,152
v_lshl_add_u32 v249, v250, 3, v249
s_lshl_b32 s36, s3, 13
MA 104,a,200,v,168
ds_read_b128 a[136:139], v10 offset:2048
s_add_u32 s36, s36, 131072
MA 12,a,204,v,144
v_add_u32 v246, -32, v13
v_add_u32 v249, s36, v249
MA 44,a,204,v,152
v_exp_f32 v82, v82
MA 108,a,204,v,168
s_nop 0
v_xor_b32 v250, 0, v248
MA 16,a,208,v,144
ds_read_b128 a[140:143], v10 offset:3072
v_lshl_add_u32 v250, v250, 5, v249
MA 48,a,208,v,152
v_cmp_gt_i32_e64 s[84:85], 0, v246
TR 96,250,0
MA 112,a,208,v,168
TR 98,250,4096
v_xor_b32 v250, 1, v248
MA 20,a,212,v,144
v_exp_f32 v83, v83
MA 52,a,212,v,152
ds_read_b128 a[144:147], v10 offset:4096
v_lshl_add_u32 v250, v250, 5, v249
MA 116,a,212,v,168
v_cvt_pk_bf16_f32 v80, v80, v81
v_cmp_gt_i32_e64 s[86:87], 1, v246
MA 24,a,216,v,144
TR 100,250,0
TR 102,250,4096
MA 56,a,216,v,152
ds_read_b128 a[148:151], v10 offset:5120
buffer_load_dwordx4 v12, s[52:55], s71 offen offset:1024 sc1 lds
MA 120,a,216,v,168
v_xor_b32 v250, 2, v248
v_lshl_add_u32 v250, v250, 5, v249
MA 28,a,220,v,144
v_exp_f32 v84, v84
MA 60,a,220,v,152
TR 104,250,0
TR 106,250,4096
MA 124,a,220,v,168
v_cmp_gt_i32_e64 s[88:89], 2, v246
v_xor_b32 v250, 3, v248
MA 0,a,224,v,176
ds_read_b128 a[152:155], v10 offset:6144
v_lshl_add_u32 v250, v250, 5, v249
MA 32,a,224,v,184
v_exp_f32 v85, v85
MA 96,a,224,v,200
TR 108,250,0
TR 110,250,4096
MA 4,a,228,v,176
v_cmp_gt_i32_e64 s[90:91], 3, v246
v_xor_b32 v250, 4, v248
MA 36,a,228,v,184
ds_read_b128 a[156:159], v10 offset:7168
v_lshl_add_u32 v250, v250, 5, v249
MA 100,a,228,v,200
v_cvt_pk_bf16_f32 v81, v82, v83
TR 128,250,0
MA 8,a,232,v,176
v_cndmask_b32_e64 v112, v112, v14, s[84:85]
TR 130,250,4096
MA 40,a,232,v,184
ds_read_b128 a[160:163], v10 offset:8192
v_xor_b32 v250, 5, v248
MA 104,a,232,v,200
v_exp_f32 v86, v86
MA 12,a,236,v,176
v_lshl_add_u32 v250, v250, 5, v249
TR 132,250,0
MA 44,a,236,v,184
TR 134,250,4096
v_xor_b32 v250, 6, v248
MA 108,a,236,v,200
v_exp_f32 v87, v87
MA 16,a,240,v,176
ds_read_b128 a[164:167], v10 offset:9216
buffer_load_dwordx4 v12, s[52:55], s71 offen offset:2048 sc1 lds
MA 48,a,240,v,184
v_cndmask_b32_e64 v113, v113, v14, s[86:87]
v_lshl_add_u32 v250, v250, 5, v249
MA 112,a,240,v,200
TR 136,250,0
TR 138,250,4096
MA 20,a,244,v,176
ds_read_b128 a[168:171], v10 offset:10240
v_xor_b32 v250, 7, v248
MA 52,a,244,v,184
v_cvt_pk_bf16_f32 v82, v84, v85
v_cndmask_b32_e64 v114, v114, v14, s[88:89]
MA 116,a,244,v,200
v_lshl_add_u32 v250, v250, 5, v249
TR 140,250,0
MA 24,a,248,v,176
v_cndmask_b32_e64 v115, v115, v14, s[90:91]
TR 142,250,4096
MA 56,a,248,v,184
v_exp_f32 v88, v88
MA 120,a,248,v,200
s_add_u32 s32, s40, 100663296
s_addc_u32 s33, s41, 0
MA 28,a,252,v,176
ds_read_b128 a[172:175], v10 offset:11264
s_mov_b32 s34, 8388608
MA 60,a,252,v,184
s_mov_b32 s35, 0x20000
s_and_b32 s36, s2, 7
MA 124,a,252,v,200
ds_read_b128 a[176:179], v10 offset:12288
ds_read_b128 a[180:183], v10 offset:13312
ds_read_b128 a[184:187], v10 offset:14336
ds_read_b128 a[188:191], v10 offset:15360
buffer_load_dwordx4 v12, s[52:55], s71 offen offset:3072 sc1 lds
s_xor_b32 s72, s72, 0x8000
v_exp_f32 v89, v89
s_lshl_b32 s36, s36, 20
v_add_u32 v247, -48, v13
s_lshr_b32 s37, s2, 3
s_lshl_b32 s37, s37, 15
v_cvt_pk_bf16_f32 v83, v86, v87
s_add_u32 s36, s36, s37
s_lshl_b32 s37, s3, 12
v_exp_f32 v90, v90
v_cmp_gt_i32_e64 s[92:93], 0, v247
s_add_u32 s36, s36, s37
s_add_u32 s37, s36, 4096
s_waitcnt lgkmcnt(15)
buffer_store_dwordx4 v[96:99], v12, s[32:35], s36 offen offset:0 sc1
buffer_store_dwordx4 v[100:103], v12, s[32:35], s36 offen offset:1024 sc1
v_exp_f32 v91, v91
v_cmp_gt_i32_e64 s[94:95], 1, v247
buffer_store_dwordx4 v[104:107], v12, s[32:35], s36 offen offset:2048 sc1
buffer_store_dwordx4 v[108:111], v12, s[32:35], s36 offen offset:3072 sc1
s_waitcnt lgkmcnt(14)
buffer_store_dwordx4 v[128:131], v12, s[32:35], s37 offen offset:0 sc1
v_cvt_pk_bf16_f32 v88, v88, v89
s_waitcnt lgkmcnt(11)
buffer_store_dwordx4 v[132:135], v12, s[32:35], s37 offen offset:1024 sc1
s_waitcnt lgkmcnt(8)
buffer_store_dwordx4 v[136:139], v12, s[32:35], s37 offen offset:2048 sc1
v_cmp_gt_i32_e64 s[96:97], 2, v247
s_waitcnt lgkmcnt(5)
buffer_store_dwordx4 v[140:143], v12, s[32:35], s37 offen offset:3072 sc1
s_add_u32 s32, s40, 109051904
s_addc_u32 s33, s41, 0
v_exp_f32 v92, v92
s_mov_b32 s34, 4194304
v_cmp_gt_i32_e64 s[98:99], 3, v247
s_mov_b32 s35, 0x20000
s_lshl_b32 s36, s2, 14
v_exp_f32 v93, v93
v_mov_b32 v252, -1
v_mov_b32 v253, -1
v_cndmask_b32_e64 v116, v116, v14, s[92:93]
v_mov_b32 v254, -1
v_mov_b32 v255, -1
v_cvt_pk_bf16_f32 v89, v90, v91
buffer_store_dwordx4 v[252:255], v12, s[32:35], s36 offen offset:0 sc1
buffer_store_dwordx4 v[252:255], v12, s[32:35], s36 offen offset:1024 sc1
v_exp_f32 v94, v94
buffer_store_dwordx4 v[252:255], v12, s[32:35], s36 offen offset:2048 sc1
v_cndmask_b32_e64 v117, v117, v14, s[94:95]
buffer_store_dwordx4 v[252:255], v12, s[32:35], s36 offen offset:3072 sc1
v_lshlrev_b32 v232, 4, v1
v_add_u32 v233, -4, v232
v_mov_b32 v235, 0
v_exp_f32 v95, v95
v_cndmask_b32_e64 v118, v118, v14, s[96:97]
buffer_load_ushort v234, v235, s[28:31], s42 offen
buffer_load_dword v209, v233, s[16:19], 0 offen
buffer_load_dwordx4 v[210:213], v232, s[16:19], 0 offen offset:0
buffer_load_dword v215, v232, s[16:19], 0 offen offset:1020
v_cvt_pk_bf16_f32 v90, v92, v93
v_cndmask_b32_e64 v119, v119, v14, s[98:99]
buffer_load_dwordx4 v[216:219], v232, s[16:19], 0 offen offset:1024
buffer_load_dword v221, v232, s[16:19], 0 offen offset:2044
v_cvt_pk_bf16_f32 v91, v94, v95
buffer_load_dwordx4 v[222:225], v232, s[16:19], 0 offen offset:2048
buffer_load_dword v227, v232, s[16:19], 0 offen offset:3068
buffer_load_dwordx4 v[228:231], v232, s[16:19], 0 offen offset:3072
s_branch L_p3_eps
L_fallback:
s_mov_b32 s81, 0
s_mov_b32 s74, s77
s_mov_b32 s73, s100
s_sub_u32 s72, 15, s70
v_mov_b32 v10, v15
v_add_u32 v11, 16384, v15
s_nop 15
L_fb_set:
s_lshl_b32 s72, s72, 7
s_mov_b32 s71, 0
v_accvgpr_write_b32 a0, 0
v_accvgpr_write_b32 a1, 0
v_accvgpr_write_b32 a2, 0
v_accvgpr_write_b32 a3, 0
v_accvgpr_write_b32 a4, 0
v_accvgpr_write_b32 a5, 0
v_accvgpr_write_b32 a6, 0
v_accvgpr_write_b32 a7, 0
v_accvgpr_write_b32 a8, 0
v_accvgpr_write_b32 a9, 0
v_accvgpr_write_b32 a10, 0
v_accvgpr_write_b32 a11, 0
v_accvgpr_write_b32 a12, 0
v_accvgpr_write_b32 a13, 0
v_accvgpr_write_b32 a14, 0
v_accvgpr_write_b32 a15, 0
v_accvgpr_write_b32 a16, 0
v_accvgpr_write_b32 a17, 0
v_accvgpr_write_b32 a18, 0
v_accvgpr_write_b32 a19, 0
v_accvgpr_write_b32 a20, 0
v_accvgpr_write_b32 a21, 0
v_accvgpr_write_b32 a22, 0
v_accvgpr_write_b32 a23, 0
v_accvgpr_write_b32 a24, 0
v_accvgpr_write_b32 a25, 0
v_accvgpr_write_b32 a26, 0
v_accvgpr_write_b32 a27, 0
v_accvgpr_write_b32 a28, 0
v_accvgpr_write_b32 a29, 0
v_accvgpr_write_b32 a30, 0
v_accvgpr_write_b32 a31, 0
v_accvgpr_write_b32 a32, 0
v_accvgpr_write_b32 a33, 0
v_accvgpr_write_b32 a34, 0
v_accvgpr_write_b32 a35, 0
v_accvgpr_write_b32 a36, 0
v_accvgpr_write_b32 a37, 0
v_accvgpr_write_b32 a38, 0
v_accvgpr_write_b32 a39, 0
v_accvgpr_write_b32 a40, 0
v_accvgpr_write_b32 a41, 0
v_accvgpr_write_b32 a42, 0
v_accvgpr_write_b32 a43, 0
v_accvgpr_write_b32 a44, 0
v_accvgpr_write_b32 a45, 0
v_accvgpr_write_b32 a46, 0
v_accvgpr_write_b32 a47, 0
v_accvgpr_write_b32 a48, 0
v_accvgpr_write_b32 a49, 0
v_accvgpr_write_b32 a50, 0
v_accvgpr_write_b32 a51, 0
v_accvgpr_write_b32 a52, 0
v_accvgpr_write_b32 a53, 0
v_accvgpr_write_b32 a54, 0
v_accvgpr_write_b32 a55, 0
v_accvgpr_write_b32 a56, 0
v_accvgpr_write_b32 a57, 0
v_accvgpr_write_b32 a58, 0
v_accvgpr_write_b32 a59, 0
v_accvgpr_write_b32 a60, 0
v_accvgpr_write_b32 a61, 0
v_accvgpr_write_b32 a62, 0
v_accvgpr_write_b32 a63, 0
v_mov_b32 v2, 0
v_mov_b32 v96, v14
v_mov_b32 v3, 0
v_mov_b32 v97, v14
L_fb_tile:
s_waitcnt vmcnt(0) lgkmcnt(0)
s_barrier
s_mov_b32 m0, s68
s_add_u32 s80, s71, 16384
buffer_load_dwordx4 v12, s[52:55], s71 offen offset:0 sc1 lds
buffer_load_dwordx4 v12, s[52:55], s71 offen offset:1024 sc1 lds
buffer_load_dwordx4 v12, s[52:55], s71 offen offset:2048 sc1 lds
buffer_load_dwordx4 v12, s[52:55], s71 offen offset:3072 sc1 lds
s_add_u32 m0, s68, 16384
s_nop 0
buffer_load_dwordx4 v12, s[56:59], s80 offen offset:0 sc1 lds
buffer_load_dwordx4 v12, s[56:59], s80 offen offset:1024 sc1 lds
buffer_load_dwordx4 v12, s[56:59], s80 offen offset:2048 sc1 lds
buffer_load_dwordx4 v12, s[56:59], s80 offen offset:3072 sc1 lds
s_waitcnt vmcnt(0)
s_barrier
ds_read_b128 a[128:131], v10 offset:0
ds_read_b128 a[132:135], v10 offset:1024
ds_read_b128 a[136:139], v10 offset:2048
ds_read_b128 a[140:143], v10 offset:3072
ds_read_b128 a[144:147], v10 offset:4096
ds_read_b128 a[148:151], v10 offset:5120
ds_read_b128 a[152:155], v10 offset:6144
ds_read_b128 a[156:159], v10 offset:7168
ds_read_b128 a[160:163], v10 offset:8192
ds_read_b128 a[164:167], v10 offset:9216
ds_read_b128 a[168:171], v10 offset:10240
ds_read_b128 a[172:175], v10 offset:11264
ds_read_b128 a[176:179], v10 offset:12288
ds_read_b128 a[180:183], v10 offset:13312
ds_read_b128 a[184:187], v10 offset:14336
ds_read_b128 a[188:191], v10 offset:15360
s_waitcnt lgkmcnt(0)
ds_read_b128 a[192:195], v11 offset:0
ds_read_b128 a[196:199], v11 offset:1024
ds_read_b128 a[200:203], v11 offset:2048
ds_read_b128 a[204:207], v11 offset:3072
ds_read_b128 a[208:211], v11 offset:4096
ds_read_b128 a[212:215], v11 offset:5120
ds_read_b128 a[216:219], v11 offset:6144
ds_read_b128 a[220:223], v11 offset:7168
ds_read_b128 a[224:227], v11 offset:8192
ds_read_b128 a[228:231], v11 offset:9216
ds_read_b128 a[232:235], v11 offset:10240
ds_read_b128 a[236:239], v11 offset:11264
ds_read_b128 a[240:243], v11 offset:12288
ds_read_b128 a[244:247], v11 offset:13312
ds_read_b128 a[248:251], v11 offset:14336
ds_read_b128 a[252:255], v11 offset:15360
v_mfma_f32_16x16x32_bf16 v[80:83], a[128:131], v[16:19], 0
v_mfma_f32_16x16x32_bf16 v[88:91], a[128:131], v[32:35], 0
MV 80,a,132,v,20
MV 88,a,132,v,36
MV 80,a,136,v,24
MV 88,a,136,v,40
MV 80,a,140,v,28
MV 88,a,140,v,44
v_mfma_f32_16x16x32_bf16 v[84:87], a[144:147], v[16:19], 0
v_mfma_f32_16x16x32_bf16 v[92:95], a[144:147], v[32:35], 0
MV 84,a,148,v,20
MV 92,a,148,v,36
MV 84,a,152,v,24
MV 92,a,152,v,40
MV 84,a,156,v,28
MV 92,a,156,v,44
v_mfma_f32_16x16x32_bf16 v[112:115], a[160:163], v[16:19], 0
v_mfma_f32_16x16x32_bf16 v[120:123], a[160:163], v[32:35], 0
MV 112,a,164,v,20
MV 120,a,164,v,36
MV 112,a,168,v,24
MV 120,a,168,v,40
MV 112,a,172,v,28
MV 120,a,172,v,44
v_mfma_f32_16x16x32_bf16 v[116:119], a[176:179], v[16:19], 0
v_mfma_f32_16x16x32_bf16 v[124:127], a[176:179], v[32:35], 0
MV 116,a,180,v,20
MV 124,a,180,v,36
MV 116,a,184,v,24
MV 124,a,184,v,40
MV 116,a,188,v,28
MV 124,a,188,v,44
v_add_u32 v246, s72, v13
v_add_u32 v246, 0, v246
v_cmp_gt_i32_e64 s[84:85], 0, v246
v_cmp_gt_i32_e64 s[86:87], 1, v246
v_cmp_gt_i32_e64 s[88:89], 2, v246
v_cmp_gt_i32_e64 s[90:91], 3, v246
v_cndmask_b32_e64 v80, v80, v14, s[84:85]
v_cndmask_b32_e64 v81, v81, v14, s[86:87]
v_cndmask_b32_e64 v82, v82, v14, s[88:89]
v_cndmask_b32_e64 v83, v83, v14, s[90:91]
v_add_u32 v247, s72, v239
v_add_u32 v247, 0, v247
v_cmp_gt_i32_e64 s[92:93], 0, v247
v_cmp_gt_i32_e64 s[94:95], 1, v247
v_cmp_gt_i32_e64 s[96:97], 2, v247
v_cmp_gt_i32_e64 s[98:99], 3, v247
v_cndmask_b32_e64 v88, v88, v14, s[92:93]
v_cndmask_b32_e64 v89, v89, v14, s[94:95]
v_cndmask_b32_e64 v90, v90, v14, s[96:97]
v_cndmask_b32_e64 v91, v91, v14, s[98:99]
v_add_u32 v246, s72, v13
v_add_u32 v246, -16, v246
v_cmp_gt_i32_e64 s[84:85], 0, v246
v_cmp_gt_i32_e64 s[86:87], 1, v246
v_cmp_gt_i32_e64 s[88:89], 2, v246
v_cmp_gt_i32_e64 s[90:91], 3, v246
v_cndmask_b32_e64 v84, v84, v14, s[84:85]
v_cndmask_b32_e64 v85, v85, v14, s[86:87]
v_cndmask_b32_e64 v86, v86, v14, s[88:89]
v_cndmask_b32_e64 v87, v87, v14, s[90:91]
v_add_u32 v247, s72, v239
v_add_u32 v247, -16, v247
v_cmp_gt_i32_e64 s[92:93], 0, v247
v_cmp_gt_i32_e64 s[94:95], 1, v247
v_cmp_gt_i32_e64 s[96:97], 2, v247
v_cmp_gt_i32_e64 s[98:99], 3, v247
v_cndmask_b32_e64 v92, v92, v14, s[92:93]
v_cndmask_b32_e64 v93, v93, v14, s[94:95]
v_cndmask_b32_e64 v94, v94, v14, s[96:97]
v_cndmask_b32_e64 v95, v95, v14, s[98:99]
v_add_u32 v246, s72, v13
v_add_u32 v246, -32, v246
v_cmp_gt_i32_e64 s[84:85], 0, v246
v_cmp_gt_i32_e64 s[86:87], 1, v246
v_cmp_gt_i32_e64 s[88:89], 2, v246
v_cmp_gt_i32_e64 s[90:91], 3, v246
v_cndmask_b32_e64 v112, v112, v14, s[84:85]
v_cndmask_b32_e64 v113, v113, v14, s[86:87]
v_cndmask_b32_e64 v114, v114, v14, s[88:89]
v_cndmask_b32_e64 v115, v115, v14, s[90:91]
v_add_u32 v247, s72, v239
v_add_u32 v247, -32, v247
v_cmp_gt_i32_e64 s[92:93], 0, v247
v_cmp_gt_i32_e64 s[94:95], 1, v247
v_cmp_gt_i32_e64 s[96:97], 2, v247
v_cmp_gt_i32_e64 s[98:99], 3, v247
v_cndmask_b32_e64 v120, v120, v14, s[92:93]
v_cndmask_b32_e64 v121, v121, v14, s[94:95]
v_cndmask_b32_e64 v122, v122, v14, s[96:97]
v_cndmask_b32_e64 v123, v123, v14, s[98:99]
v_add_u32 v246, s72, v13
v_add_u32 v246, -48, v246
v_cmp_gt_i32_e64 s[84:85], 0, v246
v_cmp_gt_i32_e64 s[86:87], 1, v246
v_cmp_gt_i32_e64 s[88:89], 2, v246
v_cmp_gt_i32_e64 s[90:91], 3, v246
v_cndmask_b32_e64 v116, v116, v14, s[84:85]
v_cndmask_b32_e64 v117, v117, v14, s[86:87]
v_cndmask_b32_e64 v118, v118, v14, s[88:89]
v_cndmask_b32_e64 v119, v119, v14, s[90:91]
v_add_u32 v247, s72, v239
v_add_u32 v247, -48, v247
v_cmp_gt_i32_e64 s[92:93], 0, v247
v_cmp_gt_i32_e64 s[94:95], 1, v247
v_cmp_gt_i32_e64 s[96:97], 2, v247
v_cmp_gt_i32_e64 s[98:99], 3, v247
v_cndmask_b32_e64 v124, v124, v14, s[92:93]
v_cndmask_b32_e64 v125, v125, v14, s[94:95]
v_cndmask_b32_e64 v126, v126, v14, s[96:97]
v_cndmask_b32_e64 v127, v127, v14, s[98:99]
v_mov_b32 v242, v96
v_max3_f32 v242, v242, v80, v81
v_max3_f32 v242, v242, v82, v83
v_max3_f32 v242, v242, v84, v85
v_max3_f32 v242, v242, v86, v87
v_max3_f32 v242, v242, v112, v113
v_max3_f32 v242, v242, v114, v115
v_max3_f32 v242, v242, v116, v117
v_max3_f32 v242, v242, v118, v119
v_mov_b32 v243, v242
s_nop 1
v_permlane32_swap_b32 v242, v243
v_max_f32 v242, v242, v243
v_mov_b32 v243, v242
s_nop 1
v_permlane16_swap_b32 v242, v243
v_max_f32 v242, v242, v243
v_sub_f32 v98, v96, v242
v_exp_f32 v98, v98
v_mov_b32 v96, v242
v_sub_f32 v80, v80, v242
v_sub_f32 v81, v81, v242
v_sub_f32 v82, v82, v242
v_sub_f32 v83, v83, v242
v_sub_f32 v84, v84, v242
v_sub_f32 v85, v85, v242
v_sub_f32 v86, v86, v242
v_sub_f32 v87, v87, v242
v_sub_f32 v112, v112, v242
v_sub_f32 v113, v113, v242
v_sub_f32 v114, v114, v242
v_sub_f32 v115, v115, v242
v_sub_f32 v116, v116, v242
v_sub_f32 v117, v117, v242
v_sub_f32 v118, v118, v242
v_sub_f32 v119, v119, v242
v_mul_f32 v2, v2, v98
v_accvgpr_read_b32 v243, a0
v_mul_f32 v243, v243, v98
v_accvgpr_write_b32 a0, v243
v_accvgpr_read_b32 v243, a1
v_mul_f32 v243, v243, v98
v_accvgpr_write_b32 a1, v243
v_accvgpr_read_b32 v243, a2
v_mul_f32 v243, v243, v98
v_accvgpr_write_b32 a2, v243
v_accvgpr_read_b32 v243, a3
v_mul_f32 v243, v243, v98
v_accvgpr_write_b32 a3, v243
v_accvgpr_read_b32 v243, a4
v_mul_f32 v243, v243, v98
v_accvgpr_write_b32 a4, v243
v_accvgpr_read_b32 v243, a5
v_mul_f32 v243, v243, v98
v_accvgpr_write_b32 a5, v243
v_accvgpr_read_b32 v243, a6
v_mul_f32 v243, v243, v98
v_accvgpr_write_b32 a6, v243
v_accvgpr_read_b32 v243, a7
v_mul_f32 v243, v243, v98
v_accvgpr_write_b32 a7, v243
v_accvgpr_read_b32 v243, a8
v_mul_f32 v243, v243, v98
v_accvgpr_write_b32 a8, v243
v_accvgpr_read_b32 v243, a9
v_mul_f32 v243, v243, v98
v_accvgpr_write_b32 a9, v243
v_accvgpr_read_b32 v243, a10
v_mul_f32 v243, v243, v98
v_accvgpr_write_b32 a10, v243
v_accvgpr_read_b32 v243, a11
v_mul_f32 v243, v243, v98
v_accvgpr_write_b32 a11, v243
v_accvgpr_read_b32 v243, a12
v_mul_f32 v243, v243, v98
v_accvgpr_write_b32 a12, v243
v_accvgpr_read_b32 v243, a13
v_mul_f32 v243, v243, v98
v_accvgpr_write_b32 a13, v243
v_accvgpr_read_b32 v243, a14
v_mul_f32 v243, v243, v98
v_accvgpr_write_b32 a14, v243
v_accvgpr_read_b32 v243, a15
v_mul_f32 v243, v243, v98
v_accvgpr_write_b32 a15, v243
v_accvgpr_read_b32 v243, a16
v_mul_f32 v243, v243, v98
v_accvgpr_write_b32 a16, v243
v_accvgpr_read_b32 v243, a17
v_mul_f32 v243, v243, v98
v_accvgpr_write_b32 a17, v243
v_accvgpr_read_b32 v243, a18
v_mul_f32 v243, v243, v98
v_accvgpr_write_b32 a18, v243
v_accvgpr_read_b32 v243, a19
v_mul_f32 v243, v243, v98
v_accvgpr_write_b32 a19, v243
v_accvgpr_read_b32 v243, a20
v_mul_f32 v243, v243, v98
v_accvgpr_write_b32 a20, v243
v_accvgpr_read_b32 v243, a21
v_mul_f32 v243, v243, v98
v_accvgpr_write_b32 a21, v243
v_accvgpr_read_b32 v243, a22
v_mul_f32 v243, v243, v98
v_accvgpr_write_b32 a22, v243
v_accvgpr_read_b32 v243, a23
v_mul_f32 v243, v243, v98
v_accvgpr_write_b32 a23, v243
v_accvgpr_read_b32 v243, a24
v_mul_f32 v243, v243, v98
v_accvgpr_write_b32 a24, v243
v_accvgpr_read_b32 v243, a25
v_mul_f32 v243, v243, v98
v_accvgpr_write_b32 a25, v243
v_accvgpr_read_b32 v243, a26
v_mul_f32 v243, v243, v98
v_accvgpr_write_b32 a26, v243
v_accvgpr_read_b32 v243, a27
v_mul_f32 v243, v243, v98
v_accvgpr_write_b32 a27, v243
v_accvgpr_read_b32 v243, a28
v_mul_f32 v243, v243, v98
v_accvgpr_write_b32 a28, v243
v_accvgpr_read_b32 v243, a29
v_mul_f32 v243, v243, v98
v_accvgpr_write_b32 a29, v243
v_accvgpr_read_b32 v243, a30
v_mul_f32 v243, v243, v98
v_accvgpr_write_b32 a30, v243
v_accvgpr_read_b32 v243, a31
v_mul_f32 v243, v243, v98
v_accvgpr_write_b32 a31, v243
v_mov_b32 v242, v97
v_max3_f32 v242, v242, v88, v89
v_max3_f32 v242, v242, v90, v91
v_max3_f32 v242, v242, v92, v93
v_max3_f32 v242, v242, v94, v95
v_max3_f32 v242, v242, v120, v121
v_max3_f32 v242, v242, v122, v123
v_max3_f32 v242, v242, v124, v125
v_max3_f32 v242, v242, v126, v127
v_mov_b32 v243, v242
s_nop 1
v_permlane32_swap_b32 v242, v243
v_max_f32 v242, v242, v243
v_mov_b32 v243, v242
s_nop 1
v_permlane16_swap_b32 v242, v243
v_max_f32 v242, v242, v243
v_sub_f32 v99, v97, v242
v_exp_f32 v99, v99
v_mov_b32 v97, v242
v_sub_f32 v88, v88, v242
v_sub_f32 v89, v89, v242
v_sub_f32 v90, v90, v242
v_sub_f32 v91, v91, v242
v_sub_f32 v92, v92, v242
v_sub_f32 v93, v93, v242
v_sub_f32 v94, v94, v242
v_sub_f32 v95, v95, v242
v_sub_f32 v120, v120, v242
v_sub_f32 v121, v121, v242
v_sub_f32 v122, v122, v242
v_sub_f32 v123, v123, v242
v_sub_f32 v124, v124, v242
v_sub_f32 v125, v125, v242
v_sub_f32 v126, v126, v242
v_sub_f32 v127, v127, v242
v_mul_f32 v3, v3, v99
v_accvgpr_read_b32 v243, a32
v_mul_f32 v243, v243, v99
v_accvgpr_write_b32 a32, v243
v_accvgpr_read_b32 v243, a33
v_mul_f32 v243, v243, v99
v_accvgpr_write_b32 a33, v243
v_accvgpr_read_b32 v243, a34
v_mul_f32 v243, v243, v99
v_accvgpr_write_b32 a34, v243
v_accvgpr_read_b32 v243, a35
v_mul_f32 v243, v243, v99
v_accvgpr_write_b32 a35, v243
v_accvgpr_read_b32 v243, a36
v_mul_f32 v243, v243, v99
v_accvgpr_write_b32 a36, v243
v_accvgpr_read_b32 v243, a37
v_mul_f32 v243, v243, v99
v_accvgpr_write_b32 a37, v243
v_accvgpr_read_b32 v243, a38
v_mul_f32 v243, v243, v99
v_accvgpr_write_b32 a38, v243
v_accvgpr_read_b32 v243, a39
v_mul_f32 v243, v243, v99
v_accvgpr_write_b32 a39, v243
v_accvgpr_read_b32 v243, a40
v_mul_f32 v243, v243, v99
v_accvgpr_write_b32 a40, v243
v_accvgpr_read_b32 v243, a41
v_mul_f32 v243, v243, v99
v_accvgpr_write_b32 a41, v243
v_accvgpr_read_b32 v243, a42
v_mul_f32 v243, v243, v99
v_accvgpr_write_b32 a42, v243
v_accvgpr_read_b32 v243, a43
v_mul_f32 v243, v243, v99
v_accvgpr_write_b32 a43, v243
v_accvgpr_read_b32 v243, a44
v_mul_f32 v243, v243, v99
v_accvgpr_write_b32 a44, v243
v_accvgpr_read_b32 v243, a45
v_mul_f32 v243, v243, v99
v_accvgpr_write_b32 a45, v243
v_accvgpr_read_b32 v243, a46
v_mul_f32 v243, v243, v99
v_accvgpr_write_b32 a46, v243
v_accvgpr_read_b32 v243, a47
v_mul_f32 v243, v243, v99
v_accvgpr_write_b32 a47, v243
v_accvgpr_read_b32 v243, a48
v_mul_f32 v243, v243, v99
v_accvgpr_write_b32 a48, v243
v_accvgpr_read_b32 v243, a49
v_mul_f32 v243, v243, v99
v_accvgpr_write_b32 a49, v243
v_accvgpr_read_b32 v243, a50
v_mul_f32 v243, v243, v99
v_accvgpr_write_b32 a50, v243
v_accvgpr_read_b32 v243, a51
v_mul_f32 v243, v243, v99
v_accvgpr_write_b32 a51, v243
v_accvgpr_read_b32 v243, a52
v_mul_f32 v243, v243, v99
v_accvgpr_write_b32 a52, v243
v_accvgpr_read_b32 v243, a53
v_mul_f32 v243, v243, v99
v_accvgpr_write_b32 a53, v243
v_accvgpr_read_b32 v243, a54
v_mul_f32 v243, v243, v99
v_accvgpr_write_b32 a54, v243
v_accvgpr_read_b32 v243, a55
v_mul_f32 v243, v243, v99
v_accvgpr_write_b32 a55, v243
v_accvgpr_read_b32 v243, a56
v_mul_f32 v243, v243, v99
v_accvgpr_write_b32 a56, v243
v_accvgpr_read_b32 v243, a57
v_mul_f32 v243, v243, v99
v_accvgpr_write_b32 a57, v243
v_accvgpr_read_b32 v243, a58
v_mul_f32 v243, v243, v99
v_accvgpr_write_b32 a58, v243
v_accvgpr_read_b32 v243, a59
v_mul_f32 v243, v243, v99
v_accvgpr_write_b32 a59, v243
v_accvgpr_read_b32 v243, a60
v_mul_f32 v243, v243, v99
v_accvgpr_write_b32 a60, v243
v_accvgpr_read_b32 v243, a61
v_mul_f32 v243, v243, v99
v_accvgpr_write_b32 a61, v243
v_accvgpr_read_b32 v243, a62
v_mul_f32 v243, v243, v99
v_accvgpr_write_b32 a62, v243
v_accvgpr_read_b32 v243, a63
v_mul_f32 v243, v243, v99
v_accvgpr_write_b32 a63, v243
v_exp_f32 v80, v80
v_exp_f32 v81, v81
v_exp_f32 v82, v82
v_add_f32 v2, v2, v80
v_add_f32 v2, v2, v81
v_exp_f32 v83, v83
v_cvt_pk_bf16_f32 v80, v80, v81
v_exp_f32 v84, v84
v_add_f32 v2, v2, v82
v_add_f32 v2, v2, v83
v_exp_f32 v85, v85
v_cvt_pk_bf16_f32 v81, v82, v83
v_exp_f32 v86, v86
v_add_f32 v2, v2, v84
v_add_f32 v2, v2, v85
v_exp_f32 v87, v87
v_cvt_pk_bf16_f32 v82, v84, v85
v_exp_f32 v88, v88
v_add_f32 v2, v2, v86
v_add_f32 v2, v2, v87
v_exp_f32 v89, v89
v_cvt_pk_bf16_f32 v83, v86, v87
v_exp_f32 v90, v90
v_add_f32 v3, v3, v88
v_add_f32 v3, v3, v89
v_exp_f32 v91, v91
v_cvt_pk_bf16_f32 v88, v88, v89
v_exp_f32 v92, v92
v_add_f32 v3, v3, v90
v_add_f32 v3, v3, v91
v_exp_f32 v93, v93
v_cvt_pk_bf16_f32 v89, v90, v91
v_exp_f32 v94, v94
v_add_f32 v3, v3, v92
v_add_f32 v3, v3, v93
v_exp_f32 v95, v95
v_cvt_pk_bf16_f32 v90, v92, v93
v_exp_f32 v112, v112
v_add_f32 v3, v3, v94
v_add_f32 v3, v3, v95
v_exp_f32 v113, v113
v_cvt_pk_bf16_f32 v91, v94, v95
v_exp_f32 v114, v114
v_add_f32 v2, v2, v112
v_add_f32 v2, v2, v113
v_exp_f32 v115, v115
v_cvt_pk_bf16_f32 v112, v112, v113
v_exp_f32 v116, v116
v_add_f32 v2, v2, v114
v_add_f32 v2, v2, v115
v_exp_f32 v117, v117
v_cvt_pk_bf16_f32 v113, v114, v115
v_exp_f32 v118, v118
v_add_f32 v2, v2, v116
v_add_f32 v2, v2, v117
v_exp_f32 v119, v119
v_cvt_pk_bf16_f32 v114, v116, v117
v_exp_f32 v120, v120
v_add_f32 v2, v2, v118
v_add_f32 v2, v2, v119
v_exp_f32 v121, v121
v_cvt_pk_bf16_f32 v115, v118, v119
v_exp_f32 v122, v122
v_add_f32 v3, v3, v120
v_add_f32 v3, v3, v121
v_exp_f32 v123, v123
v_cvt_pk_bf16_f32 v120, v120, v121
v_exp_f32 v124, v124
v_add_f32 v3, v3, v122
v_add_f32 v3, v3, v123
v_exp_f32 v125, v125
v_cvt_pk_bf16_f32 v121, v122, v123
v_exp_f32 v126, v126
v_add_f32 v3, v3, v124
v_add_f32 v3, v3, v125
v_exp_f32 v127, v127
v_cvt_pk_bf16_f32 v122, v124, v125
v_add_f32 v3, v3, v126
v_add_f32 v3, v3, v127
v_cvt_pk_bf16_f32 v123, v126, v127
s_waitcnt lgkmcnt(15)
MA 0,a,192,v,80
MA 32,a,192,v,88
s_waitcnt lgkmcnt(14)
MA 4,a,196,v,80
MA 36,a,196,v,88
s_waitcnt lgkmcnt(13)
MA 8,a,200,v,80
MA 40,a,200,v,88
s_waitcnt lgkmcnt(12)
MA 12,a,204,v,80
MA 44,a,204,v,88
s_waitcnt lgkmcnt(11)
MA 16,a,208,v,80
MA 48,a,208,v,88
s_waitcnt lgkmcnt(10)
MA 20,a,212,v,80
MA 52,a,212,v,88
s_waitcnt lgkmcnt(9)
MA 24,a,216,v,80
MA 56,a,216,v,88
s_waitcnt lgkmcnt(8)
MA 28,a,220,v,80
MA 60,a,220,v,88
s_waitcnt lgkmcnt(7)
MA 0,a,224,v,112
MA 32,a,224,v,120
s_waitcnt lgkmcnt(6)
MA 4,a,228,v,112
MA 36,a,228,v,120
s_waitcnt lgkmcnt(5)
MA 8,a,232,v,112
MA 40,a,232,v,120
s_waitcnt lgkmcnt(4)
MA 12,a,236,v,112
MA 44,a,236,v,120
s_waitcnt lgkmcnt(3)
MA 16,a,240,v,112
MA 48,a,240,v,120
s_waitcnt lgkmcnt(2)
MA 20,a,244,v,112
MA 52,a,244,v,120
s_waitcnt lgkmcnt(1)
MA 24,a,248,v,112
MA 56,a,248,v,120
s_waitcnt lgkmcnt(0)
MA 28,a,252,v,112
MA 60,a,252,v,120
s_add_u32 s71, s71, 16384
s_sub_u32 s72, s72, 64
s_sub_u32 s74, s74, 1
s_nop 15
s_cmp_lg_u32 s74, 0
s_cbranch_scc1 L_fb_tile
v_mov_b32 v240, v2
s_nop 1
v_permlane32_swap_b32 v2, v240
v_add_f32 v2, v2, v240
v_mov_b32 v240, v2
s_nop 1
v_permlane16_swap_b32 v2, v240
v_add_f32 v2, v2, v240
v_mov_b32 v240, v3
s_nop 1
v_permlane32_swap_b32 v3, v240
v_add_f32 v3, v3, v240
v_mov_b32 v240, v3
s_nop 1
v_permlane16_swap_b32 v3, v240
v_add_f32 v3, v3, v240
v_rcp_f32 v2, v2
v_rcp_f32 v3, v3
s_add_u32 s80, s73, s76
s_nop 4
v_accvgpr_read_b32 v240, a0
v_accvgpr_read_b32 v241, a1
v_accvgpr_read_b32 v242, a2
v_accvgpr_read_b32 v243, a3
v_accvgpr_read_b32 v244, a4
v_accvgpr_read_b32 v245, a5
v_accvgpr_read_b32 v246, a6
v_accvgpr_read_b32 v247, a7
v_mul_f32 v240, v240, v2
v_mul_f32 v241, v241, v2
v_mul_f32 v242, v242, v2
v_mul_f32 v243, v243, v2
v_mul_f32 v244, v244, v2
v_mul_f32 v245, v245, v2
v_mul_f32 v246, v246, v2
v_mul_f32 v247, v247, v2
v_cvt_pk_bf16_f32 v248, v240, v241
v_cvt_pk_bf16_f32 v249, v242, v243
v_cvt_pk_bf16_f32 v250, v244, v245
v_cvt_pk_bf16_f32 v251, v246, v247
buffer_store_dwordx4 v[248:251], v15, s[60:63], s73 offen offset:0 sc1
v_accvgpr_read_b32 v240, a8
v_accvgpr_read_b32 v241, a9
v_accvgpr_read_b32 v242, a10
v_accvgpr_read_b32 v243, a11
v_accvgpr_read_b32 v244, a12
v_accvgpr_read_b32 v245, a13
v_accvgpr_read_b32 v246, a14
v_accvgpr_read_b32 v247, a15
v_mul_f32 v240, v240, v2
v_mul_f32 v241, v241, v2
v_mul_f32 v242, v242, v2
v_mul_f32 v243, v243, v2
v_mul_f32 v244, v244, v2
v_mul_f32 v245, v245, v2
v_mul_f32 v246, v246, v2
v_mul_f32 v247, v247, v2
v_cvt_pk_bf16_f32 v252, v240, v241
v_cvt_pk_bf16_f32 v253, v242, v243
v_cvt_pk_bf16_f32 v254, v244, v245
v_cvt_pk_bf16_f32 v255, v246, v247
buffer_store_dwordx4 v[252:255], v15, s[60:63], s73 offen offset:1024 sc1
v_accvgpr_read_b32 v240, a16
v_accvgpr_read_b32 v241, a17
v_accvgpr_read_b32 v242, a18
v_accvgpr_read_b32 v243, a19
v_accvgpr_read_b32 v244, a20
v_accvgpr_read_b32 v245, a21
v_accvgpr_read_b32 v246, a22
v_accvgpr_read_b32 v247, a23
v_mul_f32 v240, v240, v2
v_mul_f32 v241, v241, v2
v_mul_f32 v242, v242, v2
v_mul_f32 v243, v243, v2
v_mul_f32 v244, v244, v2
v_mul_f32 v245, v245, v2
v_mul_f32 v246, v246, v2
v_mul_f32 v247, v247, v2
v_cvt_pk_bf16_f32 v248, v240, v241
v_cvt_pk_bf16_f32 v249, v242, v243
v_cvt_pk_bf16_f32 v250, v244, v245
v_cvt_pk_bf16_f32 v251, v246, v247
buffer_store_dwordx4 v[248:251], v15, s[60:63], s73 offen offset:2048 sc1
v_accvgpr_read_b32 v240, a24
v_accvgpr_read_b32 v241, a25
v_accvgpr_read_b32 v242, a26
v_accvgpr_read_b32 v243, a27
v_accvgpr_read_b32 v244, a28
v_accvgpr_read_b32 v245, a29
v_accvgpr_read_b32 v246, a30
v_accvgpr_read_b32 v247, a31
v_mul_f32 v240, v240, v2
v_mul_f32 v241, v241, v2
v_mul_f32 v242, v242, v2
v_mul_f32 v243, v243, v2
v_mul_f32 v244, v244, v2
v_mul_f32 v245, v245, v2
v_mul_f32 v246, v246, v2
v_mul_f32 v247, v247, v2
v_cvt_pk_bf16_f32 v252, v240, v241
v_cvt_pk_bf16_f32 v253, v242, v243
v_cvt_pk_bf16_f32 v254, v244, v245
v_cvt_pk_bf16_f32 v255, v246, v247
buffer_store_dwordx4 v[252:255], v15, s[60:63], s73 offen offset:3072 sc1
v_accvgpr_read_b32 v240, a32
v_accvgpr_read_b32 v241, a33
v_accvgpr_read_b32 v242, a34
v_accvgpr_read_b32 v243, a35
v_accvgpr_read_b32 v244, a36
v_accvgpr_read_b32 v245, a37
v_accvgpr_read_b32 v246, a38
v_accvgpr_read_b32 v247, a39
v_mul_f32 v240, v240, v3
v_mul_f32 v241, v241, v3
v_mul_f32 v242, v242, v3
v_mul_f32 v243, v243, v3
v_mul_f32 v244, v244, v3
v_mul_f32 v245, v245, v3
v_mul_f32 v246, v246, v3
v_mul_f32 v247, v247, v3
v_cvt_pk_bf16_f32 v248, v240, v241
v_cvt_pk_bf16_f32 v249, v242, v243
v_cvt_pk_bf16_f32 v250, v244, v245
v_cvt_pk_bf16_f32 v251, v246, v247
buffer_store_dwordx4 v[248:251], v15, s[60:63], s80 offen offset:0 sc1
v_accvgpr_read_b32 v240, a40
v_accvgpr_read_b32 v241, a41
v_accvgpr_read_b32 v242, a42
v_accvgpr_read_b32 v243, a43
v_accvgpr_read_b32 v244, a44
v_accvgpr_read_b32 v245, a45
v_accvgpr_read_b32 v246, a46
v_accvgpr_read_b32 v247, a47
v_mul_f32 v240, v240, v3
v_mul_f32 v241, v241, v3
v_mul_f32 v242, v242, v3
v_mul_f32 v243, v243, v3
v_mul_f32 v244, v244, v3
v_mul_f32 v245, v245, v3
v_mul_f32 v246, v246, v3
v_mul_f32 v247, v247, v3
v_cvt_pk_bf16_f32 v252, v240, v241
v_cvt_pk_bf16_f32 v253, v242, v243
v_cvt_pk_bf16_f32 v254, v244, v245
v_cvt_pk_bf16_f32 v255, v246, v247
buffer_store_dwordx4 v[252:255], v15, s[60:63], s80 offen offset:1024 sc1
v_accvgpr_read_b32 v240, a48
v_accvgpr_read_b32 v241, a49
v_accvgpr_read_b32 v242, a50
v_accvgpr_read_b32 v243, a51
v_accvgpr_read_b32 v244, a52
v_accvgpr_read_b32 v245, a53
v_accvgpr_read_b32 v246, a54
v_accvgpr_read_b32 v247, a55
v_mul_f32 v240, v240, v3
v_mul_f32 v241, v241, v3
v_mul_f32 v242, v242, v3
v_mul_f32 v243, v243, v3
v_mul_f32 v244, v244, v3
v_mul_f32 v245, v245, v3
v_mul_f32 v246, v246, v3
v_mul_f32 v247, v247, v3
v_cvt_pk_bf16_f32 v248, v240, v241
v_cvt_pk_bf16_f32 v249, v242, v243
v_cvt_pk_bf16_f32 v250, v244, v245
v_cvt_pk_bf16_f32 v251, v246, v247
buffer_store_dwordx4 v[248:251], v15, s[60:63], s80 offen offset:2048 sc1
v_accvgpr_read_b32 v240, a56
v_accvgpr_read_b32 v241, a57
v_accvgpr_read_b32 v242, a58
v_accvgpr_read_b32 v243, a59
v_accvgpr_read_b32 v244, a60
v_accvgpr_read_b32 v245, a61
v_accvgpr_read_b32 v246, a62
v_accvgpr_read_b32 v247, a63
v_mul_f32 v240, v240, v3
v_mul_f32 v241, v241, v3
v_mul_f32 v242, v242, v3
v_mul_f32 v243, v243, v3
v_mul_f32 v244, v244, v3
v_mul_f32 v245, v245, v3
v_mul_f32 v246, v246, v3
v_mul_f32 v247, v247, v3
v_cvt_pk_bf16_f32 v252, v240, v241
v_cvt_pk_bf16_f32 v253, v242, v243
v_cvt_pk_bf16_f32 v254, v244, v245
v_cvt_pk_bf16_f32 v255, v246, v247
buffer_store_dwordx4 v[252:255], v15, s[60:63], s80 offen offset:3072 sc1
s_cmp_lg_u32 s81, 0
s_cbranch_scc1 L_fb_done
s_mov_b32 s81, 1
s_sub_u32 s74, 34, s77
s_mov_b32 s73, s101
s_mov_b32 s72, s70
v_mov_b32 v16, v48
v_mov_b32 v17, v49
v_mov_b32 v18, v50
v_mov_b32 v19, v51
v_mov_b32 v20, v52
v_mov_b32 v21, v53
v_mov_b32 v22, v54
v_mov_b32 v23, v55
v_mov_b32 v24, v56
v_mov_b32 v25, v57
v_mov_b32 v26, v58
v_mov_b32 v27, v59
v_mov_b32 v28, v60
v_mov_b32 v29, v61
v_mov_b32 v30, v62
v_mov_b32 v31, v63
v_mov_b32 v32, v64
v_mov_b32 v33, v65
v_mov_b32 v34, v66
v_mov_b32 v35, v67
v_mov_b32 v36, v68
v_mov_b32 v37, v69
v_mov_b32 v38, v70
v_mov_b32 v39, v71
v_mov_b32 v40, v72
v_mov_b32 v41, v73
v_mov_b32 v42, v74
v_mov_b32 v43, v75
v_mov_b32 v44, v76
v_mov_b32 v45, v77
v_mov_b32 v46, v78
v_mov_b32 v47, v79
s_branch L_fb_set
L_fb_done:
s_waitcnt vmcnt(0) lgkmcnt(0)
s_barrier
s_load_dwordx2 s[88:89], s[0:1], 104
s_mul_i32 s36, s3, 8320
v_and_b32 v16, 15, v1
v_lshrrev_b32 v17, 4, v1
v_add_u32 v18, 1, v16
v_and_b32 v19, 1, v18
v_mul_u32_u24 v19, 4160, v19
v_add_u32 v18, 2, v16
v_lshrrev_b32 v18, 1, v18
v_lshl_add_u32 v19, v18, 2, v19
v_lshl_add_u32 v19, v17, 4, v19
v_add_u32 v40, s36, v19
v_add_u32 v41, 1024, v40
v_add_u32 v42, 2048, v40
v_add_u32 v43, 3072, v40
v_add_u32 v10, s36, v232
v_lshlrev_b32 v18, 5, v16
v_lshlrev_b32 v19, 4, v17
v_sub_u32 v19, v19, v18
s_add_u32 s37, s43, 480
v_add_u32 v5, s37, v19
v_mov_b32 v20, 0
v_mov_b32 v21, 0
v_mov_b32 v22, 0
v_mov_b32 v23, 0
v_and_b32 v16, 1, v1
v_mul_u32_u24 v16, 4160, v16
v_and_b32 v17, 2, v1
v_lshl_add_u32 v16, v17, 3, v16
v_add_u32 v16, s36, v16
ds_write_b128 v16, v[20:23]
v_and_b32 v17, 31, v1
v_lshlrev_b32 v17, 4, v17
v_add_u32 v17, s43, v17
ds_write_b128 v17, v[20:23] offset:4096
ds_write_b128 v10, v[210:213] offset:32
v_alignbit_b32 v24, v210, v209, 16
v_alignbit_b32 v25, v211, v210, 16
v_alignbit_b32 v26, v212, v211, 16
v_alignbit_b32 v27, v213, v212, 16
ds_write_b128 v10, v[24:27] offset:4192
ds_write_b128 v10, v[216:219] offset:1056
v_alignbit_b32 v28, v216, v215, 16
v_alignbit_b32 v29, v217, v216, 16
v_alignbit_b32 v30, v218, v217, 16
v_alignbit_b32 v31, v219, v218, 16
ds_write_b128 v10, v[28:31] offset:5216
ds_write_b128 v10, v[222:225] offset:2080
v_alignbit_b32 v24, v222, v221, 16
v_alignbit_b32 v25, v223, v222, 16
v_alignbit_b32 v26, v224, v223, 16
v_alignbit_b32 v27, v225, v224, 16
ds_write_b128 v10, v[24:27] offset:6240
ds_write_b128 v10, v[228:231] offset:3104
v_alignbit_b32 v28, v228, v227, 16
v_alignbit_b32 v29, v229, v228, 16
v_alignbit_b32 v30, v230, v229, 16
v_alignbit_b32 v31, v231, v230, 16
ds_write_b128 v10, v[28:31] offset:7264
s_waitcnt lgkmcnt(0)
s_branch L_p3_done
L_spin_go:
s_mov_b32 s36, 400000
L_spin_go_l:
s_sleep 1
buffer_load_dword v254, off, s[12:15], 0 sc1
s_waitcnt vmcnt(0)
v_cmp_gt_u32 vcc, 1, v254
s_nop 4
s_cbranch_vccz L_spin_go_ret
s_sub_u32 s36, s36, 1
s_cmp_lg_u32 s36, 0
s_cbranch_scc1 L_spin_go_l
s_branch L_spin_go_ret
L_spin_f1:
s_mov_b32 s36, 400000
L_spin_f1_l:
s_sleep 1
buffer_load_dword v237, v233, s[8:11], 0 offen offset:0 sc1
s_waitcnt vmcnt(0)
v_cmp_gt_u32 vcc, 1, v237
s_nop 4
s_cbranch_vccz L_spin_f1_ret
s_sub_u32 s36, s36, 1
s_cmp_lg_u32 s36, 0
s_cbranch_scc1 L_spin_f1_l
s_branch L_spin_f1_ret
L_spin_w:
s_mov_b32 s36, 400000
L_spin_w_l:
s_sleep 1
buffer_load_dword v253, v254, s[8:11], 0 offen offset:1024 sc1
s_waitcnt vmcnt(0)
v_cmp_gt_u32 vcc, 1, v253
s_nop 4
s_cbranch_vccz L_spin_w_ret
s_sub_u32 s36, s36, 1
s_cmp_lg_u32 s36, 0
s_cbranch_scc1 L_spin_w_l
s_branch L_spin_w_ret
L_spin_f2:
s_mov_b32 s36, 400000
L_spin_f2_l:
s_sleep 1
buffer_load_dword v253, v252, s[8:11], 0 offen sc1
s_waitcnt vmcnt(0)
v_cmp_gt_u32 vcc, 1, v253
s_nop 4
s_cbranch_vccz L_spin_f2_ret
s_sub_u32 s36, s36, 1
s_cmp_lg_u32 s36, 0
s_cbranch_scc1 L_spin_f2_l
s_branch L_spin_f2_ret
L_p5_x1:
v_mov_b32 v253, 1
s_lshl_b32 s36, s2, 2
buffer_store_dword v253, v255, s[8:11], s36 offen offset:2048 sc1
v_and_b32 v254, 15, v1
s_lshl_b32 s36, s82, 4
v_add_u32 v254, s36, v254
v_lshlrev_b32 v254, 2, v254
s_branch L_p5_loop
L_p5_x2:
buffer_load_dword v253, v254, s[8:11], 0 offen offset:2048 sc1
s_branch L_p5_loop
L_spin_f3:
s_mov_b32 s36, 400000
L_spin_f3_l:
s_sleep 1
buffer_load_dword v253, v254, s[8:11], 0 offen offset:2048 sc1
s_waitcnt vmcnt(0)
v_cmp_gt_u32 vcc, 1, v253
s_nop 4
s_cbranch_vccz L_spin_f3_ret
s_sub_u32 s36, s36, 1
s_cmp_lg_u32 s36, 0
s_cbranch_scc1 L_spin_f3_l
s_branch L_spin_f3_ret
L_code_end:
s_endpgm
.section .rodata,"a"
.p2align 6
.amdhsa_kernel gated_mix__ssm_conv_h3__compressed_kv_cla__prompt_kernel
  .amdhsa_next_free_vgpr 512
  .amdhsa_next_free_sgpr 102
  .amdhsa_accum_offset 256
  .amdhsa_group_segment_fixed_size 0
  .amdhsa_kernarg_size 128
  .amdhsa_user_sgpr_count 2
  .amdhsa_user_sgpr_kernarg_segment_ptr 1
  .amdhsa_system_sgpr_workgroup_id_x 1
  .amdhsa_float_denorm_mode_32 3
.end_amdhsa_kernel
.text
```

```asm
; @launch grid=(256,1,1) block=(256,1,1) lds=163840
.amdgcn_target "amdgcn-amd-amdhsa--gfx950"
.text
.macro MA d,x,a,y,b
v_mfma_f32_16x16x32_bf16 a[\d:\d+3], \x[\a:\a+3], \y[\b:\b+3], a[\d:\d+3]
.endm
.macro MV d,x,a,y,b
v_mfma_f32_16x16x32_bf16 v[\d:\d+3], \x[\a:\a+3], \y[\b:\b+3], v[\d:\d+3]
.endm
.macro TR d,a,o
ds_read_b64_tr_b16 v[\d:\d+1], v\a offset:\o
.endm
.globl gated_mix__ssm_conv_h3__compressed_kv_cla__prompt_kernel
.p2align 8
.type gated_mix__ssm_conv_h3__compressed_kv_cla__prompt_kernel,@function
gated_mix__ssm_conv_h3__compressed_kv_cla__prompt_kernel:
s_cmp_ge_u32 s2, 256
s_cbranch_scc1 L_end
s_load_dwordx2 s[44:45], s[0:1], 56
s_load_dwordx4 s[48:51], s[0:1], 72
s_load_dwordx2 s[40:41], s[0:1], 120
s_load_dwordx2 s[52:53], s[0:1], 112
s_load_dwordx2 s[32:33], s[0:1], 0
s_load_dwordx2 s[34:35], s[0:1], 64
v_lshrrev_b32 v2, 6, v0
v_and_b32 v1, 63, v0
v_lshlrev_b32 v3, 4, v0
v_readfirstlane_b32 s3, v2
s_getpc_b64 s[4:5]
L_ct_e:
s_add_u32 s4, s4, L_p1_K - L_ct_e
s_addc_u32 s5, s5, 0
v_mov_b32 v77, s5
v_mov_b32 v76, s4
s_lshr_b32 s4, s2, 3
s_lshl_b32 s4, s4, 2
s_add_u32 s4, s4, s3
s_lshl_b32 s4, s4, 7
v_and_b32 v79, 3, v1
v_lshlrev_b32 v79, 14, v79
v_add_u32 v79, s4, v79
v_min_u32 v79, L_p3_begin - L_p1_K - 4, v79
v_add_co_u32 v76, vcc, v76, v79
s_nop 1
v_addc_co_u32 v77, vcc, 0, v77, vcc
global_load_dword v79, v[76:77], off
s_and_b32 s36, s2, 7
s_lshr_b32 s37, s2, 3
s_and_b32 s38, s37, 7
s_lshr_b32 s37, s37, 3
s_lshr_b32 s42, s37, 1
s_and_b32 s37, s37, 1
s_lshl_b32 s36, s36, 1
s_add_u32 s36, s36, s37
s_lshl_b32 s24, s38, 18
s_lshl_b32 s39, s3, 16
s_add_u32 s24, s24, s39
s_lshl_b32 s25, s3, 17
s_lshl_b32 s39, s36, 9
s_add_u32 s25, s25, s39
s_and_b32 s20, s2, 7
s_lshl_b32 s21, s20, 19
s_lshl_b32 s20, s20, 7
s_lshl_b32 s22, s3, 13
s_add_u32 s23, s22, 98304
v_lshrrev_b32 v204, 3, v1
v_lshlrev_b32 v204, 10, v204
v_lshrrev_b32 v205, 4, v1
v_and_b32 v206, 7, v1
v_xor_b32 v206, v206, v205
v_lshl_add_u32 v204, v206, 4, v204
v_xor_b32 v207, 64, v204
v_add_u32 v176, 0, v204
v_add_u32 v177, 7168, v207
v_add_u32 v178, 14336, v204
v_add_u32 v179, 21504, v207
v_add_u32 v180, 32768, v204
v_add_u32 v181, 39936, v207
v_add_u32 v182, 47104, v204
v_add_u32 v183, 54272, v207
v_lshrrev_b32 v204, 5, v1
v_and_b32 v206, 31, v1
v_lshlrev_b32 v207, 1, v204
v_xor_b32 v206, v206, v207
v_lshlrev_b32 v204, 13, v204
v_xor_b32 v207, 0, v206
v_lshl_add_u32 v207, v207, 4, v204
v_add_u32 v184, 0, v207
v_xor_b32 v207, 4, v206
v_lshl_add_u32 v207, v207, 4, v204
v_add_u32 v185, 15360, v207
v_xor_b32 v207, 0, v206
v_lshl_add_u32 v207, v207, 4, v204
v_add_u32 v186, 30720, v207
v_xor_b32 v207, 4, v206
v_lshl_add_u32 v207, v207, 4, v204
v_add_u32 v187, 46080, v207
v_xor_b32 v207, 8, v206
v_lshl_add_u32 v207, v207, 4, v204
v_add_u32 v188, 65536, v207
v_xor_b32 v207, 12, v206
v_lshl_add_u32 v207, v207, 4, v204
v_add_u32 v189, 80896, v207
v_xor_b32 v207, 8, v206
v_lshl_add_u32 v207, v207, 4, v204
v_add_u32 v190, 96256, v207
v_xor_b32 v207, 12, v206
v_lshl_add_u32 v207, v207, 4, v204
v_add_u32 v191, 111616, v207
s_waitcnt lgkmcnt(0)
s_add_u32 s8, s44, s24
s_addc_u32 s9, s45, 0
s_mov_b32 s10, 65536
s_mov_b32 s11, 0x20000
s_cmp_eq_u32 s42, 0
s_cselect_b32 s12, s48, s50
s_cselect_b32 s13, s49, s51
s_add_u32 s12, s12, s25
s_addc_u32 s13, s13, 0
s_sub_u32 s14, 4194304, s25
s_mov_b32 s15, 0x20000
s_add_u32 s4, s40, 59768832
s_addc_u32 s5, s41, 0
s_mov_b32 s6, 8192
s_mov_b32 s7, 0x20000
s_lshl_b32 s43, s2, 20
v_add_u32 v3, s43, v3
v_mov_b32 v4, 0
v_mov_b32 v5, 0
v_mov_b32 v6, 0
v_mov_b32 v7, 0
s_movk_i32 s43, 4096
buffer_store_dwordx4 v[4:7], v3, s[4:7], 0 offen sc1
buffer_store_dwordx4 v[4:7], v3, s[4:7], s43 offen sc1
s_waitcnt vmcnt(2)
v_lshlrev_b32 v79, 16, v3
s_add_u32 m0, s23, 0
s_nop 0
buffer_load_dwordx4 v184, s[12:15], s21 offen offset:0 lds
buffer_load_dwordx4 v185, s[12:15], s21 offen offset:1024 lds
buffer_load_dwordx4 v186, s[12:15], s21 offen offset:2048 lds
buffer_load_dwordx4 v187, s[12:15], s21 offen offset:3072 lds
s_add_u32 m0, s23, 4096
s_nop 0
buffer_load_dwordx4 v188, s[12:15], s21 offen offset:0 lds
buffer_load_dwordx4 v189, s[12:15], s21 offen offset:1024 lds
buffer_load_dwordx4 v190, s[12:15], s21 offen offset:2048 lds
buffer_load_dwordx4 v191, s[12:15], s21 offen offset:3072 lds
s_add_u32 s21, s21, 524288
s_and_b32 s21, s21, 4194303
s_add_u32 m0, s22, 0
s_nop 0
buffer_load_dwordx4 v176, s[8:11], s20 offen offset:0 lds
buffer_load_dwordx4 v177, s[8:11], s20 offen offset:1024 lds
buffer_load_dwordx4 v178, s[8:11], s20 offen offset:2048 lds
buffer_load_dwordx4 v179, s[8:11], s20 offen offset:3072 lds
s_add_u32 m0, s22, 4096
s_nop 0
buffer_load_dwordx4 v180, s[8:11], s20 offen offset:0 lds
buffer_load_dwordx4 v181, s[8:11], s20 offen offset:1024 lds
buffer_load_dwordx4 v182, s[8:11], s20 offen offset:2048 lds
buffer_load_dwordx4 v183, s[8:11], s20 offen offset:3072 lds
s_add_u32 s20, s20, 128
s_and_b32 s20, s20, 1023
v_and_b32 v204, 15, v1
v_lshrrev_b32 v206, 1, v204
v_xor_b32 v206, v206, v205
v_lshlrev_b32 v206, 4, v206
v_lshl_add_u32 v206, v204, 7, v206
s_and_b32 s39, s3, 1
s_lshl_b32 s39, s39, 14
v_add_u32 v192, s39, v206
v_xor_b32 v193, 64, v192
v_add_u32 v194, 0x10000, v192
v_add_u32 v195, 0x10000, v193
v_bfe_u32 v204, v1, 2, 2
v_and_b32 v206, 1, v205
v_lshl_or_b32 v206, v206, 2, v204
v_lshl_add_u32 v204, v205, 3, v204
v_lshlrev_b32 v204, 9, v204
v_and_b32 v207, 3, v1
v_lshl_add_u32 v204, v207, 3, v204
s_lshr_b32 s39, s3, 1
s_lshl_b32 s39, s39, 8
s_add_u32 s39, s39, 98304
v_add_u32 v204, s39, v204
v_xor_b32 v207, 0, v206
v_lshl_add_u32 v196, v207, 5, v204
v_xor_b32 v207, 1, v206
v_lshl_add_u32 v197, v207, 5, v204
v_xor_b32 v207, 2, v206
v_lshl_add_u32 v198, v207, 5, v204
v_xor_b32 v207, 3, v206
v_lshl_add_u32 v199, v207, 5, v204
v_xor_b32 v207, 4, v206
v_lshl_add_u32 v200, v207, 5, v204
v_xor_b32 v207, 5, v206
v_lshl_add_u32 v201, v207, 5, v204
v_xor_b32 v207, 6, v206
v_lshl_add_u32 v202, v207, 5, v204
v_xor_b32 v207, 7, v206
v_lshl_add_u32 v203, v207, 5, v204
s_lshl_b32 s36, s36, 1
s_lshr_b32 s39, s3, 1
s_add_u32 s36, s36, s39
s_lshl_b32 s24, s36, 19
s_lshl_b32 s38, s38, 16
s_add_u32 s24, s24, s38
s_and_b32 s39, s3, 1
s_lshl_b32 s39, s39, 15
s_add_u32 s24, s24, s39
s_lshl_b32 s36, s42, 24
s_add_u32 s16, s40, s36
s_addc_u32 s17, s41, 0
s_mov_b32 s18, 16777216
s_mov_b32 s19, 0x20000
s_mov_b32 s54, 256
s_mov_b32 s55, 0x20000
v_mov_b32 v78, 1
s_cmp_lg_u32 s2, 0
s_cselect_b32 s43, 0x10000000, 0
v_or_b32 v79, s43, v79
s_waitcnt vmcnt(0)
s_barrier
buffer_store_dword v78, v79, s[52:55], 0 offen sc1
ds_read_b128 v[80:83], v192 offset:0
ds_read_b128 v[84:87], v192 offset:2048
ds_read_b128 v[88:91], v192 offset:4096
ds_read_b128 v[92:95], v192 offset:6144
ds_read_b128 v[96:99], v192 offset:8192
ds_read_b128 v[100:103], v192 offset:10240
ds_read_b128 v[104:107], v192 offset:12288
ds_read_b128 v[108:111], v192 offset:14336
TR 144,196,0
TR 146,196,2048
TR 148,197,0
TR 150,197,2048
TR 152,198,0
TR 154,198,2048
TR 156,199,0
TR 158,199,2048
TR 160,200,0
TR 162,200,2048
TR 164,201,0
TR 166,201,2048
TR 168,202,0
TR 170,202,2048
TR 172,203,0
TR 174,203,2048
s_cmp_eq_u32 s42, 0
s_cbranch_scc0 L_p1_V
L_p1_K:
s_waitcnt lgkmcnt(14)
v_mfma_f32_16x16x32_bf16 a[0:3], v[144:147], v[80:83], 0
s_add_u32 m0, s23, 32768
s_waitcnt lgkmcnt(12)
v_mfma_f32_16x16x32_bf16 a[4:7], v[148:151], v[80:83], 0
ds_read_b128 v[112:115], v193 offset:0
v_mfma_f32_16x16x32_bf16 a[32:35], v[144:147], v[84:87], 0
buffer_load_dwordx4 v184, s[12:15], s21 offen offset:0 lds
v_mfma_f32_16x16x32_bf16 a[36:39], v[148:151], v[84:87], 0
v_mfma_f32_16x16x32_bf16 a[64:67], v[144:147], v[88:91], 0
v_mfma_f32_16x16x32_bf16 a[68:71], v[148:151], v[88:91], 0
buffer_load_dwordx4 v185, s[12:15], s21 offen offset:1024 lds
v_mfma_f32_16x16x32_bf16 a[96:99], v[144:147], v[92:95], 0
v_mfma_f32_16x16x32_bf16 a[100:103], v[148:151], v[92:95], 0
ds_read_b128 v[116:119], v193 offset:2048
buffer_load_dwordx4 v186, s[12:15], s21 offen offset:2048 lds
v_mfma_f32_16x16x32_bf16 a[128:131], v[144:147], v[96:99], 0
v_mfma_f32_16x16x32_bf16 a[132:135], v[148:151], v[96:99], 0
v_mfma_f32_16x16x32_bf16 a[160:163], v[144:147], v[100:103], 0
buffer_load_dwordx4 v187, s[12:15], s21 offen offset:3072 lds
v_mfma_f32_16x16x32_bf16 a[164:167], v[148:151], v[100:103], 0
v_mfma_f32_16x16x32_bf16 a[192:195], v[144:147], v[104:107], 0
s_add_u32 m0, s23, 36864
v_mfma_f32_16x16x32_bf16 a[196:199], v[148:151], v[104:107], 0
ds_read_b128 v[120:123], v193 offset:4096
v_mfma_f32_16x16x32_bf16 a[224:227], v[144:147], v[108:111], 0
TR 144,196,16384
TR 146,196,18432
v_mfma_f32_16x16x32_bf16 a[228:231], v[148:151], v[108:111], 0
TR 148,197,16384
TR 150,197,18432
s_waitcnt lgkmcnt(15)
v_mfma_f32_16x16x32_bf16 a[232:235], v[152:155], v[108:111], 0
buffer_load_dwordx4 v188, s[12:15], s21 offen offset:0 lds
v_mfma_f32_16x16x32_bf16 a[236:239], v[156:159], v[108:111], 0
v_mfma_f32_16x16x32_bf16 a[200:203], v[152:155], v[104:107], 0
buffer_load_dwordx4 v189, s[12:15], s21 offen offset:1024 lds
v_mfma_f32_16x16x32_bf16 a[204:207], v[156:159], v[104:107], 0
v_mfma_f32_16x16x32_bf16 a[168:171], v[152:155], v[100:103], 0
ds_read_b128 v[124:127], v193 offset:6144
buffer_load_dwordx4 v190, s[12:15], s21 offen offset:2048 lds
v_mfma_f32_16x16x32_bf16 a[172:175], v[156:159], v[100:103], 0
v_mfma_f32_16x16x32_bf16 a[136:139], v[152:155], v[96:99], 0
v_mfma_f32_16x16x32_bf16 a[140:143], v[156:159], v[96:99], 0
buffer_load_dwordx4 v191, s[12:15], s21 offen offset:3072 lds
v_mfma_f32_16x16x32_bf16 a[104:107], v[152:155], v[92:95], 0
v_mfma_f32_16x16x32_bf16 a[108:111], v[156:159], v[92:95], 0
s_add_u32 s21, s21, 524288
v_mfma_f32_16x16x32_bf16 a[72:75], v[152:155], v[88:91], 0
ds_read_b128 v[128:131], v193 offset:8192
v_mfma_f32_16x16x32_bf16 a[76:79], v[156:159], v[88:91], 0
v_mfma_f32_16x16x32_bf16 a[40:43], v[152:155], v[84:87], 0
s_and_b32 s21, s21, 4194303
v_mfma_f32_16x16x32_bf16 a[44:47], v[156:159], v[84:87], 0
v_mfma_f32_16x16x32_bf16 a[8:11], v[152:155], v[80:83], 0
TR 152,198,16384
TR 154,198,18432
v_mfma_f32_16x16x32_bf16 a[12:15], v[156:159], v[80:83], 0
TR 156,199,16384
TR 158,199,18432
s_waitcnt lgkmcnt(15)
v_mfma_f32_16x16x32_bf16 a[16:19], v[160:163], v[80:83], 0
ds_read_b128 v[132:135], v193 offset:10240
s_add_u32 m0, s22, 32768
v_mfma_f32_16x16x32_bf16 a[20:23], v[164:167], v[80:83], 0
buffer_load_dwordx4 v176, s[8:11], s20 offen offset:0 lds
v_mfma_f32_16x16x32_bf16 a[48:51], v[160:163], v[84:87], 0
v_mfma_f32_16x16x32_bf16 a[52:55], v[164:167], v[84:87], 0
v_mfma_f32_16x16x32_bf16 a[80:83], v[160:163], v[88:91], 0
buffer_load_dwordx4 v177, s[8:11], s20 offen offset:1024 lds
v_mfma_f32_16x16x32_bf16 a[84:87], v[164:167], v[88:91], 0
v_mfma_f32_16x16x32_bf16 a[112:115], v[160:163], v[92:95], 0
buffer_load_dwordx4 v178, s[8:11], s20 offen offset:2048 lds
v_mfma_f32_16x16x32_bf16 a[116:119], v[164:167], v[92:95], 0
ds_read_b128 v[136:139], v193 offset:12288
v_mfma_f32_16x16x32_bf16 a[144:147], v[160:163], v[96:99], 0
v_mfma_f32_16x16x32_bf16 a[148:151], v[164:167], v[96:99], 0
buffer_load_dwordx4 v179, s[8:11], s20 offen offset:3072 lds
v_mfma_f32_16x16x32_bf16 a[176:179], v[160:163], v[100:103], 0
v_mfma_f32_16x16x32_bf16 a[180:183], v[164:167], v[100:103], 0
s_add_u32 m0, s22, 36864
v_mfma_f32_16x16x32_bf16 a[208:211], v[160:163], v[104:107], 0
v_mfma_f32_16x16x32_bf16 a[212:215], v[164:167], v[104:107], 0
ds_read_b128 v[140:143], v193 offset:14336
v_mfma_f32_16x16x32_bf16 a[240:243], v[160:163], v[108:111], 0
TR 160,200,16384
TR 162,200,18432
v_mfma_f32_16x16x32_bf16 a[244:247], v[164:167], v[108:111], 0
TR 164,201,16384
TR 166,201,18432
v_mfma_f32_16x16x32_bf16 a[248:251], v[168:171], v[108:111], 0
buffer_load_dwordx4 v180, s[8:11], s20 offen offset:0 lds
s_waitcnt lgkmcnt(15)
v_mfma_f32_16x16x32_bf16 a[252:255], v[172:175], v[108:111], 0
buffer_load_dwordx4 v181, s[8:11], s20 offen offset:1024 lds
v_mfma_f32_16x16x32_bf16 a[216:219], v[168:171], v[104:107], 0
v_mfma_f32_16x16x32_bf16 a[220:223], v[172:175], v[104:107], 0
buffer_load_dwordx4 v182, s[8:11], s20 offen offset:2048 lds
v_mfma_f32_16x16x32_bf16 a[184:187], v[168:171], v[100:103], 0
v_mfma_f32_16x16x32_bf16 a[188:191], v[172:175], v[100:103], 0
v_mfma_f32_16x16x32_bf16 a[152:155], v[168:171], v[96:99], 0
buffer_load_dwordx4 v183, s[8:11], s20 offen offset:3072 lds
v_mfma_f32_16x16x32_bf16 a[156:159], v[172:175], v[96:99], 0
v_mfma_f32_16x16x32_bf16 a[120:123], v[168:171], v[92:95], 0
s_add_u32 s20, s20, 128
v_mfma_f32_16x16x32_bf16 a[124:127], v[172:175], v[92:95], 0
v_mfma_f32_16x16x32_bf16 a[88:91], v[168:171], v[88:91], 0
v_mfma_f32_16x16x32_bf16 a[92:95], v[172:175], v[88:91], 0
s_and_b32 s20, s20, 1023
v_mfma_f32_16x16x32_bf16 a[56:59], v[168:171], v[84:87], 0
v_mfma_f32_16x16x32_bf16 a[60:63], v[172:175], v[84:87], 0
v_mfma_f32_16x16x32_bf16 a[24:27], v[168:171], v[80:83], 0
TR 168,202,16384
TR 170,202,18432
v_mfma_f32_16x16x32_bf16 a[28:31], v[172:175], v[80:83], 0
TR 172,203,16384
TR 174,203,18432
s_waitcnt lgkmcnt(4)
MA 0,v,144,v,112
s_add_u32 m0, s22, 65536
MA 4,v,148,v,112
MA 32,v,144,v,116
MA 36,v,148,v,116
buffer_load_dwordx4 v176, s[8:11], s20 offen offset:0 lds
MA 64,v,144,v,120
MA 68,v,148,v,120
MA 96,v,144,v,124
MA 100,v,148,v,124
buffer_load_dwordx4 v177, s[8:11], s20 offen offset:1024 lds
MA 128,v,144,v,128
MA 132,v,148,v,128
MA 160,v,144,v,132
buffer_load_dwordx4 v178, s[8:11], s20 offen offset:2048 lds
MA 164,v,148,v,132
MA 192,v,144,v,136
MA 196,v,148,v,136
MA 224,v,144,v,140
buffer_load_dwordx4 v179, s[8:11], s20 offen offset:3072 lds
MA 228,v,148,v,140
MA 232,v,152,v,140
MA 236,v,156,v,140
s_add_u32 m0, s22, 69632
MA 200,v,152,v,136
MA 204,v,156,v,136
MA 168,v,152,v,132
MA 172,v,156,v,132
buffer_load_dwordx4 v180, s[8:11], s20 offen offset:0 lds
MA 136,v,152,v,128
MA 140,v,156,v,128
MA 104,v,152,v,124
MA 108,v,156,v,124
buffer_load_dwordx4 v181, s[8:11], s20 offen offset:1024 lds
MA 72,v,152,v,120
MA 76,v,156,v,120
MA 40,v,152,v,116
buffer_load_dwordx4 v182, s[8:11], s20 offen offset:2048 lds
MA 44,v,156,v,116
MA 8,v,152,v,112
MA 12,v,156,v,112
MA 16,v,160,v,112
buffer_load_dwordx4 v183, s[8:11], s20 offen offset:3072 lds
MA 20,v,164,v,112
MA 48,v,160,v,116
MA 52,v,164,v,116
s_add_u32 s20, s20, 128
MA 80,v,160,v,120
MA 84,v,164,v,120
MA 112,v,160,v,124
MA 116,v,164,v,124
s_and_b32 s20, s20, 1023
MA 144,v,160,v,128
MA 148,v,164,v,128
MA 176,v,160,v,132
MA 180,v,164,v,132
MA 208,v,160,v,136
s_waitcnt vmcnt(8) lgkmcnt(0)
s_barrier
MA 212,v,164,v,136
TR 144,196,32768
TR 146,196,34816
MA 240,v,160,v,140
ds_read_b128 v[80:83], v192 offset:32768
s_add_u32 m0, s23, 0
MA 244,v,164,v,140
TR 148,197,32768
TR 150,197,34816
MA 248,v,168,v,140
ds_read_b128 v[84:87], v192 offset:34816
ds_read_b128 v[88:91], v192 offset:36864
MA 252,v,172,v,140
TR 152,198,32768
TR 154,198,34816
MA 216,v,168,v,136
ds_read_b128 v[92:95], v192 offset:38912
ds_read_b128 v[96:99], v192 offset:40960
MA 220,v,172,v,136
TR 156,199,32768
TR 158,199,34816
MA 184,v,168,v,132
ds_read_b128 v[100:103], v192 offset:43008
ds_read_b128 v[104:107], v192 offset:45056
MA 188,v,172,v,132
TR 160,200,32768
TR 162,200,34816
MA 152,v,168,v,128
ds_read_b128 v[108:111], v192 offset:47104
buffer_load_dwordx4 v184, s[12:15], s21 offen offset:0 lds
MA 156,v,172,v,128
TR 164,201,32768
TR 166,201,34816
MA 120,v,168,v,124
buffer_load_dwordx4 v185, s[12:15], s21 offen offset:1024 lds
buffer_load_dwordx4 v186, s[12:15], s21 offen offset:2048 lds
MA 124,v,172,v,124
buffer_load_dwordx4 v187, s[12:15], s21 offen offset:3072 lds
s_add_u32 m0, s23, 4096
MA 88,v,168,v,120
buffer_load_dwordx4 v188, s[12:15], s21 offen offset:0 lds
buffer_load_dwordx4 v189, s[12:15], s21 offen offset:1024 lds
MA 92,v,172,v,120
buffer_load_dwordx4 v190, s[12:15], s21 offen offset:2048 lds
buffer_load_dwordx4 v191, s[12:15], s21 offen offset:3072 lds
MA 56,v,168,v,116
s_add_u32 s21, s21, 524288
s_and_b32 s21, s21, 4194303
MA 60,v,172,v,116
s_load_dwordx2 s[84:85], s[0:1], 8
s_load_dwordx2 s[88:89], s[0:1], 16
MA 24,v,168,v,112
TR 168,202,32768
TR 170,202,34816
MA 28,v,172,v,112
TR 172,203,32768
TR 174,203,34816
s_load_dwordx2 s[92:93], s[0:1], 0
s_load_dwordx2 s[96:97], s[0:1], 24
s_load_dwordx2 s[76:77], s[0:1], 96
s_waitcnt lgkmcnt(4)
MA 0,v,144,v,80
s_add_u32 m0, s22, 0
MA 4,v,148,v,80
ds_read_b128 v[112:115], v193 offset:32768
MA 32,v,144,v,84
s_mov_b32 s4, s34
s_mov_b32 s5, s35
MA 36,v,148,v,84
MA 64,v,144,v,88
MA 68,v,148,v,88
buffer_load_dwordx4 v176, s[8:11], s20 offen offset:0 lds
MA 96,v,144,v,92
MA 100,v,148,v,92
ds_read_b128 v[116:119], v193 offset:34816
MA 128,v,144,v,96
s_mov_b32 s6, 8388608
s_mov_b32 s7, 0x20000
MA 132,v,148,v,96
MA 160,v,144,v,100
buffer_load_dwordx4 v177, s[8:11], s20 offen offset:1024 lds
MA 164,v,148,v,100
MA 192,v,144,v,104
MA 196,v,148,v,104
ds_read_b128 v[120:123], v193 offset:36864
MA 224,v,144,v,108
TR 144,196,49152
TR 146,196,51200
MA 228,v,148,v,108
TR 148,197,49152
TR 150,197,51200
MA 232,v,152,v,108
buffer_load_dwordx4 v178, s[8:11], s20 offen offset:2048 lds
s_lshr_b32 s43, s2, 3
MA 236,v,156,v,108
MA 200,v,152,v,104
MA 204,v,156,v,104
s_lshl_b32 s43, s43, 2
MA 168,v,152,v,100
ds_read_b128 v[124:127], v193 offset:38912
buffer_load_dwordx4 v179, s[8:11], s20 offen offset:3072 lds
MA 172,v,156,v,100
MA 136,v,152,v,96
MA 140,v,156,v,96
s_add_u32 s43, s43, s3
MA 104,v,152,v,92
MA 108,v,156,v,92
s_add_u32 m0, s22, 4096
MA 72,v,152,v,88
ds_read_b128 v[128:131], v193 offset:40960
MA 76,v,156,v,88
s_lshl_b32 s43, s43, 16
MA 40,v,152,v,84
MA 44,v,156,v,84
MA 8,v,152,v,80
TR 152,198,49152
TR 154,198,51200
MA 12,v,156,v,80
TR 156,199,49152
TR 158,199,51200
MA 16,v,160,v,80
ds_read_b128 v[132:135], v193 offset:43008
buffer_load_dwordx4 v180, s[8:11], s20 offen offset:0 lds
MA 20,v,164,v,80
s_and_b32 s37, s2, 7
MA 48,v,160,v,84
s_lshl_b32 s37, s37, 10
MA 52,v,164,v,84
MA 80,v,160,v,88
buffer_load_dwordx4 v181, s[8:11], s20 offen offset:1024 lds
MA 84,v,164,v,88
MA 112,v,160,v,92
s_add_u32 s43, s43, s37
MA 116,v,164,v,92
ds_read_b128 v[136:139], v193 offset:45056
MA 144,v,160,v,96
MA 148,v,164,v,96
buffer_load_dwordx4 v182, s[8:11], s20 offen offset:2048 lds
MA 176,v,160,v,100
v_lshrrev_b32 v78, 3, v1
MA 180,v,164,v,100
MA 208,v,160,v,104
MA 212,v,164,v,104
ds_read_b128 v[140:143], v193 offset:47104
MA 240,v,160,v,108
TR 160,200,49152
TR 162,200,51200
MA 244,v,164,v,108
TR 164,201,49152
TR 166,201,51200
s_waitcnt lgkmcnt(15)
MA 248,v,168,v,108
buffer_load_dwordx4 v183, s[8:11], s20 offen offset:3072 lds
v_and_b32 v79, 7, v1
MA 252,v,172,v,108
MA 216,v,168,v,104
v_lshlrev_b32 v79, 7, v79
MA 220,v,172,v,104
s_add_u32 s20, s20, 128
MA 184,v,168,v,100
MA 188,v,172,v,100
MA 152,v,168,v,96
v_lshl_add_u32 v78, v78, 13, v79
MA 156,v,172,v,96
MA 120,v,168,v,92
s_and_b32 s20, s20, 1023
MA 124,v,172,v,92
MA 88,v,168,v,88
v_add_u32 v78, s43, v78
MA 92,v,172,v,88
MA 56,v,168,v,84
MA 60,v,172,v,84
MA 24,v,168,v,80
TR 168,202,49152
TR 170,202,51200
MA 28,v,172,v,80
TR 172,203,49152
TR 174,203,51200
s_waitcnt lgkmcnt(4)
MA 0,v,144,v,112
MA 4,v,148,v,112
MA 32,v,144,v,116
MA 36,v,148,v,116
MA 64,v,144,v,120
MA 68,v,148,v,120
MA 96,v,144,v,124
MA 100,v,148,v,124
MA 128,v,144,v,128
MA 132,v,148,v,128
s_waitcnt vmcnt(8) lgkmcnt(0)
s_barrier
MA 160,v,144,v,132
s_add_u32 m0, s23, 32768
s_mov_b32 s86, 4194304
MA 164,v,148,v,132
ds_read_b128 v[80:83], v194 offset:0
s_mov_b32 s87, 0x20000
MA 192,v,144,v,136
s_mov_b32 s90, 4194304
MA 196,v,148,v,136
s_mov_b32 s91, 0x20000
MA 224,v,144,v,140
TR 144,196,0
TR 146,196,2048
MA 228,v,148,v,140
TR 148,197,0
TR 150,197,2048
MA 232,v,152,v,140
ds_read_b128 v[84:87], v194 offset:2048
buffer_load_dwordx4 v184, s[12:15], s21 offen offset:0 lds
MA 236,v,156,v,140
s_mov_b32 s94, 4194304
s_mov_b32 s95, 0x20000
MA 200,v,152,v,136
buffer_load_dwordx4 v185, s[12:15], s21 offen offset:1024 lds
s_mov_b32 s98, 8192
MA 204,v,156,v,136
s_mov_b32 s99, 0x20000
MA 168,v,152,v,132
s_mov_b32 s78, 2048
MA 172,v,156,v,132
ds_read_b128 v[88:91], v194 offset:4096
s_mov_b32 s79, 0x20000
MA 136,v,152,v,128
s_and_b32 s36, s2, 15
MA 140,v,156,v,128
buffer_load_dwordx4 v186, s[12:15], s21 offen offset:2048 lds
s_lshl_b32 s36, s36, 1
MA 104,v,152,v,124
MA 108,v,156,v,124
s_lshr_b32 s37, s3, 1
MA 72,v,152,v,120
ds_read_b128 v[92:95], v194 offset:6144
s_add_u32 s36, s36, s37
MA 76,v,156,v,120
buffer_load_dwordx4 v187, s[12:15], s21 offen offset:3072 lds
s_lshl_b32 s36, s36, 3
MA 40,v,152,v,116
MA 44,v,156,v,116
v_and_b32 v252, 7, v1
MA 8,v,152,v,112
TR 152,198,0
TR 154,198,2048
MA 12,v,156,v,112
TR 156,199,0
TR 158,199,2048
MA 16,v,160,v,112
ds_read_b128 v[96:99], v194 offset:8192
s_add_u32 m0, s23, 36864
MA 20,v,164,v,112
v_add_u32 v252, s36, v252
s_lshr_b32 s36, s2, 4
MA 48,v,160,v,116
s_lshl_b32 s36, s36, 1
s_and_b32 s37, s3, 1
MA 52,v,164,v,116
s_add_u32 s36, s36, s37
MA 80,v,160,v,120
ds_read_b128 v[100:103], v194 offset:10240
buffer_load_dwordx4 v188, s[12:15], s21 offen offset:0 lds
MA 84,v,164,v,120
s_lshl_b32 s36, s36, 3
v_lshrrev_b32 v253, 3, v1
MA 112,v,160,v,124
MA 116,v,164,v,124
v_add_u32 v253, s36, v253
MA 144,v,160,v,128
buffer_load_dwordx4 v189, s[12:15], s21 offen offset:1024 lds
v_lshlrev_b32 v254, 14, v253
MA 148,v,164,v,128
ds_read_b128 v[104:107], v194 offset:12288
v_lshl_add_u32 v254, v252, 3, v254
MA 176,v,160,v,132
v_add_u32 v229, -6144, v254
MA 180,v,164,v,132
MA 208,v,160,v,136
buffer_load_dwordx4 v190, s[12:15], s21 offen offset:2048 lds
v_lshlrev_b32 v62, 5, v252
MA 212,v,164,v,136
v_lshlrev_b32 v254, 4, v253
MA 240,v,160,v,140
TR 160,200,0
TR 162,200,2048
MA 244,v,164,v,140
TR 164,201,0
TR 166,201,2048
MA 248,v,168,v,140
ds_read_b128 v[108:111], v194 offset:14336
v_sub_u32 v254, 4080, v254
MA 252,v,172,v,140
buffer_load_dwordx4 v191, s[12:15], s21 offen offset:3072 lds
v_lshl_add_u32 v10, v252, 14, v254
MA 216,v,168,v,136
v_and_b32 v252, 31, v1
v_lshlrev_b32 v64, 4, v252
MA 220,v,172,v,136
s_lshl_b32 s36, s2, 2
MA 184,v,168,v,132
MA 188,v,172,v,132
s_add_u32 s21, s21, 524288
s_add_u32 s36, s36, s3
MA 152,v,168,v,128
s_lshl_b32 s36, s36, 1
MA 156,v,172,v,128
v_lshrrev_b32 v253, 5, v1
MA 120,v,168,v,124
v_add_u32 v253, s36, v253
MA 124,v,172,v,124
s_and_b32 s21, s21, 4194303
MA 88,v,168,v,120
v_lshl_add_u32 v63, v253, 11, v64
MA 92,v,172,v,120
v_lshlrev_b32 v253, 2, v253
MA 56,v,168,v,116
v_lshl_add_u32 v11, v252, 20, v253
MA 60,v,172,v,116
MA 24,v,168,v,112
TR 168,202,0
TR 170,202,2048
MA 28,v,172,v,112
TR 172,203,0
TR 174,203,2048
s_waitcnt lgkmcnt(4)
MA 0,v,144,v,80
s_add_u32 m0, s22, 32768
buffer_load_dwordx4 v[230:233], v63, s[92:95], 0 offen offset:0
MA 4,v,148,v,80
ds_read_b128 v[112:115], v195 offset:0
MA 32,v,144,v,84
MA 36,v,148,v,84
MA 64,v,144,v,88
buffer_load_dwordx4 v[2:5], v64, s[76:79], 0 offen offset:0
MA 68,v,148,v,88
buffer_load_dwordx4 v176, s[8:11], s20 offen offset:0 lds
MA 96,v,144,v,92
MA 100,v,148,v,92
ds_read_b128 v[116:119], v195 offset:2048
MA 128,v,144,v,96
MA 132,v,148,v,96
buffer_load_dwordx4 v[234:237], v63, s[92:95], 0 offen offset:512
MA 160,v,144,v,100
buffer_load_dwordx4 v177, s[8:11], s20 offen offset:1024 lds
MA 164,v,148,v,100
MA 192,v,144,v,104
MA 196,v,148,v,104
ds_read_b128 v[120:123], v195 offset:4096
MA 224,v,144,v,108
TR 144,196,16384
TR 146,196,18432
MA 228,v,148,v,108
TR 148,197,16384
TR 150,197,18432
MA 232,v,152,v,108
buffer_load_dwordx4 v178, s[8:11], s20 offen offset:2048 lds
buffer_load_dwordx4 v[6:9], v64, s[76:79], 0 offen offset:512
MA 236,v,156,v,108
MA 200,v,152,v,104
MA 204,v,156,v,104
buffer_load_dwordx4 v[238:241], v63, s[92:95], 0 offen offset:1024
MA 168,v,152,v,100
ds_read_b128 v[124:127], v195 offset:6144
buffer_load_dwordx4 v179, s[8:11], s20 offen offset:3072 lds
MA 172,v,156,v,100
MA 136,v,152,v,96
MA 140,v,156,v,96
buffer_load_dwordx4 v[12:15], v64, s[76:79], 0 offen offset:1024
MA 104,v,152,v,92
MA 108,v,156,v,92
s_add_u32 m0, s22, 36864
MA 72,v,152,v,88
ds_read_b128 v[128:131], v195 offset:8192
MA 76,v,156,v,88
MA 40,v,152,v,84
buffer_load_dwordx4 v[242:245], v63, s[92:95], 0 offen offset:1536
MA 44,v,156,v,84
MA 8,v,152,v,80
TR 152,198,16384
TR 154,198,18432
MA 12,v,156,v,80
TR 156,199,16384
TR 158,199,18432
MA 16,v,160,v,80
ds_read_b128 v[132:135], v195 offset:10240
buffer_load_dwordx4 v180, s[8:11], s20 offen offset:0 lds
MA 20,v,164,v,80
buffer_load_dwordx4 v[246:249], v64, s[76:79], 0 offen offset:1536
MA 48,v,160,v,84
MA 52,v,164,v,84
MA 80,v,160,v,88
buffer_load_dwordx4 v181, s[8:11], s20 offen offset:1024 lds
MA 84,v,164,v,88
MA 112,v,160,v,92
buffer_load_dwordx4 v[54:57], v62, s[96:99], 0 offen offset:0
MA 116,v,164,v,92
ds_read_b128 v[136:139], v195 offset:12288
MA 144,v,160,v,96
MA 148,v,164,v,96
buffer_load_dwordx4 v182, s[8:11], s20 offen offset:2048 lds
MA 176,v,160,v,100
buffer_load_dwordx4 v[58:61], v62, s[96:99], 0 offen offset:16
MA 180,v,164,v,100
MA 208,v,160,v,104
MA 212,v,164,v,104
ds_read_b128 v[140:143], v195 offset:14336
MA 240,v,160,v,108
TR 160,200,16384
TR 162,200,18432
MA 244,v,164,v,108
TR 164,201,16384
TR 166,201,18432
s_waitcnt lgkmcnt(15)
MA 248,v,168,v,108
buffer_load_dwordx4 v183, s[8:11], s20 offen offset:3072 lds
v_add_u32 v252, 0, v229
MA 252,v,172,v,108
MA 216,v,168,v,104
MA 220,v,172,v,104
s_add_u32 s20, s20, 128
MA 184,v,168,v,100
buffer_load_dwordx2 v[16:17], v252, s[84:87], 0 offen
MA 188,v,172,v,100
MA 152,v,168,v,96
MA 156,v,172,v,96
MA 120,v,168,v,92
s_and_b32 s20, s20, 1023
MA 124,v,172,v,92
v_add_u32 v253, 2048, v229
MA 88,v,168,v,88
MA 92,v,172,v,88
MA 56,v,168,v,84
MA 60,v,172,v,84
MA 24,v,168,v,80
TR 168,202,16384
TR 170,202,18432
MA 28,v,172,v,80
TR 172,203,16384
TR 174,203,18432
s_waitcnt lgkmcnt(4)
MA 0,v,144,v,112
MA 4,v,148,v,112
MA 32,v,144,v,116
MA 36,v,148,v,116
MA 64,v,144,v,120
MA 68,v,148,v,120
MA 96,v,144,v,124
MA 100,v,148,v,124
MA 128,v,144,v,128
MA 132,v,148,v,128
s_waitcnt vmcnt(19) lgkmcnt(0)
s_barrier
MA 160,v,144,v,132
s_add_u32 m0, s23, 0
s_bfe_u32 s80, s2, 0x20001
MA 164,v,148,v,132
ds_read_b128 v[80:83], v192 offset:0
s_bfe_u32 s69, s2, 0x30003
MA 192,v,144,v,136
s_lshl_b32 s80, s80, 3
s_add_u32 s69, s69, s80
MA 196,v,148,v,136
s_lshr_b32 s80, s2, 6
MA 224,v,144,v,140
TR 144,196,32768
TR 146,196,34816
MA 228,v,148,v,140
TR 148,197,32768
TR 150,197,34816
MA 232,v,152,v,140
ds_read_b128 v[84:87], v192 offset:2048
buffer_load_dwordx4 v184, s[12:15], s21 offen offset:0 lds
MA 236,v,156,v,140
s_xor_b32 s81, s80, s2
s_and_b32 s81, s81, 1
MA 200,v,152,v,136
buffer_load_dwordx4 v185, s[12:15], s21 offen offset:1024 lds
s_lshl_b32 s70, s80, 1
MA 204,v,156,v,136
s_add_u32 s70, s70, s81
s_lshl_b32 s80, s3, 1
MA 168,v,152,v,132
s_sub_u32 s80, 7, s80
s_lshl_b32 s76, s80, 17
MA 172,v,156,v,132
ds_read_b128 v[88:91], v192 offset:4096
s_lshl_b32 s80, s3, 15
MA 136,v,152,v,128
s_lshl_b32 s65, s70, 18
s_sub_u32 s64, 3932160, s65
MA 140,v,156,v,128
buffer_load_dwordx4 v186, s[12:15], s21 offen offset:2048 lds
s_add_u32 s65, s65, s80
MA 104,v,152,v,124
s_add_u32 s64, s64, s80
MA 108,v,156,v,124
s_lshl_b32 s81, s69, 12
MA 72,v,152,v,120
ds_read_b128 v[92:95], v192 offset:6144
s_lshl_b32 s100, s64, 2
MA 76,v,156,v,120
buffer_load_dwordx4 v187, s[12:15], s21 offen offset:3072 lds
s_add_u32 s100, s100, s81
MA 40,v,152,v,116
s_lshl_b32 s101, s65, 2
MA 44,v,156,v,116
s_add_u32 s101, s101, s81
MA 8,v,152,v,112
TR 152,198,32768
TR 154,198,34816
MA 12,v,156,v,112
TR 156,199,32768
TR 158,199,34816
MA 16,v,160,v,112
ds_read_b128 v[96:99], v192 offset:8192
s_add_u32 m0, s23, 4096
MA 20,v,164,v,112
s_lshl_b32 s66, s3, 17
s_lshl_b32 s81, s69, 8
MA 48,v,160,v,116
s_add_u32 s66, s66, s81
s_and_b32 s74, s2, 7
MA 52,v,164,v,116
s_lshl_b32 s74, s74, 8
s_mov_b32 s82, s66
MA 80,v,160,v,120
ds_read_b128 v[100:103], v192 offset:10240
buffer_load_dwordx4 v188, s[12:15], s21 offen offset:0 lds
MA 84,v,164,v,120
s_lshl_b32 s66, s74, 12
s_lshl_b32 s67, s3, 13
MA 112,v,160,v,124
s_lshl_b32 s68, s3, 12
s_lshl_b32 s77, s70, 1
MA 116,v,164,v,124
s_sub_u32 s77, 32, s77
MA 144,v,160,v,128
buffer_load_dwordx4 v189, s[12:15], s21 offen offset:1024 lds
v_lshrrev_b32 v66, 3, v1
MA 148,v,164,v,128
ds_read_b128 v[104:107], v192 offset:12288
v_lshlrev_b32 v66, 11, v66
MA 176,v,160,v,132
v_lshrrev_b32 v67, 4, v1
v_and_b32 v68, 7, v1
MA 180,v,164,v,132
v_xor_b32 v68, v68, v67
MA 208,v,160,v,136
buffer_load_dwordx4 v190, s[12:15], s21 offen offset:2048 lds
v_lshl_add_u32 v66, v68, 4, v66
MA 212,v,164,v,136
v_xor_b32 v69, 64, v66
MA 240,v,160,v,140
TR 160,200,32768
TR 162,200,34816
MA 244,v,164,v,140
TR 164,201,32768
TR 166,201,34816
MA 248,v,168,v,140
ds_read_b128 v[108:111], v192 offset:14336
s_lshr_b32 s83, s76, 2
MA 252,v,172,v,140
buffer_load_dwordx4 v191, s[12:15], s21 offen offset:3072 lds
v_add_u32 v208, 0, v66
MA 216,v,168,v,136
v_add_u32 v209, 15360, v69
v_add_u32 v210, -2048, v66
MA 220,v,172,v,136
v_add_u32 v210, s83, v210
v_add_u32 v211, 13312, v69
MA 184,v,168,v,132
v_add_u32 v211, s83, v211
v_and_b32 v68, 15, v1
MA 188,v,172,v,132
s_add_u32 s21, s21, 524288
v_lshlrev_b32 v69, 1, v67
MA 152,v,168,v,128
v_xor_b32 v68, v68, v69
MA 156,v,172,v,128
v_lshlrev_b32 v66, 13, v67
MA 120,v,168,v,124
v_xor_b32 v69, 0, v68
MA 124,v,172,v,124
s_and_b32 s21, s21, 4194303
v_lshl_add_u32 v69, v69, 4, v66
MA 88,v,168,v,120
v_add_u32 v212, 0, v69
MA 92,v,172,v,120
v_xor_b32 v69, 0, v68
MA 56,v,168,v,116
v_lshl_add_u32 v69, v69, 4, v66
MA 60,v,172,v,116
v_add_u32 v213, 31744, v69
MA 24,v,168,v,112
TR 168,202,32768
TR 170,202,34816
MA 28,v,172,v,112
TR 172,203,32768
TR 174,203,34816
s_waitcnt lgkmcnt(4)
MA 0,v,144,v,80
s_add_u32 m0, s22, 65536
buffer_load_dwordx2 v[18:19], v253, s[84:87], 0 offen
MA 4,v,148,v,80
ds_read_b128 v[112:115], v193 offset:0
MA 32,v,144,v,84
MA 36,v,148,v,84
MA 64,v,144,v,88
v_add_u32 v254, 4096, v229
MA 68,v,148,v,88
buffer_load_dwordx4 v176, s[8:11], s20 offen offset:0 lds
MA 96,v,144,v,92
MA 100,v,148,v,92
ds_read_b128 v[116:119], v193 offset:2048
MA 128,v,144,v,96
MA 132,v,148,v,96
buffer_load_dwordx2 v[20:21], v254, s[84:87], 0 offen
MA 160,v,144,v,100
buffer_load_dwordx4 v177, s[8:11], s20 offen offset:1024 lds
MA 164,v,148,v,100
MA 192,v,144,v,104
MA 196,v,148,v,104
ds_read_b128 v[120:123], v193 offset:4096
MA 224,v,144,v,108
TR 144,196,49152
TR 146,196,51200
MA 228,v,148,v,108
TR 148,197,49152
TR 150,197,51200
MA 232,v,152,v,108
buffer_load_dwordx4 v178, s[8:11], s20 offen offset:2048 lds
v_add_u32 v255, 6144, v229
MA 236,v,156,v,108
MA 200,v,152,v,104
MA 204,v,156,v,104
buffer_load_dwordx2 v[22:23], v255, s[84:87], 0 offen
MA 168,v,152,v,100
ds_read_b128 v[124:127], v193 offset:6144
buffer_load_dwordx4 v179, s[8:11], s20 offen offset:3072 lds
MA 172,v,156,v,100
MA 136,v,152,v,96
MA 140,v,156,v,96
buffer_load_dwordx2 v[38:39], v255, s[88:91], 0 offen
MA 104,v,152,v,92
MA 108,v,156,v,92
s_add_u32 m0, s22, 69632
MA 72,v,152,v,88
ds_read_b128 v[128:131], v193 offset:8192
MA 76,v,156,v,88
MA 40,v,152,v,84
v_add_u32 v252, 8192, v229
MA 44,v,156,v,84
MA 8,v,152,v,80
TR 152,198,49152
TR 154,198,51200
MA 12,v,156,v,80
TR 156,199,49152
TR 158,199,51200
MA 16,v,160,v,80
ds_read_b128 v[132:135], v193 offset:10240
buffer_load_dwordx4 v180, s[8:11], s20 offen offset:0 lds
MA 20,v,164,v,80
buffer_load_dwordx2 v[24:25], v252, s[84:87], 0 offen
MA 48,v,160,v,84
MA 52,v,164,v,84
MA 80,v,160,v,88
buffer_load_dwordx4 v181, s[8:11], s20 offen offset:1024 lds
MA 84,v,164,v,88
MA 112,v,160,v,92
buffer_load_dwordx2 v[40:41], v252, s[88:91], 0 offen
MA 116,v,164,v,92
ds_read_b128 v[136:139], v193 offset:12288
MA 144,v,160,v,96
MA 148,v,164,v,96
buffer_load_dwordx4 v182, s[8:11], s20 offen offset:2048 lds
MA 176,v,160,v,100
v_add_u32 v253, 10240, v229
MA 180,v,164,v,100
MA 208,v,160,v,104
MA 212,v,164,v,104
ds_read_b128 v[140:143], v193 offset:14336
MA 240,v,160,v,108
TR 160,200,49152
TR 162,200,51200
MA 244,v,164,v,108
TR 164,201,49152
TR 166,201,51200
s_waitcnt lgkmcnt(15)
MA 248,v,168,v,108
buffer_load_dwordx4 v183, s[8:11], s20 offen offset:3072 lds
buffer_load_dwordx2 v[26:27], v253, s[84:87], 0 offen
MA 252,v,172,v,108
MA 216,v,168,v,104
MA 220,v,172,v,104
s_add_u32 s20, s20, 128
MA 184,v,168,v,100
buffer_load_dwordx2 v[42:43], v253, s[88:91], 0 offen
MA 188,v,172,v,100
MA 152,v,168,v,96
MA 156,v,172,v,96
MA 120,v,168,v,92
s_and_b32 s20, s20, 1023
MA 124,v,172,v,92
v_add_u32 v254, 12288, v229
MA 88,v,168,v,88
MA 92,v,172,v,88
MA 56,v,168,v,84
MA 60,v,172,v,84
MA 24,v,168,v,80
TR 168,202,49152
TR 170,202,51200
MA 28,v,172,v,80
TR 172,203,49152
TR 174,203,51200
s_waitcnt lgkmcnt(4)
MA 0,v,144,v,112
MA 4,v,148,v,112
MA 32,v,144,v,116
MA 36,v,148,v,116
MA 64,v,144,v,120
MA 68,v,148,v,120
MA 96,v,144,v,124
MA 100,v,148,v,124
MA 128,v,144,v,128
MA 132,v,148,v,128
s_waitcnt vmcnt(16) lgkmcnt(0)
s_barrier
MA 160,v,144,v,132
s_add_u32 m0, s23, 32768
v_xor_b32 v69, 8, v68
MA 164,v,148,v,132
ds_read_b128 v[80:83], v192 offset:32768
v_lshl_add_u32 v69, v69, 4, v66
MA 192,v,144,v,136
v_add_u32 v214, 63488, v69
v_xor_b32 v69, 8, v68
MA 196,v,148,v,136
v_lshl_add_u32 v69, v69, 4, v66
MA 224,v,144,v,140
TR 144,196,0
TR 146,196,2048
MA 228,v,148,v,140
TR 148,197,0
TR 150,197,2048
MA 232,v,152,v,140
ds_read_b128 v[84:87], v192 offset:34816
buffer_load_dwordx4 v184, s[12:15], s21 offen offset:0 lds
MA 236,v,156,v,140
v_add_u32 v215, 95232, v69
v_and_b32 v66, 15, v1
MA 200,v,152,v,136
buffer_load_dwordx4 v185, s[12:15], s21 offen offset:1024 lds
v_lshrrev_b32 v68, 1, v66
MA 204,v,156,v,136
v_xor_b32 v68, v68, v67
v_lshlrev_b32 v68, 4, v68
MA 168,v,152,v,132
v_lshl_add_u32 v68, v66, 7, v68
v_add_u32 v224, s67, v68
MA 172,v,156,v,132
ds_read_b128 v[88:91], v192 offset:36864
v_xor_b32 v225, 64, v224
MA 136,v,152,v,128
v_add_u32 v226, 0x10000, v224
v_add_u32 v227, 0x10000, v225
MA 140,v,156,v,128
buffer_load_dwordx4 v186, s[12:15], s21 offen offset:2048 lds
v_bfe_u32 v66, v1, 2, 2
MA 104,v,152,v,124
v_and_b32 v68, 1, v67
v_lshl_or_b32 v68, v68, 2, v66
MA 108,v,156,v,124
v_lshl_add_u32 v66, v67, 3, v66
v_lshlrev_b32 v66, 8, v66
MA 72,v,152,v,120
ds_read_b128 v[92:95], v192 offset:38912
v_and_b32 v69, 3, v1
MA 76,v,156,v,120
buffer_load_dwordx4 v187, s[12:15], s21 offen offset:3072 lds
v_lshl_add_u32 v66, v69, 3, v66
MA 40,v,152,v,116
v_add_u32 v66, 98304, v66
MA 44,v,156,v,116
v_xor_b32 v69, 0, v68
MA 8,v,152,v,112
TR 152,198,0
TR 154,198,2048
MA 12,v,156,v,112
TR 156,199,0
TR 158,199,2048
MA 16,v,160,v,112
ds_read_b128 v[96:99], v192 offset:40960
s_add_u32 m0, s23, 36864
MA 20,v,164,v,112
v_lshl_add_u32 v216, v69, 5, v66
v_xor_b32 v69, 1, v68
MA 48,v,160,v,116
v_lshl_add_u32 v217, v69, 5, v66
v_xor_b32 v69, 2, v68
MA 52,v,164,v,116
v_lshl_add_u32 v218, v69, 5, v66
v_xor_b32 v69, 3, v68
MA 80,v,160,v,120
ds_read_b128 v[100:103], v192 offset:43008
buffer_load_dwordx4 v188, s[12:15], s21 offen offset:0 lds
MA 84,v,164,v,120
v_lshl_add_u32 v219, v69, 5, v66
v_xor_b32 v69, 4, v68
MA 112,v,160,v,124
v_lshl_add_u32 v220, v69, 5, v66
v_xor_b32 v69, 5, v68
MA 116,v,164,v,124
v_lshl_add_u32 v221, v69, 5, v66
v_xor_b32 v69, 6, v68
MA 144,v,160,v,128
buffer_load_dwordx4 v189, s[12:15], s21 offen offset:1024 lds
v_lshl_add_u32 v222, v69, 5, v66
MA 148,v,164,v,128
ds_read_b128 v[104:107], v192 offset:45056
v_xor_b32 v69, 7, v68
MA 176,v,160,v,132
v_lshl_add_u32 v223, v69, 5, v66
s_mov_b32 s44, s32
MA 180,v,164,v,132
s_mov_b32 s45, s33
MA 208,v,160,v,136
buffer_load_dwordx4 v190, s[12:15], s21 offen offset:2048 lds
s_mov_b32 s46, 4194304
MA 212,v,164,v,136
s_mov_b32 s47, 0x20000
MA 240,v,160,v,140
TR 160,200,0
TR 162,200,2048
MA 244,v,164,v,140
TR 164,201,0
TR 166,201,2048
MA 248,v,168,v,140
ds_read_b128 v[108:111], v192 offset:47104
MA 252,v,172,v,140
buffer_load_dwordx4 v191, s[12:15], s21 offen offset:3072 lds
MA 216,v,168,v,136
s_add_u32 s48, s34, s82
s_addc_u32 s49, s35, 0
MA 220,v,172,v,136
s_sub_u32 s50, 8388608, s82
s_mov_b32 s51, 0x20000
MA 184,v,168,v,132
s_add_u32 s60, s40, 33554432
s_addc_u32 s61, s41, 0
MA 188,v,172,v,132
s_add_u32 s21, s21, 524288
s_mov_b32 s62, 16777216
MA 152,v,168,v,128
s_mov_b32 s63, 0x20000
s_lshl_b32 s80, s69, 19
MA 156,v,172,v,128
s_add_u32 s52, s40, s80
s_addc_u32 s53, s41, 0
MA 120,v,168,v,124
s_lshl_b32 s54, s77, 14
s_mov_b32 s55, 0x20000
MA 124,v,172,v,124
s_and_b32 s21, s21, 4194303
s_add_u32 s80, s80, 16760832
MA 88,v,168,v,120
s_add_u32 s56, s40, s80
s_addc_u32 s57, s41, 0
MA 92,v,172,v,120
s_add_u32 s58, s54, 16384
MA 56,v,168,v,116
s_mov_b32 s59, 0x20000
MA 60,v,172,v,116
s_load_dwordx2 s[38:39], s[0:1], 112
MA 24,v,168,v,112
TR 168,202,0
TR 170,202,2048
MA 28,v,172,v,112
TR 172,203,0
TR 174,203,2048
s_waitcnt lgkmcnt(4)
MA 0,v,144,v,80
s_add_u32 m0, s22, 0
buffer_load_dwordx2 v[28:29], v254, s[84:87], 0 offen
MA 4,v,148,v,80
ds_read_b128 v[112:115], v193 offset:32768
MA 32,v,144,v,84
MA 36,v,148,v,84
MA 64,v,144,v,88
buffer_load_dwordx2 v[44:45], v254, s[88:91], 0 offen
MA 68,v,148,v,88
buffer_load_dwordx4 v176, s[8:11], s20 offen offset:0 lds
MA 96,v,144,v,92
MA 100,v,148,v,92
ds_read_b128 v[116:119], v193 offset:34816
MA 128,v,144,v,96
v_add_u32 v255, 14336, v229
MA 132,v,148,v,96
MA 160,v,144,v,100
buffer_load_dwordx4 v177, s[8:11], s20 offen offset:1024 lds
MA 164,v,148,v,100
MA 192,v,144,v,104
MA 196,v,148,v,104
ds_read_b128 v[120:123], v193 offset:36864
buffer_load_dwordx2 v[30:31], v255, s[84:87], 0 offen
MA 224,v,144,v,108
TR 144,196,16384
TR 146,196,18432
MA 228,v,148,v,108
TR 148,197,16384
TR 150,197,18432
MA 232,v,152,v,108
buffer_load_dwordx4 v178, s[8:11], s20 offen offset:2048 lds
MA 236,v,156,v,108
buffer_load_dwordx2 v[46:47], v255, s[88:91], 0 offen
MA 200,v,152,v,104
MA 204,v,156,v,104
MA 168,v,152,v,100
ds_read_b128 v[124:127], v193 offset:38912
buffer_load_dwordx4 v179, s[8:11], s20 offen offset:3072 lds
MA 172,v,156,v,100
MA 136,v,152,v,96
v_add_u32 v252, 16384, v229
MA 140,v,156,v,96
MA 104,v,152,v,92
MA 108,v,156,v,92
s_add_u32 m0, s22, 4096
MA 72,v,152,v,88
ds_read_b128 v[128:131], v193 offset:40960
buffer_load_dwordx2 v[32:33], v252, s[84:87], 0 offen
MA 76,v,156,v,88
MA 40,v,152,v,84
MA 44,v,156,v,84
MA 8,v,152,v,80
TR 152,198,16384
TR 154,198,18432
MA 12,v,156,v,80
TR 156,199,16384
TR 158,199,18432
MA 16,v,160,v,80
ds_read_b128 v[132:135], v193 offset:43008
buffer_load_dwordx4 v180, s[8:11], s20 offen offset:0 lds
MA 20,v,164,v,80
buffer_load_dwordx2 v[48:49], v252, s[88:91], 0 offen
MA 48,v,160,v,84
MA 52,v,164,v,84
v_add_u32 v253, 18432, v229
MA 80,v,160,v,88
buffer_load_dwordx4 v181, s[8:11], s20 offen offset:1024 lds
MA 84,v,164,v,88
MA 112,v,160,v,92
MA 116,v,164,v,92
ds_read_b128 v[136:139], v193 offset:45056
buffer_load_dwordx2 v[34:35], v253, s[84:87], 0 offen
MA 144,v,160,v,96
MA 148,v,164,v,96
buffer_load_dwordx4 v182, s[8:11], s20 offen offset:2048 lds
MA 176,v,160,v,100
MA 180,v,164,v,100
MA 208,v,160,v,104
buffer_load_dwordx2 v[50:51], v253, s[88:91], 0 offen
MA 212,v,164,v,104
ds_read_b128 v[140:143], v193 offset:47104
MA 240,v,160,v,108
TR 160,200,16384
TR 162,200,18432
MA 244,v,164,v,108
TR 164,201,16384
TR 166,201,18432
s_waitcnt lgkmcnt(15)
MA 248,v,168,v,108
buffer_load_dwordx4 v183, s[8:11], s20 offen offset:3072 lds
v_add_u32 v254, 20480, v229
MA 252,v,172,v,108
MA 216,v,168,v,104
MA 220,v,172,v,104
s_add_u32 s20, s20, 128
MA 184,v,168,v,100
MA 188,v,172,v,100
buffer_load_dwordx2 v[36:37], v254, s[84:87], 0 offen
MA 152,v,168,v,96
MA 156,v,172,v,96
MA 120,v,168,v,92
s_and_b32 s20, s20, 1023
MA 124,v,172,v,92
buffer_load_dwordx2 v[52:53], v254, s[88:91], 0 offen
MA 88,v,168,v,88
MA 92,v,172,v,88
MA 56,v,168,v,84
MA 60,v,172,v,84
MA 24,v,168,v,80
TR 168,202,16384
TR 170,202,18432
MA 28,v,172,v,80
TR 172,203,16384
TR 174,203,18432
s_waitcnt lgkmcnt(4)
MA 0,v,144,v,112
MA 4,v,148,v,112
MA 32,v,144,v,116
MA 36,v,148,v,116
MA 64,v,144,v,120
MA 68,v,148,v,120
MA 96,v,144,v,124
MA 100,v,148,v,124
MA 128,v,144,v,128
MA 132,v,148,v,128
s_waitcnt vmcnt(18) lgkmcnt(0)
s_barrier
MA 160,v,144,v,132
s_add_u32 m0, s23, 0
s_and_b32 s37, s3, 3
MA 164,v,148,v,132
ds_read_b128 v[80:83], v194 offset:0
MA 192,v,144,v,136
s_cmp_eq_u32 s37, 0
s_cselect_b32 s37, 0, 0x40000000
MA 196,v,148,v,136
MA 224,v,144,v,140
TR 144,196,32768
TR 146,196,34816
MA 228,v,148,v,140
TR 148,197,32768
TR 150,197,34816
MA 232,v,152,v,140
ds_read_b128 v[84:87], v194 offset:2048
buffer_load_dwordx4 v184, s[12:15], s21 offen offset:0 lds
MA 236,v,156,v,140
v_add_u32 v229, s37, v78
MA 200,v,152,v,136
buffer_load_dwordx4 v185, s[12:15], s21 offen offset:1024 lds
MA 204,v,156,v,136
buffer_load_dword v79, v229, s[4:7], 0 offen
MA 168,v,152,v,132
MA 172,v,156,v,132
ds_read_b128 v[88:91], v194 offset:4096
s_getpc_b64 s[82:83]
L_ct_fK:
MA 136,v,152,v,128
MA 140,v,156,v,128
buffer_load_dwordx4 v186, s[12:15], s21 offen offset:2048 lds
MA 104,v,152,v,124
s_add_u32 s82, s82, L_p2 - L_ct_fK
s_addc_u32 s83, s83, 0
MA 108,v,156,v,124
MA 72,v,152,v,120
ds_read_b128 v[92:95], v194 offset:6144
MA 76,v,156,v,120
buffer_load_dwordx4 v187, s[12:15], s21 offen offset:3072 lds
MA 40,v,152,v,116
v_mov_b32 v67, s83
MA 44,v,156,v,116
MA 8,v,152,v,112
TR 152,198,32768
TR 154,198,34816
MA 12,v,156,v,112
TR 156,199,32768
TR 158,199,34816
MA 16,v,160,v,112
ds_read_b128 v[96:99], v194 offset:8192
s_add_u32 m0, s23, 4096
MA 20,v,164,v,112
v_mov_b32 v66, s82
s_lshr_b32 s82, s2, 3
MA 48,v,160,v,116
s_lshl_b32 s82, s82, 2
MA 52,v,164,v,116
MA 80,v,160,v,120
ds_read_b128 v[100:103], v194 offset:10240
buffer_load_dwordx4 v188, s[12:15], s21 offen offset:0 lds
MA 84,v,164,v,120
s_add_u32 s82, s82, s3
MA 112,v,160,v,124
MA 116,v,164,v,124
s_lshl_b32 s82, s82, 7
MA 144,v,160,v,128
buffer_load_dwordx4 v189, s[12:15], s21 offen offset:1024 lds
MA 148,v,164,v,128
ds_read_b128 v[104:107], v194 offset:12288
v_and_b32 v68, 3, v1
MA 176,v,160,v,132
MA 180,v,164,v,132
v_lshlrev_b32 v68, 14, v68
MA 208,v,160,v,136
buffer_load_dwordx4 v190, s[12:15], s21 offen offset:2048 lds
MA 212,v,164,v,136
MA 240,v,160,v,140
TR 160,200,32768
TR 162,200,34816
MA 244,v,164,v,140
TR 164,201,32768
TR 166,201,34816
MA 248,v,168,v,140
ds_read_b128 v[108:111], v194 offset:14336
v_add_u32 v68, s82, v68
MA 252,v,172,v,140
buffer_load_dwordx4 v191, s[12:15], s21 offen offset:3072 lds
v_min_u32 v68, L_p3_begin - L_p2 - 4, v68
MA 216,v,168,v,136
v_add_co_u32 v66, vcc, v66, v68
s_nop 1
v_addc_co_u32 v67, vcc, 0, v67, vcc
MA 220,v,172,v,136
MA 184,v,168,v,132
MA 188,v,172,v,132
s_add_u32 s21, s21, 524288
MA 152,v,168,v,128
MA 156,v,172,v,128
MA 120,v,168,v,124
MA 124,v,172,v,124
s_and_b32 s21, s21, 4194303
MA 88,v,168,v,120
MA 92,v,172,v,120
global_load_dword v68, v[66:67], off
MA 56,v,168,v,116
MA 60,v,172,v,116
MA 24,v,168,v,112
TR 168,202,32768
TR 170,202,34816
MA 28,v,172,v,112
TR 172,203,32768
TR 174,203,34816
s_waitcnt lgkmcnt(4)
MA 0,v,144,v,80
s_add_u32 m0, s22, 32768
s_and_b32 s37, s3, 3
MA 4,v,148,v,80
ds_read_b128 v[112:115], v195 offset:0
MA 32,v,144,v,84
MA 36,v,148,v,84
MA 64,v,144,v,88
MA 68,v,148,v,88
buffer_load_dwordx4 v176, s[8:11], s20 offen offset:0 lds
MA 96,v,144,v,92
MA 100,v,148,v,92
ds_read_b128 v[116:119], v195 offset:2048
MA 128,v,144,v,96
MA 132,v,148,v,96
MA 160,v,144,v,100
buffer_load_dwordx4 v177, s[8:11], s20 offen offset:1024 lds
MA 164,v,148,v,100
MA 192,v,144,v,104
s_cmp_eq_u32 s37, 1
s_cselect_b32 s37, 0, 0x40000000
MA 196,v,148,v,104
ds_read_b128 v[120:123], v195 offset:4096
MA 224,v,144,v,108
TR 144,196,49152
TR 146,196,51200
MA 228,v,148,v,108
TR 148,197,49152
TR 150,197,51200
MA 232,v,152,v,108
buffer_load_dwordx4 v178, s[8:11], s20 offen offset:2048 lds
MA 236,v,156,v,108
MA 200,v,152,v,104
MA 204,v,156,v,104
MA 168,v,152,v,100
ds_read_b128 v[124:127], v195 offset:6144
buffer_load_dwordx4 v179, s[8:11], s20 offen offset:3072 lds
MA 172,v,156,v,100
MA 136,v,152,v,96
MA 140,v,156,v,96
MA 104,v,152,v,92
MA 108,v,156,v,92
s_add_u32 m0, s22, 36864
MA 72,v,152,v,88
ds_read_b128 v[128:131], v195 offset:8192
MA 76,v,156,v,88
MA 40,v,152,v,84
MA 44,v,156,v,84
MA 8,v,152,v,80
TR 152,198,49152
TR 154,198,51200
MA 12,v,156,v,80
TR 156,199,49152
TR 158,199,51200
MA 16,v,160,v,80
ds_read_b128 v[132:135], v195 offset:10240
buffer_load_dwordx4 v180, s[8:11], s20 offen offset:0 lds
MA 20,v,164,v,80
MA 48,v,160,v,84
MA 52,v,164,v,84
MA 80,v,160,v,88
buffer_load_dwordx4 v181, s[8:11], s20 offen offset:1024 lds
MA 84,v,164,v,88
v_add_u32 v229, s37, v78
MA 112,v,160,v,92
MA 116,v,164,v,92
ds_read_b128 v[136:139], v195 offset:12288
MA 144,v,160,v,96
MA 148,v,164,v,96
buffer_load_dwordx4 v182, s[8:11], s20 offen offset:2048 lds
MA 176,v,160,v,100
MA 180,v,164,v,100
MA 208,v,160,v,104
MA 212,v,164,v,104
ds_read_b128 v[140:143], v195 offset:14336
MA 240,v,160,v,108
TR 160,200,49152
TR 162,200,51200
MA 244,v,164,v,108
TR 164,201,49152
TR 166,201,51200
s_waitcnt lgkmcnt(15)
MA 248,v,168,v,108
buffer_load_dwordx4 v183, s[8:11], s20 offen offset:3072 lds
MA 252,v,172,v,108
buffer_load_dword v79, v229, s[4:7], 0 offen
MA 216,v,168,v,104
MA 220,v,172,v,104
s_add_u32 s20, s20, 128
MA 184,v,168,v,100
MA 188,v,172,v,100
MA 152,v,168,v,96
MA 156,v,172,v,96
MA 120,v,168,v,92
s_and_b32 s20, s20, 1023
MA 124,v,172,v,92
MA 88,v,168,v,88
MA 92,v,172,v,88
MA 56,v,168,v,84
MA 60,v,172,v,84
MA 24,v,168,v,80
TR 168,202,49152
TR 170,202,51200
MA 28,v,172,v,80
TR 172,203,49152
TR 174,203,51200
s_waitcnt lgkmcnt(4)
MA 0,v,144,v,112
MA 4,v,148,v,112
MA 32,v,144,v,116
MA 36,v,148,v,116
MA 64,v,144,v,120
MA 68,v,148,v,120
MA 96,v,144,v,124
MA 100,v,148,v,124
MA 128,v,144,v,128
MA 132,v,148,v,128
s_waitcnt vmcnt(10) lgkmcnt(0)
s_barrier
MA 160,v,144,v,132
s_add_u32 m0, s23, 32768
s_and_b32 s37, s3, 3
MA 164,v,148,v,132
ds_read_b128 v[80:83], v192 offset:0
MA 192,v,144,v,136
s_cmp_eq_u32 s37, 2
s_cselect_b32 s37, 0, 0x40000000
MA 196,v,148,v,136
v_add_u32 v229, s37, v78
buffer_load_dword v79, v229, s[4:7], 0 offen
MA 224,v,144,v,140
TR 144,196,0
TR 146,196,2048
MA 228,v,148,v,140
TR 148,197,0
TR 150,197,2048
MA 232,v,152,v,140
ds_read_b128 v[84:87], v192 offset:2048
buffer_load_dwordx4 v184, s[12:15], s21 offen offset:0 lds
MA 236,v,156,v,140
s_add_u32 s84, s40, 50331648
s_addc_u32 s85, s41, 0
MA 200,v,152,v,136
buffer_load_dwordx4 v185, s[12:15], s21 offen offset:1024 lds
s_mov_b32 s86, 4194304
MA 204,v,156,v,136
s_mov_b32 s87, 0x20000
MA 168,v,152,v,132
s_add_u32 s88, s40, 58720256
s_addc_u32 s89, s41, 0
MA 172,v,156,v,132
ds_read_b128 v[88:91], v192 offset:4096
s_mov_b32 s90, 8192
MA 136,v,152,v,128
s_mov_b32 s91, 0x20000
v_mov_b32 v252, 0
MA 140,v,156,v,128
buffer_load_dwordx4 v186, s[12:15], s21 offen offset:2048 lds
v_mov_b32 v253, 0
MA 104,v,152,v,124
v_dot2_f32_bf16 v252, v230, v2, v252
v_dot2_f32_bf16 v253, v231, v3, v253
MA 108,v,156,v,124
v_dot2_f32_bf16 v252, v232, v4, v252
v_dot2_f32_bf16 v253, v233, v5, v253
MA 72,v,152,v,120
ds_read_b128 v[92:95], v192 offset:6144
v_dot2_f32_bf16 v252, v234, v6, v252
MA 76,v,156,v,120
buffer_load_dwordx4 v187, s[12:15], s21 offen offset:3072 lds
v_dot2_f32_bf16 v253, v235, v7, v253
MA 40,v,152,v,116
v_dot2_f32_bf16 v252, v236, v8, v252
v_dot2_f32_bf16 v253, v237, v9, v253
MA 44,v,156,v,116
v_dot2_f32_bf16 v252, v238, v12, v252
v_dot2_f32_bf16 v253, v239, v13, v253
MA 8,v,152,v,112
TR 152,198,0
TR 154,198,2048
MA 12,v,156,v,112
TR 156,199,0
TR 158,199,2048
MA 16,v,160,v,112
ds_read_b128 v[96:99], v192 offset:8192
s_add_u32 m0, s23, 36864
MA 20,v,164,v,112
v_dot2_f32_bf16 v252, v240, v14, v252
v_dot2_f32_bf16 v253, v241, v15, v253
MA 48,v,160,v,116
v_dot2_f32_bf16 v252, v242, v246, v252
v_dot2_f32_bf16 v253, v243, v247, v253
MA 52,v,164,v,116
v_dot2_f32_bf16 v252, v244, v248, v252
v_dot2_f32_bf16 v253, v245, v249, v253
MA 80,v,160,v,120
ds_read_b128 v[100:103], v192 offset:10240
buffer_load_dwordx4 v188, s[12:15], s21 offen offset:0 lds
MA 84,v,164,v,120
s_nop 2
v_add_f32 v252, v252, v253
MA 112,v,160,v,124
s_nop 0
v_add_f32_dpp v252, v252, v252 row_ror:8 row_mask:0xf bank_mask:0xf
s_nop 1
v_add_f32_dpp v252, v252, v252 row_ror:4 row_mask:0xf bank_mask:0xf
MA 116,v,164,v,124
s_nop 0
v_add_f32_dpp v252, v252, v252 row_ror:2 row_mask:0xf bank_mask:0xf
s_nop 1
v_add_f32_dpp v252, v252, v252 row_ror:1 row_mask:0xf bank_mask:0xf
MA 144,v,160,v,128
buffer_load_dwordx4 v189, s[12:15], s21 offen offset:1024 lds
v_mov_b32 v253, v252
MA 148,v,164,v,128
ds_read_b128 v[104:107], v192 offset:12288
v_permlane16_swap_b32 v252, v253
MA 176,v,160,v,132
v_add_f32 v252, v252, v253
v_mul_f32 v252, 0xbfb8aa3b, v252
MA 180,v,164,v,132
v_exp_f32 v252, v252
MA 208,v,160,v,136
buffer_load_dwordx4 v190, s[12:15], s21 offen offset:2048 lds
v_add_f32 v252, 1.0, v252
MA 212,v,164,v,136
v_rcp_f32 v252, v252
MA 240,v,160,v,140
TR 160,200,0
TR 162,200,2048
MA 244,v,164,v,140
TR 164,201,0
TR 166,201,2048
MA 248,v,168,v,140
ds_read_b128 v[108:111], v192 offset:14336
MA 252,v,172,v,140
buffer_load_dwordx4 v191, s[12:15], s21 offen offset:3072 lds
MA 216,v,168,v,136
s_nop 0
buffer_store_dword v252, v11, s[88:91], 0 offen sc1
MA 220,v,172,v,136
v_lshlrev_b32 v2, 16, v54
v_and_b32 v3, 0xffff0000, v54
MA 184,v,168,v,132
v_lshlrev_b32 v4, 16, v55
v_and_b32 v5, 0xffff0000, v55
MA 188,v,172,v,132
s_add_u32 s21, s21, 524288
v_lshlrev_b32 v6, 16, v56
MA 152,v,168,v,128
v_and_b32 v7, 0xffff0000, v56
v_lshlrev_b32 v8, 16, v57
MA 156,v,172,v,128
v_and_b32 v9, 0xffff0000, v57
v_lshlrev_b32 v230, 16, v16
MA 120,v,168,v,124
v_and_b32 v231, 0xffff0000, v16
v_lshlrev_b32 v232, 16, v18
MA 124,v,172,v,124
s_and_b32 s21, s21, 4194303
v_and_b32 v233, 0xffff0000, v18
MA 88,v,168,v,120
v_lshlrev_b32 v234, 16, v20
v_and_b32 v235, 0xffff0000, v20
MA 92,v,172,v,120
v_lshlrev_b32 v236, 16, v22
v_and_b32 v237, 0xffff0000, v22
MA 56,v,168,v,116
v_lshlrev_b32 v238, 16, v24
v_and_b32 v239, 0xffff0000, v24
MA 60,v,172,v,116
v_lshlrev_b32 v240, 16, v26
v_and_b32 v241, 0xffff0000, v26
MA 24,v,168,v,112
TR 168,202,0
TR 170,202,2048
MA 28,v,172,v,112
TR 172,203,0
TR 174,203,2048
v_lshlrev_b32 v242, 16, v28
v_and_b32 v243, 0xffff0000, v28
v_lshlrev_b32 v244, 16, v30
v_and_b32 v245, 0xffff0000, v30
v_lshlrev_b32 v246, 16, v32
v_and_b32 v247, 0xffff0000, v32
v_lshlrev_b32 v248, 16, v34
v_and_b32 v249, 0xffff0000, v34
v_lshlrev_b32 v250, 16, v36
v_and_b32 v251, 0xffff0000, v36
v_lshlrev_b32 v254, 16, v38
v_and_b32 v255, 0xffff0000, v38
v_mul_f32 v62, v236, v2
v_mul_f32 v70, v237, v6
v_fmac_f32 v62, v234, v3
v_fmac_f32 v70, v235, v7
v_fmac_f32 v62, v232, v4
v_fmac_f32 v70, v233, v8
v_fmac_f32 v62, v230, v5
v_fmac_f32 v70, v231, v9
v_mul_f32 v62, v62, v254
s_waitcnt lgkmcnt(4)
MA 0,v,144,v,80
s_add_u32 s75, s64, s74
s_and_b32 s37, s3, 3
MA 4,v,148,v,80
ds_read_b128 v[112:115], v193 offset:0
MA 32,v,144,v,84
s_cmp_eq_u32 s37, 3
s_cselect_b32 s37, 0, 0x40000000
MA 36,v,148,v,84
v_add_u32 v229, s37, v78
buffer_load_dword v79, v229, s[4:7], 0 offen
MA 64,v,144,v,88
s_add_u32 m0, s67, 65536
v_mul_f32 v70, v70, v255
MA 68,v,148,v,88
v_lshlrev_b32 v254, 16, v40
v_and_b32 v255, 0xffff0000, v40
MA 96,v,144,v,92
v_mul_f32 v63, v238, v2
v_mul_f32 v71, v239, v6
MA 100,v,148,v,92
ds_read_b128 v[116:119], v193 offset:2048
v_fmac_f32 v63, v236, v3
MA 128,v,144,v,96
buffer_load_dwordx4 v208, s[44:47], s75 offen offset:0 lds
v_fmac_f32 v71, v237, v7
MA 132,v,148,v,96
v_fmac_f32 v63, v234, v4
v_fmac_f32 v71, v235, v8
MA 160,v,144,v,100
v_fmac_f32 v63, v232, v5
MA 164,v,148,v,100
v_fmac_f32 v71, v233, v9
v_mul_f32 v63, v63, v254
MA 192,v,144,v,104
v_mul_f32 v71, v71, v255
MA 196,v,148,v,104
ds_read_b128 v[120:123], v193 offset:4096
buffer_load_dwordx4 v209, s[44:47], s75 offen offset:1024 lds
MA 224,v,144,v,108
TR 144,196,16384
TR 146,196,18432
MA 228,v,148,v,108
TR 148,197,16384
TR 150,197,18432
MA 232,v,152,v,108
v_lshlrev_b32 v254, 16, v42
v_and_b32 v255, 0xffff0000, v42
MA 236,v,156,v,108
buffer_load_dwordx4 v210, s[44:47], s75 offen offset:2048 lds
v_mul_f32 v64, v240, v2
MA 200,v,152,v,104
v_mul_f32 v72, v241, v6
v_fmac_f32 v64, v238, v3
MA 204,v,156,v,104
v_fmac_f32 v72, v239, v7
v_fmac_f32 v64, v236, v4
MA 168,v,152,v,100
ds_read_b128 v[124:127], v193 offset:6144
v_fmac_f32 v72, v237, v8
MA 172,v,156,v,100
v_fmac_f32 v64, v234, v5
v_fmac_f32 v72, v235, v9
MA 136,v,152,v,96
buffer_load_dwordx4 v211, s[44:47], s75 offen offset:3072 lds
v_mul_f32 v64, v64, v254
MA 140,v,156,v,96
v_mul_f32 v72, v72, v255
v_lshlrev_b32 v254, 16, v44
MA 104,v,152,v,92
v_and_b32 v255, 0xffff0000, v44
v_mul_f32 v65, v242, v2
MA 108,v,156,v,92
v_mul_f32 v73, v243, v6
v_fmac_f32 v65, v240, v3
MA 72,v,152,v,88
ds_read_b128 v[128:131], v193 offset:8192
s_add_u32 s75, s65, s74
MA 76,v,156,v,88
v_fmac_f32 v73, v241, v7
v_fmac_f32 v65, v238, v4
MA 40,v,152,v,84
v_fmac_f32 v73, v239, v8
v_fmac_f32 v65, v236, v5
MA 44,v,156,v,84
v_fmac_f32 v73, v237, v9
v_mul_f32 v65, v65, v254
MA 8,v,152,v,80
TR 152,198,16384
TR 154,198,18432
MA 12,v,156,v,80
TR 156,199,16384
TR 158,199,18432
MA 16,v,160,v,80
ds_read_b128 v[132:135], v193 offset:10240
s_add_u32 m0, s67, 69632
MA 20,v,164,v,80
v_mul_f32 v73, v73, v255
v_lshlrev_b32 v254, 16, v46
MA 48,v,160,v,84
v_and_b32 v255, 0xffff0000, v46
v_mul_f32 v66, v244, v2
MA 52,v,164,v,84
buffer_load_dwordx4 v208, s[44:47], s75 offen offset:0 lds
v_mul_f32 v74, v245, v6
MA 80,v,160,v,88
v_fmac_f32 v66, v242, v3
v_fmac_f32 v74, v243, v7
MA 84,v,164,v,88
v_fmac_f32 v66, v240, v4
v_fmac_f32 v74, v241, v8
MA 112,v,160,v,92
v_fmac_f32 v66, v238, v5
v_fmac_f32 v74, v239, v9
MA 116,v,164,v,92
ds_read_b128 v[136:139], v193 offset:12288
buffer_load_dwordx4 v209, s[44:47], s75 offen offset:1024 lds
MA 144,v,160,v,96
v_mul_f32 v66, v66, v254
v_mul_f32 v74, v74, v255
MA 148,v,164,v,96
v_lshlrev_b32 v254, 16, v48
v_and_b32 v255, 0xffff0000, v48
MA 176,v,160,v,100
v_mul_f32 v67, v246, v2
v_mul_f32 v75, v247, v6
MA 180,v,164,v,100
v_fmac_f32 v67, v244, v3
MA 208,v,160,v,104
buffer_load_dwordx4 v210, s[44:47], s75 offen offset:2048 lds
v_fmac_f32 v75, v245, v7
MA 212,v,164,v,104
ds_read_b128 v[140:143], v193 offset:14336
v_fmac_f32 v67, v242, v4
MA 240,v,160,v,108
TR 160,200,16384
TR 162,200,18432
MA 244,v,164,v,108
TR 164,201,16384
TR 166,201,18432
s_waitcnt lgkmcnt(15)
MA 248,v,168,v,108
buffer_load_dwordx4 v211, s[44:47], s75 offen offset:3072 lds
v_fmac_f32 v75, v243, v8
MA 252,v,172,v,108
v_fmac_f32 v67, v240, v5
v_fmac_f32 v75, v241, v9
MA 216,v,168,v,104
v_mul_f32 v67, v67, v254
v_mul_f32 v75, v75, v255
MA 220,v,172,v,104
v_lshlrev_b32 v254, 16, v50
v_and_b32 v255, 0xffff0000, v50
MA 184,v,168,v,100
s_waitcnt vmcnt(28)
v_mul_f32 v68, v248, v2
v_mul_f32 v76, v249, v6
MA 188,v,172,v,100
s_add_u32 s74, s74, 128
v_fmac_f32 v68, v246, v3
MA 152,v,168,v,96
v_fmac_f32 v76, v247, v7
v_fmac_f32 v68, v244, v4
MA 156,v,172,v,96
v_fmac_f32 v76, v245, v8
v_fmac_f32 v68, v242, v5
MA 120,v,168,v,92
v_fmac_f32 v76, v243, v9
v_mul_f32 v68, v68, v254
MA 124,v,172,v,92
s_and_b32 s74, s74, 2047
v_mul_f32 v76, v76, v255
MA 88,v,168,v,88
v_lshlrev_b32 v254, 16, v52
MA 92,v,172,v,88
v_and_b32 v255, 0xffff0000, v52
v_mul_f32 v69, v250, v2
MA 56,v,168,v,84
v_mul_f32 v77, v251, v6
MA 60,v,172,v,84
v_fmac_f32 v69, v248, v3
MA 24,v,168,v,80
TR 168,202,16384
TR 170,202,18432
MA 28,v,172,v,80
TR 172,203,16384
TR 174,203,18432
s_waitcnt lgkmcnt(4)
MA 0,v,144,v,112
MA 4,v,148,v,112
MA 32,v,144,v,116
MA 36,v,148,v,116
MA 64,v,144,v,120
MA 68,v,148,v,120
MA 96,v,144,v,124
MA 100,v,148,v,124
MA 128,v,144,v,128
MA 132,v,148,v,128
s_waitcnt vmcnt(10) lgkmcnt(0)
s_barrier
MA 160,v,144,v,132
s_add_u32 m0, s68, 98304
v_fmac_f32 v77, v249, v7
MA 164,v,148,v,132
ds_read_b128 v[80:83], v192 offset:32768
v_fmac_f32 v69, v246, v4
MA 192,v,144,v,136
v_fmac_f32 v77, v247, v8
v_fmac_f32 v69, v244, v5
MA 196,v,148,v,136
buffer_load_dwordx4 v212, s[48:51], s66 offen offset:0 lds
v_fmac_f32 v77, v245, v9
MA 224,v,144,v,140
TR 144,196,32768
TR 146,196,34816
MA 228,v,148,v,140
TR 148,197,32768
TR 150,197,34816
MA 232,v,152,v,140
ds_read_b128 v[84:87], v192 offset:34816
v_mul_f32 v69, v69, v254
MA 236,v,156,v,140
buffer_load_dwordx4 v213, s[48:51], s66 offen offset:1024 lds
v_mul_f32 v77, v77, v255
MA 200,v,152,v,136
v_cvt_pk_bf16_f32 v12, v69, v68
v_cvt_pk_bf16_f32 v13, v67, v66
MA 204,v,156,v,136
v_cvt_pk_bf16_f32 v14, v65, v64
v_cvt_pk_bf16_f32 v15, v63, v62
MA 168,v,152,v,132
s_mov_b32 s36, 0
buffer_store_dwordx4 v[12:15], v10, s[84:87], s36 offen sc1
MA 172,v,156,v,132
ds_read_b128 v[88:91], v192 offset:36864
buffer_load_dwordx4 v214, s[48:51], s66 offen offset:2048 lds
MA 136,v,152,v,128
v_cvt_pk_bf16_f32 v54, v77, v76
v_cvt_pk_bf16_f32 v55, v75, v74
MA 140,v,156,v,128
v_cvt_pk_bf16_f32 v56, v73, v72
v_cvt_pk_bf16_f32 v57, v71, v70
MA 104,v,152,v,124
buffer_load_dwordx4 v215, s[48:51], s66 offen offset:3072 lds
s_mov_b32 s36, 4096
MA 108,v,156,v,124
buffer_store_dwordx4 v[54:57], v10, s[84:87], s36 offen sc1
v_lshlrev_b32 v2, 16, v58
MA 72,v,152,v,120
ds_read_b128 v[92:95], v192 offset:38912
v_and_b32 v3, 0xffff0000, v58
MA 76,v,156,v,120
v_lshlrev_b32 v4, 16, v59
v_and_b32 v5, 0xffff0000, v59
MA 40,v,152,v,116
s_add_u32 s66, s66, 524288
v_lshlrev_b32 v6, 16, v60
MA 44,v,156,v,116
v_and_b32 v7, 0xffff0000, v60
v_lshlrev_b32 v8, 16, v61
MA 8,v,152,v,112
TR 152,198,32768
TR 154,198,34816
MA 12,v,156,v,112
TR 156,199,32768
TR 158,199,34816
MA 16,v,160,v,112
ds_read_b128 v[96:99], v192 offset:40960
s_and_b32 s66, s66, 8388607
MA 20,v,164,v,112
v_and_b32 v9, 0xffff0000, v61
v_lshlrev_b32 v230, 16, v17
MA 48,v,160,v,116
v_and_b32 v231, 0xffff0000, v17
v_lshlrev_b32 v232, 16, v19
MA 52,v,164,v,116
v_and_b32 v233, 0xffff0000, v19
v_lshlrev_b32 v234, 16, v21
MA 80,v,160,v,120
ds_read_b128 v[100:103], v192 offset:43008
s_add_u32 m0, s68, 114688
MA 84,v,164,v,120
v_and_b32 v235, 0xffff0000, v21
v_lshlrev_b32 v236, 16, v23
MA 112,v,160,v,124
v_and_b32 v237, 0xffff0000, v23
v_lshlrev_b32 v238, 16, v25
MA 116,v,164,v,124
buffer_load_dwordx4 v212, s[48:51], s66 offen offset:0 lds
v_and_b32 v239, 0xffff0000, v25
MA 144,v,160,v,128
v_lshlrev_b32 v240, 16, v27
v_and_b32 v241, 0xffff0000, v27
MA 148,v,164,v,128
ds_read_b128 v[104:107], v192 offset:45056
v_lshlrev_b32 v242, 16, v29
MA 176,v,160,v,132
v_and_b32 v243, 0xffff0000, v29
v_lshlrev_b32 v244, 16, v31
MA 180,v,164,v,132
buffer_load_dwordx4 v213, s[48:51], s66 offen offset:1024 lds
v_and_b32 v245, 0xffff0000, v31
MA 208,v,160,v,136
v_lshlrev_b32 v246, 16, v33
v_and_b32 v247, 0xffff0000, v33
MA 212,v,164,v,136
v_lshlrev_b32 v248, 16, v35
v_and_b32 v249, 0xffff0000, v35
MA 240,v,160,v,140
TR 160,200,32768
TR 162,200,34816
MA 244,v,164,v,140
TR 164,201,32768
TR 166,201,34816
MA 248,v,168,v,140
ds_read_b128 v[108:111], v192 offset:47104
buffer_load_dwordx4 v214, s[48:51], s66 offen offset:2048 lds
MA 252,v,172,v,140
v_lshlrev_b32 v250, 16, v37
v_and_b32 v251, 0xffff0000, v37
MA 216,v,168,v,136
buffer_load_dwordx4 v215, s[48:51], s66 offen offset:3072 lds
v_lshlrev_b32 v254, 16, v39
MA 220,v,172,v,136
v_and_b32 v255, 0xffff0000, v39
v_mul_f32 v62, v236, v2
MA 184,v,168,v,132
v_mul_f32 v70, v237, v6
v_fmac_f32 v62, v234, v3
MA 188,v,172,v,132
v_fmac_f32 v70, v235, v7
v_fmac_f32 v62, v232, v4
MA 152,v,168,v,128
s_add_u32 s66, s66, 524288
v_fmac_f32 v70, v233, v8
MA 156,v,172,v,128
v_fmac_f32 v62, v230, v5
v_fmac_f32 v70, v231, v9
MA 120,v,168,v,124
v_mul_f32 v62, v62, v254
v_mul_f32 v70, v70, v255
MA 124,v,172,v,124
v_lshlrev_b32 v254, 16, v41
v_and_b32 v255, 0xffff0000, v41
MA 88,v,168,v,120
s_and_b32 s66, s66, 8388607
v_mul_f32 v63, v238, v2
MA 92,v,172,v,120
v_mul_f32 v71, v239, v6
v_fmac_f32 v63, v236, v3
MA 56,v,168,v,116
v_fmac_f32 v71, v237, v7
v_fmac_f32 v63, v234, v4
MA 60,v,172,v,116
v_fmac_f32 v71, v235, v8
v_fmac_f32 v63, v232, v5
MA 24,v,168,v,112
TR 168,202,32768
TR 170,202,34816
MA 28,v,172,v,112
TR 172,203,32768
TR 174,203,34816
v_fmac_f32 v71, v233, v9
v_mul_f32 v63, v63, v254
v_mul_f32 v71, v71, v255
v_lshlrev_b32 v254, 16, v43
v_and_b32 v255, 0xffff0000, v43
v_mul_f32 v64, v240, v2
v_mul_f32 v72, v241, v6
v_fmac_f32 v64, v238, v3
s_waitcnt lgkmcnt(4)
MA 0,v,144,v,80
s_add_u32 s75, s64, s74
v_fmac_f32 v72, v239, v7
MA 4,v,148,v,80
ds_read_b128 v[112:115], v193 offset:32768
v_fmac_f32 v64, v236, v4
MA 32,v,144,v,84
v_fmac_f32 v72, v237, v8
v_fmac_f32 v64, v234, v5
MA 36,v,148,v,84
v_fmac_f32 v72, v235, v9
v_mul_f32 v64, v64, v254
MA 64,v,144,v,88
s_add_u32 m0, s67, 0
v_mul_f32 v72, v72, v255
MA 68,v,148,v,88
v_lshlrev_b32 v254, 16, v45
MA 96,v,144,v,92
v_and_b32 v255, 0xffff0000, v45
v_mul_f32 v65, v242, v2
MA 100,v,148,v,92
ds_read_b128 v[116:119], v193 offset:34816
v_mul_f32 v73, v243, v6
MA 128,v,144,v,96
buffer_load_dwordx4 v208, s[44:47], s75 offen offset:0 lds
v_fmac_f32 v65, v240, v3
MA 132,v,148,v,96
v_fmac_f32 v73, v241, v7
MA 160,v,144,v,100
v_fmac_f32 v65, v238, v4
v_fmac_f32 v73, v239, v8
MA 164,v,148,v,100
v_fmac_f32 v65, v236, v5
MA 192,v,144,v,104
v_fmac_f32 v73, v237, v9
MA 196,v,148,v,104
ds_read_b128 v[120:123], v193 offset:36864
buffer_load_dwordx4 v209, s[44:47], s75 offen offset:1024 lds
MA 224,v,144,v,108
TR 144,196,49152
TR 146,196,51200
MA 228,v,148,v,108
TR 148,197,49152
TR 150,197,51200
MA 232,v,152,v,108
v_mul_f32 v65, v65, v254
v_mul_f32 v73, v73, v255
MA 236,v,156,v,108
buffer_load_dwordx4 v210, s[44:47], s75 offen offset:2048 lds
v_lshlrev_b32 v254, 16, v47
MA 200,v,152,v,104
v_and_b32 v255, 0xffff0000, v47
v_mul_f32 v66, v244, v2
MA 204,v,156,v,104
v_mul_f32 v74, v245, v6
v_fmac_f32 v66, v242, v3
MA 168,v,152,v,100
ds_read_b128 v[124:127], v193 offset:38912
v_fmac_f32 v74, v243, v7
MA 172,v,156,v,100
v_fmac_f32 v66, v240, v4
v_fmac_f32 v74, v241, v8
MA 136,v,152,v,96
buffer_load_dwordx4 v211, s[44:47], s75 offen offset:3072 lds
v_fmac_f32 v66, v238, v5
MA 140,v,156,v,96
v_fmac_f32 v74, v239, v9
v_mul_f32 v66, v66, v254
MA 104,v,152,v,92
v_mul_f32 v74, v74, v255
v_lshlrev_b32 v254, 16, v49
MA 108,v,156,v,92
v_and_b32 v255, 0xffff0000, v49
v_mul_f32 v67, v246, v2
MA 72,v,152,v,88
ds_read_b128 v[128:131], v193 offset:40960
s_add_u32 s75, s65, s74
MA 76,v,156,v,88
v_mul_f32 v75, v247, v6
v_fmac_f32 v67, v244, v3
MA 40,v,152,v,84
v_fmac_f32 v75, v245, v7
v_fmac_f32 v67, v242, v4
MA 44,v,156,v,84
v_fmac_f32 v75, v243, v8
MA 8,v,152,v,80
TR 152,198,49152
TR 154,198,51200
MA 12,v,156,v,80
TR 156,199,49152
TR 158,199,51200
MA 16,v,160,v,80
ds_read_b128 v[132:135], v193 offset:43008
s_add_u32 m0, s67, 4096
MA 20,v,164,v,80
v_fmac_f32 v67, v240, v5
v_fmac_f32 v75, v241, v9
MA 48,v,160,v,84
v_mul_f32 v67, v67, v254
v_mul_f32 v75, v75, v255
MA 52,v,164,v,84
buffer_load_dwordx4 v208, s[44:47], s75 offen offset:0 lds
v_lshlrev_b32 v254, 16, v51
MA 80,v,160,v,88
v_and_b32 v255, 0xffff0000, v51
v_mul_f32 v68, v248, v2
MA 84,v,164,v,88
v_mul_f32 v76, v249, v6
v_fmac_f32 v68, v246, v3
MA 112,v,160,v,92
v_fmac_f32 v76, v247, v7
v_fmac_f32 v68, v244, v4
MA 116,v,164,v,92
ds_read_b128 v[136:139], v193 offset:45056
buffer_load_dwordx4 v209, s[44:47], s75 offen offset:1024 lds
MA 144,v,160,v,96
v_fmac_f32 v76, v245, v8
v_fmac_f32 v68, v242, v5
MA 148,v,164,v,96
v_fmac_f32 v76, v243, v9
v_mul_f32 v68, v68, v254
MA 176,v,160,v,100
v_mul_f32 v76, v76, v255
v_lshlrev_b32 v254, 16, v53
MA 180,v,164,v,100
v_and_b32 v255, 0xffff0000, v53
MA 208,v,160,v,104
buffer_load_dwordx4 v210, s[44:47], s75 offen offset:2048 lds
v_mul_f32 v69, v250, v2
MA 212,v,164,v,104
ds_read_b128 v[140:143], v193 offset:47104
v_mul_f32 v77, v251, v6
MA 240,v,160,v,108
TR 160,200,49152
TR 162,200,51200
MA 244,v,164,v,108
TR 164,201,49152
TR 166,201,51200
s_waitcnt lgkmcnt(15)
MA 248,v,168,v,108
buffer_load_dwordx4 v211, s[44:47], s75 offen offset:3072 lds
v_fmac_f32 v69, v248, v3
MA 252,v,172,v,108
v_fmac_f32 v77, v249, v7
v_fmac_f32 v69, v246, v4
MA 216,v,168,v,104
v_fmac_f32 v77, v247, v8
v_fmac_f32 v69, v244, v5
MA 220,v,172,v,104
v_fmac_f32 v77, v245, v9
v_mul_f32 v69, v69, v254
MA 184,v,168,v,100
v_mul_f32 v77, v77, v255
v_cvt_pk_bf16_f32 v230, v69, v68
MA 188,v,172,v,100
s_add_u32 s74, s74, 128
v_cvt_pk_bf16_f32 v231, v67, v66
MA 152,v,168,v,96
v_cvt_pk_bf16_f32 v232, v65, v64
v_cvt_pk_bf16_f32 v233, v63, v62
MA 156,v,172,v,96
s_mov_b32 s36, 8192
buffer_store_dwordx4 v[230:233], v10, s[84:87], s36 offen sc1
MA 120,v,168,v,92
v_cvt_pk_bf16_f32 v234, v77, v76
MA 124,v,172,v,92
s_and_b32 s74, s74, 2047
v_cvt_pk_bf16_f32 v235, v75, v74
MA 88,v,168,v,88
v_cvt_pk_bf16_f32 v236, v73, v72
v_cvt_pk_bf16_f32 v237, v71, v70
MA 92,v,172,v,88
s_mov_b32 s36, 12288
MA 56,v,168,v,84
buffer_store_dwordx4 v[234:237], v10, s[84:87], s36 offen sc1
MA 60,v,172,v,84
v_lshlrev_b32 v228, 4, v1
MA 24,v,168,v,80
TR 168,202,49152
TR 170,202,51200
MA 28,v,172,v,80
TR 172,203,49152
TR 174,203,51200
s_waitcnt lgkmcnt(4)
MA 0,v,144,v,112
MA 4,v,148,v,112
MA 32,v,144,v,116
MA 36,v,148,v,116
MA 64,v,144,v,120
MA 68,v,148,v,120
MA 96,v,144,v,124
MA 100,v,148,v,124
MA 128,v,144,v,128
MA 132,v,148,v,128
s_waitcnt vmcnt(15) lgkmcnt(0)
s_barrier
MA 160,v,144,v,132
ds_read_b128 v[48:51], v226 offset:0
s_add_u32 m0, s68, 131072
MA 164,v,148,v,132
MA 192,v,144,v,136
ds_read_b128 v[52:55], v226 offset:2048
buffer_load_dwordx4 v212, s[48:51], s66 offen offset:0 lds
MA 196,v,148,v,136
MA 224,v,144,v,140
ds_read_b128 v[56:59], v226 offset:4096
buffer_load_dwordx4 v213, s[48:51], s66 offen offset:1024 lds
MA 228,v,148,v,140
MA 232,v,152,v,140
ds_read_b128 v[60:63], v226 offset:6144
MA 236,v,156,v,140
buffer_load_dwordx4 v214, s[48:51], s66 offen offset:2048 lds
MA 200,v,152,v,136
TR 16,216,0
MA 204,v,156,v,136
buffer_load_dwordx4 v215, s[48:51], s66 offen offset:3072 lds
MA 168,v,152,v,132
TR 18,216,1024
MA 172,v,156,v,132
MA 136,v,152,v,128
TR 20,217,0
s_add_u32 s66, s66, 524288
MA 140,v,156,v,128
MA 104,v,152,v,124
TR 22,217,1024
s_and_b32 s66, s66, 8388607
MA 108,v,156,v,124
MA 72,v,152,v,120
TR 24,218,0
MA 76,v,156,v,120
s_add_u32 s75, s64, s74
MA 40,v,152,v,116
TR 26,218,1024
MA 44,v,156,v,116
s_add_u32 m0, s67, 32768
MA 8,v,152,v,112
TR 28,219,0
MA 12,v,156,v,112
MA 16,v,160,v,112
TR 30,219,1024
buffer_load_dwordx4 v208, s[44:47], s75 offen offset:0 lds
MA 20,v,164,v,112
MA 48,v,160,v,116
TR 32,220,0
buffer_load_dwordx4 v209, s[44:47], s75 offen offset:1024 lds
MA 52,v,164,v,116
MA 80,v,160,v,120
TR 34,220,1024
MA 84,v,164,v,120
buffer_load_dwordx4 v210, s[44:47], s75 offen offset:2048 lds
MA 112,v,160,v,124
TR 36,221,0
MA 116,v,164,v,124
buffer_load_dwordx4 v211, s[44:47], s75 offen offset:3072 lds
MA 144,v,160,v,128
TR 38,221,1024
MA 148,v,164,v,128
MA 176,v,160,v,132
TR 40,222,0
s_add_u32 s75, s65, s74
MA 180,v,164,v,132
MA 208,v,160,v,136
TR 42,222,1024
s_add_u32 m0, s67, 36864
MA 212,v,164,v,136
MA 240,v,160,v,140
TR 44,223,0
MA 244,v,164,v,140
buffer_load_dwordx4 v208, s[44:47], s75 offen offset:0 lds
MA 248,v,168,v,140
TR 46,223,1024
MA 252,v,172,v,140
buffer_load_dwordx4 v209, s[44:47], s75 offen offset:1024 lds
MA 216,v,168,v,136
MA 220,v,172,v,136
MA 184,v,168,v,132
buffer_load_dwordx4 v210, s[44:47], s75 offen offset:2048 lds
MA 188,v,172,v,132
MA 152,v,168,v,128
buffer_load_dwordx4 v211, s[44:47], s75 offen offset:3072 lds
MA 156,v,172,v,128
MA 120,v,168,v,124
MA 124,v,172,v,124
s_add_u32 s74, s74, 128
MA 88,v,168,v,120
MA 92,v,172,v,120
s_and_b32 s74, s74, 2047
MA 56,v,168,v,116
MA 60,v,172,v,116
MA 24,v,168,v,112
MA 28,v,172,v,112
s_branch L_p2
L_p1_V:
s_waitcnt lgkmcnt(14)
v_mfma_f32_16x16x32_bf16 a[0:3], v[80:83], v[144:147], 0
s_add_u32 m0, s23, 32768
s_waitcnt lgkmcnt(12)
v_mfma_f32_16x16x32_bf16 a[8:11], v[80:83], v[148:151], 0
ds_read_b128 v[112:115], v193 offset:0
v_mfma_f32_16x16x32_bf16 a[4:7], v[84:87], v[144:147], 0
buffer_load_dwordx4 v184, s[12:15], s21 offen offset:0 lds
v_mfma_f32_16x16x32_bf16 a[12:15], v[84:87], v[148:151], 0
v_mfma_f32_16x16x32_bf16 a[64:67], v[88:91], v[144:147], 0
v_mfma_f32_16x16x32_bf16 a[72:75], v[88:91], v[148:151], 0
buffer_load_dwordx4 v185, s[12:15], s21 offen offset:1024 lds
v_mfma_f32_16x16x32_bf16 a[68:71], v[92:95], v[144:147], 0
v_mfma_f32_16x16x32_bf16 a[76:79], v[92:95], v[148:151], 0
ds_read_b128 v[116:119], v193 offset:2048
buffer_load_dwordx4 v186, s[12:15], s21 offen offset:2048 lds
v_mfma_f32_16x16x32_bf16 a[128:131], v[96:99], v[144:147], 0
v_mfma_f32_16x16x32_bf16 a[136:139], v[96:99], v[148:151], 0
v_mfma_f32_16x16x32_bf16 a[132:135], v[100:103], v[144:147], 0
buffer_load_dwordx4 v187, s[12:15], s21 offen offset:3072 lds
v_mfma_f32_16x16x32_bf16 a[140:143], v[100:103], v[148:151], 0
v_mfma_f32_16x16x32_bf16 a[192:195], v[104:107], v[144:147], 0
s_add_u32 m0, s23, 36864
v_mfma_f32_16x16x32_bf16 a[200:203], v[104:107], v[148:151], 0
ds_read_b128 v[120:123], v193 offset:4096
v_mfma_f32_16x16x32_bf16 a[196:199], v[108:111], v[144:147], 0
TR 144,196,16384
TR 146,196,18432
v_mfma_f32_16x16x32_bf16 a[204:207], v[108:111], v[148:151], 0
TR 148,197,16384
TR 150,197,18432
s_waitcnt lgkmcnt(15)
v_mfma_f32_16x16x32_bf16 a[212:215], v[108:111], v[152:155], 0
buffer_load_dwordx4 v188, s[12:15], s21 offen offset:0 lds
v_mfma_f32_16x16x32_bf16 a[220:223], v[108:111], v[156:159], 0
v_mfma_f32_16x16x32_bf16 a[208:211], v[104:107], v[152:155], 0
buffer_load_dwordx4 v189, s[12:15], s21 offen offset:1024 lds
v_mfma_f32_16x16x32_bf16 a[216:219], v[104:107], v[156:159], 0
v_mfma_f32_16x16x32_bf16 a[148:151], v[100:103], v[152:155], 0
ds_read_b128 v[124:127], v193 offset:6144
buffer_load_dwordx4 v190, s[12:15], s21 offen offset:2048 lds
v_mfma_f32_16x16x32_bf16 a[156:159], v[100:103], v[156:159], 0
v_mfma_f32_16x16x32_bf16 a[144:147], v[96:99], v[152:155], 0
v_mfma_f32_16x16x32_bf16 a[152:155], v[96:99], v[156:159], 0
buffer_load_dwordx4 v191, s[12:15], s21 offen offset:3072 lds
v_mfma_f32_16x16x32_bf16 a[84:87], v[92:95], v[152:155], 0
v_mfma_f32_16x16x32_bf16 a[92:95], v[92:95], v[156:159], 0
s_add_u32 s21, s21, 524288
v_mfma_f32_16x16x32_bf16 a[80:83], v[88:91], v[152:155], 0
ds_read_b128 v[128:131], v193 offset:8192
v_mfma_f32_16x16x32_bf16 a[88:91], v[88:91], v[156:159], 0
v_mfma_f32_16x16x32_bf16 a[20:23], v[84:87], v[152:155], 0
s_and_b32 s21, s21, 4194303
v_mfma_f32_16x16x32_bf16 a[28:31], v[84:87], v[156:159], 0
v_mfma_f32_16x16x32_bf16 a[16:19], v[80:83], v[152:155], 0
TR 152,198,16384
TR 154,198,18432
v_mfma_f32_16x16x32_bf16 a[24:27], v[80:83], v[156:159], 0
TR 156,199,16384
TR 158,199,18432
s_waitcnt lgkmcnt(15)
v_mfma_f32_16x16x32_bf16 a[32:35], v[80:83], v[160:163], 0
ds_read_b128 v[132:135], v193 offset:10240
s_add_u32 m0, s22, 32768
v_mfma_f32_16x16x32_bf16 a[40:43], v[80:83], v[164:167], 0
buffer_load_dwordx4 v176, s[8:11], s20 offen offset:0 lds
v_mfma_f32_16x16x32_bf16 a[36:39], v[84:87], v[160:163], 0
v_mfma_f32_16x16x32_bf16 a[44:47], v[84:87], v[164:167], 0
v_mfma_f32_16x16x32_bf16 a[96:99], v[88:91], v[160:163], 0
buffer_load_dwordx4 v177, s[8:11], s20 offen offset:1024 lds
v_mfma_f32_16x16x32_bf16 a[104:107], v[88:91], v[164:167], 0
v_mfma_f32_16x16x32_bf16 a[100:103], v[92:95], v[160:163], 0
buffer_load_dwordx4 v178, s[8:11], s20 offen offset:2048 lds
v_mfma_f32_16x16x32_bf16 a[108:111], v[92:95], v[164:167], 0
ds_read_b128 v[136:139], v193 offset:12288
v_mfma_f32_16x16x32_bf16 a[160:163], v[96:99], v[160:163], 0
v_mfma_f32_16x16x32_bf16 a[168:171], v[96:99], v[164:167], 0
buffer_load_dwordx4 v179, s[8:11], s20 offen offset:3072 lds
v_mfma_f32_16x16x32_bf16 a[164:167], v[100:103], v[160:163], 0
v_mfma_f32_16x16x32_bf16 a[172:175], v[100:103], v[164:167], 0
s_add_u32 m0, s22, 36864
v_mfma_f32_16x16x32_bf16 a[224:227], v[104:107], v[160:163], 0
v_mfma_f32_16x16x32_bf16 a[232:235], v[104:107], v[164:167], 0
ds_read_b128 v[140:143], v193 offset:14336
v_mfma_f32_16x16x32_bf16 a[228:231], v[108:111], v[160:163], 0
TR 160,200,16384
TR 162,200,18432
v_mfma_f32_16x16x32_bf16 a[236:239], v[108:111], v[164:167], 0
TR 164,201,16384
TR 166,201,18432
v_mfma_f32_16x16x32_bf16 a[244:247], v[108:111], v[168:171], 0
buffer_load_dwordx4 v180, s[8:11], s20 offen offset:0 lds
s_waitcnt lgkmcnt(15)
v_mfma_f32_16x16x32_bf16 a[252:255], v[108:111], v[172:175], 0
buffer_load_dwordx4 v181, s[8:11], s20 offen offset:1024 lds
v_mfma_f32_16x16x32_bf16 a[240:243], v[104:107], v[168:171], 0
v_mfma_f32_16x16x32_bf16 a[248:251], v[104:107], v[172:175], 0
buffer_load_dwordx4 v182, s[8:11], s20 offen offset:2048 lds
v_mfma_f32_16x16x32_bf16 a[180:183], v[100:103], v[168:171], 0
v_mfma_f32_16x16x32_bf16 a[188:191], v[100:103], v[172:175], 0
v_mfma_f32_16x16x32_bf16 a[176:179], v[96:99], v[168:171], 0
buffer_load_dwordx4 v183, s[8:11], s20 offen offset:3072 lds
v_mfma_f32_16x16x32_bf16 a[184:187], v[96:99], v[172:175], 0
v_mfma_f32_16x16x32_bf16 a[116:119], v[92:95], v[168:171], 0
s_add_u32 s20, s20, 128
v_mfma_f32_16x16x32_bf16 a[124:127], v[92:95], v[172:175], 0
v_mfma_f32_16x16x32_bf16 a[112:115], v[88:91], v[168:171], 0
v_mfma_f32_16x16x32_bf16 a[120:123], v[88:91], v[172:175], 0
s_and_b32 s20, s20, 1023
v_mfma_f32_16x16x32_bf16 a[52:55], v[84:87], v[168:171], 0
v_mfma_f32_16x16x32_bf16 a[60:63], v[84:87], v[172:175], 0
v_mfma_f32_16x16x32_bf16 a[48:51], v[80:83], v[168:171], 0
TR 168,202,16384
TR 170,202,18432
v_mfma_f32_16x16x32_bf16 a[56:59], v[80:83], v[172:175], 0
TR 172,203,16384
TR 174,203,18432
s_waitcnt lgkmcnt(4)
MA 0,v,112,v,144
s_add_u32 m0, s22, 65536
MA 8,v,112,v,148
MA 4,v,116,v,144
MA 12,v,116,v,148
buffer_load_dwordx4 v176, s[8:11], s20 offen offset:0 lds
MA 64,v,120,v,144
MA 72,v,120,v,148
MA 68,v,124,v,144
MA 76,v,124,v,148
buffer_load_dwordx4 v177, s[8:11], s20 offen offset:1024 lds
MA 128,v,128,v,144
MA 136,v,128,v,148
MA 132,v,132,v,144
buffer_load_dwordx4 v178, s[8:11], s20 offen offset:2048 lds
MA 140,v,132,v,148
MA 192,v,136,v,144
MA 200,v,136,v,148
MA 196,v,140,v,144
buffer_load_dwordx4 v179, s[8:11], s20 offen offset:3072 lds
MA 204,v,140,v,148
MA 212,v,140,v,152
MA 220,v,140,v,156
s_add_u32 m0, s22, 69632
MA 208,v,136,v,152
MA 216,v,136,v,156
MA 148,v,132,v,152
MA 156,v,132,v,156
buffer_load_dwordx4 v180, s[8:11], s20 offen offset:0 lds
MA 144,v,128,v,152
MA 152,v,128,v,156
MA 84,v,124,v,152
MA 92,v,124,v,156
buffer_load_dwordx4 v181, s[8:11], s20 offen offset:1024 lds
MA 80,v,120,v,152
MA 88,v,120,v,156
MA 20,v,116,v,152
buffer_load_dwordx4 v182, s[8:11], s20 offen offset:2048 lds
MA 28,v,116,v,156
MA 16,v,112,v,152
MA 24,v,112,v,156
MA 32,v,112,v,160
buffer_load_dwordx4 v183, s[8:11], s20 offen offset:3072 lds
MA 40,v,112,v,164
MA 36,v,116,v,160
MA 44,v,116,v,164
s_add_u32 s20, s20, 128
MA 96,v,120,v,160
MA 104,v,120,v,164
MA 100,v,124,v,160
MA 108,v,124,v,164
s_and_b32 s20, s20, 1023
MA 160,v,128,v,160
MA 168,v,128,v,164
MA 164,v,132,v,160
MA 172,v,132,v,164
MA 224,v,136,v,160
s_waitcnt vmcnt(8) lgkmcnt(0)
s_barrier
MA 232,v,136,v,164
TR 144,196,32768
TR 146,196,34816
MA 228,v,140,v,160
ds_read_b128 v[80:83], v192 offset:32768
s_add_u32 m0, s23, 0
MA 236,v,140,v,164
TR 148,197,32768
TR 150,197,34816
MA 244,v,140,v,168
ds_read_b128 v[84:87], v192 offset:34816
ds_read_b128 v[88:91], v192 offset:36864
MA 252,v,140,v,172
TR 152,198,32768
TR 154,198,34816
MA 240,v,136,v,168
ds_read_b128 v[92:95], v192 offset:38912
ds_read_b128 v[96:99], v192 offset:40960
MA 248,v,136,v,172
TR 156,199,32768
TR 158,199,34816
MA 180,v,132,v,168
ds_read_b128 v[100:103], v192 offset:43008
ds_read_b128 v[104:107], v192 offset:45056
MA 188,v,132,v,172
TR 160,200,32768
TR 162,200,34816
MA 176,v,128,v,168
ds_read_b128 v[108:111], v192 offset:47104
buffer_load_dwordx4 v184, s[12:15], s21 offen offset:0 lds
MA 184,v,128,v,172
TR 164,201,32768
TR 166,201,34816
MA 116,v,124,v,168
buffer_load_dwordx4 v185, s[12:15], s21 offen offset:1024 lds
buffer_load_dwordx4 v186, s[12:15], s21 offen offset:2048 lds
MA 124,v,124,v,172
buffer_load_dwordx4 v187, s[12:15], s21 offen offset:3072 lds
s_add_u32 m0, s23, 4096
MA 112,v,120,v,168
buffer_load_dwordx4 v188, s[12:15], s21 offen offset:0 lds
buffer_load_dwordx4 v189, s[12:15], s21 offen offset:1024 lds
MA 120,v,120,v,172
buffer_load_dwordx4 v190, s[12:15], s21 offen offset:2048 lds
buffer_load_dwordx4 v191, s[12:15], s21 offen offset:3072 lds
MA 52,v,116,v,168
s_add_u32 s21, s21, 524288
s_and_b32 s21, s21, 4194303
MA 60,v,116,v,172
s_load_dwordx2 s[84:85], s[0:1], 8
s_load_dwordx2 s[88:89], s[0:1], 16
MA 48,v,112,v,168
TR 168,202,32768
TR 170,202,34816
MA 56,v,112,v,172
TR 172,203,32768
TR 174,203,34816
s_load_dwordx2 s[92:93], s[0:1], 0
s_load_dwordx2 s[96:97], s[0:1], 24
s_load_dwordx2 s[76:77], s[0:1], 96
s_waitcnt lgkmcnt(4)
MA 0,v,80,v,144
s_add_u32 m0, s22, 0
MA 8,v,80,v,148
ds_read_b128 v[112:115], v193 offset:32768
MA 4,v,84,v,144
s_mov_b32 s4, s34
s_mov_b32 s5, s35
MA 12,v,84,v,148
MA 64,v,88,v,144
MA 72,v,88,v,148
buffer_load_dwordx4 v176, s[8:11], s20 offen offset:0 lds
MA 68,v,92,v,144
MA 76,v,92,v,148
ds_read_b128 v[116:119], v193 offset:34816
MA 128,v,96,v,144
s_mov_b32 s6, 8388608
s_mov_b32 s7, 0x20000
MA 136,v,96,v,148
MA 132,v,100,v,144
buffer_load_dwordx4 v177, s[8:11], s20 offen offset:1024 lds
MA 140,v,100,v,148
MA 192,v,104,v,144
MA 200,v,104,v,148
ds_read_b128 v[120:123], v193 offset:36864
MA 196,v,108,v,144
TR 144,196,49152
TR 146,196,51200
MA 204,v,108,v,148
TR 148,197,49152
TR 150,197,51200
MA 212,v,108,v,152
buffer_load_dwordx4 v178, s[8:11], s20 offen offset:2048 lds
s_lshr_b32 s43, s2, 3
MA 220,v,108,v,156
MA 208,v,104,v,152
MA 216,v,104,v,156
s_lshl_b32 s43, s43, 2
MA 148,v,100,v,152
ds_read_b128 v[124:127], v193 offset:38912
buffer_load_dwordx4 v179, s[8:11], s20 offen offset:3072 lds
MA 156,v,100,v,156
MA 144,v,96,v,152
MA 152,v,96,v,156
s_add_u32 s43, s43, s3
MA 84,v,92,v,152
MA 92,v,92,v,156
s_add_u32 m0, s22, 4096
MA 80,v,88,v,152
ds_read_b128 v[128:131], v193 offset:40960
MA 88,v,88,v,156
s_lshl_b32 s43, s43, 16
MA 20,v,84,v,152
MA 28,v,84,v,156
MA 16,v,80,v,152
TR 152,198,49152
TR 154,198,51200
MA 24,v,80,v,156
TR 156,199,49152
TR 158,199,51200
MA 32,v,80,v,160
ds_read_b128 v[132:135], v193 offset:43008
buffer_load_dwordx4 v180, s[8:11], s20 offen offset:0 lds
MA 40,v,80,v,164
s_and_b32 s37, s2, 7
MA 36,v,84,v,160
s_lshl_b32 s37, s37, 10
MA 44,v,84,v,164
MA 96,v,88,v,160
buffer_load_dwordx4 v181, s[8:11], s20 offen offset:1024 lds
MA 104,v,88,v,164
MA 100,v,92,v,160
s_add_u32 s43, s43, s37
MA 108,v,92,v,164
ds_read_b128 v[136:139], v193 offset:45056
MA 160,v,96,v,160
MA 168,v,96,v,164
buffer_load_dwordx4 v182, s[8:11], s20 offen offset:2048 lds
MA 164,v,100,v,160
v_lshrrev_b32 v78, 3, v1
MA 172,v,100,v,164
MA 224,v,104,v,160
MA 232,v,104,v,164
ds_read_b128 v[140:143], v193 offset:47104
MA 228,v,108,v,160
TR 160,200,49152
TR 162,200,51200
MA 236,v,108,v,164
TR 164,201,49152
TR 166,201,51200
s_waitcnt lgkmcnt(15)
MA 244,v,108,v,168
buffer_load_dwordx4 v183, s[8:11], s20 offen offset:3072 lds
v_and_b32 v79, 7, v1
MA 252,v,108,v,172
MA 240,v,104,v,168
v_lshlrev_b32 v79, 7, v79
MA 248,v,104,v,172
s_add_u32 s20, s20, 128
MA 180,v,100,v,168
MA 188,v,100,v,172
MA 176,v,96,v,168
v_lshl_add_u32 v78, v78, 13, v79
MA 184,v,96,v,172
MA 116,v,92,v,168
s_and_b32 s20, s20, 1023
MA 124,v,92,v,172
MA 112,v,88,v,168
v_add_u32 v78, s43, v78
MA 120,v,88,v,172
MA 52,v,84,v,168
MA 60,v,84,v,172
MA 48,v,80,v,168
TR 168,202,49152
TR 170,202,51200
MA 56,v,80,v,172
TR 172,203,49152
TR 174,203,51200
s_waitcnt lgkmcnt(4)
MA 0,v,112,v,144
MA 8,v,112,v,148
MA 4,v,116,v,144
MA 12,v,116,v,148
MA 64,v,120,v,144
MA 72,v,120,v,148
MA 68,v,124,v,144
MA 76,v,124,v,148
MA 128,v,128,v,144
MA 136,v,128,v,148
s_waitcnt vmcnt(8) lgkmcnt(0)
s_barrier
MA 132,v,132,v,144
s_add_u32 m0, s23, 32768
s_mov_b32 s86, 4194304
MA 140,v,132,v,148
ds_read_b128 v[80:83], v194 offset:0
s_mov_b32 s87, 0x20000
MA 192,v,136,v,144
s_mov_b32 s90, 4194304
MA 200,v,136,v,148
s_mov_b32 s91, 0x20000
MA 196,v,140,v,144
TR 144,196,0
TR 146,196,2048
MA 204,v,140,v,148
TR 148,197,0
TR 150,197,2048
MA 212,v,140,v,152
ds_read_b128 v[84:87], v194 offset:2048
buffer_load_dwordx4 v184, s[12:15], s21 offen offset:0 lds
MA 220,v,140,v,156
s_mov_b32 s94, 4194304
s_mov_b32 s95, 0x20000
MA 208,v,136,v,152
buffer_load_dwordx4 v185, s[12:15], s21 offen offset:1024 lds
s_mov_b32 s98, 8192
MA 216,v,136,v,156
s_mov_b32 s99, 0x20000
MA 148,v,132,v,152
s_mov_b32 s78, 2048
MA 156,v,132,v,156
ds_read_b128 v[88:91], v194 offset:4096
s_mov_b32 s79, 0x20000
MA 144,v,128,v,152
s_and_b32 s36, s2, 15
MA 152,v,128,v,156
buffer_load_dwordx4 v186, s[12:15], s21 offen offset:2048 lds
s_lshl_b32 s36, s36, 1
MA 84,v,124,v,152
MA 92,v,124,v,156
s_lshr_b32 s37, s3, 1
MA 80,v,120,v,152
ds_read_b128 v[92:95], v194 offset:6144
s_add_u32 s36, s36, s37
MA 88,v,120,v,156
buffer_load_dwordx4 v187, s[12:15], s21 offen offset:3072 lds
s_lshl_b32 s36, s36, 3
MA 20,v,116,v,152
MA 28,v,116,v,156
v_and_b32 v252, 7, v1
MA 16,v,112,v,152
TR 152,198,0
TR 154,198,2048
MA 24,v,112,v,156
TR 156,199,0
TR 158,199,2048
MA 32,v,112,v,160
ds_read_b128 v[96:99], v194 offset:8192
s_add_u32 m0, s23, 36864
MA 40,v,112,v,164
v_add_u32 v252, s36, v252
s_lshr_b32 s36, s2, 4
MA 36,v,116,v,160
s_lshl_b32 s36, s36, 1
s_and_b32 s37, s3, 1
MA 44,v,116,v,164
s_add_u32 s36, s36, s37
MA 96,v,120,v,160
ds_read_b128 v[100:103], v194 offset:10240
buffer_load_dwordx4 v188, s[12:15], s21 offen offset:0 lds
MA 104,v,120,v,164
s_lshl_b32 s36, s36, 3
v_lshrrev_b32 v253, 3, v1
MA 100,v,124,v,160
MA 108,v,124,v,164
v_add_u32 v253, s36, v253
MA 160,v,128,v,160
buffer_load_dwordx4 v189, s[12:15], s21 offen offset:1024 lds
v_lshlrev_b32 v254, 14, v253
MA 168,v,128,v,164
ds_read_b128 v[104:107], v194 offset:12288
v_lshl_add_u32 v254, v252, 3, v254
MA 164,v,132,v,160
v_add_u32 v229, -6144, v254
MA 172,v,132,v,164
MA 224,v,136,v,160
buffer_load_dwordx4 v190, s[12:15], s21 offen offset:2048 lds
v_lshlrev_b32 v62, 5, v252
MA 232,v,136,v,164
v_lshlrev_b32 v254, 4, v253
MA 228,v,140,v,160
TR 160,200,0
TR 162,200,2048
MA 236,v,140,v,164
TR 164,201,0
TR 166,201,2048
MA 244,v,140,v,168
ds_read_b128 v[108:111], v194 offset:14336
v_sub_u32 v254, 4080, v254
MA 252,v,140,v,172
buffer_load_dwordx4 v191, s[12:15], s21 offen offset:3072 lds
v_lshl_add_u32 v10, v252, 14, v254
MA 240,v,136,v,168
v_and_b32 v252, 31, v1
v_lshlrev_b32 v64, 4, v252
MA 248,v,136,v,172
s_lshl_b32 s36, s2, 2
MA 180,v,132,v,168
MA 188,v,132,v,172
s_add_u32 s21, s21, 524288
s_add_u32 s36, s36, s3
MA 176,v,128,v,168
s_lshl_b32 s36, s36, 1
MA 184,v,128,v,172
v_lshrrev_b32 v253, 5, v1
MA 116,v,124,v,168
v_add_u32 v253, s36, v253
MA 124,v,124,v,172
s_and_b32 s21, s21, 4194303
MA 112,v,120,v,168
v_lshl_add_u32 v63, v253, 11, v64
MA 120,v,120,v,172
v_lshlrev_b32 v253, 2, v253
MA 52,v,116,v,168
v_lshl_add_u32 v11, v252, 20, v253
MA 60,v,116,v,172
MA 48,v,112,v,168
TR 168,202,0
TR 170,202,2048
MA 56,v,112,v,172
TR 172,203,0
TR 174,203,2048
s_waitcnt lgkmcnt(4)
MA 0,v,80,v,144
s_add_u32 m0, s22, 32768
buffer_load_dwordx4 v[230:233], v63, s[92:95], 0 offen offset:0
MA 8,v,80,v,148
ds_read_b128 v[112:115], v195 offset:0
MA 4,v,84,v,144
MA 12,v,84,v,148
MA 64,v,88,v,144
buffer_load_dwordx4 v[2:5], v64, s[76:79], 0 offen offset:0
MA 72,v,88,v,148
buffer_load_dwordx4 v176, s[8:11], s20 offen offset:0 lds
MA 68,v,92,v,144
MA 76,v,92,v,148
ds_read_b128 v[116:119], v195 offset:2048
MA 128,v,96,v,144
MA 136,v,96,v,148
buffer_load_dwordx4 v[234:237], v63, s[92:95], 0 offen offset:512
MA 132,v,100,v,144
buffer_load_dwordx4 v177, s[8:11], s20 offen offset:1024 lds
MA 140,v,100,v,148
MA 192,v,104,v,144
MA 200,v,104,v,148
ds_read_b128 v[120:123], v195 offset:4096
MA 196,v,108,v,144
TR 144,196,16384
TR 146,196,18432
MA 204,v,108,v,148
TR 148,197,16384
TR 150,197,18432
MA 212,v,108,v,152
buffer_load_dwordx4 v178, s[8:11], s20 offen offset:2048 lds
buffer_load_dwordx4 v[6:9], v64, s[76:79], 0 offen offset:512
MA 220,v,108,v,156
MA 208,v,104,v,152
MA 216,v,104,v,156
buffer_load_dwordx4 v[238:241], v63, s[92:95], 0 offen offset:1024
MA 148,v,100,v,152
ds_read_b128 v[124:127], v195 offset:6144
buffer_load_dwordx4 v179, s[8:11], s20 offen offset:3072 lds
MA 156,v,100,v,156
MA 144,v,96,v,152
MA 152,v,96,v,156
buffer_load_dwordx4 v[12:15], v64, s[76:79], 0 offen offset:1024
MA 84,v,92,v,152
MA 92,v,92,v,156
s_add_u32 m0, s22, 36864
MA 80,v,88,v,152
ds_read_b128 v[128:131], v195 offset:8192
MA 88,v,88,v,156
MA 20,v,84,v,152
buffer_load_dwordx4 v[242:245], v63, s[92:95], 0 offen offset:1536
MA 28,v,84,v,156
MA 16,v,80,v,152
TR 152,198,16384
TR 154,198,18432
MA 24,v,80,v,156
TR 156,199,16384
TR 158,199,18432
MA 32,v,80,v,160
ds_read_b128 v[132:135], v195 offset:10240
buffer_load_dwordx4 v180, s[8:11], s20 offen offset:0 lds
MA 40,v,80,v,164
buffer_load_dwordx4 v[246:249], v64, s[76:79], 0 offen offset:1536
MA 36,v,84,v,160
MA 44,v,84,v,164
MA 96,v,88,v,160
buffer_load_dwordx4 v181, s[8:11], s20 offen offset:1024 lds
MA 104,v,88,v,164
MA 100,v,92,v,160
buffer_load_dwordx4 v[54:57], v62, s[96:99], 0 offen offset:0
MA 108,v,92,v,164
ds_read_b128 v[136:139], v195 offset:12288
MA 160,v,96,v,160
MA 168,v,96,v,164
buffer_load_dwordx4 v182, s[8:11], s20 offen offset:2048 lds
MA 164,v,100,v,160
buffer_load_dwordx4 v[58:61], v62, s[96:99], 0 offen offset:16
MA 172,v,100,v,164
MA 224,v,104,v,160
MA 232,v,104,v,164
ds_read_b128 v[140:143], v195 offset:14336
MA 228,v,108,v,160
TR 160,200,16384
TR 162,200,18432
MA 236,v,108,v,164
TR 164,201,16384
TR 166,201,18432
s_waitcnt lgkmcnt(15)
MA 244,v,108,v,168
buffer_load_dwordx4 v183, s[8:11], s20 offen offset:3072 lds
v_add_u32 v252, 0, v229
MA 252,v,108,v,172
MA 240,v,104,v,168
MA 248,v,104,v,172
s_add_u32 s20, s20, 128
MA 180,v,100,v,168
buffer_load_dwordx2 v[16:17], v252, s[84:87], 0 offen
MA 188,v,100,v,172
MA 176,v,96,v,168
MA 184,v,96,v,172
MA 116,v,92,v,168
s_and_b32 s20, s20, 1023
MA 124,v,92,v,172
v_add_u32 v253, 2048, v229
MA 112,v,88,v,168
MA 120,v,88,v,172
MA 52,v,84,v,168
MA 60,v,84,v,172
MA 48,v,80,v,168
TR 168,202,16384
TR 170,202,18432
MA 56,v,80,v,172
TR 172,203,16384
TR 174,203,18432
s_waitcnt lgkmcnt(4)
MA 0,v,112,v,144
MA 8,v,112,v,148
MA 4,v,116,v,144
MA 12,v,116,v,148
MA 64,v,120,v,144
MA 72,v,120,v,148
MA 68,v,124,v,144
MA 76,v,124,v,148
MA 128,v,128,v,144
MA 136,v,128,v,148
s_waitcnt vmcnt(19) lgkmcnt(0)
s_barrier
MA 132,v,132,v,144
s_add_u32 m0, s23, 0
s_bfe_u32 s80, s2, 0x20001
MA 140,v,132,v,148
ds_read_b128 v[80:83], v192 offset:0
s_bfe_u32 s69, s2, 0x30003
MA 192,v,136,v,144
s_lshl_b32 s80, s80, 3
s_add_u32 s69, s69, s80
MA 200,v,136,v,148
s_lshr_b32 s80, s2, 6
MA 196,v,140,v,144
TR 144,196,32768
TR 146,196,34816
MA 204,v,140,v,148
TR 148,197,32768
TR 150,197,34816
MA 212,v,140,v,152
ds_read_b128 v[84:87], v192 offset:2048
buffer_load_dwordx4 v184, s[12:15], s21 offen offset:0 lds
MA 220,v,140,v,156
s_xor_b32 s81, s80, s2
s_and_b32 s81, s81, 1
MA 208,v,136,v,152
buffer_load_dwordx4 v185, s[12:15], s21 offen offset:1024 lds
s_lshl_b32 s70, s80, 1
MA 216,v,136,v,156
s_add_u32 s70, s70, s81
s_lshl_b32 s80, s3, 1
MA 148,v,132,v,152
s_sub_u32 s80, 7, s80
s_lshl_b32 s76, s80, 17
MA 156,v,132,v,156
ds_read_b128 v[88:91], v192 offset:4096
s_lshl_b32 s80, s3, 15
MA 144,v,128,v,152
s_lshl_b32 s65, s70, 18
s_sub_u32 s64, 3932160, s65
MA 152,v,128,v,156
buffer_load_dwordx4 v186, s[12:15], s21 offen offset:2048 lds
s_add_u32 s65, s65, s80
MA 84,v,124,v,152
s_add_u32 s64, s64, s80
MA 92,v,124,v,156
s_lshl_b32 s81, s69, 12
MA 80,v,120,v,152
ds_read_b128 v[92:95], v192 offset:6144
s_lshl_b32 s100, s64, 2
MA 88,v,120,v,156
buffer_load_dwordx4 v187, s[12:15], s21 offen offset:3072 lds
s_add_u32 s100, s100, s81
MA 20,v,116,v,152
s_lshl_b32 s101, s65, 2
MA 28,v,116,v,156
s_add_u32 s101, s101, s81
MA 16,v,112,v,152
TR 152,198,32768
TR 154,198,34816
MA 24,v,112,v,156
TR 156,199,32768
TR 158,199,34816
MA 32,v,112,v,160
ds_read_b128 v[96:99], v192 offset:8192
s_add_u32 m0, s23, 4096
MA 40,v,112,v,164
s_lshl_b32 s66, s3, 17
s_lshl_b32 s81, s69, 8
MA 36,v,116,v,160
s_add_u32 s66, s66, s81
s_and_b32 s74, s2, 7
MA 44,v,116,v,164
s_lshl_b32 s74, s74, 8
s_mov_b32 s82, s66
MA 96,v,120,v,160
ds_read_b128 v[100:103], v192 offset:10240
buffer_load_dwordx4 v188, s[12:15], s21 offen offset:0 lds
MA 104,v,120,v,164
s_lshl_b32 s66, s74, 12
s_lshl_b32 s67, s3, 13
MA 100,v,124,v,160
s_lshl_b32 s68, s3, 12
s_lshl_b32 s77, s70, 1
MA 108,v,124,v,164
s_sub_u32 s77, 32, s77
MA 160,v,128,v,160
buffer_load_dwordx4 v189, s[12:15], s21 offen offset:1024 lds
v_lshrrev_b32 v66, 3, v1
MA 168,v,128,v,164
ds_read_b128 v[104:107], v192 offset:12288
v_lshlrev_b32 v66, 11, v66
MA 164,v,132,v,160
v_lshrrev_b32 v67, 4, v1
v_and_b32 v68, 7, v1
MA 172,v,132,v,164
v_xor_b32 v68, v68, v67
MA 224,v,136,v,160
buffer_load_dwordx4 v190, s[12:15], s21 offen offset:2048 lds
v_lshl_add_u32 v66, v68, 4, v66
MA 232,v,136,v,164
v_xor_b32 v69, 64, v66
MA 228,v,140,v,160
TR 160,200,32768
TR 162,200,34816
MA 236,v,140,v,164
TR 164,201,32768
TR 166,201,34816
MA 244,v,140,v,168
ds_read_b128 v[108:111], v192 offset:14336
s_lshr_b32 s83, s76, 2
MA 252,v,140,v,172
buffer_load_dwordx4 v191, s[12:15], s21 offen offset:3072 lds
v_add_u32 v208, 0, v66
MA 240,v,136,v,168
v_add_u32 v209, 15360, v69
v_add_u32 v210, -2048, v66
MA 248,v,136,v,172
v_add_u32 v210, s83, v210
v_add_u32 v211, 13312, v69
MA 180,v,132,v,168
v_add_u32 v211, s83, v211
v_and_b32 v68, 15, v1
MA 188,v,132,v,172
s_add_u32 s21, s21, 524288
v_lshlrev_b32 v69, 1, v67
MA 176,v,128,v,168
v_xor_b32 v68, v68, v69
MA 184,v,128,v,172
v_lshlrev_b32 v66, 13, v67
MA 116,v,124,v,168
v_xor_b32 v69, 0, v68
MA 124,v,124,v,172
s_and_b32 s21, s21, 4194303
v_lshl_add_u32 v69, v69, 4, v66
MA 112,v,120,v,168
v_add_u32 v212, 0, v69
MA 120,v,120,v,172
v_xor_b32 v69, 0, v68
MA 52,v,116,v,168
v_lshl_add_u32 v69, v69, 4, v66
MA 60,v,116,v,172
v_add_u32 v213, 31744, v69
MA 48,v,112,v,168
TR 168,202,32768
TR 170,202,34816
MA 56,v,112,v,172
TR 172,203,32768
TR 174,203,34816
s_waitcnt lgkmcnt(4)
MA 0,v,80,v,144
s_add_u32 m0, s22, 65536
buffer_load_dwordx2 v[18:19], v253, s[84:87], 0 offen
MA 8,v,80,v,148
ds_read_b128 v[112:115], v193 offset:0
MA 4,v,84,v,144
MA 12,v,84,v,148
MA 64,v,88,v,144
v_add_u32 v254, 4096, v229
MA 72,v,88,v,148
buffer_load_dwordx4 v176, s[8:11], s20 offen offset:0 lds
MA 68,v,92,v,144
MA 76,v,92,v,148
ds_read_b128 v[116:119], v193 offset:2048
MA 128,v,96,v,144
MA 136,v,96,v,148
buffer_load_dwordx2 v[20:21], v254, s[84:87], 0 offen
MA 132,v,100,v,144
buffer_load_dwordx4 v177, s[8:11], s20 offen offset:1024 lds
MA 140,v,100,v,148
MA 192,v,104,v,144
MA 200,v,104,v,148
ds_read_b128 v[120:123], v193 offset:4096
MA 196,v,108,v,144
TR 144,196,49152
TR 146,196,51200
MA 204,v,108,v,148
TR 148,197,49152
TR 150,197,51200
MA 212,v,108,v,152
buffer_load_dwordx4 v178, s[8:11], s20 offen offset:2048 lds
v_add_u32 v255, 6144, v229
MA 220,v,108,v,156
MA 208,v,104,v,152
MA 216,v,104,v,156
buffer_load_dwordx2 v[22:23], v255, s[84:87], 0 offen
MA 148,v,100,v,152
ds_read_b128 v[124:127], v193 offset:6144
buffer_load_dwordx4 v179, s[8:11], s20 offen offset:3072 lds
MA 156,v,100,v,156
MA 144,v,96,v,152
MA 152,v,96,v,156
buffer_load_dwordx2 v[38:39], v255, s[88:91], 0 offen
MA 84,v,92,v,152
MA 92,v,92,v,156
s_add_u32 m0, s22, 69632
MA 80,v,88,v,152
ds_read_b128 v[128:131], v193 offset:8192
MA 88,v,88,v,156
MA 20,v,84,v,152
v_add_u32 v252, 8192, v229
MA 28,v,84,v,156
MA 16,v,80,v,152
TR 152,198,49152
TR 154,198,51200
MA 24,v,80,v,156
TR 156,199,49152
TR 158,199,51200
MA 32,v,80,v,160
ds_read_b128 v[132:135], v193 offset:10240
buffer_load_dwordx4 v180, s[8:11], s20 offen offset:0 lds
MA 40,v,80,v,164
buffer_load_dwordx2 v[24:25], v252, s[84:87], 0 offen
MA 36,v,84,v,160
MA 44,v,84,v,164
MA 96,v,88,v,160
buffer_load_dwordx4 v181, s[8:11], s20 offen offset:1024 lds
MA 104,v,88,v,164
MA 100,v,92,v,160
buffer_load_dwordx2 v[40:41], v252, s[88:91], 0 offen
MA 108,v,92,v,164
ds_read_b128 v[136:139], v193 offset:12288
MA 160,v,96,v,160
MA 168,v,96,v,164
buffer_load_dwordx4 v182, s[8:11], s20 offen offset:2048 lds
MA 164,v,100,v,160
v_add_u32 v253, 10240, v229
MA 172,v,100,v,164
MA 224,v,104,v,160
MA 232,v,104,v,164
ds_read_b128 v[140:143], v193 offset:14336
MA 228,v,108,v,160
TR 160,200,49152
TR 162,200,51200
MA 236,v,108,v,164
TR 164,201,49152
TR 166,201,51200
s_waitcnt lgkmcnt(15)
MA 244,v,108,v,168
buffer_load_dwordx4 v183, s[8:11], s20 offen offset:3072 lds
buffer_load_dwordx2 v[26:27], v253, s[84:87], 0 offen
MA 252,v,108,v,172
MA 240,v,104,v,168
MA 248,v,104,v,172
s_add_u32 s20, s20, 128
MA 180,v,100,v,168
buffer_load_dwordx2 v[42:43], v253, s[88:91], 0 offen
MA 188,v,100,v,172
MA 176,v,96,v,168
MA 184,v,96,v,172
MA 116,v,92,v,168
s_and_b32 s20, s20, 1023
MA 124,v,92,v,172
v_add_u32 v254, 12288, v229
MA 112,v,88,v,168
MA 120,v,88,v,172
MA 52,v,84,v,168
MA 60,v,84,v,172
MA 48,v,80,v,168
TR 168,202,49152
TR 170,202,51200
MA 56,v,80,v,172
TR 172,203,49152
TR 174,203,51200
s_waitcnt lgkmcnt(4)
MA 0,v,112,v,144
MA 8,v,112,v,148
MA 4,v,116,v,144
MA 12,v,116,v,148
MA 64,v,120,v,144
MA 72,v,120,v,148
MA 68,v,124,v,144
MA 76,v,124,v,148
MA 128,v,128,v,144
MA 136,v,128,v,148
s_waitcnt vmcnt(16) lgkmcnt(0)
s_barrier
MA 132,v,132,v,144
s_add_u32 m0, s23, 32768
v_xor_b32 v69, 8, v68
MA 140,v,132,v,148
ds_read_b128 v[80:83], v192 offset:32768
v_lshl_add_u32 v69, v69, 4, v66
MA 192,v,136,v,144
v_add_u32 v214, 63488, v69
v_xor_b32 v69, 8, v68
MA 200,v,136,v,148
v_lshl_add_u32 v69, v69, 4, v66
MA 196,v,140,v,144
TR 144,196,0
TR 146,196,2048
MA 204,v,140,v,148
TR 148,197,0
TR 150,197,2048
MA 212,v,140,v,152
ds_read_b128 v[84:87], v192 offset:34816
buffer_load_dwordx4 v184, s[12:15], s21 offen offset:0 lds
MA 220,v,140,v,156
v_add_u32 v215, 95232, v69
v_and_b32 v66, 15, v1
MA 208,v,136,v,152
buffer_load_dwordx4 v185, s[12:15], s21 offen offset:1024 lds
v_lshrrev_b32 v68, 1, v66
MA 216,v,136,v,156
v_xor_b32 v68, v68, v67
v_lshlrev_b32 v68, 4, v68
MA 148,v,132,v,152
v_lshl_add_u32 v68, v66, 7, v68
v_add_u32 v224, s67, v68
MA 156,v,132,v,156
ds_read_b128 v[88:91], v192 offset:36864
v_xor_b32 v225, 64, v224
MA 144,v,128,v,152
v_add_u32 v226, 0x10000, v224
v_add_u32 v227, 0x10000, v225
MA 152,v,128,v,156
buffer_load_dwordx4 v186, s[12:15], s21 offen offset:2048 lds
v_bfe_u32 v66, v1, 2, 2
MA 84,v,124,v,152
v_and_b32 v68, 1, v67
v_lshl_or_b32 v68, v68, 2, v66
MA 92,v,124,v,156
v_lshl_add_u32 v66, v67, 3, v66
v_lshlrev_b32 v66, 8, v66
MA 80,v,120,v,152
ds_read_b128 v[92:95], v192 offset:38912
v_and_b32 v69, 3, v1
MA 88,v,120,v,156
buffer_load_dwordx4 v187, s[12:15], s21 offen offset:3072 lds
v_lshl_add_u32 v66, v69, 3, v66
MA 20,v,116,v,152
v_add_u32 v66, 98304, v66
MA 28,v,116,v,156
v_xor_b32 v69, 0, v68
MA 16,v,112,v,152
TR 152,198,0
TR 154,198,2048
MA 24,v,112,v,156
TR 156,199,0
TR 158,199,2048
MA 32,v,112,v,160
ds_read_b128 v[96:99], v192 offset:40960
s_add_u32 m0, s23, 36864
MA 40,v,112,v,164
v_lshl_add_u32 v216, v69, 5, v66
v_xor_b32 v69, 1, v68
MA 36,v,116,v,160
v_lshl_add_u32 v217, v69, 5, v66
v_xor_b32 v69, 2, v68
MA 44,v,116,v,164
v_lshl_add_u32 v218, v69, 5, v66
v_xor_b32 v69, 3, v68
MA 96,v,120,v,160
ds_read_b128 v[100:103], v192 offset:43008
buffer_load_dwordx4 v188, s[12:15], s21 offen offset:0 lds
MA 104,v,120,v,164
v_lshl_add_u32 v219, v69, 5, v66
v_xor_b32 v69, 4, v68
MA 100,v,124,v,160
v_lshl_add_u32 v220, v69, 5, v66
v_xor_b32 v69, 5, v68
MA 108,v,124,v,164
v_lshl_add_u32 v221, v69, 5, v66
v_xor_b32 v69, 6, v68
MA 160,v,128,v,160
buffer_load_dwordx4 v189, s[12:15], s21 offen offset:1024 lds
v_lshl_add_u32 v222, v69, 5, v66
MA 168,v,128,v,164
ds_read_b128 v[104:107], v192 offset:45056
v_xor_b32 v69, 7, v68
MA 164,v,132,v,160
v_lshl_add_u32 v223, v69, 5, v66
s_mov_b32 s44, s32
MA 172,v,132,v,164
s_mov_b32 s45, s33
MA 224,v,136,v,160
buffer_load_dwordx4 v190, s[12:15], s21 offen offset:2048 lds
s_mov_b32 s46, 4194304
MA 232,v,136,v,164
s_mov_b32 s47, 0x20000
MA 228,v,140,v,160
TR 160,200,0
TR 162,200,2048
MA 236,v,140,v,164
TR 164,201,0
TR 166,201,2048
MA 244,v,140,v,168
ds_read_b128 v[108:111], v192 offset:47104
MA 252,v,140,v,172
buffer_load_dwordx4 v191, s[12:15], s21 offen offset:3072 lds
MA 240,v,136,v,168
s_add_u32 s48, s34, s82
s_addc_u32 s49, s35, 0
MA 248,v,136,v,172
s_sub_u32 s50, 8388608, s82
s_mov_b32 s51, 0x20000
MA 180,v,132,v,168
s_add_u32 s60, s40, 33554432
s_addc_u32 s61, s41, 0
MA 188,v,132,v,172
s_add_u32 s21, s21, 524288
s_mov_b32 s62, 16777216
MA 176,v,128,v,168
s_mov_b32 s63, 0x20000
s_lshl_b32 s80, s69, 19
MA 184,v,128,v,172
s_add_u32 s52, s40, s80
s_addc_u32 s53, s41, 0
MA 116,v,124,v,168
s_lshl_b32 s54, s77, 14
s_mov_b32 s55, 0x20000
MA 124,v,124,v,172
s_and_b32 s21, s21, 4194303
s_add_u32 s80, s80, 16760832
MA 112,v,120,v,168
s_add_u32 s56, s40, s80
s_addc_u32 s57, s41, 0
MA 120,v,120,v,172
s_add_u32 s58, s54, 16384
MA 52,v,116,v,168
s_mov_b32 s59, 0x20000
MA 60,v,116,v,172
s_load_dwordx2 s[38:39], s[0:1], 112
MA 48,v,112,v,168
TR 168,202,0
TR 170,202,2048
MA 56,v,112,v,172
TR 172,203,0
TR 174,203,2048
s_waitcnt lgkmcnt(4)
MA 0,v,80,v,144
s_add_u32 m0, s22, 0
buffer_load_dwordx2 v[28:29], v254, s[84:87], 0 offen
MA 8,v,80,v,148
ds_read_b128 v[112:115], v193 offset:32768
MA 4,v,84,v,144
MA 12,v,84,v,148
MA 64,v,88,v,144
buffer_load_dwordx2 v[44:45], v254, s[88:91], 0 offen
MA 72,v,88,v,148
buffer_load_dwordx4 v176, s[8:11], s20 offen offset:0 lds
MA 68,v,92,v,144
MA 76,v,92,v,148
ds_read_b128 v[116:119], v193 offset:34816
MA 128,v,96,v,144
v_add_u32 v255, 14336, v229
MA 136,v,96,v,148
MA 132,v,100,v,144
buffer_load_dwordx4 v177, s[8:11], s20 offen offset:1024 lds
MA 140,v,100,v,148
MA 192,v,104,v,144
MA 200,v,104,v,148
ds_read_b128 v[120:123], v193 offset:36864
buffer_load_dwordx2 v[30:31], v255, s[84:87], 0 offen
MA 196,v,108,v,144
TR 144,196,16384
TR 146,196,18432
MA 204,v,108,v,148
TR 148,197,16384
TR 150,197,18432
MA 212,v,108,v,152
buffer_load_dwordx4 v178, s[8:11], s20 offen offset:2048 lds
MA 220,v,108,v,156
buffer_load_dwordx2 v[46:47], v255, s[88:91], 0 offen
MA 208,v,104,v,152
MA 216,v,104,v,156
MA 148,v,100,v,152
ds_read_b128 v[124:127], v193 offset:38912
buffer_load_dwordx4 v179, s[8:11], s20 offen offset:3072 lds
MA 156,v,100,v,156
MA 144,v,96,v,152
v_add_u32 v252, 16384, v229
MA 152,v,96,v,156
MA 84,v,92,v,152
MA 92,v,92,v,156
s_add_u32 m0, s22, 4096
MA 80,v,88,v,152
ds_read_b128 v[128:131], v193 offset:40960
buffer_load_dwordx2 v[32:33], v252, s[84:87], 0 offen
MA 88,v,88,v,156
MA 20,v,84,v,152
MA 28,v,84,v,156
MA 16,v,80,v,152
TR 152,198,16384
TR 154,198,18432
MA 24,v,80,v,156
TR 156,199,16384
TR 158,199,18432
MA 32,v,80,v,160
ds_read_b128 v[132:135], v193 offset:43008
buffer_load_dwordx4 v180, s[8:11], s20 offen offset:0 lds
MA 40,v,80,v,164
buffer_load_dwordx2 v[48:49], v252, s[88:91], 0 offen
MA 36,v,84,v,160
MA 44,v,84,v,164
v_add_u32 v253, 18432, v229
MA 96,v,88,v,160
buffer_load_dwordx4 v181, s[8:11], s20 offen offset:1024 lds
MA 104,v,88,v,164
MA 100,v,92,v,160
MA 108,v,92,v,164
ds_read_b128 v[136:139], v193 offset:45056
buffer_load_dwordx2 v[34:35], v253, s[84:87], 0 offen
MA 160,v,96,v,160
MA 168,v,96,v,164
buffer_load_dwordx4 v182, s[8:11], s20 offen offset:2048 lds
MA 164,v,100,v,160
MA 172,v,100,v,164
MA 224,v,104,v,160
buffer_load_dwordx2 v[50:51], v253, s[88:91], 0 offen
MA 232,v,104,v,164
ds_read_b128 v[140:143], v193 offset:47104
MA 228,v,108,v,160
TR 160,200,16384
TR 162,200,18432
MA 236,v,108,v,164
TR 164,201,16384
TR 166,201,18432
s_waitcnt lgkmcnt(15)
MA 244,v,108,v,168
buffer_load_dwordx4 v183, s[8:11], s20 offen offset:3072 lds
v_add_u32 v254, 20480, v229
MA 252,v,108,v,172
MA 240,v,104,v,168
MA 248,v,104,v,172
s_add_u32 s20, s20, 128
MA 180,v,100,v,168
MA 188,v,100,v,172
buffer_load_dwordx2 v[36:37], v254, s[84:87], 0 offen
MA 176,v,96,v,168
MA 184,v,96,v,172
MA 116,v,92,v,168
s_and_b32 s20, s20, 1023
MA 124,v,92,v,172
buffer_load_dwordx2 v[52:53], v254, s[88:91], 0 offen
MA 112,v,88,v,168
MA 120,v,88,v,172
MA 52,v,84,v,168
MA 60,v,84,v,172
MA 48,v,80,v,168
TR 168,202,16384
TR 170,202,18432
MA 56,v,80,v,172
TR 172,203,16384
TR 174,203,18432
s_waitcnt lgkmcnt(4)
MA 0,v,112,v,144
MA 8,v,112,v,148
MA 4,v,116,v,144
MA 12,v,116,v,148
MA 64,v,120,v,144
MA 72,v,120,v,148
MA 68,v,124,v,144
MA 76,v,124,v,148
MA 128,v,128,v,144
MA 136,v,128,v,148
s_waitcnt vmcnt(18) lgkmcnt(0)
s_barrier
MA 132,v,132,v,144
s_add_u32 m0, s23, 0
s_and_b32 s37, s3, 3
MA 140,v,132,v,148
ds_read_b128 v[80:83], v194 offset:0
MA 192,v,136,v,144
s_cmp_eq_u32 s37, 0
s_cselect_b32 s37, 0, 0x40000000
MA 200,v,136,v,148
MA 196,v,140,v,144
TR 144,196,32768
TR 146,196,34816
MA 204,v,140,v,148
TR 148,197,32768
TR 150,197,34816
MA 212,v,140,v,152
ds_read_b128 v[84:87], v194 offset:2048
buffer_load_dwordx4 v184, s[12:15], s21 offen offset:0 lds
MA 220,v,140,v,156
v_add_u32 v229, s37, v78
MA 208,v,136,v,152
buffer_load_dwordx4 v185, s[12:15], s21 offen offset:1024 lds
MA 216,v,136,v,156
buffer_load_dword v79, v229, s[4:7], 0 offen
MA 148,v,132,v,152
MA 156,v,132,v,156
ds_read_b128 v[88:91], v194 offset:4096
s_getpc_b64 s[82:83]
L_ct_fV:
MA 144,v,128,v,152
MA 152,v,128,v,156
buffer_load_dwordx4 v186, s[12:15], s21 offen offset:2048 lds
MA 84,v,124,v,152
s_add_u32 s82, s82, L_p2 - L_ct_fV
s_addc_u32 s83, s83, 0
MA 92,v,124,v,156
MA 80,v,120,v,152
ds_read_b128 v[92:95], v194 offset:6144
MA 88,v,120,v,156
buffer_load_dwordx4 v187, s[12:15], s21 offen offset:3072 lds
MA 20,v,116,v,152
v_mov_b32 v67, s83
MA 28,v,116,v,156
MA 16,v,112,v,152
TR 152,198,32768
TR 154,198,34816
MA 24,v,112,v,156
TR 156,199,32768
TR 158,199,34816
MA 32,v,112,v,160
ds_read_b128 v[96:99], v194 offset:8192
s_add_u32 m0, s23, 4096
MA 40,v,112,v,164
v_mov_b32 v66, s82
s_lshr_b32 s82, s2, 3
MA 36,v,116,v,160
s_lshl_b32 s82, s82, 2
MA 44,v,116,v,164
MA 96,v,120,v,160
ds_read_b128 v[100:103], v194 offset:10240
buffer_load_dwordx4 v188, s[12:15], s21 offen offset:0 lds
MA 104,v,120,v,164
s_add_u32 s82, s82, s3
MA 100,v,124,v,160
MA 108,v,124,v,164
s_lshl_b32 s82, s82, 7
MA 160,v,128,v,160
buffer_load_dwordx4 v189, s[12:15], s21 offen offset:1024 lds
MA 168,v,128,v,164
ds_read_b128 v[104:107], v194 offset:12288
v_and_b32 v68, 3, v1
MA 164,v,132,v,160
MA 172,v,132,v,164
v_lshlrev_b32 v68, 14, v68
MA 224,v,136,v,160
buffer_load_dwordx4 v190, s[12:15], s21 offen offset:2048 lds
MA 232,v,136,v,164
MA 228,v,140,v,160
TR 160,200,32768
TR 162,200,34816
MA 236,v,140,v,164
TR 164,201,32768
TR 166,201,34816
MA 244,v,140,v,168
ds_read_b128 v[108:111], v194 offset:14336
v_add_u32 v68, s82, v68
MA 252,v,140,v,172
buffer_load_dwordx4 v191, s[12:15], s21 offen offset:3072 lds
v_min_u32 v68, L_p3_begin - L_p2 - 4, v68
MA 240,v,136,v,168
v_add_co_u32 v66, vcc, v66, v68
s_nop 1
v_addc_co_u32 v67, vcc, 0, v67, vcc
MA 248,v,136,v,172
MA 180,v,132,v,168
MA 188,v,132,v,172
s_add_u32 s21, s21, 524288
MA 176,v,128,v,168
MA 184,v,128,v,172
MA 116,v,124,v,168
MA 124,v,124,v,172
s_and_b32 s21, s21, 4194303
MA 112,v,120,v,168
MA 120,v,120,v,172
global_load_dword v68, v[66:67], off
MA 52,v,116,v,168
MA 60,v,116,v,172
MA 48,v,112,v,168
TR 168,202,32768
TR 170,202,34816
MA 56,v,112,v,172
TR 172,203,32768
TR 174,203,34816
s_waitcnt lgkmcnt(4)
MA 0,v,80,v,144
s_add_u32 m0, s22, 32768
s_and_b32 s37, s3, 3
MA 8,v,80,v,148
ds_read_b128 v[112:115], v195 offset:0
MA 4,v,84,v,144
MA 12,v,84,v,148
MA 64,v,88,v,144
MA 72,v,88,v,148
buffer_load_dwordx4 v176, s[8:11], s20 offen offset:0 lds
MA 68,v,92,v,144
MA 76,v,92,v,148
ds_read_b128 v[116:119], v195 offset:2048
MA 128,v,96,v,144
MA 136,v,96,v,148
MA 132,v,100,v,144
buffer_load_dwordx4 v177, s[8:11], s20 offen offset:1024 lds
MA 140,v,100,v,148
MA 192,v,104,v,144
s_cmp_eq_u32 s37, 1
s_cselect_b32 s37, 0, 0x40000000
MA 200,v,104,v,148
ds_read_b128 v[120:123], v195 offset:4096
MA 196,v,108,v,144
TR 144,196,49152
TR 146,196,51200
MA 204,v,108,v,148
TR 148,197,49152
TR 150,197,51200
MA 212,v,108,v,152
buffer_load_dwordx4 v178, s[8:11], s20 offen offset:2048 lds
MA 220,v,108,v,156
MA 208,v,104,v,152
MA 216,v,104,v,156
MA 148,v,100,v,152
ds_read_b128 v[124:127], v195 offset:6144
buffer_load_dwordx4 v179, s[8:11], s20 offen offset:3072 lds
MA 156,v,100,v,156
MA 144,v,96,v,152
MA 152,v,96,v,156
MA 84,v,92,v,152
MA 92,v,92,v,156
s_add_u32 m0, s22, 36864
MA 80,v,88,v,152
ds_read_b128 v[128:131], v195 offset:8192
MA 88,v,88,v,156
MA 20,v,84,v,152
MA 28,v,84,v,156
MA 16,v,80,v,152
TR 152,198,49152
TR 154,198,51200
MA 24,v,80,v,156
TR 156,199,49152
TR 158,199,51200
MA 32,v,80,v,160
ds_read_b128 v[132:135], v195 offset:10240
buffer_load_dwordx4 v180, s[8:11], s20 offen offset:0 lds
MA 40,v,80,v,164
MA 36,v,84,v,160
MA 44,v,84,v,164
MA 96,v,88,v,160
buffer_load_dwordx4 v181, s[8:11], s20 offen offset:1024 lds
MA 104,v,88,v,164
v_add_u32 v229, s37, v78
MA 100,v,92,v,160
MA 108,v,92,v,164
ds_read_b128 v[136:139], v195 offset:12288
MA 160,v,96,v,160
MA 168,v,96,v,164
buffer_load_dwordx4 v182, s[8:11], s20 offen offset:2048 lds
MA 164,v,100,v,160
MA 172,v,100,v,164
MA 224,v,104,v,160
MA 232,v,104,v,164
ds_read_b128 v[140:143], v195 offset:14336
MA 228,v,108,v,160
TR 160,200,49152
TR 162,200,51200
MA 236,v,108,v,164
TR 164,201,49152
TR 166,201,51200
s_waitcnt lgkmcnt(15)
MA 244,v,108,v,168
buffer_load_dwordx4 v183, s[8:11], s20 offen offset:3072 lds
MA 252,v,108,v,172
buffer_load_dword v79, v229, s[4:7], 0 offen
MA 240,v,104,v,168
MA 248,v,104,v,172
s_add_u32 s20, s20, 128
MA 180,v,100,v,168
MA 188,v,100,v,172
MA 176,v,96,v,168
MA 184,v,96,v,172
MA 116,v,92,v,168
s_and_b32 s20, s20, 1023
MA 124,v,92,v,172
MA 112,v,88,v,168
MA 120,v,88,v,172
MA 52,v,84,v,168
MA 60,v,84,v,172
MA 48,v,80,v,168
TR 168,202,49152
TR 170,202,51200
MA 56,v,80,v,172
TR 172,203,49152
TR 174,203,51200
s_waitcnt lgkmcnt(4)
MA 0,v,112,v,144
MA 8,v,112,v,148
MA 4,v,116,v,144
MA 12,v,116,v,148
MA 64,v,120,v,144
MA 72,v,120,v,148
MA 68,v,124,v,144
MA 76,v,124,v,148
MA 128,v,128,v,144
MA 136,v,128,v,148
s_waitcnt vmcnt(10) lgkmcnt(0)
s_barrier
MA 132,v,132,v,144
s_add_u32 m0, s23, 32768
s_and_b32 s37, s3, 3
MA 140,v,132,v,148
ds_read_b128 v[80:83], v192 offset:0
MA 192,v,136,v,144
s_cmp_eq_u32 s37, 2
s_cselect_b32 s37, 0, 0x40000000
MA 200,v,136,v,148
v_add_u32 v229, s37, v78
buffer_load_dword v79, v229, s[4:7], 0 offen
MA 196,v,140,v,144
TR 144,196,0
TR 146,196,2048
MA 204,v,140,v,148
TR 148,197,0
TR 150,197,2048
MA 212,v,140,v,152
ds_read_b128 v[84:87], v192 offset:2048
buffer_load_dwordx4 v184, s[12:15], s21 offen offset:0 lds
MA 220,v,140,v,156
s_add_u32 s84, s40, 50331648
s_addc_u32 s85, s41, 0
MA 208,v,136,v,152
buffer_load_dwordx4 v185, s[12:15], s21 offen offset:1024 lds
s_mov_b32 s86, 4194304
MA 216,v,136,v,156
s_mov_b32 s87, 0x20000
MA 148,v,132,v,152
s_add_u32 s88, s40, 58720256
s_addc_u32 s89, s41, 0
MA 156,v,132,v,156
ds_read_b128 v[88:91], v192 offset:4096
s_mov_b32 s90, 8192
MA 144,v,128,v,152
s_mov_b32 s91, 0x20000
v_mov_b32 v252, 0
MA 152,v,128,v,156
buffer_load_dwordx4 v186, s[12:15], s21 offen offset:2048 lds
v_mov_b32 v253, 0
MA 84,v,124,v,152
v_dot2_f32_bf16 v252, v230, v2, v252
v_dot2_f32_bf16 v253, v231, v3, v253
MA 92,v,124,v,156
v_dot2_f32_bf16 v252, v232, v4, v252
v_dot2_f32_bf16 v253, v233, v5, v253
MA 80,v,120,v,152
ds_read_b128 v[92:95], v192 offset:6144
v_dot2_f32_bf16 v252, v234, v6, v252
MA 88,v,120,v,156
buffer_load_dwordx4 v187, s[12:15], s21 offen offset:3072 lds
v_dot2_f32_bf16 v253, v235, v7, v253
MA 20,v,116,v,152
v_dot2_f32_bf16 v252, v236, v8, v252
v_dot2_f32_bf16 v253, v237, v9, v253
MA 28,v,116,v,156
v_dot2_f32_bf16 v252, v238, v12, v252
v_dot2_f32_bf16 v253, v239, v13, v253
MA 16,v,112,v,152
TR 152,198,0
TR 154,198,2048
MA 24,v,112,v,156
TR 156,199,0
TR 158,199,2048
MA 32,v,112,v,160
ds_read_b128 v[96:99], v192 offset:8192
s_add_u32 m0, s23, 36864
MA 40,v,112,v,164
v_dot2_f32_bf16 v252, v240, v14, v252
v_dot2_f32_bf16 v253, v241, v15, v253
MA 36,v,116,v,160
v_dot2_f32_bf16 v252, v242, v246, v252
v_dot2_f32_bf16 v253, v243, v247, v253
MA 44,v,116,v,164
v_dot2_f32_bf16 v252, v244, v248, v252
v_dot2_f32_bf16 v253, v245, v249, v253
MA 96,v,120,v,160
ds_read_b128 v[100:103], v192 offset:10240
buffer_load_dwordx4 v188, s[12:15], s21 offen offset:0 lds
MA 104,v,120,v,164
s_nop 2
v_add_f32 v252, v252, v253
MA 100,v,124,v,160
s_nop 0
v_add_f32_dpp v252, v252, v252 row_ror:8 row_mask:0xf bank_mask:0xf
s_nop 1
v_add_f32_dpp v252, v252, v252 row_ror:4 row_mask:0xf bank_mask:0xf
MA 108,v,124,v,164
s_nop 0
v_add_f32_dpp v252, v252, v252 row_ror:2 row_mask:0xf bank_mask:0xf
s_nop 1
v_add_f32_dpp v252, v252, v252 row_ror:1 row_mask:0xf bank_mask:0xf
MA 160,v,128,v,160
buffer_load_dwordx4 v189, s[12:15], s21 offen offset:1024 lds
v_mov_b32 v253, v252
MA 168,v,128,v,164
ds_read_b128 v[104:107], v192 offset:12288
v_permlane16_swap_b32 v252, v253
MA 164,v,132,v,160
v_add_f32 v252, v252, v253
v_mul_f32 v252, 0xbfb8aa3b, v252
MA 172,v,132,v,164
v_exp_f32 v252, v252
MA 224,v,136,v,160
buffer_load_dwordx4 v190, s[12:15], s21 offen offset:2048 lds
v_add_f32 v252, 1.0, v252
MA 232,v,136,v,164
v_rcp_f32 v252, v252
MA 228,v,140,v,160
TR 160,200,0
TR 162,200,2048
MA 236,v,140,v,164
TR 164,201,0
TR 166,201,2048
MA 244,v,140,v,168
ds_read_b128 v[108:111], v192 offset:14336
MA 252,v,140,v,172
buffer_load_dwordx4 v191, s[12:15], s21 offen offset:3072 lds
MA 240,v,136,v,168
s_nop 0
buffer_store_dword v252, v11, s[88:91], 0 offen sc1
MA 248,v,136,v,172
v_lshlrev_b32 v2, 16, v54
v_and_b32 v3, 0xffff0000, v54
MA 180,v,132,v,168
v_lshlrev_b32 v4, 16, v55
v_and_b32 v5, 0xffff0000, v55
MA 188,v,132,v,172
s_add_u32 s21, s21, 524288
v_lshlrev_b32 v6, 16, v56
MA 176,v,128,v,168
v_and_b32 v7, 0xffff0000, v56
v_lshlrev_b32 v8, 16, v57
MA 184,v,128,v,172
v_and_b32 v9, 0xffff0000, v57
v_lshlrev_b32 v230, 16, v16
MA 116,v,124,v,168
v_and_b32 v231, 0xffff0000, v16
v_lshlrev_b32 v232, 16, v18
MA 124,v,124,v,172
s_and_b32 s21, s21, 4194303
v_and_b32 v233, 0xffff0000, v18
MA 112,v,120,v,168
v_lshlrev_b32 v234, 16, v20
v_and_b32 v235, 0xffff0000, v20
MA 120,v,120,v,172
v_lshlrev_b32 v236, 16, v22
v_and_b32 v237, 0xffff0000, v22
MA 52,v,116,v,168
v_lshlrev_b32 v238, 16, v24
v_and_b32 v239, 0xffff0000, v24
MA 60,v,116,v,172
v_lshlrev_b32 v240, 16, v26
v_and_b32 v241, 0xffff0000, v26
MA 48,v,112,v,168
TR 168,202,0
TR 170,202,2048
MA 56,v,112,v,172
TR 172,203,0
TR 174,203,2048
v_lshlrev_b32 v242, 16, v28
v_and_b32 v243, 0xffff0000, v28
v_lshlrev_b32 v244, 16, v30
v_and_b32 v245, 0xffff0000, v30
v_lshlrev_b32 v246, 16, v32
v_and_b32 v247, 0xffff0000, v32
v_lshlrev_b32 v248, 16, v34
v_and_b32 v249, 0xffff0000, v34
v_lshlrev_b32 v250, 16, v36
v_and_b32 v251, 0xffff0000, v36
v_lshlrev_b32 v254, 16, v38
v_and_b32 v255, 0xffff0000, v38
v_mul_f32 v62, v236, v2
v_mul_f32 v70, v237, v6
v_fmac_f32 v62, v234, v3
v_fmac_f32 v70, v235, v7
v_fmac_f32 v62, v232, v4
v_fmac_f32 v70, v233, v8
v_fmac_f32 v62, v230, v5
v_fmac_f32 v70, v231, v9
v_mul_f32 v62, v62, v254
s_waitcnt lgkmcnt(4)
MA 0,v,80,v,144
s_add_u32 s75, s64, s74
s_and_b32 s37, s3, 3
MA 8,v,80,v,148
ds_read_b128 v[112:115], v193 offset:0
MA 4,v,84,v,144
s_cmp_eq_u32 s37, 3
s_cselect_b32 s37, 0, 0x40000000
MA 12,v,84,v,148
v_add_u32 v229, s37, v78
buffer_load_dword v79, v229, s[4:7], 0 offen
MA 64,v,88,v,144
s_add_u32 m0, s67, 65536
v_mul_f32 v70, v70, v255
MA 72,v,88,v,148
v_lshlrev_b32 v254, 16, v40
v_and_b32 v255, 0xffff0000, v40
MA 68,v,92,v,144
v_mul_f32 v63, v238, v2
v_mul_f32 v71, v239, v6
MA 76,v,92,v,148
ds_read_b128 v[116:119], v193 offset:2048
v_fmac_f32 v63, v236, v3
MA 128,v,96,v,144
buffer_load_dwordx4 v208, s[44:47], s75 offen offset:0 lds
v_fmac_f32 v71, v237, v7
MA 136,v,96,v,148
v_fmac_f32 v63, v234, v4
v_fmac_f32 v71, v235, v8
MA 132,v,100,v,144
v_fmac_f32 v63, v232, v5
MA 140,v,100,v,148
v_fmac_f32 v71, v233, v9
v_mul_f32 v63, v63, v254
MA 192,v,104,v,144
v_mul_f32 v71, v71, v255
MA 200,v,104,v,148
ds_read_b128 v[120:123], v193 offset:4096
buffer_load_dwordx4 v209, s[44:47], s75 offen offset:1024 lds
MA 196,v,108,v,144
TR 144,196,16384
TR 146,196,18432
MA 204,v,108,v,148
TR 148,197,16384
TR 150,197,18432
MA 212,v,108,v,152
v_lshlrev_b32 v254, 16, v42
v_and_b32 v255, 0xffff0000, v42
MA 220,v,108,v,156
buffer_load_dwordx4 v210, s[44:47], s75 offen offset:2048 lds
v_mul_f32 v64, v240, v2
MA 208,v,104,v,152
v_mul_f32 v72, v241, v6
v_fmac_f32 v64, v238, v3
MA 216,v,104,v,156
v_fmac_f32 v72, v239, v7
v_fmac_f32 v64, v236, v4
MA 148,v,100,v,152
ds_read_b128 v[124:127], v193 offset:6144
v_fmac_f32 v72, v237, v8
MA 156,v,100,v,156
v_fmac_f32 v64, v234, v5
v_fmac_f32 v72, v235, v9
MA 144,v,96,v,152
buffer_load_dwordx4 v211, s[44:47], s75 offen offset:3072 lds
v_mul_f32 v64, v64, v254
MA 152,v,96,v,156
v_mul_f32 v72, v72, v255
v_lshlrev_b32 v254, 16, v44
MA 84,v,92,v,152
v_and_b32 v255, 0xffff0000, v44
v_mul_f32 v65, v242, v2
MA 92,v,92,v,156
v_mul_f32 v73, v243, v6
v_fmac_f32 v65, v240, v3
MA 80,v,88,v,152
ds_read_b128 v[128:131], v193 offset:8192
s_add_u32 s75, s65, s74
MA 88,v,88,v,156
v_fmac_f32 v73, v241, v7
v_fmac_f32 v65, v238, v4
MA 20,v,84,v,152
v_fmac_f32 v73, v239, v8
v_fmac_f32 v65, v236, v5
MA 28,v,84,v,156
v_fmac_f32 v73, v237, v9
v_mul_f32 v65, v65, v254
MA 16,v,80,v,152
TR 152,198,16384
TR 154,198,18432
MA 24,v,80,v,156
TR 156,199,16384
TR 158,199,18432
MA 32,v,80,v,160
ds_read_b128 v[132:135], v193 offset:10240
s_add_u32 m0, s67, 69632
MA 40,v,80,v,164
v_mul_f32 v73, v73, v255
v_lshlrev_b32 v254, 16, v46
MA 36,v,84,v,160
v_and_b32 v255, 0xffff0000, v46
v_mul_f32 v66, v244, v2
MA 44,v,84,v,164
buffer_load_dwordx4 v208, s[44:47], s75 offen offset:0 lds
v_mul_f32 v74, v245, v6
MA 96,v,88,v,160
v_fmac_f32 v66, v242, v3
v_fmac_f32 v74, v243, v7
MA 104,v,88,v,164
v_fmac_f32 v66, v240, v4
v_fmac_f32 v74, v241, v8
MA 100,v,92,v,160
v_fmac_f32 v66, v238, v5
v_fmac_f32 v74, v239, v9
MA 108,v,92,v,164
ds_read_b128 v[136:139], v193 offset:12288
buffer_load_dwordx4 v209, s[44:47], s75 offen offset:1024 lds
MA 160,v,96,v,160
v_mul_f32 v66, v66, v254
v_mul_f32 v74, v74, v255
MA 168,v,96,v,164
v_lshlrev_b32 v254, 16, v48
v_and_b32 v255, 0xffff0000, v48
MA 164,v,100,v,160
v_mul_f32 v67, v246, v2
v_mul_f32 v75, v247, v6
MA 172,v,100,v,164
v_fmac_f32 v67, v244, v3
MA 224,v,104,v,160
buffer_load_dwordx4 v210, s[44:47], s75 offen offset:2048 lds
v_fmac_f32 v75, v245, v7
MA 232,v,104,v,164
ds_read_b128 v[140:143], v193 offset:14336
v_fmac_f32 v67, v242, v4
MA 228,v,108,v,160
TR 160,200,16384
TR 162,200,18432
MA 236,v,108,v,164
TR 164,201,16384
TR 166,201,18432
s_waitcnt lgkmcnt(15)
MA 244,v,108,v,168
buffer_load_dwordx4 v211, s[44:47], s75 offen offset:3072 lds
v_fmac_f32 v75, v243, v8
MA 252,v,108,v,172
v_fmac_f32 v67, v240, v5
v_fmac_f32 v75, v241, v9
MA 240,v,104,v,168
v_mul_f32 v67, v67, v254
v_mul_f32 v75, v75, v255
MA 248,v,104,v,172
v_lshlrev_b32 v254, 16, v50
v_and_b32 v255, 0xffff0000, v50
MA 180,v,100,v,168
s_waitcnt vmcnt(28)
v_mul_f32 v68, v248, v2
v_mul_f32 v76, v249, v6
MA 188,v,100,v,172
s_add_u32 s74, s74, 128
v_fmac_f32 v68, v246, v3
MA 176,v,96,v,168
v_fmac_f32 v76, v247, v7
v_fmac_f32 v68, v244, v4
MA 184,v,96,v,172
v_fmac_f32 v76, v245, v8
v_fmac_f32 v68, v242, v5
MA 116,v,92,v,168
v_fmac_f32 v76, v243, v9
v_mul_f32 v68, v68, v254
MA 124,v,92,v,172
s_and_b32 s74, s74, 2047
v_mul_f32 v76, v76, v255
MA 112,v,88,v,168
v_lshlrev_b32 v254, 16, v52
MA 120,v,88,v,172
v_and_b32 v255, 0xffff0000, v52
v_mul_f32 v69, v250, v2
MA 52,v,84,v,168
v_mul_f32 v77, v251, v6
MA 60,v,84,v,172
v_fmac_f32 v69, v248, v3
MA 48,v,80,v,168
TR 168,202,16384
TR 170,202,18432
MA 56,v,80,v,172
TR 172,203,16384
TR 174,203,18432
s_waitcnt lgkmcnt(4)
MA 0,v,112,v,144
MA 8,v,112,v,148
MA 4,v,116,v,144
MA 12,v,116,v,148
MA 64,v,120,v,144
MA 72,v,120,v,148
MA 68,v,124,v,144
MA 76,v,124,v,148
MA 128,v,128,v,144
MA 136,v,128,v,148
s_waitcnt vmcnt(10) lgkmcnt(0)
s_barrier
MA 132,v,132,v,144
s_add_u32 m0, s68, 98304
v_fmac_f32 v77, v249, v7
MA 140,v,132,v,148
ds_read_b128 v[80:83], v192 offset:32768
v_fmac_f32 v69, v246, v4
MA 192,v,136,v,144
v_fmac_f32 v77, v247, v8
v_fmac_f32 v69, v244, v5
MA 200,v,136,v,148
buffer_load_dwordx4 v212, s[48:51], s66 offen offset:0 lds
v_fmac_f32 v77, v245, v9
MA 196,v,140,v,144
TR 144,196,32768
TR 146,196,34816
MA 204,v,140,v,148
TR 148,197,32768
TR 150,197,34816
MA 212,v,140,v,152
ds_read_b128 v[84:87], v192 offset:34816
v_mul_f32 v69, v69, v254
MA 220,v,140,v,156
buffer_load_dwordx4 v213, s[48:51], s66 offen offset:1024 lds
v_mul_f32 v77, v77, v255
MA 208,v,136,v,152
v_cvt_pk_bf16_f32 v12, v69, v68
v_cvt_pk_bf16_f32 v13, v67, v66
MA 216,v,136,v,156
v_cvt_pk_bf16_f32 v14, v65, v64
v_cvt_pk_bf16_f32 v15, v63, v62
MA 148,v,132,v,152
s_mov_b32 s36, 0
buffer_store_dwordx4 v[12:15], v10, s[84:87], s36 offen sc1
MA 156,v,132,v,156
ds_read_b128 v[88:91], v192 offset:36864
buffer_load_dwordx4 v214, s[48:51], s66 offen offset:2048 lds
MA 144,v,128,v,152
v_cvt_pk_bf16_f32 v54, v77, v76
v_cvt_pk_bf16_f32 v55, v75, v74
MA 152,v,128,v,156
v_cvt_pk_bf16_f32 v56, v73, v72
v_cvt_pk_bf16_f32 v57, v71, v70
MA 84,v,124,v,152
buffer_load_dwordx4 v215, s[48:51], s66 offen offset:3072 lds
s_mov_b32 s36, 4096
MA 92,v,124,v,156
buffer_store_dwordx4 v[54:57], v10, s[84:87], s36 offen sc1
v_lshlrev_b32 v2, 16, v58
MA 80,v,120,v,152
ds_read_b128 v[92:95], v192 offset:38912
v_and_b32 v3, 0xffff0000, v58
MA 88,v,120,v,156
v_lshlrev_b32 v4, 16, v59
v_and_b32 v5, 0xffff0000, v59
MA 20,v,116,v,152
s_add_u32 s66, s66, 524288
v_lshlrev_b32 v6, 16, v60
MA 28,v,116,v,156
v_and_b32 v7, 0xffff0000, v60
v_lshlrev_b32 v8, 16, v61
MA 16,v,112,v,152
TR 152,198,32768
TR 154,198,34816
MA 24,v,112,v,156
TR 156,199,32768
TR 158,199,34816
MA 32,v,112,v,160
ds_read_b128 v[96:99], v192 offset:40960
s_and_b32 s66, s66, 8388607
MA 40,v,112,v,164
v_and_b32 v9, 0xffff0000, v61
v_lshlrev_b32 v230, 16, v17
MA 36,v,116,v,160
v_and_b32 v231, 0xffff0000, v17
v_lshlrev_b32 v232, 16, v19
MA 44,v,116,v,164
v_and_b32 v233, 0xffff0000, v19
v_lshlrev_b32 v234, 16, v21
MA 96,v,120,v,160
ds_read_b128 v[100:103], v192 offset:43008
s_add_u32 m0, s68, 114688
MA 104,v,120,v,164
v_and_b32 v235, 0xffff0000, v21
v_lshlrev_b32 v236, 16, v23
MA 100,v,124,v,160
v_and_b32 v237, 0xffff0000, v23
v_lshlrev_b32 v238, 16, v25
MA 108,v,124,v,164
buffer_load_dwordx4 v212, s[48:51], s66 offen offset:0 lds
v_and_b32 v239, 0xffff0000, v25
MA 160,v,128,v,160
v_lshlrev_b32 v240, 16, v27
v_and_b32 v241, 0xffff0000, v27
MA 168,v,128,v,164
ds_read_b128 v[104:107], v192 offset:45056
v_lshlrev_b32 v242, 16, v29
MA 164,v,132,v,160
v_and_b32 v243, 0xffff0000, v29
v_lshlrev_b32 v244, 16, v31
MA 172,v,132,v,164
buffer_load_dwordx4 v213, s[48:51], s66 offen offset:1024 lds
v_and_b32 v245, 0xffff0000, v31
MA 224,v,136,v,160
v_lshlrev_b32 v246, 16, v33
v_and_b32 v247, 0xffff0000, v33
MA 232,v,136,v,164
v_lshlrev_b32 v248, 16, v35
v_and_b32 v249, 0xffff0000, v35
MA 228,v,140,v,160
TR 160,200,32768
TR 162,200,34816
MA 236,v,140,v,164
TR 164,201,32768
TR 166,201,34816
MA 244,v,140,v,168
ds_read_b128 v[108:111], v192 offset:47104
buffer_load_dwordx4 v214, s[48:51], s66 offen offset:2048 lds
MA 252,v,140,v,172
v_lshlrev_b32 v250, 16, v37
v_and_b32 v251, 0xffff0000, v37
MA 240,v,136,v,168
buffer_load_dwordx4 v215, s[48:51], s66 offen offset:3072 lds
v_lshlrev_b32 v254, 16, v39
MA 248,v,136,v,172
v_and_b32 v255, 0xffff0000, v39
v_mul_f32 v62, v236, v2
MA 180,v,132,v,168
v_mul_f32 v70, v237, v6
v_fmac_f32 v62, v234, v3
MA 188,v,132,v,172
v_fmac_f32 v70, v235, v7
v_fmac_f32 v62, v232, v4
MA 176,v,128,v,168
s_add_u32 s66, s66, 524288
v_fmac_f32 v70, v233, v8
MA 184,v,128,v,172
v_fmac_f32 v62, v230, v5
v_fmac_f32 v70, v231, v9
MA 116,v,124,v,168
v_mul_f32 v62, v62, v254
v_mul_f32 v70, v70, v255
MA 124,v,124,v,172
v_lshlrev_b32 v254, 16, v41
v_and_b32 v255, 0xffff0000, v41
MA 112,v,120,v,168
s_and_b32 s66, s66, 8388607
v_mul_f32 v63, v238, v2
MA 120,v,120,v,172
v_mul_f32 v71, v239, v6
v_fmac_f32 v63, v236, v3
MA 52,v,116,v,168
v_fmac_f32 v71, v237, v7
v_fmac_f32 v63, v234, v4
MA 60,v,116,v,172
v_fmac_f32 v71, v235, v8
v_fmac_f32 v63, v232, v5
MA 48,v,112,v,168
TR 168,202,32768
TR 170,202,34816
MA 56,v,112,v,172
TR 172,203,32768
TR 174,203,34816
v_fmac_f32 v71, v233, v9
v_mul_f32 v63, v63, v254
v_mul_f32 v71, v71, v255
v_lshlrev_b32 v254, 16, v43
v_and_b32 v255, 0xffff0000, v43
v_mul_f32 v64, v240, v2
v_mul_f32 v72, v241, v6
v_fmac_f32 v64, v238, v3
s_waitcnt lgkmcnt(4)
MA 0,v,80,v,144
s_add_u32 s75, s64, s74
v_fmac_f32 v72, v239, v7
MA 8,v,80,v,148
ds_read_b128 v[112:115], v193 offset:32768
v_fmac_f32 v64, v236, v4
MA 4,v,84,v,144
v_fmac_f32 v72, v237, v8
v_fmac_f32 v64, v234, v5
MA 12,v,84,v,148
v_fmac_f32 v72, v235, v9
v_mul_f32 v64, v64, v254
MA 64,v,88,v,144
s_add_u32 m0, s67, 0
v_mul_f32 v72, v72, v255
MA 72,v,88,v,148
v_lshlrev_b32 v254, 16, v45
MA 68,v,92,v,144
v_and_b32 v255, 0xffff0000, v45
v_mul_f32 v65, v242, v2
MA 76,v,92,v,148
ds_read_b128 v[116:119], v193 offset:34816
v_mul_f32 v73, v243, v6
MA 128,v,96,v,144
buffer_load_dwordx4 v208, s[44:47], s75 offen offset:0 lds
v_fmac_f32 v65, v240, v3
MA 136,v,96,v,148
v_fmac_f32 v73, v241, v7
MA 132,v,100,v,144
v_fmac_f32 v65, v238, v4
v_fmac_f32 v73, v239, v8
MA 140,v,100,v,148
v_fmac_f32 v65, v236, v5
MA 192,v,104,v,144
v_fmac_f32 v73, v237, v9
MA 200,v,104,v,148
ds_read_b128 v[120:123], v193 offset:36864
buffer_load_dwordx4 v209, s[44:47], s75 offen offset:1024 lds
MA 196,v,108,v,144
TR 144,196,49152
TR 146,196,51200
MA 204,v,108,v,148
TR 148,197,49152
TR 150,197,51200
MA 212,v,108,v,152
v_mul_f32 v65, v65, v254
v_mul_f32 v73, v73, v255
MA 220,v,108,v,156
buffer_load_dwordx4 v210, s[44:47], s75 offen offset:2048 lds
v_lshlrev_b32 v254, 16, v47
MA 208,v,104,v,152
v_and_b32 v255, 0xffff0000, v47
v_mul_f32 v66, v244, v2
MA 216,v,104,v,156
v_mul_f32 v74, v245, v6
v_fmac_f32 v66, v242, v3
MA 148,v,100,v,152
ds_read_b128 v[124:127], v193 offset:38912
v_fmac_f32 v74, v243, v7
MA 156,v,100,v,156
v_fmac_f32 v66, v240, v4
v_fmac_f32 v74, v241, v8
MA 144,v,96,v,152
buffer_load_dwordx4 v211, s[44:47], s75 offen offset:3072 lds
v_fmac_f32 v66, v238, v5
MA 152,v,96,v,156
v_fmac_f32 v74, v239, v9
v_mul_f32 v66, v66, v254
MA 84,v,92,v,152
v_mul_f32 v74, v74, v255
v_lshlrev_b32 v254, 16, v49
MA 92,v,92,v,156
v_and_b32 v255, 0xffff0000, v49
v_mul_f32 v67, v246, v2
MA 80,v,88,v,152
ds_read_b128 v[128:131], v193 offset:40960
s_add_u32 s75, s65, s74
MA 88,v,88,v,156
v_mul_f32 v75, v247, v6
v_fmac_f32 v67, v244, v3
MA 20,v,84,v,152
v_fmac_f32 v75, v245, v7
v_fmac_f32 v67, v242, v4
MA 28,v,84,v,156
v_fmac_f32 v75, v243, v8
MA 16,v,80,v,152
TR 152,198,49152
TR 154,198,51200
MA 24,v,80,v,156
TR 156,199,49152
TR 158,199,51200
MA 32,v,80,v,160
ds_read_b128 v[132:135], v193 offset:43008
s_add_u32 m0, s67, 4096
MA 40,v,80,v,164
v_fmac_f32 v67, v240, v5
v_fmac_f32 v75, v241, v9
MA 36,v,84,v,160
v_mul_f32 v67, v67, v254
v_mul_f32 v75, v75, v255
MA 44,v,84,v,164
buffer_load_dwordx4 v208, s[44:47], s75 offen offset:0 lds
v_lshlrev_b32 v254, 16, v51
MA 96,v,88,v,160
v_and_b32 v255, 0xffff0000, v51
v_mul_f32 v68, v248, v2
MA 104,v,88,v,164
v_mul_f32 v76, v249, v6
v_fmac_f32 v68, v246, v3
MA 100,v,92,v,160
v_fmac_f32 v76, v247, v7
v_fmac_f32 v68, v244, v4
MA 108,v,92,v,164
ds_read_b128 v[136:139], v193 offset:45056
buffer_load_dwordx4 v209, s[44:47], s75 offen offset:1024 lds
MA 160,v,96,v,160
v_fmac_f32 v76, v245, v8
v_fmac_f32 v68, v242, v5
MA 168,v,96,v,164
v_fmac_f32 v76, v243, v9
v_mul_f32 v68, v68, v254
MA 164,v,100,v,160
v_mul_f32 v76, v76, v255
v_lshlrev_b32 v254, 16, v53
MA 172,v,100,v,164
v_and_b32 v255, 0xffff0000, v53
MA 224,v,104,v,160
buffer_load_dwordx4 v210, s[44:47], s75 offen offset:2048 lds
v_mul_f32 v69, v250, v2
MA 232,v,104,v,164
ds_read_b128 v[140:143], v193 offset:47104
v_mul_f32 v77, v251, v6
MA 228,v,108,v,160
TR 160,200,49152
TR 162,200,51200
MA 236,v,108,v,164
TR 164,201,49152
TR 166,201,51200
s_waitcnt lgkmcnt(15)
MA 244,v,108,v,168
buffer_load_dwordx4 v211, s[44:47], s75 offen offset:3072 lds
v_fmac_f32 v69, v248, v3
MA 252,v,108,v,172
v_fmac_f32 v77, v249, v7
v_fmac_f32 v69, v246, v4
MA 240,v,104,v,168
v_fmac_f32 v77, v247, v8
v_fmac_f32 v69, v244, v5
MA 248,v,104,v,172
v_fmac_f32 v77, v245, v9
v_mul_f32 v69, v69, v254
MA 180,v,100,v,168
v_mul_f32 v77, v77, v255
v_cvt_pk_bf16_f32 v230, v69, v68
MA 188,v,100,v,172
s_add_u32 s74, s74, 128
v_cvt_pk_bf16_f32 v231, v67, v66
MA 176,v,96,v,168
v_cvt_pk_bf16_f32 v232, v65, v64
v_cvt_pk_bf16_f32 v233, v63, v62
MA 184,v,96,v,172
s_mov_b32 s36, 8192
buffer_store_dwordx4 v[230:233], v10, s[84:87], s36 offen sc1
MA 116,v,92,v,168
v_cvt_pk_bf16_f32 v234, v77, v76
MA 124,v,92,v,172
s_and_b32 s74, s74, 2047
v_cvt_pk_bf16_f32 v235, v75, v74
MA 112,v,88,v,168
v_cvt_pk_bf16_f32 v236, v73, v72
v_cvt_pk_bf16_f32 v237, v71, v70
MA 120,v,88,v,172
s_mov_b32 s36, 12288
MA 52,v,84,v,168
buffer_store_dwordx4 v[234:237], v10, s[84:87], s36 offen sc1
MA 60,v,84,v,172
v_lshlrev_b32 v228, 4, v1
MA 48,v,80,v,168
TR 168,202,49152
TR 170,202,51200
MA 56,v,80,v,172
TR 172,203,49152
TR 174,203,51200
s_waitcnt lgkmcnt(4)
MA 0,v,112,v,144
MA 8,v,112,v,148
MA 4,v,116,v,144
MA 12,v,116,v,148
MA 64,v,120,v,144
MA 72,v,120,v,148
MA 68,v,124,v,144
MA 76,v,124,v,148
MA 128,v,128,v,144
MA 136,v,128,v,148
s_waitcnt vmcnt(15) lgkmcnt(0)
s_barrier
MA 132,v,132,v,144
ds_read_b128 v[48:51], v226 offset:0
s_add_u32 m0, s68, 131072
MA 140,v,132,v,148
MA 192,v,136,v,144
ds_read_b128 v[52:55], v226 offset:2048
buffer_load_dwordx4 v212, s[48:51], s66 offen offset:0 lds
MA 200,v,136,v,148
MA 196,v,140,v,144
ds_read_b128 v[56:59], v226 offset:4096
buffer_load_dwordx4 v213, s[48:51], s66 offen offset:1024 lds
MA 204,v,140,v,148
MA 212,v,140,v,152
ds_read_b128 v[60:63], v226 offset:6144
MA 220,v,140,v,156
buffer_load_dwordx4 v214, s[48:51], s66 offen offset:2048 lds
MA 208,v,136,v,152
TR 16,216,0
MA 216,v,136,v,156
buffer_load_dwordx4 v215, s[48:51], s66 offen offset:3072 lds
MA 148,v,132,v,152
TR 18,216,1024
MA 156,v,132,v,156
MA 144,v,128,v,152
TR 20,217,0
s_add_u32 s66, s66, 524288
MA 152,v,128,v,156
MA 84,v,124,v,152
TR 22,217,1024
s_and_b32 s66, s66, 8388607
MA 92,v,124,v,156
MA 80,v,120,v,152
TR 24,218,0
MA 88,v,120,v,156
s_add_u32 s75, s64, s74
MA 20,v,116,v,152
TR 26,218,1024
MA 28,v,116,v,156
s_add_u32 m0, s67, 32768
MA 16,v,112,v,152
TR 28,219,0
MA 24,v,112,v,156
MA 32,v,112,v,160
TR 30,219,1024
buffer_load_dwordx4 v208, s[44:47], s75 offen offset:0 lds
MA 40,v,112,v,164
MA 36,v,116,v,160
TR 32,220,0
buffer_load_dwordx4 v209, s[44:47], s75 offen offset:1024 lds
MA 44,v,116,v,164
MA 96,v,120,v,160
TR 34,220,1024
MA 104,v,120,v,164
buffer_load_dwordx4 v210, s[44:47], s75 offen offset:2048 lds
MA 100,v,124,v,160
TR 36,221,0
MA 108,v,124,v,164
buffer_load_dwordx4 v211, s[44:47], s75 offen offset:3072 lds
MA 160,v,128,v,160
TR 38,221,1024
MA 168,v,128,v,164
MA 164,v,132,v,160
TR 40,222,0
s_add_u32 s75, s65, s74
MA 172,v,132,v,164
MA 224,v,136,v,160
TR 42,222,1024
s_add_u32 m0, s67, 36864
MA 232,v,136,v,164
MA 228,v,140,v,160
TR 44,223,0
MA 236,v,140,v,164
buffer_load_dwordx4 v208, s[44:47], s75 offen offset:0 lds
MA 244,v,140,v,168
TR 46,223,1024
MA 252,v,140,v,172
buffer_load_dwordx4 v209, s[44:47], s75 offen offset:1024 lds
MA 240,v,136,v,168
MA 248,v,136,v,172
MA 180,v,132,v,168
buffer_load_dwordx4 v210, s[44:47], s75 offen offset:2048 lds
MA 188,v,132,v,172
MA 176,v,128,v,168
buffer_load_dwordx4 v211, s[44:47], s75 offen offset:3072 lds
MA 184,v,128,v,172
MA 116,v,124,v,168
MA 124,v,124,v,172
s_add_u32 s74, s74, 128
MA 112,v,120,v,168
MA 120,v,120,v,172
s_and_b32 s74, s74, 2047
MA 52,v,116,v,168
MA 60,v,116,v,172
MA 48,v,112,v,168
MA 56,v,112,v,172
L_p2:
s_waitcnt lgkmcnt(4)
v_mfma_f32_16x16x32_bf16 v[80:83], v[16:19], v[48:51], 0
s_add_u32 s8, s40, 59768832
s_addc_u32 s9, s41, 0
v_mfma_f32_16x16x32_bf16 v[96:99], v[20:23], v[48:51], 0
ds_read_b128 v[64:67], v227 offset:0
v_mfma_f32_16x16x32_bf16 v[84:87], v[16:19], v[52:55], 0
s_mov_b32 s10, 8192
v_mfma_f32_16x16x32_bf16 v[100:103], v[20:23], v[52:55], 0
s_mov_b32 s11, 0x20000
v_mfma_f32_16x16x32_bf16 v[88:91], v[16:19], v[56:59], 0
s_mov_b32 s12, s38
v_mfma_f32_16x16x32_bf16 v[104:107], v[20:23], v[56:59], 0
s_mov_b32 s13, s39
v_mfma_f32_16x16x32_bf16 v[92:95], v[16:19], v[60:63], 0
TR 16,216,8192
TR 18,216,9216
v_mfma_f32_16x16x32_bf16 v[108:111], v[20:23], v[60:63], 0
TR 20,217,8192
TR 22,217,9216
v_mfma_f32_16x16x32_bf16 v[124:127], v[24:27], v[60:63], 0
ds_read_b128 v[68:71], v227 offset:2048
s_mov_b32 s14, 256
v_mfma_f32_16x16x32_bf16 v[140:143], v[28:31], v[60:63], 0
s_mov_b32 s15, 0x20000
v_accvgpr_read_b32 v234, a0
v_mfma_f32_16x16x32_bf16 v[120:123], v[24:27], v[56:59], 0
v_accvgpr_read_b32 v235, a1
v_accvgpr_read_b32 v236, a2
v_mfma_f32_16x16x32_bf16 v[136:139], v[28:31], v[56:59], 0
v_accvgpr_read_b32 v237, a3
v_mfma_f32_16x16x32_bf16 v[116:119], v[24:27], v[52:55], 0
ds_read_b128 v[72:75], v227 offset:4096
v_accvgpr_read_b32 v238, a4
v_mfma_f32_16x16x32_bf16 v[132:135], v[28:31], v[52:55], 0
v_accvgpr_read_b32 v239, a5
v_mfma_f32_16x16x32_bf16 v[112:115], v[24:27], v[48:51], 0
TR 24,218,8192
TR 26,218,9216
v_mfma_f32_16x16x32_bf16 v[128:131], v[28:31], v[48:51], 0
TR 28,219,8192
TR 30,219,9216
v_mfma_f32_16x16x32_bf16 v[144:147], v[32:35], v[48:51], 0
v_accvgpr_read_b32 v240, a6
v_accvgpr_read_b32 v241, a7
v_mfma_f32_16x16x32_bf16 v[160:163], v[36:39], v[48:51], 0
v_cvt_pk_bf16_f32 v230, v234, v235
v_cvt_pk_bf16_f32 v231, v236, v237
v_mfma_f32_16x16x32_bf16 v[148:151], v[32:35], v[52:55], 0
ds_read_b128 v[76:79], v227 offset:6144
v_cvt_pk_bf16_f32 v232, v238, v239
v_mfma_f32_16x16x32_bf16 v[164:167], v[36:39], v[52:55], 0
v_cvt_pk_bf16_f32 v233, v240, v241
v_mfma_f32_16x16x32_bf16 v[152:155], v[32:35], v[56:59], 0
buffer_store_dwordx4 v[230:233], v228, s[16:19], s24 offen offset:0 sc1
v_mfma_f32_16x16x32_bf16 v[168:171], v[36:39], v[56:59], 0
v_accvgpr_read_b32 v246, a8
v_mfma_f32_16x16x32_bf16 v[156:159], v[32:35], v[60:63], 0
TR 32,220,8192
TR 34,220,9216
v_mfma_f32_16x16x32_bf16 v[172:175], v[36:39], v[60:63], 0
TR 36,221,8192
TR 38,221,9216
s_waitcnt lgkmcnt(15)
v_mfma_f32_16x16x32_bf16 v[188:191], v[40:43], v[60:63], 0
v_accvgpr_read_b32 v247, a9
v_accvgpr_read_b32 v248, a10
v_mfma_f32_16x16x32_bf16 v[204:207], v[44:47], v[60:63], 0
v_accvgpr_read_b32 v249, a11
v_accvgpr_read_b32 v250, a12
v_mfma_f32_16x16x32_bf16 v[184:187], v[40:43], v[56:59], 0
v_accvgpr_read_b32 v251, a13
v_mfma_f32_16x16x32_bf16 v[200:203], v[44:47], v[56:59], 0
v_accvgpr_read_b32 v252, a14
v_mfma_f32_16x16x32_bf16 v[180:183], v[40:43], v[52:55], 0
v_accvgpr_read_b32 v253, a15
v_mfma_f32_16x16x32_bf16 v[196:199], v[44:47], v[52:55], 0
v_mfma_f32_16x16x32_bf16 v[176:179], v[40:43], v[48:51], 0
TR 40,222,8192
TR 42,222,9216
v_mfma_f32_16x16x32_bf16 v[192:195], v[44:47], v[48:51], 0
TR 44,223,8192
TR 46,223,9216
s_waitcnt lgkmcnt(4)
MV 80,v,16,v,64
v_cvt_pk_bf16_f32 v242, v246, v247
MV 96,v,20,v,64
v_cvt_pk_bf16_f32 v243, v248, v249
MV 84,v,16,v,68
v_cvt_pk_bf16_f32 v244, v250, v251
MV 100,v,20,v,68
MV 88,v,16,v,72
v_cvt_pk_bf16_f32 v245, v252, v253
MV 104,v,20,v,72
buffer_store_dwordx4 v[242:245], v228, s[16:19], s24 offen offset:1024 sc1
MV 92,v,16,v,76
MV 108,v,20,v,76
s_waitcnt vmcnt(16) lgkmcnt(0)
s_barrier
MV 124,v,24,v,76
TR 16,216,16384
TR 18,216,17408
MV 140,v,28,v,76
ds_read_b128 v[48:51], v224 offset:0
s_add_u32 m0, s68, 98304
MV 120,v,24,v,72
TR 20,217,16384
TR 22,217,17408
MV 136,v,28,v,72
buffer_load_dwordx4 v212, s[48:51], s66 offen offset:0 lds
v_accvgpr_read_b32 v234, a16
MV 116,v,24,v,68
ds_read_b128 v[52:55], v224 offset:2048
buffer_load_dwordx4 v213, s[48:51], s66 offen offset:1024 lds
MV 132,v,28,v,68
v_accvgpr_read_b32 v235, a17
v_accvgpr_read_b32 v236, a18
MV 112,v,24,v,64
TR 24,218,16384
TR 26,218,17408
MV 128,v,28,v,64
TR 28,219,16384
TR 30,219,17408
MV 144,v,32,v,64
ds_read_b128 v[56:59], v224 offset:4096
buffer_load_dwordx4 v214, s[48:51], s66 offen offset:2048 lds
MV 160,v,36,v,64
buffer_load_dwordx4 v215, s[48:51], s66 offen offset:3072 lds
v_accvgpr_read_b32 v237, a19
MV 148,v,32,v,68
v_accvgpr_read_b32 v238, a20
v_accvgpr_read_b32 v239, a21
MV 164,v,36,v,68
s_add_u32 s66, s66, 524288
v_accvgpr_read_b32 v240, a22
MV 152,v,32,v,72
ds_read_b128 v[60:63], v224 offset:6144
v_accvgpr_read_b32 v241, a23
MV 168,v,36,v,72
s_and_b32 s66, s66, 8388607
v_cvt_pk_bf16_f32 v230, v234, v235
MV 156,v,32,v,76
TR 32,220,16384
TR 34,220,17408
MV 172,v,36,v,76
TR 36,221,16384
TR 38,221,17408
MV 188,v,40,v,76
s_add_u32 s75, s64, s74
v_cvt_pk_bf16_f32 v231, v236, v237
MV 204,v,44,v,76
v_cvt_pk_bf16_f32 v232, v238, v239
v_cvt_pk_bf16_f32 v233, v240, v241
MV 184,v,40,v,72
s_add_u32 m0, s67, 65536
buffer_store_dwordx4 v[230:233], v228, s[16:19], s24 offen offset:2048 sc1
MV 200,v,44,v,72
v_accvgpr_read_b32 v246, a24
v_accvgpr_read_b32 v247, a25
MV 180,v,40,v,68
buffer_load_dwordx4 v208, s[44:47], s75 offen offset:0 lds
v_accvgpr_read_b32 v248, a26
MV 196,v,44,v,68
MV 176,v,40,v,64
TR 40,222,16384
TR 42,222,17408
MV 192,v,44,v,64
TR 44,223,16384
TR 46,223,17408
s_waitcnt lgkmcnt(4)
MV 80,v,16,v,48
buffer_load_dwordx4 v209, s[44:47], s75 offen offset:1024 lds
v_accvgpr_read_b32 v249, a27
MV 96,v,20,v,48
ds_read_b128 v[64:67], v225 offset:0
v_accvgpr_read_b32 v250, a28
MV 84,v,16,v,52
buffer_load_dwordx4 v210, s[44:47], s75 offen offset:2048 lds
v_accvgpr_read_b32 v251, a29
MV 100,v,20,v,52
MV 88,v,16,v,56
v_accvgpr_read_b32 v252, a30
MV 104,v,20,v,56
buffer_load_dwordx4 v211, s[44:47], s75 offen offset:3072 lds
v_accvgpr_read_b32 v253, a31
MV 92,v,16,v,60
TR 16,216,24576
TR 18,216,25600
MV 108,v,20,v,60
TR 20,217,24576
TR 22,217,25600
MV 124,v,24,v,60
ds_read_b128 v[68:71], v225 offset:2048
s_add_u32 s75, s65, s74
MV 140,v,28,v,60
v_cvt_pk_bf16_f32 v242, v246, v247
v_cvt_pk_bf16_f32 v243, v248, v249
MV 120,v,24,v,56
v_cvt_pk_bf16_f32 v244, v250, v251
MV 136,v,28,v,56
s_add_u32 m0, s67, 69632
v_cvt_pk_bf16_f32 v245, v252, v253
MV 116,v,24,v,52
ds_read_b128 v[72:75], v225 offset:4096
buffer_store_dwordx4 v[242:245], v228, s[16:19], s24 offen offset:3072 sc1
MV 132,v,28,v,52
MV 112,v,24,v,48
TR 24,218,24576
TR 26,218,25600
MV 128,v,28,v,48
TR 28,219,24576
TR 30,219,25600
MV 144,v,32,v,48
buffer_load_dwordx4 v208, s[44:47], s75 offen offset:0 lds
buffer_load_dwordx4 v209, s[44:47], s75 offen offset:1024 lds
MV 160,v,36,v,48
v_accvgpr_read_b32 v234, a32
v_accvgpr_read_b32 v235, a33
MV 148,v,32,v,52
ds_read_b128 v[76:79], v225 offset:6144
v_accvgpr_read_b32 v236, a34
MV 164,v,36,v,52
buffer_load_dwordx4 v210, s[44:47], s75 offen offset:2048 lds
v_accvgpr_read_b32 v237, a35
MV 152,v,32,v,56
v_accvgpr_read_b32 v238, a36
MV 168,v,36,v,56
v_accvgpr_read_b32 v239, a37
MV 156,v,32,v,60
TR 32,220,24576
TR 34,220,25600
MV 172,v,36,v,60
TR 36,221,24576
TR 38,221,25600
s_waitcnt lgkmcnt(15)
MV 188,v,40,v,60
buffer_load_dwordx4 v211, s[44:47], s75 offen offset:3072 lds
v_accvgpr_read_b32 v240, a38
MV 204,v,44,v,60
s_add_u32 s74, s74, 128
v_accvgpr_read_b32 v241, a39
MV 184,v,40,v,56
v_cvt_pk_bf16_f32 v230, v234, v235
MV 200,v,44,v,56
v_cvt_pk_bf16_f32 v231, v236, v237
MV 180,v,40,v,52
s_and_b32 s74, s74, 2047
v_cvt_pk_bf16_f32 v232, v238, v239
MV 196,v,44,v,52
MV 176,v,40,v,48
TR 40,222,24576
TR 42,222,25600
MV 192,v,44,v,48
TR 44,223,24576
TR 46,223,25600
s_waitcnt lgkmcnt(4)
MV 80,v,16,v,64
v_cvt_pk_bf16_f32 v233, v240, v241
MV 96,v,20,v,64
s_add_u32 s24, s24, 4096
MV 84,v,16,v,68
buffer_store_dwordx4 v[230:233], v228, s[16:19], s24 offen offset:0 sc1
MV 100,v,20,v,68
MV 88,v,16,v,72
v_accvgpr_read_b32 v246, a40
MV 104,v,20,v,72
v_accvgpr_read_b32 v247, a41
MV 92,v,16,v,76
MV 108,v,20,v,76
s_waitcnt vmcnt(17) lgkmcnt(0)
s_barrier
MV 124,v,24,v,76
TR 16,216,32768
TR 18,216,33792
MV 140,v,28,v,76
ds_read_b128 v[48:51], v224 offset:32768
s_add_u32 m0, s68, 114688
MV 120,v,24,v,72
TR 20,217,32768
TR 22,217,33792
MV 136,v,28,v,72
buffer_load_dwordx4 v212, s[48:51], s66 offen offset:0 lds
v_accvgpr_read_b32 v248, a42
MV 116,v,24,v,68
ds_read_b128 v[52:55], v224 offset:34816
buffer_load_dwordx4 v213, s[48:51], s66 offen offset:1024 lds
MV 132,v,28,v,68
v_accvgpr_read_b32 v249, a43
v_accvgpr_read_b32 v250, a44
MV 112,v,24,v,64
TR 24,218,32768
TR 26,218,33792
MV 128,v,28,v,64
TR 28,219,32768
TR 30,219,33792
MV 144,v,32,v,64
ds_read_b128 v[56:59], v224 offset:36864
buffer_load_dwordx4 v214, s[48:51], s66 offen offset:2048 lds
MV 160,v,36,v,64
buffer_load_dwordx4 v215, s[48:51], s66 offen offset:3072 lds
v_accvgpr_read_b32 v251, a45
MV 148,v,32,v,68
v_accvgpr_read_b32 v252, a46
v_accvgpr_read_b32 v253, a47
MV 164,v,36,v,68
s_add_u32 s66, s66, 524288
v_cvt_pk_bf16_f32 v242, v246, v247
MV 152,v,32,v,72
ds_read_b128 v[60:63], v224 offset:38912
v_cvt_pk_bf16_f32 v243, v248, v249
MV 168,v,36,v,72
s_and_b32 s66, s66, 8388607
v_cvt_pk_bf16_f32 v244, v250, v251
MV 156,v,32,v,76
TR 32,220,32768
TR 34,220,33792
MV 172,v,36,v,76
TR 36,221,32768
TR 38,221,33792
MV 188,v,40,v,76
s_add_u32 s75, s64, s74
v_cvt_pk_bf16_f32 v245, v252, v253
MV 204,v,44,v,76
buffer_store_dwordx4 v[242:245], v228, s[16:19], s24 offen offset:1024 sc1
v_accvgpr_read_b32 v234, a48
MV 184,v,40,v,72
s_add_u32 m0, s67, 0
v_accvgpr_read_b32 v235, a49
MV 200,v,44,v,72
v_accvgpr_read_b32 v236, a50
v_accvgpr_read_b32 v237, a51
MV 180,v,40,v,68
buffer_load_dwordx4 v208, s[44:47], s75 offen offset:0 lds
v_accvgpr_read_b32 v238, a52
MV 196,v,44,v,68
MV 176,v,40,v,64
TR 40,222,32768
TR 42,222,33792
MV 192,v,44,v,64
TR 44,223,32768
TR 46,223,33792
s_waitcnt lgkmcnt(4)
MV 80,v,16,v,48
buffer_load_dwordx4 v209, s[44:47], s75 offen offset:1024 lds
v_accvgpr_read_b32 v239, a53
MV 96,v,20,v,48
ds_read_b128 v[64:67], v225 offset:32768
v_accvgpr_read_b32 v240, a54
MV 84,v,16,v,52
buffer_load_dwordx4 v210, s[44:47], s75 offen offset:2048 lds
v_accvgpr_read_b32 v241, a55
MV 100,v,20,v,52
MV 88,v,16,v,56
v_cvt_pk_bf16_f32 v230, v234, v235
MV 104,v,20,v,56
buffer_load_dwordx4 v211, s[44:47], s75 offen offset:3072 lds
v_cvt_pk_bf16_f32 v231, v236, v237
MV 92,v,16,v,60
TR 16,216,40960
TR 18,216,41984
MV 108,v,20,v,60
TR 20,217,40960
TR 22,217,41984
MV 124,v,24,v,60
ds_read_b128 v[68:71], v225 offset:34816
s_add_u32 s75, s65, s74
MV 140,v,28,v,60
v_cvt_pk_bf16_f32 v232, v238, v239
v_cvt_pk_bf16_f32 v233, v240, v241
MV 120,v,24,v,56
buffer_store_dwordx4 v[230:233], v228, s[16:19], s24 offen offset:2048 sc1
MV 136,v,28,v,56
s_add_u32 m0, s67, 4096
v_accvgpr_read_b32 v246, a56
MV 116,v,24,v,52
ds_read_b128 v[72:75], v225 offset:36864
v_accvgpr_read_b32 v247, a57
MV 132,v,28,v,52
MV 112,v,24,v,48
TR 24,218,40960
TR 26,218,41984
MV 128,v,28,v,48
TR 28,219,40960
TR 30,219,41984
MV 144,v,32,v,48
buffer_load_dwordx4 v208, s[44:47], s75 offen offset:0 lds
buffer_load_dwordx4 v209, s[44:47], s75 offen offset:1024 lds
MV 160,v,36,v,48
v_accvgpr_read_b32 v248, a58
v_accvgpr_read_b32 v249, a59
MV 148,v,32,v,52
ds_read_b128 v[76:79], v225 offset:38912
v_accvgpr_read_b32 v250, a60
MV 164,v,36,v,52
buffer_load_dwordx4 v210, s[44:47], s75 offen offset:2048 lds
v_accvgpr_read_b32 v251, a61
MV 152,v,32,v,56
v_accvgpr_read_b32 v252, a62
MV 168,v,36,v,56
v_accvgpr_read_b32 v253, a63
MV 156,v,32,v,60
TR 32,220,40960
TR 34,220,41984
MV 172,v,36,v,60
TR 36,221,40960
TR 38,221,41984
s_waitcnt lgkmcnt(15)
MV 188,v,40,v,60
buffer_load_dwordx4 v211, s[44:47], s75 offen offset:3072 lds
v_cvt_pk_bf16_f32 v242, v246, v247
MV 204,v,44,v,60
s_add_u32 s74, s74, 128
v_cvt_pk_bf16_f32 v243, v248, v249
MV 184,v,40,v,56
v_cvt_pk_bf16_f32 v244, v250, v251
MV 200,v,44,v,56
v_cvt_pk_bf16_f32 v245, v252, v253
MV 180,v,40,v,52
s_and_b32 s74, s74, 2047
buffer_store_dwordx4 v[242:245], v228, s[16:19], s24 offen offset:3072 sc1
MV 196,v,44,v,52
MV 176,v,40,v,48
TR 40,222,40960
TR 42,222,41984
MV 192,v,44,v,48
TR 44,223,40960
TR 46,223,41984
s_waitcnt lgkmcnt(4)
MV 80,v,16,v,64
v_accvgpr_read_b32 v234, a64
MV 96,v,20,v,64
v_accvgpr_read_b32 v235, a65
MV 84,v,16,v,68
v_accvgpr_read_b32 v236, a66
MV 100,v,20,v,68
MV 88,v,16,v,72
v_accvgpr_read_b32 v237, a67
MV 104,v,20,v,72
v_accvgpr_read_b32 v238, a68
MV 92,v,16,v,76
MV 108,v,20,v,76
s_waitcnt vmcnt(16) lgkmcnt(0)
s_barrier
MV 124,v,24,v,76
TR 16,216,0
TR 18,216,1024
MV 140,v,28,v,76
ds_read_b128 v[48:51], v226 offset:0
s_add_u32 m0, s68, 131072
MV 120,v,24,v,72
TR 20,217,0
TR 22,217,1024
MV 136,v,28,v,72
buffer_load_dwordx4 v212, s[48:51], s66 offen offset:0 lds
v_accvgpr_read_b32 v239, a69
MV 116,v,24,v,68
ds_read_b128 v[52:55], v226 offset:2048
buffer_load_dwordx4 v213, s[48:51], s66 offen offset:1024 lds
MV 132,v,28,v,68
v_accvgpr_read_b32 v240, a70
v_accvgpr_read_b32 v241, a71
MV 112,v,24,v,64
TR 24,218,0
TR 26,218,1024
MV 128,v,28,v,64
TR 28,219,0
TR 30,219,1024
MV 144,v,32,v,64
ds_read_b128 v[56:59], v226 offset:4096
buffer_load_dwordx4 v214, s[48:51], s66 offen offset:2048 lds
MV 160,v,36,v,64
buffer_load_dwordx4 v215, s[48:51], s66 offen offset:3072 lds
v_cvt_pk_bf16_f32 v230, v234, v235
MV 148,v,32,v,68
v_cvt_pk_bf16_f32 v231, v236, v237
v_cvt_pk_bf16_f32 v232, v238, v239
MV 164,v,36,v,68
s_add_u32 s66, s66, 524288
v_cvt_pk_bf16_f32 v233, v240, v241
MV 152,v,32,v,72
ds_read_b128 v[60:63], v226 offset:6144
s_add_u32 s24, s24, 4096
MV 168,v,36,v,72
s_and_b32 s66, s66, 8388607
buffer_store_dwordx4 v[230:233], v228, s[16:19], s24 offen offset:0 sc1
MV 156,v,32,v,76
TR 32,220,0
TR 34,220,1024
MV 172,v,36,v,76
TR 36,221,0
TR 38,221,1024
MV 188,v,40,v,76
s_add_u32 s75, s64, s74
v_accvgpr_read_b32 v246, a72
MV 204,v,44,v,76
v_accvgpr_read_b32 v247, a73
v_accvgpr_read_b32 v248, a74
MV 184,v,40,v,72
s_add_u32 m0, s67, 32768
v_accvgpr_read_b32 v249, a75
MV 200,v,44,v,72
v_accvgpr_read_b32 v250, a76
v_accvgpr_read_b32 v251, a77
MV 180,v,40,v,68
buffer_load_dwordx4 v208, s[44:47], s75 offen offset:0 lds
v_accvgpr_read_b32 v252, a78
MV 196,v,44,v,68
MV 176,v,40,v,64
TR 40,222,0
TR 42,222,1024
MV 192,v,44,v,64
TR 44,223,0
TR 46,223,1024
s_waitcnt lgkmcnt(4)
MV 80,v,16,v,48
buffer_load_dwordx4 v209, s[44:47], s75 offen offset:1024 lds
v_accvgpr_read_b32 v253, a79
MV 96,v,20,v,48
ds_read_b128 v[64:67], v227 offset:0
v_cvt_pk_bf16_f32 v242, v246, v247
MV 84,v,16,v,52
buffer_load_dwordx4 v210, s[44:47], s75 offen offset:2048 lds
v_cvt_pk_bf16_f32 v243, v248, v249
MV 100,v,20,v,52
MV 88,v,16,v,56
v_cvt_pk_bf16_f32 v244, v250, v251
MV 104,v,20,v,56
buffer_load_dwordx4 v211, s[44:47], s75 offen offset:3072 lds
v_cvt_pk_bf16_f32 v245, v252, v253
MV 92,v,16,v,60
TR 16,216,8192
TR 18,216,9216
MV 108,v,20,v,60
TR 20,217,8192
TR 22,217,9216
MV 124,v,24,v,60
ds_read_b128 v[68:71], v227 offset:2048
s_add_u32 s75, s65, s74
MV 140,v,28,v,60
buffer_store_dwordx4 v[242:245], v228, s[16:19], s24 offen offset:1024 sc1
v_accvgpr_read_b32 v234, a80
MV 120,v,24,v,56
v_accvgpr_read_b32 v235, a81
v_accvgpr_read_b32 v236, a82
MV 136,v,28,v,56
s_add_u32 m0, s67, 36864
MV 116,v,24,v,52
ds_read_b128 v[72:75], v227 offset:4096
v_accvgpr_read_b32 v237, a83
MV 132,v,28,v,52
v_accvgpr_read_b32 v238, a84
MV 112,v,24,v,48
TR 24,218,8192
TR 26,218,9216
MV 128,v,28,v,48
TR 28,219,8192
TR 30,219,9216
MV 144,v,32,v,48
buffer_load_dwordx4 v208, s[44:47], s75 offen offset:0 lds
buffer_load_dwordx4 v209, s[44:47], s75 offen offset:1024 lds
MV 160,v,36,v,48
v_accvgpr_read_b32 v239, a85
v_accvgpr_read_b32 v240, a86
MV 148,v,32,v,52
ds_read_b128 v[76:79], v227 offset:6144
v_accvgpr_read_b32 v241, a87
MV 164,v,36,v,52
buffer_load_dwordx4 v210, s[44:47], s75 offen offset:2048 lds
v_cvt_pk_bf16_f32 v230, v234, v235
MV 152,v,32,v,56
v_cvt_pk_bf16_f32 v231, v236, v237
MV 168,v,36,v,56
v_cvt_pk_bf16_f32 v232, v238, v239
MV 156,v,32,v,60
TR 32,220,8192
TR 34,220,9216
MV 172,v,36,v,60
TR 36,221,8192
TR 38,221,9216
s_waitcnt lgkmcnt(15)
MV 188,v,40,v,60
buffer_load_dwordx4 v211, s[44:47], s75 offen offset:3072 lds
v_cvt_pk_bf16_f32 v233, v240, v241
MV 204,v,44,v,60
s_add_u32 s74, s74, 128
buffer_store_dwordx4 v[230:233], v228, s[16:19], s24 offen offset:2048 sc1
MV 184,v,40,v,56
v_accvgpr_read_b32 v246, a88
MV 200,v,44,v,56
v_accvgpr_read_b32 v247, a89
MV 180,v,40,v,52
s_and_b32 s74, s74, 2047
v_accvgpr_read_b32 v248, a90
MV 196,v,44,v,52
MV 176,v,40,v,48
TR 40,222,8192
TR 42,222,9216
MV 192,v,44,v,48
TR 44,223,8192
TR 46,223,9216
s_waitcnt lgkmcnt(4)
MV 80,v,16,v,64
v_accvgpr_read_b32 v249, a91
MV 96,v,20,v,64
v_accvgpr_read_b32 v250, a92
MV 84,v,16,v,68
v_accvgpr_read_b32 v251, a93
MV 100,v,20,v,68
MV 88,v,16,v,72
v_accvgpr_read_b32 v252, a94
MV 104,v,20,v,72
v_accvgpr_read_b32 v253, a95
MV 92,v,16,v,76
MV 108,v,20,v,76
s_waitcnt vmcnt(16) lgkmcnt(0)
s_barrier
MV 124,v,24,v,76
TR 16,216,16384
TR 18,216,17408
MV 140,v,28,v,76
ds_read_b128 v[48:51], v224 offset:0
s_add_u32 m0, s68, 98304
MV 120,v,24,v,72
TR 20,217,16384
TR 22,217,17408
MV 136,v,28,v,72
buffer_load_dwordx4 v212, s[48:51], s66 offen offset:0 lds
v_cvt_pk_bf16_f32 v242, v246, v247
MV 116,v,24,v,68
ds_read_b128 v[52:55], v224 offset:2048
buffer_load_dwordx4 v213, s[48:51], s66 offen offset:1024 lds
MV 132,v,28,v,68
v_cvt_pk_bf16_f32 v243, v248, v249
v_cvt_pk_bf16_f32 v244, v250, v251
MV 112,v,24,v,64
TR 24,218,16384
TR 26,218,17408
MV 128,v,28,v,64
TR 28,219,16384
TR 30,219,17408
MV 144,v,32,v,64
ds_read_b128 v[56:59], v224 offset:4096
buffer_load_dwordx4 v214, s[48:51], s66 offen offset:2048 lds
MV 160,v,36,v,64
buffer_load_dwordx4 v215, s[48:51], s66 offen offset:3072 lds
v_cvt_pk_bf16_f32 v245, v252, v253
MV 148,v,32,v,68
buffer_store_dwordx4 v[242:245], v228, s[16:19], s24 offen offset:3072 sc1
v_accvgpr_read_b32 v234, a96
MV 164,v,36,v,68
s_add_u32 s66, s66, 524288
v_accvgpr_read_b32 v235, a97
MV 152,v,32,v,72
ds_read_b128 v[60:63], v224 offset:6144
v_accvgpr_read_b32 v236, a98
MV 168,v,36,v,72
s_and_b32 s66, s66, 8388607
v_accvgpr_read_b32 v237, a99
MV 156,v,32,v,76
TR 32,220,16384
TR 34,220,17408
MV 172,v,36,v,76
TR 36,221,16384
TR 38,221,17408
MV 188,v,40,v,76
s_add_u32 s75, s64, s74
v_accvgpr_read_b32 v238, a100
MV 204,v,44,v,76
v_accvgpr_read_b32 v239, a101
v_accvgpr_read_b32 v240, a102
MV 184,v,40,v,72
s_add_u32 m0, s67, 65536
v_accvgpr_read_b32 v241, a103
MV 200,v,44,v,72
v_cvt_pk_bf16_f32 v230, v234, v235
v_cvt_pk_bf16_f32 v231, v236, v237
MV 180,v,40,v,68
buffer_load_dwordx4 v208, s[44:47], s75 offen offset:0 lds
v_cvt_pk_bf16_f32 v232, v238, v239
MV 196,v,44,v,68
MV 176,v,40,v,64
TR 40,222,16384
TR 42,222,17408
MV 192,v,44,v,64
TR 44,223,16384
TR 46,223,17408
s_waitcnt lgkmcnt(4)
MV 80,v,16,v,48
buffer_load_dwordx4 v209, s[44:47], s75 offen offset:1024 lds
v_cvt_pk_bf16_f32 v233, v240, v241
MV 96,v,20,v,48
ds_read_b128 v[64:67], v225 offset:0
s_add_u32 s24, s24, 4096
MV 84,v,16,v,52
buffer_load_dwordx4 v210, s[44:47], s75 offen offset:2048 lds
buffer_store_dwordx4 v[230:233], v228, s[16:19], s24 offen offset:0 sc1
MV 100,v,20,v,52
MV 88,v,16,v,56
v_accvgpr_read_b32 v246, a104
MV 104,v,20,v,56
buffer_load_dwordx4 v211, s[44:47], s75 offen offset:3072 lds
v_accvgpr_read_b32 v247, a105
MV 92,v,16,v,60
TR 16,216,24576
TR 18,216,25600
MV 108,v,20,v,60
TR 20,217,24576
TR 22,217,25600
MV 124,v,24,v,60
ds_read_b128 v[68:71], v225 offset:2048
s_add_u32 s75, s65, s74
MV 140,v,28,v,60
v_accvgpr_read_b32 v248, a106
v_accvgpr_read_b32 v249, a107
MV 120,v,24,v,56
v_accvgpr_read_b32 v250, a108
MV 136,v,28,v,56
s_add_u32 m0, s67, 69632
v_accvgpr_read_b32 v251, a109
MV 116,v,24,v,52
ds_read_b128 v[72:75], v225 offset:4096
v_accvgpr_read_b32 v252, a110
MV 132,v,28,v,52
MV 112,v,24,v,48
TR 24,218,24576
TR 26,218,25600
MV 128,v,28,v,48
TR 28,219,24576
TR 30,219,25600
MV 144,v,32,v,48
buffer_load_dwordx4 v208, s[44:47], s75 offen offset:0 lds
buffer_load_dwordx4 v209, s[44:47], s75 offen offset:1024 lds
MV 160,v,36,v,48
v_accvgpr_read_b32 v253, a111
v_cvt_pk_bf16_f32 v242, v246, v247
MV 148,v,32,v,52
ds_read_b128 v[76:79], v225 offset:6144
v_cvt_pk_bf16_f32 v243, v248, v249
MV 164,v,36,v,52
buffer_load_dwordx4 v210, s[44:47], s75 offen offset:2048 lds
v_cvt_pk_bf16_f32 v244, v250, v251
MV 152,v,32,v,56
v_cvt_pk_bf16_f32 v245, v252, v253
MV 168,v,36,v,56
buffer_store_dwordx4 v[242:245], v228, s[16:19], s24 offen offset:1024 sc1
MV 156,v,32,v,60
TR 32,220,24576
TR 34,220,25600
MV 172,v,36,v,60
TR 36,221,24576
TR 38,221,25600
s_waitcnt lgkmcnt(15)
MV 188,v,40,v,60
buffer_load_dwordx4 v211, s[44:47], s75 offen offset:3072 lds
v_accvgpr_read_b32 v234, a112
MV 204,v,44,v,60
s_add_u32 s74, s74, 128
v_accvgpr_read_b32 v235, a113
MV 184,v,40,v,56
v_accvgpr_read_b32 v236, a114
MV 200,v,44,v,56
v_accvgpr_read_b32 v237, a115
MV 180,v,40,v,52
s_and_b32 s74, s74, 2047
v_accvgpr_read_b32 v238, a116
MV 196,v,44,v,52
MV 176,v,40,v,48
TR 40,222,24576
TR 42,222,25600
MV 192,v,44,v,48
TR 44,223,24576
TR 46,223,25600
s_waitcnt lgkmcnt(4)
MV 80,v,16,v,64
v_accvgpr_read_b32 v239, a117
MV 96,v,20,v,64
v_accvgpr_read_b32 v240, a118
MV 84,v,16,v,68
v_accvgpr_read_b32 v241, a119
MV 100,v,20,v,68
MV 88,v,16,v,72
v_cvt_pk_bf16_f32 v230, v234, v235
MV 104,v,20,v,72
v_cvt_pk_bf16_f32 v231, v236, v237
MV 92,v,16,v,76
MV 108,v,20,v,76
s_waitcnt vmcnt(16) lgkmcnt(0)
s_barrier
MV 124,v,24,v,76
TR 16,216,32768
TR 18,216,33792
MV 140,v,28,v,76
ds_read_b128 v[48:51], v224 offset:32768
s_add_u32 m0, s68, 114688
MV 120,v,24,v,72
TR 20,217,32768
TR 22,217,33792
MV 136,v,28,v,72
buffer_load_dwordx4 v212, s[48:51], s66 offen offset:0 lds
v_cvt_pk_bf16_f32 v232, v238, v239
MV 116,v,24,v,68
ds_read_b128 v[52:55], v224 offset:34816
buffer_load_dwordx4 v213, s[48:51], s66 offen offset:1024 lds
MV 132,v,28,v,68
v_cvt_pk_bf16_f32 v233, v240, v241
buffer_store_dwordx4 v[230:233], v228, s[16:19], s24 offen offset:2048 sc1
MV 112,v,24,v,64
TR 24,218,32768
TR 26,218,33792
MV 128,v,28,v,64
TR 28,219,32768
TR 30,219,33792
MV 144,v,32,v,64
ds_read_b128 v[56:59], v224 offset:36864
buffer_load_dwordx4 v214, s[48:51], s66 offen offset:2048 lds
MV 160,v,36,v,64
buffer_load_dwordx4 v215, s[48:51], s66 offen offset:3072 lds
v_accvgpr_read_b32 v246, a120
MV 148,v,32,v,68
v_accvgpr_read_b32 v247, a121
v_accvgpr_read_b32 v248, a122
MV 164,v,36,v,68
s_add_u32 s66, s66, 524288
v_accvgpr_read_b32 v249, a123
MV 152,v,32,v,72
ds_read_b128 v[60:63], v224 offset:38912
v_accvgpr_read_b32 v250, a124
MV 168,v,36,v,72
s_and_b32 s66, s66, 8388607
v_accvgpr_read_b32 v251, a125
MV 156,v,32,v,76
TR 32,220,32768
TR 34,220,33792
MV 172,v,36,v,76
TR 36,221,32768
TR 38,221,33792
MV 188,v,40,v,76
s_add_u32 s75, s64, s74
v_accvgpr_read_b32 v252, a126
MV 204,v,44,v,76
v_accvgpr_read_b32 v253, a127
v_cvt_pk_bf16_f32 v242, v246, v247
MV 184,v,40,v,72
s_add_u32 m0, s67, 0
v_cvt_pk_bf16_f32 v243, v248, v249
MV 200,v,44,v,72
v_cvt_pk_bf16_f32 v244, v250, v251
v_cvt_pk_bf16_f32 v245, v252, v253
MV 180,v,40,v,68
buffer_load_dwordx4 v208, s[44:47], s75 offen offset:0 lds
buffer_store_dwordx4 v[242:245], v228, s[16:19], s24 offen offset:3072 sc1
MV 196,v,44,v,68
MV 176,v,40,v,64
TR 40,222,32768
TR 42,222,33792
MV 192,v,44,v,64
TR 44,223,32768
TR 46,223,33792
s_waitcnt lgkmcnt(4)
MV 80,v,16,v,48
buffer_load_dwordx4 v209, s[44:47], s75 offen offset:1024 lds
v_accvgpr_read_b32 v234, a128
MV 96,v,20,v,48
ds_read_b128 v[64:67], v225 offset:32768
v_accvgpr_read_b32 v235, a129
MV 84,v,16,v,52
buffer_load_dwordx4 v210, s[44:47], s75 offen offset:2048 lds
v_accvgpr_read_b32 v236, a130
MV 100,v,20,v,52
MV 88,v,16,v,56
v_accvgpr_read_b32 v237, a131
MV 104,v,20,v,56
buffer_load_dwordx4 v211, s[44:47], s75 offen offset:3072 lds
v_accvgpr_read_b32 v238, a132
MV 92,v,16,v,60
TR 16,216,40960
TR 18,216,41984
MV 108,v,20,v,60
TR 20,217,40960
TR 22,217,41984
MV 124,v,24,v,60
ds_read_b128 v[68:71], v225 offset:34816
s_add_u32 s75, s65, s74
MV 140,v,28,v,60
v_accvgpr_read_b32 v239, a133
v_accvgpr_read_b32 v240, a134
MV 120,v,24,v,56
v_accvgpr_read_b32 v241, a135
MV 136,v,28,v,56
s_add_u32 m0, s67, 4096
v_cvt_pk_bf16_f32 v230, v234, v235
MV 116,v,24,v,52
ds_read_b128 v[72:75], v225 offset:36864
v_cvt_pk_bf16_f32 v231, v236, v237
MV 132,v,28,v,52
MV 112,v,24,v,48
TR 24,218,40960
TR 26,218,41984
MV 128,v,28,v,48
TR 28,219,40960
TR 30,219,41984
MV 144,v,32,v,48
buffer_load_dwordx4 v208, s[44:47], s75 offen offset:0 lds
buffer_load_dwordx4 v209, s[44:47], s75 offen offset:1024 lds
MV 160,v,36,v,48
v_cvt_pk_bf16_f32 v232, v238, v239
v_cvt_pk_bf16_f32 v233, v240, v241
MV 148,v,32,v,52
ds_read_b128 v[76:79], v225 offset:38912
s_add_u32 s24, s24, 4096
MV 164,v,36,v,52
buffer_load_dwordx4 v210, s[44:47], s75 offen offset:2048 lds
buffer_store_dwordx4 v[230:233], v228, s[16:19], s24 offen offset:0 sc1
MV 152,v,32,v,56
v_accvgpr_read_b32 v246, a136
MV 168,v,36,v,56
v_accvgpr_read_b32 v247, a137
MV 156,v,32,v,60
TR 32,220,40960
TR 34,220,41984
MV 172,v,36,v,60
TR 36,221,40960
TR 38,221,41984
s_waitcnt lgkmcnt(15)
MV 188,v,40,v,60
buffer_load_dwordx4 v211, s[44:47], s75 offen offset:3072 lds
v_accvgpr_read_b32 v248, a138
MV 204,v,44,v,60
s_add_u32 s74, s74, 128
v_accvgpr_read_b32 v249, a139
MV 184,v,40,v,56
v_accvgpr_read_b32 v250, a140
MV 200,v,44,v,56
v_accvgpr_read_b32 v251, a141
MV 180,v,40,v,52
s_and_b32 s74, s74, 2047
v_accvgpr_read_b32 v252, a142
MV 196,v,44,v,52
MV 176,v,40,v,48
TR 40,222,40960
TR 42,222,41984
MV 192,v,44,v,48
TR 44,223,40960
TR 46,223,41984
s_waitcnt lgkmcnt(4)
MV 80,v,16,v,64
v_accvgpr_read_b32 v253, a143
MV 96,v,20,v,64
v_cvt_pk_bf16_f32 v242, v246, v247
MV 84,v,16,v,68
v_cvt_pk_bf16_f32 v243, v248, v249
MV 100,v,20,v,68
MV 88,v,16,v,72
v_cvt_pk_bf16_f32 v244, v250, v251
MV 104,v,20,v,72
v_cvt_pk_bf16_f32 v245, v252, v253
MV 92,v,16,v,76
MV 108,v,20,v,76
s_waitcnt vmcnt(15) lgkmcnt(0)
s_barrier
MV 124,v,24,v,76
TR 16,216,0
TR 18,216,1024
MV 140,v,28,v,76
ds_read_b128 v[48:51], v226 offset:0
s_add_u32 m0, s68, 131072
MV 120,v,24,v,72
TR 20,217,0
TR 22,217,1024
MV 136,v,28,v,72
buffer_load_dwordx4 v212, s[48:51], s66 offen offset:0 lds
buffer_store_dwordx4 v[242:245], v228, s[16:19], s24 offen offset:1024 sc1
MV 116,v,24,v,68
ds_read_b128 v[52:55], v226 offset:2048
buffer_load_dwordx4 v213, s[48:51], s66 offen offset:1024 lds
MV 132,v,28,v,68
v_accvgpr_read_b32 v234, a144
v_accvgpr_read_b32 v235, a145
MV 112,v,24,v,64
TR 24,218,0
TR 26,218,1024
MV 128,v,28,v,64
TR 28,219,0
TR 30,219,1024
MV 144,v,32,v,64
ds_read_b128 v[56:59], v226 offset:4096
buffer_load_dwordx4 v214, s[48:51], s66 offen offset:2048 lds
MV 160,v,36,v,64
buffer_load_dwordx4 v215, s[48:51], s66 offen offset:3072 lds
v_accvgpr_read_b32 v236, a146
MV 148,v,32,v,68
v_accvgpr_read_b32 v237, a147
v_accvgpr_read_b32 v238, a148
MV 164,v,36,v,68
s_add_u32 s66, s66, 524288
v_accvgpr_read_b32 v239, a149
MV 152,v,32,v,72
ds_read_b128 v[60:63], v226 offset:6144
v_accvgpr_read_b32 v240, a150
MV 168,v,36,v,72
s_and_b32 s66, s66, 8388607
v_accvgpr_read_b32 v241, a151
MV 156,v,32,v,76
TR 32,220,0
TR 34,220,1024
MV 172,v,36,v,76
TR 36,221,0
TR 38,221,1024
MV 188,v,40,v,76
s_add_u32 s75, s64, s74
v_cvt_pk_bf16_f32 v230, v234, v235
MV 204,v,44,v,76
v_cvt_pk_bf16_f32 v231, v236, v237
v_cvt_pk_bf16_f32 v232, v238, v239
MV 184,v,40,v,72
s_add_u32 m0, s67, 32768
v_cvt_pk_bf16_f32 v233, v240, v241
MV 200,v,44,v,72
buffer_store_dwordx4 v[230:233], v228, s[16:19], s24 offen offset:2048 sc1
v_accvgpr_read_b32 v246, a152
MV 180,v,40,v,68
buffer_load_dwordx4 v208, s[44:47], s75 offen offset:0 lds
v_accvgpr_read_b32 v247, a153
MV 196,v,44,v,68
MV 176,v,40,v,64
TR 40,222,0
TR 42,222,1024
MV 192,v,44,v,64
TR 44,223,0
TR 46,223,1024
s_waitcnt lgkmcnt(4)
MV 80,v,16,v,48
buffer_load_dwordx4 v209, s[44:47], s75 offen offset:1024 lds
v_accvgpr_read_b32 v248, a154
MV 96,v,20,v,48
ds_read_b128 v[64:67], v227 offset:0
v_accvgpr_read_b32 v249, a155
MV 84,v,16,v,52
buffer_load_dwordx4 v210, s[44:47], s75 offen offset:2048 lds
v_accvgpr_read_b32 v250, a156
MV 100,v,20,v,52
MV 88,v,16,v,56
v_accvgpr_read_b32 v251, a157
MV 104,v,20,v,56
buffer_load_dwordx4 v211, s[44:47], s75 offen offset:3072 lds
v_accvgpr_read_b32 v252, a158
MV 92,v,16,v,60
TR 16,216,8192
TR 18,216,9216
MV 108,v,20,v,60
TR 20,217,8192
TR 22,217,9216
MV 124,v,24,v,60
ds_read_b128 v[68:71], v227 offset:2048
s_add_u32 s75, s65, s74
MV 140,v,28,v,60
v_accvgpr_read_b32 v253, a159
v_cvt_pk_bf16_f32 v242, v246, v247
MV 120,v,24,v,56
v_cvt_pk_bf16_f32 v243, v248, v249
MV 136,v,28,v,56
s_add_u32 m0, s67, 36864
v_cvt_pk_bf16_f32 v244, v250, v251
MV 116,v,24,v,52
ds_read_b128 v[72:75], v227 offset:4096
v_cvt_pk_bf16_f32 v245, v252, v253
MV 132,v,28,v,52
MV 112,v,24,v,48
TR 24,218,8192
TR 26,218,9216
MV 128,v,28,v,48
TR 28,219,8192
TR 30,219,9216
MV 144,v,32,v,48
buffer_load_dwordx4 v208, s[44:47], s75 offen offset:0 lds
buffer_load_dwordx4 v209, s[44:47], s75 offen offset:1024 lds
MV 160,v,36,v,48
buffer_store_dwordx4 v[242:245], v228, s[16:19], s24 offen offset:3072 sc1
v_accvgpr_read_b32 v234, a160
MV 148,v,32,v,52
ds_read_b128 v[76:79], v227 offset:6144
v_accvgpr_read_b32 v235, a161
MV 164,v,36,v,52
buffer_load_dwordx4 v210, s[44:47], s75 offen offset:2048 lds
v_accvgpr_read_b32 v236, a162
MV 152,v,32,v,56
v_accvgpr_read_b32 v237, a163
MV 168,v,36,v,56
v_accvgpr_read_b32 v238, a164
MV 156,v,32,v,60
TR 32,220,8192
TR 34,220,9216
MV 172,v,36,v,60
TR 36,221,8192
TR 38,221,9216
s_waitcnt lgkmcnt(15)
MV 188,v,40,v,60
buffer_load_dwordx4 v211, s[44:47], s75 offen offset:3072 lds
v_accvgpr_read_b32 v239, a165
MV 204,v,44,v,60
s_add_u32 s74, s74, 128
v_accvgpr_read_b32 v240, a166
MV 184,v,40,v,56
v_accvgpr_read_b32 v241, a167
MV 200,v,44,v,56
v_cvt_pk_bf16_f32 v230, v234, v235
MV 180,v,40,v,52
s_and_b32 s74, s74, 2047
v_cvt_pk_bf16_f32 v231, v236, v237
MV 196,v,44,v,52
MV 176,v,40,v,48
TR 40,222,8192
TR 42,222,9216
MV 192,v,44,v,48
TR 44,223,8192
TR 46,223,9216
s_waitcnt lgkmcnt(4)
MV 80,v,16,v,64
v_cvt_pk_bf16_f32 v232, v238, v239
MV 96,v,20,v,64
v_cvt_pk_bf16_f32 v233, v240, v241
MV 84,v,16,v,68
s_add_u32 s24, s24, 4096
MV 100,v,20,v,68
MV 88,v,16,v,72
buffer_store_dwordx4 v[230:233], v228, s[16:19], s24 offen offset:0 sc1
MV 104,v,20,v,72
v_accvgpr_read_b32 v246, a168
MV 92,v,16,v,76
v_accvgpr_read_b32 v247, a169
MV 108,v,20,v,76
s_waitcnt vmcnt(16) lgkmcnt(0)
s_barrier
MV 124,v,24,v,76
TR 16,216,16384
TR 18,216,17408
MV 140,v,28,v,76
ds_read_b128 v[48:51], v224 offset:0
s_add_u32 m0, s68, 98304
MV 120,v,24,v,72
TR 20,217,16384
TR 22,217,17408
MV 136,v,28,v,72
buffer_load_dwordx4 v212, s[48:51], s66 offen offset:0 lds
v_accvgpr_read_b32 v248, a170
MV 116,v,24,v,68
ds_read_b128 v[52:55], v224 offset:2048
buffer_load_dwordx4 v213, s[48:51], s66 offen offset:1024 lds
MV 132,v,28,v,68
v_accvgpr_read_b32 v249, a171
v_accvgpr_read_b32 v250, a172
MV 112,v,24,v,64
TR 24,218,16384
TR 26,218,17408
MV 128,v,28,v,64
TR 28,219,16384
TR 30,219,17408
MV 144,v,32,v,64
ds_read_b128 v[56:59], v224 offset:4096
buffer_load_dwordx4 v214, s[48:51], s66 offen offset:2048 lds
MV 160,v,36,v,64
buffer_load_dwordx4 v215, s[48:51], s66 offen offset:3072 lds
v_accvgpr_read_b32 v251, a173
MV 148,v,32,v,68
v_accvgpr_read_b32 v252, a174
v_accvgpr_read_b32 v253, a175
MV 164,v,36,v,68
s_add_u32 s66, s66, 524288
v_cvt_pk_bf16_f32 v242, v246, v247
MV 152,v,32,v,72
ds_read_b128 v[60:63], v224 offset:6144
v_cvt_pk_bf16_f32 v243, v248, v249
MV 168,v,36,v,72
s_and_b32 s66, s66, 8388607
v_cvt_pk_bf16_f32 v244, v250, v251
MV 156,v,32,v,76
TR 32,220,16384
TR 34,220,17408
MV 172,v,36,v,76
TR 36,221,16384
TR 38,221,17408
MV 188,v,40,v,76
s_add_u32 s75, s64, s74
v_cvt_pk_bf16_f32 v245, v252, v253
MV 204,v,44,v,76
buffer_store_dwordx4 v[242:245], v228, s[16:19], s24 offen offset:1024 sc1
v_accvgpr_read_b32 v234, a176
MV 184,v,40,v,72
s_add_u32 m0, s67, 65536
v_accvgpr_read_b32 v235, a177
MV 200,v,44,v,72
v_accvgpr_read_b32 v236, a178
v_accvgpr_read_b32 v237, a179
MV 180,v,40,v,68
buffer_load_dwordx4 v208, s[44:47], s75 offen offset:0 lds
v_accvgpr_read_b32 v238, a180
MV 196,v,44,v,68
MV 176,v,40,v,64
TR 40,222,16384
TR 42,222,17408
MV 192,v,44,v,64
TR 44,223,16384
TR 46,223,17408
s_waitcnt lgkmcnt(4)
MV 80,v,16,v,48
buffer_load_dwordx4 v209, s[44:47], s75 offen offset:1024 lds
v_accvgpr_read_b32 v239, a181
MV 96,v,20,v,48
ds_read_b128 v[64:67], v225 offset:0
v_accvgpr_read_b32 v240, a182
MV 84,v,16,v,52
buffer_load_dwordx4 v210, s[44:47], s75 offen offset:2048 lds
v_accvgpr_read_b32 v241, a183
MV 100,v,20,v,52
MV 88,v,16,v,56
v_cvt_pk_bf16_f32 v230, v234, v235
MV 104,v,20,v,56
buffer_load_dwordx4 v211, s[44:47], s75 offen offset:3072 lds
v_cvt_pk_bf16_f32 v231, v236, v237
MV 92,v,16,v,60
TR 16,216,24576
TR 18,216,25600
MV 108,v,20,v,60
TR 20,217,24576
TR 22,217,25600
MV 124,v,24,v,60
ds_read_b128 v[68:71], v225 offset:2048
s_add_u32 s75, s65, s74
MV 140,v,28,v,60
v_cvt_pk_bf16_f32 v232, v238, v239
v_cvt_pk_bf16_f32 v233, v240, v241
MV 120,v,24,v,56
buffer_store_dwordx4 v[230:233], v228, s[16:19], s24 offen offset:2048 sc1
v_accvgpr_read_b32 v246, a184
MV 136,v,28,v,56
s_add_u32 m0, s67, 69632
MV 116,v,24,v,52
ds_read_b128 v[72:75], v225 offset:4096
v_accvgpr_read_b32 v247, a185
MV 132,v,28,v,52
v_accvgpr_read_b32 v248, a186
MV 112,v,24,v,48
TR 24,218,24576
TR 26,218,25600
MV 128,v,28,v,48
TR 28,219,24576
TR 30,219,25600
MV 144,v,32,v,48
buffer_load_dwordx4 v208, s[44:47], s75 offen offset:0 lds
buffer_load_dwordx4 v209, s[44:47], s75 offen offset:1024 lds
MV 160,v,36,v,48
v_accvgpr_read_b32 v249, a187
v_accvgpr_read_b32 v250, a188
MV 148,v,32,v,52
ds_read_b128 v[76:79], v225 offset:6144
v_accvgpr_read_b32 v251, a189
MV 164,v,36,v,52
buffer_load_dwordx4 v210, s[44:47], s75 offen offset:2048 lds
v_accvgpr_read_b32 v252, a190
MV 152,v,32,v,56
v_accvgpr_read_b32 v253, a191
MV 168,v,36,v,56
v_cvt_pk_bf16_f32 v242, v246, v247
MV 156,v,32,v,60
TR 32,220,24576
TR 34,220,25600
MV 172,v,36,v,60
TR 36,221,24576
TR 38,221,25600
s_waitcnt lgkmcnt(15)
MV 188,v,40,v,60
buffer_load_dwordx4 v211, s[44:47], s75 offen offset:3072 lds
v_cvt_pk_bf16_f32 v243, v248, v249
MV 204,v,44,v,60
s_add_u32 s74, s74, 128
v_cvt_pk_bf16_f32 v244, v250, v251
MV 184,v,40,v,56
v_cvt_pk_bf16_f32 v245, v252, v253
MV 200,v,44,v,56
buffer_store_dwordx4 v[242:245], v228, s[16:19], s24 offen offset:3072 sc1
MV 180,v,40,v,52
s_and_b32 s74, s74, 2047
buffer_load_dword v254, off, s[12:15], 0 sc1
MV 196,v,44,v,52
MV 176,v,40,v,48
TR 40,222,24576
TR 42,222,25600
MV 192,v,44,v,48
TR 44,223,24576
TR 46,223,25600
s_waitcnt lgkmcnt(4)
MV 80,v,16,v,64
v_accvgpr_read_b32 v234, a192
MV 96,v,20,v,64
v_accvgpr_read_b32 v235, a193
MV 84,v,16,v,68
v_accvgpr_read_b32 v236, a194
MV 100,v,20,v,68
MV 88,v,16,v,72
v_accvgpr_read_b32 v237, a195
MV 104,v,20,v,72
v_accvgpr_read_b32 v238, a196
MV 92,v,16,v,76
MV 108,v,20,v,76
s_waitcnt vmcnt(17) lgkmcnt(0)
s_barrier
MV 124,v,24,v,76
TR 16,216,32768
TR 18,216,33792
MV 140,v,28,v,76
ds_read_b128 v[48:51], v224 offset:32768
s_add_u32 m0, s68, 114688
MV 120,v,24,v,72
TR 20,217,32768
TR 22,217,33792
MV 136,v,28,v,72
buffer_load_dwordx4 v212, s[48:51], s66 offen offset:0 lds
v_accvgpr_read_b32 v239, a197
MV 116,v,24,v,68
ds_read_b128 v[52:55], v224 offset:34816
buffer_load_dwordx4 v213, s[48:51], s66 offen offset:1024 lds
MV 132,v,28,v,68
v_accvgpr_read_b32 v240, a198
v_accvgpr_read_b32 v241, a199
MV 112,v,24,v,64
TR 24,218,32768
TR 26,218,33792
MV 128,v,28,v,64
TR 28,219,32768
TR 30,219,33792
MV 144,v,32,v,64
ds_read_b128 v[56:59], v224 offset:36864
buffer_load_dwordx4 v214, s[48:51], s66 offen offset:2048 lds
MV 160,v,36,v,64
buffer_load_dwordx4 v215, s[48:51], s66 offen offset:3072 lds
v_cvt_pk_bf16_f32 v230, v234, v235
MV 148,v,32,v,68
v_cvt_pk_bf16_f32 v231, v236, v237
v_cvt_pk_bf16_f32 v232, v238, v239
MV 164,v,36,v,68
s_add_u32 s66, s66, 524288
v_cvt_pk_bf16_f32 v233, v240, v241
MV 152,v,32,v,72
ds_read_b128 v[60:63], v224 offset:38912
s_add_u32 s24, s24, 4096
MV 168,v,36,v,72
s_and_b32 s66, s66, 8388607
buffer_store_dwordx4 v[230:233], v228, s[16:19], s24 offen offset:0 sc1
MV 156,v,32,v,76
TR 32,220,32768
TR 34,220,33792
MV 172,v,36,v,76
TR 36,221,32768
TR 38,221,33792
MV 188,v,40,v,76
s_add_u32 s75, s64, s74
v_accvgpr_read_b32 v246, a200
MV 204,v,44,v,76
v_accvgpr_read_b32 v247, a201
v_accvgpr_read_b32 v248, a202
MV 184,v,40,v,72
s_add_u32 m0, s67, 0
v_accvgpr_read_b32 v249, a203
MV 200,v,44,v,72
v_accvgpr_read_b32 v250, a204
v_accvgpr_read_b32 v251, a205
MV 180,v,40,v,68
buffer_load_dwordx4 v208, s[44:47], s75 offen offset:0 lds
v_accvgpr_read_b32 v252, a206
MV 196,v,44,v,68
MV 176,v,40,v,64
TR 40,222,32768
TR 42,222,33792
MV 192,v,44,v,64
TR 44,223,32768
TR 46,223,33792
s_waitcnt lgkmcnt(4)
MV 80,v,16,v,48
buffer_load_dwordx4 v209, s[44:47], s75 offen offset:1024 lds
v_accvgpr_read_b32 v253, a207
MV 96,v,20,v,48
ds_read_b128 v[64:67], v225 offset:32768
v_cvt_pk_bf16_f32 v242, v246, v247
MV 84,v,16,v,52
buffer_load_dwordx4 v210, s[44:47], s75 offen offset:2048 lds
v_cvt_pk_bf16_f32 v243, v248, v249
MV 100,v,20,v,52
MV 88,v,16,v,56
v_cvt_pk_bf16_f32 v244, v250, v251
MV 104,v,20,v,56
buffer_load_dwordx4 v211, s[44:47], s75 offen offset:3072 lds
v_cvt_pk_bf16_f32 v245, v252, v253
MV 92,v,16,v,60
TR 16,216,40960
TR 18,216,41984
MV 108,v,20,v,60
TR 20,217,40960
TR 22,217,41984
MV 124,v,24,v,60
ds_read_b128 v[68:71], v225 offset:34816
s_add_u32 s75, s65, s74
MV 140,v,28,v,60
buffer_store_dwordx4 v[242:245], v228, s[16:19], s24 offen offset:1024 sc1
v_accvgpr_read_b32 v234, a208
MV 120,v,24,v,56
v_accvgpr_read_b32 v235, a209
MV 136,v,28,v,56
s_add_u32 m0, s67, 4096
v_accvgpr_read_b32 v236, a210
MV 116,v,24,v,52
ds_read_b128 v[72:75], v225 offset:36864
v_accvgpr_read_b32 v237, a211
MV 132,v,28,v,52
MV 112,v,24,v,48
TR 24,218,40960
TR 26,218,41984
MV 128,v,28,v,48
TR 28,219,40960
TR 30,219,41984
MV 144,v,32,v,48
buffer_load_dwordx4 v208, s[44:47], s75 offen offset:0 lds
buffer_load_dwordx4 v209, s[44:47], s75 offen offset:1024 lds
MV 160,v,36,v,48
v_accvgpr_read_b32 v238, a212
v_accvgpr_read_b32 v239, a213
MV 148,v,32,v,52
ds_read_b128 v[76:79], v225 offset:38912
v_accvgpr_read_b32 v240, a214
MV 164,v,36,v,52
buffer_load_dwordx4 v210, s[44:47], s75 offen offset:2048 lds
v_accvgpr_read_b32 v241, a215
MV 152,v,32,v,56
v_cvt_pk_bf16_f32 v230, v234, v235
MV 168,v,36,v,56
v_cvt_pk_bf16_f32 v231, v236, v237
MV 156,v,32,v,60
TR 32,220,40960
TR 34,220,41984
MV 172,v,36,v,60
TR 36,221,40960
TR 38,221,41984
s_waitcnt lgkmcnt(15)
MV 188,v,40,v,60
buffer_load_dwordx4 v211, s[44:47], s75 offen offset:3072 lds
v_cvt_pk_bf16_f32 v232, v238, v239
MV 204,v,44,v,60
s_add_u32 s74, s74, 128
v_cvt_pk_bf16_f32 v233, v240, v241
MV 184,v,40,v,56
buffer_store_dwordx4 v[230:233], v228, s[16:19], s24 offen offset:2048 sc1
MV 200,v,44,v,56
v_accvgpr_read_b32 v246, a216
MV 180,v,40,v,52
s_and_b32 s74, s74, 2047
v_accvgpr_read_b32 v247, a217
MV 196,v,44,v,52
MV 176,v,40,v,48
TR 40,222,40960
TR 42,222,41984
MV 192,v,44,v,48
TR 44,223,40960
TR 46,223,41984
s_waitcnt lgkmcnt(4)
MV 80,v,16,v,64
v_accvgpr_read_b32 v248, a218
MV 96,v,20,v,64
v_accvgpr_read_b32 v249, a219
MV 84,v,16,v,68
v_accvgpr_read_b32 v250, a220
MV 100,v,20,v,68
MV 88,v,16,v,72
v_accvgpr_read_b32 v251, a221
MV 104,v,20,v,72
v_accvgpr_read_b32 v252, a222
MV 92,v,16,v,76
MV 108,v,20,v,76
s_waitcnt vmcnt(17) lgkmcnt(0)
s_barrier
MV 124,v,24,v,76
TR 16,216,0
TR 18,216,1024
MV 140,v,28,v,76
ds_read_b128 v[48:51], v226 offset:0
s_add_u32 m0, s68, 131072
MV 120,v,24,v,72
TR 20,217,0
TR 22,217,1024
MV 136,v,28,v,72
buffer_load_dwordx4 v212, s[48:51], s66 offen offset:0 lds
v_accvgpr_read_b32 v253, a223
MV 116,v,24,v,68
ds_read_b128 v[52:55], v226 offset:2048
buffer_load_dwordx4 v213, s[48:51], s66 offen offset:1024 lds
MV 132,v,28,v,68
v_cvt_pk_bf16_f32 v242, v246, v247
v_cvt_pk_bf16_f32 v243, v248, v249
MV 112,v,24,v,64
TR 24,218,0
TR 26,218,1024
MV 128,v,28,v,64
TR 28,219,0
TR 30,219,1024
MV 144,v,32,v,64
ds_read_b128 v[56:59], v226 offset:4096
buffer_load_dwordx4 v214, s[48:51], s66 offen offset:2048 lds
MV 160,v,36,v,64
buffer_load_dwordx4 v215, s[48:51], s66 offen offset:3072 lds
v_cvt_pk_bf16_f32 v244, v250, v251
MV 148,v,32,v,68
v_cvt_pk_bf16_f32 v245, v252, v253
buffer_store_dwordx4 v[242:245], v228, s[16:19], s24 offen offset:3072 sc1
MV 164,v,36,v,68
s_add_u32 s66, s66, 524288
v_accvgpr_read_b32 v234, a224
MV 152,v,32,v,72
ds_read_b128 v[60:63], v226 offset:6144
v_accvgpr_read_b32 v235, a225
MV 168,v,36,v,72
s_and_b32 s66, s66, 8388607
v_accvgpr_read_b32 v236, a226
MV 156,v,32,v,76
TR 32,220,0
TR 34,220,1024
MV 172,v,36,v,76
TR 36,221,0
TR 38,221,1024
MV 188,v,40,v,76
s_add_u32 s75, s64, s74
v_accvgpr_read_b32 v237, a227
MV 204,v,44,v,76
v_accvgpr_read_b32 v238, a228
v_accvgpr_read_b32 v239, a229
MV 184,v,40,v,72
s_add_u32 m0, s67, 32768
v_accvgpr_read_b32 v240, a230
MV 200,v,44,v,72
v_accvgpr_read_b32 v241, a231
v_cvt_pk_bf16_f32 v230, v234, v235
MV 180,v,40,v,68
buffer_load_dwordx4 v208, s[44:47], s75 offen offset:0 lds
v_cvt_pk_bf16_f32 v231, v236, v237
MV 196,v,44,v,68
MV 176,v,40,v,64
TR 40,222,0
TR 42,222,1024
MV 192,v,44,v,64
TR 44,223,0
TR 46,223,1024
s_waitcnt lgkmcnt(4)
MV 80,v,16,v,48
buffer_load_dwordx4 v209, s[44:47], s75 offen offset:1024 lds
v_cvt_pk_bf16_f32 v232, v238, v239
MV 96,v,20,v,48
ds_read_b128 v[64:67], v227 offset:0
v_cvt_pk_bf16_f32 v233, v240, v241
MV 84,v,16,v,52
buffer_load_dwordx4 v210, s[44:47], s75 offen offset:2048 lds
s_add_u32 s24, s24, 4096
MV 100,v,20,v,52
MV 88,v,16,v,56
buffer_store_dwordx4 v[230:233], v228, s[16:19], s24 offen offset:0 sc1
MV 104,v,20,v,56
buffer_load_dwordx4 v211, s[44:47], s75 offen offset:3072 lds
v_accvgpr_read_b32 v246, a232
MV 92,v,16,v,60
TR 16,216,8192
TR 18,216,9216
MV 108,v,20,v,60
TR 20,217,8192
TR 22,217,9216
MV 124,v,24,v,60
ds_read_b128 v[68:71], v227 offset:2048
s_add_u32 s75, s65, s74
MV 140,v,28,v,60
v_accvgpr_read_b32 v247, a233
v_accvgpr_read_b32 v248, a234
MV 120,v,24,v,56
v_accvgpr_read_b32 v249, a235
MV 136,v,28,v,56
s_add_u32 m0, s67, 36864
v_accvgpr_read_b32 v250, a236
MV 116,v,24,v,52
ds_read_b128 v[72:75], v227 offset:4096
v_accvgpr_read_b32 v251, a237
MV 132,v,28,v,52
MV 112,v,24,v,48
TR 24,218,8192
TR 26,218,9216
MV 128,v,28,v,48
TR 28,219,8192
TR 30,219,9216
MV 144,v,32,v,48
buffer_load_dwordx4 v208, s[44:47], s75 offen offset:0 lds
buffer_load_dwordx4 v209, s[44:47], s75 offen offset:1024 lds
MV 160,v,36,v,48
v_accvgpr_read_b32 v252, a238
v_accvgpr_read_b32 v253, a239
MV 148,v,32,v,52
ds_read_b128 v[76:79], v227 offset:6144
v_cvt_pk_bf16_f32 v242, v246, v247
MV 164,v,36,v,52
buffer_load_dwordx4 v210, s[44:47], s75 offen offset:2048 lds
v_cvt_pk_bf16_f32 v243, v248, v249
MV 152,v,32,v,56
v_cvt_pk_bf16_f32 v244, v250, v251
MV 168,v,36,v,56
v_cvt_pk_bf16_f32 v245, v252, v253
MV 156,v,32,v,60
TR 32,220,8192
TR 34,220,9216
MV 172,v,36,v,60
TR 36,221,8192
TR 38,221,9216
s_waitcnt lgkmcnt(15)
MV 188,v,40,v,60
buffer_load_dwordx4 v211, s[44:47], s75 offen offset:3072 lds
buffer_store_dwordx4 v[242:245], v228, s[16:19], s24 offen offset:1024 sc1
MV 204,v,44,v,60
s_add_u32 s74, s74, 128
v_accvgpr_read_b32 v234, a240
MV 184,v,40,v,56
v_accvgpr_read_b32 v235, a241
MV 200,v,44,v,56
v_accvgpr_read_b32 v236, a242
MV 180,v,40,v,52
s_and_b32 s74, s74, 2047
v_accvgpr_read_b32 v237, a243
MV 196,v,44,v,52
MV 176,v,40,v,48
TR 40,222,8192
TR 42,222,9216
MV 192,v,44,v,48
TR 44,223,8192
TR 46,223,9216
s_waitcnt lgkmcnt(4)
MV 80,v,16,v,64
v_accvgpr_read_b32 v238, a244
MV 96,v,20,v,64
v_accvgpr_read_b32 v239, a245
MV 84,v,16,v,68
v_accvgpr_read_b32 v240, a246
MV 100,v,20,v,68
MV 88,v,16,v,72
v_accvgpr_read_b32 v241, a247
MV 104,v,20,v,72
v_cvt_pk_bf16_f32 v230, v234, v235
MV 92,v,16,v,76
v_cvt_pk_bf16_f32 v231, v236, v237
MV 108,v,20,v,76
s_waitcnt vmcnt(16) lgkmcnt(0)
s_barrier
MV 124,v,24,v,76
TR 16,216,16384
TR 18,216,17408
MV 140,v,28,v,76
ds_read_b128 v[48:51], v224 offset:0
s_add_u32 m0, s68, 98304
MV 120,v,24,v,72
TR 20,217,16384
TR 22,217,17408
MV 136,v,28,v,72
buffer_load_dwordx4 v212, s[48:51], s66 offen offset:0 lds
v_cvt_pk_bf16_f32 v232, v238, v239
MV 116,v,24,v,68
ds_read_b128 v[52:55], v224 offset:2048
buffer_load_dwordx4 v213, s[48:51], s66 offen offset:1024 lds
MV 132,v,28,v,68
v_cvt_pk_bf16_f32 v233, v240, v241
buffer_store_dwordx4 v[230:233], v228, s[16:19], s24 offen offset:2048 sc1
MV 112,v,24,v,64
TR 24,218,16384
TR 26,218,17408
MV 128,v,28,v,64
TR 28,219,16384
TR 30,219,17408
MV 144,v,32,v,64
ds_read_b128 v[56:59], v224 offset:4096
buffer_load_dwordx4 v214, s[48:51], s66 offen offset:2048 lds
MV 160,v,36,v,64
buffer_load_dwordx4 v215, s[48:51], s66 offen offset:3072 lds
v_accvgpr_read_b32 v246, a248
MV 148,v,32,v,68
v_accvgpr_read_b32 v247, a249
v_accvgpr_read_b32 v248, a250
MV 164,v,36,v,68
s_add_u32 s66, s66, 524288
v_accvgpr_read_b32 v249, a251
MV 152,v,32,v,72
ds_read_b128 v[60:63], v224 offset:6144
v_accvgpr_read_b32 v250, a252
MV 168,v,36,v,72
s_and_b32 s66, s66, 8388607
v_accvgpr_read_b32 v251, a253
MV 156,v,32,v,76
TR 32,220,16384
TR 34,220,17408
MV 172,v,36,v,76
TR 36,221,16384
TR 38,221,17408
MV 188,v,40,v,76
s_add_u32 s75, s64, s74
v_accvgpr_read_b32 v252, a254
MV 204,v,44,v,76
v_accvgpr_read_b32 v253, a255
v_cvt_pk_bf16_f32 v242, v246, v247
MV 184,v,40,v,72
s_add_u32 m0, s67, 65536
v_cvt_pk_bf16_f32 v243, v248, v249
MV 200,v,44,v,72
v_cvt_pk_bf16_f32 v244, v250, v251
v_cvt_pk_bf16_f32 v245, v252, v253
MV 180,v,40,v,68
buffer_load_dwordx4 v208, s[44:47], s75 offen offset:0 lds
buffer_store_dwordx4 v[242:245], v228, s[16:19], s24 offen offset:3072 sc1
MV 196,v,44,v,68
MV 176,v,40,v,64
TR 40,222,16384
TR 42,222,17408
MV 192,v,44,v,64
TR 44,223,16384
TR 46,223,17408
s_waitcnt lgkmcnt(4)
MV 80,v,16,v,48
buffer_load_dwordx4 v209, s[44:47], s75 offen offset:1024 lds
v_lshlrev_b32 v255, 20, v1
MV 96,v,20,v,48
ds_read_b128 v[64:67], v225 offset:0
MV 84,v,16,v,52
buffer_load_dwordx4 v210, s[44:47], s75 offen offset:2048 lds
MV 100,v,20,v,52
MV 88,v,16,v,56
MV 104,v,20,v,56
buffer_load_dwordx4 v211, s[44:47], s75 offen offset:3072 lds
MV 92,v,16,v,60
TR 16,216,24576
TR 18,216,25600
MV 108,v,20,v,60
TR 20,217,24576
TR 22,217,25600
MV 124,v,24,v,60
ds_read_b128 v[68:71], v225 offset:2048
s_add_u32 s75, s65, s74
MV 140,v,28,v,60
MV 120,v,24,v,56
s_lshl_b32 s36, s3, 26
MV 136,v,28,v,56
s_add_u32 m0, s67, 69632
MV 116,v,24,v,52
ds_read_b128 v[72:75], v225 offset:4096
MV 132,v,28,v,52
MV 112,v,24,v,48
TR 24,218,24576
TR 26,218,25600
MV 128,v,28,v,48
TR 28,219,24576
TR 30,219,25600
MV 144,v,32,v,48
buffer_load_dwordx4 v208, s[44:47], s75 offen offset:0 lds
buffer_load_dwordx4 v209, s[44:47], s75 offen offset:1024 lds
MV 160,v,36,v,48
MV 148,v,32,v,52
ds_read_b128 v[76:79], v225 offset:6144
MV 164,v,36,v,52
buffer_load_dwordx4 v210, s[44:47], s75 offen offset:2048 lds
MV 152,v,32,v,56
v_add_u32 v255, s36, v255
MV 168,v,36,v,56
MV 156,v,32,v,60
TR 32,220,24576
TR 34,220,25600
MV 172,v,36,v,60
TR 36,221,24576
TR 38,221,25600
s_waitcnt lgkmcnt(15)
MV 188,v,40,v,60
buffer_load_dwordx4 v211, s[44:47], s75 offen offset:3072 lds
MV 204,v,44,v,60
s_add_u32 s74, s74, 128
MV 184,v,40,v,56
MV 200,v,44,v,56
MV 180,v,40,v,52
s_and_b32 s74, s74, 2047
MV 196,v,44,v,52
MV 176,v,40,v,48
TR 40,222,24576
TR 42,222,25600
MV 192,v,44,v,48
TR 44,223,24576
TR 46,223,25600
s_waitcnt lgkmcnt(4)
MV 80,v,16,v,64
v_lshlrev_b32 v230, 4, v1
MV 96,v,20,v,64
s_lshl_b32 s80, s3, 12
MV 84,v,16,v,68
MV 100,v,20,v,68
v_add_u32 v12, s80, v230
MV 88,v,16,v,72
MV 104,v,20,v,72
v_add_u32 v10, 0x8000, v230
MV 92,v,16,v,76
MV 108,v,20,v,76
s_waitcnt vmcnt(15) lgkmcnt(0)
s_barrier
MV 124,v,24,v,76
TR 16,216,32768
TR 18,216,33792
MV 140,v,28,v,76
ds_read_b128 v[48:51], v224 offset:32768
s_add_u32 m0, s68, 114688
MV 120,v,24,v,72
TR 20,217,32768
TR 22,217,33792
MV 136,v,28,v,72
buffer_load_dwordx4 v212, s[48:51], s66 offen offset:0 lds
v_add_u32 v11, 0x10000, v230
MV 116,v,24,v,68
ds_read_b128 v[52:55], v224 offset:34816
buffer_load_dwordx4 v213, s[48:51], s66 offen offset:1024 lds
MV 132,v,28,v,68
s_add_u32 s72, s80, 0x8000
s_add_u32 s73, s80, 0x10000
MV 112,v,24,v,64
TR 24,218,32768
TR 26,218,33792
MV 128,v,28,v,64
TR 28,219,32768
TR 30,219,33792
MV 144,v,32,v,64
ds_read_b128 v[56:59], v224 offset:36864
buffer_load_dwordx4 v214, s[48:51], s66 offen offset:2048 lds
MV 160,v,36,v,64
buffer_load_dwordx4 v215, s[48:51], s66 offen offset:3072 lds
v_mov_b32 v15, v230
MV 148,v,32,v,68
v_and_b32 v230, 15, v1
v_lshrrev_b32 v232, 4, v1
MV 164,v,36,v,68
s_add_u32 s66, s66, 524288
v_lshlrev_b32 v232, 2, v232
MV 152,v,32,v,72
ds_read_b128 v[60:63], v224 offset:38912
v_sub_u32 v230, v230, v232
MV 168,v,36,v,72
s_and_b32 s66, s66, 8388607
s_lshl_b32 s81, s3, 4
MV 156,v,32,v,76
TR 32,220,32768
TR 34,220,33792
MV 172,v,36,v,76
TR 36,221,32768
TR 38,221,33792
MV 188,v,40,v,76
s_add_u32 s75, s64, s74
v_add_u32 v13, s81, v230
MV 204,v,44,v,76
s_sub_u32 s81, 112, s81
MV 184,v,40,v,72
s_add_u32 m0, s67, 0
v_add_u32 v239, s81, v230
MV 200,v,44,v,72
MV 180,v,40,v,68
buffer_load_dwordx4 v208, s[44:47], s75 offen offset:0 lds
v_mov_b32 v14, 0xff800000
MV 196,v,44,v,68
MV 176,v,40,v,64
TR 40,222,32768
TR 42,222,33792
MV 192,v,44,v,64
TR 44,223,32768
TR 46,223,33792
s_waitcnt lgkmcnt(4)
MV 80,v,16,v,48
buffer_load_dwordx4 v209, s[44:47], s75 offen offset:1024 lds
s_getpc_b64 s[38:39]
L_ct_a:
MV 96,v,20,v,48
ds_read_b128 v[64:67], v225 offset:32768
MV 84,v,16,v,52
buffer_load_dwordx4 v210, s[44:47], s75 offen offset:2048 lds
MV 100,v,20,v,52
s_add_u32 s38, s38, L_p3_begin - L_ct_a
s_addc_u32 s39, s39, 0
MV 88,v,16,v,56
MV 104,v,20,v,56
buffer_load_dwordx4 v211, s[44:47], s75 offen offset:3072 lds
v_mov_b32 v229, s39
MV 92,v,16,v,60
TR 16,216,40960
TR 18,216,41984
MV 108,v,20,v,60
TR 20,217,40960
TR 22,217,41984
MV 124,v,24,v,60
ds_read_b128 v[68:71], v225 offset:34816
s_add_u32 s75, s65, s74
MV 140,v,28,v,60
v_mov_b32 v228, s38
s_lshr_b32 s38, s2, 3
MV 120,v,24,v,56
s_lshl_b32 s38, s38, 2
MV 136,v,28,v,56
s_add_u32 m0, s67, 4096
s_add_u32 s38, s38, s3
MV 116,v,24,v,52
ds_read_b128 v[72:75], v225 offset:36864
MV 132,v,28,v,52
s_lshl_b32 s38, s38, 7
MV 112,v,24,v,48
TR 24,218,40960
TR 26,218,41984
MV 128,v,28,v,48
TR 28,219,40960
TR 30,219,41984
MV 144,v,32,v,48
buffer_load_dwordx4 v208, s[44:47], s75 offen offset:0 lds
buffer_load_dwordx4 v209, s[44:47], s75 offen offset:1024 lds
MV 160,v,36,v,48
v_and_b32 v238, 3, v1
v_lshlrev_b32 v238, 14, v238
MV 148,v,32,v,52
ds_read_b128 v[76:79], v225 offset:38912
v_add_u32 v238, s38, v238
MV 164,v,36,v,52
buffer_load_dwordx4 v210, s[44:47], s75 offen offset:2048 lds
MV 152,v,32,v,56
v_min_u32 v238, L_p3_s1m_top - L_p3_begin - 4, v238
MV 168,v,36,v,56
v_add_co_u32 v228, vcc, v228, v238
s_nop 1
v_addc_co_u32 v229, vcc, 0, v229, vcc
MV 156,v,32,v,60
TR 32,220,40960
TR 34,220,41984
MV 172,v,36,v,60
TR 36,221,40960
TR 38,221,41984
s_waitcnt lgkmcnt(15)
MV 188,v,40,v,60
buffer_load_dwordx4 v211, s[44:47], s75 offen offset:3072 lds
MV 204,v,44,v,60
s_add_u32 s74, s74, 128
MV 184,v,40,v,56
MV 200,v,44,v,56
MV 180,v,40,v,52
s_and_b32 s74, s74, 2047
global_load_dword v238, v[228:229], off
MV 196,v,44,v,52
MV 176,v,40,v,48
TR 40,222,40960
TR 42,222,41984
MV 192,v,44,v,48
TR 44,223,40960
TR 46,223,41984
s_waitcnt lgkmcnt(4)
MV 80,v,16,v,64
MV 96,v,20,v,64
MV 84,v,16,v,68
MV 100,v,20,v,68
MV 88,v,16,v,72
MV 104,v,20,v,72
MV 92,v,16,v,76
MV 108,v,20,v,76
s_waitcnt vmcnt(13) lgkmcnt(0)
s_barrier
MV 124,v,24,v,76
v_cmp_gt_u32 vcc, 1, v254
s_nop 4
s_cbranch_vccnz L_spin_go
L_spin_go_ret:
v_mov_b32 v254, 1
s_lshl_b32 s36, s2, 2
buffer_store_dword v254, v255, s[8:11], s36 offen offset:0 sc1
s_load_dwordx4 s[32:35], s[0:1], 32
MV 140,v,28,v,76
TR 16,216,0
TR 18,216,1024
MV 120,v,24,v,72
TR 20,217,0
TR 22,217,1024
MV 136,v,28,v,72
ds_read_b128 v[48:51], v226 offset:0
s_add_u32 m0, s68, 131072
MV 116,v,24,v,68
ds_read_b128 v[52:55], v226 offset:2048
buffer_load_dwordx4 v212, s[48:51], s66 offen offset:0 lds
MV 132,v,28,v,68
buffer_load_dwordx4 v213, s[48:51], s66 offen offset:1024 lds
MV 112,v,24,v,64
TR 24,218,0
TR 26,218,1024
MV 128,v,28,v,64
TR 28,219,0
TR 30,219,1024
MV 144,v,32,v,64
ds_read_b128 v[56:59], v226 offset:4096
buffer_load_dwordx4 v214, s[48:51], s66 offen offset:2048 lds
MV 160,v,36,v,64
buffer_load_dwordx4 v215, s[48:51], s66 offen offset:3072 lds
MV 148,v,32,v,68
MV 164,v,36,v,68
s_add_u32 s66, s66, 524288
MV 152,v,32,v,72
ds_read_b128 v[60:63], v226 offset:6144
MV 168,v,36,v,72
s_and_b32 s66, s66, 8388607
MV 156,v,32,v,76
TR 32,220,0
TR 34,220,1024
MV 172,v,36,v,76
TR 36,221,0
TR 38,221,1024
MV 188,v,40,v,76
s_add_u32 s75, s64, s74
MV 204,v,44,v,76
MV 184,v,40,v,72
s_add_u32 m0, s67, 32768
MV 200,v,44,v,72
MV 180,v,40,v,68
buffer_load_dwordx4 v208, s[44:47], s75 offen offset:0 lds
MV 196,v,44,v,68
MV 176,v,40,v,64
TR 40,222,0
TR 42,222,1024
MV 192,v,44,v,64
TR 44,223,0
TR 46,223,1024
s_waitcnt lgkmcnt(4)
MV 80,v,16,v,48
buffer_load_dwordx4 v209, s[44:47], s75 offen offset:1024 lds
s_and_b32 s36, s2, 3
MV 96,v,20,v,48
ds_read_b128 v[64:67], v227 offset:0
s_lshl_b32 s36, s36, 1
MV 84,v,16,v,52
buffer_load_dwordx4 v210, s[44:47], s75 offen offset:2048 lds
s_sub_u32 s43, 14, s36
MV 100,v,20,v,52
s_bitcmp1_b32 s2, 4
s_cselect_b32 s36, s43, s36
MV 88,v,16,v,56
s_bfe_u32 s43, s2, 0x10003
MV 104,v,20,v,56
buffer_load_dwordx4 v211, s[44:47], s75 offen offset:3072 lds
s_add_u32 s36, s36, s43
MV 92,v,16,v,60
TR 16,216,8192
TR 18,216,9216
MV 108,v,20,v,60
TR 20,217,8192
TR 22,217,9216
MV 124,v,24,v,60
ds_read_b128 v[68:71], v227 offset:2048
s_add_u32 s75, s65, s74
MV 140,v,28,v,60
s_bfe_u32 s37, s2, 0x10002
s_lshr_b32 s43, s2, 5
MV 120,v,24,v,56
s_lshl_b32 s43, s43, 1
s_add_u32 s37, s37, s43
MV 136,v,28,v,56
s_add_u32 m0, s67, 36864
v_and_b32 v230, 15, v1
MV 116,v,24,v,52
ds_read_b128 v[72:75], v227 offset:4096
s_lshl_b32 s36, s36, 4
MV 132,v,28,v,52
v_add_u32 v231, s36, v230
s_lshr_b32 s36, s2, 4
MV 112,v,24,v,48
TR 24,218,8192
TR 26,218,9216
MV 128,v,28,v,48
TR 28,219,8192
TR 30,219,9216
MV 144,v,32,v,48
buffer_load_dwordx4 v208, s[44:47], s75 offen offset:0 lds
buffer_load_dwordx4 v209, s[44:47], s75 offen offset:1024 lds
MV 160,v,36,v,48
v_lshl_add_u32 v232, v230, 4, s36
v_and_b32 v233, 7, v1
MV 148,v,32,v,52
ds_read_b128 v[76:79], v227 offset:6144
v_bfe_u32 v234, v1, 3, 1
MV 164,v,36,v,52
buffer_load_dwordx4 v210, s[44:47], s75 offen offset:2048 lds
v_lshlrev_b32 v233, 3, v233
MV 152,v,32,v,56
v_lshl_add_u32 v233, v234, 7, v233
s_bfe_u32 s36, s69, 0x10001
MV 168,v,36,v,56
s_lshl_b32 s36, s36, 6
s_lshr_b32 s37, s69, 2
MV 156,v,32,v,60
TR 32,220,8192
TR 34,220,9216
MV 172,v,36,v,60
TR 36,221,8192
TR 38,221,9216
s_waitcnt lgkmcnt(15)
MV 188,v,40,v,60
buffer_load_dwordx4 v211, s[44:47], s75 offen offset:3072 lds
s_add_u32 s36, s36, s37
MV 204,v,44,v,60
s_add_u32 s74, s74, 128
v_add_u32 v233, s36, v233
MV 184,v,40,v,56
v_lshrrev_b32 v234, 4, v1
MV 200,v,44,v,56
v_cmp_eq_u32 vcc, 1, v234
s_nop 1
v_cndmask_b32 v233, v233, v232, vcc
MV 180,v,40,v,52
s_and_b32 s74, s74, 2047
MV 196,v,44,v,52
v_cmp_eq_u32 vcc, 2, v234
s_nop 1
v_cndmask_b32 v233, v233, v231, vcc
MV 176,v,40,v,48
TR 40,222,8192
TR 42,222,9216
MV 192,v,44,v,48
TR 44,223,8192
TR 46,223,9216
v_lshlrev_b32 v233, 2, v233
s_waitcnt lgkmcnt(4)
MV 80,v,16,v,64
MV 96,v,20,v,64
MV 84,v,16,v,68
MV 100,v,20,v,68
MV 88,v,16,v,72
MV 104,v,20,v,72
MV 92,v,16,v,76
MV 108,v,20,v,76
s_waitcnt vmcnt(14) lgkmcnt(0)
s_barrier
MV 124,v,24,v,76
TR 16,216,16384
TR 18,216,17408
MV 140,v,28,v,76
ds_read_b128 v[48:51], v224 offset:0
s_add_u32 m0, s68, 98304
MV 120,v,24,v,72
TR 20,217,16384
TR 22,217,17408
MV 136,v,28,v,72
buffer_load_dwordx4 v212, s[48:51], s66 offen offset:0 lds
MV 116,v,24,v,68
ds_read_b128 v[52:55], v224 offset:2048
buffer_load_dwordx4 v213, s[48:51], s66 offen offset:1024 lds
MV 132,v,28,v,68
MV 112,v,24,v,64
TR 24,218,16384
TR 26,218,17408
MV 128,v,28,v,64
TR 28,219,16384
TR 30,219,17408
MV 144,v,32,v,64
ds_read_b128 v[56:59], v224 offset:4096
buffer_load_dwordx4 v214, s[48:51], s66 offen offset:2048 lds
MV 160,v,36,v,64
buffer_load_dwordx4 v215, s[48:51], s66 offen offset:3072 lds
MV 148,v,32,v,68
MV 164,v,36,v,68
s_add_u32 s66, s66, 524288
MV 152,v,32,v,72
ds_read_b128 v[60:63], v224 offset:6144
MV 168,v,36,v,72
s_and_b32 s66, s66, 8388607
MV 156,v,32,v,76
TR 32,220,16384
TR 34,220,17408
MV 172,v,36,v,76
TR 36,221,16384
TR 38,221,17408
MV 188,v,40,v,76
s_add_u32 s75, s64, s74
MV 204,v,44,v,76
MV 184,v,40,v,72
s_add_u32 m0, s67, 65536
MV 200,v,44,v,72
MV 180,v,40,v,68
buffer_load_dwordx4 v208, s[44:47], s75 offen offset:0 lds
MV 196,v,44,v,68
MV 176,v,40,v,64
TR 40,222,16384
TR 42,222,17408
MV 192,v,44,v,64
TR 44,223,16384
TR 46,223,17408
s_waitcnt lgkmcnt(4)
MV 80,v,16,v,48
buffer_load_dwordx4 v209, s[44:47], s75 offen offset:1024 lds
s_lshl_b32 s36, s2, 2
MV 96,v,20,v,48
ds_read_b128 v[64:67], v225 offset:0
s_add_u32 s36, s36, s3
MV 84,v,16,v,52
buffer_load_dwordx4 v210, s[44:47], s75 offen offset:2048 lds
s_lshl_b32 s42, s36, 1
MV 100,v,20,v,52
s_lshl_b32 s37, s36, 12
MV 88,v,16,v,56
s_add_u32 s16, s32, s37
s_addc_u32 s17, s33, 0
MV 104,v,20,v,56
buffer_load_dwordx4 v211, s[44:47], s75 offen offset:3072 lds
MV 92,v,16,v,60
TR 16,216,24576
TR 18,216,25600
MV 108,v,20,v,60
TR 20,217,24576
TR 22,217,25600
MV 124,v,24,v,60
ds_read_b128 v[68:71], v225 offset:2048
s_add_u32 s75, s65, s74
MV 140,v,28,v,60
s_mov_b32 s18, 4096
s_mov_b32 s19, 0x20000
MV 120,v,24,v,56
s_add_u32 s37, s37, 50331648
MV 136,v,28,v,56
s_add_u32 m0, s67, 69632
MV 116,v,24,v,52
ds_read_b128 v[72:75], v225 offset:4096
MV 132,v,28,v,52
s_add_u32 s20, s40, s37
s_addc_u32 s21, s41, 0
MV 112,v,24,v,48
TR 24,218,24576
TR 26,218,25600
MV 128,v,28,v,48
TR 28,219,24576
TR 30,219,25600
MV 144,v,32,v,48
buffer_load_dwordx4 v208, s[44:47], s75 offen offset:0 lds
buffer_load_dwordx4 v209, s[44:47], s75 offen offset:1024 lds
MV 160,v,36,v,48
s_mov_b32 s22, 4096
s_mov_b32 s23, 0x20000
MV 148,v,32,v,52
ds_read_b128 v[76:79], v225 offset:6144
s_lshl_b32 s37, s2, 14
MV 164,v,36,v,52
buffer_load_dwordx4 v210, s[44:47], s75 offen offset:2048 lds
s_add_u32 s37, s37, 54525952
MV 152,v,32,v,56
s_add_u32 s24, s40, s37
s_addc_u32 s25, s41, 0
MV 168,v,36,v,56
s_mov_b32 s26, 16384
s_mov_b32 s27, 0x20000
MV 156,v,32,v,60
TR 32,220,24576
TR 34,220,25600
MV 172,v,36,v,60
TR 36,221,24576
TR 38,221,25600
s_waitcnt lgkmcnt(15)
MV 188,v,40,v,60
buffer_load_dwordx4 v211, s[44:47], s75 offen offset:3072 lds
s_mov_b32 s28, s34
MV 204,v,44,v,60
s_add_u32 s74, s74, 128
s_mov_b32 s29, s35
MV 184,v,40,v,56
s_mov_b32 s30, 2048
s_mov_b32 s31, 0x20000
MV 200,v,44,v,56
s_mul_i32 s43, s3, 4608
MV 180,v,40,v,52
s_and_b32 s74, s74, 2047
s_add_u32 s43, s43, 132096
MV 196,v,44,v,52
MV 176,v,40,v,48
TR 40,222,24576
TR 42,222,25600
MV 192,v,44,v,48
TR 44,223,24576
TR 46,223,25600
s_waitcnt lgkmcnt(4)
MV 80,v,16,v,64
MV 96,v,20,v,64
MV 84,v,16,v,68
MV 100,v,20,v,68
MV 88,v,16,v,72
MV 104,v,20,v,72
MV 92,v,16,v,76
MV 108,v,20,v,76
s_waitcnt vmcnt(12) lgkmcnt(0)
s_barrier
MV 124,v,24,v,76
s_load_dwordx2 s[32:33], s[0:1], 88
TR 16,216,32768
MV 140,v,28,v,76
TR 18,216,33792
ds_read_b128 v[48:51], v224 offset:32768
MV 120,v,24,v,72
TR 20,217,32768
TR 22,217,33792
MV 136,v,28,v,72
MV 116,v,24,v,68
ds_read_b128 v[52:55], v224 offset:34816
MV 132,v,28,v,68
MV 112,v,24,v,64
TR 24,218,32768
TR 26,218,33792
MV 128,v,28,v,64
TR 28,219,32768
TR 30,219,33792
MV 144,v,32,v,64
ds_read_b128 v[56:59], v224 offset:36864
MV 160,v,36,v,64
MV 148,v,32,v,68
MV 164,v,36,v,68
MV 152,v,32,v,72
ds_read_b128 v[60:63], v224 offset:38912
MV 168,v,36,v,72
MV 156,v,32,v,76
TR 32,220,32768
TR 34,220,33792
MV 172,v,36,v,76
TR 36,221,32768
TR 38,221,33792
MV 188,v,40,v,76
MV 204,v,44,v,76
MV 184,v,40,v,72
MV 200,v,44,v,72
MV 180,v,40,v,68
MV 196,v,44,v,68
MV 176,v,40,v,64
TR 40,222,32768
TR 42,222,33792
MV 192,v,44,v,64
TR 44,223,32768
TR 46,223,33792
s_waitcnt lgkmcnt(4)
MV 80,v,16,v,48
s_add_u32 s4, s40, 109051904
s_addc_u32 s5, s41, 0
MV 96,v,20,v,48
ds_read_b128 v[64:67], v225 offset:32768
MV 84,v,16,v,52
MV 100,v,20,v,52
MV 88,v,16,v,56
s_mov_b32 s6, 4194304
MV 104,v,20,v,56
MV 92,v,16,v,60
TR 16,216,40960
TR 18,216,41984
MV 108,v,20,v,60
TR 20,217,40960
TR 22,217,41984
MV 124,v,24,v,60
ds_read_b128 v[68:71], v225 offset:34816
s_mov_b32 s7, 0x20000
MV 140,v,28,v,60
s_lshl_b32 s36, s2, 14
MV 120,v,24,v,56
MV 136,v,28,v,56
v_mov_b32 v244, -1
MV 116,v,24,v,52
ds_read_b128 v[72:75], v225 offset:36864
MV 132,v,28,v,52
v_mov_b32 v245, -1
MV 112,v,24,v,48
TR 24,218,40960
TR 26,218,41984
MV 128,v,28,v,48
TR 28,219,40960
TR 30,219,41984
MV 144,v,32,v,48
v_mov_b32 v246, -1
MV 160,v,36,v,48
MV 148,v,32,v,52
ds_read_b128 v[76:79], v225 offset:38912
v_mov_b32 v247, -1
MV 164,v,36,v,52
MV 152,v,32,v,56
buffer_store_dwordx4 v[244:247], v12, s[4:7], s36 offen offset:0 sc1
MV 168,v,36,v,56
MV 156,v,32,v,60
TR 32,220,40960
TR 34,220,41984
MV 172,v,36,v,60
TR 36,221,40960
TR 38,221,41984
s_waitcnt lgkmcnt(15)
MV 188,v,40,v,60
buffer_store_dwordx4 v[244:247], v12, s[4:7], s36 offen offset:1024 sc1
MV 204,v,44,v,60
buffer_store_dwordx4 v[244:247], v12, s[4:7], s36 offen offset:2048 sc1
MV 184,v,40,v,56
MV 200,v,44,v,56
buffer_store_dwordx4 v[244:247], v12, s[4:7], s36 offen offset:3072 sc1
MV 180,v,40,v,52
MV 196,v,44,v,52
MV 176,v,40,v,48
TR 40,222,40960
TR 42,222,41984
MV 192,v,44,v,48
TR 44,223,40960
TR 46,223,41984
s_waitcnt lgkmcnt(4)
MV 80,v,16,v,64
MV 96,v,20,v,64
MV 84,v,16,v,68
MV 100,v,20,v,68
MV 88,v,16,v,72
MV 104,v,20,v,72
MV 92,v,16,v,76
MV 108,v,20,v,76
s_waitcnt vmcnt(4) lgkmcnt(0)
s_barrier
MV 124,v,24,v,76
TR 16,216,0
TR 18,216,1024
MV 140,v,28,v,76
ds_read_b128 v[48:51], v226 offset:0
MV 120,v,24,v,72
TR 20,217,0
TR 22,217,1024
MV 136,v,28,v,72
MV 116,v,24,v,68
ds_read_b128 v[52:55], v226 offset:2048
MV 132,v,28,v,68
MV 112,v,24,v,64
TR 24,218,0
TR 26,218,1024
MV 128,v,28,v,64
TR 28,219,0
TR 30,219,1024
MV 144,v,32,v,64
ds_read_b128 v[56:59], v226 offset:4096
MV 160,v,36,v,64
MV 148,v,32,v,68
MV 164,v,36,v,68
MV 152,v,32,v,72
ds_read_b128 v[60:63], v226 offset:6144
MV 168,v,36,v,72
MV 156,v,32,v,76
TR 32,220,0
TR 34,220,1024
MV 172,v,36,v,76
TR 36,221,0
TR 38,221,1024
MV 188,v,40,v,76
MV 204,v,44,v,76
MV 184,v,40,v,72
MV 200,v,44,v,72
MV 180,v,40,v,68
MV 196,v,44,v,68
MV 176,v,40,v,64
TR 40,222,0
TR 42,222,1024
MV 192,v,44,v,64
TR 44,223,0
TR 46,223,1024
s_waitcnt lgkmcnt(4)
MV 80,v,16,v,48
buffer_load_dword v237, v233, s[8:11], 0 offen offset:0 sc1
MV 96,v,20,v,48
ds_read_b128 v[64:67], v227 offset:0
MV 84,v,16,v,52
s_lshr_b32 s36, s2, 3
MV 100,v,20,v,52
MV 88,v,16,v,56
MV 104,v,20,v,56
s_lshl_b32 s36, s36, 18
MV 92,v,16,v,60
TR 16,216,8192
TR 18,216,9216
MV 108,v,20,v,60
TR 20,217,8192
TR 22,217,9216
MV 124,v,24,v,60
ds_read_b128 v[68:71], v227 offset:2048
s_and_b32 s37, s2, 7
MV 140,v,28,v,60
MV 120,v,24,v,56
s_lshl_b32 s37, s37, 8
MV 136,v,28,v,56
MV 116,v,24,v,52
ds_read_b128 v[72:75], v227 offset:4096
s_add_u32 s36, s36, s37
MV 132,v,28,v,52
MV 112,v,24,v,48
TR 24,218,8192
TR 26,218,9216
MV 128,v,28,v,48
TR 28,219,8192
TR 30,219,9216
MV 144,v,32,v,48
s_lshl_b32 s37, s3, 16
MV 160,v,36,v,48
s_add_u32 s36, s36, s37
MV 148,v,32,v,52
ds_read_b128 v[76:79], v227 offset:6144
MV 164,v,36,v,52
MV 152,v,32,v,56
s_add_u32 s32, s32, s36
s_addc_u32 s33, s33, 0
MV 168,v,36,v,56
MV 156,v,32,v,60
TR 32,220,8192
TR 34,220,9216
MV 172,v,36,v,60
TR 36,221,8192
TR 38,221,9216
s_waitcnt lgkmcnt(15)
MV 188,v,40,v,60
MV 204,v,44,v,60
s_mov_b32 s34, 65536
MV 184,v,40,v,56
MV 200,v,44,v,56
s_mov_b32 s35, 0x20000
MV 180,v,40,v,52
MV 196,v,44,v,52
MV 176,v,40,v,48
TR 40,222,8192
TR 42,222,9216
MV 192,v,44,v,48
TR 44,223,8192
TR 46,223,9216
s_waitcnt lgkmcnt(4)
MV 80,v,16,v,64
MV 96,v,20,v,64
MV 84,v,16,v,68
MV 100,v,20,v,68
MV 88,v,16,v,72
MV 104,v,20,v,72
MV 92,v,16,v,76
MV 108,v,20,v,76
MV 124,v,24,v,76
MV 140,v,28,v,76
MV 120,v,24,v,72
MV 136,v,28,v,72
MV 116,v,24,v,68
MV 132,v,28,v,68
MV 112,v,24,v,64
MV 128,v,28,v,64
MV 144,v,32,v,64
MV 160,v,36,v,64
MV 148,v,32,v,68
MV 164,v,36,v,68
MV 152,v,32,v,72
MV 168,v,36,v,72
MV 156,v,32,v,76
MV 172,v,36,v,76
s_waitcnt lgkmcnt(2)
MV 188,v,40,v,76
s_waitcnt lgkmcnt(0)
MV 204,v,44,v,76
MV 184,v,40,v,72
MV 200,v,44,v,72
MV 180,v,40,v,68
MV 196,v,44,v,68
MV 176,v,40,v,64
MV 192,v,44,v,64
s_waitcnt vmcnt(0)
v_cmp_gt_u32 vcc, 1, v237
s_nop 4
s_cbranch_vccnz L_spin_f1
L_spin_f1_ret:
L_p3_begin:
s_waitcnt lgkmcnt(0)
s_barrier
s_add_u32 m0, s68, 16384
s_mov_b32 s80, 0
buffer_load_dwordx4 v12, s[52:55], s80 offen offset:0 sc1 lds
buffer_load_dwordx4 v12, s[52:55], s80 offen offset:1024 sc1 lds
buffer_load_dwordx4 v12, s[52:55], s80 offen offset:2048 sc1 lds
buffer_load_dwordx4 v12, s[52:55], s80 offen offset:3072 sc1 lds
s_mov_b32 s82, 0x3e0293ee
s_mov_b32 s83, 0x3e0293ee
v_pk_mul_f32 v[80:81], v[80:81], s[82:83]
v_pk_mul_f32 v[82:83], v[82:83], s[82:83]
v_pk_mul_f32 v[84:85], v[84:85], s[82:83]
v_pk_mul_f32 v[86:87], v[86:87], s[82:83]
v_pk_mul_f32 v[88:89], v[88:89], s[82:83]
v_pk_mul_f32 v[90:91], v[90:91], s[82:83]
v_pk_mul_f32 v[92:93], v[92:93], s[82:83]
v_pk_mul_f32 v[94:95], v[94:95], s[82:83]
s_add_u32 m0, s68, 32768
v_pk_mul_f32 v[96:97], v[96:97], s[82:83]
v_pk_mul_f32 v[98:99], v[98:99], s[82:83]
v_pk_mul_f32 v[100:101], v[100:101], s[82:83]
v_pk_mul_f32 v[102:103], v[102:103], s[82:83]
v_pk_mul_f32 v[104:105], v[104:105], s[82:83]
v_pk_mul_f32 v[106:107], v[106:107], s[82:83]
v_pk_mul_f32 v[108:109], v[108:109], s[82:83]
v_pk_mul_f32 v[110:111], v[110:111], s[82:83]
v_cvt_pk_bf16_f32 v16, v80, v81
v_cvt_pk_bf16_f32 v17, v82, v83
v_cvt_pk_bf16_f32 v18, v96, v97
s_mov_b32 s80, 16384
v_cvt_pk_bf16_f32 v19, v98, v99
v_cvt_pk_bf16_f32 v32, v84, v85
v_cvt_pk_bf16_f32 v33, v86, v87
v_cvt_pk_bf16_f32 v34, v100, v101
v_cvt_pk_bf16_f32 v35, v102, v103
v_cvt_pk_bf16_f32 v48, v88, v89
v_cvt_pk_bf16_f32 v49, v90, v91
v_cvt_pk_bf16_f32 v50, v104, v105
v_cvt_pk_bf16_f32 v51, v106, v107
v_cvt_pk_bf16_f32 v64, v92, v93
v_cvt_pk_bf16_f32 v65, v94, v95
buffer_load_dwordx4 v12, s[52:55], s80 offen offset:0 sc1 lds
v_cvt_pk_bf16_f32 v66, v108, v109
v_cvt_pk_bf16_f32 v67, v110, v111
v_pk_mul_f32 v[112:113], v[112:113], s[82:83]
v_pk_mul_f32 v[114:115], v[114:115], s[82:83]
v_pk_mul_f32 v[116:117], v[116:117], s[82:83]
v_pk_mul_f32 v[118:119], v[118:119], s[82:83]
v_pk_mul_f32 v[120:121], v[120:121], s[82:83]
v_pk_mul_f32 v[122:123], v[122:123], s[82:83]
v_pk_mul_f32 v[124:125], v[124:125], s[82:83]
v_pk_mul_f32 v[126:127], v[126:127], s[82:83]
v_pk_mul_f32 v[128:129], v[128:129], s[82:83]
buffer_load_dwordx4 v12, s[52:55], s80 offen offset:1024 sc1 lds
v_pk_mul_f32 v[130:131], v[130:131], s[82:83]
v_pk_mul_f32 v[132:133], v[132:133], s[82:83]
v_pk_mul_f32 v[134:135], v[134:135], s[82:83]
v_pk_mul_f32 v[136:137], v[136:137], s[82:83]
v_pk_mul_f32 v[138:139], v[138:139], s[82:83]
v_pk_mul_f32 v[140:141], v[140:141], s[82:83]
v_pk_mul_f32 v[142:143], v[142:143], s[82:83]
v_cvt_pk_bf16_f32 v20, v112, v113
v_cvt_pk_bf16_f32 v21, v114, v115
v_cvt_pk_bf16_f32 v22, v128, v129
v_cvt_pk_bf16_f32 v23, v130, v131
buffer_load_dwordx4 v12, s[52:55], s80 offen offset:2048 sc1 lds
v_cvt_pk_bf16_f32 v36, v116, v117
v_cvt_pk_bf16_f32 v37, v118, v119
v_cvt_pk_bf16_f32 v38, v132, v133
v_cvt_pk_bf16_f32 v39, v134, v135
v_cvt_pk_bf16_f32 v52, v120, v121
v_cvt_pk_bf16_f32 v53, v122, v123
v_cvt_pk_bf16_f32 v54, v136, v137
v_cvt_pk_bf16_f32 v55, v138, v139
v_cvt_pk_bf16_f32 v68, v124, v125
v_cvt_pk_bf16_f32 v69, v126, v127
v_cvt_pk_bf16_f32 v70, v140, v141
buffer_load_dwordx4 v12, s[52:55], s80 offen offset:3072 sc1 lds
v_cvt_pk_bf16_f32 v71, v142, v143
v_pk_mul_f32 v[144:145], v[144:145], s[82:83]
v_pk_mul_f32 v[146:147], v[146:147], s[82:83]
v_pk_mul_f32 v[148:149], v[148:149], s[82:83]
v_pk_mul_f32 v[150:151], v[150:151], s[82:83]
v_pk_mul_f32 v[152:153], v[152:153], s[82:83]
v_pk_mul_f32 v[154:155], v[154:155], s[82:83]
v_pk_mul_f32 v[156:157], v[156:157], s[82:83]
v_pk_mul_f32 v[158:159], v[158:159], s[82:83]
v_pk_mul_f32 v[160:161], v[160:161], s[82:83]
v_pk_mul_f32 v[162:163], v[162:163], s[82:83]
s_add_u32 m0, s68, 81920
v_pk_mul_f32 v[164:165], v[164:165], s[82:83]
v_pk_mul_f32 v[166:167], v[166:167], s[82:83]
v_pk_mul_f32 v[168:169], v[168:169], s[82:83]
v_pk_mul_f32 v[170:171], v[170:171], s[82:83]
v_pk_mul_f32 v[172:173], v[172:173], s[82:83]
v_pk_mul_f32 v[174:175], v[174:175], s[82:83]
v_cvt_pk_bf16_f32 v24, v144, v145
v_cvt_pk_bf16_f32 v25, v146, v147
v_cvt_pk_bf16_f32 v26, v160, v161
v_cvt_pk_bf16_f32 v27, v162, v163
v_cvt_pk_bf16_f32 v40, v148, v149
s_mov_b32 s80, 16384
v_cvt_pk_bf16_f32 v41, v150, v151
v_cvt_pk_bf16_f32 v42, v164, v165
v_cvt_pk_bf16_f32 v43, v166, v167
v_cvt_pk_bf16_f32 v56, v152, v153
v_cvt_pk_bf16_f32 v57, v154, v155
v_cvt_pk_bf16_f32 v58, v168, v169
v_cvt_pk_bf16_f32 v59, v170, v171
v_cvt_pk_bf16_f32 v72, v156, v157
v_cvt_pk_bf16_f32 v73, v158, v159
v_cvt_pk_bf16_f32 v74, v172, v173
v_cvt_pk_bf16_f32 v75, v174, v175
buffer_load_dwordx4 v12, s[56:59], s80 offen offset:0 sc1 lds
v_pk_mul_f32 v[176:177], v[176:177], s[82:83]
v_pk_mul_f32 v[178:179], v[178:179], s[82:83]
v_pk_mul_f32 v[180:181], v[180:181], s[82:83]
v_pk_mul_f32 v[182:183], v[182:183], s[82:83]
v_pk_mul_f32 v[184:185], v[184:185], s[82:83]
v_pk_mul_f32 v[186:187], v[186:187], s[82:83]
v_pk_mul_f32 v[188:189], v[188:189], s[82:83]
v_pk_mul_f32 v[190:191], v[190:191], s[82:83]
v_pk_mul_f32 v[192:193], v[192:193], s[82:83]
v_pk_mul_f32 v[194:195], v[194:195], s[82:83]
v_pk_mul_f32 v[196:197], v[196:197], s[82:83]
buffer_load_dwordx4 v12, s[56:59], s80 offen offset:1024 sc1 lds
v_pk_mul_f32 v[198:199], v[198:199], s[82:83]
v_pk_mul_f32 v[200:201], v[200:201], s[82:83]
v_pk_mul_f32 v[202:203], v[202:203], s[82:83]
v_pk_mul_f32 v[204:205], v[204:205], s[82:83]
v_pk_mul_f32 v[206:207], v[206:207], s[82:83]
v_cvt_pk_bf16_f32 v28, v176, v177
v_cvt_pk_bf16_f32 v29, v178, v179
v_cvt_pk_bf16_f32 v30, v192, v193
v_cvt_pk_bf16_f32 v31, v194, v195
v_cvt_pk_bf16_f32 v44, v180, v181
v_cvt_pk_bf16_f32 v45, v182, v183
buffer_load_dwordx4 v12, s[56:59], s80 offen offset:2048 sc1 lds
v_cvt_pk_bf16_f32 v46, v196, v197
v_cvt_pk_bf16_f32 v47, v198, v199
v_cvt_pk_bf16_f32 v60, v184, v185
v_cvt_pk_bf16_f32 v61, v186, v187
v_cvt_pk_bf16_f32 v62, v200, v201
v_cvt_pk_bf16_f32 v63, v202, v203
v_cvt_pk_bf16_f32 v76, v188, v189
v_cvt_pk_bf16_f32 v77, v190, v191
v_cvt_pk_bf16_f32 v78, v204, v205
v_cvt_pk_bf16_f32 v79, v206, v207
v_mov_b32 v2, 0
buffer_load_dwordx4 v12, s[56:59], s80 offen offset:3072 sc1 lds
v_mov_b32 v3, 0
v_mov_b32 v4, 0
v_mov_b32 v5, 0
v_accvgpr_write_b32 a0, 0
v_accvgpr_write_b32 a1, 0
v_accvgpr_write_b32 a2, 0
v_accvgpr_write_b32 a3, 0
v_accvgpr_write_b32 a4, 0
v_accvgpr_write_b32 a5, 0
v_accvgpr_write_b32 a6, 0
v_accvgpr_write_b32 a7, 0
s_add_u32 m0, s68, 49152
v_accvgpr_write_b32 a8, 0
v_accvgpr_write_b32 a9, 0
v_accvgpr_write_b32 a10, 0
v_accvgpr_write_b32 a11, 0
v_accvgpr_write_b32 a12, 0
v_accvgpr_write_b32 a13, 0
v_accvgpr_write_b32 a14, 0
v_accvgpr_write_b32 a15, 0
v_accvgpr_write_b32 a16, 0
v_accvgpr_write_b32 a17, 0
v_accvgpr_write_b32 a18, 0
s_mov_b32 s80, 32768
v_accvgpr_write_b32 a19, 0
v_accvgpr_write_b32 a20, 0
v_accvgpr_write_b32 a21, 0
v_accvgpr_write_b32 a22, 0
v_accvgpr_write_b32 a23, 0
v_accvgpr_write_b32 a24, 0
v_accvgpr_write_b32 a25, 0
v_accvgpr_write_b32 a26, 0
v_accvgpr_write_b32 a27, 0
v_accvgpr_write_b32 a28, 0
v_accvgpr_write_b32 a29, 0
buffer_load_dwordx4 v12, s[52:55], s80 offen offset:0 sc1 lds
v_accvgpr_write_b32 a30, 0
v_accvgpr_write_b32 a31, 0
v_accvgpr_write_b32 a32, 0
v_accvgpr_write_b32 a33, 0
v_accvgpr_write_b32 a34, 0
v_accvgpr_write_b32 a35, 0
v_accvgpr_write_b32 a36, 0
v_accvgpr_write_b32 a37, 0
v_accvgpr_write_b32 a38, 0
v_accvgpr_write_b32 a39, 0
v_accvgpr_write_b32 a40, 0
buffer_load_dwordx4 v12, s[52:55], s80 offen offset:1024 sc1 lds
v_accvgpr_write_b32 a41, 0
v_accvgpr_write_b32 a42, 0
v_accvgpr_write_b32 a43, 0
v_accvgpr_write_b32 a44, 0
v_accvgpr_write_b32 a45, 0
v_accvgpr_write_b32 a46, 0
v_accvgpr_write_b32 a47, 0
v_accvgpr_write_b32 a48, 0
v_accvgpr_write_b32 a49, 0
v_accvgpr_write_b32 a50, 0
v_accvgpr_write_b32 a51, 0
buffer_load_dwordx4 v12, s[52:55], s80 offen offset:2048 sc1 lds
v_accvgpr_write_b32 a52, 0
v_accvgpr_write_b32 a53, 0
v_accvgpr_write_b32 a54, 0
v_accvgpr_write_b32 a55, 0
v_accvgpr_write_b32 a56, 0
v_accvgpr_write_b32 a57, 0
v_accvgpr_write_b32 a58, 0
v_accvgpr_write_b32 a59, 0
v_accvgpr_write_b32 a60, 0
v_accvgpr_write_b32 a61, 0
v_accvgpr_write_b32 a62, 0
buffer_load_dwordx4 v12, s[52:55], s80 offen offset:3072 sc1 lds
v_accvgpr_write_b32 a63, 0
v_accvgpr_write_b32 a64, 0
v_accvgpr_write_b32 a65, 0
v_accvgpr_write_b32 a66, 0
v_accvgpr_write_b32 a67, 0
v_accvgpr_write_b32 a68, 0
v_accvgpr_write_b32 a69, 0
v_accvgpr_write_b32 a70, 0
v_accvgpr_write_b32 a71, 0
v_accvgpr_write_b32 a72, 0
v_accvgpr_write_b32 a73, 0
s_add_u32 m0, s68, 98304
v_accvgpr_write_b32 a74, 0
v_accvgpr_write_b32 a75, 0
v_accvgpr_write_b32 a76, 0
v_accvgpr_write_b32 a77, 0
v_accvgpr_write_b32 a78, 0
v_accvgpr_write_b32 a79, 0
v_accvgpr_write_b32 a80, 0
v_accvgpr_write_b32 a81, 0
v_accvgpr_write_b32 a82, 0
v_accvgpr_write_b32 a83, 0
v_accvgpr_write_b32 a84, 0
s_mov_b32 s80, 32768
v_accvgpr_write_b32 a85, 0
v_accvgpr_write_b32 a86, 0
v_accvgpr_write_b32 a87, 0
v_accvgpr_write_b32 a88, 0
v_accvgpr_write_b32 a89, 0
v_accvgpr_write_b32 a90, 0
v_accvgpr_write_b32 a91, 0
v_accvgpr_write_b32 a92, 0
v_accvgpr_write_b32 a93, 0
v_accvgpr_write_b32 a94, 0
v_accvgpr_write_b32 a95, 0
buffer_load_dwordx4 v12, s[56:59], s80 offen offset:0 sc1 lds
v_accvgpr_write_b32 a96, 0
v_accvgpr_write_b32 a97, 0
v_accvgpr_write_b32 a98, 0
v_accvgpr_write_b32 a99, 0
v_accvgpr_write_b32 a100, 0
v_accvgpr_write_b32 a101, 0
v_accvgpr_write_b32 a102, 0
v_accvgpr_write_b32 a103, 0
v_accvgpr_write_b32 a104, 0
v_accvgpr_write_b32 a105, 0
v_accvgpr_write_b32 a106, 0
buffer_load_dwordx4 v12, s[56:59], s80 offen offset:1024 sc1 lds
v_accvgpr_write_b32 a107, 0
v_accvgpr_write_b32 a108, 0
v_accvgpr_write_b32 a109, 0
v_accvgpr_write_b32 a110, 0
v_accvgpr_write_b32 a111, 0
v_accvgpr_write_b32 a112, 0
v_accvgpr_write_b32 a113, 0
v_accvgpr_write_b32 a114, 0
v_accvgpr_write_b32 a115, 0
v_accvgpr_write_b32 a116, 0
v_accvgpr_write_b32 a117, 0
buffer_load_dwordx4 v12, s[56:59], s80 offen offset:2048 sc1 lds
v_accvgpr_write_b32 a118, 0
v_accvgpr_write_b32 a119, 0
v_accvgpr_write_b32 a120, 0
v_accvgpr_write_b32 a121, 0
v_accvgpr_write_b32 a122, 0
v_accvgpr_write_b32 a123, 0
v_accvgpr_write_b32 a124, 0
v_accvgpr_write_b32 a125, 0
v_accvgpr_write_b32 a126, 0
v_accvgpr_write_b32 a127, 0
v_xor_b32 v244, 0x8000, v10
buffer_load_dwordx4 v12, s[56:59], s80 offen offset:3072 sc1 lds
s_waitcnt vmcnt(16)
s_barrier
ds_read_b128 a[128:131], v244 offset:16384
ds_read_b128 a[132:135], v244 offset:17408
ds_read_b128 a[136:139], v244 offset:18432
ds_read_b128 a[140:143], v244 offset:19456
ds_read_b128 a[144:147], v244 offset:20480
ds_read_b128 a[148:151], v244 offset:21504
ds_read_b128 a[152:155], v244 offset:22528
ds_read_b128 a[156:159], v244 offset:23552
ds_read_b128 a[160:163], v244 offset:24576
ds_read_b128 a[164:167], v244 offset:25600
ds_read_b128 a[168:171], v244 offset:26624
ds_read_b128 a[172:175], v244 offset:27648
ds_read_b128 a[176:179], v244 offset:28672
ds_read_b128 a[180:183], v244 offset:29696
ds_read_b128 a[184:187], v244 offset:30720
ds_read_b128 a[188:191], v244 offset:31744
s_waitcnt lgkmcnt(15)
v_mfma_f32_16x16x32_bf16 v[80:83], a[128:131], v[16:19], 0
s_add_u32 m0, s68, 0
v_mfma_f32_16x16x32_bf16 v[88:91], a[128:131], v[32:35], 0
s_mov_b32 s80, 49152
v_mfma_f32_16x16x32_bf16 v[96:99], a[128:131], v[48:51], 0
v_mfma_f32_16x16x32_bf16 v[104:107], a[128:131], v[64:67], 0
buffer_load_dwordx4 v12, s[52:55], s80 offen offset:0 sc1 lds
s_waitcnt lgkmcnt(14)
MV 80,a,132,v,20
MV 88,a,132,v,36
buffer_load_dwordx4 v12, s[52:55], s80 offen offset:1024 sc1 lds
MV 96,a,132,v,52
MV 104,a,132,v,68
buffer_load_dwordx4 v12, s[52:55], s80 offen offset:2048 sc1 lds
s_waitcnt lgkmcnt(13)
MV 80,a,136,v,24
MV 88,a,136,v,40
buffer_load_dwordx4 v12, s[52:55], s80 offen offset:3072 sc1 lds
MV 96,a,136,v,56
MV 104,a,136,v,72
s_add_u32 m0, s68, 114688
s_waitcnt lgkmcnt(12)
MV 80,a,140,v,28
s_mov_b32 s80, 49152
MV 88,a,140,v,44
MV 96,a,140,v,60
buffer_load_dwordx4 v12, s[56:59], s80 offen offset:0 sc1 lds
MV 104,a,140,v,76
s_waitcnt lgkmcnt(11)
v_mfma_f32_16x16x32_bf16 v[84:87], a[144:147], v[16:19], 0
buffer_load_dwordx4 v12, s[56:59], s80 offen offset:1024 sc1 lds
v_mfma_f32_16x16x32_bf16 v[92:95], a[144:147], v[32:35], 0
v_mfma_f32_16x16x32_bf16 v[100:103], a[144:147], v[48:51], 0
buffer_load_dwordx4 v12, s[56:59], s80 offen offset:2048 sc1 lds
v_mfma_f32_16x16x32_bf16 v[108:111], a[144:147], v[64:67], 0
s_waitcnt lgkmcnt(10)
MV 84,a,148,v,20
buffer_load_dwordx4 v12, s[56:59], s80 offen offset:3072 sc1 lds
MV 92,a,148,v,36
MV 100,a,148,v,52
MV 108,a,148,v,68
s_waitcnt lgkmcnt(9)
MV 84,a,152,v,24
s_waitcnt vmcnt(16) lgkmcnt(0)
s_barrier
MV 92,a,152,v,40
ds_read_b128 a[128:131], v10 offset:0
s_add_u32 m0, s68, 16384
MV 100,a,152,v,56
ds_read_b128 a[132:135], v10 offset:1024
s_mov_b32 s80, 65536
MV 108,a,152,v,72
ds_read_b128 a[136:139], v10 offset:2048
buffer_load_dwordx4 v12, s[52:55], s80 offen offset:0 sc1 lds
MV 84,a,156,v,28
ds_read_b128 a[140:143], v10 offset:3072
buffer_load_dwordx4 v12, s[52:55], s80 offen offset:1024 sc1 lds
MV 92,a,156,v,44
ds_read_b128 a[144:147], v10 offset:4096
buffer_load_dwordx4 v12, s[52:55], s80 offen offset:2048 sc1 lds
MV 100,a,156,v,60
ds_read_b128 a[148:151], v10 offset:5120
buffer_load_dwordx4 v12, s[52:55], s80 offen offset:3072 sc1 lds
MV 108,a,156,v,76
ds_read_b128 a[152:155], v10 offset:6144
s_mov_b32 s71, 65536
v_mfma_f32_16x16x32_bf16 v[112:115], a[160:163], v[16:19], 0
ds_read_b128 a[156:159], v10 offset:7168
v_mfma_f32_16x16x32_bf16 v[120:123], a[160:163], v[32:35], 0
v_lshrrev_b32 v245, 4, v1
v_mfma_f32_16x16x32_bf16 v[128:131], a[160:163], v[48:51], 0
v_and_b32 v246, 15, v1
v_mfma_f32_16x16x32_bf16 v[136:139], a[160:163], v[64:67], 0
ds_read_b128 a[160:163], v10 offset:8192
v_lshlrev_b32 v247, 1, v245
MV 112,a,164,v,20
v_xor_b32 v246, v246, v247
MV 120,a,164,v,36
v_lshlrev_b32 v245, 11, v245
MV 128,a,164,v,52
v_lshl_add_u32 v245, v246, 4, v245
MV 136,a,164,v,68
ds_read_b128 a[164:167], v10 offset:9216
v_xor_b32 v246, 128, v245
MV 112,a,168,v,24
MV 120,a,168,v,40
s_lshl_b32 s36, s3, 13
MV 128,a,168,v,56
s_add_u32 m0, s36, 131072
MV 136,a,168,v,72
ds_read_b128 a[168:171], v10 offset:10240
s_mov_b32 s37, 0
MV 112,a,172,v,28
buffer_load_dwordx4 v245, s[32:35], s37 offen offset:0 lds
MV 120,a,172,v,44
s_mov_b32 s37, 7168
MV 128,a,172,v,60
buffer_load_dwordx4 v246, s[32:35], s37 offen offset:1024 lds
MV 136,a,172,v,76
ds_read_b128 a[172:175], v10 offset:11264
v_mfma_f32_16x16x32_bf16 v[116:119], a[176:179], v[16:19], 0
s_mov_b32 s37, 14336
v_mfma_f32_16x16x32_bf16 v[124:127], a[176:179], v[32:35], 0
buffer_load_dwordx4 v245, s[32:35], s37 offen offset:2048 lds
v_mfma_f32_16x16x32_bf16 v[132:135], a[176:179], v[48:51], 0
s_mov_b32 s37, 21504
v_mfma_f32_16x16x32_bf16 v[140:143], a[176:179], v[64:67], 0
ds_read_b128 a[176:179], v10 offset:12288
buffer_load_dwordx4 v246, s[32:35], s37 offen offset:3072 lds
MV 116,a,180,v,20
s_add_u32 m0, s36, 135168
MV 124,a,180,v,36
s_mov_b32 s37, 32768
MV 132,a,180,v,52
buffer_load_dwordx4 v245, s[32:35], s37 offen offset:0 lds
MV 140,a,180,v,68
ds_read_b128 a[180:183], v10 offset:13312
MV 116,a,184,v,24
s_mov_b32 s37, 39936
MV 124,a,184,v,40
buffer_load_dwordx4 v246, s[32:35], s37 offen offset:1024 lds
MV 132,a,184,v,56
s_mov_b32 s37, 47104
MV 140,a,184,v,72
ds_read_b128 a[184:187], v10 offset:14336
buffer_load_dwordx4 v245, s[32:35], s37 offen offset:2048 lds
MV 116,a,188,v,28
s_mov_b32 s37, 54272
MV 124,a,188,v,44
buffer_load_dwordx4 v246, s[32:35], s37 offen offset:3072 lds
MV 132,a,188,v,60
MV 140,a,188,v,76
ds_read_b128 a[188:191], v10 offset:15360
s_cmp_eq_u32 s70, 0
s_cbranch_scc1 L_p3_pmask
L_p3_pmask_ret:
v_exp_f32 v80, v80
v_exp_f32 v81, v81
v_exp_f32 v82, v82
v_add_f32 v2, v2, v80
v_add_f32 v2, v2, v81
v_exp_f32 v83, v83
v_cvt_pk_bf16_f32 v80, v80, v81
v_exp_f32 v84, v84
v_add_f32 v2, v2, v82
v_add_f32 v2, v2, v83
v_exp_f32 v85, v85
v_cvt_pk_bf16_f32 v81, v82, v83
v_exp_f32 v86, v86
v_add_f32 v2, v2, v84
v_add_f32 v2, v2, v85
v_exp_f32 v87, v87
v_cvt_pk_bf16_f32 v82, v84, v85
v_exp_f32 v88, v88
v_add_f32 v2, v2, v86
v_add_f32 v2, v2, v87
v_exp_f32 v89, v89
v_cvt_pk_bf16_f32 v83, v86, v87
v_exp_f32 v90, v90
v_add_f32 v3, v3, v88
v_add_f32 v3, v3, v89
v_exp_f32 v91, v91
v_cvt_pk_bf16_f32 v88, v88, v89
v_exp_f32 v92, v92
v_add_f32 v3, v3, v90
v_add_f32 v3, v3, v91
v_exp_f32 v93, v93
v_cvt_pk_bf16_f32 v89, v90, v91
v_exp_f32 v94, v94
v_add_f32 v3, v3, v92
v_add_f32 v3, v3, v93
v_exp_f32 v95, v95
v_cvt_pk_bf16_f32 v90, v92, v93
v_exp_f32 v96, v96
v_add_f32 v3, v3, v94
v_add_f32 v3, v3, v95
v_exp_f32 v97, v97
v_cvt_pk_bf16_f32 v91, v94, v95
v_exp_f32 v98, v98
v_add_f32 v4, v4, v96
v_add_f32 v4, v4, v97
v_exp_f32 v99, v99
v_cvt_pk_bf16_f32 v96, v96, v97
v_exp_f32 v100, v100
v_add_f32 v4, v4, v98
v_add_f32 v4, v4, v99
v_exp_f32 v101, v101
v_cvt_pk_bf16_f32 v97, v98, v99
v_exp_f32 v102, v102
v_add_f32 v4, v4, v100
v_add_f32 v4, v4, v101
v_exp_f32 v103, v103
v_cvt_pk_bf16_f32 v98, v100, v101
v_exp_f32 v104, v104
v_add_f32 v4, v4, v102
v_add_f32 v4, v4, v103
v_exp_f32 v105, v105
v_cvt_pk_bf16_f32 v99, v102, v103
v_exp_f32 v106, v106
v_add_f32 v5, v5, v104
v_add_f32 v5, v5, v105
v_exp_f32 v107, v107
v_cvt_pk_bf16_f32 v104, v104, v105
v_exp_f32 v108, v108
v_add_f32 v5, v5, v106
v_add_f32 v5, v5, v107
v_exp_f32 v109, v109
v_cvt_pk_bf16_f32 v105, v106, v107
v_exp_f32 v110, v110
v_add_f32 v5, v5, v108
v_add_f32 v5, v5, v109
v_exp_f32 v111, v111
v_cvt_pk_bf16_f32 v106, v108, v109
v_add_f32 v5, v5, v110
v_add_f32 v5, v5, v111
v_cvt_pk_bf16_f32 v107, v110, v111
s_sub_u32 s74, s70, 1
s_cbranch_scc1 L_p3_d0m_top
.p2align 5
L_p3_d0_top:
s_waitcnt lgkmcnt(0)
v_mfma_f32_16x16x32_bf16 v[144:147], a[128:131], v[16:19], 0
s_add_u32 m0, s73, 0
ds_read_b128 a[192:195], v11 offset:16384
v_mfma_f32_16x16x32_bf16 v[152:155], a[128:131], v[32:35], 0
v_exp_f32 v112, v112
v_mfma_f32_16x16x32_bf16 v[148:151], a[144:147], v[16:19], 0
ds_read_b128 a[196:199], v11 offset:17408
buffer_load_dwordx4 v12, s[56:59], s71 offen offset:0 sc1 lds
v_mfma_f32_16x16x32_bf16 v[156:159], a[144:147], v[32:35], 0
v_exp_f32 v113, v113
v_mfma_f32_16x16x32_bf16 v[176:179], a[160:163], v[16:19], 0
v_exp_f32 v114, v114
v_mfma_f32_16x16x32_bf16 v[184:187], a[160:163], v[32:35], 0
v_add_f32 v2, v2, v112
v_add_f32 v2, v2, v113
v_mfma_f32_16x16x32_bf16 v[180:183], a[176:179], v[16:19], 0
v_exp_f32 v115, v115
v_mfma_f32_16x16x32_bf16 v[188:191], a[176:179], v[32:35], 0
ds_read_b128 a[200:203], v11 offset:18432
v_cvt_pk_bf16_f32 v112, v112, v113
v_mfma_f32_16x16x32_bf16 v[196:199], a[176:179], v[48:51], 0
v_exp_f32 v116, v116
v_mfma_f32_16x16x32_bf16 v[204:207], a[176:179], v[64:67], 0
v_add_f32 v2, v2, v114
v_add_f32 v2, v2, v115
v_mfma_f32_16x16x32_bf16 v[192:195], a[160:163], v[48:51], 0
v_exp_f32 v117, v117
v_mfma_f32_16x16x32_bf16 v[200:203], a[160:163], v[64:67], 0
ds_read_b128 a[204:207], v11 offset:19456
v_cvt_pk_bf16_f32 v113, v114, v115
v_mfma_f32_16x16x32_bf16 v[164:167], a[144:147], v[48:51], 0
v_exp_f32 v118, v118
v_mfma_f32_16x16x32_bf16 v[172:175], a[144:147], v[64:67], 0
ds_read_b128 a[208:211], v11 offset:20480
v_add_f32 v2, v2, v116
v_mfma_f32_16x16x32_bf16 v[160:163], a[128:131], v[48:51], 0
buffer_load_dwordx4 v12, s[56:59], s71 offen offset:1024 sc1 lds
v_add_f32 v2, v2, v117
v_mfma_f32_16x16x32_bf16 v[168:171], a[128:131], v[64:67], 0
v_exp_f32 v119, v119
MV 180,a,180,v,20
ds_read_b128 a[212:215], v11 offset:21504
v_cvt_pk_bf16_f32 v114, v116, v117
MV 188,a,180,v,36
v_exp_f32 v120, v120
MV 176,a,164,v,20
v_add_f32 v2, v2, v118
v_add_f32 v2, v2, v119
MV 184,a,164,v,36
v_exp_f32 v121, v121
MV 148,a,148,v,20
ds_read_b128 a[216:219], v11 offset:22528
v_cvt_pk_bf16_f32 v115, v118, v119
MV 156,a,148,v,36
v_exp_f32 v122, v122
MV 144,a,132,v,20
v_add_f32 v3, v3, v120
v_add_f32 v3, v3, v121
MV 152,a,132,v,36
v_exp_f32 v123, v123
MV 160,a,132,v,52
ds_read_b128 a[220:223], v11 offset:23552
v_cvt_pk_bf16_f32 v120, v120, v121
MV 168,a,132,v,68
v_exp_f32 v124, v124
MV 164,a,148,v,52
ds_read_b128 a[224:227], v11 offset:24576
v_add_f32 v3, v3, v122
MV 172,a,148,v,68
buffer_load_dwordx4 v12, s[56:59], s71 offen offset:2048 sc1 lds
v_add_f32 v3, v3, v123
MV 192,a,164,v,52
v_exp_f32 v125, v125
MV 200,a,164,v,68
ds_read_b128 a[228:231], v11 offset:25600
v_cvt_pk_bf16_f32 v121, v122, v123
MV 196,a,180,v,52
v_exp_f32 v126, v126
MV 204,a,180,v,68
v_add_f32 v3, v3, v124
v_add_f32 v3, v3, v125
MV 144,a,136,v,24
v_exp_f32 v127, v127
MV 152,a,136,v,40
ds_read_b128 a[232:235], v11 offset:26624
v_cvt_pk_bf16_f32 v122, v124, v125
MV 148,a,152,v,24
v_exp_f32 v128, v128
MV 156,a,152,v,40
v_add_f32 v3, v3, v126
v_add_f32 v3, v3, v127
MV 176,a,168,v,24
v_exp_f32 v129, v129
MV 184,a,168,v,40
ds_read_b128 a[236:239], v11 offset:27648
v_cvt_pk_bf16_f32 v123, v126, v127
MV 180,a,184,v,24
v_exp_f32 v130, v130
MV 188,a,184,v,40
ds_read_b128 a[240:243], v11 offset:28672
v_add_f32 v4, v4, v128
MV 196,a,184,v,56
buffer_load_dwordx4 v12, s[56:59], s71 offen offset:3072 sc1 lds
v_add_f32 v4, v4, v129
MV 204,a,184,v,72
v_exp_f32 v131, v131
MV 192,a,168,v,56
ds_read_b128 a[244:247], v11 offset:29696
v_cvt_pk_bf16_f32 v128, v128, v129
MV 200,a,168,v,72
v_exp_f32 v132, v132
MV 164,a,152,v,56
v_add_f32 v4, v4, v130
v_add_f32 v4, v4, v131
MV 172,a,152,v,72
v_exp_f32 v133, v133
MV 160,a,136,v,56
ds_read_b128 a[248:251], v11 offset:30720
v_cvt_pk_bf16_f32 v129, v130, v131
MV 168,a,136,v,72
v_exp_f32 v134, v134
MV 180,a,188,v,28
v_add_f32 v4, v4, v132
v_add_f32 v4, v4, v133
MV 188,a,188,v,44
v_exp_f32 v135, v135
MV 176,a,172,v,28
ds_read_b128 a[252:255], v11 offset:31744
v_cvt_pk_bf16_f32 v130, v132, v133
MV 184,a,172,v,44
v_exp_f32 v136, v136
MV 148,a,156,v,28
v_add_f32 v4, v4, v134
v_add_f32 v4, v4, v135
MV 156,a,156,v,44
v_exp_f32 v137, v137
MV 144,a,140,v,28
s_add_u32 s71, s71, 16384
v_cvt_pk_bf16_f32 v131, v134, v135
MV 152,a,140,v,44
v_exp_f32 v138, v138
MV 160,a,140,v,60
v_add_f32 v5, v5, v136
v_add_f32 v5, v5, v137
MV 168,a,140,v,76
v_exp_f32 v139, v139
MV 164,a,156,v,60
v_cvt_pk_bf16_f32 v136, v136, v137
MV 172,a,156,v,76
v_exp_f32 v140, v140
MV 192,a,172,v,60
v_add_f32 v5, v5, v138
v_add_f32 v5, v5, v139
MV 200,a,172,v,76
v_exp_f32 v141, v141
MV 196,a,188,v,60
v_cvt_pk_bf16_f32 v137, v138, v139
MV 204,a,188,v,76
v_exp_f32 v142, v142
v_add_f32 v5, v5, v140
v_add_f32 v5, v5, v141
v_exp_f32 v143, v143
v_cvt_pk_bf16_f32 v138, v140, v141
v_add_f32 v5, v5, v142
v_add_f32 v5, v5, v143
v_cvt_pk_bf16_f32 v139, v142, v143
s_waitcnt vmcnt(16) lgkmcnt(0)
MA 0,a,192,v,80
s_barrier
MA 32,a,192,v,88
s_add_u32 m0, s72, 0
ds_read_b128 a[128:131], v10 offset:16384
MA 4,a,196,v,80
ds_read_b128 a[132:135], v10 offset:17408
buffer_load_dwordx4 v12, s[52:55], s71 offen offset:0 sc1 lds
MA 36,a,196,v,88
v_exp_f32 v144, v144
MA 8,a,200,v,80
v_exp_f32 v145, v145
MA 40,a,200,v,88
v_exp_f32 v146, v146
MA 12,a,204,v,80
v_add_f32 v2, v2, v144
v_add_f32 v2, v2, v145
MA 44,a,204,v,88
ds_read_b128 a[136:139], v10 offset:18432
ds_read_b128 a[140:143], v10 offset:19456
MA 16,a,208,v,80
v_exp_f32 v147, v147
MA 48,a,208,v,88
ds_read_b128 a[144:147], v10 offset:20480
v_cvt_pk_bf16_f32 v144, v144, v145
MA 20,a,212,v,80
v_exp_f32 v148, v148
MA 52,a,212,v,88
v_add_f32 v2, v2, v146
v_add_f32 v2, v2, v147
MA 24,a,216,v,80
v_exp_f32 v149, v149
MA 56,a,216,v,88
buffer_load_dwordx4 v12, s[52:55], s71 offen offset:1024 sc1 lds
v_cvt_pk_bf16_f32 v145, v146, v147
MA 28,a,220,v,80
v_exp_f32 v150, v150
MA 60,a,220,v,88
v_add_f32 v2, v2, v148
v_add_f32 v2, v2, v149
MA 92,a,220,v,96
v_exp_f32 v151, v151
MA 124,a,220,v,104
ds_read_b128 a[148:151], v10 offset:21504
v_cvt_pk_bf16_f32 v146, v148, v149
MA 88,a,216,v,96
v_exp_f32 v152, v152
MA 120,a,216,v,104
v_add_f32 v2, v2, v150
v_add_f32 v2, v2, v151
MA 84,a,212,v,96
ds_read_b128 a[152:155], v10 offset:22528
ds_read_b128 a[156:159], v10 offset:23552
MA 116,a,212,v,104
v_exp_f32 v153, v153
MA 80,a,208,v,96
ds_read_b128 a[160:163], v10 offset:24576
v_cvt_pk_bf16_f32 v147, v150, v151
MA 112,a,208,v,104
v_exp_f32 v154, v154
MA 76,a,204,v,96
v_add_f32 v3, v3, v152
v_add_f32 v3, v3, v153
MA 108,a,204,v,104
v_exp_f32 v155, v155
MA 72,a,200,v,96
buffer_load_dwordx4 v12, s[52:55], s71 offen offset:2048 sc1 lds
v_cvt_pk_bf16_f32 v152, v152, v153
MA 104,a,200,v,104
v_exp_f32 v156, v156
MA 68,a,196,v,96
v_add_f32 v3, v3, v154
v_add_f32 v3, v3, v155
MA 100,a,196,v,104
v_exp_f32 v157, v157
MA 64,a,192,v,96
ds_read_b128 a[164:167], v10 offset:25600
v_cvt_pk_bf16_f32 v153, v154, v155
MA 96,a,192,v,104
v_exp_f32 v158, v158
MA 0,a,224,v,112
v_add_f32 v3, v3, v156
v_add_f32 v3, v3, v157
MA 32,a,224,v,120
v_exp_f32 v159, v159
MA 4,a,228,v,112
ds_read_b128 a[168:171], v10 offset:26624
v_cvt_pk_bf16_f32 v154, v156, v157
MA 36,a,228,v,120
v_exp_f32 v160, v160
MA 8,a,232,v,112
ds_read_b128 a[172:175], v10 offset:27648
v_add_f32 v3, v3, v158
MA 40,a,232,v,120
ds_read_b128 a[176:179], v10 offset:28672
v_add_f32 v3, v3, v159
MA 12,a,236,v,112
v_exp_f32 v161, v161
MA 44,a,236,v,120
ds_read_b128 a[180:183], v10 offset:29696
v_cvt_pk_bf16_f32 v155, v158, v159
MA 16,a,240,v,112
v_exp_f32 v162, v162
MA 48,a,240,v,120
v_add_f32 v4, v4, v160
v_add_f32 v4, v4, v161
MA 20,a,244,v,112
v_exp_f32 v163, v163
MA 52,a,244,v,120
buffer_load_dwordx4 v12, s[52:55], s71 offen offset:3072 sc1 lds
v_cvt_pk_bf16_f32 v160, v160, v161
MA 24,a,248,v,112
v_exp_f32 v164, v164
MA 56,a,248,v,120
v_add_f32 v4, v4, v162
v_add_f32 v4, v4, v163
MA 28,a,252,v,112
v_exp_f32 v165, v165
MA 60,a,252,v,120
ds_read_b128 a[184:187], v10 offset:30720
v_cvt_pk_bf16_f32 v161, v162, v163
MA 92,a,252,v,128
v_exp_f32 v166, v166
MA 124,a,252,v,136
v_add_f32 v4, v4, v164
v_add_f32 v4, v4, v165
MA 88,a,248,v,128
ds_read_b128 a[188:191], v10 offset:31744
s_sub_u32 s74, s74, 1
MA 120,a,248,v,136
v_exp_f32 v167, v167
MA 84,a,244,v,128
v_cvt_pk_bf16_f32 v162, v164, v165
MA 116,a,244,v,136
v_exp_f32 v168, v168
MA 80,a,240,v,128
v_add_f32 v4, v4, v166
v_add_f32 v4, v4, v167
MA 112,a,240,v,136
v_exp_f32 v169, v169
MA 76,a,236,v,128
v_cvt_pk_bf16_f32 v163, v166, v167
MA 108,a,236,v,136
v_exp_f32 v170, v170
MA 72,a,232,v,128
v_add_f32 v5, v5, v168
v_add_f32 v5, v5, v169
MA 104,a,232,v,136
v_exp_f32 v171, v171
MA 68,a,228,v,128
v_cvt_pk_bf16_f32 v168, v168, v169
MA 100,a,228,v,136
v_exp_f32 v172, v172
MA 64,a,224,v,128
v_add_f32 v5, v5, v170
v_add_f32 v5, v5, v171
MA 96,a,224,v,136
v_exp_f32 v173, v173
v_cvt_pk_bf16_f32 v169, v170, v171
v_exp_f32 v174, v174
v_add_f32 v5, v5, v172
v_add_f32 v5, v5, v173
v_exp_f32 v175, v175
v_cvt_pk_bf16_f32 v170, v172, v173
v_add_f32 v5, v5, v174
v_add_f32 v5, v5, v175
v_cvt_pk_bf16_f32 v171, v174, v175
s_cbranch_scc1 L_p3_d1m_top
s_waitcnt lgkmcnt(0)
v_xor_b32 v11, 0x8000, v11
v_mfma_f32_16x16x32_bf16 v[80:83], a[128:131], v[16:19], 0
s_add_u32 m0, s73, 16384
ds_read_b128 a[192:195], v11 offset:0
v_mfma_f32_16x16x32_bf16 v[88:91], a[128:131], v[32:35], 0
v_exp_f32 v176, v176
v_mfma_f32_16x16x32_bf16 v[84:87], a[144:147], v[16:19], 0
ds_read_b128 a[196:199], v11 offset:1024
buffer_load_dwordx4 v12, s[56:59], s71 offen offset:0 sc1 lds
v_mfma_f32_16x16x32_bf16 v[92:95], a[144:147], v[32:35], 0
v_exp_f32 v177, v177
v_mfma_f32_16x16x32_bf16 v[112:115], a[160:163], v[16:19], 0
v_exp_f32 v178, v178
v_mfma_f32_16x16x32_bf16 v[120:123], a[160:163], v[32:35], 0
v_add_f32 v2, v2, v176
v_add_f32 v2, v2, v177
v_mfma_f32_16x16x32_bf16 v[116:119], a[176:179], v[16:19], 0
v_exp_f32 v179, v179
v_mfma_f32_16x16x32_bf16 v[124:127], a[176:179], v[32:35], 0
ds_read_b128 a[200:203], v11 offset:2048
v_cvt_pk_bf16_f32 v176, v176, v177
v_mfma_f32_16x16x32_bf16 v[132:135], a[176:179], v[48:51], 0
v_exp_f32 v180, v180
v_mfma_f32_16x16x32_bf16 v[140:143], a[176:179], v[64:67], 0
v_add_f32 v2, v2, v178
v_add_f32 v2, v2, v179
v_mfma_f32_16x16x32_bf16 v[128:131], a[160:163], v[48:51], 0
v_exp_f32 v181, v181
v_mfma_f32_16x16x32_bf16 v[136:139], a[160:163], v[64:67], 0
ds_read_b128 a[204:207], v11 offset:3072
v_cvt_pk_bf16_f32 v177, v178, v179
v_mfma_f32_16x16x32_bf16 v[100:103], a[144:147], v[48:51], 0
v_exp_f32 v182, v182
v_mfma_f32_16x16x32_bf16 v[108:111], a[144:147], v[64:67], 0
buffer_load_dwordx4 v12, s[56:59], s71 offen offset:1024 sc1 lds
v_add_f32 v2, v2, v180
v_mfma_f32_16x16x32_bf16 v[96:99], a[128:131], v[48:51], 0
ds_read_b128 a[208:211], v11 offset:4096
v_add_f32 v2, v2, v181
v_mfma_f32_16x16x32_bf16 v[104:107], a[128:131], v[64:67], 0
v_exp_f32 v183, v183
MV 116,a,180,v,20
ds_read_b128 a[212:215], v11 offset:5120
v_cvt_pk_bf16_f32 v178, v180, v181
MV 124,a,180,v,36
v_exp_f32 v184, v184
MV 112,a,164,v,20
v_add_f32 v2, v2, v182
v_add_f32 v2, v2, v183
MV 120,a,164,v,36
v_exp_f32 v185, v185
MV 84,a,148,v,20
ds_read_b128 a[216:219], v11 offset:6144
v_cvt_pk_bf16_f32 v179, v182, v183
MV 92,a,148,v,36
v_exp_f32 v186, v186
MV 80,a,132,v,20
v_add_f32 v3, v3, v184
v_add_f32 v3, v3, v185
MV 88,a,132,v,36
v_exp_f32 v187, v187
MV 96,a,132,v,52
ds_read_b128 a[220:223], v11 offset:7168
v_cvt_pk_bf16_f32 v184, v184, v185
MV 104,a,132,v,68
ds_read_b128 a[224:227], v11 offset:8192
buffer_load_dwordx4 v12, s[56:59], s71 offen offset:2048 sc1 lds
MV 100,a,148,v,52
v_exp_f32 v188, v188
MV 108,a,148,v,68
v_add_f32 v3, v3, v186
v_add_f32 v3, v3, v187
MV 128,a,164,v,52
v_exp_f32 v189, v189
MV 136,a,164,v,68
ds_read_b128 a[228:231], v11 offset:9216
v_cvt_pk_bf16_f32 v185, v186, v187
MV 132,a,180,v,52
v_exp_f32 v190, v190
MV 140,a,180,v,68
v_add_f32 v3, v3, v188
v_add_f32 v3, v3, v189
MV 80,a,136,v,24
v_exp_f32 v191, v191
MV 88,a,136,v,40
ds_read_b128 a[232:235], v11 offset:10240
v_cvt_pk_bf16_f32 v186, v188, v189
MV 84,a,152,v,24
v_exp_f32 v192, v192
MV 92,a,152,v,40
buffer_load_dwordx4 v12, s[56:59], s71 offen offset:3072 sc1 lds
v_add_f32 v3, v3, v190
MV 112,a,168,v,24
ds_read_b128 a[236:239], v11 offset:11264
v_add_f32 v3, v3, v191
MV 120,a,168,v,40
v_exp_f32 v193, v193
MV 116,a,184,v,24
ds_read_b128 a[240:243], v11 offset:12288
v_cvt_pk_bf16_f32 v187, v190, v191
MV 124,a,184,v,40
v_exp_f32 v194, v194
MV 132,a,184,v,56
v_add_f32 v4, v4, v192
v_add_f32 v4, v4, v193
MV 140,a,184,v,72
v_exp_f32 v195, v195
MV 128,a,168,v,56
ds_read_b128 a[244:247], v11 offset:13312
v_cvt_pk_bf16_f32 v192, v192, v193
MV 136,a,168,v,72
v_exp_f32 v196, v196
MV 100,a,152,v,56
v_add_f32 v4, v4, v194
v_add_f32 v4, v4, v195
MV 108,a,152,v,72
v_exp_f32 v197, v197
MV 96,a,136,v,56
ds_read_b128 a[248:251], v11 offset:14336
v_cvt_pk_bf16_f32 v193, v194, v195
MV 104,a,136,v,72
v_exp_f32 v198, v198
MV 116,a,188,v,28
s_add_u32 s71, s71, 16384
v_add_f32 v4, v4, v196
MV 124,a,188,v,44
ds_read_b128 a[252:255], v11 offset:15360
v_add_f32 v4, v4, v197
MV 112,a,172,v,28
v_exp_f32 v199, v199
MV 120,a,172,v,44
s_xor_b32 s73, s73, 0x8000
v_cvt_pk_bf16_f32 v194, v196, v197
MV 84,a,156,v,28
v_exp_f32 v200, v200
MV 92,a,156,v,44
v_add_f32 v4, v4, v198
v_add_f32 v4, v4, v199
MV 80,a,140,v,28
v_exp_f32 v201, v201
MV 88,a,140,v,44
v_cvt_pk_bf16_f32 v195, v198, v199
MV 96,a,140,v,60
v_exp_f32 v202, v202
MV 104,a,140,v,76
v_add_f32 v5, v5, v200
v_add_f32 v5, v5, v201
MV 100,a,156,v,60
v_exp_f32 v203, v203
MV 108,a,156,v,76
v_cvt_pk_bf16_f32 v200, v200, v201
MV 128,a,172,v,60
v_exp_f32 v204, v204
MV 136,a,172,v,76
v_add_f32 v5, v5, v202
v_add_f32 v5, v5, v203
MV 132,a,188,v,60
v_exp_f32 v205, v205
MV 140,a,188,v,76
v_cvt_pk_bf16_f32 v201, v202, v203
v_exp_f32 v206, v206
v_add_f32 v5, v5, v204
v_add_f32 v5, v5, v205
v_exp_f32 v207, v207
v_cvt_pk_bf16_f32 v202, v204, v205
v_add_f32 v5, v5, v206
v_add_f32 v5, v5, v207
v_cvt_pk_bf16_f32 v203, v206, v207
s_waitcnt vmcnt(16) lgkmcnt(0)
MA 0,a,192,v,144
s_barrier
v_xor_b32 v10, 0x8000, v10
MA 32,a,192,v,152
s_add_u32 m0, s72, 16384
ds_read_b128 a[128:131], v10 offset:0
MA 4,a,196,v,144
ds_read_b128 a[132:135], v10 offset:1024
buffer_load_dwordx4 v12, s[52:55], s71 offen offset:0 sc1 lds
MA 36,a,196,v,152
v_exp_f32 v80, v80
MA 8,a,200,v,144
v_exp_f32 v81, v81
MA 40,a,200,v,152
v_exp_f32 v82, v82
MA 12,a,204,v,144
v_add_f32 v2, v2, v80
v_add_f32 v2, v2, v81
MA 44,a,204,v,152
ds_read_b128 a[136:139], v10 offset:2048
ds_read_b128 a[140:143], v10 offset:3072
MA 16,a,208,v,144
v_exp_f32 v83, v83
MA 48,a,208,v,152
ds_read_b128 a[144:147], v10 offset:4096
v_cvt_pk_bf16_f32 v80, v80, v81
MA 20,a,212,v,144
v_exp_f32 v84, v84
MA 52,a,212,v,152
v_add_f32 v2, v2, v82
v_add_f32 v2, v2, v83
MA 24,a,216,v,144
v_exp_f32 v85, v85
MA 56,a,216,v,152
buffer_load_dwordx4 v12, s[52:55], s71 offen offset:1024 sc1 lds
v_cvt_pk_bf16_f32 v81, v82, v83
MA 28,a,220,v,144
v_exp_f32 v86, v86
MA 60,a,220,v,152
v_add_f32 v2, v2, v84
v_add_f32 v2, v2, v85
MA 92,a,220,v,160
v_exp_f32 v87, v87
MA 124,a,220,v,168
ds_read_b128 a[148:151], v10 offset:5120
v_cvt_pk_bf16_f32 v82, v84, v85
MA 88,a,216,v,160
v_exp_f32 v88, v88
MA 120,a,216,v,168
v_add_f32 v2, v2, v86
v_add_f32 v2, v2, v87
MA 84,a,212,v,160
ds_read_b128 a[152:155], v10 offset:6144
ds_read_b128 a[156:159], v10 offset:7168
MA 116,a,212,v,168
v_exp_f32 v89, v89
MA 80,a,208,v,160
ds_read_b128 a[160:163], v10 offset:8192
v_cvt_pk_bf16_f32 v83, v86, v87
MA 112,a,208,v,168
v_exp_f32 v90, v90
MA 76,a,204,v,160
v_add_f32 v3, v3, v88
v_add_f32 v3, v3, v89
MA 108,a,204,v,168
v_exp_f32 v91, v91
MA 72,a,200,v,160
buffer_load_dwordx4 v12, s[52:55], s71 offen offset:2048 sc1 lds
v_cvt_pk_bf16_f32 v88, v88, v89
MA 104,a,200,v,168
v_exp_f32 v92, v92
MA 68,a,196,v,160
v_add_f32 v3, v3, v90
v_add_f32 v3, v3, v91
MA 100,a,196,v,168
v_exp_f32 v93, v93
MA 64,a,192,v,160
ds_read_b128 a[164:167], v10 offset:9216
v_cvt_pk_bf16_f32 v89, v90, v91
MA 96,a,192,v,168
v_exp_f32 v94, v94
MA 0,a,224,v,176
v_add_f32 v3, v3, v92
v_add_f32 v3, v3, v93
MA 32,a,224,v,184
v_exp_f32 v95, v95
MA 4,a,228,v,176
ds_read_b128 a[168:171], v10 offset:10240
v_cvt_pk_bf16_f32 v90, v92, v93
MA 36,a,228,v,184
v_exp_f32 v96, v96
MA 8,a,232,v,176
ds_read_b128 a[172:175], v10 offset:11264
v_add_f32 v3, v3, v94
MA 40,a,232,v,184
ds_read_b128 a[176:179], v10 offset:12288
v_add_f32 v3, v3, v95
MA 12,a,236,v,176
v_exp_f32 v97, v97
MA 44,a,236,v,184
ds_read_b128 a[180:183], v10 offset:13312
v_cvt_pk_bf16_f32 v91, v94, v95
MA 16,a,240,v,176
v_exp_f32 v98, v98
MA 48,a,240,v,184
v_add_f32 v4, v4, v96
v_add_f32 v4, v4, v97
MA 20,a,244,v,176
v_exp_f32 v99, v99
MA 52,a,244,v,184
buffer_load_dwordx4 v12, s[52:55], s71 offen offset:3072 sc1 lds
v_cvt_pk_bf16_f32 v96, v96, v97
MA 24,a,248,v,176
v_exp_f32 v100, v100
MA 56,a,248,v,184
v_add_f32 v4, v4, v98
v_add_f32 v4, v4, v99
MA 28,a,252,v,176
v_exp_f32 v101, v101
MA 60,a,252,v,184
ds_read_b128 a[184:187], v10 offset:14336
v_cvt_pk_bf16_f32 v97, v98, v99
MA 92,a,252,v,192
v_exp_f32 v102, v102
MA 124,a,252,v,200
v_add_f32 v4, v4, v100
v_add_f32 v4, v4, v101
MA 88,a,248,v,192
ds_read_b128 a[188:191], v10 offset:15360
s_xor_b32 s72, s72, 0x8000
MA 120,a,248,v,200
v_exp_f32 v103, v103
MA 84,a,244,v,192
v_cvt_pk_bf16_f32 v98, v100, v101
MA 116,a,244,v,200
v_exp_f32 v104, v104
MA 80,a,240,v,192
v_add_f32 v4, v4, v102
v_add_f32 v4, v4, v103
MA 112,a,240,v,200
v_exp_f32 v105, v105
MA 76,a,236,v,192
v_cvt_pk_bf16_f32 v99, v102, v103
MA 108,a,236,v,200
v_exp_f32 v106, v106
MA 72,a,232,v,192
v_add_f32 v5, v5, v104
v_add_f32 v5, v5, v105
MA 104,a,232,v,200
v_exp_f32 v107, v107
MA 68,a,228,v,192
v_cvt_pk_bf16_f32 v104, v104, v105
MA 100,a,228,v,200
v_exp_f32 v108, v108
MA 64,a,224,v,192
v_add_f32 v5, v5, v106
v_add_f32 v5, v5, v107
MA 96,a,224,v,200
v_exp_f32 v109, v109
v_cvt_pk_bf16_f32 v105, v106, v107
v_exp_f32 v110, v110
v_add_f32 v5, v5, v108
v_add_f32 v5, v5, v109
v_exp_f32 v111, v111
v_cvt_pk_bf16_f32 v106, v108, v109
v_add_f32 v5, v5, v110
v_add_f32 v5, v5, v111
v_cvt_pk_bf16_f32 v107, v110, v111
s_branch L_p3_d0_top
L_p3_d1m_top:
s_waitcnt lgkmcnt(0)
v_xor_b32 v11, 0x8000, v11
v_mfma_f32_16x16x32_bf16 v[80:83], a[128:131], v[16:19], 0
s_add_u32 m0, s73, 16384
ds_read_b128 a[192:195], v11 offset:0
v_mfma_f32_16x16x32_bf16 v[88:91], a[128:131], v[32:35], 0
v_exp_f32 v176, v176
v_mfma_f32_16x16x32_bf16 v[96:99], a[128:131], v[48:51], 0
ds_read_b128 a[196:199], v11 offset:1024
buffer_load_dwordx4 v12, s[56:59], s71 offen offset:0 sc1 lds
v_mfma_f32_16x16x32_bf16 v[104:107], a[128:131], v[64:67], 0
v_exp_f32 v177, v177
MV 80,a,132,v,20
v_exp_f32 v178, v178
MV 88,a,132,v,36
v_add_f32 v2, v2, v176
v_add_f32 v2, v2, v177
MV 96,a,132,v,52
v_exp_f32 v179, v179
MV 104,a,132,v,68
ds_read_b128 a[200:203], v11 offset:2048
v_cvt_pk_bf16_f32 v176, v176, v177
MV 80,a,136,v,24
v_exp_f32 v180, v180
MV 88,a,136,v,40
v_add_f32 v2, v2, v178
v_add_f32 v2, v2, v179
MV 96,a,136,v,56
v_exp_f32 v181, v181
MV 104,a,136,v,72
ds_read_b128 a[204:207], v11 offset:3072
v_cvt_pk_bf16_f32 v177, v178, v179
MV 80,a,140,v,28
v_exp_f32 v182, v182
MV 88,a,140,v,44
buffer_load_dwordx4 v12, s[56:59], s71 offen offset:1024 sc1 lds
v_add_f32 v2, v2, v180
MV 96,a,140,v,60
ds_read_b128 a[208:211], v11 offset:4096
v_add_f32 v2, v2, v181
MV 104,a,140,v,76
v_exp_f32 v183, v183
v_mfma_f32_16x16x32_bf16 v[84:87], a[144:147], v[16:19], 0
ds_read_b128 a[212:215], v11 offset:5120
v_cvt_pk_bf16_f32 v178, v180, v181
v_mfma_f32_16x16x32_bf16 v[92:95], a[144:147], v[32:35], 0
v_exp_f32 v184, v184
v_mfma_f32_16x16x32_bf16 v[100:103], a[144:147], v[48:51], 0
v_add_f32 v2, v2, v182
v_add_f32 v2, v2, v183
v_mfma_f32_16x16x32_bf16 v[108:111], a[144:147], v[64:67], 0
v_exp_f32 v185, v185
MV 84,a,148,v,20
ds_read_b128 a[216:219], v11 offset:6144
v_cvt_pk_bf16_f32 v179, v182, v183
MV 92,a,148,v,36
v_exp_f32 v186, v186
MV 100,a,148,v,52
v_add_f32 v3, v3, v184
v_add_f32 v3, v3, v185
MV 108,a,148,v,68
v_exp_f32 v187, v187
MV 84,a,152,v,24
ds_read_b128 a[220:223], v11 offset:7168
v_cvt_pk_bf16_f32 v184, v184, v185
MV 92,a,152,v,40
ds_read_b128 a[224:227], v11 offset:8192
buffer_load_dwordx4 v12, s[56:59], s71 offen offset:2048 sc1 lds
MV 100,a,152,v,56
v_exp_f32 v188, v188
MV 108,a,152,v,72
v_add_f32 v3, v3, v186
v_add_f32 v3, v3, v187
MV 84,a,156,v,28
v_exp_f32 v189, v189
MV 92,a,156,v,44
ds_read_b128 a[228:231], v11 offset:9216
v_cvt_pk_bf16_f32 v185, v186, v187
MV 100,a,156,v,60
v_exp_f32 v190, v190
MV 108,a,156,v,76
v_add_f32 v3, v3, v188
v_add_f32 v3, v3, v189
v_mfma_f32_16x16x32_bf16 v[112:115], a[160:163], v[16:19], 0
v_exp_f32 v191, v191
v_mfma_f32_16x16x32_bf16 v[120:123], a[160:163], v[32:35], 0
ds_read_b128 a[232:235], v11 offset:10240
v_cvt_pk_bf16_f32 v186, v188, v189
v_mfma_f32_16x16x32_bf16 v[128:131], a[160:163], v[48:51], 0
v_exp_f32 v192, v192
v_mfma_f32_16x16x32_bf16 v[136:139], a[160:163], v[64:67], 0
buffer_load_dwordx4 v12, s[56:59], s71 offen offset:3072 sc1 lds
v_add_f32 v3, v3, v190
MV 112,a,164,v,20
ds_read_b128 a[236:239], v11 offset:11264
v_add_f32 v3, v3, v191
MV 120,a,164,v,36
v_exp_f32 v193, v193
MV 128,a,164,v,52
ds_read_b128 a[240:243], v11 offset:12288
v_cvt_pk_bf16_f32 v187, v190, v191
MV 136,a,164,v,68
v_exp_f32 v194, v194
MV 112,a,168,v,24
v_add_f32 v4, v4, v192
v_add_f32 v4, v4, v193
MV 120,a,168,v,40
v_exp_f32 v195, v195
MV 128,a,168,v,56
v_cvt_pk_bf16_f32 v192, v192, v193
v_add_u32 v246, 0, v13
MV 136,a,168,v,72
v_exp_f32 v196, v196
MV 112,a,172,v,28
ds_read_b128 a[244:247], v11 offset:13312
v_add_f32 v4, v4, v194
MV 120,a,172,v,44
v_add_f32 v4, v4, v195
v_cmp_gt_i32_e64 s[84:85], 0, v246
MV 128,a,172,v,60
ds_read_b128 a[248:251], v11 offset:14336
v_cmp_gt_i32_e64 s[86:87], 1, v246
MV 136,a,172,v,76
v_exp_f32 v197, v197
v_mfma_f32_16x16x32_bf16 v[116:119], a[176:179], v[16:19], 0
v_cvt_pk_bf16_f32 v193, v194, v195
v_cmp_gt_i32_e64 s[88:89], 2, v246
v_mfma_f32_16x16x32_bf16 v[124:127], a[176:179], v[32:35], 0
v_exp_f32 v198, v198
v_mfma_f32_16x16x32_bf16 v[132:135], a[176:179], v[48:51], 0
s_add_u32 s71, s71, 16384
v_add_f32 v4, v4, v196
v_mfma_f32_16x16x32_bf16 v[140:143], a[176:179], v[64:67], 0
v_add_f32 v4, v4, v197
v_cmp_gt_i32_e64 s[90:91], 3, v246
MV 116,a,180,v,20
v_exp_f32 v199, v199
MV 124,a,180,v,36
ds_read_b128 a[252:255], v11 offset:15360
v_cvt_pk_bf16_f32 v194, v196, v197
MV 132,a,180,v,52
v_cndmask_b32_e64 v96, v96, v14, s[84:85]
v_cndmask_b32_e64 v97, v97, v14, s[86:87]
MV 140,a,180,v,68
v_exp_f32 v200, v200
MV 116,a,184,v,24
v_add_f32 v4, v4, v198
v_add_f32 v4, v4, v199
MV 124,a,184,v,40
v_cndmask_b32_e64 v98, v98, v14, s[88:89]
v_cndmask_b32_e64 v99, v99, v14, s[90:91]
MV 132,a,184,v,56
v_exp_f32 v201, v201
MV 140,a,184,v,72
v_cvt_pk_bf16_f32 v195, v198, v199
v_add_u32 v247, -16, v13
MV 116,a,188,v,28
v_exp_f32 v202, v202
MV 124,a,188,v,44
v_add_f32 v5, v5, v200
v_add_f32 v5, v5, v201
MV 132,a,188,v,60
s_xor_b32 s73, s73, 0x8000
v_cmp_gt_i32_e64 s[92:93], 0, v247
MV 140,a,188,v,76
v_exp_f32 v203, v203
v_cvt_pk_bf16_f32 v200, v200, v201
v_cmp_gt_i32_e64 s[94:95], 1, v247
v_exp_f32 v204, v204
v_add_f32 v5, v5, v202
v_cmp_gt_i32_e64 s[96:97], 2, v247
v_add_f32 v5, v5, v203
v_exp_f32 v205, v205
v_cmp_gt_i32_e64 s[98:99], 3, v247
v_cvt_pk_bf16_f32 v201, v202, v203
v_exp_f32 v206, v206
v_cndmask_b32_e64 v100, v100, v14, s[92:93]
v_add_f32 v5, v5, v204
v_cndmask_b32_e64 v101, v101, v14, s[94:95]
v_add_f32 v5, v5, v205
v_exp_f32 v207, v207
v_cvt_pk_bf16_f32 v202, v204, v205
v_cndmask_b32_e64 v102, v102, v14, s[96:97]
v_add_f32 v5, v5, v206
v_add_f32 v5, v5, v207
v_cndmask_b32_e64 v103, v103, v14, s[98:99]
v_cvt_pk_bf16_f32 v203, v206, v207
s_waitcnt vmcnt(16) lgkmcnt(0)
MA 0,a,192,v,144
s_barrier
v_xor_b32 v10, 0x8000, v10
MA 32,a,192,v,152
s_add_u32 m0, s72, 16384
ds_read_b128 a[128:131], v10 offset:0
MA 4,a,196,v,144
ds_read_b128 a[132:135], v10 offset:1024
buffer_load_dwordx4 v12, s[52:55], s71 offen offset:0 sc1 lds
MA 36,a,196,v,152
v_exp_f32 v80, v80
MA 8,a,200,v,144
v_exp_f32 v81, v81
MA 40,a,200,v,152
v_exp_f32 v82, v82
MA 12,a,204,v,144
v_add_f32 v2, v2, v80
v_add_f32 v2, v2, v81
MA 44,a,204,v,152
ds_read_b128 a[136:139], v10 offset:2048
v_add_u32 v246, -32, v13
MA 16,a,208,v,144
v_exp_f32 v83, v83
MA 48,a,208,v,152
ds_read_b128 a[140:143], v10 offset:3072
v_cvt_pk_bf16_f32 v80, v80, v81
MA 20,a,212,v,144
v_exp_f32 v84, v84
MA 52,a,212,v,152
v_add_f32 v2, v2, v82
v_add_f32 v2, v2, v83
MA 24,a,216,v,144
ds_read_b128 a[144:147], v10 offset:4096
v_cmp_gt_i32_e64 s[84:85], 0, v246
MA 56,a,216,v,152
v_exp_f32 v85, v85
MA 28,a,220,v,144
v_cvt_pk_bf16_f32 v81, v82, v83
v_cmp_gt_i32_e64 s[86:87], 1, v246
MA 60,a,220,v,152
v_exp_f32 v86, v86
MA 92,a,220,v,160
v_add_f32 v2, v2, v84
v_add_f32 v2, v2, v85
MA 124,a,220,v,168
ds_read_b128 a[148:151], v10 offset:5120
buffer_load_dwordx4 v12, s[52:55], s71 offen offset:1024 sc1 lds
MA 88,a,216,v,160
v_exp_f32 v87, v87
MA 120,a,216,v,168
v_cvt_pk_bf16_f32 v82, v84, v85
v_cmp_gt_i32_e64 s[88:89], 2, v246
MA 84,a,212,v,160
v_exp_f32 v88, v88
MA 116,a,212,v,168
v_add_f32 v2, v2, v86
v_add_f32 v2, v2, v87
MA 80,a,208,v,160
ds_read_b128 a[152:155], v10 offset:6144
v_cmp_gt_i32_e64 s[90:91], 3, v246
MA 112,a,208,v,168
v_exp_f32 v89, v89
MA 76,a,204,v,160
ds_read_b128 a[156:159], v10 offset:7168
v_cvt_pk_bf16_f32 v83, v86, v87
MA 108,a,204,v,168
v_exp_f32 v90, v90
MA 72,a,200,v,160
v_add_f32 v3, v3, v88
v_add_f32 v3, v3, v89
MA 104,a,200,v,168
v_exp_f32 v91, v91
MA 68,a,196,v,160
v_cvt_pk_bf16_f32 v88, v88, v89
v_cndmask_b32_e64 v128, v128, v14, s[84:85]
MA 100,a,196,v,168
v_exp_f32 v92, v92
MA 64,a,192,v,160
ds_read_b128 a[160:163], v10 offset:8192
v_add_f32 v3, v3, v90
MA 96,a,192,v,168
v_add_f32 v3, v3, v91
v_cndmask_b32_e64 v129, v129, v14, s[86:87]
MA 0,a,224,v,176
v_exp_f32 v93, v93
MA 32,a,224,v,184
buffer_load_dwordx4 v12, s[52:55], s71 offen offset:2048 sc1 lds
v_cvt_pk_bf16_f32 v89, v90, v91
MA 4,a,228,v,176
ds_read_b128 a[164:167], v10 offset:9216
v_cndmask_b32_e64 v130, v130, v14, s[88:89]
MA 36,a,228,v,184
v_exp_f32 v94, v94
MA 8,a,232,v,176
v_add_f32 v3, v3, v92
v_add_f32 v3, v3, v93
MA 40,a,232,v,184
v_exp_f32 v95, v95
MA 12,a,236,v,176
ds_read_b128 a[168:171], v10 offset:10240
v_cvt_pk_bf16_f32 v90, v92, v93
MA 44,a,236,v,184
ds_read_b128 a[172:175], v10 offset:11264
v_cndmask_b32_e64 v131, v131, v14, s[90:91]
MA 16,a,240,v,176
v_exp_f32 v96, v96
MA 48,a,240,v,184
v_add_f32 v3, v3, v94
v_add_f32 v3, v3, v95
MA 20,a,244,v,176
v_exp_f32 v97, v97
MA 52,a,244,v,184
v_cvt_pk_bf16_f32 v91, v94, v95
v_add_u32 v247, -48, v13
MA 24,a,248,v,176
v_exp_f32 v98, v98
MA 56,a,248,v,184
ds_read_b128 a[176:179], v10 offset:12288
v_add_f32 v4, v4, v96
MA 28,a,252,v,176
v_add_f32 v4, v4, v97
v_cmp_gt_i32_e64 s[92:93], 0, v247
MA 60,a,252,v,184
v_exp_f32 v99, v99
MA 92,a,252,v,192
ds_read_b128 a[180:183], v10 offset:13312
v_cvt_pk_bf16_f32 v96, v96, v97
MA 124,a,252,v,200
buffer_load_dwordx4 v12, s[52:55], s71 offen offset:3072 sc1 lds
v_cmp_gt_i32_e64 s[94:95], 1, v247
MA 88,a,248,v,192
v_exp_f32 v100, v100
MA 120,a,248,v,200
v_add_f32 v4, v4, v98
v_add_f32 v4, v4, v99
MA 84,a,244,v,192
v_exp_f32 v101, v101
MA 116,a,244,v,200
ds_read_b128 a[184:187], v10 offset:14336
v_cvt_pk_bf16_f32 v97, v98, v99
MA 80,a,240,v,192
v_exp_f32 v102, v102
MA 112,a,240,v,200
v_add_f32 v4, v4, v100
v_add_f32 v4, v4, v101
MA 76,a,236,v,192
ds_read_b128 a[188:191], v10 offset:15360
v_cmp_gt_i32_e64 s[96:97], 2, v247
MA 108,a,236,v,200
v_exp_f32 v103, v103
MA 72,a,232,v,192
v_cvt_pk_bf16_f32 v98, v100, v101
v_cmp_gt_i32_e64 s[98:99], 3, v247
MA 104,a,232,v,200
v_exp_f32 v104, v104
MA 68,a,228,v,192
v_add_f32 v4, v4, v102
v_add_f32 v4, v4, v103
MA 100,a,228,v,200
v_exp_f32 v105, v105
MA 64,a,224,v,192
s_xor_b32 s72, s72, 0x8000
v_cvt_pk_bf16_f32 v99, v102, v103
MA 96,a,224,v,200
v_exp_f32 v106, v106
v_add_f32 v5, v5, v104
v_cndmask_b32_e64 v132, v132, v14, s[92:93]
v_add_f32 v5, v5, v105
v_exp_f32 v107, v107
v_cvt_pk_bf16_f32 v104, v104, v105
v_exp_f32 v108, v108
v_cndmask_b32_e64 v133, v133, v14, s[94:95]
v_add_f32 v5, v5, v106
v_add_f32 v5, v5, v107
v_exp_f32 v109, v109
v_cvt_pk_bf16_f32 v105, v106, v107
v_cndmask_b32_e64 v134, v134, v14, s[96:97]
v_exp_f32 v110, v110
v_add_f32 v5, v5, v108
v_add_f32 v5, v5, v109
v_exp_f32 v111, v111
v_cndmask_b32_e64 v135, v135, v14, s[98:99]
v_cvt_pk_bf16_f32 v106, v108, v109
v_add_f32 v5, v5, v110
v_add_f32 v5, v5, v111
v_cvt_pk_bf16_f32 v107, v110, v111
L_p3_d0m_top:
s_waitcnt lgkmcnt(0)
v_mfma_f32_16x16x32_bf16 v[144:147], a[128:131], v[16:19], 0
s_add_u32 m0, s73, 0
ds_read_b128 a[192:195], v11 offset:16384
v_mfma_f32_16x16x32_bf16 v[152:155], a[128:131], v[32:35], 0
v_exp_f32 v112, v112
v_mfma_f32_16x16x32_bf16 v[168:171], a[128:131], v[64:67], 0
v_exp_f32 v113, v113
MV 144,a,132,v,20
ds_read_b128 a[196:199], v11 offset:17408
buffer_load_dwordx4 v12, s[56:59], s71 offen offset:0 sc1 lds
MV 152,a,132,v,36
v_exp_f32 v114, v114
MV 168,a,132,v,68
v_add_f32 v2, v2, v112
v_add_f32 v2, v2, v113
MV 144,a,136,v,24
v_exp_f32 v115, v115
MV 152,a,136,v,40
ds_read_b128 a[200:203], v11 offset:18432
v_cvt_pk_bf16_f32 v112, v112, v113
MV 168,a,136,v,72
v_exp_f32 v116, v116
MV 144,a,140,v,28
ds_read_b128 a[204:207], v11 offset:19456
v_add_f32 v2, v2, v114
MV 152,a,140,v,44
ds_read_b128 a[208:211], v11 offset:20480
v_add_f32 v2, v2, v115
MV 168,a,140,v,76
v_exp_f32 v117, v117
v_mfma_f32_16x16x32_bf16 v[148:151], a[144:147], v[16:19], 0
buffer_load_dwordx4 v12, s[56:59], s71 offen offset:1024 sc1 lds
v_cvt_pk_bf16_f32 v113, v114, v115
v_mfma_f32_16x16x32_bf16 v[156:159], a[144:147], v[32:35], 0
v_exp_f32 v118, v118
v_mfma_f32_16x16x32_bf16 v[172:175], a[144:147], v[64:67], 0
v_add_f32 v2, v2, v116
v_add_f32 v2, v2, v117
MV 148,a,148,v,20
v_exp_f32 v119, v119
MV 156,a,148,v,36
ds_read_b128 a[212:215], v11 offset:21504
v_cvt_pk_bf16_f32 v114, v116, v117
MV 172,a,148,v,68
v_exp_f32 v120, v120
MV 148,a,152,v,24
v_add_f32 v2, v2, v118
v_add_f32 v2, v2, v119
MV 156,a,152,v,40
v_exp_f32 v121, v121
MV 172,a,152,v,72
ds_read_b128 a[216:219], v11 offset:22528
v_cvt_pk_bf16_f32 v115, v118, v119
MV 148,a,156,v,28
v_exp_f32 v122, v122
MV 156,a,156,v,44
ds_read_b128 a[220:223], v11 offset:23552
v_add_f32 v3, v3, v120
MV 172,a,156,v,76
ds_read_b128 a[224:227], v11 offset:24576
v_add_f32 v3, v3, v121
v_mfma_f32_16x16x32_bf16 v[176:179], a[160:163], v[16:19], 0
v_exp_f32 v123, v123
v_mfma_f32_16x16x32_bf16 v[184:187], a[160:163], v[32:35], 0
buffer_load_dwordx4 v12, s[56:59], s71 offen offset:2048 sc1 lds
v_cvt_pk_bf16_f32 v120, v120, v121
v_mfma_f32_16x16x32_bf16 v[200:203], a[160:163], v[64:67], 0
v_exp_f32 v124, v124
MV 176,a,164,v,20
v_add_f32 v3, v3, v122
v_add_f32 v3, v3, v123
MV 184,a,164,v,36
v_exp_f32 v125, v125
MV 200,a,164,v,68
ds_read_b128 a[228:231], v11 offset:25600
v_cvt_pk_bf16_f32 v121, v122, v123
MV 176,a,168,v,24
v_exp_f32 v126, v126
MV 184,a,168,v,40
v_add_f32 v3, v3, v124
v_add_f32 v3, v3, v125
MV 200,a,168,v,72
v_exp_f32 v127, v127
MV 176,a,172,v,28
ds_read_b128 a[232:235], v11 offset:26624
v_cvt_pk_bf16_f32 v122, v124, v125
MV 184,a,172,v,44
v_exp_f32 v128, v128
MV 200,a,172,v,76
ds_read_b128 a[236:239], v11 offset:27648
v_add_f32 v3, v3, v126
v_mfma_f32_16x16x32_bf16 v[180:183], a[176:179], v[16:19], 0
ds_read_b128 a[240:243], v11 offset:28672
v_add_f32 v3, v3, v127
v_mfma_f32_16x16x32_bf16 v[188:191], a[176:179], v[32:35], 0
v_exp_f32 v129, v129
v_mfma_f32_16x16x32_bf16 v[204:207], a[176:179], v[64:67], 0
ds_read_b128 a[244:247], v11 offset:29696
v_cvt_pk_bf16_f32 v123, v126, v127
MV 180,a,180,v,20
v_exp_f32 v130, v130
MV 188,a,180,v,36
v_add_f32 v4, v4, v128
v_add_f32 v4, v4, v129
MV 204,a,180,v,68
v_exp_f32 v131, v131
MV 180,a,184,v,24
buffer_load_dwordx4 v12, s[56:59], s71 offen offset:3072 sc1 lds
v_cvt_pk_bf16_f32 v128, v128, v129
MV 188,a,184,v,40
v_exp_f32 v132, v132
MV 204,a,184,v,72
v_add_f32 v4, v4, v130
v_add_f32 v4, v4, v131
MV 180,a,188,v,28
ds_read_b128 a[248:251], v11 offset:30720
v_add_u32 v246, -64, v239
MV 188,a,188,v,44
v_exp_f32 v133, v133
MV 204,a,188,v,76
ds_read_b128 a[252:255], v11 offset:31744
s_add_u32 s71, s71, 16384
v_cvt_pk_bf16_f32 v129, v130, v131
v_exp_f32 v134, v134
v_cmp_gt_i32_e64 s[84:85], 0, v246
v_add_f32 v4, v4, v132
v_cmp_gt_i32_e64 s[86:87], 1, v246
v_add_f32 v4, v4, v133
v_exp_f32 v135, v135
v_cmp_gt_i32_e64 s[88:89], 2, v246
v_cvt_pk_bf16_f32 v130, v132, v133
v_exp_f32 v136, v136
v_cmp_gt_i32_e64 s[90:91], 3, v246
v_add_f32 v4, v4, v134
v_cndmask_b32_e64 v168, v168, v14, s[84:85]
v_add_f32 v4, v4, v135
v_exp_f32 v137, v137
v_cndmask_b32_e64 v169, v169, v14, s[86:87]
v_cvt_pk_bf16_f32 v131, v134, v135
v_exp_f32 v138, v138
v_cndmask_b32_e64 v170, v170, v14, s[88:89]
v_add_f32 v5, v5, v136
v_cndmask_b32_e64 v171, v171, v14, s[90:91]
v_add_f32 v5, v5, v137
v_exp_f32 v139, v139
v_add_u32 v247, -80, v239
v_cvt_pk_bf16_f32 v136, v136, v137
v_exp_f32 v140, v140
v_cmp_gt_i32_e64 s[92:93], 0, v247
v_add_f32 v5, v5, v138
v_cmp_gt_i32_e64 s[94:95], 1, v247
v_add_f32 v5, v5, v139
v_exp_f32 v141, v141
v_cmp_gt_i32_e64 s[96:97], 2, v247
v_cvt_pk_bf16_f32 v137, v138, v139
v_exp_f32 v142, v142
v_cmp_gt_i32_e64 s[98:99], 3, v247
v_add_f32 v5, v5, v140
v_cndmask_b32_e64 v172, v172, v14, s[92:93]
v_add_f32 v5, v5, v141
v_exp_f32 v143, v143
v_cndmask_b32_e64 v173, v173, v14, s[94:95]
v_cvt_pk_bf16_f32 v138, v140, v141
v_add_f32 v5, v5, v142
v_cndmask_b32_e64 v174, v174, v14, s[96:97]
v_add_f32 v5, v5, v143
v_cvt_pk_bf16_f32 v139, v142, v143
v_cndmask_b32_e64 v175, v175, v14, s[98:99]
s_waitcnt vmcnt(16) lgkmcnt(0)
MA 0,a,192,v,80
s_barrier
MA 32,a,192,v,88
s_add_u32 m0, s72, 0
ds_read_b128 a[128:131], v10 offset:16384
MA 4,a,196,v,80
ds_read_b128 a[132:135], v10 offset:17408
buffer_load_dwordx4 v12, s[52:55], s71 offen offset:0 sc1 lds
MA 36,a,196,v,88
v_exp_f32 v144, v144
MA 8,a,200,v,80
v_exp_f32 v145, v145
MA 40,a,200,v,88
v_exp_f32 v146, v146
MA 12,a,204,v,80
ds_read_b128 a[136:139], v10 offset:18432
v_add_f32 v2, v2, v144
MA 44,a,204,v,88
v_add_f32 v2, v2, v145
v_add_u32 v246, -96, v239
MA 16,a,208,v,80
v_exp_f32 v147, v147
MA 48,a,208,v,88
ds_read_b128 a[140:143], v10 offset:19456
v_cvt_pk_bf16_f32 v144, v144, v145
MA 20,a,212,v,80
ds_read_b128 a[144:147], v10 offset:20480
v_cmp_gt_i32_e64 s[84:85], 0, v246
MA 52,a,212,v,88
v_exp_f32 v148, v148
MA 24,a,216,v,80
v_add_f32 v2, v2, v146
v_add_f32 v2, v2, v147
MA 56,a,216,v,88
buffer_load_dwordx4 v12, s[52:55], s71 offen offset:1024 sc1 lds
v_cmp_gt_i32_e64 s[86:87], 1, v246
MA 28,a,220,v,80
v_exp_f32 v149, v149
MA 60,a,220,v,88
ds_read_b128 a[148:151], v10 offset:21504
v_cvt_pk_bf16_f32 v145, v146, v147
MA 92,a,220,v,96
v_exp_f32 v150, v150
MA 124,a,220,v,104
v_add_f32 v2, v2, v148
v_cmp_gt_i32_e64 s[88:89], 2, v246
MA 88,a,216,v,96
ds_read_b128 a[152:155], v10 offset:22528
v_add_f32 v2, v2, v149
MA 120,a,216,v,104
v_exp_f32 v151, v151
MA 84,a,212,v,96
v_cvt_pk_bf16_f32 v146, v148, v149
v_cmp_gt_i32_e64 s[90:91], 3, v246
MA 116,a,212,v,104
v_exp_f32 v152, v152
MA 80,a,208,v,96
ds_read_b128 a[156:159], v10 offset:23552
v_add_f32 v2, v2, v150
MA 112,a,208,v,104
v_add_f32 v2, v2, v151
v_cndmask_b32_e64 v200, v200, v14, s[84:85]
MA 76,a,204,v,96
v_exp_f32 v153, v153
MA 108,a,204,v,104
ds_read_b128 a[160:163], v10 offset:24576
v_cvt_pk_bf16_f32 v147, v150, v151
MA 72,a,200,v,96
buffer_load_dwordx4 v12, s[52:55], s71 offen offset:2048 sc1 lds
v_cndmask_b32_e64 v201, v201, v14, s[86:87]
MA 104,a,200,v,104
v_exp_f32 v154, v154
MA 68,a,196,v,96
ds_read_b128 a[164:167], v10 offset:25600
v_add_f32 v3, v3, v152
MA 100,a,196,v,104
v_add_f32 v3, v3, v153
v_cndmask_b32_e64 v202, v202, v14, s[88:89]
MA 64,a,192,v,96
v_exp_f32 v155, v155
MA 96,a,192,v,104
ds_read_b128 a[168:171], v10 offset:26624
v_cvt_pk_bf16_f32 v152, v152, v153
MA 0,a,224,v,112
v_exp_f32 v156, v156
MA 32,a,224,v,120
v_add_f32 v3, v3, v154
v_cndmask_b32_e64 v203, v203, v14, s[90:91]
MA 4,a,228,v,112
ds_read_b128 a[172:175], v10 offset:27648
v_add_f32 v3, v3, v155
MA 36,a,228,v,120
v_exp_f32 v157, v157
MA 8,a,232,v,112
v_cvt_pk_bf16_f32 v153, v154, v155
v_add_u32 v247, -112, v239
MA 40,a,232,v,120
v_exp_f32 v158, v158
MA 12,a,236,v,112
ds_read_b128 a[176:179], v10 offset:28672
v_add_f32 v3, v3, v156
MA 44,a,236,v,120
v_add_f32 v3, v3, v157
v_cmp_gt_i32_e64 s[92:93], 0, v247
MA 16,a,240,v,112
v_exp_f32 v159, v159
MA 48,a,240,v,120
ds_read_b128 a[180:183], v10 offset:29696
buffer_load_dwordx4 v12, s[52:55], s71 offen offset:3072 sc1 lds
MA 20,a,244,v,112
v_cvt_pk_bf16_f32 v154, v156, v157
v_cmp_gt_i32_e64 s[94:95], 1, v247
MA 52,a,244,v,120
v_exp_f32 v168, v168
MA 24,a,248,v,112
ds_read_b128 a[184:187], v10 offset:30720
v_add_f32 v3, v3, v158
MA 56,a,248,v,120
v_add_f32 v3, v3, v159
v_cmp_gt_i32_e64 s[96:97], 2, v247
MA 28,a,252,v,112
v_exp_f32 v169, v169
MA 60,a,252,v,120
ds_read_b128 a[188:191], v10 offset:31744
v_cvt_pk_bf16_f32 v155, v158, v159
MA 92,a,252,v,128
v_exp_f32 v170, v170
MA 124,a,252,v,136
v_add_f32 v5, v5, v168
v_cmp_gt_i32_e64 s[98:99], 3, v247
MA 88,a,248,v,128
s_cmp_eq_u32 s70, 7
v_add_f32 v5, v5, v169
MA 120,a,248,v,136
v_exp_f32 v171, v171
MA 84,a,244,v,128
v_cvt_pk_bf16_f32 v168, v168, v169
v_cndmask_b32_e64 v204, v204, v14, s[92:93]
MA 116,a,244,v,136
v_exp_f32 v172, v172
MA 80,a,240,v,128
v_add_f32 v5, v5, v170
v_add_f32 v5, v5, v171
MA 112,a,240,v,136
v_exp_f32 v173, v173
MA 76,a,236,v,128
v_cvt_pk_bf16_f32 v169, v170, v171
v_cndmask_b32_e64 v205, v205, v14, s[94:95]
MA 108,a,236,v,136
v_exp_f32 v174, v174
MA 72,a,232,v,128
v_add_f32 v5, v5, v172
v_cndmask_b32_e64 v206, v206, v14, s[96:97]
MA 104,a,232,v,136
v_add_f32 v5, v5, v173
v_cndmask_b32_e64 v207, v207, v14, s[98:99]
MA 68,a,228,v,128
v_exp_f32 v175, v175
MA 100,a,228,v,136
v_cvt_pk_bf16_f32 v170, v172, v173
v_add_f32 v5, v5, v174
MA 64,a,224,v,128
v_add_f32 v5, v5, v175
v_cvt_pk_bf16_f32 v171, v174, v175
MA 96,a,224,v,136
s_cbranch_scc1 L_p3_mxm_top
s_waitcnt lgkmcnt(0)
v_xor_b32 v11, 0x8000, v11
v_mfma_f32_16x16x32_bf16 v[80:83], a[128:131], v[16:19], 0
s_add_u32 m0, s73, 16384
ds_read_b128 a[192:195], v11 offset:0
v_mfma_f32_16x16x32_bf16 v[88:91], a[128:131], v[32:35], 0
v_exp_f32 v176, v176
v_mfma_f32_16x16x32_bf16 v[84:87], a[144:147], v[16:19], 0
v_exp_f32 v177, v177
v_mfma_f32_16x16x32_bf16 v[92:95], a[144:147], v[32:35], 0
ds_read_b128 a[196:199], v11 offset:1024
buffer_load_dwordx4 v12, s[56:59], s71 offen offset:0 sc1 lds
v_mfma_f32_16x16x32_bf16 v[112:115], a[160:163], v[16:19], 0
v_exp_f32 v178, v178
v_mfma_f32_16x16x32_bf16 v[120:123], a[160:163], v[32:35], 0
v_add_f32 v2, v2, v176
v_add_f32 v2, v2, v177
v_mfma_f32_16x16x32_bf16 v[116:119], a[176:179], v[16:19], 0
ds_read_b128 a[200:203], v11 offset:2048
ds_read_b128 a[204:207], v11 offset:3072
v_mfma_f32_16x16x32_bf16 v[124:127], a[176:179], v[32:35], 0
v_exp_f32 v179, v179
MV 116,a,180,v,20
ds_read_b128 a[208:211], v11 offset:4096
v_cvt_pk_bf16_f32 v176, v176, v177
MV 124,a,180,v,36
v_exp_f32 v180, v180
MV 112,a,164,v,20
v_add_f32 v2, v2, v178
v_add_f32 v2, v2, v179
MV 120,a,164,v,36
v_exp_f32 v181, v181
MV 84,a,148,v,20
buffer_load_dwordx4 v12, s[56:59], s71 offen offset:1024 sc1 lds
v_cvt_pk_bf16_f32 v177, v178, v179
MV 92,a,148,v,36
v_exp_f32 v182, v182
MV 80,a,132,v,20
ds_read_b128 a[212:215], v11 offset:5120
v_add_f32 v2, v2, v180
MV 88,a,132,v,36
ds_read_b128 a[216:219], v11 offset:6144
v_add_f32 v2, v2, v181
MV 80,a,136,v,24
v_exp_f32 v183, v183
MV 88,a,136,v,40
ds_read_b128 a[220:223], v11 offset:7168
v_cvt_pk_bf16_f32 v178, v180, v181
MV 84,a,152,v,24
v_exp_f32 v184, v184
MV 92,a,152,v,40
v_add_f32 v2, v2, v182
v_add_f32 v2, v2, v183
MV 112,a,168,v,24
ds_read_b128 a[224:227], v11 offset:8192
buffer_load_dwordx4 v12, s[56:59], s71 offen offset:2048 sc1 lds
MV 120,a,168,v,40
v_exp_f32 v185, v185
MV 116,a,184,v,24
ds_read_b128 a[228:231], v11 offset:9216
v_cvt_pk_bf16_f32 v179, v182, v183
MV 124,a,184,v,40
v_exp_f32 v186, v186
MV 116,a,188,v,28
v_add_f32 v3, v3, v184
v_add_f32 v3, v3, v185
MV 124,a,188,v,44
v_exp_f32 v187, v187
MV 112,a,172,v,28
ds_read_b128 a[232:235], v11 offset:10240
v_cvt_pk_bf16_f32 v184, v184, v185
MV 120,a,172,v,44
v_exp_f32 v188, v188
MV 84,a,156,v,28
ds_read_b128 a[236:239], v11 offset:11264
v_add_f32 v3, v3, v186
MV 92,a,156,v,44
buffer_load_dwordx4 v12, s[56:59], s71 offen offset:3072 sc1 lds
v_add_f32 v3, v3, v187
MV 80,a,140,v,28
v_exp_f32 v189, v189
MV 88,a,140,v,44
ds_read_b128 a[240:243], v11 offset:12288
ds_read_b128 a[244:247], v11 offset:13312
ds_read_b128 a[248:251], v11 offset:14336
ds_read_b128 a[252:255], v11 offset:15360
s_add_u32 s71, s71, 16384
s_xor_b32 s73, s73, 0x8000
v_cvt_pk_bf16_f32 v185, v186, v187
v_exp_f32 v190, v190
v_add_f32 v3, v3, v188
v_add_f32 v3, v3, v189
v_exp_f32 v191, v191
v_cvt_pk_bf16_f32 v186, v188, v189
v_exp_f32 v200, v200
v_add_f32 v3, v3, v190
v_add_f32 v3, v3, v191
v_exp_f32 v201, v201
v_cvt_pk_bf16_f32 v187, v190, v191
v_exp_f32 v202, v202
v_add_f32 v5, v5, v200
v_add_f32 v5, v5, v201
v_exp_f32 v203, v203
v_cvt_pk_bf16_f32 v200, v200, v201
v_exp_f32 v204, v204
v_add_f32 v5, v5, v202
v_add_f32 v5, v5, v203
v_exp_f32 v205, v205
v_cvt_pk_bf16_f32 v201, v202, v203
v_exp_f32 v206, v206
v_add_f32 v5, v5, v204
v_add_f32 v5, v5, v205
v_exp_f32 v207, v207
v_cvt_pk_bf16_f32 v202, v204, v205
v_add_f32 v5, v5, v206
v_add_f32 v5, v5, v207
v_cvt_pk_bf16_f32 v203, v206, v207
s_waitcnt vmcnt(16) lgkmcnt(0)
MA 0,a,192,v,144
s_barrier
v_xor_b32 v10, 0x8000, v10
MA 32,a,192,v,152
s_add_u32 m0, s72, 16384
ds_read_b128 a[128:131], v10 offset:0
MA 4,a,196,v,144
buffer_load_dwordx4 v12, s[52:55], s71 offen offset:0 sc1 lds
v_lshrrev_b32 v249, 2, v1
MA 36,a,196,v,152
ds_read_b128 a[132:135], v10 offset:1024
v_and_b32 v248, 7, v249
MA 8,a,200,v,144
v_exp_f32 v80, v80
MA 40,a,200,v,152
v_lshlrev_b32 v249, 8, v249
v_and_b32 v250, 3, v1
MA 12,a,204,v,144
ds_read_b128 a[136:139], v10 offset:2048
v_lshl_add_u32 v249, v250, 3, v249
MA 44,a,204,v,152
v_exp_f32 v81, v81
MA 16,a,208,v,144
s_lshl_b32 s36, s3, 13
s_add_u32 s36, s36, 131072
MA 48,a,208,v,152
ds_read_b128 a[140:143], v10 offset:3072
v_add_u32 v249, s36, v249
MA 20,a,212,v,144
v_exp_f32 v82, v82
MA 52,a,212,v,152
s_waitcnt vmcnt(13)
v_xor_b32 v250, 0, v248
MA 24,a,216,v,144
ds_read_b128 a[144:147], v10 offset:4096
v_lshl_add_u32 v250, v250, 5, v249
MA 56,a,216,v,152
v_exp_f32 v83, v83
MA 28,a,220,v,144
TR 96,250,0
TR 98,250,4096
MA 60,a,220,v,152
ds_read_b128 a[148:151], v10 offset:5120
v_xor_b32 v250, 1, v248
MA 124,a,220,v,168
buffer_load_dwordx4 v12, s[52:55], s71 offen offset:1024 sc1 lds
v_cvt_pk_bf16_f32 v80, v80, v81
MA 120,a,216,v,168
v_lshl_add_u32 v250, v250, 5, v249
TR 100,250,0
MA 116,a,212,v,168
TR 102,250,4096
v_xor_b32 v250, 2, v248
MA 112,a,208,v,168
v_exp_f32 v84, v84
MA 108,a,204,v,168
ds_read_b128 a[152:155], v10 offset:6144
v_lshl_add_u32 v250, v250, 5, v249
MA 104,a,200,v,168
TR 104,250,0
TR 106,250,4096
MA 100,a,196,v,168
v_exp_f32 v85, v85
MA 96,a,192,v,168
ds_read_b128 a[156:159], v10 offset:7168
v_cvt_pk_bf16_f32 v81, v82, v83
MA 0,a,224,v,176
v_xor_b32 v250, 3, v248
v_lshl_add_u32 v250, v250, 5, v249
MA 32,a,224,v,184
ds_read_b128 a[160:163], v10 offset:8192
TR 108,250,0
MA 4,a,228,v,176
TR 110,250,4096
v_xor_b32 v250, 4, v248
MA 36,a,228,v,184
v_exp_f32 v86, v86
MA 8,a,232,v,176
ds_read_b128 a[164:167], v10 offset:9216
v_lshl_add_u32 v250, v250, 5, v249
MA 40,a,232,v,184
buffer_load_dwordx4 v12, s[52:55], s71 offen offset:2048 sc1 lds
TR 128,250,0
MA 12,a,236,v,176
TR 130,250,4096
v_xor_b32 v250, 5, v248
MA 44,a,236,v,184
v_exp_f32 v87, v87
MA 16,a,240,v,176
ds_read_b128 a[168:171], v10 offset:10240
v_cvt_pk_bf16_f32 v82, v84, v85
MA 48,a,240,v,184
v_lshl_add_u32 v250, v250, 5, v249
TR 132,250,0
MA 20,a,244,v,176
TR 134,250,4096
v_xor_b32 v250, 6, v248
MA 52,a,244,v,184
v_exp_f32 v88, v88
MA 24,a,248,v,176
ds_read_b128 a[172:175], v10 offset:11264
v_lshl_add_u32 v250, v250, 5, v249
MA 56,a,248,v,184
TR 136,250,0
TR 138,250,4096
MA 28,a,252,v,176
v_exp_f32 v89, v89
MA 60,a,252,v,184
ds_read_b128 a[176:179], v10 offset:12288
v_xor_b32 v250, 7, v248
MA 124,a,252,v,200
v_cvt_pk_bf16_f32 v83, v86, v87
v_lshl_add_u32 v250, v250, 5, v249
MA 120,a,248,v,200
ds_read_b128 a[180:183], v10 offset:13312
TR 140,250,0
MA 116,a,244,v,200
buffer_load_dwordx4 v12, s[52:55], s71 offen offset:3072 sc1 lds
TR 142,250,4096
MA 112,a,240,v,200
v_exp_f32 v90, v90
MA 108,a,236,v,200
s_add_u32 s32, s40, 100663296
s_addc_u32 s33, s41, 0
MA 104,a,232,v,200
ds_read_b128 a[184:187], v10 offset:14336
s_mov_b32 s34, 8388608
MA 100,a,228,v,200
s_mov_b32 s35, 0x20000
s_and_b32 s36, s2, 7
MA 96,a,224,v,200
ds_read_b128 a[188:191], v10 offset:15360
s_xor_b32 s72, s72, 0x8000
v_exp_f32 v91, v91
s_lshl_b32 s36, s36, 20
s_lshr_b32 s37, s2, 3
v_cvt_pk_bf16_f32 v88, v88, v89
s_lshl_b32 s37, s37, 15
v_exp_f32 v92, v92
s_add_u32 s36, s36, s37
s_lshl_b32 s37, s3, 12
s_add_u32 s36, s36, s37
v_exp_f32 v93, v93
s_add_u32 s37, s36, 4096
s_waitcnt lgkmcnt(15)
buffer_store_dwordx4 v[96:99], v12, s[32:35], s36 offen offset:0 sc1
buffer_store_dwordx4 v[100:103], v12, s[32:35], s36 offen offset:1024 sc1
v_cvt_pk_bf16_f32 v89, v90, v91
buffer_store_dwordx4 v[104:107], v12, s[32:35], s36 offen offset:2048 sc1
buffer_store_dwordx4 v[108:111], v12, s[32:35], s36 offen offset:3072 sc1
s_waitcnt lgkmcnt(12)
buffer_store_dwordx4 v[128:131], v12, s[32:35], s37 offen offset:0 sc1
v_exp_f32 v94, v94
s_waitcnt lgkmcnt(9)
buffer_store_dwordx4 v[132:135], v12, s[32:35], s37 offen offset:1024 sc1
s_waitcnt lgkmcnt(6)
buffer_store_dwordx4 v[136:139], v12, s[32:35], s37 offen offset:2048 sc1
s_waitcnt lgkmcnt(2)
buffer_store_dwordx4 v[140:143], v12, s[32:35], s37 offen offset:3072 sc1
v_exp_f32 v95, v95
v_lshlrev_b32 v232, 4, v1
v_mov_b32 v235, 0
buffer_load_ushort v234, v235, s[28:31], s42 offen
v_cvt_pk_bf16_f32 v90, v92, v93
buffer_load_dwordx4 v[210:213], v232, s[16:19], 0 offen offset:0
buffer_load_dwordx4 v[216:219], v232, s[16:19], 0 offen offset:1024
v_cvt_pk_bf16_f32 v91, v94, v95
buffer_load_dwordx4 v[222:225], v232, s[16:19], 0 offen offset:2048
buffer_load_dwordx4 v[228:231], v232, s[16:19], 0 offen offset:3072
L_p3_eps:
v_mov_b32 v240, v4
v_mov_b32 v241, v5
s_nop 0
v_permlane32_swap_b32 v4, v240
v_permlane32_swap_b32 v5, v241
v_add_f32 v4, v4, v240
v_add_f32 v5, v5, v241
v_mov_b32 v240, v4
v_mov_b32 v241, v5
s_nop 0
v_permlane16_swap_b32 v4, v240
v_permlane16_swap_b32 v5, v241
v_add_f32 v4, v4, v240
v_add_f32 v5, v5, v241
v_cmp_nle_f32 vcc, 0x30800000, v4
s_nop 0
s_mov_b64 s[78:79], vcc
v_cmp_nge_f32 vcc, 0x4e800000, v4
s_nop 0
s_or_b64 s[78:79], s[78:79], vcc
v_cmp_nle_f32 vcc, 0x30800000, v5
s_nop 0
s_or_b64 s[78:79], s[78:79], vcc
v_cmp_nge_f32 vcc, 0x4e800000, v5
s_nop 0
s_or_b64 s[78:79], s[78:79], vcc
v_rcp_f32 v4, v4
v_rcp_f32 v5, v5
s_add_u32 s80, s101, s76
s_nop 4
v_accvgpr_read_b32 v240, a64
v_accvgpr_read_b32 v241, a65
v_accvgpr_read_b32 v242, a66
v_accvgpr_read_b32 v243, a67
v_accvgpr_read_b32 v244, a68
v_accvgpr_read_b32 v245, a69
v_accvgpr_read_b32 v246, a70
v_accvgpr_read_b32 v247, a71
v_pk_mul_f32 v[240:241], v[240:241], v[4:5] op_sel:[0,0] op_sel_hi:[1,0]
v_pk_mul_f32 v[242:243], v[242:243], v[4:5] op_sel:[0,0] op_sel_hi:[1,0]
v_pk_mul_f32 v[244:245], v[244:245], v[4:5] op_sel:[0,0] op_sel_hi:[1,0]
v_pk_mul_f32 v[246:247], v[246:247], v[4:5] op_sel:[0,0] op_sel_hi:[1,0]
v_cvt_pk_bf16_f32 v248, v240, v241
v_cvt_pk_bf16_f32 v249, v242, v243
v_cvt_pk_bf16_f32 v250, v244, v245
v_cvt_pk_bf16_f32 v251, v246, v247
buffer_store_dwordx4 v[248:251], v15, s[60:63], s101 offen offset:0 sc1
v_accvgpr_read_b32 v240, a72
v_accvgpr_read_b32 v241, a73
v_accvgpr_read_b32 v242, a74
v_accvgpr_read_b32 v243, a75
v_accvgpr_read_b32 v244, a76
v_accvgpr_read_b32 v245, a77
v_accvgpr_read_b32 v246, a78
v_accvgpr_read_b32 v247, a79
v_pk_mul_f32 v[240:241], v[240:241], v[4:5] op_sel:[0,0] op_sel_hi:[1,0]
v_pk_mul_f32 v[242:243], v[242:243], v[4:5] op_sel:[0,0] op_sel_hi:[1,0]
v_pk_mul_f32 v[244:245], v[244:245], v[4:5] op_sel:[0,0] op_sel_hi:[1,0]
v_pk_mul_f32 v[246:247], v[246:247], v[4:5] op_sel:[0,0] op_sel_hi:[1,0]
v_cvt_pk_bf16_f32 v252, v240, v241
v_cvt_pk_bf16_f32 v253, v242, v243
v_cvt_pk_bf16_f32 v254, v244, v245
v_cvt_pk_bf16_f32 v255, v246, v247
buffer_store_dwordx4 v[252:255], v15, s[60:63], s101 offen offset:1024 sc1
v_accvgpr_read_b32 v240, a80
v_accvgpr_read_b32 v241, a81
v_accvgpr_read_b32 v242, a82
v_accvgpr_read_b32 v243, a83
v_accvgpr_read_b32 v244, a84
v_accvgpr_read_b32 v245, a85
v_accvgpr_read_b32 v246, a86
v_accvgpr_read_b32 v247, a87
v_pk_mul_f32 v[240:241], v[240:241], v[4:5] op_sel:[0,0] op_sel_hi:[1,0]
v_pk_mul_f32 v[242:243], v[242:243], v[4:5] op_sel:[0,0] op_sel_hi:[1,0]
v_pk_mul_f32 v[244:245], v[244:245], v[4:5] op_sel:[0,0] op_sel_hi:[1,0]
v_pk_mul_f32 v[246:247], v[246:247], v[4:5] op_sel:[0,0] op_sel_hi:[1,0]
v_cvt_pk_bf16_f32 v248, v240, v241
v_cvt_pk_bf16_f32 v249, v242, v243
v_cvt_pk_bf16_f32 v250, v244, v245
v_cvt_pk_bf16_f32 v251, v246, v247
buffer_store_dwordx4 v[248:251], v15, s[60:63], s101 offen offset:2048 sc1
v_accvgpr_read_b32 v240, a88
v_accvgpr_read_b32 v241, a89
v_accvgpr_read_b32 v242, a90
v_accvgpr_read_b32 v243, a91
v_accvgpr_read_b32 v244, a92
v_accvgpr_read_b32 v245, a93
v_accvgpr_read_b32 v246, a94
v_accvgpr_read_b32 v247, a95
v_pk_mul_f32 v[240:241], v[240:241], v[4:5] op_sel:[0,0] op_sel_hi:[1,0]
v_pk_mul_f32 v[242:243], v[242:243], v[4:5] op_sel:[0,0] op_sel_hi:[1,0]
v_pk_mul_f32 v[244:245], v[244:245], v[4:5] op_sel:[0,0] op_sel_hi:[1,0]
v_pk_mul_f32 v[246:247], v[246:247], v[4:5] op_sel:[0,0] op_sel_hi:[1,0]
v_cvt_pk_bf16_f32 v252, v240, v241
v_cvt_pk_bf16_f32 v253, v242, v243
v_cvt_pk_bf16_f32 v254, v244, v245
v_cvt_pk_bf16_f32 v255, v246, v247
buffer_store_dwordx4 v[252:255], v15, s[60:63], s101 offen offset:3072 sc1
v_accvgpr_read_b32 v240, a96
v_accvgpr_read_b32 v241, a97
v_accvgpr_read_b32 v242, a98
v_accvgpr_read_b32 v243, a99
v_accvgpr_read_b32 v244, a100
v_accvgpr_read_b32 v245, a101
v_accvgpr_read_b32 v246, a102
v_accvgpr_read_b32 v247, a103
v_pk_mul_f32 v[240:241], v[240:241], v[4:5] op_sel:[0,1] op_sel_hi:[1,1]
v_pk_mul_f32 v[242:243], v[242:243], v[4:5] op_sel:[0,1] op_sel_hi:[1,1]
v_pk_mul_f32 v[244:245], v[244:245], v[4:5] op_sel:[0,1] op_sel_hi:[1,1]
v_pk_mul_f32 v[246:247], v[246:247], v[4:5] op_sel:[0,1] op_sel_hi:[1,1]
v_cvt_pk_bf16_f32 v248, v240, v241
v_cvt_pk_bf16_f32 v249, v242, v243
v_cvt_pk_bf16_f32 v250, v244, v245
v_cvt_pk_bf16_f32 v251, v246, v247
buffer_store_dwordx4 v[248:251], v15, s[60:63], s80 offen offset:0 sc1
v_accvgpr_read_b32 v240, a104
v_accvgpr_read_b32 v241, a105
v_accvgpr_read_b32 v242, a106
v_accvgpr_read_b32 v243, a107
v_accvgpr_read_b32 v244, a108
v_accvgpr_read_b32 v245, a109
v_accvgpr_read_b32 v246, a110
v_accvgpr_read_b32 v247, a111
v_pk_mul_f32 v[240:241], v[240:241], v[4:5] op_sel:[0,1] op_sel_hi:[1,1]
v_pk_mul_f32 v[242:243], v[242:243], v[4:5] op_sel:[0,1] op_sel_hi:[1,1]
v_pk_mul_f32 v[244:245], v[244:245], v[4:5] op_sel:[0,1] op_sel_hi:[1,1]
v_pk_mul_f32 v[246:247], v[246:247], v[4:5] op_sel:[0,1] op_sel_hi:[1,1]
v_cvt_pk_bf16_f32 v252, v240, v241
v_cvt_pk_bf16_f32 v253, v242, v243
v_cvt_pk_bf16_f32 v254, v244, v245
v_cvt_pk_bf16_f32 v255, v246, v247
buffer_store_dwordx4 v[252:255], v15, s[60:63], s80 offen offset:1024 sc1
v_accvgpr_read_b32 v240, a112
v_accvgpr_read_b32 v241, a113
v_accvgpr_read_b32 v242, a114
v_accvgpr_read_b32 v243, a115
v_accvgpr_read_b32 v244, a116
v_accvgpr_read_b32 v245, a117
v_accvgpr_read_b32 v246, a118
v_accvgpr_read_b32 v247, a119
v_pk_mul_f32 v[240:241], v[240:241], v[4:5] op_sel:[0,1] op_sel_hi:[1,1]
v_pk_mul_f32 v[242:243], v[242:243], v[4:5] op_sel:[0,1] op_sel_hi:[1,1]
v_pk_mul_f32 v[244:245], v[244:245], v[4:5] op_sel:[0,1] op_sel_hi:[1,1]
v_pk_mul_f32 v[246:247], v[246:247], v[4:5] op_sel:[0,1] op_sel_hi:[1,1]
v_cvt_pk_bf16_f32 v248, v240, v241
v_cvt_pk_bf16_f32 v249, v242, v243
v_cvt_pk_bf16_f32 v250, v244, v245
v_cvt_pk_bf16_f32 v251, v246, v247
buffer_store_dwordx4 v[248:251], v15, s[60:63], s80 offen offset:2048 sc1
v_accvgpr_read_b32 v240, a120
v_accvgpr_read_b32 v241, a121
v_accvgpr_read_b32 v242, a122
v_accvgpr_read_b32 v243, a123
v_accvgpr_read_b32 v244, a124
v_accvgpr_read_b32 v245, a125
v_accvgpr_read_b32 v246, a126
v_accvgpr_read_b32 v247, a127
v_pk_mul_f32 v[240:241], v[240:241], v[4:5] op_sel:[0,1] op_sel_hi:[1,1]
v_pk_mul_f32 v[242:243], v[242:243], v[4:5] op_sel:[0,1] op_sel_hi:[1,1]
v_pk_mul_f32 v[244:245], v[244:245], v[4:5] op_sel:[0,1] op_sel_hi:[1,1]
v_pk_mul_f32 v[246:247], v[246:247], v[4:5] op_sel:[0,1] op_sel_hi:[1,1]
v_cvt_pk_bf16_f32 v252, v240, v241
v_cvt_pk_bf16_f32 v253, v242, v243
v_cvt_pk_bf16_f32 v254, v244, v245
v_cvt_pk_bf16_f32 v255, v246, v247
buffer_store_dwordx4 v[252:255], v15, s[60:63], s80 offen offset:3072 sc1
v_mov_b32 v160, 0x3f803f80
v_mov_b32 v161, 0x3f803f80
v_mov_b32 v162, 0x3f803f80
v_mov_b32 v163, 0x3f803f80
v_mov_b32 v164, 0
v_mov_b32 v165, 0
v_mov_b32 v166, 0
v_mov_b32 v167, 0
v_mov_b32 v168, 0
v_mov_b32 v169, 0
v_mov_b32 v170, 0
v_mov_b32 v171, 0
s_and_b32 s36, s2, 3
s_lshl_b32 s36, s36, 1
s_sub_u32 s32, 14, s36
s_bitcmp1_b32 s2, 4
s_cselect_b32 s36, s32, s36
s_bfe_u32 s32, s2, 0x10003
s_add_u32 s36, s36, s32
s_bfe_u32 s37, s2, 0x10002
s_lshr_b32 s32, s2, 5
s_lshl_b32 s32, s32, 1
s_add_u32 s37, s37, s32
s_lshl_b32 s36, s36, 2
s_add_u32 s36, s36, s3
s_lshl_b32 s37, s37, 7
s_lshl_b32 s32, s36, 16
s_add_u32 s37, s37, s32
s_lshl_b32 s36, s36, 7
v_and_b32 v240, 15, v1
v_bfe_u32 v241, v1, 4, 1
v_lshlrev_b32 v241, 5, v241
v_lshrrev_b32 v242, 5, v1
v_lshl_add_u32 v241, v242, 4, v241
v_lshl_add_u32 v241, v240, 11, v241
v_lshlrev_b32 v240, 2, v240
s_add_u32 s32, s40, 58720256
s_addc_u32 s33, s41, 0
s_mov_b32 s34, 8192
s_mov_b32 s35, 0x20000
buffer_load_dwordx4 v[192:195], v241, s[44:47], s37 offen offset:0
buffer_load_dwordx4 v[196:199], v241, s[44:47], s37 offen offset:64
buffer_load_dword v6, v240, s[32:35], s36 offen offset:0 sc1
s_add_u32 s37, s37, 32768
buffer_load_dwordx4 v[200:203], v241, s[44:47], s37 offen offset:0
buffer_load_dwordx4 v[204:207], v241, s[44:47], s37 offen offset:64
buffer_load_dword v7, v240, s[32:35], s36 offen offset:64 sc1
v_lshlrev_b32 v236, 20, v1
s_lshl_b32 s36, s3, 26
v_add_u32 v236, s36, v236
v_mov_b32 v237, 1
s_lshl_b32 s37, s2, 2
s_getpc_b64 s[38:39]
L_ct_b:
s_add_u32 s38, s38, L_p3_s1m_top - L_ct_b
s_addc_u32 s39, s39, 0
v_mov_b32 v173, s39
v_mov_b32 v172, s38
s_lshr_b32 s38, s2, 3
s_lshl_b32 s38, s38, 2
s_add_u32 s38, s38, s3
s_lshl_b32 s38, s38, 7
v_and_b32 v174, 3, v1
v_lshlrev_b32 v174, 14, v174
v_add_u32 v174, s38, v174
v_min_u32 v174, L_end - L_p3_s1m_top - 4, v174
v_add_co_u32 v172, vcc, v172, v174
s_nop 1
v_addc_co_u32 v173, vcc, 0, v173, vcc
global_load_dword v174, v[172:173], off
s_lshl_b32 s74, s70, 1
s_sub_u32 s74, 13, s74
s_cbranch_scc1 L_p3_s0m_top
.p2align 5
L_p3_s0_top:
s_waitcnt lgkmcnt(0)
v_mfma_f32_16x16x32_bf16 v[144:147], a[128:131], v[16:19], 0
s_add_u32 m0, s73, 0
ds_read_b128 a[192:195], v11 offset:16384
v_mfma_f32_16x16x32_bf16 v[152:155], a[128:131], v[32:35], 0
v_exp_f32 v112, v112
v_mfma_f32_16x16x32_bf16 v[148:151], a[144:147], v[16:19], 0
ds_read_b128 a[196:199], v11 offset:17408
buffer_load_dwordx4 v12, s[56:59], s71 offen offset:0 sc1 lds
v_mfma_f32_16x16x32_bf16 v[156:159], a[144:147], v[32:35], 0
v_exp_f32 v113, v113
v_mfma_f32_16x16x32_bf16 v[176:179], a[160:163], v[16:19], 0
ds_read_b128 a[200:203], v11 offset:18432
ds_read_b128 a[204:207], v11 offset:19456
v_mfma_f32_16x16x32_bf16 v[184:187], a[160:163], v[32:35], 0
v_exp_f32 v114, v114
v_mfma_f32_16x16x32_bf16 v[180:183], a[176:179], v[16:19], 0
v_exp_f32 v115, v115
v_mfma_f32_16x16x32_bf16 v[188:191], a[176:179], v[32:35], 0
ds_read_b128 a[208:211], v11 offset:20480
v_cvt_pk_bf16_f32 v112, v112, v113
MV 180,a,180,v,20
ds_read_b128 a[212:215], v11 offset:21504
buffer_load_dwordx4 v12, s[56:59], s71 offen offset:1024 sc1 lds
MV 188,a,180,v,36
v_exp_f32 v116, v116
MV 176,a,164,v,20
v_exp_f32 v117, v117
MV 184,a,164,v,36
ds_read_b128 a[216:219], v11 offset:22528
ds_read_b128 a[220:223], v11 offset:23552
MV 148,a,148,v,20
ds_read_b128 a[224:227], v11 offset:24576
v_cvt_pk_bf16_f32 v113, v114, v115
MV 156,a,148,v,36
v_exp_f32 v118, v118
MV 144,a,132,v,20
v_exp_f32 v119, v119
MV 152,a,132,v,36
ds_read_b128 a[228:231], v11 offset:25600
buffer_load_dwordx4 v12, s[56:59], s71 offen offset:2048 sc1 lds
MV 144,a,136,v,24
ds_read_b128 a[232:235], v11 offset:26624
v_cvt_pk_bf16_f32 v114, v116, v117
MV 152,a,136,v,40
v_exp_f32 v120, v120
MV 148,a,152,v,24
ds_read_b128 a[236:239], v11 offset:27648
ds_read_b128 a[240:243], v11 offset:28672
MV 156,a,152,v,40
v_exp_f32 v121, v121
MV 176,a,168,v,24
ds_read_b128 a[244:247], v11 offset:29696
v_cvt_pk_bf16_f32 v115, v118, v119
MV 184,a,168,v,40
ds_read_b128 a[248:251], v11 offset:30720
buffer_load_dwordx4 v12, s[56:59], s71 offen offset:3072 sc1 lds
MV 180,a,184,v,24
v_exp_f32 v122, v122
MV 188,a,184,v,40
v_exp_f32 v123, v123
MV 180,a,188,v,28
ds_read_b128 a[252:255], v11 offset:31744
v_cvt_pk_bf16_f32 v120, v120, v121
MV 188,a,188,v,44
v_exp_f32 v124, v124
MV 176,a,172,v,28
v_exp_f32 v125, v125
MV 184,a,172,v,44
s_add_u32 s71, s71, 16384
v_cvt_pk_bf16_f32 v121, v122, v123
MV 148,a,156,v,28
v_exp_f32 v126, v126
MV 156,a,156,v,44
v_exp_f32 v127, v127
MV 144,a,140,v,28
v_cvt_pk_bf16_f32 v122, v124, v125
v_cvt_pk_bf16_f32 v123, v126, v127
MV 152,a,140,v,44
s_waitcnt vmcnt(16) lgkmcnt(0)
MA 0,a,192,v,80
s_barrier
MA 32,a,192,v,88
s_add_u32 m0, s72, 0
ds_read_b128 a[128:131], v10 offset:16384
MA 4,a,196,v,80
ds_read_b128 a[132:135], v10 offset:17408
buffer_load_dwordx4 v12, s[52:55], s71 offen offset:0 sc1 lds
MA 36,a,196,v,88
v_exp_f32 v144, v144
MA 8,a,200,v,80
v_exp_f32 v145, v145
MA 40,a,200,v,88
ds_read_b128 a[136:139], v10 offset:18432
ds_read_b128 a[140:143], v10 offset:19456
MA 12,a,204,v,80
v_exp_f32 v146, v146
MA 44,a,204,v,88
ds_read_b128 a[144:147], v10 offset:20480
buffer_load_dwordx4 v12, s[52:55], s71 offen offset:1024 sc1 lds
MV 164,v,160,v,80
v_exp_f32 v147, v147
MV 168,v,160,v,88
ds_read_b128 a[148:151], v10 offset:21504
v_cvt_pk_bf16_f32 v144, v144, v145
MA 16,a,208,v,80
v_exp_f32 v148, v148
MA 48,a,208,v,88
ds_read_b128 a[152:155], v10 offset:22528
ds_read_b128 a[156:159], v10 offset:23552
MA 20,a,212,v,80
v_exp_f32 v149, v149
MA 52,a,212,v,88
ds_read_b128 a[160:163], v10 offset:24576
v_cvt_pk_bf16_f32 v145, v146, v147
MA 24,a,216,v,80
v_exp_f32 v150, v150
MA 56,a,216,v,88
ds_read_b128 a[164:167], v10 offset:25600
buffer_load_dwordx4 v12, s[52:55], s71 offen offset:2048 sc1 lds
MA 28,a,220,v,80
v_exp_f32 v151, v151
MA 60,a,220,v,88
ds_read_b128 a[168:171], v10 offset:26624
v_cvt_pk_bf16_f32 v146, v148, v149
MA 0,a,224,v,112
ds_read_b128 a[172:175], v10 offset:27648
ds_read_b128 a[176:179], v10 offset:28672
MA 32,a,224,v,120
v_exp_f32 v152, v152
MA 4,a,228,v,112
v_exp_f32 v153, v153
MA 36,a,228,v,120
ds_read_b128 a[180:183], v10 offset:29696
v_cvt_pk_bf16_f32 v147, v150, v151
MA 8,a,232,v,112
ds_read_b128 a[184:187], v10 offset:30720
buffer_load_dwordx4 v12, s[52:55], s71 offen offset:3072 sc1 lds
MA 40,a,232,v,120
v_exp_f32 v154, v154
MA 12,a,236,v,112
v_exp_f32 v155, v155
MA 44,a,236,v,120
ds_read_b128 a[188:191], v10 offset:31744
v_cvt_pk_bf16_f32 v152, v152, v153
MV 164,v,160,v,112
v_exp_f32 v156, v156
MV 168,v,160,v,120
MA 16,a,240,v,112
v_exp_f32 v157, v157
MA 48,a,240,v,120
s_sub_u32 s74, s74, 1
v_cvt_pk_bf16_f32 v153, v154, v155
MA 20,a,244,v,112
v_exp_f32 v158, v158
MA 52,a,244,v,120
MA 24,a,248,v,112
v_exp_f32 v159, v159
MA 56,a,248,v,120
MA 28,a,252,v,112
v_cvt_pk_bf16_f32 v154, v156, v157
v_cvt_pk_bf16_f32 v155, v158, v159
MA 60,a,252,v,120
s_cbranch_scc1 L_p3_s1m_top
s_waitcnt lgkmcnt(0)
v_xor_b32 v11, 0x8000, v11
v_mfma_f32_16x16x32_bf16 v[80:83], a[128:131], v[16:19], 0
s_add_u32 m0, s73, 16384
ds_read_b128 a[192:195], v11 offset:0
v_mfma_f32_16x16x32_bf16 v[88:91], a[128:131], v[32:35], 0
v_exp_f32 v176, v176
v_mfma_f32_16x16x32_bf16 v[84:87], a[144:147], v[16:19], 0
ds_read_b128 a[196:199], v11 offset:1024
buffer_load_dwordx4 v12, s[56:59], s71 offen offset:0 sc1 lds
v_mfma_f32_16x16x32_bf16 v[92:95], a[144:147], v[32:35], 0
v_exp_f32 v177, v177
v_mfma_f32_16x16x32_bf16 v[112:115], a[160:163], v[16:19], 0
ds_read_b128 a[200:203], v11 offset:2048
ds_read_b128 a[204:207], v11 offset:3072
v_mfma_f32_16x16x32_bf16 v[120:123], a[160:163], v[32:35], 0
v_exp_f32 v178, v178
v_mfma_f32_16x16x32_bf16 v[116:119], a[176:179], v[16:19], 0
v_exp_f32 v179, v179
v_mfma_f32_16x16x32_bf16 v[124:127], a[176:179], v[32:35], 0
ds_read_b128 a[208:211], v11 offset:4096
buffer_load_dwordx4 v12, s[56:59], s71 offen offset:1024 sc1 lds
MV 116,a,180,v,20
ds_read_b128 a[212:215], v11 offset:5120
v_cvt_pk_bf16_f32 v176, v176, v177
MV 124,a,180,v,36
v_exp_f32 v180, v180
MV 112,a,164,v,20
v_exp_f32 v181, v181
MV 120,a,164,v,36
ds_read_b128 a[216:219], v11 offset:6144
ds_read_b128 a[220:223], v11 offset:7168
MV 84,a,148,v,20
buffer_load_dwordx4 v12, s[56:59], s71 offen offset:2048 sc1 lds
v_cvt_pk_bf16_f32 v177, v178, v179
MV 92,a,148,v,36
v_exp_f32 v182, v182
MV 80,a,132,v,20
ds_read_b128 a[224:227], v11 offset:8192
ds_read_b128 a[228:231], v11 offset:9216
MV 88,a,132,v,36
v_exp_f32 v183, v183
MV 80,a,136,v,24
ds_read_b128 a[232:235], v11 offset:10240
v_cvt_pk_bf16_f32 v178, v180, v181
MV 88,a,136,v,40
v_exp_f32 v184, v184
MV 84,a,152,v,24
ds_read_b128 a[236:239], v11 offset:11264
buffer_load_dwordx4 v12, s[56:59], s71 offen offset:3072 sc1 lds
MV 92,a,152,v,40
v_exp_f32 v185, v185
MV 112,a,168,v,24
ds_read_b128 a[240:243], v11 offset:12288
v_cvt_pk_bf16_f32 v179, v182, v183
MV 120,a,168,v,40
ds_read_b128 a[244:247], v11 offset:13312
ds_read_b128 a[248:251], v11 offset:14336
MV 116,a,184,v,24
v_exp_f32 v186, v186
MV 124,a,184,v,40
v_exp_f32 v187, v187
MV 116,a,188,v,28
ds_read_b128 a[252:255], v11 offset:15360
s_add_u32 s71, s71, 16384
MV 124,a,188,v,44
s_xor_b32 s73, s73, 0x8000
v_cvt_pk_bf16_f32 v184, v184, v185
MV 112,a,172,v,28
v_exp_f32 v188, v188
MV 120,a,172,v,44
v_exp_f32 v189, v189
MV 84,a,156,v,28
v_cvt_pk_bf16_f32 v185, v186, v187
MV 92,a,156,v,44
v_exp_f32 v190, v190
MV 80,a,140,v,28
v_exp_f32 v191, v191
MV 88,a,140,v,44
v_cvt_pk_bf16_f32 v186, v188, v189
v_cvt_pk_bf16_f32 v187, v190, v191
s_waitcnt vmcnt(16) lgkmcnt(0)
MA 0,a,192,v,144
s_barrier
v_xor_b32 v10, 0x8000, v10
MA 32,a,192,v,152
s_add_u32 m0, s72, 16384
ds_read_b128 a[128:131], v10 offset:0
MA 4,a,196,v,144
ds_read_b128 a[132:135], v10 offset:1024
buffer_load_dwordx4 v12, s[52:55], s71 offen offset:0 sc1 lds
MA 36,a,196,v,152
v_exp_f32 v80, v80
MA 8,a,200,v,144
v_exp_f32 v81, v81
MA 40,a,200,v,152
ds_read_b128 a[136:139], v10 offset:2048
ds_read_b128 a[140:143], v10 offset:3072
MA 12,a,204,v,144
v_exp_f32 v82, v82
MA 44,a,204,v,152
ds_read_b128 a[144:147], v10 offset:4096
buffer_load_dwordx4 v12, s[52:55], s71 offen offset:1024 sc1 lds
MV 164,v,160,v,144
v_exp_f32 v83, v83
MV 168,v,160,v,152
ds_read_b128 a[148:151], v10 offset:5120
v_cvt_pk_bf16_f32 v80, v80, v81
MA 16,a,208,v,144
v_exp_f32 v84, v84
MA 48,a,208,v,152
ds_read_b128 a[152:155], v10 offset:6144
buffer_load_dwordx4 v12, s[52:55], s71 offen offset:2048 sc1 lds
MA 20,a,212,v,144
v_exp_f32 v85, v85
MA 52,a,212,v,152
ds_read_b128 a[156:159], v10 offset:7168
v_cvt_pk_bf16_f32 v81, v82, v83
MA 24,a,216,v,144
v_exp_f32 v86, v86
MA 56,a,216,v,152
ds_read_b128 a[160:163], v10 offset:8192
ds_read_b128 a[164:167], v10 offset:9216
MA 28,a,220,v,144
v_exp_f32 v87, v87
MA 60,a,220,v,152
ds_read_b128 a[168:171], v10 offset:10240
buffer_load_dwordx4 v12, s[52:55], s71 offen offset:3072 sc1 lds
MA 0,a,224,v,176
ds_read_b128 a[172:175], v10 offset:11264
v_cvt_pk_bf16_f32 v82, v84, v85
MA 32,a,224,v,184
v_exp_f32 v88, v88
MA 4,a,228,v,176
v_exp_f32 v89, v89
MA 36,a,228,v,184
ds_read_b128 a[176:179], v10 offset:12288
s_xor_b32 s72, s72, 0x8000
MA 8,a,232,v,176
ds_read_b128 a[180:183], v10 offset:13312
v_cvt_pk_bf16_f32 v83, v86, v87
MA 40,a,232,v,184
v_exp_f32 v90, v90
MA 12,a,236,v,176
ds_read_b128 a[184:187], v10 offset:14336
ds_read_b128 a[188:191], v10 offset:15360
MA 44,a,236,v,184
v_exp_f32 v91, v91
MV 164,v,160,v,176
buffer_store_dword v237, v236, s[8:11], s37 offen offset:1024 sc1
v_cvt_pk_bf16_f32 v88, v88, v89
MV 168,v,160,v,184
v_exp_f32 v92, v92
MA 16,a,240,v,176
v_exp_f32 v93, v93
MA 48,a,240,v,184
MA 20,a,244,v,176
global_load_dword v174, v[172:173], off
v_cvt_pk_bf16_f32 v89, v90, v91
MA 52,a,244,v,184
v_exp_f32 v94, v94
MA 24,a,248,v,176
v_exp_f32 v95, v95
MA 56,a,248,v,184
MA 28,a,252,v,176
v_cvt_pk_bf16_f32 v90, v92, v93
v_cvt_pk_bf16_f32 v91, v94, v95
MA 60,a,252,v,184
s_branch L_p3_s0_top
L_p3_s1m_top:
s_waitcnt lgkmcnt(0)
v_xor_b32 v11, 0x8000, v11
v_mfma_f32_16x16x32_bf16 v[80:83], a[128:131], v[16:19], 0
ds_read_b128 a[192:195], v11 offset:0
ds_read_b128 a[196:199], v11 offset:1024
v_mfma_f32_16x16x32_bf16 v[88:91], a[128:131], v[32:35], 0
v_exp_f32 v176, v176
MV 80,a,132,v,20
v_exp_f32 v177, v177
MV 88,a,132,v,36
ds_read_b128 a[200:203], v11 offset:2048
ds_read_b128 a[204:207], v11 offset:3072
MV 80,a,136,v,24
v_exp_f32 v178, v178
MV 88,a,136,v,40
v_exp_f32 v179, v179
MV 80,a,140,v,28
ds_read_b128 a[208:211], v11 offset:4096
v_cvt_pk_bf16_f32 v176, v176, v177
MV 88,a,140,v,44
ds_read_b128 a[212:215], v11 offset:5120
ds_read_b128 a[216:219], v11 offset:6144
v_mfma_f32_16x16x32_bf16 v[84:87], a[144:147], v[16:19], 0
v_exp_f32 v180, v180
v_mfma_f32_16x16x32_bf16 v[92:95], a[144:147], v[32:35], 0
v_exp_f32 v181, v181
MV 84,a,148,v,20
ds_read_b128 a[220:223], v11 offset:7168
v_cvt_pk_bf16_f32 v177, v178, v179
MV 92,a,148,v,36
v_exp_f32 v182, v182
MV 84,a,152,v,24
ds_read_b128 a[224:227], v11 offset:8192
ds_read_b128 a[228:231], v11 offset:9216
MV 92,a,152,v,40
v_exp_f32 v183, v183
MV 84,a,156,v,28
ds_read_b128 a[232:235], v11 offset:10240
v_cvt_pk_bf16_f32 v178, v180, v181
MV 92,a,156,v,44
v_exp_f32 v184, v184
v_mfma_f32_16x16x32_bf16 v[112:115], a[160:163], v[16:19], 0
ds_read_b128 a[236:239], v11 offset:11264
ds_read_b128 a[240:243], v11 offset:12288
v_mfma_f32_16x16x32_bf16 v[120:123], a[160:163], v[32:35], 0
v_exp_f32 v185, v185
MV 112,a,164,v,20
ds_read_b128 a[244:247], v11 offset:13312
v_cvt_pk_bf16_f32 v179, v182, v183
MV 120,a,164,v,36
v_exp_f32 v186, v186
MV 112,a,168,v,24
v_exp_f32 v187, v187
MV 120,a,168,v,40
ds_read_b128 a[248:251], v11 offset:14336
ds_read_b128 a[252:255], v11 offset:15360
MV 112,a,172,v,28
v_cvt_pk_bf16_f32 v184, v184, v185
v_add_u32 v246, 0, v13
MV 120,a,172,v,44
v_cmp_gt_i32_e64 s[84:85], 0, v246
v_cmp_gt_i32_e64 s[86:87], 1, v246
v_mfma_f32_16x16x32_bf16 v[116:119], a[176:179], v[16:19], 0
v_exp_f32 v188, v188
v_mfma_f32_16x16x32_bf16 v[124:127], a[176:179], v[32:35], 0
v_cmp_gt_i32_e64 s[88:89], 2, v246
v_cmp_gt_i32_e64 s[90:91], 3, v246
MV 116,a,180,v,20
v_cndmask_b32_e64 v80, v80, v14, s[84:85]
v_cndmask_b32_e64 v81, v81, v14, s[86:87]
MV 124,a,180,v,36
v_exp_f32 v189, v189
MV 116,a,184,v,24
v_cvt_pk_bf16_f32 v185, v186, v187
v_cndmask_b32_e64 v82, v82, v14, s[88:89]
MV 124,a,184,v,40
v_cndmask_b32_e64 v83, v83, v14, s[90:91]
v_add_u32 v247, -16, v13
MV 116,a,188,v,28
v_cmp_gt_i32_e64 s[92:93], 0, v247
v_cmp_gt_i32_e64 s[94:95], 1, v247
MV 124,a,188,v,44
v_exp_f32 v190, v190
v_exp_f32 v191, v191
v_cmp_gt_i32_e64 s[96:97], 2, v247
v_cmp_gt_i32_e64 s[98:99], 3, v247
v_cndmask_b32_e64 v84, v84, v14, s[92:93]
v_cvt_pk_bf16_f32 v186, v188, v189
v_cndmask_b32_e64 v85, v85, v14, s[94:95]
v_cndmask_b32_e64 v86, v86, v14, s[96:97]
v_cvt_pk_bf16_f32 v187, v190, v191
v_cndmask_b32_e64 v87, v87, v14, s[98:99]
s_waitcnt vmcnt(12) lgkmcnt(0)
MA 0,a,192,v,144
s_barrier
v_xor_b32 v10, 0x8000, v10
MA 32,a,192,v,152
ds_read_b128 a[128:131], v10 offset:0
ds_read_b128 a[132:135], v10 offset:1024
MA 4,a,196,v,144
v_exp_f32 v80, v80
MA 36,a,196,v,152
v_exp_f32 v81, v81
MA 8,a,200,v,144
ds_read_b128 a[136:139], v10 offset:2048
ds_read_b128 a[140:143], v10 offset:3072
MA 40,a,200,v,152
v_exp_f32 v82, v82
MA 12,a,204,v,144
ds_read_b128 a[144:147], v10 offset:4096
v_add_u32 v246, -32, v13
MA 44,a,204,v,152
v_exp_f32 v83, v83
MV 164,v,160,v,144
v_cvt_pk_bf16_f32 v80, v80, v81
v_cmp_gt_i32_e64 s[84:85], 0, v246
MV 168,v,160,v,152
ds_read_b128 a[148:151], v10 offset:5120
v_cmp_gt_i32_e64 s[86:87], 1, v246
MA 16,a,208,v,144
v_exp_f32 v84, v84
MA 48,a,208,v,152
ds_read_b128 a[152:155], v10 offset:6144
v_cmp_gt_i32_e64 s[88:89], 2, v246
MA 20,a,212,v,144
v_exp_f32 v85, v85
MA 52,a,212,v,152
ds_read_b128 a[156:159], v10 offset:7168
v_cmp_gt_i32_e64 s[90:91], 3, v246
MA 24,a,216,v,144
ds_read_b128 a[160:163], v10 offset:8192
v_cvt_pk_bf16_f32 v81, v82, v83
MA 56,a,216,v,152
v_exp_f32 v86, v86
MA 28,a,220,v,144
ds_read_b128 a[164:167], v10 offset:9216
v_cndmask_b32_e64 v112, v112, v14, s[84:85]
MA 60,a,220,v,152
v_exp_f32 v87, v87
MA 0,a,224,v,176
ds_read_b128 a[168:171], v10 offset:10240
v_cndmask_b32_e64 v113, v113, v14, s[86:87]
MA 32,a,224,v,184
v_cvt_pk_bf16_f32 v82, v84, v85
v_cndmask_b32_e64 v114, v114, v14, s[88:89]
MA 4,a,228,v,176
ds_read_b128 a[172:175], v10 offset:11264
v_cndmask_b32_e64 v115, v115, v14, s[90:91]
MA 36,a,228,v,184
v_exp_f32 v88, v88
MA 8,a,232,v,176
v_exp_f32 v89, v89
MA 40,a,232,v,184
ds_read_b128 a[176:179], v10 offset:12288
v_cvt_pk_bf16_f32 v83, v86, v87
MA 12,a,236,v,176
ds_read_b128 a[180:183], v10 offset:13312
v_add_u32 v247, -48, v13
MA 44,a,236,v,184
ds_read_b128 a[184:187], v10 offset:14336
v_cmp_gt_i32_e64 s[92:93], 0, v247
MV 164,v,160,v,176
v_exp_f32 v90, v90
MV 168,v,160,v,184
ds_read_b128 a[188:191], v10 offset:15360
v_cmp_gt_i32_e64 s[94:95], 1, v247
MA 16,a,240,v,176
v_exp_f32 v91, v91
MA 48,a,240,v,184
v_cvt_pk_bf16_f32 v88, v88, v89
v_cmp_gt_i32_e64 s[96:97], 2, v247
MA 20,a,244,v,176
v_exp_f32 v92, v92
MA 52,a,244,v,184
v_cmp_gt_i32_e64 s[98:99], 3, v247
v_cndmask_b32_e64 v116, v116, v14, s[92:93]
MA 24,a,248,v,176
v_exp_f32 v93, v93
MA 56,a,248,v,184
v_cvt_pk_bf16_f32 v89, v90, v91
v_cndmask_b32_e64 v117, v117, v14, s[94:95]
MA 28,a,252,v,176
v_exp_f32 v94, v94
MA 60,a,252,v,184
v_exp_f32 v95, v95
v_cndmask_b32_e64 v118, v118, v14, s[96:97]
v_cvt_pk_bf16_f32 v90, v92, v93
v_cndmask_b32_e64 v119, v119, v14, s[98:99]
v_cvt_pk_bf16_f32 v91, v94, v95
L_p3_s0m_top:
s_waitcnt lgkmcnt(0)
v_mfma_f32_16x16x32_bf16 v[152:155], a[128:131], v[32:35], 0
ds_read_b128 a[192:195], v11 offset:16384
ds_read_b128 a[196:199], v11 offset:17408
MV 152,a,132,v,36
v_exp_f32 v112, v112
MV 152,a,136,v,40
v_exp_f32 v113, v113
MV 152,a,140,v,44
ds_read_b128 a[200:203], v11 offset:18432
ds_read_b128 a[204:207], v11 offset:19456
v_mfma_f32_16x16x32_bf16 v[156:159], a[144:147], v[32:35], 0
v_exp_f32 v114, v114
MV 156,a,148,v,36
v_exp_f32 v115, v115
MV 156,a,152,v,40
ds_read_b128 a[208:211], v11 offset:20480
ds_read_b128 a[212:215], v11 offset:21504
MV 156,a,156,v,44
ds_read_b128 a[216:219], v11 offset:22528
v_cvt_pk_bf16_f32 v112, v112, v113
v_mfma_f32_16x16x32_bf16 v[184:187], a[160:163], v[32:35], 0
v_exp_f32 v116, v116
MV 184,a,164,v,36
v_exp_f32 v117, v117
MV 184,a,168,v,40
ds_read_b128 a[220:223], v11 offset:23552
v_cvt_pk_bf16_f32 v113, v114, v115
MV 184,a,172,v,44
v_exp_f32 v118, v118
v_mfma_f32_16x16x32_bf16 v[188:191], a[176:179], v[32:35], 0
ds_read_b128 a[224:227], v11 offset:24576
ds_read_b128 a[228:231], v11 offset:25600
MV 188,a,180,v,36
v_exp_f32 v119, v119
MV 188,a,184,v,40
ds_read_b128 a[232:235], v11 offset:26624
v_cvt_pk_bf16_f32 v114, v116, v117
MV 188,a,188,v,44
ds_read_b128 a[236:239], v11 offset:27648
ds_read_b128 a[240:243], v11 offset:28672
ds_read_b128 a[244:247], v11 offset:29696
ds_read_b128 a[248:251], v11 offset:30720
ds_read_b128 a[252:255], v11 offset:31744
v_exp_f32 v120, v120
v_exp_f32 v121, v121
v_cvt_pk_bf16_f32 v115, v118, v119
v_exp_f32 v122, v122
v_exp_f32 v123, v123
v_cvt_pk_bf16_f32 v120, v120, v121
v_exp_f32 v124, v124
v_exp_f32 v125, v125
v_cvt_pk_bf16_f32 v121, v122, v123
v_exp_f32 v126, v126
v_exp_f32 v127, v127
v_add_u32 v246, -64, v239
v_cmp_gt_i32_e64 s[84:85], 0, v246
v_cmp_gt_i32_e64 s[86:87], 1, v246
v_cmp_gt_i32_e64 s[88:89], 2, v246
v_cmp_gt_i32_e64 s[90:91], 3, v246
v_cndmask_b32_e64 v152, v152, v14, s[84:85]
v_cndmask_b32_e64 v153, v153, v14, s[86:87]
v_cndmask_b32_e64 v154, v154, v14, s[88:89]
v_cndmask_b32_e64 v155, v155, v14, s[90:91]
v_cvt_pk_bf16_f32 v122, v124, v125
v_cvt_pk_bf16_f32 v123, v126, v127
v_add_u32 v247, -80, v239
v_cmp_gt_i32_e64 s[92:93], 0, v247
v_cmp_gt_i32_e64 s[94:95], 1, v247
v_cmp_gt_i32_e64 s[96:97], 2, v247
v_cmp_gt_i32_e64 s[98:99], 3, v247
v_cndmask_b32_e64 v156, v156, v14, s[92:93]
v_cndmask_b32_e64 v157, v157, v14, s[94:95]
v_cndmask_b32_e64 v158, v158, v14, s[96:97]
v_cndmask_b32_e64 v159, v159, v14, s[98:99]
s_waitcnt vmcnt(4) lgkmcnt(0)
MA 0,a,192,v,80
s_barrier
MA 32,a,192,v,88
MA 4,a,196,v,80
v_lshlrev_b32 v245, 4, v1
s_mov_b32 m0, s43
MA 36,a,196,v,88
v_exp_f32 v152, v152
MA 8,a,200,v,80
MA 40,a,200,v,88
v_exp_f32 v153, v153
MA 12,a,204,v,80
v_add_u32 v246, -96, v239
v_cmp_gt_i32_e64 s[84:85], 0, v246
MA 44,a,204,v,88
MV 164,v,160,v,80
v_exp_f32 v154, v154
MV 168,v,160,v,88
s_nop 0
v_cmp_gt_i32_e64 s[86:87], 1, v246
MA 16,a,208,v,80
MA 48,a,208,v,88
v_cmp_gt_i32_e64 s[88:89], 2, v246
v_cmp_gt_i32_e64 s[90:91], 3, v246
MA 20,a,212,v,80
v_exp_f32 v155, v155
MA 52,a,212,v,88
MA 24,a,216,v,80
v_cvt_pk_bf16_f32 v152, v152, v153
v_cndmask_b32_e64 v184, v184, v14, s[84:85]
MA 56,a,216,v,88
MA 28,a,220,v,80
buffer_load_dwordx4 v245, s[20:23], 0 offen offset:0 sc1 lds
v_cndmask_b32_e64 v185, v185, v14, s[86:87]
MA 60,a,220,v,88
v_exp_f32 v156, v156
MA 0,a,224,v,112
v_cndmask_b32_e64 v186, v186, v14, s[88:89]
v_cndmask_b32_e64 v187, v187, v14, s[90:91]
MA 32,a,224,v,120
MA 4,a,228,v,112
v_exp_f32 v157, v157
MA 36,a,228,v,120
buffer_load_dwordx4 v245, s[20:23], 0 offen offset:1024 sc1 lds
v_add_u32 v247, -112, v239
MA 8,a,232,v,112
v_cvt_pk_bf16_f32 v153, v154, v155
v_cmp_gt_i32_e64 s[92:93], 0, v247
MA 40,a,232,v,120
MA 12,a,236,v,112
buffer_load_dwordx4 v245, s[20:23], 0 offen offset:2048 sc1 lds
v_cmp_gt_i32_e64 s[94:95], 1, v247
MA 44,a,236,v,120
v_exp_f32 v158, v158
MV 164,v,160,v,112
v_cmp_gt_i32_e64 s[96:97], 2, v247
v_cmp_gt_i32_e64 s[98:99], 3, v247
MV 168,v,160,v,120
MA 16,a,240,v,112
MA 48,a,240,v,120
v_exp_f32 v159, v159
MA 20,a,244,v,112
buffer_load_dwordx4 v245, s[20:23], 0 offen offset:3072 sc1 lds
v_cndmask_b32_e64 v188, v188, v14, s[92:93]
MA 52,a,244,v,120
v_cvt_pk_bf16_f32 v154, v156, v157
v_cndmask_b32_e64 v189, v189, v14, s[94:95]
MA 24,a,248,v,112
v_cvt_pk_bf16_f32 v155, v158, v159
v_cndmask_b32_e64 v190, v190, v14, s[96:97]
MA 56,a,248,v,120
MA 28,a,252,v,112
v_cndmask_b32_e64 v191, v191, v14, s[98:99]
MA 60,a,252,v,120
s_load_dwordx2 s[88:89], s[0:1], 104
s_waitcnt lgkmcnt(0)
v_xor_b32 v11, 0x8000, v11
ds_read_b128 a[192:195], v11 offset:0
ds_read_b128 a[196:199], v11 offset:1024
ds_read_b128 a[200:203], v11 offset:2048
ds_read_b128 a[204:207], v11 offset:3072
ds_read_b128 a[208:211], v11 offset:4096
ds_read_b128 a[212:215], v11 offset:5120
ds_read_b128 a[216:219], v11 offset:6144
ds_read_b128 a[220:223], v11 offset:7168
ds_read_b128 a[224:227], v11 offset:8192
ds_read_b128 a[228:231], v11 offset:9216
ds_read_b128 a[232:235], v11 offset:10240
ds_read_b128 a[236:239], v11 offset:11264
ds_read_b128 a[240:243], v11 offset:12288
ds_read_b128 a[244:247], v11 offset:13312
ds_read_b128 a[248:251], v11 offset:14336
ds_read_b128 a[252:255], v11 offset:15360
v_exp_f32 v184, v184
v_exp_f32 v185, v185
v_exp_f32 v186, v186
v_exp_f32 v187, v187
v_cvt_pk_bf16_f32 v184, v184, v185
v_exp_f32 v188, v188
v_exp_f32 v189, v189
v_cvt_pk_bf16_f32 v185, v186, v187
v_exp_f32 v190, v190
v_exp_f32 v191, v191
v_cvt_pk_bf16_f32 v186, v188, v189
v_cvt_pk_bf16_f32 v187, v190, v191
MV 168,v,160,v,152
s_nop 0
MV 168,v,160,v,184
v_mov_b32 v240, v2
v_mov_b32 v241, v3
s_nop 0
v_permlane32_swap_b32 v2, v240
v_permlane32_swap_b32 v3, v241
v_add_f32 v2, v2, v240
v_add_f32 v3, v3, v241
v_mov_b32 v240, v2
v_mov_b32 v241, v3
s_nop 0
v_permlane16_swap_b32 v2, v240
v_permlane16_swap_b32 v3, v241
v_add_f32 v2, v2, v240
v_add_f32 v3, v3, v241
v_add_f32 v2, v2, v164
v_cmp_nle_f32 vcc, 0x30800000, v2
s_nop 0
s_or_b64 s[78:79], s[78:79], vcc
v_cmp_nge_f32 vcc, 0x4e800000, v2
s_nop 0
s_or_b64 s[78:79], s[78:79], vcc
v_add_f32 v3, v3, v168
v_cmp_nle_f32 vcc, 0x30800000, v3
s_nop 0
s_or_b64 s[78:79], s[78:79], vcc
v_cmp_nge_f32 vcc, 0x4e800000, v3
s_nop 0
s_or_b64 s[78:79], s[78:79], vcc
s_cmp_lg_u64 s[78:79], 0
s_cselect_b32 s80, 1, 0
v_mov_b32 v240, s80
s_lshl_b32 s80, s3, 2
s_add_u32 s80, s80, 163824
v_mov_b32 v241, s80
ds_write_b32 v241, v240
v_mov_b32 v241, 163824
s_waitcnt vmcnt(0) lgkmcnt(0)
s_barrier
ds_read_b128 v[244:247], v241
buffer_store_dword v237, v236, s[8:11], s37 offen offset:1024 sc1
MA 32,a,192,v,152
MA 36,a,196,v,152
MA 40,a,200,v,152
MA 44,a,204,v,152
MA 48,a,208,v,152
MA 52,a,212,v,152
s_waitcnt lgkmcnt(0)
v_or3_b32 v240, v244, v245, v246
v_or_b32 v240, v240, v247
MA 56,a,216,v,152
v_cmp_ne_u32 vcc, 0, v240
MA 60,a,220,v,152
MA 32,a,224,v,184
s_cbranch_vccnz L_fallback
MA 36,a,228,v,184
s_mul_i32 s36, s3, 8320
v_and_b32 v16, 15, v1
MA 40,a,232,v,184
v_lshrrev_b32 v17, 4, v1
v_add_u32 v18, 1, v16
MA 44,a,236,v,184
v_and_b32 v19, 1, v18
v_mul_u32_u24 v19, 4160, v19
MA 48,a,240,v,184
v_add_u32 v18, 2, v16
v_lshrrev_b32 v18, 1, v18
MA 52,a,244,v,184
v_lshl_add_u32 v19, v18, 2, v19
v_lshl_add_u32 v19, v17, 4, v19
MA 56,a,248,v,184
v_add_u32 v40, s36, v19
v_add_u32 v41, 1024, v40
MA 60,a,252,v,184
v_add_u32 v42, 2048, v40
v_add_u32 v43, 3072, v40
v_add_u32 v10, s36, v232
v_lshlrev_b32 v18, 5, v16
v_lshlrev_b32 v19, 4, v17
v_sub_u32 v19, v19, v18
s_add_u32 s37, s43, 480
v_add_u32 v5, s37, v19
v_mov_b32 v20, 0
v_mov_b32 v21, 0
v_mov_b32 v22, 0
v_mov_b32 v23, 0
v_and_b32 v16, 1, v1
v_mul_u32_u24 v16, 4160, v16
v_and_b32 v17, 2, v1
v_lshl_add_u32 v16, v17, 3, v16
v_add_u32 v16, s36, v16
ds_write_b128 v16, v[20:23]
v_and_b32 v17, 31, v1
v_lshlrev_b32 v17, 4, v17
v_add_u32 v17, s43, v17
ds_write_b128 v17, v[20:23] offset:4096
v_mov_b32 v209, 0
ds_write_b128 v10, v[210:213] offset:32
s_nop 0
v_mov_b32_dpp v209, v213 wave_shr:1 row_mask:0xf bank_mask:0xf
v_alignbit_b32 v24, v210, v209, 16
v_alignbit_b32 v25, v211, v210, 16
v_alignbit_b32 v26, v212, v211, 16
v_alignbit_b32 v27, v213, v212, 16
ds_write_b128 v10, v[24:27] offset:4192
v_mov_b32_dpp v215, v213 wave_ror:1 row_mask:0xf bank_mask:0xf
ds_write_b128 v10, v[216:219] offset:1056
s_nop 0
v_mov_b32_dpp v215, v219 wave_shr:1 row_mask:0xf bank_mask:0xf
v_alignbit_b32 v28, v216, v215, 16
v_alignbit_b32 v29, v217, v216, 16
v_alignbit_b32 v30, v218, v217, 16
v_alignbit_b32 v31, v219, v218, 16
ds_write_b128 v10, v[28:31] offset:5216
v_mov_b32_dpp v221, v219 wave_ror:1 row_mask:0xf bank_mask:0xf
ds_write_b128 v10, v[222:225] offset:2080
s_nop 0
v_mov_b32_dpp v221, v225 wave_shr:1 row_mask:0xf bank_mask:0xf
v_alignbit_b32 v24, v222, v221, 16
v_alignbit_b32 v25, v223, v222, 16
v_alignbit_b32 v26, v224, v223, 16
v_alignbit_b32 v27, v225, v224, 16
ds_write_b128 v10, v[24:27] offset:6240
v_mov_b32_dpp v227, v225 wave_ror:1 row_mask:0xf bank_mask:0xf
ds_write_b128 v10, v[228:231] offset:3104
s_nop 0
v_mov_b32_dpp v227, v231 wave_shr:1 row_mask:0xf bank_mask:0xf
v_alignbit_b32 v28, v228, v227, 16
v_alignbit_b32 v29, v229, v228, 16
v_alignbit_b32 v30, v230, v229, 16
v_alignbit_b32 v31, v231, v230, 16
ds_write_b128 v10, v[28:31] offset:7264
v_rcp_f32 v2, v2
v_rcp_f32 v3, v3
s_add_u32 s80, s100, s76
s_nop 4
v_accvgpr_read_b32 v240, a0
v_accvgpr_read_b32 v241, a1
v_accvgpr_read_b32 v242, a2
v_accvgpr_read_b32 v243, a3
v_accvgpr_read_b32 v244, a4
v_accvgpr_read_b32 v245, a5
v_accvgpr_read_b32 v246, a6
v_accvgpr_read_b32 v247, a7
v_pk_mul_f32 v[240:241], v[240:241], v[2:3] op_sel:[0,0] op_sel_hi:[1,0]
v_pk_mul_f32 v[242:243], v[242:243], v[2:3] op_sel:[0,0] op_sel_hi:[1,0]
v_pk_mul_f32 v[244:245], v[244:245], v[2:3] op_sel:[0,0] op_sel_hi:[1,0]
v_pk_mul_f32 v[246:247], v[246:247], v[2:3] op_sel:[0,0] op_sel_hi:[1,0]
v_cvt_pk_bf16_f32 v248, v240, v241
v_cvt_pk_bf16_f32 v249, v242, v243
v_cvt_pk_bf16_f32 v250, v244, v245
v_cvt_pk_bf16_f32 v251, v246, v247
buffer_store_dwordx4 v[248:251], v15, s[60:63], s100 offen offset:0 sc1
v_accvgpr_read_b32 v240, a8
v_accvgpr_read_b32 v241, a9
v_accvgpr_read_b32 v242, a10
v_accvgpr_read_b32 v243, a11
v_accvgpr_read_b32 v244, a12
v_accvgpr_read_b32 v245, a13
v_accvgpr_read_b32 v246, a14
v_accvgpr_read_b32 v247, a15
v_pk_mul_f32 v[240:241], v[240:241], v[2:3] op_sel:[0,0] op_sel_hi:[1,0]
v_pk_mul_f32 v[242:243], v[242:243], v[2:3] op_sel:[0,0] op_sel_hi:[1,0]
v_pk_mul_f32 v[244:245], v[244:245], v[2:3] op_sel:[0,0] op_sel_hi:[1,0]
v_pk_mul_f32 v[246:247], v[246:247], v[2:3] op_sel:[0,0] op_sel_hi:[1,0]
v_cvt_pk_bf16_f32 v252, v240, v241
v_cvt_pk_bf16_f32 v253, v242, v243
v_cvt_pk_bf16_f32 v254, v244, v245
v_cvt_pk_bf16_f32 v255, v246, v247
buffer_store_dwordx4 v[252:255], v15, s[60:63], s100 offen offset:1024 sc1
v_accvgpr_read_b32 v240, a16
v_accvgpr_read_b32 v241, a17
v_accvgpr_read_b32 v242, a18
v_accvgpr_read_b32 v243, a19
v_accvgpr_read_b32 v244, a20
v_accvgpr_read_b32 v245, a21
v_accvgpr_read_b32 v246, a22
v_accvgpr_read_b32 v247, a23
v_pk_mul_f32 v[240:241], v[240:241], v[2:3] op_sel:[0,0] op_sel_hi:[1,0]
v_pk_mul_f32 v[242:243], v[242:243], v[2:3] op_sel:[0,0] op_sel_hi:[1,0]
v_pk_mul_f32 v[244:245], v[244:245], v[2:3] op_sel:[0,0] op_sel_hi:[1,0]
v_pk_mul_f32 v[246:247], v[246:247], v[2:3] op_sel:[0,0] op_sel_hi:[1,0]
v_cvt_pk_bf16_f32 v248, v240, v241
v_cvt_pk_bf16_f32 v249, v242, v243
v_cvt_pk_bf16_f32 v250, v244, v245
v_cvt_pk_bf16_f32 v251, v246, v247
buffer_store_dwordx4 v[248:251], v15, s[60:63], s100 offen offset:2048 sc1
v_accvgpr_read_b32 v240, a24
v_accvgpr_read_b32 v241, a25
v_accvgpr_read_b32 v242, a26
v_accvgpr_read_b32 v243, a27
v_accvgpr_read_b32 v244, a28
v_accvgpr_read_b32 v245, a29
v_accvgpr_read_b32 v246, a30
v_accvgpr_read_b32 v247, a31
v_pk_mul_f32 v[240:241], v[240:241], v[2:3] op_sel:[0,0] op_sel_hi:[1,0]
v_pk_mul_f32 v[242:243], v[242:243], v[2:3] op_sel:[0,0] op_sel_hi:[1,0]
v_pk_mul_f32 v[244:245], v[244:245], v[2:3] op_sel:[0,0] op_sel_hi:[1,0]
v_pk_mul_f32 v[246:247], v[246:247], v[2:3] op_sel:[0,0] op_sel_hi:[1,0]
v_cvt_pk_bf16_f32 v252, v240, v241
v_cvt_pk_bf16_f32 v253, v242, v243
v_cvt_pk_bf16_f32 v254, v244, v245
v_cvt_pk_bf16_f32 v255, v246, v247
buffer_store_dwordx4 v[252:255], v15, s[60:63], s100 offen offset:3072 sc1
v_accvgpr_read_b32 v240, a32
v_accvgpr_read_b32 v241, a33
v_accvgpr_read_b32 v242, a34
v_accvgpr_read_b32 v243, a35
v_accvgpr_read_b32 v244, a36
v_accvgpr_read_b32 v245, a37
v_accvgpr_read_b32 v246, a38
v_accvgpr_read_b32 v247, a39
v_pk_mul_f32 v[240:241], v[240:241], v[2:3] op_sel:[0,1] op_sel_hi:[1,1]
v_pk_mul_f32 v[242:243], v[242:243], v[2:3] op_sel:[0,1] op_sel_hi:[1,1]
v_pk_mul_f32 v[244:245], v[244:245], v[2:3] op_sel:[0,1] op_sel_hi:[1,1]
v_pk_mul_f32 v[246:247], v[246:247], v[2:3] op_sel:[0,1] op_sel_hi:[1,1]
v_cvt_pk_bf16_f32 v248, v240, v241
v_cvt_pk_bf16_f32 v249, v242, v243
v_cvt_pk_bf16_f32 v250, v244, v245
v_cvt_pk_bf16_f32 v251, v246, v247
buffer_store_dwordx4 v[248:251], v15, s[60:63], s80 offen offset:0 sc1
v_accvgpr_read_b32 v240, a40
v_accvgpr_read_b32 v241, a41
v_accvgpr_read_b32 v242, a42
v_accvgpr_read_b32 v243, a43
v_accvgpr_read_b32 v244, a44
v_accvgpr_read_b32 v245, a45
v_accvgpr_read_b32 v246, a46
v_accvgpr_read_b32 v247, a47
v_pk_mul_f32 v[240:241], v[240:241], v[2:3] op_sel:[0,1] op_sel_hi:[1,1]
v_pk_mul_f32 v[242:243], v[242:243], v[2:3] op_sel:[0,1] op_sel_hi:[1,1]
v_pk_mul_f32 v[244:245], v[244:245], v[2:3] op_sel:[0,1] op_sel_hi:[1,1]
v_pk_mul_f32 v[246:247], v[246:247], v[2:3] op_sel:[0,1] op_sel_hi:[1,1]
v_cvt_pk_bf16_f32 v252, v240, v241
v_cvt_pk_bf16_f32 v253, v242, v243
v_cvt_pk_bf16_f32 v254, v244, v245
v_cvt_pk_bf16_f32 v255, v246, v247
buffer_store_dwordx4 v[252:255], v15, s[60:63], s80 offen offset:1024 sc1
v_accvgpr_read_b32 v240, a48
v_accvgpr_read_b32 v241, a49
v_accvgpr_read_b32 v242, a50
v_accvgpr_read_b32 v243, a51
v_accvgpr_read_b32 v244, a52
v_accvgpr_read_b32 v245, a53
v_accvgpr_read_b32 v246, a54
v_accvgpr_read_b32 v247, a55
v_pk_mul_f32 v[240:241], v[240:241], v[2:3] op_sel:[0,1] op_sel_hi:[1,1]
v_pk_mul_f32 v[242:243], v[242:243], v[2:3] op_sel:[0,1] op_sel_hi:[1,1]
v_pk_mul_f32 v[244:245], v[244:245], v[2:3] op_sel:[0,1] op_sel_hi:[1,1]
v_pk_mul_f32 v[246:247], v[246:247], v[2:3] op_sel:[0,1] op_sel_hi:[1,1]
v_cvt_pk_bf16_f32 v248, v240, v241
v_cvt_pk_bf16_f32 v249, v242, v243
v_cvt_pk_bf16_f32 v250, v244, v245
v_cvt_pk_bf16_f32 v251, v246, v247
buffer_store_dwordx4 v[248:251], v15, s[60:63], s80 offen offset:2048 sc1
v_accvgpr_read_b32 v240, a56
v_accvgpr_read_b32 v241, a57
v_accvgpr_read_b32 v242, a58
v_accvgpr_read_b32 v243, a59
v_accvgpr_read_b32 v244, a60
v_accvgpr_read_b32 v245, a61
v_accvgpr_read_b32 v246, a62
v_accvgpr_read_b32 v247, a63
v_pk_mul_f32 v[240:241], v[240:241], v[2:3] op_sel:[0,1] op_sel_hi:[1,1]
v_pk_mul_f32 v[242:243], v[242:243], v[2:3] op_sel:[0,1] op_sel_hi:[1,1]
v_pk_mul_f32 v[244:245], v[244:245], v[2:3] op_sel:[0,1] op_sel_hi:[1,1]
v_pk_mul_f32 v[246:247], v[246:247], v[2:3] op_sel:[0,1] op_sel_hi:[1,1]
v_cvt_pk_bf16_f32 v252, v240, v241
v_cvt_pk_bf16_f32 v253, v242, v243
v_cvt_pk_bf16_f32 v254, v244, v245
v_cvt_pk_bf16_f32 v255, v246, v247
buffer_store_dwordx4 v[252:255], v15, s[60:63], s80 offen offset:3072 sc1
L_p3_done:
s_waitcnt lgkmcnt(0)
ds_read_b128 a[160:163], v5 offset:3584
ds_read2_b32 a[128:129], v40 offset0:0 offset1:1
ds_read2_b32 a[130:131], v40 offset0:2 offset1:3
ds_read_b128 a[164:167], v5 offset:3072
ds_read2_b32 a[132:133], v40 offset0:128 offset1:129
ds_read2_b32 a[134:135], v40 offset0:130 offset1:131
ds_read_b128 a[168:171], v5 offset:2560
ds_read2_b32 a[136:137], v41 offset0:0 offset1:1
ds_read2_b32 a[138:139], v41 offset0:2 offset1:3
ds_read_b128 a[172:175], v5 offset:2048
ds_read2_b32 a[140:141], v41 offset0:128 offset1:129
ds_read2_b32 a[142:143], v41 offset0:130 offset1:131
ds_read_b128 a[176:179], v5 offset:1536
ds_read2_b32 a[144:145], v42 offset0:0 offset1:1
ds_read2_b32 a[146:147], v42 offset0:2 offset1:3
ds_read_b128 a[180:183], v5 offset:1024
ds_read2_b32 a[148:149], v42 offset0:128 offset1:129
ds_read2_b32 a[150:151], v42 offset0:130 offset1:131
ds_read_b128 a[184:187], v5 offset:512
ds_read2_b32 a[152:153], v43 offset0:0 offset1:1
ds_read2_b32 a[154:155], v43 offset0:2 offset1:3
ds_read_b128 a[188:191], v5 offset:0
ds_read2_b32 a[156:157], v43 offset0:128 offset1:129
ds_read2_b32 a[158:159], v43 offset0:130 offset1:131
v_lshlrev_b32 v255, 20, v1
v_mov_b32 v253, 1
s_lshl_b32 s83, s3, 8
s_add_u32 s83, s83, s2
s_lshl_b32 s83, s83, 2
s_add_u32 s83, s83, 4096
s_waitcnt lgkmcnt(15)
v_mfma_f32_16x16x32_bf16 v[76:79], a[128:131], a[160:163], 0
v_and_b32 v16, 15, v1
v_lshrrev_b32 v17, 4, v1
v_mfma_f32_16x16x32_bf16 v[80:83], a[128:131], a[164:167], 0
v_lshl_add_u32 v18, v17, 3, v16
ds_read_b128 a[224:227], v5 offset:3648
v_mfma_f32_16x16x32_bf16 v[84:87], a[128:131], a[168:171], 0
v_sub_u32 v235, 15, v18
ds_read2_b32 a[192:193], v40 offset0:16 offset1:17
s_waitcnt lgkmcnt(15)
v_mfma_f32_16x16x32_bf16 v[88:91], a[128:131], a[172:175], 0
v_lshlrev_b32 v18, 16, v234
ds_read2_b32 a[194:195], v40 offset0:18 offset1:19
s_waitcnt lgkmcnt(14)
v_mfma_f32_16x16x32_bf16 v[92:95], a[128:131], a[176:179], 0
v_cmp_eq_u32 vcc, 0, v235
v_cmp_eq_u32_e64 s[38:39], 1, v235
s_waitcnt lgkmcnt(11)
v_mfma_f32_16x16x32_bf16 v[96:99], a[128:131], a[180:183], 0
ds_read_b128 a[228:231], v5 offset:3136
ds_read2_b32 a[196:197], v40 offset0:144 offset1:145
s_waitcnt lgkmcnt(10)
v_mfma_f32_16x16x32_bf16 v[100:103], a[128:131], a[184:187], 0
s_nop 0
v_cndmask_b32 v44, 0, v234, vcc
s_waitcnt lgkmcnt(7)
v_mfma_f32_16x16x32_bf16 v[104:107], a[128:131], a[188:191], 0
ds_read2_b32 a[198:199], v40 offset0:146 offset1:147
ds_read_b128 a[232:235], v5 offset:2624
MV 80,a,132,a,160
v_cndmask_b32_e64 v44, v44, v18, s[38:39]
ds_read2_b32 a[200:201], v41 offset0:16 offset1:17
MV 84,a,132,a,164
v_cmp_eq_u32 vcc, 2, v235
v_cmp_eq_u32_e64 s[38:39], 3, v235
MV 88,a,132,a,168
ds_read2_b32 a[202:203], v41 offset0:18 offset1:19
s_and_b32 s81, s2, 3
MV 92,a,132,a,172
s_nop 0
v_cndmask_b32 v45, 0, v234, vcc
MV 96,a,132,a,176
ds_read_b128 a[236:239], v5 offset:2112
ds_read2_b32 a[204:205], v41 offset0:144 offset1:145
MV 100,a,132,a,180
v_cndmask_b32_e64 v45, v45, v18, s[38:39]
ds_read2_b32 a[206:207], v41 offset0:146 offset1:147
MV 104,a,132,a,184
v_cmp_eq_u32 vcc, 4, v235
v_cmp_eq_u32_e64 s[38:39], 5, v235
MV 84,a,136,a,160
ds_read_b128 a[240:243], v5 offset:1600
s_lshl_b32 s81, s81, 1
MV 88,a,136,a,164
s_nop 0
v_cndmask_b32 v46, 0, v234, vcc
MV 92,a,136,a,168
ds_read2_b32 a[208:209], v42 offset0:16 offset1:17
ds_read2_b32 a[210:211], v42 offset0:18 offset1:19
MV 96,a,136,a,172
v_cndmask_b32_e64 v46, v46, v18, s[38:39]
ds_read_b128 a[244:247], v5 offset:1088
MV 100,a,136,a,176
v_cmp_eq_u32 vcc, 6, v235
v_cmp_eq_u32_e64 s[38:39], 7, v235
MV 104,a,136,a,180
ds_read2_b32 a[212:213], v42 offset0:144 offset1:145
s_sub_u32 s74, 14, s81
MV 88,a,140,a,160
s_nop 0
v_cndmask_b32 v47, 0, v234, vcc
MV 92,a,140,a,164
ds_read2_b32 a[214:215], v42 offset0:146 offset1:147
ds_read_b128 a[248:251], v5 offset:576
MV 96,a,140,a,168
v_cndmask_b32_e64 v47, v47, v18, s[38:39]
ds_read2_b32 a[216:217], v43 offset0:16 offset1:17
MV 100,a,140,a,172
s_bitcmp1_b32 s2, 4
s_cselect_b32 s81, s74, s81
MV 104,a,140,a,176
ds_read2_b32 a[218:219], v43 offset0:18 offset1:19
s_bfe_u32 s74, s2, 0x10003
MV 92,a,144,a,160
ds_read_b128 a[252:255], v5 offset:64
s_add_u32 s81, s81, s74
MV 96,a,144,a,164
ds_read2_b32 a[220:221], v43 offset0:144 offset1:145
s_bfe_u32 s82, s2, 0x10002
MV 100,a,144,a,168
ds_read2_b32 a[222:223], v43 offset0:146 offset1:147
s_lshr_b32 s74, s2, 5
MV 104,a,144,a,172
s_lshl_b32 s74, s74, 1
s_add_u32 s82, s82, s74
MV 96,a,148,a,160
s_mov_b32 s72, s81
s_mov_b32 s73, s82
MV 100,a,148,a,164
s_lshl_b32 s74, s72, 2
s_add_u32 s74, s74, s3
MV 104,a,148,a,168
s_lshl_b32 s68, s74, 18
MV 100,a,152,a,160
MV 104,a,152,a,164
s_and_b32 s80, s73, 1
s_waitcnt lgkmcnt(15)
MV 104,a,156,a,160
MV 76,v,44,a,160
s_lshl_b32 s75, s80, 16
MV 80,v,44,a,164
MV 84,v,44,a,168
s_add_u32 s68, s68, s75
MV 88,v,44,a,172
MV 92,v,44,a,176
s_lshl_b32 s69, s73, 19
MV 96,v,44,a,180
MV 100,v,44,a,184
MV 104,v,44,a,188
s_waitcnt vmcnt(0)
buffer_store_dword v253, v255, s[8:11], s83 offen sc1
MV 76,a,192,a,224
ds_read_b128 a[160:163], v5 offset:3712
s_lshl_b32 s75, s73, 7
MV 80,a,196,a,224
ds_read2_b32 a[128:129], v40 offset0:32 offset1:33
s_lshl_b32 s70, s3, 12
MV 80,a,192,a,228
ds_read2_b32 a[130:131], v40 offset0:34 offset1:35
s_lshl_b32 s78, s74, 16
MV 84,a,196,a,228
ds_read_b128 a[164:167], v5 offset:3200
s_add_u32 s78, s78, s75
MV 84,a,192,a,232
s_lshl_b32 s79, s73, 18
s_lshl_b32 s75, s74, 8
MV 88,a,196,a,232
ds_read2_b32 a[132:133], v40 offset0:160 offset1:161
s_add_u32 s79, s79, s75
s_waitcnt lgkmcnt(15)
MV 88,a,192,a,236
ds_read2_b32 a[134:135], v40 offset0:162 offset1:163
v_lshlrev_b32 v236, 4, v1
MV 92,a,196,a,236
ds_read_b128 a[168:171], v5 offset:2688
v_add_u32 v237, 0x20000, v236
MV 92,a,192,a,240
ds_read2_b32 a[136:137], v41 offset0:32 offset1:33
v_add_u32 v238, s70, v236
MV 96,a,196,a,240
s_lshl_b32 s75, s80, 12
v_add_u32 v244, s75, v236
s_waitcnt lgkmcnt(15)
MV 96,a,192,a,244
ds_read2_b32 a[138:139], v41 offset0:34 offset1:35
v_xor_b32 v245, 0x1000, v244
MV 100,a,196,a,244
ds_read_b128 a[172:175], v5 offset:2176
v_add_u32 v242, 66560, v244
s_waitcnt lgkmcnt(15)
MV 100,a,192,a,248
ds_read2_b32 a[140:141], v41 offset0:160 offset1:161
v_add_u32 v243, 66560, v245
MV 104,a,196,a,248
ds_read2_b32 a[142:143], v41 offset0:162 offset1:163
v_bfe_u32 v50, v1, 4, 1
s_waitcnt lgkmcnt(14)
MV 104,a,192,a,252
v_lshrrev_b32 v52, 5, v1
v_and_b32 v48, 15, v1
MV 84,a,200,a,224
ds_read_b128 a[176:179], v5 offset:1664
v_lshlrev_b32 v53, 5, v50
MV 88,a,204,a,224
ds_read2_b32 a[144:145], v42 offset0:32 offset1:33
v_lshl_add_u32 v53, v52, 4, v53
MV 88,a,200,a,228
ds_read2_b32 a[146:147], v42 offset0:34 offset1:35
v_lshl_add_u32 v250, v48, 11, v53
MV 92,a,204,a,228
ds_read_b128 a[180:183], v5 offset:1152
v_lshlrev_b32 v53, 11, v53
MV 92,a,200,a,232
v_lshl_add_u32 v251, v48, 3, v53
MV 96,a,204,a,232
ds_read2_b32 a[148:149], v42 offset0:160 offset1:161
MV 96,a,200,a,236
ds_read2_b32 a[150:151], v42 offset0:162 offset1:163
MV 100,a,204,a,236
ds_read_b128 a[184:187], v5 offset:640
MV 100,a,200,a,240
ds_read2_b32 a[152:153], v43 offset0:32 offset1:33
MV 104,a,204,a,240
s_add_u32 s44, s40, 33554432
s_addc_u32 s45, s41, 0
MV 104,a,200,a,244
ds_read2_b32 a[154:155], v43 offset0:34 offset1:35
s_mov_b32 s46, 16777216
MV 92,a,208,a,224
ds_read_b128 a[188:191], v5 offset:128
s_mov_b32 s47, 0x20000
MV 96,a,212,a,224
ds_read2_b32 a[156:157], v43 offset0:160 offset1:161
MV 96,a,208,a,228
ds_read2_b32 a[158:159], v43 offset0:162 offset1:163
MV 100,a,212,a,228
s_add_u32 s48, s40, 100663296
s_addc_u32 s49, s41, 0
MV 100,a,208,a,232
s_mov_b32 s50, 8388608
s_mov_b32 s51, 0x20000
MV 104,a,212,a,232
s_add_u32 s52, s40, 109051904
s_addc_u32 s53, s41, 0
MV 104,a,208,a,236
s_mov_b32 s54, 4194304
s_mov_b32 s55, 0x20000
MV 100,a,216,a,224
s_add_u32 s56, s40, 54525952
s_addc_u32 s57, s41, 0
s_waitcnt lgkmcnt(15)
MV 104,a,220,a,224
s_mov_b32 s58, 4194304
s_mov_b32 s59, 0x20000
MV 104,a,216,a,228
s_mov_b32 s60, s88
s_mov_b32 s61, s89
s_mov_b32 s62, 4194304
s_mov_b32 s63, 0x20000
s_lshr_b32 s36, s82, 1
s_lshl_b32 s37, s80, 7
s_add_u32 s36, s36, s37
v_lshl_add_u32 v254, v1, 3, s36
s_xor_b32 s36, s2, 4
v_mov_b32 v253, s36
v_cmp_lt_u32 vcc, 15, v1
s_nop 1
v_cndmask_b32 v254, v254, v253, vcc
v_lshlrev_b32 v254, 2, v254
buffer_load_dword v253, v254, s[8:11], 0 offen offset:1024 sc1
MV 76,a,128,a,160
ds_read_b128 a[224:227], v5 offset:3776
s_sub_u32 s36, 15, s81
MV 80,a,132,a,160
ds_read2_b32 a[192:193], v40 offset0:48 offset1:49
s_min_u32 s36, s36, s81
MV 80,a,128,a,164
ds_read2_b32 a[194:195], v40 offset0:50 offset1:51
MV 84,a,132,a,164
ds_read_b128 a[228:231], v5 offset:3264
s_lshr_b32 s37, s36, 1
MV 84,a,128,a,168
MV 88,a,132,a,168
ds_read2_b32 a[196:197], v40 offset0:176 offset1:177
s_xor_b32 s36, s36, s37
s_waitcnt lgkmcnt(15)
MV 88,a,128,a,172
ds_read2_b32 a[198:199], v40 offset0:178 offset1:179
s_and_b32 s36, s36, 1
MV 92,a,132,a,172
ds_read_b128 a[232:235], v5 offset:2752
MV 92,a,128,a,176
ds_read2_b32 a[200:201], v41 offset0:48 offset1:49
s_lshl_b32 s37, s37, 6
MV 96,a,132,a,176
s_waitcnt lgkmcnt(15)
MV 96,a,128,a,180
ds_read2_b32 a[202:203], v41 offset0:50 offset1:51
s_add_u32 s36, s36, s37
MV 100,a,132,a,180
ds_read_b128 a[236:239], v5 offset:2240
s_lshl_b32 s37, s80, 2
s_waitcnt lgkmcnt(15)
MV 100,a,128,a,184
ds_read2_b32 a[204:205], v41 offset0:176 offset1:177
MV 104,a,132,a,184
ds_read2_b32 a[206:207], v41 offset0:178 offset1:179
s_add_u32 s36, s36, s37
s_waitcnt lgkmcnt(14)
MV 104,a,128,a,188
MV 84,a,136,a,160
ds_read_b128 a[240:243], v5 offset:1728
s_add_u32 s36, s36, 1024
MV 88,a,140,a,160
ds_read2_b32 a[208:209], v42 offset0:48 offset1:49
v_bfe_u32 v228, v1, 4, 1
MV 88,a,136,a,164
ds_read2_b32 a[210:211], v42 offset0:50 offset1:51
MV 92,a,140,a,164
ds_read_b128 a[244:247], v5 offset:1216
v_lshl_add_u32 v228, s3, 1, v228
MV 92,a,136,a,168
MV 96,a,140,a,168
ds_read2_b32 a[212:213], v42 offset0:176 offset1:177
v_sub_u32 v229, 7, v228
MV 96,a,136,a,172
ds_read2_b32 a[214:215], v42 offset0:178 offset1:179
v_min_u32 v228, v228, v229
MV 100,a,140,a,172
ds_read_b128 a[248:251], v5 offset:704
MV 100,a,136,a,176
ds_read2_b32 a[216:217], v43 offset0:48 offset1:49
v_lshl_add_u32 v229, v228, 8, s36
MV 104,a,140,a,176
MV 104,a,136,a,180
ds_read2_b32 a[218:219], v43 offset0:50 offset1:51
v_and_b32 v252, 7, v1
MV 92,a,144,a,160
ds_read_b128 a[252:255], v5 offset:192
v_lshlrev_b32 v252, 3, v252
MV 96,a,148,a,160
ds_read2_b32 a[220:221], v43 offset0:176 offset1:177
MV 96,a,144,a,164
ds_read2_b32 a[222:223], v43 offset0:178 offset1:179
v_bfe_u32 v228, v1, 3, 1
MV 100,a,148,a,164
MV 100,a,144,a,168
v_lshlrev_b32 v228, 1, v228
MV 104,a,148,a,168
v_add3_u32 v252, v252, v228, v229
MV 104,a,144,a,172
MV 100,a,152,a,160
v_lshlrev_b32 v252, 2, v252
s_waitcnt lgkmcnt(15)
MV 104,a,156,a,160
MV 104,a,152,a,164
s_waitcnt vmcnt(0)
v_cmp_gt_u32 vcc, 1, v253
s_nop 4
s_cbranch_vccnz L_spin_w
L_spin_w_ret:
MV 76,a,192,a,224
ds_read_b128 a[160:163], v5 offset:3840
s_add_u32 m0, s70, 66560
MV 80,a,196,a,224
ds_read2_b32 a[128:129], v40 offset0:64 offset1:65
v_lshlrev_b32 v255, 20, v1
MV 80,a,192,a,228
ds_read2_b32 a[130:131], v40 offset0:66 offset1:67
buffer_load_dwordx4 v238, s[48:51], s69 offen offset:0 sc1 lds
MV 84,a,196,a,228
ds_read_b128 a[164:167], v5 offset:3328
MV 84,a,192,a,232
MV 88,a,196,a,232
ds_read2_b32 a[132:133], v40 offset0:192 offset1:193
buffer_load_dwordx4 v238, s[48:51], s69 offen offset:1024 sc1 lds
s_waitcnt lgkmcnt(15)
MV 88,a,192,a,236
ds_read2_b32 a[134:135], v40 offset0:194 offset1:195
MV 92,a,196,a,236
ds_read_b128 a[168:171], v5 offset:2816
MV 92,a,192,a,240
ds_read2_b32 a[136:137], v41 offset0:64 offset1:65
buffer_load_dwordx4 v238, s[48:51], s69 offen offset:2048 sc1 lds
MV 96,a,196,a,240
s_waitcnt lgkmcnt(15)
MV 96,a,192,a,244
ds_read2_b32 a[138:139], v41 offset0:66 offset1:67
MV 100,a,196,a,244
ds_read_b128 a[172:175], v5 offset:2304
buffer_load_dwordx4 v238, s[48:51], s69 offen offset:3072 sc1 lds
s_waitcnt lgkmcnt(15)
MV 100,a,192,a,248
ds_read2_b32 a[140:141], v41 offset0:192 offset1:193
s_lshl_b32 s36, s3, 26
MV 104,a,196,a,248
ds_read2_b32 a[142:143], v41 offset0:194 offset1:195
s_waitcnt lgkmcnt(14)
MV 104,a,192,a,252
s_add_u32 s69, s69, 16384
MV 84,a,200,a,224
ds_read_b128 a[176:179], v5 offset:1792
MV 88,a,204,a,224
ds_read2_b32 a[144:145], v42 offset0:64 offset1:65
MV 88,a,200,a,228
ds_read2_b32 a[146:147], v42 offset0:66 offset1:67
s_add_u32 m0, s70, 82944
MV 92,a,204,a,228
ds_read_b128 a[180:183], v5 offset:1280
MV 92,a,200,a,232
MV 96,a,204,a,232
ds_read2_b32 a[148:149], v42 offset0:192 offset1:193
buffer_load_dwordx4 v238, s[48:51], s69 offen offset:0 sc1 lds
MV 96,a,200,a,236
ds_read2_b32 a[150:151], v42 offset0:194 offset1:195
MV 100,a,204,a,236
ds_read_b128 a[184:187], v5 offset:768
MV 100,a,200,a,240
ds_read2_b32 a[152:153], v43 offset0:64 offset1:65
buffer_load_dwordx4 v238, s[48:51], s69 offen offset:1024 sc1 lds
MV 104,a,204,a,240
v_add_u32 v255, s36, v255
MV 104,a,200,a,244
ds_read2_b32 a[154:155], v43 offset0:66 offset1:67
MV 92,a,208,a,224
ds_read_b128 a[188:191], v5 offset:256
buffer_load_dwordx4 v238, s[48:51], s69 offen offset:2048 sc1 lds
MV 96,a,212,a,224
ds_read2_b32 a[156:157], v43 offset0:192 offset1:193
MV 96,a,208,a,228
ds_read2_b32 a[158:159], v43 offset0:194 offset1:195
MV 100,a,212,a,228
buffer_load_dwordx4 v238, s[48:51], s69 offen offset:3072 sc1 lds
MV 100,a,208,a,232
MV 104,a,212,a,232
MV 104,a,208,a,236
s_add_u32 s69, s69, 16384
MV 100,a,216,a,224
s_waitcnt lgkmcnt(15)
MV 104,a,220,a,224
MV 104,a,216,a,228
MV 76,a,128,a,160
ds_read_b128 a[224:227], v5 offset:3904
s_add_u32 m0, s70, 99328
MV 80,a,132,a,160
ds_read2_b32 a[192:193], v40 offset0:80 offset1:81
v_mul_u32_u24 v18, 136, v16
MV 80,a,128,a,164
ds_read2_b32 a[194:195], v40 offset0:82 offset1:83
v_lshl_add_u32 v18, v17, 5, v18
MV 84,a,132,a,164
ds_read_b128 a[228:231], v5 offset:3392
MV 84,a,128,a,168
MV 88,a,132,a,168
ds_read2_b32 a[196:197], v40 offset0:208 offset1:209
buffer_load_dwordx4 v238, s[48:51], s69 offen offset:0 sc1 lds
s_waitcnt lgkmcnt(15)
MV 88,a,128,a,172
ds_read2_b32 a[198:199], v40 offset0:210 offset1:211
s_lshl_b32 s37, s3, 1
MV 92,a,132,a,172
ds_read_b128 a[232:235], v5 offset:2880
s_add_u32 s37, s37, 49152
MV 92,a,128,a,176
ds_read2_b32 a[200:201], v41 offset0:80 offset1:81
MV 96,a,132,a,176
s_waitcnt lgkmcnt(15)
MV 96,a,128,a,180
ds_read2_b32 a[202:203], v41 offset0:82 offset1:83
v_add_u32 v11, s37, v18
MV 100,a,132,a,180
ds_read_b128 a[236:239], v5 offset:2368
buffer_load_dwordx4 v238, s[48:51], s69 offen offset:1024 sc1 lds
s_waitcnt lgkmcnt(15)
MV 100,a,128,a,184
ds_read2_b32 a[204:205], v41 offset0:208 offset1:209
v_lshrrev_b32 v18, 3, v1
MV 104,a,132,a,184
ds_read2_b32 a[206:207], v41 offset0:210 offset1:211
s_waitcnt lgkmcnt(14)
MV 104,a,128,a,188
MV 84,a,136,a,160
ds_read_b128 a[240:243], v5 offset:1856
v_mul_u32_u24 v18, 136, v18
MV 88,a,140,a,160
ds_read2_b32 a[208:209], v42 offset0:80 offset1:81
MV 88,a,136,a,164
ds_read2_b32 a[210:211], v42 offset0:82 offset1:83
buffer_load_dwordx4 v238, s[48:51], s69 offen offset:2048 sc1 lds
MV 92,a,140,a,164
ds_read_b128 a[244:247], v5 offset:1344
v_and_b32 v19, 7, v1
MV 92,a,136,a,168
MV 96,a,140,a,168
ds_read2_b32 a[212:213], v42 offset0:208 offset1:209
v_lshl_add_u32 v18, v19, 4, v18
MV 96,a,136,a,172
ds_read2_b32 a[214:215], v42 offset0:210 offset1:211
MV 100,a,140,a,172
ds_read_b128 a[248:251], v5 offset:832
s_mul_i32 s37, s3, 4352
MV 100,a,136,a,176
ds_read2_b32 a[216:217], v43 offset0:80 offset1:81
buffer_load_dwordx4 v238, s[48:51], s69 offen offset:3072 sc1 lds
MV 104,a,140,a,176
MV 104,a,136,a,180
ds_read2_b32 a[218:219], v43 offset0:82 offset1:83
s_add_u32 s37, s37, 49152
MV 92,a,144,a,160
ds_read_b128 a[252:255], v5 offset:320
MV 96,a,148,a,160
ds_read2_b32 a[220:221], v43 offset0:208 offset1:209
v_add_u32 v12, s37, v18
MV 96,a,144,a,164
ds_read2_b32 a[222:223], v43 offset0:210 offset1:211
MV 100,a,148,a,164
s_add_u32 s69, s69, 16384
MV 100,a,144,a,168
s_lshl_b32 s37, s3, 12
MV 104,a,148,a,168
MV 104,a,144,a,172
v_add_u32 v13, s37, v232
MV 100,a,152,a,160
s_waitcnt lgkmcnt(15)
MV 104,a,156,a,160
MV 104,a,152,a,164
buffer_load_dword v253, v252, s[8:11], 0 offen sc1
MV 76,a,192,a,224
ds_read_b128 a[160:163], v5 offset:3968
MV 80,a,196,a,224
ds_read2_b32 a[128:129], v40 offset0:96 offset1:97
MV 80,a,192,a,228
ds_read2_b32 a[130:131], v40 offset0:98 offset1:99
MV 84,a,196,a,228
ds_read_b128 a[164:167], v5 offset:3456
MV 84,a,192,a,232
MV 88,a,196,a,232
ds_read2_b32 a[132:133], v40 offset0:224 offset1:225
s_waitcnt lgkmcnt(15)
MV 88,a,192,a,236
ds_read2_b32 a[134:135], v40 offset0:226 offset1:227
MV 92,a,196,a,236
ds_read_b128 a[168:171], v5 offset:2944
MV 92,a,192,a,240
ds_read2_b32 a[136:137], v41 offset0:96 offset1:97
MV 96,a,196,a,240
s_waitcnt lgkmcnt(15)
MV 96,a,192,a,244
ds_read2_b32 a[138:139], v41 offset0:98 offset1:99
MV 100,a,196,a,244
ds_read_b128 a[172:175], v5 offset:2432
s_waitcnt lgkmcnt(15)
MV 100,a,192,a,248
ds_read2_b32 a[140:141], v41 offset0:224 offset1:225
MV 104,a,196,a,248
ds_read2_b32 a[142:143], v41 offset0:226 offset1:227
s_waitcnt lgkmcnt(14)
MV 104,a,192,a,252
MV 84,a,200,a,224
ds_read_b128 a[176:179], v5 offset:1920
MV 88,a,204,a,224
ds_read2_b32 a[144:145], v42 offset0:96 offset1:97
MV 88,a,200,a,228
ds_read2_b32 a[146:147], v42 offset0:98 offset1:99
MV 92,a,204,a,228
ds_read_b128 a[180:183], v5 offset:1408
MV 92,a,200,a,232
MV 96,a,204,a,232
ds_read2_b32 a[148:149], v42 offset0:224 offset1:225
MV 96,a,200,a,236
ds_read2_b32 a[150:151], v42 offset0:226 offset1:227
MV 100,a,204,a,236
ds_read_b128 a[184:187], v5 offset:896
MV 100,a,200,a,240
ds_read2_b32 a[152:153], v43 offset0:96 offset1:97
MV 104,a,204,a,240
MV 104,a,200,a,244
ds_read2_b32 a[154:155], v43 offset0:98 offset1:99
MV 92,a,208,a,224
ds_read_b128 a[188:191], v5 offset:384
MV 96,a,212,a,224
ds_read2_b32 a[156:157], v43 offset0:224 offset1:225
MV 96,a,208,a,228
ds_read2_b32 a[158:159], v43 offset0:226 offset1:227
MV 100,a,212,a,228
MV 100,a,208,a,232
MV 104,a,212,a,232
MV 104,a,208,a,236
MV 100,a,216,a,224
s_waitcnt lgkmcnt(15)
MV 104,a,220,a,224
MV 104,a,216,a,228
s_waitcnt vmcnt(0)
v_cmp_gt_u32 vcc, 1, v253
s_nop 4
s_cbranch_vccnz L_spin_f2
L_spin_f2_ret:
buffer_load_dwordx4 a[0:3], v236, s[44:47], s68 offen offset:0 sc1
buffer_load_dwordx4 a[4:7], v237, s[44:47], s68 offen offset:0 sc1
buffer_load_dwordx4 a[8:11], v236, s[44:47], s68 offen offset:1024 sc1
buffer_load_dwordx4 a[12:15], v237, s[44:47], s68 offen offset:1024 sc1
s_add_u32 s68, s68, 2048
MV 76,a,128,a,160
ds_read_b128 a[224:227], v5 offset:4032
buffer_load_dwordx4 a[16:19], v236, s[44:47], s68 offen offset:0 sc1
MV 80,a,132,a,160
ds_read2_b32 a[192:193], v40 offset0:112 offset1:113
MV 80,a,128,a,164
ds_read2_b32 a[194:195], v40 offset0:114 offset1:115
buffer_load_dwordx4 a[20:23], v237, s[44:47], s68 offen offset:0 sc1
MV 84,a,132,a,164
ds_read_b128 a[228:231], v5 offset:3520
MV 84,a,128,a,168
buffer_load_dwordx4 a[24:27], v236, s[44:47], s68 offen offset:1024 sc1
MV 88,a,132,a,168
ds_read2_b32 a[196:197], v40 offset0:240 offset1:241
s_waitcnt lgkmcnt(15)
MV 88,a,128,a,172
ds_read2_b32 a[198:199], v40 offset0:242 offset1:243
MV 92,a,132,a,172
ds_read_b128 a[232:235], v5 offset:3008
buffer_load_dwordx4 a[28:31], v237, s[44:47], s68 offen offset:1024 sc1
MV 92,a,128,a,176
ds_read2_b32 a[200:201], v41 offset0:112 offset1:113
MV 96,a,132,a,176
s_add_u32 s68, s68, 2048
s_waitcnt lgkmcnt(15)
MV 96,a,128,a,180
ds_read2_b32 a[202:203], v41 offset0:114 offset1:115
MV 100,a,132,a,180
ds_read_b128 a[236:239], v5 offset:2496
buffer_load_dwordx4 a[32:35], v236, s[44:47], s68 offen offset:0 sc1
s_waitcnt lgkmcnt(15)
MV 100,a,128,a,184
ds_read2_b32 a[204:205], v41 offset0:240 offset1:241
MV 104,a,132,a,184
ds_read2_b32 a[206:207], v41 offset0:242 offset1:243
s_waitcnt lgkmcnt(14)
MV 104,a,128,a,188
buffer_load_dwordx4 a[36:39], v237, s[44:47], s68 offen offset:0 sc1
MV 84,a,136,a,160
ds_read_b128 a[240:243], v5 offset:1984
MV 88,a,140,a,160
ds_read2_b32 a[208:209], v42 offset0:112 offset1:113
buffer_load_dwordx4 a[40:43], v236, s[44:47], s68 offen offset:1024 sc1
MV 88,a,136,a,164
ds_read2_b32 a[210:211], v42 offset0:114 offset1:115
MV 92,a,140,a,164
ds_read_b128 a[244:247], v5 offset:1472
buffer_load_dwordx4 a[44:47], v237, s[44:47], s68 offen offset:1024 sc1
MV 92,a,136,a,168
MV 96,a,140,a,168
ds_read2_b32 a[212:213], v42 offset0:240 offset1:241
MV 96,a,136,a,172
ds_read2_b32 a[214:215], v42 offset0:242 offset1:243
s_add_u32 s68, s68, 2048
MV 100,a,140,a,172
ds_read_b128 a[248:251], v5 offset:960
MV 100,a,136,a,176
ds_read2_b32 a[216:217], v43 offset0:112 offset1:113
buffer_load_dwordx4 a[48:51], v236, s[44:47], s68 offen offset:0 sc1
MV 104,a,140,a,176
MV 104,a,136,a,180
ds_read2_b32 a[218:219], v43 offset0:114 offset1:115
buffer_load_dwordx4 a[52:55], v237, s[44:47], s68 offen offset:0 sc1
MV 92,a,144,a,160
ds_read_b128 a[252:255], v5 offset:448
MV 96,a,148,a,160
ds_read2_b32 a[220:221], v43 offset0:240 offset1:241
MV 96,a,144,a,164
ds_read2_b32 a[222:223], v43 offset0:242 offset1:243
buffer_load_dwordx4 a[56:59], v236, s[44:47], s68 offen offset:1024 sc1
MV 100,a,148,a,164
MV 100,a,144,a,168
buffer_load_dwordx4 a[60:63], v237, s[44:47], s68 offen offset:1024 sc1
MV 104,a,148,a,168
MV 104,a,144,a,172
s_add_u32 s68, s68, 2048
MV 100,a,152,a,160
s_waitcnt lgkmcnt(15)
MV 104,a,156,a,160
MV 104,a,152,a,164
s_waitcnt lgkmcnt(0)
s_barrier
ds_read_b128 a[64:67], v242 offset:0
ds_read_b128 a[68:71], v242 offset:1024
ds_read_b128 a[72:75], v242 offset:2048
ds_read_b128 a[76:79], v242 offset:3072
ds_read_b128 a[80:83], v243 offset:0
ds_read_b128 a[84:87], v243 offset:1024
ds_read_b128 a[88:91], v243 offset:2048
ds_read_b128 a[92:95], v243 offset:3072
s_waitcnt lgkmcnt(0)
s_waitcnt vmcnt(15)
v_mfma_f32_16x16x32_bf16 v[124:127], a[64:67], a[0:3], 0
ds_read_b128 a[96:99], v242 offset:8192
MV 76,a,192,a,224
s_add_u32 m0, s70, 115712
s_waitcnt vmcnt(14)
v_mfma_f32_16x16x32_bf16 v[128:131], a[64:67], a[4:7], 0
ds_read_b128 a[100:103], v242 offset:9216
MV 80,a,196,a,224
v_mfma_f32_16x16x32_bf16 v[132:135], a[68:71], a[0:3], 0
MV 80,a,192,a,228
ds_read_b128 a[104:107], v242 offset:10240
v_mfma_f32_16x16x32_bf16 v[136:139], a[68:71], a[4:7], 0
v_mfma_f32_16x16x32_bf16 v[140:143], a[72:75], a[0:3], 0
ds_read_b128 a[108:111], v242 offset:11264
MV 84,a,196,a,228
v_mfma_f32_16x16x32_bf16 v[144:147], a[72:75], a[4:7], 0
buffer_load_dwordx4 v238, s[48:51], s69 offen offset:0 sc1 lds
MV 84,a,192,a,232
ds_read_b128 a[112:115], v243 offset:8192
v_mfma_f32_16x16x32_bf16 v[148:151], a[76:79], a[0:3], 0
MV 88,a,196,a,232
v_mfma_f32_16x16x32_bf16 v[152:155], a[76:79], a[4:7], 0
ds_read_b128 a[116:119], v243 offset:9216
v_mfma_f32_16x16x32_bf16 v[156:159], a[80:83], a[0:3], 0
MV 88,a,192,a,236
ds_read_b128 a[120:123], v243 offset:10240
v_mfma_f32_16x16x32_bf16 v[160:163], a[80:83], a[4:7], 0
MV 92,a,196,a,236
buffer_load_dwordx4 v238, s[48:51], s69 offen offset:1024 sc1 lds
v_mfma_f32_16x16x32_bf16 v[164:167], a[84:87], a[0:3], 0
ds_read_b128 a[124:127], v243 offset:11264
MV 92,a,192,a,240
v_mfma_f32_16x16x32_bf16 v[168:171], a[84:87], a[4:7], 0
v_mfma_f32_16x16x32_bf16 v[172:175], a[88:91], a[0:3], 0
MV 96,a,196,a,240
v_mfma_f32_16x16x32_bf16 v[176:179], a[88:91], a[4:7], 0
MV 96,a,192,a,244
v_mfma_f32_16x16x32_bf16 v[180:183], a[92:95], a[0:3], 0
buffer_load_dwordx4 a[0:3], v236, s[44:47], s68 offen offset:0 sc1
MV 100,a,196,a,244
v_mfma_f32_16x16x32_bf16 v[184:187], a[92:95], a[4:7], 0
buffer_load_dwordx4 a[4:7], v237, s[44:47], s68 offen offset:0 sc1
s_waitcnt lgkmcnt(0)
s_barrier
s_waitcnt vmcnt(17)
MV 124,a,96,a,8
ds_read_b128 a[64:67], v242 offset:16384
MV 100,a,192,a,248
buffer_load_dwordx4 v238, s[48:51], s69 offen offset:2048 sc1 lds
s_waitcnt vmcnt(17)
MV 128,a,96,a,12
ds_read_b128 a[68:71], v242 offset:17408
MV 104,a,196,a,248
MV 132,a,100,a,8
MV 104,a,192,a,252
ds_read_b128 a[72:75], v242 offset:18432
MV 136,a,100,a,12
MV 140,a,104,a,8
ds_read_b128 a[76:79], v242 offset:19456
MV 84,a,200,a,224
MV 144,a,104,a,12
buffer_load_dwordx4 v238, s[48:51], s69 offen offset:3072 sc1 lds
MV 88,a,204,a,224
ds_read_b128 a[80:83], v243 offset:16384
MV 148,a,108,a,8
MV 88,a,200,a,228
MV 152,a,108,a,12
ds_read_b128 a[84:87], v243 offset:17408
MV 156,a,112,a,8
MV 92,a,204,a,228
ds_read_b128 a[88:91], v243 offset:18432
MV 160,a,112,a,12
MV 92,a,200,a,232
s_add_u32 s69, s69, 16384
MV 164,a,116,a,8
ds_read_b128 a[92:95], v243 offset:19456
MV 96,a,204,a,232
MV 168,a,116,a,12
MV 172,a,120,a,8
MV 96,a,200,a,236
MV 176,a,120,a,12
MV 100,a,204,a,236
MV 180,a,124,a,8
buffer_load_dwordx4 a[8:11], v236, s[44:47], s68 offen offset:1024 sc1
MV 100,a,200,a,240
MV 184,a,124,a,12
buffer_load_dwordx4 a[12:15], v237, s[44:47], s68 offen offset:1024 sc1
s_add_u32 s68, s68, 2048
s_waitcnt lgkmcnt(0)
s_waitcnt vmcnt(19)
MV 124,a,64,a,16
ds_read_b128 a[96:99], v242 offset:24576
MV 104,a,204,a,240
s_add_u32 m0, s70, 66560
s_waitcnt vmcnt(18)
MV 128,a,64,a,20
ds_read_b128 a[100:103], v242 offset:25600
MV 104,a,200,a,244
MV 132,a,68,a,16
MV 92,a,208,a,224
ds_read_b128 a[104:107], v242 offset:26624
MV 136,a,68,a,20
MV 140,a,72,a,16
ds_read_b128 a[108:111], v242 offset:27648
MV 96,a,212,a,224
MV 144,a,72,a,20
buffer_load_dwordx4 v238, s[48:51], s69 offen offset:0 sc1 lds
MV 96,a,208,a,228
ds_read_b128 a[112:115], v243 offset:24576
MV 148,a,76,a,16
MV 100,a,212,a,228
MV 152,a,76,a,20
ds_read_b128 a[116:119], v243 offset:25600
MV 156,a,80,a,16
MV 100,a,208,a,232
ds_read_b128 a[120:123], v243 offset:26624
MV 160,a,80,a,20
MV 104,a,212,a,232
buffer_load_dwordx4 v238, s[48:51], s69 offen offset:1024 sc1 lds
MV 164,a,84,a,16
ds_read_b128 a[124:127], v243 offset:27648
MV 104,a,208,a,236
MV 168,a,84,a,20
MV 172,a,88,a,16
MV 100,a,216,a,224
MV 176,a,88,a,20
MV 104,a,220,a,224
MV 180,a,92,a,16
buffer_load_dwordx4 a[16:19], v236, s[44:47], s68 offen offset:0 sc1
MV 104,a,216,a,228
MV 184,a,92,a,20
buffer_load_dwordx4 a[20:23], v237, s[44:47], s68 offen offset:0 sc1
s_waitcnt lgkmcnt(0)
s_barrier
s_waitcnt vmcnt(21)
MV 124,a,96,a,24
ds_read_b128 a[64:67], v242 offset:32768
s_waitcnt vmcnt(20)
MV 128,a,96,a,28
ds_read_b128 a[68:71], v242 offset:33792
buffer_load_dwordx4 v238, s[48:51], s69 offen offset:2048 sc1 lds
MV 132,a,100,a,24
MV 136,a,100,a,28
ds_read_b128 a[72:75], v242 offset:34816
MV 140,a,104,a,24
ds_read_b128 a[76:79], v242 offset:35840
MV 144,a,104,a,28
buffer_load_dwordx4 v238, s[48:51], s69 offen offset:3072 sc1 lds
MV 148,a,108,a,24
ds_read_b128 a[80:83], v243 offset:32768
MV 152,a,108,a,28
ds_read_b128 a[84:87], v243 offset:33792
MV 156,a,112,a,24
MV 160,a,112,a,28
ds_read_b128 a[88:91], v243 offset:34816
s_add_u32 s69, s69, 16384
MV 164,a,116,a,24
ds_read_b128 a[92:95], v243 offset:35840
MV 168,a,116,a,28
MV 172,a,120,a,24
MV 176,a,120,a,28
MV 180,a,124,a,24
buffer_load_dwordx4 a[24:27], v236, s[44:47], s68 offen offset:1024 sc1
MV 184,a,124,a,28
buffer_load_dwordx4 a[28:31], v237, s[44:47], s68 offen offset:1024 sc1
s_add_u32 s68, s68, 2048
s_waitcnt lgkmcnt(0)
s_waitcnt vmcnt(23)
MV 124,a,64,a,32
ds_read_b128 a[96:99], v242 offset:40960
v_cvt_pk_bf16_f32 v16, v76, v77
s_waitcnt vmcnt(22)
MV 128,a,64,a,36
ds_read_b128 a[100:103], v242 offset:41984
s_add_u32 m0, s70, 82944
MV 132,a,68,a,32
v_cvt_pk_bf16_f32 v17, v78, v79
MV 136,a,68,a,36
ds_read_b128 a[104:107], v242 offset:43008
ds_write_b16 v11, v16 offset:0
MV 140,a,72,a,32
ds_read_b128 a[108:111], v242 offset:44032
MV 144,a,72,a,36
buffer_load_dwordx4 v238, s[48:51], s69 offen offset:0 sc1 lds
ds_write_b16_d16_hi v11, v16 offset:8
MV 148,a,76,a,32
ds_read_b128 a[112:115], v243 offset:40960
MV 152,a,76,a,36
ds_read_b128 a[116:119], v243 offset:41984
ds_write_b16 v11, v17 offset:16
MV 156,a,80,a,32
ds_write_b16_d16_hi v11, v17 offset:24
MV 160,a,80,a,36
ds_read_b128 a[120:123], v243 offset:43008
buffer_load_dwordx4 v238, s[48:51], s69 offen offset:1024 sc1 lds
MV 164,a,84,a,32
ds_read_b128 a[124:127], v243 offset:44032
v_cvt_pk_bf16_f32 v18, v80, v81
MV 168,a,84,a,36
MV 172,a,88,a,32
v_cvt_pk_bf16_f32 v19, v82, v83
MV 176,a,88,a,36
MV 180,a,92,a,32
buffer_load_dwordx4 a[32:35], v236, s[44:47], s68 offen offset:0 sc1
ds_write_b16 v11, v18 offset:2176
MV 184,a,92,a,36
buffer_load_dwordx4 a[36:39], v237, s[44:47], s68 offen offset:0 sc1
s_waitcnt vmcnt(14) lgkmcnt(0)
s_barrier
MV 124,a,96,a,40
ds_read_b128 a[64:67], v242 offset:49152
ds_write_b16_d16_hi v11, v18 offset:2184
MV 128,a,96,a,44
ds_read_b128 a[68:71], v242 offset:50176
buffer_load_dwordx4 v238, s[48:51], s69 offen offset:2048 sc1 lds
MV 132,a,100,a,40
ds_write_b16 v11, v19 offset:2192
MV 136,a,100,a,44
ds_read_b128 a[72:75], v242 offset:51200
ds_write_b16_d16_hi v11, v19 offset:2200
MV 140,a,104,a,40
ds_read_b128 a[76:79], v242 offset:52224
v_cvt_pk_bf16_f32 v16, v84, v85
MV 144,a,104,a,44
buffer_load_dwordx4 v238, s[48:51], s69 offen offset:3072 sc1 lds
MV 148,a,108,a,40
ds_read_b128 a[80:83], v243 offset:49152
v_cvt_pk_bf16_f32 v17, v86, v87
MV 152,a,108,a,44
ds_read_b128 a[84:87], v243 offset:50176
MV 156,a,112,a,40
ds_write_b16 v11, v16 offset:4352
MV 160,a,112,a,44
ds_read_b128 a[88:91], v243 offset:51200
s_add_u32 s69, s69, 16384
MV 164,a,116,a,40
ds_read_b128 a[92:95], v243 offset:52224
ds_write_b16_d16_hi v11, v16 offset:4360
MV 168,a,116,a,44
ds_write_b16 v11, v17 offset:4368
MV 172,a,120,a,40
ds_write_b16_d16_hi v11, v17 offset:4376
MV 176,a,120,a,44
MV 180,a,124,a,40
buffer_load_dwordx4 a[40:43], v236, s[44:47], s68 offen offset:1024 sc1
v_cvt_pk_bf16_f32 v18, v88, v89
MV 184,a,124,a,44
buffer_load_dwordx4 a[44:47], v237, s[44:47], s68 offen offset:1024 sc1
s_add_u32 s68, s68, 2048
s_waitcnt lgkmcnt(0)
MV 124,a,64,a,48
ds_read_b128 a[96:99], v242 offset:57344
v_cvt_pk_bf16_f32 v19, v90, v91
MV 128,a,64,a,52
ds_read_b128 a[100:103], v242 offset:58368
s_add_u32 m0, s70, 99328
MV 132,a,68,a,48
ds_write_b16 v11, v18 offset:6528
MV 136,a,68,a,52
ds_read_b128 a[104:107], v242 offset:59392
ds_write_b16_d16_hi v11, v18 offset:6536
MV 140,a,72,a,48
ds_read_b128 a[108:111], v242 offset:60416
MV 144,a,72,a,52
buffer_load_dwordx4 v238, s[48:51], s69 offen offset:0 sc1 lds
ds_write_b16 v11, v19 offset:6544
MV 148,a,76,a,48
ds_read_b128 a[112:115], v243 offset:57344
MV 152,a,76,a,52
ds_read_b128 a[116:119], v243 offset:58368
ds_write_b16_d16_hi v11, v19 offset:6552
MV 156,a,80,a,48
v_cvt_pk_bf16_f32 v16, v92, v93
MV 160,a,80,a,52
ds_read_b128 a[120:123], v243 offset:59392
buffer_load_dwordx4 v238, s[48:51], s69 offen offset:1024 sc1 lds
MV 164,a,84,a,48
ds_read_b128 a[124:127], v243 offset:60416
v_cvt_pk_bf16_f32 v17, v94, v95
MV 168,a,84,a,52
MV 172,a,88,a,48
ds_write_b16 v11, v16 offset:8704
MV 176,a,88,a,52
MV 180,a,92,a,48
buffer_load_dwordx4 a[48:51], v236, s[44:47], s68 offen offset:0 sc1
ds_write_b16_d16_hi v11, v16 offset:8712
MV 184,a,92,a,52
buffer_load_dwordx4 a[52:55], v237, s[44:47], s68 offen offset:0 sc1
s_waitcnt vmcnt(14) lgkmcnt(0)
s_barrier
MV 124,a,96,a,56
ds_read_b128 a[64:67], v242 offset:0
ds_write_b16 v11, v17 offset:8720
MV 128,a,96,a,60
ds_read_b128 a[68:71], v242 offset:1024
buffer_load_dwordx4 v238, s[48:51], s69 offen offset:2048 sc1 lds
MV 132,a,100,a,56
ds_write_b16_d16_hi v11, v17 offset:8728
MV 136,a,100,a,60
ds_read_b128 a[72:75], v242 offset:2048
v_cvt_pk_bf16_f32 v18, v96, v97
MV 140,a,104,a,56
ds_read_b128 a[76:79], v242 offset:3072
v_cvt_pk_bf16_f32 v19, v98, v99
MV 144,a,104,a,60
buffer_load_dwordx4 v238, s[48:51], s69 offen offset:3072 sc1 lds
MV 148,a,108,a,56
ds_read_b128 a[80:83], v243 offset:0
ds_write_b16 v11, v18 offset:10880
MV 152,a,108,a,60
ds_read_b128 a[84:87], v243 offset:1024
MV 156,a,112,a,56
ds_write_b16_d16_hi v11, v18 offset:10888
MV 160,a,112,a,60
ds_read_b128 a[88:91], v243 offset:2048
s_add_u32 s69, s69, 16384
MV 164,a,116,a,56
ds_read_b128 a[92:95], v243 offset:3072
ds_write_b16 v11, v19 offset:10896
MV 168,a,116,a,60
ds_write_b16_d16_hi v11, v19 offset:10904
MV 172,a,120,a,56
v_cvt_pk_bf16_f32 v16, v100, v101
MV 176,a,120,a,60
MV 180,a,124,a,56
buffer_load_dwordx4 a[56:59], v236, s[44:47], s68 offen offset:1024 sc1
v_cvt_pk_bf16_f32 v17, v102, v103
MV 184,a,124,a,60
buffer_load_dwordx4 a[60:63], v237, s[44:47], s68 offen offset:1024 sc1
s_add_u32 s68, s68, 2048
s_waitcnt lgkmcnt(0)
MV 124,a,64,a,0
ds_read_b128 a[96:99], v242 offset:8192
ds_write_b16 v11, v16 offset:13056
MV 128,a,64,a,4
ds_read_b128 a[100:103], v242 offset:9216
s_add_u32 m0, s70, 115712
MV 132,a,68,a,0
ds_write_b16_d16_hi v11, v16 offset:13064
MV 136,a,68,a,4
ds_read_b128 a[104:107], v242 offset:10240
ds_write_b16 v11, v17 offset:13072
MV 140,a,72,a,0
ds_read_b128 a[108:111], v242 offset:11264
ds_write_b16_d16_hi v11, v17 offset:13080
MV 144,a,72,a,4
buffer_load_dwordx4 v238, s[48:51], s69 offen offset:0 sc1 lds
MV 148,a,76,a,0
ds_read_b128 a[112:115], v243 offset:8192
v_cvt_pk_bf16_f32 v18, v104, v105
MV 152,a,76,a,4
ds_read_b128 a[116:119], v243 offset:9216
MV 156,a,80,a,0
v_cvt_pk_bf16_f32 v19, v106, v107
MV 160,a,80,a,4
ds_read_b128 a[120:123], v243 offset:10240
buffer_load_dwordx4 v238, s[48:51], s69 offen offset:1024 sc1 lds
MV 164,a,84,a,0
ds_read_b128 a[124:127], v243 offset:11264
ds_write_b16 v11, v18 offset:15232
MV 168,a,84,a,4
ds_write_b16_d16_hi v11, v18 offset:15240
MV 172,a,88,a,0
ds_write_b16 v11, v19 offset:15248
MV 176,a,88,a,4
MV 180,a,92,a,0
buffer_load_dwordx4 a[0:3], v236, s[44:47], s68 offen offset:0 sc1
ds_write_b16_d16_hi v11, v19 offset:15256
MV 184,a,92,a,4
buffer_load_dwordx4 a[4:7], v237, s[44:47], s68 offen offset:0 sc1
s_waitcnt vmcnt(14) lgkmcnt(0)
s_barrier
MV 124,a,96,a,8
ds_read_b128 a[64:67], v242 offset:16384
ds_read_b64 v[108:109], v12 offset:0
MV 128,a,96,a,12
ds_read_b128 a[68:71], v242 offset:17408
buffer_load_dwordx4 v238, s[48:51], s69 offen offset:2048 sc1 lds
MV 132,a,100,a,8
ds_read_b64 v[110:111], v12 offset:8
MV 136,a,100,a,12
ds_read_b128 a[72:75], v242 offset:18432
MV 140,a,104,a,8
ds_read_b128 a[76:79], v242 offset:19456
ds_read_b64 v[112:113], v12 offset:1088
MV 144,a,104,a,12
buffer_load_dwordx4 v238, s[48:51], s69 offen offset:3072 sc1 lds
MV 148,a,108,a,8
ds_read_b128 a[80:83], v243 offset:16384
ds_read_b64 v[114:115], v12 offset:1096
MV 152,a,108,a,12
ds_read_b128 a[84:87], v243 offset:17408
MV 156,a,112,a,8
ds_read_b64 v[116:117], v12 offset:2176
MV 160,a,112,a,12
ds_read_b128 a[88:91], v243 offset:18432
s_add_u32 s69, s69, 16384
MV 164,a,116,a,8
ds_read_b128 a[92:95], v243 offset:19456
ds_read_b64 v[118:119], v12 offset:2184
MV 168,a,116,a,12
MV 172,a,120,a,8
ds_read_b64 v[120:121], v12 offset:3264
MV 176,a,120,a,12
MV 180,a,124,a,8
buffer_load_dwordx4 a[8:11], v236, s[44:47], s68 offen offset:1024 sc1
ds_read_b64 v[122:123], v12 offset:3272
MV 184,a,124,a,12
buffer_load_dwordx4 a[12:15], v237, s[44:47], s68 offen offset:1024 sc1
s_add_u32 s68, s68, 2048
s_waitcnt lgkmcnt(0)
MV 124,a,64,a,16
ds_read_b128 a[96:99], v242 offset:24576
buffer_store_dwordx4 v[108:111], v13, s[24:27], 0 offen offset:0 sc1
MV 128,a,64,a,20
ds_read_b128 a[100:103], v242 offset:25600
s_add_u32 m0, s70, 66560
MV 132,a,68,a,16
MV 136,a,68,a,20
ds_read_b128 a[104:107], v242 offset:26624
MV 140,a,72,a,16
ds_read_b128 a[108:111], v242 offset:27648
MV 144,a,72,a,20
buffer_load_dwordx4 v238, s[48:51], s69 offen offset:0 sc1 lds
MV 148,a,76,a,16
ds_read_b128 a[112:115], v243 offset:24576
MV 152,a,76,a,20
ds_read_b128 a[116:119], v243 offset:25600
MV 156,a,80,a,16
buffer_store_dwordx4 v[112:115], v13, s[24:27], 0 offen offset:1024 sc1
MV 160,a,80,a,20
ds_read_b128 a[120:123], v243 offset:26624
buffer_load_dwordx4 v238, s[48:51], s69 offen offset:1024 sc1 lds
MV 164,a,84,a,16
ds_read_b128 a[124:127], v243 offset:27648
MV 168,a,84,a,20
MV 172,a,88,a,16
MV 176,a,88,a,20
MV 180,a,92,a,16
buffer_load_dwordx4 a[16:19], v236, s[44:47], s68 offen offset:0 sc1
MV 184,a,92,a,20
buffer_load_dwordx4 a[20:23], v237, s[44:47], s68 offen offset:0 sc1
s_waitcnt vmcnt(16) lgkmcnt(0)
s_barrier
MV 124,a,96,a,24
ds_read_b128 a[64:67], v242 offset:32768
buffer_store_dwordx4 v[116:119], v13, s[24:27], 0 offen offset:2048 sc1
MV 128,a,96,a,28
ds_read_b128 a[68:71], v242 offset:33792
buffer_load_dwordx4 v238, s[48:51], s69 offen offset:2048 sc1 lds
MV 132,a,100,a,24
MV 136,a,100,a,28
ds_read_b128 a[72:75], v242 offset:34816
MV 140,a,104,a,24
ds_read_b128 a[76:79], v242 offset:35840
MV 144,a,104,a,28
buffer_load_dwordx4 v238, s[48:51], s69 offen offset:3072 sc1 lds
MV 148,a,108,a,24
ds_read_b128 a[80:83], v243 offset:32768
MV 152,a,108,a,28
ds_read_b128 a[84:87], v243 offset:33792
MV 156,a,112,a,24
buffer_store_dwordx4 v[120:123], v13, s[24:27], 0 offen offset:3072 sc1
MV 160,a,112,a,28
ds_read_b128 a[88:91], v243 offset:34816
s_add_u32 s69, s69, 16384
MV 164,a,116,a,24
ds_read_b128 a[92:95], v243 offset:35840
MV 168,a,116,a,28
MV 172,a,120,a,24
MV 176,a,120,a,28
MV 180,a,124,a,24
buffer_load_dwordx4 a[24:27], v236, s[44:47], s68 offen offset:1024 sc1
MV 184,a,124,a,28
buffer_load_dwordx4 a[28:31], v237, s[44:47], s68 offen offset:1024 sc1
s_add_u32 s68, s68, 2048
s_mov_b32 s71, 3
.p2align 5
L_p5_loop:
s_waitcnt lgkmcnt(0)
MV 124,a,64,a,32
ds_read_b128 a[96:99], v242 offset:40960
MV 128,a,64,a,36
ds_read_b128 a[100:103], v242 offset:41984
s_add_u32 m0, s70, 82944
MV 132,a,68,a,32
MV 136,a,68,a,36
ds_read_b128 a[104:107], v242 offset:43008
MV 140,a,72,a,32
ds_read_b128 a[108:111], v242 offset:44032
MV 144,a,72,a,36
buffer_load_dwordx4 v238, s[48:51], s69 offen offset:0 sc1 lds
MV 148,a,76,a,32
ds_read_b128 a[112:115], v243 offset:40960
MV 152,a,76,a,36
ds_read_b128 a[116:119], v243 offset:41984
MV 156,a,80,a,32
MV 160,a,80,a,36
ds_read_b128 a[120:123], v243 offset:43008
buffer_load_dwordx4 v238, s[48:51], s69 offen offset:1024 sc1 lds
MV 164,a,84,a,32
ds_read_b128 a[124:127], v243 offset:44032
MV 168,a,84,a,36
MV 172,a,88,a,32
MV 176,a,88,a,36
MV 180,a,92,a,32
buffer_load_dwordx4 a[32:35], v236, s[44:47], s68 offen offset:0 sc1
MV 184,a,92,a,36
buffer_load_dwordx4 a[36:39], v237, s[44:47], s68 offen offset:0 sc1
s_waitcnt vmcnt(14) lgkmcnt(0)
s_barrier
MV 124,a,96,a,40
ds_read_b128 a[64:67], v242 offset:49152
MV 128,a,96,a,44
ds_read_b128 a[68:71], v242 offset:50176
buffer_load_dwordx4 v238, s[48:51], s69 offen offset:2048 sc1 lds
MV 132,a,100,a,40
MV 136,a,100,a,44
ds_read_b128 a[72:75], v242 offset:51200
MV 140,a,104,a,40
ds_read_b128 a[76:79], v242 offset:52224
MV 144,a,104,a,44
buffer_load_dwordx4 v238, s[48:51], s69 offen offset:3072 sc1 lds
MV 148,a,108,a,40
ds_read_b128 a[80:83], v243 offset:49152
MV 152,a,108,a,44
ds_read_b128 a[84:87], v243 offset:50176
MV 156,a,112,a,40
MV 160,a,112,a,44
ds_read_b128 a[88:91], v243 offset:51200
s_add_u32 s69, s69, 16384
MV 164,a,116,a,40
ds_read_b128 a[92:95], v243 offset:52224
MV 168,a,116,a,44
MV 172,a,120,a,40
MV 176,a,120,a,44
MV 180,a,124,a,40
buffer_load_dwordx4 a[40:43], v236, s[44:47], s68 offen offset:1024 sc1
MV 184,a,124,a,44
buffer_load_dwordx4 a[44:47], v237, s[44:47], s68 offen offset:1024 sc1
s_add_u32 s68, s68, 2048
s_waitcnt lgkmcnt(0)
MV 124,a,64,a,48
ds_read_b128 a[96:99], v242 offset:57344
MV 128,a,64,a,52
ds_read_b128 a[100:103], v242 offset:58368
s_add_u32 m0, s70, 99328
MV 132,a,68,a,48
MV 136,a,68,a,52
ds_read_b128 a[104:107], v242 offset:59392
MV 140,a,72,a,48
ds_read_b128 a[108:111], v242 offset:60416
MV 144,a,72,a,52
buffer_load_dwordx4 v238, s[48:51], s69 offen offset:0 sc1 lds
MV 148,a,76,a,48
ds_read_b128 a[112:115], v243 offset:57344
MV 152,a,76,a,52
ds_read_b128 a[116:119], v243 offset:58368
MV 156,a,80,a,48
MV 160,a,80,a,52
ds_read_b128 a[120:123], v243 offset:59392
buffer_load_dwordx4 v238, s[48:51], s69 offen offset:1024 sc1 lds
MV 164,a,84,a,48
ds_read_b128 a[124:127], v243 offset:60416
MV 168,a,84,a,52
MV 172,a,88,a,48
MV 176,a,88,a,52
MV 180,a,92,a,48
buffer_load_dwordx4 a[48:51], v236, s[44:47], s68 offen offset:0 sc1
MV 184,a,92,a,52
buffer_load_dwordx4 a[52:55], v237, s[44:47], s68 offen offset:0 sc1
s_waitcnt vmcnt(14) lgkmcnt(0)
s_barrier
MV 124,a,96,a,56
ds_read_b128 a[64:67], v242 offset:0
MV 128,a,96,a,60
ds_read_b128 a[68:71], v242 offset:1024
buffer_load_dwordx4 v238, s[48:51], s69 offen offset:2048 sc1 lds
MV 132,a,100,a,56
MV 136,a,100,a,60
ds_read_b128 a[72:75], v242 offset:2048
MV 140,a,104,a,56
ds_read_b128 a[76:79], v242 offset:3072
MV 144,a,104,a,60
buffer_load_dwordx4 v238, s[48:51], s69 offen offset:3072 sc1 lds
MV 148,a,108,a,56
ds_read_b128 a[80:83], v243 offset:0
MV 152,a,108,a,60
ds_read_b128 a[84:87], v243 offset:1024
MV 156,a,112,a,56
MV 160,a,112,a,60
ds_read_b128 a[88:91], v243 offset:2048
s_add_u32 s69, s69, 16384
MV 164,a,116,a,56
ds_read_b128 a[92:95], v243 offset:3072
MV 168,a,116,a,60
MV 172,a,120,a,56
MV 176,a,120,a,60
MV 180,a,124,a,56
buffer_load_dwordx4 a[56:59], v236, s[44:47], s68 offen offset:1024 sc1
MV 184,a,124,a,60
buffer_load_dwordx4 a[60:63], v237, s[44:47], s68 offen offset:1024 sc1
s_add_u32 s68, s68, 2048
s_waitcnt lgkmcnt(0)
MV 124,a,64,a,0
ds_read_b128 a[96:99], v242 offset:8192
MV 128,a,64,a,4
ds_read_b128 a[100:103], v242 offset:9216
s_add_u32 m0, s70, 115712
MV 132,a,68,a,0
MV 136,a,68,a,4
ds_read_b128 a[104:107], v242 offset:10240
MV 140,a,72,a,0
ds_read_b128 a[108:111], v242 offset:11264
MV 144,a,72,a,4
buffer_load_dwordx4 v238, s[48:51], s69 offen offset:0 sc1 lds
MV 148,a,76,a,0
ds_read_b128 a[112:115], v243 offset:8192
MV 152,a,76,a,4
ds_read_b128 a[116:119], v243 offset:9216
MV 156,a,80,a,0
MV 160,a,80,a,4
ds_read_b128 a[120:123], v243 offset:10240
buffer_load_dwordx4 v238, s[48:51], s69 offen offset:1024 sc1 lds
MV 164,a,84,a,0
ds_read_b128 a[124:127], v243 offset:11264
MV 168,a,84,a,4
MV 172,a,88,a,0
MV 176,a,88,a,4
MV 180,a,92,a,0
buffer_load_dwordx4 a[0:3], v236, s[44:47], s68 offen offset:0 sc1
MV 184,a,92,a,4
buffer_load_dwordx4 a[4:7], v237, s[44:47], s68 offen offset:0 sc1
s_waitcnt vmcnt(14) lgkmcnt(0)
s_barrier
MV 124,a,96,a,8
ds_read_b128 a[64:67], v242 offset:16384
MV 128,a,96,a,12
ds_read_b128 a[68:71], v242 offset:17408
buffer_load_dwordx4 v238, s[48:51], s69 offen offset:2048 sc1 lds
MV 132,a,100,a,8
MV 136,a,100,a,12
ds_read_b128 a[72:75], v242 offset:18432
MV 140,a,104,a,8
ds_read_b128 a[76:79], v242 offset:19456
MV 144,a,104,a,12
buffer_load_dwordx4 v238, s[48:51], s69 offen offset:3072 sc1 lds
MV 148,a,108,a,8
ds_read_b128 a[80:83], v243 offset:16384
MV 152,a,108,a,12
ds_read_b128 a[84:87], v243 offset:17408
MV 156,a,112,a,8
MV 160,a,112,a,12
ds_read_b128 a[88:91], v243 offset:18432
s_add_u32 s69, s69, 16384
MV 164,a,116,a,8
ds_read_b128 a[92:95], v243 offset:19456
MV 168,a,116,a,12
MV 172,a,120,a,8
MV 176,a,120,a,12
MV 180,a,124,a,8
buffer_load_dwordx4 a[8:11], v236, s[44:47], s68 offen offset:1024 sc1
MV 184,a,124,a,12
buffer_load_dwordx4 a[12:15], v237, s[44:47], s68 offen offset:1024 sc1
s_add_u32 s68, s68, 2048
s_waitcnt lgkmcnt(0)
MV 124,a,64,a,16
ds_read_b128 a[96:99], v242 offset:24576
MV 128,a,64,a,20
ds_read_b128 a[100:103], v242 offset:25600
s_add_u32 m0, s70, 66560
MV 132,a,68,a,16
MV 136,a,68,a,20
ds_read_b128 a[104:107], v242 offset:26624
MV 140,a,72,a,16
ds_read_b128 a[108:111], v242 offset:27648
MV 144,a,72,a,20
buffer_load_dwordx4 v238, s[48:51], s69 offen offset:0 sc1 lds
MV 148,a,76,a,16
ds_read_b128 a[112:115], v243 offset:24576
MV 152,a,76,a,20
ds_read_b128 a[116:119], v243 offset:25600
MV 156,a,80,a,16
MV 160,a,80,a,20
ds_read_b128 a[120:123], v243 offset:26624
buffer_load_dwordx4 v238, s[48:51], s69 offen offset:1024 sc1 lds
MV 164,a,84,a,16
ds_read_b128 a[124:127], v243 offset:27648
MV 168,a,84,a,20
MV 172,a,88,a,16
MV 176,a,88,a,20
MV 180,a,92,a,16
buffer_load_dwordx4 a[16:19], v236, s[44:47], s68 offen offset:0 sc1
MV 184,a,92,a,20
buffer_load_dwordx4 a[20:23], v237, s[44:47], s68 offen offset:0 sc1
s_waitcnt vmcnt(14) lgkmcnt(0)
s_barrier
MV 124,a,96,a,24
ds_read_b128 a[64:67], v242 offset:32768
MV 128,a,96,a,28
ds_read_b128 a[68:71], v242 offset:33792
buffer_load_dwordx4 v238, s[48:51], s69 offen offset:2048 sc1 lds
MV 132,a,100,a,24
MV 136,a,100,a,28
ds_read_b128 a[72:75], v242 offset:34816
MV 140,a,104,a,24
ds_read_b128 a[76:79], v242 offset:35840
MV 144,a,104,a,28
buffer_load_dwordx4 v238, s[48:51], s69 offen offset:3072 sc1 lds
MV 148,a,108,a,24
ds_read_b128 a[80:83], v243 offset:32768
MV 152,a,108,a,28
ds_read_b128 a[84:87], v243 offset:33792
MV 156,a,112,a,24
MV 160,a,112,a,28
ds_read_b128 a[88:91], v243 offset:34816
s_add_u32 s69, s69, 16384
MV 164,a,116,a,24
ds_read_b128 a[92:95], v243 offset:35840
MV 168,a,116,a,28
MV 172,a,120,a,24
MV 176,a,120,a,28
MV 180,a,124,a,24
buffer_load_dwordx4 a[24:27], v236, s[44:47], s68 offen offset:1024 sc1
MV 184,a,124,a,28
buffer_load_dwordx4 a[28:31], v237, s[44:47], s68 offen offset:1024 sc1
s_add_u32 s68, s68, 2048
s_sub_u32 s71, s71, 1
s_cbranch_scc1 L_p5_out
s_cmp_eq_u32 s71, 2
s_cbranch_scc1 L_p5_x1
s_cmp_eq_u32 s71, 0
s_cbranch_scc1 L_p5_x2
s_branch L_p5_loop
L_p5_out:
s_waitcnt lgkmcnt(0)
MV 124,a,64,a,32
ds_read_b128 a[96:99], v242 offset:40960
MV 128,a,64,a,36
ds_read_b128 a[100:103], v242 offset:41984
s_add_u32 m0, s70, 82944
MV 132,a,68,a,32
v_cmp_gt_u32 vcc, 1, v253
s_nop 4
s_cbranch_vccnz L_spin_f3
L_spin_f3_ret:
MV 136,a,68,a,36
ds_read_b128 a[104:107], v242 offset:43008
MV 140,a,72,a,32
ds_read_b128 a[108:111], v242 offset:44032
MV 144,a,72,a,36
buffer_load_dwordx4 v238, s[48:51], s69 offen offset:0 sc1 lds
MV 148,a,76,a,32
ds_read_b128 a[112:115], v243 offset:40960
MV 152,a,76,a,36
ds_read_b128 a[116:119], v243 offset:41984
MV 156,a,80,a,32
MV 160,a,80,a,36
ds_read_b128 a[120:123], v243 offset:43008
buffer_load_dwordx4 v238, s[48:51], s69 offen offset:1024 sc1 lds
MV 164,a,84,a,32
ds_read_b128 a[124:127], v243 offset:44032
MV 168,a,84,a,36
MV 172,a,88,a,32
s_add_u32 s72, s79, 0
MV 176,a,88,a,36
MV 180,a,92,a,32
buffer_load_dwordx4 a[32:35], v236, s[44:47], s68 offen offset:0 sc1
buffer_load_dwordx2 v[208:209], v251, s[56:59], s72 offen offset:0 sc1
MV 184,a,92,a,36
buffer_load_dwordx4 a[36:39], v237, s[44:47], s68 offen offset:0 sc1
s_waitcnt vmcnt(15) lgkmcnt(0)
s_barrier
MV 124,a,96,a,40
ds_read_b128 a[64:67], v242 offset:49152
s_add_u32 s72, s79, 16384
MV 128,a,96,a,44
ds_read_b128 a[68:71], v242 offset:50176
buffer_load_dwordx4 v238, s[48:51], s69 offen offset:2048 sc1 lds
MV 132,a,100,a,40
MV 136,a,100,a,44
ds_read_b128 a[72:75], v242 offset:51200
MV 140,a,104,a,40
ds_read_b128 a[76:79], v242 offset:52224
MV 144,a,104,a,44
buffer_load_dwordx4 v238, s[48:51], s69 offen offset:3072 sc1 lds
MV 148,a,108,a,40
ds_read_b128 a[80:83], v243 offset:49152
MV 152,a,108,a,44
ds_read_b128 a[84:87], v243 offset:50176
MV 156,a,112,a,40
buffer_load_dwordx2 v[210:211], v251, s[56:59], s72 offen offset:0 sc1
MV 160,a,112,a,44
ds_read_b128 a[88:91], v243 offset:51200
s_add_u32 s69, s69, 16384
MV 164,a,116,a,40
ds_read_b128 a[92:95], v243 offset:52224
MV 168,a,116,a,44
MV 172,a,120,a,40
MV 176,a,120,a,44
MV 180,a,124,a,40
buffer_load_dwordx4 a[40:43], v236, s[44:47], s68 offen offset:1024 sc1
MV 184,a,124,a,44
buffer_load_dwordx4 a[44:47], v237, s[44:47], s68 offen offset:1024 sc1
s_add_u32 s68, s68, 2048
s_waitcnt lgkmcnt(0)
MV 124,a,64,a,48
ds_read_b128 a[96:99], v242 offset:57344
s_add_u32 s72, s79, 131072
MV 128,a,64,a,52
ds_read_b128 a[100:103], v242 offset:58368
s_add_u32 m0, s70, 99328
MV 132,a,68,a,48
MV 136,a,68,a,52
ds_read_b128 a[104:107], v242 offset:59392
MV 140,a,72,a,48
ds_read_b128 a[108:111], v242 offset:60416
buffer_load_dwordx2 v[212:213], v251, s[56:59], s72 offen offset:0 sc1
MV 144,a,72,a,52
buffer_load_dwordx4 v238, s[48:51], s69 offen offset:0 sc1 lds
MV 148,a,76,a,48
ds_read_b128 a[112:115], v243 offset:57344
MV 152,a,76,a,52
ds_read_b128 a[116:119], v243 offset:58368
MV 156,a,80,a,48
s_add_u32 s72, s79, 147456
MV 160,a,80,a,52
ds_read_b128 a[120:123], v243 offset:59392
buffer_load_dwordx4 v238, s[48:51], s69 offen offset:1024 sc1 lds
MV 164,a,84,a,48
ds_read_b128 a[124:127], v243 offset:60416
MV 168,a,84,a,52
MV 172,a,88,a,48
buffer_load_dwordx2 v[214:215], v251, s[56:59], s72 offen offset:0 sc1
MV 176,a,88,a,52
MV 180,a,92,a,48
buffer_load_dwordx4 a[48:51], v236, s[44:47], s68 offen offset:0 sc1
MV 184,a,92,a,52
buffer_load_dwordx4 a[52:55], v237, s[44:47], s68 offen offset:0 sc1
s_waitcnt vmcnt(18) lgkmcnt(0)
s_barrier
MV 124,a,96,a,56
ds_read_b128 a[64:67], v242 offset:0
s_add_u32 s72, s79, 0
MV 128,a,96,a,60
ds_read_b128 a[68:71], v242 offset:1024
buffer_load_dwordx4 v238, s[48:51], s69 offen offset:2048 sc1 lds
MV 132,a,100,a,56
MV 136,a,100,a,60
ds_read_b128 a[72:75], v242 offset:2048
MV 140,a,104,a,56
ds_read_b128 a[76:79], v242 offset:3072
MV 144,a,104,a,60
buffer_load_dwordx4 v238, s[48:51], s69 offen offset:3072 sc1 lds
MV 148,a,108,a,56
ds_read_b128 a[80:83], v243 offset:0
MV 152,a,108,a,60
ds_read_b128 a[84:87], v243 offset:1024
MV 156,a,112,a,56
buffer_load_dwordx2 v[216:217], v251, s[56:59], s72 offen offset:128 sc1
MV 160,a,112,a,60
ds_read_b128 a[88:91], v243 offset:2048
s_add_u32 s69, s69, 16384
MV 164,a,116,a,56
ds_read_b128 a[92:95], v243 offset:3072
MV 168,a,116,a,60
MV 172,a,120,a,56
MV 176,a,120,a,60
MV 180,a,124,a,56
buffer_load_dwordx4 a[56:59], v236, s[44:47], s68 offen offset:1024 sc1
MV 184,a,124,a,60
buffer_load_dwordx4 a[60:63], v237, s[44:47], s68 offen offset:1024 sc1
s_add_u32 s68, s68, 2048
s_waitcnt lgkmcnt(0)
MV 124,a,64,a,0
ds_read_b128 a[96:99], v242 offset:8192
s_add_u32 s72, s79, 16384
MV 128,a,64,a,4
ds_read_b128 a[100:103], v242 offset:9216
s_add_u32 m0, s70, 115712
MV 132,a,68,a,0
MV 136,a,68,a,4
ds_read_b128 a[104:107], v242 offset:10240
MV 140,a,72,a,0
ds_read_b128 a[108:111], v242 offset:11264
MV 144,a,72,a,4
buffer_load_dwordx4 v238, s[48:51], s69 offen offset:0 sc1 lds
MV 148,a,76,a,0
ds_read_b128 a[112:115], v243 offset:8192
MV 152,a,76,a,4
ds_read_b128 a[116:119], v243 offset:9216
MV 156,a,80,a,0
buffer_load_dwordx2 v[218:219], v251, s[56:59], s72 offen offset:128 sc1
MV 160,a,80,a,4
ds_read_b128 a[120:123], v243 offset:10240
buffer_load_dwordx4 v238, s[48:51], s69 offen offset:1024 sc1 lds
MV 164,a,84,a,0
ds_read_b128 a[124:127], v243 offset:11264
MV 168,a,84,a,4
MV 172,a,88,a,0
MV 176,a,88,a,4
MV 180,a,92,a,0
buffer_load_dwordx4 a[0:3], v236, s[44:47], s68 offen offset:0 sc1
MV 184,a,92,a,4
buffer_load_dwordx4 a[4:7], v237, s[44:47], s68 offen offset:0 sc1
s_waitcnt vmcnt(19) lgkmcnt(0)
s_barrier
MV 124,a,96,a,8
ds_read_b128 a[64:67], v242 offset:16384
s_add_u32 s72, s79, 131072
MV 128,a,96,a,12
ds_read_b128 a[68:71], v242 offset:17408
buffer_load_dwordx4 v238, s[48:51], s69 offen offset:2048 sc1 lds
MV 132,a,100,a,8
MV 136,a,100,a,12
ds_read_b128 a[72:75], v242 offset:18432
MV 140,a,104,a,8
ds_read_b128 a[76:79], v242 offset:19456
buffer_load_dwordx2 v[220:221], v251, s[56:59], s72 offen offset:128 sc1
MV 144,a,104,a,12
buffer_load_dwordx4 v238, s[48:51], s69 offen offset:3072 sc1 lds
MV 148,a,108,a,8
ds_read_b128 a[80:83], v243 offset:16384
MV 152,a,108,a,12
ds_read_b128 a[84:87], v243 offset:17408
MV 156,a,112,a,8
s_add_u32 s72, s79, 147456
MV 160,a,112,a,12
ds_read_b128 a[88:91], v243 offset:18432
s_add_u32 s69, s69, 16384
MV 164,a,116,a,8
ds_read_b128 a[92:95], v243 offset:19456
MV 168,a,116,a,12
MV 172,a,120,a,8
buffer_load_dwordx2 v[222:223], v251, s[56:59], s72 offen offset:128 sc1
MV 176,a,120,a,12
MV 180,a,124,a,8
buffer_load_dwordx4 a[8:11], v236, s[44:47], s68 offen offset:1024 sc1
MV 184,a,124,a,12
buffer_load_dwordx4 a[12:15], v237, s[44:47], s68 offen offset:1024 sc1
s_add_u32 s68, s68, 2048
s_waitcnt lgkmcnt(0)
MV 124,a,64,a,16
ds_read_b128 a[96:99], v242 offset:24576
MV 128,a,64,a,20
ds_read_b128 a[100:103], v242 offset:25600
s_add_u32 m0, s70, 66560
MV 132,a,68,a,16
MV 136,a,68,a,20
ds_read_b128 a[104:107], v242 offset:26624
MV 140,a,72,a,16
ds_read_b128 a[108:111], v242 offset:27648
MV 144,a,72,a,20
buffer_load_dwordx4 v238, s[48:51], s69 offen offset:0 sc1 lds
MV 148,a,76,a,16
ds_read_b128 a[112:115], v243 offset:24576
MV 152,a,76,a,20
ds_read_b128 a[116:119], v243 offset:25600
MV 156,a,80,a,16
MV 160,a,80,a,20
ds_read_b128 a[120:123], v243 offset:26624
buffer_load_dwordx4 v238, s[48:51], s69 offen offset:1024 sc1 lds
MV 164,a,84,a,16
ds_read_b128 a[124:127], v243 offset:27648
MV 168,a,84,a,20
MV 172,a,88,a,16
MV 176,a,88,a,20
MV 180,a,92,a,16
buffer_load_dwordx4 a[16:19], v236, s[44:47], s68 offen offset:0 sc1
MV 184,a,92,a,20
buffer_load_dwordx4 a[20:23], v237, s[44:47], s68 offen offset:0 sc1
s_waitcnt vmcnt(18) lgkmcnt(0)
s_barrier
MV 124,a,96,a,24
ds_read_b128 a[64:67], v242 offset:32768
MV 128,a,96,a,28
ds_read_b128 a[68:71], v242 offset:33792
buffer_load_dwordx4 v238, s[48:51], s69 offen offset:2048 sc1 lds
MV 132,a,100,a,24
MV 136,a,100,a,28
ds_read_b128 a[72:75], v242 offset:34816
MV 140,a,104,a,24
ds_read_b128 a[76:79], v242 offset:35840
MV 144,a,104,a,28
buffer_load_dwordx4 v238, s[48:51], s69 offen offset:3072 sc1 lds
MV 148,a,108,a,24
ds_read_b128 a[80:83], v243 offset:32768
MV 152,a,108,a,28
ds_read_b128 a[84:87], v243 offset:33792
MV 156,a,112,a,24
MV 160,a,112,a,28
ds_read_b128 a[88:91], v243 offset:34816
s_add_u32 s69, s69, 16384
MV 164,a,116,a,24
ds_read_b128 a[92:95], v243 offset:35840
MV 168,a,116,a,28
MV 172,a,120,a,24
MV 176,a,120,a,28
MV 180,a,124,a,24
buffer_load_dwordx4 a[24:27], v236, s[44:47], s68 offen offset:1024 sc1
MV 184,a,124,a,28
buffer_load_dwordx4 a[28:31], v237, s[44:47], s68 offen offset:1024 sc1
s_add_u32 s68, s68, 2048
s_waitcnt lgkmcnt(0)
MV 124,a,64,a,32
ds_read_b128 a[96:99], v242 offset:40960
v_sub_f32 v8, 1.0, v6
MV 128,a,64,a,36
ds_read_b128 a[100:103], v242 offset:41984
s_add_u32 m0, s70, 82944
MV 132,a,68,a,32
v_lshlrev_b32 v36, 16, v192
v_lshlrev_b32 v228, 16, v208
MV 136,a,68,a,36
ds_read_b128 a[104:107], v242 offset:43008
v_and_b32 v37, 0xffff0000, v192
MV 140,a,72,a,32
ds_read_b128 a[108:111], v242 offset:44032
v_and_b32 v229, 0xffff0000, v208
MV 144,a,72,a,36
buffer_load_dwordx4 v238, s[48:51], s69 offen offset:0 sc1 lds
v_mul_f32 v36, v36, v228
MV 148,a,76,a,32
ds_read_b128 a[112:115], v243 offset:40960
v_mul_f32 v37, v37, v229
MV 152,a,76,a,36
ds_read_b128 a[116:119], v243 offset:41984
v_mul_f32 v36, v36, v6
MV 156,a,80,a,32
v_mul_f32 v37, v37, v6
v_lshlrev_b32 v38, 16, v193
MV 160,a,80,a,36
ds_read_b128 a[120:123], v243 offset:43008
buffer_load_dwordx4 v238, s[48:51], s69 offen offset:1024 sc1 lds
MV 164,a,84,a,32
ds_read_b128 a[124:127], v243 offset:44032
v_lshlrev_b32 v228, 16, v209
MV 168,a,84,a,36
v_and_b32 v39, 0xffff0000, v193
v_and_b32 v229, 0xffff0000, v209
MV 172,a,88,a,32
v_mul_f32 v38, v38, v228
v_mul_f32 v39, v39, v229
MV 176,a,88,a,36
v_mul_f32 v38, v38, v6
v_mul_f32 v39, v39, v6
MV 180,a,92,a,32
buffer_load_dwordx4 a[32:35], v236, s[44:47], s68 offen offset:0 sc1
v_lshlrev_b32 v40, 16, v194
MV 184,a,92,a,36
buffer_load_dwordx4 a[36:39], v237, s[44:47], s68 offen offset:0 sc1
v_lshlrev_b32 v228, 16, v210
v_and_b32 v41, 0xffff0000, v194
v_and_b32 v229, 0xffff0000, v210
s_waitcnt vmcnt(15) lgkmcnt(0)
s_barrier
MV 124,a,96,a,40
ds_read_b128 a[64:67], v242 offset:49152
v_mul_f32 v40, v40, v228
MV 128,a,96,a,44
ds_read_b128 a[68:71], v242 offset:50176
buffer_load_dwordx4 v238, s[48:51], s69 offen offset:2048 sc1 lds
MV 132,a,100,a,40
v_mul_f32 v41, v41, v229
v_mul_f32 v40, v40, v6
MV 136,a,100,a,44
ds_read_b128 a[72:75], v242 offset:51200
v_mul_f32 v41, v41, v6
MV 140,a,104,a,40
ds_read_b128 a[76:79], v242 offset:52224
v_lshlrev_b32 v42, 16, v195
MV 144,a,104,a,44
buffer_load_dwordx4 v238, s[48:51], s69 offen offset:3072 sc1 lds
v_lshlrev_b32 v228, 16, v211
MV 148,a,108,a,40
ds_read_b128 a[80:83], v243 offset:49152
v_and_b32 v43, 0xffff0000, v195
MV 152,a,108,a,44
ds_read_b128 a[84:87], v243 offset:50176
v_and_b32 v229, 0xffff0000, v211
MV 156,a,112,a,40
v_mul_f32 v42, v42, v228
v_mul_f32 v43, v43, v229
MV 160,a,112,a,44
ds_read_b128 a[88:91], v243 offset:51200
s_add_u32 s69, s69, 16384
MV 164,a,116,a,40
ds_read_b128 a[92:95], v243 offset:52224
v_mul_f32 v42, v42, v6
MV 168,a,116,a,44
v_mul_f32 v43, v43, v6
v_lshlrev_b32 v44, 16, v196
MV 172,a,120,a,40
v_lshlrev_b32 v228, 16, v212
v_and_b32 v45, 0xffff0000, v196
MV 176,a,120,a,44
v_and_b32 v229, 0xffff0000, v212
v_mul_f32 v44, v44, v228
MV 180,a,124,a,40
buffer_load_dwordx4 a[40:43], v236, s[44:47], s68 offen offset:1024 sc1
v_mul_f32 v45, v45, v229
MV 184,a,124,a,44
buffer_load_dwordx4 a[44:47], v237, s[44:47], s68 offen offset:1024 sc1
s_add_u32 s68, s68, 2048
v_mul_f32 v44, v44, v6
v_mul_f32 v45, v45, v6
v_lshlrev_b32 v46, 16, v197
v_lshlrev_b32 v228, 16, v213
s_waitcnt lgkmcnt(0)
MV 124,a,64,a,48
ds_read_b128 a[96:99], v242 offset:57344
v_and_b32 v47, 0xffff0000, v197
MV 128,a,64,a,52
ds_read_b128 a[100:103], v242 offset:58368
s_add_u32 m0, s70, 99328
MV 132,a,68,a,48
v_and_b32 v229, 0xffff0000, v213
v_mul_f32 v46, v46, v228
MV 136,a,68,a,52
ds_read_b128 a[104:107], v242 offset:59392
v_mul_f32 v47, v47, v229
MV 140,a,72,a,48
ds_read_b128 a[108:111], v242 offset:60416
v_mul_f32 v46, v46, v6
MV 144,a,72,a,52
buffer_load_dwordx4 v238, s[48:51], s69 offen offset:0 sc1 lds
v_mul_f32 v47, v47, v6
MV 148,a,76,a,48
ds_read_b128 a[112:115], v243 offset:57344
v_lshlrev_b32 v48, 16, v198
MV 152,a,76,a,52
ds_read_b128 a[116:119], v243 offset:58368
v_lshlrev_b32 v228, 16, v214
MV 156,a,80,a,48
v_and_b32 v49, 0xffff0000, v198
v_and_b32 v229, 0xffff0000, v214
MV 160,a,80,a,52
ds_read_b128 a[120:123], v243 offset:59392
buffer_load_dwordx4 v238, s[48:51], s69 offen offset:1024 sc1 lds
MV 164,a,84,a,48
ds_read_b128 a[124:127], v243 offset:60416
v_mul_f32 v48, v48, v228
MV 168,a,84,a,52
v_mul_f32 v49, v49, v229
v_mul_f32 v48, v48, v6
MV 172,a,88,a,48
v_mul_f32 v49, v49, v6
v_lshlrev_b32 v50, 16, v199
MV 176,a,88,a,52
v_lshlrev_b32 v228, 16, v215
v_and_b32 v51, 0xffff0000, v199
MV 180,a,92,a,48
buffer_load_dwordx4 a[48:51], v236, s[44:47], s68 offen offset:0 sc1
v_and_b32 v229, 0xffff0000, v215
MV 184,a,92,a,52
buffer_load_dwordx4 a[52:55], v237, s[44:47], s68 offen offset:0 sc1
v_mul_f32 v50, v50, v228
v_mul_f32 v51, v51, v229
v_mul_f32 v50, v50, v6
v_mul_f32 v51, v51, v6
s_waitcnt vmcnt(14) lgkmcnt(0)
s_barrier
MV 124,a,96,a,56
ds_read_b128 a[64:67], v242 offset:0
v_sub_f32 v9, 1.0, v7
MV 128,a,96,a,60
ds_read_b128 a[68:71], v242 offset:1024
buffer_load_dwordx4 v238, s[48:51], s69 offen offset:2048 sc1 lds
MV 132,a,100,a,56
v_lshlrev_b32 v52, 16, v200
v_lshlrev_b32 v228, 16, v216
MV 136,a,100,a,60
ds_read_b128 a[72:75], v242 offset:2048
v_and_b32 v53, 0xffff0000, v200
MV 140,a,104,a,56
ds_read_b128 a[76:79], v242 offset:3072
v_and_b32 v229, 0xffff0000, v216
MV 144,a,104,a,60
buffer_load_dwordx4 v238, s[48:51], s69 offen offset:3072 sc1 lds
v_mul_f32 v52, v52, v228
MV 148,a,108,a,56
ds_read_b128 a[80:83], v243 offset:0
v_mul_f32 v53, v53, v229
MV 152,a,108,a,60
ds_read_b128 a[84:87], v243 offset:1024
v_mul_f32 v52, v52, v7
MV 156,a,112,a,56
v_mul_f32 v53, v53, v7
v_lshlrev_b32 v54, 16, v201
MV 160,a,112,a,60
ds_read_b128 a[88:91], v243 offset:2048
s_add_u32 s69, s69, 16384
MV 164,a,116,a,56
ds_read_b128 a[92:95], v243 offset:3072
v_lshlrev_b32 v228, 16, v217
MV 168,a,116,a,60
v_and_b32 v55, 0xffff0000, v201
v_and_b32 v229, 0xffff0000, v217
MV 172,a,120,a,56
v_mul_f32 v54, v54, v228
v_mul_f32 v55, v55, v229
MV 176,a,120,a,60
v_mul_f32 v54, v54, v7
v_mul_f32 v55, v55, v7
MV 180,a,124,a,56
buffer_load_dwordx4 a[56:59], v236, s[44:47], s68 offen offset:1024 sc1
v_lshlrev_b32 v56, 16, v202
MV 184,a,124,a,60
buffer_load_dwordx4 a[60:63], v237, s[44:47], s68 offen offset:1024 sc1
s_add_u32 s68, s68, 2048
v_lshlrev_b32 v228, 16, v218
v_and_b32 v57, 0xffff0000, v202
v_and_b32 v229, 0xffff0000, v218
s_waitcnt lgkmcnt(0)
MV 124,a,64,a,0
ds_read_b128 a[96:99], v242 offset:8192
v_mul_f32 v56, v56, v228
MV 128,a,64,a,4
ds_read_b128 a[100:103], v242 offset:9216
s_add_u32 m0, s70, 115712
MV 132,a,68,a,0
v_mul_f32 v57, v57, v229
v_mul_f32 v56, v56, v7
MV 136,a,68,a,4
ds_read_b128 a[104:107], v242 offset:10240
v_mul_f32 v57, v57, v7
MV 140,a,72,a,0
ds_read_b128 a[108:111], v242 offset:11264
v_lshlrev_b32 v58, 16, v203
MV 144,a,72,a,4
buffer_load_dwordx4 v238, s[48:51], s69 offen offset:0 sc1 lds
v_lshlrev_b32 v228, 16, v219
MV 148,a,76,a,0
ds_read_b128 a[112:115], v243 offset:8192
v_and_b32 v59, 0xffff0000, v203
MV 152,a,76,a,4
ds_read_b128 a[116:119], v243 offset:9216
v_and_b32 v229, 0xffff0000, v219
MV 156,a,80,a,0
v_mul_f32 v58, v58, v228
v_mul_f32 v59, v59, v229
MV 160,a,80,a,4
ds_read_b128 a[120:123], v243 offset:10240
buffer_load_dwordx4 v238, s[48:51], s69 offen offset:1024 sc1 lds
MV 164,a,84,a,0
ds_read_b128 a[124:127], v243 offset:11264
v_mul_f32 v58, v58, v7
MV 168,a,84,a,4
v_mul_f32 v59, v59, v7
v_lshlrev_b32 v60, 16, v204
MV 172,a,88,a,0
v_lshlrev_b32 v228, 16, v220
v_and_b32 v61, 0xffff0000, v204
MV 176,a,88,a,4
v_and_b32 v229, 0xffff0000, v220
v_mul_f32 v60, v60, v228
MV 180,a,92,a,0
v_mul_f32 v61, v61, v229
v_mul_f32 v60, v60, v7
MV 184,a,92,a,4
v_mul_f32 v61, v61, v7
v_lshlrev_b32 v62, 16, v205
v_lshlrev_b32 v228, 16, v221
s_waitcnt vmcnt(12) lgkmcnt(0)
s_barrier
MV 124,a,96,a,8
ds_read_b128 a[80:83], v243 offset:16384
v_and_b32 v63, 0xffff0000, v205
MV 128,a,96,a,12
buffer_load_dwordx4 v238, s[48:51], s69 offen offset:2048 sc1 lds
v_and_b32 v229, 0xffff0000, v221
MV 132,a,100,a,8
v_mul_f32 v62, v62, v228
v_mul_f32 v63, v63, v229
MV 136,a,100,a,12
ds_read_b128 a[84:87], v243 offset:17408
v_mul_f32 v62, v62, v7
MV 140,a,104,a,8
v_mul_f32 v63, v63, v7
v_lshlrev_b32 v64, 16, v206
MV 144,a,104,a,12
buffer_load_dwordx4 v238, s[48:51], s69 offen offset:3072 sc1 lds
v_lshlrev_b32 v228, 16, v222
MV 148,a,108,a,8
ds_read_b128 a[88:91], v243 offset:18432
v_and_b32 v65, 0xffff0000, v206
MV 152,a,108,a,12
v_and_b32 v229, 0xffff0000, v222
v_mul_f32 v64, v64, v228
MV 156,a,112,a,8
v_mul_f32 v65, v65, v229
v_mul_f32 v64, v64, v7
MV 160,a,112,a,12
ds_read_b128 a[92:95], v243 offset:19456
s_add_u32 s69, s69, 16384
MV 164,a,116,a,8
v_mul_f32 v65, v65, v7
v_lshlrev_b32 v66, 16, v207
MV 168,a,116,a,12
v_lshlrev_b32 v228, 16, v223
v_and_b32 v67, 0xffff0000, v207
MV 172,a,120,a,8
v_and_b32 v229, 0xffff0000, v223
MV 176,a,120,a,12
v_mul_f32 v66, v66, v228
v_mul_f32 v67, v67, v229
MV 180,a,124,a,8
v_mul_f32 v66, v66, v7
MV 184,a,124,a,12
v_mul_f32 v67, v67, v7
s_waitcnt lgkmcnt(0)
MV 156,a,80,a,16
ds_read_b128 a[112:115], v243 offset:24576
s_xor_b32 s72, s2, 4
MV 160,a,80,a,20
ds_read_b128 a[116:119], v243 offset:25600
s_lshl_b32 s72, s72, 14
MV 164,a,84,a,16
ds_read_b128 a[120:123], v243 offset:26624
MV 168,a,84,a,20
ds_read_b128 a[124:127], v243 offset:27648
MV 172,a,88,a,16
MV 176,a,88,a,20
MV 180,a,92,a,16
MV 184,a,92,a,20
s_waitcnt vmcnt(6)
s_barrier
s_waitcnt lgkmcnt(3)
MV 156,a,112,a,24
ds_read_b128 a[80:83], v243 offset:32768
MV 160,a,112,a,28
ds_read_b128 a[84:87], v243 offset:33792
s_waitcnt lgkmcnt(4)
MV 164,a,116,a,24
ds_read_b128 a[88:91], v243 offset:34816
MV 168,a,116,a,28
ds_read_b128 a[92:95], v243 offset:35840
s_waitcnt lgkmcnt(5)
MV 172,a,120,a,24
MV 176,a,120,a,28
s_waitcnt lgkmcnt(4)
MV 180,a,124,a,24
MV 184,a,124,a,28
s_waitcnt lgkmcnt(3)
MV 156,a,80,a,32
ds_read_b128 a[112:115], v243 offset:40960
MV 160,a,80,a,36
ds_read_b128 a[116:119], v243 offset:41984
s_waitcnt lgkmcnt(4)
MV 164,a,84,a,32
ds_read_b128 a[120:123], v243 offset:43008
MV 168,a,84,a,36
ds_read_b128 a[124:127], v243 offset:44032
s_waitcnt lgkmcnt(5)
MV 172,a,88,a,32
MV 176,a,88,a,36
s_waitcnt lgkmcnt(4)
MV 180,a,92,a,32
MV 184,a,92,a,36
s_waitcnt vmcnt(0)
s_barrier
s_waitcnt lgkmcnt(3)
MV 156,a,112,a,40
ds_read_b128 a[80:83], v243 offset:49152
MV 160,a,112,a,44
ds_read_b128 a[84:87], v243 offset:50176
s_waitcnt lgkmcnt(4)
MV 164,a,116,a,40
ds_read_b128 a[88:91], v243 offset:51200
MV 168,a,116,a,44
ds_read_b128 a[92:95], v243 offset:52224
s_waitcnt lgkmcnt(5)
MV 172,a,120,a,40
MV 176,a,120,a,44
s_waitcnt lgkmcnt(4)
MV 180,a,124,a,40
MV 184,a,124,a,44
s_waitcnt lgkmcnt(3)
MV 156,a,80,a,48
ds_read_b128 a[112:115], v243 offset:57344
MV 160,a,80,a,52
ds_read_b128 a[116:119], v243 offset:58368
s_waitcnt lgkmcnt(4)
MV 164,a,84,a,48
ds_read_b128 a[120:123], v243 offset:59392
MV 168,a,84,a,52
ds_read_b128 a[124:127], v243 offset:60416
s_waitcnt lgkmcnt(5)
MV 172,a,88,a,48
MV 176,a,88,a,52
s_waitcnt lgkmcnt(4)
MV 180,a,92,a,48
MV 184,a,92,a,52
s_waitcnt lgkmcnt(3)
MV 156,a,112,a,56
ds_read_b128 a[64:67], v242 offset:16384
MV 160,a,112,a,60
ds_read_b128 a[68:71], v242 offset:17408
s_waitcnt lgkmcnt(4)
MV 164,a,116,a,56
ds_read_b128 a[72:75], v242 offset:18432
MV 168,a,116,a,60
ds_read_b128 a[76:79], v242 offset:19456
s_waitcnt lgkmcnt(5)
MV 172,a,120,a,56
MV 176,a,120,a,60
s_waitcnt lgkmcnt(4)
MV 180,a,124,a,56
MV 184,a,124,a,60
s_waitcnt lgkmcnt(3)
MV 124,a,64,a,16
ds_read_b128 a[96:99], v242 offset:24576
MV 128,a,64,a,20
ds_read_b128 a[100:103], v242 offset:25600
s_waitcnt lgkmcnt(4)
MV 132,a,68,a,16
ds_read_b128 a[104:107], v242 offset:26624
v_permlane16_swap_b32 v156, v164
MV 136,a,68,a,20
ds_read_b128 a[108:111], v242 offset:27648
v_permlane16_swap_b32 v157, v165
s_waitcnt lgkmcnt(5)
MV 140,a,72,a,16
v_permlane16_swap_b32 v158, v166
v_permlane16_swap_b32 v159, v167
MV 144,a,72,a,20
v_cvt_pk_bf16_f32 v156, v156, v157
v_cvt_pk_bf16_f32 v157, v158, v159
s_waitcnt lgkmcnt(4)
MV 148,a,76,a,16
v_cvt_pk_bf16_f32 v158, v164, v165
v_cvt_pk_bf16_f32 v159, v166, v167
MV 152,a,76,a,20
buffer_store_dwordx4 v[156:159], v238, s[52:55], s72 offen offset:0 sc1
v_permlane16_swap_b32 v172, v180
s_waitcnt lgkmcnt(3)
MV 124,a,96,a,24
ds_read_b128 a[64:67], v242 offset:32768
v_permlane16_swap_b32 v173, v181
MV 128,a,96,a,28
ds_read_b128 a[68:71], v242 offset:33792
v_permlane16_swap_b32 v174, v182
s_waitcnt lgkmcnt(4)
MV 132,a,100,a,24
ds_read_b128 a[72:75], v242 offset:34816
v_permlane16_swap_b32 v175, v183
MV 136,a,100,a,28
ds_read_b128 a[76:79], v242 offset:35840
v_cvt_pk_bf16_f32 v172, v172, v173
s_waitcnt lgkmcnt(5)
MV 140,a,104,a,24
v_cvt_pk_bf16_f32 v173, v174, v175
v_cvt_pk_bf16_f32 v174, v180, v181
MV 144,a,104,a,28
v_cvt_pk_bf16_f32 v175, v182, v183
buffer_store_dwordx4 v[172:175], v238, s[52:55], s72 offen offset:1024 sc1
s_waitcnt lgkmcnt(4)
MV 148,a,108,a,24
v_permlane16_swap_b32 v160, v168
v_permlane16_swap_b32 v161, v169
MV 152,a,108,a,28
v_permlane16_swap_b32 v162, v170
v_permlane16_swap_b32 v163, v171
s_waitcnt lgkmcnt(3)
MV 124,a,64,a,32
ds_read_b128 a[96:99], v242 offset:40960
v_cvt_pk_bf16_f32 v160, v160, v161
MV 128,a,64,a,36
ds_read_b128 a[100:103], v242 offset:41984
v_cvt_pk_bf16_f32 v161, v162, v163
s_waitcnt lgkmcnt(4)
MV 132,a,68,a,32
ds_read_b128 a[104:107], v242 offset:43008
v_cvt_pk_bf16_f32 v162, v168, v169
MV 136,a,68,a,36
ds_read_b128 a[108:111], v242 offset:44032
v_cvt_pk_bf16_f32 v163, v170, v171
s_waitcnt lgkmcnt(5)
MV 140,a,72,a,32
buffer_store_dwordx4 v[160:163], v238, s[52:55], s72 offen offset:2048 sc1
v_permlane16_swap_b32 v176, v184
MV 144,a,72,a,36
v_permlane16_swap_b32 v177, v185
v_permlane16_swap_b32 v178, v186
s_waitcnt lgkmcnt(4)
MV 148,a,76,a,32
v_permlane16_swap_b32 v179, v187
v_cvt_pk_bf16_f32 v176, v176, v177
MV 152,a,76,a,36
v_cvt_pk_bf16_f32 v177, v178, v179
v_cvt_pk_bf16_f32 v178, v184, v185
s_waitcnt lgkmcnt(3)
MV 124,a,96,a,40
ds_read_b128 a[64:67], v242 offset:49152
v_cvt_pk_bf16_f32 v179, v186, v187
MV 128,a,96,a,44
ds_read_b128 a[68:71], v242 offset:50176
buffer_store_dwordx4 v[176:179], v238, s[52:55], s72 offen offset:3072 sc1
s_waitcnt lgkmcnt(4)
MV 132,a,100,a,40
ds_read_b128 a[72:75], v242 offset:51200
MV 136,a,100,a,44
ds_read_b128 a[76:79], v242 offset:52224
s_waitcnt lgkmcnt(5)
MV 140,a,104,a,40
MV 144,a,104,a,44
s_waitcnt lgkmcnt(4)
MV 148,a,108,a,40
MV 152,a,108,a,44
s_waitcnt lgkmcnt(3)
MV 124,a,64,a,48
ds_read_b128 a[96:99], v242 offset:57344
MV 128,a,64,a,52
ds_read_b128 a[100:103], v242 offset:58368
s_waitcnt lgkmcnt(4)
MV 132,a,68,a,48
ds_read_b128 a[104:107], v242 offset:59392
MV 136,a,68,a,52
ds_read_b128 a[108:111], v242 offset:60416
s_waitcnt lgkmcnt(5)
MV 140,a,72,a,48
MV 144,a,72,a,52
s_waitcnt lgkmcnt(4)
MV 148,a,76,a,48
MV 152,a,76,a,52
s_waitcnt lgkmcnt(3)
MV 124,a,96,a,56
MV 128,a,96,a,60
s_waitcnt lgkmcnt(2)
MV 132,a,100,a,56
MV 136,a,100,a,60
s_waitcnt lgkmcnt(1)
MV 140,a,104,a,56
MV 144,a,104,a,60
s_waitcnt lgkmcnt(0)
MV 148,a,108,a,56
MV 152,a,108,a,60
s_nop 0
v_permlane16_swap_b32 v124, v132
v_permlane16_swap_b32 v125, v133
v_permlane16_swap_b32 v126, v134
v_permlane16_swap_b32 v127, v135
s_nop 1
v_permlane16_swap_b32 v140, v148
v_permlane16_swap_b32 v141, v149
v_permlane16_swap_b32 v142, v150
v_permlane16_swap_b32 v143, v151
v_permlane16_swap_b32 v128, v136
v_permlane16_swap_b32 v129, v137
v_permlane16_swap_b32 v130, v138
v_permlane16_swap_b32 v131, v139
v_permlane16_swap_b32 v144, v152
v_permlane16_swap_b32 v145, v153
v_permlane16_swap_b32 v146, v154
v_permlane16_swap_b32 v147, v155
v_fma_f32 v36, v124, v8, v36
v_fma_f32 v37, v125, v8, v37
v_fma_f32 v38, v126, v8, v38
v_fma_f32 v39, v127, v8, v39
v_fma_f32 v40, v132, v8, v40
v_fma_f32 v41, v133, v8, v41
v_fma_f32 v42, v134, v8, v42
v_fma_f32 v43, v135, v8, v43
v_fma_f32 v44, v140, v8, v44
v_fma_f32 v45, v141, v8, v45
v_fma_f32 v46, v142, v8, v46
v_fma_f32 v47, v143, v8, v47
v_fma_f32 v48, v148, v8, v48
v_fma_f32 v49, v149, v8, v49
v_fma_f32 v50, v150, v8, v50
v_fma_f32 v51, v151, v8, v51
v_fma_f32 v52, v128, v9, v52
v_fma_f32 v53, v129, v9, v53
v_fma_f32 v54, v130, v9, v54
v_fma_f32 v55, v131, v9, v55
v_fma_f32 v56, v136, v9, v56
v_fma_f32 v57, v137, v9, v57
v_fma_f32 v58, v138, v9, v58
v_fma_f32 v59, v139, v9, v59
v_fma_f32 v60, v144, v9, v60
v_fma_f32 v61, v145, v9, v61
v_fma_f32 v62, v146, v9, v62
v_fma_f32 v63, v147, v9, v63
v_fma_f32 v64, v152, v9, v64
v_fma_f32 v65, v153, v9, v65
v_fma_f32 v66, v154, v9, v66
v_fma_f32 v67, v155, v9, v67
s_lshl_b32 s72, s2, 14
s_mov_b32 s73, 400000
L_xb:
buffer_load_dwordx4 v[76:79], v238, s[52:55], s72 offen offset:0 sc1
buffer_load_dwordx4 v[80:83], v238, s[52:55], s72 offen offset:1024 sc1
buffer_load_dwordx4 v[84:87], v238, s[52:55], s72 offen offset:2048 sc1
buffer_load_dwordx4 v[88:91], v238, s[52:55], s72 offen offset:3072 sc1
s_sub_u32 s73, s73, 1
s_cbranch_scc1 L_xb_done
s_waitcnt vmcnt(3)
v_max3_u32 v228, v76, v77, v78
s_waitcnt vmcnt(2)
v_max3_u32 v228, v228, v79, v80
v_max3_u32 v228, v228, v81, v82
s_waitcnt vmcnt(1)
v_max3_u32 v228, v228, v83, v84
v_max3_u32 v228, v228, v85, v86
s_waitcnt vmcnt(0)
v_max3_u32 v228, v228, v87, v88
v_max3_u32 v228, v228, v89, v90
v_max_u32 v228, v228, v91
v_cmp_eq_u32 vcc, -1, v228
s_nop 4
s_cbranch_vccnz L_xb
L_xb_done:
s_waitcnt vmcnt(0)
s_add_u32 s72, s78, 0
v_lshlrev_b32 v92, 16, v76
v_and_b32 v93, 0xffff0000, v76
v_fmac_f32 v36, v92, v8
v_fmac_f32 v37, v93, v8
v_cvt_pk_bf16_f32 v192, v36, v37
v_lshlrev_b32 v92, 16, v77
v_and_b32 v93, 0xffff0000, v77
v_fmac_f32 v38, v92, v8
v_fmac_f32 v39, v93, v8
v_cvt_pk_bf16_f32 v193, v38, v39
v_lshlrev_b32 v92, 16, v78
v_and_b32 v93, 0xffff0000, v78
v_fmac_f32 v40, v92, v8
v_fmac_f32 v41, v93, v8
v_cvt_pk_bf16_f32 v194, v40, v41
v_lshlrev_b32 v92, 16, v79
v_and_b32 v93, 0xffff0000, v79
v_fmac_f32 v42, v92, v8
v_fmac_f32 v43, v93, v8
v_cvt_pk_bf16_f32 v195, v42, v43
buffer_store_dwordx4 v[192:195], v250, s[60:63], s72 offen offset:0 sc1
v_lshlrev_b32 v92, 16, v80
v_and_b32 v93, 0xffff0000, v80
v_fmac_f32 v44, v92, v8
v_fmac_f32 v45, v93, v8
v_cvt_pk_bf16_f32 v196, v44, v45
v_lshlrev_b32 v92, 16, v81
v_and_b32 v93, 0xffff0000, v81
v_fmac_f32 v46, v92, v8
v_fmac_f32 v47, v93, v8
v_cvt_pk_bf16_f32 v197, v46, v47
v_lshlrev_b32 v92, 16, v82
v_and_b32 v93, 0xffff0000, v82
v_fmac_f32 v48, v92, v8
v_fmac_f32 v49, v93, v8
v_cvt_pk_bf16_f32 v198, v48, v49
v_lshlrev_b32 v92, 16, v83
v_and_b32 v93, 0xffff0000, v83
v_fmac_f32 v50, v92, v8
v_fmac_f32 v51, v93, v8
v_cvt_pk_bf16_f32 v199, v50, v51
buffer_store_dwordx4 v[196:199], v250, s[60:63], s72 offen offset:64 sc1
s_add_u32 s72, s78, 32768
v_lshlrev_b32 v92, 16, v84
v_and_b32 v93, 0xffff0000, v84
v_fmac_f32 v52, v92, v9
v_fmac_f32 v53, v93, v9
v_cvt_pk_bf16_f32 v200, v52, v53
v_lshlrev_b32 v92, 16, v85
v_and_b32 v93, 0xffff0000, v85
v_fmac_f32 v54, v92, v9
v_fmac_f32 v55, v93, v9
v_cvt_pk_bf16_f32 v201, v54, v55
v_lshlrev_b32 v92, 16, v86
v_and_b32 v93, 0xffff0000, v86
v_fmac_f32 v56, v92, v9
v_fmac_f32 v57, v93, v9
v_cvt_pk_bf16_f32 v202, v56, v57
v_lshlrev_b32 v92, 16, v87
v_and_b32 v93, 0xffff0000, v87
v_fmac_f32 v58, v92, v9
v_fmac_f32 v59, v93, v9
v_cvt_pk_bf16_f32 v203, v58, v59
buffer_store_dwordx4 v[200:203], v250, s[60:63], s72 offen offset:0 sc1
v_lshlrev_b32 v92, 16, v88
v_and_b32 v93, 0xffff0000, v88
v_fmac_f32 v60, v92, v9
v_fmac_f32 v61, v93, v9
v_cvt_pk_bf16_f32 v204, v60, v61
v_lshlrev_b32 v92, 16, v89
v_and_b32 v93, 0xffff0000, v89
v_fmac_f32 v62, v92, v9
v_fmac_f32 v63, v93, v9
v_cvt_pk_bf16_f32 v205, v62, v63
v_lshlrev_b32 v92, 16, v90
v_and_b32 v93, 0xffff0000, v90
v_fmac_f32 v64, v92, v9
v_fmac_f32 v65, v93, v9
v_cvt_pk_bf16_f32 v206, v64, v65
v_lshlrev_b32 v92, 16, v91
v_and_b32 v93, 0xffff0000, v91
v_fmac_f32 v66, v92, v9
v_fmac_f32 v67, v93, v9
v_cvt_pk_bf16_f32 v207, v66, v67
buffer_store_dwordx4 v[204:207], v250, s[60:63], s72 offen offset:64 sc1
L_end:
s_endpgm
L_p3_pmask:
s_nop 7
v_add_u32 v246, 0, v13
v_cmp_gt_i32_e64 s[84:85], 0, v246
v_cmp_gt_i32_e64 s[86:87], 1, v246
v_cmp_gt_i32_e64 s[88:89], 2, v246
v_cmp_gt_i32_e64 s[90:91], 3, v246
v_cndmask_b32_e64 v96, v96, v14, s[84:85]
v_cndmask_b32_e64 v97, v97, v14, s[86:87]
v_cndmask_b32_e64 v98, v98, v14, s[88:89]
v_cndmask_b32_e64 v99, v99, v14, s[90:91]
v_add_u32 v247, -16, v13
v_cmp_gt_i32_e64 s[92:93], 0, v247
v_cmp_gt_i32_e64 s[94:95], 1, v247
v_cmp_gt_i32_e64 s[96:97], 2, v247
v_cmp_gt_i32_e64 s[98:99], 3, v247
v_cndmask_b32_e64 v100, v100, v14, s[92:93]
v_cndmask_b32_e64 v101, v101, v14, s[94:95]
v_cndmask_b32_e64 v102, v102, v14, s[96:97]
v_cndmask_b32_e64 v103, v103, v14, s[98:99]
v_add_u32 v246, -32, v13
v_cmp_gt_i32_e64 s[84:85], 0, v246
v_cmp_gt_i32_e64 s[86:87], 1, v246
v_cmp_gt_i32_e64 s[88:89], 2, v246
v_cmp_gt_i32_e64 s[90:91], 3, v246
v_cndmask_b32_e64 v128, v128, v14, s[84:85]
v_cndmask_b32_e64 v129, v129, v14, s[86:87]
v_cndmask_b32_e64 v130, v130, v14, s[88:89]
v_cndmask_b32_e64 v131, v131, v14, s[90:91]
v_add_u32 v247, -48, v13
v_cmp_gt_i32_e64 s[92:93], 0, v247
v_cmp_gt_i32_e64 s[94:95], 1, v247
v_cmp_gt_i32_e64 s[96:97], 2, v247
v_cmp_gt_i32_e64 s[98:99], 3, v247
v_cndmask_b32_e64 v132, v132, v14, s[92:93]
v_cndmask_b32_e64 v133, v133, v14, s[94:95]
v_cndmask_b32_e64 v134, v134, v14, s[96:97]
v_cndmask_b32_e64 v135, v135, v14, s[98:99]
s_branch L_p3_pmask_ret
L_p3_mxm_top:
s_waitcnt lgkmcnt(0)
v_xor_b32 v11, 0x8000, v11
v_mfma_f32_16x16x32_bf16 v[80:83], a[128:131], v[16:19], 0
s_add_u32 m0, s73, 16384
ds_read_b128 a[192:195], v11 offset:0
v_mfma_f32_16x16x32_bf16 v[88:91], a[128:131], v[32:35], 0
v_exp_f32 v176, v176
MV 80,a,132,v,20
v_exp_f32 v177, v177
MV 88,a,132,v,36
ds_read_b128 a[196:199], v11 offset:1024
buffer_load_dwordx4 v12, s[56:59], s71 offen offset:0 sc1 lds
MV 80,a,136,v,24
v_exp_f32 v178, v178
MV 88,a,136,v,40
v_add_f32 v2, v2, v176
v_add_f32 v2, v2, v177
MV 80,a,140,v,28
ds_read_b128 a[200:203], v11 offset:2048
ds_read_b128 a[204:207], v11 offset:3072
MV 88,a,140,v,44
v_exp_f32 v179, v179
v_mfma_f32_16x16x32_bf16 v[84:87], a[144:147], v[16:19], 0
ds_read_b128 a[208:211], v11 offset:4096
v_cvt_pk_bf16_f32 v176, v176, v177
v_mfma_f32_16x16x32_bf16 v[92:95], a[144:147], v[32:35], 0
v_exp_f32 v180, v180
MV 84,a,148,v,20
v_add_f32 v2, v2, v178
v_add_f32 v2, v2, v179
MV 92,a,148,v,36
v_exp_f32 v181, v181
MV 84,a,152,v,24
buffer_load_dwordx4 v12, s[56:59], s71 offen offset:1024 sc1 lds
v_cvt_pk_bf16_f32 v177, v178, v179
MV 92,a,152,v,40
v_exp_f32 v182, v182
MV 84,a,156,v,28
ds_read_b128 a[212:215], v11 offset:5120
v_add_f32 v2, v2, v180
MV 92,a,156,v,44
ds_read_b128 a[216:219], v11 offset:6144
v_add_f32 v2, v2, v181
v_mfma_f32_16x16x32_bf16 v[112:115], a[160:163], v[16:19], 0
v_exp_f32 v183, v183
v_mfma_f32_16x16x32_bf16 v[120:123], a[160:163], v[32:35], 0
ds_read_b128 a[220:223], v11 offset:7168
v_cvt_pk_bf16_f32 v178, v180, v181
MV 112,a,164,v,20
v_exp_f32 v184, v184
MV 120,a,164,v,36
v_add_f32 v2, v2, v182
v_add_f32 v2, v2, v183
MV 112,a,168,v,24
ds_read_b128 a[224:227], v11 offset:8192
buffer_load_dwordx4 v12, s[56:59], s71 offen offset:2048 sc1 lds
MV 120,a,168,v,40
v_exp_f32 v185, v185
MV 112,a,172,v,28
ds_read_b128 a[228:231], v11 offset:9216
v_cvt_pk_bf16_f32 v179, v182, v183
MV 120,a,172,v,44
v_exp_f32 v186, v186
v_mfma_f32_16x16x32_bf16 v[116:119], a[176:179], v[16:19], 0
v_add_f32 v3, v3, v184
v_add_f32 v3, v3, v185
v_mfma_f32_16x16x32_bf16 v[124:127], a[176:179], v[32:35], 0
v_exp_f32 v187, v187
MV 116,a,180,v,20
ds_read_b128 a[232:235], v11 offset:10240
v_cvt_pk_bf16_f32 v184, v184, v185
MV 124,a,180,v,36
v_exp_f32 v188, v188
MV 116,a,184,v,24
ds_read_b128 a[236:239], v11 offset:11264
v_add_f32 v3, v3, v186
MV 124,a,184,v,40
buffer_load_dwordx4 v12, s[56:59], s71 offen offset:3072 sc1 lds
v_add_f32 v3, v3, v187
MV 116,a,188,v,28
v_exp_f32 v189, v189
MV 124,a,188,v,44
ds_read_b128 a[240:243], v11 offset:12288
ds_read_b128 a[244:247], v11 offset:13312
ds_read_b128 a[248:251], v11 offset:14336
ds_read_b128 a[252:255], v11 offset:15360
s_add_u32 s71, s71, 16384
s_xor_b32 s73, s73, 0x8000
v_cvt_pk_bf16_f32 v185, v186, v187
v_exp_f32 v190, v190
v_add_f32 v3, v3, v188
v_add_f32 v3, v3, v189
v_exp_f32 v191, v191
v_cvt_pk_bf16_f32 v186, v188, v189
v_exp_f32 v200, v200
v_add_f32 v3, v3, v190
v_add_f32 v3, v3, v191
v_exp_f32 v201, v201
v_cvt_pk_bf16_f32 v187, v190, v191
v_exp_f32 v202, v202
v_add_u32 v246, 0, v13
v_cmp_gt_i32_e64 s[84:85], 0, v246
v_add_f32 v5, v5, v200
v_cmp_gt_i32_e64 s[86:87], 1, v246
v_cmp_gt_i32_e64 s[88:89], 2, v246
v_add_f32 v5, v5, v201
v_exp_f32 v203, v203
v_cmp_gt_i32_e64 s[90:91], 3, v246
v_cndmask_b32_e64 v80, v80, v14, s[84:85]
v_cvt_pk_bf16_f32 v200, v200, v201
v_exp_f32 v204, v204
v_cndmask_b32_e64 v81, v81, v14, s[86:87]
v_cndmask_b32_e64 v82, v82, v14, s[88:89]
v_add_f32 v5, v5, v202
v_add_f32 v5, v5, v203
v_cndmask_b32_e64 v83, v83, v14, s[90:91]
v_exp_f32 v205, v205
v_cvt_pk_bf16_f32 v201, v202, v203
v_add_u32 v247, -16, v13
v_cmp_gt_i32_e64 s[92:93], 0, v247
v_exp_f32 v206, v206
v_add_f32 v5, v5, v204
v_cmp_gt_i32_e64 s[94:95], 1, v247
v_cmp_gt_i32_e64 s[96:97], 2, v247
v_add_f32 v5, v5, v205
v_exp_f32 v207, v207
v_cmp_gt_i32_e64 s[98:99], 3, v247
v_cndmask_b32_e64 v84, v84, v14, s[92:93]
v_cvt_pk_bf16_f32 v202, v204, v205
v_add_f32 v5, v5, v206
v_cndmask_b32_e64 v85, v85, v14, s[94:95]
v_cndmask_b32_e64 v86, v86, v14, s[96:97]
v_add_f32 v5, v5, v207
v_cvt_pk_bf16_f32 v203, v206, v207
v_cndmask_b32_e64 v87, v87, v14, s[98:99]
s_waitcnt vmcnt(16) lgkmcnt(0)
MA 0,a,192,v,144
s_barrier
v_xor_b32 v10, 0x8000, v10
MA 32,a,192,v,152
s_add_u32 m0, s72, 16384
ds_read_b128 a[128:131], v10 offset:0
MA 4,a,196,v,144
buffer_load_dwordx4 v12, s[52:55], s71 offen offset:0 sc1 lds
v_lshrrev_b32 v249, 2, v1
MA 36,a,196,v,152
ds_read_b128 a[132:135], v10 offset:1024
v_and_b32 v248, 7, v249
MA 8,a,200,v,144
v_exp_f32 v80, v80
MA 40,a,200,v,152
v_lshlrev_b32 v249, 8, v249
v_and_b32 v250, 3, v1
MA 12,a,204,v,144
ds_read_b128 a[136:139], v10 offset:2048
v_lshl_add_u32 v249, v250, 3, v249
MA 44,a,204,v,152
v_exp_f32 v81, v81
MA 16,a,208,v,144
v_add_u32 v246, -32, v13
s_lshl_b32 s36, s3, 13
MA 48,a,208,v,152
s_add_u32 s36, s36, 131072
v_add_u32 v249, s36, v249
MA 20,a,212,v,144
v_exp_f32 v82, v82
MA 52,a,212,v,152
ds_read_b128 a[140:143], v10 offset:3072
s_nop 0
MA 24,a,216,v,144
v_cmp_gt_i32_e64 s[84:85], 0, v246
v_xor_b32 v250, 0, v248
MA 56,a,216,v,152
ds_read_b128 a[144:147], v10 offset:4096
v_lshl_add_u32 v250, v250, 5, v249
MA 28,a,220,v,144
v_exp_f32 v83, v83
MA 60,a,220,v,152
v_cmp_gt_i32_e64 s[86:87], 1, v246
TR 96,250,0
MA 124,a,220,v,168
TR 98,250,4096
v_xor_b32 v250, 1, v248
MA 120,a,216,v,168
ds_read_b128 a[148:151], v10 offset:5120
buffer_load_dwordx4 v12, s[52:55], s71 offen offset:1024 sc1 lds
MA 116,a,212,v,168
v_cvt_pk_bf16_f32 v80, v80, v81
v_lshl_add_u32 v250, v250, 5, v249
MA 112,a,208,v,168
TR 100,250,0
TR 102,250,4096
MA 108,a,204,v,168
v_exp_f32 v84, v84
MA 104,a,200,v,168
v_cmp_gt_i32_e64 s[88:89], 2, v246
v_xor_b32 v250, 2, v248
MA 100,a,196,v,168
ds_read_b128 a[152:155], v10 offset:6144
v_lshl_add_u32 v250, v250, 5, v249
MA 96,a,192,v,168
v_cmp_gt_i32_e64 s[90:91], 3, v246
TR 104,250,0
MA 0,a,224,v,176
v_exp_f32 v85, v85
MA 32,a,224,v,184
ds_read_b128 a[156:159], v10 offset:7168
TR 106,250,4096
MA 4,a,228,v,176
v_cvt_pk_bf16_f32 v81, v82, v83
v_xor_b32 v250, 3, v248
MA 36,a,228,v,184
v_cndmask_b32_e64 v112, v112, v14, s[84:85]
v_lshl_add_u32 v250, v250, 5, v249
MA 8,a,232,v,176
ds_read_b128 a[160:163], v10 offset:8192
TR 108,250,0
MA 40,a,232,v,184
TR 110,250,4096
v_xor_b32 v250, 4, v248
MA 12,a,236,v,176
v_exp_f32 v86, v86
MA 44,a,236,v,184
ds_read_b128 a[164:167], v10 offset:9216
v_lshl_add_u32 v250, v250, 5, v249
MA 16,a,240,v,176
buffer_load_dwordx4 v12, s[52:55], s71 offen offset:2048 sc1 lds
v_cndmask_b32_e64 v113, v113, v14, s[86:87]
MA 48,a,240,v,184
TR 128,250,0
TR 130,250,4096
MA 20,a,244,v,176
v_exp_f32 v87, v87
MA 52,a,244,v,184
ds_read_b128 a[168:171], v10 offset:10240
v_xor_b32 v250, 5, v248
MA 24,a,248,v,176
v_cvt_pk_bf16_f32 v82, v84, v85
v_cndmask_b32_e64 v114, v114, v14, s[88:89]
MA 56,a,248,v,184
v_lshl_add_u32 v250, v250, 5, v249
TR 132,250,0
MA 28,a,252,v,176
v_cndmask_b32_e64 v115, v115, v14, s[90:91]
TR 134,250,4096
MA 60,a,252,v,184
v_exp_f32 v88, v88
MA 124,a,252,v,200
ds_read_b128 a[172:175], v10 offset:11264
v_xor_b32 v250, 6, v248
MA 120,a,248,v,200
v_lshl_add_u32 v250, v250, 5, v249
TR 136,250,0
MA 116,a,244,v,200
ds_read_b128 a[176:179], v10 offset:12288
TR 138,250,4096
MA 112,a,240,v,200
v_exp_f32 v89, v89
MA 108,a,236,v,200
v_add_u32 v247, -48, v13
v_xor_b32 v250, 7, v248
MA 104,a,232,v,200
v_cvt_pk_bf16_f32 v83, v86, v87
v_lshl_add_u32 v250, v250, 5, v249
MA 100,a,228,v,200
ds_read_b128 a[180:183], v10 offset:13312
TR 140,250,0
MA 96,a,224,v,200
ds_read_b128 a[184:187], v10 offset:14336
ds_read_b128 a[188:191], v10 offset:15360
buffer_load_dwordx4 v12, s[52:55], s71 offen offset:3072 sc1 lds
s_xor_b32 s72, s72, 0x8000
v_exp_f32 v90, v90
v_cmp_gt_i32_e64 s[92:93], 0, v247
TR 142,250,4096
s_add_u32 s32, s40, 100663296
s_addc_u32 s33, s41, 0
v_exp_f32 v91, v91
v_cmp_gt_i32_e64 s[94:95], 1, v247
s_mov_b32 s34, 8388608
s_mov_b32 s35, 0x20000
s_and_b32 s36, s2, 7
s_lshl_b32 s36, s36, 20
s_lshr_b32 s37, s2, 3
v_cvt_pk_bf16_f32 v88, v88, v89
v_cmp_gt_i32_e64 s[96:97], 2, v247
s_lshl_b32 s37, s37, 15
v_exp_f32 v92, v92
s_add_u32 s36, s36, s37
s_lshl_b32 s37, s3, 12
v_cmp_gt_i32_e64 s[98:99], 3, v247
s_add_u32 s36, s36, s37
v_exp_f32 v93, v93
s_add_u32 s37, s36, 4096
s_waitcnt lgkmcnt(15)
buffer_store_dwordx4 v[96:99], v12, s[32:35], s36 offen offset:0 sc1
v_cndmask_b32_e64 v116, v116, v14, s[92:93]
buffer_store_dwordx4 v[100:103], v12, s[32:35], s36 offen offset:1024 sc1
v_cvt_pk_bf16_f32 v89, v90, v91
buffer_store_dwordx4 v[104:107], v12, s[32:35], s36 offen offset:2048 sc1
buffer_store_dwordx4 v[108:111], v12, s[32:35], s36 offen offset:3072 sc1
s_waitcnt lgkmcnt(12)
buffer_store_dwordx4 v[128:131], v12, s[32:35], s37 offen offset:0 sc1
v_exp_f32 v94, v94
v_cndmask_b32_e64 v117, v117, v14, s[94:95]
s_waitcnt lgkmcnt(9)
buffer_store_dwordx4 v[132:135], v12, s[32:35], s37 offen offset:1024 sc1
s_waitcnt lgkmcnt(5)
buffer_store_dwordx4 v[136:139], v12, s[32:35], s37 offen offset:2048 sc1
s_waitcnt lgkmcnt(0)
buffer_store_dwordx4 v[140:143], v12, s[32:35], s37 offen offset:3072 sc1
v_exp_f32 v95, v95
v_cndmask_b32_e64 v118, v118, v14, s[96:97]
v_lshlrev_b32 v232, 4, v1
v_mov_b32 v235, 0
buffer_load_ushort v234, v235, s[28:31], s42 offen
v_cvt_pk_bf16_f32 v90, v92, v93
v_cndmask_b32_e64 v119, v119, v14, s[98:99]
buffer_load_dwordx4 v[210:213], v232, s[16:19], 0 offen offset:0
buffer_load_dwordx4 v[216:219], v232, s[16:19], 0 offen offset:1024
v_cvt_pk_bf16_f32 v91, v94, v95
buffer_load_dwordx4 v[222:225], v232, s[16:19], 0 offen offset:2048
buffer_load_dwordx4 v[228:231], v232, s[16:19], 0 offen offset:3072
s_branch L_p3_eps
L_fallback:
s_mov_b32 s81, 0
s_mov_b32 s74, s77
s_mov_b32 s73, s100
s_sub_u32 s72, 15, s70
v_mov_b32 v10, v15
v_add_u32 v11, 16384, v15
s_nop 15
L_fb_set:
s_lshl_b32 s72, s72, 7
s_mov_b32 s71, 0
v_accvgpr_write_b32 a0, 0
v_accvgpr_write_b32 a1, 0
v_accvgpr_write_b32 a2, 0
v_accvgpr_write_b32 a3, 0
v_accvgpr_write_b32 a4, 0
v_accvgpr_write_b32 a5, 0
v_accvgpr_write_b32 a6, 0
v_accvgpr_write_b32 a7, 0
v_accvgpr_write_b32 a8, 0
v_accvgpr_write_b32 a9, 0
v_accvgpr_write_b32 a10, 0
v_accvgpr_write_b32 a11, 0
v_accvgpr_write_b32 a12, 0
v_accvgpr_write_b32 a13, 0
v_accvgpr_write_b32 a14, 0
v_accvgpr_write_b32 a15, 0
v_accvgpr_write_b32 a16, 0
v_accvgpr_write_b32 a17, 0
v_accvgpr_write_b32 a18, 0
v_accvgpr_write_b32 a19, 0
v_accvgpr_write_b32 a20, 0
v_accvgpr_write_b32 a21, 0
v_accvgpr_write_b32 a22, 0
v_accvgpr_write_b32 a23, 0
v_accvgpr_write_b32 a24, 0
v_accvgpr_write_b32 a25, 0
v_accvgpr_write_b32 a26, 0
v_accvgpr_write_b32 a27, 0
v_accvgpr_write_b32 a28, 0
v_accvgpr_write_b32 a29, 0
v_accvgpr_write_b32 a30, 0
v_accvgpr_write_b32 a31, 0
v_accvgpr_write_b32 a32, 0
v_accvgpr_write_b32 a33, 0
v_accvgpr_write_b32 a34, 0
v_accvgpr_write_b32 a35, 0
v_accvgpr_write_b32 a36, 0
v_accvgpr_write_b32 a37, 0
v_accvgpr_write_b32 a38, 0
v_accvgpr_write_b32 a39, 0
v_accvgpr_write_b32 a40, 0
v_accvgpr_write_b32 a41, 0
v_accvgpr_write_b32 a42, 0
v_accvgpr_write_b32 a43, 0
v_accvgpr_write_b32 a44, 0
v_accvgpr_write_b32 a45, 0
v_accvgpr_write_b32 a46, 0
v_accvgpr_write_b32 a47, 0
v_accvgpr_write_b32 a48, 0
v_accvgpr_write_b32 a49, 0
v_accvgpr_write_b32 a50, 0
v_accvgpr_write_b32 a51, 0
v_accvgpr_write_b32 a52, 0
v_accvgpr_write_b32 a53, 0
v_accvgpr_write_b32 a54, 0
v_accvgpr_write_b32 a55, 0
v_accvgpr_write_b32 a56, 0
v_accvgpr_write_b32 a57, 0
v_accvgpr_write_b32 a58, 0
v_accvgpr_write_b32 a59, 0
v_accvgpr_write_b32 a60, 0
v_accvgpr_write_b32 a61, 0
v_accvgpr_write_b32 a62, 0
v_accvgpr_write_b32 a63, 0
v_mov_b32 v2, 0
v_mov_b32 v96, v14
v_mov_b32 v3, 0
v_mov_b32 v97, v14
L_fb_tile:
s_waitcnt vmcnt(0) lgkmcnt(0)
s_barrier
s_mov_b32 m0, s68
s_add_u32 s80, s71, 16384
buffer_load_dwordx4 v12, s[52:55], s71 offen offset:0 sc1 lds
buffer_load_dwordx4 v12, s[52:55], s71 offen offset:1024 sc1 lds
buffer_load_dwordx4 v12, s[52:55], s71 offen offset:2048 sc1 lds
buffer_load_dwordx4 v12, s[52:55], s71 offen offset:3072 sc1 lds
s_add_u32 m0, s68, 16384
s_nop 0
buffer_load_dwordx4 v12, s[56:59], s80 offen offset:0 sc1 lds
buffer_load_dwordx4 v12, s[56:59], s80 offen offset:1024 sc1 lds
buffer_load_dwordx4 v12, s[56:59], s80 offen offset:2048 sc1 lds
buffer_load_dwordx4 v12, s[56:59], s80 offen offset:3072 sc1 lds
s_waitcnt vmcnt(0)
s_barrier
ds_read_b128 a[128:131], v10 offset:0
ds_read_b128 a[132:135], v10 offset:1024
ds_read_b128 a[136:139], v10 offset:2048
ds_read_b128 a[140:143], v10 offset:3072
ds_read_b128 a[144:147], v10 offset:4096
ds_read_b128 a[148:151], v10 offset:5120
ds_read_b128 a[152:155], v10 offset:6144
ds_read_b128 a[156:159], v10 offset:7168
ds_read_b128 a[160:163], v10 offset:8192
ds_read_b128 a[164:167], v10 offset:9216
ds_read_b128 a[168:171], v10 offset:10240
ds_read_b128 a[172:175], v10 offset:11264
ds_read_b128 a[176:179], v10 offset:12288
ds_read_b128 a[180:183], v10 offset:13312
ds_read_b128 a[184:187], v10 offset:14336
ds_read_b128 a[188:191], v10 offset:15360
s_waitcnt lgkmcnt(0)
ds_read_b128 a[192:195], v11 offset:0
ds_read_b128 a[196:199], v11 offset:1024
ds_read_b128 a[200:203], v11 offset:2048
ds_read_b128 a[204:207], v11 offset:3072
ds_read_b128 a[208:211], v11 offset:4096
ds_read_b128 a[212:215], v11 offset:5120
ds_read_b128 a[216:219], v11 offset:6144
ds_read_b128 a[220:223], v11 offset:7168
ds_read_b128 a[224:227], v11 offset:8192
ds_read_b128 a[228:231], v11 offset:9216
ds_read_b128 a[232:235], v11 offset:10240
ds_read_b128 a[236:239], v11 offset:11264
ds_read_b128 a[240:243], v11 offset:12288
ds_read_b128 a[244:247], v11 offset:13312
ds_read_b128 a[248:251], v11 offset:14336
ds_read_b128 a[252:255], v11 offset:15360
v_mfma_f32_16x16x32_bf16 v[80:83], a[128:131], v[16:19], 0
v_mfma_f32_16x16x32_bf16 v[88:91], a[128:131], v[32:35], 0
MV 80,a,132,v,20
MV 88,a,132,v,36
MV 80,a,136,v,24
MV 88,a,136,v,40
MV 80,a,140,v,28
MV 88,a,140,v,44
v_mfma_f32_16x16x32_bf16 v[84:87], a[144:147], v[16:19], 0
v_mfma_f32_16x16x32_bf16 v[92:95], a[144:147], v[32:35], 0
MV 84,a,148,v,20
MV 92,a,148,v,36
MV 84,a,152,v,24
MV 92,a,152,v,40
MV 84,a,156,v,28
MV 92,a,156,v,44
v_mfma_f32_16x16x32_bf16 v[112:115], a[160:163], v[16:19], 0
v_mfma_f32_16x16x32_bf16 v[120:123], a[160:163], v[32:35], 0
MV 112,a,164,v,20
MV 120,a,164,v,36
MV 112,a,168,v,24
MV 120,a,168,v,40
MV 112,a,172,v,28
MV 120,a,172,v,44
v_mfma_f32_16x16x32_bf16 v[116:119], a[176:179], v[16:19], 0
v_mfma_f32_16x16x32_bf16 v[124:127], a[176:179], v[32:35], 0
MV 116,a,180,v,20
MV 124,a,180,v,36
MV 116,a,184,v,24
MV 124,a,184,v,40
MV 116,a,188,v,28
MV 124,a,188,v,44
v_add_u32 v246, s72, v13
v_add_u32 v246, 0, v246
v_cmp_gt_i32_e64 s[84:85], 0, v246
v_cmp_gt_i32_e64 s[86:87], 1, v246
v_cmp_gt_i32_e64 s[88:89], 2, v246
v_cmp_gt_i32_e64 s[90:91], 3, v246
v_cndmask_b32_e64 v80, v80, v14, s[84:85]
v_cndmask_b32_e64 v81, v81, v14, s[86:87]
v_cndmask_b32_e64 v82, v82, v14, s[88:89]
v_cndmask_b32_e64 v83, v83, v14, s[90:91]
v_add_u32 v247, s72, v239
v_add_u32 v247, 0, v247
v_cmp_gt_i32_e64 s[92:93], 0, v247
v_cmp_gt_i32_e64 s[94:95], 1, v247
v_cmp_gt_i32_e64 s[96:97], 2, v247
v_cmp_gt_i32_e64 s[98:99], 3, v247
v_cndmask_b32_e64 v88, v88, v14, s[92:93]
v_cndmask_b32_e64 v89, v89, v14, s[94:95]
v_cndmask_b32_e64 v90, v90, v14, s[96:97]
v_cndmask_b32_e64 v91, v91, v14, s[98:99]
v_add_u32 v246, s72, v13
v_add_u32 v246, -16, v246
v_cmp_gt_i32_e64 s[84:85], 0, v246
v_cmp_gt_i32_e64 s[86:87], 1, v246
v_cmp_gt_i32_e64 s[88:89], 2, v246
v_cmp_gt_i32_e64 s[90:91], 3, v246
v_cndmask_b32_e64 v84, v84, v14, s[84:85]
v_cndmask_b32_e64 v85, v85, v14, s[86:87]
v_cndmask_b32_e64 v86, v86, v14, s[88:89]
v_cndmask_b32_e64 v87, v87, v14, s[90:91]
v_add_u32 v247, s72, v239
v_add_u32 v247, -16, v247
v_cmp_gt_i32_e64 s[92:93], 0, v247
v_cmp_gt_i32_e64 s[94:95], 1, v247
v_cmp_gt_i32_e64 s[96:97], 2, v247
v_cmp_gt_i32_e64 s[98:99], 3, v247
v_cndmask_b32_e64 v92, v92, v14, s[92:93]
v_cndmask_b32_e64 v93, v93, v14, s[94:95]
v_cndmask_b32_e64 v94, v94, v14, s[96:97]
v_cndmask_b32_e64 v95, v95, v14, s[98:99]
v_add_u32 v246, s72, v13
v_add_u32 v246, -32, v246
v_cmp_gt_i32_e64 s[84:85], 0, v246
v_cmp_gt_i32_e64 s[86:87], 1, v246
v_cmp_gt_i32_e64 s[88:89], 2, v246
v_cmp_gt_i32_e64 s[90:91], 3, v246
v_cndmask_b32_e64 v112, v112, v14, s[84:85]
v_cndmask_b32_e64 v113, v113, v14, s[86:87]
v_cndmask_b32_e64 v114, v114, v14, s[88:89]
v_cndmask_b32_e64 v115, v115, v14, s[90:91]
v_add_u32 v247, s72, v239
v_add_u32 v247, -32, v247
v_cmp_gt_i32_e64 s[92:93], 0, v247
v_cmp_gt_i32_e64 s[94:95], 1, v247
v_cmp_gt_i32_e64 s[96:97], 2, v247
v_cmp_gt_i32_e64 s[98:99], 3, v247
v_cndmask_b32_e64 v120, v120, v14, s[92:93]
v_cndmask_b32_e64 v121, v121, v14, s[94:95]
v_cndmask_b32_e64 v122, v122, v14, s[96:97]
v_cndmask_b32_e64 v123, v123, v14, s[98:99]
v_add_u32 v246, s72, v13
v_add_u32 v246, -48, v246
v_cmp_gt_i32_e64 s[84:85], 0, v246
v_cmp_gt_i32_e64 s[86:87], 1, v246
v_cmp_gt_i32_e64 s[88:89], 2, v246
v_cmp_gt_i32_e64 s[90:91], 3, v246
v_cndmask_b32_e64 v116, v116, v14, s[84:85]
v_cndmask_b32_e64 v117, v117, v14, s[86:87]
v_cndmask_b32_e64 v118, v118, v14, s[88:89]
v_cndmask_b32_e64 v119, v119, v14, s[90:91]
v_add_u32 v247, s72, v239
v_add_u32 v247, -48, v247
v_cmp_gt_i32_e64 s[92:93], 0, v247
v_cmp_gt_i32_e64 s[94:95], 1, v247
v_cmp_gt_i32_e64 s[96:97], 2, v247
v_cmp_gt_i32_e64 s[98:99], 3, v247
v_cndmask_b32_e64 v124, v124, v14, s[92:93]
v_cndmask_b32_e64 v125, v125, v14, s[94:95]
v_cndmask_b32_e64 v126, v126, v14, s[96:97]
v_cndmask_b32_e64 v127, v127, v14, s[98:99]
v_mov_b32 v242, v96
v_max3_f32 v242, v242, v80, v81
v_max3_f32 v242, v242, v82, v83
v_max3_f32 v242, v242, v84, v85
v_max3_f32 v242, v242, v86, v87
v_max3_f32 v242, v242, v112, v113
v_max3_f32 v242, v242, v114, v115
v_max3_f32 v242, v242, v116, v117
v_max3_f32 v242, v242, v118, v119
v_mov_b32 v243, v242
s_nop 1
v_permlane32_swap_b32 v242, v243
v_max_f32 v242, v242, v243
v_mov_b32 v243, v242
s_nop 1
v_permlane16_swap_b32 v242, v243
v_max_f32 v242, v242, v243
v_sub_f32 v98, v96, v242
v_exp_f32 v98, v98
v_mov_b32 v96, v242
v_sub_f32 v80, v80, v242
v_sub_f32 v81, v81, v242
v_sub_f32 v82, v82, v242
v_sub_f32 v83, v83, v242
v_sub_f32 v84, v84, v242
v_sub_f32 v85, v85, v242
v_sub_f32 v86, v86, v242
v_sub_f32 v87, v87, v242
v_sub_f32 v112, v112, v242
v_sub_f32 v113, v113, v242
v_sub_f32 v114, v114, v242
v_sub_f32 v115, v115, v242
v_sub_f32 v116, v116, v242
v_sub_f32 v117, v117, v242
v_sub_f32 v118, v118, v242
v_sub_f32 v119, v119, v242
v_mul_f32 v2, v2, v98
v_accvgpr_read_b32 v243, a0
v_mul_f32 v243, v243, v98
v_accvgpr_write_b32 a0, v243
v_accvgpr_read_b32 v243, a1
v_mul_f32 v243, v243, v98
v_accvgpr_write_b32 a1, v243
v_accvgpr_read_b32 v243, a2
v_mul_f32 v243, v243, v98
v_accvgpr_write_b32 a2, v243
v_accvgpr_read_b32 v243, a3
v_mul_f32 v243, v243, v98
v_accvgpr_write_b32 a3, v243
v_accvgpr_read_b32 v243, a4
v_mul_f32 v243, v243, v98
v_accvgpr_write_b32 a4, v243
v_accvgpr_read_b32 v243, a5
v_mul_f32 v243, v243, v98
v_accvgpr_write_b32 a5, v243
v_accvgpr_read_b32 v243, a6
v_mul_f32 v243, v243, v98
v_accvgpr_write_b32 a6, v243
v_accvgpr_read_b32 v243, a7
v_mul_f32 v243, v243, v98
v_accvgpr_write_b32 a7, v243
v_accvgpr_read_b32 v243, a8
v_mul_f32 v243, v243, v98
v_accvgpr_write_b32 a8, v243
v_accvgpr_read_b32 v243, a9
v_mul_f32 v243, v243, v98
v_accvgpr_write_b32 a9, v243
v_accvgpr_read_b32 v243, a10
v_mul_f32 v243, v243, v98
v_accvgpr_write_b32 a10, v243
v_accvgpr_read_b32 v243, a11
v_mul_f32 v243, v243, v98
v_accvgpr_write_b32 a11, v243
v_accvgpr_read_b32 v243, a12
v_mul_f32 v243, v243, v98
v_accvgpr_write_b32 a12, v243
v_accvgpr_read_b32 v243, a13
v_mul_f32 v243, v243, v98
v_accvgpr_write_b32 a13, v243
v_accvgpr_read_b32 v243, a14
v_mul_f32 v243, v243, v98
v_accvgpr_write_b32 a14, v243
v_accvgpr_read_b32 v243, a15
v_mul_f32 v243, v243, v98
v_accvgpr_write_b32 a15, v243
v_accvgpr_read_b32 v243, a16
v_mul_f32 v243, v243, v98
v_accvgpr_write_b32 a16, v243
v_accvgpr_read_b32 v243, a17
v_mul_f32 v243, v243, v98
v_accvgpr_write_b32 a17, v243
v_accvgpr_read_b32 v243, a18
v_mul_f32 v243, v243, v98
v_accvgpr_write_b32 a18, v243
v_accvgpr_read_b32 v243, a19
v_mul_f32 v243, v243, v98
v_accvgpr_write_b32 a19, v243
v_accvgpr_read_b32 v243, a20
v_mul_f32 v243, v243, v98
v_accvgpr_write_b32 a20, v243
v_accvgpr_read_b32 v243, a21
v_mul_f32 v243, v243, v98
v_accvgpr_write_b32 a21, v243
v_accvgpr_read_b32 v243, a22
v_mul_f32 v243, v243, v98
v_accvgpr_write_b32 a22, v243
v_accvgpr_read_b32 v243, a23
v_mul_f32 v243, v243, v98
v_accvgpr_write_b32 a23, v243
v_accvgpr_read_b32 v243, a24
v_mul_f32 v243, v243, v98
v_accvgpr_write_b32 a24, v243
v_accvgpr_read_b32 v243, a25
v_mul_f32 v243, v243, v98
v_accvgpr_write_b32 a25, v243
v_accvgpr_read_b32 v243, a26
v_mul_f32 v243, v243, v98
v_accvgpr_write_b32 a26, v243
v_accvgpr_read_b32 v243, a27
v_mul_f32 v243, v243, v98
v_accvgpr_write_b32 a27, v243
v_accvgpr_read_b32 v243, a28
v_mul_f32 v243, v243, v98
v_accvgpr_write_b32 a28, v243
v_accvgpr_read_b32 v243, a29
v_mul_f32 v243, v243, v98
v_accvgpr_write_b32 a29, v243
v_accvgpr_read_b32 v243, a30
v_mul_f32 v243, v243, v98
v_accvgpr_write_b32 a30, v243
v_accvgpr_read_b32 v243, a31
v_mul_f32 v243, v243, v98
v_accvgpr_write_b32 a31, v243
v_mov_b32 v242, v97
v_max3_f32 v242, v242, v88, v89
v_max3_f32 v242, v242, v90, v91
v_max3_f32 v242, v242, v92, v93
v_max3_f32 v242, v242, v94, v95
v_max3_f32 v242, v242, v120, v121
v_max3_f32 v242, v242, v122, v123
v_max3_f32 v242, v242, v124, v125
v_max3_f32 v242, v242, v126, v127
v_mov_b32 v243, v242
s_nop 1
v_permlane32_swap_b32 v242, v243
v_max_f32 v242, v242, v243
v_mov_b32 v243, v242
s_nop 1
v_permlane16_swap_b32 v242, v243
v_max_f32 v242, v242, v243
v_sub_f32 v99, v97, v242
v_exp_f32 v99, v99
v_mov_b32 v97, v242
v_sub_f32 v88, v88, v242
v_sub_f32 v89, v89, v242
v_sub_f32 v90, v90, v242
v_sub_f32 v91, v91, v242
v_sub_f32 v92, v92, v242
v_sub_f32 v93, v93, v242
v_sub_f32 v94, v94, v242
v_sub_f32 v95, v95, v242
v_sub_f32 v120, v120, v242
v_sub_f32 v121, v121, v242
v_sub_f32 v122, v122, v242
v_sub_f32 v123, v123, v242
v_sub_f32 v124, v124, v242
v_sub_f32 v125, v125, v242
v_sub_f32 v126, v126, v242
v_sub_f32 v127, v127, v242
v_mul_f32 v3, v3, v99
v_accvgpr_read_b32 v243, a32
v_mul_f32 v243, v243, v99
v_accvgpr_write_b32 a32, v243
v_accvgpr_read_b32 v243, a33
v_mul_f32 v243, v243, v99
v_accvgpr_write_b32 a33, v243
v_accvgpr_read_b32 v243, a34
v_mul_f32 v243, v243, v99
v_accvgpr_write_b32 a34, v243
v_accvgpr_read_b32 v243, a35
v_mul_f32 v243, v243, v99
v_accvgpr_write_b32 a35, v243
v_accvgpr_read_b32 v243, a36
v_mul_f32 v243, v243, v99
v_accvgpr_write_b32 a36, v243
v_accvgpr_read_b32 v243, a37
v_mul_f32 v243, v243, v99
v_accvgpr_write_b32 a37, v243
v_accvgpr_read_b32 v243, a38
v_mul_f32 v243, v243, v99
v_accvgpr_write_b32 a38, v243
v_accvgpr_read_b32 v243, a39
v_mul_f32 v243, v243, v99
v_accvgpr_write_b32 a39, v243
v_accvgpr_read_b32 v243, a40
v_mul_f32 v243, v243, v99
v_accvgpr_write_b32 a40, v243
v_accvgpr_read_b32 v243, a41
v_mul_f32 v243, v243, v99
v_accvgpr_write_b32 a41, v243
v_accvgpr_read_b32 v243, a42
v_mul_f32 v243, v243, v99
v_accvgpr_write_b32 a42, v243
v_accvgpr_read_b32 v243, a43
v_mul_f32 v243, v243, v99
v_accvgpr_write_b32 a43, v243
v_accvgpr_read_b32 v243, a44
v_mul_f32 v243, v243, v99
v_accvgpr_write_b32 a44, v243
v_accvgpr_read_b32 v243, a45
v_mul_f32 v243, v243, v99
v_accvgpr_write_b32 a45, v243
v_accvgpr_read_b32 v243, a46
v_mul_f32 v243, v243, v99
v_accvgpr_write_b32 a46, v243
v_accvgpr_read_b32 v243, a47
v_mul_f32 v243, v243, v99
v_accvgpr_write_b32 a47, v243
v_accvgpr_read_b32 v243, a48
v_mul_f32 v243, v243, v99
v_accvgpr_write_b32 a48, v243
v_accvgpr_read_b32 v243, a49
v_mul_f32 v243, v243, v99
v_accvgpr_write_b32 a49, v243
v_accvgpr_read_b32 v243, a50
v_mul_f32 v243, v243, v99
v_accvgpr_write_b32 a50, v243
v_accvgpr_read_b32 v243, a51
v_mul_f32 v243, v243, v99
v_accvgpr_write_b32 a51, v243
v_accvgpr_read_b32 v243, a52
v_mul_f32 v243, v243, v99
v_accvgpr_write_b32 a52, v243
v_accvgpr_read_b32 v243, a53
v_mul_f32 v243, v243, v99
v_accvgpr_write_b32 a53, v243
v_accvgpr_read_b32 v243, a54
v_mul_f32 v243, v243, v99
v_accvgpr_write_b32 a54, v243
v_accvgpr_read_b32 v243, a55
v_mul_f32 v243, v243, v99
v_accvgpr_write_b32 a55, v243
v_accvgpr_read_b32 v243, a56
v_mul_f32 v243, v243, v99
v_accvgpr_write_b32 a56, v243
v_accvgpr_read_b32 v243, a57
v_mul_f32 v243, v243, v99
v_accvgpr_write_b32 a57, v243
v_accvgpr_read_b32 v243, a58
v_mul_f32 v243, v243, v99
v_accvgpr_write_b32 a58, v243
v_accvgpr_read_b32 v243, a59
v_mul_f32 v243, v243, v99
v_accvgpr_write_b32 a59, v243
v_accvgpr_read_b32 v243, a60
v_mul_f32 v243, v243, v99
v_accvgpr_write_b32 a60, v243
v_accvgpr_read_b32 v243, a61
v_mul_f32 v243, v243, v99
v_accvgpr_write_b32 a61, v243
v_accvgpr_read_b32 v243, a62
v_mul_f32 v243, v243, v99
v_accvgpr_write_b32 a62, v243
v_accvgpr_read_b32 v243, a63
v_mul_f32 v243, v243, v99
v_accvgpr_write_b32 a63, v243
v_exp_f32 v80, v80
v_exp_f32 v81, v81
v_exp_f32 v82, v82
v_add_f32 v2, v2, v80
v_add_f32 v2, v2, v81
v_exp_f32 v83, v83
v_cvt_pk_bf16_f32 v80, v80, v81
v_exp_f32 v84, v84
v_add_f32 v2, v2, v82
v_add_f32 v2, v2, v83
v_exp_f32 v85, v85
v_cvt_pk_bf16_f32 v81, v82, v83
v_exp_f32 v86, v86
v_add_f32 v2, v2, v84
v_add_f32 v2, v2, v85
v_exp_f32 v87, v87
v_cvt_pk_bf16_f32 v82, v84, v85
v_exp_f32 v88, v88
v_add_f32 v2, v2, v86
v_add_f32 v2, v2, v87
v_exp_f32 v89, v89
v_cvt_pk_bf16_f32 v83, v86, v87
v_exp_f32 v90, v90
v_add_f32 v3, v3, v88
v_add_f32 v3, v3, v89
v_exp_f32 v91, v91
v_cvt_pk_bf16_f32 v88, v88, v89
v_exp_f32 v92, v92
v_add_f32 v3, v3, v90
v_add_f32 v3, v3, v91
v_exp_f32 v93, v93
v_cvt_pk_bf16_f32 v89, v90, v91
v_exp_f32 v94, v94
v_add_f32 v3, v3, v92
v_add_f32 v3, v3, v93
v_exp_f32 v95, v95
v_cvt_pk_bf16_f32 v90, v92, v93
v_exp_f32 v112, v112
v_add_f32 v3, v3, v94
v_add_f32 v3, v3, v95
v_exp_f32 v113, v113
v_cvt_pk_bf16_f32 v91, v94, v95
v_exp_f32 v114, v114
v_add_f32 v2, v2, v112
v_add_f32 v2, v2, v113
v_exp_f32 v115, v115
v_cvt_pk_bf16_f32 v112, v112, v113
v_exp_f32 v116, v116
v_add_f32 v2, v2, v114
v_add_f32 v2, v2, v115
v_exp_f32 v117, v117
v_cvt_pk_bf16_f32 v113, v114, v115
v_exp_f32 v118, v118
v_add_f32 v2, v2, v116
v_add_f32 v2, v2, v117
v_exp_f32 v119, v119
v_cvt_pk_bf16_f32 v114, v116, v117
v_exp_f32 v120, v120
v_add_f32 v2, v2, v118
v_add_f32 v2, v2, v119
v_exp_f32 v121, v121
v_cvt_pk_bf16_f32 v115, v118, v119
v_exp_f32 v122, v122
v_add_f32 v3, v3, v120
v_add_f32 v3, v3, v121
v_exp_f32 v123, v123
v_cvt_pk_bf16_f32 v120, v120, v121
v_exp_f32 v124, v124
v_add_f32 v3, v3, v122
v_add_f32 v3, v3, v123
v_exp_f32 v125, v125
v_cvt_pk_bf16_f32 v121, v122, v123
v_exp_f32 v126, v126
v_add_f32 v3, v3, v124
v_add_f32 v3, v3, v125
v_exp_f32 v127, v127
v_cvt_pk_bf16_f32 v122, v124, v125
v_add_f32 v3, v3, v126
v_add_f32 v3, v3, v127
v_cvt_pk_bf16_f32 v123, v126, v127
s_waitcnt lgkmcnt(15)
MA 0,a,192,v,80
MA 32,a,192,v,88
s_waitcnt lgkmcnt(14)
MA 4,a,196,v,80
MA 36,a,196,v,88
s_waitcnt lgkmcnt(13)
MA 8,a,200,v,80
MA 40,a,200,v,88
s_waitcnt lgkmcnt(12)
MA 12,a,204,v,80
MA 44,a,204,v,88
s_waitcnt lgkmcnt(11)
MA 16,a,208,v,80
MA 48,a,208,v,88
s_waitcnt lgkmcnt(10)
MA 20,a,212,v,80
MA 52,a,212,v,88
s_waitcnt lgkmcnt(9)
MA 24,a,216,v,80
MA 56,a,216,v,88
s_waitcnt lgkmcnt(8)
MA 28,a,220,v,80
MA 60,a,220,v,88
s_waitcnt lgkmcnt(7)
MA 0,a,224,v,112
MA 32,a,224,v,120
s_waitcnt lgkmcnt(6)
MA 4,a,228,v,112
MA 36,a,228,v,120
s_waitcnt lgkmcnt(5)
MA 8,a,232,v,112
MA 40,a,232,v,120
s_waitcnt lgkmcnt(4)
MA 12,a,236,v,112
MA 44,a,236,v,120
s_waitcnt lgkmcnt(3)
MA 16,a,240,v,112
MA 48,a,240,v,120
s_waitcnt lgkmcnt(2)
MA 20,a,244,v,112
MA 52,a,244,v,120
s_waitcnt lgkmcnt(1)
MA 24,a,248,v,112
MA 56,a,248,v,120
s_waitcnt lgkmcnt(0)
MA 28,a,252,v,112
MA 60,a,252,v,120
s_add_u32 s71, s71, 16384
s_sub_u32 s72, s72, 64
s_sub_u32 s74, s74, 1
s_nop 15
s_cmp_lg_u32 s74, 0
s_cbranch_scc1 L_fb_tile
v_mov_b32 v240, v2
s_nop 1
v_permlane32_swap_b32 v2, v240
v_add_f32 v2, v2, v240
v_mov_b32 v240, v2
s_nop 1
v_permlane16_swap_b32 v2, v240
v_add_f32 v2, v2, v240
v_mov_b32 v240, v3
s_nop 1
v_permlane32_swap_b32 v3, v240
v_add_f32 v3, v3, v240
v_mov_b32 v240, v3
s_nop 1
v_permlane16_swap_b32 v3, v240
v_add_f32 v3, v3, v240
v_rcp_f32 v2, v2
v_rcp_f32 v3, v3
s_add_u32 s80, s73, s76
s_nop 4
v_accvgpr_read_b32 v240, a0
v_accvgpr_read_b32 v241, a1
v_accvgpr_read_b32 v242, a2
v_accvgpr_read_b32 v243, a3
v_accvgpr_read_b32 v244, a4
v_accvgpr_read_b32 v245, a5
v_accvgpr_read_b32 v246, a6
v_accvgpr_read_b32 v247, a7
v_pk_mul_f32 v[240:241], v[240:241], v[2:3] op_sel:[0,0] op_sel_hi:[1,0]
v_pk_mul_f32 v[242:243], v[242:243], v[2:3] op_sel:[0,0] op_sel_hi:[1,0]
v_pk_mul_f32 v[244:245], v[244:245], v[2:3] op_sel:[0,0] op_sel_hi:[1,0]
v_pk_mul_f32 v[246:247], v[246:247], v[2:3] op_sel:[0,0] op_sel_hi:[1,0]
v_cvt_pk_bf16_f32 v248, v240, v241
v_cvt_pk_bf16_f32 v249, v242, v243
v_cvt_pk_bf16_f32 v250, v244, v245
v_cvt_pk_bf16_f32 v251, v246, v247
buffer_store_dwordx4 v[248:251], v15, s[60:63], s73 offen offset:0 sc1
v_accvgpr_read_b32 v240, a8
v_accvgpr_read_b32 v241, a9
v_accvgpr_read_b32 v242, a10
v_accvgpr_read_b32 v243, a11
v_accvgpr_read_b32 v244, a12
v_accvgpr_read_b32 v245, a13
v_accvgpr_read_b32 v246, a14
v_accvgpr_read_b32 v247, a15
v_pk_mul_f32 v[240:241], v[240:241], v[2:3] op_sel:[0,0] op_sel_hi:[1,0]
v_pk_mul_f32 v[242:243], v[242:243], v[2:3] op_sel:[0,0] op_sel_hi:[1,0]
v_pk_mul_f32 v[244:245], v[244:245], v[2:3] op_sel:[0,0] op_sel_hi:[1,0]
v_pk_mul_f32 v[246:247], v[246:247], v[2:3] op_sel:[0,0] op_sel_hi:[1,0]
v_cvt_pk_bf16_f32 v252, v240, v241
v_cvt_pk_bf16_f32 v253, v242, v243
v_cvt_pk_bf16_f32 v254, v244, v245
v_cvt_pk_bf16_f32 v255, v246, v247
buffer_store_dwordx4 v[252:255], v15, s[60:63], s73 offen offset:1024 sc1
v_accvgpr_read_b32 v240, a16
v_accvgpr_read_b32 v241, a17
v_accvgpr_read_b32 v242, a18
v_accvgpr_read_b32 v243, a19
v_accvgpr_read_b32 v244, a20
v_accvgpr_read_b32 v245, a21
v_accvgpr_read_b32 v246, a22
v_accvgpr_read_b32 v247, a23
v_pk_mul_f32 v[240:241], v[240:241], v[2:3] op_sel:[0,0] op_sel_hi:[1,0]
v_pk_mul_f32 v[242:243], v[242:243], v[2:3] op_sel:[0,0] op_sel_hi:[1,0]
v_pk_mul_f32 v[244:245], v[244:245], v[2:3] op_sel:[0,0] op_sel_hi:[1,0]
v_pk_mul_f32 v[246:247], v[246:247], v[2:3] op_sel:[0,0] op_sel_hi:[1,0]
v_cvt_pk_bf16_f32 v248, v240, v241
v_cvt_pk_bf16_f32 v249, v242, v243
v_cvt_pk_bf16_f32 v250, v244, v245
v_cvt_pk_bf16_f32 v251, v246, v247
buffer_store_dwordx4 v[248:251], v15, s[60:63], s73 offen offset:2048 sc1
v_accvgpr_read_b32 v240, a24
v_accvgpr_read_b32 v241, a25
v_accvgpr_read_b32 v242, a26
v_accvgpr_read_b32 v243, a27
v_accvgpr_read_b32 v244, a28
v_accvgpr_read_b32 v245, a29
v_accvgpr_read_b32 v246, a30
v_accvgpr_read_b32 v247, a31
v_pk_mul_f32 v[240:241], v[240:241], v[2:3] op_sel:[0,0] op_sel_hi:[1,0]
v_pk_mul_f32 v[242:243], v[242:243], v[2:3] op_sel:[0,0] op_sel_hi:[1,0]
v_pk_mul_f32 v[244:245], v[244:245], v[2:3] op_sel:[0,0] op_sel_hi:[1,0]
v_pk_mul_f32 v[246:247], v[246:247], v[2:3] op_sel:[0,0] op_sel_hi:[1,0]
v_cvt_pk_bf16_f32 v252, v240, v241
v_cvt_pk_bf16_f32 v253, v242, v243
v_cvt_pk_bf16_f32 v254, v244, v245
v_cvt_pk_bf16_f32 v255, v246, v247
buffer_store_dwordx4 v[252:255], v15, s[60:63], s73 offen offset:3072 sc1
v_accvgpr_read_b32 v240, a32
v_accvgpr_read_b32 v241, a33
v_accvgpr_read_b32 v242, a34
v_accvgpr_read_b32 v243, a35
v_accvgpr_read_b32 v244, a36
v_accvgpr_read_b32 v245, a37
v_accvgpr_read_b32 v246, a38
v_accvgpr_read_b32 v247, a39
v_pk_mul_f32 v[240:241], v[240:241], v[2:3] op_sel:[0,1] op_sel_hi:[1,1]
v_pk_mul_f32 v[242:243], v[242:243], v[2:3] op_sel:[0,1] op_sel_hi:[1,1]
v_pk_mul_f32 v[244:245], v[244:245], v[2:3] op_sel:[0,1] op_sel_hi:[1,1]
v_pk_mul_f32 v[246:247], v[246:247], v[2:3] op_sel:[0,1] op_sel_hi:[1,1]
v_cvt_pk_bf16_f32 v248, v240, v241
v_cvt_pk_bf16_f32 v249, v242, v243
v_cvt_pk_bf16_f32 v250, v244, v245
v_cvt_pk_bf16_f32 v251, v246, v247
buffer_store_dwordx4 v[248:251], v15, s[60:63], s80 offen offset:0 sc1
v_accvgpr_read_b32 v240, a40
v_accvgpr_read_b32 v241, a41
v_accvgpr_read_b32 v242, a42
v_accvgpr_read_b32 v243, a43
v_accvgpr_read_b32 v244, a44
v_accvgpr_read_b32 v245, a45
v_accvgpr_read_b32 v246, a46
v_accvgpr_read_b32 v247, a47
v_pk_mul_f32 v[240:241], v[240:241], v[2:3] op_sel:[0,1] op_sel_hi:[1,1]
v_pk_mul_f32 v[242:243], v[242:243], v[2:3] op_sel:[0,1] op_sel_hi:[1,1]
v_pk_mul_f32 v[244:245], v[244:245], v[2:3] op_sel:[0,1] op_sel_hi:[1,1]
v_pk_mul_f32 v[246:247], v[246:247], v[2:3] op_sel:[0,1] op_sel_hi:[1,1]
v_cvt_pk_bf16_f32 v252, v240, v241
v_cvt_pk_bf16_f32 v253, v242, v243
v_cvt_pk_bf16_f32 v254, v244, v245
v_cvt_pk_bf16_f32 v255, v246, v247
buffer_store_dwordx4 v[252:255], v15, s[60:63], s80 offen offset:1024 sc1
v_accvgpr_read_b32 v240, a48
v_accvgpr_read_b32 v241, a49
v_accvgpr_read_b32 v242, a50
v_accvgpr_read_b32 v243, a51
v_accvgpr_read_b32 v244, a52
v_accvgpr_read_b32 v245, a53
v_accvgpr_read_b32 v246, a54
v_accvgpr_read_b32 v247, a55
v_pk_mul_f32 v[240:241], v[240:241], v[2:3] op_sel:[0,1] op_sel_hi:[1,1]
v_pk_mul_f32 v[242:243], v[242:243], v[2:3] op_sel:[0,1] op_sel_hi:[1,1]
v_pk_mul_f32 v[244:245], v[244:245], v[2:3] op_sel:[0,1] op_sel_hi:[1,1]
v_pk_mul_f32 v[246:247], v[246:247], v[2:3] op_sel:[0,1] op_sel_hi:[1,1]
v_cvt_pk_bf16_f32 v248, v240, v241
v_cvt_pk_bf16_f32 v249, v242, v243
v_cvt_pk_bf16_f32 v250, v244, v245
v_cvt_pk_bf16_f32 v251, v246, v247
buffer_store_dwordx4 v[248:251], v15, s[60:63], s80 offen offset:2048 sc1
v_accvgpr_read_b32 v240, a56
v_accvgpr_read_b32 v241, a57
v_accvgpr_read_b32 v242, a58
v_accvgpr_read_b32 v243, a59
v_accvgpr_read_b32 v244, a60
v_accvgpr_read_b32 v245, a61
v_accvgpr_read_b32 v246, a62
v_accvgpr_read_b32 v247, a63
v_pk_mul_f32 v[240:241], v[240:241], v[2:3] op_sel:[0,1] op_sel_hi:[1,1]
v_pk_mul_f32 v[242:243], v[242:243], v[2:3] op_sel:[0,1] op_sel_hi:[1,1]
v_pk_mul_f32 v[244:245], v[244:245], v[2:3] op_sel:[0,1] op_sel_hi:[1,1]
v_pk_mul_f32 v[246:247], v[246:247], v[2:3] op_sel:[0,1] op_sel_hi:[1,1]
v_cvt_pk_bf16_f32 v252, v240, v241
v_cvt_pk_bf16_f32 v253, v242, v243
v_cvt_pk_bf16_f32 v254, v244, v245
v_cvt_pk_bf16_f32 v255, v246, v247
buffer_store_dwordx4 v[252:255], v15, s[60:63], s80 offen offset:3072 sc1
s_cmp_lg_u32 s81, 0
s_cbranch_scc1 L_fb_done
s_mov_b32 s81, 1
s_sub_u32 s74, 34, s77
s_mov_b32 s73, s101
s_mov_b32 s72, s70
v_mov_b32 v16, v48
v_mov_b32 v17, v49
v_mov_b32 v18, v50
v_mov_b32 v19, v51
v_mov_b32 v20, v52
v_mov_b32 v21, v53
v_mov_b32 v22, v54
v_mov_b32 v23, v55
v_mov_b32 v24, v56
v_mov_b32 v25, v57
v_mov_b32 v26, v58
v_mov_b32 v27, v59
v_mov_b32 v28, v60
v_mov_b32 v29, v61
v_mov_b32 v30, v62
v_mov_b32 v31, v63
v_mov_b32 v32, v64
v_mov_b32 v33, v65
v_mov_b32 v34, v66
v_mov_b32 v35, v67
v_mov_b32 v36, v68
v_mov_b32 v37, v69
v_mov_b32 v38, v70
v_mov_b32 v39, v71
v_mov_b32 v40, v72
v_mov_b32 v41, v73
v_mov_b32 v42, v74
v_mov_b32 v43, v75
v_mov_b32 v44, v76
v_mov_b32 v45, v77
v_mov_b32 v46, v78
v_mov_b32 v47, v79
s_branch L_fb_set
L_fb_done:
s_waitcnt vmcnt(0) lgkmcnt(0)
s_barrier
s_load_dwordx2 s[88:89], s[0:1], 104
s_mul_i32 s36, s3, 8320
v_and_b32 v16, 15, v1
v_lshrrev_b32 v17, 4, v1
v_add_u32 v18, 1, v16
v_and_b32 v19, 1, v18
v_mul_u32_u24 v19, 4160, v19
v_add_u32 v18, 2, v16
v_lshrrev_b32 v18, 1, v18
v_lshl_add_u32 v19, v18, 2, v19
v_lshl_add_u32 v19, v17, 4, v19
v_add_u32 v40, s36, v19
v_add_u32 v41, 1024, v40
v_add_u32 v42, 2048, v40
v_add_u32 v43, 3072, v40
v_add_u32 v10, s36, v232
v_lshlrev_b32 v18, 5, v16
v_lshlrev_b32 v19, 4, v17
v_sub_u32 v19, v19, v18
s_add_u32 s37, s43, 480
v_add_u32 v5, s37, v19
v_mov_b32 v20, 0
v_mov_b32 v21, 0
v_mov_b32 v22, 0
v_mov_b32 v23, 0
v_and_b32 v16, 1, v1
v_mul_u32_u24 v16, 4160, v16
v_and_b32 v17, 2, v1
v_lshl_add_u32 v16, v17, 3, v16
v_add_u32 v16, s36, v16
ds_write_b128 v16, v[20:23]
v_and_b32 v17, 31, v1
v_lshlrev_b32 v17, 4, v17
v_add_u32 v17, s43, v17
ds_write_b128 v17, v[20:23] offset:4096
v_mov_b32 v209, 0
ds_write_b128 v10, v[210:213] offset:32
s_nop 0
v_mov_b32_dpp v209, v213 wave_shr:1 row_mask:0xf bank_mask:0xf
v_alignbit_b32 v24, v210, v209, 16
v_alignbit_b32 v25, v211, v210, 16
v_alignbit_b32 v26, v212, v211, 16
v_alignbit_b32 v27, v213, v212, 16
ds_write_b128 v10, v[24:27] offset:4192
v_mov_b32_dpp v215, v213 wave_ror:1 row_mask:0xf bank_mask:0xf
ds_write_b128 v10, v[216:219] offset:1056
s_nop 0
v_mov_b32_dpp v215, v219 wave_shr:1 row_mask:0xf bank_mask:0xf
v_alignbit_b32 v28, v216, v215, 16
v_alignbit_b32 v29, v217, v216, 16
v_alignbit_b32 v30, v218, v217, 16
v_alignbit_b32 v31, v219, v218, 16
ds_write_b128 v10, v[28:31] offset:5216
v_mov_b32_dpp v221, v219 wave_ror:1 row_mask:0xf bank_mask:0xf
ds_write_b128 v10, v[222:225] offset:2080
s_nop 0
v_mov_b32_dpp v221, v225 wave_shr:1 row_mask:0xf bank_mask:0xf
v_alignbit_b32 v24, v222, v221, 16
v_alignbit_b32 v25, v223, v222, 16
v_alignbit_b32 v26, v224, v223, 16
v_alignbit_b32 v27, v225, v224, 16
ds_write_b128 v10, v[24:27] offset:6240
v_mov_b32_dpp v227, v225 wave_ror:1 row_mask:0xf bank_mask:0xf
ds_write_b128 v10, v[228:231] offset:3104
s_nop 0
v_mov_b32_dpp v227, v231 wave_shr:1 row_mask:0xf bank_mask:0xf
v_alignbit_b32 v28, v228, v227, 16
v_alignbit_b32 v29, v229, v228, 16
v_alignbit_b32 v30, v230, v229, 16
v_alignbit_b32 v31, v231, v230, 16
ds_write_b128 v10, v[28:31] offset:7264
s_waitcnt lgkmcnt(0)
s_branch L_p3_done
L_spin_go:
s_mov_b32 s36, 400000
L_spin_go_l:
s_sleep 1
buffer_load_dword v254, off, s[12:15], 0 sc1
s_waitcnt vmcnt(0)
v_cmp_gt_u32 vcc, 1, v254
s_nop 4
s_cbranch_vccz L_spin_go_ret
s_sub_u32 s36, s36, 1
s_cmp_lg_u32 s36, 0
s_cbranch_scc1 L_spin_go_l
s_branch L_spin_go_ret
L_spin_f1:
s_mov_b32 s36, 400000
L_spin_f1_l:
s_sleep 1
buffer_load_dword v237, v233, s[8:11], 0 offen offset:0 sc1
s_waitcnt vmcnt(0)
v_cmp_gt_u32 vcc, 1, v237
s_nop 4
s_cbranch_vccz L_spin_f1_ret
s_sub_u32 s36, s36, 1
s_cmp_lg_u32 s36, 0
s_cbranch_scc1 L_spin_f1_l
s_branch L_spin_f1_ret
L_spin_w:
s_mov_b32 s36, 400000
L_spin_w_l:
s_sleep 1
buffer_load_dword v253, v254, s[8:11], 0 offen offset:1024 sc1
s_waitcnt vmcnt(0)
v_cmp_gt_u32 vcc, 1, v253
s_nop 4
s_cbranch_vccz L_spin_w_ret
s_sub_u32 s36, s36, 1
s_cmp_lg_u32 s36, 0
s_cbranch_scc1 L_spin_w_l
s_branch L_spin_w_ret
L_spin_f2:
s_mov_b32 s36, 400000
L_spin_f2_l:
s_sleep 1
buffer_load_dword v253, v252, s[8:11], 0 offen sc1
s_waitcnt vmcnt(0)
v_cmp_gt_u32 vcc, 1, v253
s_nop 4
s_cbranch_vccz L_spin_f2_ret
s_sub_u32 s36, s36, 1
s_cmp_lg_u32 s36, 0
s_cbranch_scc1 L_spin_f2_l
s_branch L_spin_f2_ret
L_p5_x1:
v_mov_b32 v253, 1
s_lshl_b32 s36, s2, 2
buffer_store_dword v253, v255, s[8:11], s36 offen offset:2048 sc1
v_and_b32 v254, 15, v1
s_lshl_b32 s36, s82, 4
v_add_u32 v254, s36, v254
v_lshlrev_b32 v254, 2, v254
s_branch L_p5_loop
L_p5_x2:
buffer_load_dword v253, v254, s[8:11], 0 offen offset:2048 sc1
s_branch L_p5_loop
L_spin_f3:
s_mov_b32 s36, 400000
L_spin_f3_l:
s_sleep 1
buffer_load_dword v253, v254, s[8:11], 0 offen offset:2048 sc1
s_waitcnt vmcnt(0)
v_cmp_gt_u32 vcc, 1, v253
s_nop 4
s_cbranch_vccz L_spin_f3_ret
s_sub_u32 s36, s36, 1
s_cmp_lg_u32 s36, 0
s_cbranch_scc1 L_spin_f3_l
s_branch L_spin_f3_ret
L_code_end:
s_endpgm
.section .rodata,"a"
.p2align 6
.amdhsa_kernel gated_mix__ssm_conv_h3__compressed_kv_cla__prompt_kernel
  .amdhsa_next_free_vgpr 512
  .amdhsa_next_free_sgpr 102
  .amdhsa_accum_offset 256
  .amdhsa_group_segment_fixed_size 0
  .amdhsa_kernarg_size 128
  .amdhsa_user_sgpr_count 2
  .amdhsa_user_sgpr_kernarg_segment_ptr 1
  .amdhsa_system_sgpr_workgroup_id_x 1
  .amdhsa_float_denorm_mode_32 3
.end_amdhsa_kernel
.text
```

```asm
; @launch grid=(256,1,1) block=(256,1,1) lds=163840
.amdgcn_target "amdgcn-amd-amdhsa--gfx950"
.text
.macro MA d,x,a,y,b
v_mfma_f32_16x16x32_bf16 a[\d:\d+3], \x[\a:\a+3], \y[\b:\b+3], a[\d:\d+3]
.endm
.macro MV d,x,a,y,b
v_mfma_f32_16x16x32_bf16 v[\d:\d+3], \x[\a:\a+3], \y[\b:\b+3], v[\d:\d+3]
.endm
.macro TR d,a,o
ds_read_b64_tr_b16 v[\d:\d+1], v\a offset:\o
.endm
.globl gated_mix__ssm_conv_h3__compressed_kv_cla__prompt_kernel
.p2align 8
.type gated_mix__ssm_conv_h3__compressed_kv_cla__prompt_kernel,@function
gated_mix__ssm_conv_h3__compressed_kv_cla__prompt_kernel:
s_cmp_ge_u32 s2, 256
s_cbranch_scc1 L_end
s_load_dwordx2 s[44:45], s[0:1], 56
s_load_dwordx4 s[48:51], s[0:1], 72
s_load_dwordx2 s[40:41], s[0:1], 120
s_load_dwordx2 s[52:53], s[0:1], 112
s_load_dwordx2 s[32:33], s[0:1], 0
s_load_dwordx2 s[34:35], s[0:1], 64
v_lshrrev_b32 v2, 6, v0
v_and_b32 v1, 63, v0
v_lshlrev_b32 v3, 4, v0
v_readfirstlane_b32 s3, v2
s_getpc_b64 s[4:5]
L_ct_e:
s_add_u32 s4, s4, L_p1_K - L_ct_e
s_addc_u32 s5, s5, 0
v_mov_b32 v77, s5
v_mov_b32 v76, s4
s_lshr_b32 s4, s2, 3
s_lshl_b32 s4, s4, 2
s_add_u32 s4, s4, s3
s_lshl_b32 s4, s4, 7
v_and_b32 v79, 3, v1
v_lshlrev_b32 v79, 14, v79
v_add_u32 v79, s4, v79
v_min_u32 v79, L_p3_begin - L_p1_K - 4, v79
v_add_co_u32 v76, vcc, v76, v79
s_nop 1
v_addc_co_u32 v77, vcc, 0, v77, vcc
global_load_dword v79, v[76:77], off
s_and_b32 s36, s2, 7
s_lshr_b32 s37, s2, 3
s_and_b32 s38, s37, 7
s_lshr_b32 s37, s37, 3
s_lshr_b32 s42, s37, 1
s_and_b32 s37, s37, 1
s_lshl_b32 s36, s36, 1
s_add_u32 s36, s36, s37
s_lshl_b32 s24, s38, 18
s_lshl_b32 s39, s3, 16
s_add_u32 s24, s24, s39
s_lshl_b32 s25, s3, 17
s_lshl_b32 s39, s36, 9
s_add_u32 s25, s25, s39
s_and_b32 s20, s2, 7
s_lshl_b32 s21, s20, 19
s_lshl_b32 s20, s20, 7
s_lshl_b32 s22, s3, 13
s_add_u32 s23, s22, 98304
v_lshrrev_b32 v204, 3, v1
v_lshlrev_b32 v204, 10, v204
v_lshrrev_b32 v205, 4, v1
v_and_b32 v206, 7, v1
v_xor_b32 v206, v206, v205
v_lshl_add_u32 v204, v206, 4, v204
v_xor_b32 v207, 64, v204
v_add_u32 v176, 0, v204
v_add_u32 v177, 7168, v207
v_add_u32 v178, 14336, v204
v_add_u32 v179, 21504, v207
v_add_u32 v180, 32768, v204
v_add_u32 v181, 39936, v207
v_add_u32 v182, 47104, v204
v_add_u32 v183, 54272, v207
v_lshrrev_b32 v204, 5, v1
v_and_b32 v206, 31, v1
v_lshlrev_b32 v207, 1, v204
v_xor_b32 v206, v206, v207
v_lshlrev_b32 v204, 13, v204
v_xor_b32 v207, 0, v206
v_lshl_add_u32 v207, v207, 4, v204
v_add_u32 v184, 0, v207
v_xor_b32 v207, 4, v206
v_lshl_add_u32 v207, v207, 4, v204
v_add_u32 v185, 15360, v207
v_xor_b32 v207, 0, v206
v_lshl_add_u32 v207, v207, 4, v204
v_add_u32 v186, 30720, v207
v_xor_b32 v207, 4, v206
v_lshl_add_u32 v207, v207, 4, v204
v_add_u32 v187, 46080, v207
v_xor_b32 v207, 8, v206
v_lshl_add_u32 v207, v207, 4, v204
v_add_u32 v188, 65536, v207
v_xor_b32 v207, 12, v206
v_lshl_add_u32 v207, v207, 4, v204
v_add_u32 v189, 80896, v207
v_xor_b32 v207, 8, v206
v_lshl_add_u32 v207, v207, 4, v204
v_add_u32 v190, 96256, v207
v_xor_b32 v207, 12, v206
v_lshl_add_u32 v207, v207, 4, v204
v_add_u32 v191, 111616, v207
s_waitcnt lgkmcnt(0)
s_add_u32 s8, s44, s24
s_addc_u32 s9, s45, 0
s_mov_b32 s10, 65536
s_mov_b32 s11, 0x20000
s_cmp_eq_u32 s42, 0
s_cselect_b32 s12, s48, s50
s_cselect_b32 s13, s49, s51
s_add_u32 s12, s12, s25
s_addc_u32 s13, s13, 0
s_sub_u32 s14, 4194304, s25
s_mov_b32 s15, 0x20000
s_add_u32 s4, s40, 59768832
s_addc_u32 s5, s41, 0
s_mov_b32 s6, 8192
s_mov_b32 s7, 0x20000
s_lshl_b32 s43, s2, 20
v_add_u32 v3, s43, v3
v_mov_b32 v4, 0
v_mov_b32 v5, 0
v_mov_b32 v6, 0
v_mov_b32 v7, 0
s_movk_i32 s43, 4096
buffer_store_dwordx4 v[4:7], v3, s[4:7], 0 offen sc1
buffer_store_dwordx4 v[4:7], v3, s[4:7], s43 offen sc1
s_waitcnt vmcnt(2)
v_lshlrev_b32 v79, 16, v3
s_add_u32 m0, s23, 0
s_nop 0
buffer_load_dwordx4 v184, s[12:15], s21 offen offset:0 lds
buffer_load_dwordx4 v185, s[12:15], s21 offen offset:1024 lds
buffer_load_dwordx4 v186, s[12:15], s21 offen offset:2048 lds
buffer_load_dwordx4 v187, s[12:15], s21 offen offset:3072 lds
s_add_u32 m0, s23, 4096
s_nop 0
buffer_load_dwordx4 v188, s[12:15], s21 offen offset:0 lds
buffer_load_dwordx4 v189, s[12:15], s21 offen offset:1024 lds
buffer_load_dwordx4 v190, s[12:15], s21 offen offset:2048 lds
buffer_load_dwordx4 v191, s[12:15], s21 offen offset:3072 lds
s_add_u32 s21, s21, 524288
s_and_b32 s21, s21, 4194303
s_add_u32 m0, s22, 0
s_nop 0
buffer_load_dwordx4 v176, s[8:11], s20 offen offset:0 lds
buffer_load_dwordx4 v177, s[8:11], s20 offen offset:1024 lds
buffer_load_dwordx4 v178, s[8:11], s20 offen offset:2048 lds
buffer_load_dwordx4 v179, s[8:11], s20 offen offset:3072 lds
s_add_u32 m0, s22, 4096
s_nop 0
buffer_load_dwordx4 v180, s[8:11], s20 offen offset:0 lds
buffer_load_dwordx4 v181, s[8:11], s20 offen offset:1024 lds
buffer_load_dwordx4 v182, s[8:11], s20 offen offset:2048 lds
buffer_load_dwordx4 v183, s[8:11], s20 offen offset:3072 lds
s_add_u32 s20, s20, 128
s_and_b32 s20, s20, 1023
v_and_b32 v204, 15, v1
v_lshrrev_b32 v206, 1, v204
v_xor_b32 v206, v206, v205
v_lshlrev_b32 v206, 4, v206
v_lshl_add_u32 v206, v204, 7, v206
s_and_b32 s39, s3, 1
s_lshl_b32 s39, s39, 14
v_add_u32 v192, s39, v206
v_xor_b32 v193, 64, v192
v_add_u32 v194, 0x10000, v192
v_add_u32 v195, 0x10000, v193
v_bfe_u32 v204, v1, 2, 2
v_and_b32 v206, 1, v205
v_lshl_or_b32 v206, v206, 2, v204
v_lshl_add_u32 v204, v205, 3, v204
v_lshlrev_b32 v204, 9, v204
v_and_b32 v207, 3, v1
v_lshl_add_u32 v204, v207, 3, v204
s_lshr_b32 s39, s3, 1
s_lshl_b32 s39, s39, 8
s_add_u32 s39, s39, 98304
v_add_u32 v204, s39, v204
v_xor_b32 v207, 0, v206
v_lshl_add_u32 v196, v207, 5, v204
v_xor_b32 v207, 1, v206
v_lshl_add_u32 v197, v207, 5, v204
v_xor_b32 v207, 2, v206
v_lshl_add_u32 v198, v207, 5, v204
v_xor_b32 v207, 3, v206
v_lshl_add_u32 v199, v207, 5, v204
v_xor_b32 v207, 4, v206
v_lshl_add_u32 v200, v207, 5, v204
v_xor_b32 v207, 5, v206
v_lshl_add_u32 v201, v207, 5, v204
v_xor_b32 v207, 6, v206
v_lshl_add_u32 v202, v207, 5, v204
v_xor_b32 v207, 7, v206
v_lshl_add_u32 v203, v207, 5, v204
s_lshl_b32 s36, s36, 1
s_lshr_b32 s39, s3, 1
s_add_u32 s36, s36, s39
s_lshl_b32 s24, s36, 19
s_lshl_b32 s38, s38, 16
s_add_u32 s24, s24, s38
s_and_b32 s39, s3, 1
s_lshl_b32 s39, s39, 15
s_add_u32 s24, s24, s39
s_lshl_b32 s36, s42, 24
s_add_u32 s16, s40, s36
s_addc_u32 s17, s41, 0
s_mov_b32 s18, 16777216
s_mov_b32 s19, 0x20000
s_mov_b32 s54, 256
s_mov_b32 s55, 0x20000
v_mov_b32 v78, 1
s_cmp_lg_u32 s2, 0
s_cselect_b32 s43, 0x10000000, 0
v_or_b32 v79, s43, v79
s_waitcnt vmcnt(0)
s_barrier
buffer_store_dword v78, v79, s[52:55], 0 offen sc1
ds_read_b128 v[80:83], v192 offset:0
ds_read_b128 v[84:87], v192 offset:2048
ds_read_b128 v[88:91], v192 offset:4096
ds_read_b128 v[92:95], v192 offset:6144
ds_read_b128 v[96:99], v192 offset:8192
ds_read_b128 v[100:103], v192 offset:10240
ds_read_b128 v[104:107], v192 offset:12288
ds_read_b128 v[108:111], v192 offset:14336
TR 144,196,0
TR 146,196,2048
TR 148,197,0
TR 150,197,2048
TR 152,198,0
TR 154,198,2048
TR 156,199,0
TR 158,199,2048
TR 160,200,0
TR 162,200,2048
TR 164,201,0
TR 166,201,2048
TR 168,202,0
TR 170,202,2048
TR 172,203,0
TR 174,203,2048
s_cmp_eq_u32 s42, 0
s_cbranch_scc0 L_p1_V
L_p1_K:
s_waitcnt lgkmcnt(14)
v_mfma_f32_16x16x32_bf16 a[0:3], v[144:147], v[80:83], 0
s_add_u32 m0, s23, 32768
s_waitcnt lgkmcnt(12)
v_mfma_f32_16x16x32_bf16 a[4:7], v[148:151], v[80:83], 0
ds_read_b128 v[112:115], v193 offset:0
v_mfma_f32_16x16x32_bf16 a[32:35], v[144:147], v[84:87], 0
buffer_load_dwordx4 v184, s[12:15], s21 offen offset:0 lds
v_mfma_f32_16x16x32_bf16 a[36:39], v[148:151], v[84:87], 0
v_mfma_f32_16x16x32_bf16 a[64:67], v[144:147], v[88:91], 0
v_mfma_f32_16x16x32_bf16 a[68:71], v[148:151], v[88:91], 0
buffer_load_dwordx4 v185, s[12:15], s21 offen offset:1024 lds
v_mfma_f32_16x16x32_bf16 a[96:99], v[144:147], v[92:95], 0
v_mfma_f32_16x16x32_bf16 a[100:103], v[148:151], v[92:95], 0
ds_read_b128 v[116:119], v193 offset:2048
buffer_load_dwordx4 v186, s[12:15], s21 offen offset:2048 lds
v_mfma_f32_16x16x32_bf16 a[128:131], v[144:147], v[96:99], 0
v_mfma_f32_16x16x32_bf16 a[132:135], v[148:151], v[96:99], 0
v_mfma_f32_16x16x32_bf16 a[160:163], v[144:147], v[100:103], 0
buffer_load_dwordx4 v187, s[12:15], s21 offen offset:3072 lds
v_mfma_f32_16x16x32_bf16 a[164:167], v[148:151], v[100:103], 0
v_mfma_f32_16x16x32_bf16 a[192:195], v[144:147], v[104:107], 0
s_add_u32 m0, s23, 36864
v_mfma_f32_16x16x32_bf16 a[196:199], v[148:151], v[104:107], 0
ds_read_b128 v[120:123], v193 offset:4096
v_mfma_f32_16x16x32_bf16 a[224:227], v[144:147], v[108:111], 0
TR 144,196,16384
TR 146,196,18432
v_mfma_f32_16x16x32_bf16 a[228:231], v[148:151], v[108:111], 0
TR 148,197,16384
TR 150,197,18432
s_waitcnt lgkmcnt(15)
v_mfma_f32_16x16x32_bf16 a[232:235], v[152:155], v[108:111], 0
buffer_load_dwordx4 v188, s[12:15], s21 offen offset:0 lds
v_mfma_f32_16x16x32_bf16 a[236:239], v[156:159], v[108:111], 0
v_mfma_f32_16x16x32_bf16 a[200:203], v[152:155], v[104:107], 0
buffer_load_dwordx4 v189, s[12:15], s21 offen offset:1024 lds
v_mfma_f32_16x16x32_bf16 a[204:207], v[156:159], v[104:107], 0
v_mfma_f32_16x16x32_bf16 a[168:171], v[152:155], v[100:103], 0
ds_read_b128 v[124:127], v193 offset:6144
buffer_load_dwordx4 v190, s[12:15], s21 offen offset:2048 lds
v_mfma_f32_16x16x32_bf16 a[172:175], v[156:159], v[100:103], 0
v_mfma_f32_16x16x32_bf16 a[136:139], v[152:155], v[96:99], 0
v_mfma_f32_16x16x32_bf16 a[140:143], v[156:159], v[96:99], 0
buffer_load_dwordx4 v191, s[12:15], s21 offen offset:3072 lds
v_mfma_f32_16x16x32_bf16 a[104:107], v[152:155], v[92:95], 0
v_mfma_f32_16x16x32_bf16 a[108:111], v[156:159], v[92:95], 0
s_add_u32 s21, s21, 524288
v_mfma_f32_16x16x32_bf16 a[72:75], v[152:155], v[88:91], 0
ds_read_b128 v[128:131], v193 offset:8192
v_mfma_f32_16x16x32_bf16 a[76:79], v[156:159], v[88:91], 0
v_mfma_f32_16x16x32_bf16 a[40:43], v[152:155], v[84:87], 0
s_and_b32 s21, s21, 4194303
v_mfma_f32_16x16x32_bf16 a[44:47], v[156:159], v[84:87], 0
v_mfma_f32_16x16x32_bf16 a[8:11], v[152:155], v[80:83], 0
TR 152,198,16384
TR 154,198,18432
v_mfma_f32_16x16x32_bf16 a[12:15], v[156:159], v[80:83], 0
TR 156,199,16384
TR 158,199,18432
s_waitcnt lgkmcnt(15)
v_mfma_f32_16x16x32_bf16 a[16:19], v[160:163], v[80:83], 0
ds_read_b128 v[132:135], v193 offset:10240
s_add_u32 m0, s22, 32768
v_mfma_f32_16x16x32_bf16 a[20:23], v[164:167], v[80:83], 0
buffer_load_dwordx4 v176, s[8:11], s20 offen offset:0 lds
v_mfma_f32_16x16x32_bf16 a[48:51], v[160:163], v[84:87], 0
v_mfma_f32_16x16x32_bf16 a[52:55], v[164:167], v[84:87], 0
v_mfma_f32_16x16x32_bf16 a[80:83], v[160:163], v[88:91], 0
buffer_load_dwordx4 v177, s[8:11], s20 offen offset:1024 lds
v_mfma_f32_16x16x32_bf16 a[84:87], v[164:167], v[88:91], 0
v_mfma_f32_16x16x32_bf16 a[112:115], v[160:163], v[92:95], 0
buffer_load_dwordx4 v178, s[8:11], s20 offen offset:2048 lds
v_mfma_f32_16x16x32_bf16 a[116:119], v[164:167], v[92:95], 0
ds_read_b128 v[136:139], v193 offset:12288
v_mfma_f32_16x16x32_bf16 a[144:147], v[160:163], v[96:99], 0
v_mfma_f32_16x16x32_bf16 a[148:151], v[164:167], v[96:99], 0
buffer_load_dwordx4 v179, s[8:11], s20 offen offset:3072 lds
v_mfma_f32_16x16x32_bf16 a[176:179], v[160:163], v[100:103], 0
v_mfma_f32_16x16x32_bf16 a[180:183], v[164:167], v[100:103], 0
s_add_u32 m0, s22, 36864
v_mfma_f32_16x16x32_bf16 a[208:211], v[160:163], v[104:107], 0
v_mfma_f32_16x16x32_bf16 a[212:215], v[164:167], v[104:107], 0
ds_read_b128 v[140:143], v193 offset:14336
v_mfma_f32_16x16x32_bf16 a[240:243], v[160:163], v[108:111], 0
TR 160,200,16384
TR 162,200,18432
v_mfma_f32_16x16x32_bf16 a[244:247], v[164:167], v[108:111], 0
TR 164,201,16384
TR 166,201,18432
v_mfma_f32_16x16x32_bf16 a[248:251], v[168:171], v[108:111], 0
buffer_load_dwordx4 v180, s[8:11], s20 offen offset:0 lds
s_waitcnt lgkmcnt(15)
v_mfma_f32_16x16x32_bf16 a[252:255], v[172:175], v[108:111], 0
buffer_load_dwordx4 v181, s[8:11], s20 offen offset:1024 lds
v_mfma_f32_16x16x32_bf16 a[216:219], v[168:171], v[104:107], 0
v_mfma_f32_16x16x32_bf16 a[220:223], v[172:175], v[104:107], 0
buffer_load_dwordx4 v182, s[8:11], s20 offen offset:2048 lds
v_mfma_f32_16x16x32_bf16 a[184:187], v[168:171], v[100:103], 0
v_mfma_f32_16x16x32_bf16 a[188:191], v[172:175], v[100:103], 0
v_mfma_f32_16x16x32_bf16 a[152:155], v[168:171], v[96:99], 0
buffer_load_dwordx4 v183, s[8:11], s20 offen offset:3072 lds
v_mfma_f32_16x16x32_bf16 a[156:159], v[172:175], v[96:99], 0
v_mfma_f32_16x16x32_bf16 a[120:123], v[168:171], v[92:95], 0
s_add_u32 s20, s20, 128
v_mfma_f32_16x16x32_bf16 a[124:127], v[172:175], v[92:95], 0
v_mfma_f32_16x16x32_bf16 a[88:91], v[168:171], v[88:91], 0
v_mfma_f32_16x16x32_bf16 a[92:95], v[172:175], v[88:91], 0
s_and_b32 s20, s20, 1023
v_mfma_f32_16x16x32_bf16 a[56:59], v[168:171], v[84:87], 0
v_mfma_f32_16x16x32_bf16 a[60:63], v[172:175], v[84:87], 0
v_mfma_f32_16x16x32_bf16 a[24:27], v[168:171], v[80:83], 0
TR 168,202,16384
TR 170,202,18432
v_mfma_f32_16x16x32_bf16 a[28:31], v[172:175], v[80:83], 0
TR 172,203,16384
TR 174,203,18432
s_waitcnt lgkmcnt(4)
MA 0,v,144,v,112
s_add_u32 m0, s22, 65536
MA 4,v,148,v,112
MA 32,v,144,v,116
MA 36,v,148,v,116
buffer_load_dwordx4 v176, s[8:11], s20 offen offset:0 lds
MA 64,v,144,v,120
MA 68,v,148,v,120
MA 96,v,144,v,124
MA 100,v,148,v,124
buffer_load_dwordx4 v177, s[8:11], s20 offen offset:1024 lds
MA 128,v,144,v,128
MA 132,v,148,v,128
MA 160,v,144,v,132
buffer_load_dwordx4 v178, s[8:11], s20 offen offset:2048 lds
MA 164,v,148,v,132
MA 192,v,144,v,136
MA 196,v,148,v,136
MA 224,v,144,v,140
buffer_load_dwordx4 v179, s[8:11], s20 offen offset:3072 lds
MA 228,v,148,v,140
MA 232,v,152,v,140
MA 236,v,156,v,140
s_add_u32 m0, s22, 69632
MA 200,v,152,v,136
MA 204,v,156,v,136
MA 168,v,152,v,132
MA 172,v,156,v,132
buffer_load_dwordx4 v180, s[8:11], s20 offen offset:0 lds
MA 136,v,152,v,128
MA 140,v,156,v,128
MA 104,v,152,v,124
MA 108,v,156,v,124
buffer_load_dwordx4 v181, s[8:11], s20 offen offset:1024 lds
MA 72,v,152,v,120
MA 76,v,156,v,120
MA 40,v,152,v,116
buffer_load_dwordx4 v182, s[8:11], s20 offen offset:2048 lds
MA 44,v,156,v,116
MA 8,v,152,v,112
MA 12,v,156,v,112
MA 16,v,160,v,112
buffer_load_dwordx4 v183, s[8:11], s20 offen offset:3072 lds
MA 20,v,164,v,112
MA 48,v,160,v,116
MA 52,v,164,v,116
s_add_u32 s20, s20, 128
MA 80,v,160,v,120
MA 84,v,164,v,120
MA 112,v,160,v,124
MA 116,v,164,v,124
s_and_b32 s20, s20, 1023
MA 144,v,160,v,128
MA 148,v,164,v,128
MA 176,v,160,v,132
MA 180,v,164,v,132
MA 208,v,160,v,136
s_waitcnt vmcnt(8) lgkmcnt(0)
s_barrier
MA 212,v,164,v,136
TR 144,196,32768
TR 146,196,34816
MA 240,v,160,v,140
ds_read_b128 v[80:83], v192 offset:32768
s_add_u32 m0, s23, 0
MA 244,v,164,v,140
TR 148,197,32768
TR 150,197,34816
MA 248,v,168,v,140
ds_read_b128 v[84:87], v192 offset:34816
ds_read_b128 v[88:91], v192 offset:36864
MA 252,v,172,v,140
TR 152,198,32768
TR 154,198,34816
MA 216,v,168,v,136
ds_read_b128 v[92:95], v192 offset:38912
ds_read_b128 v[96:99], v192 offset:40960
MA 220,v,172,v,136
TR 156,199,32768
TR 158,199,34816
MA 184,v,168,v,132
ds_read_b128 v[100:103], v192 offset:43008
ds_read_b128 v[104:107], v192 offset:45056
MA 188,v,172,v,132
TR 160,200,32768
TR 162,200,34816
MA 152,v,168,v,128
ds_read_b128 v[108:111], v192 offset:47104
buffer_load_dwordx4 v184, s[12:15], s21 offen offset:0 lds
MA 156,v,172,v,128
TR 164,201,32768
TR 166,201,34816
MA 120,v,168,v,124
buffer_load_dwordx4 v185, s[12:15], s21 offen offset:1024 lds
buffer_load_dwordx4 v186, s[12:15], s21 offen offset:2048 lds
MA 124,v,172,v,124
buffer_load_dwordx4 v187, s[12:15], s21 offen offset:3072 lds
s_add_u32 m0, s23, 4096
MA 88,v,168,v,120
buffer_load_dwordx4 v188, s[12:15], s21 offen offset:0 lds
buffer_load_dwordx4 v189, s[12:15], s21 offen offset:1024 lds
MA 92,v,172,v,120
buffer_load_dwordx4 v190, s[12:15], s21 offen offset:2048 lds
buffer_load_dwordx4 v191, s[12:15], s21 offen offset:3072 lds
MA 56,v,168,v,116
s_add_u32 s21, s21, 524288
s_and_b32 s21, s21, 4194303
MA 60,v,172,v,116
s_load_dwordx2 s[84:85], s[0:1], 8
s_load_dwordx2 s[88:89], s[0:1], 16
MA 24,v,168,v,112
TR 168,202,32768
TR 170,202,34816
MA 28,v,172,v,112
TR 172,203,32768
TR 174,203,34816
s_load_dwordx2 s[92:93], s[0:1], 0
s_load_dwordx2 s[96:97], s[0:1], 24
s_load_dwordx2 s[76:77], s[0:1], 96
s_waitcnt lgkmcnt(4)
MA 0,v,144,v,80
s_add_u32 m0, s22, 0
MA 4,v,148,v,80
ds_read_b128 v[112:115], v193 offset:32768
MA 32,v,144,v,84
s_mov_b32 s4, s34
s_mov_b32 s5, s35
MA 36,v,148,v,84
MA 64,v,144,v,88
MA 68,v,148,v,88
buffer_load_dwordx4 v176, s[8:11], s20 offen offset:0 lds
MA 96,v,144,v,92
MA 100,v,148,v,92
ds_read_b128 v[116:119], v193 offset:34816
MA 128,v,144,v,96
s_mov_b32 s6, 8388608
s_mov_b32 s7, 0x20000
MA 132,v,148,v,96
MA 160,v,144,v,100
buffer_load_dwordx4 v177, s[8:11], s20 offen offset:1024 lds
MA 164,v,148,v,100
MA 192,v,144,v,104
MA 196,v,148,v,104
ds_read_b128 v[120:123], v193 offset:36864
MA 224,v,144,v,108
TR 144,196,49152
TR 146,196,51200
MA 228,v,148,v,108
TR 148,197,49152
TR 150,197,51200
MA 232,v,152,v,108
buffer_load_dwordx4 v178, s[8:11], s20 offen offset:2048 lds
s_lshr_b32 s43, s2, 3
MA 236,v,156,v,108
MA 200,v,152,v,104
MA 204,v,156,v,104
s_lshl_b32 s43, s43, 2
MA 168,v,152,v,100
ds_read_b128 v[124:127], v193 offset:38912
buffer_load_dwordx4 v179, s[8:11], s20 offen offset:3072 lds
MA 172,v,156,v,100
MA 136,v,152,v,96
MA 140,v,156,v,96
s_add_u32 s43, s43, s3
MA 104,v,152,v,92
MA 108,v,156,v,92
s_add_u32 m0, s22, 4096
MA 72,v,152,v,88
ds_read_b128 v[128:131], v193 offset:40960
MA 76,v,156,v,88
s_lshl_b32 s43, s43, 16
MA 40,v,152,v,84
MA 44,v,156,v,84
MA 8,v,152,v,80
TR 152,198,49152
TR 154,198,51200
MA 12,v,156,v,80
TR 156,199,49152
TR 158,199,51200
MA 16,v,160,v,80
ds_read_b128 v[132:135], v193 offset:43008
buffer_load_dwordx4 v180, s[8:11], s20 offen offset:0 lds
MA 20,v,164,v,80
s_and_b32 s37, s2, 7
MA 48,v,160,v,84
s_lshl_b32 s37, s37, 10
MA 52,v,164,v,84
MA 80,v,160,v,88
buffer_load_dwordx4 v181, s[8:11], s20 offen offset:1024 lds
MA 84,v,164,v,88
MA 112,v,160,v,92
s_add_u32 s43, s43, s37
MA 116,v,164,v,92
ds_read_b128 v[136:139], v193 offset:45056
MA 144,v,160,v,96
MA 148,v,164,v,96
buffer_load_dwordx4 v182, s[8:11], s20 offen offset:2048 lds
MA 176,v,160,v,100
v_lshrrev_b32 v78, 3, v1
MA 180,v,164,v,100
MA 208,v,160,v,104
MA 212,v,164,v,104
ds_read_b128 v[140:143], v193 offset:47104
MA 240,v,160,v,108
TR 160,200,49152
TR 162,200,51200
MA 244,v,164,v,108
TR 164,201,49152
TR 166,201,51200
s_waitcnt lgkmcnt(15)
MA 248,v,168,v,108
buffer_load_dwordx4 v183, s[8:11], s20 offen offset:3072 lds
v_and_b32 v79, 7, v1
MA 252,v,172,v,108
MA 216,v,168,v,104
v_lshlrev_b32 v79, 7, v79
MA 220,v,172,v,104
s_add_u32 s20, s20, 128
MA 184,v,168,v,100
MA 188,v,172,v,100
MA 152,v,168,v,96
v_lshl_add_u32 v78, v78, 13, v79
MA 156,v,172,v,96
MA 120,v,168,v,92
s_and_b32 s20, s20, 1023
MA 124,v,172,v,92
MA 88,v,168,v,88
v_add_u32 v78, s43, v78
MA 92,v,172,v,88
MA 56,v,168,v,84
MA 60,v,172,v,84
MA 24,v,168,v,80
TR 168,202,49152
TR 170,202,51200
MA 28,v,172,v,80
TR 172,203,49152
TR 174,203,51200
s_waitcnt lgkmcnt(4)
MA 0,v,144,v,112
MA 4,v,148,v,112
MA 32,v,144,v,116
MA 36,v,148,v,116
MA 64,v,144,v,120
MA 68,v,148,v,120
MA 96,v,144,v,124
MA 100,v,148,v,124
MA 128,v,144,v,128
MA 132,v,148,v,128
s_waitcnt vmcnt(8) lgkmcnt(0)
s_barrier
MA 160,v,144,v,132
s_add_u32 m0, s23, 32768
s_mov_b32 s86, 4194304
MA 164,v,148,v,132
ds_read_b128 v[80:83], v194 offset:0
s_mov_b32 s87, 0x20000
MA 192,v,144,v,136
s_mov_b32 s90, 4194304
MA 196,v,148,v,136
s_mov_b32 s91, 0x20000
MA 224,v,144,v,140
TR 144,196,0
TR 146,196,2048
MA 228,v,148,v,140
TR 148,197,0
TR 150,197,2048
MA 232,v,152,v,140
ds_read_b128 v[84:87], v194 offset:2048
buffer_load_dwordx4 v184, s[12:15], s21 offen offset:0 lds
MA 236,v,156,v,140
s_mov_b32 s94, 4194304
s_mov_b32 s95, 0x20000
MA 200,v,152,v,136
buffer_load_dwordx4 v185, s[12:15], s21 offen offset:1024 lds
s_mov_b32 s98, 8192
MA 204,v,156,v,136
s_mov_b32 s99, 0x20000
MA 168,v,152,v,132
s_mov_b32 s78, 2048
MA 172,v,156,v,132
ds_read_b128 v[88:91], v194 offset:4096
s_mov_b32 s79, 0x20000
MA 136,v,152,v,128
s_and_b32 s36, s2, 15
MA 140,v,156,v,128
buffer_load_dwordx4 v186, s[12:15], s21 offen offset:2048 lds
s_lshl_b32 s36, s36, 1
MA 104,v,152,v,124
MA 108,v,156,v,124
s_lshr_b32 s37, s3, 1
MA 72,v,152,v,120
ds_read_b128 v[92:95], v194 offset:6144
s_add_u32 s36, s36, s37
MA 76,v,156,v,120
buffer_load_dwordx4 v187, s[12:15], s21 offen offset:3072 lds
s_lshl_b32 s36, s36, 3
MA 40,v,152,v,116
MA 44,v,156,v,116
v_and_b32 v252, 7, v1
MA 8,v,152,v,112
TR 152,198,0
TR 154,198,2048
MA 12,v,156,v,112
TR 156,199,0
TR 158,199,2048
MA 16,v,160,v,112
ds_read_b128 v[96:99], v194 offset:8192
s_add_u32 m0, s23, 36864
MA 20,v,164,v,112
v_add_u32 v252, s36, v252
s_lshr_b32 s36, s2, 4
MA 48,v,160,v,116
s_lshl_b32 s36, s36, 1
s_and_b32 s37, s3, 1
MA 52,v,164,v,116
s_add_u32 s36, s36, s37
MA 80,v,160,v,120
ds_read_b128 v[100:103], v194 offset:10240
buffer_load_dwordx4 v188, s[12:15], s21 offen offset:0 lds
MA 84,v,164,v,120
s_lshl_b32 s36, s36, 3
v_lshrrev_b32 v253, 3, v1
MA 112,v,160,v,124
MA 116,v,164,v,124
v_add_u32 v253, s36, v253
MA 144,v,160,v,128
buffer_load_dwordx4 v189, s[12:15], s21 offen offset:1024 lds
v_lshlrev_b32 v254, 14, v253
MA 148,v,164,v,128
ds_read_b128 v[104:107], v194 offset:12288
v_lshl_add_u32 v254, v252, 3, v254
MA 176,v,160,v,132
v_add_u32 v229, -6144, v254
MA 180,v,164,v,132
MA 208,v,160,v,136
buffer_load_dwordx4 v190, s[12:15], s21 offen offset:2048 lds
v_lshlrev_b32 v62, 5, v252
MA 212,v,164,v,136
v_lshlrev_b32 v254, 4, v253
MA 240,v,160,v,140
TR 160,200,0
TR 162,200,2048
MA 244,v,164,v,140
TR 164,201,0
TR 166,201,2048
MA 248,v,168,v,140
ds_read_b128 v[108:111], v194 offset:14336
v_sub_u32 v254, 4080, v254
MA 252,v,172,v,140
buffer_load_dwordx4 v191, s[12:15], s21 offen offset:3072 lds
v_lshl_add_u32 v10, v252, 14, v254
MA 216,v,168,v,136
v_and_b32 v252, 31, v1
v_lshlrev_b32 v64, 4, v252
MA 220,v,172,v,136
s_lshl_b32 s36, s2, 2
MA 184,v,168,v,132
MA 188,v,172,v,132
s_add_u32 s21, s21, 524288
s_add_u32 s36, s36, s3
MA 152,v,168,v,128
s_lshl_b32 s36, s36, 1
MA 156,v,172,v,128
v_lshrrev_b32 v253, 5, v1
MA 120,v,168,v,124
v_add_u32 v253, s36, v253
MA 124,v,172,v,124
s_and_b32 s21, s21, 4194303
MA 88,v,168,v,120
v_lshl_add_u32 v63, v253, 11, v64
MA 92,v,172,v,120
v_lshlrev_b32 v253, 2, v253
MA 56,v,168,v,116
v_lshl_add_u32 v11, v252, 20, v253
MA 60,v,172,v,116
MA 24,v,168,v,112
TR 168,202,0
TR 170,202,2048
MA 28,v,172,v,112
TR 172,203,0
TR 174,203,2048
s_waitcnt lgkmcnt(4)
MA 0,v,144,v,80
s_add_u32 m0, s22, 32768
buffer_load_dwordx4 v[230:233], v63, s[92:95], 0 offen offset:0
MA 4,v,148,v,80
ds_read_b128 v[112:115], v195 offset:0
MA 32,v,144,v,84
MA 36,v,148,v,84
MA 64,v,144,v,88
buffer_load_dwordx4 v[2:5], v64, s[76:79], 0 offen offset:0
MA 68,v,148,v,88
buffer_load_dwordx4 v176, s[8:11], s20 offen offset:0 lds
MA 96,v,144,v,92
MA 100,v,148,v,92
ds_read_b128 v[116:119], v195 offset:2048
MA 128,v,144,v,96
MA 132,v,148,v,96
buffer_load_dwordx4 v[234:237], v63, s[92:95], 0 offen offset:512
MA 160,v,144,v,100
buffer_load_dwordx4 v177, s[8:11], s20 offen offset:1024 lds
MA 164,v,148,v,100
MA 192,v,144,v,104
MA 196,v,148,v,104
ds_read_b128 v[120:123], v195 offset:4096
MA 224,v,144,v,108
TR 144,196,16384
TR 146,196,18432
MA 228,v,148,v,108
TR 148,197,16384
TR 150,197,18432
MA 232,v,152,v,108
buffer_load_dwordx4 v178, s[8:11], s20 offen offset:2048 lds
buffer_load_dwordx4 v[6:9], v64, s[76:79], 0 offen offset:512
MA 236,v,156,v,108
MA 200,v,152,v,104
MA 204,v,156,v,104
buffer_load_dwordx4 v[238:241], v63, s[92:95], 0 offen offset:1024
MA 168,v,152,v,100
ds_read_b128 v[124:127], v195 offset:6144
buffer_load_dwordx4 v179, s[8:11], s20 offen offset:3072 lds
MA 172,v,156,v,100
MA 136,v,152,v,96
MA 140,v,156,v,96
buffer_load_dwordx4 v[12:15], v64, s[76:79], 0 offen offset:1024
MA 104,v,152,v,92
MA 108,v,156,v,92
s_add_u32 m0, s22, 36864
MA 72,v,152,v,88
ds_read_b128 v[128:131], v195 offset:8192
MA 76,v,156,v,88
MA 40,v,152,v,84
buffer_load_dwordx4 v[242:245], v63, s[92:95], 0 offen offset:1536
MA 44,v,156,v,84
MA 8,v,152,v,80
TR 152,198,16384
TR 154,198,18432
MA 12,v,156,v,80
TR 156,199,16384
TR 158,199,18432
MA 16,v,160,v,80
ds_read_b128 v[132:135], v195 offset:10240
buffer_load_dwordx4 v180, s[8:11], s20 offen offset:0 lds
MA 20,v,164,v,80
buffer_load_dwordx4 v[246:249], v64, s[76:79], 0 offen offset:1536
MA 48,v,160,v,84
MA 52,v,164,v,84
MA 80,v,160,v,88
buffer_load_dwordx4 v181, s[8:11], s20 offen offset:1024 lds
MA 84,v,164,v,88
MA 112,v,160,v,92
buffer_load_dwordx4 v[54:57], v62, s[96:99], 0 offen offset:0
MA 116,v,164,v,92
ds_read_b128 v[136:139], v195 offset:12288
MA 144,v,160,v,96
MA 148,v,164,v,96
buffer_load_dwordx4 v182, s[8:11], s20 offen offset:2048 lds
MA 176,v,160,v,100
buffer_load_dwordx4 v[58:61], v62, s[96:99], 0 offen offset:16
MA 180,v,164,v,100
MA 208,v,160,v,104
MA 212,v,164,v,104
ds_read_b128 v[140:143], v195 offset:14336
MA 240,v,160,v,108
TR 160,200,16384
TR 162,200,18432
MA 244,v,164,v,108
TR 164,201,16384
TR 166,201,18432
s_waitcnt lgkmcnt(15)
MA 248,v,168,v,108
buffer_load_dwordx4 v183, s[8:11], s20 offen offset:3072 lds
v_add_u32 v252, 0, v229
MA 252,v,172,v,108
MA 216,v,168,v,104
MA 220,v,172,v,104
s_add_u32 s20, s20, 128
MA 184,v,168,v,100
buffer_load_dwordx2 v[16:17], v252, s[84:87], 0 offen
MA 188,v,172,v,100
MA 152,v,168,v,96
MA 156,v,172,v,96
MA 120,v,168,v,92
s_and_b32 s20, s20, 1023
MA 124,v,172,v,92
v_add_u32 v253, 2048, v229
MA 88,v,168,v,88
MA 92,v,172,v,88
MA 56,v,168,v,84
MA 60,v,172,v,84
MA 24,v,168,v,80
TR 168,202,16384
TR 170,202,18432
MA 28,v,172,v,80
TR 172,203,16384
TR 174,203,18432
s_waitcnt lgkmcnt(4)
MA 0,v,144,v,112
MA 4,v,148,v,112
MA 32,v,144,v,116
MA 36,v,148,v,116
MA 64,v,144,v,120
MA 68,v,148,v,120
MA 96,v,144,v,124
MA 100,v,148,v,124
MA 128,v,144,v,128
MA 132,v,148,v,128
s_waitcnt vmcnt(19) lgkmcnt(0)
s_barrier
MA 160,v,144,v,132
s_add_u32 m0, s23, 0
s_bfe_u32 s80, s2, 0x20001
MA 164,v,148,v,132
ds_read_b128 v[80:83], v192 offset:0
s_bfe_u32 s69, s2, 0x30003
MA 192,v,144,v,136
s_lshl_b32 s80, s80, 3
s_add_u32 s69, s69, s80
MA 196,v,148,v,136
s_lshr_b32 s80, s2, 6
MA 224,v,144,v,140
TR 144,196,32768
TR 146,196,34816
MA 228,v,148,v,140
TR 148,197,32768
TR 150,197,34816
MA 232,v,152,v,140
ds_read_b128 v[84:87], v192 offset:2048
buffer_load_dwordx4 v184, s[12:15], s21 offen offset:0 lds
MA 236,v,156,v,140
s_xor_b32 s81, s80, s2
s_and_b32 s81, s81, 1
MA 200,v,152,v,136
buffer_load_dwordx4 v185, s[12:15], s21 offen offset:1024 lds
s_lshl_b32 s70, s80, 1
MA 204,v,156,v,136
s_add_u32 s70, s70, s81
s_lshl_b32 s80, s3, 1
MA 168,v,152,v,132
s_sub_u32 s80, 7, s80
s_lshl_b32 s76, s80, 17
MA 172,v,156,v,132
ds_read_b128 v[88:91], v192 offset:4096
s_lshl_b32 s80, s3, 15
MA 136,v,152,v,128
s_lshl_b32 s65, s70, 18
s_sub_u32 s64, 3932160, s65
MA 140,v,156,v,128
buffer_load_dwordx4 v186, s[12:15], s21 offen offset:2048 lds
s_add_u32 s65, s65, s80
MA 104,v,152,v,124
s_add_u32 s64, s64, s80
MA 108,v,156,v,124
s_lshl_b32 s81, s69, 12
MA 72,v,152,v,120
ds_read_b128 v[92:95], v192 offset:6144
s_lshl_b32 s100, s64, 2
MA 76,v,156,v,120
buffer_load_dwordx4 v187, s[12:15], s21 offen offset:3072 lds
s_add_u32 s100, s100, s81
MA 40,v,152,v,116
s_lshl_b32 s101, s65, 2
MA 44,v,156,v,116
s_add_u32 s101, s101, s81
MA 8,v,152,v,112
TR 152,198,32768
TR 154,198,34816
MA 12,v,156,v,112
TR 156,199,32768
TR 158,199,34816
MA 16,v,160,v,112
ds_read_b128 v[96:99], v192 offset:8192
s_add_u32 m0, s23, 4096
MA 20,v,164,v,112
s_lshl_b32 s66, s3, 17
s_lshl_b32 s81, s69, 8
MA 48,v,160,v,116
s_add_u32 s66, s66, s81
s_and_b32 s74, s2, 7
MA 52,v,164,v,116
s_lshl_b32 s74, s74, 8
s_mov_b32 s82, s66
MA 80,v,160,v,120
ds_read_b128 v[100:103], v192 offset:10240
buffer_load_dwordx4 v188, s[12:15], s21 offen offset:0 lds
MA 84,v,164,v,120
s_lshl_b32 s66, s74, 12
s_lshl_b32 s67, s3, 13
MA 112,v,160,v,124
s_lshl_b32 s68, s3, 12
s_lshl_b32 s77, s70, 1
MA 116,v,164,v,124
s_sub_u32 s77, 32, s77
MA 144,v,160,v,128
buffer_load_dwordx4 v189, s[12:15], s21 offen offset:1024 lds
v_lshrrev_b32 v66, 3, v1
MA 148,v,164,v,128
ds_read_b128 v[104:107], v192 offset:12288
v_lshlrev_b32 v66, 11, v66
MA 176,v,160,v,132
v_lshrrev_b32 v67, 4, v1
v_and_b32 v68, 7, v1
MA 180,v,164,v,132
v_xor_b32 v68, v68, v67
MA 208,v,160,v,136
buffer_load_dwordx4 v190, s[12:15], s21 offen offset:2048 lds
v_lshl_add_u32 v66, v68, 4, v66
MA 212,v,164,v,136
v_xor_b32 v69, 64, v66
MA 240,v,160,v,140
TR 160,200,32768
TR 162,200,34816
MA 244,v,164,v,140
TR 164,201,32768
TR 166,201,34816
MA 248,v,168,v,140
ds_read_b128 v[108:111], v192 offset:14336
s_lshr_b32 s83, s76, 2
MA 252,v,172,v,140
buffer_load_dwordx4 v191, s[12:15], s21 offen offset:3072 lds
v_add_u32 v208, 0, v66
MA 216,v,168,v,136
v_add_u32 v209, 15360, v69
v_add_u32 v210, -2048, v66
MA 220,v,172,v,136
v_add_u32 v210, s83, v210
v_add_u32 v211, 13312, v69
MA 184,v,168,v,132
v_add_u32 v211, s83, v211
v_and_b32 v68, 15, v1
MA 188,v,172,v,132
s_add_u32 s21, s21, 524288
v_lshlrev_b32 v69, 1, v67
MA 152,v,168,v,128
v_xor_b32 v68, v68, v69
MA 156,v,172,v,128
v_lshlrev_b32 v66, 13, v67
MA 120,v,168,v,124
v_xor_b32 v69, 0, v68
MA 124,v,172,v,124
s_and_b32 s21, s21, 4194303
v_lshl_add_u32 v69, v69, 4, v66
MA 88,v,168,v,120
v_add_u32 v212, 0, v69
MA 92,v,172,v,120
v_xor_b32 v69, 0, v68
MA 56,v,168,v,116
v_lshl_add_u32 v69, v69, 4, v66
MA 60,v,172,v,116
v_add_u32 v213, 31744, v69
MA 24,v,168,v,112
TR 168,202,32768
TR 170,202,34816
MA 28,v,172,v,112
TR 172,203,32768
TR 174,203,34816
s_waitcnt lgkmcnt(4)
MA 0,v,144,v,80
s_add_u32 m0, s22, 65536
buffer_load_dwordx2 v[18:19], v253, s[84:87], 0 offen
MA 4,v,148,v,80
ds_read_b128 v[112:115], v193 offset:0
MA 32,v,144,v,84
MA 36,v,148,v,84
MA 64,v,144,v,88
v_add_u32 v254, 4096, v229
MA 68,v,148,v,88
buffer_load_dwordx4 v176, s[8:11], s20 offen offset:0 lds
MA 96,v,144,v,92
MA 100,v,148,v,92
ds_read_b128 v[116:119], v193 offset:2048
MA 128,v,144,v,96
MA 132,v,148,v,96
buffer_load_dwordx2 v[20:21], v254, s[84:87], 0 offen
MA 160,v,144,v,100
buffer_load_dwordx4 v177, s[8:11], s20 offen offset:1024 lds
MA 164,v,148,v,100
MA 192,v,144,v,104
MA 196,v,148,v,104
ds_read_b128 v[120:123], v193 offset:4096
MA 224,v,144,v,108
TR 144,196,49152
TR 146,196,51200
MA 228,v,148,v,108
TR 148,197,49152
TR 150,197,51200
MA 232,v,152,v,108
buffer_load_dwordx4 v178, s[8:11], s20 offen offset:2048 lds
v_add_u32 v255, 6144, v229
MA 236,v,156,v,108
MA 200,v,152,v,104
MA 204,v,156,v,104
buffer_load_dwordx2 v[22:23], v255, s[84:87], 0 offen
MA 168,v,152,v,100
ds_read_b128 v[124:127], v193 offset:6144
buffer_load_dwordx4 v179, s[8:11], s20 offen offset:3072 lds
MA 172,v,156,v,100
MA 136,v,152,v,96
MA 140,v,156,v,96
buffer_load_dwordx2 v[38:39], v255, s[88:91], 0 offen
MA 104,v,152,v,92
MA 108,v,156,v,92
s_add_u32 m0, s22, 69632
MA 72,v,152,v,88
ds_read_b128 v[128:131], v193 offset:8192
MA 76,v,156,v,88
MA 40,v,152,v,84
v_add_u32 v252, 8192, v229
MA 44,v,156,v,84
MA 8,v,152,v,80
TR 152,198,49152
TR 154,198,51200
MA 12,v,156,v,80
TR 156,199,49152
TR 158,199,51200
MA 16,v,160,v,80
ds_read_b128 v[132:135], v193 offset:10240
buffer_load_dwordx4 v180, s[8:11], s20 offen offset:0 lds
MA 20,v,164,v,80
buffer_load_dwordx2 v[24:25], v252, s[84:87], 0 offen
MA 48,v,160,v,84
MA 52,v,164,v,84
MA 80,v,160,v,88
buffer_load_dwordx4 v181, s[8:11], s20 offen offset:1024 lds
MA 84,v,164,v,88
MA 112,v,160,v,92
buffer_load_dwordx2 v[40:41], v252, s[88:91], 0 offen
MA 116,v,164,v,92
ds_read_b128 v[136:139], v193 offset:12288
MA 144,v,160,v,96
MA 148,v,164,v,96
buffer_load_dwordx4 v182, s[8:11], s20 offen offset:2048 lds
MA 176,v,160,v,100
v_add_u32 v253, 10240, v229
MA 180,v,164,v,100
MA 208,v,160,v,104
MA 212,v,164,v,104
ds_read_b128 v[140:143], v193 offset:14336
MA 240,v,160,v,108
TR 160,200,49152
TR 162,200,51200
MA 244,v,164,v,108
TR 164,201,49152
TR 166,201,51200
s_waitcnt lgkmcnt(15)
MA 248,v,168,v,108
buffer_load_dwordx4 v183, s[8:11], s20 offen offset:3072 lds
buffer_load_dwordx2 v[26:27], v253, s[84:87], 0 offen
MA 252,v,172,v,108
MA 216,v,168,v,104
MA 220,v,172,v,104
s_add_u32 s20, s20, 128
MA 184,v,168,v,100
buffer_load_dwordx2 v[42:43], v253, s[88:91], 0 offen
MA 188,v,172,v,100
MA 152,v,168,v,96
MA 156,v,172,v,96
MA 120,v,168,v,92
s_and_b32 s20, s20, 1023
MA 124,v,172,v,92
v_add_u32 v254, 12288, v229
MA 88,v,168,v,88
MA 92,v,172,v,88
MA 56,v,168,v,84
MA 60,v,172,v,84
MA 24,v,168,v,80
TR 168,202,49152
TR 170,202,51200
MA 28,v,172,v,80
TR 172,203,49152
TR 174,203,51200
s_waitcnt lgkmcnt(4)
MA 0,v,144,v,112
MA 4,v,148,v,112
MA 32,v,144,v,116
MA 36,v,148,v,116
MA 64,v,144,v,120
MA 68,v,148,v,120
MA 96,v,144,v,124
MA 100,v,148,v,124
MA 128,v,144,v,128
MA 132,v,148,v,128
s_waitcnt vmcnt(16) lgkmcnt(0)
s_barrier
MA 160,v,144,v,132
s_add_u32 m0, s23, 32768
v_xor_b32 v69, 8, v68
MA 164,v,148,v,132
ds_read_b128 v[80:83], v192 offset:32768
v_lshl_add_u32 v69, v69, 4, v66
MA 192,v,144,v,136
v_add_u32 v214, 63488, v69
v_xor_b32 v69, 8, v68
MA 196,v,148,v,136
v_lshl_add_u32 v69, v69, 4, v66
MA 224,v,144,v,140
TR 144,196,0
TR 146,196,2048
MA 228,v,148,v,140
TR 148,197,0
TR 150,197,2048
MA 232,v,152,v,140
ds_read_b128 v[84:87], v192 offset:34816
buffer_load_dwordx4 v184, s[12:15], s21 offen offset:0 lds
MA 236,v,156,v,140
v_add_u32 v215, 95232, v69
v_and_b32 v66, 15, v1
MA 200,v,152,v,136
buffer_load_dwordx4 v185, s[12:15], s21 offen offset:1024 lds
v_lshrrev_b32 v68, 1, v66
MA 204,v,156,v,136
v_xor_b32 v68, v68, v67
v_lshlrev_b32 v68, 4, v68
MA 168,v,152,v,132
v_lshl_add_u32 v68, v66, 7, v68
v_add_u32 v224, s67, v68
MA 172,v,156,v,132
ds_read_b128 v[88:91], v192 offset:36864
v_xor_b32 v225, 64, v224
MA 136,v,152,v,128
v_add_u32 v226, 0x10000, v224
v_add_u32 v227, 0x10000, v225
MA 140,v,156,v,128
buffer_load_dwordx4 v186, s[12:15], s21 offen offset:2048 lds
v_bfe_u32 v66, v1, 2, 2
MA 104,v,152,v,124
v_and_b32 v68, 1, v67
v_lshl_or_b32 v68, v68, 2, v66
MA 108,v,156,v,124
v_lshl_add_u32 v66, v67, 3, v66
v_lshlrev_b32 v66, 8, v66
MA 72,v,152,v,120
ds_read_b128 v[92:95], v192 offset:38912
v_and_b32 v69, 3, v1
MA 76,v,156,v,120
buffer_load_dwordx4 v187, s[12:15], s21 offen offset:3072 lds
v_lshl_add_u32 v66, v69, 3, v66
MA 40,v,152,v,116
v_add_u32 v66, 98304, v66
MA 44,v,156,v,116
v_xor_b32 v69, 0, v68
MA 8,v,152,v,112
TR 152,198,0
TR 154,198,2048
MA 12,v,156,v,112
TR 156,199,0
TR 158,199,2048
MA 16,v,160,v,112
ds_read_b128 v[96:99], v192 offset:40960
s_add_u32 m0, s23, 36864
MA 20,v,164,v,112
v_lshl_add_u32 v216, v69, 5, v66
v_xor_b32 v69, 1, v68
MA 48,v,160,v,116
v_lshl_add_u32 v217, v69, 5, v66
v_xor_b32 v69, 2, v68
MA 52,v,164,v,116
v_lshl_add_u32 v218, v69, 5, v66
v_xor_b32 v69, 3, v68
MA 80,v,160,v,120
ds_read_b128 v[100:103], v192 offset:43008
buffer_load_dwordx4 v188, s[12:15], s21 offen offset:0 lds
MA 84,v,164,v,120
v_lshl_add_u32 v219, v69, 5, v66
v_xor_b32 v69, 4, v68
MA 112,v,160,v,124
v_lshl_add_u32 v220, v69, 5, v66
v_xor_b32 v69, 5, v68
MA 116,v,164,v,124
v_lshl_add_u32 v221, v69, 5, v66
v_xor_b32 v69, 6, v68
MA 144,v,160,v,128
buffer_load_dwordx4 v189, s[12:15], s21 offen offset:1024 lds
v_lshl_add_u32 v222, v69, 5, v66
MA 148,v,164,v,128
ds_read_b128 v[104:107], v192 offset:45056
v_xor_b32 v69, 7, v68
MA 176,v,160,v,132
v_lshl_add_u32 v223, v69, 5, v66
s_mov_b32 s44, s32
MA 180,v,164,v,132
s_mov_b32 s45, s33
MA 208,v,160,v,136
buffer_load_dwordx4 v190, s[12:15], s21 offen offset:2048 lds
s_mov_b32 s46, 4194304
MA 212,v,164,v,136
s_mov_b32 s47, 0x20000
MA 240,v,160,v,140
TR 160,200,0
TR 162,200,2048
MA 244,v,164,v,140
TR 164,201,0
TR 166,201,2048
MA 248,v,168,v,140
ds_read_b128 v[108:111], v192 offset:47104
MA 252,v,172,v,140
buffer_load_dwordx4 v191, s[12:15], s21 offen offset:3072 lds
MA 216,v,168,v,136
s_add_u32 s48, s34, s82
s_addc_u32 s49, s35, 0
MA 220,v,172,v,136
s_sub_u32 s50, 8388608, s82
s_mov_b32 s51, 0x20000
MA 184,v,168,v,132
s_add_u32 s60, s40, 33554432
s_addc_u32 s61, s41, 0
MA 188,v,172,v,132
s_add_u32 s21, s21, 524288
s_mov_b32 s62, 16777216
MA 152,v,168,v,128
s_mov_b32 s63, 0x20000
s_lshl_b32 s80, s69, 19
MA 156,v,172,v,128
s_add_u32 s52, s40, s80
s_addc_u32 s53, s41, 0
MA 120,v,168,v,124
s_lshl_b32 s54, s77, 14
s_mov_b32 s55, 0x20000
MA 124,v,172,v,124
s_and_b32 s21, s21, 4194303
s_add_u32 s80, s80, 16760832
MA 88,v,168,v,120
s_add_u32 s56, s40, s80
s_addc_u32 s57, s41, 0
MA 92,v,172,v,120
s_add_u32 s58, s54, 16384
MA 56,v,168,v,116
s_mov_b32 s59, 0x20000
MA 60,v,172,v,116
s_load_dwordx2 s[38:39], s[0:1], 112
MA 24,v,168,v,112
TR 168,202,0
TR 170,202,2048
MA 28,v,172,v,112
TR 172,203,0
TR 174,203,2048
s_waitcnt lgkmcnt(4)
MA 0,v,144,v,80
s_add_u32 m0, s22, 0
buffer_load_dwordx2 v[28:29], v254, s[84:87], 0 offen
MA 4,v,148,v,80
ds_read_b128 v[112:115], v193 offset:32768
MA 32,v,144,v,84
MA 36,v,148,v,84
MA 64,v,144,v,88
buffer_load_dwordx2 v[44:45], v254, s[88:91], 0 offen
MA 68,v,148,v,88
buffer_load_dwordx4 v176, s[8:11], s20 offen offset:0 lds
MA 96,v,144,v,92
MA 100,v,148,v,92
ds_read_b128 v[116:119], v193 offset:34816
MA 128,v,144,v,96
v_add_u32 v255, 14336, v229
MA 132,v,148,v,96
MA 160,v,144,v,100
buffer_load_dwordx4 v177, s[8:11], s20 offen offset:1024 lds
MA 164,v,148,v,100
MA 192,v,144,v,104
MA 196,v,148,v,104
ds_read_b128 v[120:123], v193 offset:36864
buffer_load_dwordx2 v[30:31], v255, s[84:87], 0 offen
MA 224,v,144,v,108
TR 144,196,16384
TR 146,196,18432
MA 228,v,148,v,108
TR 148,197,16384
TR 150,197,18432
MA 232,v,152,v,108
buffer_load_dwordx4 v178, s[8:11], s20 offen offset:2048 lds
MA 236,v,156,v,108
buffer_load_dwordx2 v[46:47], v255, s[88:91], 0 offen
MA 200,v,152,v,104
MA 204,v,156,v,104
MA 168,v,152,v,100
ds_read_b128 v[124:127], v193 offset:38912
buffer_load_dwordx4 v179, s[8:11], s20 offen offset:3072 lds
MA 172,v,156,v,100
MA 136,v,152,v,96
v_add_u32 v252, 16384, v229
MA 140,v,156,v,96
MA 104,v,152,v,92
MA 108,v,156,v,92
s_add_u32 m0, s22, 4096
MA 72,v,152,v,88
ds_read_b128 v[128:131], v193 offset:40960
buffer_load_dwordx2 v[32:33], v252, s[84:87], 0 offen
MA 76,v,156,v,88
MA 40,v,152,v,84
MA 44,v,156,v,84
MA 8,v,152,v,80
TR 152,198,16384
TR 154,198,18432
MA 12,v,156,v,80
TR 156,199,16384
TR 158,199,18432
MA 16,v,160,v,80
ds_read_b128 v[132:135], v193 offset:43008
buffer_load_dwordx4 v180, s[8:11], s20 offen offset:0 lds
MA 20,v,164,v,80
buffer_load_dwordx2 v[48:49], v252, s[88:91], 0 offen
MA 48,v,160,v,84
MA 52,v,164,v,84
v_add_u32 v253, 18432, v229
MA 80,v,160,v,88
buffer_load_dwordx4 v181, s[8:11], s20 offen offset:1024 lds
MA 84,v,164,v,88
MA 112,v,160,v,92
MA 116,v,164,v,92
ds_read_b128 v[136:139], v193 offset:45056
buffer_load_dwordx2 v[34:35], v253, s[84:87], 0 offen
MA 144,v,160,v,96
MA 148,v,164,v,96
buffer_load_dwordx4 v182, s[8:11], s20 offen offset:2048 lds
MA 176,v,160,v,100
MA 180,v,164,v,100
MA 208,v,160,v,104
buffer_load_dwordx2 v[50:51], v253, s[88:91], 0 offen
MA 212,v,164,v,104
ds_read_b128 v[140:143], v193 offset:47104
MA 240,v,160,v,108
TR 160,200,16384
TR 162,200,18432
MA 244,v,164,v,108
TR 164,201,16384
TR 166,201,18432
s_waitcnt lgkmcnt(15)
MA 248,v,168,v,108
buffer_load_dwordx4 v183, s[8:11], s20 offen offset:3072 lds
v_add_u32 v254, 20480, v229
MA 252,v,172,v,108
MA 216,v,168,v,104
MA 220,v,172,v,104
s_add_u32 s20, s20, 128
MA 184,v,168,v,100
MA 188,v,172,v,100
buffer_load_dwordx2 v[36:37], v254, s[84:87], 0 offen
MA 152,v,168,v,96
MA 156,v,172,v,96
MA 120,v,168,v,92
s_and_b32 s20, s20, 1023
MA 124,v,172,v,92
buffer_load_dwordx2 v[52:53], v254, s[88:91], 0 offen
MA 88,v,168,v,88
MA 92,v,172,v,88
MA 56,v,168,v,84
MA 60,v,172,v,84
MA 24,v,168,v,80
TR 168,202,16384
TR 170,202,18432
MA 28,v,172,v,80
TR 172,203,16384
TR 174,203,18432
s_waitcnt lgkmcnt(4)
MA 0,v,144,v,112
MA 4,v,148,v,112
MA 32,v,144,v,116
MA 36,v,148,v,116
MA 64,v,144,v,120
MA 68,v,148,v,120
MA 96,v,144,v,124
MA 100,v,148,v,124
MA 128,v,144,v,128
MA 132,v,148,v,128
s_waitcnt vmcnt(18) lgkmcnt(0)
s_barrier
MA 160,v,144,v,132
s_add_u32 m0, s23, 0
s_and_b32 s37, s3, 3
MA 164,v,148,v,132
ds_read_b128 v[80:83], v194 offset:0
MA 192,v,144,v,136
s_cmp_eq_u32 s37, 0
s_cselect_b32 s37, 0, 0x40000000
MA 196,v,148,v,136
MA 224,v,144,v,140
TR 144,196,32768
TR 146,196,34816
MA 228,v,148,v,140
TR 148,197,32768
TR 150,197,34816
MA 232,v,152,v,140
ds_read_b128 v[84:87], v194 offset:2048
buffer_load_dwordx4 v184, s[12:15], s21 offen offset:0 lds
MA 236,v,156,v,140
v_add_u32 v229, s37, v78
MA 200,v,152,v,136
buffer_load_dwordx4 v185, s[12:15], s21 offen offset:1024 lds
MA 204,v,156,v,136
buffer_load_dword v79, v229, s[4:7], 0 offen
MA 168,v,152,v,132
MA 172,v,156,v,132
ds_read_b128 v[88:91], v194 offset:4096
s_getpc_b64 s[82:83]
L_ct_fK:
MA 136,v,152,v,128
MA 140,v,156,v,128
buffer_load_dwordx4 v186, s[12:15], s21 offen offset:2048 lds
MA 104,v,152,v,124
s_add_u32 s82, s82, L_p2 - L_ct_fK
s_addc_u32 s83, s83, 0
MA 108,v,156,v,124
MA 72,v,152,v,120
ds_read_b128 v[92:95], v194 offset:6144
MA 76,v,156,v,120
buffer_load_dwordx4 v187, s[12:15], s21 offen offset:3072 lds
MA 40,v,152,v,116
v_mov_b32 v67, s83
MA 44,v,156,v,116
MA 8,v,152,v,112
TR 152,198,32768
TR 154,198,34816
MA 12,v,156,v,112
TR 156,199,32768
TR 158,199,34816
MA 16,v,160,v,112
ds_read_b128 v[96:99], v194 offset:8192
s_add_u32 m0, s23, 4096
MA 20,v,164,v,112
v_mov_b32 v66, s82
s_lshr_b32 s82, s2, 3
MA 48,v,160,v,116
s_lshl_b32 s82, s82, 2
MA 52,v,164,v,116
MA 80,v,160,v,120
ds_read_b128 v[100:103], v194 offset:10240
buffer_load_dwordx4 v188, s[12:15], s21 offen offset:0 lds
MA 84,v,164,v,120
s_add_u32 s82, s82, s3
MA 112,v,160,v,124
MA 116,v,164,v,124
s_lshl_b32 s82, s82, 7
MA 144,v,160,v,128
buffer_load_dwordx4 v189, s[12:15], s21 offen offset:1024 lds
MA 148,v,164,v,128
ds_read_b128 v[104:107], v194 offset:12288
v_and_b32 v68, 3, v1
MA 176,v,160,v,132
MA 180,v,164,v,132
v_lshlrev_b32 v68, 14, v68
MA 208,v,160,v,136
buffer_load_dwordx4 v190, s[12:15], s21 offen offset:2048 lds
MA 212,v,164,v,136
MA 240,v,160,v,140
TR 160,200,32768
TR 162,200,34816
MA 244,v,164,v,140
TR 164,201,32768
TR 166,201,34816
MA 248,v,168,v,140
ds_read_b128 v[108:111], v194 offset:14336
v_add_u32 v68, s82, v68
MA 252,v,172,v,140
buffer_load_dwordx4 v191, s[12:15], s21 offen offset:3072 lds
v_min_u32 v68, L_p3_begin - L_p2 - 4, v68
MA 216,v,168,v,136
v_add_co_u32 v66, vcc, v66, v68
s_nop 1
v_addc_co_u32 v67, vcc, 0, v67, vcc
MA 220,v,172,v,136
MA 184,v,168,v,132
MA 188,v,172,v,132
s_add_u32 s21, s21, 524288
MA 152,v,168,v,128
MA 156,v,172,v,128
MA 120,v,168,v,124
MA 124,v,172,v,124
s_and_b32 s21, s21, 4194303
MA 88,v,168,v,120
MA 92,v,172,v,120
global_load_dword v68, v[66:67], off
MA 56,v,168,v,116
MA 60,v,172,v,116
MA 24,v,168,v,112
TR 168,202,32768
TR 170,202,34816
MA 28,v,172,v,112
TR 172,203,32768
TR 174,203,34816
s_waitcnt lgkmcnt(4)
MA 0,v,144,v,80
s_add_u32 m0, s22, 32768
s_and_b32 s37, s3, 3
MA 4,v,148,v,80
ds_read_b128 v[112:115], v195 offset:0
MA 32,v,144,v,84
MA 36,v,148,v,84
MA 64,v,144,v,88
MA 68,v,148,v,88
buffer_load_dwordx4 v176, s[8:11], s20 offen offset:0 lds
MA 96,v,144,v,92
MA 100,v,148,v,92
ds_read_b128 v[116:119], v195 offset:2048
MA 128,v,144,v,96
MA 132,v,148,v,96
MA 160,v,144,v,100
buffer_load_dwordx4 v177, s[8:11], s20 offen offset:1024 lds
MA 164,v,148,v,100
MA 192,v,144,v,104
s_cmp_eq_u32 s37, 1
s_cselect_b32 s37, 0, 0x40000000
MA 196,v,148,v,104
ds_read_b128 v[120:123], v195 offset:4096
MA 224,v,144,v,108
TR 144,196,49152
TR 146,196,51200
MA 228,v,148,v,108
TR 148,197,49152
TR 150,197,51200
MA 232,v,152,v,108
buffer_load_dwordx4 v178, s[8:11], s20 offen offset:2048 lds
MA 236,v,156,v,108
MA 200,v,152,v,104
MA 204,v,156,v,104
MA 168,v,152,v,100
ds_read_b128 v[124:127], v195 offset:6144
buffer_load_dwordx4 v179, s[8:11], s20 offen offset:3072 lds
MA 172,v,156,v,100
MA 136,v,152,v,96
MA 140,v,156,v,96
MA 104,v,152,v,92
MA 108,v,156,v,92
s_add_u32 m0, s22, 36864
MA 72,v,152,v,88
ds_read_b128 v[128:131], v195 offset:8192
MA 76,v,156,v,88
MA 40,v,152,v,84
MA 44,v,156,v,84
MA 8,v,152,v,80
TR 152,198,49152
TR 154,198,51200
MA 12,v,156,v,80
TR 156,199,49152
TR 158,199,51200
MA 16,v,160,v,80
ds_read_b128 v[132:135], v195 offset:10240
buffer_load_dwordx4 v180, s[8:11], s20 offen offset:0 lds
MA 20,v,164,v,80
MA 48,v,160,v,84
MA 52,v,164,v,84
MA 80,v,160,v,88
buffer_load_dwordx4 v181, s[8:11], s20 offen offset:1024 lds
MA 84,v,164,v,88
v_add_u32 v229, s37, v78
MA 112,v,160,v,92
MA 116,v,164,v,92
ds_read_b128 v[136:139], v195 offset:12288
MA 144,v,160,v,96
MA 148,v,164,v,96
buffer_load_dwordx4 v182, s[8:11], s20 offen offset:2048 lds
MA 176,v,160,v,100
MA 180,v,164,v,100
MA 208,v,160,v,104
MA 212,v,164,v,104
ds_read_b128 v[140:143], v195 offset:14336
MA 240,v,160,v,108
TR 160,200,49152
TR 162,200,51200
MA 244,v,164,v,108
TR 164,201,49152
TR 166,201,51200
s_waitcnt lgkmcnt(15)
MA 248,v,168,v,108
buffer_load_dwordx4 v183, s[8:11], s20 offen offset:3072 lds
MA 252,v,172,v,108
buffer_load_dword v79, v229, s[4:7], 0 offen
MA 216,v,168,v,104
MA 220,v,172,v,104
s_add_u32 s20, s20, 128
MA 184,v,168,v,100
MA 188,v,172,v,100
MA 152,v,168,v,96
MA 156,v,172,v,96
MA 120,v,168,v,92
s_and_b32 s20, s20, 1023
MA 124,v,172,v,92
MA 88,v,168,v,88
MA 92,v,172,v,88
MA 56,v,168,v,84
MA 60,v,172,v,84
MA 24,v,168,v,80
TR 168,202,49152
TR 170,202,51200
MA 28,v,172,v,80
TR 172,203,49152
TR 174,203,51200
s_waitcnt lgkmcnt(4)
MA 0,v,144,v,112
MA 4,v,148,v,112
MA 32,v,144,v,116
MA 36,v,148,v,116
MA 64,v,144,v,120
MA 68,v,148,v,120
MA 96,v,144,v,124
MA 100,v,148,v,124
MA 128,v,144,v,128
MA 132,v,148,v,128
s_waitcnt vmcnt(10) lgkmcnt(0)
s_barrier
MA 160,v,144,v,132
s_add_u32 m0, s23, 32768
s_and_b32 s37, s3, 3
MA 164,v,148,v,132
ds_read_b128 v[80:83], v192 offset:0
MA 192,v,144,v,136
s_cmp_eq_u32 s37, 2
s_cselect_b32 s37, 0, 0x40000000
MA 196,v,148,v,136
v_add_u32 v229, s37, v78
buffer_load_dword v79, v229, s[4:7], 0 offen
MA 224,v,144,v,140
TR 144,196,0
TR 146,196,2048
MA 228,v,148,v,140
TR 148,197,0
TR 150,197,2048
MA 232,v,152,v,140
ds_read_b128 v[84:87], v192 offset:2048
buffer_load_dwordx4 v184, s[12:15], s21 offen offset:0 lds
MA 236,v,156,v,140
s_add_u32 s84, s40, 50331648
s_addc_u32 s85, s41, 0
MA 200,v,152,v,136
buffer_load_dwordx4 v185, s[12:15], s21 offen offset:1024 lds
s_mov_b32 s86, 4194304
MA 204,v,156,v,136
s_mov_b32 s87, 0x20000
MA 168,v,152,v,132
s_add_u32 s88, s40, 58720256
s_addc_u32 s89, s41, 0
MA 172,v,156,v,132
ds_read_b128 v[88:91], v192 offset:4096
s_mov_b32 s90, 8192
MA 136,v,152,v,128
s_mov_b32 s91, 0x20000
v_mov_b32 v252, 0
MA 140,v,156,v,128
buffer_load_dwordx4 v186, s[12:15], s21 offen offset:2048 lds
v_mov_b32 v253, 0
MA 104,v,152,v,124
v_dot2_f32_bf16 v252, v230, v2, v252
v_dot2_f32_bf16 v253, v231, v3, v253
MA 108,v,156,v,124
v_dot2_f32_bf16 v252, v232, v4, v252
v_dot2_f32_bf16 v253, v233, v5, v253
MA 72,v,152,v,120
ds_read_b128 v[92:95], v192 offset:6144
v_dot2_f32_bf16 v252, v234, v6, v252
MA 76,v,156,v,120
buffer_load_dwordx4 v187, s[12:15], s21 offen offset:3072 lds
v_dot2_f32_bf16 v253, v235, v7, v253
MA 40,v,152,v,116
v_dot2_f32_bf16 v252, v236, v8, v252
v_dot2_f32_bf16 v253, v237, v9, v253
MA 44,v,156,v,116
v_dot2_f32_bf16 v252, v238, v12, v252
v_dot2_f32_bf16 v253, v239, v13, v253
MA 8,v,152,v,112
TR 152,198,0
TR 154,198,2048
MA 12,v,156,v,112
TR 156,199,0
TR 158,199,2048
MA 16,v,160,v,112
ds_read_b128 v[96:99], v192 offset:8192
s_add_u32 m0, s23, 36864
MA 20,v,164,v,112
v_dot2_f32_bf16 v252, v240, v14, v252
v_dot2_f32_bf16 v253, v241, v15, v253
MA 48,v,160,v,116
v_dot2_f32_bf16 v252, v242, v246, v252
v_dot2_f32_bf16 v253, v243, v247, v253
MA 52,v,164,v,116
v_dot2_f32_bf16 v252, v244, v248, v252
v_dot2_f32_bf16 v253, v245, v249, v253
MA 80,v,160,v,120
ds_read_b128 v[100:103], v192 offset:10240
buffer_load_dwordx4 v188, s[12:15], s21 offen offset:0 lds
MA 84,v,164,v,120
s_nop 2
v_add_f32 v252, v252, v253
MA 112,v,160,v,124
s_nop 0
v_add_f32_dpp v252, v252, v252 row_ror:8 row_mask:0xf bank_mask:0xf
s_nop 1
v_add_f32_dpp v252, v252, v252 row_ror:4 row_mask:0xf bank_mask:0xf
MA 116,v,164,v,124
s_nop 0
v_add_f32_dpp v252, v252, v252 row_ror:2 row_mask:0xf bank_mask:0xf
s_nop 1
v_add_f32_dpp v252, v252, v252 row_ror:1 row_mask:0xf bank_mask:0xf
MA 144,v,160,v,128
buffer_load_dwordx4 v189, s[12:15], s21 offen offset:1024 lds
v_mov_b32 v253, v252
MA 148,v,164,v,128
ds_read_b128 v[104:107], v192 offset:12288
v_permlane16_swap_b32 v252, v253
MA 176,v,160,v,132
v_add_f32 v252, v252, v253
v_mul_f32 v252, 0xbfb8aa3b, v252
MA 180,v,164,v,132
v_exp_f32 v252, v252
MA 208,v,160,v,136
buffer_load_dwordx4 v190, s[12:15], s21 offen offset:2048 lds
v_add_f32 v252, 1.0, v252
MA 212,v,164,v,136
v_rcp_f32 v252, v252
MA 240,v,160,v,140
TR 160,200,0
TR 162,200,2048
MA 244,v,164,v,140
TR 164,201,0
TR 166,201,2048
MA 248,v,168,v,140
ds_read_b128 v[108:111], v192 offset:14336
MA 252,v,172,v,140
buffer_load_dwordx4 v191, s[12:15], s21 offen offset:3072 lds
MA 216,v,168,v,136
s_nop 0
buffer_store_dword v252, v11, s[88:91], 0 offen sc1
MA 220,v,172,v,136
v_lshlrev_b32 v2, 16, v54
v_and_b32 v3, 0xffff0000, v54
MA 184,v,168,v,132
v_lshlrev_b32 v4, 16, v55
v_and_b32 v5, 0xffff0000, v55
MA 188,v,172,v,132
s_add_u32 s21, s21, 524288
v_lshlrev_b32 v6, 16, v56
MA 152,v,168,v,128
v_and_b32 v7, 0xffff0000, v56
v_lshlrev_b32 v8, 16, v57
MA 156,v,172,v,128
v_and_b32 v9, 0xffff0000, v57
v_lshlrev_b32 v230, 16, v16
MA 120,v,168,v,124
v_and_b32 v231, 0xffff0000, v16
v_lshlrev_b32 v232, 16, v18
MA 124,v,172,v,124
s_and_b32 s21, s21, 4194303
v_and_b32 v233, 0xffff0000, v18
MA 88,v,168,v,120
v_lshlrev_b32 v234, 16, v20
v_and_b32 v235, 0xffff0000, v20
MA 92,v,172,v,120
v_lshlrev_b32 v236, 16, v22
v_and_b32 v237, 0xffff0000, v22
MA 56,v,168,v,116
v_lshlrev_b32 v238, 16, v24
v_and_b32 v239, 0xffff0000, v24
MA 60,v,172,v,116
v_lshlrev_b32 v240, 16, v26
v_and_b32 v241, 0xffff0000, v26
MA 24,v,168,v,112
TR 168,202,0
TR 170,202,2048
MA 28,v,172,v,112
TR 172,203,0
TR 174,203,2048
v_lshlrev_b32 v242, 16, v28
v_and_b32 v243, 0xffff0000, v28
v_lshlrev_b32 v244, 16, v30
v_and_b32 v245, 0xffff0000, v30
v_lshlrev_b32 v246, 16, v32
v_and_b32 v247, 0xffff0000, v32
v_lshlrev_b32 v248, 16, v34
v_and_b32 v249, 0xffff0000, v34
v_lshlrev_b32 v250, 16, v36
v_and_b32 v251, 0xffff0000, v36
v_lshlrev_b32 v254, 16, v38
v_and_b32 v255, 0xffff0000, v38
v_mul_f32 v62, v236, v2
v_mul_f32 v70, v237, v6
v_fmac_f32 v62, v234, v3
v_fmac_f32 v70, v235, v7
v_fmac_f32 v62, v232, v4
v_fmac_f32 v70, v233, v8
v_fmac_f32 v62, v230, v5
v_fmac_f32 v70, v231, v9
v_mul_f32 v62, v62, v254
s_waitcnt lgkmcnt(4)
MA 0,v,144,v,80
s_add_u32 s75, s64, s74
s_and_b32 s37, s3, 3
MA 4,v,148,v,80
ds_read_b128 v[112:115], v193 offset:0
MA 32,v,144,v,84
s_cmp_eq_u32 s37, 3
s_cselect_b32 s37, 0, 0x40000000
MA 36,v,148,v,84
v_add_u32 v229, s37, v78
buffer_load_dword v79, v229, s[4:7], 0 offen
MA 64,v,144,v,88
s_add_u32 m0, s67, 65536
v_mul_f32 v70, v70, v255
MA 68,v,148,v,88
v_lshlrev_b32 v254, 16, v40
v_and_b32 v255, 0xffff0000, v40
MA 96,v,144,v,92
v_mul_f32 v63, v238, v2
v_mul_f32 v71, v239, v6
MA 100,v,148,v,92
ds_read_b128 v[116:119], v193 offset:2048
v_fmac_f32 v63, v236, v3
MA 128,v,144,v,96
buffer_load_dwordx4 v208, s[44:47], s75 offen offset:0 lds
v_fmac_f32 v71, v237, v7
MA 132,v,148,v,96
v_fmac_f32 v63, v234, v4
v_fmac_f32 v71, v235, v8
MA 160,v,144,v,100
v_fmac_f32 v63, v232, v5
MA 164,v,148,v,100
v_fmac_f32 v71, v233, v9
v_mul_f32 v63, v63, v254
MA 192,v,144,v,104
v_mul_f32 v71, v71, v255
MA 196,v,148,v,104
ds_read_b128 v[120:123], v193 offset:4096
buffer_load_dwordx4 v209, s[44:47], s75 offen offset:1024 lds
MA 224,v,144,v,108
TR 144,196,16384
TR 146,196,18432
MA 228,v,148,v,108
TR 148,197,16384
TR 150,197,18432
MA 232,v,152,v,108
v_lshlrev_b32 v254, 16, v42
v_and_b32 v255, 0xffff0000, v42
MA 236,v,156,v,108
buffer_load_dwordx4 v210, s[44:47], s75 offen offset:2048 lds
v_mul_f32 v64, v240, v2
MA 200,v,152,v,104
v_mul_f32 v72, v241, v6
v_fmac_f32 v64, v238, v3
MA 204,v,156,v,104
v_fmac_f32 v72, v239, v7
v_fmac_f32 v64, v236, v4
MA 168,v,152,v,100
ds_read_b128 v[124:127], v193 offset:6144
v_fmac_f32 v72, v237, v8
MA 172,v,156,v,100
v_fmac_f32 v64, v234, v5
v_fmac_f32 v72, v235, v9
MA 136,v,152,v,96
buffer_load_dwordx4 v211, s[44:47], s75 offen offset:3072 lds
v_mul_f32 v64, v64, v254
MA 140,v,156,v,96
v_mul_f32 v72, v72, v255
v_lshlrev_b32 v254, 16, v44
MA 104,v,152,v,92
v_and_b32 v255, 0xffff0000, v44
v_mul_f32 v65, v242, v2
MA 108,v,156,v,92
v_mul_f32 v73, v243, v6
v_fmac_f32 v65, v240, v3
MA 72,v,152,v,88
ds_read_b128 v[128:131], v193 offset:8192
s_add_u32 s75, s65, s74
MA 76,v,156,v,88
v_fmac_f32 v73, v241, v7
v_fmac_f32 v65, v238, v4
MA 40,v,152,v,84
v_fmac_f32 v73, v239, v8
v_fmac_f32 v65, v236, v5
MA 44,v,156,v,84
v_fmac_f32 v73, v237, v9
v_mul_f32 v65, v65, v254
MA 8,v,152,v,80
TR 152,198,16384
TR 154,198,18432
MA 12,v,156,v,80
TR 156,199,16384
TR 158,199,18432
MA 16,v,160,v,80
ds_read_b128 v[132:135], v193 offset:10240
s_add_u32 m0, s67, 69632
MA 20,v,164,v,80
v_mul_f32 v73, v73, v255
v_lshlrev_b32 v254, 16, v46
MA 48,v,160,v,84
v_and_b32 v255, 0xffff0000, v46
v_mul_f32 v66, v244, v2
MA 52,v,164,v,84
buffer_load_dwordx4 v208, s[44:47], s75 offen offset:0 lds
v_mul_f32 v74, v245, v6
MA 80,v,160,v,88
v_fmac_f32 v66, v242, v3
v_fmac_f32 v74, v243, v7
MA 84,v,164,v,88
v_fmac_f32 v66, v240, v4
v_fmac_f32 v74, v241, v8
MA 112,v,160,v,92
v_fmac_f32 v66, v238, v5
v_fmac_f32 v74, v239, v9
MA 116,v,164,v,92
ds_read_b128 v[136:139], v193 offset:12288
buffer_load_dwordx4 v209, s[44:47], s75 offen offset:1024 lds
MA 144,v,160,v,96
v_mul_f32 v66, v66, v254
v_mul_f32 v74, v74, v255
MA 148,v,164,v,96
v_lshlrev_b32 v254, 16, v48
v_and_b32 v255, 0xffff0000, v48
MA 176,v,160,v,100
v_mul_f32 v67, v246, v2
v_mul_f32 v75, v247, v6
MA 180,v,164,v,100
v_fmac_f32 v67, v244, v3
MA 208,v,160,v,104
buffer_load_dwordx4 v210, s[44:47], s75 offen offset:2048 lds
v_fmac_f32 v75, v245, v7
MA 212,v,164,v,104
ds_read_b128 v[140:143], v193 offset:14336
v_fmac_f32 v67, v242, v4
MA 240,v,160,v,108
TR 160,200,16384
TR 162,200,18432
MA 244,v,164,v,108
TR 164,201,16384
TR 166,201,18432
s_waitcnt lgkmcnt(15)
MA 248,v,168,v,108
buffer_load_dwordx4 v211, s[44:47], s75 offen offset:3072 lds
v_fmac_f32 v75, v243, v8
MA 252,v,172,v,108
v_fmac_f32 v67, v240, v5
v_fmac_f32 v75, v241, v9
MA 216,v,168,v,104
v_mul_f32 v67, v67, v254
v_mul_f32 v75, v75, v255
MA 220,v,172,v,104
v_lshlrev_b32 v254, 16, v50
v_and_b32 v255, 0xffff0000, v50
MA 184,v,168,v,100
s_waitcnt vmcnt(28)
v_mul_f32 v68, v248, v2
v_mul_f32 v76, v249, v6
MA 188,v,172,v,100
s_add_u32 s74, s74, 128
v_fmac_f32 v68, v246, v3
MA 152,v,168,v,96
v_fmac_f32 v76, v247, v7
v_fmac_f32 v68, v244, v4
MA 156,v,172,v,96
v_fmac_f32 v76, v245, v8
v_fmac_f32 v68, v242, v5
MA 120,v,168,v,92
v_fmac_f32 v76, v243, v9
v_mul_f32 v68, v68, v254
MA 124,v,172,v,92
s_and_b32 s74, s74, 2047
v_mul_f32 v76, v76, v255
MA 88,v,168,v,88
v_lshlrev_b32 v254, 16, v52
MA 92,v,172,v,88
v_and_b32 v255, 0xffff0000, v52
v_mul_f32 v69, v250, v2
MA 56,v,168,v,84
v_mul_f32 v77, v251, v6
MA 60,v,172,v,84
v_fmac_f32 v69, v248, v3
MA 24,v,168,v,80
TR 168,202,16384
TR 170,202,18432
MA 28,v,172,v,80
TR 172,203,16384
TR 174,203,18432
s_waitcnt lgkmcnt(4)
MA 0,v,144,v,112
MA 4,v,148,v,112
MA 32,v,144,v,116
MA 36,v,148,v,116
MA 64,v,144,v,120
MA 68,v,148,v,120
MA 96,v,144,v,124
MA 100,v,148,v,124
MA 128,v,144,v,128
MA 132,v,148,v,128
s_waitcnt vmcnt(10) lgkmcnt(0)
s_barrier
MA 160,v,144,v,132
s_add_u32 m0, s68, 98304
v_fmac_f32 v77, v249, v7
MA 164,v,148,v,132
ds_read_b128 v[80:83], v192 offset:32768
v_fmac_f32 v69, v246, v4
MA 192,v,144,v,136
v_fmac_f32 v77, v247, v8
v_fmac_f32 v69, v244, v5
MA 196,v,148,v,136
buffer_load_dwordx4 v212, s[48:51], s66 offen offset:0 lds
v_fmac_f32 v77, v245, v9
MA 224,v,144,v,140
TR 144,196,32768
TR 146,196,34816
MA 228,v,148,v,140
TR 148,197,32768
TR 150,197,34816
MA 232,v,152,v,140
ds_read_b128 v[84:87], v192 offset:34816
v_mul_f32 v69, v69, v254
MA 236,v,156,v,140
buffer_load_dwordx4 v213, s[48:51], s66 offen offset:1024 lds
v_mul_f32 v77, v77, v255
MA 200,v,152,v,136
v_cvt_pk_bf16_f32 v12, v69, v68
v_cvt_pk_bf16_f32 v13, v67, v66
MA 204,v,156,v,136
v_cvt_pk_bf16_f32 v14, v65, v64
v_cvt_pk_bf16_f32 v15, v63, v62
MA 168,v,152,v,132
s_mov_b32 s36, 0
buffer_store_dwordx4 v[12:15], v10, s[84:87], s36 offen sc1
MA 172,v,156,v,132
ds_read_b128 v[88:91], v192 offset:36864
buffer_load_dwordx4 v214, s[48:51], s66 offen offset:2048 lds
MA 136,v,152,v,128
v_cvt_pk_bf16_f32 v54, v77, v76
v_cvt_pk_bf16_f32 v55, v75, v74
MA 140,v,156,v,128
v_cvt_pk_bf16_f32 v56, v73, v72
v_cvt_pk_bf16_f32 v57, v71, v70
MA 104,v,152,v,124
buffer_load_dwordx4 v215, s[48:51], s66 offen offset:3072 lds
s_mov_b32 s36, 4096
MA 108,v,156,v,124
buffer_store_dwordx4 v[54:57], v10, s[84:87], s36 offen sc1
v_lshlrev_b32 v2, 16, v58
MA 72,v,152,v,120
ds_read_b128 v[92:95], v192 offset:38912
v_and_b32 v3, 0xffff0000, v58
MA 76,v,156,v,120
v_lshlrev_b32 v4, 16, v59
v_and_b32 v5, 0xffff0000, v59
MA 40,v,152,v,116
s_add_u32 s66, s66, 524288
v_lshlrev_b32 v6, 16, v60
MA 44,v,156,v,116
v_and_b32 v7, 0xffff0000, v60
v_lshlrev_b32 v8, 16, v61
MA 8,v,152,v,112
TR 152,198,32768
TR 154,198,34816
MA 12,v,156,v,112
TR 156,199,32768
TR 158,199,34816
MA 16,v,160,v,112
ds_read_b128 v[96:99], v192 offset:40960
s_and_b32 s66, s66, 8388607
MA 20,v,164,v,112
v_and_b32 v9, 0xffff0000, v61
v_lshlrev_b32 v230, 16, v17
MA 48,v,160,v,116
v_and_b32 v231, 0xffff0000, v17
v_lshlrev_b32 v232, 16, v19
MA 52,v,164,v,116
v_and_b32 v233, 0xffff0000, v19
v_lshlrev_b32 v234, 16, v21
MA 80,v,160,v,120
ds_read_b128 v[100:103], v192 offset:43008
s_add_u32 m0, s68, 114688
MA 84,v,164,v,120
v_and_b32 v235, 0xffff0000, v21
v_lshlrev_b32 v236, 16, v23
MA 112,v,160,v,124
v_and_b32 v237, 0xffff0000, v23
v_lshlrev_b32 v238, 16, v25
MA 116,v,164,v,124
buffer_load_dwordx4 v212, s[48:51], s66 offen offset:0 lds
v_and_b32 v239, 0xffff0000, v25
MA 144,v,160,v,128
v_lshlrev_b32 v240, 16, v27
v_and_b32 v241, 0xffff0000, v27
MA 148,v,164,v,128
ds_read_b128 v[104:107], v192 offset:45056
v_lshlrev_b32 v242, 16, v29
MA 176,v,160,v,132
v_and_b32 v243, 0xffff0000, v29
v_lshlrev_b32 v244, 16, v31
MA 180,v,164,v,132
buffer_load_dwordx4 v213, s[48:51], s66 offen offset:1024 lds
v_and_b32 v245, 0xffff0000, v31
MA 208,v,160,v,136
v_lshlrev_b32 v246, 16, v33
v_and_b32 v247, 0xffff0000, v33
MA 212,v,164,v,136
v_lshlrev_b32 v248, 16, v35
v_and_b32 v249, 0xffff0000, v35
MA 240,v,160,v,140
TR 160,200,32768
TR 162,200,34816
MA 244,v,164,v,140
TR 164,201,32768
TR 166,201,34816
MA 248,v,168,v,140
ds_read_b128 v[108:111], v192 offset:47104
buffer_load_dwordx4 v214, s[48:51], s66 offen offset:2048 lds
MA 252,v,172,v,140
v_lshlrev_b32 v250, 16, v37
v_and_b32 v251, 0xffff0000, v37
MA 216,v,168,v,136
buffer_load_dwordx4 v215, s[48:51], s66 offen offset:3072 lds
v_lshlrev_b32 v254, 16, v39
MA 220,v,172,v,136
v_and_b32 v255, 0xffff0000, v39
v_mul_f32 v62, v236, v2
MA 184,v,168,v,132
v_mul_f32 v70, v237, v6
v_fmac_f32 v62, v234, v3
MA 188,v,172,v,132
v_fmac_f32 v70, v235, v7
v_fmac_f32 v62, v232, v4
MA 152,v,168,v,128
s_add_u32 s66, s66, 524288
v_fmac_f32 v70, v233, v8
MA 156,v,172,v,128
v_fmac_f32 v62, v230, v5
v_fmac_f32 v70, v231, v9
MA 120,v,168,v,124
v_mul_f32 v62, v62, v254
v_mul_f32 v70, v70, v255
MA 124,v,172,v,124
v_lshlrev_b32 v254, 16, v41
v_and_b32 v255, 0xffff0000, v41
MA 88,v,168,v,120
s_and_b32 s66, s66, 8388607
v_mul_f32 v63, v238, v2
MA 92,v,172,v,120
v_mul_f32 v71, v239, v6
v_fmac_f32 v63, v236, v3
MA 56,v,168,v,116
v_fmac_f32 v71, v237, v7
v_fmac_f32 v63, v234, v4
MA 60,v,172,v,116
v_fmac_f32 v71, v235, v8
v_fmac_f32 v63, v232, v5
MA 24,v,168,v,112
TR 168,202,32768
TR 170,202,34816
MA 28,v,172,v,112
TR 172,203,32768
TR 174,203,34816
v_fmac_f32 v71, v233, v9
v_mul_f32 v63, v63, v254
v_mul_f32 v71, v71, v255
v_lshlrev_b32 v254, 16, v43
v_and_b32 v255, 0xffff0000, v43
v_mul_f32 v64, v240, v2
v_mul_f32 v72, v241, v6
v_fmac_f32 v64, v238, v3
s_waitcnt lgkmcnt(4)
MA 0,v,144,v,80
s_add_u32 s75, s64, s74
v_fmac_f32 v72, v239, v7
MA 4,v,148,v,80
ds_read_b128 v[112:115], v193 offset:32768
v_fmac_f32 v64, v236, v4
MA 32,v,144,v,84
v_fmac_f32 v72, v237, v8
v_fmac_f32 v64, v234, v5
MA 36,v,148,v,84
v_fmac_f32 v72, v235, v9
v_mul_f32 v64, v64, v254
MA 64,v,144,v,88
s_add_u32 m0, s67, 0
v_mul_f32 v72, v72, v255
MA 68,v,148,v,88
v_lshlrev_b32 v254, 16, v45
MA 96,v,144,v,92
v_and_b32 v255, 0xffff0000, v45
v_mul_f32 v65, v242, v2
MA 100,v,148,v,92
ds_read_b128 v[116:119], v193 offset:34816
v_mul_f32 v73, v243, v6
MA 128,v,144,v,96
buffer_load_dwordx4 v208, s[44:47], s75 offen offset:0 lds
v_fmac_f32 v65, v240, v3
MA 132,v,148,v,96
v_fmac_f32 v73, v241, v7
MA 160,v,144,v,100
v_fmac_f32 v65, v238, v4
v_fmac_f32 v73, v239, v8
MA 164,v,148,v,100
v_fmac_f32 v65, v236, v5
MA 192,v,144,v,104
v_fmac_f32 v73, v237, v9
MA 196,v,148,v,104
ds_read_b128 v[120:123], v193 offset:36864
buffer_load_dwordx4 v209, s[44:47], s75 offen offset:1024 lds
MA 224,v,144,v,108
TR 144,196,49152
TR 146,196,51200
MA 228,v,148,v,108
TR 148,197,49152
TR 150,197,51200
MA 232,v,152,v,108
v_mul_f32 v65, v65, v254
v_mul_f32 v73, v73, v255
MA 236,v,156,v,108
buffer_load_dwordx4 v210, s[44:47], s75 offen offset:2048 lds
v_lshlrev_b32 v254, 16, v47
MA 200,v,152,v,104
v_and_b32 v255, 0xffff0000, v47
v_mul_f32 v66, v244, v2
MA 204,v,156,v,104
v_mul_f32 v74, v245, v6
v_fmac_f32 v66, v242, v3
MA 168,v,152,v,100
ds_read_b128 v[124:127], v193 offset:38912
v_fmac_f32 v74, v243, v7
MA 172,v,156,v,100
v_fmac_f32 v66, v240, v4
v_fmac_f32 v74, v241, v8
MA 136,v,152,v,96
buffer_load_dwordx4 v211, s[44:47], s75 offen offset:3072 lds
v_fmac_f32 v66, v238, v5
MA 140,v,156,v,96
v_fmac_f32 v74, v239, v9
v_mul_f32 v66, v66, v254
MA 104,v,152,v,92
v_mul_f32 v74, v74, v255
v_lshlrev_b32 v254, 16, v49
MA 108,v,156,v,92
v_and_b32 v255, 0xffff0000, v49
v_mul_f32 v67, v246, v2
MA 72,v,152,v,88
ds_read_b128 v[128:131], v193 offset:40960
s_add_u32 s75, s65, s74
MA 76,v,156,v,88
v_mul_f32 v75, v247, v6
v_fmac_f32 v67, v244, v3
MA 40,v,152,v,84
v_fmac_f32 v75, v245, v7
v_fmac_f32 v67, v242, v4
MA 44,v,156,v,84
v_fmac_f32 v75, v243, v8
MA 8,v,152,v,80
TR 152,198,49152
TR 154,198,51200
MA 12,v,156,v,80
TR 156,199,49152
TR 158,199,51200
MA 16,v,160,v,80
ds_read_b128 v[132:135], v193 offset:43008
s_add_u32 m0, s67, 4096
MA 20,v,164,v,80
v_fmac_f32 v67, v240, v5
v_fmac_f32 v75, v241, v9
MA 48,v,160,v,84
v_mul_f32 v67, v67, v254
v_mul_f32 v75, v75, v255
MA 52,v,164,v,84
buffer_load_dwordx4 v208, s[44:47], s75 offen offset:0 lds
v_lshlrev_b32 v254, 16, v51
MA 80,v,160,v,88
v_and_b32 v255, 0xffff0000, v51
v_mul_f32 v68, v248, v2
MA 84,v,164,v,88
v_mul_f32 v76, v249, v6
v_fmac_f32 v68, v246, v3
MA 112,v,160,v,92
v_fmac_f32 v76, v247, v7
v_fmac_f32 v68, v244, v4
MA 116,v,164,v,92
ds_read_b128 v[136:139], v193 offset:45056
buffer_load_dwordx4 v209, s[44:47], s75 offen offset:1024 lds
MA 144,v,160,v,96
v_fmac_f32 v76, v245, v8
v_fmac_f32 v68, v242, v5
MA 148,v,164,v,96
v_fmac_f32 v76, v243, v9
v_mul_f32 v68, v68, v254
MA 176,v,160,v,100
v_mul_f32 v76, v76, v255
v_lshlrev_b32 v254, 16, v53
MA 180,v,164,v,100
v_and_b32 v255, 0xffff0000, v53
MA 208,v,160,v,104
buffer_load_dwordx4 v210, s[44:47], s75 offen offset:2048 lds
v_mul_f32 v69, v250, v2
MA 212,v,164,v,104
ds_read_b128 v[140:143], v193 offset:47104
v_mul_f32 v77, v251, v6
MA 240,v,160,v,108
TR 160,200,49152
TR 162,200,51200
MA 244,v,164,v,108
TR 164,201,49152
TR 166,201,51200
s_waitcnt lgkmcnt(15)
MA 248,v,168,v,108
buffer_load_dwordx4 v211, s[44:47], s75 offen offset:3072 lds
v_fmac_f32 v69, v248, v3
MA 252,v,172,v,108
v_fmac_f32 v77, v249, v7
v_fmac_f32 v69, v246, v4
MA 216,v,168,v,104
v_fmac_f32 v77, v247, v8
v_fmac_f32 v69, v244, v5
MA 220,v,172,v,104
v_fmac_f32 v77, v245, v9
v_mul_f32 v69, v69, v254
MA 184,v,168,v,100
v_mul_f32 v77, v77, v255
v_cvt_pk_bf16_f32 v230, v69, v68
MA 188,v,172,v,100
s_add_u32 s74, s74, 128
v_cvt_pk_bf16_f32 v231, v67, v66
MA 152,v,168,v,96
v_cvt_pk_bf16_f32 v232, v65, v64
v_cvt_pk_bf16_f32 v233, v63, v62
MA 156,v,172,v,96
s_mov_b32 s36, 8192
buffer_store_dwordx4 v[230:233], v10, s[84:87], s36 offen sc1
MA 120,v,168,v,92
v_cvt_pk_bf16_f32 v234, v77, v76
MA 124,v,172,v,92
s_and_b32 s74, s74, 2047
v_cvt_pk_bf16_f32 v235, v75, v74
MA 88,v,168,v,88
v_cvt_pk_bf16_f32 v236, v73, v72
v_cvt_pk_bf16_f32 v237, v71, v70
MA 92,v,172,v,88
s_mov_b32 s36, 12288
MA 56,v,168,v,84
buffer_store_dwordx4 v[234:237], v10, s[84:87], s36 offen sc1
MA 60,v,172,v,84
v_lshlrev_b32 v228, 4, v1
MA 24,v,168,v,80
TR 168,202,49152
TR 170,202,51200
MA 28,v,172,v,80
TR 172,203,49152
TR 174,203,51200
s_waitcnt lgkmcnt(4)
MA 0,v,144,v,112
MA 4,v,148,v,112
MA 32,v,144,v,116
MA 36,v,148,v,116
MA 64,v,144,v,120
MA 68,v,148,v,120
MA 96,v,144,v,124
MA 100,v,148,v,124
MA 128,v,144,v,128
MA 132,v,148,v,128
s_waitcnt vmcnt(15) lgkmcnt(0)
s_barrier
MA 160,v,144,v,132
ds_read_b128 v[48:51], v226 offset:0
s_add_u32 m0, s68, 131072
MA 164,v,148,v,132
MA 192,v,144,v,136
ds_read_b128 v[52:55], v226 offset:2048
buffer_load_dwordx4 v212, s[48:51], s66 offen offset:0 lds
MA 196,v,148,v,136
MA 224,v,144,v,140
ds_read_b128 v[56:59], v226 offset:4096
buffer_load_dwordx4 v213, s[48:51], s66 offen offset:1024 lds
MA 228,v,148,v,140
MA 232,v,152,v,140
ds_read_b128 v[60:63], v226 offset:6144
MA 236,v,156,v,140
buffer_load_dwordx4 v214, s[48:51], s66 offen offset:2048 lds
MA 200,v,152,v,136
TR 16,216,0
MA 204,v,156,v,136
buffer_load_dwordx4 v215, s[48:51], s66 offen offset:3072 lds
MA 168,v,152,v,132
TR 18,216,1024
MA 172,v,156,v,132
MA 136,v,152,v,128
TR 20,217,0
s_add_u32 s66, s66, 524288
MA 140,v,156,v,128
MA 104,v,152,v,124
TR 22,217,1024
s_and_b32 s66, s66, 8388607
MA 108,v,156,v,124
MA 72,v,152,v,120
TR 24,218,0
MA 76,v,156,v,120
s_add_u32 s75, s64, s74
MA 40,v,152,v,116
TR 26,218,1024
MA 44,v,156,v,116
s_add_u32 m0, s67, 32768
MA 8,v,152,v,112
TR 28,219,0
MA 12,v,156,v,112
MA 16,v,160,v,112
TR 30,219,1024
buffer_load_dwordx4 v208, s[44:47], s75 offen offset:0 lds
MA 20,v,164,v,112
MA 48,v,160,v,116
TR 32,220,0
buffer_load_dwordx4 v209, s[44:47], s75 offen offset:1024 lds
MA 52,v,164,v,116
MA 80,v,160,v,120
TR 34,220,1024
MA 84,v,164,v,120
buffer_load_dwordx4 v210, s[44:47], s75 offen offset:2048 lds
MA 112,v,160,v,124
TR 36,221,0
MA 116,v,164,v,124
buffer_load_dwordx4 v211, s[44:47], s75 offen offset:3072 lds
MA 144,v,160,v,128
TR 38,221,1024
MA 148,v,164,v,128
MA 176,v,160,v,132
TR 40,222,0
s_add_u32 s75, s65, s74
MA 180,v,164,v,132
MA 208,v,160,v,136
TR 42,222,1024
s_add_u32 m0, s67, 36864
MA 212,v,164,v,136
MA 240,v,160,v,140
TR 44,223,0
MA 244,v,164,v,140
buffer_load_dwordx4 v208, s[44:47], s75 offen offset:0 lds
MA 248,v,168,v,140
TR 46,223,1024
MA 252,v,172,v,140
buffer_load_dwordx4 v209, s[44:47], s75 offen offset:1024 lds
MA 216,v,168,v,136
MA 220,v,172,v,136
MA 184,v,168,v,132
buffer_load_dwordx4 v210, s[44:47], s75 offen offset:2048 lds
MA 188,v,172,v,132
MA 152,v,168,v,128
buffer_load_dwordx4 v211, s[44:47], s75 offen offset:3072 lds
MA 156,v,172,v,128
MA 120,v,168,v,124
MA 124,v,172,v,124
s_add_u32 s74, s74, 128
MA 88,v,168,v,120
MA 92,v,172,v,120
s_and_b32 s74, s74, 2047
MA 56,v,168,v,116
MA 60,v,172,v,116
MA 24,v,168,v,112
MA 28,v,172,v,112
s_branch L_p2
L_p1_V:
s_waitcnt lgkmcnt(14)
v_mfma_f32_16x16x32_bf16 a[0:3], v[80:83], v[144:147], 0
s_add_u32 m0, s23, 32768
s_waitcnt lgkmcnt(12)
v_mfma_f32_16x16x32_bf16 a[8:11], v[80:83], v[148:151], 0
ds_read_b128 v[112:115], v193 offset:0
v_mfma_f32_16x16x32_bf16 a[4:7], v[84:87], v[144:147], 0
buffer_load_dwordx4 v184, s[12:15], s21 offen offset:0 lds
v_mfma_f32_16x16x32_bf16 a[12:15], v[84:87], v[148:151], 0
v_mfma_f32_16x16x32_bf16 a[64:67], v[88:91], v[144:147], 0
v_mfma_f32_16x16x32_bf16 a[72:75], v[88:91], v[148:151], 0
buffer_load_dwordx4 v185, s[12:15], s21 offen offset:1024 lds
v_mfma_f32_16x16x32_bf16 a[68:71], v[92:95], v[144:147], 0
v_mfma_f32_16x16x32_bf16 a[76:79], v[92:95], v[148:151], 0
ds_read_b128 v[116:119], v193 offset:2048
buffer_load_dwordx4 v186, s[12:15], s21 offen offset:2048 lds
v_mfma_f32_16x16x32_bf16 a[128:131], v[96:99], v[144:147], 0
v_mfma_f32_16x16x32_bf16 a[136:139], v[96:99], v[148:151], 0
v_mfma_f32_16x16x32_bf16 a[132:135], v[100:103], v[144:147], 0
buffer_load_dwordx4 v187, s[12:15], s21 offen offset:3072 lds
v_mfma_f32_16x16x32_bf16 a[140:143], v[100:103], v[148:151], 0
v_mfma_f32_16x16x32_bf16 a[192:195], v[104:107], v[144:147], 0
s_add_u32 m0, s23, 36864
v_mfma_f32_16x16x32_bf16 a[200:203], v[104:107], v[148:151], 0
ds_read_b128 v[120:123], v193 offset:4096
v_mfma_f32_16x16x32_bf16 a[196:199], v[108:111], v[144:147], 0
TR 144,196,16384
TR 146,196,18432
v_mfma_f32_16x16x32_bf16 a[204:207], v[108:111], v[148:151], 0
TR 148,197,16384
TR 150,197,18432
s_waitcnt lgkmcnt(15)
v_mfma_f32_16x16x32_bf16 a[212:215], v[108:111], v[152:155], 0
buffer_load_dwordx4 v188, s[12:15], s21 offen offset:0 lds
v_mfma_f32_16x16x32_bf16 a[220:223], v[108:111], v[156:159], 0
v_mfma_f32_16x16x32_bf16 a[208:211], v[104:107], v[152:155], 0
buffer_load_dwordx4 v189, s[12:15], s21 offen offset:1024 lds
v_mfma_f32_16x16x32_bf16 a[216:219], v[104:107], v[156:159], 0
v_mfma_f32_16x16x32_bf16 a[148:151], v[100:103], v[152:155], 0
ds_read_b128 v[124:127], v193 offset:6144
buffer_load_dwordx4 v190, s[12:15], s21 offen offset:2048 lds
v_mfma_f32_16x16x32_bf16 a[156:159], v[100:103], v[156:159], 0
v_mfma_f32_16x16x32_bf16 a[144:147], v[96:99], v[152:155], 0
v_mfma_f32_16x16x32_bf16 a[152:155], v[96:99], v[156:159], 0
buffer_load_dwordx4 v191, s[12:15], s21 offen offset:3072 lds
v_mfma_f32_16x16x32_bf16 a[84:87], v[92:95], v[152:155], 0
v_mfma_f32_16x16x32_bf16 a[92:95], v[92:95], v[156:159], 0
s_add_u32 s21, s21, 524288
v_mfma_f32_16x16x32_bf16 a[80:83], v[88:91], v[152:155], 0
ds_read_b128 v[128:131], v193 offset:8192
v_mfma_f32_16x16x32_bf16 a[88:91], v[88:91], v[156:159], 0
v_mfma_f32_16x16x32_bf16 a[20:23], v[84:87], v[152:155], 0
s_and_b32 s21, s21, 4194303
v_mfma_f32_16x16x32_bf16 a[28:31], v[84:87], v[156:159], 0
v_mfma_f32_16x16x32_bf16 a[16:19], v[80:83], v[152:155], 0
TR 152,198,16384
TR 154,198,18432
v_mfma_f32_16x16x32_bf16 a[24:27], v[80:83], v[156:159], 0
TR 156,199,16384
TR 158,199,18432
s_waitcnt lgkmcnt(15)
v_mfma_f32_16x16x32_bf16 a[32:35], v[80:83], v[160:163], 0
ds_read_b128 v[132:135], v193 offset:10240
s_add_u32 m0, s22, 32768
v_mfma_f32_16x16x32_bf16 a[40:43], v[80:83], v[164:167], 0
buffer_load_dwordx4 v176, s[8:11], s20 offen offset:0 lds
v_mfma_f32_16x16x32_bf16 a[36:39], v[84:87], v[160:163], 0
v_mfma_f32_16x16x32_bf16 a[44:47], v[84:87], v[164:167], 0
v_mfma_f32_16x16x32_bf16 a[96:99], v[88:91], v[160:163], 0
buffer_load_dwordx4 v177, s[8:11], s20 offen offset:1024 lds
v_mfma_f32_16x16x32_bf16 a[104:107], v[88:91], v[164:167], 0
v_mfma_f32_16x16x32_bf16 a[100:103], v[92:95], v[160:163], 0
buffer_load_dwordx4 v178, s[8:11], s20 offen offset:2048 lds
v_mfma_f32_16x16x32_bf16 a[108:111], v[92:95], v[164:167], 0
ds_read_b128 v[136:139], v193 offset:12288
v_mfma_f32_16x16x32_bf16 a[160:163], v[96:99], v[160:163], 0
v_mfma_f32_16x16x32_bf16 a[168:171], v[96:99], v[164:167], 0
buffer_load_dwordx4 v179, s[8:11], s20 offen offset:3072 lds
v_mfma_f32_16x16x32_bf16 a[164:167], v[100:103], v[160:163], 0
v_mfma_f32_16x16x32_bf16 a[172:175], v[100:103], v[164:167], 0
s_add_u32 m0, s22, 36864
v_mfma_f32_16x16x32_bf16 a[224:227], v[104:107], v[160:163], 0
v_mfma_f32_16x16x32_bf16 a[232:235], v[104:107], v[164:167], 0
ds_read_b128 v[140:143], v193 offset:14336
v_mfma_f32_16x16x32_bf16 a[228:231], v[108:111], v[160:163], 0
TR 160,200,16384
TR 162,200,18432
v_mfma_f32_16x16x32_bf16 a[236:239], v[108:111], v[164:167], 0
TR 164,201,16384
TR 166,201,18432
v_mfma_f32_16x16x32_bf16 a[244:247], v[108:111], v[168:171], 0
buffer_load_dwordx4 v180, s[8:11], s20 offen offset:0 lds
s_waitcnt lgkmcnt(15)
v_mfma_f32_16x16x32_bf16 a[252:255], v[108:111], v[172:175], 0
buffer_load_dwordx4 v181, s[8:11], s20 offen offset:1024 lds
v_mfma_f32_16x16x32_bf16 a[240:243], v[104:107], v[168:171], 0
v_mfma_f32_16x16x32_bf16 a[248:251], v[104:107], v[172:175], 0
buffer_load_dwordx4 v182, s[8:11], s20 offen offset:2048 lds
v_mfma_f32_16x16x32_bf16 a[180:183], v[100:103], v[168:171], 0
v_mfma_f32_16x16x32_bf16 a[188:191], v[100:103], v[172:175], 0
v_mfma_f32_16x16x32_bf16 a[176:179], v[96:99], v[168:171], 0
buffer_load_dwordx4 v183, s[8:11], s20 offen offset:3072 lds
v_mfma_f32_16x16x32_bf16 a[184:187], v[96:99], v[172:175], 0
v_mfma_f32_16x16x32_bf16 a[116:119], v[92:95], v[168:171], 0
s_add_u32 s20, s20, 128
v_mfma_f32_16x16x32_bf16 a[124:127], v[92:95], v[172:175], 0
v_mfma_f32_16x16x32_bf16 a[112:115], v[88:91], v[168:171], 0
v_mfma_f32_16x16x32_bf16 a[120:123], v[88:91], v[172:175], 0
s_and_b32 s20, s20, 1023
v_mfma_f32_16x16x32_bf16 a[52:55], v[84:87], v[168:171], 0
v_mfma_f32_16x16x32_bf16 a[60:63], v[84:87], v[172:175], 0
v_mfma_f32_16x16x32_bf16 a[48:51], v[80:83], v[168:171], 0
TR 168,202,16384
TR 170,202,18432
v_mfma_f32_16x16x32_bf16 a[56:59], v[80:83], v[172:175], 0
TR 172,203,16384
TR 174,203,18432
s_waitcnt lgkmcnt(4)
MA 0,v,112,v,144
s_add_u32 m0, s22, 65536
MA 8,v,112,v,148
MA 4,v,116,v,144
MA 12,v,116,v,148
buffer_load_dwordx4 v176, s[8:11], s20 offen offset:0 lds
MA 64,v,120,v,144
MA 72,v,120,v,148
MA 68,v,124,v,144
MA 76,v,124,v,148
buffer_load_dwordx4 v177, s[8:11], s20 offen offset:1024 lds
MA 128,v,128,v,144
MA 136,v,128,v,148
MA 132,v,132,v,144
buffer_load_dwordx4 v178, s[8:11], s20 offen offset:2048 lds
MA 140,v,132,v,148
MA 192,v,136,v,144
MA 200,v,136,v,148
MA 196,v,140,v,144
buffer_load_dwordx4 v179, s[8:11], s20 offen offset:3072 lds
MA 204,v,140,v,148
MA 212,v,140,v,152
MA 220,v,140,v,156
s_add_u32 m0, s22, 69632
MA 208,v,136,v,152
MA 216,v,136,v,156
MA 148,v,132,v,152
MA 156,v,132,v,156
buffer_load_dwordx4 v180, s[8:11], s20 offen offset:0 lds
MA 144,v,128,v,152
MA 152,v,128,v,156
MA 84,v,124,v,152
MA 92,v,124,v,156
buffer_load_dwordx4 v181, s[8:11], s20 offen offset:1024 lds
MA 80,v,120,v,152
MA 88,v,120,v,156
MA 20,v,116,v,152
buffer_load_dwordx4 v182, s[8:11], s20 offen offset:2048 lds
MA 28,v,116,v,156
MA 16,v,112,v,152
MA 24,v,112,v,156
MA 32,v,112,v,160
buffer_load_dwordx4 v183, s[8:11], s20 offen offset:3072 lds
MA 40,v,112,v,164
MA 36,v,116,v,160
MA 44,v,116,v,164
s_add_u32 s20, s20, 128
MA 96,v,120,v,160
MA 104,v,120,v,164
MA 100,v,124,v,160
MA 108,v,124,v,164
s_and_b32 s20, s20, 1023
MA 160,v,128,v,160
MA 168,v,128,v,164
MA 164,v,132,v,160
MA 172,v,132,v,164
MA 224,v,136,v,160
s_waitcnt vmcnt(8) lgkmcnt(0)
s_barrier
MA 232,v,136,v,164
TR 144,196,32768
TR 146,196,34816
MA 228,v,140,v,160
ds_read_b128 v[80:83], v192 offset:32768
s_add_u32 m0, s23, 0
MA 236,v,140,v,164
TR 148,197,32768
TR 150,197,34816
MA 244,v,140,v,168
ds_read_b128 v[84:87], v192 offset:34816
ds_read_b128 v[88:91], v192 offset:36864
MA 252,v,140,v,172
TR 152,198,32768
TR 154,198,34816
MA 240,v,136,v,168
ds_read_b128 v[92:95], v192 offset:38912
ds_read_b128 v[96:99], v192 offset:40960
MA 248,v,136,v,172
TR 156,199,32768
TR 158,199,34816
MA 180,v,132,v,168
ds_read_b128 v[100:103], v192 offset:43008
ds_read_b128 v[104:107], v192 offset:45056
MA 188,v,132,v,172
TR 160,200,32768
TR 162,200,34816
MA 176,v,128,v,168
ds_read_b128 v[108:111], v192 offset:47104
buffer_load_dwordx4 v184, s[12:15], s21 offen offset:0 lds
MA 184,v,128,v,172
TR 164,201,32768
TR 166,201,34816
MA 116,v,124,v,168
buffer_load_dwordx4 v185, s[12:15], s21 offen offset:1024 lds
buffer_load_dwordx4 v186, s[12:15], s21 offen offset:2048 lds
MA 124,v,124,v,172
buffer_load_dwordx4 v187, s[12:15], s21 offen offset:3072 lds
s_add_u32 m0, s23, 4096
MA 112,v,120,v,168
buffer_load_dwordx4 v188, s[12:15], s21 offen offset:0 lds
buffer_load_dwordx4 v189, s[12:15], s21 offen offset:1024 lds
MA 120,v,120,v,172
buffer_load_dwordx4 v190, s[12:15], s21 offen offset:2048 lds
buffer_load_dwordx4 v191, s[12:15], s21 offen offset:3072 lds
MA 52,v,116,v,168
s_add_u32 s21, s21, 524288
s_and_b32 s21, s21, 4194303
MA 60,v,116,v,172
s_load_dwordx2 s[84:85], s[0:1], 8
s_load_dwordx2 s[88:89], s[0:1], 16
MA 48,v,112,v,168
TR 168,202,32768
TR 170,202,34816
MA 56,v,112,v,172
TR 172,203,32768
TR 174,203,34816
s_load_dwordx2 s[92:93], s[0:1], 0
s_load_dwordx2 s[96:97], s[0:1], 24
s_load_dwordx2 s[76:77], s[0:1], 96
s_waitcnt lgkmcnt(4)
MA 0,v,80,v,144
s_add_u32 m0, s22, 0
MA 8,v,80,v,148
ds_read_b128 v[112:115], v193 offset:32768
MA 4,v,84,v,144
s_mov_b32 s4, s34
s_mov_b32 s5, s35
MA 12,v,84,v,148
MA 64,v,88,v,144
MA 72,v,88,v,148
buffer_load_dwordx4 v176, s[8:11], s20 offen offset:0 lds
MA 68,v,92,v,144
MA 76,v,92,v,148
ds_read_b128 v[116:119], v193 offset:34816
MA 128,v,96,v,144
s_mov_b32 s6, 8388608
s_mov_b32 s7, 0x20000
MA 136,v,96,v,148
MA 132,v,100,v,144
buffer_load_dwordx4 v177, s[8:11], s20 offen offset:1024 lds
MA 140,v,100,v,148
MA 192,v,104,v,144
MA 200,v,104,v,148
ds_read_b128 v[120:123], v193 offset:36864
MA 196,v,108,v,144
TR 144,196,49152
TR 146,196,51200
MA 204,v,108,v,148
TR 148,197,49152
TR 150,197,51200
MA 212,v,108,v,152
buffer_load_dwordx4 v178, s[8:11], s20 offen offset:2048 lds
s_lshr_b32 s43, s2, 3
MA 220,v,108,v,156
MA 208,v,104,v,152
MA 216,v,104,v,156
s_lshl_b32 s43, s43, 2
MA 148,v,100,v,152
ds_read_b128 v[124:127], v193 offset:38912
buffer_load_dwordx4 v179, s[8:11], s20 offen offset:3072 lds
MA 156,v,100,v,156
MA 144,v,96,v,152
MA 152,v,96,v,156
s_add_u32 s43, s43, s3
MA 84,v,92,v,152
MA 92,v,92,v,156
s_add_u32 m0, s22, 4096
MA 80,v,88,v,152
ds_read_b128 v[128:131], v193 offset:40960
MA 88,v,88,v,156
s_lshl_b32 s43, s43, 16
MA 20,v,84,v,152
MA 28,v,84,v,156
MA 16,v,80,v,152
TR 152,198,49152
TR 154,198,51200
MA 24,v,80,v,156
TR 156,199,49152
TR 158,199,51200
MA 32,v,80,v,160
ds_read_b128 v[132:135], v193 offset:43008
buffer_load_dwordx4 v180, s[8:11], s20 offen offset:0 lds
MA 40,v,80,v,164
s_and_b32 s37, s2, 7
MA 36,v,84,v,160
s_lshl_b32 s37, s37, 10
MA 44,v,84,v,164
MA 96,v,88,v,160
buffer_load_dwordx4 v181, s[8:11], s20 offen offset:1024 lds
MA 104,v,88,v,164
MA 100,v,92,v,160
s_add_u32 s43, s43, s37
MA 108,v,92,v,164
ds_read_b128 v[136:139], v193 offset:45056
MA 160,v,96,v,160
MA 168,v,96,v,164
buffer_load_dwordx4 v182, s[8:11], s20 offen offset:2048 lds
MA 164,v,100,v,160
v_lshrrev_b32 v78, 3, v1
MA 172,v,100,v,164
MA 224,v,104,v,160
MA 232,v,104,v,164
ds_read_b128 v[140:143], v193 offset:47104
MA 228,v,108,v,160
TR 160,200,49152
TR 162,200,51200
MA 236,v,108,v,164
TR 164,201,49152
TR 166,201,51200
s_waitcnt lgkmcnt(15)
MA 244,v,108,v,168
buffer_load_dwordx4 v183, s[8:11], s20 offen offset:3072 lds
v_and_b32 v79, 7, v1
MA 252,v,108,v,172
MA 240,v,104,v,168
v_lshlrev_b32 v79, 7, v79
MA 248,v,104,v,172
s_add_u32 s20, s20, 128
MA 180,v,100,v,168
MA 188,v,100,v,172
MA 176,v,96,v,168
v_lshl_add_u32 v78, v78, 13, v79
MA 184,v,96,v,172
MA 116,v,92,v,168
s_and_b32 s20, s20, 1023
MA 124,v,92,v,172
MA 112,v,88,v,168
v_add_u32 v78, s43, v78
MA 120,v,88,v,172
MA 52,v,84,v,168
MA 60,v,84,v,172
MA 48,v,80,v,168
TR 168,202,49152
TR 170,202,51200
MA 56,v,80,v,172
TR 172,203,49152
TR 174,203,51200
s_waitcnt lgkmcnt(4)
MA 0,v,112,v,144
MA 8,v,112,v,148
MA 4,v,116,v,144
MA 12,v,116,v,148
MA 64,v,120,v,144
MA 72,v,120,v,148
MA 68,v,124,v,144
MA 76,v,124,v,148
MA 128,v,128,v,144
MA 136,v,128,v,148
s_waitcnt vmcnt(8) lgkmcnt(0)
s_barrier
MA 132,v,132,v,144
s_add_u32 m0, s23, 32768
s_mov_b32 s86, 4194304
MA 140,v,132,v,148
ds_read_b128 v[80:83], v194 offset:0
s_mov_b32 s87, 0x20000
MA 192,v,136,v,144
s_mov_b32 s90, 4194304
MA 200,v,136,v,148
s_mov_b32 s91, 0x20000
MA 196,v,140,v,144
TR 144,196,0
TR 146,196,2048
MA 204,v,140,v,148
TR 148,197,0
TR 150,197,2048
MA 212,v,140,v,152
ds_read_b128 v[84:87], v194 offset:2048
buffer_load_dwordx4 v184, s[12:15], s21 offen offset:0 lds
MA 220,v,140,v,156
s_mov_b32 s94, 4194304
s_mov_b32 s95, 0x20000
MA 208,v,136,v,152
buffer_load_dwordx4 v185, s[12:15], s21 offen offset:1024 lds
s_mov_b32 s98, 8192
MA 216,v,136,v,156
s_mov_b32 s99, 0x20000
MA 148,v,132,v,152
s_mov_b32 s78, 2048
MA 156,v,132,v,156
ds_read_b128 v[88:91], v194 offset:4096
s_mov_b32 s79, 0x20000
MA 144,v,128,v,152
s_and_b32 s36, s2, 15
MA 152,v,128,v,156
buffer_load_dwordx4 v186, s[12:15], s21 offen offset:2048 lds
s_lshl_b32 s36, s36, 1
MA 84,v,124,v,152
MA 92,v,124,v,156
s_lshr_b32 s37, s3, 1
MA 80,v,120,v,152
ds_read_b128 v[92:95], v194 offset:6144
s_add_u32 s36, s36, s37
MA 88,v,120,v,156
buffer_load_dwordx4 v187, s[12:15], s21 offen offset:3072 lds
s_lshl_b32 s36, s36, 3
MA 20,v,116,v,152
MA 28,v,116,v,156
v_and_b32 v252, 7, v1
MA 16,v,112,v,152
TR 152,198,0
TR 154,198,2048
MA 24,v,112,v,156
TR 156,199,0
TR 158,199,2048
MA 32,v,112,v,160
ds_read_b128 v[96:99], v194 offset:8192
s_add_u32 m0, s23, 36864
MA 40,v,112,v,164
v_add_u32 v252, s36, v252
s_lshr_b32 s36, s2, 4
MA 36,v,116,v,160
s_lshl_b32 s36, s36, 1
s_and_b32 s37, s3, 1
MA 44,v,116,v,164
s_add_u32 s36, s36, s37
MA 96,v,120,v,160
ds_read_b128 v[100:103], v194 offset:10240
buffer_load_dwordx4 v188, s[12:15], s21 offen offset:0 lds
MA 104,v,120,v,164
s_lshl_b32 s36, s36, 3
v_lshrrev_b32 v253, 3, v1
MA 100,v,124,v,160
MA 108,v,124,v,164
v_add_u32 v253, s36, v253
MA 160,v,128,v,160
buffer_load_dwordx4 v189, s[12:15], s21 offen offset:1024 lds
v_lshlrev_b32 v254, 14, v253
MA 168,v,128,v,164
ds_read_b128 v[104:107], v194 offset:12288
v_lshl_add_u32 v254, v252, 3, v254
MA 164,v,132,v,160
v_add_u32 v229, -6144, v254
MA 172,v,132,v,164
MA 224,v,136,v,160
buffer_load_dwordx4 v190, s[12:15], s21 offen offset:2048 lds
v_lshlrev_b32 v62, 5, v252
MA 232,v,136,v,164
v_lshlrev_b32 v254, 4, v253
MA 228,v,140,v,160
TR 160,200,0
TR 162,200,2048
MA 236,v,140,v,164
TR 164,201,0
TR 166,201,2048
MA 244,v,140,v,168
ds_read_b128 v[108:111], v194 offset:14336
v_sub_u32 v254, 4080, v254
MA 252,v,140,v,172
buffer_load_dwordx4 v191, s[12:15], s21 offen offset:3072 lds
v_lshl_add_u32 v10, v252, 14, v254
MA 240,v,136,v,168
v_and_b32 v252, 31, v1
v_lshlrev_b32 v64, 4, v252
MA 248,v,136,v,172
s_lshl_b32 s36, s2, 2
MA 180,v,132,v,168
MA 188,v,132,v,172
s_add_u32 s21, s21, 524288
s_add_u32 s36, s36, s3
MA 176,v,128,v,168
s_lshl_b32 s36, s36, 1
MA 184,v,128,v,172
v_lshrrev_b32 v253, 5, v1
MA 116,v,124,v,168
v_add_u32 v253, s36, v253
MA 124,v,124,v,172
s_and_b32 s21, s21, 4194303
MA 112,v,120,v,168
v_lshl_add_u32 v63, v253, 11, v64
MA 120,v,120,v,172
v_lshlrev_b32 v253, 2, v253
MA 52,v,116,v,168
v_lshl_add_u32 v11, v252, 20, v253
MA 60,v,116,v,172
MA 48,v,112,v,168
TR 168,202,0
TR 170,202,2048
MA 56,v,112,v,172
TR 172,203,0
TR 174,203,2048
s_waitcnt lgkmcnt(4)
MA 0,v,80,v,144
s_add_u32 m0, s22, 32768
buffer_load_dwordx4 v[230:233], v63, s[92:95], 0 offen offset:0
MA 8,v,80,v,148
ds_read_b128 v[112:115], v195 offset:0
MA 4,v,84,v,144
MA 12,v,84,v,148
MA 64,v,88,v,144
buffer_load_dwordx4 v[2:5], v64, s[76:79], 0 offen offset:0
MA 72,v,88,v,148
buffer_load_dwordx4 v176, s[8:11], s20 offen offset:0 lds
MA 68,v,92,v,144
MA 76,v,92,v,148
ds_read_b128 v[116:119], v195 offset:2048
MA 128,v,96,v,144
MA 136,v,96,v,148
buffer_load_dwordx4 v[234:237], v63, s[92:95], 0 offen offset:512
MA 132,v,100,v,144
buffer_load_dwordx4 v177, s[8:11], s20 offen offset:1024 lds
MA 140,v,100,v,148
MA 192,v,104,v,144
MA 200,v,104,v,148
ds_read_b128 v[120:123], v195 offset:4096
MA 196,v,108,v,144
TR 144,196,16384
TR 146,196,18432
MA 204,v,108,v,148
TR 148,197,16384
TR 150,197,18432
MA 212,v,108,v,152
buffer_load_dwordx4 v178, s[8:11], s20 offen offset:2048 lds
buffer_load_dwordx4 v[6:9], v64, s[76:79], 0 offen offset:512
MA 220,v,108,v,156
MA 208,v,104,v,152
MA 216,v,104,v,156
buffer_load_dwordx4 v[238:241], v63, s[92:95], 0 offen offset:1024
MA 148,v,100,v,152
ds_read_b128 v[124:127], v195 offset:6144
buffer_load_dwordx4 v179, s[8:11], s20 offen offset:3072 lds
MA 156,v,100,v,156
MA 144,v,96,v,152
MA 152,v,96,v,156
buffer_load_dwordx4 v[12:15], v64, s[76:79], 0 offen offset:1024
MA 84,v,92,v,152
MA 92,v,92,v,156
s_add_u32 m0, s22, 36864
MA 80,v,88,v,152
ds_read_b128 v[128:131], v195 offset:8192
MA 88,v,88,v,156
MA 20,v,84,v,152
buffer_load_dwordx4 v[242:245], v63, s[92:95], 0 offen offset:1536
MA 28,v,84,v,156
MA 16,v,80,v,152
TR 152,198,16384
TR 154,198,18432
MA 24,v,80,v,156
TR 156,199,16384
TR 158,199,18432
MA 32,v,80,v,160
ds_read_b128 v[132:135], v195 offset:10240
buffer_load_dwordx4 v180, s[8:11], s20 offen offset:0 lds
MA 40,v,80,v,164
buffer_load_dwordx4 v[246:249], v64, s[76:79], 0 offen offset:1536
MA 36,v,84,v,160
MA 44,v,84,v,164
MA 96,v,88,v,160
buffer_load_dwordx4 v181, s[8:11], s20 offen offset:1024 lds
MA 104,v,88,v,164
MA 100,v,92,v,160
buffer_load_dwordx4 v[54:57], v62, s[96:99], 0 offen offset:0
MA 108,v,92,v,164
ds_read_b128 v[136:139], v195 offset:12288
MA 160,v,96,v,160
MA 168,v,96,v,164
buffer_load_dwordx4 v182, s[8:11], s20 offen offset:2048 lds
MA 164,v,100,v,160
buffer_load_dwordx4 v[58:61], v62, s[96:99], 0 offen offset:16
MA 172,v,100,v,164
MA 224,v,104,v,160
MA 232,v,104,v,164
ds_read_b128 v[140:143], v195 offset:14336
MA 228,v,108,v,160
TR 160,200,16384
TR 162,200,18432
MA 236,v,108,v,164
TR 164,201,16384
TR 166,201,18432
s_waitcnt lgkmcnt(15)
MA 244,v,108,v,168
buffer_load_dwordx4 v183, s[8:11], s20 offen offset:3072 lds
v_add_u32 v252, 0, v229
MA 252,v,108,v,172
MA 240,v,104,v,168
MA 248,v,104,v,172
s_add_u32 s20, s20, 128
MA 180,v,100,v,168
buffer_load_dwordx2 v[16:17], v252, s[84:87], 0 offen
MA 188,v,100,v,172
MA 176,v,96,v,168
MA 184,v,96,v,172
MA 116,v,92,v,168
s_and_b32 s20, s20, 1023
MA 124,v,92,v,172
v_add_u32 v253, 2048, v229
MA 112,v,88,v,168
MA 120,v,88,v,172
MA 52,v,84,v,168
MA 60,v,84,v,172
MA 48,v,80,v,168
TR 168,202,16384
TR 170,202,18432
MA 56,v,80,v,172
TR 172,203,16384
TR 174,203,18432
s_waitcnt lgkmcnt(4)
MA 0,v,112,v,144
MA 8,v,112,v,148
MA 4,v,116,v,144
MA 12,v,116,v,148
MA 64,v,120,v,144
MA 72,v,120,v,148
MA 68,v,124,v,144
MA 76,v,124,v,148
MA 128,v,128,v,144
MA 136,v,128,v,148
s_waitcnt vmcnt(19) lgkmcnt(0)
s_barrier
MA 132,v,132,v,144
s_add_u32 m0, s23, 0
s_bfe_u32 s80, s2, 0x20001
MA 140,v,132,v,148
ds_read_b128 v[80:83], v192 offset:0
s_bfe_u32 s69, s2, 0x30003
MA 192,v,136,v,144
s_lshl_b32 s80, s80, 3
s_add_u32 s69, s69, s80
MA 200,v,136,v,148
s_lshr_b32 s80, s2, 6
MA 196,v,140,v,144
TR 144,196,32768
TR 146,196,34816
MA 204,v,140,v,148
TR 148,197,32768
TR 150,197,34816
MA 212,v,140,v,152
ds_read_b128 v[84:87], v192 offset:2048
buffer_load_dwordx4 v184, s[12:15], s21 offen offset:0 lds
MA 220,v,140,v,156
s_xor_b32 s81, s80, s2
s_and_b32 s81, s81, 1
MA 208,v,136,v,152
buffer_load_dwordx4 v185, s[12:15], s21 offen offset:1024 lds
s_lshl_b32 s70, s80, 1
MA 216,v,136,v,156
s_add_u32 s70, s70, s81
s_lshl_b32 s80, s3, 1
MA 148,v,132,v,152
s_sub_u32 s80, 7, s80
s_lshl_b32 s76, s80, 17
MA 156,v,132,v,156
ds_read_b128 v[88:91], v192 offset:4096
s_lshl_b32 s80, s3, 15
MA 144,v,128,v,152
s_lshl_b32 s65, s70, 18
s_sub_u32 s64, 3932160, s65
MA 152,v,128,v,156
buffer_load_dwordx4 v186, s[12:15], s21 offen offset:2048 lds
s_add_u32 s65, s65, s80
MA 84,v,124,v,152
s_add_u32 s64, s64, s80
MA 92,v,124,v,156
s_lshl_b32 s81, s69, 12
MA 80,v,120,v,152
ds_read_b128 v[92:95], v192 offset:6144
s_lshl_b32 s100, s64, 2
MA 88,v,120,v,156
buffer_load_dwordx4 v187, s[12:15], s21 offen offset:3072 lds
s_add_u32 s100, s100, s81
MA 20,v,116,v,152
s_lshl_b32 s101, s65, 2
MA 28,v,116,v,156
s_add_u32 s101, s101, s81
MA 16,v,112,v,152
TR 152,198,32768
TR 154,198,34816
MA 24,v,112,v,156
TR 156,199,32768
TR 158,199,34816
MA 32,v,112,v,160
ds_read_b128 v[96:99], v192 offset:8192
s_add_u32 m0, s23, 4096
MA 40,v,112,v,164
s_lshl_b32 s66, s3, 17
s_lshl_b32 s81, s69, 8
MA 36,v,116,v,160
s_add_u32 s66, s66, s81
s_and_b32 s74, s2, 7
MA 44,v,116,v,164
s_lshl_b32 s74, s74, 8
s_mov_b32 s82, s66
MA 96,v,120,v,160
ds_read_b128 v[100:103], v192 offset:10240
buffer_load_dwordx4 v188, s[12:15], s21 offen offset:0 lds
MA 104,v,120,v,164
s_lshl_b32 s66, s74, 12
s_lshl_b32 s67, s3, 13
MA 100,v,124,v,160
s_lshl_b32 s68, s3, 12
s_lshl_b32 s77, s70, 1
MA 108,v,124,v,164
s_sub_u32 s77, 32, s77
MA 160,v,128,v,160
buffer_load_dwordx4 v189, s[12:15], s21 offen offset:1024 lds
v_lshrrev_b32 v66, 3, v1
MA 168,v,128,v,164
ds_read_b128 v[104:107], v192 offset:12288
v_lshlrev_b32 v66, 11, v66
MA 164,v,132,v,160
v_lshrrev_b32 v67, 4, v1
v_and_b32 v68, 7, v1
MA 172,v,132,v,164
v_xor_b32 v68, v68, v67
MA 224,v,136,v,160
buffer_load_dwordx4 v190, s[12:15], s21 offen offset:2048 lds
v_lshl_add_u32 v66, v68, 4, v66
MA 232,v,136,v,164
v_xor_b32 v69, 64, v66
MA 228,v,140,v,160
TR 160,200,32768
TR 162,200,34816
MA 236,v,140,v,164
TR 164,201,32768
TR 166,201,34816
MA 244,v,140,v,168
ds_read_b128 v[108:111], v192 offset:14336
s_lshr_b32 s83, s76, 2
MA 252,v,140,v,172
buffer_load_dwordx4 v191, s[12:15], s21 offen offset:3072 lds
v_add_u32 v208, 0, v66
MA 240,v,136,v,168
v_add_u32 v209, 15360, v69
v_add_u32 v210, -2048, v66
MA 248,v,136,v,172
v_add_u32 v210, s83, v210
v_add_u32 v211, 13312, v69
MA 180,v,132,v,168
v_add_u32 v211, s83, v211
v_and_b32 v68, 15, v1
MA 188,v,132,v,172
s_add_u32 s21, s21, 524288
v_lshlrev_b32 v69, 1, v67
MA 176,v,128,v,168
v_xor_b32 v68, v68, v69
MA 184,v,128,v,172
v_lshlrev_b32 v66, 13, v67
MA 116,v,124,v,168
v_xor_b32 v69, 0, v68
MA 124,v,124,v,172
s_and_b32 s21, s21, 4194303
v_lshl_add_u32 v69, v69, 4, v66
MA 112,v,120,v,168
v_add_u32 v212, 0, v69
MA 120,v,120,v,172
v_xor_b32 v69, 0, v68
MA 52,v,116,v,168
v_lshl_add_u32 v69, v69, 4, v66
MA 60,v,116,v,172
v_add_u32 v213, 31744, v69
MA 48,v,112,v,168
TR 168,202,32768
TR 170,202,34816
MA 56,v,112,v,172
TR 172,203,32768
TR 174,203,34816
s_waitcnt lgkmcnt(4)
MA 0,v,80,v,144
s_add_u32 m0, s22, 65536
buffer_load_dwordx2 v[18:19], v253, s[84:87], 0 offen
MA 8,v,80,v,148
ds_read_b128 v[112:115], v193 offset:0
MA 4,v,84,v,144
MA 12,v,84,v,148
MA 64,v,88,v,144
v_add_u32 v254, 4096, v229
MA 72,v,88,v,148
buffer_load_dwordx4 v176, s[8:11], s20 offen offset:0 lds
MA 68,v,92,v,144
MA 76,v,92,v,148
ds_read_b128 v[116:119], v193 offset:2048
MA 128,v,96,v,144
MA 136,v,96,v,148
buffer_load_dwordx2 v[20:21], v254, s[84:87], 0 offen
MA 132,v,100,v,144
buffer_load_dwordx4 v177, s[8:11], s20 offen offset:1024 lds
MA 140,v,100,v,148
MA 192,v,104,v,144
MA 200,v,104,v,148
ds_read_b128 v[120:123], v193 offset:4096
MA 196,v,108,v,144
TR 144,196,49152
TR 146,196,51200
MA 204,v,108,v,148
TR 148,197,49152
TR 150,197,51200
MA 212,v,108,v,152
buffer_load_dwordx4 v178, s[8:11], s20 offen offset:2048 lds
v_add_u32 v255, 6144, v229
MA 220,v,108,v,156
MA 208,v,104,v,152
MA 216,v,104,v,156
buffer_load_dwordx2 v[22:23], v255, s[84:87], 0 offen
MA 148,v,100,v,152
ds_read_b128 v[124:127], v193 offset:6144
buffer_load_dwordx4 v179, s[8:11], s20 offen offset:3072 lds
MA 156,v,100,v,156
MA 144,v,96,v,152
MA 152,v,96,v,156
buffer_load_dwordx2 v[38:39], v255, s[88:91], 0 offen
MA 84,v,92,v,152
MA 92,v,92,v,156
s_add_u32 m0, s22, 69632
MA 80,v,88,v,152
ds_read_b128 v[128:131], v193 offset:8192
MA 88,v,88,v,156
MA 20,v,84,v,152
v_add_u32 v252, 8192, v229
MA 28,v,84,v,156
MA 16,v,80,v,152
TR 152,198,49152
TR 154,198,51200
MA 24,v,80,v,156
TR 156,199,49152
TR 158,199,51200
MA 32,v,80,v,160
ds_read_b128 v[132:135], v193 offset:10240
buffer_load_dwordx4 v180, s[8:11], s20 offen offset:0 lds
MA 40,v,80,v,164
buffer_load_dwordx2 v[24:25], v252, s[84:87], 0 offen
MA 36,v,84,v,160
MA 44,v,84,v,164
MA 96,v,88,v,160
buffer_load_dwordx4 v181, s[8:11], s20 offen offset:1024 lds
MA 104,v,88,v,164
MA 100,v,92,v,160
buffer_load_dwordx2 v[40:41], v252, s[88:91], 0 offen
MA 108,v,92,v,164
ds_read_b128 v[136:139], v193 offset:12288
MA 160,v,96,v,160
MA 168,v,96,v,164
buffer_load_dwordx4 v182, s[8:11], s20 offen offset:2048 lds
MA 164,v,100,v,160
v_add_u32 v253, 10240, v229
MA 172,v,100,v,164
MA 224,v,104,v,160
MA 232,v,104,v,164
ds_read_b128 v[140:143], v193 offset:14336
MA 228,v,108,v,160
TR 160,200,49152
TR 162,200,51200
MA 236,v,108,v,164
TR 164,201,49152
TR 166,201,51200
s_waitcnt lgkmcnt(15)
MA 244,v,108,v,168
buffer_load_dwordx4 v183, s[8:11], s20 offen offset:3072 lds
buffer_load_dwordx2 v[26:27], v253, s[84:87], 0 offen
MA 252,v,108,v,172
MA 240,v,104,v,168
MA 248,v,104,v,172
s_add_u32 s20, s20, 128
MA 180,v,100,v,168
buffer_load_dwordx2 v[42:43], v253, s[88:91], 0 offen
MA 188,v,100,v,172
MA 176,v,96,v,168
MA 184,v,96,v,172
MA 116,v,92,v,168
s_and_b32 s20, s20, 1023
MA 124,v,92,v,172
v_add_u32 v254, 12288, v229
MA 112,v,88,v,168
MA 120,v,88,v,172
MA 52,v,84,v,168
MA 60,v,84,v,172
MA 48,v,80,v,168
TR 168,202,49152
TR 170,202,51200
MA 56,v,80,v,172
TR 172,203,49152
TR 174,203,51200
s_waitcnt lgkmcnt(4)
MA 0,v,112,v,144
MA 8,v,112,v,148
MA 4,v,116,v,144
MA 12,v,116,v,148
MA 64,v,120,v,144
MA 72,v,120,v,148
MA 68,v,124,v,144
MA 76,v,124,v,148
MA 128,v,128,v,144
MA 136,v,128,v,148
s_waitcnt vmcnt(16) lgkmcnt(0)
s_barrier
MA 132,v,132,v,144
s_add_u32 m0, s23, 32768
v_xor_b32 v69, 8, v68
MA 140,v,132,v,148
ds_read_b128 v[80:83], v192 offset:32768
v_lshl_add_u32 v69, v69, 4, v66
MA 192,v,136,v,144
v_add_u32 v214, 63488, v69
v_xor_b32 v69, 8, v68
MA 200,v,136,v,148
v_lshl_add_u32 v69, v69, 4, v66
MA 196,v,140,v,144
TR 144,196,0
TR 146,196,2048
MA 204,v,140,v,148
TR 148,197,0
TR 150,197,2048
MA 212,v,140,v,152
ds_read_b128 v[84:87], v192 offset:34816
buffer_load_dwordx4 v184, s[12:15], s21 offen offset:0 lds
MA 220,v,140,v,156
v_add_u32 v215, 95232, v69
v_and_b32 v66, 15, v1
MA 208,v,136,v,152
buffer_load_dwordx4 v185, s[12:15], s21 offen offset:1024 lds
v_lshrrev_b32 v68, 1, v66
MA 216,v,136,v,156
v_xor_b32 v68, v68, v67
v_lshlrev_b32 v68, 4, v68
MA 148,v,132,v,152
v_lshl_add_u32 v68, v66, 7, v68
v_add_u32 v224, s67, v68
MA 156,v,132,v,156
ds_read_b128 v[88:91], v192 offset:36864
v_xor_b32 v225, 64, v224
MA 144,v,128,v,152
v_add_u32 v226, 0x10000, v224
v_add_u32 v227, 0x10000, v225
MA 152,v,128,v,156
buffer_load_dwordx4 v186, s[12:15], s21 offen offset:2048 lds
v_bfe_u32 v66, v1, 2, 2
MA 84,v,124,v,152
v_and_b32 v68, 1, v67
v_lshl_or_b32 v68, v68, 2, v66
MA 92,v,124,v,156
v_lshl_add_u32 v66, v67, 3, v66
v_lshlrev_b32 v66, 8, v66
MA 80,v,120,v,152
ds_read_b128 v[92:95], v192 offset:38912
v_and_b32 v69, 3, v1
MA 88,v,120,v,156
buffer_load_dwordx4 v187, s[12:15], s21 offen offset:3072 lds
v_lshl_add_u32 v66, v69, 3, v66
MA 20,v,116,v,152
v_add_u32 v66, 98304, v66
MA 28,v,116,v,156
v_xor_b32 v69, 0, v68
MA 16,v,112,v,152
TR 152,198,0
TR 154,198,2048
MA 24,v,112,v,156
TR 156,199,0
TR 158,199,2048
MA 32,v,112,v,160
ds_read_b128 v[96:99], v192 offset:40960
s_add_u32 m0, s23, 36864
MA 40,v,112,v,164
v_lshl_add_u32 v216, v69, 5, v66
v_xor_b32 v69, 1, v68
MA 36,v,116,v,160
v_lshl_add_u32 v217, v69, 5, v66
v_xor_b32 v69, 2, v68
MA 44,v,116,v,164
v_lshl_add_u32 v218, v69, 5, v66
v_xor_b32 v69, 3, v68
MA 96,v,120,v,160
ds_read_b128 v[100:103], v192 offset:43008
buffer_load_dwordx4 v188, s[12:15], s21 offen offset:0 lds
MA 104,v,120,v,164
v_lshl_add_u32 v219, v69, 5, v66
v_xor_b32 v69, 4, v68
MA 100,v,124,v,160
v_lshl_add_u32 v220, v69, 5, v66
v_xor_b32 v69, 5, v68
MA 108,v,124,v,164
v_lshl_add_u32 v221, v69, 5, v66
v_xor_b32 v69, 6, v68
MA 160,v,128,v,160
buffer_load_dwordx4 v189, s[12:15], s21 offen offset:1024 lds
v_lshl_add_u32 v222, v69, 5, v66
MA 168,v,128,v,164
ds_read_b128 v[104:107], v192 offset:45056
v_xor_b32 v69, 7, v68
MA 164,v,132,v,160
v_lshl_add_u32 v223, v69, 5, v66
s_mov_b32 s44, s32
MA 172,v,132,v,164
s_mov_b32 s45, s33
MA 224,v,136,v,160
buffer_load_dwordx4 v190, s[12:15], s21 offen offset:2048 lds
s_mov_b32 s46, 4194304
MA 232,v,136,v,164
s_mov_b32 s47, 0x20000
MA 228,v,140,v,160
TR 160,200,0
TR 162,200,2048
MA 236,v,140,v,164
TR 164,201,0
TR 166,201,2048
MA 244,v,140,v,168
ds_read_b128 v[108:111], v192 offset:47104
MA 252,v,140,v,172
buffer_load_dwordx4 v191, s[12:15], s21 offen offset:3072 lds
MA 240,v,136,v,168
s_add_u32 s48, s34, s82
s_addc_u32 s49, s35, 0
MA 248,v,136,v,172
s_sub_u32 s50, 8388608, s82
s_mov_b32 s51, 0x20000
MA 180,v,132,v,168
s_add_u32 s60, s40, 33554432
s_addc_u32 s61, s41, 0
MA 188,v,132,v,172
s_add_u32 s21, s21, 524288
s_mov_b32 s62, 16777216
MA 176,v,128,v,168
s_mov_b32 s63, 0x20000
s_lshl_b32 s80, s69, 19
MA 184,v,128,v,172
s_add_u32 s52, s40, s80
s_addc_u32 s53, s41, 0
MA 116,v,124,v,168
s_lshl_b32 s54, s77, 14
s_mov_b32 s55, 0x20000
MA 124,v,124,v,172
s_and_b32 s21, s21, 4194303
s_add_u32 s80, s80, 16760832
MA 112,v,120,v,168
s_add_u32 s56, s40, s80
s_addc_u32 s57, s41, 0
MA 120,v,120,v,172
s_add_u32 s58, s54, 16384
MA 52,v,116,v,168
s_mov_b32 s59, 0x20000
MA 60,v,116,v,172
s_load_dwordx2 s[38:39], s[0:1], 112
MA 48,v,112,v,168
TR 168,202,0
TR 170,202,2048
MA 56,v,112,v,172
TR 172,203,0
TR 174,203,2048
s_waitcnt lgkmcnt(4)
MA 0,v,80,v,144
s_add_u32 m0, s22, 0
buffer_load_dwordx2 v[28:29], v254, s[84:87], 0 offen
MA 8,v,80,v,148
ds_read_b128 v[112:115], v193 offset:32768
MA 4,v,84,v,144
MA 12,v,84,v,148
MA 64,v,88,v,144
buffer_load_dwordx2 v[44:45], v254, s[88:91], 0 offen
MA 72,v,88,v,148
buffer_load_dwordx4 v176, s[8:11], s20 offen offset:0 lds
MA 68,v,92,v,144
MA 76,v,92,v,148
ds_read_b128 v[116:119], v193 offset:34816
MA 128,v,96,v,144
v_add_u32 v255, 14336, v229
MA 136,v,96,v,148
MA 132,v,100,v,144
buffer_load_dwordx4 v177, s[8:11], s20 offen offset:1024 lds
MA 140,v,100,v,148
MA 192,v,104,v,144
MA 200,v,104,v,148
ds_read_b128 v[120:123], v193 offset:36864
buffer_load_dwordx2 v[30:31], v255, s[84:87], 0 offen
MA 196,v,108,v,144
TR 144,196,16384
TR 146,196,18432
MA 204,v,108,v,148
TR 148,197,16384
TR 150,197,18432
MA 212,v,108,v,152
buffer_load_dwordx4 v178, s[8:11], s20 offen offset:2048 lds
MA 220,v,108,v,156
buffer_load_dwordx2 v[46:47], v255, s[88:91], 0 offen
MA 208,v,104,v,152
MA 216,v,104,v,156
MA 148,v,100,v,152
ds_read_b128 v[124:127], v193 offset:38912
buffer_load_dwordx4 v179, s[8:11], s20 offen offset:3072 lds
MA 156,v,100,v,156
MA 144,v,96,v,152
v_add_u32 v252, 16384, v229
MA 152,v,96,v,156
MA 84,v,92,v,152
MA 92,v,92,v,156
s_add_u32 m0, s22, 4096
MA 80,v,88,v,152
ds_read_b128 v[128:131], v193 offset:40960
buffer_load_dwordx2 v[32:33], v252, s[84:87], 0 offen
MA 88,v,88,v,156
MA 20,v,84,v,152
MA 28,v,84,v,156
MA 16,v,80,v,152
TR 152,198,16384
TR 154,198,18432
MA 24,v,80,v,156
TR 156,199,16384
TR 158,199,18432
MA 32,v,80,v,160
ds_read_b128 v[132:135], v193 offset:43008
buffer_load_dwordx4 v180, s[8:11], s20 offen offset:0 lds
MA 40,v,80,v,164
buffer_load_dwordx2 v[48:49], v252, s[88:91], 0 offen
MA 36,v,84,v,160
MA 44,v,84,v,164
v_add_u32 v253, 18432, v229
MA 96,v,88,v,160
buffer_load_dwordx4 v181, s[8:11], s20 offen offset:1024 lds
MA 104,v,88,v,164
MA 100,v,92,v,160
MA 108,v,92,v,164
ds_read_b128 v[136:139], v193 offset:45056
buffer_load_dwordx2 v[34:35], v253, s[84:87], 0 offen
MA 160,v,96,v,160
MA 168,v,96,v,164
buffer_load_dwordx4 v182, s[8:11], s20 offen offset:2048 lds
MA 164,v,100,v,160
MA 172,v,100,v,164
MA 224,v,104,v,160
buffer_load_dwordx2 v[50:51], v253, s[88:91], 0 offen
MA 232,v,104,v,164
ds_read_b128 v[140:143], v193 offset:47104
MA 228,v,108,v,160
TR 160,200,16384
TR 162,200,18432
MA 236,v,108,v,164
TR 164,201,16384
TR 166,201,18432
s_waitcnt lgkmcnt(15)
MA 244,v,108,v,168
buffer_load_dwordx4 v183, s[8:11], s20 offen offset:3072 lds
v_add_u32 v254, 20480, v229
MA 252,v,108,v,172
MA 240,v,104,v,168
MA 248,v,104,v,172
s_add_u32 s20, s20, 128
MA 180,v,100,v,168
MA 188,v,100,v,172
buffer_load_dwordx2 v[36:37], v254, s[84:87], 0 offen
MA 176,v,96,v,168
MA 184,v,96,v,172
MA 116,v,92,v,168
s_and_b32 s20, s20, 1023
MA 124,v,92,v,172
buffer_load_dwordx2 v[52:53], v254, s[88:91], 0 offen
MA 112,v,88,v,168
MA 120,v,88,v,172
MA 52,v,84,v,168
MA 60,v,84,v,172
MA 48,v,80,v,168
TR 168,202,16384
TR 170,202,18432
MA 56,v,80,v,172
TR 172,203,16384
TR 174,203,18432
s_waitcnt lgkmcnt(4)
MA 0,v,112,v,144
MA 8,v,112,v,148
MA 4,v,116,v,144
MA 12,v,116,v,148
MA 64,v,120,v,144
MA 72,v,120,v,148
MA 68,v,124,v,144
MA 76,v,124,v,148
MA 128,v,128,v,144
MA 136,v,128,v,148
s_waitcnt vmcnt(18) lgkmcnt(0)
s_barrier
MA 132,v,132,v,144
s_add_u32 m0, s23, 0
s_and_b32 s37, s3, 3
MA 140,v,132,v,148
ds_read_b128 v[80:83], v194 offset:0
MA 192,v,136,v,144
s_cmp_eq_u32 s37, 0
s_cselect_b32 s37, 0, 0x40000000
MA 200,v,136,v,148
MA 196,v,140,v,144
TR 144,196,32768
TR 146,196,34816
MA 204,v,140,v,148
TR 148,197,32768
TR 150,197,34816
MA 212,v,140,v,152
ds_read_b128 v[84:87], v194 offset:2048
buffer_load_dwordx4 v184, s[12:15], s21 offen offset:0 lds
MA 220,v,140,v,156
v_add_u32 v229, s37, v78
MA 208,v,136,v,152
buffer_load_dwordx4 v185, s[12:15], s21 offen offset:1024 lds
MA 216,v,136,v,156
buffer_load_dword v79, v229, s[4:7], 0 offen
MA 148,v,132,v,152
MA 156,v,132,v,156
ds_read_b128 v[88:91], v194 offset:4096
s_getpc_b64 s[82:83]
L_ct_fV:
MA 144,v,128,v,152
MA 152,v,128,v,156
buffer_load_dwordx4 v186, s[12:15], s21 offen offset:2048 lds
MA 84,v,124,v,152
s_add_u32 s82, s82, L_p2 - L_ct_fV
s_addc_u32 s83, s83, 0
MA 92,v,124,v,156
MA 80,v,120,v,152
ds_read_b128 v[92:95], v194 offset:6144
MA 88,v,120,v,156
buffer_load_dwordx4 v187, s[12:15], s21 offen offset:3072 lds
MA 20,v,116,v,152
v_mov_b32 v67, s83
MA 28,v,116,v,156
MA 16,v,112,v,152
TR 152,198,32768
TR 154,198,34816
MA 24,v,112,v,156
TR 156,199,32768
TR 158,199,34816
MA 32,v,112,v,160
ds_read_b128 v[96:99], v194 offset:8192
s_add_u32 m0, s23, 4096
MA 40,v,112,v,164
v_mov_b32 v66, s82
s_lshr_b32 s82, s2, 3
MA 36,v,116,v,160
s_lshl_b32 s82, s82, 2
MA 44,v,116,v,164
MA 96,v,120,v,160
ds_read_b128 v[100:103], v194 offset:10240
buffer_load_dwordx4 v188, s[12:15], s21 offen offset:0 lds
MA 104,v,120,v,164
s_add_u32 s82, s82, s3
MA 100,v,124,v,160
MA 108,v,124,v,164
s_lshl_b32 s82, s82, 7
MA 160,v,128,v,160
buffer_load_dwordx4 v189, s[12:15], s21 offen offset:1024 lds
MA 168,v,128,v,164
ds_read_b128 v[104:107], v194 offset:12288
v_and_b32 v68, 3, v1
MA 164,v,132,v,160
MA 172,v,132,v,164
v_lshlrev_b32 v68, 14, v68
MA 224,v,136,v,160
buffer_load_dwordx4 v190, s[12:15], s21 offen offset:2048 lds
MA 232,v,136,v,164
MA 228,v,140,v,160
TR 160,200,32768
TR 162,200,34816
MA 236,v,140,v,164
TR 164,201,32768
TR 166,201,34816
MA 244,v,140,v,168
ds_read_b128 v[108:111], v194 offset:14336
v_add_u32 v68, s82, v68
MA 252,v,140,v,172
buffer_load_dwordx4 v191, s[12:15], s21 offen offset:3072 lds
v_min_u32 v68, L_p3_begin - L_p2 - 4, v68
MA 240,v,136,v,168
v_add_co_u32 v66, vcc, v66, v68
s_nop 1
v_addc_co_u32 v67, vcc, 0, v67, vcc
MA 248,v,136,v,172
MA 180,v,132,v,168
MA 188,v,132,v,172
s_add_u32 s21, s21, 524288
MA 176,v,128,v,168
MA 184,v,128,v,172
MA 116,v,124,v,168
MA 124,v,124,v,172
s_and_b32 s21, s21, 4194303
MA 112,v,120,v,168
MA 120,v,120,v,172
global_load_dword v68, v[66:67], off
MA 52,v,116,v,168
MA 60,v,116,v,172
MA 48,v,112,v,168
TR 168,202,32768
TR 170,202,34816
MA 56,v,112,v,172
TR 172,203,32768
TR 174,203,34816
s_waitcnt lgkmcnt(4)
MA 0,v,80,v,144
s_add_u32 m0, s22, 32768
s_and_b32 s37, s3, 3
MA 8,v,80,v,148
ds_read_b128 v[112:115], v195 offset:0
MA 4,v,84,v,144
MA 12,v,84,v,148
MA 64,v,88,v,144
MA 72,v,88,v,148
buffer_load_dwordx4 v176, s[8:11], s20 offen offset:0 lds
MA 68,v,92,v,144
MA 76,v,92,v,148
ds_read_b128 v[116:119], v195 offset:2048
MA 128,v,96,v,144
MA 136,v,96,v,148
MA 132,v,100,v,144
buffer_load_dwordx4 v177, s[8:11], s20 offen offset:1024 lds
MA 140,v,100,v,148
MA 192,v,104,v,144
s_cmp_eq_u32 s37, 1
s_cselect_b32 s37, 0, 0x40000000
MA 200,v,104,v,148
ds_read_b128 v[120:123], v195 offset:4096
MA 196,v,108,v,144
TR 144,196,49152
TR 146,196,51200
MA 204,v,108,v,148
TR 148,197,49152
TR 150,197,51200
MA 212,v,108,v,152
buffer_load_dwordx4 v178, s[8:11], s20 offen offset:2048 lds
MA 220,v,108,v,156
MA 208,v,104,v,152
MA 216,v,104,v,156
MA 148,v,100,v,152
ds_read_b128 v[124:127], v195 offset:6144
buffer_load_dwordx4 v179, s[8:11], s20 offen offset:3072 lds
MA 156,v,100,v,156
MA 144,v,96,v,152
MA 152,v,96,v,156
MA 84,v,92,v,152
MA 92,v,92,v,156
s_add_u32 m0, s22, 36864
MA 80,v,88,v,152
ds_read_b128 v[128:131], v195 offset:8192
MA 88,v,88,v,156
MA 20,v,84,v,152
MA 28,v,84,v,156
MA 16,v,80,v,152
TR 152,198,49152
TR 154,198,51200
MA 24,v,80,v,156
TR 156,199,49152
TR 158,199,51200
MA 32,v,80,v,160
ds_read_b128 v[132:135], v195 offset:10240
buffer_load_dwordx4 v180, s[8:11], s20 offen offset:0 lds
MA 40,v,80,v,164
MA 36,v,84,v,160
MA 44,v,84,v,164
MA 96,v,88,v,160
buffer_load_dwordx4 v181, s[8:11], s20 offen offset:1024 lds
MA 104,v,88,v,164
v_add_u32 v229, s37, v78
MA 100,v,92,v,160
MA 108,v,92,v,164
ds_read_b128 v[136:139], v195 offset:12288
MA 160,v,96,v,160
MA 168,v,96,v,164
buffer_load_dwordx4 v182, s[8:11], s20 offen offset:2048 lds
MA 164,v,100,v,160
MA 172,v,100,v,164
MA 224,v,104,v,160
MA 232,v,104,v,164
ds_read_b128 v[140:143], v195 offset:14336
MA 228,v,108,v,160
TR 160,200,49152
TR 162,200,51200
MA 236,v,108,v,164
TR 164,201,49152
TR 166,201,51200
s_waitcnt lgkmcnt(15)
MA 244,v,108,v,168
buffer_load_dwordx4 v183, s[8:11], s20 offen offset:3072 lds
MA 252,v,108,v,172
buffer_load_dword v79, v229, s[4:7], 0 offen
MA 240,v,104,v,168
MA 248,v,104,v,172
s_add_u32 s20, s20, 128
MA 180,v,100,v,168
MA 188,v,100,v,172
MA 176,v,96,v,168
MA 184,v,96,v,172
MA 116,v,92,v,168
s_and_b32 s20, s20, 1023
MA 124,v,92,v,172
MA 112,v,88,v,168
MA 120,v,88,v,172
MA 52,v,84,v,168
MA 60,v,84,v,172
MA 48,v,80,v,168
TR 168,202,49152
TR 170,202,51200
MA 56,v,80,v,172
TR 172,203,49152
TR 174,203,51200
s_waitcnt lgkmcnt(4)
MA 0,v,112,v,144
MA 8,v,112,v,148
MA 4,v,116,v,144
MA 12,v,116,v,148
MA 64,v,120,v,144
MA 72,v,120,v,148
MA 68,v,124,v,144
MA 76,v,124,v,148
MA 128,v,128,v,144
MA 136,v,128,v,148
s_waitcnt vmcnt(10) lgkmcnt(0)
s_barrier
MA 132,v,132,v,144
s_add_u32 m0, s23, 32768
s_and_b32 s37, s3, 3
MA 140,v,132,v,148
ds_read_b128 v[80:83], v192 offset:0
MA 192,v,136,v,144
s_cmp_eq_u32 s37, 2
s_cselect_b32 s37, 0, 0x40000000
MA 200,v,136,v,148
v_add_u32 v229, s37, v78
buffer_load_dword v79, v229, s[4:7], 0 offen
MA 196,v,140,v,144
TR 144,196,0
TR 146,196,2048
MA 204,v,140,v,148
TR 148,197,0
TR 150,197,2048
MA 212,v,140,v,152
ds_read_b128 v[84:87], v192 offset:2048
buffer_load_dwordx4 v184, s[12:15], s21 offen offset:0 lds
MA 220,v,140,v,156
s_add_u32 s84, s40, 50331648
s_addc_u32 s85, s41, 0
MA 208,v,136,v,152
buffer_load_dwordx4 v185, s[12:15], s21 offen offset:1024 lds
s_mov_b32 s86, 4194304
MA 216,v,136,v,156
s_mov_b32 s87, 0x20000
MA 148,v,132,v,152
s_add_u32 s88, s40, 58720256
s_addc_u32 s89, s41, 0
MA 156,v,132,v,156
ds_read_b128 v[88:91], v192 offset:4096
s_mov_b32 s90, 8192
MA 144,v,128,v,152
s_mov_b32 s91, 0x20000
v_mov_b32 v252, 0
MA 152,v,128,v,156
buffer_load_dwordx4 v186, s[12:15], s21 offen offset:2048 lds
v_mov_b32 v253, 0
MA 84,v,124,v,152
v_dot2_f32_bf16 v252, v230, v2, v252
v_dot2_f32_bf16 v253, v231, v3, v253
MA 92,v,124,v,156
v_dot2_f32_bf16 v252, v232, v4, v252
v_dot2_f32_bf16 v253, v233, v5, v253
MA 80,v,120,v,152
ds_read_b128 v[92:95], v192 offset:6144
v_dot2_f32_bf16 v252, v234, v6, v252
MA 88,v,120,v,156
buffer_load_dwordx4 v187, s[12:15], s21 offen offset:3072 lds
v_dot2_f32_bf16 v253, v235, v7, v253
MA 20,v,116,v,152
v_dot2_f32_bf16 v252, v236, v8, v252
v_dot2_f32_bf16 v253, v237, v9, v253
MA 28,v,116,v,156
v_dot2_f32_bf16 v252, v238, v12, v252
v_dot2_f32_bf16 v253, v239, v13, v253
MA 16,v,112,v,152
TR 152,198,0
TR 154,198,2048
MA 24,v,112,v,156
TR 156,199,0
TR 158,199,2048
MA 32,v,112,v,160
ds_read_b128 v[96:99], v192 offset:8192
s_add_u32 m0, s23, 36864
MA 40,v,112,v,164
v_dot2_f32_bf16 v252, v240, v14, v252
v_dot2_f32_bf16 v253, v241, v15, v253
MA 36,v,116,v,160
v_dot2_f32_bf16 v252, v242, v246, v252
v_dot2_f32_bf16 v253, v243, v247, v253
MA 44,v,116,v,164
v_dot2_f32_bf16 v252, v244, v248, v252
v_dot2_f32_bf16 v253, v245, v249, v253
MA 96,v,120,v,160
ds_read_b128 v[100:103], v192 offset:10240
buffer_load_dwordx4 v188, s[12:15], s21 offen offset:0 lds
MA 104,v,120,v,164
s_nop 2
v_add_f32 v252, v252, v253
MA 100,v,124,v,160
s_nop 0
v_add_f32_dpp v252, v252, v252 row_ror:8 row_mask:0xf bank_mask:0xf
s_nop 1
v_add_f32_dpp v252, v252, v252 row_ror:4 row_mask:0xf bank_mask:0xf
MA 108,v,124,v,164
s_nop 0
v_add_f32_dpp v252, v252, v252 row_ror:2 row_mask:0xf bank_mask:0xf
s_nop 1
v_add_f32_dpp v252, v252, v252 row_ror:1 row_mask:0xf bank_mask:0xf
MA 160,v,128,v,160
buffer_load_dwordx4 v189, s[12:15], s21 offen offset:1024 lds
v_mov_b32 v253, v252
MA 168,v,128,v,164
ds_read_b128 v[104:107], v192 offset:12288
v_permlane16_swap_b32 v252, v253
MA 164,v,132,v,160
v_add_f32 v252, v252, v253
v_mul_f32 v252, 0xbfb8aa3b, v252
MA 172,v,132,v,164
v_exp_f32 v252, v252
MA 224,v,136,v,160
buffer_load_dwordx4 v190, s[12:15], s21 offen offset:2048 lds
v_add_f32 v252, 1.0, v252
MA 232,v,136,v,164
v_rcp_f32 v252, v252
MA 228,v,140,v,160
TR 160,200,0
TR 162,200,2048
MA 236,v,140,v,164
TR 164,201,0
TR 166,201,2048
MA 244,v,140,v,168
ds_read_b128 v[108:111], v192 offset:14336
MA 252,v,140,v,172
buffer_load_dwordx4 v191, s[12:15], s21 offen offset:3072 lds
MA 240,v,136,v,168
s_nop 0
buffer_store_dword v252, v11, s[88:91], 0 offen sc1
MA 248,v,136,v,172
v_lshlrev_b32 v2, 16, v54
v_and_b32 v3, 0xffff0000, v54
MA 180,v,132,v,168
v_lshlrev_b32 v4, 16, v55
v_and_b32 v5, 0xffff0000, v55
MA 188,v,132,v,172
s_add_u32 s21, s21, 524288
v_lshlrev_b32 v6, 16, v56
MA 176,v,128,v,168
v_and_b32 v7, 0xffff0000, v56
v_lshlrev_b32 v8, 16, v57
MA 184,v,128,v,172
v_and_b32 v9, 0xffff0000, v57
v_lshlrev_b32 v230, 16, v16
MA 116,v,124,v,168
v_and_b32 v231, 0xffff0000, v16
v_lshlrev_b32 v232, 16, v18
MA 124,v,124,v,172
s_and_b32 s21, s21, 4194303
v_and_b32 v233, 0xffff0000, v18
MA 112,v,120,v,168
v_lshlrev_b32 v234, 16, v20
v_and_b32 v235, 0xffff0000, v20
MA 120,v,120,v,172
v_lshlrev_b32 v236, 16, v22
v_and_b32 v237, 0xffff0000, v22
MA 52,v,116,v,168
v_lshlrev_b32 v238, 16, v24
v_and_b32 v239, 0xffff0000, v24
MA 60,v,116,v,172
v_lshlrev_b32 v240, 16, v26
v_and_b32 v241, 0xffff0000, v26
MA 48,v,112,v,168
TR 168,202,0
TR 170,202,2048
MA 56,v,112,v,172
TR 172,203,0
TR 174,203,2048
v_lshlrev_b32 v242, 16, v28
v_and_b32 v243, 0xffff0000, v28
v_lshlrev_b32 v244, 16, v30
v_and_b32 v245, 0xffff0000, v30
v_lshlrev_b32 v246, 16, v32
v_and_b32 v247, 0xffff0000, v32
v_lshlrev_b32 v248, 16, v34
v_and_b32 v249, 0xffff0000, v34
v_lshlrev_b32 v250, 16, v36
v_and_b32 v251, 0xffff0000, v36
v_lshlrev_b32 v254, 16, v38
v_and_b32 v255, 0xffff0000, v38
v_mul_f32 v62, v236, v2
v_mul_f32 v70, v237, v6
v_fmac_f32 v62, v234, v3
v_fmac_f32 v70, v235, v7
v_fmac_f32 v62, v232, v4
v_fmac_f32 v70, v233, v8
v_fmac_f32 v62, v230, v5
v_fmac_f32 v70, v231, v9
v_mul_f32 v62, v62, v254
s_waitcnt lgkmcnt(4)
MA 0,v,80,v,144
s_add_u32 s75, s64, s74
s_and_b32 s37, s3, 3
MA 8,v,80,v,148
ds_read_b128 v[112:115], v193 offset:0
MA 4,v,84,v,144
s_cmp_eq_u32 s37, 3
s_cselect_b32 s37, 0, 0x40000000
MA 12,v,84,v,148
v_add_u32 v229, s37, v78
buffer_load_dword v79, v229, s[4:7], 0 offen
MA 64,v,88,v,144
s_add_u32 m0, s67, 65536
v_mul_f32 v70, v70, v255
MA 72,v,88,v,148
v_lshlrev_b32 v254, 16, v40
v_and_b32 v255, 0xffff0000, v40
MA 68,v,92,v,144
v_mul_f32 v63, v238, v2
v_mul_f32 v71, v239, v6
MA 76,v,92,v,148
ds_read_b128 v[116:119], v193 offset:2048
v_fmac_f32 v63, v236, v3
MA 128,v,96,v,144
buffer_load_dwordx4 v208, s[44:47], s75 offen offset:0 lds
v_fmac_f32 v71, v237, v7
MA 136,v,96,v,148
v_fmac_f32 v63, v234, v4
v_fmac_f32 v71, v235, v8
MA 132,v,100,v,144
v_fmac_f32 v63, v232, v5
MA 140,v,100,v,148
v_fmac_f32 v71, v233, v9
v_mul_f32 v63, v63, v254
MA 192,v,104,v,144
v_mul_f32 v71, v71, v255
MA 200,v,104,v,148
ds_read_b128 v[120:123], v193 offset:4096
buffer_load_dwordx4 v209, s[44:47], s75 offen offset:1024 lds
MA 196,v,108,v,144
TR 144,196,16384
TR 146,196,18432
MA 204,v,108,v,148
TR 148,197,16384
TR 150,197,18432
MA 212,v,108,v,152
v_lshlrev_b32 v254, 16, v42
v_and_b32 v255, 0xffff0000, v42
MA 220,v,108,v,156
buffer_load_dwordx4 v210, s[44:47], s75 offen offset:2048 lds
v_mul_f32 v64, v240, v2
MA 208,v,104,v,152
v_mul_f32 v72, v241, v6
v_fmac_f32 v64, v238, v3
MA 216,v,104,v,156
v_fmac_f32 v72, v239, v7
v_fmac_f32 v64, v236, v4
MA 148,v,100,v,152
ds_read_b128 v[124:127], v193 offset:6144
v_fmac_f32 v72, v237, v8
MA 156,v,100,v,156
v_fmac_f32 v64, v234, v5
v_fmac_f32 v72, v235, v9
MA 144,v,96,v,152
buffer_load_dwordx4 v211, s[44:47], s75 offen offset:3072 lds
v_mul_f32 v64, v64, v254
MA 152,v,96,v,156
v_mul_f32 v72, v72, v255
v_lshlrev_b32 v254, 16, v44
MA 84,v,92,v,152
v_and_b32 v255, 0xffff0000, v44
v_mul_f32 v65, v242, v2
MA 92,v,92,v,156
v_mul_f32 v73, v243, v6
v_fmac_f32 v65, v240, v3
MA 80,v,88,v,152
ds_read_b128 v[128:131], v193 offset:8192
s_add_u32 s75, s65, s74
MA 88,v,88,v,156
v_fmac_f32 v73, v241, v7
v_fmac_f32 v65, v238, v4
MA 20,v,84,v,152
v_fmac_f32 v73, v239, v8
v_fmac_f32 v65, v236, v5
MA 28,v,84,v,156
v_fmac_f32 v73, v237, v9
v_mul_f32 v65, v65, v254
MA 16,v,80,v,152
TR 152,198,16384
TR 154,198,18432
MA 24,v,80,v,156
TR 156,199,16384
TR 158,199,18432
MA 32,v,80,v,160
ds_read_b128 v[132:135], v193 offset:10240
s_add_u32 m0, s67, 69632
MA 40,v,80,v,164
v_mul_f32 v73, v73, v255
v_lshlrev_b32 v254, 16, v46
MA 36,v,84,v,160
v_and_b32 v255, 0xffff0000, v46
v_mul_f32 v66, v244, v2
MA 44,v,84,v,164
buffer_load_dwordx4 v208, s[44:47], s75 offen offset:0 lds
v_mul_f32 v74, v245, v6
MA 96,v,88,v,160
v_fmac_f32 v66, v242, v3
v_fmac_f32 v74, v243, v7
MA 104,v,88,v,164
v_fmac_f32 v66, v240, v4
v_fmac_f32 v74, v241, v8
MA 100,v,92,v,160
v_fmac_f32 v66, v238, v5
v_fmac_f32 v74, v239, v9
MA 108,v,92,v,164
ds_read_b128 v[136:139], v193 offset:12288
buffer_load_dwordx4 v209, s[44:47], s75 offen offset:1024 lds
MA 160,v,96,v,160
v_mul_f32 v66, v66, v254
v_mul_f32 v74, v74, v255
MA 168,v,96,v,164
v_lshlrev_b32 v254, 16, v48
v_and_b32 v255, 0xffff0000, v48
MA 164,v,100,v,160
v_mul_f32 v67, v246, v2
v_mul_f32 v75, v247, v6
MA 172,v,100,v,164
v_fmac_f32 v67, v244, v3
MA 224,v,104,v,160
buffer_load_dwordx4 v210, s[44:47], s75 offen offset:2048 lds
v_fmac_f32 v75, v245, v7
MA 232,v,104,v,164
ds_read_b128 v[140:143], v193 offset:14336
v_fmac_f32 v67, v242, v4
MA 228,v,108,v,160
TR 160,200,16384
TR 162,200,18432
MA 236,v,108,v,164
TR 164,201,16384
TR 166,201,18432
s_waitcnt lgkmcnt(15)
MA 244,v,108,v,168
buffer_load_dwordx4 v211, s[44:47], s75 offen offset:3072 lds
v_fmac_f32 v75, v243, v8
MA 252,v,108,v,172
v_fmac_f32 v67, v240, v5
v_fmac_f32 v75, v241, v9
MA 240,v,104,v,168
v_mul_f32 v67, v67, v254
v_mul_f32 v75, v75, v255
MA 248,v,104,v,172
v_lshlrev_b32 v254, 16, v50
v_and_b32 v255, 0xffff0000, v50
MA 180,v,100,v,168
s_waitcnt vmcnt(28)
v_mul_f32 v68, v248, v2
v_mul_f32 v76, v249, v6
MA 188,v,100,v,172
s_add_u32 s74, s74, 128
v_fmac_f32 v68, v246, v3
MA 176,v,96,v,168
v_fmac_f32 v76, v247, v7
v_fmac_f32 v68, v244, v4
MA 184,v,96,v,172
v_fmac_f32 v76, v245, v8
v_fmac_f32 v68, v242, v5
MA 116,v,92,v,168
v_fmac_f32 v76, v243, v9
v_mul_f32 v68, v68, v254
MA 124,v,92,v,172
s_and_b32 s74, s74, 2047
v_mul_f32 v76, v76, v255
MA 112,v,88,v,168
v_lshlrev_b32 v254, 16, v52
MA 120,v,88,v,172
v_and_b32 v255, 0xffff0000, v52
v_mul_f32 v69, v250, v2
MA 52,v,84,v,168
v_mul_f32 v77, v251, v6
MA 60,v,84,v,172
v_fmac_f32 v69, v248, v3
MA 48,v,80,v,168
TR 168,202,16384
TR 170,202,18432
MA 56,v,80,v,172
TR 172,203,16384
TR 174,203,18432
s_waitcnt lgkmcnt(4)
MA 0,v,112,v,144
MA 8,v,112,v,148
MA 4,v,116,v,144
MA 12,v,116,v,148
MA 64,v,120,v,144
MA 72,v,120,v,148
MA 68,v,124,v,144
MA 76,v,124,v,148
MA 128,v,128,v,144
MA 136,v,128,v,148
s_waitcnt vmcnt(10) lgkmcnt(0)
s_barrier
MA 132,v,132,v,144
s_add_u32 m0, s68, 98304
v_fmac_f32 v77, v249, v7
MA 140,v,132,v,148
ds_read_b128 v[80:83], v192 offset:32768
v_fmac_f32 v69, v246, v4
MA 192,v,136,v,144
v_fmac_f32 v77, v247, v8
v_fmac_f32 v69, v244, v5
MA 200,v,136,v,148
buffer_load_dwordx4 v212, s[48:51], s66 offen offset:0 lds
v_fmac_f32 v77, v245, v9
MA 196,v,140,v,144
TR 144,196,32768
TR 146,196,34816
MA 204,v,140,v,148
TR 148,197,32768
TR 150,197,34816
MA 212,v,140,v,152
ds_read_b128 v[84:87], v192 offset:34816
v_mul_f32 v69, v69, v254
MA 220,v,140,v,156
buffer_load_dwordx4 v213, s[48:51], s66 offen offset:1024 lds
v_mul_f32 v77, v77, v255
MA 208,v,136,v,152
v_cvt_pk_bf16_f32 v12, v69, v68
v_cvt_pk_bf16_f32 v13, v67, v66
MA 216,v,136,v,156
v_cvt_pk_bf16_f32 v14, v65, v64
v_cvt_pk_bf16_f32 v15, v63, v62
MA 148,v,132,v,152
s_mov_b32 s36, 0
buffer_store_dwordx4 v[12:15], v10, s[84:87], s36 offen sc1
MA 156,v,132,v,156
ds_read_b128 v[88:91], v192 offset:36864
buffer_load_dwordx4 v214, s[48:51], s66 offen offset:2048 lds
MA 144,v,128,v,152
v_cvt_pk_bf16_f32 v54, v77, v76
v_cvt_pk_bf16_f32 v55, v75, v74
MA 152,v,128,v,156
v_cvt_pk_bf16_f32 v56, v73, v72
v_cvt_pk_bf16_f32 v57, v71, v70
MA 84,v,124,v,152
buffer_load_dwordx4 v215, s[48:51], s66 offen offset:3072 lds
s_mov_b32 s36, 4096
MA 92,v,124,v,156
buffer_store_dwordx4 v[54:57], v10, s[84:87], s36 offen sc1
v_lshlrev_b32 v2, 16, v58
MA 80,v,120,v,152
ds_read_b128 v[92:95], v192 offset:38912
v_and_b32 v3, 0xffff0000, v58
MA 88,v,120,v,156
v_lshlrev_b32 v4, 16, v59
v_and_b32 v5, 0xffff0000, v59
MA 20,v,116,v,152
s_add_u32 s66, s66, 524288
v_lshlrev_b32 v6, 16, v60
MA 28,v,116,v,156
v_and_b32 v7, 0xffff0000, v60
v_lshlrev_b32 v8, 16, v61
MA 16,v,112,v,152
TR 152,198,32768
TR 154,198,34816
MA 24,v,112,v,156
TR 156,199,32768
TR 158,199,34816
MA 32,v,112,v,160
ds_read_b128 v[96:99], v192 offset:40960
s_and_b32 s66, s66, 8388607
MA 40,v,112,v,164
v_and_b32 v9, 0xffff0000, v61
v_lshlrev_b32 v230, 16, v17
MA 36,v,116,v,160
v_and_b32 v231, 0xffff0000, v17
v_lshlrev_b32 v232, 16, v19
MA 44,v,116,v,164
v_and_b32 v233, 0xffff0000, v19
v_lshlrev_b32 v234, 16, v21
MA 96,v,120,v,160
ds_read_b128 v[100:103], v192 offset:43008
s_add_u32 m0, s68, 114688
MA 104,v,120,v,164
v_and_b32 v235, 0xffff0000, v21
v_lshlrev_b32 v236, 16, v23
MA 100,v,124,v,160
v_and_b32 v237, 0xffff0000, v23
v_lshlrev_b32 v238, 16, v25
MA 108,v,124,v,164
buffer_load_dwordx4 v212, s[48:51], s66 offen offset:0 lds
v_and_b32 v239, 0xffff0000, v25
MA 160,v,128,v,160
v_lshlrev_b32 v240, 16, v27
v_and_b32 v241, 0xffff0000, v27
MA 168,v,128,v,164
ds_read_b128 v[104:107], v192 offset:45056
v_lshlrev_b32 v242, 16, v29
MA 164,v,132,v,160
v_and_b32 v243, 0xffff0000, v29
v_lshlrev_b32 v244, 16, v31
MA 172,v,132,v,164
buffer_load_dwordx4 v213, s[48:51], s66 offen offset:1024 lds
v_and_b32 v245, 0xffff0000, v31
MA 224,v,136,v,160
v_lshlrev_b32 v246, 16, v33
v_and_b32 v247, 0xffff0000, v33
MA 232,v,136,v,164
v_lshlrev_b32 v248, 16, v35
v_and_b32 v249, 0xffff0000, v35
MA 228,v,140,v,160
TR 160,200,32768
TR 162,200,34816
MA 236,v,140,v,164
TR 164,201,32768
TR 166,201,34816
MA 244,v,140,v,168
ds_read_b128 v[108:111], v192 offset:47104
buffer_load_dwordx4 v214, s[48:51], s66 offen offset:2048 lds
MA 252,v,140,v,172
v_lshlrev_b32 v250, 16, v37
v_and_b32 v251, 0xffff0000, v37
MA 240,v,136,v,168
buffer_load_dwordx4 v215, s[48:51], s66 offen offset:3072 lds
v_lshlrev_b32 v254, 16, v39
MA 248,v,136,v,172
v_and_b32 v255, 0xffff0000, v39
v_mul_f32 v62, v236, v2
MA 180,v,132,v,168
v_mul_f32 v70, v237, v6
v_fmac_f32 v62, v234, v3
MA 188,v,132,v,172
v_fmac_f32 v70, v235, v7
v_fmac_f32 v62, v232, v4
MA 176,v,128,v,168
s_add_u32 s66, s66, 524288
v_fmac_f32 v70, v233, v8
MA 184,v,128,v,172
v_fmac_f32 v62, v230, v5
v_fmac_f32 v70, v231, v9
MA 116,v,124,v,168
v_mul_f32 v62, v62, v254
v_mul_f32 v70, v70, v255
MA 124,v,124,v,172
v_lshlrev_b32 v254, 16, v41
v_and_b32 v255, 0xffff0000, v41
MA 112,v,120,v,168
s_and_b32 s66, s66, 8388607
v_mul_f32 v63, v238, v2
MA 120,v,120,v,172
v_mul_f32 v71, v239, v6
v_fmac_f32 v63, v236, v3
MA 52,v,116,v,168
v_fmac_f32 v71, v237, v7
v_fmac_f32 v63, v234, v4
MA 60,v,116,v,172
v_fmac_f32 v71, v235, v8
v_fmac_f32 v63, v232, v5
MA 48,v,112,v,168
TR 168,202,32768
TR 170,202,34816
MA 56,v,112,v,172
TR 172,203,32768
TR 174,203,34816
v_fmac_f32 v71, v233, v9
v_mul_f32 v63, v63, v254
v_mul_f32 v71, v71, v255
v_lshlrev_b32 v254, 16, v43
v_and_b32 v255, 0xffff0000, v43
v_mul_f32 v64, v240, v2
v_mul_f32 v72, v241, v6
v_fmac_f32 v64, v238, v3
s_waitcnt lgkmcnt(4)
MA 0,v,80,v,144
s_add_u32 s75, s64, s74
v_fmac_f32 v72, v239, v7
MA 8,v,80,v,148
ds_read_b128 v[112:115], v193 offset:32768
v_fmac_f32 v64, v236, v4
MA 4,v,84,v,144
v_fmac_f32 v72, v237, v8
v_fmac_f32 v64, v234, v5
MA 12,v,84,v,148
v_fmac_f32 v72, v235, v9
v_mul_f32 v64, v64, v254
MA 64,v,88,v,144
s_add_u32 m0, s67, 0
v_mul_f32 v72, v72, v255
MA 72,v,88,v,148
v_lshlrev_b32 v254, 16, v45
MA 68,v,92,v,144
v_and_b32 v255, 0xffff0000, v45
v_mul_f32 v65, v242, v2
MA 76,v,92,v,148
ds_read_b128 v[116:119], v193 offset:34816
v_mul_f32 v73, v243, v6
MA 128,v,96,v,144
buffer_load_dwordx4 v208, s[44:47], s75 offen offset:0 lds
v_fmac_f32 v65, v240, v3
MA 136,v,96,v,148
v_fmac_f32 v73, v241, v7
MA 132,v,100,v,144
v_fmac_f32 v65, v238, v4
v_fmac_f32 v73, v239, v8
MA 140,v,100,v,148
v_fmac_f32 v65, v236, v5
MA 192,v,104,v,144
v_fmac_f32 v73, v237, v9
MA 200,v,104,v,148
ds_read_b128 v[120:123], v193 offset:36864
buffer_load_dwordx4 v209, s[44:47], s75 offen offset:1024 lds
MA 196,v,108,v,144
TR 144,196,49152
TR 146,196,51200
MA 204,v,108,v,148
TR 148,197,49152
TR 150,197,51200
MA 212,v,108,v,152
v_mul_f32 v65, v65, v254
v_mul_f32 v73, v73, v255
MA 220,v,108,v,156
buffer_load_dwordx4 v210, s[44:47], s75 offen offset:2048 lds
v_lshlrev_b32 v254, 16, v47
MA 208,v,104,v,152
v_and_b32 v255, 0xffff0000, v47
v_mul_f32 v66, v244, v2
MA 216,v,104,v,156
v_mul_f32 v74, v245, v6
v_fmac_f32 v66, v242, v3
MA 148,v,100,v,152
ds_read_b128 v[124:127], v193 offset:38912
v_fmac_f32 v74, v243, v7
MA 156,v,100,v,156
v_fmac_f32 v66, v240, v4
v_fmac_f32 v74, v241, v8
MA 144,v,96,v,152
buffer_load_dwordx4 v211, s[44:47], s75 offen offset:3072 lds
v_fmac_f32 v66, v238, v5
MA 152,v,96,v,156
v_fmac_f32 v74, v239, v9
v_mul_f32 v66, v66, v254
MA 84,v,92,v,152
v_mul_f32 v74, v74, v255
v_lshlrev_b32 v254, 16, v49
MA 92,v,92,v,156
v_and_b32 v255, 0xffff0000, v49
v_mul_f32 v67, v246, v2
MA 80,v,88,v,152
ds_read_b128 v[128:131], v193 offset:40960
s_add_u32 s75, s65, s74
MA 88,v,88,v,156
v_mul_f32 v75, v247, v6
v_fmac_f32 v67, v244, v3
MA 20,v,84,v,152
v_fmac_f32 v75, v245, v7
v_fmac_f32 v67, v242, v4
MA 28,v,84,v,156
v_fmac_f32 v75, v243, v8
MA 16,v,80,v,152
TR 152,198,49152
TR 154,198,51200
MA 24,v,80,v,156
TR 156,199,49152
TR 158,199,51200
MA 32,v,80,v,160
ds_read_b128 v[132:135], v193 offset:43008
s_add_u32 m0, s67, 4096
MA 40,v,80,v,164
v_fmac_f32 v67, v240, v5
v_fmac_f32 v75, v241, v9
MA 36,v,84,v,160
v_mul_f32 v67, v67, v254
v_mul_f32 v75, v75, v255
MA 44,v,84,v,164
buffer_load_dwordx4 v208, s[44:47], s75 offen offset:0 lds
v_lshlrev_b32 v254, 16, v51
MA 96,v,88,v,160
v_and_b32 v255, 0xffff0000, v51
v_mul_f32 v68, v248, v2
MA 104,v,88,v,164
v_mul_f32 v76, v249, v6
v_fmac_f32 v68, v246, v3
MA 100,v,92,v,160
v_fmac_f32 v76, v247, v7
v_fmac_f32 v68, v244, v4
MA 108,v,92,v,164
ds_read_b128 v[136:139], v193 offset:45056
buffer_load_dwordx4 v209, s[44:47], s75 offen offset:1024 lds
MA 160,v,96,v,160
v_fmac_f32 v76, v245, v8
v_fmac_f32 v68, v242, v5
MA 168,v,96,v,164
v_fmac_f32 v76, v243, v9
v_mul_f32 v68, v68, v254
MA 164,v,100,v,160
v_mul_f32 v76, v76, v255
v_lshlrev_b32 v254, 16, v53
MA 172,v,100,v,164
v_and_b32 v255, 0xffff0000, v53
MA 224,v,104,v,160
buffer_load_dwordx4 v210, s[44:47], s75 offen offset:2048 lds
v_mul_f32 v69, v250, v2
MA 232,v,104,v,164
ds_read_b128 v[140:143], v193 offset:47104
v_mul_f32 v77, v251, v6
MA 228,v,108,v,160
TR 160,200,49152
TR 162,200,51200
MA 236,v,108,v,164
TR 164,201,49152
TR 166,201,51200
s_waitcnt lgkmcnt(15)
MA 244,v,108,v,168
buffer_load_dwordx4 v211, s[44:47], s75 offen offset:3072 lds
v_fmac_f32 v69, v248, v3
MA 252,v,108,v,172
v_fmac_f32 v77, v249, v7
v_fmac_f32 v69, v246, v4
MA 240,v,104,v,168
v_fmac_f32 v77, v247, v8
v_fmac_f32 v69, v244, v5
MA 248,v,104,v,172
v_fmac_f32 v77, v245, v9
v_mul_f32 v69, v69, v254
MA 180,v,100,v,168
v_mul_f32 v77, v77, v255
v_cvt_pk_bf16_f32 v230, v69, v68
MA 188,v,100,v,172
s_add_u32 s74, s74, 128
v_cvt_pk_bf16_f32 v231, v67, v66
MA 176,v,96,v,168
v_cvt_pk_bf16_f32 v232, v65, v64
v_cvt_pk_bf16_f32 v233, v63, v62
MA 184,v,96,v,172
s_mov_b32 s36, 8192
buffer_store_dwordx4 v[230:233], v10, s[84:87], s36 offen sc1
MA 116,v,92,v,168
v_cvt_pk_bf16_f32 v234, v77, v76
MA 124,v,92,v,172
s_and_b32 s74, s74, 2047
v_cvt_pk_bf16_f32 v235, v75, v74
MA 112,v,88,v,168
v_cvt_pk_bf16_f32 v236, v73, v72
v_cvt_pk_bf16_f32 v237, v71, v70
MA 120,v,88,v,172
s_mov_b32 s36, 12288
MA 52,v,84,v,168
buffer_store_dwordx4 v[234:237], v10, s[84:87], s36 offen sc1
MA 60,v,84,v,172
v_lshlrev_b32 v228, 4, v1
MA 48,v,80,v,168
TR 168,202,49152
TR 170,202,51200
MA 56,v,80,v,172
TR 172,203,49152
TR 174,203,51200
s_waitcnt lgkmcnt(4)
MA 0,v,112,v,144
MA 8,v,112,v,148
MA 4,v,116,v,144
MA 12,v,116,v,148
MA 64,v,120,v,144
MA 72,v,120,v,148
MA 68,v,124,v,144
MA 76,v,124,v,148
MA 128,v,128,v,144
MA 136,v,128,v,148
s_waitcnt vmcnt(15) lgkmcnt(0)
s_barrier
MA 132,v,132,v,144
ds_read_b128 v[48:51], v226 offset:0
s_add_u32 m0, s68, 131072
MA 140,v,132,v,148
MA 192,v,136,v,144
ds_read_b128 v[52:55], v226 offset:2048
buffer_load_dwordx4 v212, s[48:51], s66 offen offset:0 lds
MA 200,v,136,v,148
MA 196,v,140,v,144
ds_read_b128 v[56:59], v226 offset:4096
buffer_load_dwordx4 v213, s[48:51], s66 offen offset:1024 lds
MA 204,v,140,v,148
MA 212,v,140,v,152
ds_read_b128 v[60:63], v226 offset:6144
MA 220,v,140,v,156
buffer_load_dwordx4 v214, s[48:51], s66 offen offset:2048 lds
MA 208,v,136,v,152
TR 16,216,0
MA 216,v,136,v,156
buffer_load_dwordx4 v215, s[48:51], s66 offen offset:3072 lds
MA 148,v,132,v,152
TR 18,216,1024
MA 156,v,132,v,156
MA 144,v,128,v,152
TR 20,217,0
s_add_u32 s66, s66, 524288
MA 152,v,128,v,156
MA 84,v,124,v,152
TR 22,217,1024
s_and_b32 s66, s66, 8388607
MA 92,v,124,v,156
MA 80,v,120,v,152
TR 24,218,0
MA 88,v,120,v,156
s_add_u32 s75, s64, s74
MA 20,v,116,v,152
TR 26,218,1024
MA 28,v,116,v,156
s_add_u32 m0, s67, 32768
MA 16,v,112,v,152
TR 28,219,0
MA 24,v,112,v,156
MA 32,v,112,v,160
TR 30,219,1024
buffer_load_dwordx4 v208, s[44:47], s75 offen offset:0 lds
MA 40,v,112,v,164
MA 36,v,116,v,160
TR 32,220,0
buffer_load_dwordx4 v209, s[44:47], s75 offen offset:1024 lds
MA 44,v,116,v,164
MA 96,v,120,v,160
TR 34,220,1024
MA 104,v,120,v,164
buffer_load_dwordx4 v210, s[44:47], s75 offen offset:2048 lds
MA 100,v,124,v,160
TR 36,221,0
MA 108,v,124,v,164
buffer_load_dwordx4 v211, s[44:47], s75 offen offset:3072 lds
MA 160,v,128,v,160
TR 38,221,1024
MA 168,v,128,v,164
MA 164,v,132,v,160
TR 40,222,0
s_add_u32 s75, s65, s74
MA 172,v,132,v,164
MA 224,v,136,v,160
TR 42,222,1024
s_add_u32 m0, s67, 36864
MA 232,v,136,v,164
MA 228,v,140,v,160
TR 44,223,0
MA 236,v,140,v,164
buffer_load_dwordx4 v208, s[44:47], s75 offen offset:0 lds
MA 244,v,140,v,168
TR 46,223,1024
MA 252,v,140,v,172
buffer_load_dwordx4 v209, s[44:47], s75 offen offset:1024 lds
MA 240,v,136,v,168
MA 248,v,136,v,172
MA 180,v,132,v,168
buffer_load_dwordx4 v210, s[44:47], s75 offen offset:2048 lds
MA 188,v,132,v,172
MA 176,v,128,v,168
buffer_load_dwordx4 v211, s[44:47], s75 offen offset:3072 lds
MA 184,v,128,v,172
MA 116,v,124,v,168
MA 124,v,124,v,172
s_add_u32 s74, s74, 128
MA 112,v,120,v,168
MA 120,v,120,v,172
s_and_b32 s74, s74, 2047
MA 52,v,116,v,168
MA 60,v,116,v,172
MA 48,v,112,v,168
MA 56,v,112,v,172
L_p2:
s_waitcnt lgkmcnt(4)
v_mfma_f32_16x16x32_bf16 v[80:83], v[16:19], v[48:51], 0
s_add_u32 s8, s40, 59768832
s_addc_u32 s9, s41, 0
v_mfma_f32_16x16x32_bf16 v[96:99], v[20:23], v[48:51], 0
ds_read_b128 v[64:67], v227 offset:0
v_mfma_f32_16x16x32_bf16 v[84:87], v[16:19], v[52:55], 0
s_mov_b32 s10, 8192
v_mfma_f32_16x16x32_bf16 v[100:103], v[20:23], v[52:55], 0
s_mov_b32 s11, 0x20000
v_mfma_f32_16x16x32_bf16 v[88:91], v[16:19], v[56:59], 0
s_mov_b32 s12, s38
v_mfma_f32_16x16x32_bf16 v[104:107], v[20:23], v[56:59], 0
s_mov_b32 s13, s39
v_mfma_f32_16x16x32_bf16 v[92:95], v[16:19], v[60:63], 0
TR 16,216,8192
TR 18,216,9216
v_mfma_f32_16x16x32_bf16 v[108:111], v[20:23], v[60:63], 0
TR 20,217,8192
TR 22,217,9216
v_mfma_f32_16x16x32_bf16 v[124:127], v[24:27], v[60:63], 0
ds_read_b128 v[68:71], v227 offset:2048
s_mov_b32 s14, 256
v_mfma_f32_16x16x32_bf16 v[140:143], v[28:31], v[60:63], 0
s_mov_b32 s15, 0x20000
v_accvgpr_read_b32 v234, a0
v_mfma_f32_16x16x32_bf16 v[120:123], v[24:27], v[56:59], 0
v_accvgpr_read_b32 v235, a1
v_accvgpr_read_b32 v236, a2
v_mfma_f32_16x16x32_bf16 v[136:139], v[28:31], v[56:59], 0
v_accvgpr_read_b32 v237, a3
v_mfma_f32_16x16x32_bf16 v[116:119], v[24:27], v[52:55], 0
ds_read_b128 v[72:75], v227 offset:4096
v_accvgpr_read_b32 v238, a4
v_mfma_f32_16x16x32_bf16 v[132:135], v[28:31], v[52:55], 0
v_accvgpr_read_b32 v239, a5
v_mfma_f32_16x16x32_bf16 v[112:115], v[24:27], v[48:51], 0
TR 24,218,8192
TR 26,218,9216
v_mfma_f32_16x16x32_bf16 v[128:131], v[28:31], v[48:51], 0
TR 28,219,8192
TR 30,219,9216
v_mfma_f32_16x16x32_bf16 v[144:147], v[32:35], v[48:51], 0
v_accvgpr_read_b32 v240, a6
v_accvgpr_read_b32 v241, a7
v_mfma_f32_16x16x32_bf16 v[160:163], v[36:39], v[48:51], 0
v_cvt_pk_bf16_f32 v230, v234, v235
v_cvt_pk_bf16_f32 v231, v236, v237
v_mfma_f32_16x16x32_bf16 v[148:151], v[32:35], v[52:55], 0
ds_read_b128 v[76:79], v227 offset:6144
v_cvt_pk_bf16_f32 v232, v238, v239
v_mfma_f32_16x16x32_bf16 v[164:167], v[36:39], v[52:55], 0
v_cvt_pk_bf16_f32 v233, v240, v241
v_mfma_f32_16x16x32_bf16 v[152:155], v[32:35], v[56:59], 0
buffer_store_dwordx4 v[230:233], v228, s[16:19], s24 offen offset:0 sc1
v_mfma_f32_16x16x32_bf16 v[168:171], v[36:39], v[56:59], 0
v_accvgpr_read_b32 v246, a8
v_mfma_f32_16x16x32_bf16 v[156:159], v[32:35], v[60:63], 0
TR 32,220,8192
TR 34,220,9216
v_mfma_f32_16x16x32_bf16 v[172:175], v[36:39], v[60:63], 0
TR 36,221,8192
TR 38,221,9216
s_waitcnt lgkmcnt(15)
v_mfma_f32_16x16x32_bf16 v[188:191], v[40:43], v[60:63], 0
v_accvgpr_read_b32 v247, a9
v_accvgpr_read_b32 v248, a10
v_mfma_f32_16x16x32_bf16 v[204:207], v[44:47], v[60:63], 0
v_accvgpr_read_b32 v249, a11
v_accvgpr_read_b32 v250, a12
v_mfma_f32_16x16x32_bf16 v[184:187], v[40:43], v[56:59], 0
v_accvgpr_read_b32 v251, a13
v_mfma_f32_16x16x32_bf16 v[200:203], v[44:47], v[56:59], 0
v_accvgpr_read_b32 v252, a14
v_mfma_f32_16x16x32_bf16 v[180:183], v[40:43], v[52:55], 0
v_accvgpr_read_b32 v253, a15
v_mfma_f32_16x16x32_bf16 v[196:199], v[44:47], v[52:55], 0
v_mfma_f32_16x16x32_bf16 v[176:179], v[40:43], v[48:51], 0
TR 40,222,8192
TR 42,222,9216
v_mfma_f32_16x16x32_bf16 v[192:195], v[44:47], v[48:51], 0
TR 44,223,8192
TR 46,223,9216
s_waitcnt lgkmcnt(4)
MV 80,v,16,v,64
v_cvt_pk_bf16_f32 v242, v246, v247
MV 96,v,20,v,64
v_cvt_pk_bf16_f32 v243, v248, v249
MV 84,v,16,v,68
v_cvt_pk_bf16_f32 v244, v250, v251
MV 100,v,20,v,68
MV 88,v,16,v,72
v_cvt_pk_bf16_f32 v245, v252, v253
MV 104,v,20,v,72
buffer_store_dwordx4 v[242:245], v228, s[16:19], s24 offen offset:1024 sc1
MV 92,v,16,v,76
MV 108,v,20,v,76
s_waitcnt vmcnt(16) lgkmcnt(0)
s_barrier
MV 124,v,24,v,76
TR 16,216,16384
TR 18,216,17408
MV 140,v,28,v,76
ds_read_b128 v[48:51], v224 offset:0
s_add_u32 m0, s68, 98304
MV 120,v,24,v,72
TR 20,217,16384
TR 22,217,17408
MV 136,v,28,v,72
buffer_load_dwordx4 v212, s[48:51], s66 offen offset:0 lds
v_accvgpr_read_b32 v234, a16
MV 116,v,24,v,68
ds_read_b128 v[52:55], v224 offset:2048
buffer_load_dwordx4 v213, s[48:51], s66 offen offset:1024 lds
MV 132,v,28,v,68
v_accvgpr_read_b32 v235, a17
v_accvgpr_read_b32 v236, a18
MV 112,v,24,v,64
TR 24,218,16384
TR 26,218,17408
MV 128,v,28,v,64
TR 28,219,16384
TR 30,219,17408
MV 144,v,32,v,64
ds_read_b128 v[56:59], v224 offset:4096
buffer_load_dwordx4 v214, s[48:51], s66 offen offset:2048 lds
MV 160,v,36,v,64
buffer_load_dwordx4 v215, s[48:51], s66 offen offset:3072 lds
v_accvgpr_read_b32 v237, a19
MV 148,v,32,v,68
v_accvgpr_read_b32 v238, a20
v_accvgpr_read_b32 v239, a21
MV 164,v,36,v,68
s_add_u32 s66, s66, 524288
v_accvgpr_read_b32 v240, a22
MV 152,v,32,v,72
ds_read_b128 v[60:63], v224 offset:6144
v_accvgpr_read_b32 v241, a23
MV 168,v,36,v,72
s_and_b32 s66, s66, 8388607
v_cvt_pk_bf16_f32 v230, v234, v235
MV 156,v,32,v,76
TR 32,220,16384
TR 34,220,17408
MV 172,v,36,v,76
TR 36,221,16384
TR 38,221,17408
MV 188,v,40,v,76
s_add_u32 s75, s64, s74
v_cvt_pk_bf16_f32 v231, v236, v237
MV 204,v,44,v,76
v_cvt_pk_bf16_f32 v232, v238, v239
v_cvt_pk_bf16_f32 v233, v240, v241
MV 184,v,40,v,72
s_add_u32 m0, s67, 65536
buffer_store_dwordx4 v[230:233], v228, s[16:19], s24 offen offset:2048 sc1
MV 200,v,44,v,72
v_accvgpr_read_b32 v246, a24
v_accvgpr_read_b32 v247, a25
MV 180,v,40,v,68
buffer_load_dwordx4 v208, s[44:47], s75 offen offset:0 lds
v_accvgpr_read_b32 v248, a26
MV 196,v,44,v,68
MV 176,v,40,v,64
TR 40,222,16384
TR 42,222,17408
MV 192,v,44,v,64
TR 44,223,16384
TR 46,223,17408
s_waitcnt lgkmcnt(4)
MV 80,v,16,v,48
buffer_load_dwordx4 v209, s[44:47], s75 offen offset:1024 lds
v_accvgpr_read_b32 v249, a27
MV 96,v,20,v,48
ds_read_b128 v[64:67], v225 offset:0
v_accvgpr_read_b32 v250, a28
MV 84,v,16,v,52
buffer_load_dwordx4 v210, s[44:47], s75 offen offset:2048 lds
v_accvgpr_read_b32 v251, a29
MV 100,v,20,v,52
MV 88,v,16,v,56
v_accvgpr_read_b32 v252, a30
MV 104,v,20,v,56
buffer_load_dwordx4 v211, s[44:47], s75 offen offset:3072 lds
v_accvgpr_read_b32 v253, a31
MV 92,v,16,v,60
TR 16,216,24576
TR 18,216,25600
MV 108,v,20,v,60
TR 20,217,24576
TR 22,217,25600
MV 124,v,24,v,60
ds_read_b128 v[68:71], v225 offset:2048
s_add_u32 s75, s65, s74
MV 140,v,28,v,60
v_cvt_pk_bf16_f32 v242, v246, v247
v_cvt_pk_bf16_f32 v243, v248, v249
MV 120,v,24,v,56
v_cvt_pk_bf16_f32 v244, v250, v251
MV 136,v,28,v,56
s_add_u32 m0, s67, 69632
v_cvt_pk_bf16_f32 v245, v252, v253
MV 116,v,24,v,52
ds_read_b128 v[72:75], v225 offset:4096
buffer_store_dwordx4 v[242:245], v228, s[16:19], s24 offen offset:3072 sc1
MV 132,v,28,v,52
MV 112,v,24,v,48
TR 24,218,24576
TR 26,218,25600
MV 128,v,28,v,48
TR 28,219,24576
TR 30,219,25600
MV 144,v,32,v,48
buffer_load_dwordx4 v208, s[44:47], s75 offen offset:0 lds
buffer_load_dwordx4 v209, s[44:47], s75 offen offset:1024 lds
MV 160,v,36,v,48
v_accvgpr_read_b32 v234, a32
v_accvgpr_read_b32 v235, a33
MV 148,v,32,v,52
ds_read_b128 v[76:79], v225 offset:6144
v_accvgpr_read_b32 v236, a34
MV 164,v,36,v,52
buffer_load_dwordx4 v210, s[44:47], s75 offen offset:2048 lds
v_accvgpr_read_b32 v237, a35
MV 152,v,32,v,56
v_accvgpr_read_b32 v238, a36
MV 168,v,36,v,56
v_accvgpr_read_b32 v239, a37
MV 156,v,32,v,60
TR 32,220,24576
TR 34,220,25600
MV 172,v,36,v,60
TR 36,221,24576
TR 38,221,25600
s_waitcnt lgkmcnt(15)
MV 188,v,40,v,60
buffer_load_dwordx4 v211, s[44:47], s75 offen offset:3072 lds
v_accvgpr_read_b32 v240, a38
MV 204,v,44,v,60
s_add_u32 s74, s74, 128
v_accvgpr_read_b32 v241, a39
MV 184,v,40,v,56
v_cvt_pk_bf16_f32 v230, v234, v235
MV 200,v,44,v,56
v_cvt_pk_bf16_f32 v231, v236, v237
MV 180,v,40,v,52
s_and_b32 s74, s74, 2047
v_cvt_pk_bf16_f32 v232, v238, v239
MV 196,v,44,v,52
MV 176,v,40,v,48
TR 40,222,24576
TR 42,222,25600
MV 192,v,44,v,48
TR 44,223,24576
TR 46,223,25600
s_waitcnt lgkmcnt(4)
MV 80,v,16,v,64
v_cvt_pk_bf16_f32 v233, v240, v241
MV 96,v,20,v,64
s_add_u32 s24, s24, 4096
MV 84,v,16,v,68
buffer_store_dwordx4 v[230:233], v228, s[16:19], s24 offen offset:0 sc1
MV 100,v,20,v,68
MV 88,v,16,v,72
v_accvgpr_read_b32 v246, a40
MV 104,v,20,v,72
v_accvgpr_read_b32 v247, a41
MV 92,v,16,v,76
MV 108,v,20,v,76
s_waitcnt vmcnt(17) lgkmcnt(0)
s_barrier
MV 124,v,24,v,76
TR 16,216,32768
TR 18,216,33792
MV 140,v,28,v,76
ds_read_b128 v[48:51], v224 offset:32768
s_add_u32 m0, s68, 114688
MV 120,v,24,v,72
TR 20,217,32768
TR 22,217,33792
MV 136,v,28,v,72
buffer_load_dwordx4 v212, s[48:51], s66 offen offset:0 lds
v_accvgpr_read_b32 v248, a42
MV 116,v,24,v,68
ds_read_b128 v[52:55], v224 offset:34816
buffer_load_dwordx4 v213, s[48:51], s66 offen offset:1024 lds
MV 132,v,28,v,68
v_accvgpr_read_b32 v249, a43
v_accvgpr_read_b32 v250, a44
MV 112,v,24,v,64
TR 24,218,32768
TR 26,218,33792
MV 128,v,28,v,64
TR 28,219,32768
TR 30,219,33792
MV 144,v,32,v,64
ds_read_b128 v[56:59], v224 offset:36864
buffer_load_dwordx4 v214, s[48:51], s66 offen offset:2048 lds
MV 160,v,36,v,64
buffer_load_dwordx4 v215, s[48:51], s66 offen offset:3072 lds
v_accvgpr_read_b32 v251, a45
MV 148,v,32,v,68
v_accvgpr_read_b32 v252, a46
v_accvgpr_read_b32 v253, a47
MV 164,v,36,v,68
s_add_u32 s66, s66, 524288
v_cvt_pk_bf16_f32 v242, v246, v247
MV 152,v,32,v,72
ds_read_b128 v[60:63], v224 offset:38912
v_cvt_pk_bf16_f32 v243, v248, v249
MV 168,v,36,v,72
s_and_b32 s66, s66, 8388607
v_cvt_pk_bf16_f32 v244, v250, v251
MV 156,v,32,v,76
TR 32,220,32768
TR 34,220,33792
MV 172,v,36,v,76
TR 36,221,32768
TR 38,221,33792
MV 188,v,40,v,76
s_add_u32 s75, s64, s74
v_cvt_pk_bf16_f32 v245, v252, v253
MV 204,v,44,v,76
buffer_store_dwordx4 v[242:245], v228, s[16:19], s24 offen offset:1024 sc1
v_accvgpr_read_b32 v234, a48
MV 184,v,40,v,72
s_add_u32 m0, s67, 0
v_accvgpr_read_b32 v235, a49
MV 200,v,44,v,72
v_accvgpr_read_b32 v236, a50
v_accvgpr_read_b32 v237, a51
MV 180,v,40,v,68
buffer_load_dwordx4 v208, s[44:47], s75 offen offset:0 lds
v_accvgpr_read_b32 v238, a52
MV 196,v,44,v,68
MV 176,v,40,v,64
TR 40,222,32768
TR 42,222,33792
MV 192,v,44,v,64
TR 44,223,32768
TR 46,223,33792
s_waitcnt lgkmcnt(4)
MV 80,v,16,v,48
buffer_load_dwordx4 v209, s[44:47], s75 offen offset:1024 lds
v_accvgpr_read_b32 v239, a53
MV 96,v,20,v,48
ds_read_b128 v[64:67], v225 offset:32768
v_accvgpr_read_b32 v240, a54
MV 84,v,16,v,52
buffer_load_dwordx4 v210, s[44:47], s75 offen offset:2048 lds
v_accvgpr_read_b32 v241, a55
MV 100,v,20,v,52
MV 88,v,16,v,56
v_cvt_pk_bf16_f32 v230, v234, v235
MV 104,v,20,v,56
buffer_load_dwordx4 v211, s[44:47], s75 offen offset:3072 lds
v_cvt_pk_bf16_f32 v231, v236, v237
MV 92,v,16,v,60
TR 16,216,40960
TR 18,216,41984
MV 108,v,20,v,60
TR 20,217,40960
TR 22,217,41984
MV 124,v,24,v,60
ds_read_b128 v[68:71], v225 offset:34816
s_add_u32 s75, s65, s74
MV 140,v,28,v,60
v_cvt_pk_bf16_f32 v232, v238, v239
v_cvt_pk_bf16_f32 v233, v240, v241
MV 120,v,24,v,56
buffer_store_dwordx4 v[230:233], v228, s[16:19], s24 offen offset:2048 sc1
MV 136,v,28,v,56
s_add_u32 m0, s67, 4096
v_accvgpr_read_b32 v246, a56
MV 116,v,24,v,52
ds_read_b128 v[72:75], v225 offset:36864
v_accvgpr_read_b32 v247, a57
MV 132,v,28,v,52
MV 112,v,24,v,48
TR 24,218,40960
TR 26,218,41984
MV 128,v,28,v,48
TR 28,219,40960
TR 30,219,41984
MV 144,v,32,v,48
buffer_load_dwordx4 v208, s[44:47], s75 offen offset:0 lds
buffer_load_dwordx4 v209, s[44:47], s75 offen offset:1024 lds
MV 160,v,36,v,48
v_accvgpr_read_b32 v248, a58
v_accvgpr_read_b32 v249, a59
MV 148,v,32,v,52
ds_read_b128 v[76:79], v225 offset:38912
v_accvgpr_read_b32 v250, a60
MV 164,v,36,v,52
buffer_load_dwordx4 v210, s[44:47], s75 offen offset:2048 lds
v_accvgpr_read_b32 v251, a61
MV 152,v,32,v,56
v_accvgpr_read_b32 v252, a62
MV 168,v,36,v,56
v_accvgpr_read_b32 v253, a63
MV 156,v,32,v,60
TR 32,220,40960
TR 34,220,41984
MV 172,v,36,v,60
TR 36,221,40960
TR 38,221,41984
s_waitcnt lgkmcnt(15)
MV 188,v,40,v,60
buffer_load_dwordx4 v211, s[44:47], s75 offen offset:3072 lds
v_cvt_pk_bf16_f32 v242, v246, v247
MV 204,v,44,v,60
s_add_u32 s74, s74, 128
v_cvt_pk_bf16_f32 v243, v248, v249
MV 184,v,40,v,56
v_cvt_pk_bf16_f32 v244, v250, v251
MV 200,v,44,v,56
v_cvt_pk_bf16_f32 v245, v252, v253
MV 180,v,40,v,52
s_and_b32 s74, s74, 2047
buffer_store_dwordx4 v[242:245], v228, s[16:19], s24 offen offset:3072 sc1
MV 196,v,44,v,52
MV 176,v,40,v,48
TR 40,222,40960
TR 42,222,41984
MV 192,v,44,v,48
TR 44,223,40960
TR 46,223,41984
s_waitcnt lgkmcnt(4)
MV 80,v,16,v,64
v_accvgpr_read_b32 v234, a64
MV 96,v,20,v,64
v_accvgpr_read_b32 v235, a65
MV 84,v,16,v,68
v_accvgpr_read_b32 v236, a66
MV 100,v,20,v,68
MV 88,v,16,v,72
v_accvgpr_read_b32 v237, a67
MV 104,v,20,v,72
v_accvgpr_read_b32 v238, a68
MV 92,v,16,v,76
MV 108,v,20,v,76
s_waitcnt vmcnt(16) lgkmcnt(0)
s_barrier
MV 124,v,24,v,76
TR 16,216,0
TR 18,216,1024
MV 140,v,28,v,76
ds_read_b128 v[48:51], v226 offset:0
s_add_u32 m0, s68, 131072
MV 120,v,24,v,72
TR 20,217,0
TR 22,217,1024
MV 136,v,28,v,72
buffer_load_dwordx4 v212, s[48:51], s66 offen offset:0 lds
v_accvgpr_read_b32 v239, a69
MV 116,v,24,v,68
ds_read_b128 v[52:55], v226 offset:2048
buffer_load_dwordx4 v213, s[48:51], s66 offen offset:1024 lds
MV 132,v,28,v,68
v_accvgpr_read_b32 v240, a70
v_accvgpr_read_b32 v241, a71
MV 112,v,24,v,64
TR 24,218,0
TR 26,218,1024
MV 128,v,28,v,64
TR 28,219,0
TR 30,219,1024
MV 144,v,32,v,64
ds_read_b128 v[56:59], v226 offset:4096
buffer_load_dwordx4 v214, s[48:51], s66 offen offset:2048 lds
MV 160,v,36,v,64
buffer_load_dwordx4 v215, s[48:51], s66 offen offset:3072 lds
v_cvt_pk_bf16_f32 v230, v234, v235
MV 148,v,32,v,68
v_cvt_pk_bf16_f32 v231, v236, v237
v_cvt_pk_bf16_f32 v232, v238, v239
MV 164,v,36,v,68
s_add_u32 s66, s66, 524288
v_cvt_pk_bf16_f32 v233, v240, v241
MV 152,v,32,v,72
ds_read_b128 v[60:63], v226 offset:6144
s_add_u32 s24, s24, 4096
MV 168,v,36,v,72
s_and_b32 s66, s66, 8388607
buffer_store_dwordx4 v[230:233], v228, s[16:19], s24 offen offset:0 sc1
MV 156,v,32,v,76
TR 32,220,0
TR 34,220,1024
MV 172,v,36,v,76
TR 36,221,0
TR 38,221,1024
MV 188,v,40,v,76
s_add_u32 s75, s64, s74
v_accvgpr_read_b32 v246, a72
MV 204,v,44,v,76
v_accvgpr_read_b32 v247, a73
v_accvgpr_read_b32 v248, a74
MV 184,v,40,v,72
s_add_u32 m0, s67, 32768
v_accvgpr_read_b32 v249, a75
MV 200,v,44,v,72
v_accvgpr_read_b32 v250, a76
v_accvgpr_read_b32 v251, a77
MV 180,v,40,v,68
buffer_load_dwordx4 v208, s[44:47], s75 offen offset:0 lds
v_accvgpr_read_b32 v252, a78
MV 196,v,44,v,68
MV 176,v,40,v,64
TR 40,222,0
TR 42,222,1024
MV 192,v,44,v,64
TR 44,223,0
TR 46,223,1024
s_waitcnt lgkmcnt(4)
MV 80,v,16,v,48
buffer_load_dwordx4 v209, s[44:47], s75 offen offset:1024 lds
v_accvgpr_read_b32 v253, a79
MV 96,v,20,v,48
ds_read_b128 v[64:67], v227 offset:0
v_cvt_pk_bf16_f32 v242, v246, v247
MV 84,v,16,v,52
buffer_load_dwordx4 v210, s[44:47], s75 offen offset:2048 lds
v_cvt_pk_bf16_f32 v243, v248, v249
MV 100,v,20,v,52
MV 88,v,16,v,56
v_cvt_pk_bf16_f32 v244, v250, v251
MV 104,v,20,v,56
buffer_load_dwordx4 v211, s[44:47], s75 offen offset:3072 lds
v_cvt_pk_bf16_f32 v245, v252, v253
MV 92,v,16,v,60
TR 16,216,8192
TR 18,216,9216
MV 108,v,20,v,60
TR 20,217,8192
TR 22,217,9216
MV 124,v,24,v,60
ds_read_b128 v[68:71], v227 offset:2048
s_add_u32 s75, s65, s74
MV 140,v,28,v,60
buffer_store_dwordx4 v[242:245], v228, s[16:19], s24 offen offset:1024 sc1
v_accvgpr_read_b32 v234, a80
MV 120,v,24,v,56
v_accvgpr_read_b32 v235, a81
v_accvgpr_read_b32 v236, a82
MV 136,v,28,v,56
s_add_u32 m0, s67, 36864
MV 116,v,24,v,52
ds_read_b128 v[72:75], v227 offset:4096
v_accvgpr_read_b32 v237, a83
MV 132,v,28,v,52
v_accvgpr_read_b32 v238, a84
MV 112,v,24,v,48
TR 24,218,8192
TR 26,218,9216
MV 128,v,28,v,48
TR 28,219,8192
TR 30,219,9216
MV 144,v,32,v,48
buffer_load_dwordx4 v208, s[44:47], s75 offen offset:0 lds
buffer_load_dwordx4 v209, s[44:47], s75 offen offset:1024 lds
MV 160,v,36,v,48
v_accvgpr_read_b32 v239, a85
v_accvgpr_read_b32 v240, a86
MV 148,v,32,v,52
ds_read_b128 v[76:79], v227 offset:6144
v_accvgpr_read_b32 v241, a87
MV 164,v,36,v,52
buffer_load_dwordx4 v210, s[44:47], s75 offen offset:2048 lds
v_cvt_pk_bf16_f32 v230, v234, v235
MV 152,v,32,v,56
v_cvt_pk_bf16_f32 v231, v236, v237
MV 168,v,36,v,56
v_cvt_pk_bf16_f32 v232, v238, v239
MV 156,v,32,v,60
TR 32,220,8192
TR 34,220,9216
MV 172,v,36,v,60
TR 36,221,8192
TR 38,221,9216
s_waitcnt lgkmcnt(15)
MV 188,v,40,v,60
buffer_load_dwordx4 v211, s[44:47], s75 offen offset:3072 lds
v_cvt_pk_bf16_f32 v233, v240, v241
MV 204,v,44,v,60
s_add_u32 s74, s74, 128
buffer_store_dwordx4 v[230:233], v228, s[16:19], s24 offen offset:2048 sc1
MV 184,v,40,v,56
v_accvgpr_read_b32 v246, a88
MV 200,v,44,v,56
v_accvgpr_read_b32 v247, a89
MV 180,v,40,v,52
s_and_b32 s74, s74, 2047
v_accvgpr_read_b32 v248, a90
MV 196,v,44,v,52
MV 176,v,40,v,48
TR 40,222,8192
TR 42,222,9216
MV 192,v,44,v,48
TR 44,223,8192
TR 46,223,9216
s_waitcnt lgkmcnt(4)
MV 80,v,16,v,64
v_accvgpr_read_b32 v249, a91
MV 96,v,20,v,64
v_accvgpr_read_b32 v250, a92
MV 84,v,16,v,68
v_accvgpr_read_b32 v251, a93
MV 100,v,20,v,68
MV 88,v,16,v,72
v_accvgpr_read_b32 v252, a94
MV 104,v,20,v,72
v_accvgpr_read_b32 v253, a95
MV 92,v,16,v,76
MV 108,v,20,v,76
s_waitcnt vmcnt(16) lgkmcnt(0)
s_barrier
MV 124,v,24,v,76
TR 16,216,16384
TR 18,216,17408
MV 140,v,28,v,76
ds_read_b128 v[48:51], v224 offset:0
s_add_u32 m0, s68, 98304
MV 120,v,24,v,72
TR 20,217,16384
TR 22,217,17408
MV 136,v,28,v,72
buffer_load_dwordx4 v212, s[48:51], s66 offen offset:0 lds
v_cvt_pk_bf16_f32 v242, v246, v247
MV 116,v,24,v,68
ds_read_b128 v[52:55], v224 offset:2048
buffer_load_dwordx4 v213, s[48:51], s66 offen offset:1024 lds
MV 132,v,28,v,68
v_cvt_pk_bf16_f32 v243, v248, v249
v_cvt_pk_bf16_f32 v244, v250, v251
MV 112,v,24,v,64
TR 24,218,16384
TR 26,218,17408
MV 128,v,28,v,64
TR 28,219,16384
TR 30,219,17408
MV 144,v,32,v,64
ds_read_b128 v[56:59], v224 offset:4096
buffer_load_dwordx4 v214, s[48:51], s66 offen offset:2048 lds
MV 160,v,36,v,64
buffer_load_dwordx4 v215, s[48:51], s66 offen offset:3072 lds
v_cvt_pk_bf16_f32 v245, v252, v253
MV 148,v,32,v,68
buffer_store_dwordx4 v[242:245], v228, s[16:19], s24 offen offset:3072 sc1
v_accvgpr_read_b32 v234, a96
MV 164,v,36,v,68
s_add_u32 s66, s66, 524288
v_accvgpr_read_b32 v235, a97
MV 152,v,32,v,72
ds_read_b128 v[60:63], v224 offset:6144
v_accvgpr_read_b32 v236, a98
MV 168,v,36,v,72
s_and_b32 s66, s66, 8388607
v_accvgpr_read_b32 v237, a99
MV 156,v,32,v,76
TR 32,220,16384
TR 34,220,17408
MV 172,v,36,v,76
TR 36,221,16384
TR 38,221,17408
MV 188,v,40,v,76
s_add_u32 s75, s64, s74
v_accvgpr_read_b32 v238, a100
MV 204,v,44,v,76
v_accvgpr_read_b32 v239, a101
v_accvgpr_read_b32 v240, a102
MV 184,v,40,v,72
s_add_u32 m0, s67, 65536
v_accvgpr_read_b32 v241, a103
MV 200,v,44,v,72
v_cvt_pk_bf16_f32 v230, v234, v235
v_cvt_pk_bf16_f32 v231, v236, v237
MV 180,v,40,v,68
buffer_load_dwordx4 v208, s[44:47], s75 offen offset:0 lds
v_cvt_pk_bf16_f32 v232, v238, v239
MV 196,v,44,v,68
MV 176,v,40,v,64
TR 40,222,16384
TR 42,222,17408
MV 192,v,44,v,64
TR 44,223,16384
TR 46,223,17408
s_waitcnt lgkmcnt(4)
MV 80,v,16,v,48
buffer_load_dwordx4 v209, s[44:47], s75 offen offset:1024 lds
v_cvt_pk_bf16_f32 v233, v240, v241
MV 96,v,20,v,48
ds_read_b128 v[64:67], v225 offset:0
s_add_u32 s24, s24, 4096
MV 84,v,16,v,52
buffer_load_dwordx4 v210, s[44:47], s75 offen offset:2048 lds
buffer_store_dwordx4 v[230:233], v228, s[16:19], s24 offen offset:0 sc1
MV 100,v,20,v,52
MV 88,v,16,v,56
v_accvgpr_read_b32 v246, a104
MV 104,v,20,v,56
buffer_load_dwordx4 v211, s[44:47], s75 offen offset:3072 lds
v_accvgpr_read_b32 v247, a105
MV 92,v,16,v,60
TR 16,216,24576
TR 18,216,25600
MV 108,v,20,v,60
TR 20,217,24576
TR 22,217,25600
MV 124,v,24,v,60
ds_read_b128 v[68:71], v225 offset:2048
s_add_u32 s75, s65, s74
MV 140,v,28,v,60
v_accvgpr_read_b32 v248, a106
v_accvgpr_read_b32 v249, a107
MV 120,v,24,v,56
v_accvgpr_read_b32 v250, a108
MV 136,v,28,v,56
s_add_u32 m0, s67, 69632
v_accvgpr_read_b32 v251, a109
MV 116,v,24,v,52
ds_read_b128 v[72:75], v225 offset:4096
v_accvgpr_read_b32 v252, a110
MV 132,v,28,v,52
MV 112,v,24,v,48
TR 24,218,24576
TR 26,218,25600
MV 128,v,28,v,48
TR 28,219,24576
TR 30,219,25600
MV 144,v,32,v,48
buffer_load_dwordx4 v208, s[44:47], s75 offen offset:0 lds
buffer_load_dwordx4 v209, s[44:47], s75 offen offset:1024 lds
MV 160,v,36,v,48
v_accvgpr_read_b32 v253, a111
v_cvt_pk_bf16_f32 v242, v246, v247
MV 148,v,32,v,52
ds_read_b128 v[76:79], v225 offset:6144
v_cvt_pk_bf16_f32 v243, v248, v249
MV 164,v,36,v,52
buffer_load_dwordx4 v210, s[44:47], s75 offen offset:2048 lds
v_cvt_pk_bf16_f32 v244, v250, v251
MV 152,v,32,v,56
v_cvt_pk_bf16_f32 v245, v252, v253
MV 168,v,36,v,56
buffer_store_dwordx4 v[242:245], v228, s[16:19], s24 offen offset:1024 sc1
MV 156,v,32,v,60
TR 32,220,24576
TR 34,220,25600
MV 172,v,36,v,60
TR 36,221,24576
TR 38,221,25600
s_waitcnt lgkmcnt(15)
MV 188,v,40,v,60
buffer_load_dwordx4 v211, s[44:47], s75 offen offset:3072 lds
v_accvgpr_read_b32 v234, a112
MV 204,v,44,v,60
s_add_u32 s74, s74, 128
v_accvgpr_read_b32 v235, a113
MV 184,v,40,v,56
v_accvgpr_read_b32 v236, a114
MV 200,v,44,v,56
v_accvgpr_read_b32 v237, a115
MV 180,v,40,v,52
s_and_b32 s74, s74, 2047
v_accvgpr_read_b32 v238, a116
MV 196,v,44,v,52
MV 176,v,40,v,48
TR 40,222,24576
TR 42,222,25600
MV 192,v,44,v,48
TR 44,223,24576
TR 46,223,25600
s_waitcnt lgkmcnt(4)
MV 80,v,16,v,64
v_accvgpr_read_b32 v239, a117
MV 96,v,20,v,64
v_accvgpr_read_b32 v240, a118
MV 84,v,16,v,68
v_accvgpr_read_b32 v241, a119
MV 100,v,20,v,68
MV 88,v,16,v,72
v_cvt_pk_bf16_f32 v230, v234, v235
MV 104,v,20,v,72
v_cvt_pk_bf16_f32 v231, v236, v237
MV 92,v,16,v,76
MV 108,v,20,v,76
s_waitcnt vmcnt(16) lgkmcnt(0)
s_barrier
MV 124,v,24,v,76
TR 16,216,32768
TR 18,216,33792
MV 140,v,28,v,76
ds_read_b128 v[48:51], v224 offset:32768
s_add_u32 m0, s68, 114688
MV 120,v,24,v,72
TR 20,217,32768
TR 22,217,33792
MV 136,v,28,v,72
buffer_load_dwordx4 v212, s[48:51], s66 offen offset:0 lds
v_cvt_pk_bf16_f32 v232, v238, v239
MV 116,v,24,v,68
ds_read_b128 v[52:55], v224 offset:34816
buffer_load_dwordx4 v213, s[48:51], s66 offen offset:1024 lds
MV 132,v,28,v,68
v_cvt_pk_bf16_f32 v233, v240, v241
buffer_store_dwordx4 v[230:233], v228, s[16:19], s24 offen offset:2048 sc1
MV 112,v,24,v,64
TR 24,218,32768
TR 26,218,33792
MV 128,v,28,v,64
TR 28,219,32768
TR 30,219,33792
MV 144,v,32,v,64
ds_read_b128 v[56:59], v224 offset:36864
buffer_load_dwordx4 v214, s[48:51], s66 offen offset:2048 lds
MV 160,v,36,v,64
buffer_load_dwordx4 v215, s[48:51], s66 offen offset:3072 lds
v_accvgpr_read_b32 v246, a120
MV 148,v,32,v,68
v_accvgpr_read_b32 v247, a121
v_accvgpr_read_b32 v248, a122
MV 164,v,36,v,68
s_add_u32 s66, s66, 524288
v_accvgpr_read_b32 v249, a123
MV 152,v,32,v,72
ds_read_b128 v[60:63], v224 offset:38912
v_accvgpr_read_b32 v250, a124
MV 168,v,36,v,72
s_and_b32 s66, s66, 8388607
v_accvgpr_read_b32 v251, a125
MV 156,v,32,v,76
TR 32,220,32768
TR 34,220,33792
MV 172,v,36,v,76
TR 36,221,32768
TR 38,221,33792
MV 188,v,40,v,76
s_add_u32 s75, s64, s74
v_accvgpr_read_b32 v252, a126
MV 204,v,44,v,76
v_accvgpr_read_b32 v253, a127
v_cvt_pk_bf16_f32 v242, v246, v247
MV 184,v,40,v,72
s_add_u32 m0, s67, 0
v_cvt_pk_bf16_f32 v243, v248, v249
MV 200,v,44,v,72
v_cvt_pk_bf16_f32 v244, v250, v251
v_cvt_pk_bf16_f32 v245, v252, v253
MV 180,v,40,v,68
buffer_load_dwordx4 v208, s[44:47], s75 offen offset:0 lds
buffer_store_dwordx4 v[242:245], v228, s[16:19], s24 offen offset:3072 sc1
MV 196,v,44,v,68
MV 176,v,40,v,64
TR 40,222,32768
TR 42,222,33792
MV 192,v,44,v,64
TR 44,223,32768
TR 46,223,33792
s_waitcnt lgkmcnt(4)
MV 80,v,16,v,48
buffer_load_dwordx4 v209, s[44:47], s75 offen offset:1024 lds
v_accvgpr_read_b32 v234, a128
MV 96,v,20,v,48
ds_read_b128 v[64:67], v225 offset:32768
v_accvgpr_read_b32 v235, a129
MV 84,v,16,v,52
buffer_load_dwordx4 v210, s[44:47], s75 offen offset:2048 lds
v_accvgpr_read_b32 v236, a130
MV 100,v,20,v,52
MV 88,v,16,v,56
v_accvgpr_read_b32 v237, a131
MV 104,v,20,v,56
buffer_load_dwordx4 v211, s[44:47], s75 offen offset:3072 lds
v_accvgpr_read_b32 v238, a132
MV 92,v,16,v,60
TR 16,216,40960
TR 18,216,41984
MV 108,v,20,v,60
TR 20,217,40960
TR 22,217,41984
MV 124,v,24,v,60
ds_read_b128 v[68:71], v225 offset:34816
s_add_u32 s75, s65, s74
MV 140,v,28,v,60
v_accvgpr_read_b32 v239, a133
v_accvgpr_read_b32 v240, a134
MV 120,v,24,v,56
v_accvgpr_read_b32 v241, a135
MV 136,v,28,v,56
s_add_u32 m0, s67, 4096
v_cvt_pk_bf16_f32 v230, v234, v235
MV 116,v,24,v,52
ds_read_b128 v[72:75], v225 offset:36864
v_cvt_pk_bf16_f32 v231, v236, v237
MV 132,v,28,v,52
MV 112,v,24,v,48
TR 24,218,40960
TR 26,218,41984
MV 128,v,28,v,48
TR 28,219,40960
TR 30,219,41984
MV 144,v,32,v,48
buffer_load_dwordx4 v208, s[44:47], s75 offen offset:0 lds
buffer_load_dwordx4 v209, s[44:47], s75 offen offset:1024 lds
MV 160,v,36,v,48
v_cvt_pk_bf16_f32 v232, v238, v239
v_cvt_pk_bf16_f32 v233, v240, v241
MV 148,v,32,v,52
ds_read_b128 v[76:79], v225 offset:38912
s_add_u32 s24, s24, 4096
MV 164,v,36,v,52
buffer_load_dwordx4 v210, s[44:47], s75 offen offset:2048 lds
buffer_store_dwordx4 v[230:233], v228, s[16:19], s24 offen offset:0 sc1
MV 152,v,32,v,56
v_accvgpr_read_b32 v246, a136
MV 168,v,36,v,56
v_accvgpr_read_b32 v247, a137
MV 156,v,32,v,60
TR 32,220,40960
TR 34,220,41984
MV 172,v,36,v,60
TR 36,221,40960
TR 38,221,41984
s_waitcnt lgkmcnt(15)
MV 188,v,40,v,60
buffer_load_dwordx4 v211, s[44:47], s75 offen offset:3072 lds
v_accvgpr_read_b32 v248, a138
MV 204,v,44,v,60
s_add_u32 s74, s74, 128
v_accvgpr_read_b32 v249, a139
MV 184,v,40,v,56
v_accvgpr_read_b32 v250, a140
MV 200,v,44,v,56
v_accvgpr_read_b32 v251, a141
MV 180,v,40,v,52
s_and_b32 s74, s74, 2047
v_accvgpr_read_b32 v252, a142
MV 196,v,44,v,52
MV 176,v,40,v,48
TR 40,222,40960
TR 42,222,41984
MV 192,v,44,v,48
TR 44,223,40960
TR 46,223,41984
s_waitcnt lgkmcnt(4)
MV 80,v,16,v,64
v_accvgpr_read_b32 v253, a143
MV 96,v,20,v,64
v_cvt_pk_bf16_f32 v242, v246, v247
MV 84,v,16,v,68
v_cvt_pk_bf16_f32 v243, v248, v249
MV 100,v,20,v,68
MV 88,v,16,v,72
v_cvt_pk_bf16_f32 v244, v250, v251
MV 104,v,20,v,72
v_cvt_pk_bf16_f32 v245, v252, v253
MV 92,v,16,v,76
MV 108,v,20,v,76
s_waitcnt vmcnt(15) lgkmcnt(0)
s_barrier
MV 124,v,24,v,76
TR 16,216,0
TR 18,216,1024
MV 140,v,28,v,76
ds_read_b128 v[48:51], v226 offset:0
s_add_u32 m0, s68, 131072
MV 120,v,24,v,72
TR 20,217,0
TR 22,217,1024
MV 136,v,28,v,72
buffer_load_dwordx4 v212, s[48:51], s66 offen offset:0 lds
buffer_store_dwordx4 v[242:245], v228, s[16:19], s24 offen offset:1024 sc1
MV 116,v,24,v,68
ds_read_b128 v[52:55], v226 offset:2048
buffer_load_dwordx4 v213, s[48:51], s66 offen offset:1024 lds
MV 132,v,28,v,68
v_accvgpr_read_b32 v234, a144
v_accvgpr_read_b32 v235, a145
MV 112,v,24,v,64
TR 24,218,0
TR 26,218,1024
MV 128,v,28,v,64
TR 28,219,0
TR 30,219,1024
MV 144,v,32,v,64
ds_read_b128 v[56:59], v226 offset:4096
buffer_load_dwordx4 v214, s[48:51], s66 offen offset:2048 lds
MV 160,v,36,v,64
buffer_load_dwordx4 v215, s[48:51], s66 offen offset:3072 lds
v_accvgpr_read_b32 v236, a146
MV 148,v,32,v,68
v_accvgpr_read_b32 v237, a147
v_accvgpr_read_b32 v238, a148
MV 164,v,36,v,68
s_add_u32 s66, s66, 524288
v_accvgpr_read_b32 v239, a149
MV 152,v,32,v,72
ds_read_b128 v[60:63], v226 offset:6144
v_accvgpr_read_b32 v240, a150
MV 168,v,36,v,72
s_and_b32 s66, s66, 8388607
v_accvgpr_read_b32 v241, a151
MV 156,v,32,v,76
TR 32,220,0
TR 34,220,1024
MV 172,v,36,v,76
TR 36,221,0
TR 38,221,1024
MV 188,v,40,v,76
s_add_u32 s75, s64, s74
v_cvt_pk_bf16_f32 v230, v234, v235
MV 204,v,44,v,76
v_cvt_pk_bf16_f32 v231, v236, v237
v_cvt_pk_bf16_f32 v232, v238, v239
MV 184,v,40,v,72
s_add_u32 m0, s67, 32768
v_cvt_pk_bf16_f32 v233, v240, v241
MV 200,v,44,v,72
buffer_store_dwordx4 v[230:233], v228, s[16:19], s24 offen offset:2048 sc1
v_accvgpr_read_b32 v246, a152
MV 180,v,40,v,68
buffer_load_dwordx4 v208, s[44:47], s75 offen offset:0 lds
v_accvgpr_read_b32 v247, a153
MV 196,v,44,v,68
MV 176,v,40,v,64
TR 40,222,0
TR 42,222,1024
MV 192,v,44,v,64
TR 44,223,0
TR 46,223,1024
s_waitcnt lgkmcnt(4)
MV 80,v,16,v,48
buffer_load_dwordx4 v209, s[44:47], s75 offen offset:1024 lds
v_accvgpr_read_b32 v248, a154
MV 96,v,20,v,48
ds_read_b128 v[64:67], v227 offset:0
v_accvgpr_read_b32 v249, a155
MV 84,v,16,v,52
buffer_load_dwordx4 v210, s[44:47], s75 offen offset:2048 lds
v_accvgpr_read_b32 v250, a156
MV 100,v,20,v,52
MV 88,v,16,v,56
v_accvgpr_read_b32 v251, a157
MV 104,v,20,v,56
buffer_load_dwordx4 v211, s[44:47], s75 offen offset:3072 lds
v_accvgpr_read_b32 v252, a158
MV 92,v,16,v,60
TR 16,216,8192
TR 18,216,9216
MV 108,v,20,v,60
TR 20,217,8192
TR 22,217,9216
MV 124,v,24,v,60
ds_read_b128 v[68:71], v227 offset:2048
s_add_u32 s75, s65, s74
MV 140,v,28,v,60
v_accvgpr_read_b32 v253, a159
v_cvt_pk_bf16_f32 v242, v246, v247
MV 120,v,24,v,56
v_cvt_pk_bf16_f32 v243, v248, v249
MV 136,v,28,v,56
s_add_u32 m0, s67, 36864
v_cvt_pk_bf16_f32 v244, v250, v251
MV 116,v,24,v,52
ds_read_b128 v[72:75], v227 offset:4096
v_cvt_pk_bf16_f32 v245, v252, v253
MV 132,v,28,v,52
MV 112,v,24,v,48
TR 24,218,8192
TR 26,218,9216
MV 128,v,28,v,48
TR 28,219,8192
TR 30,219,9216
MV 144,v,32,v,48
buffer_load_dwordx4 v208, s[44:47], s75 offen offset:0 lds
buffer_load_dwordx4 v209, s[44:47], s75 offen offset:1024 lds
MV 160,v,36,v,48
buffer_store_dwordx4 v[242:245], v228, s[16:19], s24 offen offset:3072 sc1
v_accvgpr_read_b32 v234, a160
MV 148,v,32,v,52
ds_read_b128 v[76:79], v227 offset:6144
v_accvgpr_read_b32 v235, a161
MV 164,v,36,v,52
buffer_load_dwordx4 v210, s[44:47], s75 offen offset:2048 lds
v_accvgpr_read_b32 v236, a162
MV 152,v,32,v,56
v_accvgpr_read_b32 v237, a163
MV 168,v,36,v,56
v_accvgpr_read_b32 v238, a164
MV 156,v,32,v,60
TR 32,220,8192
TR 34,220,9216
MV 172,v,36,v,60
TR 36,221,8192
TR 38,221,9216
s_waitcnt lgkmcnt(15)
MV 188,v,40,v,60
buffer_load_dwordx4 v211, s[44:47], s75 offen offset:3072 lds
v_accvgpr_read_b32 v239, a165
MV 204,v,44,v,60
s_add_u32 s74, s74, 128
v_accvgpr_read_b32 v240, a166
MV 184,v,40,v,56
v_accvgpr_read_b32 v241, a167
MV 200,v,44,v,56
v_cvt_pk_bf16_f32 v230, v234, v235
MV 180,v,40,v,52
s_and_b32 s74, s74, 2047
v_cvt_pk_bf16_f32 v231, v236, v237
MV 196,v,44,v,52
MV 176,v,40,v,48
TR 40,222,8192
TR 42,222,9216
MV 192,v,44,v,48
TR 44,223,8192
TR 46,223,9216
s_waitcnt lgkmcnt(4)
MV 80,v,16,v,64
v_cvt_pk_bf16_f32 v232, v238, v239
MV 96,v,20,v,64
v_cvt_pk_bf16_f32 v233, v240, v241
MV 84,v,16,v,68
s_add_u32 s24, s24, 4096
MV 100,v,20,v,68
MV 88,v,16,v,72
buffer_store_dwordx4 v[230:233], v228, s[16:19], s24 offen offset:0 sc1
MV 104,v,20,v,72
v_accvgpr_read_b32 v246, a168
MV 92,v,16,v,76
v_accvgpr_read_b32 v247, a169
MV 108,v,20,v,76
s_waitcnt vmcnt(16) lgkmcnt(0)
s_barrier
MV 124,v,24,v,76
TR 16,216,16384
TR 18,216,17408
MV 140,v,28,v,76
ds_read_b128 v[48:51], v224 offset:0
s_add_u32 m0, s68, 98304
MV 120,v,24,v,72
TR 20,217,16384
TR 22,217,17408
MV 136,v,28,v,72
buffer_load_dwordx4 v212, s[48:51], s66 offen offset:0 lds
v_accvgpr_read_b32 v248, a170
MV 116,v,24,v,68
ds_read_b128 v[52:55], v224 offset:2048
buffer_load_dwordx4 v213, s[48:51], s66 offen offset:1024 lds
MV 132,v,28,v,68
v_accvgpr_read_b32 v249, a171
v_accvgpr_read_b32 v250, a172
MV 112,v,24,v,64
TR 24,218,16384
TR 26,218,17408
MV 128,v,28,v,64
TR 28,219,16384
TR 30,219,17408
MV 144,v,32,v,64
ds_read_b128 v[56:59], v224 offset:4096
buffer_load_dwordx4 v214, s[48:51], s66 offen offset:2048 lds
MV 160,v,36,v,64
buffer_load_dwordx4 v215, s[48:51], s66 offen offset:3072 lds
v_accvgpr_read_b32 v251, a173
MV 148,v,32,v,68
v_accvgpr_read_b32 v252, a174
v_accvgpr_read_b32 v253, a175
MV 164,v,36,v,68
s_add_u32 s66, s66, 524288
v_cvt_pk_bf16_f32 v242, v246, v247
MV 152,v,32,v,72
ds_read_b128 v[60:63], v224 offset:6144
v_cvt_pk_bf16_f32 v243, v248, v249
MV 168,v,36,v,72
s_and_b32 s66, s66, 8388607
v_cvt_pk_bf16_f32 v244, v250, v251
MV 156,v,32,v,76
TR 32,220,16384
TR 34,220,17408
MV 172,v,36,v,76
TR 36,221,16384
TR 38,221,17408
MV 188,v,40,v,76
s_add_u32 s75, s64, s74
v_cvt_pk_bf16_f32 v245, v252, v253
MV 204,v,44,v,76
buffer_store_dwordx4 v[242:245], v228, s[16:19], s24 offen offset:1024 sc1
v_accvgpr_read_b32 v234, a176
MV 184,v,40,v,72
s_add_u32 m0, s67, 65536
v_accvgpr_read_b32 v235, a177
MV 200,v,44,v,72
v_accvgpr_read_b32 v236, a178
v_accvgpr_read_b32 v237, a179
MV 180,v,40,v,68
buffer_load_dwordx4 v208, s[44:47], s75 offen offset:0 lds
v_accvgpr_read_b32 v238, a180
MV 196,v,44,v,68
MV 176,v,40,v,64
TR 40,222,16384
TR 42,222,17408
MV 192,v,44,v,64
TR 44,223,16384
TR 46,223,17408
s_waitcnt lgkmcnt(4)
MV 80,v,16,v,48
buffer_load_dwordx4 v209, s[44:47], s75 offen offset:1024 lds
v_accvgpr_read_b32 v239, a181
MV 96,v,20,v,48
ds_read_b128 v[64:67], v225 offset:0
v_accvgpr_read_b32 v240, a182
MV 84,v,16,v,52
buffer_load_dwordx4 v210, s[44:47], s75 offen offset:2048 lds
v_accvgpr_read_b32 v241, a183
MV 100,v,20,v,52
MV 88,v,16,v,56
v_cvt_pk_bf16_f32 v230, v234, v235
MV 104,v,20,v,56
buffer_load_dwordx4 v211, s[44:47], s75 offen offset:3072 lds
v_cvt_pk_bf16_f32 v231, v236, v237
MV 92,v,16,v,60
TR 16,216,24576
TR 18,216,25600
MV 108,v,20,v,60
TR 20,217,24576
TR 22,217,25600
MV 124,v,24,v,60
ds_read_b128 v[68:71], v225 offset:2048
s_add_u32 s75, s65, s74
MV 140,v,28,v,60
v_cvt_pk_bf16_f32 v232, v238, v239
v_cvt_pk_bf16_f32 v233, v240, v241
MV 120,v,24,v,56
buffer_store_dwordx4 v[230:233], v228, s[16:19], s24 offen offset:2048 sc1
v_accvgpr_read_b32 v246, a184
MV 136,v,28,v,56
s_add_u32 m0, s67, 69632
MV 116,v,24,v,52
ds_read_b128 v[72:75], v225 offset:4096
v_accvgpr_read_b32 v247, a185
MV 132,v,28,v,52
v_accvgpr_read_b32 v248, a186
MV 112,v,24,v,48
TR 24,218,24576
TR 26,218,25600
MV 128,v,28,v,48
TR 28,219,24576
TR 30,219,25600
MV 144,v,32,v,48
buffer_load_dwordx4 v208, s[44:47], s75 offen offset:0 lds
buffer_load_dwordx4 v209, s[44:47], s75 offen offset:1024 lds
MV 160,v,36,v,48
v_accvgpr_read_b32 v249, a187
v_accvgpr_read_b32 v250, a188
MV 148,v,32,v,52
ds_read_b128 v[76:79], v225 offset:6144
v_accvgpr_read_b32 v251, a189
MV 164,v,36,v,52
buffer_load_dwordx4 v210, s[44:47], s75 offen offset:2048 lds
v_accvgpr_read_b32 v252, a190
MV 152,v,32,v,56
v_accvgpr_read_b32 v253, a191
MV 168,v,36,v,56
v_cvt_pk_bf16_f32 v242, v246, v247
MV 156,v,32,v,60
TR 32,220,24576
TR 34,220,25600
MV 172,v,36,v,60
TR 36,221,24576
TR 38,221,25600
s_waitcnt lgkmcnt(15)
MV 188,v,40,v,60
buffer_load_dwordx4 v211, s[44:47], s75 offen offset:3072 lds
v_cvt_pk_bf16_f32 v243, v248, v249
MV 204,v,44,v,60
s_add_u32 s74, s74, 128
v_cvt_pk_bf16_f32 v244, v250, v251
MV 184,v,40,v,56
v_cvt_pk_bf16_f32 v245, v252, v253
MV 200,v,44,v,56
buffer_store_dwordx4 v[242:245], v228, s[16:19], s24 offen offset:3072 sc1
MV 180,v,40,v,52
s_and_b32 s74, s74, 2047
buffer_load_dword v254, off, s[12:15], 0 sc1
MV 196,v,44,v,52
MV 176,v,40,v,48
TR 40,222,24576
TR 42,222,25600
MV 192,v,44,v,48
TR 44,223,24576
TR 46,223,25600
s_waitcnt lgkmcnt(4)
MV 80,v,16,v,64
v_accvgpr_read_b32 v234, a192
MV 96,v,20,v,64
v_accvgpr_read_b32 v235, a193
MV 84,v,16,v,68
v_accvgpr_read_b32 v236, a194
MV 100,v,20,v,68
MV 88,v,16,v,72
v_accvgpr_read_b32 v237, a195
MV 104,v,20,v,72
v_accvgpr_read_b32 v238, a196
MV 92,v,16,v,76
MV 108,v,20,v,76
s_waitcnt vmcnt(17) lgkmcnt(0)
s_barrier
MV 124,v,24,v,76
TR 16,216,32768
TR 18,216,33792
MV 140,v,28,v,76
ds_read_b128 v[48:51], v224 offset:32768
s_add_u32 m0, s68, 114688
MV 120,v,24,v,72
TR 20,217,32768
TR 22,217,33792
MV 136,v,28,v,72
buffer_load_dwordx4 v212, s[48:51], s66 offen offset:0 lds
v_accvgpr_read_b32 v239, a197
MV 116,v,24,v,68
ds_read_b128 v[52:55], v224 offset:34816
buffer_load_dwordx4 v213, s[48:51], s66 offen offset:1024 lds
MV 132,v,28,v,68
v_accvgpr_read_b32 v240, a198
v_accvgpr_read_b32 v241, a199
MV 112,v,24,v,64
TR 24,218,32768
TR 26,218,33792
MV 128,v,28,v,64
TR 28,219,32768
TR 30,219,33792
MV 144,v,32,v,64
ds_read_b128 v[56:59], v224 offset:36864
buffer_load_dwordx4 v214, s[48:51], s66 offen offset:2048 lds
MV 160,v,36,v,64
buffer_load_dwordx4 v215, s[48:51], s66 offen offset:3072 lds
v_cvt_pk_bf16_f32 v230, v234, v235
MV 148,v,32,v,68
v_cvt_pk_bf16_f32 v231, v236, v237
v_cvt_pk_bf16_f32 v232, v238, v239
MV 164,v,36,v,68
s_add_u32 s66, s66, 524288
v_cvt_pk_bf16_f32 v233, v240, v241
MV 152,v,32,v,72
ds_read_b128 v[60:63], v224 offset:38912
s_add_u32 s24, s24, 4096
MV 168,v,36,v,72
s_and_b32 s66, s66, 8388607
buffer_store_dwordx4 v[230:233], v228, s[16:19], s24 offen offset:0 sc1
MV 156,v,32,v,76
TR 32,220,32768
TR 34,220,33792
MV 172,v,36,v,76
TR 36,221,32768
TR 38,221,33792
MV 188,v,40,v,76
s_add_u32 s75, s64, s74
v_accvgpr_read_b32 v246, a200
MV 204,v,44,v,76
v_accvgpr_read_b32 v247, a201
v_accvgpr_read_b32 v248, a202
MV 184,v,40,v,72
s_add_u32 m0, s67, 0
v_accvgpr_read_b32 v249, a203
MV 200,v,44,v,72
v_accvgpr_read_b32 v250, a204
v_accvgpr_read_b32 v251, a205
MV 180,v,40,v,68
buffer_load_dwordx4 v208, s[44:47], s75 offen offset:0 lds
v_accvgpr_read_b32 v252, a206
MV 196,v,44,v,68
MV 176,v,40,v,64
TR 40,222,32768
TR 42,222,33792
MV 192,v,44,v,64
TR 44,223,32768
TR 46,223,33792
s_waitcnt lgkmcnt(4)
MV 80,v,16,v,48
buffer_load_dwordx4 v209, s[44:47], s75 offen offset:1024 lds
v_accvgpr_read_b32 v253, a207
MV 96,v,20,v,48
ds_read_b128 v[64:67], v225 offset:32768
v_cvt_pk_bf16_f32 v242, v246, v247
MV 84,v,16,v,52
buffer_load_dwordx4 v210, s[44:47], s75 offen offset:2048 lds
v_cvt_pk_bf16_f32 v243, v248, v249
MV 100,v,20,v,52
MV 88,v,16,v,56
v_cvt_pk_bf16_f32 v244, v250, v251
MV 104,v,20,v,56
buffer_load_dwordx4 v211, s[44:47], s75 offen offset:3072 lds
v_cvt_pk_bf16_f32 v245, v252, v253
MV 92,v,16,v,60
TR 16,216,40960
TR 18,216,41984
MV 108,v,20,v,60
TR 20,217,40960
TR 22,217,41984
MV 124,v,24,v,60
ds_read_b128 v[68:71], v225 offset:34816
s_add_u32 s75, s65, s74
MV 140,v,28,v,60
buffer_store_dwordx4 v[242:245], v228, s[16:19], s24 offen offset:1024 sc1
v_accvgpr_read_b32 v234, a208
MV 120,v,24,v,56
v_accvgpr_read_b32 v235, a209
MV 136,v,28,v,56
s_add_u32 m0, s67, 4096
v_accvgpr_read_b32 v236, a210
MV 116,v,24,v,52
ds_read_b128 v[72:75], v225 offset:36864
v_accvgpr_read_b32 v237, a211
MV 132,v,28,v,52
MV 112,v,24,v,48
TR 24,218,40960
TR 26,218,41984
MV 128,v,28,v,48
TR 28,219,40960
TR 30,219,41984
MV 144,v,32,v,48
buffer_load_dwordx4 v208, s[44:47], s75 offen offset:0 lds
buffer_load_dwordx4 v209, s[44:47], s75 offen offset:1024 lds
MV 160,v,36,v,48
v_accvgpr_read_b32 v238, a212
v_accvgpr_read_b32 v239, a213
MV 148,v,32,v,52
ds_read_b128 v[76:79], v225 offset:38912
v_accvgpr_read_b32 v240, a214
MV 164,v,36,v,52
buffer_load_dwordx4 v210, s[44:47], s75 offen offset:2048 lds
v_accvgpr_read_b32 v241, a215
MV 152,v,32,v,56
v_cvt_pk_bf16_f32 v230, v234, v235
MV 168,v,36,v,56
v_cvt_pk_bf16_f32 v231, v236, v237
MV 156,v,32,v,60
TR 32,220,40960
TR 34,220,41984
MV 172,v,36,v,60
TR 36,221,40960
TR 38,221,41984
s_waitcnt lgkmcnt(15)
MV 188,v,40,v,60
buffer_load_dwordx4 v211, s[44:47], s75 offen offset:3072 lds
v_cvt_pk_bf16_f32 v232, v238, v239
MV 204,v,44,v,60
s_add_u32 s74, s74, 128
v_cvt_pk_bf16_f32 v233, v240, v241
MV 184,v,40,v,56
buffer_store_dwordx4 v[230:233], v228, s[16:19], s24 offen offset:2048 sc1
MV 200,v,44,v,56
v_accvgpr_read_b32 v246, a216
MV 180,v,40,v,52
s_and_b32 s74, s74, 2047
v_accvgpr_read_b32 v247, a217
MV 196,v,44,v,52
MV 176,v,40,v,48
TR 40,222,40960
TR 42,222,41984
MV 192,v,44,v,48
TR 44,223,40960
TR 46,223,41984
s_waitcnt lgkmcnt(4)
MV 80,v,16,v,64
v_accvgpr_read_b32 v248, a218
MV 96,v,20,v,64
v_accvgpr_read_b32 v249, a219
MV 84,v,16,v,68
v_accvgpr_read_b32 v250, a220
MV 100,v,20,v,68
MV 88,v,16,v,72
v_accvgpr_read_b32 v251, a221
MV 104,v,20,v,72
v_accvgpr_read_b32 v252, a222
MV 92,v,16,v,76
MV 108,v,20,v,76
s_waitcnt vmcnt(17) lgkmcnt(0)
s_barrier
MV 124,v,24,v,76
TR 16,216,0
TR 18,216,1024
MV 140,v,28,v,76
ds_read_b128 v[48:51], v226 offset:0
s_add_u32 m0, s68, 131072
MV 120,v,24,v,72
TR 20,217,0
TR 22,217,1024
MV 136,v,28,v,72
buffer_load_dwordx4 v212, s[48:51], s66 offen offset:0 lds
v_accvgpr_read_b32 v253, a223
MV 116,v,24,v,68
ds_read_b128 v[52:55], v226 offset:2048
buffer_load_dwordx4 v213, s[48:51], s66 offen offset:1024 lds
MV 132,v,28,v,68
v_cvt_pk_bf16_f32 v242, v246, v247
v_cvt_pk_bf16_f32 v243, v248, v249
MV 112,v,24,v,64
TR 24,218,0
TR 26,218,1024
MV 128,v,28,v,64
TR 28,219,0
TR 30,219,1024
MV 144,v,32,v,64
ds_read_b128 v[56:59], v226 offset:4096
buffer_load_dwordx4 v214, s[48:51], s66 offen offset:2048 lds
MV 160,v,36,v,64
buffer_load_dwordx4 v215, s[48:51], s66 offen offset:3072 lds
v_cvt_pk_bf16_f32 v244, v250, v251
MV 148,v,32,v,68
v_cvt_pk_bf16_f32 v245, v252, v253
buffer_store_dwordx4 v[242:245], v228, s[16:19], s24 offen offset:3072 sc1
MV 164,v,36,v,68
s_add_u32 s66, s66, 524288
v_accvgpr_read_b32 v234, a224
MV 152,v,32,v,72
ds_read_b128 v[60:63], v226 offset:6144
v_accvgpr_read_b32 v235, a225
MV 168,v,36,v,72
s_and_b32 s66, s66, 8388607
v_accvgpr_read_b32 v236, a226
MV 156,v,32,v,76
TR 32,220,0
TR 34,220,1024
MV 172,v,36,v,76
TR 36,221,0
TR 38,221,1024
MV 188,v,40,v,76
s_add_u32 s75, s64, s74
v_accvgpr_read_b32 v237, a227
MV 204,v,44,v,76
v_accvgpr_read_b32 v238, a228
v_accvgpr_read_b32 v239, a229
MV 184,v,40,v,72
s_add_u32 m0, s67, 32768
v_accvgpr_read_b32 v240, a230
MV 200,v,44,v,72
v_accvgpr_read_b32 v241, a231
v_cvt_pk_bf16_f32 v230, v234, v235
MV 180,v,40,v,68
buffer_load_dwordx4 v208, s[44:47], s75 offen offset:0 lds
v_cvt_pk_bf16_f32 v231, v236, v237
MV 196,v,44,v,68
MV 176,v,40,v,64
TR 40,222,0
TR 42,222,1024
MV 192,v,44,v,64
TR 44,223,0
TR 46,223,1024
s_waitcnt lgkmcnt(4)
MV 80,v,16,v,48
buffer_load_dwordx4 v209, s[44:47], s75 offen offset:1024 lds
v_cvt_pk_bf16_f32 v232, v238, v239
MV 96,v,20,v,48
ds_read_b128 v[64:67], v227 offset:0
v_cvt_pk_bf16_f32 v233, v240, v241
MV 84,v,16,v,52
buffer_load_dwordx4 v210, s[44:47], s75 offen offset:2048 lds
s_add_u32 s24, s24, 4096
MV 100,v,20,v,52
MV 88,v,16,v,56
buffer_store_dwordx4 v[230:233], v228, s[16:19], s24 offen offset:0 sc1
MV 104,v,20,v,56
buffer_load_dwordx4 v211, s[44:47], s75 offen offset:3072 lds
v_accvgpr_read_b32 v246, a232
MV 92,v,16,v,60
TR 16,216,8192
TR 18,216,9216
MV 108,v,20,v,60
TR 20,217,8192
TR 22,217,9216
MV 124,v,24,v,60
ds_read_b128 v[68:71], v227 offset:2048
s_add_u32 s75, s65, s74
MV 140,v,28,v,60
v_accvgpr_read_b32 v247, a233
v_accvgpr_read_b32 v248, a234
MV 120,v,24,v,56
v_accvgpr_read_b32 v249, a235
MV 136,v,28,v,56
s_add_u32 m0, s67, 36864
v_accvgpr_read_b32 v250, a236
MV 116,v,24,v,52
ds_read_b128 v[72:75], v227 offset:4096
v_accvgpr_read_b32 v251, a237
MV 132,v,28,v,52
MV 112,v,24,v,48
TR 24,218,8192
TR 26,218,9216
MV 128,v,28,v,48
TR 28,219,8192
TR 30,219,9216
MV 144,v,32,v,48
buffer_load_dwordx4 v208, s[44:47], s75 offen offset:0 lds
buffer_load_dwordx4 v209, s[44:47], s75 offen offset:1024 lds
MV 160,v,36,v,48
v_accvgpr_read_b32 v252, a238
v_accvgpr_read_b32 v253, a239
MV 148,v,32,v,52
ds_read_b128 v[76:79], v227 offset:6144
v_cvt_pk_bf16_f32 v242, v246, v247
MV 164,v,36,v,52
buffer_load_dwordx4 v210, s[44:47], s75 offen offset:2048 lds
v_cvt_pk_bf16_f32 v243, v248, v249
MV 152,v,32,v,56
v_cvt_pk_bf16_f32 v244, v250, v251
MV 168,v,36,v,56
v_cvt_pk_bf16_f32 v245, v252, v253
MV 156,v,32,v,60
TR 32,220,8192
TR 34,220,9216
MV 172,v,36,v,60
TR 36,221,8192
TR 38,221,9216
s_waitcnt lgkmcnt(15)
MV 188,v,40,v,60
buffer_load_dwordx4 v211, s[44:47], s75 offen offset:3072 lds
buffer_store_dwordx4 v[242:245], v228, s[16:19], s24 offen offset:1024 sc1
MV 204,v,44,v,60
s_add_u32 s74, s74, 128
v_accvgpr_read_b32 v234, a240
MV 184,v,40,v,56
v_accvgpr_read_b32 v235, a241
MV 200,v,44,v,56
v_accvgpr_read_b32 v236, a242
MV 180,v,40,v,52
s_and_b32 s74, s74, 2047
v_accvgpr_read_b32 v237, a243
MV 196,v,44,v,52
MV 176,v,40,v,48
TR 40,222,8192
TR 42,222,9216
MV 192,v,44,v,48
TR 44,223,8192
TR 46,223,9216
s_waitcnt lgkmcnt(4)
MV 80,v,16,v,64
v_accvgpr_read_b32 v238, a244
MV 96,v,20,v,64
v_accvgpr_read_b32 v239, a245
MV 84,v,16,v,68
v_accvgpr_read_b32 v240, a246
MV 100,v,20,v,68
MV 88,v,16,v,72
v_accvgpr_read_b32 v241, a247
MV 104,v,20,v,72
v_cvt_pk_bf16_f32 v230, v234, v235
MV 92,v,16,v,76
v_cvt_pk_bf16_f32 v231, v236, v237
MV 108,v,20,v,76
s_waitcnt vmcnt(16) lgkmcnt(0)
s_barrier
MV 124,v,24,v,76
TR 16,216,16384
TR 18,216,17408
MV 140,v,28,v,76
ds_read_b128 v[48:51], v224 offset:0
s_add_u32 m0, s68, 98304
MV 120,v,24,v,72
TR 20,217,16384
TR 22,217,17408
MV 136,v,28,v,72
buffer_load_dwordx4 v212, s[48:51], s66 offen offset:0 lds
v_cvt_pk_bf16_f32 v232, v238, v239
MV 116,v,24,v,68
ds_read_b128 v[52:55], v224 offset:2048
buffer_load_dwordx4 v213, s[48:51], s66 offen offset:1024 lds
MV 132,v,28,v,68
v_cvt_pk_bf16_f32 v233, v240, v241
buffer_store_dwordx4 v[230:233], v228, s[16:19], s24 offen offset:2048 sc1
MV 112,v,24,v,64
TR 24,218,16384
TR 26,218,17408
MV 128,v,28,v,64
TR 28,219,16384
TR 30,219,17408
MV 144,v,32,v,64
ds_read_b128 v[56:59], v224 offset:4096
buffer_load_dwordx4 v214, s[48:51], s66 offen offset:2048 lds
MV 160,v,36,v,64
buffer_load_dwordx4 v215, s[48:51], s66 offen offset:3072 lds
v_accvgpr_read_b32 v246, a248
MV 148,v,32,v,68
v_accvgpr_read_b32 v247, a249
v_accvgpr_read_b32 v248, a250
MV 164,v,36,v,68
s_add_u32 s66, s66, 524288
v_accvgpr_read_b32 v249, a251
MV 152,v,32,v,72
ds_read_b128 v[60:63], v224 offset:6144
v_accvgpr_read_b32 v250, a252
MV 168,v,36,v,72
s_and_b32 s66, s66, 8388607
v_accvgpr_read_b32 v251, a253
MV 156,v,32,v,76
TR 32,220,16384
TR 34,220,17408
MV 172,v,36,v,76
TR 36,221,16384
TR 38,221,17408
MV 188,v,40,v,76
s_add_u32 s75, s64, s74
v_accvgpr_read_b32 v252, a254
MV 204,v,44,v,76
v_accvgpr_read_b32 v253, a255
v_cvt_pk_bf16_f32 v242, v246, v247
MV 184,v,40,v,72
s_add_u32 m0, s67, 65536
v_cvt_pk_bf16_f32 v243, v248, v249
MV 200,v,44,v,72
v_cvt_pk_bf16_f32 v244, v250, v251
v_cvt_pk_bf16_f32 v245, v252, v253
MV 180,v,40,v,68
buffer_load_dwordx4 v208, s[44:47], s75 offen offset:0 lds
buffer_store_dwordx4 v[242:245], v228, s[16:19], s24 offen offset:3072 sc1
MV 196,v,44,v,68
MV 176,v,40,v,64
TR 40,222,16384
TR 42,222,17408
MV 192,v,44,v,64
TR 44,223,16384
TR 46,223,17408
s_waitcnt lgkmcnt(4)
MV 80,v,16,v,48
buffer_load_dwordx4 v209, s[44:47], s75 offen offset:1024 lds
v_lshlrev_b32 v255, 20, v1
MV 96,v,20,v,48
ds_read_b128 v[64:67], v225 offset:0
MV 84,v,16,v,52
buffer_load_dwordx4 v210, s[44:47], s75 offen offset:2048 lds
MV 100,v,20,v,52
MV 88,v,16,v,56
MV 104,v,20,v,56
buffer_load_dwordx4 v211, s[44:47], s75 offen offset:3072 lds
MV 92,v,16,v,60
TR 16,216,24576
TR 18,216,25600
MV 108,v,20,v,60
TR 20,217,24576
TR 22,217,25600
MV 124,v,24,v,60
ds_read_b128 v[68:71], v225 offset:2048
s_add_u32 s75, s65, s74
MV 140,v,28,v,60
MV 120,v,24,v,56
s_lshl_b32 s36, s3, 26
MV 136,v,28,v,56
s_add_u32 m0, s67, 69632
MV 116,v,24,v,52
ds_read_b128 v[72:75], v225 offset:4096
MV 132,v,28,v,52
MV 112,v,24,v,48
TR 24,218,24576
TR 26,218,25600
MV 128,v,28,v,48
TR 28,219,24576
TR 30,219,25600
MV 144,v,32,v,48
buffer_load_dwordx4 v208, s[44:47], s75 offen offset:0 lds
buffer_load_dwordx4 v209, s[44:47], s75 offen offset:1024 lds
MV 160,v,36,v,48
MV 148,v,32,v,52
ds_read_b128 v[76:79], v225 offset:6144
MV 164,v,36,v,52
buffer_load_dwordx4 v210, s[44:47], s75 offen offset:2048 lds
MV 152,v,32,v,56
v_add_u32 v255, s36, v255
MV 168,v,36,v,56
MV 156,v,32,v,60
TR 32,220,24576
TR 34,220,25600
MV 172,v,36,v,60
TR 36,221,24576
TR 38,221,25600
s_waitcnt lgkmcnt(15)
MV 188,v,40,v,60
buffer_load_dwordx4 v211, s[44:47], s75 offen offset:3072 lds
MV 204,v,44,v,60
s_add_u32 s74, s74, 128
MV 184,v,40,v,56
MV 200,v,44,v,56
MV 180,v,40,v,52
s_and_b32 s74, s74, 2047
MV 196,v,44,v,52
MV 176,v,40,v,48
TR 40,222,24576
TR 42,222,25600
MV 192,v,44,v,48
TR 44,223,24576
TR 46,223,25600
s_waitcnt lgkmcnt(4)
MV 80,v,16,v,64
v_lshlrev_b32 v230, 4, v1
MV 96,v,20,v,64
s_lshl_b32 s80, s3, 12
MV 84,v,16,v,68
MV 100,v,20,v,68
v_add_u32 v12, s80, v230
MV 88,v,16,v,72
MV 104,v,20,v,72
v_add_u32 v10, 0x8000, v230
MV 92,v,16,v,76
MV 108,v,20,v,76
s_waitcnt vmcnt(15) lgkmcnt(0)
s_barrier
MV 124,v,24,v,76
TR 16,216,32768
TR 18,216,33792
MV 140,v,28,v,76
ds_read_b128 v[48:51], v224 offset:32768
s_add_u32 m0, s68, 114688
MV 120,v,24,v,72
TR 20,217,32768
TR 22,217,33792
MV 136,v,28,v,72
buffer_load_dwordx4 v212, s[48:51], s66 offen offset:0 lds
v_add_u32 v11, 0x18000, v230
MV 116,v,24,v,68
ds_read_b128 v[52:55], v224 offset:34816
buffer_load_dwordx4 v213, s[48:51], s66 offen offset:1024 lds
MV 132,v,28,v,68
s_add_u32 s72, s80, 0x8000
s_add_u32 s73, s80, 0x18000
MV 112,v,24,v,64
TR 24,218,32768
TR 26,218,33792
MV 128,v,28,v,64
TR 28,219,32768
TR 30,219,33792
MV 144,v,32,v,64
ds_read_b128 v[56:59], v224 offset:36864
buffer_load_dwordx4 v214, s[48:51], s66 offen offset:2048 lds
MV 160,v,36,v,64
buffer_load_dwordx4 v215, s[48:51], s66 offen offset:3072 lds
v_mov_b32 v15, v230
MV 148,v,32,v,68
v_and_b32 v230, 15, v1
v_lshrrev_b32 v232, 4, v1
MV 164,v,36,v,68
s_add_u32 s66, s66, 524288
v_lshlrev_b32 v232, 2, v232
MV 152,v,32,v,72
ds_read_b128 v[60:63], v224 offset:38912
v_sub_u32 v230, v230, v232
MV 168,v,36,v,72
s_and_b32 s66, s66, 8388607
s_lshl_b32 s81, s3, 4
MV 156,v,32,v,76
TR 32,220,32768
TR 34,220,33792
MV 172,v,36,v,76
TR 36,221,32768
TR 38,221,33792
MV 188,v,40,v,76
s_add_u32 s75, s64, s74
v_add_u32 v13, s81, v230
MV 204,v,44,v,76
s_sub_u32 s81, 112, s81
MV 184,v,40,v,72
s_add_u32 m0, s67, 0
v_add_u32 v239, s81, v230
MV 200,v,44,v,72
MV 180,v,40,v,68
buffer_load_dwordx4 v208, s[44:47], s75 offen offset:0 lds
v_mov_b32 v14, 0xff800000
MV 196,v,44,v,68
MV 176,v,40,v,64
TR 40,222,32768
TR 42,222,33792
MV 192,v,44,v,64
TR 44,223,32768
TR 46,223,33792
s_waitcnt lgkmcnt(4)
MV 80,v,16,v,48
buffer_load_dwordx4 v209, s[44:47], s75 offen offset:1024 lds
s_getpc_b64 s[38:39]
L_ct_a:
MV 96,v,20,v,48
ds_read_b128 v[64:67], v225 offset:32768
MV 84,v,16,v,52
buffer_load_dwordx4 v210, s[44:47], s75 offen offset:2048 lds
MV 100,v,20,v,52
s_add_u32 s38, s38, L_p3_begin - L_ct_a
s_addc_u32 s39, s39, 0
MV 88,v,16,v,56
MV 104,v,20,v,56
buffer_load_dwordx4 v211, s[44:47], s75 offen offset:3072 lds
v_mov_b32 v229, s39
MV 92,v,16,v,60
TR 16,216,40960
TR 18,216,41984
MV 108,v,20,v,60
TR 20,217,40960
TR 22,217,41984
MV 124,v,24,v,60
ds_read_b128 v[68:71], v225 offset:34816
s_add_u32 s75, s65, s74
MV 140,v,28,v,60
v_mov_b32 v228, s38
s_lshr_b32 s38, s2, 3
MV 120,v,24,v,56
s_lshl_b32 s38, s38, 2
MV 136,v,28,v,56
s_add_u32 m0, s67, 4096
s_add_u32 s38, s38, s3
MV 116,v,24,v,52
ds_read_b128 v[72:75], v225 offset:36864
MV 132,v,28,v,52
s_lshl_b32 s38, s38, 7
MV 112,v,24,v,48
TR 24,218,40960
TR 26,218,41984
MV 128,v,28,v,48
TR 28,219,40960
TR 30,219,41984
MV 144,v,32,v,48
buffer_load_dwordx4 v208, s[44:47], s75 offen offset:0 lds
buffer_load_dwordx4 v209, s[44:47], s75 offen offset:1024 lds
MV 160,v,36,v,48
v_and_b32 v238, 3, v1
v_lshlrev_b32 v238, 14, v238
MV 148,v,32,v,52
ds_read_b128 v[76:79], v225 offset:38912
v_add_u32 v238, s38, v238
MV 164,v,36,v,52
buffer_load_dwordx4 v210, s[44:47], s75 offen offset:2048 lds
MV 152,v,32,v,56
v_min_u32 v238, L_p3_s1m_top - L_p3_begin - 4, v238
MV 168,v,36,v,56
v_add_co_u32 v228, vcc, v228, v238
s_nop 1
v_addc_co_u32 v229, vcc, 0, v229, vcc
MV 156,v,32,v,60
TR 32,220,40960
TR 34,220,41984
MV 172,v,36,v,60
TR 36,221,40960
TR 38,221,41984
s_waitcnt lgkmcnt(15)
MV 188,v,40,v,60
buffer_load_dwordx4 v211, s[44:47], s75 offen offset:3072 lds
MV 204,v,44,v,60
s_add_u32 s74, s74, 128
MV 184,v,40,v,56
MV 200,v,44,v,56
MV 180,v,40,v,52
s_and_b32 s74, s74, 2047
global_load_dword v238, v[228:229], off
MV 196,v,44,v,52
MV 176,v,40,v,48
TR 40,222,40960
TR 42,222,41984
MV 192,v,44,v,48
TR 44,223,40960
TR 46,223,41984
s_waitcnt lgkmcnt(4)
MV 80,v,16,v,64
MV 96,v,20,v,64
MV 84,v,16,v,68
MV 100,v,20,v,68
MV 88,v,16,v,72
MV 104,v,20,v,72
MV 92,v,16,v,76
MV 108,v,20,v,76
s_waitcnt vmcnt(13) lgkmcnt(0)
s_barrier
MV 124,v,24,v,76
v_cmp_gt_u32 vcc, 1, v254
s_nop 4
s_cbranch_vccnz L_spin_go
L_spin_go_ret:
v_mov_b32 v254, 1
s_lshl_b32 s36, s2, 2
buffer_store_dword v254, v255, s[8:11], s36 offen offset:0 sc1
s_load_dwordx4 s[32:35], s[0:1], 32
MV 140,v,28,v,76
TR 16,216,0
TR 18,216,1024
MV 120,v,24,v,72
TR 20,217,0
TR 22,217,1024
MV 136,v,28,v,72
ds_read_b128 v[48:51], v226 offset:0
s_add_u32 m0, s68, 131072
MV 116,v,24,v,68
ds_read_b128 v[52:55], v226 offset:2048
buffer_load_dwordx4 v212, s[48:51], s66 offen offset:0 lds
MV 132,v,28,v,68
buffer_load_dwordx4 v213, s[48:51], s66 offen offset:1024 lds
MV 112,v,24,v,64
TR 24,218,0
TR 26,218,1024
MV 128,v,28,v,64
TR 28,219,0
TR 30,219,1024
MV 144,v,32,v,64
ds_read_b128 v[56:59], v226 offset:4096
buffer_load_dwordx4 v214, s[48:51], s66 offen offset:2048 lds
MV 160,v,36,v,64
buffer_load_dwordx4 v215, s[48:51], s66 offen offset:3072 lds
MV 148,v,32,v,68
MV 164,v,36,v,68
s_add_u32 s66, s66, 524288
MV 152,v,32,v,72
ds_read_b128 v[60:63], v226 offset:6144
MV 168,v,36,v,72
s_and_b32 s66, s66, 8388607
MV 156,v,32,v,76
TR 32,220,0
TR 34,220,1024
MV 172,v,36,v,76
TR 36,221,0
TR 38,221,1024
MV 188,v,40,v,76
s_add_u32 s75, s64, s74
MV 204,v,44,v,76
MV 184,v,40,v,72
s_add_u32 m0, s67, 32768
MV 200,v,44,v,72
MV 180,v,40,v,68
buffer_load_dwordx4 v208, s[44:47], s75 offen offset:0 lds
MV 196,v,44,v,68
MV 176,v,40,v,64
TR 40,222,0
TR 42,222,1024
MV 192,v,44,v,64
TR 44,223,0
TR 46,223,1024
s_waitcnt lgkmcnt(4)
MV 80,v,16,v,48
buffer_load_dwordx4 v209, s[44:47], s75 offen offset:1024 lds
s_and_b32 s36, s2, 3
MV 96,v,20,v,48
ds_read_b128 v[64:67], v227 offset:0
s_lshl_b32 s36, s36, 1
MV 84,v,16,v,52
buffer_load_dwordx4 v210, s[44:47], s75 offen offset:2048 lds
s_sub_u32 s43, 14, s36
MV 100,v,20,v,52
s_bitcmp1_b32 s2, 4
s_cselect_b32 s36, s43, s36
MV 88,v,16,v,56
s_bfe_u32 s43, s2, 0x10003
MV 104,v,20,v,56
buffer_load_dwordx4 v211, s[44:47], s75 offen offset:3072 lds
s_add_u32 s36, s36, s43
MV 92,v,16,v,60
TR 16,216,8192
TR 18,216,9216
MV 108,v,20,v,60
TR 20,217,8192
TR 22,217,9216
MV 124,v,24,v,60
ds_read_b128 v[68:71], v227 offset:2048
s_add_u32 s75, s65, s74
MV 140,v,28,v,60
s_bfe_u32 s37, s2, 0x10002
s_lshr_b32 s43, s2, 5
MV 120,v,24,v,56
s_lshl_b32 s43, s43, 1
s_add_u32 s37, s37, s43
MV 136,v,28,v,56
s_add_u32 m0, s67, 36864
v_and_b32 v230, 15, v1
MV 116,v,24,v,52
ds_read_b128 v[72:75], v227 offset:4096
s_lshl_b32 s36, s36, 4
MV 132,v,28,v,52
v_add_u32 v231, s36, v230
s_lshr_b32 s36, s2, 4
MV 112,v,24,v,48
TR 24,218,8192
TR 26,218,9216
MV 128,v,28,v,48
TR 28,219,8192
TR 30,219,9216
MV 144,v,32,v,48
buffer_load_dwordx4 v208, s[44:47], s75 offen offset:0 lds
buffer_load_dwordx4 v209, s[44:47], s75 offen offset:1024 lds
MV 160,v,36,v,48
v_lshl_add_u32 v232, v230, 4, s36
v_and_b32 v233, 7, v1
MV 148,v,32,v,52
ds_read_b128 v[76:79], v227 offset:6144
v_bfe_u32 v234, v1, 3, 1
MV 164,v,36,v,52
buffer_load_dwordx4 v210, s[44:47], s75 offen offset:2048 lds
v_lshlrev_b32 v233, 3, v233
MV 152,v,32,v,56
v_lshl_add_u32 v233, v234, 7, v233
s_bfe_u32 s36, s69, 0x10001
MV 168,v,36,v,56
s_lshl_b32 s36, s36, 6
s_lshr_b32 s37, s69, 2
MV 156,v,32,v,60
TR 32,220,8192
TR 34,220,9216
MV 172,v,36,v,60
TR 36,221,8192
TR 38,221,9216
s_waitcnt lgkmcnt(15)
MV 188,v,40,v,60
buffer_load_dwordx4 v211, s[44:47], s75 offen offset:3072 lds
s_add_u32 s36, s36, s37
MV 204,v,44,v,60
s_add_u32 s74, s74, 128
v_add_u32 v233, s36, v233
MV 184,v,40,v,56
v_lshrrev_b32 v234, 4, v1
MV 200,v,44,v,56
v_cmp_eq_u32 vcc, 1, v234
s_nop 1
v_cndmask_b32 v233, v233, v232, vcc
MV 180,v,40,v,52
s_and_b32 s74, s74, 2047
MV 196,v,44,v,52
v_cmp_eq_u32 vcc, 2, v234
s_nop 1
v_cndmask_b32 v233, v233, v231, vcc
MV 176,v,40,v,48
TR 40,222,8192
TR 42,222,9216
MV 192,v,44,v,48
TR 44,223,8192
TR 46,223,9216
v_lshlrev_b32 v233, 2, v233
s_waitcnt lgkmcnt(4)
MV 80,v,16,v,64
MV 96,v,20,v,64
MV 84,v,16,v,68
MV 100,v,20,v,68
MV 88,v,16,v,72
MV 104,v,20,v,72
MV 92,v,16,v,76
MV 108,v,20,v,76
s_waitcnt vmcnt(14) lgkmcnt(0)
s_barrier
MV 124,v,24,v,76
TR 16,216,16384
TR 18,216,17408
MV 140,v,28,v,76
ds_read_b128 v[48:51], v224 offset:0
s_add_u32 m0, s68, 98304
MV 120,v,24,v,72
TR 20,217,16384
TR 22,217,17408
MV 136,v,28,v,72
buffer_load_dwordx4 v212, s[48:51], s66 offen offset:0 lds
MV 116,v,24,v,68
ds_read_b128 v[52:55], v224 offset:2048
buffer_load_dwordx4 v213, s[48:51], s66 offen offset:1024 lds
MV 132,v,28,v,68
MV 112,v,24,v,64
TR 24,218,16384
TR 26,218,17408
MV 128,v,28,v,64
TR 28,219,16384
TR 30,219,17408
MV 144,v,32,v,64
ds_read_b128 v[56:59], v224 offset:4096
buffer_load_dwordx4 v214, s[48:51], s66 offen offset:2048 lds
MV 160,v,36,v,64
buffer_load_dwordx4 v215, s[48:51], s66 offen offset:3072 lds
MV 148,v,32,v,68
MV 164,v,36,v,68
s_add_u32 s66, s66, 524288
MV 152,v,32,v,72
ds_read_b128 v[60:63], v224 offset:6144
MV 168,v,36,v,72
s_and_b32 s66, s66, 8388607
MV 156,v,32,v,76
TR 32,220,16384
TR 34,220,17408
MV 172,v,36,v,76
TR 36,221,16384
TR 38,221,17408
MV 188,v,40,v,76
s_add_u32 s75, s64, s74
MV 204,v,44,v,76
MV 184,v,40,v,72
s_add_u32 m0, s67, 65536
MV 200,v,44,v,72
MV 180,v,40,v,68
buffer_load_dwordx4 v208, s[44:47], s75 offen offset:0 lds
MV 196,v,44,v,68
MV 176,v,40,v,64
TR 40,222,16384
TR 42,222,17408
MV 192,v,44,v,64
TR 44,223,16384
TR 46,223,17408
s_waitcnt lgkmcnt(4)
MV 80,v,16,v,48
buffer_load_dwordx4 v209, s[44:47], s75 offen offset:1024 lds
s_lshl_b32 s36, s2, 2
MV 96,v,20,v,48
ds_read_b128 v[64:67], v225 offset:0
s_add_u32 s36, s36, s3
MV 84,v,16,v,52
buffer_load_dwordx4 v210, s[44:47], s75 offen offset:2048 lds
s_lshl_b32 s42, s36, 1
MV 100,v,20,v,52
s_lshl_b32 s37, s36, 12
MV 88,v,16,v,56
s_add_u32 s16, s32, s37
s_addc_u32 s17, s33, 0
MV 104,v,20,v,56
buffer_load_dwordx4 v211, s[44:47], s75 offen offset:3072 lds
MV 92,v,16,v,60
TR 16,216,24576
TR 18,216,25600
MV 108,v,20,v,60
TR 20,217,24576
TR 22,217,25600
MV 124,v,24,v,60
ds_read_b128 v[68:71], v225 offset:2048
s_add_u32 s75, s65, s74
MV 140,v,28,v,60
s_mov_b32 s18, 4096
s_mov_b32 s19, 0x20000
MV 120,v,24,v,56
s_add_u32 s37, s37, 50331648
MV 136,v,28,v,56
s_add_u32 m0, s67, 69632
MV 116,v,24,v,52
ds_read_b128 v[72:75], v225 offset:4096
MV 132,v,28,v,52
s_add_u32 s20, s40, s37
s_addc_u32 s21, s41, 0
MV 112,v,24,v,48
TR 24,218,24576
TR 26,218,25600
MV 128,v,28,v,48
TR 28,219,24576
TR 30,219,25600
MV 144,v,32,v,48
buffer_load_dwordx4 v208, s[44:47], s75 offen offset:0 lds
buffer_load_dwordx4 v209, s[44:47], s75 offen offset:1024 lds
MV 160,v,36,v,48
s_mov_b32 s22, 4096
s_mov_b32 s23, 0x20000
MV 148,v,32,v,52
ds_read_b128 v[76:79], v225 offset:6144
s_lshl_b32 s37, s2, 14
MV 164,v,36,v,52
buffer_load_dwordx4 v210, s[44:47], s75 offen offset:2048 lds
s_add_u32 s37, s37, 54525952
MV 152,v,32,v,56
s_add_u32 s24, s40, s37
s_addc_u32 s25, s41, 0
MV 168,v,36,v,56
s_mov_b32 s26, 16384
s_mov_b32 s27, 0x20000
MV 156,v,32,v,60
TR 32,220,24576
TR 34,220,25600
MV 172,v,36,v,60
TR 36,221,24576
TR 38,221,25600
s_waitcnt lgkmcnt(15)
MV 188,v,40,v,60
buffer_load_dwordx4 v211, s[44:47], s75 offen offset:3072 lds
s_mov_b32 s28, s34
MV 204,v,44,v,60
s_add_u32 s74, s74, 128
s_mov_b32 s29, s35
MV 184,v,40,v,56
s_mov_b32 s30, 2048
s_mov_b32 s31, 0x20000
MV 200,v,44,v,56
s_mul_i32 s43, s3, 4608
MV 180,v,40,v,52
s_and_b32 s74, s74, 2047
s_add_u32 s43, s43, 132096
MV 196,v,44,v,52
MV 176,v,40,v,48
TR 40,222,24576
TR 42,222,25600
MV 192,v,44,v,48
TR 44,223,24576
TR 46,223,25600
s_waitcnt lgkmcnt(4)
MV 80,v,16,v,64
MV 96,v,20,v,64
MV 84,v,16,v,68
MV 100,v,20,v,68
MV 88,v,16,v,72
MV 104,v,20,v,72
MV 92,v,16,v,76
MV 108,v,20,v,76
s_waitcnt vmcnt(12) lgkmcnt(0)
s_barrier
MV 124,v,24,v,76
s_load_dwordx2 s[32:33], s[0:1], 88
TR 16,216,32768
MV 140,v,28,v,76
TR 18,216,33792
ds_read_b128 v[48:51], v224 offset:32768
MV 120,v,24,v,72
TR 20,217,32768
TR 22,217,33792
MV 136,v,28,v,72
MV 116,v,24,v,68
ds_read_b128 v[52:55], v224 offset:34816
MV 132,v,28,v,68
MV 112,v,24,v,64
TR 24,218,32768
TR 26,218,33792
MV 128,v,28,v,64
TR 28,219,32768
TR 30,219,33792
MV 144,v,32,v,64
ds_read_b128 v[56:59], v224 offset:36864
MV 160,v,36,v,64
MV 148,v,32,v,68
MV 164,v,36,v,68
MV 152,v,32,v,72
ds_read_b128 v[60:63], v224 offset:38912
MV 168,v,36,v,72
MV 156,v,32,v,76
TR 32,220,32768
TR 34,220,33792
MV 172,v,36,v,76
TR 36,221,32768
TR 38,221,33792
MV 188,v,40,v,76
MV 204,v,44,v,76
MV 184,v,40,v,72
MV 200,v,44,v,72
MV 180,v,40,v,68
MV 196,v,44,v,68
MV 176,v,40,v,64
TR 40,222,32768
TR 42,222,33792
MV 192,v,44,v,64
TR 44,223,32768
TR 46,223,33792
s_waitcnt lgkmcnt(4)
MV 80,v,16,v,48
s_add_u32 s4, s40, 109051904
s_addc_u32 s5, s41, 0
MV 96,v,20,v,48
ds_read_b128 v[64:67], v225 offset:32768
MV 84,v,16,v,52
MV 100,v,20,v,52
MV 88,v,16,v,56
s_mov_b32 s6, 4194304
MV 104,v,20,v,56
MV 92,v,16,v,60
TR 16,216,40960
TR 18,216,41984
MV 108,v,20,v,60
TR 20,217,40960
TR 22,217,41984
MV 124,v,24,v,60
ds_read_b128 v[68:71], v225 offset:34816
s_mov_b32 s7, 0x20000
MV 140,v,28,v,60
s_lshl_b32 s36, s2, 14
MV 120,v,24,v,56
MV 136,v,28,v,56
v_mov_b32 v244, -1
MV 116,v,24,v,52
ds_read_b128 v[72:75], v225 offset:36864
MV 132,v,28,v,52
v_mov_b32 v245, -1
MV 112,v,24,v,48
TR 24,218,40960
TR 26,218,41984
MV 128,v,28,v,48
TR 28,219,40960
TR 30,219,41984
MV 144,v,32,v,48
v_mov_b32 v246, -1
MV 160,v,36,v,48
MV 148,v,32,v,52
ds_read_b128 v[76:79], v225 offset:38912
v_mov_b32 v247, -1
MV 164,v,36,v,52
MV 152,v,32,v,56
buffer_store_dwordx4 v[244:247], v12, s[4:7], s36 offen offset:0 sc1
MV 168,v,36,v,56
MV 156,v,32,v,60
TR 32,220,40960
TR 34,220,41984
MV 172,v,36,v,60
TR 36,221,40960
TR 38,221,41984
s_waitcnt lgkmcnt(15)
MV 188,v,40,v,60
buffer_store_dwordx4 v[244:247], v12, s[4:7], s36 offen offset:1024 sc1
MV 204,v,44,v,60
buffer_store_dwordx4 v[244:247], v12, s[4:7], s36 offen offset:2048 sc1
MV 184,v,40,v,56
MV 200,v,44,v,56
buffer_store_dwordx4 v[244:247], v12, s[4:7], s36 offen offset:3072 sc1
MV 180,v,40,v,52
MV 196,v,44,v,52
MV 176,v,40,v,48
TR 40,222,40960
TR 42,222,41984
MV 192,v,44,v,48
TR 44,223,40960
TR 46,223,41984
s_waitcnt lgkmcnt(4)
MV 80,v,16,v,64
MV 96,v,20,v,64
MV 84,v,16,v,68
MV 100,v,20,v,68
MV 88,v,16,v,72
MV 104,v,20,v,72
MV 92,v,16,v,76
MV 108,v,20,v,76
s_waitcnt vmcnt(4) lgkmcnt(0)
s_barrier
MV 124,v,24,v,76
TR 16,216,0
TR 18,216,1024
MV 140,v,28,v,76
ds_read_b128 v[48:51], v226 offset:0
MV 120,v,24,v,72
TR 20,217,0
TR 22,217,1024
MV 136,v,28,v,72
MV 116,v,24,v,68
ds_read_b128 v[52:55], v226 offset:2048
MV 132,v,28,v,68
MV 112,v,24,v,64
TR 24,218,0
TR 26,218,1024
MV 128,v,28,v,64
TR 28,219,0
TR 30,219,1024
MV 144,v,32,v,64
ds_read_b128 v[56:59], v226 offset:4096
MV 160,v,36,v,64
MV 148,v,32,v,68
MV 164,v,36,v,68
MV 152,v,32,v,72
ds_read_b128 v[60:63], v226 offset:6144
MV 168,v,36,v,72
MV 156,v,32,v,76
TR 32,220,0
TR 34,220,1024
MV 172,v,36,v,76
TR 36,221,0
TR 38,221,1024
MV 188,v,40,v,76
MV 204,v,44,v,76
MV 184,v,40,v,72
MV 200,v,44,v,72
MV 180,v,40,v,68
MV 196,v,44,v,68
MV 176,v,40,v,64
TR 40,222,0
TR 42,222,1024
MV 192,v,44,v,64
TR 44,223,0
TR 46,223,1024
s_waitcnt lgkmcnt(4)
MV 80,v,16,v,48
buffer_load_dword v237, v233, s[8:11], 0 offen offset:0 sc1
MV 96,v,20,v,48
ds_read_b128 v[64:67], v227 offset:0
MV 84,v,16,v,52
s_lshr_b32 s36, s2, 3
MV 100,v,20,v,52
MV 88,v,16,v,56
MV 104,v,20,v,56
s_lshl_b32 s36, s36, 18
MV 92,v,16,v,60
TR 16,216,8192
TR 18,216,9216
MV 108,v,20,v,60
TR 20,217,8192
TR 22,217,9216
MV 124,v,24,v,60
ds_read_b128 v[68:71], v227 offset:2048
s_and_b32 s37, s2, 7
MV 140,v,28,v,60
MV 120,v,24,v,56
s_lshl_b32 s37, s37, 8
MV 136,v,28,v,56
MV 116,v,24,v,52
ds_read_b128 v[72:75], v227 offset:4096
s_add_u32 s36, s36, s37
MV 132,v,28,v,52
MV 112,v,24,v,48
TR 24,218,8192
TR 26,218,9216
MV 128,v,28,v,48
TR 28,219,8192
TR 30,219,9216
MV 144,v,32,v,48
s_lshl_b32 s37, s3, 16
MV 160,v,36,v,48
s_add_u32 s36, s36, s37
MV 148,v,32,v,52
ds_read_b128 v[76:79], v227 offset:6144
MV 164,v,36,v,52
MV 152,v,32,v,56
s_add_u32 s32, s32, s36
s_addc_u32 s33, s33, 0
MV 168,v,36,v,56
MV 156,v,32,v,60
TR 32,220,8192
TR 34,220,9216
MV 172,v,36,v,60
TR 36,221,8192
TR 38,221,9216
s_waitcnt lgkmcnt(15)
MV 188,v,40,v,60
MV 204,v,44,v,60
s_mov_b32 s34, 65536
MV 184,v,40,v,56
MV 200,v,44,v,56
s_mov_b32 s35, 0x20000
MV 180,v,40,v,52
MV 196,v,44,v,52
MV 176,v,40,v,48
TR 40,222,8192
TR 42,222,9216
MV 192,v,44,v,48
TR 44,223,8192
TR 46,223,9216
s_waitcnt vmcnt(0)
v_cmp_gt_u32 vcc, 1, v237
s_nop 4
s_cbranch_vccnz L_spin_f1
L_spin_f1_ret:
s_waitcnt lgkmcnt(4)
MV 80,v,16,v,64
s_add_u32 m0, s68, 16384
MV 96,v,20,v,64
MV 84,v,16,v,68
s_mov_b32 s80, 0
MV 100,v,20,v,68
MV 88,v,16,v,72
MV 104,v,20,v,72
buffer_load_dwordx4 v12, s[52:55], s80 offen offset:0 sc1 lds
MV 92,v,16,v,76
MV 108,v,20,v,76
buffer_load_dwordx4 v12, s[52:55], s80 offen offset:1024 sc1 lds
MV 124,v,24,v,76
MV 140,v,28,v,76
MV 120,v,24,v,72
buffer_load_dwordx4 v12, s[52:55], s80 offen offset:2048 sc1 lds
MV 136,v,28,v,72
MV 116,v,24,v,68
buffer_load_dwordx4 v12, s[52:55], s80 offen offset:3072 sc1 lds
MV 132,v,28,v,68
MV 112,v,24,v,64
MV 128,v,28,v,64
s_add_u32 m0, s68, 32768
MV 144,v,32,v,64
MV 160,v,36,v,64
s_mov_b32 s80, 16384
MV 148,v,32,v,68
MV 164,v,36,v,68
MV 152,v,32,v,72
buffer_load_dwordx4 v12, s[52:55], s80 offen offset:0 sc1 lds
MV 168,v,36,v,72
MV 156,v,32,v,76
buffer_load_dwordx4 v12, s[52:55], s80 offen offset:1024 sc1 lds
MV 172,v,36,v,76
s_waitcnt lgkmcnt(2)
MV 188,v,40,v,76
s_waitcnt lgkmcnt(0)
MV 204,v,44,v,76
buffer_load_dwordx4 v12, s[52:55], s80 offen offset:2048 sc1 lds
MV 184,v,40,v,72
MV 200,v,44,v,72
buffer_load_dwordx4 v12, s[52:55], s80 offen offset:3072 sc1 lds
MV 180,v,40,v,68
MV 196,v,44,v,68
MV 176,v,40,v,64
MV 192,v,44,v,64
L_p3_begin:
s_waitcnt lgkmcnt(0)
s_barrier
s_mov_b32 s82, 0x3e0293ee
s_mov_b32 s83, 0x3e0293ee
v_pk_mul_f32 v[80:81], v[80:81], s[82:83]
v_pk_mul_f32 v[82:83], v[82:83], s[82:83]
v_pk_mul_f32 v[84:85], v[84:85], s[82:83]
v_pk_mul_f32 v[86:87], v[86:87], s[82:83]
v_pk_mul_f32 v[88:89], v[88:89], s[82:83]
v_pk_mul_f32 v[90:91], v[90:91], s[82:83]
v_pk_mul_f32 v[92:93], v[92:93], s[82:83]
v_pk_mul_f32 v[94:95], v[94:95], s[82:83]
v_pk_mul_f32 v[96:97], v[96:97], s[82:83]
v_pk_mul_f32 v[98:99], v[98:99], s[82:83]
v_pk_mul_f32 v[100:101], v[100:101], s[82:83]
v_pk_mul_f32 v[102:103], v[102:103], s[82:83]
s_add_u32 m0, s68, 114688
v_pk_mul_f32 v[104:105], v[104:105], s[82:83]
v_pk_mul_f32 v[106:107], v[106:107], s[82:83]
v_pk_mul_f32 v[108:109], v[108:109], s[82:83]
v_pk_mul_f32 v[110:111], v[110:111], s[82:83]
v_cvt_pk_bf16_f32 v16, v80, v81
v_cvt_pk_bf16_f32 v17, v82, v83
v_cvt_pk_bf16_f32 v18, v96, v97
v_cvt_pk_bf16_f32 v19, v98, v99
v_cvt_pk_bf16_f32 v32, v84, v85
v_cvt_pk_bf16_f32 v33, v86, v87
v_cvt_pk_bf16_f32 v34, v100, v101
v_cvt_pk_bf16_f32 v35, v102, v103
v_cvt_pk_bf16_f32 v48, v88, v89
v_cvt_pk_bf16_f32 v49, v90, v91
v_cvt_pk_bf16_f32 v50, v104, v105
s_mov_b32 s80, 16384
v_cvt_pk_bf16_f32 v51, v106, v107
v_cvt_pk_bf16_f32 v64, v92, v93
v_cvt_pk_bf16_f32 v65, v94, v95
v_cvt_pk_bf16_f32 v66, v108, v109
v_cvt_pk_bf16_f32 v67, v110, v111
v_pk_mul_f32 v[112:113], v[112:113], s[82:83]
v_pk_mul_f32 v[114:115], v[114:115], s[82:83]
v_pk_mul_f32 v[116:117], v[116:117], s[82:83]
v_pk_mul_f32 v[118:119], v[118:119], s[82:83]
v_pk_mul_f32 v[120:121], v[120:121], s[82:83]
v_pk_mul_f32 v[122:123], v[122:123], s[82:83]
v_pk_mul_f32 v[124:125], v[124:125], s[82:83]
v_pk_mul_f32 v[126:127], v[126:127], s[82:83]
v_pk_mul_f32 v[128:129], v[128:129], s[82:83]
buffer_load_dwordx4 v12, s[56:59], s80 offen offset:0 sc1 lds
v_pk_mul_f32 v[130:131], v[130:131], s[82:83]
v_pk_mul_f32 v[132:133], v[132:133], s[82:83]
v_pk_mul_f32 v[134:135], v[134:135], s[82:83]
v_pk_mul_f32 v[136:137], v[136:137], s[82:83]
v_pk_mul_f32 v[138:139], v[138:139], s[82:83]
v_pk_mul_f32 v[140:141], v[140:141], s[82:83]
v_pk_mul_f32 v[142:143], v[142:143], s[82:83]
v_cvt_pk_bf16_f32 v20, v112, v113
v_cvt_pk_bf16_f32 v21, v114, v115
v_cvt_pk_bf16_f32 v22, v128, v129
v_cvt_pk_bf16_f32 v23, v130, v131
v_cvt_pk_bf16_f32 v36, v116, v117
v_cvt_pk_bf16_f32 v37, v118, v119
v_cvt_pk_bf16_f32 v38, v132, v133
v_cvt_pk_bf16_f32 v39, v134, v135
buffer_load_dwordx4 v12, s[56:59], s80 offen offset:1024 sc1 lds
v_cvt_pk_bf16_f32 v52, v120, v121
v_cvt_pk_bf16_f32 v53, v122, v123
v_cvt_pk_bf16_f32 v54, v136, v137
v_cvt_pk_bf16_f32 v55, v138, v139
v_cvt_pk_bf16_f32 v68, v124, v125
v_cvt_pk_bf16_f32 v69, v126, v127
v_cvt_pk_bf16_f32 v70, v140, v141
v_cvt_pk_bf16_f32 v71, v142, v143
v_pk_mul_f32 v[144:145], v[144:145], s[82:83]
v_pk_mul_f32 v[146:147], v[146:147], s[82:83]
v_pk_mul_f32 v[148:149], v[148:149], s[82:83]
v_pk_mul_f32 v[150:151], v[150:151], s[82:83]
v_pk_mul_f32 v[152:153], v[152:153], s[82:83]
v_pk_mul_f32 v[154:155], v[154:155], s[82:83]
v_pk_mul_f32 v[156:157], v[156:157], s[82:83]
buffer_load_dwordx4 v12, s[56:59], s80 offen offset:2048 sc1 lds
v_pk_mul_f32 v[158:159], v[158:159], s[82:83]
v_pk_mul_f32 v[160:161], v[160:161], s[82:83]
v_pk_mul_f32 v[162:163], v[162:163], s[82:83]
v_pk_mul_f32 v[164:165], v[164:165], s[82:83]
v_pk_mul_f32 v[166:167], v[166:167], s[82:83]
v_pk_mul_f32 v[168:169], v[168:169], s[82:83]
v_pk_mul_f32 v[170:171], v[170:171], s[82:83]
v_pk_mul_f32 v[172:173], v[172:173], s[82:83]
v_pk_mul_f32 v[174:175], v[174:175], s[82:83]
v_cvt_pk_bf16_f32 v24, v144, v145
v_cvt_pk_bf16_f32 v25, v146, v147
v_cvt_pk_bf16_f32 v26, v160, v161
v_cvt_pk_bf16_f32 v27, v162, v163
v_cvt_pk_bf16_f32 v40, v148, v149
buffer_load_dwordx4 v12, s[56:59], s80 offen offset:3072 sc1 lds
v_cvt_pk_bf16_f32 v41, v150, v151
v_cvt_pk_bf16_f32 v42, v164, v165
v_cvt_pk_bf16_f32 v43, v166, v167
v_cvt_pk_bf16_f32 v56, v152, v153
v_cvt_pk_bf16_f32 v57, v154, v155
v_cvt_pk_bf16_f32 v58, v168, v169
v_cvt_pk_bf16_f32 v59, v170, v171
v_cvt_pk_bf16_f32 v72, v156, v157
v_cvt_pk_bf16_f32 v73, v158, v159
v_cvt_pk_bf16_f32 v74, v172, v173
v_cvt_pk_bf16_f32 v75, v174, v175
v_pk_mul_f32 v[176:177], v[176:177], s[82:83]
v_pk_mul_f32 v[178:179], v[178:179], s[82:83]
v_pk_mul_f32 v[180:181], v[180:181], s[82:83]
v_pk_mul_f32 v[182:183], v[182:183], s[82:83]
s_add_u32 m0, s68, 49152
v_pk_mul_f32 v[184:185], v[184:185], s[82:83]
v_pk_mul_f32 v[186:187], v[186:187], s[82:83]
v_pk_mul_f32 v[188:189], v[188:189], s[82:83]
v_pk_mul_f32 v[190:191], v[190:191], s[82:83]
v_pk_mul_f32 v[192:193], v[192:193], s[82:83]
v_pk_mul_f32 v[194:195], v[194:195], s[82:83]
v_pk_mul_f32 v[196:197], v[196:197], s[82:83]
v_pk_mul_f32 v[198:199], v[198:199], s[82:83]
v_pk_mul_f32 v[200:201], v[200:201], s[82:83]
v_pk_mul_f32 v[202:203], v[202:203], s[82:83]
v_pk_mul_f32 v[204:205], v[204:205], s[82:83]
v_pk_mul_f32 v[206:207], v[206:207], s[82:83]
v_cvt_pk_bf16_f32 v28, v176, v177
v_cvt_pk_bf16_f32 v29, v178, v179
s_mov_b32 s80, 32768
v_cvt_pk_bf16_f32 v30, v192, v193
v_cvt_pk_bf16_f32 v31, v194, v195
v_cvt_pk_bf16_f32 v44, v180, v181
v_cvt_pk_bf16_f32 v45, v182, v183
v_cvt_pk_bf16_f32 v46, v196, v197
v_cvt_pk_bf16_f32 v47, v198, v199
v_cvt_pk_bf16_f32 v60, v184, v185
v_cvt_pk_bf16_f32 v61, v186, v187
v_cvt_pk_bf16_f32 v62, v200, v201
v_cvt_pk_bf16_f32 v63, v202, v203
v_cvt_pk_bf16_f32 v76, v188, v189
v_cvt_pk_bf16_f32 v77, v190, v191
v_cvt_pk_bf16_f32 v78, v204, v205
v_cvt_pk_bf16_f32 v79, v206, v207
v_mov_b32 v2, 0
buffer_load_dwordx4 v12, s[52:55], s80 offen offset:0 sc1 lds
v_mov_b32 v3, 0
v_mov_b32 v4, 0
v_mov_b32 v5, 0
v_accvgpr_write_b32 a0, 0
v_accvgpr_write_b32 a1, 0
v_accvgpr_write_b32 a2, 0
v_accvgpr_write_b32 a3, 0
v_accvgpr_write_b32 a4, 0
v_accvgpr_write_b32 a5, 0
v_accvgpr_write_b32 a6, 0
v_accvgpr_write_b32 a7, 0
v_accvgpr_write_b32 a8, 0
v_accvgpr_write_b32 a9, 0
v_accvgpr_write_b32 a10, 0
v_accvgpr_write_b32 a11, 0
buffer_load_dwordx4 v12, s[52:55], s80 offen offset:1024 sc1 lds
v_accvgpr_write_b32 a12, 0
v_accvgpr_write_b32 a13, 0
v_accvgpr_write_b32 a14, 0
v_accvgpr_write_b32 a15, 0
v_accvgpr_write_b32 a16, 0
v_accvgpr_write_b32 a17, 0
v_accvgpr_write_b32 a18, 0
v_accvgpr_write_b32 a19, 0
v_accvgpr_write_b32 a20, 0
v_accvgpr_write_b32 a21, 0
v_accvgpr_write_b32 a22, 0
v_accvgpr_write_b32 a23, 0
v_accvgpr_write_b32 a24, 0
v_accvgpr_write_b32 a25, 0
buffer_load_dwordx4 v12, s[52:55], s80 offen offset:2048 sc1 lds
v_accvgpr_write_b32 a26, 0
v_accvgpr_write_b32 a27, 0
v_accvgpr_write_b32 a28, 0
v_accvgpr_write_b32 a29, 0
v_accvgpr_write_b32 a30, 0
v_accvgpr_write_b32 a31, 0
v_accvgpr_write_b32 a32, 0
v_accvgpr_write_b32 a33, 0
v_accvgpr_write_b32 a34, 0
v_accvgpr_write_b32 a35, 0
v_accvgpr_write_b32 a36, 0
v_accvgpr_write_b32 a37, 0
v_accvgpr_write_b32 a38, 0
v_accvgpr_write_b32 a39, 0
v_accvgpr_write_b32 a40, 0
buffer_load_dwordx4 v12, s[52:55], s80 offen offset:3072 sc1 lds
v_accvgpr_write_b32 a41, 0
v_accvgpr_write_b32 a42, 0
v_accvgpr_write_b32 a43, 0
v_accvgpr_write_b32 a44, 0
v_accvgpr_write_b32 a45, 0
v_accvgpr_write_b32 a46, 0
v_accvgpr_write_b32 a47, 0
v_accvgpr_write_b32 a48, 0
v_accvgpr_write_b32 a49, 0
v_accvgpr_write_b32 a50, 0
v_accvgpr_write_b32 a51, 0
v_accvgpr_write_b32 a52, 0
v_accvgpr_write_b32 a53, 0
v_accvgpr_write_b32 a54, 0
s_add_u32 m0, s68, 65536
v_accvgpr_write_b32 a55, 0
v_accvgpr_write_b32 a56, 0
v_accvgpr_write_b32 a57, 0
v_accvgpr_write_b32 a58, 0
v_accvgpr_write_b32 a59, 0
v_accvgpr_write_b32 a60, 0
v_accvgpr_write_b32 a61, 0
v_accvgpr_write_b32 a62, 0
v_accvgpr_write_b32 a63, 0
v_accvgpr_write_b32 a64, 0
v_accvgpr_write_b32 a65, 0
v_accvgpr_write_b32 a66, 0
v_accvgpr_write_b32 a67, 0
v_accvgpr_write_b32 a68, 0
v_accvgpr_write_b32 a69, 0
s_mov_b32 s80, 32768
v_accvgpr_write_b32 a70, 0
v_accvgpr_write_b32 a71, 0
v_accvgpr_write_b32 a72, 0
v_accvgpr_write_b32 a73, 0
v_accvgpr_write_b32 a74, 0
v_accvgpr_write_b32 a75, 0
v_accvgpr_write_b32 a76, 0
v_accvgpr_write_b32 a77, 0
v_accvgpr_write_b32 a78, 0
v_accvgpr_write_b32 a79, 0
v_accvgpr_write_b32 a80, 0
v_accvgpr_write_b32 a81, 0
v_accvgpr_write_b32 a82, 0
v_accvgpr_write_b32 a83, 0
v_accvgpr_write_b32 a84, 0
buffer_load_dwordx4 v12, s[56:59], s80 offen offset:0 sc1 lds
v_accvgpr_write_b32 a85, 0
v_accvgpr_write_b32 a86, 0
v_accvgpr_write_b32 a87, 0
v_accvgpr_write_b32 a88, 0
v_accvgpr_write_b32 a89, 0
v_accvgpr_write_b32 a90, 0
v_accvgpr_write_b32 a91, 0
v_accvgpr_write_b32 a92, 0
v_accvgpr_write_b32 a93, 0
v_accvgpr_write_b32 a94, 0
v_accvgpr_write_b32 a95, 0
v_accvgpr_write_b32 a96, 0
v_accvgpr_write_b32 a97, 0
v_accvgpr_write_b32 a98, 0
buffer_load_dwordx4 v12, s[56:59], s80 offen offset:1024 sc1 lds
v_accvgpr_write_b32 a99, 0
v_accvgpr_write_b32 a100, 0
v_accvgpr_write_b32 a101, 0
v_accvgpr_write_b32 a102, 0
v_accvgpr_write_b32 a103, 0
v_accvgpr_write_b32 a104, 0
v_accvgpr_write_b32 a105, 0
v_accvgpr_write_b32 a106, 0
v_accvgpr_write_b32 a107, 0
v_accvgpr_write_b32 a108, 0
v_accvgpr_write_b32 a109, 0
v_accvgpr_write_b32 a110, 0
v_accvgpr_write_b32 a111, 0
v_accvgpr_write_b32 a112, 0
v_accvgpr_write_b32 a113, 0
buffer_load_dwordx4 v12, s[56:59], s80 offen offset:2048 sc1 lds
v_accvgpr_write_b32 a114, 0
v_accvgpr_write_b32 a115, 0
v_accvgpr_write_b32 a116, 0
v_accvgpr_write_b32 a117, 0
v_accvgpr_write_b32 a118, 0
v_accvgpr_write_b32 a119, 0
v_accvgpr_write_b32 a120, 0
v_accvgpr_write_b32 a121, 0
v_accvgpr_write_b32 a122, 0
v_accvgpr_write_b32 a123, 0
v_accvgpr_write_b32 a124, 0
v_accvgpr_write_b32 a125, 0
v_accvgpr_write_b32 a126, 0
v_accvgpr_write_b32 a127, 0
v_xor_b32 v244, 0x8000, v10
buffer_load_dwordx4 v12, s[56:59], s80 offen offset:3072 sc1 lds
s_waitcnt vmcnt(16)
s_barrier
ds_read_b128 a[128:131], v244 offset:16384
ds_read_b128 a[132:135], v244 offset:17408
ds_read_b128 a[136:139], v244 offset:18432
ds_read_b128 a[140:143], v244 offset:19456
ds_read_b128 a[144:147], v244 offset:20480
ds_read_b128 a[148:151], v244 offset:21504
ds_read_b128 a[152:155], v244 offset:22528
ds_read_b128 a[156:159], v244 offset:23552
ds_read_b128 a[160:163], v244 offset:24576
ds_read_b128 a[164:167], v244 offset:25600
ds_read_b128 a[168:171], v244 offset:26624
ds_read_b128 a[172:175], v244 offset:27648
ds_read_b128 a[176:179], v244 offset:28672
ds_read_b128 a[180:183], v244 offset:29696
ds_read_b128 a[184:187], v244 offset:30720
ds_read_b128 a[188:191], v244 offset:31744
s_waitcnt lgkmcnt(15)
v_mfma_f32_16x16x32_bf16 v[80:83], a[128:131], v[16:19], 0
s_add_u32 m0, s68, 0
v_mfma_f32_16x16x32_bf16 v[88:91], a[128:131], v[32:35], 0
s_mov_b32 s80, 49152
v_mfma_f32_16x16x32_bf16 v[96:99], a[128:131], v[48:51], 0
v_mfma_f32_16x16x32_bf16 v[104:107], a[128:131], v[64:67], 0
buffer_load_dwordx4 v12, s[52:55], s80 offen offset:0 sc1 lds
s_waitcnt lgkmcnt(14)
MV 80,a,132,v,20
MV 88,a,132,v,36
buffer_load_dwordx4 v12, s[52:55], s80 offen offset:1024 sc1 lds
MV 96,a,132,v,52
MV 104,a,132,v,68
buffer_load_dwordx4 v12, s[52:55], s80 offen offset:2048 sc1 lds
s_waitcnt lgkmcnt(13)
MV 80,a,136,v,24
MV 88,a,136,v,40
buffer_load_dwordx4 v12, s[52:55], s80 offen offset:3072 sc1 lds
MV 96,a,136,v,56
MV 104,a,136,v,72
s_add_u32 m0, s68, 81920
s_waitcnt lgkmcnt(12)
MV 80,a,140,v,28
s_mov_b32 s80, 49152
MV 88,a,140,v,44
MV 96,a,140,v,60
buffer_load_dwordx4 v12, s[56:59], s80 offen offset:0 sc1 lds
MV 104,a,140,v,76
s_waitcnt lgkmcnt(11)
v_mfma_f32_16x16x32_bf16 v[84:87], a[144:147], v[16:19], 0
buffer_load_dwordx4 v12, s[56:59], s80 offen offset:1024 sc1 lds
v_mfma_f32_16x16x32_bf16 v[92:95], a[144:147], v[32:35], 0
v_mfma_f32_16x16x32_bf16 v[100:103], a[144:147], v[48:51], 0
buffer_load_dwordx4 v12, s[56:59], s80 offen offset:2048 sc1 lds
v_mfma_f32_16x16x32_bf16 v[108:111], a[144:147], v[64:67], 0
s_waitcnt lgkmcnt(10)
MV 84,a,148,v,20
buffer_load_dwordx4 v12, s[56:59], s80 offen offset:3072 sc1 lds
MV 92,a,148,v,36
MV 100,a,148,v,52
MV 108,a,148,v,68
s_waitcnt lgkmcnt(9)
MV 84,a,152,v,24
s_waitcnt vmcnt(16) lgkmcnt(0)
s_barrier
MV 92,a,152,v,40
ds_read_b128 a[128:131], v10 offset:0
s_add_u32 m0, s68, 16384
MV 100,a,152,v,56
ds_read_b128 a[132:135], v10 offset:1024
s_mov_b32 s80, 65536
MV 108,a,152,v,72
ds_read_b128 a[136:139], v10 offset:2048
buffer_load_dwordx4 v12, s[52:55], s80 offen offset:0 sc1 lds
MV 84,a,156,v,28
ds_read_b128 a[140:143], v10 offset:3072
buffer_load_dwordx4 v12, s[52:55], s80 offen offset:1024 sc1 lds
MV 92,a,156,v,44
ds_read_b128 a[144:147], v10 offset:4096
buffer_load_dwordx4 v12, s[52:55], s80 offen offset:2048 sc1 lds
MV 100,a,156,v,60
ds_read_b128 a[148:151], v10 offset:5120
buffer_load_dwordx4 v12, s[52:55], s80 offen offset:3072 sc1 lds
MV 108,a,156,v,76
ds_read_b128 a[152:155], v10 offset:6144
s_mov_b32 s71, 65536
v_mfma_f32_16x16x32_bf16 v[112:115], a[160:163], v[16:19], 0
ds_read_b128 a[156:159], v10 offset:7168
v_mfma_f32_16x16x32_bf16 v[120:123], a[160:163], v[32:35], 0
v_lshrrev_b32 v245, 4, v1
v_mfma_f32_16x16x32_bf16 v[128:131], a[160:163], v[48:51], 0
v_and_b32 v246, 15, v1
v_mfma_f32_16x16x32_bf16 v[136:139], a[160:163], v[64:67], 0
ds_read_b128 a[160:163], v10 offset:8192
v_lshlrev_b32 v247, 1, v245
MV 112,a,164,v,20
v_xor_b32 v246, v246, v247
MV 120,a,164,v,36
v_lshlrev_b32 v245, 11, v245
MV 128,a,164,v,52
v_lshl_add_u32 v245, v246, 4, v245
MV 136,a,164,v,68
ds_read_b128 a[164:167], v10 offset:9216
v_xor_b32 v246, 128, v245
MV 112,a,168,v,24
MV 120,a,168,v,40
s_lshl_b32 s36, s3, 13
MV 128,a,168,v,56
s_add_u32 m0, s36, 131072
MV 136,a,168,v,72
ds_read_b128 a[168:171], v10 offset:10240
s_mov_b32 s37, 0
MV 112,a,172,v,28
buffer_load_dwordx4 v245, s[32:35], s37 offen offset:0 lds
MV 120,a,172,v,44
s_mov_b32 s37, 7168
MV 128,a,172,v,60
buffer_load_dwordx4 v246, s[32:35], s37 offen offset:1024 lds
MV 136,a,172,v,76
ds_read_b128 a[172:175], v10 offset:11264
v_mfma_f32_16x16x32_bf16 v[116:119], a[176:179], v[16:19], 0
s_mov_b32 s37, 14336
v_mfma_f32_16x16x32_bf16 v[124:127], a[176:179], v[32:35], 0
buffer_load_dwordx4 v245, s[32:35], s37 offen offset:2048 lds
v_mfma_f32_16x16x32_bf16 v[132:135], a[176:179], v[48:51], 0
s_mov_b32 s37, 21504
v_mfma_f32_16x16x32_bf16 v[140:143], a[176:179], v[64:67], 0
ds_read_b128 a[176:179], v10 offset:12288
buffer_load_dwordx4 v246, s[32:35], s37 offen offset:3072 lds
MV 116,a,180,v,20
s_add_u32 m0, s36, 135168
MV 124,a,180,v,36
s_mov_b32 s37, 32768
MV 132,a,180,v,52
buffer_load_dwordx4 v245, s[32:35], s37 offen offset:0 lds
MV 140,a,180,v,68
ds_read_b128 a[180:183], v10 offset:13312
MV 116,a,184,v,24
s_mov_b32 s37, 39936
MV 124,a,184,v,40
buffer_load_dwordx4 v246, s[32:35], s37 offen offset:1024 lds
MV 132,a,184,v,56
s_mov_b32 s37, 47104
MV 140,a,184,v,72
ds_read_b128 a[184:187], v10 offset:14336
buffer_load_dwordx4 v245, s[32:35], s37 offen offset:2048 lds
MV 116,a,188,v,28
s_mov_b32 s37, 54272
MV 124,a,188,v,44
buffer_load_dwordx4 v246, s[32:35], s37 offen offset:3072 lds
MV 132,a,188,v,60
MV 140,a,188,v,76
ds_read_b128 a[188:191], v10 offset:15360
s_cmp_eq_u32 s70, 0
s_cbranch_scc1 L_p3_pmask
L_p3_pmask_ret:
v_exp_f32 v80, v80
v_exp_f32 v81, v81
v_exp_f32 v82, v82
v_add_f32 v2, v2, v80
v_add_f32 v2, v2, v81
v_exp_f32 v83, v83
v_cvt_pk_bf16_f32 v80, v80, v81
v_exp_f32 v84, v84
v_add_f32 v2, v2, v82
v_add_f32 v2, v2, v83
v_exp_f32 v85, v85
v_cvt_pk_bf16_f32 v81, v82, v83
v_exp_f32 v86, v86
v_add_f32 v2, v2, v84
v_add_f32 v2, v2, v85
v_exp_f32 v87, v87
v_cvt_pk_bf16_f32 v82, v84, v85
v_exp_f32 v88, v88
v_add_f32 v2, v2, v86
v_add_f32 v2, v2, v87
v_exp_f32 v89, v89
v_cvt_pk_bf16_f32 v83, v86, v87
v_exp_f32 v90, v90
v_add_f32 v3, v3, v88
v_add_f32 v3, v3, v89
v_exp_f32 v91, v91
v_cvt_pk_bf16_f32 v88, v88, v89
v_exp_f32 v92, v92
v_add_f32 v3, v3, v90
v_add_f32 v3, v3, v91
v_exp_f32 v93, v93
v_cvt_pk_bf16_f32 v89, v90, v91
v_exp_f32 v94, v94
v_add_f32 v3, v3, v92
v_add_f32 v3, v3, v93
v_exp_f32 v95, v95
v_cvt_pk_bf16_f32 v90, v92, v93
v_exp_f32 v96, v96
v_add_f32 v3, v3, v94
v_add_f32 v3, v3, v95
v_exp_f32 v97, v97
v_cvt_pk_bf16_f32 v91, v94, v95
v_exp_f32 v98, v98
v_add_f32 v4, v4, v96
v_add_f32 v4, v4, v97
v_exp_f32 v99, v99
v_cvt_pk_bf16_f32 v96, v96, v97
v_exp_f32 v100, v100
v_add_f32 v4, v4, v98
v_add_f32 v4, v4, v99
v_exp_f32 v101, v101
v_cvt_pk_bf16_f32 v97, v98, v99
v_exp_f32 v102, v102
v_add_f32 v4, v4, v100
v_add_f32 v4, v4, v101
v_exp_f32 v103, v103
v_cvt_pk_bf16_f32 v98, v100, v101
v_exp_f32 v104, v104
v_add_f32 v4, v4, v102
v_add_f32 v4, v4, v103
v_exp_f32 v105, v105
v_cvt_pk_bf16_f32 v99, v102, v103
v_exp_f32 v106, v106
v_add_f32 v5, v5, v104
v_add_f32 v5, v5, v105
v_exp_f32 v107, v107
v_cvt_pk_bf16_f32 v104, v104, v105
v_exp_f32 v108, v108
v_add_f32 v5, v5, v106
v_add_f32 v5, v5, v107
v_exp_f32 v109, v109
v_cvt_pk_bf16_f32 v105, v106, v107
v_exp_f32 v110, v110
v_add_f32 v5, v5, v108
v_add_f32 v5, v5, v109
v_exp_f32 v111, v111
v_cvt_pk_bf16_f32 v106, v108, v109
v_add_f32 v5, v5, v110
v_add_f32 v5, v5, v111
v_cvt_pk_bf16_f32 v107, v110, v111
s_sub_u32 s74, s70, 1
s_cbranch_scc1 L_p3_d0m_top
.p2align 5
L_p3_d0_top:
s_waitcnt lgkmcnt(0)
v_mfma_f32_16x16x32_bf16 v[144:147], a[128:131], v[16:19], 0
s_add_u32 m0, s73, 0
ds_read_b128 a[192:195], v11 offset:16384
v_mfma_f32_16x16x32_bf16 v[152:155], a[128:131], v[32:35], 0
v_exp_f32 v112, v112
v_mfma_f32_16x16x32_bf16 v[148:151], a[144:147], v[16:19], 0
ds_read_b128 a[196:199], v11 offset:17408
buffer_load_dwordx4 v12, s[56:59], s71 offen offset:0 sc1 lds
v_mfma_f32_16x16x32_bf16 v[156:159], a[144:147], v[32:35], 0
v_exp_f32 v113, v113
v_mfma_f32_16x16x32_bf16 v[176:179], a[160:163], v[16:19], 0
v_exp_f32 v114, v114
v_mfma_f32_16x16x32_bf16 v[184:187], a[160:163], v[32:35], 0
v_add_f32 v2, v2, v112
v_add_f32 v2, v2, v113
v_mfma_f32_16x16x32_bf16 v[180:183], a[176:179], v[16:19], 0
v_exp_f32 v115, v115
v_mfma_f32_16x16x32_bf16 v[188:191], a[176:179], v[32:35], 0
ds_read_b128 a[200:203], v11 offset:18432
v_cvt_pk_bf16_f32 v112, v112, v113
v_mfma_f32_16x16x32_bf16 v[196:199], a[176:179], v[48:51], 0
v_exp_f32 v116, v116
v_mfma_f32_16x16x32_bf16 v[204:207], a[176:179], v[64:67], 0
v_add_f32 v2, v2, v114
v_add_f32 v2, v2, v115
v_mfma_f32_16x16x32_bf16 v[192:195], a[160:163], v[48:51], 0
v_exp_f32 v117, v117
v_mfma_f32_16x16x32_bf16 v[200:203], a[160:163], v[64:67], 0
ds_read_b128 a[204:207], v11 offset:19456
v_cvt_pk_bf16_f32 v113, v114, v115
v_mfma_f32_16x16x32_bf16 v[164:167], a[144:147], v[48:51], 0
v_exp_f32 v118, v118
v_mfma_f32_16x16x32_bf16 v[172:175], a[144:147], v[64:67], 0
ds_read_b128 a[208:211], v11 offset:20480
v_add_f32 v2, v2, v116
v_mfma_f32_16x16x32_bf16 v[160:163], a[128:131], v[48:51], 0
buffer_load_dwordx4 v12, s[56:59], s71 offen offset:1024 sc1 lds
v_add_f32 v2, v2, v117
v_mfma_f32_16x16x32_bf16 v[168:171], a[128:131], v[64:67], 0
v_exp_f32 v119, v119
MV 180,a,180,v,20
ds_read_b128 a[212:215], v11 offset:21504
v_cvt_pk_bf16_f32 v114, v116, v117
MV 188,a,180,v,36
v_exp_f32 v120, v120
MV 176,a,164,v,20
v_add_f32 v2, v2, v118
v_add_f32 v2, v2, v119
MV 184,a,164,v,36
v_exp_f32 v121, v121
MV 148,a,148,v,20
ds_read_b128 a[216:219], v11 offset:22528
v_cvt_pk_bf16_f32 v115, v118, v119
MV 156,a,148,v,36
v_exp_f32 v122, v122
MV 144,a,132,v,20
v_add_f32 v3, v3, v120
v_add_f32 v3, v3, v121
MV 152,a,132,v,36
v_exp_f32 v123, v123
MV 160,a,132,v,52
ds_read_b128 a[220:223], v11 offset:23552
v_cvt_pk_bf16_f32 v120, v120, v121
MV 168,a,132,v,68
v_exp_f32 v124, v124
MV 164,a,148,v,52
ds_read_b128 a[224:227], v11 offset:24576
v_add_f32 v3, v3, v122
MV 172,a,148,v,68
buffer_load_dwordx4 v12, s[56:59], s71 offen offset:2048 sc1 lds
v_add_f32 v3, v3, v123
MV 192,a,164,v,52
v_exp_f32 v125, v125
MV 200,a,164,v,68
ds_read_b128 a[228:231], v11 offset:25600
v_cvt_pk_bf16_f32 v121, v122, v123
MV 196,a,180,v,52
v_exp_f32 v126, v126
MV 204,a,180,v,68
v_add_f32 v3, v3, v124
v_add_f32 v3, v3, v125
MV 144,a,136,v,24
v_exp_f32 v127, v127
MV 152,a,136,v,40
ds_read_b128 a[232:235], v11 offset:26624
v_cvt_pk_bf16_f32 v122, v124, v125
MV 148,a,152,v,24
v_exp_f32 v128, v128
MV 156,a,152,v,40
v_add_f32 v3, v3, v126
v_add_f32 v3, v3, v127
MV 176,a,168,v,24
v_exp_f32 v129, v129
MV 184,a,168,v,40
ds_read_b128 a[236:239], v11 offset:27648
v_cvt_pk_bf16_f32 v123, v126, v127
MV 180,a,184,v,24
v_exp_f32 v130, v130
MV 188,a,184,v,40
ds_read_b128 a[240:243], v11 offset:28672
v_add_f32 v4, v4, v128
MV 196,a,184,v,56
buffer_load_dwordx4 v12, s[56:59], s71 offen offset:3072 sc1 lds
v_add_f32 v4, v4, v129
MV 204,a,184,v,72
v_exp_f32 v131, v131
MV 192,a,168,v,56
ds_read_b128 a[244:247], v11 offset:29696
v_cvt_pk_bf16_f32 v128, v128, v129
MV 200,a,168,v,72
v_exp_f32 v132, v132
MV 164,a,152,v,56
v_add_f32 v4, v4, v130
v_add_f32 v4, v4, v131
MV 172,a,152,v,72
v_exp_f32 v133, v133
MV 160,a,136,v,56
ds_read_b128 a[248:251], v11 offset:30720
v_cvt_pk_bf16_f32 v129, v130, v131
MV 168,a,136,v,72
v_exp_f32 v134, v134
MV 180,a,188,v,28
v_add_f32 v4, v4, v132
v_add_f32 v4, v4, v133
MV 188,a,188,v,44
v_exp_f32 v135, v135
MV 176,a,172,v,28
ds_read_b128 a[252:255], v11 offset:31744
v_cvt_pk_bf16_f32 v130, v132, v133
MV 184,a,172,v,44
v_exp_f32 v136, v136
MV 148,a,156,v,28
v_add_f32 v4, v4, v134
v_add_f32 v4, v4, v135
MV 156,a,156,v,44
v_exp_f32 v137, v137
MV 144,a,140,v,28
s_add_u32 s71, s71, 16384
v_cvt_pk_bf16_f32 v131, v134, v135
MV 152,a,140,v,44
v_exp_f32 v138, v138
MV 160,a,140,v,60
v_add_f32 v5, v5, v136
v_add_f32 v5, v5, v137
MV 168,a,140,v,76
v_exp_f32 v139, v139
MV 164,a,156,v,60
v_cvt_pk_bf16_f32 v136, v136, v137
MV 172,a,156,v,76
v_exp_f32 v140, v140
MV 192,a,172,v,60
v_add_f32 v5, v5, v138
v_add_f32 v5, v5, v139
MV 200,a,172,v,76
v_exp_f32 v141, v141
MV 196,a,188,v,60
v_cvt_pk_bf16_f32 v137, v138, v139
MV 204,a,188,v,76
v_exp_f32 v142, v142
v_add_f32 v5, v5, v140
v_add_f32 v5, v5, v141
v_exp_f32 v143, v143
v_cvt_pk_bf16_f32 v138, v140, v141
v_add_f32 v5, v5, v142
v_add_f32 v5, v5, v143
v_cvt_pk_bf16_f32 v139, v142, v143
s_waitcnt vmcnt(16) lgkmcnt(0)
MA 0,a,192,v,80
s_barrier
MA 32,a,192,v,88
s_add_u32 m0, s72, 0
ds_read_b128 a[128:131], v10 offset:16384
MA 4,a,196,v,80
ds_read_b128 a[132:135], v10 offset:17408
buffer_load_dwordx4 v12, s[52:55], s71 offen offset:0 sc1 lds
MA 36,a,196,v,88
v_exp_f32 v144, v144
MA 8,a,200,v,80
v_exp_f32 v145, v145
MA 40,a,200,v,88
v_exp_f32 v146, v146
MA 12,a,204,v,80
v_add_f32 v2, v2, v144
v_add_f32 v2, v2, v145
MA 44,a,204,v,88
ds_read_b128 a[136:139], v10 offset:18432
ds_read_b128 a[140:143], v10 offset:19456
MA 16,a,208,v,80
v_exp_f32 v147, v147
MA 48,a,208,v,88
ds_read_b128 a[144:147], v10 offset:20480
v_cvt_pk_bf16_f32 v144, v144, v145
MA 20,a,212,v,80
v_exp_f32 v148, v148
MA 52,a,212,v,88
v_add_f32 v2, v2, v146
v_add_f32 v2, v2, v147
MA 24,a,216,v,80
v_exp_f32 v149, v149
MA 56,a,216,v,88
buffer_load_dwordx4 v12, s[52:55], s71 offen offset:1024 sc1 lds
v_cvt_pk_bf16_f32 v145, v146, v147
MA 28,a,220,v,80
v_exp_f32 v150, v150
MA 60,a,220,v,88
v_add_f32 v2, v2, v148
v_add_f32 v2, v2, v149
MA 92,a,220,v,96
v_exp_f32 v151, v151
MA 124,a,220,v,104
ds_read_b128 a[148:151], v10 offset:21504
v_cvt_pk_bf16_f32 v146, v148, v149
MA 88,a,216,v,96
v_exp_f32 v152, v152
MA 120,a,216,v,104
v_add_f32 v2, v2, v150
v_add_f32 v2, v2, v151
MA 84,a,212,v,96
ds_read_b128 a[152:155], v10 offset:22528
ds_read_b128 a[156:159], v10 offset:23552
MA 116,a,212,v,104
v_exp_f32 v153, v153
MA 80,a,208,v,96
ds_read_b128 a[160:163], v10 offset:24576
v_cvt_pk_bf16_f32 v147, v150, v151
MA 112,a,208,v,104
v_exp_f32 v154, v154
MA 76,a,204,v,96
v_add_f32 v3, v3, v152
v_add_f32 v3, v3, v153
MA 108,a,204,v,104
v_exp_f32 v155, v155
MA 72,a,200,v,96
buffer_load_dwordx4 v12, s[52:55], s71 offen offset:2048 sc1 lds
v_cvt_pk_bf16_f32 v152, v152, v153
MA 104,a,200,v,104
v_exp_f32 v156, v156
MA 68,a,196,v,96
v_add_f32 v3, v3, v154
v_add_f32 v3, v3, v155
MA 100,a,196,v,104
v_exp_f32 v157, v157
MA 64,a,192,v,96
ds_read_b128 a[164:167], v10 offset:25600
v_cvt_pk_bf16_f32 v153, v154, v155
MA 96,a,192,v,104
v_exp_f32 v158, v158
MA 0,a,224,v,112
v_add_f32 v3, v3, v156
v_add_f32 v3, v3, v157
MA 32,a,224,v,120
v_exp_f32 v159, v159
MA 4,a,228,v,112
ds_read_b128 a[168:171], v10 offset:26624
v_cvt_pk_bf16_f32 v154, v156, v157
MA 36,a,228,v,120
v_exp_f32 v160, v160
MA 8,a,232,v,112
ds_read_b128 a[172:175], v10 offset:27648
v_add_f32 v3, v3, v158
MA 40,a,232,v,120
ds_read_b128 a[176:179], v10 offset:28672
v_add_f32 v3, v3, v159
MA 12,a,236,v,112
v_exp_f32 v161, v161
MA 44,a,236,v,120
ds_read_b128 a[180:183], v10 offset:29696
v_cvt_pk_bf16_f32 v155, v158, v159
MA 16,a,240,v,112
v_exp_f32 v162, v162
MA 48,a,240,v,120
v_add_f32 v4, v4, v160
v_add_f32 v4, v4, v161
MA 20,a,244,v,112
v_exp_f32 v163, v163
MA 52,a,244,v,120
buffer_load_dwordx4 v12, s[52:55], s71 offen offset:3072 sc1 lds
v_cvt_pk_bf16_f32 v160, v160, v161
MA 24,a,248,v,112
v_exp_f32 v164, v164
MA 56,a,248,v,120
v_add_f32 v4, v4, v162
v_add_f32 v4, v4, v163
MA 28,a,252,v,112
v_exp_f32 v165, v165
MA 60,a,252,v,120
ds_read_b128 a[184:187], v10 offset:30720
v_cvt_pk_bf16_f32 v161, v162, v163
MA 92,a,252,v,128
v_exp_f32 v166, v166
MA 124,a,252,v,136
v_add_f32 v4, v4, v164
v_add_f32 v4, v4, v165
MA 88,a,248,v,128
ds_read_b128 a[188:191], v10 offset:31744
s_sub_u32 s74, s74, 1
MA 120,a,248,v,136
v_exp_f32 v167, v167
MA 84,a,244,v,128
v_cvt_pk_bf16_f32 v162, v164, v165
MA 116,a,244,v,136
v_exp_f32 v168, v168
MA 80,a,240,v,128
v_add_f32 v4, v4, v166
v_add_f32 v4, v4, v167
MA 112,a,240,v,136
v_exp_f32 v169, v169
MA 76,a,236,v,128
v_cvt_pk_bf16_f32 v163, v166, v167
MA 108,a,236,v,136
v_exp_f32 v170, v170
MA 72,a,232,v,128
v_add_f32 v5, v5, v168
v_add_f32 v5, v5, v169
MA 104,a,232,v,136
v_exp_f32 v171, v171
MA 68,a,228,v,128
v_cvt_pk_bf16_f32 v168, v168, v169
MA 100,a,228,v,136
v_exp_f32 v172, v172
MA 64,a,224,v,128
v_add_f32 v5, v5, v170
v_add_f32 v5, v5, v171
MA 96,a,224,v,136
v_exp_f32 v173, v173
v_cvt_pk_bf16_f32 v169, v170, v171
v_exp_f32 v174, v174
v_add_f32 v5, v5, v172
v_add_f32 v5, v5, v173
v_exp_f32 v175, v175
v_cvt_pk_bf16_f32 v170, v172, v173
v_add_f32 v5, v5, v174
v_add_f32 v5, v5, v175
v_cvt_pk_bf16_f32 v171, v174, v175
s_cbranch_scc1 L_p3_d1m_top
s_waitcnt lgkmcnt(0)
v_xor_b32 v11, 0x8000, v11
v_mfma_f32_16x16x32_bf16 v[80:83], a[128:131], v[16:19], 0
s_add_u32 m0, s73, 16384
ds_read_b128 a[192:195], v11 offset:0
v_mfma_f32_16x16x32_bf16 v[88:91], a[128:131], v[32:35], 0
v_exp_f32 v176, v176
v_mfma_f32_16x16x32_bf16 v[84:87], a[144:147], v[16:19], 0
ds_read_b128 a[196:199], v11 offset:1024
buffer_load_dwordx4 v12, s[56:59], s71 offen offset:0 sc1 lds
v_mfma_f32_16x16x32_bf16 v[92:95], a[144:147], v[32:35], 0
v_exp_f32 v177, v177
v_mfma_f32_16x16x32_bf16 v[112:115], a[160:163], v[16:19], 0
v_exp_f32 v178, v178
v_mfma_f32_16x16x32_bf16 v[120:123], a[160:163], v[32:35], 0
v_add_f32 v2, v2, v176
v_add_f32 v2, v2, v177
v_mfma_f32_16x16x32_bf16 v[116:119], a[176:179], v[16:19], 0
v_exp_f32 v179, v179
v_mfma_f32_16x16x32_bf16 v[124:127], a[176:179], v[32:35], 0
ds_read_b128 a[200:203], v11 offset:2048
v_cvt_pk_bf16_f32 v176, v176, v177
v_mfma_f32_16x16x32_bf16 v[132:135], a[176:179], v[48:51], 0
v_exp_f32 v180, v180
v_mfma_f32_16x16x32_bf16 v[140:143], a[176:179], v[64:67], 0
v_add_f32 v2, v2, v178
v_add_f32 v2, v2, v179
v_mfma_f32_16x16x32_bf16 v[128:131], a[160:163], v[48:51], 0
v_exp_f32 v181, v181
v_mfma_f32_16x16x32_bf16 v[136:139], a[160:163], v[64:67], 0
ds_read_b128 a[204:207], v11 offset:3072
v_cvt_pk_bf16_f32 v177, v178, v179
v_mfma_f32_16x16x32_bf16 v[100:103], a[144:147], v[48:51], 0
v_exp_f32 v182, v182
v_mfma_f32_16x16x32_bf16 v[108:111], a[144:147], v[64:67], 0
buffer_load_dwordx4 v12, s[56:59], s71 offen offset:1024 sc1 lds
v_add_f32 v2, v2, v180
v_mfma_f32_16x16x32_bf16 v[96:99], a[128:131], v[48:51], 0
ds_read_b128 a[208:211], v11 offset:4096
v_add_f32 v2, v2, v181
v_mfma_f32_16x16x32_bf16 v[104:107], a[128:131], v[64:67], 0
v_exp_f32 v183, v183
MV 116,a,180,v,20
ds_read_b128 a[212:215], v11 offset:5120
v_cvt_pk_bf16_f32 v178, v180, v181
MV 124,a,180,v,36
v_exp_f32 v184, v184
MV 112,a,164,v,20
v_add_f32 v2, v2, v182
v_add_f32 v2, v2, v183
MV 120,a,164,v,36
v_exp_f32 v185, v185
MV 84,a,148,v,20
ds_read_b128 a[216:219], v11 offset:6144
v_cvt_pk_bf16_f32 v179, v182, v183
MV 92,a,148,v,36
v_exp_f32 v186, v186
MV 80,a,132,v,20
v_add_f32 v3, v3, v184
v_add_f32 v3, v3, v185
MV 88,a,132,v,36
v_exp_f32 v187, v187
MV 96,a,132,v,52
ds_read_b128 a[220:223], v11 offset:7168
v_cvt_pk_bf16_f32 v184, v184, v185
MV 104,a,132,v,68
ds_read_b128 a[224:227], v11 offset:8192
buffer_load_dwordx4 v12, s[56:59], s71 offen offset:2048 sc1 lds
MV 100,a,148,v,52
v_exp_f32 v188, v188
MV 108,a,148,v,68
v_add_f32 v3, v3, v186
v_add_f32 v3, v3, v187
MV 128,a,164,v,52
v_exp_f32 v189, v189
MV 136,a,164,v,68
ds_read_b128 a[228:231], v11 offset:9216
v_cvt_pk_bf16_f32 v185, v186, v187
MV 132,a,180,v,52
v_exp_f32 v190, v190
MV 140,a,180,v,68
v_add_f32 v3, v3, v188
v_add_f32 v3, v3, v189
MV 80,a,136,v,24
v_exp_f32 v191, v191
MV 88,a,136,v,40
ds_read_b128 a[232:235], v11 offset:10240
v_cvt_pk_bf16_f32 v186, v188, v189
MV 84,a,152,v,24
v_exp_f32 v192, v192
MV 92,a,152,v,40
buffer_load_dwordx4 v12, s[56:59], s71 offen offset:3072 sc1 lds
v_add_f32 v3, v3, v190
MV 112,a,168,v,24
ds_read_b128 a[236:239], v11 offset:11264
v_add_f32 v3, v3, v191
MV 120,a,168,v,40
v_exp_f32 v193, v193
MV 116,a,184,v,24
ds_read_b128 a[240:243], v11 offset:12288
v_cvt_pk_bf16_f32 v187, v190, v191
MV 124,a,184,v,40
v_exp_f32 v194, v194
MV 132,a,184,v,56
v_add_f32 v4, v4, v192
v_add_f32 v4, v4, v193
MV 140,a,184,v,72
v_exp_f32 v195, v195
MV 128,a,168,v,56
ds_read_b128 a[244:247], v11 offset:13312
v_cvt_pk_bf16_f32 v192, v192, v193
MV 136,a,168,v,72
v_exp_f32 v196, v196
MV 100,a,152,v,56
v_add_f32 v4, v4, v194
v_add_f32 v4, v4, v195
MV 108,a,152,v,72
v_exp_f32 v197, v197
MV 96,a,136,v,56
ds_read_b128 a[248:251], v11 offset:14336
v_cvt_pk_bf16_f32 v193, v194, v195
MV 104,a,136,v,72
v_exp_f32 v198, v198
MV 116,a,188,v,28
s_add_u32 s71, s71, 16384
v_add_f32 v4, v4, v196
MV 124,a,188,v,44
ds_read_b128 a[252:255], v11 offset:15360
v_add_f32 v4, v4, v197
MV 112,a,172,v,28
v_exp_f32 v199, v199
MV 120,a,172,v,44
s_xor_b32 s73, s73, 0x8000
v_cvt_pk_bf16_f32 v194, v196, v197
MV 84,a,156,v,28
v_exp_f32 v200, v200
MV 92,a,156,v,44
v_add_f32 v4, v4, v198
v_add_f32 v4, v4, v199
MV 80,a,140,v,28
v_exp_f32 v201, v201
MV 88,a,140,v,44
v_cvt_pk_bf16_f32 v195, v198, v199
MV 96,a,140,v,60
v_exp_f32 v202, v202
MV 104,a,140,v,76
v_add_f32 v5, v5, v200
v_add_f32 v5, v5, v201
MV 100,a,156,v,60
v_exp_f32 v203, v203
MV 108,a,156,v,76
v_cvt_pk_bf16_f32 v200, v200, v201
MV 128,a,172,v,60
v_exp_f32 v204, v204
MV 136,a,172,v,76
v_add_f32 v5, v5, v202
v_add_f32 v5, v5, v203
MV 132,a,188,v,60
v_exp_f32 v205, v205
MV 140,a,188,v,76
v_cvt_pk_bf16_f32 v201, v202, v203
v_exp_f32 v206, v206
v_add_f32 v5, v5, v204
v_add_f32 v5, v5, v205
v_exp_f32 v207, v207
v_cvt_pk_bf16_f32 v202, v204, v205
v_add_f32 v5, v5, v206
v_add_f32 v5, v5, v207
v_cvt_pk_bf16_f32 v203, v206, v207
s_waitcnt vmcnt(16) lgkmcnt(0)
MA 0,a,192,v,144
s_barrier
v_xor_b32 v10, 0x8000, v10
MA 32,a,192,v,152
s_add_u32 m0, s72, 16384
ds_read_b128 a[128:131], v10 offset:0
MA 4,a,196,v,144
ds_read_b128 a[132:135], v10 offset:1024
buffer_load_dwordx4 v12, s[52:55], s71 offen offset:0 sc1 lds
MA 36,a,196,v,152
v_exp_f32 v80, v80
MA 8,a,200,v,144
v_exp_f32 v81, v81
MA 40,a,200,v,152
v_exp_f32 v82, v82
MA 12,a,204,v,144
v_add_f32 v2, v2, v80
v_add_f32 v2, v2, v81
MA 44,a,204,v,152
ds_read_b128 a[136:139], v10 offset:2048
ds_read_b128 a[140:143], v10 offset:3072
MA 16,a,208,v,144
v_exp_f32 v83, v83
MA 48,a,208,v,152
ds_read_b128 a[144:147], v10 offset:4096
v_cvt_pk_bf16_f32 v80, v80, v81
MA 20,a,212,v,144
v_exp_f32 v84, v84
MA 52,a,212,v,152
v_add_f32 v2, v2, v82
v_add_f32 v2, v2, v83
MA 24,a,216,v,144
v_exp_f32 v85, v85
MA 56,a,216,v,152
buffer_load_dwordx4 v12, s[52:55], s71 offen offset:1024 sc1 lds
v_cvt_pk_bf16_f32 v81, v82, v83
MA 28,a,220,v,144
v_exp_f32 v86, v86
MA 60,a,220,v,152
v_add_f32 v2, v2, v84
v_add_f32 v2, v2, v85
MA 92,a,220,v,160
v_exp_f32 v87, v87
MA 124,a,220,v,168
ds_read_b128 a[148:151], v10 offset:5120
v_cvt_pk_bf16_f32 v82, v84, v85
MA 88,a,216,v,160
v_exp_f32 v88, v88
MA 120,a,216,v,168
v_add_f32 v2, v2, v86
v_add_f32 v2, v2, v87
MA 84,a,212,v,160
ds_read_b128 a[152:155], v10 offset:6144
ds_read_b128 a[156:159], v10 offset:7168
MA 116,a,212,v,168
v_exp_f32 v89, v89
MA 80,a,208,v,160
ds_read_b128 a[160:163], v10 offset:8192
v_cvt_pk_bf16_f32 v83, v86, v87
MA 112,a,208,v,168
v_exp_f32 v90, v90
MA 76,a,204,v,160
v_add_f32 v3, v3, v88
v_add_f32 v3, v3, v89
MA 108,a,204,v,168
v_exp_f32 v91, v91
MA 72,a,200,v,160
buffer_load_dwordx4 v12, s[52:55], s71 offen offset:2048 sc1 lds
v_cvt_pk_bf16_f32 v88, v88, v89
MA 104,a,200,v,168
v_exp_f32 v92, v92
MA 68,a,196,v,160
v_add_f32 v3, v3, v90
v_add_f32 v3, v3, v91
MA 100,a,196,v,168
v_exp_f32 v93, v93
MA 64,a,192,v,160
ds_read_b128 a[164:167], v10 offset:9216
v_cvt_pk_bf16_f32 v89, v90, v91
MA 96,a,192,v,168
v_exp_f32 v94, v94
MA 0,a,224,v,176
v_add_f32 v3, v3, v92
v_add_f32 v3, v3, v93
MA 32,a,224,v,184
v_exp_f32 v95, v95
MA 4,a,228,v,176
ds_read_b128 a[168:171], v10 offset:10240
v_cvt_pk_bf16_f32 v90, v92, v93
MA 36,a,228,v,184
v_exp_f32 v96, v96
MA 8,a,232,v,176
ds_read_b128 a[172:175], v10 offset:11264
v_add_f32 v3, v3, v94
MA 40,a,232,v,184
ds_read_b128 a[176:179], v10 offset:12288
v_add_f32 v3, v3, v95
MA 12,a,236,v,176
v_exp_f32 v97, v97
MA 44,a,236,v,184
ds_read_b128 a[180:183], v10 offset:13312
v_cvt_pk_bf16_f32 v91, v94, v95
MA 16,a,240,v,176
v_exp_f32 v98, v98
MA 48,a,240,v,184
v_add_f32 v4, v4, v96
v_add_f32 v4, v4, v97
MA 20,a,244,v,176
v_exp_f32 v99, v99
MA 52,a,244,v,184
buffer_load_dwordx4 v12, s[52:55], s71 offen offset:3072 sc1 lds
v_cvt_pk_bf16_f32 v96, v96, v97
MA 24,a,248,v,176
v_exp_f32 v100, v100
MA 56,a,248,v,184
v_add_f32 v4, v4, v98
v_add_f32 v4, v4, v99
MA 28,a,252,v,176
v_exp_f32 v101, v101
MA 60,a,252,v,184
ds_read_b128 a[184:187], v10 offset:14336
v_cvt_pk_bf16_f32 v97, v98, v99
MA 92,a,252,v,192
v_exp_f32 v102, v102
MA 124,a,252,v,200
v_add_f32 v4, v4, v100
v_add_f32 v4, v4, v101
MA 88,a,248,v,192
ds_read_b128 a[188:191], v10 offset:15360
s_xor_b32 s72, s72, 0x8000
MA 120,a,248,v,200
v_exp_f32 v103, v103
MA 84,a,244,v,192
v_cvt_pk_bf16_f32 v98, v100, v101
MA 116,a,244,v,200
v_exp_f32 v104, v104
MA 80,a,240,v,192
v_add_f32 v4, v4, v102
v_add_f32 v4, v4, v103
MA 112,a,240,v,200
v_exp_f32 v105, v105
MA 76,a,236,v,192
v_cvt_pk_bf16_f32 v99, v102, v103
MA 108,a,236,v,200
v_exp_f32 v106, v106
MA 72,a,232,v,192
v_add_f32 v5, v5, v104
v_add_f32 v5, v5, v105
MA 104,a,232,v,200
v_exp_f32 v107, v107
MA 68,a,228,v,192
v_cvt_pk_bf16_f32 v104, v104, v105
MA 100,a,228,v,200
v_exp_f32 v108, v108
MA 64,a,224,v,192
v_add_f32 v5, v5, v106
v_add_f32 v5, v5, v107
MA 96,a,224,v,200
v_exp_f32 v109, v109
v_cvt_pk_bf16_f32 v105, v106, v107
v_exp_f32 v110, v110
v_add_f32 v5, v5, v108
v_add_f32 v5, v5, v109
v_exp_f32 v111, v111
v_cvt_pk_bf16_f32 v106, v108, v109
v_add_f32 v5, v5, v110
v_add_f32 v5, v5, v111
v_cvt_pk_bf16_f32 v107, v110, v111
s_branch L_p3_d0_top
L_p3_d1m_top:
s_waitcnt lgkmcnt(0)
v_xor_b32 v11, 0x8000, v11
v_mfma_f32_16x16x32_bf16 v[80:83], a[128:131], v[16:19], 0
s_add_u32 m0, s73, 16384
ds_read_b128 a[192:195], v11 offset:0
v_mfma_f32_16x16x32_bf16 v[88:91], a[128:131], v[32:35], 0
v_exp_f32 v176, v176
v_mfma_f32_16x16x32_bf16 v[96:99], a[128:131], v[48:51], 0
ds_read_b128 a[196:199], v11 offset:1024
buffer_load_dwordx4 v12, s[56:59], s71 offen offset:0 sc1 lds
v_mfma_f32_16x16x32_bf16 v[104:107], a[128:131], v[64:67], 0
v_exp_f32 v177, v177
MV 80,a,132,v,20
v_exp_f32 v178, v178
MV 88,a,132,v,36
v_add_f32 v2, v2, v176
v_add_f32 v2, v2, v177
MV 96,a,132,v,52
v_exp_f32 v179, v179
MV 104,a,132,v,68
ds_read_b128 a[200:203], v11 offset:2048
v_cvt_pk_bf16_f32 v176, v176, v177
MV 80,a,136,v,24
v_exp_f32 v180, v180
MV 88,a,136,v,40
v_add_f32 v2, v2, v178
v_add_f32 v2, v2, v179
MV 96,a,136,v,56
v_exp_f32 v181, v181
MV 104,a,136,v,72
ds_read_b128 a[204:207], v11 offset:3072
v_cvt_pk_bf16_f32 v177, v178, v179
MV 80,a,140,v,28
v_exp_f32 v182, v182
MV 88,a,140,v,44
buffer_load_dwordx4 v12, s[56:59], s71 offen offset:1024 sc1 lds
v_add_f32 v2, v2, v180
MV 96,a,140,v,60
ds_read_b128 a[208:211], v11 offset:4096
v_add_f32 v2, v2, v181
MV 104,a,140,v,76
v_exp_f32 v183, v183
v_mfma_f32_16x16x32_bf16 v[84:87], a[144:147], v[16:19], 0
ds_read_b128 a[212:215], v11 offset:5120
v_cvt_pk_bf16_f32 v178, v180, v181
v_mfma_f32_16x16x32_bf16 v[92:95], a[144:147], v[32:35], 0
v_exp_f32 v184, v184
v_mfma_f32_16x16x32_bf16 v[100:103], a[144:147], v[48:51], 0
v_add_f32 v2, v2, v182
v_add_f32 v2, v2, v183
v_mfma_f32_16x16x32_bf16 v[108:111], a[144:147], v[64:67], 0
v_exp_f32 v185, v185
MV 84,a,148,v,20
ds_read_b128 a[216:219], v11 offset:6144
v_cvt_pk_bf16_f32 v179, v182, v183
MV 92,a,148,v,36
v_exp_f32 v186, v186
MV 100,a,148,v,52
v_add_f32 v3, v3, v184
v_add_f32 v3, v3, v185
MV 108,a,148,v,68
v_exp_f32 v187, v187
MV 84,a,152,v,24
ds_read_b128 a[220:223], v11 offset:7168
v_cvt_pk_bf16_f32 v184, v184, v185
MV 92,a,152,v,40
ds_read_b128 a[224:227], v11 offset:8192
buffer_load_dwordx4 v12, s[56:59], s71 offen offset:2048 sc1 lds
MV 100,a,152,v,56
v_exp_f32 v188, v188
MV 108,a,152,v,72
v_add_f32 v3, v3, v186
v_add_f32 v3, v3, v187
MV 84,a,156,v,28
v_exp_f32 v189, v189
MV 92,a,156,v,44
ds_read_b128 a[228:231], v11 offset:9216
v_cvt_pk_bf16_f32 v185, v186, v187
MV 100,a,156,v,60
v_exp_f32 v190, v190
MV 108,a,156,v,76
v_add_f32 v3, v3, v188
v_add_f32 v3, v3, v189
v_mfma_f32_16x16x32_bf16 v[112:115], a[160:163], v[16:19], 0
v_exp_f32 v191, v191
v_mfma_f32_16x16x32_bf16 v[120:123], a[160:163], v[32:35], 0
ds_read_b128 a[232:235], v11 offset:10240
v_cvt_pk_bf16_f32 v186, v188, v189
v_mfma_f32_16x16x32_bf16 v[128:131], a[160:163], v[48:51], 0
v_exp_f32 v192, v192
v_mfma_f32_16x16x32_bf16 v[136:139], a[160:163], v[64:67], 0
buffer_load_dwordx4 v12, s[56:59], s71 offen offset:3072 sc1 lds
v_add_f32 v3, v3, v190
MV 112,a,164,v,20
ds_read_b128 a[236:239], v11 offset:11264
v_add_f32 v3, v3, v191
MV 120,a,164,v,36
v_exp_f32 v193, v193
MV 128,a,164,v,52
ds_read_b128 a[240:243], v11 offset:12288
v_cvt_pk_bf16_f32 v187, v190, v191
MV 136,a,164,v,68
v_exp_f32 v194, v194
MV 112,a,168,v,24
v_add_f32 v4, v4, v192
v_add_f32 v4, v4, v193
MV 120,a,168,v,40
v_exp_f32 v195, v195
MV 128,a,168,v,56
v_cvt_pk_bf16_f32 v192, v192, v193
v_add_u32 v246, 0, v13
MV 136,a,168,v,72
v_exp_f32 v196, v196
MV 112,a,172,v,28
ds_read_b128 a[244:247], v11 offset:13312
v_add_f32 v4, v4, v194
MV 120,a,172,v,44
v_add_f32 v4, v4, v195
v_cmp_gt_i32_e64 s[84:85], 0, v246
MV 128,a,172,v,60
ds_read_b128 a[248:251], v11 offset:14336
v_cmp_gt_i32_e64 s[86:87], 1, v246
MV 136,a,172,v,76
v_exp_f32 v197, v197
v_mfma_f32_16x16x32_bf16 v[116:119], a[176:179], v[16:19], 0
v_cvt_pk_bf16_f32 v193, v194, v195
v_cmp_gt_i32_e64 s[88:89], 2, v246
v_mfma_f32_16x16x32_bf16 v[124:127], a[176:179], v[32:35], 0
v_exp_f32 v198, v198
v_mfma_f32_16x16x32_bf16 v[132:135], a[176:179], v[48:51], 0
s_add_u32 s71, s71, 16384
v_add_f32 v4, v4, v196
v_mfma_f32_16x16x32_bf16 v[140:143], a[176:179], v[64:67], 0
v_add_f32 v4, v4, v197
v_cmp_gt_i32_e64 s[90:91], 3, v246
MV 116,a,180,v,20
v_exp_f32 v199, v199
MV 124,a,180,v,36
ds_read_b128 a[252:255], v11 offset:15360
v_cvt_pk_bf16_f32 v194, v196, v197
MV 132,a,180,v,52
v_cndmask_b32_e64 v96, v96, v14, s[84:85]
v_cndmask_b32_e64 v97, v97, v14, s[86:87]
MV 140,a,180,v,68
v_exp_f32 v200, v200
MV 116,a,184,v,24
v_add_f32 v4, v4, v198
v_add_f32 v4, v4, v199
MV 124,a,184,v,40
v_cndmask_b32_e64 v98, v98, v14, s[88:89]
v_cndmask_b32_e64 v99, v99, v14, s[90:91]
MV 132,a,184,v,56
v_exp_f32 v201, v201
MV 140,a,184,v,72
v_cvt_pk_bf16_f32 v195, v198, v199
v_add_u32 v247, -16, v13
MV 116,a,188,v,28
v_exp_f32 v202, v202
MV 124,a,188,v,44
v_add_f32 v5, v5, v200
v_add_f32 v5, v5, v201
MV 132,a,188,v,60
s_xor_b32 s73, s73, 0x8000
v_cmp_gt_i32_e64 s[92:93], 0, v247
MV 140,a,188,v,76
v_exp_f32 v203, v203
v_cvt_pk_bf16_f32 v200, v200, v201
v_cmp_gt_i32_e64 s[94:95], 1, v247
v_exp_f32 v204, v204
v_add_f32 v5, v5, v202
v_cmp_gt_i32_e64 s[96:97], 2, v247
v_add_f32 v5, v5, v203
v_exp_f32 v205, v205
v_cmp_gt_i32_e64 s[98:99], 3, v247
v_cvt_pk_bf16_f32 v201, v202, v203
v_exp_f32 v206, v206
v_cndmask_b32_e64 v100, v100, v14, s[92:93]
v_add_f32 v5, v5, v204
v_cndmask_b32_e64 v101, v101, v14, s[94:95]
v_add_f32 v5, v5, v205
v_exp_f32 v207, v207
v_cvt_pk_bf16_f32 v202, v204, v205
v_cndmask_b32_e64 v102, v102, v14, s[96:97]
v_add_f32 v5, v5, v206
v_add_f32 v5, v5, v207
v_cndmask_b32_e64 v103, v103, v14, s[98:99]
v_cvt_pk_bf16_f32 v203, v206, v207
s_waitcnt vmcnt(16) lgkmcnt(0)
MA 0,a,192,v,144
s_barrier
v_xor_b32 v10, 0x8000, v10
MA 32,a,192,v,152
s_add_u32 m0, s72, 16384
ds_read_b128 a[128:131], v10 offset:0
MA 4,a,196,v,144
ds_read_b128 a[132:135], v10 offset:1024
buffer_load_dwordx4 v12, s[52:55], s71 offen offset:0 sc1 lds
MA 36,a,196,v,152
v_exp_f32 v80, v80
MA 8,a,200,v,144
v_exp_f32 v81, v81
MA 40,a,200,v,152
v_exp_f32 v82, v82
MA 12,a,204,v,144
v_add_f32 v2, v2, v80
v_add_f32 v2, v2, v81
MA 44,a,204,v,152
ds_read_b128 a[136:139], v10 offset:2048
v_add_u32 v246, -32, v13
MA 16,a,208,v,144
v_exp_f32 v83, v83
MA 48,a,208,v,152
ds_read_b128 a[140:143], v10 offset:3072
v_cvt_pk_bf16_f32 v80, v80, v81
MA 20,a,212,v,144
v_exp_f32 v84, v84
MA 52,a,212,v,152
v_add_f32 v2, v2, v82
v_add_f32 v2, v2, v83
MA 24,a,216,v,144
ds_read_b128 a[144:147], v10 offset:4096
v_cmp_gt_i32_e64 s[84:85], 0, v246
MA 56,a,216,v,152
v_exp_f32 v85, v85
MA 28,a,220,v,144
v_cvt_pk_bf16_f32 v81, v82, v83
v_cmp_gt_i32_e64 s[86:87], 1, v246
MA 60,a,220,v,152
v_exp_f32 v86, v86
MA 92,a,220,v,160
v_add_f32 v2, v2, v84
v_add_f32 v2, v2, v85
MA 124,a,220,v,168
ds_read_b128 a[148:151], v10 offset:5120
buffer_load_dwordx4 v12, s[52:55], s71 offen offset:1024 sc1 lds
MA 88,a,216,v,160
v_exp_f32 v87, v87
MA 120,a,216,v,168
v_cvt_pk_bf16_f32 v82, v84, v85
v_cmp_gt_i32_e64 s[88:89], 2, v246
MA 84,a,212,v,160
v_exp_f32 v88, v88
MA 116,a,212,v,168
v_add_f32 v2, v2, v86
v_add_f32 v2, v2, v87
MA 80,a,208,v,160
ds_read_b128 a[152:155], v10 offset:6144
v_cmp_gt_i32_e64 s[90:91], 3, v246
MA 112,a,208,v,168
v_exp_f32 v89, v89
MA 76,a,204,v,160
ds_read_b128 a[156:159], v10 offset:7168
v_cvt_pk_bf16_f32 v83, v86, v87
MA 108,a,204,v,168
v_exp_f32 v90, v90
MA 72,a,200,v,160
v_add_f32 v3, v3, v88
v_add_f32 v3, v3, v89
MA 104,a,200,v,168
v_exp_f32 v91, v91
MA 68,a,196,v,160
v_cvt_pk_bf16_f32 v88, v88, v89
v_cndmask_b32_e64 v128, v128, v14, s[84:85]
MA 100,a,196,v,168
v_exp_f32 v92, v92
MA 64,a,192,v,160
ds_read_b128 a[160:163], v10 offset:8192
v_add_f32 v3, v3, v90
MA 96,a,192,v,168
v_add_f32 v3, v3, v91
v_cndmask_b32_e64 v129, v129, v14, s[86:87]
MA 0,a,224,v,176
v_exp_f32 v93, v93
MA 32,a,224,v,184
buffer_load_dwordx4 v12, s[52:55], s71 offen offset:2048 sc1 lds
v_cvt_pk_bf16_f32 v89, v90, v91
MA 4,a,228,v,176
ds_read_b128 a[164:167], v10 offset:9216
v_cndmask_b32_e64 v130, v130, v14, s[88:89]
MA 36,a,228,v,184
v_exp_f32 v94, v94
MA 8,a,232,v,176
v_add_f32 v3, v3, v92
v_add_f32 v3, v3, v93
MA 40,a,232,v,184
v_exp_f32 v95, v95
MA 12,a,236,v,176
ds_read_b128 a[168:171], v10 offset:10240
v_cvt_pk_bf16_f32 v90, v92, v93
MA 44,a,236,v,184
ds_read_b128 a[172:175], v10 offset:11264
v_cndmask_b32_e64 v131, v131, v14, s[90:91]
MA 16,a,240,v,176
v_exp_f32 v96, v96
MA 48,a,240,v,184
v_add_f32 v3, v3, v94
v_add_f32 v3, v3, v95
MA 20,a,244,v,176
v_exp_f32 v97, v97
MA 52,a,244,v,184
v_cvt_pk_bf16_f32 v91, v94, v95
v_add_u32 v247, -48, v13
MA 24,a,248,v,176
v_exp_f32 v98, v98
MA 56,a,248,v,184
ds_read_b128 a[176:179], v10 offset:12288
v_add_f32 v4, v4, v96
MA 28,a,252,v,176
v_add_f32 v4, v4, v97
v_cmp_gt_i32_e64 s[92:93], 0, v247
MA 60,a,252,v,184
v_exp_f32 v99, v99
MA 92,a,252,v,192
ds_read_b128 a[180:183], v10 offset:13312
v_cvt_pk_bf16_f32 v96, v96, v97
MA 124,a,252,v,200
buffer_load_dwordx4 v12, s[52:55], s71 offen offset:3072 sc1 lds
v_cmp_gt_i32_e64 s[94:95], 1, v247
MA 88,a,248,v,192
v_exp_f32 v100, v100
MA 120,a,248,v,200
v_add_f32 v4, v4, v98
v_add_f32 v4, v4, v99
MA 84,a,244,v,192
v_exp_f32 v101, v101
MA 116,a,244,v,200
ds_read_b128 a[184:187], v10 offset:14336
v_cvt_pk_bf16_f32 v97, v98, v99
MA 80,a,240,v,192
v_exp_f32 v102, v102
MA 112,a,240,v,200
v_add_f32 v4, v4, v100
v_add_f32 v4, v4, v101
MA 76,a,236,v,192
ds_read_b128 a[188:191], v10 offset:15360
v_cmp_gt_i32_e64 s[96:97], 2, v247
MA 108,a,236,v,200
v_exp_f32 v103, v103
MA 72,a,232,v,192
v_cvt_pk_bf16_f32 v98, v100, v101
v_cmp_gt_i32_e64 s[98:99], 3, v247
MA 104,a,232,v,200
v_exp_f32 v104, v104
MA 68,a,228,v,192
v_add_f32 v4, v4, v102
v_add_f32 v4, v4, v103
MA 100,a,228,v,200
v_exp_f32 v105, v105
MA 64,a,224,v,192
s_xor_b32 s72, s72, 0x8000
v_cvt_pk_bf16_f32 v99, v102, v103
MA 96,a,224,v,200
v_exp_f32 v106, v106
v_add_f32 v5, v5, v104
v_cndmask_b32_e64 v132, v132, v14, s[92:93]
v_add_f32 v5, v5, v105
v_exp_f32 v107, v107
v_cvt_pk_bf16_f32 v104, v104, v105
v_exp_f32 v108, v108
v_cndmask_b32_e64 v133, v133, v14, s[94:95]
v_add_f32 v5, v5, v106
v_add_f32 v5, v5, v107
v_exp_f32 v109, v109
v_cvt_pk_bf16_f32 v105, v106, v107
v_cndmask_b32_e64 v134, v134, v14, s[96:97]
v_exp_f32 v110, v110
v_add_f32 v5, v5, v108
v_add_f32 v5, v5, v109
v_exp_f32 v111, v111
v_cndmask_b32_e64 v135, v135, v14, s[98:99]
v_cvt_pk_bf16_f32 v106, v108, v109
v_add_f32 v5, v5, v110
v_add_f32 v5, v5, v111
v_cvt_pk_bf16_f32 v107, v110, v111
L_p3_d0m_top:
s_waitcnt lgkmcnt(0)
v_mfma_f32_16x16x32_bf16 v[144:147], a[128:131], v[16:19], 0
s_add_u32 m0, s73, 0
ds_read_b128 a[192:195], v11 offset:16384
v_mfma_f32_16x16x32_bf16 v[152:155], a[128:131], v[32:35], 0
v_exp_f32 v112, v112
v_mfma_f32_16x16x32_bf16 v[168:171], a[128:131], v[64:67], 0
v_exp_f32 v113, v113
MV 144,a,132,v,20
ds_read_b128 a[196:199], v11 offset:17408
buffer_load_dwordx4 v12, s[56:59], s71 offen offset:0 sc1 lds
MV 152,a,132,v,36
v_exp_f32 v114, v114
MV 168,a,132,v,68
v_add_f32 v2, v2, v112
v_add_f32 v2, v2, v113
MV 144,a,136,v,24
v_exp_f32 v115, v115
MV 152,a,136,v,40
ds_read_b128 a[200:203], v11 offset:18432
v_cvt_pk_bf16_f32 v112, v112, v113
MV 168,a,136,v,72
v_exp_f32 v116, v116
MV 144,a,140,v,28
ds_read_b128 a[204:207], v11 offset:19456
v_add_f32 v2, v2, v114
MV 152,a,140,v,44
ds_read_b128 a[208:211], v11 offset:20480
v_add_f32 v2, v2, v115
MV 168,a,140,v,76
v_exp_f32 v117, v117
v_mfma_f32_16x16x32_bf16 v[148:151], a[144:147], v[16:19], 0
buffer_load_dwordx4 v12, s[56:59], s71 offen offset:1024 sc1 lds
v_cvt_pk_bf16_f32 v113, v114, v115
v_mfma_f32_16x16x32_bf16 v[156:159], a[144:147], v[32:35], 0
v_exp_f32 v118, v118
v_mfma_f32_16x16x32_bf16 v[172:175], a[144:147], v[64:67], 0
v_add_f32 v2, v2, v116
v_add_f32 v2, v2, v117
MV 148,a,148,v,20
v_exp_f32 v119, v119
MV 156,a,148,v,36
ds_read_b128 a[212:215], v11 offset:21504
v_cvt_pk_bf16_f32 v114, v116, v117
MV 172,a,148,v,68
v_exp_f32 v120, v120
MV 148,a,152,v,24
v_add_f32 v2, v2, v118
v_add_f32 v2, v2, v119
MV 156,a,152,v,40
v_exp_f32 v121, v121
MV 172,a,152,v,72
ds_read_b128 a[216:219], v11 offset:22528
v_cvt_pk_bf16_f32 v115, v118, v119
MV 148,a,156,v,28
v_exp_f32 v122, v122
MV 156,a,156,v,44
ds_read_b128 a[220:223], v11 offset:23552
v_add_f32 v3, v3, v120
MV 172,a,156,v,76
ds_read_b128 a[224:227], v11 offset:24576
v_add_f32 v3, v3, v121
v_mfma_f32_16x16x32_bf16 v[176:179], a[160:163], v[16:19], 0
v_exp_f32 v123, v123
v_mfma_f32_16x16x32_bf16 v[184:187], a[160:163], v[32:35], 0
buffer_load_dwordx4 v12, s[56:59], s71 offen offset:2048 sc1 lds
v_cvt_pk_bf16_f32 v120, v120, v121
v_mfma_f32_16x16x32_bf16 v[200:203], a[160:163], v[64:67], 0
v_exp_f32 v124, v124
MV 176,a,164,v,20
v_add_f32 v3, v3, v122
v_add_f32 v3, v3, v123
MV 184,a,164,v,36
v_exp_f32 v125, v125
MV 200,a,164,v,68
ds_read_b128 a[228:231], v11 offset:25600
v_cvt_pk_bf16_f32 v121, v122, v123
MV 176,a,168,v,24
v_exp_f32 v126, v126
MV 184,a,168,v,40
v_add_f32 v3, v3, v124
v_add_f32 v3, v3, v125
MV 200,a,168,v,72
v_exp_f32 v127, v127
MV 176,a,172,v,28
ds_read_b128 a[232:235], v11 offset:26624
v_cvt_pk_bf16_f32 v122, v124, v125
MV 184,a,172,v,44
v_exp_f32 v128, v128
MV 200,a,172,v,76
ds_read_b128 a[236:239], v11 offset:27648
v_add_f32 v3, v3, v126
v_mfma_f32_16x16x32_bf16 v[180:183], a[176:179], v[16:19], 0
ds_read_b128 a[240:243], v11 offset:28672
v_add_f32 v3, v3, v127
v_mfma_f32_16x16x32_bf16 v[188:191], a[176:179], v[32:35], 0
v_exp_f32 v129, v129
v_mfma_f32_16x16x32_bf16 v[204:207], a[176:179], v[64:67], 0
ds_read_b128 a[244:247], v11 offset:29696
v_cvt_pk_bf16_f32 v123, v126, v127
MV 180,a,180,v,20
v_exp_f32 v130, v130
MV 188,a,180,v,36
v_add_f32 v4, v4, v128
v_add_f32 v4, v4, v129
MV 204,a,180,v,68
v_exp_f32 v131, v131
MV 180,a,184,v,24
buffer_load_dwordx4 v12, s[56:59], s71 offen offset:3072 sc1 lds
v_cvt_pk_bf16_f32 v128, v128, v129
MV 188,a,184,v,40
v_exp_f32 v132, v132
MV 204,a,184,v,72
v_add_f32 v4, v4, v130
v_add_f32 v4, v4, v131
MV 180,a,188,v,28
ds_read_b128 a[248:251], v11 offset:30720
v_add_u32 v246, -64, v239
MV 188,a,188,v,44
v_exp_f32 v133, v133
MV 204,a,188,v,76
ds_read_b128 a[252:255], v11 offset:31744
s_add_u32 s71, s71, 16384
v_cvt_pk_bf16_f32 v129, v130, v131
v_exp_f32 v134, v134
v_cmp_gt_i32_e64 s[84:85], 0, v246
v_add_f32 v4, v4, v132
v_cmp_gt_i32_e64 s[86:87], 1, v246
v_add_f32 v4, v4, v133
v_exp_f32 v135, v135
v_cmp_gt_i32_e64 s[88:89], 2, v246
v_cvt_pk_bf16_f32 v130, v132, v133
v_exp_f32 v136, v136
v_cmp_gt_i32_e64 s[90:91], 3, v246
v_add_f32 v4, v4, v134
v_cndmask_b32_e64 v168, v168, v14, s[84:85]
v_add_f32 v4, v4, v135
v_exp_f32 v137, v137
v_cndmask_b32_e64 v169, v169, v14, s[86:87]
v_cvt_pk_bf16_f32 v131, v134, v135
v_exp_f32 v138, v138
v_cndmask_b32_e64 v170, v170, v14, s[88:89]
v_add_f32 v5, v5, v136
v_cndmask_b32_e64 v171, v171, v14, s[90:91]
v_add_f32 v5, v5, v137
v_exp_f32 v139, v139
v_add_u32 v247, -80, v239
v_cvt_pk_bf16_f32 v136, v136, v137
v_exp_f32 v140, v140
v_cmp_gt_i32_e64 s[92:93], 0, v247
v_add_f32 v5, v5, v138
v_cmp_gt_i32_e64 s[94:95], 1, v247
v_add_f32 v5, v5, v139
v_exp_f32 v141, v141
v_cmp_gt_i32_e64 s[96:97], 2, v247
v_cvt_pk_bf16_f32 v137, v138, v139
v_exp_f32 v142, v142
v_cmp_gt_i32_e64 s[98:99], 3, v247
v_add_f32 v5, v5, v140
v_cndmask_b32_e64 v172, v172, v14, s[92:93]
v_add_f32 v5, v5, v141
v_exp_f32 v143, v143
v_cndmask_b32_e64 v173, v173, v14, s[94:95]
v_cvt_pk_bf16_f32 v138, v140, v141
v_add_f32 v5, v5, v142
v_cndmask_b32_e64 v174, v174, v14, s[96:97]
v_add_f32 v5, v5, v143
v_cvt_pk_bf16_f32 v139, v142, v143
v_cndmask_b32_e64 v175, v175, v14, s[98:99]
s_waitcnt vmcnt(16) lgkmcnt(0)
MA 0,a,192,v,80
s_barrier
MA 32,a,192,v,88
s_add_u32 m0, s72, 0
ds_read_b128 a[128:131], v10 offset:16384
MA 4,a,196,v,80
ds_read_b128 a[132:135], v10 offset:17408
buffer_load_dwordx4 v12, s[52:55], s71 offen offset:0 sc1 lds
MA 36,a,196,v,88
v_exp_f32 v144, v144
MA 8,a,200,v,80
v_exp_f32 v145, v145
MA 40,a,200,v,88
v_exp_f32 v146, v146
MA 12,a,204,v,80
ds_read_b128 a[136:139], v10 offset:18432
v_add_f32 v2, v2, v144
MA 44,a,204,v,88
v_add_f32 v2, v2, v145
v_add_u32 v246, -96, v239
MA 16,a,208,v,80
v_exp_f32 v147, v147
MA 48,a,208,v,88
ds_read_b128 a[140:143], v10 offset:19456
v_cvt_pk_bf16_f32 v144, v144, v145
MA 20,a,212,v,80
ds_read_b128 a[144:147], v10 offset:20480
v_cmp_gt_i32_e64 s[84:85], 0, v246
MA 52,a,212,v,88
v_exp_f32 v148, v148
MA 24,a,216,v,80
v_add_f32 v2, v2, v146
v_add_f32 v2, v2, v147
MA 56,a,216,v,88
buffer_load_dwordx4 v12, s[52:55], s71 offen offset:1024 sc1 lds
v_cmp_gt_i32_e64 s[86:87], 1, v246
MA 28,a,220,v,80
v_exp_f32 v149, v149
MA 60,a,220,v,88
ds_read_b128 a[148:151], v10 offset:21504
v_cvt_pk_bf16_f32 v145, v146, v147
MA 92,a,220,v,96
v_exp_f32 v150, v150
MA 124,a,220,v,104
v_add_f32 v2, v2, v148
v_cmp_gt_i32_e64 s[88:89], 2, v246
MA 88,a,216,v,96
ds_read_b128 a[152:155], v10 offset:22528
v_add_f32 v2, v2, v149
MA 120,a,216,v,104
v_exp_f32 v151, v151
MA 84,a,212,v,96
v_cvt_pk_bf16_f32 v146, v148, v149
v_cmp_gt_i32_e64 s[90:91], 3, v246
MA 116,a,212,v,104
v_exp_f32 v152, v152
MA 80,a,208,v,96
ds_read_b128 a[156:159], v10 offset:23552
v_add_f32 v2, v2, v150
MA 112,a,208,v,104
v_add_f32 v2, v2, v151
v_cndmask_b32_e64 v200, v200, v14, s[84:85]
MA 76,a,204,v,96
v_exp_f32 v153, v153
MA 108,a,204,v,104
ds_read_b128 a[160:163], v10 offset:24576
v_cvt_pk_bf16_f32 v147, v150, v151
MA 72,a,200,v,96
buffer_load_dwordx4 v12, s[52:55], s71 offen offset:2048 sc1 lds
v_cndmask_b32_e64 v201, v201, v14, s[86:87]
MA 104,a,200,v,104
v_exp_f32 v154, v154
MA 68,a,196,v,96
ds_read_b128 a[164:167], v10 offset:25600
v_add_f32 v3, v3, v152
MA 100,a,196,v,104
v_add_f32 v3, v3, v153
v_cndmask_b32_e64 v202, v202, v14, s[88:89]
MA 64,a,192,v,96
v_exp_f32 v155, v155
MA 96,a,192,v,104
ds_read_b128 a[168:171], v10 offset:26624
v_cvt_pk_bf16_f32 v152, v152, v153
MA 0,a,224,v,112
v_exp_f32 v156, v156
MA 32,a,224,v,120
v_add_f32 v3, v3, v154
v_cndmask_b32_e64 v203, v203, v14, s[90:91]
MA 4,a,228,v,112
ds_read_b128 a[172:175], v10 offset:27648
v_add_f32 v3, v3, v155
MA 36,a,228,v,120
v_exp_f32 v157, v157
MA 8,a,232,v,112
v_cvt_pk_bf16_f32 v153, v154, v155
v_add_u32 v247, -112, v239
MA 40,a,232,v,120
v_exp_f32 v158, v158
MA 12,a,236,v,112
ds_read_b128 a[176:179], v10 offset:28672
v_add_f32 v3, v3, v156
MA 44,a,236,v,120
v_add_f32 v3, v3, v157
v_cmp_gt_i32_e64 s[92:93], 0, v247
MA 16,a,240,v,112
v_exp_f32 v159, v159
MA 48,a,240,v,120
ds_read_b128 a[180:183], v10 offset:29696
buffer_load_dwordx4 v12, s[52:55], s71 offen offset:3072 sc1 lds
MA 20,a,244,v,112
v_cvt_pk_bf16_f32 v154, v156, v157
v_cmp_gt_i32_e64 s[94:95], 1, v247
MA 52,a,244,v,120
v_exp_f32 v168, v168
MA 24,a,248,v,112
ds_read_b128 a[184:187], v10 offset:30720
v_add_f32 v3, v3, v158
MA 56,a,248,v,120
v_add_f32 v3, v3, v159
v_cmp_gt_i32_e64 s[96:97], 2, v247
MA 28,a,252,v,112
v_exp_f32 v169, v169
MA 60,a,252,v,120
ds_read_b128 a[188:191], v10 offset:31744
v_cvt_pk_bf16_f32 v155, v158, v159
MA 92,a,252,v,128
v_exp_f32 v170, v170
MA 124,a,252,v,136
v_add_f32 v5, v5, v168
v_cmp_gt_i32_e64 s[98:99], 3, v247
MA 88,a,248,v,128
s_cmp_eq_u32 s70, 7
v_add_f32 v5, v5, v169
MA 120,a,248,v,136
v_exp_f32 v171, v171
MA 84,a,244,v,128
v_cvt_pk_bf16_f32 v168, v168, v169
v_cndmask_b32_e64 v204, v204, v14, s[92:93]
MA 116,a,244,v,136
v_exp_f32 v172, v172
MA 80,a,240,v,128
v_add_f32 v5, v5, v170
v_add_f32 v5, v5, v171
MA 112,a,240,v,136
v_exp_f32 v173, v173
MA 76,a,236,v,128
v_cvt_pk_bf16_f32 v169, v170, v171
v_cndmask_b32_e64 v205, v205, v14, s[94:95]
MA 108,a,236,v,136
v_exp_f32 v174, v174
MA 72,a,232,v,128
v_add_f32 v5, v5, v172
v_cndmask_b32_e64 v206, v206, v14, s[96:97]
MA 104,a,232,v,136
v_add_f32 v5, v5, v173
v_cndmask_b32_e64 v207, v207, v14, s[98:99]
MA 68,a,228,v,128
v_exp_f32 v175, v175
MA 100,a,228,v,136
v_cvt_pk_bf16_f32 v170, v172, v173
v_add_f32 v5, v5, v174
MA 64,a,224,v,128
v_add_f32 v5, v5, v175
v_cvt_pk_bf16_f32 v171, v174, v175
MA 96,a,224,v,136
s_cbranch_scc1 L_p3_mxm_top
s_waitcnt lgkmcnt(0)
v_xor_b32 v11, 0x8000, v11
v_mfma_f32_16x16x32_bf16 v[80:83], a[128:131], v[16:19], 0
s_add_u32 m0, s73, 16384
ds_read_b128 a[192:195], v11 offset:0
v_mfma_f32_16x16x32_bf16 v[88:91], a[128:131], v[32:35], 0
v_exp_f32 v176, v176
v_mfma_f32_16x16x32_bf16 v[84:87], a[144:147], v[16:19], 0
v_exp_f32 v177, v177
v_mfma_f32_16x16x32_bf16 v[92:95], a[144:147], v[32:35], 0
ds_read_b128 a[196:199], v11 offset:1024
buffer_load_dwordx4 v12, s[56:59], s71 offen offset:0 sc1 lds
v_mfma_f32_16x16x32_bf16 v[112:115], a[160:163], v[16:19], 0
v_exp_f32 v178, v178
v_mfma_f32_16x16x32_bf16 v[120:123], a[160:163], v[32:35], 0
v_add_f32 v2, v2, v176
v_add_f32 v2, v2, v177
v_mfma_f32_16x16x32_bf16 v[116:119], a[176:179], v[16:19], 0
ds_read_b128 a[200:203], v11 offset:2048
ds_read_b128 a[204:207], v11 offset:3072
v_mfma_f32_16x16x32_bf16 v[124:127], a[176:179], v[32:35], 0
v_exp_f32 v179, v179
MV 116,a,180,v,20
ds_read_b128 a[208:211], v11 offset:4096
v_cvt_pk_bf16_f32 v176, v176, v177
MV 124,a,180,v,36
v_exp_f32 v180, v180
MV 112,a,164,v,20
v_add_f32 v2, v2, v178
v_add_f32 v2, v2, v179
MV 120,a,164,v,36
v_exp_f32 v181, v181
MV 84,a,148,v,20
buffer_load_dwordx4 v12, s[56:59], s71 offen offset:1024 sc1 lds
v_cvt_pk_bf16_f32 v177, v178, v179
MV 92,a,148,v,36
v_exp_f32 v182, v182
MV 80,a,132,v,20
ds_read_b128 a[212:215], v11 offset:5120
v_add_f32 v2, v2, v180
MV 88,a,132,v,36
ds_read_b128 a[216:219], v11 offset:6144
v_add_f32 v2, v2, v181
MV 80,a,136,v,24
v_exp_f32 v183, v183
MV 88,a,136,v,40
ds_read_b128 a[220:223], v11 offset:7168
v_cvt_pk_bf16_f32 v178, v180, v181
MV 84,a,152,v,24
v_exp_f32 v184, v184
MV 92,a,152,v,40
v_add_f32 v2, v2, v182
v_add_f32 v2, v2, v183
MV 112,a,168,v,24
ds_read_b128 a[224:227], v11 offset:8192
buffer_load_dwordx4 v12, s[56:59], s71 offen offset:2048 sc1 lds
MV 120,a,168,v,40
v_exp_f32 v185, v185
MV 116,a,184,v,24
ds_read_b128 a[228:231], v11 offset:9216
v_cvt_pk_bf16_f32 v179, v182, v183
MV 124,a,184,v,40
v_exp_f32 v186, v186
MV 116,a,188,v,28
v_add_f32 v3, v3, v184
v_add_f32 v3, v3, v185
MV 124,a,188,v,44
v_exp_f32 v187, v187
MV 112,a,172,v,28
ds_read_b128 a[232:235], v11 offset:10240
v_cvt_pk_bf16_f32 v184, v184, v185
MV 120,a,172,v,44
v_exp_f32 v188, v188
MV 84,a,156,v,28
ds_read_b128 a[236:239], v11 offset:11264
v_add_f32 v3, v3, v186
MV 92,a,156,v,44
buffer_load_dwordx4 v12, s[56:59], s71 offen offset:3072 sc1 lds
v_add_f32 v3, v3, v187
MV 80,a,140,v,28
v_exp_f32 v189, v189
MV 88,a,140,v,44
ds_read_b128 a[240:243], v11 offset:12288
ds_read_b128 a[244:247], v11 offset:13312
ds_read_b128 a[248:251], v11 offset:14336
ds_read_b128 a[252:255], v11 offset:15360
s_add_u32 s71, s71, 16384
s_xor_b32 s73, s73, 0x8000
v_cvt_pk_bf16_f32 v185, v186, v187
v_exp_f32 v190, v190
v_add_f32 v3, v3, v188
v_add_f32 v3, v3, v189
v_exp_f32 v191, v191
v_cvt_pk_bf16_f32 v186, v188, v189
v_exp_f32 v200, v200
v_add_f32 v3, v3, v190
v_add_f32 v3, v3, v191
v_exp_f32 v201, v201
v_cvt_pk_bf16_f32 v187, v190, v191
v_exp_f32 v202, v202
v_add_f32 v5, v5, v200
v_add_f32 v5, v5, v201
v_exp_f32 v203, v203
v_cvt_pk_bf16_f32 v200, v200, v201
v_exp_f32 v204, v204
v_add_f32 v5, v5, v202
v_add_f32 v5, v5, v203
v_exp_f32 v205, v205
v_cvt_pk_bf16_f32 v201, v202, v203
v_exp_f32 v206, v206
v_add_f32 v5, v5, v204
v_add_f32 v5, v5, v205
v_exp_f32 v207, v207
v_cvt_pk_bf16_f32 v202, v204, v205
v_add_f32 v5, v5, v206
v_add_f32 v5, v5, v207
v_cvt_pk_bf16_f32 v203, v206, v207
s_waitcnt vmcnt(16) lgkmcnt(0)
MA 0,a,192,v,144
s_barrier
v_xor_b32 v10, 0x8000, v10
MA 32,a,192,v,152
s_add_u32 m0, s72, 16384
ds_read_b128 a[128:131], v10 offset:0
MA 4,a,196,v,144
buffer_load_dwordx4 v12, s[52:55], s71 offen offset:0 sc1 lds
v_lshrrev_b32 v249, 2, v1
MA 36,a,196,v,152
ds_read_b128 a[132:135], v10 offset:1024
v_and_b32 v248, 7, v249
MA 8,a,200,v,144
v_exp_f32 v80, v80
MA 40,a,200,v,152
v_lshlrev_b32 v249, 8, v249
v_and_b32 v250, 3, v1
MA 12,a,204,v,144
ds_read_b128 a[136:139], v10 offset:2048
v_lshl_add_u32 v249, v250, 3, v249
MA 44,a,204,v,152
v_exp_f32 v81, v81
MA 16,a,208,v,144
s_lshl_b32 s36, s3, 13
s_add_u32 s36, s36, 131072
MA 48,a,208,v,152
ds_read_b128 a[140:143], v10 offset:3072
v_add_u32 v249, s36, v249
MA 20,a,212,v,144
v_exp_f32 v82, v82
MA 52,a,212,v,152
s_waitcnt vmcnt(13)
v_xor_b32 v250, 0, v248
MA 24,a,216,v,144
ds_read_b128 a[144:147], v10 offset:4096
v_lshl_add_u32 v250, v250, 5, v249
MA 56,a,216,v,152
v_exp_f32 v83, v83
MA 28,a,220,v,144
TR 96,250,0
TR 98,250,4096
MA 60,a,220,v,152
ds_read_b128 a[148:151], v10 offset:5120
v_xor_b32 v250, 1, v248
MA 124,a,220,v,168
buffer_load_dwordx4 v12, s[52:55], s71 offen offset:1024 sc1 lds
v_cvt_pk_bf16_f32 v80, v80, v81
MA 120,a,216,v,168
v_lshl_add_u32 v250, v250, 5, v249
TR 100,250,0
MA 116,a,212,v,168
TR 102,250,4096
v_xor_b32 v250, 2, v248
MA 112,a,208,v,168
v_exp_f32 v84, v84
MA 108,a,204,v,168
ds_read_b128 a[152:155], v10 offset:6144
v_lshl_add_u32 v250, v250, 5, v249
MA 104,a,200,v,168
TR 104,250,0
TR 106,250,4096
MA 100,a,196,v,168
v_exp_f32 v85, v85
MA 96,a,192,v,168
ds_read_b128 a[156:159], v10 offset:7168
v_cvt_pk_bf16_f32 v81, v82, v83
MA 0,a,224,v,176
v_xor_b32 v250, 3, v248
v_lshl_add_u32 v250, v250, 5, v249
MA 32,a,224,v,184
ds_read_b128 a[160:163], v10 offset:8192
TR 108,250,0
MA 4,a,228,v,176
TR 110,250,4096
v_xor_b32 v250, 4, v248
MA 36,a,228,v,184
v_exp_f32 v86, v86
MA 8,a,232,v,176
ds_read_b128 a[164:167], v10 offset:9216
v_lshl_add_u32 v250, v250, 5, v249
MA 40,a,232,v,184
buffer_load_dwordx4 v12, s[52:55], s71 offen offset:2048 sc1 lds
TR 128,250,0
MA 12,a,236,v,176
TR 130,250,4096
v_xor_b32 v250, 5, v248
MA 44,a,236,v,184
v_exp_f32 v87, v87
MA 16,a,240,v,176
ds_read_b128 a[168:171], v10 offset:10240
v_cvt_pk_bf16_f32 v82, v84, v85
MA 48,a,240,v,184
v_lshl_add_u32 v250, v250, 5, v249
TR 132,250,0
MA 20,a,244,v,176
TR 134,250,4096
v_xor_b32 v250, 6, v248
MA 52,a,244,v,184
v_exp_f32 v88, v88
MA 24,a,248,v,176
ds_read_b128 a[172:175], v10 offset:11264
v_lshl_add_u32 v250, v250, 5, v249
MA 56,a,248,v,184
TR 136,250,0
TR 138,250,4096
MA 28,a,252,v,176
v_exp_f32 v89, v89
MA 60,a,252,v,184
ds_read_b128 a[176:179], v10 offset:12288
v_xor_b32 v250, 7, v248
MA 124,a,252,v,200
v_cvt_pk_bf16_f32 v83, v86, v87
v_lshl_add_u32 v250, v250, 5, v249
MA 120,a,248,v,200
ds_read_b128 a[180:183], v10 offset:13312
TR 140,250,0
MA 116,a,244,v,200
buffer_load_dwordx4 v12, s[52:55], s71 offen offset:3072 sc1 lds
TR 142,250,4096
MA 112,a,240,v,200
v_exp_f32 v90, v90
MA 108,a,236,v,200
s_add_u32 s32, s40, 100663296
s_addc_u32 s33, s41, 0
MA 104,a,232,v,200
ds_read_b128 a[184:187], v10 offset:14336
s_mov_b32 s34, 8388608
MA 100,a,228,v,200
s_mov_b32 s35, 0x20000
s_and_b32 s36, s2, 7
MA 96,a,224,v,200
ds_read_b128 a[188:191], v10 offset:15360
s_xor_b32 s72, s72, 0x8000
v_exp_f32 v91, v91
s_lshl_b32 s36, s36, 20
s_lshr_b32 s37, s2, 3
v_cvt_pk_bf16_f32 v88, v88, v89
s_lshl_b32 s37, s37, 15
v_exp_f32 v92, v92
s_add_u32 s36, s36, s37
s_lshl_b32 s37, s3, 12
s_add_u32 s36, s36, s37
v_exp_f32 v93, v93
s_add_u32 s37, s36, 4096
s_waitcnt lgkmcnt(15)
buffer_store_dwordx4 v[96:99], v12, s[32:35], s36 offen offset:0 sc1
buffer_store_dwordx4 v[100:103], v12, s[32:35], s36 offen offset:1024 sc1
v_cvt_pk_bf16_f32 v89, v90, v91
buffer_store_dwordx4 v[104:107], v12, s[32:35], s36 offen offset:2048 sc1
buffer_store_dwordx4 v[108:111], v12, s[32:35], s36 offen offset:3072 sc1
s_waitcnt lgkmcnt(12)
buffer_store_dwordx4 v[128:131], v12, s[32:35], s37 offen offset:0 sc1
v_exp_f32 v94, v94
s_waitcnt lgkmcnt(9)
buffer_store_dwordx4 v[132:135], v12, s[32:35], s37 offen offset:1024 sc1
s_waitcnt lgkmcnt(6)
buffer_store_dwordx4 v[136:139], v12, s[32:35], s37 offen offset:2048 sc1
s_waitcnt lgkmcnt(2)
buffer_store_dwordx4 v[140:143], v12, s[32:35], s37 offen offset:3072 sc1
v_exp_f32 v95, v95
v_lshlrev_b32 v232, 4, v1
v_mov_b32 v235, 0
buffer_load_ushort v234, v235, s[28:31], s42 offen
v_cvt_pk_bf16_f32 v90, v92, v93
buffer_load_dwordx4 v[210:213], v232, s[16:19], 0 offen offset:0
buffer_load_dwordx4 v[216:219], v232, s[16:19], 0 offen offset:1024
v_cvt_pk_bf16_f32 v91, v94, v95
buffer_load_dwordx4 v[222:225], v232, s[16:19], 0 offen offset:2048
buffer_load_dwordx4 v[228:231], v232, s[16:19], 0 offen offset:3072
L_p3_eps:
v_mov_b32 v240, v4
v_mov_b32 v241, v5
s_nop 0
v_permlane32_swap_b32 v4, v240
v_permlane32_swap_b32 v5, v241
v_add_f32 v4, v4, v240
v_add_f32 v5, v5, v241
v_mov_b32 v240, v4
v_mov_b32 v241, v5
s_nop 0
v_permlane16_swap_b32 v4, v240
v_permlane16_swap_b32 v5, v241
v_add_f32 v4, v4, v240
v_add_f32 v5, v5, v241
v_cmp_nle_f32 vcc, 0x30800000, v4
s_nop 0
s_mov_b64 s[78:79], vcc
v_cmp_nge_f32 vcc, 0x4e800000, v4
s_nop 0
s_or_b64 s[78:79], s[78:79], vcc
v_cmp_nle_f32 vcc, 0x30800000, v5
s_nop 0
s_or_b64 s[78:79], s[78:79], vcc
v_cmp_nge_f32 vcc, 0x4e800000, v5
s_nop 0
s_or_b64 s[78:79], s[78:79], vcc
v_rcp_f32 v4, v4
v_rcp_f32 v5, v5
s_add_u32 s80, s101, s76
s_nop 4
v_accvgpr_read_b32 v240, a64
v_accvgpr_read_b32 v241, a65
v_accvgpr_read_b32 v242, a66
v_accvgpr_read_b32 v243, a67
v_accvgpr_read_b32 v244, a68
v_accvgpr_read_b32 v245, a69
v_accvgpr_read_b32 v246, a70
v_accvgpr_read_b32 v247, a71
v_pk_mul_f32 v[240:241], v[240:241], v[4:5] op_sel:[0,0] op_sel_hi:[1,0]
v_pk_mul_f32 v[242:243], v[242:243], v[4:5] op_sel:[0,0] op_sel_hi:[1,0]
v_pk_mul_f32 v[244:245], v[244:245], v[4:5] op_sel:[0,0] op_sel_hi:[1,0]
v_pk_mul_f32 v[246:247], v[246:247], v[4:5] op_sel:[0,0] op_sel_hi:[1,0]
v_cvt_pk_bf16_f32 v248, v240, v241
v_cvt_pk_bf16_f32 v249, v242, v243
v_cvt_pk_bf16_f32 v250, v244, v245
v_cvt_pk_bf16_f32 v251, v246, v247
buffer_store_dwordx4 v[248:251], v15, s[60:63], s101 offen offset:0 sc1
v_accvgpr_read_b32 v240, a72
v_accvgpr_read_b32 v241, a73
v_accvgpr_read_b32 v242, a74
v_accvgpr_read_b32 v243, a75
v_accvgpr_read_b32 v244, a76
v_accvgpr_read_b32 v245, a77
v_accvgpr_read_b32 v246, a78
v_accvgpr_read_b32 v247, a79
v_pk_mul_f32 v[240:241], v[240:241], v[4:5] op_sel:[0,0] op_sel_hi:[1,0]
v_pk_mul_f32 v[242:243], v[242:243], v[4:5] op_sel:[0,0] op_sel_hi:[1,0]
v_pk_mul_f32 v[244:245], v[244:245], v[4:5] op_sel:[0,0] op_sel_hi:[1,0]
v_pk_mul_f32 v[246:247], v[246:247], v[4:5] op_sel:[0,0] op_sel_hi:[1,0]
v_cvt_pk_bf16_f32 v252, v240, v241
v_cvt_pk_bf16_f32 v253, v242, v243
v_cvt_pk_bf16_f32 v254, v244, v245
v_cvt_pk_bf16_f32 v255, v246, v247
buffer_store_dwordx4 v[252:255], v15, s[60:63], s101 offen offset:1024 sc1
v_accvgpr_read_b32 v240, a80
v_accvgpr_read_b32 v241, a81
v_accvgpr_read_b32 v242, a82
v_accvgpr_read_b32 v243, a83
v_accvgpr_read_b32 v244, a84
v_accvgpr_read_b32 v245, a85
v_accvgpr_read_b32 v246, a86
v_accvgpr_read_b32 v247, a87
v_pk_mul_f32 v[240:241], v[240:241], v[4:5] op_sel:[0,0] op_sel_hi:[1,0]
v_pk_mul_f32 v[242:243], v[242:243], v[4:5] op_sel:[0,0] op_sel_hi:[1,0]
v_pk_mul_f32 v[244:245], v[244:245], v[4:5] op_sel:[0,0] op_sel_hi:[1,0]
v_pk_mul_f32 v[246:247], v[246:247], v[4:5] op_sel:[0,0] op_sel_hi:[1,0]
v_cvt_pk_bf16_f32 v248, v240, v241
v_cvt_pk_bf16_f32 v249, v242, v243
v_cvt_pk_bf16_f32 v250, v244, v245
v_cvt_pk_bf16_f32 v251, v246, v247
buffer_store_dwordx4 v[248:251], v15, s[60:63], s101 offen offset:2048 sc1
v_accvgpr_read_b32 v240, a88
v_accvgpr_read_b32 v241, a89
v_accvgpr_read_b32 v242, a90
v_accvgpr_read_b32 v243, a91
v_accvgpr_read_b32 v244, a92
v_accvgpr_read_b32 v245, a93
v_accvgpr_read_b32 v246, a94
v_accvgpr_read_b32 v247, a95
v_pk_mul_f32 v[240:241], v[240:241], v[4:5] op_sel:[0,0] op_sel_hi:[1,0]
v_pk_mul_f32 v[242:243], v[242:243], v[4:5] op_sel:[0,0] op_sel_hi:[1,0]
v_pk_mul_f32 v[244:245], v[244:245], v[4:5] op_sel:[0,0] op_sel_hi:[1,0]
v_pk_mul_f32 v[246:247], v[246:247], v[4:5] op_sel:[0,0] op_sel_hi:[1,0]
v_cvt_pk_bf16_f32 v252, v240, v241
v_cvt_pk_bf16_f32 v253, v242, v243
v_cvt_pk_bf16_f32 v254, v244, v245
v_cvt_pk_bf16_f32 v255, v246, v247
buffer_store_dwordx4 v[252:255], v15, s[60:63], s101 offen offset:3072 sc1
v_accvgpr_read_b32 v240, a96
v_accvgpr_read_b32 v241, a97
v_accvgpr_read_b32 v242, a98
v_accvgpr_read_b32 v243, a99
v_accvgpr_read_b32 v244, a100
v_accvgpr_read_b32 v245, a101
v_accvgpr_read_b32 v246, a102
v_accvgpr_read_b32 v247, a103
v_pk_mul_f32 v[240:241], v[240:241], v[4:5] op_sel:[0,1] op_sel_hi:[1,1]
v_pk_mul_f32 v[242:243], v[242:243], v[4:5] op_sel:[0,1] op_sel_hi:[1,1]
v_pk_mul_f32 v[244:245], v[244:245], v[4:5] op_sel:[0,1] op_sel_hi:[1,1]
v_pk_mul_f32 v[246:247], v[246:247], v[4:5] op_sel:[0,1] op_sel_hi:[1,1]
v_cvt_pk_bf16_f32 v248, v240, v241
v_cvt_pk_bf16_f32 v249, v242, v243
v_cvt_pk_bf16_f32 v250, v244, v245
v_cvt_pk_bf16_f32 v251, v246, v247
buffer_store_dwordx4 v[248:251], v15, s[60:63], s80 offen offset:0 sc1
v_accvgpr_read_b32 v240, a104
v_accvgpr_read_b32 v241, a105
v_accvgpr_read_b32 v242, a106
v_accvgpr_read_b32 v243, a107
v_accvgpr_read_b32 v244, a108
v_accvgpr_read_b32 v245, a109
v_accvgpr_read_b32 v246, a110
v_accvgpr_read_b32 v247, a111
v_pk_mul_f32 v[240:241], v[240:241], v[4:5] op_sel:[0,1] op_sel_hi:[1,1]
v_pk_mul_f32 v[242:243], v[242:243], v[4:5] op_sel:[0,1] op_sel_hi:[1,1]
v_pk_mul_f32 v[244:245], v[244:245], v[4:5] op_sel:[0,1] op_sel_hi:[1,1]
v_pk_mul_f32 v[246:247], v[246:247], v[4:5] op_sel:[0,1] op_sel_hi:[1,1]
v_cvt_pk_bf16_f32 v252, v240, v241
v_cvt_pk_bf16_f32 v253, v242, v243
v_cvt_pk_bf16_f32 v254, v244, v245
v_cvt_pk_bf16_f32 v255, v246, v247
buffer_store_dwordx4 v[252:255], v15, s[60:63], s80 offen offset:1024 sc1
v_accvgpr_read_b32 v240, a112
v_accvgpr_read_b32 v241, a113
v_accvgpr_read_b32 v242, a114
v_accvgpr_read_b32 v243, a115
v_accvgpr_read_b32 v244, a116
v_accvgpr_read_b32 v245, a117
v_accvgpr_read_b32 v246, a118
v_accvgpr_read_b32 v247, a119
v_pk_mul_f32 v[240:241], v[240:241], v[4:5] op_sel:[0,1] op_sel_hi:[1,1]
v_pk_mul_f32 v[242:243], v[242:243], v[4:5] op_sel:[0,1] op_sel_hi:[1,1]
v_pk_mul_f32 v[244:245], v[244:245], v[4:5] op_sel:[0,1] op_sel_hi:[1,1]
v_pk_mul_f32 v[246:247], v[246:247], v[4:5] op_sel:[0,1] op_sel_hi:[1,1]
v_cvt_pk_bf16_f32 v248, v240, v241
v_cvt_pk_bf16_f32 v249, v242, v243
v_cvt_pk_bf16_f32 v250, v244, v245
v_cvt_pk_bf16_f32 v251, v246, v247
buffer_store_dwordx4 v[248:251], v15, s[60:63], s80 offen offset:2048 sc1
v_accvgpr_read_b32 v240, a120
v_accvgpr_read_b32 v241, a121
v_accvgpr_read_b32 v242, a122
v_accvgpr_read_b32 v243, a123
v_accvgpr_read_b32 v244, a124
v_accvgpr_read_b32 v245, a125
v_accvgpr_read_b32 v246, a126
v_accvgpr_read_b32 v247, a127
v_pk_mul_f32 v[240:241], v[240:241], v[4:5] op_sel:[0,1] op_sel_hi:[1,1]
v_pk_mul_f32 v[242:243], v[242:243], v[4:5] op_sel:[0,1] op_sel_hi:[1,1]
v_pk_mul_f32 v[244:245], v[244:245], v[4:5] op_sel:[0,1] op_sel_hi:[1,1]
v_pk_mul_f32 v[246:247], v[246:247], v[4:5] op_sel:[0,1] op_sel_hi:[1,1]
v_cvt_pk_bf16_f32 v252, v240, v241
v_cvt_pk_bf16_f32 v253, v242, v243
v_cvt_pk_bf16_f32 v254, v244, v245
v_cvt_pk_bf16_f32 v255, v246, v247
buffer_store_dwordx4 v[252:255], v15, s[60:63], s80 offen offset:3072 sc1
v_mov_b32 v160, 0x3f803f80
v_mov_b32 v161, 0x3f803f80
v_mov_b32 v162, 0x3f803f80
v_mov_b32 v163, 0x3f803f80
v_mov_b32 v164, 0
v_mov_b32 v165, 0
v_mov_b32 v166, 0
v_mov_b32 v167, 0
v_mov_b32 v168, 0
v_mov_b32 v169, 0
v_mov_b32 v170, 0
v_mov_b32 v171, 0
s_and_b32 s36, s2, 3
s_lshl_b32 s36, s36, 1
s_sub_u32 s32, 14, s36
s_bitcmp1_b32 s2, 4
s_cselect_b32 s36, s32, s36
s_bfe_u32 s32, s2, 0x10003
s_add_u32 s36, s36, s32
s_bfe_u32 s37, s2, 0x10002
s_lshr_b32 s32, s2, 5
s_lshl_b32 s32, s32, 1
s_add_u32 s37, s37, s32
s_lshl_b32 s36, s36, 2
s_add_u32 s36, s36, s3
s_lshl_b32 s37, s37, 7
s_lshl_b32 s32, s36, 16
s_add_u32 s37, s37, s32
s_lshl_b32 s36, s36, 7
v_and_b32 v240, 15, v1
v_bfe_u32 v241, v1, 4, 1
v_lshlrev_b32 v241, 5, v241
v_lshrrev_b32 v242, 5, v1
v_lshl_add_u32 v241, v242, 4, v241
v_lshl_add_u32 v241, v240, 11, v241
v_lshlrev_b32 v240, 2, v240
s_add_u32 s32, s40, 58720256
s_addc_u32 s33, s41, 0
s_mov_b32 s34, 8192
s_mov_b32 s35, 0x20000
buffer_load_dwordx4 v[192:195], v241, s[44:47], s37 offen offset:0
buffer_load_dwordx4 v[196:199], v241, s[44:47], s37 offen offset:64
buffer_load_dword v6, v240, s[32:35], s36 offen offset:0 sc1
s_add_u32 s37, s37, 32768
buffer_load_dwordx4 v[200:203], v241, s[44:47], s37 offen offset:0
buffer_load_dwordx4 v[204:207], v241, s[44:47], s37 offen offset:64
buffer_load_dword v7, v240, s[32:35], s36 offen offset:64 sc1
v_lshlrev_b32 v236, 20, v1
s_lshl_b32 s36, s3, 26
v_add_u32 v236, s36, v236
v_mov_b32 v237, 1
s_lshl_b32 s37, s2, 2
s_getpc_b64 s[38:39]
L_ct_b:
s_add_u32 s38, s38, L_p3_s1m_top - L_ct_b
s_addc_u32 s39, s39, 0
v_mov_b32 v173, s39
v_mov_b32 v172, s38
s_lshr_b32 s38, s2, 3
s_lshl_b32 s38, s38, 2
s_add_u32 s38, s38, s3
s_lshl_b32 s38, s38, 7
v_and_b32 v174, 3, v1
v_lshlrev_b32 v174, 14, v174
v_add_u32 v174, s38, v174
v_min_u32 v174, L_end - L_p3_s1m_top - 4, v174
v_add_co_u32 v172, vcc, v172, v174
s_nop 1
v_addc_co_u32 v173, vcc, 0, v173, vcc
global_load_dword v174, v[172:173], off
s_lshl_b32 s74, s70, 1
s_sub_u32 s74, 13, s74
s_cbranch_scc1 L_p3_s0m_top
.p2align 5
L_p3_s0_top:
s_waitcnt lgkmcnt(0)
v_mfma_f32_16x16x32_bf16 v[144:147], a[128:131], v[16:19], 0
s_add_u32 m0, s73, 0
ds_read_b128 a[192:195], v11 offset:16384
v_mfma_f32_16x16x32_bf16 v[152:155], a[128:131], v[32:35], 0
v_exp_f32 v112, v112
v_mfma_f32_16x16x32_bf16 v[148:151], a[144:147], v[16:19], 0
ds_read_b128 a[196:199], v11 offset:17408
buffer_load_dwordx4 v12, s[56:59], s71 offen offset:0 sc1 lds
v_mfma_f32_16x16x32_bf16 v[156:159], a[144:147], v[32:35], 0
v_exp_f32 v113, v113
v_mfma_f32_16x16x32_bf16 v[176:179], a[160:163], v[16:19], 0
ds_read_b128 a[200:203], v11 offset:18432
ds_read_b128 a[204:207], v11 offset:19456
v_mfma_f32_16x16x32_bf16 v[184:187], a[160:163], v[32:35], 0
v_exp_f32 v114, v114
v_mfma_f32_16x16x32_bf16 v[180:183], a[176:179], v[16:19], 0
v_exp_f32 v115, v115
v_mfma_f32_16x16x32_bf16 v[188:191], a[176:179], v[32:35], 0
ds_read_b128 a[208:211], v11 offset:20480
v_cvt_pk_bf16_f32 v112, v112, v113
MV 180,a,180,v,20
ds_read_b128 a[212:215], v11 offset:21504
buffer_load_dwordx4 v12, s[56:59], s71 offen offset:1024 sc1 lds
MV 188,a,180,v,36
v_exp_f32 v116, v116
MV 176,a,164,v,20
v_exp_f32 v117, v117
MV 184,a,164,v,36
ds_read_b128 a[216:219], v11 offset:22528
ds_read_b128 a[220:223], v11 offset:23552
MV 148,a,148,v,20
ds_read_b128 a[224:227], v11 offset:24576
v_cvt_pk_bf16_f32 v113, v114, v115
MV 156,a,148,v,36
v_exp_f32 v118, v118
MV 144,a,132,v,20
v_exp_f32 v119, v119
MV 152,a,132,v,36
ds_read_b128 a[228:231], v11 offset:25600
buffer_load_dwordx4 v12, s[56:59], s71 offen offset:2048 sc1 lds
MV 144,a,136,v,24
ds_read_b128 a[232:235], v11 offset:26624
v_cvt_pk_bf16_f32 v114, v116, v117
MV 152,a,136,v,40
v_exp_f32 v120, v120
MV 148,a,152,v,24
ds_read_b128 a[236:239], v11 offset:27648
ds_read_b128 a[240:243], v11 offset:28672
MV 156,a,152,v,40
v_exp_f32 v121, v121
MV 176,a,168,v,24
ds_read_b128 a[244:247], v11 offset:29696
v_cvt_pk_bf16_f32 v115, v118, v119
MV 184,a,168,v,40
ds_read_b128 a[248:251], v11 offset:30720
buffer_load_dwordx4 v12, s[56:59], s71 offen offset:3072 sc1 lds
MV 180,a,184,v,24
v_exp_f32 v122, v122
MV 188,a,184,v,40
v_exp_f32 v123, v123
MV 180,a,188,v,28
ds_read_b128 a[252:255], v11 offset:31744
v_cvt_pk_bf16_f32 v120, v120, v121
MV 188,a,188,v,44
v_exp_f32 v124, v124
MV 176,a,172,v,28
v_exp_f32 v125, v125
MV 184,a,172,v,44
s_add_u32 s71, s71, 16384
v_cvt_pk_bf16_f32 v121, v122, v123
MV 148,a,156,v,28
v_exp_f32 v126, v126
MV 156,a,156,v,44
v_exp_f32 v127, v127
MV 144,a,140,v,28
v_cvt_pk_bf16_f32 v122, v124, v125
v_cvt_pk_bf16_f32 v123, v126, v127
MV 152,a,140,v,44
s_waitcnt vmcnt(16) lgkmcnt(0)
MA 0,a,192,v,80
s_barrier
MA 32,a,192,v,88
s_add_u32 m0, s72, 0
ds_read_b128 a[128:131], v10 offset:16384
MA 4,a,196,v,80
ds_read_b128 a[132:135], v10 offset:17408
buffer_load_dwordx4 v12, s[52:55], s71 offen offset:0 sc1 lds
MA 36,a,196,v,88
v_exp_f32 v144, v144
MA 8,a,200,v,80
v_exp_f32 v145, v145
MA 40,a,200,v,88
ds_read_b128 a[136:139], v10 offset:18432
ds_read_b128 a[140:143], v10 offset:19456
MA 12,a,204,v,80
v_exp_f32 v146, v146
MA 44,a,204,v,88
ds_read_b128 a[144:147], v10 offset:20480
buffer_load_dwordx4 v12, s[52:55], s71 offen offset:1024 sc1 lds
MV 164,v,160,v,80
v_exp_f32 v147, v147
MV 168,v,160,v,88
ds_read_b128 a[148:151], v10 offset:21504
v_cvt_pk_bf16_f32 v144, v144, v145
MA 16,a,208,v,80
v_exp_f32 v148, v148
MA 48,a,208,v,88
ds_read_b128 a[152:155], v10 offset:22528
ds_read_b128 a[156:159], v10 offset:23552
MA 20,a,212,v,80
v_exp_f32 v149, v149
MA 52,a,212,v,88
ds_read_b128 a[160:163], v10 offset:24576
v_cvt_pk_bf16_f32 v145, v146, v147
MA 24,a,216,v,80
v_exp_f32 v150, v150
MA 56,a,216,v,88
ds_read_b128 a[164:167], v10 offset:25600
buffer_load_dwordx4 v12, s[52:55], s71 offen offset:2048 sc1 lds
MA 28,a,220,v,80
v_exp_f32 v151, v151
MA 60,a,220,v,88
ds_read_b128 a[168:171], v10 offset:26624
v_cvt_pk_bf16_f32 v146, v148, v149
MA 0,a,224,v,112
ds_read_b128 a[172:175], v10 offset:27648
ds_read_b128 a[176:179], v10 offset:28672
MA 32,a,224,v,120
v_exp_f32 v152, v152
MA 4,a,228,v,112
v_exp_f32 v153, v153
MA 36,a,228,v,120
ds_read_b128 a[180:183], v10 offset:29696
v_cvt_pk_bf16_f32 v147, v150, v151
MA 8,a,232,v,112
ds_read_b128 a[184:187], v10 offset:30720
buffer_load_dwordx4 v12, s[52:55], s71 offen offset:3072 sc1 lds
MA 40,a,232,v,120
v_exp_f32 v154, v154
MA 12,a,236,v,112
v_exp_f32 v155, v155
MA 44,a,236,v,120
ds_read_b128 a[188:191], v10 offset:31744
v_cvt_pk_bf16_f32 v152, v152, v153
MV 164,v,160,v,112
v_exp_f32 v156, v156
MV 168,v,160,v,120
MA 16,a,240,v,112
v_exp_f32 v157, v157
MA 48,a,240,v,120
s_sub_u32 s74, s74, 1
v_cvt_pk_bf16_f32 v153, v154, v155
MA 20,a,244,v,112
v_exp_f32 v158, v158
MA 52,a,244,v,120
MA 24,a,248,v,112
v_exp_f32 v159, v159
MA 56,a,248,v,120
MA 28,a,252,v,112
v_cvt_pk_bf16_f32 v154, v156, v157
v_cvt_pk_bf16_f32 v155, v158, v159
MA 60,a,252,v,120
s_cbranch_scc1 L_p3_s1m_top
s_waitcnt lgkmcnt(0)
v_xor_b32 v11, 0x8000, v11
v_mfma_f32_16x16x32_bf16 v[80:83], a[128:131], v[16:19], 0
s_add_u32 m0, s73, 16384
ds_read_b128 a[192:195], v11 offset:0
v_mfma_f32_16x16x32_bf16 v[88:91], a[128:131], v[32:35], 0
v_exp_f32 v176, v176
v_mfma_f32_16x16x32_bf16 v[84:87], a[144:147], v[16:19], 0
ds_read_b128 a[196:199], v11 offset:1024
buffer_load_dwordx4 v12, s[56:59], s71 offen offset:0 sc1 lds
v_mfma_f32_16x16x32_bf16 v[92:95], a[144:147], v[32:35], 0
v_exp_f32 v177, v177
v_mfma_f32_16x16x32_bf16 v[112:115], a[160:163], v[16:19], 0
ds_read_b128 a[200:203], v11 offset:2048
ds_read_b128 a[204:207], v11 offset:3072
v_mfma_f32_16x16x32_bf16 v[120:123], a[160:163], v[32:35], 0
v_exp_f32 v178, v178
v_mfma_f32_16x16x32_bf16 v[116:119], a[176:179], v[16:19], 0
v_exp_f32 v179, v179
v_mfma_f32_16x16x32_bf16 v[124:127], a[176:179], v[32:35], 0
ds_read_b128 a[208:211], v11 offset:4096
buffer_load_dwordx4 v12, s[56:59], s71 offen offset:1024 sc1 lds
MV 116,a,180,v,20
ds_read_b128 a[212:215], v11 offset:5120
v_cvt_pk_bf16_f32 v176, v176, v177
MV 124,a,180,v,36
v_exp_f32 v180, v180
MV 112,a,164,v,20
v_exp_f32 v181, v181
MV 120,a,164,v,36
ds_read_b128 a[216:219], v11 offset:6144
ds_read_b128 a[220:223], v11 offset:7168
MV 84,a,148,v,20
buffer_load_dwordx4 v12, s[56:59], s71 offen offset:2048 sc1 lds
v_cvt_pk_bf16_f32 v177, v178, v179
MV 92,a,148,v,36
v_exp_f32 v182, v182
MV 80,a,132,v,20
ds_read_b128 a[224:227], v11 offset:8192
ds_read_b128 a[228:231], v11 offset:9216
MV 88,a,132,v,36
v_exp_f32 v183, v183
MV 80,a,136,v,24
ds_read_b128 a[232:235], v11 offset:10240
v_cvt_pk_bf16_f32 v178, v180, v181
MV 88,a,136,v,40
v_exp_f32 v184, v184
MV 84,a,152,v,24
ds_read_b128 a[236:239], v11 offset:11264
buffer_load_dwordx4 v12, s[56:59], s71 offen offset:3072 sc1 lds
MV 92,a,152,v,40
v_exp_f32 v185, v185
MV 112,a,168,v,24
ds_read_b128 a[240:243], v11 offset:12288
v_cvt_pk_bf16_f32 v179, v182, v183
MV 120,a,168,v,40
ds_read_b128 a[244:247], v11 offset:13312
ds_read_b128 a[248:251], v11 offset:14336
MV 116,a,184,v,24
v_exp_f32 v186, v186
MV 124,a,184,v,40
v_exp_f32 v187, v187
MV 116,a,188,v,28
ds_read_b128 a[252:255], v11 offset:15360
s_add_u32 s71, s71, 16384
MV 124,a,188,v,44
s_xor_b32 s73, s73, 0x8000
v_cvt_pk_bf16_f32 v184, v184, v185
MV 112,a,172,v,28
v_exp_f32 v188, v188
MV 120,a,172,v,44
v_exp_f32 v189, v189
MV 84,a,156,v,28
v_cvt_pk_bf16_f32 v185, v186, v187
MV 92,a,156,v,44
v_exp_f32 v190, v190
MV 80,a,140,v,28
v_exp_f32 v191, v191
MV 88,a,140,v,44
v_cvt_pk_bf16_f32 v186, v188, v189
v_cvt_pk_bf16_f32 v187, v190, v191
s_waitcnt vmcnt(16) lgkmcnt(0)
MA 0,a,192,v,144
s_barrier
v_xor_b32 v10, 0x8000, v10
MA 32,a,192,v,152
s_add_u32 m0, s72, 16384
ds_read_b128 a[128:131], v10 offset:0
MA 4,a,196,v,144
ds_read_b128 a[132:135], v10 offset:1024
buffer_load_dwordx4 v12, s[52:55], s71 offen offset:0 sc1 lds
MA 36,a,196,v,152
v_exp_f32 v80, v80
MA 8,a,200,v,144
v_exp_f32 v81, v81
MA 40,a,200,v,152
ds_read_b128 a[136:139], v10 offset:2048
ds_read_b128 a[140:143], v10 offset:3072
MA 12,a,204,v,144
v_exp_f32 v82, v82
MA 44,a,204,v,152
ds_read_b128 a[144:147], v10 offset:4096
buffer_load_dwordx4 v12, s[52:55], s71 offen offset:1024 sc1 lds
MV 164,v,160,v,144
v_exp_f32 v83, v83
MV 168,v,160,v,152
ds_read_b128 a[148:151], v10 offset:5120
v_cvt_pk_bf16_f32 v80, v80, v81
MA 16,a,208,v,144
v_exp_f32 v84, v84
MA 48,a,208,v,152
ds_read_b128 a[152:155], v10 offset:6144
buffer_load_dwordx4 v12, s[52:55], s71 offen offset:2048 sc1 lds
MA 20,a,212,v,144
v_exp_f32 v85, v85
MA 52,a,212,v,152
ds_read_b128 a[156:159], v10 offset:7168
v_cvt_pk_bf16_f32 v81, v82, v83
MA 24,a,216,v,144
v_exp_f32 v86, v86
MA 56,a,216,v,152
ds_read_b128 a[160:163], v10 offset:8192
ds_read_b128 a[164:167], v10 offset:9216
MA 28,a,220,v,144
v_exp_f32 v87, v87
MA 60,a,220,v,152
ds_read_b128 a[168:171], v10 offset:10240
buffer_load_dwordx4 v12, s[52:55], s71 offen offset:3072 sc1 lds
MA 0,a,224,v,176
ds_read_b128 a[172:175], v10 offset:11264
v_cvt_pk_bf16_f32 v82, v84, v85
MA 32,a,224,v,184
v_exp_f32 v88, v88
MA 4,a,228,v,176
v_exp_f32 v89, v89
MA 36,a,228,v,184
ds_read_b128 a[176:179], v10 offset:12288
s_xor_b32 s72, s72, 0x8000
MA 8,a,232,v,176
ds_read_b128 a[180:183], v10 offset:13312
v_cvt_pk_bf16_f32 v83, v86, v87
MA 40,a,232,v,184
v_exp_f32 v90, v90
MA 12,a,236,v,176
ds_read_b128 a[184:187], v10 offset:14336
ds_read_b128 a[188:191], v10 offset:15360
MA 44,a,236,v,184
v_exp_f32 v91, v91
MV 164,v,160,v,176
buffer_store_dword v237, v236, s[8:11], s37 offen offset:1024 sc1
v_cvt_pk_bf16_f32 v88, v88, v89
MV 168,v,160,v,184
v_exp_f32 v92, v92
MA 16,a,240,v,176
v_exp_f32 v93, v93
MA 48,a,240,v,184
MA 20,a,244,v,176
global_load_dword v174, v[172:173], off
v_cvt_pk_bf16_f32 v89, v90, v91
MA 52,a,244,v,184
v_exp_f32 v94, v94
MA 24,a,248,v,176
v_exp_f32 v95, v95
MA 56,a,248,v,184
MA 28,a,252,v,176
v_cvt_pk_bf16_f32 v90, v92, v93
v_cvt_pk_bf16_f32 v91, v94, v95
MA 60,a,252,v,184
s_branch L_p3_s0_top
L_p3_s1m_top:
s_waitcnt lgkmcnt(0)
v_xor_b32 v11, 0x8000, v11
v_mfma_f32_16x16x32_bf16 v[80:83], a[128:131], v[16:19], 0
ds_read_b128 a[192:195], v11 offset:0
ds_read_b128 a[196:199], v11 offset:1024
v_mfma_f32_16x16x32_bf16 v[88:91], a[128:131], v[32:35], 0
v_exp_f32 v176, v176
MV 80,a,132,v,20
v_exp_f32 v177, v177
MV 88,a,132,v,36
ds_read_b128 a[200:203], v11 offset:2048
ds_read_b128 a[204:207], v11 offset:3072
MV 80,a,136,v,24
v_exp_f32 v178, v178
MV 88,a,136,v,40
v_exp_f32 v179, v179
MV 80,a,140,v,28
ds_read_b128 a[208:211], v11 offset:4096
v_cvt_pk_bf16_f32 v176, v176, v177
MV 88,a,140,v,44
ds_read_b128 a[212:215], v11 offset:5120
ds_read_b128 a[216:219], v11 offset:6144
v_mfma_f32_16x16x32_bf16 v[84:87], a[144:147], v[16:19], 0
v_exp_f32 v180, v180
v_mfma_f32_16x16x32_bf16 v[92:95], a[144:147], v[32:35], 0
v_exp_f32 v181, v181
MV 84,a,148,v,20
ds_read_b128 a[220:223], v11 offset:7168
v_cvt_pk_bf16_f32 v177, v178, v179
MV 92,a,148,v,36
v_exp_f32 v182, v182
MV 84,a,152,v,24
ds_read_b128 a[224:227], v11 offset:8192
ds_read_b128 a[228:231], v11 offset:9216
MV 92,a,152,v,40
v_exp_f32 v183, v183
MV 84,a,156,v,28
ds_read_b128 a[232:235], v11 offset:10240
v_cvt_pk_bf16_f32 v178, v180, v181
MV 92,a,156,v,44
v_exp_f32 v184, v184
v_mfma_f32_16x16x32_bf16 v[112:115], a[160:163], v[16:19], 0
ds_read_b128 a[236:239], v11 offset:11264
ds_read_b128 a[240:243], v11 offset:12288
v_mfma_f32_16x16x32_bf16 v[120:123], a[160:163], v[32:35], 0
v_exp_f32 v185, v185
MV 112,a,164,v,20
ds_read_b128 a[244:247], v11 offset:13312
v_cvt_pk_bf16_f32 v179, v182, v183
MV 120,a,164,v,36
v_exp_f32 v186, v186
MV 112,a,168,v,24
v_exp_f32 v187, v187
MV 120,a,168,v,40
ds_read_b128 a[248:251], v11 offset:14336
ds_read_b128 a[252:255], v11 offset:15360
MV 112,a,172,v,28
v_cvt_pk_bf16_f32 v184, v184, v185
v_add_u32 v246, 0, v13
MV 120,a,172,v,44
v_cmp_gt_i32_e64 s[84:85], 0, v246
v_cmp_gt_i32_e64 s[86:87], 1, v246
v_mfma_f32_16x16x32_bf16 v[116:119], a[176:179], v[16:19], 0
v_exp_f32 v188, v188
v_mfma_f32_16x16x32_bf16 v[124:127], a[176:179], v[32:35], 0
v_cmp_gt_i32_e64 s[88:89], 2, v246
v_cmp_gt_i32_e64 s[90:91], 3, v246
MV 116,a,180,v,20
v_cndmask_b32_e64 v80, v80, v14, s[84:85]
v_cndmask_b32_e64 v81, v81, v14, s[86:87]
MV 124,a,180,v,36
v_exp_f32 v189, v189
MV 116,a,184,v,24
v_cvt_pk_bf16_f32 v185, v186, v187
v_cndmask_b32_e64 v82, v82, v14, s[88:89]
MV 124,a,184,v,40
v_cndmask_b32_e64 v83, v83, v14, s[90:91]
v_add_u32 v247, -16, v13
MV 116,a,188,v,28
v_cmp_gt_i32_e64 s[92:93], 0, v247
v_cmp_gt_i32_e64 s[94:95], 1, v247
MV 124,a,188,v,44
v_exp_f32 v190, v190
v_exp_f32 v191, v191
v_cmp_gt_i32_e64 s[96:97], 2, v247
v_cmp_gt_i32_e64 s[98:99], 3, v247
v_cndmask_b32_e64 v84, v84, v14, s[92:93]
v_cvt_pk_bf16_f32 v186, v188, v189
v_cndmask_b32_e64 v85, v85, v14, s[94:95]
v_cndmask_b32_e64 v86, v86, v14, s[96:97]
v_cvt_pk_bf16_f32 v187, v190, v191
v_cndmask_b32_e64 v87, v87, v14, s[98:99]
s_waitcnt vmcnt(12) lgkmcnt(0)
MA 0,a,192,v,144
s_barrier
v_xor_b32 v10, 0x8000, v10
MA 32,a,192,v,152
ds_read_b128 a[128:131], v10 offset:0
ds_read_b128 a[132:135], v10 offset:1024
MA 4,a,196,v,144
v_exp_f32 v80, v80
MA 36,a,196,v,152
v_exp_f32 v81, v81
MA 8,a,200,v,144
ds_read_b128 a[136:139], v10 offset:2048
ds_read_b128 a[140:143], v10 offset:3072
MA 40,a,200,v,152
v_exp_f32 v82, v82
MA 12,a,204,v,144
ds_read_b128 a[144:147], v10 offset:4096
v_add_u32 v246, -32, v13
MA 44,a,204,v,152
v_exp_f32 v83, v83
MV 164,v,160,v,144
v_cvt_pk_bf16_f32 v80, v80, v81
v_cmp_gt_i32_e64 s[84:85], 0, v246
MV 168,v,160,v,152
ds_read_b128 a[148:151], v10 offset:5120
v_cmp_gt_i32_e64 s[86:87], 1, v246
MA 16,a,208,v,144
v_exp_f32 v84, v84
MA 48,a,208,v,152
ds_read_b128 a[152:155], v10 offset:6144
v_cmp_gt_i32_e64 s[88:89], 2, v246
MA 20,a,212,v,144
v_exp_f32 v85, v85
MA 52,a,212,v,152
ds_read_b128 a[156:159], v10 offset:7168
v_cmp_gt_i32_e64 s[90:91], 3, v246
MA 24,a,216,v,144
ds_read_b128 a[160:163], v10 offset:8192
v_cvt_pk_bf16_f32 v81, v82, v83
MA 56,a,216,v,152
v_exp_f32 v86, v86
MA 28,a,220,v,144
ds_read_b128 a[164:167], v10 offset:9216
v_cndmask_b32_e64 v112, v112, v14, s[84:85]
MA 60,a,220,v,152
v_exp_f32 v87, v87
MA 0,a,224,v,176
ds_read_b128 a[168:171], v10 offset:10240
v_cndmask_b32_e64 v113, v113, v14, s[86:87]
MA 32,a,224,v,184
v_cvt_pk_bf16_f32 v82, v84, v85
v_cndmask_b32_e64 v114, v114, v14, s[88:89]
MA 4,a,228,v,176
ds_read_b128 a[172:175], v10 offset:11264
v_cndmask_b32_e64 v115, v115, v14, s[90:91]
MA 36,a,228,v,184
v_exp_f32 v88, v88
MA 8,a,232,v,176
v_exp_f32 v89, v89
MA 40,a,232,v,184
ds_read_b128 a[176:179], v10 offset:12288
v_cvt_pk_bf16_f32 v83, v86, v87
MA 12,a,236,v,176
ds_read_b128 a[180:183], v10 offset:13312
v_add_u32 v247, -48, v13
MA 44,a,236,v,184
ds_read_b128 a[184:187], v10 offset:14336
v_cmp_gt_i32_e64 s[92:93], 0, v247
MV 164,v,160,v,176
v_exp_f32 v90, v90
MV 168,v,160,v,184
ds_read_b128 a[188:191], v10 offset:15360
v_cmp_gt_i32_e64 s[94:95], 1, v247
MA 16,a,240,v,176
v_exp_f32 v91, v91
MA 48,a,240,v,184
v_cvt_pk_bf16_f32 v88, v88, v89
v_cmp_gt_i32_e64 s[96:97], 2, v247
MA 20,a,244,v,176
v_exp_f32 v92, v92
MA 52,a,244,v,184
v_cmp_gt_i32_e64 s[98:99], 3, v247
v_cndmask_b32_e64 v116, v116, v14, s[92:93]
MA 24,a,248,v,176
v_exp_f32 v93, v93
MA 56,a,248,v,184
v_cvt_pk_bf16_f32 v89, v90, v91
v_cndmask_b32_e64 v117, v117, v14, s[94:95]
MA 28,a,252,v,176
v_exp_f32 v94, v94
MA 60,a,252,v,184
v_exp_f32 v95, v95
v_cndmask_b32_e64 v118, v118, v14, s[96:97]
v_cvt_pk_bf16_f32 v90, v92, v93
v_cndmask_b32_e64 v119, v119, v14, s[98:99]
v_cvt_pk_bf16_f32 v91, v94, v95
L_p3_s0m_top:
s_waitcnt lgkmcnt(0)
v_mfma_f32_16x16x32_bf16 v[152:155], a[128:131], v[32:35], 0
ds_read_b128 a[192:195], v11 offset:16384
ds_read_b128 a[196:199], v11 offset:17408
MV 152,a,132,v,36
v_exp_f32 v112, v112
MV 152,a,136,v,40
v_exp_f32 v113, v113
MV 152,a,140,v,44
ds_read_b128 a[200:203], v11 offset:18432
ds_read_b128 a[204:207], v11 offset:19456
v_mfma_f32_16x16x32_bf16 v[156:159], a[144:147], v[32:35], 0
v_exp_f32 v114, v114
MV 156,a,148,v,36
v_exp_f32 v115, v115
MV 156,a,152,v,40
ds_read_b128 a[208:211], v11 offset:20480
ds_read_b128 a[212:215], v11 offset:21504
MV 156,a,156,v,44
ds_read_b128 a[216:219], v11 offset:22528
v_cvt_pk_bf16_f32 v112, v112, v113
v_mfma_f32_16x16x32_bf16 v[184:187], a[160:163], v[32:35], 0
v_exp_f32 v116, v116
MV 184,a,164,v,36
v_exp_f32 v117, v117
MV 184,a,168,v,40
ds_read_b128 a[220:223], v11 offset:23552
v_cvt_pk_bf16_f32 v113, v114, v115
MV 184,a,172,v,44
v_exp_f32 v118, v118
v_mfma_f32_16x16x32_bf16 v[188:191], a[176:179], v[32:35], 0
ds_read_b128 a[224:227], v11 offset:24576
ds_read_b128 a[228:231], v11 offset:25600
MV 188,a,180,v,36
v_exp_f32 v119, v119
MV 188,a,184,v,40
ds_read_b128 a[232:235], v11 offset:26624
v_cvt_pk_bf16_f32 v114, v116, v117
MV 188,a,188,v,44
ds_read_b128 a[236:239], v11 offset:27648
ds_read_b128 a[240:243], v11 offset:28672
ds_read_b128 a[244:247], v11 offset:29696
ds_read_b128 a[248:251], v11 offset:30720
ds_read_b128 a[252:255], v11 offset:31744
v_exp_f32 v120, v120
v_exp_f32 v121, v121
v_cvt_pk_bf16_f32 v115, v118, v119
v_exp_f32 v122, v122
v_exp_f32 v123, v123
v_cvt_pk_bf16_f32 v120, v120, v121
v_exp_f32 v124, v124
v_exp_f32 v125, v125
v_cvt_pk_bf16_f32 v121, v122, v123
v_exp_f32 v126, v126
v_exp_f32 v127, v127
v_add_u32 v246, -64, v239
v_cmp_gt_i32_e64 s[84:85], 0, v246
v_cmp_gt_i32_e64 s[86:87], 1, v246
v_cmp_gt_i32_e64 s[88:89], 2, v246
v_cmp_gt_i32_e64 s[90:91], 3, v246
v_cndmask_b32_e64 v152, v152, v14, s[84:85]
v_cndmask_b32_e64 v153, v153, v14, s[86:87]
v_cndmask_b32_e64 v154, v154, v14, s[88:89]
v_cndmask_b32_e64 v155, v155, v14, s[90:91]
v_cvt_pk_bf16_f32 v122, v124, v125
v_cvt_pk_bf16_f32 v123, v126, v127
v_add_u32 v247, -80, v239
v_cmp_gt_i32_e64 s[92:93], 0, v247
v_cmp_gt_i32_e64 s[94:95], 1, v247
v_cmp_gt_i32_e64 s[96:97], 2, v247
v_cmp_gt_i32_e64 s[98:99], 3, v247
v_cndmask_b32_e64 v156, v156, v14, s[92:93]
v_cndmask_b32_e64 v157, v157, v14, s[94:95]
v_cndmask_b32_e64 v158, v158, v14, s[96:97]
v_cndmask_b32_e64 v159, v159, v14, s[98:99]
s_waitcnt vmcnt(4) lgkmcnt(0)
MA 0,a,192,v,80
s_barrier
MA 32,a,192,v,88
MA 4,a,196,v,80
v_lshlrev_b32 v245, 4, v1
s_mov_b32 m0, s43
MA 36,a,196,v,88
v_exp_f32 v152, v152
MA 8,a,200,v,80
MA 40,a,200,v,88
v_exp_f32 v153, v153
MA 12,a,204,v,80
v_add_u32 v246, -96, v239
v_cmp_gt_i32_e64 s[84:85], 0, v246
MA 44,a,204,v,88
MV 164,v,160,v,80
v_exp_f32 v154, v154
MV 168,v,160,v,88
s_nop 0
v_cmp_gt_i32_e64 s[86:87], 1, v246
MA 16,a,208,v,80
MA 48,a,208,v,88
v_cmp_gt_i32_e64 s[88:89], 2, v246
v_cmp_gt_i32_e64 s[90:91], 3, v246
MA 20,a,212,v,80
v_exp_f32 v155, v155
MA 52,a,212,v,88
MA 24,a,216,v,80
v_cvt_pk_bf16_f32 v152, v152, v153
v_cndmask_b32_e64 v184, v184, v14, s[84:85]
MA 56,a,216,v,88
MA 28,a,220,v,80
buffer_load_dwordx4 v245, s[20:23], 0 offen offset:0 sc1 lds
v_cndmask_b32_e64 v185, v185, v14, s[86:87]
MA 60,a,220,v,88
v_exp_f32 v156, v156
MA 0,a,224,v,112
v_cndmask_b32_e64 v186, v186, v14, s[88:89]
v_cndmask_b32_e64 v187, v187, v14, s[90:91]
MA 32,a,224,v,120
MA 4,a,228,v,112
v_exp_f32 v157, v157
MA 36,a,228,v,120
buffer_load_dwordx4 v245, s[20:23], 0 offen offset:1024 sc1 lds
v_add_u32 v247, -112, v239
MA 8,a,232,v,112
v_cvt_pk_bf16_f32 v153, v154, v155
v_cmp_gt_i32_e64 s[92:93], 0, v247
MA 40,a,232,v,120
MA 12,a,236,v,112
buffer_load_dwordx4 v245, s[20:23], 0 offen offset:2048 sc1 lds
v_cmp_gt_i32_e64 s[94:95], 1, v247
MA 44,a,236,v,120
v_exp_f32 v158, v158
MV 164,v,160,v,112
v_cmp_gt_i32_e64 s[96:97], 2, v247
v_cmp_gt_i32_e64 s[98:99], 3, v247
MV 168,v,160,v,120
MA 16,a,240,v,112
MA 48,a,240,v,120
v_exp_f32 v159, v159
MA 20,a,244,v,112
buffer_load_dwordx4 v245, s[20:23], 0 offen offset:3072 sc1 lds
v_cndmask_b32_e64 v188, v188, v14, s[92:93]
MA 52,a,244,v,120
v_cvt_pk_bf16_f32 v154, v156, v157
v_cndmask_b32_e64 v189, v189, v14, s[94:95]
MA 24,a,248,v,112
v_cvt_pk_bf16_f32 v155, v158, v159
v_cndmask_b32_e64 v190, v190, v14, s[96:97]
MA 56,a,248,v,120
MA 28,a,252,v,112
v_cndmask_b32_e64 v191, v191, v14, s[98:99]
MA 60,a,252,v,120
s_load_dwordx2 s[88:89], s[0:1], 104
s_waitcnt lgkmcnt(0)
v_xor_b32 v11, 0x8000, v11
ds_read_b128 a[192:195], v11 offset:0
ds_read_b128 a[196:199], v11 offset:1024
ds_read_b128 a[200:203], v11 offset:2048
ds_read_b128 a[204:207], v11 offset:3072
ds_read_b128 a[208:211], v11 offset:4096
ds_read_b128 a[212:215], v11 offset:5120
ds_read_b128 a[216:219], v11 offset:6144
ds_read_b128 a[220:223], v11 offset:7168
ds_read_b128 a[224:227], v11 offset:8192
ds_read_b128 a[228:231], v11 offset:9216
ds_read_b128 a[232:235], v11 offset:10240
ds_read_b128 a[236:239], v11 offset:11264
ds_read_b128 a[240:243], v11 offset:12288
ds_read_b128 a[244:247], v11 offset:13312
ds_read_b128 a[248:251], v11 offset:14336
ds_read_b128 a[252:255], v11 offset:15360
v_exp_f32 v184, v184
v_exp_f32 v185, v185
v_exp_f32 v186, v186
v_exp_f32 v187, v187
v_cvt_pk_bf16_f32 v184, v184, v185
v_exp_f32 v188, v188
v_exp_f32 v189, v189
v_cvt_pk_bf16_f32 v185, v186, v187
v_exp_f32 v190, v190
v_exp_f32 v191, v191
v_cvt_pk_bf16_f32 v186, v188, v189
v_cvt_pk_bf16_f32 v187, v190, v191
MV 168,v,160,v,152
s_nop 0
MV 168,v,160,v,184
v_mov_b32 v240, v2
v_mov_b32 v241, v3
s_nop 0
v_permlane32_swap_b32 v2, v240
v_permlane32_swap_b32 v3, v241
v_add_f32 v2, v2, v240
v_add_f32 v3, v3, v241
v_mov_b32 v240, v2
v_mov_b32 v241, v3
s_nop 0
v_permlane16_swap_b32 v2, v240
v_permlane16_swap_b32 v3, v241
v_add_f32 v2, v2, v240
v_add_f32 v3, v3, v241
v_add_f32 v2, v2, v164
v_cmp_nle_f32 vcc, 0x30800000, v2
s_nop 0
s_or_b64 s[78:79], s[78:79], vcc
v_cmp_nge_f32 vcc, 0x4e800000, v2
s_nop 0
s_or_b64 s[78:79], s[78:79], vcc
v_add_f32 v3, v3, v168
v_cmp_nle_f32 vcc, 0x30800000, v3
s_nop 0
s_or_b64 s[78:79], s[78:79], vcc
v_cmp_nge_f32 vcc, 0x4e800000, v3
s_nop 0
s_or_b64 s[78:79], s[78:79], vcc
s_cmp_lg_u64 s[78:79], 0
s_cselect_b32 s80, 1, 0
v_mov_b32 v240, s80
s_lshl_b32 s80, s3, 2
s_add_u32 s80, s80, 163824
v_mov_b32 v241, s80
ds_write_b32 v241, v240
v_mov_b32 v241, 163824
s_waitcnt vmcnt(0) lgkmcnt(0)
s_barrier
ds_read_b128 v[244:247], v241
buffer_store_dword v237, v236, s[8:11], s37 offen offset:1024 sc1
MA 32,a,192,v,152
MA 36,a,196,v,152
MA 40,a,200,v,152
MA 44,a,204,v,152
MA 48,a,208,v,152
MA 52,a,212,v,152
s_waitcnt lgkmcnt(0)
v_or3_b32 v240, v244, v245, v246
v_or_b32 v240, v240, v247
MA 56,a,216,v,152
v_cmp_ne_u32 vcc, 0, v240
MA 60,a,220,v,152
MA 32,a,224,v,184
s_cbranch_vccnz L_fallback
MA 36,a,228,v,184
s_mul_i32 s36, s3, 8320
v_and_b32 v16, 15, v1
MA 40,a,232,v,184
v_lshrrev_b32 v17, 4, v1
v_add_u32 v18, 1, v16
MA 44,a,236,v,184
v_and_b32 v19, 1, v18
v_mul_u32_u24 v19, 4160, v19
MA 48,a,240,v,184
v_add_u32 v18, 2, v16
v_lshrrev_b32 v18, 1, v18
MA 52,a,244,v,184
v_lshl_add_u32 v19, v18, 2, v19
v_lshl_add_u32 v19, v17, 4, v19
MA 56,a,248,v,184
v_add_u32 v40, s36, v19
v_add_u32 v41, 1024, v40
MA 60,a,252,v,184
v_add_u32 v42, 2048, v40
v_add_u32 v43, 3072, v40
v_add_u32 v10, s36, v232
v_lshlrev_b32 v18, 5, v16
v_lshlrev_b32 v19, 4, v17
v_sub_u32 v19, v19, v18
s_add_u32 s37, s43, 480
v_add_u32 v5, s37, v19
v_mov_b32 v20, 0
v_mov_b32 v21, 0
v_mov_b32 v22, 0
v_mov_b32 v23, 0
v_and_b32 v16, 1, v1
v_mul_u32_u24 v16, 4160, v16
v_and_b32 v17, 2, v1
v_lshl_add_u32 v16, v17, 3, v16
v_add_u32 v16, s36, v16
ds_write_b128 v16, v[20:23]
v_and_b32 v17, 31, v1
v_lshlrev_b32 v17, 4, v17
v_add_u32 v17, s43, v17
ds_write_b128 v17, v[20:23] offset:4096
v_mov_b32 v209, 0
ds_write_b128 v10, v[210:213] offset:32
s_nop 0
v_mov_b32_dpp v209, v213 wave_shr:1 row_mask:0xf bank_mask:0xf
v_alignbit_b32 v24, v210, v209, 16
v_alignbit_b32 v25, v211, v210, 16
v_alignbit_b32 v26, v212, v211, 16
v_alignbit_b32 v27, v213, v212, 16
ds_write_b128 v10, v[24:27] offset:4192
v_mov_b32_dpp v215, v213 wave_ror:1 row_mask:0xf bank_mask:0xf
ds_write_b128 v10, v[216:219] offset:1056
s_nop 0
v_mov_b32_dpp v215, v219 wave_shr:1 row_mask:0xf bank_mask:0xf
v_alignbit_b32 v28, v216, v215, 16
v_alignbit_b32 v29, v217, v216, 16
v_alignbit_b32 v30, v218, v217, 16
v_alignbit_b32 v31, v219, v218, 16
ds_write_b128 v10, v[28:31] offset:5216
v_mov_b32_dpp v221, v219 wave_ror:1 row_mask:0xf bank_mask:0xf
ds_write_b128 v10, v[222:225] offset:2080
s_nop 0
v_mov_b32_dpp v221, v225 wave_shr:1 row_mask:0xf bank_mask:0xf
v_alignbit_b32 v24, v222, v221, 16
v_alignbit_b32 v25, v223, v222, 16
v_alignbit_b32 v26, v224, v223, 16
v_alignbit_b32 v27, v225, v224, 16
ds_write_b128 v10, v[24:27] offset:6240
v_mov_b32_dpp v227, v225 wave_ror:1 row_mask:0xf bank_mask:0xf
ds_write_b128 v10, v[228:231] offset:3104
s_nop 0
v_mov_b32_dpp v227, v231 wave_shr:1 row_mask:0xf bank_mask:0xf
v_alignbit_b32 v28, v228, v227, 16
v_alignbit_b32 v29, v229, v228, 16
v_alignbit_b32 v30, v230, v229, 16
v_alignbit_b32 v31, v231, v230, 16
ds_write_b128 v10, v[28:31] offset:7264
ds_read_b128 a[160:163], v5 offset:3584
ds_read2_b32 a[128:129], v40 offset0:0 offset1:1
ds_read2_b32 a[130:131], v40 offset0:2 offset1:3
ds_read_b128 a[164:167], v5 offset:3072
ds_read2_b32 a[132:133], v40 offset0:128 offset1:129
ds_read2_b32 a[134:135], v40 offset0:130 offset1:131
ds_read_b128 a[168:171], v5 offset:2560
ds_read2_b32 a[136:137], v41 offset0:0 offset1:1
ds_read2_b32 a[138:139], v41 offset0:2 offset1:3
ds_read_b128 a[172:175], v5 offset:2048
ds_read2_b32 a[140:141], v41 offset0:128 offset1:129
ds_read2_b32 a[142:143], v41 offset0:130 offset1:131
ds_read_b128 a[176:179], v5 offset:1536
ds_read2_b32 a[144:145], v42 offset0:0 offset1:1
ds_read2_b32 a[146:147], v42 offset0:2 offset1:3
ds_read_b128 a[180:183], v5 offset:1024
ds_read2_b32 a[148:149], v42 offset0:128 offset1:129
ds_read2_b32 a[150:151], v42 offset0:130 offset1:131
ds_read_b128 a[184:187], v5 offset:512
ds_read2_b32 a[152:153], v43 offset0:0 offset1:1
ds_read2_b32 a[154:155], v43 offset0:2 offset1:3
ds_read_b128 a[188:191], v5 offset:0
ds_read2_b32 a[156:157], v43 offset0:128 offset1:129
ds_read2_b32 a[158:159], v43 offset0:130 offset1:131
v_rcp_f32 v2, v2
v_rcp_f32 v3, v3
s_add_u32 s80, s100, s76
s_nop 4
v_accvgpr_read_b32 v240, a0
v_accvgpr_read_b32 v241, a1
v_accvgpr_read_b32 v242, a2
v_accvgpr_read_b32 v243, a3
v_accvgpr_read_b32 v244, a4
v_accvgpr_read_b32 v245, a5
v_accvgpr_read_b32 v246, a6
v_accvgpr_read_b32 v247, a7
v_pk_mul_f32 v[240:241], v[240:241], v[2:3] op_sel:[0,0] op_sel_hi:[1,0]
v_pk_mul_f32 v[242:243], v[242:243], v[2:3] op_sel:[0,0] op_sel_hi:[1,0]
v_pk_mul_f32 v[244:245], v[244:245], v[2:3] op_sel:[0,0] op_sel_hi:[1,0]
v_pk_mul_f32 v[246:247], v[246:247], v[2:3] op_sel:[0,0] op_sel_hi:[1,0]
v_cvt_pk_bf16_f32 v248, v240, v241
v_cvt_pk_bf16_f32 v249, v242, v243
v_cvt_pk_bf16_f32 v250, v244, v245
v_cvt_pk_bf16_f32 v251, v246, v247
buffer_store_dwordx4 v[248:251], v15, s[60:63], s100 offen offset:0 sc1
v_accvgpr_read_b32 v240, a8
v_accvgpr_read_b32 v241, a9
v_accvgpr_read_b32 v242, a10
v_accvgpr_read_b32 v243, a11
v_accvgpr_read_b32 v244, a12
v_accvgpr_read_b32 v245, a13
v_accvgpr_read_b32 v246, a14
v_accvgpr_read_b32 v247, a15
v_pk_mul_f32 v[240:241], v[240:241], v[2:3] op_sel:[0,0] op_sel_hi:[1,0]
v_pk_mul_f32 v[242:243], v[242:243], v[2:3] op_sel:[0,0] op_sel_hi:[1,0]
v_pk_mul_f32 v[244:245], v[244:245], v[2:3] op_sel:[0,0] op_sel_hi:[1,0]
v_pk_mul_f32 v[246:247], v[246:247], v[2:3] op_sel:[0,0] op_sel_hi:[1,0]
v_cvt_pk_bf16_f32 v252, v240, v241
v_cvt_pk_bf16_f32 v253, v242, v243
v_cvt_pk_bf16_f32 v254, v244, v245
v_cvt_pk_bf16_f32 v255, v246, v247
buffer_store_dwordx4 v[252:255], v15, s[60:63], s100 offen offset:1024 sc1
v_accvgpr_read_b32 v240, a16
v_accvgpr_read_b32 v241, a17
v_accvgpr_read_b32 v242, a18
v_accvgpr_read_b32 v243, a19
v_accvgpr_read_b32 v244, a20
v_accvgpr_read_b32 v245, a21
v_accvgpr_read_b32 v246, a22
v_accvgpr_read_b32 v247, a23
v_pk_mul_f32 v[240:241], v[240:241], v[2:3] op_sel:[0,0] op_sel_hi:[1,0]
v_pk_mul_f32 v[242:243], v[242:243], v[2:3] op_sel:[0,0] op_sel_hi:[1,0]
v_pk_mul_f32 v[244:245], v[244:245], v[2:3] op_sel:[0,0] op_sel_hi:[1,0]
v_pk_mul_f32 v[246:247], v[246:247], v[2:3] op_sel:[0,0] op_sel_hi:[1,0]
v_cvt_pk_bf16_f32 v248, v240, v241
v_cvt_pk_bf16_f32 v249, v242, v243
v_cvt_pk_bf16_f32 v250, v244, v245
v_cvt_pk_bf16_f32 v251, v246, v247
buffer_store_dwordx4 v[248:251], v15, s[60:63], s100 offen offset:2048 sc1
v_accvgpr_read_b32 v240, a24
v_accvgpr_read_b32 v241, a25
v_accvgpr_read_b32 v242, a26
v_accvgpr_read_b32 v243, a27
v_accvgpr_read_b32 v244, a28
v_accvgpr_read_b32 v245, a29
v_accvgpr_read_b32 v246, a30
v_accvgpr_read_b32 v247, a31
v_pk_mul_f32 v[240:241], v[240:241], v[2:3] op_sel:[0,0] op_sel_hi:[1,0]
v_pk_mul_f32 v[242:243], v[242:243], v[2:3] op_sel:[0,0] op_sel_hi:[1,0]
v_pk_mul_f32 v[244:245], v[244:245], v[2:3] op_sel:[0,0] op_sel_hi:[1,0]
v_pk_mul_f32 v[246:247], v[246:247], v[2:3] op_sel:[0,0] op_sel_hi:[1,0]
v_cvt_pk_bf16_f32 v252, v240, v241
v_cvt_pk_bf16_f32 v253, v242, v243
v_cvt_pk_bf16_f32 v254, v244, v245
v_cvt_pk_bf16_f32 v255, v246, v247
buffer_store_dwordx4 v[252:255], v15, s[60:63], s100 offen offset:3072 sc1
v_accvgpr_read_b32 v240, a32
v_accvgpr_read_b32 v241, a33
v_accvgpr_read_b32 v242, a34
v_accvgpr_read_b32 v243, a35
v_accvgpr_read_b32 v244, a36
v_accvgpr_read_b32 v245, a37
v_accvgpr_read_b32 v246, a38
v_accvgpr_read_b32 v247, a39
v_pk_mul_f32 v[240:241], v[240:241], v[2:3] op_sel:[0,1] op_sel_hi:[1,1]
v_pk_mul_f32 v[242:243], v[242:243], v[2:3] op_sel:[0,1] op_sel_hi:[1,1]
v_pk_mul_f32 v[244:245], v[244:245], v[2:3] op_sel:[0,1] op_sel_hi:[1,1]
v_pk_mul_f32 v[246:247], v[246:247], v[2:3] op_sel:[0,1] op_sel_hi:[1,1]
v_cvt_pk_bf16_f32 v248, v240, v241
v_cvt_pk_bf16_f32 v249, v242, v243
v_cvt_pk_bf16_f32 v250, v244, v245
v_cvt_pk_bf16_f32 v251, v246, v247
buffer_store_dwordx4 v[248:251], v15, s[60:63], s80 offen offset:0 sc1
v_accvgpr_read_b32 v240, a40
v_accvgpr_read_b32 v241, a41
v_accvgpr_read_b32 v242, a42
v_accvgpr_read_b32 v243, a43
v_accvgpr_read_b32 v244, a44
v_accvgpr_read_b32 v245, a45
v_accvgpr_read_b32 v246, a46
v_accvgpr_read_b32 v247, a47
v_pk_mul_f32 v[240:241], v[240:241], v[2:3] op_sel:[0,1] op_sel_hi:[1,1]
v_pk_mul_f32 v[242:243], v[242:243], v[2:3] op_sel:[0,1] op_sel_hi:[1,1]
v_pk_mul_f32 v[244:245], v[244:245], v[2:3] op_sel:[0,1] op_sel_hi:[1,1]
v_pk_mul_f32 v[246:247], v[246:247], v[2:3] op_sel:[0,1] op_sel_hi:[1,1]
v_cvt_pk_bf16_f32 v252, v240, v241
v_cvt_pk_bf16_f32 v253, v242, v243
v_cvt_pk_bf16_f32 v254, v244, v245
v_cvt_pk_bf16_f32 v255, v246, v247
buffer_store_dwordx4 v[252:255], v15, s[60:63], s80 offen offset:1024 sc1
v_accvgpr_read_b32 v240, a48
v_accvgpr_read_b32 v241, a49
v_accvgpr_read_b32 v242, a50
v_accvgpr_read_b32 v243, a51
v_accvgpr_read_b32 v244, a52
v_accvgpr_read_b32 v245, a53
v_accvgpr_read_b32 v246, a54
v_accvgpr_read_b32 v247, a55
v_pk_mul_f32 v[240:241], v[240:241], v[2:3] op_sel:[0,1] op_sel_hi:[1,1]
v_pk_mul_f32 v[242:243], v[242:243], v[2:3] op_sel:[0,1] op_sel_hi:[1,1]
v_pk_mul_f32 v[244:245], v[244:245], v[2:3] op_sel:[0,1] op_sel_hi:[1,1]
v_pk_mul_f32 v[246:247], v[246:247], v[2:3] op_sel:[0,1] op_sel_hi:[1,1]
v_cvt_pk_bf16_f32 v248, v240, v241
v_cvt_pk_bf16_f32 v249, v242, v243
v_cvt_pk_bf16_f32 v250, v244, v245
v_cvt_pk_bf16_f32 v251, v246, v247
buffer_store_dwordx4 v[248:251], v15, s[60:63], s80 offen offset:2048 sc1
v_accvgpr_read_b32 v240, a56
v_accvgpr_read_b32 v241, a57
v_accvgpr_read_b32 v242, a58
v_accvgpr_read_b32 v243, a59
v_accvgpr_read_b32 v244, a60
v_accvgpr_read_b32 v245, a61
v_accvgpr_read_b32 v246, a62
v_accvgpr_read_b32 v247, a63
v_pk_mul_f32 v[240:241], v[240:241], v[2:3] op_sel:[0,1] op_sel_hi:[1,1]
v_pk_mul_f32 v[242:243], v[242:243], v[2:3] op_sel:[0,1] op_sel_hi:[1,1]
v_pk_mul_f32 v[244:245], v[244:245], v[2:3] op_sel:[0,1] op_sel_hi:[1,1]
v_pk_mul_f32 v[246:247], v[246:247], v[2:3] op_sel:[0,1] op_sel_hi:[1,1]
v_cvt_pk_bf16_f32 v252, v240, v241
v_cvt_pk_bf16_f32 v253, v242, v243
v_cvt_pk_bf16_f32 v254, v244, v245
v_cvt_pk_bf16_f32 v255, v246, v247
buffer_store_dwordx4 v[252:255], v15, s[60:63], s80 offen offset:3072 sc1
L_p3_done:
s_nop 1
v_lshlrev_b32 v255, 20, v1
v_mov_b32 v253, 1
s_lshl_b32 s83, s3, 8
s_add_u32 s83, s83, s2
s_lshl_b32 s83, s83, 2
s_add_u32 s83, s83, 4096
s_waitcnt lgkmcnt(15)
v_mfma_f32_16x16x32_bf16 v[76:79], a[128:131], a[160:163], 0
v_and_b32 v16, 15, v1
v_lshrrev_b32 v17, 4, v1
v_mfma_f32_16x16x32_bf16 v[80:83], a[128:131], a[164:167], 0
v_lshl_add_u32 v18, v17, 3, v16
ds_read_b128 a[224:227], v5 offset:3648
v_mfma_f32_16x16x32_bf16 v[84:87], a[128:131], a[168:171], 0
v_sub_u32 v235, 15, v18
ds_read2_b32 a[192:193], v40 offset0:16 offset1:17
s_waitcnt lgkmcnt(15)
v_mfma_f32_16x16x32_bf16 v[88:91], a[128:131], a[172:175], 0
v_lshlrev_b32 v18, 16, v234
ds_read2_b32 a[194:195], v40 offset0:18 offset1:19
s_waitcnt lgkmcnt(14)
v_mfma_f32_16x16x32_bf16 v[92:95], a[128:131], a[176:179], 0
v_cmp_eq_u32 vcc, 0, v235
v_cmp_eq_u32_e64 s[38:39], 1, v235
s_waitcnt lgkmcnt(11)
v_mfma_f32_16x16x32_bf16 v[96:99], a[128:131], a[180:183], 0
ds_read_b128 a[228:231], v5 offset:3136
ds_read2_b32 a[196:197], v40 offset0:144 offset1:145
s_waitcnt lgkmcnt(10)
v_mfma_f32_16x16x32_bf16 v[100:103], a[128:131], a[184:187], 0
s_nop 0
v_cndmask_b32 v44, 0, v234, vcc
s_waitcnt lgkmcnt(7)
v_mfma_f32_16x16x32_bf16 v[104:107], a[128:131], a[188:191], 0
ds_read2_b32 a[198:199], v40 offset0:146 offset1:147
ds_read_b128 a[232:235], v5 offset:2624
MV 80,a,132,a,160
v_cndmask_b32_e64 v44, v44, v18, s[38:39]
ds_read2_b32 a[200:201], v41 offset0:16 offset1:17
MV 84,a,132,a,164
v_cmp_eq_u32 vcc, 2, v235
v_cmp_eq_u32_e64 s[38:39], 3, v235
MV 88,a,132,a,168
ds_read2_b32 a[202:203], v41 offset0:18 offset1:19
s_and_b32 s81, s2, 3
MV 92,a,132,a,172
s_nop 0
v_cndmask_b32 v45, 0, v234, vcc
MV 96,a,132,a,176
ds_read_b128 a[236:239], v5 offset:2112
ds_read2_b32 a[204:205], v41 offset0:144 offset1:145
MV 100,a,132,a,180
v_cndmask_b32_e64 v45, v45, v18, s[38:39]
ds_read2_b32 a[206:207], v41 offset0:146 offset1:147
MV 104,a,132,a,184
v_cmp_eq_u32 vcc, 4, v235
v_cmp_eq_u32_e64 s[38:39], 5, v235
MV 84,a,136,a,160
ds_read_b128 a[240:243], v5 offset:1600
s_lshl_b32 s81, s81, 1
MV 88,a,136,a,164
s_nop 0
v_cndmask_b32 v46, 0, v234, vcc
MV 92,a,136,a,168
ds_read2_b32 a[208:209], v42 offset0:16 offset1:17
ds_read2_b32 a[210:211], v42 offset0:18 offset1:19
MV 96,a,136,a,172
v_cndmask_b32_e64 v46, v46, v18, s[38:39]
ds_read_b128 a[244:247], v5 offset:1088
MV 100,a,136,a,176
v_cmp_eq_u32 vcc, 6, v235
v_cmp_eq_u32_e64 s[38:39], 7, v235
MV 104,a,136,a,180
ds_read2_b32 a[212:213], v42 offset0:144 offset1:145
s_sub_u32 s74, 14, s81
MV 88,a,140,a,160
s_nop 0
v_cndmask_b32 v47, 0, v234, vcc
MV 92,a,140,a,164
ds_read2_b32 a[214:215], v42 offset0:146 offset1:147
ds_read_b128 a[248:251], v5 offset:576
MV 96,a,140,a,168
v_cndmask_b32_e64 v47, v47, v18, s[38:39]
ds_read2_b32 a[216:217], v43 offset0:16 offset1:17
MV 100,a,140,a,172
s_bitcmp1_b32 s2, 4
s_cselect_b32 s81, s74, s81
MV 104,a,140,a,176
ds_read2_b32 a[218:219], v43 offset0:18 offset1:19
s_bfe_u32 s74, s2, 0x10003
MV 92,a,144,a,160
ds_read_b128 a[252:255], v5 offset:64
s_add_u32 s81, s81, s74
MV 96,a,144,a,164
ds_read2_b32 a[220:221], v43 offset0:144 offset1:145
s_bfe_u32 s82, s2, 0x10002
MV 100,a,144,a,168
ds_read2_b32 a[222:223], v43 offset0:146 offset1:147
s_lshr_b32 s74, s2, 5
MV 104,a,144,a,172
s_lshl_b32 s74, s74, 1
s_add_u32 s82, s82, s74
MV 96,a,148,a,160
s_mov_b32 s72, s81
s_mov_b32 s73, s82
MV 100,a,148,a,164
s_lshl_b32 s74, s72, 2
s_add_u32 s74, s74, s3
MV 104,a,148,a,168
s_lshl_b32 s68, s74, 18
MV 100,a,152,a,160
MV 104,a,152,a,164
s_and_b32 s80, s73, 1
s_waitcnt lgkmcnt(15)
MV 104,a,156,a,160
MV 76,v,44,a,160
s_lshl_b32 s75, s80, 16
MV 80,v,44,a,164
MV 84,v,44,a,168
s_add_u32 s68, s68, s75
MV 88,v,44,a,172
MV 92,v,44,a,176
s_lshl_b32 s69, s73, 19
MV 96,v,44,a,180
MV 100,v,44,a,184
MV 104,v,44,a,188
s_waitcnt vmcnt(0)
buffer_store_dword v253, v255, s[8:11], s83 offen sc1
MV 76,a,192,a,224
ds_read_b128 a[160:163], v5 offset:3712
s_lshl_b32 s75, s73, 7
MV 80,a,196,a,224
ds_read2_b32 a[128:129], v40 offset0:32 offset1:33
s_lshl_b32 s70, s3, 12
MV 80,a,192,a,228
ds_read2_b32 a[130:131], v40 offset0:34 offset1:35
s_lshl_b32 s78, s74, 16
MV 84,a,196,a,228
ds_read_b128 a[164:167], v5 offset:3200
s_add_u32 s78, s78, s75
MV 84,a,192,a,232
s_lshl_b32 s79, s73, 18
s_lshl_b32 s75, s74, 8
MV 88,a,196,a,232
ds_read2_b32 a[132:133], v40 offset0:160 offset1:161
s_add_u32 s79, s79, s75
s_waitcnt lgkmcnt(15)
MV 88,a,192,a,236
ds_read2_b32 a[134:135], v40 offset0:162 offset1:163
v_lshlrev_b32 v236, 4, v1
MV 92,a,196,a,236
ds_read_b128 a[168:171], v5 offset:2688
v_add_u32 v237, 0x20000, v236
MV 92,a,192,a,240
ds_read2_b32 a[136:137], v41 offset0:32 offset1:33
v_add_u32 v238, s70, v236
MV 96,a,196,a,240
s_lshl_b32 s75, s80, 12
v_add_u32 v244, s75, v236
s_waitcnt lgkmcnt(15)
MV 96,a,192,a,244
ds_read2_b32 a[138:139], v41 offset0:34 offset1:35
v_xor_b32 v245, 0x1000, v244
MV 100,a,196,a,244
ds_read_b128 a[172:175], v5 offset:2176
v_add_u32 v242, 66560, v244
s_waitcnt lgkmcnt(15)
MV 100,a,192,a,248
ds_read2_b32 a[140:141], v41 offset0:160 offset1:161
v_add_u32 v243, 66560, v245
MV 104,a,196,a,248
ds_read2_b32 a[142:143], v41 offset0:162 offset1:163
v_bfe_u32 v50, v1, 4, 1
s_waitcnt lgkmcnt(14)
MV 104,a,192,a,252
v_lshrrev_b32 v52, 5, v1
v_and_b32 v48, 15, v1
MV 84,a,200,a,224
ds_read_b128 a[176:179], v5 offset:1664
v_lshlrev_b32 v53, 5, v50
MV 88,a,204,a,224
ds_read2_b32 a[144:145], v42 offset0:32 offset1:33
v_lshl_add_u32 v53, v52, 4, v53
MV 88,a,200,a,228
ds_read2_b32 a[146:147], v42 offset0:34 offset1:35
v_lshl_add_u32 v250, v48, 11, v53
MV 92,a,204,a,228
ds_read_b128 a[180:183], v5 offset:1152
v_lshlrev_b32 v53, 11, v53
MV 92,a,200,a,232
v_lshl_add_u32 v251, v48, 3, v53
MV 96,a,204,a,232
ds_read2_b32 a[148:149], v42 offset0:160 offset1:161
MV 96,a,200,a,236
ds_read2_b32 a[150:151], v42 offset0:162 offset1:163
MV 100,a,204,a,236
ds_read_b128 a[184:187], v5 offset:640
MV 100,a,200,a,240
ds_read2_b32 a[152:153], v43 offset0:32 offset1:33
MV 104,a,204,a,240
s_add_u32 s44, s40, 33554432
s_addc_u32 s45, s41, 0
MV 104,a,200,a,244
ds_read2_b32 a[154:155], v43 offset0:34 offset1:35
s_mov_b32 s46, 16777216
MV 92,a,208,a,224
ds_read_b128 a[188:191], v5 offset:128
s_mov_b32 s47, 0x20000
MV 96,a,212,a,224
ds_read2_b32 a[156:157], v43 offset0:160 offset1:161
MV 96,a,208,a,228
ds_read2_b32 a[158:159], v43 offset0:162 offset1:163
MV 100,a,212,a,228
s_add_u32 s48, s40, 100663296
s_addc_u32 s49, s41, 0
MV 100,a,208,a,232
s_mov_b32 s50, 8388608
s_mov_b32 s51, 0x20000
MV 104,a,212,a,232
s_add_u32 s52, s40, 109051904
s_addc_u32 s53, s41, 0
MV 104,a,208,a,236
s_mov_b32 s54, 4194304
s_mov_b32 s55, 0x20000
MV 100,a,216,a,224
s_add_u32 s56, s40, 54525952
s_addc_u32 s57, s41, 0
s_waitcnt lgkmcnt(15)
MV 104,a,220,a,224
s_mov_b32 s58, 4194304
s_mov_b32 s59, 0x20000
MV 104,a,216,a,228
s_mov_b32 s60, s88
s_mov_b32 s61, s89
s_mov_b32 s62, 4194304
s_mov_b32 s63, 0x20000
s_lshr_b32 s36, s82, 1
s_lshl_b32 s37, s80, 7
s_add_u32 s36, s36, s37
v_lshl_add_u32 v254, v1, 3, s36
s_xor_b32 s36, s2, 4
v_mov_b32 v253, s36
v_cmp_lt_u32 vcc, 15, v1
s_nop 1
v_cndmask_b32 v254, v254, v253, vcc
v_lshlrev_b32 v254, 2, v254
buffer_load_dword v253, v254, s[8:11], 0 offen offset:1024 sc1
MV 76,a,128,a,160
ds_read_b128 a[224:227], v5 offset:3776
s_sub_u32 s36, 15, s81
MV 80,a,132,a,160
ds_read2_b32 a[192:193], v40 offset0:48 offset1:49
s_min_u32 s36, s36, s81
MV 80,a,128,a,164
ds_read2_b32 a[194:195], v40 offset0:50 offset1:51
MV 84,a,132,a,164
ds_read_b128 a[228:231], v5 offset:3264
s_lshr_b32 s37, s36, 1
MV 84,a,128,a,168
MV 88,a,132,a,168
ds_read2_b32 a[196:197], v40 offset0:176 offset1:177
s_xor_b32 s36, s36, s37
s_waitcnt lgkmcnt(15)
MV 88,a,128,a,172
ds_read2_b32 a[198:199], v40 offset0:178 offset1:179
s_and_b32 s36, s36, 1
MV 92,a,132,a,172
ds_read_b128 a[232:235], v5 offset:2752
MV 92,a,128,a,176
ds_read2_b32 a[200:201], v41 offset0:48 offset1:49
s_lshl_b32 s37, s37, 6
MV 96,a,132,a,176
s_waitcnt lgkmcnt(15)
MV 96,a,128,a,180
ds_read2_b32 a[202:203], v41 offset0:50 offset1:51
s_add_u32 s36, s36, s37
MV 100,a,132,a,180
ds_read_b128 a[236:239], v5 offset:2240
s_lshl_b32 s37, s80, 2
s_waitcnt lgkmcnt(15)
MV 100,a,128,a,184
ds_read2_b32 a[204:205], v41 offset0:176 offset1:177
MV 104,a,132,a,184
ds_read2_b32 a[206:207], v41 offset0:178 offset1:179
s_add_u32 s36, s36, s37
s_waitcnt lgkmcnt(14)
MV 104,a,128,a,188
MV 84,a,136,a,160
ds_read_b128 a[240:243], v5 offset:1728
s_add_u32 s36, s36, 1024
MV 88,a,140,a,160
ds_read2_b32 a[208:209], v42 offset0:48 offset1:49
v_bfe_u32 v228, v1, 4, 1
MV 88,a,136,a,164
ds_read2_b32 a[210:211], v42 offset0:50 offset1:51
MV 92,a,140,a,164
ds_read_b128 a[244:247], v5 offset:1216
v_lshl_add_u32 v228, s3, 1, v228
MV 92,a,136,a,168
MV 96,a,140,a,168
ds_read2_b32 a[212:213], v42 offset0:176 offset1:177
v_sub_u32 v229, 7, v228
MV 96,a,136,a,172
ds_read2_b32 a[214:215], v42 offset0:178 offset1:179
v_min_u32 v228, v228, v229
MV 100,a,140,a,172
ds_read_b128 a[248:251], v5 offset:704
MV 100,a,136,a,176
ds_read2_b32 a[216:217], v43 offset0:48 offset1:49
v_lshl_add_u32 v229, v228, 8, s36
MV 104,a,140,a,176
MV 104,a,136,a,180
ds_read2_b32 a[218:219], v43 offset0:50 offset1:51
v_and_b32 v252, 7, v1
MV 92,a,144,a,160
ds_read_b128 a[252:255], v5 offset:192
v_lshlrev_b32 v252, 3, v252
MV 96,a,148,a,160
ds_read2_b32 a[220:221], v43 offset0:176 offset1:177
MV 96,a,144,a,164
ds_read2_b32 a[222:223], v43 offset0:178 offset1:179
v_bfe_u32 v228, v1, 3, 1
MV 100,a,148,a,164
MV 100,a,144,a,168
v_lshlrev_b32 v228, 1, v228
MV 104,a,148,a,168
v_add3_u32 v252, v252, v228, v229
MV 104,a,144,a,172
MV 100,a,152,a,160
v_lshlrev_b32 v252, 2, v252
s_waitcnt lgkmcnt(15)
MV 104,a,156,a,160
MV 104,a,152,a,164
s_waitcnt vmcnt(0)
v_cmp_gt_u32 vcc, 1, v253
s_nop 4
s_cbranch_vccnz L_spin_w
L_spin_w_ret:
MV 76,a,192,a,224
ds_read_b128 a[160:163], v5 offset:3840
s_add_u32 m0, s70, 66560
MV 80,a,196,a,224
ds_read2_b32 a[128:129], v40 offset0:64 offset1:65
v_lshlrev_b32 v255, 20, v1
MV 80,a,192,a,228
ds_read2_b32 a[130:131], v40 offset0:66 offset1:67
buffer_load_dwordx4 v238, s[48:51], s69 offen offset:0 sc1 lds
MV 84,a,196,a,228
ds_read_b128 a[164:167], v5 offset:3328
MV 84,a,192,a,232
MV 88,a,196,a,232
ds_read2_b32 a[132:133], v40 offset0:192 offset1:193
buffer_load_dwordx4 v238, s[48:51], s69 offen offset:1024 sc1 lds
s_waitcnt lgkmcnt(15)
MV 88,a,192,a,236
ds_read2_b32 a[134:135], v40 offset0:194 offset1:195
MV 92,a,196,a,236
ds_read_b128 a[168:171], v5 offset:2816
MV 92,a,192,a,240
ds_read2_b32 a[136:137], v41 offset0:64 offset1:65
buffer_load_dwordx4 v238, s[48:51], s69 offen offset:2048 sc1 lds
MV 96,a,196,a,240
s_waitcnt lgkmcnt(15)
MV 96,a,192,a,244
ds_read2_b32 a[138:139], v41 offset0:66 offset1:67
MV 100,a,196,a,244
ds_read_b128 a[172:175], v5 offset:2304
buffer_load_dwordx4 v238, s[48:51], s69 offen offset:3072 sc1 lds
s_waitcnt lgkmcnt(15)
MV 100,a,192,a,248
ds_read2_b32 a[140:141], v41 offset0:192 offset1:193
s_lshl_b32 s36, s3, 26
MV 104,a,196,a,248
ds_read2_b32 a[142:143], v41 offset0:194 offset1:195
s_waitcnt lgkmcnt(14)
MV 104,a,192,a,252
s_add_u32 s69, s69, 16384
MV 84,a,200,a,224
ds_read_b128 a[176:179], v5 offset:1792
MV 88,a,204,a,224
ds_read2_b32 a[144:145], v42 offset0:64 offset1:65
MV 88,a,200,a,228
ds_read2_b32 a[146:147], v42 offset0:66 offset1:67
s_add_u32 m0, s70, 82944
MV 92,a,204,a,228
ds_read_b128 a[180:183], v5 offset:1280
MV 92,a,200,a,232
MV 96,a,204,a,232
ds_read2_b32 a[148:149], v42 offset0:192 offset1:193
buffer_load_dwordx4 v238, s[48:51], s69 offen offset:0 sc1 lds
MV 96,a,200,a,236
ds_read2_b32 a[150:151], v42 offset0:194 offset1:195
MV 100,a,204,a,236
ds_read_b128 a[184:187], v5 offset:768
MV 100,a,200,a,240
ds_read2_b32 a[152:153], v43 offset0:64 offset1:65
buffer_load_dwordx4 v238, s[48:51], s69 offen offset:1024 sc1 lds
MV 104,a,204,a,240
v_add_u32 v255, s36, v255
MV 104,a,200,a,244
ds_read2_b32 a[154:155], v43 offset0:66 offset1:67
MV 92,a,208,a,224
ds_read_b128 a[188:191], v5 offset:256
buffer_load_dwordx4 v238, s[48:51], s69 offen offset:2048 sc1 lds
MV 96,a,212,a,224
ds_read2_b32 a[156:157], v43 offset0:192 offset1:193
MV 96,a,208,a,228
ds_read2_b32 a[158:159], v43 offset0:194 offset1:195
MV 100,a,212,a,228
buffer_load_dwordx4 v238, s[48:51], s69 offen offset:3072 sc1 lds
MV 100,a,208,a,232
MV 104,a,212,a,232
MV 104,a,208,a,236
s_add_u32 s69, s69, 16384
MV 100,a,216,a,224
s_waitcnt lgkmcnt(15)
MV 104,a,220,a,224
MV 104,a,216,a,228
MV 76,a,128,a,160
ds_read_b128 a[224:227], v5 offset:3904
s_add_u32 m0, s70, 99328
MV 80,a,132,a,160
ds_read2_b32 a[192:193], v40 offset0:80 offset1:81
v_mul_u32_u24 v18, 136, v16
MV 80,a,128,a,164
ds_read2_b32 a[194:195], v40 offset0:82 offset1:83
v_lshl_add_u32 v18, v17, 5, v18
MV 84,a,132,a,164
ds_read_b128 a[228:231], v5 offset:3392
MV 84,a,128,a,168
MV 88,a,132,a,168
ds_read2_b32 a[196:197], v40 offset0:208 offset1:209
buffer_load_dwordx4 v238, s[48:51], s69 offen offset:0 sc1 lds
s_waitcnt lgkmcnt(15)
MV 88,a,128,a,172
ds_read2_b32 a[198:199], v40 offset0:210 offset1:211
s_lshl_b32 s37, s3, 1
MV 92,a,132,a,172
ds_read_b128 a[232:235], v5 offset:2880
s_add_u32 s37, s37, 49152
MV 92,a,128,a,176
ds_read2_b32 a[200:201], v41 offset0:80 offset1:81
MV 96,a,132,a,176
s_waitcnt lgkmcnt(15)
MV 96,a,128,a,180
ds_read2_b32 a[202:203], v41 offset0:82 offset1:83
v_add_u32 v11, s37, v18
MV 100,a,132,a,180
ds_read_b128 a[236:239], v5 offset:2368
buffer_load_dwordx4 v238, s[48:51], s69 offen offset:1024 sc1 lds
s_waitcnt lgkmcnt(15)
MV 100,a,128,a,184
ds_read2_b32 a[204:205], v41 offset0:208 offset1:209
v_lshrrev_b32 v18, 3, v1
MV 104,a,132,a,184
ds_read2_b32 a[206:207], v41 offset0:210 offset1:211
s_waitcnt lgkmcnt(14)
MV 104,a,128,a,188
MV 84,a,136,a,160
ds_read_b128 a[240:243], v5 offset:1856
v_mul_u32_u24 v18, 136, v18
MV 88,a,140,a,160
ds_read2_b32 a[208:209], v42 offset0:80 offset1:81
MV 88,a,136,a,164
ds_read2_b32 a[210:211], v42 offset0:82 offset1:83
buffer_load_dwordx4 v238, s[48:51], s69 offen offset:2048 sc1 lds
MV 92,a,140,a,164
ds_read_b128 a[244:247], v5 offset:1344
v_and_b32 v19, 7, v1
MV 92,a,136,a,168
MV 96,a,140,a,168
ds_read2_b32 a[212:213], v42 offset0:208 offset1:209
v_lshl_add_u32 v18, v19, 4, v18
MV 96,a,136,a,172
ds_read2_b32 a[214:215], v42 offset0:210 offset1:211
MV 100,a,140,a,172
ds_read_b128 a[248:251], v5 offset:832
s_mul_i32 s37, s3, 4352
MV 100,a,136,a,176
ds_read2_b32 a[216:217], v43 offset0:80 offset1:81
buffer_load_dwordx4 v238, s[48:51], s69 offen offset:3072 sc1 lds
MV 104,a,140,a,176
MV 104,a,136,a,180
ds_read2_b32 a[218:219], v43 offset0:82 offset1:83
s_add_u32 s37, s37, 49152
MV 92,a,144,a,160
ds_read_b128 a[252:255], v5 offset:320
MV 96,a,148,a,160
ds_read2_b32 a[220:221], v43 offset0:208 offset1:209
v_add_u32 v12, s37, v18
MV 96,a,144,a,164
ds_read2_b32 a[222:223], v43 offset0:210 offset1:211
MV 100,a,148,a,164
s_add_u32 s69, s69, 16384
MV 100,a,144,a,168
s_lshl_b32 s37, s3, 12
MV 104,a,148,a,168
MV 104,a,144,a,172
v_add_u32 v13, s37, v232
MV 100,a,152,a,160
s_waitcnt lgkmcnt(15)
MV 104,a,156,a,160
MV 104,a,152,a,164
buffer_load_dword v253, v252, s[8:11], 0 offen sc1
MV 76,a,192,a,224
ds_read_b128 a[160:163], v5 offset:3968
MV 80,a,196,a,224
ds_read2_b32 a[128:129], v40 offset0:96 offset1:97
MV 80,a,192,a,228
ds_read2_b32 a[130:131], v40 offset0:98 offset1:99
MV 84,a,196,a,228
ds_read_b128 a[164:167], v5 offset:3456
MV 84,a,192,a,232
MV 88,a,196,a,232
ds_read2_b32 a[132:133], v40 offset0:224 offset1:225
s_waitcnt lgkmcnt(15)
MV 88,a,192,a,236
ds_read2_b32 a[134:135], v40 offset0:226 offset1:227
MV 92,a,196,a,236
ds_read_b128 a[168:171], v5 offset:2944
MV 92,a,192,a,240
ds_read2_b32 a[136:137], v41 offset0:96 offset1:97
MV 96,a,196,a,240
s_waitcnt lgkmcnt(15)
MV 96,a,192,a,244
ds_read2_b32 a[138:139], v41 offset0:98 offset1:99
MV 100,a,196,a,244
ds_read_b128 a[172:175], v5 offset:2432
s_waitcnt lgkmcnt(15)
MV 100,a,192,a,248
ds_read2_b32 a[140:141], v41 offset0:224 offset1:225
MV 104,a,196,a,248
ds_read2_b32 a[142:143], v41 offset0:226 offset1:227
s_waitcnt lgkmcnt(14)
MV 104,a,192,a,252
MV 84,a,200,a,224
ds_read_b128 a[176:179], v5 offset:1920
MV 88,a,204,a,224
ds_read2_b32 a[144:145], v42 offset0:96 offset1:97
MV 88,a,200,a,228
ds_read2_b32 a[146:147], v42 offset0:98 offset1:99
MV 92,a,204,a,228
ds_read_b128 a[180:183], v5 offset:1408
MV 92,a,200,a,232
MV 96,a,204,a,232
ds_read2_b32 a[148:149], v42 offset0:224 offset1:225
MV 96,a,200,a,236
ds_read2_b32 a[150:151], v42 offset0:226 offset1:227
MV 100,a,204,a,236
ds_read_b128 a[184:187], v5 offset:896
MV 100,a,200,a,240
ds_read2_b32 a[152:153], v43 offset0:96 offset1:97
MV 104,a,204,a,240
MV 104,a,200,a,244
ds_read2_b32 a[154:155], v43 offset0:98 offset1:99
MV 92,a,208,a,224
ds_read_b128 a[188:191], v5 offset:384
MV 96,a,212,a,224
ds_read2_b32 a[156:157], v43 offset0:224 offset1:225
MV 96,a,208,a,228
ds_read2_b32 a[158:159], v43 offset0:226 offset1:227
MV 100,a,212,a,228
MV 100,a,208,a,232
MV 104,a,212,a,232
MV 104,a,208,a,236
MV 100,a,216,a,224
s_waitcnt lgkmcnt(15)
MV 104,a,220,a,224
MV 104,a,216,a,228
s_waitcnt vmcnt(0)
v_cmp_gt_u32 vcc, 1, v253
s_nop 4
s_cbranch_vccnz L_spin_f2
L_spin_f2_ret:
buffer_load_dwordx4 a[0:3], v236, s[44:47], s68 offen offset:0 sc1
buffer_load_dwordx4 a[4:7], v237, s[44:47], s68 offen offset:0 sc1
buffer_load_dwordx4 a[8:11], v236, s[44:47], s68 offen offset:1024 sc1
buffer_load_dwordx4 a[12:15], v237, s[44:47], s68 offen offset:1024 sc1
s_add_u32 s68, s68, 2048
MV 76,a,128,a,160
ds_read_b128 a[224:227], v5 offset:4032
buffer_load_dwordx4 a[16:19], v236, s[44:47], s68 offen offset:0 sc1
MV 80,a,132,a,160
ds_read2_b32 a[192:193], v40 offset0:112 offset1:113
MV 80,a,128,a,164
ds_read2_b32 a[194:195], v40 offset0:114 offset1:115
buffer_load_dwordx4 a[20:23], v237, s[44:47], s68 offen offset:0 sc1
MV 84,a,132,a,164
ds_read_b128 a[228:231], v5 offset:3520
MV 84,a,128,a,168
buffer_load_dwordx4 a[24:27], v236, s[44:47], s68 offen offset:1024 sc1
MV 88,a,132,a,168
ds_read2_b32 a[196:197], v40 offset0:240 offset1:241
s_waitcnt lgkmcnt(15)
MV 88,a,128,a,172
ds_read2_b32 a[198:199], v40 offset0:242 offset1:243
MV 92,a,132,a,172
ds_read_b128 a[232:235], v5 offset:3008
buffer_load_dwordx4 a[28:31], v237, s[44:47], s68 offen offset:1024 sc1
MV 92,a,128,a,176
ds_read2_b32 a[200:201], v41 offset0:112 offset1:113
MV 96,a,132,a,176
s_add_u32 s68, s68, 2048
s_waitcnt lgkmcnt(15)
MV 96,a,128,a,180
ds_read2_b32 a[202:203], v41 offset0:114 offset1:115
MV 100,a,132,a,180
ds_read_b128 a[236:239], v5 offset:2496
buffer_load_dwordx4 a[32:35], v236, s[44:47], s68 offen offset:0 sc1
s_waitcnt lgkmcnt(15)
MV 100,a,128,a,184
ds_read2_b32 a[204:205], v41 offset0:240 offset1:241
MV 104,a,132,a,184
ds_read2_b32 a[206:207], v41 offset0:242 offset1:243
s_waitcnt lgkmcnt(14)
MV 104,a,128,a,188
buffer_load_dwordx4 a[36:39], v237, s[44:47], s68 offen offset:0 sc1
MV 84,a,136,a,160
ds_read_b128 a[240:243], v5 offset:1984
MV 88,a,140,a,160
ds_read2_b32 a[208:209], v42 offset0:112 offset1:113
buffer_load_dwordx4 a[40:43], v236, s[44:47], s68 offen offset:1024 sc1
MV 88,a,136,a,164
ds_read2_b32 a[210:211], v42 offset0:114 offset1:115
MV 92,a,140,a,164
ds_read_b128 a[244:247], v5 offset:1472
buffer_load_dwordx4 a[44:47], v237, s[44:47], s68 offen offset:1024 sc1
MV 92,a,136,a,168
MV 96,a,140,a,168
ds_read2_b32 a[212:213], v42 offset0:240 offset1:241
MV 96,a,136,a,172
ds_read2_b32 a[214:215], v42 offset0:242 offset1:243
s_add_u32 s68, s68, 2048
MV 100,a,140,a,172
ds_read_b128 a[248:251], v5 offset:960
MV 100,a,136,a,176
ds_read2_b32 a[216:217], v43 offset0:112 offset1:113
buffer_load_dwordx4 a[48:51], v236, s[44:47], s68 offen offset:0 sc1
MV 104,a,140,a,176
MV 104,a,136,a,180
ds_read2_b32 a[218:219], v43 offset0:114 offset1:115
buffer_load_dwordx4 a[52:55], v237, s[44:47], s68 offen offset:0 sc1
MV 92,a,144,a,160
ds_read_b128 a[252:255], v5 offset:448
MV 96,a,148,a,160
ds_read2_b32 a[220:221], v43 offset0:240 offset1:241
MV 96,a,144,a,164
ds_read2_b32 a[222:223], v43 offset0:242 offset1:243
buffer_load_dwordx4 a[56:59], v236, s[44:47], s68 offen offset:1024 sc1
MV 100,a,148,a,164
MV 100,a,144,a,168
buffer_load_dwordx4 a[60:63], v237, s[44:47], s68 offen offset:1024 sc1
MV 104,a,148,a,168
MV 104,a,144,a,172
s_add_u32 s68, s68, 2048
MV 100,a,152,a,160
s_waitcnt lgkmcnt(15)
MV 104,a,156,a,160
MV 104,a,152,a,164
s_waitcnt lgkmcnt(0)
s_barrier
ds_read_b128 a[64:67], v242 offset:0
ds_read_b128 a[68:71], v242 offset:1024
ds_read_b128 a[72:75], v242 offset:2048
ds_read_b128 a[76:79], v242 offset:3072
ds_read_b128 a[80:83], v243 offset:0
ds_read_b128 a[84:87], v243 offset:1024
ds_read_b128 a[88:91], v243 offset:2048
ds_read_b128 a[92:95], v243 offset:3072
s_waitcnt lgkmcnt(0)
s_waitcnt vmcnt(15)
v_mfma_f32_16x16x32_bf16 v[124:127], a[64:67], a[0:3], 0
ds_read_b128 a[96:99], v242 offset:8192
MV 76,a,192,a,224
s_add_u32 m0, s70, 115712
s_waitcnt vmcnt(14)
v_mfma_f32_16x16x32_bf16 v[128:131], a[64:67], a[4:7], 0
ds_read_b128 a[100:103], v242 offset:9216
MV 80,a,196,a,224
v_mfma_f32_16x16x32_bf16 v[132:135], a[68:71], a[0:3], 0
MV 80,a,192,a,228
ds_read_b128 a[104:107], v242 offset:10240
v_mfma_f32_16x16x32_bf16 v[136:139], a[68:71], a[4:7], 0
v_mfma_f32_16x16x32_bf16 v[140:143], a[72:75], a[0:3], 0
ds_read_b128 a[108:111], v242 offset:11264
MV 84,a,196,a,228
v_mfma_f32_16x16x32_bf16 v[144:147], a[72:75], a[4:7], 0
buffer_load_dwordx4 v238, s[48:51], s69 offen offset:0 sc1 lds
MV 84,a,192,a,232
ds_read_b128 a[112:115], v243 offset:8192
v_mfma_f32_16x16x32_bf16 v[148:151], a[76:79], a[0:3], 0
MV 88,a,196,a,232
v_mfma_f32_16x16x32_bf16 v[152:155], a[76:79], a[4:7], 0
ds_read_b128 a[116:119], v243 offset:9216
v_mfma_f32_16x16x32_bf16 v[156:159], a[80:83], a[0:3], 0
MV 88,a,192,a,236
ds_read_b128 a[120:123], v243 offset:10240
v_mfma_f32_16x16x32_bf16 v[160:163], a[80:83], a[4:7], 0
MV 92,a,196,a,236
buffer_load_dwordx4 v238, s[48:51], s69 offen offset:1024 sc1 lds
v_mfma_f32_16x16x32_bf16 v[164:167], a[84:87], a[0:3], 0
ds_read_b128 a[124:127], v243 offset:11264
MV 92,a,192,a,240
v_mfma_f32_16x16x32_bf16 v[168:171], a[84:87], a[4:7], 0
v_mfma_f32_16x16x32_bf16 v[172:175], a[88:91], a[0:3], 0
MV 96,a,196,a,240
v_mfma_f32_16x16x32_bf16 v[176:179], a[88:91], a[4:7], 0
MV 96,a,192,a,244
v_mfma_f32_16x16x32_bf16 v[180:183], a[92:95], a[0:3], 0
buffer_load_dwordx4 a[0:3], v236, s[44:47], s68 offen offset:0 sc1
MV 100,a,196,a,244
v_mfma_f32_16x16x32_bf16 v[184:187], a[92:95], a[4:7], 0
buffer_load_dwordx4 a[4:7], v237, s[44:47], s68 offen offset:0 sc1
s_waitcnt lgkmcnt(0)
s_barrier
s_waitcnt vmcnt(17)
MV 124,a,96,a,8
ds_read_b128 a[64:67], v242 offset:16384
MV 100,a,192,a,248
buffer_load_dwordx4 v238, s[48:51], s69 offen offset:2048 sc1 lds
s_waitcnt vmcnt(17)
MV 128,a,96,a,12
ds_read_b128 a[68:71], v242 offset:17408
MV 104,a,196,a,248
MV 132,a,100,a,8
MV 104,a,192,a,252
ds_read_b128 a[72:75], v242 offset:18432
MV 136,a,100,a,12
MV 140,a,104,a,8
ds_read_b128 a[76:79], v242 offset:19456
MV 84,a,200,a,224
MV 144,a,104,a,12
buffer_load_dwordx4 v238, s[48:51], s69 offen offset:3072 sc1 lds
MV 88,a,204,a,224
ds_read_b128 a[80:83], v243 offset:16384
MV 148,a,108,a,8
MV 88,a,200,a,228
MV 152,a,108,a,12
ds_read_b128 a[84:87], v243 offset:17408
MV 156,a,112,a,8
MV 92,a,204,a,228
ds_read_b128 a[88:91], v243 offset:18432
MV 160,a,112,a,12
MV 92,a,200,a,232
s_add_u32 s69, s69, 16384
MV 164,a,116,a,8
ds_read_b128 a[92:95], v243 offset:19456
MV 96,a,204,a,232
MV 168,a,116,a,12
MV 172,a,120,a,8
MV 96,a,200,a,236
MV 176,a,120,a,12
MV 100,a,204,a,236
MV 180,a,124,a,8
buffer_load_dwordx4 a[8:11], v236, s[44:47], s68 offen offset:1024 sc1
MV 100,a,200,a,240
MV 184,a,124,a,12
buffer_load_dwordx4 a[12:15], v237, s[44:47], s68 offen offset:1024 sc1
s_add_u32 s68, s68, 2048
s_waitcnt lgkmcnt(0)
s_waitcnt vmcnt(19)
MV 124,a,64,a,16
ds_read_b128 a[96:99], v242 offset:24576
MV 104,a,204,a,240
s_add_u32 m0, s70, 66560
s_waitcnt vmcnt(18)
MV 128,a,64,a,20
ds_read_b128 a[100:103], v242 offset:25600
MV 104,a,200,a,244
MV 132,a,68,a,16
MV 92,a,208,a,224
ds_read_b128 a[104:107], v242 offset:26624
MV 136,a,68,a,20
MV 140,a,72,a,16
ds_read_b128 a[108:111], v242 offset:27648
MV 96,a,212,a,224
MV 144,a,72,a,20
buffer_load_dwordx4 v238, s[48:51], s69 offen offset:0 sc1 lds
MV 96,a,208,a,228
ds_read_b128 a[112:115], v243 offset:24576
MV 148,a,76,a,16
MV 100,a,212,a,228
MV 152,a,76,a,20
ds_read_b128 a[116:119], v243 offset:25600
MV 156,a,80,a,16
MV 100,a,208,a,232
ds_read_b128 a[120:123], v243 offset:26624
MV 160,a,80,a,20
MV 104,a,212,a,232
buffer_load_dwordx4 v238, s[48:51], s69 offen offset:1024 sc1 lds
MV 164,a,84,a,16
ds_read_b128 a[124:127], v243 offset:27648
MV 104,a,208,a,236
MV 168,a,84,a,20
MV 172,a,88,a,16
MV 100,a,216,a,224
MV 176,a,88,a,20
MV 104,a,220,a,224
MV 180,a,92,a,16
buffer_load_dwordx4 a[16:19], v236, s[44:47], s68 offen offset:0 sc1
MV 104,a,216,a,228
MV 184,a,92,a,20
buffer_load_dwordx4 a[20:23], v237, s[44:47], s68 offen offset:0 sc1
s_waitcnt lgkmcnt(0)
s_barrier
s_waitcnt vmcnt(21)
MV 124,a,96,a,24
ds_read_b128 a[64:67], v242 offset:32768
s_waitcnt vmcnt(20)
MV 128,a,96,a,28
ds_read_b128 a[68:71], v242 offset:33792
buffer_load_dwordx4 v238, s[48:51], s69 offen offset:2048 sc1 lds
MV 132,a,100,a,24
MV 136,a,100,a,28
ds_read_b128 a[72:75], v242 offset:34816
MV 140,a,104,a,24
ds_read_b128 a[76:79], v242 offset:35840
MV 144,a,104,a,28
buffer_load_dwordx4 v238, s[48:51], s69 offen offset:3072 sc1 lds
MV 148,a,108,a,24
ds_read_b128 a[80:83], v243 offset:32768
MV 152,a,108,a,28
ds_read_b128 a[84:87], v243 offset:33792
MV 156,a,112,a,24
MV 160,a,112,a,28
ds_read_b128 a[88:91], v243 offset:34816
s_add_u32 s69, s69, 16384
MV 164,a,116,a,24
ds_read_b128 a[92:95], v243 offset:35840
MV 168,a,116,a,28
MV 172,a,120,a,24
MV 176,a,120,a,28
MV 180,a,124,a,24
buffer_load_dwordx4 a[24:27], v236, s[44:47], s68 offen offset:1024 sc1
MV 184,a,124,a,28
buffer_load_dwordx4 a[28:31], v237, s[44:47], s68 offen offset:1024 sc1
s_add_u32 s68, s68, 2048
s_waitcnt lgkmcnt(0)
s_waitcnt vmcnt(23)
MV 124,a,64,a,32
ds_read_b128 a[96:99], v242 offset:40960
v_cvt_pk_bf16_f32 v16, v76, v77
s_waitcnt vmcnt(22)
MV 128,a,64,a,36
ds_read_b128 a[100:103], v242 offset:41984
s_add_u32 m0, s70, 82944
MV 132,a,68,a,32
v_cvt_pk_bf16_f32 v17, v78, v79
MV 136,a,68,a,36
ds_read_b128 a[104:107], v242 offset:43008
ds_write_b16 v11, v16 offset:0
MV 140,a,72,a,32
ds_read_b128 a[108:111], v242 offset:44032
MV 144,a,72,a,36
buffer_load_dwordx4 v238, s[48:51], s69 offen offset:0 sc1 lds
ds_write_b16_d16_hi v11, v16 offset:8
MV 148,a,76,a,32
ds_read_b128 a[112:115], v243 offset:40960
MV 152,a,76,a,36
ds_read_b128 a[116:119], v243 offset:41984
ds_write_b16 v11, v17 offset:16
MV 156,a,80,a,32
ds_write_b16_d16_hi v11, v17 offset:24
MV 160,a,80,a,36
ds_read_b128 a[120:123], v243 offset:43008
buffer_load_dwordx4 v238, s[48:51], s69 offen offset:1024 sc1 lds
MV 164,a,84,a,32
ds_read_b128 a[124:127], v243 offset:44032
v_cvt_pk_bf16_f32 v18, v80, v81
MV 168,a,84,a,36
MV 172,a,88,a,32
v_cvt_pk_bf16_f32 v19, v82, v83
MV 176,a,88,a,36
MV 180,a,92,a,32
buffer_load_dwordx4 a[32:35], v236, s[44:47], s68 offen offset:0 sc1
ds_write_b16 v11, v18 offset:2176
MV 184,a,92,a,36
buffer_load_dwordx4 a[36:39], v237, s[44:47], s68 offen offset:0 sc1
s_waitcnt vmcnt(14) lgkmcnt(0)
s_barrier
MV 124,a,96,a,40
ds_read_b128 a[64:67], v242 offset:49152
ds_write_b16_d16_hi v11, v18 offset:2184
MV 128,a,96,a,44
ds_read_b128 a[68:71], v242 offset:50176
buffer_load_dwordx4 v238, s[48:51], s69 offen offset:2048 sc1 lds
MV 132,a,100,a,40
ds_write_b16 v11, v19 offset:2192
MV 136,a,100,a,44
ds_read_b128 a[72:75], v242 offset:51200
ds_write_b16_d16_hi v11, v19 offset:2200
MV 140,a,104,a,40
ds_read_b128 a[76:79], v242 offset:52224
v_cvt_pk_bf16_f32 v16, v84, v85
MV 144,a,104,a,44
buffer_load_dwordx4 v238, s[48:51], s69 offen offset:3072 sc1 lds
MV 148,a,108,a,40
ds_read_b128 a[80:83], v243 offset:49152
v_cvt_pk_bf16_f32 v17, v86, v87
MV 152,a,108,a,44
ds_read_b128 a[84:87], v243 offset:50176
MV 156,a,112,a,40
ds_write_b16 v11, v16 offset:4352
MV 160,a,112,a,44
ds_read_b128 a[88:91], v243 offset:51200
s_add_u32 s69, s69, 16384
MV 164,a,116,a,40
ds_read_b128 a[92:95], v243 offset:52224
ds_write_b16_d16_hi v11, v16 offset:4360
MV 168,a,116,a,44
ds_write_b16 v11, v17 offset:4368
MV 172,a,120,a,40
ds_write_b16_d16_hi v11, v17 offset:4376
MV 176,a,120,a,44
MV 180,a,124,a,40
buffer_load_dwordx4 a[40:43], v236, s[44:47], s68 offen offset:1024 sc1
v_cvt_pk_bf16_f32 v18, v88, v89
MV 184,a,124,a,44
buffer_load_dwordx4 a[44:47], v237, s[44:47], s68 offen offset:1024 sc1
s_add_u32 s68, s68, 2048
s_waitcnt lgkmcnt(0)
MV 124,a,64,a,48
ds_read_b128 a[96:99], v242 offset:57344
v_cvt_pk_bf16_f32 v19, v90, v91
MV 128,a,64,a,52
ds_read_b128 a[100:103], v242 offset:58368
s_add_u32 m0, s70, 99328
MV 132,a,68,a,48
ds_write_b16 v11, v18 offset:6528
MV 136,a,68,a,52
ds_read_b128 a[104:107], v242 offset:59392
ds_write_b16_d16_hi v11, v18 offset:6536
MV 140,a,72,a,48
ds_read_b128 a[108:111], v242 offset:60416
MV 144,a,72,a,52
buffer_load_dwordx4 v238, s[48:51], s69 offen offset:0 sc1 lds
ds_write_b16 v11, v19 offset:6544
MV 148,a,76,a,48
ds_read_b128 a[112:115], v243 offset:57344
MV 152,a,76,a,52
ds_read_b128 a[116:119], v243 offset:58368
ds_write_b16_d16_hi v11, v19 offset:6552
MV 156,a,80,a,48
v_cvt_pk_bf16_f32 v16, v92, v93
MV 160,a,80,a,52
ds_read_b128 a[120:123], v243 offset:59392
buffer_load_dwordx4 v238, s[48:51], s69 offen offset:1024 sc1 lds
MV 164,a,84,a,48
ds_read_b128 a[124:127], v243 offset:60416
v_cvt_pk_bf16_f32 v17, v94, v95
MV 168,a,84,a,52
MV 172,a,88,a,48
ds_write_b16 v11, v16 offset:8704
MV 176,a,88,a,52
MV 180,a,92,a,48
buffer_load_dwordx4 a[48:51], v236, s[44:47], s68 offen offset:0 sc1
ds_write_b16_d16_hi v11, v16 offset:8712
MV 184,a,92,a,52
buffer_load_dwordx4 a[52:55], v237, s[44:47], s68 offen offset:0 sc1
s_waitcnt vmcnt(14) lgkmcnt(0)
s_barrier
MV 124,a,96,a,56
ds_read_b128 a[64:67], v242 offset:0
ds_write_b16 v11, v17 offset:8720
MV 128,a,96,a,60
ds_read_b128 a[68:71], v242 offset:1024
buffer_load_dwordx4 v238, s[48:51], s69 offen offset:2048 sc1 lds
MV 132,a,100,a,56
ds_write_b16_d16_hi v11, v17 offset:8728
MV 136,a,100,a,60
ds_read_b128 a[72:75], v242 offset:2048
v_cvt_pk_bf16_f32 v18, v96, v97
MV 140,a,104,a,56
ds_read_b128 a[76:79], v242 offset:3072
v_cvt_pk_bf16_f32 v19, v98, v99
MV 144,a,104,a,60
buffer_load_dwordx4 v238, s[48:51], s69 offen offset:3072 sc1 lds
MV 148,a,108,a,56
ds_read_b128 a[80:83], v243 offset:0
ds_write_b16 v11, v18 offset:10880
MV 152,a,108,a,60
ds_read_b128 a[84:87], v243 offset:1024
MV 156,a,112,a,56
ds_write_b16_d16_hi v11, v18 offset:10888
MV 160,a,112,a,60
ds_read_b128 a[88:91], v243 offset:2048
s_add_u32 s69, s69, 16384
MV 164,a,116,a,56
ds_read_b128 a[92:95], v243 offset:3072
ds_write_b16 v11, v19 offset:10896
MV 168,a,116,a,60
ds_write_b16_d16_hi v11, v19 offset:10904
MV 172,a,120,a,56
v_cvt_pk_bf16_f32 v16, v100, v101
MV 176,a,120,a,60
MV 180,a,124,a,56
buffer_load_dwordx4 a[56:59], v236, s[44:47], s68 offen offset:1024 sc1
v_cvt_pk_bf16_f32 v17, v102, v103
MV 184,a,124,a,60
buffer_load_dwordx4 a[60:63], v237, s[44:47], s68 offen offset:1024 sc1
s_add_u32 s68, s68, 2048
s_waitcnt lgkmcnt(0)
MV 124,a,64,a,0
ds_read_b128 a[96:99], v242 offset:8192
ds_write_b16 v11, v16 offset:13056
MV 128,a,64,a,4
ds_read_b128 a[100:103], v242 offset:9216
s_add_u32 m0, s70, 115712
MV 132,a,68,a,0
ds_write_b16_d16_hi v11, v16 offset:13064
MV 136,a,68,a,4
ds_read_b128 a[104:107], v242 offset:10240
ds_write_b16 v11, v17 offset:13072
MV 140,a,72,a,0
ds_read_b128 a[108:111], v242 offset:11264
ds_write_b16_d16_hi v11, v17 offset:13080
MV 144,a,72,a,4
buffer_load_dwordx4 v238, s[48:51], s69 offen offset:0 sc1 lds
MV 148,a,76,a,0
ds_read_b128 a[112:115], v243 offset:8192
v_cvt_pk_bf16_f32 v18, v104, v105
MV 152,a,76,a,4
ds_read_b128 a[116:119], v243 offset:9216
MV 156,a,80,a,0
v_cvt_pk_bf16_f32 v19, v106, v107
MV 160,a,80,a,4
ds_read_b128 a[120:123], v243 offset:10240
buffer_load_dwordx4 v238, s[48:51], s69 offen offset:1024 sc1 lds
MV 164,a,84,a,0
ds_read_b128 a[124:127], v243 offset:11264
ds_write_b16 v11, v18 offset:15232
MV 168,a,84,a,4
ds_write_b16_d16_hi v11, v18 offset:15240
MV 172,a,88,a,0
ds_write_b16 v11, v19 offset:15248
MV 176,a,88,a,4
MV 180,a,92,a,0
buffer_load_dwordx4 a[0:3], v236, s[44:47], s68 offen offset:0 sc1
ds_write_b16_d16_hi v11, v19 offset:15256
MV 184,a,92,a,4
buffer_load_dwordx4 a[4:7], v237, s[44:47], s68 offen offset:0 sc1
s_waitcnt vmcnt(14) lgkmcnt(0)
s_barrier
MV 124,a,96,a,8
ds_read_b128 a[64:67], v242 offset:16384
ds_read_b64 v[108:109], v12 offset:0
MV 128,a,96,a,12
ds_read_b128 a[68:71], v242 offset:17408
buffer_load_dwordx4 v238, s[48:51], s69 offen offset:2048 sc1 lds
MV 132,a,100,a,8
ds_read_b64 v[110:111], v12 offset:8
MV 136,a,100,a,12
ds_read_b128 a[72:75], v242 offset:18432
MV 140,a,104,a,8
ds_read_b128 a[76:79], v242 offset:19456
ds_read_b64 v[112:113], v12 offset:1088
MV 144,a,104,a,12
buffer_load_dwordx4 v238, s[48:51], s69 offen offset:3072 sc1 lds
MV 148,a,108,a,8
ds_read_b128 a[80:83], v243 offset:16384
ds_read_b64 v[114:115], v12 offset:1096
MV 152,a,108,a,12
ds_read_b128 a[84:87], v243 offset:17408
MV 156,a,112,a,8
ds_read_b64 v[116:117], v12 offset:2176
MV 160,a,112,a,12
ds_read_b128 a[88:91], v243 offset:18432
s_add_u32 s69, s69, 16384
MV 164,a,116,a,8
ds_read_b128 a[92:95], v243 offset:19456
ds_read_b64 v[118:119], v12 offset:2184
MV 168,a,116,a,12
MV 172,a,120,a,8
ds_read_b64 v[120:121], v12 offset:3264
MV 176,a,120,a,12
MV 180,a,124,a,8
buffer_load_dwordx4 a[8:11], v236, s[44:47], s68 offen offset:1024 sc1
ds_read_b64 v[122:123], v12 offset:3272
MV 184,a,124,a,12
buffer_load_dwordx4 a[12:15], v237, s[44:47], s68 offen offset:1024 sc1
s_add_u32 s68, s68, 2048
s_waitcnt lgkmcnt(0)
MV 124,a,64,a,16
ds_read_b128 a[96:99], v242 offset:24576
buffer_store_dwordx4 v[108:111], v13, s[24:27], 0 offen offset:0 sc1
MV 128,a,64,a,20
ds_read_b128 a[100:103], v242 offset:25600
s_add_u32 m0, s70, 66560
MV 132,a,68,a,16
MV 136,a,68,a,20
ds_read_b128 a[104:107], v242 offset:26624
MV 140,a,72,a,16
ds_read_b128 a[108:111], v242 offset:27648
MV 144,a,72,a,20
buffer_load_dwordx4 v238, s[48:51], s69 offen offset:0 sc1 lds
MV 148,a,76,a,16
ds_read_b128 a[112:115], v243 offset:24576
MV 152,a,76,a,20
ds_read_b128 a[116:119], v243 offset:25600
MV 156,a,80,a,16
buffer_store_dwordx4 v[112:115], v13, s[24:27], 0 offen offset:1024 sc1
MV 160,a,80,a,20
ds_read_b128 a[120:123], v243 offset:26624
buffer_load_dwordx4 v238, s[48:51], s69 offen offset:1024 sc1 lds
MV 164,a,84,a,16
ds_read_b128 a[124:127], v243 offset:27648
MV 168,a,84,a,20
MV 172,a,88,a,16
MV 176,a,88,a,20
MV 180,a,92,a,16
buffer_load_dwordx4 a[16:19], v236, s[44:47], s68 offen offset:0 sc1
MV 184,a,92,a,20
buffer_load_dwordx4 a[20:23], v237, s[44:47], s68 offen offset:0 sc1
s_waitcnt vmcnt(16) lgkmcnt(0)
s_barrier
MV 124,a,96,a,24
ds_read_b128 a[64:67], v242 offset:32768
buffer_store_dwordx4 v[116:119], v13, s[24:27], 0 offen offset:2048 sc1
MV 128,a,96,a,28
ds_read_b128 a[68:71], v242 offset:33792
buffer_load_dwordx4 v238, s[48:51], s69 offen offset:2048 sc1 lds
MV 132,a,100,a,24
MV 136,a,100,a,28
ds_read_b128 a[72:75], v242 offset:34816
MV 140,a,104,a,24
ds_read_b128 a[76:79], v242 offset:35840
MV 144,a,104,a,28
buffer_load_dwordx4 v238, s[48:51], s69 offen offset:3072 sc1 lds
MV 148,a,108,a,24
ds_read_b128 a[80:83], v243 offset:32768
MV 152,a,108,a,28
ds_read_b128 a[84:87], v243 offset:33792
MV 156,a,112,a,24
buffer_store_dwordx4 v[120:123], v13, s[24:27], 0 offen offset:3072 sc1
MV 160,a,112,a,28
ds_read_b128 a[88:91], v243 offset:34816
s_add_u32 s69, s69, 16384
MV 164,a,116,a,24
ds_read_b128 a[92:95], v243 offset:35840
MV 168,a,116,a,28
MV 172,a,120,a,24
MV 176,a,120,a,28
MV 180,a,124,a,24
buffer_load_dwordx4 a[24:27], v236, s[44:47], s68 offen offset:1024 sc1
MV 184,a,124,a,28
buffer_load_dwordx4 a[28:31], v237, s[44:47], s68 offen offset:1024 sc1
s_add_u32 s68, s68, 2048
s_mov_b32 s71, 3
.p2align 5
L_p5_loop:
s_waitcnt lgkmcnt(0)
MV 124,a,64,a,32
ds_read_b128 a[96:99], v242 offset:40960
MV 128,a,64,a,36
ds_read_b128 a[100:103], v242 offset:41984
s_add_u32 m0, s70, 82944
MV 132,a,68,a,32
MV 136,a,68,a,36
ds_read_b128 a[104:107], v242 offset:43008
MV 140,a,72,a,32
ds_read_b128 a[108:111], v242 offset:44032
MV 144,a,72,a,36
buffer_load_dwordx4 v238, s[48:51], s69 offen offset:0 sc1 lds
MV 148,a,76,a,32
ds_read_b128 a[112:115], v243 offset:40960
MV 152,a,76,a,36
ds_read_b128 a[116:119], v243 offset:41984
MV 156,a,80,a,32
MV 160,a,80,a,36
ds_read_b128 a[120:123], v243 offset:43008
buffer_load_dwordx4 v238, s[48:51], s69 offen offset:1024 sc1 lds
MV 164,a,84,a,32
ds_read_b128 a[124:127], v243 offset:44032
MV 168,a,84,a,36
MV 172,a,88,a,32
MV 176,a,88,a,36
MV 180,a,92,a,32
buffer_load_dwordx4 a[32:35], v236, s[44:47], s68 offen offset:0 sc1
MV 184,a,92,a,36
buffer_load_dwordx4 a[36:39], v237, s[44:47], s68 offen offset:0 sc1
s_waitcnt vmcnt(14) lgkmcnt(0)
s_barrier
MV 124,a,96,a,40
ds_read_b128 a[64:67], v242 offset:49152
MV 128,a,96,a,44
ds_read_b128 a[68:71], v242 offset:50176
buffer_load_dwordx4 v238, s[48:51], s69 offen offset:2048 sc1 lds
MV 132,a,100,a,40
MV 136,a,100,a,44
ds_read_b128 a[72:75], v242 offset:51200
MV 140,a,104,a,40
ds_read_b128 a[76:79], v242 offset:52224
MV 144,a,104,a,44
buffer_load_dwordx4 v238, s[48:51], s69 offen offset:3072 sc1 lds
MV 148,a,108,a,40
ds_read_b128 a[80:83], v243 offset:49152
MV 152,a,108,a,44
ds_read_b128 a[84:87], v243 offset:50176
MV 156,a,112,a,40
MV 160,a,112,a,44
ds_read_b128 a[88:91], v243 offset:51200
s_add_u32 s69, s69, 16384
MV 164,a,116,a,40
ds_read_b128 a[92:95], v243 offset:52224
MV 168,a,116,a,44
MV 172,a,120,a,40
MV 176,a,120,a,44
MV 180,a,124,a,40
buffer_load_dwordx4 a[40:43], v236, s[44:47], s68 offen offset:1024 sc1
MV 184,a,124,a,44
buffer_load_dwordx4 a[44:47], v237, s[44:47], s68 offen offset:1024 sc1
s_add_u32 s68, s68, 2048
s_waitcnt lgkmcnt(0)
MV 124,a,64,a,48
ds_read_b128 a[96:99], v242 offset:57344
MV 128,a,64,a,52
ds_read_b128 a[100:103], v242 offset:58368
s_add_u32 m0, s70, 99328
MV 132,a,68,a,48
MV 136,a,68,a,52
ds_read_b128 a[104:107], v242 offset:59392
MV 140,a,72,a,48
ds_read_b128 a[108:111], v242 offset:60416
MV 144,a,72,a,52
buffer_load_dwordx4 v238, s[48:51], s69 offen offset:0 sc1 lds
MV 148,a,76,a,48
ds_read_b128 a[112:115], v243 offset:57344
MV 152,a,76,a,52
ds_read_b128 a[116:119], v243 offset:58368
MV 156,a,80,a,48
MV 160,a,80,a,52
ds_read_b128 a[120:123], v243 offset:59392
buffer_load_dwordx4 v238, s[48:51], s69 offen offset:1024 sc1 lds
MV 164,a,84,a,48
ds_read_b128 a[124:127], v243 offset:60416
MV 168,a,84,a,52
MV 172,a,88,a,48
MV 176,a,88,a,52
MV 180,a,92,a,48
buffer_load_dwordx4 a[48:51], v236, s[44:47], s68 offen offset:0 sc1
MV 184,a,92,a,52
buffer_load_dwordx4 a[52:55], v237, s[44:47], s68 offen offset:0 sc1
s_waitcnt vmcnt(14) lgkmcnt(0)
s_barrier
MV 124,a,96,a,56
ds_read_b128 a[64:67], v242 offset:0
MV 128,a,96,a,60
ds_read_b128 a[68:71], v242 offset:1024
buffer_load_dwordx4 v238, s[48:51], s69 offen offset:2048 sc1 lds
MV 132,a,100,a,56
MV 136,a,100,a,60
ds_read_b128 a[72:75], v242 offset:2048
MV 140,a,104,a,56
ds_read_b128 a[76:79], v242 offset:3072
MV 144,a,104,a,60
buffer_load_dwordx4 v238, s[48:51], s69 offen offset:3072 sc1 lds
MV 148,a,108,a,56
ds_read_b128 a[80:83], v243 offset:0
MV 152,a,108,a,60
ds_read_b128 a[84:87], v243 offset:1024
MV 156,a,112,a,56
MV 160,a,112,a,60
ds_read_b128 a[88:91], v243 offset:2048
s_add_u32 s69, s69, 16384
MV 164,a,116,a,56
ds_read_b128 a[92:95], v243 offset:3072
MV 168,a,116,a,60
MV 172,a,120,a,56
MV 176,a,120,a,60
MV 180,a,124,a,56
buffer_load_dwordx4 a[56:59], v236, s[44:47], s68 offen offset:1024 sc1
MV 184,a,124,a,60
buffer_load_dwordx4 a[60:63], v237, s[44:47], s68 offen offset:1024 sc1
s_add_u32 s68, s68, 2048
s_waitcnt lgkmcnt(0)
MV 124,a,64,a,0
ds_read_b128 a[96:99], v242 offset:8192
MV 128,a,64,a,4
ds_read_b128 a[100:103], v242 offset:9216
s_add_u32 m0, s70, 115712
MV 132,a,68,a,0
MV 136,a,68,a,4
ds_read_b128 a[104:107], v242 offset:10240
MV 140,a,72,a,0
ds_read_b128 a[108:111], v242 offset:11264
MV 144,a,72,a,4
buffer_load_dwordx4 v238, s[48:51], s69 offen offset:0 sc1 lds
MV 148,a,76,a,0
ds_read_b128 a[112:115], v243 offset:8192
MV 152,a,76,a,4
ds_read_b128 a[116:119], v243 offset:9216
MV 156,a,80,a,0
MV 160,a,80,a,4
ds_read_b128 a[120:123], v243 offset:10240
buffer_load_dwordx4 v238, s[48:51], s69 offen offset:1024 sc1 lds
MV 164,a,84,a,0
ds_read_b128 a[124:127], v243 offset:11264
MV 168,a,84,a,4
MV 172,a,88,a,0
MV 176,a,88,a,4
MV 180,a,92,a,0
buffer_load_dwordx4 a[0:3], v236, s[44:47], s68 offen offset:0 sc1
MV 184,a,92,a,4
buffer_load_dwordx4 a[4:7], v237, s[44:47], s68 offen offset:0 sc1
s_waitcnt vmcnt(14) lgkmcnt(0)
s_barrier
MV 124,a,96,a,8
ds_read_b128 a[64:67], v242 offset:16384
MV 128,a,96,a,12
ds_read_b128 a[68:71], v242 offset:17408
buffer_load_dwordx4 v238, s[48:51], s69 offen offset:2048 sc1 lds
MV 132,a,100,a,8
MV 136,a,100,a,12
ds_read_b128 a[72:75], v242 offset:18432
MV 140,a,104,a,8
ds_read_b128 a[76:79], v242 offset:19456
MV 144,a,104,a,12
buffer_load_dwordx4 v238, s[48:51], s69 offen offset:3072 sc1 lds
MV 148,a,108,a,8
ds_read_b128 a[80:83], v243 offset:16384
MV 152,a,108,a,12
ds_read_b128 a[84:87], v243 offset:17408
MV 156,a,112,a,8
MV 160,a,112,a,12
ds_read_b128 a[88:91], v243 offset:18432
s_add_u32 s69, s69, 16384
MV 164,a,116,a,8
ds_read_b128 a[92:95], v243 offset:19456
MV 168,a,116,a,12
MV 172,a,120,a,8
MV 176,a,120,a,12
MV 180,a,124,a,8
buffer_load_dwordx4 a[8:11], v236, s[44:47], s68 offen offset:1024 sc1
MV 184,a,124,a,12
buffer_load_dwordx4 a[12:15], v237, s[44:47], s68 offen offset:1024 sc1
s_add_u32 s68, s68, 2048
s_waitcnt lgkmcnt(0)
MV 124,a,64,a,16
ds_read_b128 a[96:99], v242 offset:24576
MV 128,a,64,a,20
ds_read_b128 a[100:103], v242 offset:25600
s_add_u32 m0, s70, 66560
MV 132,a,68,a,16
MV 136,a,68,a,20
ds_read_b128 a[104:107], v242 offset:26624
MV 140,a,72,a,16
ds_read_b128 a[108:111], v242 offset:27648
MV 144,a,72,a,20
buffer_load_dwordx4 v238, s[48:51], s69 offen offset:0 sc1 lds
MV 148,a,76,a,16
ds_read_b128 a[112:115], v243 offset:24576
MV 152,a,76,a,20
ds_read_b128 a[116:119], v243 offset:25600
MV 156,a,80,a,16
MV 160,a,80,a,20
ds_read_b128 a[120:123], v243 offset:26624
buffer_load_dwordx4 v238, s[48:51], s69 offen offset:1024 sc1 lds
MV 164,a,84,a,16
ds_read_b128 a[124:127], v243 offset:27648
MV 168,a,84,a,20
MV 172,a,88,a,16
MV 176,a,88,a,20
MV 180,a,92,a,16
buffer_load_dwordx4 a[16:19], v236, s[44:47], s68 offen offset:0 sc1
MV 184,a,92,a,20
buffer_load_dwordx4 a[20:23], v237, s[44:47], s68 offen offset:0 sc1
s_waitcnt vmcnt(14) lgkmcnt(0)
s_barrier
MV 124,a,96,a,24
ds_read_b128 a[64:67], v242 offset:32768
MV 128,a,96,a,28
ds_read_b128 a[68:71], v242 offset:33792
buffer_load_dwordx4 v238, s[48:51], s69 offen offset:2048 sc1 lds
MV 132,a,100,a,24
MV 136,a,100,a,28
ds_read_b128 a[72:75], v242 offset:34816
MV 140,a,104,a,24
ds_read_b128 a[76:79], v242 offset:35840
MV 144,a,104,a,28
buffer_load_dwordx4 v238, s[48:51], s69 offen offset:3072 sc1 lds
MV 148,a,108,a,24
ds_read_b128 a[80:83], v243 offset:32768
MV 152,a,108,a,28
ds_read_b128 a[84:87], v243 offset:33792
MV 156,a,112,a,24
MV 160,a,112,a,28
ds_read_b128 a[88:91], v243 offset:34816
s_add_u32 s69, s69, 16384
MV 164,a,116,a,24
ds_read_b128 a[92:95], v243 offset:35840
MV 168,a,116,a,28
MV 172,a,120,a,24
MV 176,a,120,a,28
MV 180,a,124,a,24
buffer_load_dwordx4 a[24:27], v236, s[44:47], s68 offen offset:1024 sc1
MV 184,a,124,a,28
buffer_load_dwordx4 a[28:31], v237, s[44:47], s68 offen offset:1024 sc1
s_add_u32 s68, s68, 2048
s_sub_u32 s71, s71, 1
s_cbranch_scc1 L_p5_out
s_cmp_eq_u32 s71, 2
s_cbranch_scc1 L_p5_x1
s_cmp_eq_u32 s71, 0
s_cbranch_scc1 L_p5_x2
s_branch L_p5_loop
L_p5_out:
s_waitcnt lgkmcnt(0)
MV 124,a,64,a,32
ds_read_b128 a[96:99], v242 offset:40960
MV 128,a,64,a,36
ds_read_b128 a[100:103], v242 offset:41984
s_add_u32 m0, s70, 82944
MV 132,a,68,a,32
v_cmp_gt_u32 vcc, 1, v253
s_nop 4
s_cbranch_vccnz L_spin_f3
L_spin_f3_ret:
MV 136,a,68,a,36
ds_read_b128 a[104:107], v242 offset:43008
MV 140,a,72,a,32
ds_read_b128 a[108:111], v242 offset:44032
MV 144,a,72,a,36
buffer_load_dwordx4 v238, s[48:51], s69 offen offset:0 sc1 lds
MV 148,a,76,a,32
ds_read_b128 a[112:115], v243 offset:40960
MV 152,a,76,a,36
ds_read_b128 a[116:119], v243 offset:41984
MV 156,a,80,a,32
MV 160,a,80,a,36
ds_read_b128 a[120:123], v243 offset:43008
buffer_load_dwordx4 v238, s[48:51], s69 offen offset:1024 sc1 lds
MV 164,a,84,a,32
ds_read_b128 a[124:127], v243 offset:44032
MV 168,a,84,a,36
MV 172,a,88,a,32
s_add_u32 s72, s79, 0
MV 176,a,88,a,36
MV 180,a,92,a,32
buffer_load_dwordx4 a[32:35], v236, s[44:47], s68 offen offset:0 sc1
buffer_load_dwordx2 v[208:209], v251, s[56:59], s72 offen offset:0 sc1
MV 184,a,92,a,36
buffer_load_dwordx4 a[36:39], v237, s[44:47], s68 offen offset:0 sc1
s_waitcnt vmcnt(15) lgkmcnt(0)
s_barrier
MV 124,a,96,a,40
ds_read_b128 a[64:67], v242 offset:49152
s_add_u32 s72, s79, 16384
MV 128,a,96,a,44
ds_read_b128 a[68:71], v242 offset:50176
buffer_load_dwordx4 v238, s[48:51], s69 offen offset:2048 sc1 lds
MV 132,a,100,a,40
MV 136,a,100,a,44
ds_read_b128 a[72:75], v242 offset:51200
MV 140,a,104,a,40
ds_read_b128 a[76:79], v242 offset:52224
MV 144,a,104,a,44
buffer_load_dwordx4 v238, s[48:51], s69 offen offset:3072 sc1 lds
MV 148,a,108,a,40
ds_read_b128 a[80:83], v243 offset:49152
MV 152,a,108,a,44
ds_read_b128 a[84:87], v243 offset:50176
MV 156,a,112,a,40
buffer_load_dwordx2 v[210:211], v251, s[56:59], s72 offen offset:0 sc1
MV 160,a,112,a,44
ds_read_b128 a[88:91], v243 offset:51200
s_add_u32 s69, s69, 16384
MV 164,a,116,a,40
ds_read_b128 a[92:95], v243 offset:52224
MV 168,a,116,a,44
MV 172,a,120,a,40
MV 176,a,120,a,44
MV 180,a,124,a,40
buffer_load_dwordx4 a[40:43], v236, s[44:47], s68 offen offset:1024 sc1
MV 184,a,124,a,44
buffer_load_dwordx4 a[44:47], v237, s[44:47], s68 offen offset:1024 sc1
s_add_u32 s68, s68, 2048
s_waitcnt lgkmcnt(0)
MV 124,a,64,a,48
ds_read_b128 a[96:99], v242 offset:57344
s_add_u32 s72, s79, 131072
MV 128,a,64,a,52
ds_read_b128 a[100:103], v242 offset:58368
s_add_u32 m0, s70, 99328
MV 132,a,68,a,48
MV 136,a,68,a,52
ds_read_b128 a[104:107], v242 offset:59392
MV 140,a,72,a,48
ds_read_b128 a[108:111], v242 offset:60416
buffer_load_dwordx2 v[212:213], v251, s[56:59], s72 offen offset:0 sc1
MV 144,a,72,a,52
buffer_load_dwordx4 v238, s[48:51], s69 offen offset:0 sc1 lds
MV 148,a,76,a,48
ds_read_b128 a[112:115], v243 offset:57344
MV 152,a,76,a,52
ds_read_b128 a[116:119], v243 offset:58368
MV 156,a,80,a,48
s_add_u32 s72, s79, 147456
MV 160,a,80,a,52
ds_read_b128 a[120:123], v243 offset:59392
buffer_load_dwordx4 v238, s[48:51], s69 offen offset:1024 sc1 lds
MV 164,a,84,a,48
ds_read_b128 a[124:127], v243 offset:60416
MV 168,a,84,a,52
MV 172,a,88,a,48
buffer_load_dwordx2 v[214:215], v251, s[56:59], s72 offen offset:0 sc1
MV 176,a,88,a,52
MV 180,a,92,a,48
buffer_load_dwordx4 a[48:51], v236, s[44:47], s68 offen offset:0 sc1
MV 184,a,92,a,52
buffer_load_dwordx4 a[52:55], v237, s[44:47], s68 offen offset:0 sc1
s_waitcnt vmcnt(18) lgkmcnt(0)
s_barrier
MV 124,a,96,a,56
ds_read_b128 a[64:67], v242 offset:0
s_add_u32 s72, s79, 0
MV 128,a,96,a,60
ds_read_b128 a[68:71], v242 offset:1024
buffer_load_dwordx4 v238, s[48:51], s69 offen offset:2048 sc1 lds
MV 132,a,100,a,56
MV 136,a,100,a,60
ds_read_b128 a[72:75], v242 offset:2048
MV 140,a,104,a,56
ds_read_b128 a[76:79], v242 offset:3072
MV 144,a,104,a,60
buffer_load_dwordx4 v238, s[48:51], s69 offen offset:3072 sc1 lds
MV 148,a,108,a,56
ds_read_b128 a[80:83], v243 offset:0
MV 152,a,108,a,60
ds_read_b128 a[84:87], v243 offset:1024
MV 156,a,112,a,56
buffer_load_dwordx2 v[216:217], v251, s[56:59], s72 offen offset:128 sc1
MV 160,a,112,a,60
ds_read_b128 a[88:91], v243 offset:2048
s_add_u32 s69, s69, 16384
MV 164,a,116,a,56
ds_read_b128 a[92:95], v243 offset:3072
MV 168,a,116,a,60
MV 172,a,120,a,56
MV 176,a,120,a,60
MV 180,a,124,a,56
buffer_load_dwordx4 a[56:59], v236, s[44:47], s68 offen offset:1024 sc1
MV 184,a,124,a,60
buffer_load_dwordx4 a[60:63], v237, s[44:47], s68 offen offset:1024 sc1
s_add_u32 s68, s68, 2048
s_waitcnt lgkmcnt(0)
MV 124,a,64,a,0
ds_read_b128 a[96:99], v242 offset:8192
s_add_u32 s72, s79, 16384
MV 128,a,64,a,4
ds_read_b128 a[100:103], v242 offset:9216
s_add_u32 m0, s70, 115712
MV 132,a,68,a,0
MV 136,a,68,a,4
ds_read_b128 a[104:107], v242 offset:10240
MV 140,a,72,a,0
ds_read_b128 a[108:111], v242 offset:11264
MV 144,a,72,a,4
buffer_load_dwordx4 v238, s[48:51], s69 offen offset:0 sc1 lds
MV 148,a,76,a,0
ds_read_b128 a[112:115], v243 offset:8192
MV 152,a,76,a,4
ds_read_b128 a[116:119], v243 offset:9216
MV 156,a,80,a,0
buffer_load_dwordx2 v[218:219], v251, s[56:59], s72 offen offset:128 sc1
MV 160,a,80,a,4
ds_read_b128 a[120:123], v243 offset:10240
buffer_load_dwordx4 v238, s[48:51], s69 offen offset:1024 sc1 lds
MV 164,a,84,a,0
ds_read_b128 a[124:127], v243 offset:11264
MV 168,a,84,a,4
MV 172,a,88,a,0
MV 176,a,88,a,4
MV 180,a,92,a,0
buffer_load_dwordx4 a[0:3], v236, s[44:47], s68 offen offset:0 sc1
MV 184,a,92,a,4
buffer_load_dwordx4 a[4:7], v237, s[44:47], s68 offen offset:0 sc1
s_waitcnt vmcnt(19) lgkmcnt(0)
s_barrier
MV 124,a,96,a,8
ds_read_b128 a[64:67], v242 offset:16384
s_add_u32 s72, s79, 131072
MV 128,a,96,a,12
ds_read_b128 a[68:71], v242 offset:17408
buffer_load_dwordx4 v238, s[48:51], s69 offen offset:2048 sc1 lds
MV 132,a,100,a,8
MV 136,a,100,a,12
ds_read_b128 a[72:75], v242 offset:18432
MV 140,a,104,a,8
ds_read_b128 a[76:79], v242 offset:19456
buffer_load_dwordx2 v[220:221], v251, s[56:59], s72 offen offset:128 sc1
MV 144,a,104,a,12
buffer_load_dwordx4 v238, s[48:51], s69 offen offset:3072 sc1 lds
MV 148,a,108,a,8
ds_read_b128 a[80:83], v243 offset:16384
MV 152,a,108,a,12
ds_read_b128 a[84:87], v243 offset:17408
MV 156,a,112,a,8
s_add_u32 s72, s79, 147456
MV 160,a,112,a,12
ds_read_b128 a[88:91], v243 offset:18432
s_add_u32 s69, s69, 16384
MV 164,a,116,a,8
ds_read_b128 a[92:95], v243 offset:19456
MV 168,a,116,a,12
MV 172,a,120,a,8
buffer_load_dwordx2 v[222:223], v251, s[56:59], s72 offen offset:128 sc1
MV 176,a,120,a,12
MV 180,a,124,a,8
buffer_load_dwordx4 a[8:11], v236, s[44:47], s68 offen offset:1024 sc1
MV 184,a,124,a,12
buffer_load_dwordx4 a[12:15], v237, s[44:47], s68 offen offset:1024 sc1
s_add_u32 s68, s68, 2048
s_waitcnt lgkmcnt(0)
MV 124,a,64,a,16
ds_read_b128 a[96:99], v242 offset:24576
MV 128,a,64,a,20
ds_read_b128 a[100:103], v242 offset:25600
s_add_u32 m0, s70, 66560
MV 132,a,68,a,16
MV 136,a,68,a,20
ds_read_b128 a[104:107], v242 offset:26624
MV 140,a,72,a,16
ds_read_b128 a[108:111], v242 offset:27648
MV 144,a,72,a,20
buffer_load_dwordx4 v238, s[48:51], s69 offen offset:0 sc1 lds
MV 148,a,76,a,16
ds_read_b128 a[112:115], v243 offset:24576
MV 152,a,76,a,20
ds_read_b128 a[116:119], v243 offset:25600
MV 156,a,80,a,16
MV 160,a,80,a,20
ds_read_b128 a[120:123], v243 offset:26624
buffer_load_dwordx4 v238, s[48:51], s69 offen offset:1024 sc1 lds
MV 164,a,84,a,16
ds_read_b128 a[124:127], v243 offset:27648
MV 168,a,84,a,20
MV 172,a,88,a,16
MV 176,a,88,a,20
MV 180,a,92,a,16
buffer_load_dwordx4 a[16:19], v236, s[44:47], s68 offen offset:0 sc1
MV 184,a,92,a,20
buffer_load_dwordx4 a[20:23], v237, s[44:47], s68 offen offset:0 sc1
s_waitcnt vmcnt(18) lgkmcnt(0)
s_barrier
MV 124,a,96,a,24
ds_read_b128 a[64:67], v242 offset:32768
MV 128,a,96,a,28
ds_read_b128 a[68:71], v242 offset:33792
buffer_load_dwordx4 v238, s[48:51], s69 offen offset:2048 sc1 lds
MV 132,a,100,a,24
MV 136,a,100,a,28
ds_read_b128 a[72:75], v242 offset:34816
MV 140,a,104,a,24
ds_read_b128 a[76:79], v242 offset:35840
MV 144,a,104,a,28
buffer_load_dwordx4 v238, s[48:51], s69 offen offset:3072 sc1 lds
MV 148,a,108,a,24
ds_read_b128 a[80:83], v243 offset:32768
MV 152,a,108,a,28
ds_read_b128 a[84:87], v243 offset:33792
MV 156,a,112,a,24
MV 160,a,112,a,28
ds_read_b128 a[88:91], v243 offset:34816
s_add_u32 s69, s69, 16384
MV 164,a,116,a,24
ds_read_b128 a[92:95], v243 offset:35840
MV 168,a,116,a,28
MV 172,a,120,a,24
MV 176,a,120,a,28
MV 180,a,124,a,24
buffer_load_dwordx4 a[24:27], v236, s[44:47], s68 offen offset:1024 sc1
MV 184,a,124,a,28
buffer_load_dwordx4 a[28:31], v237, s[44:47], s68 offen offset:1024 sc1
s_add_u32 s68, s68, 2048
s_waitcnt lgkmcnt(0)
MV 124,a,64,a,32
ds_read_b128 a[96:99], v242 offset:40960
v_sub_f32 v8, 1.0, v6
MV 128,a,64,a,36
ds_read_b128 a[100:103], v242 offset:41984
s_add_u32 m0, s70, 82944
MV 132,a,68,a,32
v_lshlrev_b32 v36, 16, v192
v_lshlrev_b32 v228, 16, v208
MV 136,a,68,a,36
ds_read_b128 a[104:107], v242 offset:43008
v_and_b32 v37, 0xffff0000, v192
MV 140,a,72,a,32
ds_read_b128 a[108:111], v242 offset:44032
v_and_b32 v229, 0xffff0000, v208
MV 144,a,72,a,36
buffer_load_dwordx4 v238, s[48:51], s69 offen offset:0 sc1 lds
v_mul_f32 v36, v36, v228
MV 148,a,76,a,32
ds_read_b128 a[112:115], v243 offset:40960
v_mul_f32 v37, v37, v229
MV 152,a,76,a,36
ds_read_b128 a[116:119], v243 offset:41984
v_mul_f32 v36, v36, v6
MV 156,a,80,a,32
v_mul_f32 v37, v37, v6
v_lshlrev_b32 v38, 16, v193
MV 160,a,80,a,36
ds_read_b128 a[120:123], v243 offset:43008
buffer_load_dwordx4 v238, s[48:51], s69 offen offset:1024 sc1 lds
MV 164,a,84,a,32
ds_read_b128 a[124:127], v243 offset:44032
v_lshlrev_b32 v228, 16, v209
MV 168,a,84,a,36
v_and_b32 v39, 0xffff0000, v193
v_and_b32 v229, 0xffff0000, v209
MV 172,a,88,a,32
v_mul_f32 v38, v38, v228
v_mul_f32 v39, v39, v229
MV 176,a,88,a,36
v_mul_f32 v38, v38, v6
v_mul_f32 v39, v39, v6
MV 180,a,92,a,32
buffer_load_dwordx4 a[32:35], v236, s[44:47], s68 offen offset:0 sc1
v_lshlrev_b32 v40, 16, v194
MV 184,a,92,a,36
buffer_load_dwordx4 a[36:39], v237, s[44:47], s68 offen offset:0 sc1
v_lshlrev_b32 v228, 16, v210
v_and_b32 v41, 0xffff0000, v194
v_and_b32 v229, 0xffff0000, v210
s_waitcnt vmcnt(15) lgkmcnt(0)
s_barrier
MV 124,a,96,a,40
ds_read_b128 a[64:67], v242 offset:49152
v_mul_f32 v40, v40, v228
MV 128,a,96,a,44
ds_read_b128 a[68:71], v242 offset:50176
buffer_load_dwordx4 v238, s[48:51], s69 offen offset:2048 sc1 lds
MV 132,a,100,a,40
v_mul_f32 v41, v41, v229
v_mul_f32 v40, v40, v6
MV 136,a,100,a,44
ds_read_b128 a[72:75], v242 offset:51200
v_mul_f32 v41, v41, v6
MV 140,a,104,a,40
ds_read_b128 a[76:79], v242 offset:52224
v_lshlrev_b32 v42, 16, v195
MV 144,a,104,a,44
buffer_load_dwordx4 v238, s[48:51], s69 offen offset:3072 sc1 lds
v_lshlrev_b32 v228, 16, v211
MV 148,a,108,a,40
ds_read_b128 a[80:83], v243 offset:49152
v_and_b32 v43, 0xffff0000, v195
MV 152,a,108,a,44
ds_read_b128 a[84:87], v243 offset:50176
v_and_b32 v229, 0xffff0000, v211
MV 156,a,112,a,40
v_mul_f32 v42, v42, v228
v_mul_f32 v43, v43, v229
MV 160,a,112,a,44
ds_read_b128 a[88:91], v243 offset:51200
s_add_u32 s69, s69, 16384
MV 164,a,116,a,40
ds_read_b128 a[92:95], v243 offset:52224
v_mul_f32 v42, v42, v6
MV 168,a,116,a,44
v_mul_f32 v43, v43, v6
v_lshlrev_b32 v44, 16, v196
MV 172,a,120,a,40
v_lshlrev_b32 v228, 16, v212
v_and_b32 v45, 0xffff0000, v196
MV 176,a,120,a,44
v_and_b32 v229, 0xffff0000, v212
v_mul_f32 v44, v44, v228
MV 180,a,124,a,40
buffer_load_dwordx4 a[40:43], v236, s[44:47], s68 offen offset:1024 sc1
v_mul_f32 v45, v45, v229
MV 184,a,124,a,44
buffer_load_dwordx4 a[44:47], v237, s[44:47], s68 offen offset:1024 sc1
s_add_u32 s68, s68, 2048
v_mul_f32 v44, v44, v6
v_mul_f32 v45, v45, v6
v_lshlrev_b32 v46, 16, v197
v_lshlrev_b32 v228, 16, v213
s_waitcnt lgkmcnt(0)
MV 124,a,64,a,48
ds_read_b128 a[96:99], v242 offset:57344
v_and_b32 v47, 0xffff0000, v197
MV 128,a,64,a,52
ds_read_b128 a[100:103], v242 offset:58368
s_add_u32 m0, s70, 99328
MV 132,a,68,a,48
v_and_b32 v229, 0xffff0000, v213
v_mul_f32 v46, v46, v228
MV 136,a,68,a,52
ds_read_b128 a[104:107], v242 offset:59392
v_mul_f32 v47, v47, v229
MV 140,a,72,a,48
ds_read_b128 a[108:111], v242 offset:60416
v_mul_f32 v46, v46, v6
MV 144,a,72,a,52
buffer_load_dwordx4 v238, s[48:51], s69 offen offset:0 sc1 lds
v_mul_f32 v47, v47, v6
MV 148,a,76,a,48
ds_read_b128 a[112:115], v243 offset:57344
v_lshlrev_b32 v48, 16, v198
MV 152,a,76,a,52
ds_read_b128 a[116:119], v243 offset:58368
v_lshlrev_b32 v228, 16, v214
MV 156,a,80,a,48
v_and_b32 v49, 0xffff0000, v198
v_and_b32 v229, 0xffff0000, v214
MV 160,a,80,a,52
ds_read_b128 a[120:123], v243 offset:59392
buffer_load_dwordx4 v238, s[48:51], s69 offen offset:1024 sc1 lds
MV 164,a,84,a,48
ds_read_b128 a[124:127], v243 offset:60416
v_mul_f32 v48, v48, v228
MV 168,a,84,a,52
v_mul_f32 v49, v49, v229
v_mul_f32 v48, v48, v6
MV 172,a,88,a,48
v_mul_f32 v49, v49, v6
v_lshlrev_b32 v50, 16, v199
MV 176,a,88,a,52
v_lshlrev_b32 v228, 16, v215
v_and_b32 v51, 0xffff0000, v199
MV 180,a,92,a,48
buffer_load_dwordx4 a[48:51], v236, s[44:47], s68 offen offset:0 sc1
v_and_b32 v229, 0xffff0000, v215
MV 184,a,92,a,52
buffer_load_dwordx4 a[52:55], v237, s[44:47], s68 offen offset:0 sc1
v_mul_f32 v50, v50, v228
v_mul_f32 v51, v51, v229
v_mul_f32 v50, v50, v6
v_mul_f32 v51, v51, v6
s_waitcnt vmcnt(14) lgkmcnt(0)
s_barrier
MV 124,a,96,a,56
ds_read_b128 a[64:67], v242 offset:0
v_sub_f32 v9, 1.0, v7
MV 128,a,96,a,60
ds_read_b128 a[68:71], v242 offset:1024
buffer_load_dwordx4 v238, s[48:51], s69 offen offset:2048 sc1 lds
MV 132,a,100,a,56
v_lshlrev_b32 v52, 16, v200
v_lshlrev_b32 v228, 16, v216
MV 136,a,100,a,60
ds_read_b128 a[72:75], v242 offset:2048
v_and_b32 v53, 0xffff0000, v200
MV 140,a,104,a,56
ds_read_b128 a[76:79], v242 offset:3072
v_and_b32 v229, 0xffff0000, v216
MV 144,a,104,a,60
buffer_load_dwordx4 v238, s[48:51], s69 offen offset:3072 sc1 lds
v_mul_f32 v52, v52, v228
MV 148,a,108,a,56
ds_read_b128 a[80:83], v243 offset:0
v_mul_f32 v53, v53, v229
MV 152,a,108,a,60
ds_read_b128 a[84:87], v243 offset:1024
v_mul_f32 v52, v52, v7
MV 156,a,112,a,56
v_mul_f32 v53, v53, v7
v_lshlrev_b32 v54, 16, v201
MV 160,a,112,a,60
ds_read_b128 a[88:91], v243 offset:2048
s_add_u32 s69, s69, 16384
MV 164,a,116,a,56
ds_read_b128 a[92:95], v243 offset:3072
v_lshlrev_b32 v228, 16, v217
MV 168,a,116,a,60
v_and_b32 v55, 0xffff0000, v201
v_and_b32 v229, 0xffff0000, v217
MV 172,a,120,a,56
v_mul_f32 v54, v54, v228
v_mul_f32 v55, v55, v229
MV 176,a,120,a,60
v_mul_f32 v54, v54, v7
v_mul_f32 v55, v55, v7
MV 180,a,124,a,56
buffer_load_dwordx4 a[56:59], v236, s[44:47], s68 offen offset:1024 sc1
v_lshlrev_b32 v56, 16, v202
MV 184,a,124,a,60
buffer_load_dwordx4 a[60:63], v237, s[44:47], s68 offen offset:1024 sc1
s_add_u32 s68, s68, 2048
v_lshlrev_b32 v228, 16, v218
v_and_b32 v57, 0xffff0000, v202
v_and_b32 v229, 0xffff0000, v218
s_waitcnt lgkmcnt(0)
MV 124,a,64,a,0
ds_read_b128 a[96:99], v242 offset:8192
v_mul_f32 v56, v56, v228
MV 128,a,64,a,4
ds_read_b128 a[100:103], v242 offset:9216
s_add_u32 m0, s70, 115712
MV 132,a,68,a,0
v_mul_f32 v57, v57, v229
v_mul_f32 v56, v56, v7
MV 136,a,68,a,4
ds_read_b128 a[104:107], v242 offset:10240
v_mul_f32 v57, v57, v7
MV 140,a,72,a,0
ds_read_b128 a[108:111], v242 offset:11264
v_lshlrev_b32 v58, 16, v203
MV 144,a,72,a,4
buffer_load_dwordx4 v238, s[48:51], s69 offen offset:0 sc1 lds
v_lshlrev_b32 v228, 16, v219
MV 148,a,76,a,0
ds_read_b128 a[112:115], v243 offset:8192
v_and_b32 v59, 0xffff0000, v203
MV 152,a,76,a,4
ds_read_b128 a[116:119], v243 offset:9216
v_and_b32 v229, 0xffff0000, v219
MV 156,a,80,a,0
v_mul_f32 v58, v58, v228
v_mul_f32 v59, v59, v229
MV 160,a,80,a,4
ds_read_b128 a[120:123], v243 offset:10240
buffer_load_dwordx4 v238, s[48:51], s69 offen offset:1024 sc1 lds
MV 164,a,84,a,0
ds_read_b128 a[124:127], v243 offset:11264
v_mul_f32 v58, v58, v7
MV 168,a,84,a,4
v_mul_f32 v59, v59, v7
v_lshlrev_b32 v60, 16, v204
MV 172,a,88,a,0
v_lshlrev_b32 v228, 16, v220
v_and_b32 v61, 0xffff0000, v204
MV 176,a,88,a,4
v_and_b32 v229, 0xffff0000, v220
v_mul_f32 v60, v60, v228
MV 180,a,92,a,0
v_mul_f32 v61, v61, v229
v_mul_f32 v60, v60, v7
MV 184,a,92,a,4
v_mul_f32 v61, v61, v7
v_lshlrev_b32 v62, 16, v205
v_lshlrev_b32 v228, 16, v221
s_waitcnt vmcnt(12) lgkmcnt(0)
s_barrier
MV 124,a,96,a,8
ds_read_b128 a[80:83], v243 offset:16384
v_and_b32 v63, 0xffff0000, v205
MV 128,a,96,a,12
buffer_load_dwordx4 v238, s[48:51], s69 offen offset:2048 sc1 lds
v_and_b32 v229, 0xffff0000, v221
MV 132,a,100,a,8
v_mul_f32 v62, v62, v228
v_mul_f32 v63, v63, v229
MV 136,a,100,a,12
ds_read_b128 a[84:87], v243 offset:17408
v_mul_f32 v62, v62, v7
MV 140,a,104,a,8
v_mul_f32 v63, v63, v7
v_lshlrev_b32 v64, 16, v206
MV 144,a,104,a,12
buffer_load_dwordx4 v238, s[48:51], s69 offen offset:3072 sc1 lds
v_lshlrev_b32 v228, 16, v222
MV 148,a,108,a,8
ds_read_b128 a[88:91], v243 offset:18432
v_and_b32 v65, 0xffff0000, v206
MV 152,a,108,a,12
v_and_b32 v229, 0xffff0000, v222
v_mul_f32 v64, v64, v228
MV 156,a,112,a,8
v_mul_f32 v65, v65, v229
v_mul_f32 v64, v64, v7
MV 160,a,112,a,12
ds_read_b128 a[92:95], v243 offset:19456
s_add_u32 s69, s69, 16384
MV 164,a,116,a,8
v_mul_f32 v65, v65, v7
v_lshlrev_b32 v66, 16, v207
MV 168,a,116,a,12
v_lshlrev_b32 v228, 16, v223
v_and_b32 v67, 0xffff0000, v207
MV 172,a,120,a,8
v_and_b32 v229, 0xffff0000, v223
MV 176,a,120,a,12
v_mul_f32 v66, v66, v228
v_mul_f32 v67, v67, v229
MV 180,a,124,a,8
v_mul_f32 v66, v66, v7
MV 184,a,124,a,12
v_mul_f32 v67, v67, v7
s_waitcnt lgkmcnt(0)
MV 156,a,80,a,16
ds_read_b128 a[112:115], v243 offset:24576
s_xor_b32 s72, s2, 4
MV 160,a,80,a,20
ds_read_b128 a[116:119], v243 offset:25600
s_lshl_b32 s72, s72, 14
MV 164,a,84,a,16
ds_read_b128 a[120:123], v243 offset:26624
MV 168,a,84,a,20
ds_read_b128 a[124:127], v243 offset:27648
MV 172,a,88,a,16
MV 176,a,88,a,20
MV 180,a,92,a,16
MV 184,a,92,a,20
s_waitcnt vmcnt(6)
s_barrier
s_waitcnt lgkmcnt(3)
MV 156,a,112,a,24
ds_read_b128 a[80:83], v243 offset:32768
MV 160,a,112,a,28
ds_read_b128 a[84:87], v243 offset:33792
s_waitcnt lgkmcnt(4)
MV 164,a,116,a,24
ds_read_b128 a[88:91], v243 offset:34816
MV 168,a,116,a,28
ds_read_b128 a[92:95], v243 offset:35840
s_waitcnt lgkmcnt(5)
MV 172,a,120,a,24
MV 176,a,120,a,28
s_waitcnt lgkmcnt(4)
MV 180,a,124,a,24
MV 184,a,124,a,28
s_waitcnt lgkmcnt(3)
MV 156,a,80,a,32
ds_read_b128 a[112:115], v243 offset:40960
MV 160,a,80,a,36
ds_read_b128 a[116:119], v243 offset:41984
s_waitcnt lgkmcnt(4)
MV 164,a,84,a,32
ds_read_b128 a[120:123], v243 offset:43008
MV 168,a,84,a,36
ds_read_b128 a[124:127], v243 offset:44032
s_waitcnt lgkmcnt(5)
MV 172,a,88,a,32
MV 176,a,88,a,36
s_waitcnt lgkmcnt(4)
MV 180,a,92,a,32
MV 184,a,92,a,36
s_waitcnt vmcnt(0)
s_barrier
s_waitcnt lgkmcnt(3)
MV 156,a,112,a,40
ds_read_b128 a[80:83], v243 offset:49152
MV 160,a,112,a,44
ds_read_b128 a[84:87], v243 offset:50176
s_waitcnt lgkmcnt(4)
MV 164,a,116,a,40
ds_read_b128 a[88:91], v243 offset:51200
MV 168,a,116,a,44
ds_read_b128 a[92:95], v243 offset:52224
s_waitcnt lgkmcnt(5)
MV 172,a,120,a,40
MV 176,a,120,a,44
s_waitcnt lgkmcnt(4)
MV 180,a,124,a,40
MV 184,a,124,a,44
s_waitcnt lgkmcnt(3)
MV 156,a,80,a,48
ds_read_b128 a[112:115], v243 offset:57344
MV 160,a,80,a,52
ds_read_b128 a[116:119], v243 offset:58368
s_waitcnt lgkmcnt(4)
MV 164,a,84,a,48
ds_read_b128 a[120:123], v243 offset:59392
MV 168,a,84,a,52
ds_read_b128 a[124:127], v243 offset:60416
s_waitcnt lgkmcnt(5)
MV 172,a,88,a,48
MV 176,a,88,a,52
s_waitcnt lgkmcnt(4)
MV 180,a,92,a,48
MV 184,a,92,a,52
s_waitcnt lgkmcnt(3)
MV 156,a,112,a,56
ds_read_b128 a[64:67], v242 offset:16384
MV 160,a,112,a,60
ds_read_b128 a[68:71], v242 offset:17408
s_waitcnt lgkmcnt(4)
MV 164,a,116,a,56
ds_read_b128 a[72:75], v242 offset:18432
MV 168,a,116,a,60
ds_read_b128 a[76:79], v242 offset:19456
s_waitcnt lgkmcnt(5)
MV 172,a,120,a,56
MV 176,a,120,a,60
s_waitcnt lgkmcnt(4)
MV 180,a,124,a,56
MV 184,a,124,a,60
s_waitcnt lgkmcnt(3)
MV 124,a,64,a,16
ds_read_b128 a[96:99], v242 offset:24576
MV 128,a,64,a,20
ds_read_b128 a[100:103], v242 offset:25600
s_waitcnt lgkmcnt(4)
MV 132,a,68,a,16
ds_read_b128 a[104:107], v242 offset:26624
v_permlane16_swap_b32 v156, v164
MV 136,a,68,a,20
ds_read_b128 a[108:111], v242 offset:27648
v_permlane16_swap_b32 v157, v165
s_waitcnt lgkmcnt(5)
MV 140,a,72,a,16
v_permlane16_swap_b32 v158, v166
v_permlane16_swap_b32 v159, v167
MV 144,a,72,a,20
v_cvt_pk_bf16_f32 v156, v156, v157
v_cvt_pk_bf16_f32 v157, v158, v159
s_waitcnt lgkmcnt(4)
MV 148,a,76,a,16
v_cvt_pk_bf16_f32 v158, v164, v165
v_cvt_pk_bf16_f32 v159, v166, v167
MV 152,a,76,a,20
buffer_store_dwordx4 v[156:159], v238, s[52:55], s72 offen offset:0 sc1
v_permlane16_swap_b32 v172, v180
s_waitcnt lgkmcnt(3)
MV 124,a,96,a,24
ds_read_b128 a[64:67], v242 offset:32768
v_permlane16_swap_b32 v173, v181
MV 128,a,96,a,28
ds_read_b128 a[68:71], v242 offset:33792
v_permlane16_swap_b32 v174, v182
s_waitcnt lgkmcnt(4)
MV 132,a,100,a,24
ds_read_b128 a[72:75], v242 offset:34816
v_permlane16_swap_b32 v175, v183
MV 136,a,100,a,28
ds_read_b128 a[76:79], v242 offset:35840
v_cvt_pk_bf16_f32 v172, v172, v173
s_waitcnt lgkmcnt(5)
MV 140,a,104,a,24
v_cvt_pk_bf16_f32 v173, v174, v175
v_cvt_pk_bf16_f32 v174, v180, v181
MV 144,a,104,a,28
v_cvt_pk_bf16_f32 v175, v182, v183
buffer_store_dwordx4 v[172:175], v238, s[52:55], s72 offen offset:1024 sc1
s_waitcnt lgkmcnt(4)
MV 148,a,108,a,24
v_permlane16_swap_b32 v160, v168
v_permlane16_swap_b32 v161, v169
MV 152,a,108,a,28
v_permlane16_swap_b32 v162, v170
v_permlane16_swap_b32 v163, v171
s_waitcnt lgkmcnt(3)
MV 124,a,64,a,32
ds_read_b128 a[96:99], v242 offset:40960
v_cvt_pk_bf16_f32 v160, v160, v161
MV 128,a,64,a,36
ds_read_b128 a[100:103], v242 offset:41984
v_cvt_pk_bf16_f32 v161, v162, v163
s_waitcnt lgkmcnt(4)
MV 132,a,68,a,32
ds_read_b128 a[104:107], v242 offset:43008
v_cvt_pk_bf16_f32 v162, v168, v169
MV 136,a,68,a,36
ds_read_b128 a[108:111], v242 offset:44032
v_cvt_pk_bf16_f32 v163, v170, v171
s_waitcnt lgkmcnt(5)
MV 140,a,72,a,32
buffer_store_dwordx4 v[160:163], v238, s[52:55], s72 offen offset:2048 sc1
v_permlane16_swap_b32 v176, v184
MV 144,a,72,a,36
v_permlane16_swap_b32 v177, v185
v_permlane16_swap_b32 v178, v186
s_waitcnt lgkmcnt(4)
MV 148,a,76,a,32
v_permlane16_swap_b32 v179, v187
v_cvt_pk_bf16_f32 v176, v176, v177
MV 152,a,76,a,36
v_cvt_pk_bf16_f32 v177, v178, v179
v_cvt_pk_bf16_f32 v178, v184, v185
s_waitcnt lgkmcnt(3)
MV 124,a,96,a,40
ds_read_b128 a[64:67], v242 offset:49152
v_cvt_pk_bf16_f32 v179, v186, v187
MV 128,a,96,a,44
ds_read_b128 a[68:71], v242 offset:50176
buffer_store_dwordx4 v[176:179], v238, s[52:55], s72 offen offset:3072 sc1
s_waitcnt lgkmcnt(4)
MV 132,a,100,a,40
ds_read_b128 a[72:75], v242 offset:51200
MV 136,a,100,a,44
ds_read_b128 a[76:79], v242 offset:52224
s_waitcnt lgkmcnt(5)
MV 140,a,104,a,40
MV 144,a,104,a,44
s_waitcnt lgkmcnt(4)
MV 148,a,108,a,40
MV 152,a,108,a,44
s_waitcnt lgkmcnt(3)
MV 124,a,64,a,48
ds_read_b128 a[96:99], v242 offset:57344
MV 128,a,64,a,52
ds_read_b128 a[100:103], v242 offset:58368
s_waitcnt lgkmcnt(4)
MV 132,a,68,a,48
ds_read_b128 a[104:107], v242 offset:59392
MV 136,a,68,a,52
ds_read_b128 a[108:111], v242 offset:60416
s_waitcnt lgkmcnt(5)
MV 140,a,72,a,48
MV 144,a,72,a,52
s_waitcnt lgkmcnt(4)
MV 148,a,76,a,48
MV 152,a,76,a,52
s_waitcnt lgkmcnt(3)
MV 124,a,96,a,56
MV 128,a,96,a,60
s_waitcnt lgkmcnt(2)
MV 132,a,100,a,56
MV 136,a,100,a,60
s_waitcnt lgkmcnt(1)
MV 140,a,104,a,56
MV 144,a,104,a,60
s_waitcnt lgkmcnt(0)
MV 148,a,108,a,56
MV 152,a,108,a,60
s_lshl_b32 s72, s2, 14
s_mov_b32 s73, 400000
buffer_load_dwordx4 v[76:79], v238, s[52:55], s72 offen offset:0 sc1
buffer_load_dwordx4 v[80:83], v238, s[52:55], s72 offen offset:1024 sc1
buffer_load_dwordx4 v[84:87], v238, s[52:55], s72 offen offset:2048 sc1
buffer_load_dwordx4 v[88:91], v238, s[52:55], s72 offen offset:3072 sc1
v_permlane16_swap_b32 v124, v132
v_permlane16_swap_b32 v125, v133
v_permlane16_swap_b32 v126, v134
v_permlane16_swap_b32 v127, v135
v_permlane16_swap_b32 v140, v148
v_permlane16_swap_b32 v141, v149
v_permlane16_swap_b32 v142, v150
v_permlane16_swap_b32 v143, v151
v_permlane16_swap_b32 v128, v136
v_permlane16_swap_b32 v129, v137
v_permlane16_swap_b32 v130, v138
v_permlane16_swap_b32 v131, v139
v_permlane16_swap_b32 v144, v152
v_permlane16_swap_b32 v145, v153
v_permlane16_swap_b32 v146, v154
v_permlane16_swap_b32 v147, v155
v_fma_f32 v36, v124, v8, v36
v_fma_f32 v37, v125, v8, v37
v_fma_f32 v38, v126, v8, v38
v_fma_f32 v39, v127, v8, v39
v_fma_f32 v40, v132, v8, v40
v_fma_f32 v41, v133, v8, v41
v_fma_f32 v42, v134, v8, v42
v_fma_f32 v43, v135, v8, v43
v_fma_f32 v44, v140, v8, v44
v_fma_f32 v45, v141, v8, v45
v_fma_f32 v46, v142, v8, v46
v_fma_f32 v47, v143, v8, v47
v_fma_f32 v48, v148, v8, v48
v_fma_f32 v49, v149, v8, v49
v_fma_f32 v50, v150, v8, v50
v_fma_f32 v51, v151, v8, v51
v_fma_f32 v52, v128, v9, v52
v_fma_f32 v53, v129, v9, v53
v_fma_f32 v54, v130, v9, v54
v_fma_f32 v55, v131, v9, v55
v_fma_f32 v56, v136, v9, v56
v_fma_f32 v57, v137, v9, v57
v_fma_f32 v58, v138, v9, v58
v_fma_f32 v59, v139, v9, v59
v_fma_f32 v60, v144, v9, v60
v_fma_f32 v61, v145, v9, v61
v_fma_f32 v62, v146, v9, v62
v_fma_f32 v63, v147, v9, v63
v_fma_f32 v64, v152, v9, v64
v_fma_f32 v65, v153, v9, v65
v_fma_f32 v66, v154, v9, v66
v_fma_f32 v67, v155, v9, v67
s_branch L_xb_chk
L_xb:
buffer_load_dwordx4 v[76:79], v238, s[52:55], s72 offen offset:0 sc1
buffer_load_dwordx4 v[80:83], v238, s[52:55], s72 offen offset:1024 sc1
buffer_load_dwordx4 v[84:87], v238, s[52:55], s72 offen offset:2048 sc1
buffer_load_dwordx4 v[88:91], v238, s[52:55], s72 offen offset:3072 sc1
s_sub_u32 s73, s73, 1
s_cbranch_scc1 L_xb_done
L_xb_chk:
s_waitcnt vmcnt(3)
v_max3_u32 v228, v76, v77, v78
s_waitcnt vmcnt(2)
v_max3_u32 v228, v228, v79, v80
v_max3_u32 v228, v228, v81, v82
s_waitcnt vmcnt(1)
v_max3_u32 v228, v228, v83, v84
v_max3_u32 v228, v228, v85, v86
s_waitcnt vmcnt(0)
v_max3_u32 v228, v228, v87, v88
v_max3_u32 v228, v228, v89, v90
v_max_u32 v228, v228, v91
v_cmp_eq_u32 vcc, -1, v228
s_nop 4
s_cbranch_vccnz L_xb
L_xb_done:
s_waitcnt vmcnt(0)
s_add_u32 s72, s78, 0
v_lshlrev_b32 v92, 16, v76
v_and_b32 v93, 0xffff0000, v76
v_fmac_f32 v36, v92, v8
v_fmac_f32 v37, v93, v8
v_cvt_pk_bf16_f32 v192, v36, v37
v_lshlrev_b32 v92, 16, v77
v_and_b32 v93, 0xffff0000, v77
v_fmac_f32 v38, v92, v8
v_fmac_f32 v39, v93, v8
v_cvt_pk_bf16_f32 v193, v38, v39
v_lshlrev_b32 v92, 16, v78
v_and_b32 v93, 0xffff0000, v78
v_fmac_f32 v40, v92, v8
v_fmac_f32 v41, v93, v8
v_cvt_pk_bf16_f32 v194, v40, v41
v_lshlrev_b32 v92, 16, v79
v_and_b32 v93, 0xffff0000, v79
v_fmac_f32 v42, v92, v8
v_fmac_f32 v43, v93, v8
v_cvt_pk_bf16_f32 v195, v42, v43
buffer_store_dwordx4 v[192:195], v250, s[60:63], s72 offen offset:0 sc1
v_lshlrev_b32 v92, 16, v80
v_and_b32 v93, 0xffff0000, v80
v_fmac_f32 v44, v92, v8
v_fmac_f32 v45, v93, v8
v_cvt_pk_bf16_f32 v196, v44, v45
v_lshlrev_b32 v92, 16, v81
v_and_b32 v93, 0xffff0000, v81
v_fmac_f32 v46, v92, v8
v_fmac_f32 v47, v93, v8
v_cvt_pk_bf16_f32 v197, v46, v47
v_lshlrev_b32 v92, 16, v82
v_and_b32 v93, 0xffff0000, v82
v_fmac_f32 v48, v92, v8
v_fmac_f32 v49, v93, v8
v_cvt_pk_bf16_f32 v198, v48, v49
v_lshlrev_b32 v92, 16, v83
v_and_b32 v93, 0xffff0000, v83
v_fmac_f32 v50, v92, v8
v_fmac_f32 v51, v93, v8
v_cvt_pk_bf16_f32 v199, v50, v51
buffer_store_dwordx4 v[196:199], v250, s[60:63], s72 offen offset:64 sc1
s_add_u32 s72, s78, 32768
v_lshlrev_b32 v92, 16, v84
v_and_b32 v93, 0xffff0000, v84
v_fmac_f32 v52, v92, v9
v_fmac_f32 v53, v93, v9
v_cvt_pk_bf16_f32 v200, v52, v53
v_lshlrev_b32 v92, 16, v85
v_and_b32 v93, 0xffff0000, v85
v_fmac_f32 v54, v92, v9
v_fmac_f32 v55, v93, v9
v_cvt_pk_bf16_f32 v201, v54, v55
v_lshlrev_b32 v92, 16, v86
v_and_b32 v93, 0xffff0000, v86
v_fmac_f32 v56, v92, v9
v_fmac_f32 v57, v93, v9
v_cvt_pk_bf16_f32 v202, v56, v57
v_lshlrev_b32 v92, 16, v87
v_and_b32 v93, 0xffff0000, v87
v_fmac_f32 v58, v92, v9
v_fmac_f32 v59, v93, v9
v_cvt_pk_bf16_f32 v203, v58, v59
buffer_store_dwordx4 v[200:203], v250, s[60:63], s72 offen offset:0 sc1
v_lshlrev_b32 v92, 16, v88
v_and_b32 v93, 0xffff0000, v88
v_fmac_f32 v60, v92, v9
v_fmac_f32 v61, v93, v9
v_cvt_pk_bf16_f32 v204, v60, v61
v_lshlrev_b32 v92, 16, v89
v_and_b32 v93, 0xffff0000, v89
v_fmac_f32 v62, v92, v9
v_fmac_f32 v63, v93, v9
v_cvt_pk_bf16_f32 v205, v62, v63
v_lshlrev_b32 v92, 16, v90
v_and_b32 v93, 0xffff0000, v90
v_fmac_f32 v64, v92, v9
v_fmac_f32 v65, v93, v9
v_cvt_pk_bf16_f32 v206, v64, v65
v_lshlrev_b32 v92, 16, v91
v_and_b32 v93, 0xffff0000, v91
v_fmac_f32 v66, v92, v9
v_fmac_f32 v67, v93, v9
v_cvt_pk_bf16_f32 v207, v66, v67
buffer_store_dwordx4 v[204:207], v250, s[60:63], s72 offen offset:64 sc1
L_end:
s_endpgm
L_p3_pmask:
s_nop 7
v_add_u32 v246, 0, v13
v_cmp_gt_i32_e64 s[84:85], 0, v246
v_cmp_gt_i32_e64 s[86:87], 1, v246
v_cmp_gt_i32_e64 s[88:89], 2, v246
v_cmp_gt_i32_e64 s[90:91], 3, v246
v_cndmask_b32_e64 v96, v96, v14, s[84:85]
v_cndmask_b32_e64 v97, v97, v14, s[86:87]
v_cndmask_b32_e64 v98, v98, v14, s[88:89]
v_cndmask_b32_e64 v99, v99, v14, s[90:91]
v_add_u32 v247, -16, v13
v_cmp_gt_i32_e64 s[92:93], 0, v247
v_cmp_gt_i32_e64 s[94:95], 1, v247
v_cmp_gt_i32_e64 s[96:97], 2, v247
v_cmp_gt_i32_e64 s[98:99], 3, v247
v_cndmask_b32_e64 v100, v100, v14, s[92:93]
v_cndmask_b32_e64 v101, v101, v14, s[94:95]
v_cndmask_b32_e64 v102, v102, v14, s[96:97]
v_cndmask_b32_e64 v103, v103, v14, s[98:99]
v_add_u32 v246, -32, v13
v_cmp_gt_i32_e64 s[84:85], 0, v246
v_cmp_gt_i32_e64 s[86:87], 1, v246
v_cmp_gt_i32_e64 s[88:89], 2, v246
v_cmp_gt_i32_e64 s[90:91], 3, v246
v_cndmask_b32_e64 v128, v128, v14, s[84:85]
v_cndmask_b32_e64 v129, v129, v14, s[86:87]
v_cndmask_b32_e64 v130, v130, v14, s[88:89]
v_cndmask_b32_e64 v131, v131, v14, s[90:91]
v_add_u32 v247, -48, v13
v_cmp_gt_i32_e64 s[92:93], 0, v247
v_cmp_gt_i32_e64 s[94:95], 1, v247
v_cmp_gt_i32_e64 s[96:97], 2, v247
v_cmp_gt_i32_e64 s[98:99], 3, v247
v_cndmask_b32_e64 v132, v132, v14, s[92:93]
v_cndmask_b32_e64 v133, v133, v14, s[94:95]
v_cndmask_b32_e64 v134, v134, v14, s[96:97]
v_cndmask_b32_e64 v135, v135, v14, s[98:99]
s_branch L_p3_pmask_ret
L_p3_mxm_top:
s_waitcnt lgkmcnt(0)
v_xor_b32 v11, 0x8000, v11
v_mfma_f32_16x16x32_bf16 v[80:83], a[128:131], v[16:19], 0
s_add_u32 m0, s73, 16384
ds_read_b128 a[192:195], v11 offset:0
v_mfma_f32_16x16x32_bf16 v[88:91], a[128:131], v[32:35], 0
v_exp_f32 v176, v176
MV 80,a,132,v,20
v_exp_f32 v177, v177
MV 88,a,132,v,36
ds_read_b128 a[196:199], v11 offset:1024
buffer_load_dwordx4 v12, s[56:59], s71 offen offset:0 sc1 lds
MV 80,a,136,v,24
v_exp_f32 v178, v178
MV 88,a,136,v,40
v_add_f32 v2, v2, v176
v_add_f32 v2, v2, v177
MV 80,a,140,v,28
ds_read_b128 a[200:203], v11 offset:2048
ds_read_b128 a[204:207], v11 offset:3072
MV 88,a,140,v,44
v_exp_f32 v179, v179
v_mfma_f32_16x16x32_bf16 v[84:87], a[144:147], v[16:19], 0
ds_read_b128 a[208:211], v11 offset:4096
v_cvt_pk_bf16_f32 v176, v176, v177
v_mfma_f32_16x16x32_bf16 v[92:95], a[144:147], v[32:35], 0
v_exp_f32 v180, v180
MV 84,a,148,v,20
v_add_f32 v2, v2, v178
v_add_f32 v2, v2, v179
MV 92,a,148,v,36
v_exp_f32 v181, v181
MV 84,a,152,v,24
buffer_load_dwordx4 v12, s[56:59], s71 offen offset:1024 sc1 lds
v_cvt_pk_bf16_f32 v177, v178, v179
MV 92,a,152,v,40
v_exp_f32 v182, v182
MV 84,a,156,v,28
ds_read_b128 a[212:215], v11 offset:5120
v_add_f32 v2, v2, v180
MV 92,a,156,v,44
ds_read_b128 a[216:219], v11 offset:6144
v_add_f32 v2, v2, v181
v_mfma_f32_16x16x32_bf16 v[112:115], a[160:163], v[16:19], 0
v_exp_f32 v183, v183
v_mfma_f32_16x16x32_bf16 v[120:123], a[160:163], v[32:35], 0
ds_read_b128 a[220:223], v11 offset:7168
v_cvt_pk_bf16_f32 v178, v180, v181
MV 112,a,164,v,20
v_exp_f32 v184, v184
MV 120,a,164,v,36
v_add_f32 v2, v2, v182
v_add_f32 v2, v2, v183
MV 112,a,168,v,24
ds_read_b128 a[224:227], v11 offset:8192
buffer_load_dwordx4 v12, s[56:59], s71 offen offset:2048 sc1 lds
MV 120,a,168,v,40
v_exp_f32 v185, v185
MV 112,a,172,v,28
ds_read_b128 a[228:231], v11 offset:9216
v_cvt_pk_bf16_f32 v179, v182, v183
MV 120,a,172,v,44
v_exp_f32 v186, v186
v_mfma_f32_16x16x32_bf16 v[116:119], a[176:179], v[16:19], 0
v_add_f32 v3, v3, v184
v_add_f32 v3, v3, v185
v_mfma_f32_16x16x32_bf16 v[124:127], a[176:179], v[32:35], 0
v_exp_f32 v187, v187
MV 116,a,180,v,20
ds_read_b128 a[232:235], v11 offset:10240
v_cvt_pk_bf16_f32 v184, v184, v185
MV 124,a,180,v,36
v_exp_f32 v188, v188
MV 116,a,184,v,24
ds_read_b128 a[236:239], v11 offset:11264
v_add_f32 v3, v3, v186
MV 124,a,184,v,40
buffer_load_dwordx4 v12, s[56:59], s71 offen offset:3072 sc1 lds
v_add_f32 v3, v3, v187
MV 116,a,188,v,28
v_exp_f32 v189, v189
MV 124,a,188,v,44
ds_read_b128 a[240:243], v11 offset:12288
ds_read_b128 a[244:247], v11 offset:13312
ds_read_b128 a[248:251], v11 offset:14336
ds_read_b128 a[252:255], v11 offset:15360
s_add_u32 s71, s71, 16384
s_xor_b32 s73, s73, 0x8000
v_cvt_pk_bf16_f32 v185, v186, v187
v_exp_f32 v190, v190
v_add_f32 v3, v3, v188
v_add_f32 v3, v3, v189
v_exp_f32 v191, v191
v_cvt_pk_bf16_f32 v186, v188, v189
v_exp_f32 v200, v200
v_add_f32 v3, v3, v190
v_add_f32 v3, v3, v191
v_exp_f32 v201, v201
v_cvt_pk_bf16_f32 v187, v190, v191
v_exp_f32 v202, v202
v_add_u32 v246, 0, v13
v_cmp_gt_i32_e64 s[84:85], 0, v246
v_add_f32 v5, v5, v200
v_cmp_gt_i32_e64 s[86:87], 1, v246
v_cmp_gt_i32_e64 s[88:89], 2, v246
v_add_f32 v5, v5, v201
v_exp_f32 v203, v203
v_cmp_gt_i32_e64 s[90:91], 3, v246
v_cndmask_b32_e64 v80, v80, v14, s[84:85]
v_cvt_pk_bf16_f32 v200, v200, v201
v_exp_f32 v204, v204
v_cndmask_b32_e64 v81, v81, v14, s[86:87]
v_cndmask_b32_e64 v82, v82, v14, s[88:89]
v_add_f32 v5, v5, v202
v_add_f32 v5, v5, v203
v_cndmask_b32_e64 v83, v83, v14, s[90:91]
v_exp_f32 v205, v205
v_cvt_pk_bf16_f32 v201, v202, v203
v_add_u32 v247, -16, v13
v_cmp_gt_i32_e64 s[92:93], 0, v247
v_exp_f32 v206, v206
v_add_f32 v5, v5, v204
v_cmp_gt_i32_e64 s[94:95], 1, v247
v_cmp_gt_i32_e64 s[96:97], 2, v247
v_add_f32 v5, v5, v205
v_exp_f32 v207, v207
v_cmp_gt_i32_e64 s[98:99], 3, v247
v_cndmask_b32_e64 v84, v84, v14, s[92:93]
v_cvt_pk_bf16_f32 v202, v204, v205
v_add_f32 v5, v5, v206
v_cndmask_b32_e64 v85, v85, v14, s[94:95]
v_cndmask_b32_e64 v86, v86, v14, s[96:97]
v_add_f32 v5, v5, v207
v_cvt_pk_bf16_f32 v203, v206, v207
v_cndmask_b32_e64 v87, v87, v14, s[98:99]
s_waitcnt vmcnt(16) lgkmcnt(0)
MA 0,a,192,v,144
s_barrier
v_xor_b32 v10, 0x8000, v10
MA 32,a,192,v,152
s_add_u32 m0, s72, 16384
ds_read_b128 a[128:131], v10 offset:0
MA 4,a,196,v,144
buffer_load_dwordx4 v12, s[52:55], s71 offen offset:0 sc1 lds
v_lshrrev_b32 v249, 2, v1
MA 36,a,196,v,152
ds_read_b128 a[132:135], v10 offset:1024
v_and_b32 v248, 7, v249
MA 8,a,200,v,144
v_exp_f32 v80, v80
MA 40,a,200,v,152
v_lshlrev_b32 v249, 8, v249
v_and_b32 v250, 3, v1
MA 12,a,204,v,144
ds_read_b128 a[136:139], v10 offset:2048
v_lshl_add_u32 v249, v250, 3, v249
MA 44,a,204,v,152
v_exp_f32 v81, v81
MA 16,a,208,v,144
v_add_u32 v246, -32, v13
s_lshl_b32 s36, s3, 13
MA 48,a,208,v,152
s_add_u32 s36, s36, 131072
v_add_u32 v249, s36, v249
MA 20,a,212,v,144
v_exp_f32 v82, v82
MA 52,a,212,v,152
ds_read_b128 a[140:143], v10 offset:3072
s_nop 0
MA 24,a,216,v,144
v_cmp_gt_i32_e64 s[84:85], 0, v246
v_xor_b32 v250, 0, v248
MA 56,a,216,v,152
ds_read_b128 a[144:147], v10 offset:4096
v_lshl_add_u32 v250, v250, 5, v249
MA 28,a,220,v,144
v_exp_f32 v83, v83
MA 60,a,220,v,152
v_cmp_gt_i32_e64 s[86:87], 1, v246
TR 96,250,0
MA 124,a,220,v,168
TR 98,250,4096
v_xor_b32 v250, 1, v248
MA 120,a,216,v,168
ds_read_b128 a[148:151], v10 offset:5120
buffer_load_dwordx4 v12, s[52:55], s71 offen offset:1024 sc1 lds
MA 116,a,212,v,168
v_cvt_pk_bf16_f32 v80, v80, v81
v_lshl_add_u32 v250, v250, 5, v249
MA 112,a,208,v,168
TR 100,250,0
TR 102,250,4096
MA 108,a,204,v,168
v_exp_f32 v84, v84
MA 104,a,200,v,168
v_cmp_gt_i32_e64 s[88:89], 2, v246
v_xor_b32 v250, 2, v248
MA 100,a,196,v,168
ds_read_b128 a[152:155], v10 offset:6144
v_lshl_add_u32 v250, v250, 5, v249
MA 96,a,192,v,168
v_cmp_gt_i32_e64 s[90:91], 3, v246
TR 104,250,0
MA 0,a,224,v,176
v_exp_f32 v85, v85
MA 32,a,224,v,184
ds_read_b128 a[156:159], v10 offset:7168
TR 106,250,4096
MA 4,a,228,v,176
v_cvt_pk_bf16_f32 v81, v82, v83
v_xor_b32 v250, 3, v248
MA 36,a,228,v,184
v_cndmask_b32_e64 v112, v112, v14, s[84:85]
v_lshl_add_u32 v250, v250, 5, v249
MA 8,a,232,v,176
ds_read_b128 a[160:163], v10 offset:8192
TR 108,250,0
MA 40,a,232,v,184
TR 110,250,4096
v_xor_b32 v250, 4, v248
MA 12,a,236,v,176
v_exp_f32 v86, v86
MA 44,a,236,v,184
ds_read_b128 a[164:167], v10 offset:9216
v_lshl_add_u32 v250, v250, 5, v249
MA 16,a,240,v,176
buffer_load_dwordx4 v12, s[52:55], s71 offen offset:2048 sc1 lds
v_cndmask_b32_e64 v113, v113, v14, s[86:87]
MA 48,a,240,v,184
TR 128,250,0
TR 130,250,4096
MA 20,a,244,v,176
v_exp_f32 v87, v87
MA 52,a,244,v,184
ds_read_b128 a[168:171], v10 offset:10240
v_xor_b32 v250, 5, v248
MA 24,a,248,v,176
v_cvt_pk_bf16_f32 v82, v84, v85
v_cndmask_b32_e64 v114, v114, v14, s[88:89]
MA 56,a,248,v,184
v_lshl_add_u32 v250, v250, 5, v249
TR 132,250,0
MA 28,a,252,v,176
v_cndmask_b32_e64 v115, v115, v14, s[90:91]
TR 134,250,4096
MA 60,a,252,v,184
v_exp_f32 v88, v88
MA 124,a,252,v,200
ds_read_b128 a[172:175], v10 offset:11264
v_xor_b32 v250, 6, v248
MA 120,a,248,v,200
v_lshl_add_u32 v250, v250, 5, v249
TR 136,250,0
MA 116,a,244,v,200
ds_read_b128 a[176:179], v10 offset:12288
TR 138,250,4096
MA 112,a,240,v,200
v_exp_f32 v89, v89
MA 108,a,236,v,200
v_add_u32 v247, -48, v13
v_xor_b32 v250, 7, v248
MA 104,a,232,v,200
v_cvt_pk_bf16_f32 v83, v86, v87
v_lshl_add_u32 v250, v250, 5, v249
MA 100,a,228,v,200
ds_read_b128 a[180:183], v10 offset:13312
TR 140,250,0
MA 96,a,224,v,200
ds_read_b128 a[184:187], v10 offset:14336
ds_read_b128 a[188:191], v10 offset:15360
buffer_load_dwordx4 v12, s[52:55], s71 offen offset:3072 sc1 lds
s_xor_b32 s72, s72, 0x8000
v_exp_f32 v90, v90
v_cmp_gt_i32_e64 s[92:93], 0, v247
TR 142,250,4096
s_add_u32 s32, s40, 100663296
s_addc_u32 s33, s41, 0
v_exp_f32 v91, v91
v_cmp_gt_i32_e64 s[94:95], 1, v247
s_mov_b32 s34, 8388608
s_mov_b32 s35, 0x20000
s_and_b32 s36, s2, 7
s_lshl_b32 s36, s36, 20
s_lshr_b32 s37, s2, 3
v_cvt_pk_bf16_f32 v88, v88, v89
v_cmp_gt_i32_e64 s[96:97], 2, v247
s_lshl_b32 s37, s37, 15
v_exp_f32 v92, v92
s_add_u32 s36, s36, s37
s_lshl_b32 s37, s3, 12
v_cmp_gt_i32_e64 s[98:99], 3, v247
s_add_u32 s36, s36, s37
v_exp_f32 v93, v93
s_add_u32 s37, s36, 4096
s_waitcnt lgkmcnt(15)
buffer_store_dwordx4 v[96:99], v12, s[32:35], s36 offen offset:0 sc1
v_cndmask_b32_e64 v116, v116, v14, s[92:93]
buffer_store_dwordx4 v[100:103], v12, s[32:35], s36 offen offset:1024 sc1
v_cvt_pk_bf16_f32 v89, v90, v91
buffer_store_dwordx4 v[104:107], v12, s[32:35], s36 offen offset:2048 sc1
buffer_store_dwordx4 v[108:111], v12, s[32:35], s36 offen offset:3072 sc1
s_waitcnt lgkmcnt(12)
buffer_store_dwordx4 v[128:131], v12, s[32:35], s37 offen offset:0 sc1
v_exp_f32 v94, v94
v_cndmask_b32_e64 v117, v117, v14, s[94:95]
s_waitcnt lgkmcnt(9)
buffer_store_dwordx4 v[132:135], v12, s[32:35], s37 offen offset:1024 sc1
s_waitcnt lgkmcnt(5)
buffer_store_dwordx4 v[136:139], v12, s[32:35], s37 offen offset:2048 sc1
s_waitcnt lgkmcnt(0)
buffer_store_dwordx4 v[140:143], v12, s[32:35], s37 offen offset:3072 sc1
v_exp_f32 v95, v95
v_cndmask_b32_e64 v118, v118, v14, s[96:97]
v_lshlrev_b32 v232, 4, v1
v_mov_b32 v235, 0
buffer_load_ushort v234, v235, s[28:31], s42 offen
v_cvt_pk_bf16_f32 v90, v92, v93
v_cndmask_b32_e64 v119, v119, v14, s[98:99]
buffer_load_dwordx4 v[210:213], v232, s[16:19], 0 offen offset:0
buffer_load_dwordx4 v[216:219], v232, s[16:19], 0 offen offset:1024
v_cvt_pk_bf16_f32 v91, v94, v95
buffer_load_dwordx4 v[222:225], v232, s[16:19], 0 offen offset:2048
buffer_load_dwordx4 v[228:231], v232, s[16:19], 0 offen offset:3072
s_branch L_p3_eps
L_fallback:
s_mov_b32 s81, 0
s_mov_b32 s74, s77
s_mov_b32 s73, s100
s_sub_u32 s72, 15, s70
v_mov_b32 v10, v15
v_add_u32 v11, 16384, v15
s_nop 15
L_fb_set:
s_lshl_b32 s72, s72, 7
s_mov_b32 s71, 0
v_accvgpr_write_b32 a0, 0
v_accvgpr_write_b32 a1, 0
v_accvgpr_write_b32 a2, 0
v_accvgpr_write_b32 a3, 0
v_accvgpr_write_b32 a4, 0
v_accvgpr_write_b32 a5, 0
v_accvgpr_write_b32 a6, 0
v_accvgpr_write_b32 a7, 0
v_accvgpr_write_b32 a8, 0
v_accvgpr_write_b32 a9, 0
v_accvgpr_write_b32 a10, 0
v_accvgpr_write_b32 a11, 0
v_accvgpr_write_b32 a12, 0
v_accvgpr_write_b32 a13, 0
v_accvgpr_write_b32 a14, 0
v_accvgpr_write_b32 a15, 0
v_accvgpr_write_b32 a16, 0
v_accvgpr_write_b32 a17, 0
v_accvgpr_write_b32 a18, 0
v_accvgpr_write_b32 a19, 0
v_accvgpr_write_b32 a20, 0
v_accvgpr_write_b32 a21, 0
v_accvgpr_write_b32 a22, 0
v_accvgpr_write_b32 a23, 0
v_accvgpr_write_b32 a24, 0
v_accvgpr_write_b32 a25, 0
v_accvgpr_write_b32 a26, 0
v_accvgpr_write_b32 a27, 0
v_accvgpr_write_b32 a28, 0
v_accvgpr_write_b32 a29, 0
v_accvgpr_write_b32 a30, 0
v_accvgpr_write_b32 a31, 0
v_accvgpr_write_b32 a32, 0
v_accvgpr_write_b32 a33, 0
v_accvgpr_write_b32 a34, 0
v_accvgpr_write_b32 a35, 0
v_accvgpr_write_b32 a36, 0
v_accvgpr_write_b32 a37, 0
v_accvgpr_write_b32 a38, 0
v_accvgpr_write_b32 a39, 0
v_accvgpr_write_b32 a40, 0
v_accvgpr_write_b32 a41, 0
v_accvgpr_write_b32 a42, 0
v_accvgpr_write_b32 a43, 0
v_accvgpr_write_b32 a44, 0
v_accvgpr_write_b32 a45, 0
v_accvgpr_write_b32 a46, 0
v_accvgpr_write_b32 a47, 0
v_accvgpr_write_b32 a48, 0
v_accvgpr_write_b32 a49, 0
v_accvgpr_write_b32 a50, 0
v_accvgpr_write_b32 a51, 0
v_accvgpr_write_b32 a52, 0
v_accvgpr_write_b32 a53, 0
v_accvgpr_write_b32 a54, 0
v_accvgpr_write_b32 a55, 0
v_accvgpr_write_b32 a56, 0
v_accvgpr_write_b32 a57, 0
v_accvgpr_write_b32 a58, 0
v_accvgpr_write_b32 a59, 0
v_accvgpr_write_b32 a60, 0
v_accvgpr_write_b32 a61, 0
v_accvgpr_write_b32 a62, 0
v_accvgpr_write_b32 a63, 0
v_mov_b32 v2, 0
v_mov_b32 v96, v14
v_mov_b32 v3, 0
v_mov_b32 v97, v14
L_fb_tile:
s_waitcnt vmcnt(0) lgkmcnt(0)
s_barrier
s_mov_b32 m0, s68
s_add_u32 s80, s71, 16384
buffer_load_dwordx4 v12, s[52:55], s71 offen offset:0 sc1 lds
buffer_load_dwordx4 v12, s[52:55], s71 offen offset:1024 sc1 lds
buffer_load_dwordx4 v12, s[52:55], s71 offen offset:2048 sc1 lds
buffer_load_dwordx4 v12, s[52:55], s71 offen offset:3072 sc1 lds
s_add_u32 m0, s68, 16384
s_nop 0
buffer_load_dwordx4 v12, s[56:59], s80 offen offset:0 sc1 lds
buffer_load_dwordx4 v12, s[56:59], s80 offen offset:1024 sc1 lds
buffer_load_dwordx4 v12, s[56:59], s80 offen offset:2048 sc1 lds
buffer_load_dwordx4 v12, s[56:59], s80 offen offset:3072 sc1 lds
s_waitcnt vmcnt(0)
s_barrier
ds_read_b128 a[128:131], v10 offset:0
ds_read_b128 a[132:135], v10 offset:1024
ds_read_b128 a[136:139], v10 offset:2048
ds_read_b128 a[140:143], v10 offset:3072
ds_read_b128 a[144:147], v10 offset:4096
ds_read_b128 a[148:151], v10 offset:5120
ds_read_b128 a[152:155], v10 offset:6144
ds_read_b128 a[156:159], v10 offset:7168
ds_read_b128 a[160:163], v10 offset:8192
ds_read_b128 a[164:167], v10 offset:9216
ds_read_b128 a[168:171], v10 offset:10240
ds_read_b128 a[172:175], v10 offset:11264
ds_read_b128 a[176:179], v10 offset:12288
ds_read_b128 a[180:183], v10 offset:13312
ds_read_b128 a[184:187], v10 offset:14336
ds_read_b128 a[188:191], v10 offset:15360
s_waitcnt lgkmcnt(0)
ds_read_b128 a[192:195], v11 offset:0
ds_read_b128 a[196:199], v11 offset:1024
ds_read_b128 a[200:203], v11 offset:2048
ds_read_b128 a[204:207], v11 offset:3072
ds_read_b128 a[208:211], v11 offset:4096
ds_read_b128 a[212:215], v11 offset:5120
ds_read_b128 a[216:219], v11 offset:6144
ds_read_b128 a[220:223], v11 offset:7168
ds_read_b128 a[224:227], v11 offset:8192
ds_read_b128 a[228:231], v11 offset:9216
ds_read_b128 a[232:235], v11 offset:10240
ds_read_b128 a[236:239], v11 offset:11264
ds_read_b128 a[240:243], v11 offset:12288
ds_read_b128 a[244:247], v11 offset:13312
ds_read_b128 a[248:251], v11 offset:14336
ds_read_b128 a[252:255], v11 offset:15360
v_mfma_f32_16x16x32_bf16 v[80:83], a[128:131], v[16:19], 0
v_mfma_f32_16x16x32_bf16 v[88:91], a[128:131], v[32:35], 0
MV 80,a,132,v,20
MV 88,a,132,v,36
MV 80,a,136,v,24
MV 88,a,136,v,40
MV 80,a,140,v,28
MV 88,a,140,v,44
v_mfma_f32_16x16x32_bf16 v[84:87], a[144:147], v[16:19], 0
v_mfma_f32_16x16x32_bf16 v[92:95], a[144:147], v[32:35], 0
MV 84,a,148,v,20
MV 92,a,148,v,36
MV 84,a,152,v,24
MV 92,a,152,v,40
MV 84,a,156,v,28
MV 92,a,156,v,44
v_mfma_f32_16x16x32_bf16 v[112:115], a[160:163], v[16:19], 0
v_mfma_f32_16x16x32_bf16 v[120:123], a[160:163], v[32:35], 0
MV 112,a,164,v,20
MV 120,a,164,v,36
MV 112,a,168,v,24
MV 120,a,168,v,40
MV 112,a,172,v,28
MV 120,a,172,v,44
v_mfma_f32_16x16x32_bf16 v[116:119], a[176:179], v[16:19], 0
v_mfma_f32_16x16x32_bf16 v[124:127], a[176:179], v[32:35], 0
MV 116,a,180,v,20
MV 124,a,180,v,36
MV 116,a,184,v,24
MV 124,a,184,v,40
MV 116,a,188,v,28
MV 124,a,188,v,44
v_add_u32 v246, s72, v13
v_add_u32 v246, 0, v246
v_cmp_gt_i32_e64 s[84:85], 0, v246
v_cmp_gt_i32_e64 s[86:87], 1, v246
v_cmp_gt_i32_e64 s[88:89], 2, v246
v_cmp_gt_i32_e64 s[90:91], 3, v246
v_cndmask_b32_e64 v80, v80, v14, s[84:85]
v_cndmask_b32_e64 v81, v81, v14, s[86:87]
v_cndmask_b32_e64 v82, v82, v14, s[88:89]
v_cndmask_b32_e64 v83, v83, v14, s[90:91]
v_add_u32 v247, s72, v239
v_add_u32 v247, 0, v247
v_cmp_gt_i32_e64 s[92:93], 0, v247
v_cmp_gt_i32_e64 s[94:95], 1, v247
v_cmp_gt_i32_e64 s[96:97], 2, v247
v_cmp_gt_i32_e64 s[98:99], 3, v247
v_cndmask_b32_e64 v88, v88, v14, s[92:93]
v_cndmask_b32_e64 v89, v89, v14, s[94:95]
v_cndmask_b32_e64 v90, v90, v14, s[96:97]
v_cndmask_b32_e64 v91, v91, v14, s[98:99]
v_add_u32 v246, s72, v13
v_add_u32 v246, -16, v246
v_cmp_gt_i32_e64 s[84:85], 0, v246
v_cmp_gt_i32_e64 s[86:87], 1, v246
v_cmp_gt_i32_e64 s[88:89], 2, v246
v_cmp_gt_i32_e64 s[90:91], 3, v246
v_cndmask_b32_e64 v84, v84, v14, s[84:85]
v_cndmask_b32_e64 v85, v85, v14, s[86:87]
v_cndmask_b32_e64 v86, v86, v14, s[88:89]
v_cndmask_b32_e64 v87, v87, v14, s[90:91]
v_add_u32 v247, s72, v239
v_add_u32 v247, -16, v247
v_cmp_gt_i32_e64 s[92:93], 0, v247
v_cmp_gt_i32_e64 s[94:95], 1, v247
v_cmp_gt_i32_e64 s[96:97], 2, v247
v_cmp_gt_i32_e64 s[98:99], 3, v247
v_cndmask_b32_e64 v92, v92, v14, s[92:93]
v_cndmask_b32_e64 v93, v93, v14, s[94:95]
v_cndmask_b32_e64 v94, v94, v14, s[96:97]
v_cndmask_b32_e64 v95, v95, v14, s[98:99]
v_add_u32 v246, s72, v13
v_add_u32 v246, -32, v246
v_cmp_gt_i32_e64 s[84:85], 0, v246
v_cmp_gt_i32_e64 s[86:87], 1, v246
v_cmp_gt_i32_e64 s[88:89], 2, v246
v_cmp_gt_i32_e64 s[90:91], 3, v246
v_cndmask_b32_e64 v112, v112, v14, s[84:85]
v_cndmask_b32_e64 v113, v113, v14, s[86:87]
v_cndmask_b32_e64 v114, v114, v14, s[88:89]
v_cndmask_b32_e64 v115, v115, v14, s[90:91]
v_add_u32 v247, s72, v239
v_add_u32 v247, -32, v247
v_cmp_gt_i32_e64 s[92:93], 0, v247
v_cmp_gt_i32_e64 s[94:95], 1, v247
v_cmp_gt_i32_e64 s[96:97], 2, v247
v_cmp_gt_i32_e64 s[98:99], 3, v247
v_cndmask_b32_e64 v120, v120, v14, s[92:93]
v_cndmask_b32_e64 v121, v121, v14, s[94:95]
v_cndmask_b32_e64 v122, v122, v14, s[96:97]
v_cndmask_b32_e64 v123, v123, v14, s[98:99]
v_add_u32 v246, s72, v13
v_add_u32 v246, -48, v246
v_cmp_gt_i32_e64 s[84:85], 0, v246
v_cmp_gt_i32_e64 s[86:87], 1, v246
v_cmp_gt_i32_e64 s[88:89], 2, v246
v_cmp_gt_i32_e64 s[90:91], 3, v246
v_cndmask_b32_e64 v116, v116, v14, s[84:85]
v_cndmask_b32_e64 v117, v117, v14, s[86:87]
v_cndmask_b32_e64 v118, v118, v14, s[88:89]
v_cndmask_b32_e64 v119, v119, v14, s[90:91]
v_add_u32 v247, s72, v239
v_add_u32 v247, -48, v247
v_cmp_gt_i32_e64 s[92:93], 0, v247
v_cmp_gt_i32_e64 s[94:95], 1, v247
v_cmp_gt_i32_e64 s[96:97], 2, v247
v_cmp_gt_i32_e64 s[98:99], 3, v247
v_cndmask_b32_e64 v124, v124, v14, s[92:93]
v_cndmask_b32_e64 v125, v125, v14, s[94:95]
v_cndmask_b32_e64 v126, v126, v14, s[96:97]
v_cndmask_b32_e64 v127, v127, v14, s[98:99]
v_mov_b32 v242, v96
v_max3_f32 v242, v242, v80, v81
v_max3_f32 v242, v242, v82, v83
v_max3_f32 v242, v242, v84, v85
v_max3_f32 v242, v242, v86, v87
v_max3_f32 v242, v242, v112, v113
v_max3_f32 v242, v242, v114, v115
v_max3_f32 v242, v242, v116, v117
v_max3_f32 v242, v242, v118, v119
v_mov_b32 v243, v242
s_nop 1
v_permlane32_swap_b32 v242, v243
v_max_f32 v242, v242, v243
v_mov_b32 v243, v242
s_nop 1
v_permlane16_swap_b32 v242, v243
v_max_f32 v242, v242, v243
v_sub_f32 v98, v96, v242
v_exp_f32 v98, v98
v_mov_b32 v96, v242
v_sub_f32 v80, v80, v242
v_sub_f32 v81, v81, v242
v_sub_f32 v82, v82, v242
v_sub_f32 v83, v83, v242
v_sub_f32 v84, v84, v242
v_sub_f32 v85, v85, v242
v_sub_f32 v86, v86, v242
v_sub_f32 v87, v87, v242
v_sub_f32 v112, v112, v242
v_sub_f32 v113, v113, v242
v_sub_f32 v114, v114, v242
v_sub_f32 v115, v115, v242
v_sub_f32 v116, v116, v242
v_sub_f32 v117, v117, v242
v_sub_f32 v118, v118, v242
v_sub_f32 v119, v119, v242
v_mul_f32 v2, v2, v98
v_accvgpr_read_b32 v243, a0
v_mul_f32 v243, v243, v98
v_accvgpr_write_b32 a0, v243
v_accvgpr_read_b32 v243, a1
v_mul_f32 v243, v243, v98
v_accvgpr_write_b32 a1, v243
v_accvgpr_read_b32 v243, a2
v_mul_f32 v243, v243, v98
v_accvgpr_write_b32 a2, v243
v_accvgpr_read_b32 v243, a3
v_mul_f32 v243, v243, v98
v_accvgpr_write_b32 a3, v243
v_accvgpr_read_b32 v243, a4
v_mul_f32 v243, v243, v98
v_accvgpr_write_b32 a4, v243
v_accvgpr_read_b32 v243, a5
v_mul_f32 v243, v243, v98
v_accvgpr_write_b32 a5, v243
v_accvgpr_read_b32 v243, a6
v_mul_f32 v243, v243, v98
v_accvgpr_write_b32 a6, v243
v_accvgpr_read_b32 v243, a7
v_mul_f32 v243, v243, v98
v_accvgpr_write_b32 a7, v243
v_accvgpr_read_b32 v243, a8
v_mul_f32 v243, v243, v98
v_accvgpr_write_b32 a8, v243
v_accvgpr_read_b32 v243, a9
v_mul_f32 v243, v243, v98
v_accvgpr_write_b32 a9, v243
v_accvgpr_read_b32 v243, a10
v_mul_f32 v243, v243, v98
v_accvgpr_write_b32 a10, v243
v_accvgpr_read_b32 v243, a11
v_mul_f32 v243, v243, v98
v_accvgpr_write_b32 a11, v243
v_accvgpr_read_b32 v243, a12
v_mul_f32 v243, v243, v98
v_accvgpr_write_b32 a12, v243
v_accvgpr_read_b32 v243, a13
v_mul_f32 v243, v243, v98
v_accvgpr_write_b32 a13, v243
v_accvgpr_read_b32 v243, a14
v_mul_f32 v243, v243, v98
v_accvgpr_write_b32 a14, v243
v_accvgpr_read_b32 v243, a15
v_mul_f32 v243, v243, v98
v_accvgpr_write_b32 a15, v243
v_accvgpr_read_b32 v243, a16
v_mul_f32 v243, v243, v98
v_accvgpr_write_b32 a16, v243
v_accvgpr_read_b32 v243, a17
v_mul_f32 v243, v243, v98
v_accvgpr_write_b32 a17, v243
v_accvgpr_read_b32 v243, a18
v_mul_f32 v243, v243, v98
v_accvgpr_write_b32 a18, v243
v_accvgpr_read_b32 v243, a19
v_mul_f32 v243, v243, v98
v_accvgpr_write_b32 a19, v243
v_accvgpr_read_b32 v243, a20
v_mul_f32 v243, v243, v98
v_accvgpr_write_b32 a20, v243
v_accvgpr_read_b32 v243, a21
v_mul_f32 v243, v243, v98
v_accvgpr_write_b32 a21, v243
v_accvgpr_read_b32 v243, a22
v_mul_f32 v243, v243, v98
v_accvgpr_write_b32 a22, v243
v_accvgpr_read_b32 v243, a23
v_mul_f32 v243, v243, v98
v_accvgpr_write_b32 a23, v243
v_accvgpr_read_b32 v243, a24
v_mul_f32 v243, v243, v98
v_accvgpr_write_b32 a24, v243
v_accvgpr_read_b32 v243, a25
v_mul_f32 v243, v243, v98
v_accvgpr_write_b32 a25, v243
v_accvgpr_read_b32 v243, a26
v_mul_f32 v243, v243, v98
v_accvgpr_write_b32 a26, v243
v_accvgpr_read_b32 v243, a27
v_mul_f32 v243, v243, v98
v_accvgpr_write_b32 a27, v243
v_accvgpr_read_b32 v243, a28
v_mul_f32 v243, v243, v98
v_accvgpr_write_b32 a28, v243
v_accvgpr_read_b32 v243, a29
v_mul_f32 v243, v243, v98
v_accvgpr_write_b32 a29, v243
v_accvgpr_read_b32 v243, a30
v_mul_f32 v243, v243, v98
v_accvgpr_write_b32 a30, v243
v_accvgpr_read_b32 v243, a31
v_mul_f32 v243, v243, v98
v_accvgpr_write_b32 a31, v243
v_mov_b32 v242, v97
v_max3_f32 v242, v242, v88, v89
v_max3_f32 v242, v242, v90, v91
v_max3_f32 v242, v242, v92, v93
v_max3_f32 v242, v242, v94, v95
v_max3_f32 v242, v242, v120, v121
v_max3_f32 v242, v242, v122, v123
v_max3_f32 v242, v242, v124, v125
v_max3_f32 v242, v242, v126, v127
v_mov_b32 v243, v242
s_nop 1
v_permlane32_swap_b32 v242, v243
v_max_f32 v242, v242, v243
v_mov_b32 v243, v242
s_nop 1
v_permlane16_swap_b32 v242, v243
v_max_f32 v242, v242, v243
v_sub_f32 v99, v97, v242
v_exp_f32 v99, v99
v_mov_b32 v97, v242
v_sub_f32 v88, v88, v242
v_sub_f32 v89, v89, v242
v_sub_f32 v90, v90, v242
v_sub_f32 v91, v91, v242
v_sub_f32 v92, v92, v242
v_sub_f32 v93, v93, v242
v_sub_f32 v94, v94, v242
v_sub_f32 v95, v95, v242
v_sub_f32 v120, v120, v242
v_sub_f32 v121, v121, v242
v_sub_f32 v122, v122, v242
v_sub_f32 v123, v123, v242
v_sub_f32 v124, v124, v242
v_sub_f32 v125, v125, v242
v_sub_f32 v126, v126, v242
v_sub_f32 v127, v127, v242
v_mul_f32 v3, v3, v99
v_accvgpr_read_b32 v243, a32
v_mul_f32 v243, v243, v99
v_accvgpr_write_b32 a32, v243
v_accvgpr_read_b32 v243, a33
v_mul_f32 v243, v243, v99
v_accvgpr_write_b32 a33, v243
v_accvgpr_read_b32 v243, a34
v_mul_f32 v243, v243, v99
v_accvgpr_write_b32 a34, v243
v_accvgpr_read_b32 v243, a35
v_mul_f32 v243, v243, v99
v_accvgpr_write_b32 a35, v243
v_accvgpr_read_b32 v243, a36
v_mul_f32 v243, v243, v99
v_accvgpr_write_b32 a36, v243
v_accvgpr_read_b32 v243, a37
v_mul_f32 v243, v243, v99
v_accvgpr_write_b32 a37, v243
v_accvgpr_read_b32 v243, a38
v_mul_f32 v243, v243, v99
v_accvgpr_write_b32 a38, v243
v_accvgpr_read_b32 v243, a39
v_mul_f32 v243, v243, v99
v_accvgpr_write_b32 a39, v243
v_accvgpr_read_b32 v243, a40
v_mul_f32 v243, v243, v99
v_accvgpr_write_b32 a40, v243
v_accvgpr_read_b32 v243, a41
v_mul_f32 v243, v243, v99
v_accvgpr_write_b32 a41, v243
v_accvgpr_read_b32 v243, a42
v_mul_f32 v243, v243, v99
v_accvgpr_write_b32 a42, v243
v_accvgpr_read_b32 v243, a43
v_mul_f32 v243, v243, v99
v_accvgpr_write_b32 a43, v243
v_accvgpr_read_b32 v243, a44
v_mul_f32 v243, v243, v99
v_accvgpr_write_b32 a44, v243
v_accvgpr_read_b32 v243, a45
v_mul_f32 v243, v243, v99
v_accvgpr_write_b32 a45, v243
v_accvgpr_read_b32 v243, a46
v_mul_f32 v243, v243, v99
v_accvgpr_write_b32 a46, v243
v_accvgpr_read_b32 v243, a47
v_mul_f32 v243, v243, v99
v_accvgpr_write_b32 a47, v243
v_accvgpr_read_b32 v243, a48
v_mul_f32 v243, v243, v99
v_accvgpr_write_b32 a48, v243
v_accvgpr_read_b32 v243, a49
v_mul_f32 v243, v243, v99
v_accvgpr_write_b32 a49, v243
v_accvgpr_read_b32 v243, a50
v_mul_f32 v243, v243, v99
v_accvgpr_write_b32 a50, v243
v_accvgpr_read_b32 v243, a51
v_mul_f32 v243, v243, v99
v_accvgpr_write_b32 a51, v243
v_accvgpr_read_b32 v243, a52
v_mul_f32 v243, v243, v99
v_accvgpr_write_b32 a52, v243
v_accvgpr_read_b32 v243, a53
v_mul_f32 v243, v243, v99
v_accvgpr_write_b32 a53, v243
v_accvgpr_read_b32 v243, a54
v_mul_f32 v243, v243, v99
v_accvgpr_write_b32 a54, v243
v_accvgpr_read_b32 v243, a55
v_mul_f32 v243, v243, v99
v_accvgpr_write_b32 a55, v243
v_accvgpr_read_b32 v243, a56
v_mul_f32 v243, v243, v99
v_accvgpr_write_b32 a56, v243
v_accvgpr_read_b32 v243, a57
v_mul_f32 v243, v243, v99
v_accvgpr_write_b32 a57, v243
v_accvgpr_read_b32 v243, a58
v_mul_f32 v243, v243, v99
v_accvgpr_write_b32 a58, v243
v_accvgpr_read_b32 v243, a59
v_mul_f32 v243, v243, v99
v_accvgpr_write_b32 a59, v243
v_accvgpr_read_b32 v243, a60
v_mul_f32 v243, v243, v99
v_accvgpr_write_b32 a60, v243
v_accvgpr_read_b32 v243, a61
v_mul_f32 v243, v243, v99
v_accvgpr_write_b32 a61, v243
v_accvgpr_read_b32 v243, a62
v_mul_f32 v243, v243, v99
v_accvgpr_write_b32 a62, v243
v_accvgpr_read_b32 v243, a63
v_mul_f32 v243, v243, v99
v_accvgpr_write_b32 a63, v243
v_exp_f32 v80, v80
v_exp_f32 v81, v81
v_exp_f32 v82, v82
v_add_f32 v2, v2, v80
v_add_f32 v2, v2, v81
v_exp_f32 v83, v83
v_cvt_pk_bf16_f32 v80, v80, v81
v_exp_f32 v84, v84
v_add_f32 v2, v2, v82
v_add_f32 v2, v2, v83
v_exp_f32 v85, v85
v_cvt_pk_bf16_f32 v81, v82, v83
v_exp_f32 v86, v86
v_add_f32 v2, v2, v84
v_add_f32 v2, v2, v85
v_exp_f32 v87, v87
v_cvt_pk_bf16_f32 v82, v84, v85
v_exp_f32 v88, v88
v_add_f32 v2, v2, v86
v_add_f32 v2, v2, v87
v_exp_f32 v89, v89
v_cvt_pk_bf16_f32 v83, v86, v87
v_exp_f32 v90, v90
v_add_f32 v3, v3, v88
v_add_f32 v3, v3, v89
v_exp_f32 v91, v91
v_cvt_pk_bf16_f32 v88, v88, v89
v_exp_f32 v92, v92
v_add_f32 v3, v3, v90
v_add_f32 v3, v3, v91
v_exp_f32 v93, v93
v_cvt_pk_bf16_f32 v89, v90, v91
v_exp_f32 v94, v94
v_add_f32 v3, v3, v92
v_add_f32 v3, v3, v93
v_exp_f32 v95, v95
v_cvt_pk_bf16_f32 v90, v92, v93
v_exp_f32 v112, v112
v_add_f32 v3, v3, v94
v_add_f32 v3, v3, v95
v_exp_f32 v113, v113
v_cvt_pk_bf16_f32 v91, v94, v95
v_exp_f32 v114, v114
v_add_f32 v2, v2, v112
v_add_f32 v2, v2, v113
v_exp_f32 v115, v115
v_cvt_pk_bf16_f32 v112, v112, v113
v_exp_f32 v116, v116
v_add_f32 v2, v2, v114
v_add_f32 v2, v2, v115
v_exp_f32 v117, v117
v_cvt_pk_bf16_f32 v113, v114, v115
v_exp_f32 v118, v118
v_add_f32 v2, v2, v116
v_add_f32 v2, v2, v117
v_exp_f32 v119, v119
v_cvt_pk_bf16_f32 v114, v116, v117
v_exp_f32 v120, v120
v_add_f32 v2, v2, v118
v_add_f32 v2, v2, v119
v_exp_f32 v121, v121
v_cvt_pk_bf16_f32 v115, v118, v119
v_exp_f32 v122, v122
v_add_f32 v3, v3, v120
v_add_f32 v3, v3, v121
v_exp_f32 v123, v123
v_cvt_pk_bf16_f32 v120, v120, v121
v_exp_f32 v124, v124
v_add_f32 v3, v3, v122
v_add_f32 v3, v3, v123
v_exp_f32 v125, v125
v_cvt_pk_bf16_f32 v121, v122, v123
v_exp_f32 v126, v126
v_add_f32 v3, v3, v124
v_add_f32 v3, v3, v125
v_exp_f32 v127, v127
v_cvt_pk_bf16_f32 v122, v124, v125
v_add_f32 v3, v3, v126
v_add_f32 v3, v3, v127
v_cvt_pk_bf16_f32 v123, v126, v127
s_waitcnt lgkmcnt(15)
MA 0,a,192,v,80
MA 32,a,192,v,88
s_waitcnt lgkmcnt(14)
MA 4,a,196,v,80
MA 36,a,196,v,88
s_waitcnt lgkmcnt(13)
MA 8,a,200,v,80
MA 40,a,200,v,88
s_waitcnt lgkmcnt(12)
MA 12,a,204,v,80
MA 44,a,204,v,88
s_waitcnt lgkmcnt(11)
MA 16,a,208,v,80
MA 48,a,208,v,88
s_waitcnt lgkmcnt(10)
MA 20,a,212,v,80
MA 52,a,212,v,88
s_waitcnt lgkmcnt(9)
MA 24,a,216,v,80
MA 56,a,216,v,88
s_waitcnt lgkmcnt(8)
MA 28,a,220,v,80
MA 60,a,220,v,88
s_waitcnt lgkmcnt(7)
MA 0,a,224,v,112
MA 32,a,224,v,120
s_waitcnt lgkmcnt(6)
MA 4,a,228,v,112
MA 36,a,228,v,120
s_waitcnt lgkmcnt(5)
MA 8,a,232,v,112
MA 40,a,232,v,120
s_waitcnt lgkmcnt(4)
MA 12,a,236,v,112
MA 44,a,236,v,120
s_waitcnt lgkmcnt(3)
MA 16,a,240,v,112
MA 48,a,240,v,120
s_waitcnt lgkmcnt(2)
MA 20,a,244,v,112
MA 52,a,244,v,120
s_waitcnt lgkmcnt(1)
MA 24,a,248,v,112
MA 56,a,248,v,120
s_waitcnt lgkmcnt(0)
MA 28,a,252,v,112
MA 60,a,252,v,120
s_add_u32 s71, s71, 16384
s_sub_u32 s72, s72, 64
s_sub_u32 s74, s74, 1
s_nop 15
s_cmp_lg_u32 s74, 0
s_cbranch_scc1 L_fb_tile
v_mov_b32 v240, v2
s_nop 1
v_permlane32_swap_b32 v2, v240
v_add_f32 v2, v2, v240
v_mov_b32 v240, v2
s_nop 1
v_permlane16_swap_b32 v2, v240
v_add_f32 v2, v2, v240
v_mov_b32 v240, v3
s_nop 1
v_permlane32_swap_b32 v3, v240
v_add_f32 v3, v3, v240
v_mov_b32 v240, v3
s_nop 1
v_permlane16_swap_b32 v3, v240
v_add_f32 v3, v3, v240
v_rcp_f32 v2, v2
v_rcp_f32 v3, v3
s_add_u32 s80, s73, s76
s_nop 4
v_accvgpr_read_b32 v240, a0
v_accvgpr_read_b32 v241, a1
v_accvgpr_read_b32 v242, a2
v_accvgpr_read_b32 v243, a3
v_accvgpr_read_b32 v244, a4
v_accvgpr_read_b32 v245, a5
v_accvgpr_read_b32 v246, a6
v_accvgpr_read_b32 v247, a7
v_pk_mul_f32 v[240:241], v[240:241], v[2:3] op_sel:[0,0] op_sel_hi:[1,0]
v_pk_mul_f32 v[242:243], v[242:243], v[2:3] op_sel:[0,0] op_sel_hi:[1,0]
v_pk_mul_f32 v[244:245], v[244:245], v[2:3] op_sel:[0,0] op_sel_hi:[1,0]
v_pk_mul_f32 v[246:247], v[246:247], v[2:3] op_sel:[0,0] op_sel_hi:[1,0]
v_cvt_pk_bf16_f32 v248, v240, v241
v_cvt_pk_bf16_f32 v249, v242, v243
v_cvt_pk_bf16_f32 v250, v244, v245
v_cvt_pk_bf16_f32 v251, v246, v247
buffer_store_dwordx4 v[248:251], v15, s[60:63], s73 offen offset:0 sc1
v_accvgpr_read_b32 v240, a8
v_accvgpr_read_b32 v241, a9
v_accvgpr_read_b32 v242, a10
v_accvgpr_read_b32 v243, a11
v_accvgpr_read_b32 v244, a12
v_accvgpr_read_b32 v245, a13
v_accvgpr_read_b32 v246, a14
v_accvgpr_read_b32 v247, a15
v_pk_mul_f32 v[240:241], v[240:241], v[2:3] op_sel:[0,0] op_sel_hi:[1,0]
v_pk_mul_f32 v[242:243], v[242:243], v[2:3] op_sel:[0,0] op_sel_hi:[1,0]
v_pk_mul_f32 v[244:245], v[244:245], v[2:3] op_sel:[0,0] op_sel_hi:[1,0]
v_pk_mul_f32 v[246:247], v[246:247], v[2:3] op_sel:[0,0] op_sel_hi:[1,0]
v_cvt_pk_bf16_f32 v252, v240, v241
v_cvt_pk_bf16_f32 v253, v242, v243
v_cvt_pk_bf16_f32 v254, v244, v245
v_cvt_pk_bf16_f32 v255, v246, v247
buffer_store_dwordx4 v[252:255], v15, s[60:63], s73 offen offset:1024 sc1
v_accvgpr_read_b32 v240, a16
v_accvgpr_read_b32 v241, a17
v_accvgpr_read_b32 v242, a18
v_accvgpr_read_b32 v243, a19
v_accvgpr_read_b32 v244, a20
v_accvgpr_read_b32 v245, a21
v_accvgpr_read_b32 v246, a22
v_accvgpr_read_b32 v247, a23
v_pk_mul_f32 v[240:241], v[240:241], v[2:3] op_sel:[0,0] op_sel_hi:[1,0]
v_pk_mul_f32 v[242:243], v[242:243], v[2:3] op_sel:[0,0] op_sel_hi:[1,0]
v_pk_mul_f32 v[244:245], v[244:245], v[2:3] op_sel:[0,0] op_sel_hi:[1,0]
v_pk_mul_f32 v[246:247], v[246:247], v[2:3] op_sel:[0,0] op_sel_hi:[1,0]
v_cvt_pk_bf16_f32 v248, v240, v241
v_cvt_pk_bf16_f32 v249, v242, v243
v_cvt_pk_bf16_f32 v250, v244, v245
v_cvt_pk_bf16_f32 v251, v246, v247
buffer_store_dwordx4 v[248:251], v15, s[60:63], s73 offen offset:2048 sc1
v_accvgpr_read_b32 v240, a24
v_accvgpr_read_b32 v241, a25
v_accvgpr_read_b32 v242, a26
v_accvgpr_read_b32 v243, a27
v_accvgpr_read_b32 v244, a28
v_accvgpr_read_b32 v245, a29
v_accvgpr_read_b32 v246, a30
v_accvgpr_read_b32 v247, a31
v_pk_mul_f32 v[240:241], v[240:241], v[2:3] op_sel:[0,0] op_sel_hi:[1,0]
v_pk_mul_f32 v[242:243], v[242:243], v[2:3] op_sel:[0,0] op_sel_hi:[1,0]
v_pk_mul_f32 v[244:245], v[244:245], v[2:3] op_sel:[0,0] op_sel_hi:[1,0]
v_pk_mul_f32 v[246:247], v[246:247], v[2:3] op_sel:[0,0] op_sel_hi:[1,0]
v_cvt_pk_bf16_f32 v252, v240, v241
v_cvt_pk_bf16_f32 v253, v242, v243
v_cvt_pk_bf16_f32 v254, v244, v245
v_cvt_pk_bf16_f32 v255, v246, v247
buffer_store_dwordx4 v[252:255], v15, s[60:63], s73 offen offset:3072 sc1
v_accvgpr_read_b32 v240, a32
v_accvgpr_read_b32 v241, a33
v_accvgpr_read_b32 v242, a34
v_accvgpr_read_b32 v243, a35
v_accvgpr_read_b32 v244, a36
v_accvgpr_read_b32 v245, a37
v_accvgpr_read_b32 v246, a38
v_accvgpr_read_b32 v247, a39
v_pk_mul_f32 v[240:241], v[240:241], v[2:3] op_sel:[0,1] op_sel_hi:[1,1]
v_pk_mul_f32 v[242:243], v[242:243], v[2:3] op_sel:[0,1] op_sel_hi:[1,1]
v_pk_mul_f32 v[244:245], v[244:245], v[2:3] op_sel:[0,1] op_sel_hi:[1,1]
v_pk_mul_f32 v[246:247], v[246:247], v[2:3] op_sel:[0,1] op_sel_hi:[1,1]
v_cvt_pk_bf16_f32 v248, v240, v241
v_cvt_pk_bf16_f32 v249, v242, v243
v_cvt_pk_bf16_f32 v250, v244, v245
v_cvt_pk_bf16_f32 v251, v246, v247
buffer_store_dwordx4 v[248:251], v15, s[60:63], s80 offen offset:0 sc1
v_accvgpr_read_b32 v240, a40
v_accvgpr_read_b32 v241, a41
v_accvgpr_read_b32 v242, a42
v_accvgpr_read_b32 v243, a43
v_accvgpr_read_b32 v244, a44
v_accvgpr_read_b32 v245, a45
v_accvgpr_read_b32 v246, a46
v_accvgpr_read_b32 v247, a47
v_pk_mul_f32 v[240:241], v[240:241], v[2:3] op_sel:[0,1] op_sel_hi:[1,1]
v_pk_mul_f32 v[242:243], v[242:243], v[2:3] op_sel:[0,1] op_sel_hi:[1,1]
v_pk_mul_f32 v[244:245], v[244:245], v[2:3] op_sel:[0,1] op_sel_hi:[1,1]
v_pk_mul_f32 v[246:247], v[246:247], v[2:3] op_sel:[0,1] op_sel_hi:[1,1]
v_cvt_pk_bf16_f32 v252, v240, v241
v_cvt_pk_bf16_f32 v253, v242, v243
v_cvt_pk_bf16_f32 v254, v244, v245
v_cvt_pk_bf16_f32 v255, v246, v247
buffer_store_dwordx4 v[252:255], v15, s[60:63], s80 offen offset:1024 sc1
v_accvgpr_read_b32 v240, a48
v_accvgpr_read_b32 v241, a49
v_accvgpr_read_b32 v242, a50
v_accvgpr_read_b32 v243, a51
v_accvgpr_read_b32 v244, a52
v_accvgpr_read_b32 v245, a53
v_accvgpr_read_b32 v246, a54
v_accvgpr_read_b32 v247, a55
v_pk_mul_f32 v[240:241], v[240:241], v[2:3] op_sel:[0,1] op_sel_hi:[1,1]
v_pk_mul_f32 v[242:243], v[242:243], v[2:3] op_sel:[0,1] op_sel_hi:[1,1]
v_pk_mul_f32 v[244:245], v[244:245], v[2:3] op_sel:[0,1] op_sel_hi:[1,1]
v_pk_mul_f32 v[246:247], v[246:247], v[2:3] op_sel:[0,1] op_sel_hi:[1,1]
v_cvt_pk_bf16_f32 v248, v240, v241
v_cvt_pk_bf16_f32 v249, v242, v243
v_cvt_pk_bf16_f32 v250, v244, v245
v_cvt_pk_bf16_f32 v251, v246, v247
buffer_store_dwordx4 v[248:251], v15, s[60:63], s80 offen offset:2048 sc1
v_accvgpr_read_b32 v240, a56
v_accvgpr_read_b32 v241, a57
v_accvgpr_read_b32 v242, a58
v_accvgpr_read_b32 v243, a59
v_accvgpr_read_b32 v244, a60
v_accvgpr_read_b32 v245, a61
v_accvgpr_read_b32 v246, a62
v_accvgpr_read_b32 v247, a63
v_pk_mul_f32 v[240:241], v[240:241], v[2:3] op_sel:[0,1] op_sel_hi:[1,1]
v_pk_mul_f32 v[242:243], v[242:243], v[2:3] op_sel:[0,1] op_sel_hi:[1,1]
v_pk_mul_f32 v[244:245], v[244:245], v[2:3] op_sel:[0,1] op_sel_hi:[1,1]
v_pk_mul_f32 v[246:247], v[246:247], v[2:3] op_sel:[0,1] op_sel_hi:[1,1]
v_cvt_pk_bf16_f32 v252, v240, v241
v_cvt_pk_bf16_f32 v253, v242, v243
v_cvt_pk_bf16_f32 v254, v244, v245
v_cvt_pk_bf16_f32 v255, v246, v247
buffer_store_dwordx4 v[252:255], v15, s[60:63], s80 offen offset:3072 sc1
s_cmp_lg_u32 s81, 0
s_cbranch_scc1 L_fb_done
s_mov_b32 s81, 1
s_sub_u32 s74, 34, s77
s_mov_b32 s73, s101
s_mov_b32 s72, s70
v_mov_b32 v16, v48
v_mov_b32 v17, v49
v_mov_b32 v18, v50
v_mov_b32 v19, v51
v_mov_b32 v20, v52
v_mov_b32 v21, v53
v_mov_b32 v22, v54
v_mov_b32 v23, v55
v_mov_b32 v24, v56
v_mov_b32 v25, v57
v_mov_b32 v26, v58
v_mov_b32 v27, v59
v_mov_b32 v28, v60
v_mov_b32 v29, v61
v_mov_b32 v30, v62
v_mov_b32 v31, v63
v_mov_b32 v32, v64
v_mov_b32 v33, v65
v_mov_b32 v34, v66
v_mov_b32 v35, v67
v_mov_b32 v36, v68
v_mov_b32 v37, v69
v_mov_b32 v38, v70
v_mov_b32 v39, v71
v_mov_b32 v40, v72
v_mov_b32 v41, v73
v_mov_b32 v42, v74
v_mov_b32 v43, v75
v_mov_b32 v44, v76
v_mov_b32 v45, v77
v_mov_b32 v46, v78
v_mov_b32 v47, v79
s_branch L_fb_set
L_fb_done:
s_waitcnt vmcnt(0) lgkmcnt(0)
s_barrier
s_load_dwordx2 s[88:89], s[0:1], 104
s_mul_i32 s36, s3, 8320
v_and_b32 v16, 15, v1
v_lshrrev_b32 v17, 4, v1
v_add_u32 v18, 1, v16
v_and_b32 v19, 1, v18
v_mul_u32_u24 v19, 4160, v19
v_add_u32 v18, 2, v16
v_lshrrev_b32 v18, 1, v18
v_lshl_add_u32 v19, v18, 2, v19
v_lshl_add_u32 v19, v17, 4, v19
v_add_u32 v40, s36, v19
v_add_u32 v41, 1024, v40
v_add_u32 v42, 2048, v40
v_add_u32 v43, 3072, v40
v_add_u32 v10, s36, v232
v_lshlrev_b32 v18, 5, v16
v_lshlrev_b32 v19, 4, v17
v_sub_u32 v19, v19, v18
s_add_u32 s37, s43, 480
v_add_u32 v5, s37, v19
v_mov_b32 v20, 0
v_mov_b32 v21, 0
v_mov_b32 v22, 0
v_mov_b32 v23, 0
v_and_b32 v16, 1, v1
v_mul_u32_u24 v16, 4160, v16
v_and_b32 v17, 2, v1
v_lshl_add_u32 v16, v17, 3, v16
v_add_u32 v16, s36, v16
ds_write_b128 v16, v[20:23]
v_and_b32 v17, 31, v1
v_lshlrev_b32 v17, 4, v17
v_add_u32 v17, s43, v17
ds_write_b128 v17, v[20:23] offset:4096
v_mov_b32 v209, 0
ds_write_b128 v10, v[210:213] offset:32
s_nop 0
v_mov_b32_dpp v209, v213 wave_shr:1 row_mask:0xf bank_mask:0xf
v_alignbit_b32 v24, v210, v209, 16
v_alignbit_b32 v25, v211, v210, 16
v_alignbit_b32 v26, v212, v211, 16
v_alignbit_b32 v27, v213, v212, 16
ds_write_b128 v10, v[24:27] offset:4192
v_mov_b32_dpp v215, v213 wave_ror:1 row_mask:0xf bank_mask:0xf
ds_write_b128 v10, v[216:219] offset:1056
s_nop 0
v_mov_b32_dpp v215, v219 wave_shr:1 row_mask:0xf bank_mask:0xf
v_alignbit_b32 v28, v216, v215, 16
v_alignbit_b32 v29, v217, v216, 16
v_alignbit_b32 v30, v218, v217, 16
v_alignbit_b32 v31, v219, v218, 16
ds_write_b128 v10, v[28:31] offset:5216
v_mov_b32_dpp v221, v219 wave_ror:1 row_mask:0xf bank_mask:0xf
ds_write_b128 v10, v[222:225] offset:2080
s_nop 0
v_mov_b32_dpp v221, v225 wave_shr:1 row_mask:0xf bank_mask:0xf
v_alignbit_b32 v24, v222, v221, 16
v_alignbit_b32 v25, v223, v222, 16
v_alignbit_b32 v26, v224, v223, 16
v_alignbit_b32 v27, v225, v224, 16
ds_write_b128 v10, v[24:27] offset:6240
v_mov_b32_dpp v227, v225 wave_ror:1 row_mask:0xf bank_mask:0xf
ds_write_b128 v10, v[228:231] offset:3104
s_nop 0
v_mov_b32_dpp v227, v231 wave_shr:1 row_mask:0xf bank_mask:0xf
v_alignbit_b32 v28, v228, v227, 16
v_alignbit_b32 v29, v229, v228, 16
v_alignbit_b32 v30, v230, v229, 16
v_alignbit_b32 v31, v231, v230, 16
ds_write_b128 v10, v[28:31] offset:7264
ds_read_b128 a[160:163], v5 offset:3584
ds_read2_b32 a[128:129], v40 offset0:0 offset1:1
ds_read2_b32 a[130:131], v40 offset0:2 offset1:3
ds_read_b128 a[164:167], v5 offset:3072
ds_read2_b32 a[132:133], v40 offset0:128 offset1:129
ds_read2_b32 a[134:135], v40 offset0:130 offset1:131
ds_read_b128 a[168:171], v5 offset:2560
ds_read2_b32 a[136:137], v41 offset0:0 offset1:1
ds_read2_b32 a[138:139], v41 offset0:2 offset1:3
ds_read_b128 a[172:175], v5 offset:2048
ds_read2_b32 a[140:141], v41 offset0:128 offset1:129
ds_read2_b32 a[142:143], v41 offset0:130 offset1:131
ds_read_b128 a[176:179], v5 offset:1536
ds_read2_b32 a[144:145], v42 offset0:0 offset1:1
ds_read2_b32 a[146:147], v42 offset0:2 offset1:3
ds_read_b128 a[180:183], v5 offset:1024
ds_read2_b32 a[148:149], v42 offset0:128 offset1:129
ds_read2_b32 a[150:151], v42 offset0:130 offset1:131
ds_read_b128 a[184:187], v5 offset:512
ds_read2_b32 a[152:153], v43 offset0:0 offset1:1
ds_read2_b32 a[154:155], v43 offset0:2 offset1:3
ds_read_b128 a[188:191], v5 offset:0
ds_read2_b32 a[156:157], v43 offset0:128 offset1:129
ds_read2_b32 a[158:159], v43 offset0:130 offset1:131
s_waitcnt lgkmcnt(0)
s_branch L_p3_done
L_spin_go:
s_mov_b32 s36, 400000
L_spin_go_l:
s_sleep 1
buffer_load_dword v254, off, s[12:15], 0 sc1
s_waitcnt vmcnt(0)
v_cmp_gt_u32 vcc, 1, v254
s_nop 4
s_cbranch_vccz L_spin_go_ret
s_sub_u32 s36, s36, 1
s_cmp_lg_u32 s36, 0
s_cbranch_scc1 L_spin_go_l
s_branch L_spin_go_ret
L_spin_f1:
s_mov_b32 s36, 400000
L_spin_f1_l:
s_sleep 1
buffer_load_dword v237, v233, s[8:11], 0 offen offset:0 sc1
s_waitcnt vmcnt(0)
v_cmp_gt_u32 vcc, 1, v237
s_nop 4
s_cbranch_vccz L_spin_f1_ret
s_sub_u32 s36, s36, 1
s_cmp_lg_u32 s36, 0
s_cbranch_scc1 L_spin_f1_l
s_branch L_spin_f1_ret
L_spin_w:
s_mov_b32 s36, 400000
L_spin_w_l:
s_sleep 1
buffer_load_dword v253, v254, s[8:11], 0 offen offset:1024 sc1
s_waitcnt vmcnt(0)
v_cmp_gt_u32 vcc, 1, v253
s_nop 4
s_cbranch_vccz L_spin_w_ret
s_sub_u32 s36, s36, 1
s_cmp_lg_u32 s36, 0
s_cbranch_scc1 L_spin_w_l
s_branch L_spin_w_ret
L_spin_f2:
s_mov_b32 s36, 400000
L_spin_f2_l:
s_sleep 1
buffer_load_dword v253, v252, s[8:11], 0 offen sc1
s_waitcnt vmcnt(0)
v_cmp_gt_u32 vcc, 1, v253
s_nop 4
s_cbranch_vccz L_spin_f2_ret
s_sub_u32 s36, s36, 1
s_cmp_lg_u32 s36, 0
s_cbranch_scc1 L_spin_f2_l
s_branch L_spin_f2_ret
L_p5_x1:
v_mov_b32 v253, 1
s_lshl_b32 s36, s2, 2
buffer_store_dword v253, v255, s[8:11], s36 offen offset:2048 sc1
v_and_b32 v254, 15, v1
s_lshl_b32 s36, s82, 4
v_add_u32 v254, s36, v254
v_lshlrev_b32 v254, 2, v254
s_branch L_p5_loop
L_p5_x2:
buffer_load_dword v253, v254, s[8:11], 0 offen offset:2048 sc1
s_branch L_p5_loop
L_spin_f3:
s_mov_b32 s36, 400000
L_spin_f3_l:
s_sleep 1
buffer_load_dword v253, v254, s[8:11], 0 offen offset:2048 sc1
s_waitcnt vmcnt(0)
v_cmp_gt_u32 vcc, 1, v253
s_nop 4
s_cbranch_vccz L_spin_f3_ret
s_sub_u32 s36, s36, 1
s_cmp_lg_u32 s36, 0
s_cbranch_scc1 L_spin_f3_l
s_branch L_spin_f3_ret
L_code_end:
s_endpgm
.section .rodata,"a"
.p2align 6
.amdhsa_kernel gated_mix__ssm_conv_h3__compressed_kv_cla__prompt_kernel
  .amdhsa_next_free_vgpr 512
  .amdhsa_next_free_sgpr 102
  .amdhsa_accum_offset 256
  .amdhsa_group_segment_fixed_size 0
  .amdhsa_kernarg_size 128
  .amdhsa_user_sgpr_count 2
  .amdhsa_user_sgpr_kernarg_segment_ptr 1
  .amdhsa_system_sgpr_workgroup_id_x 1
  .amdhsa_float_denorm_mode_32 3
.end_amdhsa_kernel
.text
```

```asm
; @launch grid=(256,1,1) block=(256,1,1) lds=163840
.amdgcn_target "amdgcn-amd-amdhsa--gfx950"
.text
.macro MA d,x,a,y,b
v_mfma_f32_16x16x32_bf16 a[\d:\d+3], \x[\a:\a+3], \y[\b:\b+3], a[\d:\d+3]
.endm
.macro MV d,x,a,y,b
v_mfma_f32_16x16x32_bf16 v[\d:\d+3], \x[\a:\a+3], \y[\b:\b+3], v[\d:\d+3]
.endm
.macro TR d,a,o
ds_read_b64_tr_b16 v[\d:\d+1], v\a offset:\o
.endm
.globl gated_mix__ssm_conv_h3__compressed_kv_cla__prompt_kernel
.p2align 8
.type gated_mix__ssm_conv_h3__compressed_kv_cla__prompt_kernel,@function
gated_mix__ssm_conv_h3__compressed_kv_cla__prompt_kernel:
s_cmp_ge_u32 s2, 256
s_cbranch_scc1 L_end
s_load_dwordx2 s[44:45], s[0:1], 56
s_load_dwordx4 s[48:51], s[0:1], 72
s_load_dwordx2 s[40:41], s[0:1], 120
s_load_dwordx2 s[52:53], s[0:1], 112
s_load_dwordx2 s[32:33], s[0:1], 0
s_load_dwordx2 s[34:35], s[0:1], 64
v_lshrrev_b32 v2, 6, v0
v_and_b32 v1, 63, v0
v_lshlrev_b32 v3, 4, v0
v_readfirstlane_b32 s3, v2
s_getpc_b64 s[4:5]
L_ct_e:
s_add_u32 s4, s4, L_p1_K - L_ct_e
s_addc_u32 s5, s5, 0
v_mov_b32 v77, s5
v_mov_b32 v76, s4
s_lshr_b32 s4, s2, 3
s_lshl_b32 s4, s4, 2
s_add_u32 s4, s4, s3
s_lshl_b32 s4, s4, 7
v_and_b32 v79, 3, v1
v_lshlrev_b32 v79, 14, v79
v_add_u32 v79, s4, v79
v_min_u32 v79, L_p3_begin - L_p1_K - 4, v79
v_add_co_u32 v76, vcc, v76, v79
s_nop 1
v_addc_co_u32 v77, vcc, 0, v77, vcc
global_load_dword v79, v[76:77], off
s_and_b32 s36, s2, 7
s_lshr_b32 s37, s2, 3
s_and_b32 s38, s37, 7
s_lshr_b32 s37, s37, 3
s_lshr_b32 s42, s37, 1
s_and_b32 s37, s37, 1
s_lshl_b32 s36, s36, 1
s_add_u32 s36, s36, s37
s_lshl_b32 s24, s38, 18
s_lshl_b32 s39, s3, 16
s_add_u32 s24, s24, s39
s_lshl_b32 s25, s3, 17
s_lshl_b32 s39, s36, 9
s_add_u32 s25, s25, s39
s_and_b32 s20, s2, 7
s_lshl_b32 s21, s20, 19
s_lshl_b32 s20, s20, 7
s_lshl_b32 s22, s3, 13
s_add_u32 s23, s22, 98304
v_lshrrev_b32 v204, 3, v1
v_lshlrev_b32 v204, 10, v204
v_lshrrev_b32 v205, 4, v1
v_and_b32 v206, 7, v1
v_xor_b32 v206, v206, v205
v_lshl_add_u32 v204, v206, 4, v204
v_xor_b32 v207, 64, v204
v_add_u32 v176, 0, v204
v_add_u32 v177, 7168, v207
v_add_u32 v178, 14336, v204
v_add_u32 v179, 21504, v207
v_add_u32 v180, 32768, v204
v_add_u32 v181, 39936, v207
v_add_u32 v182, 47104, v204
v_add_u32 v183, 54272, v207
v_lshrrev_b32 v204, 5, v1
v_and_b32 v206, 31, v1
v_lshlrev_b32 v207, 1, v204
v_xor_b32 v206, v206, v207
v_lshlrev_b32 v204, 13, v204
v_xor_b32 v207, 0, v206
v_lshl_add_u32 v207, v207, 4, v204
v_add_u32 v184, 0, v207
v_xor_b32 v207, 4, v206
v_lshl_add_u32 v207, v207, 4, v204
v_add_u32 v185, 15360, v207
v_xor_b32 v207, 0, v206
v_lshl_add_u32 v207, v207, 4, v204
v_add_u32 v186, 30720, v207
v_xor_b32 v207, 4, v206
v_lshl_add_u32 v207, v207, 4, v204
v_add_u32 v187, 46080, v207
v_xor_b32 v207, 8, v206
v_lshl_add_u32 v207, v207, 4, v204
v_add_u32 v188, 65536, v207
v_xor_b32 v207, 12, v206
v_lshl_add_u32 v207, v207, 4, v204
v_add_u32 v189, 80896, v207
v_xor_b32 v207, 8, v206
v_lshl_add_u32 v207, v207, 4, v204
v_add_u32 v190, 96256, v207
v_xor_b32 v207, 12, v206
v_lshl_add_u32 v207, v207, 4, v204
v_add_u32 v191, 111616, v207
s_waitcnt lgkmcnt(0)
s_add_u32 s8, s44, s24
s_addc_u32 s9, s45, 0
s_mov_b32 s10, 65536
s_mov_b32 s11, 0x20000
s_cmp_eq_u32 s42, 0
s_cselect_b32 s12, s48, s50
s_cselect_b32 s13, s49, s51
s_add_u32 s12, s12, s25
s_addc_u32 s13, s13, 0
s_sub_u32 s14, 4194304, s25
s_mov_b32 s15, 0x20000
s_add_u32 s4, s40, 59768832
s_addc_u32 s5, s41, 0
s_mov_b32 s6, 8192
s_mov_b32 s7, 0x20000
s_lshl_b32 s43, s2, 20
v_add_u32 v3, s43, v3
v_mov_b32 v4, 0
v_mov_b32 v5, 0
v_mov_b32 v6, 0
v_mov_b32 v7, 0
s_movk_i32 s43, 4096
buffer_store_dwordx4 v[4:7], v3, s[4:7], 0 offen sc1
buffer_store_dwordx4 v[4:7], v3, s[4:7], s43 offen sc1
s_waitcnt vmcnt(2)
v_lshlrev_b32 v79, 16, v3
s_add_u32 m0, s23, 0
s_nop 0
buffer_load_dwordx4 v184, s[12:15], s21 offen offset:0 lds
buffer_load_dwordx4 v185, s[12:15], s21 offen offset:1024 lds
buffer_load_dwordx4 v186, s[12:15], s21 offen offset:2048 lds
buffer_load_dwordx4 v187, s[12:15], s21 offen offset:3072 lds
s_add_u32 m0, s23, 4096
s_nop 0
buffer_load_dwordx4 v188, s[12:15], s21 offen offset:0 lds
buffer_load_dwordx4 v189, s[12:15], s21 offen offset:1024 lds
buffer_load_dwordx4 v190, s[12:15], s21 offen offset:2048 lds
buffer_load_dwordx4 v191, s[12:15], s21 offen offset:3072 lds
s_add_u32 s21, s21, 524288
s_and_b32 s21, s21, 4194303
s_add_u32 m0, s22, 0
s_nop 0
buffer_load_dwordx4 v176, s[8:11], s20 offen offset:0 lds
buffer_load_dwordx4 v177, s[8:11], s20 offen offset:1024 lds
buffer_load_dwordx4 v178, s[8:11], s20 offen offset:2048 lds
buffer_load_dwordx4 v179, s[8:11], s20 offen offset:3072 lds
s_add_u32 m0, s22, 4096
s_nop 0
buffer_load_dwordx4 v180, s[8:11], s20 offen offset:0 lds
buffer_load_dwordx4 v181, s[8:11], s20 offen offset:1024 lds
buffer_load_dwordx4 v182, s[8:11], s20 offen offset:2048 lds
buffer_load_dwordx4 v183, s[8:11], s20 offen offset:3072 lds
s_add_u32 s20, s20, 128
s_and_b32 s20, s20, 1023
v_and_b32 v204, 15, v1
v_lshrrev_b32 v206, 1, v204
v_xor_b32 v206, v206, v205
v_lshlrev_b32 v206, 4, v206
v_lshl_add_u32 v206, v204, 7, v206
s_and_b32 s39, s3, 1
s_lshl_b32 s39, s39, 14
v_add_u32 v192, s39, v206
v_xor_b32 v193, 64, v192
v_add_u32 v194, 0x10000, v192
v_add_u32 v195, 0x10000, v193
v_bfe_u32 v204, v1, 2, 2
v_and_b32 v206, 1, v205
v_lshl_or_b32 v206, v206, 2, v204
v_lshl_add_u32 v204, v205, 3, v204
v_lshlrev_b32 v204, 9, v204
v_and_b32 v207, 3, v1
v_lshl_add_u32 v204, v207, 3, v204
s_lshr_b32 s39, s3, 1
s_lshl_b32 s39, s39, 8
s_add_u32 s39, s39, 98304
v_add_u32 v204, s39, v204
v_xor_b32 v207, 0, v206
v_lshl_add_u32 v196, v207, 5, v204
v_xor_b32 v207, 1, v206
v_lshl_add_u32 v197, v207, 5, v204
v_xor_b32 v207, 2, v206
v_lshl_add_u32 v198, v207, 5, v204
v_xor_b32 v207, 3, v206
v_lshl_add_u32 v199, v207, 5, v204
v_xor_b32 v207, 4, v206
v_lshl_add_u32 v200, v207, 5, v204
v_xor_b32 v207, 5, v206
v_lshl_add_u32 v201, v207, 5, v204
v_xor_b32 v207, 6, v206
v_lshl_add_u32 v202, v207, 5, v204
v_xor_b32 v207, 7, v206
v_lshl_add_u32 v203, v207, 5, v204
s_lshl_b32 s36, s36, 1
s_lshr_b32 s39, s3, 1
s_add_u32 s36, s36, s39
s_lshl_b32 s24, s36, 19
s_lshl_b32 s38, s38, 16
s_add_u32 s24, s24, s38
s_and_b32 s39, s3, 1
s_lshl_b32 s39, s39, 15
s_add_u32 s24, s24, s39
s_lshl_b32 s36, s42, 24
s_add_u32 s16, s40, s36
s_addc_u32 s17, s41, 0
s_mov_b32 s18, 16777216
s_mov_b32 s19, 0x20000
s_mov_b32 s54, 256
s_mov_b32 s55, 0x20000
v_mov_b32 v78, 1
s_cmp_lg_u32 s2, 0
s_cselect_b32 s43, 0x10000000, 0
v_or_b32 v79, s43, v79
s_waitcnt vmcnt(0)
s_barrier
buffer_store_dword v78, v79, s[52:55], 0 offen sc1
ds_read_b128 v[80:83], v192 offset:0
ds_read_b128 v[84:87], v192 offset:2048
ds_read_b128 v[88:91], v192 offset:4096
ds_read_b128 v[92:95], v192 offset:6144
ds_read_b128 v[96:99], v192 offset:8192
ds_read_b128 v[100:103], v192 offset:10240
ds_read_b128 v[104:107], v192 offset:12288
ds_read_b128 v[108:111], v192 offset:14336
TR 144,196,0
TR 146,196,2048
TR 148,197,0
TR 150,197,2048
TR 152,198,0
TR 154,198,2048
TR 156,199,0
TR 158,199,2048
TR 160,200,0
TR 162,200,2048
TR 164,201,0
TR 166,201,2048
TR 168,202,0
TR 170,202,2048
TR 172,203,0
TR 174,203,2048
s_cmp_eq_u32 s42, 0
s_cbranch_scc0 L_p1_V
L_p1_K:
s_waitcnt lgkmcnt(14)
v_mfma_f32_16x16x32_bf16 a[0:3], v[144:147], v[80:83], 0
s_add_u32 m0, s23, 32768
s_waitcnt lgkmcnt(12)
v_mfma_f32_16x16x32_bf16 a[4:7], v[148:151], v[80:83], 0
ds_read_b128 v[112:115], v193 offset:0
v_mfma_f32_16x16x32_bf16 a[32:35], v[144:147], v[84:87], 0
buffer_load_dwordx4 v184, s[12:15], s21 offen offset:0 lds
v_mfma_f32_16x16x32_bf16 a[36:39], v[148:151], v[84:87], 0
v_mfma_f32_16x16x32_bf16 a[64:67], v[144:147], v[88:91], 0
v_mfma_f32_16x16x32_bf16 a[68:71], v[148:151], v[88:91], 0
buffer_load_dwordx4 v185, s[12:15], s21 offen offset:1024 lds
v_mfma_f32_16x16x32_bf16 a[96:99], v[144:147], v[92:95], 0
v_mfma_f32_16x16x32_bf16 a[100:103], v[148:151], v[92:95], 0
ds_read_b128 v[116:119], v193 offset:2048
buffer_load_dwordx4 v186, s[12:15], s21 offen offset:2048 lds
v_mfma_f32_16x16x32_bf16 a[128:131], v[144:147], v[96:99], 0
v_mfma_f32_16x16x32_bf16 a[132:135], v[148:151], v[96:99], 0
v_mfma_f32_16x16x32_bf16 a[160:163], v[144:147], v[100:103], 0
buffer_load_dwordx4 v187, s[12:15], s21 offen offset:3072 lds
v_mfma_f32_16x16x32_bf16 a[164:167], v[148:151], v[100:103], 0
v_mfma_f32_16x16x32_bf16 a[192:195], v[144:147], v[104:107], 0
s_add_u32 m0, s23, 36864
v_mfma_f32_16x16x32_bf16 a[196:199], v[148:151], v[104:107], 0
ds_read_b128 v[120:123], v193 offset:4096
v_mfma_f32_16x16x32_bf16 a[224:227], v[144:147], v[108:111], 0
TR 144,196,16384
TR 146,196,18432
v_mfma_f32_16x16x32_bf16 a[228:231], v[148:151], v[108:111], 0
TR 148,197,16384
TR 150,197,18432
s_waitcnt lgkmcnt(15)
v_mfma_f32_16x16x32_bf16 a[232:235], v[152:155], v[108:111], 0
buffer_load_dwordx4 v188, s[12:15], s21 offen offset:0 lds
v_mfma_f32_16x16x32_bf16 a[236:239], v[156:159], v[108:111], 0
v_mfma_f32_16x16x32_bf16 a[200:203], v[152:155], v[104:107], 0
buffer_load_dwordx4 v189, s[12:15], s21 offen offset:1024 lds
v_mfma_f32_16x16x32_bf16 a[204:207], v[156:159], v[104:107], 0
v_mfma_f32_16x16x32_bf16 a[168:171], v[152:155], v[100:103], 0
ds_read_b128 v[124:127], v193 offset:6144
buffer_load_dwordx4 v190, s[12:15], s21 offen offset:2048 lds
v_mfma_f32_16x16x32_bf16 a[172:175], v[156:159], v[100:103], 0
v_mfma_f32_16x16x32_bf16 a[136:139], v[152:155], v[96:99], 0
v_mfma_f32_16x16x32_bf16 a[140:143], v[156:159], v[96:99], 0
buffer_load_dwordx4 v191, s[12:15], s21 offen offset:3072 lds
v_mfma_f32_16x16x32_bf16 a[104:107], v[152:155], v[92:95], 0
v_mfma_f32_16x16x32_bf16 a[108:111], v[156:159], v[92:95], 0
s_add_u32 s21, s21, 524288
v_mfma_f32_16x16x32_bf16 a[72:75], v[152:155], v[88:91], 0
ds_read_b128 v[128:131], v193 offset:8192
v_mfma_f32_16x16x32_bf16 a[76:79], v[156:159], v[88:91], 0
v_mfma_f32_16x16x32_bf16 a[40:43], v[152:155], v[84:87], 0
s_and_b32 s21, s21, 4194303
v_mfma_f32_16x16x32_bf16 a[44:47], v[156:159], v[84:87], 0
v_mfma_f32_16x16x32_bf16 a[8:11], v[152:155], v[80:83], 0
TR 152,198,16384
TR 154,198,18432
v_mfma_f32_16x16x32_bf16 a[12:15], v[156:159], v[80:83], 0
TR 156,199,16384
TR 158,199,18432
s_waitcnt lgkmcnt(15)
v_mfma_f32_16x16x32_bf16 a[16:19], v[160:163], v[80:83], 0
ds_read_b128 v[132:135], v193 offset:10240
s_add_u32 m0, s22, 32768
v_mfma_f32_16x16x32_bf16 a[20:23], v[164:167], v[80:83], 0
buffer_load_dwordx4 v176, s[8:11], s20 offen offset:0 lds
v_mfma_f32_16x16x32_bf16 a[48:51], v[160:163], v[84:87], 0
v_mfma_f32_16x16x32_bf16 a[52:55], v[164:167], v[84:87], 0
v_mfma_f32_16x16x32_bf16 a[80:83], v[160:163], v[88:91], 0
buffer_load_dwordx4 v177, s[8:11], s20 offen offset:1024 lds
v_mfma_f32_16x16x32_bf16 a[84:87], v[164:167], v[88:91], 0
v_mfma_f32_16x16x32_bf16 a[112:115], v[160:163], v[92:95], 0
buffer_load_dwordx4 v178, s[8:11], s20 offen offset:2048 lds
v_mfma_f32_16x16x32_bf16 a[116:119], v[164:167], v[92:95], 0
ds_read_b128 v[136:139], v193 offset:12288
v_mfma_f32_16x16x32_bf16 a[144:147], v[160:163], v[96:99], 0
v_mfma_f32_16x16x32_bf16 a[148:151], v[164:167], v[96:99], 0
buffer_load_dwordx4 v179, s[8:11], s20 offen offset:3072 lds
v_mfma_f32_16x16x32_bf16 a[176:179], v[160:163], v[100:103], 0
v_mfma_f32_16x16x32_bf16 a[180:183], v[164:167], v[100:103], 0
s_add_u32 m0, s22, 36864
v_mfma_f32_16x16x32_bf16 a[208:211], v[160:163], v[104:107], 0
v_mfma_f32_16x16x32_bf16 a[212:215], v[164:167], v[104:107], 0
ds_read_b128 v[140:143], v193 offset:14336
v_mfma_f32_16x16x32_bf16 a[240:243], v[160:163], v[108:111], 0
TR 160,200,16384
TR 162,200,18432
v_mfma_f32_16x16x32_bf16 a[244:247], v[164:167], v[108:111], 0
TR 164,201,16384
TR 166,201,18432
v_mfma_f32_16x16x32_bf16 a[248:251], v[168:171], v[108:111], 0
buffer_load_dwordx4 v180, s[8:11], s20 offen offset:0 lds
s_waitcnt lgkmcnt(15)
v_mfma_f32_16x16x32_bf16 a[252:255], v[172:175], v[108:111], 0
buffer_load_dwordx4 v181, s[8:11], s20 offen offset:1024 lds
v_mfma_f32_16x16x32_bf16 a[216:219], v[168:171], v[104:107], 0
v_mfma_f32_16x16x32_bf16 a[220:223], v[172:175], v[104:107], 0
buffer_load_dwordx4 v182, s[8:11], s20 offen offset:2048 lds
v_mfma_f32_16x16x32_bf16 a[184:187], v[168:171], v[100:103], 0
v_mfma_f32_16x16x32_bf16 a[188:191], v[172:175], v[100:103], 0
v_mfma_f32_16x16x32_bf16 a[152:155], v[168:171], v[96:99], 0
buffer_load_dwordx4 v183, s[8:11], s20 offen offset:3072 lds
v_mfma_f32_16x16x32_bf16 a[156:159], v[172:175], v[96:99], 0
v_mfma_f32_16x16x32_bf16 a[120:123], v[168:171], v[92:95], 0
s_add_u32 s20, s20, 128
v_mfma_f32_16x16x32_bf16 a[124:127], v[172:175], v[92:95], 0
v_mfma_f32_16x16x32_bf16 a[88:91], v[168:171], v[88:91], 0
v_mfma_f32_16x16x32_bf16 a[92:95], v[172:175], v[88:91], 0
s_and_b32 s20, s20, 1023
v_mfma_f32_16x16x32_bf16 a[56:59], v[168:171], v[84:87], 0
v_mfma_f32_16x16x32_bf16 a[60:63], v[172:175], v[84:87], 0
v_mfma_f32_16x16x32_bf16 a[24:27], v[168:171], v[80:83], 0
TR 168,202,16384
TR 170,202,18432
v_mfma_f32_16x16x32_bf16 a[28:31], v[172:175], v[80:83], 0
TR 172,203,16384
TR 174,203,18432
s_waitcnt lgkmcnt(4)
MA 0,v,144,v,112
s_add_u32 m0, s22, 65536
MA 4,v,148,v,112
MA 32,v,144,v,116
MA 36,v,148,v,116
buffer_load_dwordx4 v176, s[8:11], s20 offen offset:0 lds
MA 64,v,144,v,120
MA 68,v,148,v,120
MA 96,v,144,v,124
MA 100,v,148,v,124
buffer_load_dwordx4 v177, s[8:11], s20 offen offset:1024 lds
MA 128,v,144,v,128
MA 132,v,148,v,128
MA 160,v,144,v,132
buffer_load_dwordx4 v178, s[8:11], s20 offen offset:2048 lds
MA 164,v,148,v,132
MA 192,v,144,v,136
MA 196,v,148,v,136
MA 224,v,144,v,140
buffer_load_dwordx4 v179, s[8:11], s20 offen offset:3072 lds
MA 228,v,148,v,140
MA 232,v,152,v,140
MA 236,v,156,v,140
s_add_u32 m0, s22, 69632
MA 200,v,152,v,136
MA 204,v,156,v,136
MA 168,v,152,v,132
MA 172,v,156,v,132
buffer_load_dwordx4 v180, s[8:11], s20 offen offset:0 lds
MA 136,v,152,v,128
MA 140,v,156,v,128
MA 104,v,152,v,124
MA 108,v,156,v,124
buffer_load_dwordx4 v181, s[8:11], s20 offen offset:1024 lds
MA 72,v,152,v,120
MA 76,v,156,v,120
MA 40,v,152,v,116
buffer_load_dwordx4 v182, s[8:11], s20 offen offset:2048 lds
MA 44,v,156,v,116
MA 8,v,152,v,112
MA 12,v,156,v,112
MA 16,v,160,v,112
buffer_load_dwordx4 v183, s[8:11], s20 offen offset:3072 lds
MA 20,v,164,v,112
MA 48,v,160,v,116
MA 52,v,164,v,116
s_add_u32 s20, s20, 128
MA 80,v,160,v,120
MA 84,v,164,v,120
MA 112,v,160,v,124
MA 116,v,164,v,124
s_and_b32 s20, s20, 1023
MA 144,v,160,v,128
MA 148,v,164,v,128
MA 176,v,160,v,132
MA 180,v,164,v,132
MA 208,v,160,v,136
s_waitcnt vmcnt(8) lgkmcnt(0)
s_barrier
MA 212,v,164,v,136
TR 144,196,32768
TR 146,196,34816
MA 240,v,160,v,140
ds_read_b128 v[80:83], v192 offset:32768
s_add_u32 m0, s23, 0
MA 244,v,164,v,140
TR 148,197,32768
TR 150,197,34816
MA 248,v,168,v,140
ds_read_b128 v[84:87], v192 offset:34816
ds_read_b128 v[88:91], v192 offset:36864
MA 252,v,172,v,140
TR 152,198,32768
TR 154,198,34816
MA 216,v,168,v,136
ds_read_b128 v[92:95], v192 offset:38912
ds_read_b128 v[96:99], v192 offset:40960
MA 220,v,172,v,136
TR 156,199,32768
TR 158,199,34816
MA 184,v,168,v,132
ds_read_b128 v[100:103], v192 offset:43008
ds_read_b128 v[104:107], v192 offset:45056
MA 188,v,172,v,132
TR 160,200,32768
TR 162,200,34816
MA 152,v,168,v,128
ds_read_b128 v[108:111], v192 offset:47104
buffer_load_dwordx4 v184, s[12:15], s21 offen offset:0 lds
MA 156,v,172,v,128
TR 164,201,32768
TR 166,201,34816
MA 120,v,168,v,124
buffer_load_dwordx4 v185, s[12:15], s21 offen offset:1024 lds
buffer_load_dwordx4 v186, s[12:15], s21 offen offset:2048 lds
MA 124,v,172,v,124
buffer_load_dwordx4 v187, s[12:15], s21 offen offset:3072 lds
s_add_u32 m0, s23, 4096
MA 88,v,168,v,120
buffer_load_dwordx4 v188, s[12:15], s21 offen offset:0 lds
buffer_load_dwordx4 v189, s[12:15], s21 offen offset:1024 lds
MA 92,v,172,v,120
buffer_load_dwordx4 v190, s[12:15], s21 offen offset:2048 lds
buffer_load_dwordx4 v191, s[12:15], s21 offen offset:3072 lds
MA 56,v,168,v,116
s_add_u32 s21, s21, 524288
s_and_b32 s21, s21, 4194303
MA 60,v,172,v,116
s_load_dwordx2 s[84:85], s[0:1], 8
s_load_dwordx2 s[88:89], s[0:1], 16
MA 24,v,168,v,112
TR 168,202,32768
TR 170,202,34816
MA 28,v,172,v,112
TR 172,203,32768
TR 174,203,34816
s_load_dwordx2 s[92:93], s[0:1], 0
s_load_dwordx2 s[96:97], s[0:1], 24
s_load_dwordx2 s[76:77], s[0:1], 96
s_waitcnt lgkmcnt(4)
MA 0,v,144,v,80
s_add_u32 m0, s22, 0
MA 4,v,148,v,80
ds_read_b128 v[112:115], v193 offset:32768
MA 32,v,144,v,84
s_mov_b32 s4, s34
s_mov_b32 s5, s35
MA 36,v,148,v,84
MA 64,v,144,v,88
MA 68,v,148,v,88
buffer_load_dwordx4 v176, s[8:11], s20 offen offset:0 lds
MA 96,v,144,v,92
MA 100,v,148,v,92
ds_read_b128 v[116:119], v193 offset:34816
MA 128,v,144,v,96
s_mov_b32 s6, 8388608
s_mov_b32 s7, 0x20000
MA 132,v,148,v,96
MA 160,v,144,v,100
buffer_load_dwordx4 v177, s[8:11], s20 offen offset:1024 lds
MA 164,v,148,v,100
MA 192,v,144,v,104
MA 196,v,148,v,104
ds_read_b128 v[120:123], v193 offset:36864
MA 224,v,144,v,108
TR 144,196,49152
TR 146,196,51200
MA 228,v,148,v,108
TR 148,197,49152
TR 150,197,51200
MA 232,v,152,v,108
buffer_load_dwordx4 v178, s[8:11], s20 offen offset:2048 lds
s_lshr_b32 s43, s2, 3
MA 236,v,156,v,108
MA 200,v,152,v,104
MA 204,v,156,v,104
s_lshl_b32 s43, s43, 2
MA 168,v,152,v,100
ds_read_b128 v[124:127], v193 offset:38912
buffer_load_dwordx4 v179, s[8:11], s20 offen offset:3072 lds
MA 172,v,156,v,100
MA 136,v,152,v,96
MA 140,v,156,v,96
s_add_u32 s43, s43, s3
MA 104,v,152,v,92
MA 108,v,156,v,92
s_add_u32 m0, s22, 4096
MA 72,v,152,v,88
ds_read_b128 v[128:131], v193 offset:40960
MA 76,v,156,v,88
s_lshl_b32 s43, s43, 16
MA 40,v,152,v,84
MA 44,v,156,v,84
MA 8,v,152,v,80
TR 152,198,49152
TR 154,198,51200
MA 12,v,156,v,80
TR 156,199,49152
TR 158,199,51200
MA 16,v,160,v,80
ds_read_b128 v[132:135], v193 offset:43008
buffer_load_dwordx4 v180, s[8:11], s20 offen offset:0 lds
MA 20,v,164,v,80
s_and_b32 s37, s2, 7
MA 48,v,160,v,84
s_lshl_b32 s37, s37, 10
MA 52,v,164,v,84
MA 80,v,160,v,88
buffer_load_dwordx4 v181, s[8:11], s20 offen offset:1024 lds
MA 84,v,164,v,88
MA 112,v,160,v,92
s_add_u32 s43, s43, s37
MA 116,v,164,v,92
ds_read_b128 v[136:139], v193 offset:45056
MA 144,v,160,v,96
MA 148,v,164,v,96
buffer_load_dwordx4 v182, s[8:11], s20 offen offset:2048 lds
MA 176,v,160,v,100
v_lshrrev_b32 v78, 3, v1
MA 180,v,164,v,100
MA 208,v,160,v,104
MA 212,v,164,v,104
ds_read_b128 v[140:143], v193 offset:47104
MA 240,v,160,v,108
TR 160,200,49152
TR 162,200,51200
MA 244,v,164,v,108
TR 164,201,49152
TR 166,201,51200
s_waitcnt lgkmcnt(15)
MA 248,v,168,v,108
buffer_load_dwordx4 v183, s[8:11], s20 offen offset:3072 lds
v_and_b32 v79, 7, v1
MA 252,v,172,v,108
MA 216,v,168,v,104
v_lshlrev_b32 v79, 7, v79
MA 220,v,172,v,104
s_add_u32 s20, s20, 128
MA 184,v,168,v,100
MA 188,v,172,v,100
MA 152,v,168,v,96
v_lshl_add_u32 v78, v78, 13, v79
MA 156,v,172,v,96
MA 120,v,168,v,92
s_and_b32 s20, s20, 1023
MA 124,v,172,v,92
MA 88,v,168,v,88
v_add_u32 v78, s43, v78
MA 92,v,172,v,88
MA 56,v,168,v,84
MA 60,v,172,v,84
MA 24,v,168,v,80
TR 168,202,49152
TR 170,202,51200
MA 28,v,172,v,80
TR 172,203,49152
TR 174,203,51200
s_waitcnt lgkmcnt(4)
MA 0,v,144,v,112
MA 4,v,148,v,112
MA 32,v,144,v,116
MA 36,v,148,v,116
MA 64,v,144,v,120
MA 68,v,148,v,120
MA 96,v,144,v,124
MA 100,v,148,v,124
MA 128,v,144,v,128
MA 132,v,148,v,128
s_waitcnt vmcnt(8) lgkmcnt(0)
s_barrier
MA 160,v,144,v,132
s_add_u32 m0, s23, 32768
s_mov_b32 s86, 4194304
MA 164,v,148,v,132
ds_read_b128 v[80:83], v194 offset:0
s_mov_b32 s87, 0x20000
MA 192,v,144,v,136
s_mov_b32 s90, 4194304
MA 196,v,148,v,136
s_mov_b32 s91, 0x20000
MA 224,v,144,v,140
TR 144,196,0
TR 146,196,2048
MA 228,v,148,v,140
TR 148,197,0
TR 150,197,2048
MA 232,v,152,v,140
ds_read_b128 v[84:87], v194 offset:2048
buffer_load_dwordx4 v184, s[12:15], s21 offen offset:0 lds
MA 236,v,156,v,140
s_mov_b32 s94, 4194304
s_mov_b32 s95, 0x20000
MA 200,v,152,v,136
buffer_load_dwordx4 v185, s[12:15], s21 offen offset:1024 lds
s_mov_b32 s98, 8192
MA 204,v,156,v,136
s_mov_b32 s99, 0x20000
MA 168,v,152,v,132
s_mov_b32 s78, 2048
MA 172,v,156,v,132
ds_read_b128 v[88:91], v194 offset:4096
s_mov_b32 s79, 0x20000
MA 136,v,152,v,128
s_and_b32 s36, s2, 15
MA 140,v,156,v,128
buffer_load_dwordx4 v186, s[12:15], s21 offen offset:2048 lds
s_lshl_b32 s36, s36, 1
MA 104,v,152,v,124
MA 108,v,156,v,124
s_lshr_b32 s37, s3, 1
MA 72,v,152,v,120
ds_read_b128 v[92:95], v194 offset:6144
s_add_u32 s36, s36, s37
MA 76,v,156,v,120
buffer_load_dwordx4 v187, s[12:15], s21 offen offset:3072 lds
s_lshl_b32 s36, s36, 3
MA 40,v,152,v,116
MA 44,v,156,v,116
v_and_b32 v252, 7, v1
MA 8,v,152,v,112
TR 152,198,0
TR 154,198,2048
MA 12,v,156,v,112
TR 156,199,0
TR 158,199,2048
MA 16,v,160,v,112
ds_read_b128 v[96:99], v194 offset:8192
s_add_u32 m0, s23, 36864
MA 20,v,164,v,112
v_add_u32 v252, s36, v252
s_lshr_b32 s36, s2, 4
MA 48,v,160,v,116
s_lshl_b32 s36, s36, 1
s_and_b32 s37, s3, 1
MA 52,v,164,v,116
s_add_u32 s36, s36, s37
MA 80,v,160,v,120
ds_read_b128 v[100:103], v194 offset:10240
buffer_load_dwordx4 v188, s[12:15], s21 offen offset:0 lds
MA 84,v,164,v,120
s_lshl_b32 s36, s36, 3
v_lshrrev_b32 v253, 3, v1
MA 112,v,160,v,124
MA 116,v,164,v,124
v_add_u32 v253, s36, v253
MA 144,v,160,v,128
buffer_load_dwordx4 v189, s[12:15], s21 offen offset:1024 lds
v_lshlrev_b32 v254, 14, v253
MA 148,v,164,v,128
ds_read_b128 v[104:107], v194 offset:12288
v_lshl_add_u32 v254, v252, 3, v254
MA 176,v,160,v,132
v_add_u32 v229, -6144, v254
MA 180,v,164,v,132
MA 208,v,160,v,136
buffer_load_dwordx4 v190, s[12:15], s21 offen offset:2048 lds
v_lshlrev_b32 v62, 5, v252
MA 212,v,164,v,136
v_lshlrev_b32 v254, 4, v253
MA 240,v,160,v,140
TR 160,200,0
TR 162,200,2048
MA 244,v,164,v,140
TR 164,201,0
TR 166,201,2048
MA 248,v,168,v,140
ds_read_b128 v[108:111], v194 offset:14336
v_sub_u32 v254, 4080, v254
MA 252,v,172,v,140
buffer_load_dwordx4 v191, s[12:15], s21 offen offset:3072 lds
v_lshl_add_u32 v10, v252, 14, v254
MA 216,v,168,v,136
v_and_b32 v252, 31, v1
v_lshlrev_b32 v64, 4, v252
MA 220,v,172,v,136
s_lshl_b32 s36, s2, 2
MA 184,v,168,v,132
MA 188,v,172,v,132
s_add_u32 s21, s21, 524288
s_add_u32 s36, s36, s3
MA 152,v,168,v,128
s_lshl_b32 s36, s36, 1
MA 156,v,172,v,128
v_lshrrev_b32 v253, 5, v1
MA 120,v,168,v,124
v_add_u32 v253, s36, v253
MA 124,v,172,v,124
s_and_b32 s21, s21, 4194303
MA 88,v,168,v,120
v_lshl_add_u32 v63, v253, 11, v64
MA 92,v,172,v,120
v_lshlrev_b32 v253, 2, v253
MA 56,v,168,v,116
v_lshl_add_u32 v11, v252, 20, v253
MA 60,v,172,v,116
MA 24,v,168,v,112
TR 168,202,0
TR 170,202,2048
MA 28,v,172,v,112
TR 172,203,0
TR 174,203,2048
s_waitcnt lgkmcnt(4)
MA 0,v,144,v,80
s_add_u32 m0, s22, 32768
buffer_load_dwordx4 v[230:233], v63, s[92:95], 0 offen offset:0
MA 4,v,148,v,80
ds_read_b128 v[112:115], v195 offset:0
MA 32,v,144,v,84
MA 36,v,148,v,84
MA 64,v,144,v,88
buffer_load_dwordx4 v[2:5], v64, s[76:79], 0 offen offset:0
MA 68,v,148,v,88
buffer_load_dwordx4 v176, s[8:11], s20 offen offset:0 lds
MA 96,v,144,v,92
MA 100,v,148,v,92
ds_read_b128 v[116:119], v195 offset:2048
MA 128,v,144,v,96
MA 132,v,148,v,96
buffer_load_dwordx4 v[234:237], v63, s[92:95], 0 offen offset:512
MA 160,v,144,v,100
buffer_load_dwordx4 v177, s[8:11], s20 offen offset:1024 lds
MA 164,v,148,v,100
MA 192,v,144,v,104
MA 196,v,148,v,104
ds_read_b128 v[120:123], v195 offset:4096
MA 224,v,144,v,108
TR 144,196,16384
TR 146,196,18432
MA 228,v,148,v,108
TR 148,197,16384
TR 150,197,18432
MA 232,v,152,v,108
buffer_load_dwordx4 v178, s[8:11], s20 offen offset:2048 lds
buffer_load_dwordx4 v[6:9], v64, s[76:79], 0 offen offset:512
MA 236,v,156,v,108
MA 200,v,152,v,104
MA 204,v,156,v,104
buffer_load_dwordx4 v[238:241], v63, s[92:95], 0 offen offset:1024
MA 168,v,152,v,100
ds_read_b128 v[124:127], v195 offset:6144
buffer_load_dwordx4 v179, s[8:11], s20 offen offset:3072 lds
MA 172,v,156,v,100
MA 136,v,152,v,96
MA 140,v,156,v,96
buffer_load_dwordx4 v[12:15], v64, s[76:79], 0 offen offset:1024
MA 104,v,152,v,92
MA 108,v,156,v,92
s_add_u32 m0, s22, 36864
MA 72,v,152,v,88
ds_read_b128 v[128:131], v195 offset:8192
MA 76,v,156,v,88
MA 40,v,152,v,84
buffer_load_dwordx4 v[242:245], v63, s[92:95], 0 offen offset:1536
MA 44,v,156,v,84
MA 8,v,152,v,80
TR 152,198,16384
TR 154,198,18432
MA 12,v,156,v,80
TR 156,199,16384
TR 158,199,18432
MA 16,v,160,v,80
ds_read_b128 v[132:135], v195 offset:10240
buffer_load_dwordx4 v180, s[8:11], s20 offen offset:0 lds
MA 20,v,164,v,80
buffer_load_dwordx4 v[246:249], v64, s[76:79], 0 offen offset:1536
MA 48,v,160,v,84
MA 52,v,164,v,84
MA 80,v,160,v,88
buffer_load_dwordx4 v181, s[8:11], s20 offen offset:1024 lds
MA 84,v,164,v,88
MA 112,v,160,v,92
buffer_load_dwordx4 v[54:57], v62, s[96:99], 0 offen offset:0
MA 116,v,164,v,92
ds_read_b128 v[136:139], v195 offset:12288
MA 144,v,160,v,96
MA 148,v,164,v,96
buffer_load_dwordx4 v182, s[8:11], s20 offen offset:2048 lds
MA 176,v,160,v,100
buffer_load_dwordx4 v[58:61], v62, s[96:99], 0 offen offset:16
MA 180,v,164,v,100
MA 208,v,160,v,104
MA 212,v,164,v,104
ds_read_b128 v[140:143], v195 offset:14336
MA 240,v,160,v,108
TR 160,200,16384
TR 162,200,18432
MA 244,v,164,v,108
TR 164,201,16384
TR 166,201,18432
s_waitcnt lgkmcnt(15)
MA 248,v,168,v,108
buffer_load_dwordx4 v183, s[8:11], s20 offen offset:3072 lds
v_add_u32 v252, 0, v229
MA 252,v,172,v,108
MA 216,v,168,v,104
MA 220,v,172,v,104
s_add_u32 s20, s20, 128
MA 184,v,168,v,100
buffer_load_dwordx2 v[16:17], v252, s[84:87], 0 offen
MA 188,v,172,v,100
MA 152,v,168,v,96
MA 156,v,172,v,96
MA 120,v,168,v,92
s_and_b32 s20, s20, 1023
MA 124,v,172,v,92
v_add_u32 v253, 2048, v229
MA 88,v,168,v,88
MA 92,v,172,v,88
MA 56,v,168,v,84
MA 60,v,172,v,84
MA 24,v,168,v,80
TR 168,202,16384
TR 170,202,18432
MA 28,v,172,v,80
TR 172,203,16384
TR 174,203,18432
s_waitcnt lgkmcnt(4)
MA 0,v,144,v,112
MA 4,v,148,v,112
MA 32,v,144,v,116
MA 36,v,148,v,116
MA 64,v,144,v,120
MA 68,v,148,v,120
MA 96,v,144,v,124
MA 100,v,148,v,124
MA 128,v,144,v,128
MA 132,v,148,v,128
s_waitcnt vmcnt(19) lgkmcnt(0)
s_barrier
MA 160,v,144,v,132
s_add_u32 m0, s23, 0
s_bfe_u32 s80, s2, 0x20001
MA 164,v,148,v,132
ds_read_b128 v[80:83], v192 offset:0
s_bfe_u32 s69, s2, 0x30003
MA 192,v,144,v,136
s_lshl_b32 s80, s80, 3
s_add_u32 s69, s69, s80
MA 196,v,148,v,136
s_lshr_b32 s80, s2, 6
MA 224,v,144,v,140
TR 144,196,32768
TR 146,196,34816
MA 228,v,148,v,140
TR 148,197,32768
TR 150,197,34816
MA 232,v,152,v,140
ds_read_b128 v[84:87], v192 offset:2048
buffer_load_dwordx4 v184, s[12:15], s21 offen offset:0 lds
MA 236,v,156,v,140
s_xor_b32 s81, s80, s2
s_and_b32 s81, s81, 1
MA 200,v,152,v,136
buffer_load_dwordx4 v185, s[12:15], s21 offen offset:1024 lds
s_lshl_b32 s70, s80, 1
MA 204,v,156,v,136
s_add_u32 s70, s70, s81
s_lshl_b32 s80, s3, 1
MA 168,v,152,v,132
s_sub_u32 s80, 7, s80
s_lshl_b32 s76, s80, 17
MA 172,v,156,v,132
ds_read_b128 v[88:91], v192 offset:4096
s_lshl_b32 s80, s3, 15
MA 136,v,152,v,128
s_lshl_b32 s65, s70, 18
s_sub_u32 s64, 3932160, s65
MA 140,v,156,v,128
buffer_load_dwordx4 v186, s[12:15], s21 offen offset:2048 lds
s_add_u32 s65, s65, s80
MA 104,v,152,v,124
s_add_u32 s64, s64, s80
MA 108,v,156,v,124
s_lshl_b32 s81, s69, 12
MA 72,v,152,v,120
ds_read_b128 v[92:95], v192 offset:6144
s_lshl_b32 s100, s64, 2
MA 76,v,156,v,120
buffer_load_dwordx4 v187, s[12:15], s21 offen offset:3072 lds
s_add_u32 s100, s100, s81
MA 40,v,152,v,116
s_lshl_b32 s101, s65, 2
MA 44,v,156,v,116
s_add_u32 s101, s101, s81
MA 8,v,152,v,112
TR 152,198,32768
TR 154,198,34816
MA 12,v,156,v,112
TR 156,199,32768
TR 158,199,34816
MA 16,v,160,v,112
ds_read_b128 v[96:99], v192 offset:8192
s_add_u32 m0, s23, 4096
MA 20,v,164,v,112
s_lshl_b32 s66, s3, 17
s_lshl_b32 s81, s69, 8
MA 48,v,160,v,116
s_add_u32 s66, s66, s81
s_and_b32 s74, s2, 7
MA 52,v,164,v,116
s_lshl_b32 s74, s74, 8
s_mov_b32 s82, s66
MA 80,v,160,v,120
ds_read_b128 v[100:103], v192 offset:10240
buffer_load_dwordx4 v188, s[12:15], s21 offen offset:0 lds
MA 84,v,164,v,120
s_lshl_b32 s66, s74, 12
s_lshl_b32 s67, s3, 13
MA 112,v,160,v,124
s_lshl_b32 s68, s3, 12
s_lshl_b32 s77, s70, 1
MA 116,v,164,v,124
s_sub_u32 s77, 32, s77
MA 144,v,160,v,128
buffer_load_dwordx4 v189, s[12:15], s21 offen offset:1024 lds
v_lshrrev_b32 v66, 3, v1
MA 148,v,164,v,128
ds_read_b128 v[104:107], v192 offset:12288
v_lshlrev_b32 v66, 11, v66
MA 176,v,160,v,132
v_lshrrev_b32 v67, 4, v1
v_and_b32 v68, 7, v1
MA 180,v,164,v,132
v_xor_b32 v68, v68, v67
MA 208,v,160,v,136
buffer_load_dwordx4 v190, s[12:15], s21 offen offset:2048 lds
v_lshl_add_u32 v66, v68, 4, v66
MA 212,v,164,v,136
v_xor_b32 v69, 64, v66
MA 240,v,160,v,140
TR 160,200,32768
TR 162,200,34816
MA 244,v,164,v,140
TR 164,201,32768
TR 166,201,34816
MA 248,v,168,v,140
ds_read_b128 v[108:111], v192 offset:14336
s_lshr_b32 s83, s76, 2
MA 252,v,172,v,140
buffer_load_dwordx4 v191, s[12:15], s21 offen offset:3072 lds
v_add_u32 v208, 0, v66
MA 216,v,168,v,136
v_add_u32 v209, 15360, v69
v_add_u32 v210, -2048, v66
MA 220,v,172,v,136
v_add_u32 v210, s83, v210
v_add_u32 v211, 13312, v69
MA 184,v,168,v,132
v_add_u32 v211, s83, v211
v_and_b32 v68, 15, v1
MA 188,v,172,v,132
s_add_u32 s21, s21, 524288
v_lshlrev_b32 v69, 1, v67
MA 152,v,168,v,128
v_xor_b32 v68, v68, v69
MA 156,v,172,v,128
v_lshlrev_b32 v66, 13, v67
MA 120,v,168,v,124
v_xor_b32 v69, 0, v68
MA 124,v,172,v,124
s_and_b32 s21, s21, 4194303
v_lshl_add_u32 v69, v69, 4, v66
MA 88,v,168,v,120
v_add_u32 v212, 0, v69
MA 92,v,172,v,120
v_xor_b32 v69, 0, v68
MA 56,v,168,v,116
v_lshl_add_u32 v69, v69, 4, v66
MA 60,v,172,v,116
v_add_u32 v213, 31744, v69
MA 24,v,168,v,112
TR 168,202,32768
TR 170,202,34816
MA 28,v,172,v,112
TR 172,203,32768
TR 174,203,34816
s_waitcnt lgkmcnt(4)
MA 0,v,144,v,80
s_add_u32 m0, s22, 65536
buffer_load_dwordx2 v[18:19], v253, s[84:87], 0 offen
MA 4,v,148,v,80
ds_read_b128 v[112:115], v193 offset:0
MA 32,v,144,v,84
MA 36,v,148,v,84
MA 64,v,144,v,88
v_add_u32 v254, 4096, v229
MA 68,v,148,v,88
buffer_load_dwordx4 v176, s[8:11], s20 offen offset:0 lds
MA 96,v,144,v,92
MA 100,v,148,v,92
ds_read_b128 v[116:119], v193 offset:2048
MA 128,v,144,v,96
MA 132,v,148,v,96
buffer_load_dwordx2 v[20:21], v254, s[84:87], 0 offen
MA 160,v,144,v,100
buffer_load_dwordx4 v177, s[8:11], s20 offen offset:1024 lds
MA 164,v,148,v,100
MA 192,v,144,v,104
MA 196,v,148,v,104
ds_read_b128 v[120:123], v193 offset:4096
MA 224,v,144,v,108
TR 144,196,49152
TR 146,196,51200
MA 228,v,148,v,108
TR 148,197,49152
TR 150,197,51200
MA 232,v,152,v,108
buffer_load_dwordx4 v178, s[8:11], s20 offen offset:2048 lds
v_add_u32 v255, 6144, v229
MA 236,v,156,v,108
MA 200,v,152,v,104
MA 204,v,156,v,104
buffer_load_dwordx2 v[22:23], v255, s[84:87], 0 offen
MA 168,v,152,v,100
ds_read_b128 v[124:127], v193 offset:6144
buffer_load_dwordx4 v179, s[8:11], s20 offen offset:3072 lds
MA 172,v,156,v,100
MA 136,v,152,v,96
MA 140,v,156,v,96
buffer_load_dwordx2 v[38:39], v255, s[88:91], 0 offen
MA 104,v,152,v,92
MA 108,v,156,v,92
s_add_u32 m0, s22, 69632
MA 72,v,152,v,88
ds_read_b128 v[128:131], v193 offset:8192
MA 76,v,156,v,88
MA 40,v,152,v,84
v_add_u32 v252, 8192, v229
MA 44,v,156,v,84
MA 8,v,152,v,80
TR 152,198,49152
TR 154,198,51200
MA 12,v,156,v,80
TR 156,199,49152
TR 158,199,51200
MA 16,v,160,v,80
ds_read_b128 v[132:135], v193 offset:10240
buffer_load_dwordx4 v180, s[8:11], s20 offen offset:0 lds
MA 20,v,164,v,80
buffer_load_dwordx2 v[24:25], v252, s[84:87], 0 offen
MA 48,v,160,v,84
MA 52,v,164,v,84
MA 80,v,160,v,88
buffer_load_dwordx4 v181, s[8:11], s20 offen offset:1024 lds
MA 84,v,164,v,88
MA 112,v,160,v,92
buffer_load_dwordx2 v[40:41], v252, s[88:91], 0 offen
MA 116,v,164,v,92
ds_read_b128 v[136:139], v193 offset:12288
MA 144,v,160,v,96
MA 148,v,164,v,96
buffer_load_dwordx4 v182, s[8:11], s20 offen offset:2048 lds
MA 176,v,160,v,100
v_add_u32 v253, 10240, v229
MA 180,v,164,v,100
MA 208,v,160,v,104
MA 212,v,164,v,104
ds_read_b128 v[140:143], v193 offset:14336
MA 240,v,160,v,108
TR 160,200,49152
TR 162,200,51200
MA 244,v,164,v,108
TR 164,201,49152
TR 166,201,51200
s_waitcnt lgkmcnt(15)
MA 248,v,168,v,108
buffer_load_dwordx4 v183, s[8:11], s20 offen offset:3072 lds
buffer_load_dwordx2 v[26:27], v253, s[84:87], 0 offen
MA 252,v,172,v,108
MA 216,v,168,v,104
MA 220,v,172,v,104
s_add_u32 s20, s20, 128
MA 184,v,168,v,100
buffer_load_dwordx2 v[42:43], v253, s[88:91], 0 offen
MA 188,v,172,v,100
MA 152,v,168,v,96
MA 156,v,172,v,96
MA 120,v,168,v,92
s_and_b32 s20, s20, 1023
MA 124,v,172,v,92
v_add_u32 v254, 12288, v229
MA 88,v,168,v,88
MA 92,v,172,v,88
MA 56,v,168,v,84
MA 60,v,172,v,84
MA 24,v,168,v,80
TR 168,202,49152
TR 170,202,51200
MA 28,v,172,v,80
TR 172,203,49152
TR 174,203,51200
s_waitcnt lgkmcnt(4)
MA 0,v,144,v,112
MA 4,v,148,v,112
MA 32,v,144,v,116
MA 36,v,148,v,116
MA 64,v,144,v,120
MA 68,v,148,v,120
MA 96,v,144,v,124
MA 100,v,148,v,124
MA 128,v,144,v,128
MA 132,v,148,v,128
s_waitcnt vmcnt(16) lgkmcnt(0)
s_barrier
MA 160,v,144,v,132
s_add_u32 m0, s23, 32768
v_xor_b32 v69, 8, v68
MA 164,v,148,v,132
ds_read_b128 v[80:83], v192 offset:32768
v_lshl_add_u32 v69, v69, 4, v66
MA 192,v,144,v,136
v_add_u32 v214, 63488, v69
v_xor_b32 v69, 8, v68
MA 196,v,148,v,136
v_lshl_add_u32 v69, v69, 4, v66
MA 224,v,144,v,140
TR 144,196,0
TR 146,196,2048
MA 228,v,148,v,140
TR 148,197,0
TR 150,197,2048
MA 232,v,152,v,140
ds_read_b128 v[84:87], v192 offset:34816
buffer_load_dwordx4 v184, s[12:15], s21 offen offset:0 lds
MA 236,v,156,v,140
v_add_u32 v215, 95232, v69
v_and_b32 v66, 15, v1
MA 200,v,152,v,136
buffer_load_dwordx4 v185, s[12:15], s21 offen offset:1024 lds
v_lshrrev_b32 v68, 1, v66
MA 204,v,156,v,136
v_xor_b32 v68, v68, v67
v_lshlrev_b32 v68, 4, v68
MA 168,v,152,v,132
v_lshl_add_u32 v68, v66, 7, v68
v_add_u32 v224, s67, v68
MA 172,v,156,v,132
ds_read_b128 v[88:91], v192 offset:36864
v_xor_b32 v225, 64, v224
MA 136,v,152,v,128
v_add_u32 v226, 0x10000, v224
v_add_u32 v227, 0x10000, v225
MA 140,v,156,v,128
buffer_load_dwordx4 v186, s[12:15], s21 offen offset:2048 lds
v_bfe_u32 v66, v1, 2, 2
MA 104,v,152,v,124
v_and_b32 v68, 1, v67
v_lshl_or_b32 v68, v68, 2, v66
MA 108,v,156,v,124
v_lshl_add_u32 v66, v67, 3, v66
v_lshlrev_b32 v66, 8, v66
MA 72,v,152,v,120
ds_read_b128 v[92:95], v192 offset:38912
v_and_b32 v69, 3, v1
MA 76,v,156,v,120
buffer_load_dwordx4 v187, s[12:15], s21 offen offset:3072 lds
v_lshl_add_u32 v66, v69, 3, v66
MA 40,v,152,v,116
v_add_u32 v66, 98304, v66
MA 44,v,156,v,116
v_xor_b32 v69, 0, v68
MA 8,v,152,v,112
TR 152,198,0
TR 154,198,2048
MA 12,v,156,v,112
TR 156,199,0
TR 158,199,2048
MA 16,v,160,v,112
ds_read_b128 v[96:99], v192 offset:40960
s_add_u32 m0, s23, 36864
MA 20,v,164,v,112
v_lshl_add_u32 v216, v69, 5, v66
v_xor_b32 v69, 1, v68
MA 48,v,160,v,116
v_lshl_add_u32 v217, v69, 5, v66
v_xor_b32 v69, 2, v68
MA 52,v,164,v,116
v_lshl_add_u32 v218, v69, 5, v66
v_xor_b32 v69, 3, v68
MA 80,v,160,v,120
ds_read_b128 v[100:103], v192 offset:43008
buffer_load_dwordx4 v188, s[12:15], s21 offen offset:0 lds
MA 84,v,164,v,120
v_lshl_add_u32 v219, v69, 5, v66
v_xor_b32 v69, 4, v68
MA 112,v,160,v,124
v_lshl_add_u32 v220, v69, 5, v66
v_xor_b32 v69, 5, v68
MA 116,v,164,v,124
v_lshl_add_u32 v221, v69, 5, v66
v_xor_b32 v69, 6, v68
MA 144,v,160,v,128
buffer_load_dwordx4 v189, s[12:15], s21 offen offset:1024 lds
v_lshl_add_u32 v222, v69, 5, v66
MA 148,v,164,v,128
ds_read_b128 v[104:107], v192 offset:45056
v_xor_b32 v69, 7, v68
MA 176,v,160,v,132
v_lshl_add_u32 v223, v69, 5, v66
s_mov_b32 s44, s32
MA 180,v,164,v,132
s_mov_b32 s45, s33
MA 208,v,160,v,136
buffer_load_dwordx4 v190, s[12:15], s21 offen offset:2048 lds
s_mov_b32 s46, 4194304
MA 212,v,164,v,136
s_mov_b32 s47, 0x20000
MA 240,v,160,v,140
TR 160,200,0
TR 162,200,2048
MA 244,v,164,v,140
TR 164,201,0
TR 166,201,2048
MA 248,v,168,v,140
ds_read_b128 v[108:111], v192 offset:47104
MA 252,v,172,v,140
buffer_load_dwordx4 v191, s[12:15], s21 offen offset:3072 lds
MA 216,v,168,v,136
s_add_u32 s48, s34, s82
s_addc_u32 s49, s35, 0
MA 220,v,172,v,136
s_sub_u32 s50, 8388608, s82
s_mov_b32 s51, 0x20000
MA 184,v,168,v,132
s_add_u32 s60, s40, 33554432
s_addc_u32 s61, s41, 0
MA 188,v,172,v,132
s_add_u32 s21, s21, 524288
s_mov_b32 s62, 16777216
MA 152,v,168,v,128
s_mov_b32 s63, 0x20000
s_lshl_b32 s80, s69, 19
MA 156,v,172,v,128
s_add_u32 s52, s40, s80
s_addc_u32 s53, s41, 0
MA 120,v,168,v,124
s_lshl_b32 s54, s77, 14
s_mov_b32 s55, 0x20000
MA 124,v,172,v,124
s_and_b32 s21, s21, 4194303
s_add_u32 s80, s80, 16760832
MA 88,v,168,v,120
s_add_u32 s56, s40, s80
s_addc_u32 s57, s41, 0
MA 92,v,172,v,120
s_add_u32 s58, s54, 16384
MA 56,v,168,v,116
s_mov_b32 s59, 0x20000
MA 60,v,172,v,116
s_load_dwordx2 s[38:39], s[0:1], 112
MA 24,v,168,v,112
TR 168,202,0
TR 170,202,2048
MA 28,v,172,v,112
TR 172,203,0
TR 174,203,2048
s_waitcnt lgkmcnt(4)
MA 0,v,144,v,80
s_add_u32 m0, s22, 0
buffer_load_dwordx2 v[28:29], v254, s[84:87], 0 offen
MA 4,v,148,v,80
ds_read_b128 v[112:115], v193 offset:32768
MA 32,v,144,v,84
MA 36,v,148,v,84
MA 64,v,144,v,88
buffer_load_dwordx2 v[44:45], v254, s[88:91], 0 offen
MA 68,v,148,v,88
buffer_load_dwordx4 v176, s[8:11], s20 offen offset:0 lds
MA 96,v,144,v,92
MA 100,v,148,v,92
ds_read_b128 v[116:119], v193 offset:34816
MA 128,v,144,v,96
v_add_u32 v255, 14336, v229
MA 132,v,148,v,96
MA 160,v,144,v,100
buffer_load_dwordx4 v177, s[8:11], s20 offen offset:1024 lds
MA 164,v,148,v,100
MA 192,v,144,v,104
MA 196,v,148,v,104
ds_read_b128 v[120:123], v193 offset:36864
buffer_load_dwordx2 v[30:31], v255, s[84:87], 0 offen
MA 224,v,144,v,108
TR 144,196,16384
TR 146,196,18432
MA 228,v,148,v,108
TR 148,197,16384
TR 150,197,18432
MA 232,v,152,v,108
buffer_load_dwordx4 v178, s[8:11], s20 offen offset:2048 lds
MA 236,v,156,v,108
buffer_load_dwordx2 v[46:47], v255, s[88:91], 0 offen
MA 200,v,152,v,104
MA 204,v,156,v,104
MA 168,v,152,v,100
ds_read_b128 v[124:127], v193 offset:38912
buffer_load_dwordx4 v179, s[8:11], s20 offen offset:3072 lds
MA 172,v,156,v,100
MA 136,v,152,v,96
v_add_u32 v252, 16384, v229
MA 140,v,156,v,96
MA 104,v,152,v,92
MA 108,v,156,v,92
s_add_u32 m0, s22, 4096
MA 72,v,152,v,88
ds_read_b128 v[128:131], v193 offset:40960
buffer_load_dwordx2 v[32:33], v252, s[84:87], 0 offen
MA 76,v,156,v,88
MA 40,v,152,v,84
MA 44,v,156,v,84
MA 8,v,152,v,80
TR 152,198,16384
TR 154,198,18432
MA 12,v,156,v,80
TR 156,199,16384
TR 158,199,18432
MA 16,v,160,v,80
ds_read_b128 v[132:135], v193 offset:43008
buffer_load_dwordx4 v180, s[8:11], s20 offen offset:0 lds
MA 20,v,164,v,80
buffer_load_dwordx2 v[48:49], v252, s[88:91], 0 offen
MA 48,v,160,v,84
MA 52,v,164,v,84
v_add_u32 v253, 18432, v229
MA 80,v,160,v,88
buffer_load_dwordx4 v181, s[8:11], s20 offen offset:1024 lds
MA 84,v,164,v,88
MA 112,v,160,v,92
MA 116,v,164,v,92
ds_read_b128 v[136:139], v193 offset:45056
buffer_load_dwordx2 v[34:35], v253, s[84:87], 0 offen
MA 144,v,160,v,96
MA 148,v,164,v,96
buffer_load_dwordx4 v182, s[8:11], s20 offen offset:2048 lds
MA 176,v,160,v,100
MA 180,v,164,v,100
MA 208,v,160,v,104
buffer_load_dwordx2 v[50:51], v253, s[88:91], 0 offen
MA 212,v,164,v,104
ds_read_b128 v[140:143], v193 offset:47104
MA 240,v,160,v,108
TR 160,200,16384
TR 162,200,18432
MA 244,v,164,v,108
TR 164,201,16384
TR 166,201,18432
s_waitcnt lgkmcnt(15)
MA 248,v,168,v,108
buffer_load_dwordx4 v183, s[8:11], s20 offen offset:3072 lds
v_add_u32 v254, 20480, v229
MA 252,v,172,v,108
MA 216,v,168,v,104
MA 220,v,172,v,104
s_add_u32 s20, s20, 128
MA 184,v,168,v,100
MA 188,v,172,v,100
buffer_load_dwordx2 v[36:37], v254, s[84:87], 0 offen
MA 152,v,168,v,96
MA 156,v,172,v,96
MA 120,v,168,v,92
s_and_b32 s20, s20, 1023
MA 124,v,172,v,92
buffer_load_dwordx2 v[52:53], v254, s[88:91], 0 offen
MA 88,v,168,v,88
MA 92,v,172,v,88
MA 56,v,168,v,84
MA 60,v,172,v,84
MA 24,v,168,v,80
TR 168,202,16384
TR 170,202,18432
MA 28,v,172,v,80
TR 172,203,16384
TR 174,203,18432
s_waitcnt lgkmcnt(4)
MA 0,v,144,v,112
MA 4,v,148,v,112
MA 32,v,144,v,116
MA 36,v,148,v,116
MA 64,v,144,v,120
MA 68,v,148,v,120
MA 96,v,144,v,124
MA 100,v,148,v,124
MA 128,v,144,v,128
MA 132,v,148,v,128
s_waitcnt vmcnt(18) lgkmcnt(0)
s_barrier
MA 160,v,144,v,132
s_add_u32 m0, s23, 0
s_and_b32 s37, s3, 3
MA 164,v,148,v,132
ds_read_b128 v[80:83], v194 offset:0
MA 192,v,144,v,136
s_cmp_eq_u32 s37, 0
s_cselect_b32 s37, 0, 0x40000000
MA 196,v,148,v,136
MA 224,v,144,v,140
TR 144,196,32768
TR 146,196,34816
MA 228,v,148,v,140
TR 148,197,32768
TR 150,197,34816
MA 232,v,152,v,140
ds_read_b128 v[84:87], v194 offset:2048
buffer_load_dwordx4 v184, s[12:15], s21 offen offset:0 lds
MA 236,v,156,v,140
v_add_u32 v229, s37, v78
MA 200,v,152,v,136
buffer_load_dwordx4 v185, s[12:15], s21 offen offset:1024 lds
MA 204,v,156,v,136
buffer_load_dword v79, v229, s[4:7], 0 offen
MA 168,v,152,v,132
MA 172,v,156,v,132
ds_read_b128 v[88:91], v194 offset:4096
s_getpc_b64 s[82:83]
L_ct_fK:
MA 136,v,152,v,128
MA 140,v,156,v,128
buffer_load_dwordx4 v186, s[12:15], s21 offen offset:2048 lds
MA 104,v,152,v,124
s_add_u32 s82, s82, L_p2 - L_ct_fK
s_addc_u32 s83, s83, 0
MA 108,v,156,v,124
MA 72,v,152,v,120
ds_read_b128 v[92:95], v194 offset:6144
MA 76,v,156,v,120
buffer_load_dwordx4 v187, s[12:15], s21 offen offset:3072 lds
MA 40,v,152,v,116
v_mov_b32 v67, s83
MA 44,v,156,v,116
MA 8,v,152,v,112
TR 152,198,32768
TR 154,198,34816
MA 12,v,156,v,112
TR 156,199,32768
TR 158,199,34816
MA 16,v,160,v,112
ds_read_b128 v[96:99], v194 offset:8192
s_add_u32 m0, s23, 4096
MA 20,v,164,v,112
v_mov_b32 v66, s82
s_lshr_b32 s82, s2, 3
MA 48,v,160,v,116
s_lshl_b32 s82, s82, 2
MA 52,v,164,v,116
MA 80,v,160,v,120
ds_read_b128 v[100:103], v194 offset:10240
buffer_load_dwordx4 v188, s[12:15], s21 offen offset:0 lds
MA 84,v,164,v,120
s_add_u32 s82, s82, s3
MA 112,v,160,v,124
MA 116,v,164,v,124
s_lshl_b32 s82, s82, 7
MA 144,v,160,v,128
buffer_load_dwordx4 v189, s[12:15], s21 offen offset:1024 lds
MA 148,v,164,v,128
ds_read_b128 v[104:107], v194 offset:12288
v_and_b32 v68, 3, v1
MA 176,v,160,v,132
MA 180,v,164,v,132
v_lshlrev_b32 v68, 14, v68
MA 208,v,160,v,136
buffer_load_dwordx4 v190, s[12:15], s21 offen offset:2048 lds
MA 212,v,164,v,136
MA 240,v,160,v,140
TR 160,200,32768
TR 162,200,34816
MA 244,v,164,v,140
TR 164,201,32768
TR 166,201,34816
MA 248,v,168,v,140
ds_read_b128 v[108:111], v194 offset:14336
v_add_u32 v68, s82, v68
MA 252,v,172,v,140
buffer_load_dwordx4 v191, s[12:15], s21 offen offset:3072 lds
v_min_u32 v68, L_p3_begin - L_p2 - 4, v68
MA 216,v,168,v,136
v_add_co_u32 v66, vcc, v66, v68
s_nop 1
v_addc_co_u32 v67, vcc, 0, v67, vcc
MA 220,v,172,v,136
MA 184,v,168,v,132
MA 188,v,172,v,132
s_add_u32 s21, s21, 524288
MA 152,v,168,v,128
MA 156,v,172,v,128
MA 120,v,168,v,124
MA 124,v,172,v,124
s_and_b32 s21, s21, 4194303
MA 88,v,168,v,120
MA 92,v,172,v,120
global_load_dword v68, v[66:67], off
MA 56,v,168,v,116
MA 60,v,172,v,116
MA 24,v,168,v,112
TR 168,202,32768
TR 170,202,34816
MA 28,v,172,v,112
TR 172,203,32768
TR 174,203,34816
s_waitcnt lgkmcnt(4)
MA 0,v,144,v,80
s_add_u32 m0, s22, 32768
s_and_b32 s37, s3, 3
MA 4,v,148,v,80
ds_read_b128 v[112:115], v195 offset:0
MA 32,v,144,v,84
MA 36,v,148,v,84
MA 64,v,144,v,88
MA 68,v,148,v,88
buffer_load_dwordx4 v176, s[8:11], s20 offen offset:0 lds
MA 96,v,144,v,92
MA 100,v,148,v,92
ds_read_b128 v[116:119], v195 offset:2048
MA 128,v,144,v,96
MA 132,v,148,v,96
MA 160,v,144,v,100
buffer_load_dwordx4 v177, s[8:11], s20 offen offset:1024 lds
MA 164,v,148,v,100
MA 192,v,144,v,104
s_cmp_eq_u32 s37, 1
s_cselect_b32 s37, 0, 0x40000000
MA 196,v,148,v,104
ds_read_b128 v[120:123], v195 offset:4096
MA 224,v,144,v,108
TR 144,196,49152
TR 146,196,51200
MA 228,v,148,v,108
TR 148,197,49152
TR 150,197,51200
MA 232,v,152,v,108
buffer_load_dwordx4 v178, s[8:11], s20 offen offset:2048 lds
MA 236,v,156,v,108
MA 200,v,152,v,104
MA 204,v,156,v,104
MA 168,v,152,v,100
ds_read_b128 v[124:127], v195 offset:6144
buffer_load_dwordx4 v179, s[8:11], s20 offen offset:3072 lds
MA 172,v,156,v,100
MA 136,v,152,v,96
MA 140,v,156,v,96
MA 104,v,152,v,92
MA 108,v,156,v,92
s_add_u32 m0, s22, 36864
MA 72,v,152,v,88
ds_read_b128 v[128:131], v195 offset:8192
MA 76,v,156,v,88
MA 40,v,152,v,84
MA 44,v,156,v,84
MA 8,v,152,v,80
TR 152,198,49152
TR 154,198,51200
MA 12,v,156,v,80
TR 156,199,49152
TR 158,199,51200
MA 16,v,160,v,80
ds_read_b128 v[132:135], v195 offset:10240
buffer_load_dwordx4 v180, s[8:11], s20 offen offset:0 lds
MA 20,v,164,v,80
MA 48,v,160,v,84
MA 52,v,164,v,84
MA 80,v,160,v,88
buffer_load_dwordx4 v181, s[8:11], s20 offen offset:1024 lds
MA 84,v,164,v,88
v_add_u32 v229, s37, v78
MA 112,v,160,v,92
MA 116,v,164,v,92
ds_read_b128 v[136:139], v195 offset:12288
MA 144,v,160,v,96
MA 148,v,164,v,96
buffer_load_dwordx4 v182, s[8:11], s20 offen offset:2048 lds
MA 176,v,160,v,100
MA 180,v,164,v,100
MA 208,v,160,v,104
MA 212,v,164,v,104
ds_read_b128 v[140:143], v195 offset:14336
MA 240,v,160,v,108
TR 160,200,49152
TR 162,200,51200
MA 244,v,164,v,108
TR 164,201,49152
TR 166,201,51200
s_waitcnt lgkmcnt(15)
MA 248,v,168,v,108
buffer_load_dwordx4 v183, s[8:11], s20 offen offset:3072 lds
MA 252,v,172,v,108
buffer_load_dword v79, v229, s[4:7], 0 offen
MA 216,v,168,v,104
MA 220,v,172,v,104
s_add_u32 s20, s20, 128
MA 184,v,168,v,100
MA 188,v,172,v,100
MA 152,v,168,v,96
MA 156,v,172,v,96
MA 120,v,168,v,92
s_and_b32 s20, s20, 1023
MA 124,v,172,v,92
MA 88,v,168,v,88
MA 92,v,172,v,88
MA 56,v,168,v,84
MA 60,v,172,v,84
MA 24,v,168,v,80
TR 168,202,49152
TR 170,202,51200
MA 28,v,172,v,80
TR 172,203,49152
TR 174,203,51200
s_waitcnt lgkmcnt(4)
MA 0,v,144,v,112
MA 4,v,148,v,112
MA 32,v,144,v,116
MA 36,v,148,v,116
MA 64,v,144,v,120
MA 68,v,148,v,120
MA 96,v,144,v,124
MA 100,v,148,v,124
MA 128,v,144,v,128
MA 132,v,148,v,128
s_waitcnt vmcnt(10) lgkmcnt(0)
s_barrier
MA 160,v,144,v,132
s_add_u32 m0, s23, 32768
s_and_b32 s37, s3, 3
MA 164,v,148,v,132
ds_read_b128 v[80:83], v192 offset:0
MA 192,v,144,v,136
s_cmp_eq_u32 s37, 2
s_cselect_b32 s37, 0, 0x40000000
MA 196,v,148,v,136
v_add_u32 v229, s37, v78
buffer_load_dword v79, v229, s[4:7], 0 offen
MA 224,v,144,v,140
TR 144,196,0
TR 146,196,2048
MA 228,v,148,v,140
TR 148,197,0
TR 150,197,2048
MA 232,v,152,v,140
ds_read_b128 v[84:87], v192 offset:2048
buffer_load_dwordx4 v184, s[12:15], s21 offen offset:0 lds
MA 236,v,156,v,140
s_add_u32 s84, s40, 50331648
s_addc_u32 s85, s41, 0
MA 200,v,152,v,136
buffer_load_dwordx4 v185, s[12:15], s21 offen offset:1024 lds
s_mov_b32 s86, 4194304
MA 204,v,156,v,136
s_mov_b32 s87, 0x20000
MA 168,v,152,v,132
s_add_u32 s88, s40, 58720256
s_addc_u32 s89, s41, 0
MA 172,v,156,v,132
ds_read_b128 v[88:91], v192 offset:4096
s_mov_b32 s90, 8192
MA 136,v,152,v,128
s_mov_b32 s91, 0x20000
v_mov_b32 v252, 0
MA 140,v,156,v,128
buffer_load_dwordx4 v186, s[12:15], s21 offen offset:2048 lds
v_mov_b32 v253, 0
MA 104,v,152,v,124
v_dot2_f32_bf16 v252, v230, v2, v252
v_dot2_f32_bf16 v253, v231, v3, v253
v_dot2_f32_bf16 v252, v232, v4, v252
v_dot2_f32_bf16 v253, v233, v5, v253
v_dot2_f32_bf16 v252, v234, v6, v252
v_dot2_f32_bf16 v253, v235, v7, v253
v_dot2_f32_bf16 v252, v236, v8, v252
v_dot2_f32_bf16 v253, v237, v9, v253
v_dot2_f32_bf16 v252, v238, v12, v252
v_dot2_f32_bf16 v253, v239, v13, v253
v_dot2_f32_bf16 v252, v240, v14, v252
v_dot2_f32_bf16 v253, v241, v15, v253
v_dot2_f32_bf16 v252, v242, v246, v252
v_dot2_f32_bf16 v253, v243, v247, v253
v_dot2_f32_bf16 v252, v244, v248, v252
v_dot2_f32_bf16 v253, v245, v249, v253
MA 108,v,156,v,124
s_nop 2
v_add_f32 v252, v252, v253
MA 72,v,152,v,120
ds_read_b128 v[92:95], v192 offset:6144
MA 76,v,156,v,120
buffer_load_dwordx4 v187, s[12:15], s21 offen offset:3072 lds
v_add_f32_dpp v252, v252, v252 row_ror:8 row_mask:0xf bank_mask:0xf
MA 40,v,152,v,116
s_nop 0
v_add_f32_dpp v252, v252, v252 row_ror:4 row_mask:0xf bank_mask:0xf
s_nop 1
v_add_f32_dpp v252, v252, v252 row_ror:2 row_mask:0xf bank_mask:0xf
MA 44,v,156,v,116
s_nop 0
v_add_f32_dpp v252, v252, v252 row_ror:1 row_mask:0xf bank_mask:0xf
v_mov_b32 v253, v252
MA 8,v,152,v,112
TR 152,198,0
TR 154,198,2048
MA 12,v,156,v,112
TR 156,199,0
TR 158,199,2048
MA 16,v,160,v,112
ds_read_b128 v[96:99], v192 offset:8192
s_add_u32 m0, s23, 36864
MA 20,v,164,v,112
v_permlane16_swap_b32 v252, v253
v_add_f32 v252, v252, v253
MA 48,v,160,v,116
v_mul_f32 v252, 0xbfb8aa3b, v252
MA 52,v,164,v,116
v_exp_f32 v252, v252
MA 80,v,160,v,120
ds_read_b128 v[100:103], v192 offset:10240
buffer_load_dwordx4 v188, s[12:15], s21 offen offset:0 lds
MA 84,v,164,v,120
v_add_f32 v252, 1.0, v252
MA 112,v,160,v,124
v_rcp_f32 v252, v252
MA 116,v,164,v,124
s_nop 0
buffer_store_dword v252, v11, s[88:91], 0 offen sc1
MA 144,v,160,v,128
buffer_load_dwordx4 v189, s[12:15], s21 offen offset:1024 lds
v_lshlrev_b32 v2, 16, v54
MA 148,v,164,v,128
ds_read_b128 v[104:107], v192 offset:12288
v_and_b32 v3, 0xffff0000, v54
MA 176,v,160,v,132
v_lshlrev_b32 v4, 16, v55
v_and_b32 v5, 0xffff0000, v55
MA 180,v,164,v,132
v_lshlrev_b32 v6, 16, v56
v_and_b32 v7, 0xffff0000, v56
MA 208,v,160,v,136
buffer_load_dwordx4 v190, s[12:15], s21 offen offset:2048 lds
v_lshlrev_b32 v8, 16, v57
MA 212,v,164,v,136
v_and_b32 v9, 0xffff0000, v57
v_lshlrev_b32 v230, 16, v16
MA 240,v,160,v,140
TR 160,200,0
TR 162,200,2048
MA 244,v,164,v,140
TR 164,201,0
TR 166,201,2048
MA 248,v,168,v,140
ds_read_b128 v[108:111], v192 offset:14336
v_and_b32 v231, 0xffff0000, v16
MA 252,v,172,v,140
buffer_load_dwordx4 v191, s[12:15], s21 offen offset:3072 lds
v_lshlrev_b32 v232, 16, v18
MA 216,v,168,v,136
v_and_b32 v233, 0xffff0000, v18
v_lshlrev_b32 v234, 16, v20
MA 220,v,172,v,136
v_and_b32 v235, 0xffff0000, v20
v_lshlrev_b32 v236, 16, v22
MA 184,v,168,v,132
v_and_b32 v237, 0xffff0000, v22
v_lshlrev_b32 v238, 16, v24
MA 188,v,172,v,132
s_add_u32 s21, s21, 524288
v_and_b32 v239, 0xffff0000, v24
MA 152,v,168,v,128
v_lshlrev_b32 v240, 16, v26
v_and_b32 v241, 0xffff0000, v26
MA 156,v,172,v,128
v_lshlrev_b32 v242, 16, v28
v_and_b32 v243, 0xffff0000, v28
MA 120,v,168,v,124
v_lshlrev_b32 v244, 16, v30
v_and_b32 v245, 0xffff0000, v30
MA 124,v,172,v,124
s_and_b32 s21, s21, 4194303
v_lshlrev_b32 v246, 16, v32
MA 88,v,168,v,120
v_and_b32 v247, 0xffff0000, v32
v_lshlrev_b32 v248, 16, v34
MA 92,v,172,v,120
v_and_b32 v249, 0xffff0000, v34
v_lshlrev_b32 v250, 16, v36
MA 56,v,168,v,116
v_and_b32 v251, 0xffff0000, v36
v_lshlrev_b32 v254, 16, v38
MA 60,v,172,v,116
v_and_b32 v255, 0xffff0000, v38
v_mul_f32 v62, v236, v2
MA 24,v,168,v,112
TR 168,202,0
TR 170,202,2048
MA 28,v,172,v,112
TR 172,203,0
TR 174,203,2048
v_mul_f32 v70, v237, v6
v_fmac_f32 v62, v234, v3
v_fmac_f32 v70, v235, v7
v_fmac_f32 v62, v232, v4
v_fmac_f32 v70, v233, v8
v_fmac_f32 v62, v230, v5
v_fmac_f32 v70, v231, v9
v_mul_f32 v62, v62, v254
v_mul_f32 v70, v70, v255
v_lshlrev_b32 v254, 16, v40
v_and_b32 v255, 0xffff0000, v40
v_mul_f32 v63, v238, v2
v_mul_f32 v71, v239, v6
v_fmac_f32 v63, v236, v3
v_fmac_f32 v71, v237, v7
v_fmac_f32 v63, v234, v4
v_fmac_f32 v71, v235, v8
v_fmac_f32 v63, v232, v5
v_fmac_f32 v71, v233, v9
s_waitcnt lgkmcnt(4)
MA 0,v,144,v,80
s_add_u32 s75, s64, s74
s_and_b32 s37, s3, 3
MA 4,v,148,v,80
ds_read_b128 v[112:115], v193 offset:0
MA 32,v,144,v,84
s_cmp_eq_u32 s37, 3
s_cselect_b32 s37, 0, 0x40000000
MA 36,v,148,v,84
v_add_u32 v229, s37, v78
buffer_load_dword v79, v229, s[4:7], 0 offen
MA 64,v,144,v,88
s_add_u32 m0, s67, 65536
v_mul_f32 v63, v63, v254
MA 68,v,148,v,88
v_mul_f32 v71, v71, v255
v_lshlrev_b32 v254, 16, v42
MA 96,v,144,v,92
v_and_b32 v255, 0xffff0000, v42
v_mul_f32 v64, v240, v2
MA 100,v,148,v,92
ds_read_b128 v[116:119], v193 offset:2048
v_mul_f32 v72, v241, v6
MA 128,v,144,v,96
buffer_load_dwordx4 v208, s[44:47], s75 offen offset:0 lds
v_fmac_f32 v64, v238, v3
MA 132,v,148,v,96
v_fmac_f32 v72, v239, v7
MA 160,v,144,v,100
v_fmac_f32 v64, v236, v4
v_fmac_f32 v72, v237, v8
MA 164,v,148,v,100
v_fmac_f32 v64, v234, v5
MA 192,v,144,v,104
v_fmac_f32 v72, v235, v9
MA 196,v,148,v,104
ds_read_b128 v[120:123], v193 offset:4096
buffer_load_dwordx4 v209, s[44:47], s75 offen offset:1024 lds
MA 224,v,144,v,108
TR 144,196,16384
TR 146,196,18432
MA 228,v,148,v,108
TR 148,197,16384
TR 150,197,18432
MA 232,v,152,v,108
v_mul_f32 v64, v64, v254
v_mul_f32 v72, v72, v255
MA 236,v,156,v,108
buffer_load_dwordx4 v210, s[44:47], s75 offen offset:2048 lds
v_lshlrev_b32 v254, 16, v44
MA 200,v,152,v,104
v_and_b32 v255, 0xffff0000, v44
v_mul_f32 v65, v242, v2
MA 204,v,156,v,104
v_mul_f32 v73, v243, v6
v_fmac_f32 v65, v240, v3
MA 168,v,152,v,100
ds_read_b128 v[124:127], v193 offset:6144
v_fmac_f32 v73, v241, v7
MA 172,v,156,v,100
v_fmac_f32 v65, v238, v4
v_fmac_f32 v73, v239, v8
MA 136,v,152,v,96
buffer_load_dwordx4 v211, s[44:47], s75 offen offset:3072 lds
v_fmac_f32 v65, v236, v5
MA 140,v,156,v,96
v_fmac_f32 v73, v237, v9
v_mul_f32 v65, v65, v254
MA 104,v,152,v,92
v_mul_f32 v73, v73, v255
v_lshlrev_b32 v254, 16, v46
MA 108,v,156,v,92
v_and_b32 v255, 0xffff0000, v46
v_mul_f32 v66, v244, v2
MA 72,v,152,v,88
ds_read_b128 v[128:131], v193 offset:8192
s_add_u32 s75, s65, s74
MA 76,v,156,v,88
v_mul_f32 v74, v245, v6
v_fmac_f32 v66, v242, v3
MA 40,v,152,v,84
v_fmac_f32 v74, v243, v7
v_fmac_f32 v66, v240, v4
MA 44,v,156,v,84
v_fmac_f32 v74, v241, v8
MA 8,v,152,v,80
TR 152,198,16384
TR 154,198,18432
MA 12,v,156,v,80
TR 156,199,16384
TR 158,199,18432
MA 16,v,160,v,80
ds_read_b128 v[132:135], v193 offset:10240
s_add_u32 m0, s67, 69632
MA 20,v,164,v,80
v_fmac_f32 v66, v238, v5
v_fmac_f32 v74, v239, v9
MA 48,v,160,v,84
v_mul_f32 v66, v66, v254
v_mul_f32 v74, v74, v255
MA 52,v,164,v,84
buffer_load_dwordx4 v208, s[44:47], s75 offen offset:0 lds
v_lshlrev_b32 v254, 16, v48
MA 80,v,160,v,88
v_and_b32 v255, 0xffff0000, v48
v_mul_f32 v67, v246, v2
MA 84,v,164,v,88
v_mul_f32 v75, v247, v6
v_fmac_f32 v67, v244, v3
MA 112,v,160,v,92
v_fmac_f32 v75, v245, v7
v_fmac_f32 v67, v242, v4
MA 116,v,164,v,92
ds_read_b128 v[136:139], v193 offset:12288
buffer_load_dwordx4 v209, s[44:47], s75 offen offset:1024 lds
MA 144,v,160,v,96
v_fmac_f32 v75, v243, v8
v_fmac_f32 v67, v240, v5
MA 148,v,164,v,96
v_fmac_f32 v75, v241, v9
v_mul_f32 v67, v67, v254
MA 176,v,160,v,100
v_mul_f32 v75, v75, v255
v_lshlrev_b32 v254, 16, v50
MA 180,v,164,v,100
v_and_b32 v255, 0xffff0000, v50
MA 208,v,160,v,104
buffer_load_dwordx4 v210, s[44:47], s75 offen offset:2048 lds
s_waitcnt vmcnt(27)
v_mul_f32 v68, v248, v2
MA 212,v,164,v,104
ds_read_b128 v[140:143], v193 offset:14336
v_mul_f32 v76, v249, v6
MA 240,v,160,v,108
TR 160,200,16384
TR 162,200,18432
MA 244,v,164,v,108
TR 164,201,16384
TR 166,201,18432
s_waitcnt lgkmcnt(15)
MA 248,v,168,v,108
buffer_load_dwordx4 v211, s[44:47], s75 offen offset:3072 lds
v_fmac_f32 v68, v246, v3
MA 252,v,172,v,108
v_fmac_f32 v76, v247, v7
v_fmac_f32 v68, v244, v4
MA 216,v,168,v,104
v_fmac_f32 v76, v245, v8
v_fmac_f32 v68, v242, v5
MA 220,v,172,v,104
v_fmac_f32 v76, v243, v9
v_mul_f32 v68, v68, v254
MA 184,v,168,v,100
v_mul_f32 v76, v76, v255
v_lshlrev_b32 v254, 16, v52
MA 188,v,172,v,100
s_add_u32 s74, s74, 128
v_and_b32 v255, 0xffff0000, v52
MA 152,v,168,v,96
v_mul_f32 v69, v250, v2
v_mul_f32 v77, v251, v6
MA 156,v,172,v,96
v_fmac_f32 v69, v248, v3
v_fmac_f32 v77, v249, v7
MA 120,v,168,v,92
v_fmac_f32 v69, v246, v4
MA 124,v,172,v,92
s_and_b32 s74, s74, 2047
v_fmac_f32 v77, v247, v8
MA 88,v,168,v,88
v_fmac_f32 v69, v244, v5
v_fmac_f32 v77, v245, v9
MA 92,v,172,v,88
v_mul_f32 v69, v69, v254
MA 56,v,168,v,84
v_mul_f32 v77, v77, v255
MA 60,v,172,v,84
v_cvt_pk_bf16_f32 v12, v69, v68
MA 24,v,168,v,80
TR 168,202,16384
TR 170,202,18432
MA 28,v,172,v,80
TR 172,203,16384
TR 174,203,18432
s_waitcnt lgkmcnt(4)
MA 0,v,144,v,112
MA 4,v,148,v,112
MA 32,v,144,v,116
MA 36,v,148,v,116
MA 64,v,144,v,120
MA 68,v,148,v,120
MA 96,v,144,v,124
MA 100,v,148,v,124
MA 128,v,144,v,128
MA 132,v,148,v,128
s_waitcnt vmcnt(9) lgkmcnt(0)
s_barrier
MA 160,v,144,v,132
s_add_u32 m0, s68, 98304
v_cvt_pk_bf16_f32 v13, v67, v66
MA 164,v,148,v,132
ds_read_b128 v[80:83], v192 offset:32768
v_cvt_pk_bf16_f32 v14, v65, v64
MA 192,v,144,v,136
v_cvt_pk_bf16_f32 v15, v63, v62
s_mov_b32 s36, 0
MA 196,v,148,v,136
buffer_load_dwordx4 v212, s[48:51], s66 offen offset:0 lds
buffer_store_dwordx4 v[12:15], v10, s[84:87], s36 offen sc1
MA 224,v,144,v,140
TR 144,196,32768
TR 146,196,34816
MA 228,v,148,v,140
TR 148,197,32768
TR 150,197,34816
MA 232,v,152,v,140
ds_read_b128 v[84:87], v192 offset:34816
v_cvt_pk_bf16_f32 v54, v77, v76
MA 236,v,156,v,140
buffer_load_dwordx4 v213, s[48:51], s66 offen offset:1024 lds
v_cvt_pk_bf16_f32 v55, v75, v74
MA 200,v,152,v,136
v_cvt_pk_bf16_f32 v56, v73, v72
v_cvt_pk_bf16_f32 v57, v71, v70
MA 204,v,156,v,136
s_mov_b32 s36, 4096
buffer_store_dwordx4 v[54:57], v10, s[84:87], s36 offen sc1
MA 168,v,152,v,132
v_lshlrev_b32 v2, 16, v58
v_and_b32 v3, 0xffff0000, v58
MA 172,v,156,v,132
ds_read_b128 v[88:91], v192 offset:36864
buffer_load_dwordx4 v214, s[48:51], s66 offen offset:2048 lds
MA 136,v,152,v,128
v_lshlrev_b32 v4, 16, v59
v_and_b32 v5, 0xffff0000, v59
MA 140,v,156,v,128
v_lshlrev_b32 v6, 16, v60
v_and_b32 v7, 0xffff0000, v60
MA 104,v,152,v,124
buffer_load_dwordx4 v215, s[48:51], s66 offen offset:3072 lds
v_lshlrev_b32 v8, 16, v61
MA 108,v,156,v,124
v_and_b32 v9, 0xffff0000, v61
v_lshlrev_b32 v230, 16, v17
MA 72,v,152,v,120
ds_read_b128 v[92:95], v192 offset:38912
v_and_b32 v231, 0xffff0000, v17
MA 76,v,156,v,120
v_lshlrev_b32 v232, 16, v19
v_and_b32 v233, 0xffff0000, v19
MA 40,v,152,v,116
s_add_u32 s66, s66, 524288
v_lshlrev_b32 v234, 16, v21
MA 44,v,156,v,116
v_and_b32 v235, 0xffff0000, v21
v_lshlrev_b32 v236, 16, v23
MA 8,v,152,v,112
TR 152,198,32768
TR 154,198,34816
MA 12,v,156,v,112
TR 156,199,32768
TR 158,199,34816
MA 16,v,160,v,112
ds_read_b128 v[96:99], v192 offset:40960
s_and_b32 s66, s66, 8388607
MA 20,v,164,v,112
v_and_b32 v237, 0xffff0000, v23
v_lshlrev_b32 v238, 16, v25
MA 48,v,160,v,116
v_and_b32 v239, 0xffff0000, v25
v_lshlrev_b32 v240, 16, v27
MA 52,v,164,v,116
v_and_b32 v241, 0xffff0000, v27
v_lshlrev_b32 v242, 16, v29
MA 80,v,160,v,120
ds_read_b128 v[100:103], v192 offset:43008
s_add_u32 m0, s68, 114688
MA 84,v,164,v,120
v_and_b32 v243, 0xffff0000, v29
v_lshlrev_b32 v244, 16, v31
MA 112,v,160,v,124
v_and_b32 v245, 0xffff0000, v31
v_lshlrev_b32 v246, 16, v33
MA 116,v,164,v,124
buffer_load_dwordx4 v212, s[48:51], s66 offen offset:0 lds
v_and_b32 v247, 0xffff0000, v33
MA 144,v,160,v,128
v_lshlrev_b32 v248, 16, v35
v_and_b32 v249, 0xffff0000, v35
MA 148,v,164,v,128
ds_read_b128 v[104:107], v192 offset:45056
v_lshlrev_b32 v250, 16, v37
MA 176,v,160,v,132
v_and_b32 v251, 0xffff0000, v37
v_lshlrev_b32 v254, 16, v39
MA 180,v,164,v,132
buffer_load_dwordx4 v213, s[48:51], s66 offen offset:1024 lds
v_and_b32 v255, 0xffff0000, v39
MA 208,v,160,v,136
v_mul_f32 v62, v236, v2
v_mul_f32 v70, v237, v6
MA 212,v,164,v,136
v_fmac_f32 v62, v234, v3
v_fmac_f32 v70, v235, v7
MA 240,v,160,v,140
TR 160,200,32768
TR 162,200,34816
MA 244,v,164,v,140
TR 164,201,32768
TR 166,201,34816
MA 248,v,168,v,140
ds_read_b128 v[108:111], v192 offset:47104
buffer_load_dwordx4 v214, s[48:51], s66 offen offset:2048 lds
MA 252,v,172,v,140
v_fmac_f32 v62, v232, v4
v_fmac_f32 v70, v233, v8
MA 216,v,168,v,136
buffer_load_dwordx4 v215, s[48:51], s66 offen offset:3072 lds
v_fmac_f32 v62, v230, v5
MA 220,v,172,v,136
v_fmac_f32 v70, v231, v9
v_mul_f32 v62, v62, v254
MA 184,v,168,v,132
v_mul_f32 v70, v70, v255
v_lshlrev_b32 v254, 16, v41
MA 188,v,172,v,132
v_and_b32 v255, 0xffff0000, v41
v_mul_f32 v63, v238, v2
MA 152,v,168,v,128
s_add_u32 s66, s66, 524288
v_mul_f32 v71, v239, v6
MA 156,v,172,v,128
v_fmac_f32 v63, v236, v3
v_fmac_f32 v71, v237, v7
MA 120,v,168,v,124
v_fmac_f32 v63, v234, v4
v_fmac_f32 v71, v235, v8
MA 124,v,172,v,124
v_fmac_f32 v63, v232, v5
v_fmac_f32 v71, v233, v9
MA 88,v,168,v,120
s_and_b32 s66, s66, 8388607
v_mul_f32 v63, v63, v254
MA 92,v,172,v,120
v_mul_f32 v71, v71, v255
v_lshlrev_b32 v254, 16, v43
MA 56,v,168,v,116
v_and_b32 v255, 0xffff0000, v43
v_mul_f32 v64, v240, v2
MA 60,v,172,v,116
v_mul_f32 v72, v241, v6
v_fmac_f32 v64, v238, v3
MA 24,v,168,v,112
TR 168,202,32768
TR 170,202,34816
MA 28,v,172,v,112
TR 172,203,32768
TR 174,203,34816
v_fmac_f32 v72, v239, v7
v_fmac_f32 v64, v236, v4
v_fmac_f32 v72, v237, v8
v_fmac_f32 v64, v234, v5
s_waitcnt lgkmcnt(4)
MA 0,v,144,v,80
s_add_u32 s75, s64, s74
v_fmac_f32 v72, v235, v9
MA 4,v,148,v,80
ds_read_b128 v[112:115], v193 offset:32768
v_mul_f32 v64, v64, v254
MA 32,v,144,v,84
v_mul_f32 v72, v72, v255
v_lshlrev_b32 v254, 16, v45
MA 36,v,148,v,84
v_and_b32 v255, 0xffff0000, v45
MA 64,v,144,v,88
s_add_u32 m0, s67, 0
v_mul_f32 v65, v242, v2
MA 68,v,148,v,88
v_mul_f32 v73, v243, v6
v_fmac_f32 v65, v240, v3
MA 96,v,144,v,92
v_fmac_f32 v73, v241, v7
MA 100,v,148,v,92
ds_read_b128 v[116:119], v193 offset:34816
v_fmac_f32 v65, v238, v4
MA 128,v,144,v,96
buffer_load_dwordx4 v208, s[44:47], s75 offen offset:0 lds
v_fmac_f32 v73, v239, v8
MA 132,v,148,v,96
v_fmac_f32 v65, v236, v5
v_fmac_f32 v73, v237, v9
MA 160,v,144,v,100
v_mul_f32 v65, v65, v254
MA 164,v,148,v,100
v_mul_f32 v73, v73, v255
MA 192,v,144,v,104
v_lshlrev_b32 v254, 16, v47
MA 196,v,148,v,104
ds_read_b128 v[120:123], v193 offset:36864
buffer_load_dwordx4 v209, s[44:47], s75 offen offset:1024 lds
MA 224,v,144,v,108
TR 144,196,49152
TR 146,196,51200
MA 228,v,148,v,108
TR 148,197,49152
TR 150,197,51200
MA 232,v,152,v,108
v_and_b32 v255, 0xffff0000, v47
v_mul_f32 v66, v244, v2
MA 236,v,156,v,108
buffer_load_dwordx4 v210, s[44:47], s75 offen offset:2048 lds
v_mul_f32 v74, v245, v6
MA 200,v,152,v,104
v_fmac_f32 v66, v242, v3
v_fmac_f32 v74, v243, v7
MA 204,v,156,v,104
v_fmac_f32 v66, v240, v4
v_fmac_f32 v74, v241, v8
MA 168,v,152,v,100
ds_read_b128 v[124:127], v193 offset:38912
v_fmac_f32 v66, v238, v5
MA 172,v,156,v,100
v_fmac_f32 v74, v239, v9
v_mul_f32 v66, v66, v254
MA 136,v,152,v,96
buffer_load_dwordx4 v211, s[44:47], s75 offen offset:3072 lds
v_mul_f32 v74, v74, v255
MA 140,v,156,v,96
v_lshlrev_b32 v254, 16, v49
v_and_b32 v255, 0xffff0000, v49
MA 104,v,152,v,92
v_mul_f32 v67, v246, v2
v_mul_f32 v75, v247, v6
MA 108,v,156,v,92
v_fmac_f32 v67, v244, v3
MA 72,v,152,v,88
ds_read_b128 v[128:131], v193 offset:40960
s_add_u32 s75, s65, s74
MA 76,v,156,v,88
v_fmac_f32 v75, v245, v7
v_fmac_f32 v67, v242, v4
MA 40,v,152,v,84
v_fmac_f32 v75, v243, v8
v_fmac_f32 v67, v240, v5
MA 44,v,156,v,84
v_fmac_f32 v75, v241, v9
MA 8,v,152,v,80
TR 152,198,49152
TR 154,198,51200
MA 12,v,156,v,80
TR 156,199,49152
TR 158,199,51200
MA 16,v,160,v,80
ds_read_b128 v[132:135], v193 offset:43008
s_add_u32 m0, s67, 4096
MA 20,v,164,v,80
v_mul_f32 v67, v67, v254
v_mul_f32 v75, v75, v255
MA 48,v,160,v,84
v_lshlrev_b32 v254, 16, v51
v_and_b32 v255, 0xffff0000, v51
MA 52,v,164,v,84
buffer_load_dwordx4 v208, s[44:47], s75 offen offset:0 lds
v_mul_f32 v68, v248, v2
MA 80,v,160,v,88
v_mul_f32 v76, v249, v6
v_fmac_f32 v68, v246, v3
MA 84,v,164,v,88
v_fmac_f32 v76, v247, v7
v_fmac_f32 v68, v244, v4
MA 112,v,160,v,92
v_fmac_f32 v76, v245, v8
v_fmac_f32 v68, v242, v5
MA 116,v,164,v,92
ds_read_b128 v[136:139], v193 offset:45056
buffer_load_dwordx4 v209, s[44:47], s75 offen offset:1024 lds
MA 144,v,160,v,96
v_fmac_f32 v76, v243, v9
v_mul_f32 v68, v68, v254
MA 148,v,164,v,96
v_mul_f32 v76, v76, v255
v_lshlrev_b32 v254, 16, v53
MA 176,v,160,v,100
v_and_b32 v255, 0xffff0000, v53
MA 180,v,164,v,100
v_mul_f32 v69, v250, v2
MA 208,v,160,v,104
buffer_load_dwordx4 v210, s[44:47], s75 offen offset:2048 lds
v_mul_f32 v77, v251, v6
MA 212,v,164,v,104
ds_read_b128 v[140:143], v193 offset:47104
v_fmac_f32 v69, v248, v3
MA 240,v,160,v,108
TR 160,200,49152
TR 162,200,51200
MA 244,v,164,v,108
TR 164,201,49152
TR 166,201,51200
s_waitcnt lgkmcnt(15)
MA 248,v,168,v,108
buffer_load_dwordx4 v211, s[44:47], s75 offen offset:3072 lds
v_fmac_f32 v77, v249, v7
MA 252,v,172,v,108
v_fmac_f32 v69, v246, v4
v_fmac_f32 v77, v247, v8
MA 216,v,168,v,104
v_fmac_f32 v69, v244, v5
v_fmac_f32 v77, v245, v9
MA 220,v,172,v,104
v_mul_f32 v69, v69, v254
v_mul_f32 v77, v77, v255
MA 184,v,168,v,100
v_cvt_pk_bf16_f32 v230, v69, v68
v_cvt_pk_bf16_f32 v231, v67, v66
MA 188,v,172,v,100
s_add_u32 s74, s74, 128
v_cvt_pk_bf16_f32 v232, v65, v64
MA 152,v,168,v,96
v_cvt_pk_bf16_f32 v233, v63, v62
s_mov_b32 s36, 8192
MA 156,v,172,v,96
buffer_store_dwordx4 v[230:233], v10, s[84:87], s36 offen sc1
MA 120,v,168,v,92
v_cvt_pk_bf16_f32 v234, v77, v76
MA 124,v,172,v,92
s_and_b32 s74, s74, 2047
v_cvt_pk_bf16_f32 v235, v75, v74
MA 88,v,168,v,88
v_cvt_pk_bf16_f32 v236, v73, v72
v_cvt_pk_bf16_f32 v237, v71, v70
MA 92,v,172,v,88
s_mov_b32 s36, 12288
MA 56,v,168,v,84
buffer_store_dwordx4 v[234:237], v10, s[84:87], s36 offen sc1
MA 60,v,172,v,84
v_lshlrev_b32 v228, 4, v1
MA 24,v,168,v,80
TR 168,202,49152
TR 170,202,51200
MA 28,v,172,v,80
TR 172,203,49152
TR 174,203,51200
s_waitcnt lgkmcnt(4)
MA 0,v,144,v,112
MA 4,v,148,v,112
MA 32,v,144,v,116
MA 36,v,148,v,116
MA 64,v,144,v,120
MA 68,v,148,v,120
MA 96,v,144,v,124
MA 100,v,148,v,124
MA 128,v,144,v,128
MA 132,v,148,v,128
s_waitcnt vmcnt(14) lgkmcnt(0)
s_barrier
MA 160,v,144,v,132
ds_read_b128 v[48:51], v226 offset:0
s_add_u32 m0, s68, 131072
MA 164,v,148,v,132
MA 192,v,144,v,136
ds_read_b128 v[52:55], v226 offset:2048
buffer_load_dwordx4 v212, s[48:51], s66 offen offset:0 lds
MA 196,v,148,v,136
MA 224,v,144,v,140
ds_read_b128 v[56:59], v226 offset:4096
buffer_load_dwordx4 v213, s[48:51], s66 offen offset:1024 lds
MA 228,v,148,v,140
MA 232,v,152,v,140
ds_read_b128 v[60:63], v226 offset:6144
MA 236,v,156,v,140
buffer_load_dwordx4 v214, s[48:51], s66 offen offset:2048 lds
MA 200,v,152,v,136
TR 16,216,0
MA 204,v,156,v,136
buffer_load_dwordx4 v215, s[48:51], s66 offen offset:3072 lds
MA 168,v,152,v,132
TR 18,216,1024
MA 172,v,156,v,132
MA 136,v,152,v,128
TR 20,217,0
s_add_u32 s66, s66, 524288
MA 140,v,156,v,128
MA 104,v,152,v,124
TR 22,217,1024
s_and_b32 s66, s66, 8388607
MA 108,v,156,v,124
MA 72,v,152,v,120
TR 24,218,0
MA 76,v,156,v,120
s_add_u32 s75, s64, s74
MA 40,v,152,v,116
TR 26,218,1024
MA 44,v,156,v,116
s_add_u32 m0, s67, 32768
MA 8,v,152,v,112
TR 28,219,0
MA 12,v,156,v,112
MA 16,v,160,v,112
TR 30,219,1024
buffer_load_dwordx4 v208, s[44:47], s75 offen offset:0 lds
MA 20,v,164,v,112
MA 48,v,160,v,116
TR 32,220,0
buffer_load_dwordx4 v209, s[44:47], s75 offen offset:1024 lds
MA 52,v,164,v,116
MA 80,v,160,v,120
TR 34,220,1024
MA 84,v,164,v,120
buffer_load_dwordx4 v210, s[44:47], s75 offen offset:2048 lds
MA 112,v,160,v,124
TR 36,221,0
MA 116,v,164,v,124
buffer_load_dwordx4 v211, s[44:47], s75 offen offset:3072 lds
MA 144,v,160,v,128
TR 38,221,1024
MA 148,v,164,v,128
MA 176,v,160,v,132
TR 40,222,0
s_add_u32 s75, s65, s74
MA 180,v,164,v,132
MA 208,v,160,v,136
TR 42,222,1024
s_add_u32 m0, s67, 36864
MA 212,v,164,v,136
MA 240,v,160,v,140
TR 44,223,0
MA 244,v,164,v,140
buffer_load_dwordx4 v208, s[44:47], s75 offen offset:0 lds
MA 248,v,168,v,140
TR 46,223,1024
MA 252,v,172,v,140
buffer_load_dwordx4 v209, s[44:47], s75 offen offset:1024 lds
MA 216,v,168,v,136
MA 220,v,172,v,136
MA 184,v,168,v,132
buffer_load_dwordx4 v210, s[44:47], s75 offen offset:2048 lds
MA 188,v,172,v,132
MA 152,v,168,v,128
buffer_load_dwordx4 v211, s[44:47], s75 offen offset:3072 lds
MA 156,v,172,v,128
MA 120,v,168,v,124
MA 124,v,172,v,124
s_add_u32 s74, s74, 128
MA 88,v,168,v,120
MA 92,v,172,v,120
s_and_b32 s74, s74, 2047
MA 56,v,168,v,116
MA 60,v,172,v,116
MA 24,v,168,v,112
MA 28,v,172,v,112
s_branch L_p2
L_p1_V:
s_waitcnt lgkmcnt(14)
v_mfma_f32_16x16x32_bf16 a[0:3], v[80:83], v[144:147], 0
s_add_u32 m0, s23, 32768
s_waitcnt lgkmcnt(12)
v_mfma_f32_16x16x32_bf16 a[8:11], v[80:83], v[148:151], 0
ds_read_b128 v[112:115], v193 offset:0
v_mfma_f32_16x16x32_bf16 a[4:7], v[84:87], v[144:147], 0
buffer_load_dwordx4 v184, s[12:15], s21 offen offset:0 lds
v_mfma_f32_16x16x32_bf16 a[12:15], v[84:87], v[148:151], 0
v_mfma_f32_16x16x32_bf16 a[64:67], v[88:91], v[144:147], 0
v_mfma_f32_16x16x32_bf16 a[72:75], v[88:91], v[148:151], 0
buffer_load_dwordx4 v185, s[12:15], s21 offen offset:1024 lds
v_mfma_f32_16x16x32_bf16 a[68:71], v[92:95], v[144:147], 0
v_mfma_f32_16x16x32_bf16 a[76:79], v[92:95], v[148:151], 0
ds_read_b128 v[116:119], v193 offset:2048
buffer_load_dwordx4 v186, s[12:15], s21 offen offset:2048 lds
v_mfma_f32_16x16x32_bf16 a[128:131], v[96:99], v[144:147], 0
v_mfma_f32_16x16x32_bf16 a[136:139], v[96:99], v[148:151], 0
v_mfma_f32_16x16x32_bf16 a[132:135], v[100:103], v[144:147], 0
buffer_load_dwordx4 v187, s[12:15], s21 offen offset:3072 lds
v_mfma_f32_16x16x32_bf16 a[140:143], v[100:103], v[148:151], 0
v_mfma_f32_16x16x32_bf16 a[192:195], v[104:107], v[144:147], 0
s_add_u32 m0, s23, 36864
v_mfma_f32_16x16x32_bf16 a[200:203], v[104:107], v[148:151], 0
ds_read_b128 v[120:123], v193 offset:4096
v_mfma_f32_16x16x32_bf16 a[196:199], v[108:111], v[144:147], 0
TR 144,196,16384
TR 146,196,18432
v_mfma_f32_16x16x32_bf16 a[204:207], v[108:111], v[148:151], 0
TR 148,197,16384
TR 150,197,18432
s_waitcnt lgkmcnt(15)
v_mfma_f32_16x16x32_bf16 a[212:215], v[108:111], v[152:155], 0
buffer_load_dwordx4 v188, s[12:15], s21 offen offset:0 lds
v_mfma_f32_16x16x32_bf16 a[220:223], v[108:111], v[156:159], 0
v_mfma_f32_16x16x32_bf16 a[208:211], v[104:107], v[152:155], 0
buffer_load_dwordx4 v189, s[12:15], s21 offen offset:1024 lds
v_mfma_f32_16x16x32_bf16 a[216:219], v[104:107], v[156:159], 0
v_mfma_f32_16x16x32_bf16 a[148:151], v[100:103], v[152:155], 0
ds_read_b128 v[124:127], v193 offset:6144
buffer_load_dwordx4 v190, s[12:15], s21 offen offset:2048 lds
v_mfma_f32_16x16x32_bf16 a[156:159], v[100:103], v[156:159], 0
v_mfma_f32_16x16x32_bf16 a[144:147], v[96:99], v[152:155], 0
v_mfma_f32_16x16x32_bf16 a[152:155], v[96:99], v[156:159], 0
buffer_load_dwordx4 v191, s[12:15], s21 offen offset:3072 lds
v_mfma_f32_16x16x32_bf16 a[84:87], v[92:95], v[152:155], 0
v_mfma_f32_16x16x32_bf16 a[92:95], v[92:95], v[156:159], 0
s_add_u32 s21, s21, 524288
v_mfma_f32_16x16x32_bf16 a[80:83], v[88:91], v[152:155], 0
ds_read_b128 v[128:131], v193 offset:8192
v_mfma_f32_16x16x32_bf16 a[88:91], v[88:91], v[156:159], 0
v_mfma_f32_16x16x32_bf16 a[20:23], v[84:87], v[152:155], 0
s_and_b32 s21, s21, 4194303
v_mfma_f32_16x16x32_bf16 a[28:31], v[84:87], v[156:159], 0
v_mfma_f32_16x16x32_bf16 a[16:19], v[80:83], v[152:155], 0
TR 152,198,16384
TR 154,198,18432
v_mfma_f32_16x16x32_bf16 a[24:27], v[80:83], v[156:159], 0
TR 156,199,16384
TR 158,199,18432
s_waitcnt lgkmcnt(15)
v_mfma_f32_16x16x32_bf16 a[32:35], v[80:83], v[160:163], 0
ds_read_b128 v[132:135], v193 offset:10240
s_add_u32 m0, s22, 32768
v_mfma_f32_16x16x32_bf16 a[40:43], v[80:83], v[164:167], 0
buffer_load_dwordx4 v176, s[8:11], s20 offen offset:0 lds
v_mfma_f32_16x16x32_bf16 a[36:39], v[84:87], v[160:163], 0
v_mfma_f32_16x16x32_bf16 a[44:47], v[84:87], v[164:167], 0
v_mfma_f32_16x16x32_bf16 a[96:99], v[88:91], v[160:163], 0
buffer_load_dwordx4 v177, s[8:11], s20 offen offset:1024 lds
v_mfma_f32_16x16x32_bf16 a[104:107], v[88:91], v[164:167], 0
v_mfma_f32_16x16x32_bf16 a[100:103], v[92:95], v[160:163], 0
buffer_load_dwordx4 v178, s[8:11], s20 offen offset:2048 lds
v_mfma_f32_16x16x32_bf16 a[108:111], v[92:95], v[164:167], 0
ds_read_b128 v[136:139], v193 offset:12288
v_mfma_f32_16x16x32_bf16 a[160:163], v[96:99], v[160:163], 0
v_mfma_f32_16x16x32_bf16 a[168:171], v[96:99], v[164:167], 0
buffer_load_dwordx4 v179, s[8:11], s20 offen offset:3072 lds
v_mfma_f32_16x16x32_bf16 a[164:167], v[100:103], v[160:163], 0
v_mfma_f32_16x16x32_bf16 a[172:175], v[100:103], v[164:167], 0
s_add_u32 m0, s22, 36864
v_mfma_f32_16x16x32_bf16 a[224:227], v[104:107], v[160:163], 0
v_mfma_f32_16x16x32_bf16 a[232:235], v[104:107], v[164:167], 0
ds_read_b128 v[140:143], v193 offset:14336
v_mfma_f32_16x16x32_bf16 a[228:231], v[108:111], v[160:163], 0
TR 160,200,16384
TR 162,200,18432
v_mfma_f32_16x16x32_bf16 a[236:239], v[108:111], v[164:167], 0
TR 164,201,16384
TR 166,201,18432
v_mfma_f32_16x16x32_bf16 a[244:247], v[108:111], v[168:171], 0
buffer_load_dwordx4 v180, s[8:11], s20 offen offset:0 lds
s_waitcnt lgkmcnt(15)
v_mfma_f32_16x16x32_bf16 a[252:255], v[108:111], v[172:175], 0
buffer_load_dwordx4 v181, s[8:11], s20 offen offset:1024 lds
v_mfma_f32_16x16x32_bf16 a[240:243], v[104:107], v[168:171], 0
v_mfma_f32_16x16x32_bf16 a[248:251], v[104:107], v[172:175], 0
buffer_load_dwordx4 v182, s[8:11], s20 offen offset:2048 lds
v_mfma_f32_16x16x32_bf16 a[180:183], v[100:103], v[168:171], 0
v_mfma_f32_16x16x32_bf16 a[188:191], v[100:103], v[172:175], 0
v_mfma_f32_16x16x32_bf16 a[176:179], v[96:99], v[168:171], 0
buffer_load_dwordx4 v183, s[8:11], s20 offen offset:3072 lds
v_mfma_f32_16x16x32_bf16 a[184:187], v[96:99], v[172:175], 0
v_mfma_f32_16x16x32_bf16 a[116:119], v[92:95], v[168:171], 0
s_add_u32 s20, s20, 128
v_mfma_f32_16x16x32_bf16 a[124:127], v[92:95], v[172:175], 0
v_mfma_f32_16x16x32_bf16 a[112:115], v[88:91], v[168:171], 0
v_mfma_f32_16x16x32_bf16 a[120:123], v[88:91], v[172:175], 0
s_and_b32 s20, s20, 1023
v_mfma_f32_16x16x32_bf16 a[52:55], v[84:87], v[168:171], 0
v_mfma_f32_16x16x32_bf16 a[60:63], v[84:87], v[172:175], 0
v_mfma_f32_16x16x32_bf16 a[48:51], v[80:83], v[168:171], 0
TR 168,202,16384
TR 170,202,18432
v_mfma_f32_16x16x32_bf16 a[56:59], v[80:83], v[172:175], 0
TR 172,203,16384
TR 174,203,18432
s_waitcnt lgkmcnt(4)
MA 0,v,112,v,144
s_add_u32 m0, s22, 65536
MA 8,v,112,v,148
MA 4,v,116,v,144
MA 12,v,116,v,148
buffer_load_dwordx4 v176, s[8:11], s20 offen offset:0 lds
MA 64,v,120,v,144
MA 72,v,120,v,148
MA 68,v,124,v,144
MA 76,v,124,v,148
buffer_load_dwordx4 v177, s[8:11], s20 offen offset:1024 lds
MA 128,v,128,v,144
MA 136,v,128,v,148
MA 132,v,132,v,144
buffer_load_dwordx4 v178, s[8:11], s20 offen offset:2048 lds
MA 140,v,132,v,148
MA 192,v,136,v,144
MA 200,v,136,v,148
MA 196,v,140,v,144
buffer_load_dwordx4 v179, s[8:11], s20 offen offset:3072 lds
MA 204,v,140,v,148
MA 212,v,140,v,152
MA 220,v,140,v,156
s_add_u32 m0, s22, 69632
MA 208,v,136,v,152
MA 216,v,136,v,156
MA 148,v,132,v,152
MA 156,v,132,v,156
buffer_load_dwordx4 v180, s[8:11], s20 offen offset:0 lds
MA 144,v,128,v,152
MA 152,v,128,v,156
MA 84,v,124,v,152
MA 92,v,124,v,156
buffer_load_dwordx4 v181, s[8:11], s20 offen offset:1024 lds
MA 80,v,120,v,152
MA 88,v,120,v,156
MA 20,v,116,v,152
buffer_load_dwordx4 v182, s[8:11], s20 offen offset:2048 lds
MA 28,v,116,v,156
MA 16,v,112,v,152
MA 24,v,112,v,156
MA 32,v,112,v,160
buffer_load_dwordx4 v183, s[8:11], s20 offen offset:3072 lds
MA 40,v,112,v,164
MA 36,v,116,v,160
MA 44,v,116,v,164
s_add_u32 s20, s20, 128
MA 96,v,120,v,160
MA 104,v,120,v,164
MA 100,v,124,v,160
MA 108,v,124,v,164
s_and_b32 s20, s20, 1023
MA 160,v,128,v,160
MA 168,v,128,v,164
MA 164,v,132,v,160
MA 172,v,132,v,164
MA 224,v,136,v,160
s_waitcnt vmcnt(8) lgkmcnt(0)
s_barrier
MA 232,v,136,v,164
TR 144,196,32768
TR 146,196,34816
MA 228,v,140,v,160
ds_read_b128 v[80:83], v192 offset:32768
s_add_u32 m0, s23, 0
MA 236,v,140,v,164
TR 148,197,32768
TR 150,197,34816
MA 244,v,140,v,168
ds_read_b128 v[84:87], v192 offset:34816
ds_read_b128 v[88:91], v192 offset:36864
MA 252,v,140,v,172
TR 152,198,32768
TR 154,198,34816
MA 240,v,136,v,168
ds_read_b128 v[92:95], v192 offset:38912
ds_read_b128 v[96:99], v192 offset:40960
MA 248,v,136,v,172
TR 156,199,32768
TR 158,199,34816
MA 180,v,132,v,168
ds_read_b128 v[100:103], v192 offset:43008
ds_read_b128 v[104:107], v192 offset:45056
MA 188,v,132,v,172
TR 160,200,32768
TR 162,200,34816
MA 176,v,128,v,168
ds_read_b128 v[108:111], v192 offset:47104
buffer_load_dwordx4 v184, s[12:15], s21 offen offset:0 lds
MA 184,v,128,v,172
TR 164,201,32768
TR 166,201,34816
MA 116,v,124,v,168
buffer_load_dwordx4 v185, s[12:15], s21 offen offset:1024 lds
buffer_load_dwordx4 v186, s[12:15], s21 offen offset:2048 lds
MA 124,v,124,v,172
buffer_load_dwordx4 v187, s[12:15], s21 offen offset:3072 lds
s_add_u32 m0, s23, 4096
MA 112,v,120,v,168
buffer_load_dwordx4 v188, s[12:15], s21 offen offset:0 lds
buffer_load_dwordx4 v189, s[12:15], s21 offen offset:1024 lds
MA 120,v,120,v,172
buffer_load_dwordx4 v190, s[12:15], s21 offen offset:2048 lds
buffer_load_dwordx4 v191, s[12:15], s21 offen offset:3072 lds
MA 52,v,116,v,168
s_add_u32 s21, s21, 524288
s_and_b32 s21, s21, 4194303
MA 60,v,116,v,172
s_load_dwordx2 s[84:85], s[0:1], 8
s_load_dwordx2 s[88:89], s[0:1], 16
MA 48,v,112,v,168
TR 168,202,32768
TR 170,202,34816
MA 56,v,112,v,172
TR 172,203,32768
TR 174,203,34816
s_load_dwordx2 s[92:93], s[0:1], 0
s_load_dwordx2 s[96:97], s[0:1], 24
s_load_dwordx2 s[76:77], s[0:1], 96
s_waitcnt lgkmcnt(4)
MA 0,v,80,v,144
s_add_u32 m0, s22, 0
MA 8,v,80,v,148
ds_read_b128 v[112:115], v193 offset:32768
MA 4,v,84,v,144
s_mov_b32 s4, s34
s_mov_b32 s5, s35
MA 12,v,84,v,148
MA 64,v,88,v,144
MA 72,v,88,v,148
buffer_load_dwordx4 v176, s[8:11], s20 offen offset:0 lds
MA 68,v,92,v,144
MA 76,v,92,v,148
ds_read_b128 v[116:119], v193 offset:34816
MA 128,v,96,v,144
s_mov_b32 s6, 8388608
s_mov_b32 s7, 0x20000
MA 136,v,96,v,148
MA 132,v,100,v,144
buffer_load_dwordx4 v177, s[8:11], s20 offen offset:1024 lds
MA 140,v,100,v,148
MA 192,v,104,v,144
MA 200,v,104,v,148
ds_read_b128 v[120:123], v193 offset:36864
MA 196,v,108,v,144
TR 144,196,49152
TR 146,196,51200
MA 204,v,108,v,148
TR 148,197,49152
TR 150,197,51200
MA 212,v,108,v,152
buffer_load_dwordx4 v178, s[8:11], s20 offen offset:2048 lds
s_lshr_b32 s43, s2, 3
MA 220,v,108,v,156
MA 208,v,104,v,152
MA 216,v,104,v,156
s_lshl_b32 s43, s43, 2
MA 148,v,100,v,152
ds_read_b128 v[124:127], v193 offset:38912
buffer_load_dwordx4 v179, s[8:11], s20 offen offset:3072 lds
MA 156,v,100,v,156
MA 144,v,96,v,152
MA 152,v,96,v,156
s_add_u32 s43, s43, s3
MA 84,v,92,v,152
MA 92,v,92,v,156
s_add_u32 m0, s22, 4096
MA 80,v,88,v,152
ds_read_b128 v[128:131], v193 offset:40960
MA 88,v,88,v,156
s_lshl_b32 s43, s43, 16
MA 20,v,84,v,152
MA 28,v,84,v,156
MA 16,v,80,v,152
TR 152,198,49152
TR 154,198,51200
MA 24,v,80,v,156
TR 156,199,49152
TR 158,199,51200
MA 32,v,80,v,160
ds_read_b128 v[132:135], v193 offset:43008
buffer_load_dwordx4 v180, s[8:11], s20 offen offset:0 lds
MA 40,v,80,v,164
s_and_b32 s37, s2, 7
MA 36,v,84,v,160
s_lshl_b32 s37, s37, 10
MA 44,v,84,v,164
MA 96,v,88,v,160
buffer_load_dwordx4 v181, s[8:11], s20 offen offset:1024 lds
MA 104,v,88,v,164
MA 100,v,92,v,160
s_add_u32 s43, s43, s37
MA 108,v,92,v,164
ds_read_b128 v[136:139], v193 offset:45056
MA 160,v,96,v,160
MA 168,v,96,v,164
buffer_load_dwordx4 v182, s[8:11], s20 offen offset:2048 lds
MA 164,v,100,v,160
v_lshrrev_b32 v78, 3, v1
MA 172,v,100,v,164
MA 224,v,104,v,160
MA 232,v,104,v,164
ds_read_b128 v[140:143], v193 offset:47104
MA 228,v,108,v,160
TR 160,200,49152
TR 162,200,51200
MA 236,v,108,v,164
TR 164,201,49152
TR 166,201,51200
s_waitcnt lgkmcnt(15)
MA 244,v,108,v,168
buffer_load_dwordx4 v183, s[8:11], s20 offen offset:3072 lds
v_and_b32 v79, 7, v1
MA 252,v,108,v,172
MA 240,v,104,v,168
v_lshlrev_b32 v79, 7, v79
MA 248,v,104,v,172
s_add_u32 s20, s20, 128
MA 180,v,100,v,168
MA 188,v,100,v,172
MA 176,v,96,v,168
v_lshl_add_u32 v78, v78, 13, v79
MA 184,v,96,v,172
MA 116,v,92,v,168
s_and_b32 s20, s20, 1023
MA 124,v,92,v,172
MA 112,v,88,v,168
v_add_u32 v78, s43, v78
MA 120,v,88,v,172
MA 52,v,84,v,168
MA 60,v,84,v,172
MA 48,v,80,v,168
TR 168,202,49152
TR 170,202,51200
MA 56,v,80,v,172
TR 172,203,49152
TR 174,203,51200
s_waitcnt lgkmcnt(4)
MA 0,v,112,v,144
MA 8,v,112,v,148
MA 4,v,116,v,144
MA 12,v,116,v,148
MA 64,v,120,v,144
MA 72,v,120,v,148
MA 68,v,124,v,144
MA 76,v,124,v,148
MA 128,v,128,v,144
MA 136,v,128,v,148
s_waitcnt vmcnt(8) lgkmcnt(0)
s_barrier
MA 132,v,132,v,144
s_add_u32 m0, s23, 32768
s_mov_b32 s86, 4194304
MA 140,v,132,v,148
ds_read_b128 v[80:83], v194 offset:0
s_mov_b32 s87, 0x20000
MA 192,v,136,v,144
s_mov_b32 s90, 4194304
MA 200,v,136,v,148
s_mov_b32 s91, 0x20000
MA 196,v,140,v,144
TR 144,196,0
TR 146,196,2048
MA 204,v,140,v,148
TR 148,197,0
TR 150,197,2048
MA 212,v,140,v,152
ds_read_b128 v[84:87], v194 offset:2048
buffer_load_dwordx4 v184, s[12:15], s21 offen offset:0 lds
MA 220,v,140,v,156
s_mov_b32 s94, 4194304
s_mov_b32 s95, 0x20000
MA 208,v,136,v,152
buffer_load_dwordx4 v185, s[12:15], s21 offen offset:1024 lds
s_mov_b32 s98, 8192
MA 216,v,136,v,156
s_mov_b32 s99, 0x20000
MA 148,v,132,v,152
s_mov_b32 s78, 2048
MA 156,v,132,v,156
ds_read_b128 v[88:91], v194 offset:4096
s_mov_b32 s79, 0x20000
MA 144,v,128,v,152
s_and_b32 s36, s2, 15
MA 152,v,128,v,156
buffer_load_dwordx4 v186, s[12:15], s21 offen offset:2048 lds
s_lshl_b32 s36, s36, 1
MA 84,v,124,v,152
MA 92,v,124,v,156
s_lshr_b32 s37, s3, 1
MA 80,v,120,v,152
ds_read_b128 v[92:95], v194 offset:6144
s_add_u32 s36, s36, s37
MA 88,v,120,v,156
buffer_load_dwordx4 v187, s[12:15], s21 offen offset:3072 lds
s_lshl_b32 s36, s36, 3
MA 20,v,116,v,152
MA 28,v,116,v,156
v_and_b32 v252, 7, v1
MA 16,v,112,v,152
TR 152,198,0
TR 154,198,2048
MA 24,v,112,v,156
TR 156,199,0
TR 158,199,2048
MA 32,v,112,v,160
ds_read_b128 v[96:99], v194 offset:8192
s_add_u32 m0, s23, 36864
MA 40,v,112,v,164
v_add_u32 v252, s36, v252
s_lshr_b32 s36, s2, 4
MA 36,v,116,v,160
s_lshl_b32 s36, s36, 1
s_and_b32 s37, s3, 1
MA 44,v,116,v,164
s_add_u32 s36, s36, s37
MA 96,v,120,v,160
ds_read_b128 v[100:103], v194 offset:10240
buffer_load_dwordx4 v188, s[12:15], s21 offen offset:0 lds
MA 104,v,120,v,164
s_lshl_b32 s36, s36, 3
v_lshrrev_b32 v253, 3, v1
MA 100,v,124,v,160
MA 108,v,124,v,164
v_add_u32 v253, s36, v253
MA 160,v,128,v,160
buffer_load_dwordx4 v189, s[12:15], s21 offen offset:1024 lds
v_lshlrev_b32 v254, 14, v253
MA 168,v,128,v,164
ds_read_b128 v[104:107], v194 offset:12288
v_lshl_add_u32 v254, v252, 3, v254
MA 164,v,132,v,160
v_add_u32 v229, -6144, v254
MA 172,v,132,v,164
MA 224,v,136,v,160
buffer_load_dwordx4 v190, s[12:15], s21 offen offset:2048 lds
v_lshlrev_b32 v62, 5, v252
MA 232,v,136,v,164
v_lshlrev_b32 v254, 4, v253
MA 228,v,140,v,160
TR 160,200,0
TR 162,200,2048
MA 236,v,140,v,164
TR 164,201,0
TR 166,201,2048
MA 244,v,140,v,168
ds_read_b128 v[108:111], v194 offset:14336
v_sub_u32 v254, 4080, v254
MA 252,v,140,v,172
buffer_load_dwordx4 v191, s[12:15], s21 offen offset:3072 lds
v_lshl_add_u32 v10, v252, 14, v254
MA 240,v,136,v,168
v_and_b32 v252, 31, v1
v_lshlrev_b32 v64, 4, v252
MA 248,v,136,v,172
s_lshl_b32 s36, s2, 2
MA 180,v,132,v,168
MA 188,v,132,v,172
s_add_u32 s21, s21, 524288
s_add_u32 s36, s36, s3
MA 176,v,128,v,168
s_lshl_b32 s36, s36, 1
MA 184,v,128,v,172
v_lshrrev_b32 v253, 5, v1
MA 116,v,124,v,168
v_add_u32 v253, s36, v253
MA 124,v,124,v,172
s_and_b32 s21, s21, 4194303
MA 112,v,120,v,168
v_lshl_add_u32 v63, v253, 11, v64
MA 120,v,120,v,172
v_lshlrev_b32 v253, 2, v253
MA 52,v,116,v,168
v_lshl_add_u32 v11, v252, 20, v253
MA 60,v,116,v,172
MA 48,v,112,v,168
TR 168,202,0
TR 170,202,2048
MA 56,v,112,v,172
TR 172,203,0
TR 174,203,2048
s_waitcnt lgkmcnt(4)
MA 0,v,80,v,144
s_add_u32 m0, s22, 32768
buffer_load_dwordx4 v[230:233], v63, s[92:95], 0 offen offset:0
MA 8,v,80,v,148
ds_read_b128 v[112:115], v195 offset:0
MA 4,v,84,v,144
MA 12,v,84,v,148
MA 64,v,88,v,144
buffer_load_dwordx4 v[2:5], v64, s[76:79], 0 offen offset:0
MA 72,v,88,v,148
buffer_load_dwordx4 v176, s[8:11], s20 offen offset:0 lds
MA 68,v,92,v,144
MA 76,v,92,v,148
ds_read_b128 v[116:119], v195 offset:2048
MA 128,v,96,v,144
MA 136,v,96,v,148
buffer_load_dwordx4 v[234:237], v63, s[92:95], 0 offen offset:512
MA 132,v,100,v,144
buffer_load_dwordx4 v177, s[8:11], s20 offen offset:1024 lds
MA 140,v,100,v,148
MA 192,v,104,v,144
MA 200,v,104,v,148
ds_read_b128 v[120:123], v195 offset:4096
MA 196,v,108,v,144
TR 144,196,16384
TR 146,196,18432
MA 204,v,108,v,148
TR 148,197,16384
TR 150,197,18432
MA 212,v,108,v,152
buffer_load_dwordx4 v178, s[8:11], s20 offen offset:2048 lds
buffer_load_dwordx4 v[6:9], v64, s[76:79], 0 offen offset:512
MA 220,v,108,v,156
MA 208,v,104,v,152
MA 216,v,104,v,156
buffer_load_dwordx4 v[238:241], v63, s[92:95], 0 offen offset:1024
MA 148,v,100,v,152
ds_read_b128 v[124:127], v195 offset:6144
buffer_load_dwordx4 v179, s[8:11], s20 offen offset:3072 lds
MA 156,v,100,v,156
MA 144,v,96,v,152
MA 152,v,96,v,156
buffer_load_dwordx4 v[12:15], v64, s[76:79], 0 offen offset:1024
MA 84,v,92,v,152
MA 92,v,92,v,156
s_add_u32 m0, s22, 36864
MA 80,v,88,v,152
ds_read_b128 v[128:131], v195 offset:8192
MA 88,v,88,v,156
MA 20,v,84,v,152
buffer_load_dwordx4 v[242:245], v63, s[92:95], 0 offen offset:1536
MA 28,v,84,v,156
MA 16,v,80,v,152
TR 152,198,16384
TR 154,198,18432
MA 24,v,80,v,156
TR 156,199,16384
TR 158,199,18432
MA 32,v,80,v,160
ds_read_b128 v[132:135], v195 offset:10240
buffer_load_dwordx4 v180, s[8:11], s20 offen offset:0 lds
MA 40,v,80,v,164
buffer_load_dwordx4 v[246:249], v64, s[76:79], 0 offen offset:1536
MA 36,v,84,v,160
MA 44,v,84,v,164
MA 96,v,88,v,160
buffer_load_dwordx4 v181, s[8:11], s20 offen offset:1024 lds
MA 104,v,88,v,164
MA 100,v,92,v,160
buffer_load_dwordx4 v[54:57], v62, s[96:99], 0 offen offset:0
MA 108,v,92,v,164
ds_read_b128 v[136:139], v195 offset:12288
MA 160,v,96,v,160
MA 168,v,96,v,164
buffer_load_dwordx4 v182, s[8:11], s20 offen offset:2048 lds
MA 164,v,100,v,160
buffer_load_dwordx4 v[58:61], v62, s[96:99], 0 offen offset:16
MA 172,v,100,v,164
MA 224,v,104,v,160
MA 232,v,104,v,164
ds_read_b128 v[140:143], v195 offset:14336
MA 228,v,108,v,160
TR 160,200,16384
TR 162,200,18432
MA 236,v,108,v,164
TR 164,201,16384
TR 166,201,18432
s_waitcnt lgkmcnt(15)
MA 244,v,108,v,168
buffer_load_dwordx4 v183, s[8:11], s20 offen offset:3072 lds
v_add_u32 v252, 0, v229
MA 252,v,108,v,172
MA 240,v,104,v,168
MA 248,v,104,v,172
s_add_u32 s20, s20, 128
MA 180,v,100,v,168
buffer_load_dwordx2 v[16:17], v252, s[84:87], 0 offen
MA 188,v,100,v,172
MA 176,v,96,v,168
MA 184,v,96,v,172
MA 116,v,92,v,168
s_and_b32 s20, s20, 1023
MA 124,v,92,v,172
v_add_u32 v253, 2048, v229
MA 112,v,88,v,168
MA 120,v,88,v,172
MA 52,v,84,v,168
MA 60,v,84,v,172
MA 48,v,80,v,168
TR 168,202,16384
TR 170,202,18432
MA 56,v,80,v,172
TR 172,203,16384
TR 174,203,18432
s_waitcnt lgkmcnt(4)
MA 0,v,112,v,144
MA 8,v,112,v,148
MA 4,v,116,v,144
MA 12,v,116,v,148
MA 64,v,120,v,144
MA 72,v,120,v,148
MA 68,v,124,v,144
MA 76,v,124,v,148
MA 128,v,128,v,144
MA 136,v,128,v,148
s_waitcnt vmcnt(19) lgkmcnt(0)
s_barrier
MA 132,v,132,v,144
s_add_u32 m0, s23, 0
s_bfe_u32 s80, s2, 0x20001
MA 140,v,132,v,148
ds_read_b128 v[80:83], v192 offset:0
s_bfe_u32 s69, s2, 0x30003
MA 192,v,136,v,144
s_lshl_b32 s80, s80, 3
s_add_u32 s69, s69, s80
MA 200,v,136,v,148
s_lshr_b32 s80, s2, 6
MA 196,v,140,v,144
TR 144,196,32768
TR 146,196,34816
MA 204,v,140,v,148
TR 148,197,32768
TR 150,197,34816
MA 212,v,140,v,152
ds_read_b128 v[84:87], v192 offset:2048
buffer_load_dwordx4 v184, s[12:15], s21 offen offset:0 lds
MA 220,v,140,v,156
s_xor_b32 s81, s80, s2
s_and_b32 s81, s81, 1
MA 208,v,136,v,152
buffer_load_dwordx4 v185, s[12:15], s21 offen offset:1024 lds
s_lshl_b32 s70, s80, 1
MA 216,v,136,v,156
s_add_u32 s70, s70, s81
s_lshl_b32 s80, s3, 1
MA 148,v,132,v,152
s_sub_u32 s80, 7, s80
s_lshl_b32 s76, s80, 17
MA 156,v,132,v,156
ds_read_b128 v[88:91], v192 offset:4096
s_lshl_b32 s80, s3, 15
MA 144,v,128,v,152
s_lshl_b32 s65, s70, 18
s_sub_u32 s64, 3932160, s65
MA 152,v,128,v,156
buffer_load_dwordx4 v186, s[12:15], s21 offen offset:2048 lds
s_add_u32 s65, s65, s80
MA 84,v,124,v,152
s_add_u32 s64, s64, s80
MA 92,v,124,v,156
s_lshl_b32 s81, s69, 12
MA 80,v,120,v,152
ds_read_b128 v[92:95], v192 offset:6144
s_lshl_b32 s100, s64, 2
MA 88,v,120,v,156
buffer_load_dwordx4 v187, s[12:15], s21 offen offset:3072 lds
s_add_u32 s100, s100, s81
MA 20,v,116,v,152
s_lshl_b32 s101, s65, 2
MA 28,v,116,v,156
s_add_u32 s101, s101, s81
MA 16,v,112,v,152
TR 152,198,32768
TR 154,198,34816
MA 24,v,112,v,156
TR 156,199,32768
TR 158,199,34816
MA 32,v,112,v,160
ds_read_b128 v[96:99], v192 offset:8192
s_add_u32 m0, s23, 4096
MA 40,v,112,v,164
s_lshl_b32 s66, s3, 17
s_lshl_b32 s81, s69, 8
MA 36,v,116,v,160
s_add_u32 s66, s66, s81
s_and_b32 s74, s2, 7
MA 44,v,116,v,164
s_lshl_b32 s74, s74, 8
s_mov_b32 s82, s66
MA 96,v,120,v,160
ds_read_b128 v[100:103], v192 offset:10240
buffer_load_dwordx4 v188, s[12:15], s21 offen offset:0 lds
MA 104,v,120,v,164
s_lshl_b32 s66, s74, 12
s_lshl_b32 s67, s3, 13
MA 100,v,124,v,160
s_lshl_b32 s68, s3, 12
s_lshl_b32 s77, s70, 1
MA 108,v,124,v,164
s_sub_u32 s77, 32, s77
MA 160,v,128,v,160
buffer_load_dwordx4 v189, s[12:15], s21 offen offset:1024 lds
v_lshrrev_b32 v66, 3, v1
MA 168,v,128,v,164
ds_read_b128 v[104:107], v192 offset:12288
v_lshlrev_b32 v66, 11, v66
MA 164,v,132,v,160
v_lshrrev_b32 v67, 4, v1
v_and_b32 v68, 7, v1
MA 172,v,132,v,164
v_xor_b32 v68, v68, v67
MA 224,v,136,v,160
buffer_load_dwordx4 v190, s[12:15], s21 offen offset:2048 lds
v_lshl_add_u32 v66, v68, 4, v66
MA 232,v,136,v,164
v_xor_b32 v69, 64, v66
MA 228,v,140,v,160
TR 160,200,32768
TR 162,200,34816
MA 236,v,140,v,164
TR 164,201,32768
TR 166,201,34816
MA 244,v,140,v,168
ds_read_b128 v[108:111], v192 offset:14336
s_lshr_b32 s83, s76, 2
MA 252,v,140,v,172
buffer_load_dwordx4 v191, s[12:15], s21 offen offset:3072 lds
v_add_u32 v208, 0, v66
MA 240,v,136,v,168
v_add_u32 v209, 15360, v69
v_add_u32 v210, -2048, v66
MA 248,v,136,v,172
v_add_u32 v210, s83, v210
v_add_u32 v211, 13312, v69
MA 180,v,132,v,168
v_add_u32 v211, s83, v211
v_and_b32 v68, 15, v1
MA 188,v,132,v,172
s_add_u32 s21, s21, 524288
v_lshlrev_b32 v69, 1, v67
MA 176,v,128,v,168
v_xor_b32 v68, v68, v69
MA 184,v,128,v,172
v_lshlrev_b32 v66, 13, v67
MA 116,v,124,v,168
v_xor_b32 v69, 0, v68
MA 124,v,124,v,172
s_and_b32 s21, s21, 4194303
v_lshl_add_u32 v69, v69, 4, v66
MA 112,v,120,v,168
v_add_u32 v212, 0, v69
MA 120,v,120,v,172
v_xor_b32 v69, 0, v68
MA 52,v,116,v,168
v_lshl_add_u32 v69, v69, 4, v66
MA 60,v,116,v,172
v_add_u32 v213, 31744, v69
MA 48,v,112,v,168
TR 168,202,32768
TR 170,202,34816
MA 56,v,112,v,172
TR 172,203,32768
TR 174,203,34816
s_waitcnt lgkmcnt(4)
MA 0,v,80,v,144
s_add_u32 m0, s22, 65536
buffer_load_dwordx2 v[18:19], v253, s[84:87], 0 offen
MA 8,v,80,v,148
ds_read_b128 v[112:115], v193 offset:0
MA 4,v,84,v,144
MA 12,v,84,v,148
MA 64,v,88,v,144
v_add_u32 v254, 4096, v229
MA 72,v,88,v,148
buffer_load_dwordx4 v176, s[8:11], s20 offen offset:0 lds
MA 68,v,92,v,144
MA 76,v,92,v,148
ds_read_b128 v[116:119], v193 offset:2048
MA 128,v,96,v,144
MA 136,v,96,v,148
buffer_load_dwordx2 v[20:21], v254, s[84:87], 0 offen
MA 132,v,100,v,144
buffer_load_dwordx4 v177, s[8:11], s20 offen offset:1024 lds
MA 140,v,100,v,148
MA 192,v,104,v,144
MA 200,v,104,v,148
ds_read_b128 v[120:123], v193 offset:4096
MA 196,v,108,v,144
TR 144,196,49152
TR 146,196,51200
MA 204,v,108,v,148
TR 148,197,49152
TR 150,197,51200
MA 212,v,108,v,152
buffer_load_dwordx4 v178, s[8:11], s20 offen offset:2048 lds
v_add_u32 v255, 6144, v229
MA 220,v,108,v,156
MA 208,v,104,v,152
MA 216,v,104,v,156
buffer_load_dwordx2 v[22:23], v255, s[84:87], 0 offen
MA 148,v,100,v,152
ds_read_b128 v[124:127], v193 offset:6144
buffer_load_dwordx4 v179, s[8:11], s20 offen offset:3072 lds
MA 156,v,100,v,156
MA 144,v,96,v,152
MA 152,v,96,v,156
buffer_load_dwordx2 v[38:39], v255, s[88:91], 0 offen
MA 84,v,92,v,152
MA 92,v,92,v,156
s_add_u32 m0, s22, 69632
MA 80,v,88,v,152
ds_read_b128 v[128:131], v193 offset:8192
MA 88,v,88,v,156
MA 20,v,84,v,152
v_add_u32 v252, 8192, v229
MA 28,v,84,v,156
MA 16,v,80,v,152
TR 152,198,49152
TR 154,198,51200
MA 24,v,80,v,156
TR 156,199,49152
TR 158,199,51200
MA 32,v,80,v,160
ds_read_b128 v[132:135], v193 offset:10240
buffer_load_dwordx4 v180, s[8:11], s20 offen offset:0 lds
MA 40,v,80,v,164
buffer_load_dwordx2 v[24:25], v252, s[84:87], 0 offen
MA 36,v,84,v,160
MA 44,v,84,v,164
MA 96,v,88,v,160
buffer_load_dwordx4 v181, s[8:11], s20 offen offset:1024 lds
MA 104,v,88,v,164
MA 100,v,92,v,160
buffer_load_dwordx2 v[40:41], v252, s[88:91], 0 offen
MA 108,v,92,v,164
ds_read_b128 v[136:139], v193 offset:12288
MA 160,v,96,v,160
MA 168,v,96,v,164
buffer_load_dwordx4 v182, s[8:11], s20 offen offset:2048 lds
MA 164,v,100,v,160
v_add_u32 v253, 10240, v229
MA 172,v,100,v,164
MA 224,v,104,v,160
MA 232,v,104,v,164
ds_read_b128 v[140:143], v193 offset:14336
MA 228,v,108,v,160
TR 160,200,49152
TR 162,200,51200
MA 236,v,108,v,164
TR 164,201,49152
TR 166,201,51200
s_waitcnt lgkmcnt(15)
MA 244,v,108,v,168
buffer_load_dwordx4 v183, s[8:11], s20 offen offset:3072 lds
buffer_load_dwordx2 v[26:27], v253, s[84:87], 0 offen
MA 252,v,108,v,172
MA 240,v,104,v,168
MA 248,v,104,v,172
s_add_u32 s20, s20, 128
MA 180,v,100,v,168
buffer_load_dwordx2 v[42:43], v253, s[88:91], 0 offen
MA 188,v,100,v,172
MA 176,v,96,v,168
MA 184,v,96,v,172
MA 116,v,92,v,168
s_and_b32 s20, s20, 1023
MA 124,v,92,v,172
v_add_u32 v254, 12288, v229
MA 112,v,88,v,168
MA 120,v,88,v,172
MA 52,v,84,v,168
MA 60,v,84,v,172
MA 48,v,80,v,168
TR 168,202,49152
TR 170,202,51200
MA 56,v,80,v,172
TR 172,203,49152
TR 174,203,51200
s_waitcnt lgkmcnt(4)
MA 0,v,112,v,144
MA 8,v,112,v,148
MA 4,v,116,v,144
MA 12,v,116,v,148
MA 64,v,120,v,144
MA 72,v,120,v,148
MA 68,v,124,v,144
MA 76,v,124,v,148
MA 128,v,128,v,144
MA 136,v,128,v,148
s_waitcnt vmcnt(16) lgkmcnt(0)
s_barrier
MA 132,v,132,v,144
s_add_u32 m0, s23, 32768
v_xor_b32 v69, 8, v68
MA 140,v,132,v,148
ds_read_b128 v[80:83], v192 offset:32768
v_lshl_add_u32 v69, v69, 4, v66
MA 192,v,136,v,144
v_add_u32 v214, 63488, v69
v_xor_b32 v69, 8, v68
MA 200,v,136,v,148
v_lshl_add_u32 v69, v69, 4, v66
MA 196,v,140,v,144
TR 144,196,0
TR 146,196,2048
MA 204,v,140,v,148
TR 148,197,0
TR 150,197,2048
MA 212,v,140,v,152
ds_read_b128 v[84:87], v192 offset:34816
buffer_load_dwordx4 v184, s[12:15], s21 offen offset:0 lds
MA 220,v,140,v,156
v_add_u32 v215, 95232, v69
v_and_b32 v66, 15, v1
MA 208,v,136,v,152
buffer_load_dwordx4 v185, s[12:15], s21 offen offset:1024 lds
v_lshrrev_b32 v68, 1, v66
MA 216,v,136,v,156
v_xor_b32 v68, v68, v67
v_lshlrev_b32 v68, 4, v68
MA 148,v,132,v,152
v_lshl_add_u32 v68, v66, 7, v68
v_add_u32 v224, s67, v68
MA 156,v,132,v,156
ds_read_b128 v[88:91], v192 offset:36864
v_xor_b32 v225, 64, v224
MA 144,v,128,v,152
v_add_u32 v226, 0x10000, v224
v_add_u32 v227, 0x10000, v225
MA 152,v,128,v,156
buffer_load_dwordx4 v186, s[12:15], s21 offen offset:2048 lds
v_bfe_u32 v66, v1, 2, 2
MA 84,v,124,v,152
v_and_b32 v68, 1, v67
v_lshl_or_b32 v68, v68, 2, v66
MA 92,v,124,v,156
v_lshl_add_u32 v66, v67, 3, v66
v_lshlrev_b32 v66, 8, v66
MA 80,v,120,v,152
ds_read_b128 v[92:95], v192 offset:38912
v_and_b32 v69, 3, v1
MA 88,v,120,v,156
buffer_load_dwordx4 v187, s[12:15], s21 offen offset:3072 lds
v_lshl_add_u32 v66, v69, 3, v66
MA 20,v,116,v,152
v_add_u32 v66, 98304, v66
MA 28,v,116,v,156
v_xor_b32 v69, 0, v68
MA 16,v,112,v,152
TR 152,198,0
TR 154,198,2048
MA 24,v,112,v,156
TR 156,199,0
TR 158,199,2048
MA 32,v,112,v,160
ds_read_b128 v[96:99], v192 offset:40960
s_add_u32 m0, s23, 36864
MA 40,v,112,v,164
v_lshl_add_u32 v216, v69, 5, v66
v_xor_b32 v69, 1, v68
MA 36,v,116,v,160
v_lshl_add_u32 v217, v69, 5, v66
v_xor_b32 v69, 2, v68
MA 44,v,116,v,164
v_lshl_add_u32 v218, v69, 5, v66
v_xor_b32 v69, 3, v68
MA 96,v,120,v,160
ds_read_b128 v[100:103], v192 offset:43008
buffer_load_dwordx4 v188, s[12:15], s21 offen offset:0 lds
MA 104,v,120,v,164
v_lshl_add_u32 v219, v69, 5, v66
v_xor_b32 v69, 4, v68
MA 100,v,124,v,160
v_lshl_add_u32 v220, v69, 5, v66
v_xor_b32 v69, 5, v68
MA 108,v,124,v,164
v_lshl_add_u32 v221, v69, 5, v66
v_xor_b32 v69, 6, v68
MA 160,v,128,v,160
buffer_load_dwordx4 v189, s[12:15], s21 offen offset:1024 lds
v_lshl_add_u32 v222, v69, 5, v66
MA 168,v,128,v,164
ds_read_b128 v[104:107], v192 offset:45056
v_xor_b32 v69, 7, v68
MA 164,v,132,v,160
v_lshl_add_u32 v223, v69, 5, v66
s_mov_b32 s44, s32
MA 172,v,132,v,164
s_mov_b32 s45, s33
MA 224,v,136,v,160
buffer_load_dwordx4 v190, s[12:15], s21 offen offset:2048 lds
s_mov_b32 s46, 4194304
MA 232,v,136,v,164
s_mov_b32 s47, 0x20000
MA 228,v,140,v,160
TR 160,200,0
TR 162,200,2048
MA 236,v,140,v,164
TR 164,201,0
TR 166,201,2048
MA 244,v,140,v,168
ds_read_b128 v[108:111], v192 offset:47104
MA 252,v,140,v,172
buffer_load_dwordx4 v191, s[12:15], s21 offen offset:3072 lds
MA 240,v,136,v,168
s_add_u32 s48, s34, s82
s_addc_u32 s49, s35, 0
MA 248,v,136,v,172
s_sub_u32 s50, 8388608, s82
s_mov_b32 s51, 0x20000
MA 180,v,132,v,168
s_add_u32 s60, s40, 33554432
s_addc_u32 s61, s41, 0
MA 188,v,132,v,172
s_add_u32 s21, s21, 524288
s_mov_b32 s62, 16777216
MA 176,v,128,v,168
s_mov_b32 s63, 0x20000
s_lshl_b32 s80, s69, 19
MA 184,v,128,v,172
s_add_u32 s52, s40, s80
s_addc_u32 s53, s41, 0
MA 116,v,124,v,168
s_lshl_b32 s54, s77, 14
s_mov_b32 s55, 0x20000
MA 124,v,124,v,172
s_and_b32 s21, s21, 4194303
s_add_u32 s80, s80, 16760832
MA 112,v,120,v,168
s_add_u32 s56, s40, s80
s_addc_u32 s57, s41, 0
MA 120,v,120,v,172
s_add_u32 s58, s54, 16384
MA 52,v,116,v,168
s_mov_b32 s59, 0x20000
MA 60,v,116,v,172
s_load_dwordx2 s[38:39], s[0:1], 112
MA 48,v,112,v,168
TR 168,202,0
TR 170,202,2048
MA 56,v,112,v,172
TR 172,203,0
TR 174,203,2048
s_waitcnt lgkmcnt(4)
MA 0,v,80,v,144
s_add_u32 m0, s22, 0
buffer_load_dwordx2 v[28:29], v254, s[84:87], 0 offen
MA 8,v,80,v,148
ds_read_b128 v[112:115], v193 offset:32768
MA 4,v,84,v,144
MA 12,v,84,v,148
MA 64,v,88,v,144
buffer_load_dwordx2 v[44:45], v254, s[88:91], 0 offen
MA 72,v,88,v,148
buffer_load_dwordx4 v176, s[8:11], s20 offen offset:0 lds
MA 68,v,92,v,144
MA 76,v,92,v,148
ds_read_b128 v[116:119], v193 offset:34816
MA 128,v,96,v,144
v_add_u32 v255, 14336, v229
MA 136,v,96,v,148
MA 132,v,100,v,144
buffer_load_dwordx4 v177, s[8:11], s20 offen offset:1024 lds
MA 140,v,100,v,148
MA 192,v,104,v,144
MA 200,v,104,v,148
ds_read_b128 v[120:123], v193 offset:36864
buffer_load_dwordx2 v[30:31], v255, s[84:87], 0 offen
MA 196,v,108,v,144
TR 144,196,16384
TR 146,196,18432
MA 204,v,108,v,148
TR 148,197,16384
TR 150,197,18432
MA 212,v,108,v,152
buffer_load_dwordx4 v178, s[8:11], s20 offen offset:2048 lds
MA 220,v,108,v,156
buffer_load_dwordx2 v[46:47], v255, s[88:91], 0 offen
MA 208,v,104,v,152
MA 216,v,104,v,156
MA 148,v,100,v,152
ds_read_b128 v[124:127], v193 offset:38912
buffer_load_dwordx4 v179, s[8:11], s20 offen offset:3072 lds
MA 156,v,100,v,156
MA 144,v,96,v,152
v_add_u32 v252, 16384, v229
MA 152,v,96,v,156
MA 84,v,92,v,152
MA 92,v,92,v,156
s_add_u32 m0, s22, 4096
MA 80,v,88,v,152
ds_read_b128 v[128:131], v193 offset:40960
buffer_load_dwordx2 v[32:33], v252, s[84:87], 0 offen
MA 88,v,88,v,156
MA 20,v,84,v,152
MA 28,v,84,v,156
MA 16,v,80,v,152
TR 152,198,16384
TR 154,198,18432
MA 24,v,80,v,156
TR 156,199,16384
TR 158,199,18432
MA 32,v,80,v,160
ds_read_b128 v[132:135], v193 offset:43008
buffer_load_dwordx4 v180, s[8:11], s20 offen offset:0 lds
MA 40,v,80,v,164
buffer_load_dwordx2 v[48:49], v252, s[88:91], 0 offen
MA 36,v,84,v,160
MA 44,v,84,v,164
v_add_u32 v253, 18432, v229
MA 96,v,88,v,160
buffer_load_dwordx4 v181, s[8:11], s20 offen offset:1024 lds
MA 104,v,88,v,164
MA 100,v,92,v,160
MA 108,v,92,v,164
ds_read_b128 v[136:139], v193 offset:45056
buffer_load_dwordx2 v[34:35], v253, s[84:87], 0 offen
MA 160,v,96,v,160
MA 168,v,96,v,164
buffer_load_dwordx4 v182, s[8:11], s20 offen offset:2048 lds
MA 164,v,100,v,160
MA 172,v,100,v,164
MA 224,v,104,v,160
buffer_load_dwordx2 v[50:51], v253, s[88:91], 0 offen
MA 232,v,104,v,164
ds_read_b128 v[140:143], v193 offset:47104
MA 228,v,108,v,160
TR 160,200,16384
TR 162,200,18432
MA 236,v,108,v,164
TR 164,201,16384
TR 166,201,18432
s_waitcnt lgkmcnt(15)
MA 244,v,108,v,168
buffer_load_dwordx4 v183, s[8:11], s20 offen offset:3072 lds
v_add_u32 v254, 20480, v229
MA 252,v,108,v,172
MA 240,v,104,v,168
MA 248,v,104,v,172
s_add_u32 s20, s20, 128
MA 180,v,100,v,168
MA 188,v,100,v,172
buffer_load_dwordx2 v[36:37], v254, s[84:87], 0 offen
MA 176,v,96,v,168
MA 184,v,96,v,172
MA 116,v,92,v,168
s_and_b32 s20, s20, 1023
MA 124,v,92,v,172
buffer_load_dwordx2 v[52:53], v254, s[88:91], 0 offen
MA 112,v,88,v,168
MA 120,v,88,v,172
MA 52,v,84,v,168
MA 60,v,84,v,172
MA 48,v,80,v,168
TR 168,202,16384
TR 170,202,18432
MA 56,v,80,v,172
TR 172,203,16384
TR 174,203,18432
s_waitcnt lgkmcnt(4)
MA 0,v,112,v,144
MA 8,v,112,v,148
MA 4,v,116,v,144
MA 12,v,116,v,148
MA 64,v,120,v,144
MA 72,v,120,v,148
MA 68,v,124,v,144
MA 76,v,124,v,148
MA 128,v,128,v,144
MA 136,v,128,v,148
s_waitcnt vmcnt(18) lgkmcnt(0)
s_barrier
MA 132,v,132,v,144
s_add_u32 m0, s23, 0
s_and_b32 s37, s3, 3
MA 140,v,132,v,148
ds_read_b128 v[80:83], v194 offset:0
MA 192,v,136,v,144
s_cmp_eq_u32 s37, 0
s_cselect_b32 s37, 0, 0x40000000
MA 200,v,136,v,148
MA 196,v,140,v,144
TR 144,196,32768
TR 146,196,34816
MA 204,v,140,v,148
TR 148,197,32768
TR 150,197,34816
MA 212,v,140,v,152
ds_read_b128 v[84:87], v194 offset:2048
buffer_load_dwordx4 v184, s[12:15], s21 offen offset:0 lds
MA 220,v,140,v,156
v_add_u32 v229, s37, v78
MA 208,v,136,v,152
buffer_load_dwordx4 v185, s[12:15], s21 offen offset:1024 lds
MA 216,v,136,v,156
buffer_load_dword v79, v229, s[4:7], 0 offen
MA 148,v,132,v,152
MA 156,v,132,v,156
ds_read_b128 v[88:91], v194 offset:4096
s_getpc_b64 s[82:83]
L_ct_fV:
MA 144,v,128,v,152
MA 152,v,128,v,156
buffer_load_dwordx4 v186, s[12:15], s21 offen offset:2048 lds
MA 84,v,124,v,152
s_add_u32 s82, s82, L_p2 - L_ct_fV
s_addc_u32 s83, s83, 0
MA 92,v,124,v,156
MA 80,v,120,v,152
ds_read_b128 v[92:95], v194 offset:6144
MA 88,v,120,v,156
buffer_load_dwordx4 v187, s[12:15], s21 offen offset:3072 lds
MA 20,v,116,v,152
v_mov_b32 v67, s83
MA 28,v,116,v,156
MA 16,v,112,v,152
TR 152,198,32768
TR 154,198,34816
MA 24,v,112,v,156
TR 156,199,32768
TR 158,199,34816
MA 32,v,112,v,160
ds_read_b128 v[96:99], v194 offset:8192
s_add_u32 m0, s23, 4096
MA 40,v,112,v,164
v_mov_b32 v66, s82
s_lshr_b32 s82, s2, 3
MA 36,v,116,v,160
s_lshl_b32 s82, s82, 2
MA 44,v,116,v,164
MA 96,v,120,v,160
ds_read_b128 v[100:103], v194 offset:10240
buffer_load_dwordx4 v188, s[12:15], s21 offen offset:0 lds
MA 104,v,120,v,164
s_add_u32 s82, s82, s3
MA 100,v,124,v,160
MA 108,v,124,v,164
s_lshl_b32 s82, s82, 7
MA 160,v,128,v,160
buffer_load_dwordx4 v189, s[12:15], s21 offen offset:1024 lds
MA 168,v,128,v,164
ds_read_b128 v[104:107], v194 offset:12288
v_and_b32 v68, 3, v1
MA 164,v,132,v,160
MA 172,v,132,v,164
v_lshlrev_b32 v68, 14, v68
MA 224,v,136,v,160
buffer_load_dwordx4 v190, s[12:15], s21 offen offset:2048 lds
MA 232,v,136,v,164
MA 228,v,140,v,160
TR 160,200,32768
TR 162,200,34816
MA 236,v,140,v,164
TR 164,201,32768
TR 166,201,34816
MA 244,v,140,v,168
ds_read_b128 v[108:111], v194 offset:14336
v_add_u32 v68, s82, v68
MA 252,v,140,v,172
buffer_load_dwordx4 v191, s[12:15], s21 offen offset:3072 lds
v_min_u32 v68, L_p3_begin - L_p2 - 4, v68
MA 240,v,136,v,168
v_add_co_u32 v66, vcc, v66, v68
s_nop 1
v_addc_co_u32 v67, vcc, 0, v67, vcc
MA 248,v,136,v,172
MA 180,v,132,v,168
MA 188,v,132,v,172
s_add_u32 s21, s21, 524288
MA 176,v,128,v,168
MA 184,v,128,v,172
MA 116,v,124,v,168
MA 124,v,124,v,172
s_and_b32 s21, s21, 4194303
MA 112,v,120,v,168
MA 120,v,120,v,172
global_load_dword v68, v[66:67], off
MA 52,v,116,v,168
MA 60,v,116,v,172
MA 48,v,112,v,168
TR 168,202,32768
TR 170,202,34816
MA 56,v,112,v,172
TR 172,203,32768
TR 174,203,34816
s_waitcnt lgkmcnt(4)
MA 0,v,80,v,144
s_add_u32 m0, s22, 32768
s_and_b32 s37, s3, 3
MA 8,v,80,v,148
ds_read_b128 v[112:115], v195 offset:0
MA 4,v,84,v,144
MA 12,v,84,v,148
MA 64,v,88,v,144
MA 72,v,88,v,148
buffer_load_dwordx4 v176, s[8:11], s20 offen offset:0 lds
MA 68,v,92,v,144
MA 76,v,92,v,148
ds_read_b128 v[116:119], v195 offset:2048
MA 128,v,96,v,144
MA 136,v,96,v,148
MA 132,v,100,v,144
buffer_load_dwordx4 v177, s[8:11], s20 offen offset:1024 lds
MA 140,v,100,v,148
MA 192,v,104,v,144
s_cmp_eq_u32 s37, 1
s_cselect_b32 s37, 0, 0x40000000
MA 200,v,104,v,148
ds_read_b128 v[120:123], v195 offset:4096
MA 196,v,108,v,144
TR 144,196,49152
TR 146,196,51200
MA 204,v,108,v,148
TR 148,197,49152
TR 150,197,51200
MA 212,v,108,v,152
buffer_load_dwordx4 v178, s[8:11], s20 offen offset:2048 lds
MA 220,v,108,v,156
MA 208,v,104,v,152
MA 216,v,104,v,156
MA 148,v,100,v,152
ds_read_b128 v[124:127], v195 offset:6144
buffer_load_dwordx4 v179, s[8:11], s20 offen offset:3072 lds
MA 156,v,100,v,156
MA 144,v,96,v,152
MA 152,v,96,v,156
MA 84,v,92,v,152
MA 92,v,92,v,156
s_add_u32 m0, s22, 36864
MA 80,v,88,v,152
ds_read_b128 v[128:131], v195 offset:8192
MA 88,v,88,v,156
MA 20,v,84,v,152
MA 28,v,84,v,156
MA 16,v,80,v,152
TR 152,198,49152
TR 154,198,51200
MA 24,v,80,v,156
TR 156,199,49152
TR 158,199,51200
MA 32,v,80,v,160
ds_read_b128 v[132:135], v195 offset:10240
buffer_load_dwordx4 v180, s[8:11], s20 offen offset:0 lds
MA 40,v,80,v,164
MA 36,v,84,v,160
MA 44,v,84,v,164
MA 96,v,88,v,160
buffer_load_dwordx4 v181, s[8:11], s20 offen offset:1024 lds
MA 104,v,88,v,164
v_add_u32 v229, s37, v78
MA 100,v,92,v,160
MA 108,v,92,v,164
ds_read_b128 v[136:139], v195 offset:12288
MA 160,v,96,v,160
MA 168,v,96,v,164
buffer_load_dwordx4 v182, s[8:11], s20 offen offset:2048 lds
MA 164,v,100,v,160
MA 172,v,100,v,164
MA 224,v,104,v,160
MA 232,v,104,v,164
ds_read_b128 v[140:143], v195 offset:14336
MA 228,v,108,v,160
TR 160,200,49152
TR 162,200,51200
MA 236,v,108,v,164
TR 164,201,49152
TR 166,201,51200
s_waitcnt lgkmcnt(15)
MA 244,v,108,v,168
buffer_load_dwordx4 v183, s[8:11], s20 offen offset:3072 lds
MA 252,v,108,v,172
buffer_load_dword v79, v229, s[4:7], 0 offen
MA 240,v,104,v,168
MA 248,v,104,v,172
s_add_u32 s20, s20, 128
MA 180,v,100,v,168
MA 188,v,100,v,172
MA 176,v,96,v,168
MA 184,v,96,v,172
MA 116,v,92,v,168
s_and_b32 s20, s20, 1023
MA 124,v,92,v,172
MA 112,v,88,v,168
MA 120,v,88,v,172
MA 52,v,84,v,168
MA 60,v,84,v,172
MA 48,v,80,v,168
TR 168,202,49152
TR 170,202,51200
MA 56,v,80,v,172
TR 172,203,49152
TR 174,203,51200
s_waitcnt lgkmcnt(4)
MA 0,v,112,v,144
MA 8,v,112,v,148
MA 4,v,116,v,144
MA 12,v,116,v,148
MA 64,v,120,v,144
MA 72,v,120,v,148
MA 68,v,124,v,144
MA 76,v,124,v,148
MA 128,v,128,v,144
MA 136,v,128,v,148
s_waitcnt vmcnt(10) lgkmcnt(0)
s_barrier
MA 132,v,132,v,144
s_add_u32 m0, s23, 32768
s_and_b32 s37, s3, 3
MA 140,v,132,v,148
ds_read_b128 v[80:83], v192 offset:0
MA 192,v,136,v,144
s_cmp_eq_u32 s37, 2
s_cselect_b32 s37, 0, 0x40000000
MA 200,v,136,v,148
v_add_u32 v229, s37, v78
buffer_load_dword v79, v229, s[4:7], 0 offen
MA 196,v,140,v,144
TR 144,196,0
TR 146,196,2048
MA 204,v,140,v,148
TR 148,197,0
TR 150,197,2048
MA 212,v,140,v,152
ds_read_b128 v[84:87], v192 offset:2048
buffer_load_dwordx4 v184, s[12:15], s21 offen offset:0 lds
MA 220,v,140,v,156
s_add_u32 s84, s40, 50331648
s_addc_u32 s85, s41, 0
MA 208,v,136,v,152
buffer_load_dwordx4 v185, s[12:15], s21 offen offset:1024 lds
s_mov_b32 s86, 4194304
MA 216,v,136,v,156
s_mov_b32 s87, 0x20000
MA 148,v,132,v,152
s_add_u32 s88, s40, 58720256
s_addc_u32 s89, s41, 0
MA 156,v,132,v,156
ds_read_b128 v[88:91], v192 offset:4096
s_mov_b32 s90, 8192
MA 144,v,128,v,152
s_mov_b32 s91, 0x20000
v_mov_b32 v252, 0
MA 152,v,128,v,156
buffer_load_dwordx4 v186, s[12:15], s21 offen offset:2048 lds
v_mov_b32 v253, 0
MA 84,v,124,v,152
v_dot2_f32_bf16 v252, v230, v2, v252
v_dot2_f32_bf16 v253, v231, v3, v253
v_dot2_f32_bf16 v252, v232, v4, v252
v_dot2_f32_bf16 v253, v233, v5, v253
v_dot2_f32_bf16 v252, v234, v6, v252
v_dot2_f32_bf16 v253, v235, v7, v253
v_dot2_f32_bf16 v252, v236, v8, v252
v_dot2_f32_bf16 v253, v237, v9, v253
v_dot2_f32_bf16 v252, v238, v12, v252
v_dot2_f32_bf16 v253, v239, v13, v253
v_dot2_f32_bf16 v252, v240, v14, v252
v_dot2_f32_bf16 v253, v241, v15, v253
v_dot2_f32_bf16 v252, v242, v246, v252
v_dot2_f32_bf16 v253, v243, v247, v253
v_dot2_f32_bf16 v252, v244, v248, v252
v_dot2_f32_bf16 v253, v245, v249, v253
MA 92,v,124,v,156
s_nop 2
v_add_f32 v252, v252, v253
MA 80,v,120,v,152
ds_read_b128 v[92:95], v192 offset:6144
MA 88,v,120,v,156
buffer_load_dwordx4 v187, s[12:15], s21 offen offset:3072 lds
v_add_f32_dpp v252, v252, v252 row_ror:8 row_mask:0xf bank_mask:0xf
MA 20,v,116,v,152
s_nop 0
v_add_f32_dpp v252, v252, v252 row_ror:4 row_mask:0xf bank_mask:0xf
s_nop 1
v_add_f32_dpp v252, v252, v252 row_ror:2 row_mask:0xf bank_mask:0xf
MA 28,v,116,v,156
s_nop 0
v_add_f32_dpp v252, v252, v252 row_ror:1 row_mask:0xf bank_mask:0xf
v_mov_b32 v253, v252
MA 16,v,112,v,152
TR 152,198,0
TR 154,198,2048
MA 24,v,112,v,156
TR 156,199,0
TR 158,199,2048
MA 32,v,112,v,160
ds_read_b128 v[96:99], v192 offset:8192
s_add_u32 m0, s23, 36864
MA 40,v,112,v,164
v_permlane16_swap_b32 v252, v253
v_add_f32 v252, v252, v253
MA 36,v,116,v,160
v_mul_f32 v252, 0xbfb8aa3b, v252
MA 44,v,116,v,164
v_exp_f32 v252, v252
MA 96,v,120,v,160
ds_read_b128 v[100:103], v192 offset:10240
buffer_load_dwordx4 v188, s[12:15], s21 offen offset:0 lds
MA 104,v,120,v,164
v_add_f32 v252, 1.0, v252
MA 100,v,124,v,160
v_rcp_f32 v252, v252
MA 108,v,124,v,164
s_nop 0
buffer_store_dword v252, v11, s[88:91], 0 offen sc1
MA 160,v,128,v,160
buffer_load_dwordx4 v189, s[12:15], s21 offen offset:1024 lds
v_lshlrev_b32 v2, 16, v54
MA 168,v,128,v,164
ds_read_b128 v[104:107], v192 offset:12288
v_and_b32 v3, 0xffff0000, v54
MA 164,v,132,v,160
v_lshlrev_b32 v4, 16, v55
v_and_b32 v5, 0xffff0000, v55
MA 172,v,132,v,164
v_lshlrev_b32 v6, 16, v56
v_and_b32 v7, 0xffff0000, v56
MA 224,v,136,v,160
buffer_load_dwordx4 v190, s[12:15], s21 offen offset:2048 lds
v_lshlrev_b32 v8, 16, v57
MA 232,v,136,v,164
v_and_b32 v9, 0xffff0000, v57
v_lshlrev_b32 v230, 16, v16
MA 228,v,140,v,160
TR 160,200,0
TR 162,200,2048
MA 236,v,140,v,164
TR 164,201,0
TR 166,201,2048
MA 244,v,140,v,168
ds_read_b128 v[108:111], v192 offset:14336
v_and_b32 v231, 0xffff0000, v16
MA 252,v,140,v,172
buffer_load_dwordx4 v191, s[12:15], s21 offen offset:3072 lds
v_lshlrev_b32 v232, 16, v18
MA 240,v,136,v,168
v_and_b32 v233, 0xffff0000, v18
v_lshlrev_b32 v234, 16, v20
MA 248,v,136,v,172
v_and_b32 v235, 0xffff0000, v20
v_lshlrev_b32 v236, 16, v22
MA 180,v,132,v,168
v_and_b32 v237, 0xffff0000, v22
v_lshlrev_b32 v238, 16, v24
MA 188,v,132,v,172
s_add_u32 s21, s21, 524288
v_and_b32 v239, 0xffff0000, v24
MA 176,v,128,v,168
v_lshlrev_b32 v240, 16, v26
v_and_b32 v241, 0xffff0000, v26
MA 184,v,128,v,172
v_lshlrev_b32 v242, 16, v28
v_and_b32 v243, 0xffff0000, v28
MA 116,v,124,v,168
v_lshlrev_b32 v244, 16, v30
v_and_b32 v245, 0xffff0000, v30
MA 124,v,124,v,172
s_and_b32 s21, s21, 4194303
v_lshlrev_b32 v246, 16, v32
MA 112,v,120,v,168
v_and_b32 v247, 0xffff0000, v32
v_lshlrev_b32 v248, 16, v34
MA 120,v,120,v,172
v_and_b32 v249, 0xffff0000, v34
v_lshlrev_b32 v250, 16, v36
MA 52,v,116,v,168
v_and_b32 v251, 0xffff0000, v36
v_lshlrev_b32 v254, 16, v38
MA 60,v,116,v,172
v_and_b32 v255, 0xffff0000, v38
v_mul_f32 v62, v236, v2
MA 48,v,112,v,168
TR 168,202,0
TR 170,202,2048
MA 56,v,112,v,172
TR 172,203,0
TR 174,203,2048
v_mul_f32 v70, v237, v6
v_fmac_f32 v62, v234, v3
v_fmac_f32 v70, v235, v7
v_fmac_f32 v62, v232, v4
v_fmac_f32 v70, v233, v8
v_fmac_f32 v62, v230, v5
v_fmac_f32 v70, v231, v9
v_mul_f32 v62, v62, v254
v_mul_f32 v70, v70, v255
v_lshlrev_b32 v254, 16, v40
v_and_b32 v255, 0xffff0000, v40
v_mul_f32 v63, v238, v2
v_mul_f32 v71, v239, v6
v_fmac_f32 v63, v236, v3
v_fmac_f32 v71, v237, v7
v_fmac_f32 v63, v234, v4
v_fmac_f32 v71, v235, v8
v_fmac_f32 v63, v232, v5
v_fmac_f32 v71, v233, v9
s_waitcnt lgkmcnt(4)
MA 0,v,80,v,144
s_add_u32 s75, s64, s74
s_and_b32 s37, s3, 3
MA 8,v,80,v,148
ds_read_b128 v[112:115], v193 offset:0
MA 4,v,84,v,144
s_cmp_eq_u32 s37, 3
s_cselect_b32 s37, 0, 0x40000000
MA 12,v,84,v,148
v_add_u32 v229, s37, v78
buffer_load_dword v79, v229, s[4:7], 0 offen
MA 64,v,88,v,144
s_add_u32 m0, s67, 65536
v_mul_f32 v63, v63, v254
MA 72,v,88,v,148
v_mul_f32 v71, v71, v255
v_lshlrev_b32 v254, 16, v42
MA 68,v,92,v,144
v_and_b32 v255, 0xffff0000, v42
v_mul_f32 v64, v240, v2
MA 76,v,92,v,148
ds_read_b128 v[116:119], v193 offset:2048
v_mul_f32 v72, v241, v6
MA 128,v,96,v,144
buffer_load_dwordx4 v208, s[44:47], s75 offen offset:0 lds
v_fmac_f32 v64, v238, v3
MA 136,v,96,v,148
v_fmac_f32 v72, v239, v7
MA 132,v,100,v,144
v_fmac_f32 v64, v236, v4
v_fmac_f32 v72, v237, v8
MA 140,v,100,v,148
v_fmac_f32 v64, v234, v5
MA 192,v,104,v,144
v_fmac_f32 v72, v235, v9
MA 200,v,104,v,148
ds_read_b128 v[120:123], v193 offset:4096
buffer_load_dwordx4 v209, s[44:47], s75 offen offset:1024 lds
MA 196,v,108,v,144
TR 144,196,16384
TR 146,196,18432
MA 204,v,108,v,148
TR 148,197,16384
TR 150,197,18432
MA 212,v,108,v,152
v_mul_f32 v64, v64, v254
v_mul_f32 v72, v72, v255
MA 220,v,108,v,156
buffer_load_dwordx4 v210, s[44:47], s75 offen offset:2048 lds
v_lshlrev_b32 v254, 16, v44
MA 208,v,104,v,152
v_and_b32 v255, 0xffff0000, v44
v_mul_f32 v65, v242, v2
MA 216,v,104,v,156
v_mul_f32 v73, v243, v6
v_fmac_f32 v65, v240, v3
MA 148,v,100,v,152
ds_read_b128 v[124:127], v193 offset:6144
v_fmac_f32 v73, v241, v7
MA 156,v,100,v,156
v_fmac_f32 v65, v238, v4
v_fmac_f32 v73, v239, v8
MA 144,v,96,v,152
buffer_load_dwordx4 v211, s[44:47], s75 offen offset:3072 lds
v_fmac_f32 v65, v236, v5
MA 152,v,96,v,156
v_fmac_f32 v73, v237, v9
v_mul_f32 v65, v65, v254
MA 84,v,92,v,152
v_mul_f32 v73, v73, v255
v_lshlrev_b32 v254, 16, v46
MA 92,v,92,v,156
v_and_b32 v255, 0xffff0000, v46
v_mul_f32 v66, v244, v2
MA 80,v,88,v,152
ds_read_b128 v[128:131], v193 offset:8192
s_add_u32 s75, s65, s74
MA 88,v,88,v,156
v_mul_f32 v74, v245, v6
v_fmac_f32 v66, v242, v3
MA 20,v,84,v,152
v_fmac_f32 v74, v243, v7
v_fmac_f32 v66, v240, v4
MA 28,v,84,v,156
v_fmac_f32 v74, v241, v8
MA 16,v,80,v,152
TR 152,198,16384
TR 154,198,18432
MA 24,v,80,v,156
TR 156,199,16384
TR 158,199,18432
MA 32,v,80,v,160
ds_read_b128 v[132:135], v193 offset:10240
s_add_u32 m0, s67, 69632
MA 40,v,80,v,164
v_fmac_f32 v66, v238, v5
v_fmac_f32 v74, v239, v9
MA 36,v,84,v,160
v_mul_f32 v66, v66, v254
v_mul_f32 v74, v74, v255
MA 44,v,84,v,164
buffer_load_dwordx4 v208, s[44:47], s75 offen offset:0 lds
v_lshlrev_b32 v254, 16, v48
MA 96,v,88,v,160
v_and_b32 v255, 0xffff0000, v48
v_mul_f32 v67, v246, v2
MA 104,v,88,v,164
v_mul_f32 v75, v247, v6
v_fmac_f32 v67, v244, v3
MA 100,v,92,v,160
v_fmac_f32 v75, v245, v7
v_fmac_f32 v67, v242, v4
MA 108,v,92,v,164
ds_read_b128 v[136:139], v193 offset:12288
buffer_load_dwordx4 v209, s[44:47], s75 offen offset:1024 lds
MA 160,v,96,v,160
v_fmac_f32 v75, v243, v8
v_fmac_f32 v67, v240, v5
MA 168,v,96,v,164
v_fmac_f32 v75, v241, v9
v_mul_f32 v67, v67, v254
MA 164,v,100,v,160
v_mul_f32 v75, v75, v255
v_lshlrev_b32 v254, 16, v50
MA 172,v,100,v,164
v_and_b32 v255, 0xffff0000, v50
MA 224,v,104,v,160
buffer_load_dwordx4 v210, s[44:47], s75 offen offset:2048 lds
s_waitcnt vmcnt(27)
v_mul_f32 v68, v248, v2
MA 232,v,104,v,164
ds_read_b128 v[140:143], v193 offset:14336
v_mul_f32 v76, v249, v6
MA 228,v,108,v,160
TR 160,200,16384
TR 162,200,18432
MA 236,v,108,v,164
TR 164,201,16384
TR 166,201,18432
s_waitcnt lgkmcnt(15)
MA 244,v,108,v,168
buffer_load_dwordx4 v211, s[44:47], s75 offen offset:3072 lds
v_fmac_f32 v68, v246, v3
MA 252,v,108,v,172
v_fmac_f32 v76, v247, v7
v_fmac_f32 v68, v244, v4
MA 240,v,104,v,168
v_fmac_f32 v76, v245, v8
v_fmac_f32 v68, v242, v5
MA 248,v,104,v,172
v_fmac_f32 v76, v243, v9
v_mul_f32 v68, v68, v254
MA 180,v,100,v,168
v_mul_f32 v76, v76, v255
v_lshlrev_b32 v254, 16, v52
MA 188,v,100,v,172
s_add_u32 s74, s74, 128
v_and_b32 v255, 0xffff0000, v52
MA 176,v,96,v,168
v_mul_f32 v69, v250, v2
v_mul_f32 v77, v251, v6
MA 184,v,96,v,172
v_fmac_f32 v69, v248, v3
v_fmac_f32 v77, v249, v7
MA 116,v,92,v,168
v_fmac_f32 v69, v246, v4
MA 124,v,92,v,172
s_and_b32 s74, s74, 2047
v_fmac_f32 v77, v247, v8
MA 112,v,88,v,168
v_fmac_f32 v69, v244, v5
v_fmac_f32 v77, v245, v9
MA 120,v,88,v,172
v_mul_f32 v69, v69, v254
MA 52,v,84,v,168
v_mul_f32 v77, v77, v255
MA 60,v,84,v,172
v_cvt_pk_bf16_f32 v12, v69, v68
MA 48,v,80,v,168
TR 168,202,16384
TR 170,202,18432
MA 56,v,80,v,172
TR 172,203,16384
TR 174,203,18432
s_waitcnt lgkmcnt(4)
MA 0,v,112,v,144
MA 8,v,112,v,148
MA 4,v,116,v,144
MA 12,v,116,v,148
MA 64,v,120,v,144
MA 72,v,120,v,148
MA 68,v,124,v,144
MA 76,v,124,v,148
MA 128,v,128,v,144
MA 136,v,128,v,148
s_waitcnt vmcnt(9) lgkmcnt(0)
s_barrier
MA 132,v,132,v,144
s_add_u32 m0, s68, 98304
v_cvt_pk_bf16_f32 v13, v67, v66
MA 140,v,132,v,148
ds_read_b128 v[80:83], v192 offset:32768
v_cvt_pk_bf16_f32 v14, v65, v64
MA 192,v,136,v,144
v_cvt_pk_bf16_f32 v15, v63, v62
s_mov_b32 s36, 0
MA 200,v,136,v,148
buffer_load_dwordx4 v212, s[48:51], s66 offen offset:0 lds
buffer_store_dwordx4 v[12:15], v10, s[84:87], s36 offen sc1
MA 196,v,140,v,144
TR 144,196,32768
TR 146,196,34816
MA 204,v,140,v,148
TR 148,197,32768
TR 150,197,34816
MA 212,v,140,v,152
ds_read_b128 v[84:87], v192 offset:34816
v_cvt_pk_bf16_f32 v54, v77, v76
MA 220,v,140,v,156
buffer_load_dwordx4 v213, s[48:51], s66 offen offset:1024 lds
v_cvt_pk_bf16_f32 v55, v75, v74
MA 208,v,136,v,152
v_cvt_pk_bf16_f32 v56, v73, v72
v_cvt_pk_bf16_f32 v57, v71, v70
MA 216,v,136,v,156
s_mov_b32 s36, 4096
buffer_store_dwordx4 v[54:57], v10, s[84:87], s36 offen sc1
MA 148,v,132,v,152
v_lshlrev_b32 v2, 16, v58
v_and_b32 v3, 0xffff0000, v58
MA 156,v,132,v,156
ds_read_b128 v[88:91], v192 offset:36864
buffer_load_dwordx4 v214, s[48:51], s66 offen offset:2048 lds
MA 144,v,128,v,152
v_lshlrev_b32 v4, 16, v59
v_and_b32 v5, 0xffff0000, v59
MA 152,v,128,v,156
v_lshlrev_b32 v6, 16, v60
v_and_b32 v7, 0xffff0000, v60
MA 84,v,124,v,152
buffer_load_dwordx4 v215, s[48:51], s66 offen offset:3072 lds
v_lshlrev_b32 v8, 16, v61
MA 92,v,124,v,156
v_and_b32 v9, 0xffff0000, v61
v_lshlrev_b32 v230, 16, v17
MA 80,v,120,v,152
ds_read_b128 v[92:95], v192 offset:38912
v_and_b32 v231, 0xffff0000, v17
MA 88,v,120,v,156
v_lshlrev_b32 v232, 16, v19
v_and_b32 v233, 0xffff0000, v19
MA 20,v,116,v,152
s_add_u32 s66, s66, 524288
v_lshlrev_b32 v234, 16, v21
MA 28,v,116,v,156
v_and_b32 v235, 0xffff0000, v21
v_lshlrev_b32 v236, 16, v23
MA 16,v,112,v,152
TR 152,198,32768
TR 154,198,34816
MA 24,v,112,v,156
TR 156,199,32768
TR 158,199,34816
MA 32,v,112,v,160
ds_read_b128 v[96:99], v192 offset:40960
s_and_b32 s66, s66, 8388607
MA 40,v,112,v,164
v_and_b32 v237, 0xffff0000, v23
v_lshlrev_b32 v238, 16, v25
MA 36,v,116,v,160
v_and_b32 v239, 0xffff0000, v25
v_lshlrev_b32 v240, 16, v27
MA 44,v,116,v,164
v_and_b32 v241, 0xffff0000, v27
v_lshlrev_b32 v242, 16, v29
MA 96,v,120,v,160
ds_read_b128 v[100:103], v192 offset:43008
s_add_u32 m0, s68, 114688
MA 104,v,120,v,164
v_and_b32 v243, 0xffff0000, v29
v_lshlrev_b32 v244, 16, v31
MA 100,v,124,v,160
v_and_b32 v245, 0xffff0000, v31
v_lshlrev_b32 v246, 16, v33
MA 108,v,124,v,164
buffer_load_dwordx4 v212, s[48:51], s66 offen offset:0 lds
v_and_b32 v247, 0xffff0000, v33
MA 160,v,128,v,160
v_lshlrev_b32 v248, 16, v35
v_and_b32 v249, 0xffff0000, v35
MA 168,v,128,v,164
ds_read_b128 v[104:107], v192 offset:45056
v_lshlrev_b32 v250, 16, v37
MA 164,v,132,v,160
v_and_b32 v251, 0xffff0000, v37
v_lshlrev_b32 v254, 16, v39
MA 172,v,132,v,164
buffer_load_dwordx4 v213, s[48:51], s66 offen offset:1024 lds
v_and_b32 v255, 0xffff0000, v39
MA 224,v,136,v,160
v_mul_f32 v62, v236, v2
v_mul_f32 v70, v237, v6
MA 232,v,136,v,164
v_fmac_f32 v62, v234, v3
v_fmac_f32 v70, v235, v7
MA 228,v,140,v,160
TR 160,200,32768
TR 162,200,34816
MA 236,v,140,v,164
TR 164,201,32768
TR 166,201,34816
MA 244,v,140,v,168
ds_read_b128 v[108:111], v192 offset:47104
buffer_load_dwordx4 v214, s[48:51], s66 offen offset:2048 lds
MA 252,v,140,v,172
v_fmac_f32 v62, v232, v4
v_fmac_f32 v70, v233, v8
MA 240,v,136,v,168
buffer_load_dwordx4 v215, s[48:51], s66 offen offset:3072 lds
v_fmac_f32 v62, v230, v5
MA 248,v,136,v,172
v_fmac_f32 v70, v231, v9
v_mul_f32 v62, v62, v254
MA 180,v,132,v,168
v_mul_f32 v70, v70, v255
v_lshlrev_b32 v254, 16, v41
MA 188,v,132,v,172
v_and_b32 v255, 0xffff0000, v41
v_mul_f32 v63, v238, v2
MA 176,v,128,v,168
s_add_u32 s66, s66, 524288
v_mul_f32 v71, v239, v6
MA 184,v,128,v,172
v_fmac_f32 v63, v236, v3
v_fmac_f32 v71, v237, v7
MA 116,v,124,v,168
v_fmac_f32 v63, v234, v4
v_fmac_f32 v71, v235, v8
MA 124,v,124,v,172
v_fmac_f32 v63, v232, v5
v_fmac_f32 v71, v233, v9
MA 112,v,120,v,168
s_and_b32 s66, s66, 8388607
v_mul_f32 v63, v63, v254
MA 120,v,120,v,172
v_mul_f32 v71, v71, v255
v_lshlrev_b32 v254, 16, v43
MA 52,v,116,v,168
v_and_b32 v255, 0xffff0000, v43
v_mul_f32 v64, v240, v2
MA 60,v,116,v,172
v_mul_f32 v72, v241, v6
v_fmac_f32 v64, v238, v3
MA 48,v,112,v,168
TR 168,202,32768
TR 170,202,34816
MA 56,v,112,v,172
TR 172,203,32768
TR 174,203,34816
v_fmac_f32 v72, v239, v7
v_fmac_f32 v64, v236, v4
v_fmac_f32 v72, v237, v8
v_fmac_f32 v64, v234, v5
s_waitcnt lgkmcnt(4)
MA 0,v,80,v,144
s_add_u32 s75, s64, s74
v_fmac_f32 v72, v235, v9
MA 8,v,80,v,148
ds_read_b128 v[112:115], v193 offset:32768
v_mul_f32 v64, v64, v254
MA 4,v,84,v,144
v_mul_f32 v72, v72, v255
v_lshlrev_b32 v254, 16, v45
MA 12,v,84,v,148
v_and_b32 v255, 0xffff0000, v45
MA 64,v,88,v,144
s_add_u32 m0, s67, 0
v_mul_f32 v65, v242, v2
MA 72,v,88,v,148
v_mul_f32 v73, v243, v6
v_fmac_f32 v65, v240, v3
MA 68,v,92,v,144
v_fmac_f32 v73, v241, v7
MA 76,v,92,v,148
ds_read_b128 v[116:119], v193 offset:34816
v_fmac_f32 v65, v238, v4
MA 128,v,96,v,144
buffer_load_dwordx4 v208, s[44:47], s75 offen offset:0 lds
v_fmac_f32 v73, v239, v8
MA 136,v,96,v,148
v_fmac_f32 v65, v236, v5
v_fmac_f32 v73, v237, v9
MA 132,v,100,v,144
v_mul_f32 v65, v65, v254
MA 140,v,100,v,148
v_mul_f32 v73, v73, v255
MA 192,v,104,v,144
v_lshlrev_b32 v254, 16, v47
MA 200,v,104,v,148
ds_read_b128 v[120:123], v193 offset:36864
buffer_load_dwordx4 v209, s[44:47], s75 offen offset:1024 lds
MA 196,v,108,v,144
TR 144,196,49152
TR 146,196,51200
MA 204,v,108,v,148
TR 148,197,49152
TR 150,197,51200
MA 212,v,108,v,152
v_and_b32 v255, 0xffff0000, v47
v_mul_f32 v66, v244, v2
MA 220,v,108,v,156
buffer_load_dwordx4 v210, s[44:47], s75 offen offset:2048 lds
v_mul_f32 v74, v245, v6
MA 208,v,104,v,152
v_fmac_f32 v66, v242, v3
v_fmac_f32 v74, v243, v7
MA 216,v,104,v,156
v_fmac_f32 v66, v240, v4
v_fmac_f32 v74, v241, v8
MA 148,v,100,v,152
ds_read_b128 v[124:127], v193 offset:38912
v_fmac_f32 v66, v238, v5
MA 156,v,100,v,156
v_fmac_f32 v74, v239, v9
v_mul_f32 v66, v66, v254
MA 144,v,96,v,152
buffer_load_dwordx4 v211, s[44:47], s75 offen offset:3072 lds
v_mul_f32 v74, v74, v255
MA 152,v,96,v,156
v_lshlrev_b32 v254, 16, v49
v_and_b32 v255, 0xffff0000, v49
MA 84,v,92,v,152
v_mul_f32 v67, v246, v2
v_mul_f32 v75, v247, v6
MA 92,v,92,v,156
v_fmac_f32 v67, v244, v3
MA 80,v,88,v,152
ds_read_b128 v[128:131], v193 offset:40960
s_add_u32 s75, s65, s74
MA 88,v,88,v,156
v_fmac_f32 v75, v245, v7
v_fmac_f32 v67, v242, v4
MA 20,v,84,v,152
v_fmac_f32 v75, v243, v8
v_fmac_f32 v67, v240, v5
MA 28,v,84,v,156
v_fmac_f32 v75, v241, v9
MA 16,v,80,v,152
TR 152,198,49152
TR 154,198,51200
MA 24,v,80,v,156
TR 156,199,49152
TR 158,199,51200
MA 32,v,80,v,160
ds_read_b128 v[132:135], v193 offset:43008
s_add_u32 m0, s67, 4096
MA 40,v,80,v,164
v_mul_f32 v67, v67, v254
v_mul_f32 v75, v75, v255
MA 36,v,84,v,160
v_lshlrev_b32 v254, 16, v51
v_and_b32 v255, 0xffff0000, v51
MA 44,v,84,v,164
buffer_load_dwordx4 v208, s[44:47], s75 offen offset:0 lds
v_mul_f32 v68, v248, v2
MA 96,v,88,v,160
v_mul_f32 v76, v249, v6
v_fmac_f32 v68, v246, v3
MA 104,v,88,v,164
v_fmac_f32 v76, v247, v7
v_fmac_f32 v68, v244, v4
MA 100,v,92,v,160
v_fmac_f32 v76, v245, v8
v_fmac_f32 v68, v242, v5
MA 108,v,92,v,164
ds_read_b128 v[136:139], v193 offset:45056
buffer_load_dwordx4 v209, s[44:47], s75 offen offset:1024 lds
MA 160,v,96,v,160
v_fmac_f32 v76, v243, v9
v_mul_f32 v68, v68, v254
MA 168,v,96,v,164
v_mul_f32 v76, v76, v255
v_lshlrev_b32 v254, 16, v53
MA 164,v,100,v,160
v_and_b32 v255, 0xffff0000, v53
MA 172,v,100,v,164
v_mul_f32 v69, v250, v2
MA 224,v,104,v,160
buffer_load_dwordx4 v210, s[44:47], s75 offen offset:2048 lds
v_mul_f32 v77, v251, v6
MA 232,v,104,v,164
ds_read_b128 v[140:143], v193 offset:47104
v_fmac_f32 v69, v248, v3
MA 228,v,108,v,160
TR 160,200,49152
TR 162,200,51200
MA 236,v,108,v,164
TR 164,201,49152
TR 166,201,51200
s_waitcnt lgkmcnt(15)
MA 244,v,108,v,168
buffer_load_dwordx4 v211, s[44:47], s75 offen offset:3072 lds
v_fmac_f32 v77, v249, v7
MA 252,v,108,v,172
v_fmac_f32 v69, v246, v4
v_fmac_f32 v77, v247, v8
MA 240,v,104,v,168
v_fmac_f32 v69, v244, v5
v_fmac_f32 v77, v245, v9
MA 248,v,104,v,172
v_mul_f32 v69, v69, v254
v_mul_f32 v77, v77, v255
MA 180,v,100,v,168
v_cvt_pk_bf16_f32 v230, v69, v68
v_cvt_pk_bf16_f32 v231, v67, v66
MA 188,v,100,v,172
s_add_u32 s74, s74, 128
v_cvt_pk_bf16_f32 v232, v65, v64
MA 176,v,96,v,168
v_cvt_pk_bf16_f32 v233, v63, v62
s_mov_b32 s36, 8192
MA 184,v,96,v,172
buffer_store_dwordx4 v[230:233], v10, s[84:87], s36 offen sc1
MA 116,v,92,v,168
v_cvt_pk_bf16_f32 v234, v77, v76
MA 124,v,92,v,172
s_and_b32 s74, s74, 2047
v_cvt_pk_bf16_f32 v235, v75, v74
MA 112,v,88,v,168
v_cvt_pk_bf16_f32 v236, v73, v72
v_cvt_pk_bf16_f32 v237, v71, v70
MA 120,v,88,v,172
s_mov_b32 s36, 12288
MA 52,v,84,v,168
buffer_store_dwordx4 v[234:237], v10, s[84:87], s36 offen sc1
MA 60,v,84,v,172
v_lshlrev_b32 v228, 4, v1
MA 48,v,80,v,168
TR 168,202,49152
TR 170,202,51200
MA 56,v,80,v,172
TR 172,203,49152
TR 174,203,51200
s_waitcnt lgkmcnt(4)
MA 0,v,112,v,144
MA 8,v,112,v,148
MA 4,v,116,v,144
MA 12,v,116,v,148
MA 64,v,120,v,144
MA 72,v,120,v,148
MA 68,v,124,v,144
MA 76,v,124,v,148
MA 128,v,128,v,144
MA 136,v,128,v,148
s_waitcnt vmcnt(14) lgkmcnt(0)
s_barrier
MA 132,v,132,v,144
ds_read_b128 v[48:51], v226 offset:0
s_add_u32 m0, s68, 131072
MA 140,v,132,v,148
MA 192,v,136,v,144
ds_read_b128 v[52:55], v226 offset:2048
buffer_load_dwordx4 v212, s[48:51], s66 offen offset:0 lds
MA 200,v,136,v,148
MA 196,v,140,v,144
ds_read_b128 v[56:59], v226 offset:4096
buffer_load_dwordx4 v213, s[48:51], s66 offen offset:1024 lds
MA 204,v,140,v,148
MA 212,v,140,v,152
ds_read_b128 v[60:63], v226 offset:6144
MA 220,v,140,v,156
buffer_load_dwordx4 v214, s[48:51], s66 offen offset:2048 lds
MA 208,v,136,v,152
TR 16,216,0
MA 216,v,136,v,156
buffer_load_dwordx4 v215, s[48:51], s66 offen offset:3072 lds
MA 148,v,132,v,152
TR 18,216,1024
MA 156,v,132,v,156
MA 144,v,128,v,152
TR 20,217,0
s_add_u32 s66, s66, 524288
MA 152,v,128,v,156
MA 84,v,124,v,152
TR 22,217,1024
s_and_b32 s66, s66, 8388607
MA 92,v,124,v,156
MA 80,v,120,v,152
TR 24,218,0
MA 88,v,120,v,156
s_add_u32 s75, s64, s74
MA 20,v,116,v,152
TR 26,218,1024
MA 28,v,116,v,156
s_add_u32 m0, s67, 32768
MA 16,v,112,v,152
TR 28,219,0
MA 24,v,112,v,156
MA 32,v,112,v,160
TR 30,219,1024
buffer_load_dwordx4 v208, s[44:47], s75 offen offset:0 lds
MA 40,v,112,v,164
MA 36,v,116,v,160
TR 32,220,0
buffer_load_dwordx4 v209, s[44:47], s75 offen offset:1024 lds
MA 44,v,116,v,164
MA 96,v,120,v,160
TR 34,220,1024
MA 104,v,120,v,164
buffer_load_dwordx4 v210, s[44:47], s75 offen offset:2048 lds
MA 100,v,124,v,160
TR 36,221,0
MA 108,v,124,v,164
buffer_load_dwordx4 v211, s[44:47], s75 offen offset:3072 lds
MA 160,v,128,v,160
TR 38,221,1024
MA 168,v,128,v,164
MA 164,v,132,v,160
TR 40,222,0
s_add_u32 s75, s65, s74
MA 172,v,132,v,164
MA 224,v,136,v,160
TR 42,222,1024
s_add_u32 m0, s67, 36864
MA 232,v,136,v,164
MA 228,v,140,v,160
TR 44,223,0
MA 236,v,140,v,164
buffer_load_dwordx4 v208, s[44:47], s75 offen offset:0 lds
MA 244,v,140,v,168
TR 46,223,1024
MA 252,v,140,v,172
buffer_load_dwordx4 v209, s[44:47], s75 offen offset:1024 lds
MA 240,v,136,v,168
MA 248,v,136,v,172
MA 180,v,132,v,168
buffer_load_dwordx4 v210, s[44:47], s75 offen offset:2048 lds
MA 188,v,132,v,172
MA 176,v,128,v,168
buffer_load_dwordx4 v211, s[44:47], s75 offen offset:3072 lds
MA 184,v,128,v,172
MA 116,v,124,v,168
MA 124,v,124,v,172
s_add_u32 s74, s74, 128
MA 112,v,120,v,168
MA 120,v,120,v,172
s_and_b32 s74, s74, 2047
MA 52,v,116,v,168
MA 60,v,116,v,172
MA 48,v,112,v,168
MA 56,v,112,v,172
L_p2:
s_waitcnt lgkmcnt(4)
v_mfma_f32_16x16x32_bf16 v[80:83], v[16:19], v[48:51], 0
s_add_u32 s8, s40, 59768832
s_addc_u32 s9, s41, 0
v_mfma_f32_16x16x32_bf16 v[96:99], v[20:23], v[48:51], 0
ds_read_b128 v[64:67], v227 offset:0
v_mfma_f32_16x16x32_bf16 v[84:87], v[16:19], v[52:55], 0
s_mov_b32 s10, 8192
v_mfma_f32_16x16x32_bf16 v[100:103], v[20:23], v[52:55], 0
s_mov_b32 s11, 0x20000
v_mfma_f32_16x16x32_bf16 v[88:91], v[16:19], v[56:59], 0
s_mov_b32 s12, s38
v_mfma_f32_16x16x32_bf16 v[104:107], v[20:23], v[56:59], 0
s_mov_b32 s13, s39
v_mfma_f32_16x16x32_bf16 v[92:95], v[16:19], v[60:63], 0
TR 16,216,8192
TR 18,216,9216
v_mfma_f32_16x16x32_bf16 v[108:111], v[20:23], v[60:63], 0
TR 20,217,8192
TR 22,217,9216
v_mfma_f32_16x16x32_bf16 v[124:127], v[24:27], v[60:63], 0
ds_read_b128 v[68:71], v227 offset:2048
s_mov_b32 s14, 256
v_mfma_f32_16x16x32_bf16 v[140:143], v[28:31], v[60:63], 0
s_mov_b32 s15, 0x20000
v_accvgpr_read_b32 v234, a0
v_mfma_f32_16x16x32_bf16 v[120:123], v[24:27], v[56:59], 0
v_accvgpr_read_b32 v235, a1
v_accvgpr_read_b32 v236, a2
v_mfma_f32_16x16x32_bf16 v[136:139], v[28:31], v[56:59], 0
v_accvgpr_read_b32 v237, a3
v_mfma_f32_16x16x32_bf16 v[116:119], v[24:27], v[52:55], 0
ds_read_b128 v[72:75], v227 offset:4096
v_accvgpr_read_b32 v238, a4
v_mfma_f32_16x16x32_bf16 v[132:135], v[28:31], v[52:55], 0
v_accvgpr_read_b32 v239, a5
v_mfma_f32_16x16x32_bf16 v[112:115], v[24:27], v[48:51], 0
TR 24,218,8192
TR 26,218,9216
v_mfma_f32_16x16x32_bf16 v[128:131], v[28:31], v[48:51], 0
TR 28,219,8192
TR 30,219,9216
v_mfma_f32_16x16x32_bf16 v[144:147], v[32:35], v[48:51], 0
v_accvgpr_read_b32 v240, a6
v_accvgpr_read_b32 v241, a7
v_mfma_f32_16x16x32_bf16 v[160:163], v[36:39], v[48:51], 0
v_cvt_pk_bf16_f32 v230, v234, v235
v_cvt_pk_bf16_f32 v231, v236, v237
v_mfma_f32_16x16x32_bf16 v[148:151], v[32:35], v[52:55], 0
ds_read_b128 v[76:79], v227 offset:6144
v_cvt_pk_bf16_f32 v232, v238, v239
v_mfma_f32_16x16x32_bf16 v[164:167], v[36:39], v[52:55], 0
v_cvt_pk_bf16_f32 v233, v240, v241
v_mfma_f32_16x16x32_bf16 v[152:155], v[32:35], v[56:59], 0
buffer_store_dwordx4 v[230:233], v228, s[16:19], s24 offen offset:0 sc1
v_mfma_f32_16x16x32_bf16 v[168:171], v[36:39], v[56:59], 0
v_accvgpr_read_b32 v246, a8
v_mfma_f32_16x16x32_bf16 v[156:159], v[32:35], v[60:63], 0
TR 32,220,8192
TR 34,220,9216
v_mfma_f32_16x16x32_bf16 v[172:175], v[36:39], v[60:63], 0
TR 36,221,8192
TR 38,221,9216
s_waitcnt lgkmcnt(15)
v_mfma_f32_16x16x32_bf16 v[188:191], v[40:43], v[60:63], 0
v_accvgpr_read_b32 v247, a9
v_accvgpr_read_b32 v248, a10
v_mfma_f32_16x16x32_bf16 v[204:207], v[44:47], v[60:63], 0
v_accvgpr_read_b32 v249, a11
v_accvgpr_read_b32 v250, a12
v_mfma_f32_16x16x32_bf16 v[184:187], v[40:43], v[56:59], 0
v_accvgpr_read_b32 v251, a13
v_mfma_f32_16x16x32_bf16 v[200:203], v[44:47], v[56:59], 0
v_accvgpr_read_b32 v252, a14
v_mfma_f32_16x16x32_bf16 v[180:183], v[40:43], v[52:55], 0
v_accvgpr_read_b32 v253, a15
v_mfma_f32_16x16x32_bf16 v[196:199], v[44:47], v[52:55], 0
v_mfma_f32_16x16x32_bf16 v[176:179], v[40:43], v[48:51], 0
TR 40,222,8192
TR 42,222,9216
v_mfma_f32_16x16x32_bf16 v[192:195], v[44:47], v[48:51], 0
TR 44,223,8192
TR 46,223,9216
s_waitcnt lgkmcnt(4)
MV 80,v,16,v,64
v_cvt_pk_bf16_f32 v242, v246, v247
MV 96,v,20,v,64
v_cvt_pk_bf16_f32 v243, v248, v249
MV 84,v,16,v,68
v_cvt_pk_bf16_f32 v244, v250, v251
MV 100,v,20,v,68
MV 88,v,16,v,72
v_cvt_pk_bf16_f32 v245, v252, v253
MV 104,v,20,v,72
buffer_store_dwordx4 v[242:245], v228, s[16:19], s24 offen offset:1024 sc1
MV 92,v,16,v,76
MV 108,v,20,v,76
s_waitcnt vmcnt(16) lgkmcnt(0)
s_barrier
MV 124,v,24,v,76
TR 16,216,16384
TR 18,216,17408
MV 140,v,28,v,76
ds_read_b128 v[48:51], v224 offset:0
s_add_u32 m0, s68, 98304
MV 120,v,24,v,72
TR 20,217,16384
TR 22,217,17408
MV 136,v,28,v,72
buffer_load_dwordx4 v212, s[48:51], s66 offen offset:0 lds
v_accvgpr_read_b32 v234, a16
MV 116,v,24,v,68
ds_read_b128 v[52:55], v224 offset:2048
buffer_load_dwordx4 v213, s[48:51], s66 offen offset:1024 lds
MV 132,v,28,v,68
v_accvgpr_read_b32 v235, a17
v_accvgpr_read_b32 v236, a18
MV 112,v,24,v,64
TR 24,218,16384
TR 26,218,17408
MV 128,v,28,v,64
TR 28,219,16384
TR 30,219,17408
MV 144,v,32,v,64
ds_read_b128 v[56:59], v224 offset:4096
buffer_load_dwordx4 v214, s[48:51], s66 offen offset:2048 lds
MV 160,v,36,v,64
buffer_load_dwordx4 v215, s[48:51], s66 offen offset:3072 lds
v_accvgpr_read_b32 v237, a19
MV 148,v,32,v,68
v_accvgpr_read_b32 v238, a20
v_accvgpr_read_b32 v239, a21
MV 164,v,36,v,68
s_add_u32 s66, s66, 524288
v_accvgpr_read_b32 v240, a22
MV 152,v,32,v,72
ds_read_b128 v[60:63], v224 offset:6144
v_accvgpr_read_b32 v241, a23
MV 168,v,36,v,72
s_and_b32 s66, s66, 8388607
v_cvt_pk_bf16_f32 v230, v234, v235
MV 156,v,32,v,76
TR 32,220,16384
TR 34,220,17408
MV 172,v,36,v,76
TR 36,221,16384
TR 38,221,17408
MV 188,v,40,v,76
s_add_u32 s75, s64, s74
v_cvt_pk_bf16_f32 v231, v236, v237
MV 204,v,44,v,76
v_cvt_pk_bf16_f32 v232, v238, v239
v_cvt_pk_bf16_f32 v233, v240, v241
MV 184,v,40,v,72
s_add_u32 m0, s67, 65536
buffer_store_dwordx4 v[230:233], v228, s[16:19], s24 offen offset:2048 sc1
MV 200,v,44,v,72
v_accvgpr_read_b32 v246, a24
v_accvgpr_read_b32 v247, a25
MV 180,v,40,v,68
buffer_load_dwordx4 v208, s[44:47], s75 offen offset:0 lds
v_accvgpr_read_b32 v248, a26
MV 196,v,44,v,68
MV 176,v,40,v,64
TR 40,222,16384
TR 42,222,17408
MV 192,v,44,v,64
TR 44,223,16384
TR 46,223,17408
s_waitcnt lgkmcnt(4)
MV 80,v,16,v,48
buffer_load_dwordx4 v209, s[44:47], s75 offen offset:1024 lds
v_accvgpr_read_b32 v249, a27
MV 96,v,20,v,48
ds_read_b128 v[64:67], v225 offset:0
v_accvgpr_read_b32 v250, a28
MV 84,v,16,v,52
buffer_load_dwordx4 v210, s[44:47], s75 offen offset:2048 lds
v_accvgpr_read_b32 v251, a29
MV 100,v,20,v,52
MV 88,v,16,v,56
v_accvgpr_read_b32 v252, a30
MV 104,v,20,v,56
buffer_load_dwordx4 v211, s[44:47], s75 offen offset:3072 lds
v_accvgpr_read_b32 v253, a31
MV 92,v,16,v,60
TR 16,216,24576
TR 18,216,25600
MV 108,v,20,v,60
TR 20,217,24576
TR 22,217,25600
MV 124,v,24,v,60
ds_read_b128 v[68:71], v225 offset:2048
s_add_u32 s75, s65, s74
MV 140,v,28,v,60
v_cvt_pk_bf16_f32 v242, v246, v247
v_cvt_pk_bf16_f32 v243, v248, v249
MV 120,v,24,v,56
v_cvt_pk_bf16_f32 v244, v250, v251
MV 136,v,28,v,56
s_add_u32 m0, s67, 69632
v_cvt_pk_bf16_f32 v245, v252, v253
MV 116,v,24,v,52
ds_read_b128 v[72:75], v225 offset:4096
buffer_store_dwordx4 v[242:245], v228, s[16:19], s24 offen offset:3072 sc1
MV 132,v,28,v,52
MV 112,v,24,v,48
TR 24,218,24576
TR 26,218,25600
MV 128,v,28,v,48
TR 28,219,24576
TR 30,219,25600
MV 144,v,32,v,48
buffer_load_dwordx4 v208, s[44:47], s75 offen offset:0 lds
buffer_load_dwordx4 v209, s[44:47], s75 offen offset:1024 lds
MV 160,v,36,v,48
v_accvgpr_read_b32 v234, a32
v_accvgpr_read_b32 v235, a33
MV 148,v,32,v,52
ds_read_b128 v[76:79], v225 offset:6144
v_accvgpr_read_b32 v236, a34
MV 164,v,36,v,52
buffer_load_dwordx4 v210, s[44:47], s75 offen offset:2048 lds
v_accvgpr_read_b32 v237, a35
MV 152,v,32,v,56
v_accvgpr_read_b32 v238, a36
MV 168,v,36,v,56
v_accvgpr_read_b32 v239, a37
MV 156,v,32,v,60
TR 32,220,24576
TR 34,220,25600
MV 172,v,36,v,60
TR 36,221,24576
TR 38,221,25600
s_waitcnt lgkmcnt(15)
MV 188,v,40,v,60
buffer_load_dwordx4 v211, s[44:47], s75 offen offset:3072 lds
v_accvgpr_read_b32 v240, a38
MV 204,v,44,v,60
s_add_u32 s74, s74, 128
v_accvgpr_read_b32 v241, a39
MV 184,v,40,v,56
v_cvt_pk_bf16_f32 v230, v234, v235
MV 200,v,44,v,56
v_cvt_pk_bf16_f32 v231, v236, v237
MV 180,v,40,v,52
s_and_b32 s74, s74, 2047
v_cvt_pk_bf16_f32 v232, v238, v239
MV 196,v,44,v,52
MV 176,v,40,v,48
TR 40,222,24576
TR 42,222,25600
MV 192,v,44,v,48
TR 44,223,24576
TR 46,223,25600
s_waitcnt lgkmcnt(4)
MV 80,v,16,v,64
v_cvt_pk_bf16_f32 v233, v240, v241
MV 96,v,20,v,64
s_add_u32 s24, s24, 4096
MV 84,v,16,v,68
buffer_store_dwordx4 v[230:233], v228, s[16:19], s24 offen offset:0 sc1
MV 100,v,20,v,68
MV 88,v,16,v,72
v_accvgpr_read_b32 v246, a40
MV 104,v,20,v,72
v_accvgpr_read_b32 v247, a41
MV 92,v,16,v,76
MV 108,v,20,v,76
s_waitcnt vmcnt(17) lgkmcnt(0)
s_barrier
MV 124,v,24,v,76
TR 16,216,32768
TR 18,216,33792
MV 140,v,28,v,76
ds_read_b128 v[48:51], v224 offset:32768
s_add_u32 m0, s68, 114688
MV 120,v,24,v,72
TR 20,217,32768
TR 22,217,33792
MV 136,v,28,v,72
buffer_load_dwordx4 v212, s[48:51], s66 offen offset:0 lds
v_accvgpr_read_b32 v248, a42
MV 116,v,24,v,68
ds_read_b128 v[52:55], v224 offset:34816
buffer_load_dwordx4 v213, s[48:51], s66 offen offset:1024 lds
MV 132,v,28,v,68
v_accvgpr_read_b32 v249, a43
v_accvgpr_read_b32 v250, a44
MV 112,v,24,v,64
TR 24,218,32768
TR 26,218,33792
MV 128,v,28,v,64
TR 28,219,32768
TR 30,219,33792
MV 144,v,32,v,64
ds_read_b128 v[56:59], v224 offset:36864
buffer_load_dwordx4 v214, s[48:51], s66 offen offset:2048 lds
MV 160,v,36,v,64
buffer_load_dwordx4 v215, s[48:51], s66 offen offset:3072 lds
v_accvgpr_read_b32 v251, a45
MV 148,v,32,v,68
v_accvgpr_read_b32 v252, a46
v_accvgpr_read_b32 v253, a47
MV 164,v,36,v,68
s_add_u32 s66, s66, 524288
v_cvt_pk_bf16_f32 v242, v246, v247
MV 152,v,32,v,72
ds_read_b128 v[60:63], v224 offset:38912
v_cvt_pk_bf16_f32 v243, v248, v249
MV 168,v,36,v,72
s_and_b32 s66, s66, 8388607
v_cvt_pk_bf16_f32 v244, v250, v251
MV 156,v,32,v,76
TR 32,220,32768
TR 34,220,33792
MV 172,v,36,v,76
TR 36,221,32768
TR 38,221,33792
MV 188,v,40,v,76
s_add_u32 s75, s64, s74
v_cvt_pk_bf16_f32 v245, v252, v253
MV 204,v,44,v,76
buffer_store_dwordx4 v[242:245], v228, s[16:19], s24 offen offset:1024 sc1
v_accvgpr_read_b32 v234, a48
MV 184,v,40,v,72
s_add_u32 m0, s67, 0
v_accvgpr_read_b32 v235, a49
MV 200,v,44,v,72
v_accvgpr_read_b32 v236, a50
v_accvgpr_read_b32 v237, a51
MV 180,v,40,v,68
buffer_load_dwordx4 v208, s[44:47], s75 offen offset:0 lds
v_accvgpr_read_b32 v238, a52
MV 196,v,44,v,68
MV 176,v,40,v,64
TR 40,222,32768
TR 42,222,33792
MV 192,v,44,v,64
TR 44,223,32768
TR 46,223,33792
s_waitcnt lgkmcnt(4)
MV 80,v,16,v,48
buffer_load_dwordx4 v209, s[44:47], s75 offen offset:1024 lds
v_accvgpr_read_b32 v239, a53
MV 96,v,20,v,48
ds_read_b128 v[64:67], v225 offset:32768
v_accvgpr_read_b32 v240, a54
MV 84,v,16,v,52
buffer_load_dwordx4 v210, s[44:47], s75 offen offset:2048 lds
v_accvgpr_read_b32 v241, a55
MV 100,v,20,v,52
MV 88,v,16,v,56
v_cvt_pk_bf16_f32 v230, v234, v235
MV 104,v,20,v,56
buffer_load_dwordx4 v211, s[44:47], s75 offen offset:3072 lds
v_cvt_pk_bf16_f32 v231, v236, v237
MV 92,v,16,v,60
TR 16,216,40960
TR 18,216,41984
MV 108,v,20,v,60
TR 20,217,40960
TR 22,217,41984
MV 124,v,24,v,60
ds_read_b128 v[68:71], v225 offset:34816
s_add_u32 s75, s65, s74
MV 140,v,28,v,60
v_cvt_pk_bf16_f32 v232, v238, v239
v_cvt_pk_bf16_f32 v233, v240, v241
MV 120,v,24,v,56
buffer_store_dwordx4 v[230:233], v228, s[16:19], s24 offen offset:2048 sc1
MV 136,v,28,v,56
s_add_u32 m0, s67, 4096
v_accvgpr_read_b32 v246, a56
MV 116,v,24,v,52
ds_read_b128 v[72:75], v225 offset:36864
v_accvgpr_read_b32 v247, a57
MV 132,v,28,v,52
MV 112,v,24,v,48
TR 24,218,40960
TR 26,218,41984
MV 128,v,28,v,48
TR 28,219,40960
TR 30,219,41984
MV 144,v,32,v,48
buffer_load_dwordx4 v208, s[44:47], s75 offen offset:0 lds
buffer_load_dwordx4 v209, s[44:47], s75 offen offset:1024 lds
MV 160,v,36,v,48
v_accvgpr_read_b32 v248, a58
v_accvgpr_read_b32 v249, a59
MV 148,v,32,v,52
ds_read_b128 v[76:79], v225 offset:38912
v_accvgpr_read_b32 v250, a60
MV 164,v,36,v,52
buffer_load_dwordx4 v210, s[44:47], s75 offen offset:2048 lds
v_accvgpr_read_b32 v251, a61
MV 152,v,32,v,56
v_accvgpr_read_b32 v252, a62
MV 168,v,36,v,56
v_accvgpr_read_b32 v253, a63
MV 156,v,32,v,60
TR 32,220,40960
TR 34,220,41984
MV 172,v,36,v,60
TR 36,221,40960
TR 38,221,41984
s_waitcnt lgkmcnt(15)
MV 188,v,40,v,60
buffer_load_dwordx4 v211, s[44:47], s75 offen offset:3072 lds
v_cvt_pk_bf16_f32 v242, v246, v247
MV 204,v,44,v,60
s_add_u32 s74, s74, 128
v_cvt_pk_bf16_f32 v243, v248, v249
MV 184,v,40,v,56
v_cvt_pk_bf16_f32 v244, v250, v251
MV 200,v,44,v,56
v_cvt_pk_bf16_f32 v245, v252, v253
MV 180,v,40,v,52
s_and_b32 s74, s74, 2047
buffer_store_dwordx4 v[242:245], v228, s[16:19], s24 offen offset:3072 sc1
MV 196,v,44,v,52
MV 176,v,40,v,48
TR 40,222,40960
TR 42,222,41984
MV 192,v,44,v,48
TR 44,223,40960
TR 46,223,41984
s_waitcnt lgkmcnt(4)
MV 80,v,16,v,64
v_accvgpr_read_b32 v234, a64
MV 96,v,20,v,64
v_accvgpr_read_b32 v235, a65
MV 84,v,16,v,68
v_accvgpr_read_b32 v236, a66
MV 100,v,20,v,68
MV 88,v,16,v,72
v_accvgpr_read_b32 v237, a67
MV 104,v,20,v,72
v_accvgpr_read_b32 v238, a68
MV 92,v,16,v,76
MV 108,v,20,v,76
s_waitcnt vmcnt(16) lgkmcnt(0)
s_barrier
MV 124,v,24,v,76
TR 16,216,0
TR 18,216,1024
MV 140,v,28,v,76
ds_read_b128 v[48:51], v226 offset:0
s_add_u32 m0, s68, 131072
MV 120,v,24,v,72
TR 20,217,0
TR 22,217,1024
MV 136,v,28,v,72
buffer_load_dwordx4 v212, s[48:51], s66 offen offset:0 lds
v_accvgpr_read_b32 v239, a69
MV 116,v,24,v,68
ds_read_b128 v[52:55], v226 offset:2048
buffer_load_dwordx4 v213, s[48:51], s66 offen offset:1024 lds
MV 132,v,28,v,68
v_accvgpr_read_b32 v240, a70
v_accvgpr_read_b32 v241, a71
MV 112,v,24,v,64
TR 24,218,0
TR 26,218,1024
MV 128,v,28,v,64
TR 28,219,0
TR 30,219,1024
MV 144,v,32,v,64
ds_read_b128 v[56:59], v226 offset:4096
buffer_load_dwordx4 v214, s[48:51], s66 offen offset:2048 lds
MV 160,v,36,v,64
buffer_load_dwordx4 v215, s[48:51], s66 offen offset:3072 lds
v_cvt_pk_bf16_f32 v230, v234, v235
MV 148,v,32,v,68
v_cvt_pk_bf16_f32 v231, v236, v237
v_cvt_pk_bf16_f32 v232, v238, v239
MV 164,v,36,v,68
s_add_u32 s66, s66, 524288
v_cvt_pk_bf16_f32 v233, v240, v241
MV 152,v,32,v,72
ds_read_b128 v[60:63], v226 offset:6144
s_add_u32 s24, s24, 4096
MV 168,v,36,v,72
s_and_b32 s66, s66, 8388607
buffer_store_dwordx4 v[230:233], v228, s[16:19], s24 offen offset:0 sc1
MV 156,v,32,v,76
TR 32,220,0
TR 34,220,1024
MV 172,v,36,v,76
TR 36,221,0
TR 38,221,1024
MV 188,v,40,v,76
s_add_u32 s75, s64, s74
v_accvgpr_read_b32 v246, a72
MV 204,v,44,v,76
v_accvgpr_read_b32 v247, a73
v_accvgpr_read_b32 v248, a74
MV 184,v,40,v,72
s_add_u32 m0, s67, 32768
v_accvgpr_read_b32 v249, a75
MV 200,v,44,v,72
v_accvgpr_read_b32 v250, a76
v_accvgpr_read_b32 v251, a77
MV 180,v,40,v,68
buffer_load_dwordx4 v208, s[44:47], s75 offen offset:0 lds
v_accvgpr_read_b32 v252, a78
MV 196,v,44,v,68
MV 176,v,40,v,64
TR 40,222,0
TR 42,222,1024
MV 192,v,44,v,64
TR 44,223,0
TR 46,223,1024
s_waitcnt lgkmcnt(4)
MV 80,v,16,v,48
buffer_load_dwordx4 v209, s[44:47], s75 offen offset:1024 lds
v_accvgpr_read_b32 v253, a79
MV 96,v,20,v,48
ds_read_b128 v[64:67], v227 offset:0
v_cvt_pk_bf16_f32 v242, v246, v247
MV 84,v,16,v,52
buffer_load_dwordx4 v210, s[44:47], s75 offen offset:2048 lds
v_cvt_pk_bf16_f32 v243, v248, v249
MV 100,v,20,v,52
MV 88,v,16,v,56
v_cvt_pk_bf16_f32 v244, v250, v251
MV 104,v,20,v,56
buffer_load_dwordx4 v211, s[44:47], s75 offen offset:3072 lds
v_cvt_pk_bf16_f32 v245, v252, v253
MV 92,v,16,v,60
TR 16,216,8192
TR 18,216,9216
MV 108,v,20,v,60
TR 20,217,8192
TR 22,217,9216
MV 124,v,24,v,60
ds_read_b128 v[68:71], v227 offset:2048
s_add_u32 s75, s65, s74
MV 140,v,28,v,60
buffer_store_dwordx4 v[242:245], v228, s[16:19], s24 offen offset:1024 sc1
v_accvgpr_read_b32 v234, a80
MV 120,v,24,v,56
v_accvgpr_read_b32 v235, a81
v_accvgpr_read_b32 v236, a82
MV 136,v,28,v,56
s_add_u32 m0, s67, 36864
MV 116,v,24,v,52
ds_read_b128 v[72:75], v227 offset:4096
v_accvgpr_read_b32 v237, a83
MV 132,v,28,v,52
v_accvgpr_read_b32 v238, a84
MV 112,v,24,v,48
TR 24,218,8192
TR 26,218,9216
MV 128,v,28,v,48
TR 28,219,8192
TR 30,219,9216
MV 144,v,32,v,48
buffer_load_dwordx4 v208, s[44:47], s75 offen offset:0 lds
buffer_load_dwordx4 v209, s[44:47], s75 offen offset:1024 lds
MV 160,v,36,v,48
v_accvgpr_read_b32 v239, a85
v_accvgpr_read_b32 v240, a86
MV 148,v,32,v,52
ds_read_b128 v[76:79], v227 offset:6144
v_accvgpr_read_b32 v241, a87
MV 164,v,36,v,52
buffer_load_dwordx4 v210, s[44:47], s75 offen offset:2048 lds
v_cvt_pk_bf16_f32 v230, v234, v235
MV 152,v,32,v,56
v_cvt_pk_bf16_f32 v231, v236, v237
MV 168,v,36,v,56
v_cvt_pk_bf16_f32 v232, v238, v239
MV 156,v,32,v,60
TR 32,220,8192
TR 34,220,9216
MV 172,v,36,v,60
TR 36,221,8192
TR 38,221,9216
s_waitcnt lgkmcnt(15)
MV 188,v,40,v,60
buffer_load_dwordx4 v211, s[44:47], s75 offen offset:3072 lds
v_cvt_pk_bf16_f32 v233, v240, v241
MV 204,v,44,v,60
s_add_u32 s74, s74, 128
buffer_store_dwordx4 v[230:233], v228, s[16:19], s24 offen offset:2048 sc1
MV 184,v,40,v,56
v_accvgpr_read_b32 v246, a88
MV 200,v,44,v,56
v_accvgpr_read_b32 v247, a89
MV 180,v,40,v,52
s_and_b32 s74, s74, 2047
v_accvgpr_read_b32 v248, a90
MV 196,v,44,v,52
MV 176,v,40,v,48
TR 40,222,8192
TR 42,222,9216
MV 192,v,44,v,48
TR 44,223,8192
TR 46,223,9216
s_waitcnt lgkmcnt(4)
MV 80,v,16,v,64
v_accvgpr_read_b32 v249, a91
MV 96,v,20,v,64
v_accvgpr_read_b32 v250, a92
MV 84,v,16,v,68
v_accvgpr_read_b32 v251, a93
MV 100,v,20,v,68
MV 88,v,16,v,72
v_accvgpr_read_b32 v252, a94
MV 104,v,20,v,72
v_accvgpr_read_b32 v253, a95
MV 92,v,16,v,76
MV 108,v,20,v,76
s_waitcnt vmcnt(16) lgkmcnt(0)
s_barrier
MV 124,v,24,v,76
TR 16,216,16384
TR 18,216,17408
MV 140,v,28,v,76
ds_read_b128 v[48:51], v224 offset:0
s_add_u32 m0, s68, 98304
MV 120,v,24,v,72
TR 20,217,16384
TR 22,217,17408
MV 136,v,28,v,72
buffer_load_dwordx4 v212, s[48:51], s66 offen offset:0 lds
v_cvt_pk_bf16_f32 v242, v246, v247
MV 116,v,24,v,68
ds_read_b128 v[52:55], v224 offset:2048
buffer_load_dwordx4 v213, s[48:51], s66 offen offset:1024 lds
MV 132,v,28,v,68
v_cvt_pk_bf16_f32 v243, v248, v249
v_cvt_pk_bf16_f32 v244, v250, v251
MV 112,v,24,v,64
TR 24,218,16384
TR 26,218,17408
MV 128,v,28,v,64
TR 28,219,16384
TR 30,219,17408
MV 144,v,32,v,64
ds_read_b128 v[56:59], v224 offset:4096
buffer_load_dwordx4 v214, s[48:51], s66 offen offset:2048 lds
MV 160,v,36,v,64
buffer_load_dwordx4 v215, s[48:51], s66 offen offset:3072 lds
v_cvt_pk_bf16_f32 v245, v252, v253
MV 148,v,32,v,68
buffer_store_dwordx4 v[242:245], v228, s[16:19], s24 offen offset:3072 sc1
v_accvgpr_read_b32 v234, a96
MV 164,v,36,v,68
s_add_u32 s66, s66, 524288
v_accvgpr_read_b32 v235, a97
MV 152,v,32,v,72
ds_read_b128 v[60:63], v224 offset:6144
v_accvgpr_read_b32 v236, a98
MV 168,v,36,v,72
s_and_b32 s66, s66, 8388607
v_accvgpr_read_b32 v237, a99
MV 156,v,32,v,76
TR 32,220,16384
TR 34,220,17408
MV 172,v,36,v,76
TR 36,221,16384
TR 38,221,17408
MV 188,v,40,v,76
s_add_u32 s75, s64, s74
v_accvgpr_read_b32 v238, a100
MV 204,v,44,v,76
v_accvgpr_read_b32 v239, a101
v_accvgpr_read_b32 v240, a102
MV 184,v,40,v,72
s_add_u32 m0, s67, 65536
v_accvgpr_read_b32 v241, a103
MV 200,v,44,v,72
v_cvt_pk_bf16_f32 v230, v234, v235
v_cvt_pk_bf16_f32 v231, v236, v237
MV 180,v,40,v,68
buffer_load_dwordx4 v208, s[44:47], s75 offen offset:0 lds
v_cvt_pk_bf16_f32 v232, v238, v239
MV 196,v,44,v,68
MV 176,v,40,v,64
TR 40,222,16384
TR 42,222,17408
MV 192,v,44,v,64
TR 44,223,16384
TR 46,223,17408
s_waitcnt lgkmcnt(4)
MV 80,v,16,v,48
buffer_load_dwordx4 v209, s[44:47], s75 offen offset:1024 lds
v_cvt_pk_bf16_f32 v233, v240, v241
MV 96,v,20,v,48
ds_read_b128 v[64:67], v225 offset:0
s_add_u32 s24, s24, 4096
MV 84,v,16,v,52
buffer_load_dwordx4 v210, s[44:47], s75 offen offset:2048 lds
buffer_store_dwordx4 v[230:233], v228, s[16:19], s24 offen offset:0 sc1
MV 100,v,20,v,52
MV 88,v,16,v,56
v_accvgpr_read_b32 v246, a104
MV 104,v,20,v,56
buffer_load_dwordx4 v211, s[44:47], s75 offen offset:3072 lds
v_accvgpr_read_b32 v247, a105
MV 92,v,16,v,60
TR 16,216,24576
TR 18,216,25600
MV 108,v,20,v,60
TR 20,217,24576
TR 22,217,25600
MV 124,v,24,v,60
ds_read_b128 v[68:71], v225 offset:2048
s_add_u32 s75, s65, s74
MV 140,v,28,v,60
v_accvgpr_read_b32 v248, a106
v_accvgpr_read_b32 v249, a107
MV 120,v,24,v,56
v_accvgpr_read_b32 v250, a108
MV 136,v,28,v,56
s_add_u32 m0, s67, 69632
v_accvgpr_read_b32 v251, a109
MV 116,v,24,v,52
ds_read_b128 v[72:75], v225 offset:4096
v_accvgpr_read_b32 v252, a110
MV 132,v,28,v,52
MV 112,v,24,v,48
TR 24,218,24576
TR 26,218,25600
MV 128,v,28,v,48
TR 28,219,24576
TR 30,219,25600
MV 144,v,32,v,48
buffer_load_dwordx4 v208, s[44:47], s75 offen offset:0 lds
buffer_load_dwordx4 v209, s[44:47], s75 offen offset:1024 lds
MV 160,v,36,v,48
v_accvgpr_read_b32 v253, a111
v_cvt_pk_bf16_f32 v242, v246, v247
MV 148,v,32,v,52
ds_read_b128 v[76:79], v225 offset:6144
v_cvt_pk_bf16_f32 v243, v248, v249
MV 164,v,36,v,52
buffer_load_dwordx4 v210, s[44:47], s75 offen offset:2048 lds
v_cvt_pk_bf16_f32 v244, v250, v251
MV 152,v,32,v,56
v_cvt_pk_bf16_f32 v245, v252, v253
MV 168,v,36,v,56
buffer_store_dwordx4 v[242:245], v228, s[16:19], s24 offen offset:1024 sc1
MV 156,v,32,v,60
TR 32,220,24576
TR 34,220,25600
MV 172,v,36,v,60
TR 36,221,24576
TR 38,221,25600
s_waitcnt lgkmcnt(15)
MV 188,v,40,v,60
buffer_load_dwordx4 v211, s[44:47], s75 offen offset:3072 lds
v_accvgpr_read_b32 v234, a112
MV 204,v,44,v,60
s_add_u32 s74, s74, 128
v_accvgpr_read_b32 v235, a113
MV 184,v,40,v,56
v_accvgpr_read_b32 v236, a114
MV 200,v,44,v,56
v_accvgpr_read_b32 v237, a115
MV 180,v,40,v,52
s_and_b32 s74, s74, 2047
v_accvgpr_read_b32 v238, a116
MV 196,v,44,v,52
MV 176,v,40,v,48
TR 40,222,24576
TR 42,222,25600
MV 192,v,44,v,48
TR 44,223,24576
TR 46,223,25600
s_waitcnt lgkmcnt(4)
MV 80,v,16,v,64
v_accvgpr_read_b32 v239, a117
MV 96,v,20,v,64
v_accvgpr_read_b32 v240, a118
MV 84,v,16,v,68
v_accvgpr_read_b32 v241, a119
MV 100,v,20,v,68
MV 88,v,16,v,72
v_cvt_pk_bf16_f32 v230, v234, v235
MV 104,v,20,v,72
v_cvt_pk_bf16_f32 v231, v236, v237
MV 92,v,16,v,76
MV 108,v,20,v,76
s_waitcnt vmcnt(16) lgkmcnt(0)
s_barrier
MV 124,v,24,v,76
TR 16,216,32768
TR 18,216,33792
MV 140,v,28,v,76
ds_read_b128 v[48:51], v224 offset:32768
s_add_u32 m0, s68, 114688
MV 120,v,24,v,72
TR 20,217,32768
TR 22,217,33792
MV 136,v,28,v,72
buffer_load_dwordx4 v212, s[48:51], s66 offen offset:0 lds
v_cvt_pk_bf16_f32 v232, v238, v239
MV 116,v,24,v,68
ds_read_b128 v[52:55], v224 offset:34816
buffer_load_dwordx4 v213, s[48:51], s66 offen offset:1024 lds
MV 132,v,28,v,68
v_cvt_pk_bf16_f32 v233, v240, v241
buffer_store_dwordx4 v[230:233], v228, s[16:19], s24 offen offset:2048 sc1
MV 112,v,24,v,64
TR 24,218,32768
TR 26,218,33792
MV 128,v,28,v,64
TR 28,219,32768
TR 30,219,33792
MV 144,v,32,v,64
ds_read_b128 v[56:59], v224 offset:36864
buffer_load_dwordx4 v214, s[48:51], s66 offen offset:2048 lds
MV 160,v,36,v,64
buffer_load_dwordx4 v215, s[48:51], s66 offen offset:3072 lds
v_accvgpr_read_b32 v246, a120
MV 148,v,32,v,68
v_accvgpr_read_b32 v247, a121
v_accvgpr_read_b32 v248, a122
MV 164,v,36,v,68
s_add_u32 s66, s66, 524288
v_accvgpr_read_b32 v249, a123
MV 152,v,32,v,72
ds_read_b128 v[60:63], v224 offset:38912
v_accvgpr_read_b32 v250, a124
MV 168,v,36,v,72
s_and_b32 s66, s66, 8388607
v_accvgpr_read_b32 v251, a125
MV 156,v,32,v,76
TR 32,220,32768
TR 34,220,33792
MV 172,v,36,v,76
TR 36,221,32768
TR 38,221,33792
MV 188,v,40,v,76
s_add_u32 s75, s64, s74
v_accvgpr_read_b32 v252, a126
MV 204,v,44,v,76
v_accvgpr_read_b32 v253, a127
v_cvt_pk_bf16_f32 v242, v246, v247
MV 184,v,40,v,72
s_add_u32 m0, s67, 0
v_cvt_pk_bf16_f32 v243, v248, v249
MV 200,v,44,v,72
v_cvt_pk_bf16_f32 v244, v250, v251
v_cvt_pk_bf16_f32 v245, v252, v253
MV 180,v,40,v,68
buffer_load_dwordx4 v208, s[44:47], s75 offen offset:0 lds
buffer_store_dwordx4 v[242:245], v228, s[16:19], s24 offen offset:3072 sc1
MV 196,v,44,v,68
MV 176,v,40,v,64
TR 40,222,32768
TR 42,222,33792
MV 192,v,44,v,64
TR 44,223,32768
TR 46,223,33792
s_waitcnt lgkmcnt(4)
MV 80,v,16,v,48
buffer_load_dwordx4 v209, s[44:47], s75 offen offset:1024 lds
v_accvgpr_read_b32 v234, a128
MV 96,v,20,v,48
ds_read_b128 v[64:67], v225 offset:32768
v_accvgpr_read_b32 v235, a129
MV 84,v,16,v,52
buffer_load_dwordx4 v210, s[44:47], s75 offen offset:2048 lds
v_accvgpr_read_b32 v236, a130
MV 100,v,20,v,52
MV 88,v,16,v,56
v_accvgpr_read_b32 v237, a131
MV 104,v,20,v,56
buffer_load_dwordx4 v211, s[44:47], s75 offen offset:3072 lds
v_accvgpr_read_b32 v238, a132
MV 92,v,16,v,60
TR 16,216,40960
TR 18,216,41984
MV 108,v,20,v,60
TR 20,217,40960
TR 22,217,41984
MV 124,v,24,v,60
ds_read_b128 v[68:71], v225 offset:34816
s_add_u32 s75, s65, s74
MV 140,v,28,v,60
v_accvgpr_read_b32 v239, a133
v_accvgpr_read_b32 v240, a134
MV 120,v,24,v,56
v_accvgpr_read_b32 v241, a135
MV 136,v,28,v,56
s_add_u32 m0, s67, 4096
v_cvt_pk_bf16_f32 v230, v234, v235
MV 116,v,24,v,52
ds_read_b128 v[72:75], v225 offset:36864
v_cvt_pk_bf16_f32 v231, v236, v237
MV 132,v,28,v,52
MV 112,v,24,v,48
TR 24,218,40960
TR 26,218,41984
MV 128,v,28,v,48
TR 28,219,40960
TR 30,219,41984
MV 144,v,32,v,48
buffer_load_dwordx4 v208, s[44:47], s75 offen offset:0 lds
buffer_load_dwordx4 v209, s[44:47], s75 offen offset:1024 lds
MV 160,v,36,v,48
v_cvt_pk_bf16_f32 v232, v238, v239
v_cvt_pk_bf16_f32 v233, v240, v241
MV 148,v,32,v,52
ds_read_b128 v[76:79], v225 offset:38912
s_add_u32 s24, s24, 4096
MV 164,v,36,v,52
buffer_load_dwordx4 v210, s[44:47], s75 offen offset:2048 lds
buffer_store_dwordx4 v[230:233], v228, s[16:19], s24 offen offset:0 sc1
MV 152,v,32,v,56
v_accvgpr_read_b32 v246, a136
MV 168,v,36,v,56
v_accvgpr_read_b32 v247, a137
MV 156,v,32,v,60
TR 32,220,40960
TR 34,220,41984
MV 172,v,36,v,60
TR 36,221,40960
TR 38,221,41984
s_waitcnt lgkmcnt(15)
MV 188,v,40,v,60
buffer_load_dwordx4 v211, s[44:47], s75 offen offset:3072 lds
v_accvgpr_read_b32 v248, a138
MV 204,v,44,v,60
s_add_u32 s74, s74, 128
v_accvgpr_read_b32 v249, a139
MV 184,v,40,v,56
v_accvgpr_read_b32 v250, a140
MV 200,v,44,v,56
v_accvgpr_read_b32 v251, a141
MV 180,v,40,v,52
s_and_b32 s74, s74, 2047
v_accvgpr_read_b32 v252, a142
MV 196,v,44,v,52
MV 176,v,40,v,48
TR 40,222,40960
TR 42,222,41984
MV 192,v,44,v,48
TR 44,223,40960
TR 46,223,41984
s_waitcnt lgkmcnt(4)
MV 80,v,16,v,64
v_accvgpr_read_b32 v253, a143
MV 96,v,20,v,64
v_cvt_pk_bf16_f32 v242, v246, v247
MV 84,v,16,v,68
v_cvt_pk_bf16_f32 v243, v248, v249
MV 100,v,20,v,68
MV 88,v,16,v,72
v_cvt_pk_bf16_f32 v244, v250, v251
MV 104,v,20,v,72
v_cvt_pk_bf16_f32 v245, v252, v253
MV 92,v,16,v,76
MV 108,v,20,v,76
s_waitcnt vmcnt(15) lgkmcnt(0)
s_barrier
MV 124,v,24,v,76
TR 16,216,0
TR 18,216,1024
MV 140,v,28,v,76
ds_read_b128 v[48:51], v226 offset:0
s_add_u32 m0, s68, 131072
MV 120,v,24,v,72
TR 20,217,0
TR 22,217,1024
MV 136,v,28,v,72
buffer_load_dwordx4 v212, s[48:51], s66 offen offset:0 lds
buffer_store_dwordx4 v[242:245], v228, s[16:19], s24 offen offset:1024 sc1
MV 116,v,24,v,68
ds_read_b128 v[52:55], v226 offset:2048
buffer_load_dwordx4 v213, s[48:51], s66 offen offset:1024 lds
MV 132,v,28,v,68
v_accvgpr_read_b32 v234, a144
v_accvgpr_read_b32 v235, a145
MV 112,v,24,v,64
TR 24,218,0
TR 26,218,1024
MV 128,v,28,v,64
TR 28,219,0
TR 30,219,1024
MV 144,v,32,v,64
ds_read_b128 v[56:59], v226 offset:4096
buffer_load_dwordx4 v214, s[48:51], s66 offen offset:2048 lds
MV 160,v,36,v,64
buffer_load_dwordx4 v215, s[48:51], s66 offen offset:3072 lds
v_accvgpr_read_b32 v236, a146
MV 148,v,32,v,68
v_accvgpr_read_b32 v237, a147
v_accvgpr_read_b32 v238, a148
MV 164,v,36,v,68
s_add_u32 s66, s66, 524288
v_accvgpr_read_b32 v239, a149
MV 152,v,32,v,72
ds_read_b128 v[60:63], v226 offset:6144
v_accvgpr_read_b32 v240, a150
MV 168,v,36,v,72
s_and_b32 s66, s66, 8388607
v_accvgpr_read_b32 v241, a151
MV 156,v,32,v,76
TR 32,220,0
TR 34,220,1024
MV 172,v,36,v,76
TR 36,221,0
TR 38,221,1024
MV 188,v,40,v,76
s_add_u32 s75, s64, s74
v_cvt_pk_bf16_f32 v230, v234, v235
MV 204,v,44,v,76
v_cvt_pk_bf16_f32 v231, v236, v237
v_cvt_pk_bf16_f32 v232, v238, v239
MV 184,v,40,v,72
s_add_u32 m0, s67, 32768
v_cvt_pk_bf16_f32 v233, v240, v241
MV 200,v,44,v,72
buffer_store_dwordx4 v[230:233], v228, s[16:19], s24 offen offset:2048 sc1
v_accvgpr_read_b32 v246, a152
MV 180,v,40,v,68
buffer_load_dwordx4 v208, s[44:47], s75 offen offset:0 lds
v_accvgpr_read_b32 v247, a153
MV 196,v,44,v,68
MV 176,v,40,v,64
TR 40,222,0
TR 42,222,1024
MV 192,v,44,v,64
TR 44,223,0
TR 46,223,1024
s_waitcnt lgkmcnt(4)
MV 80,v,16,v,48
buffer_load_dwordx4 v209, s[44:47], s75 offen offset:1024 lds
v_accvgpr_read_b32 v248, a154
MV 96,v,20,v,48
ds_read_b128 v[64:67], v227 offset:0
v_accvgpr_read_b32 v249, a155
MV 84,v,16,v,52
buffer_load_dwordx4 v210, s[44:47], s75 offen offset:2048 lds
v_accvgpr_read_b32 v250, a156
MV 100,v,20,v,52
MV 88,v,16,v,56
v_accvgpr_read_b32 v251, a157
MV 104,v,20,v,56
buffer_load_dwordx4 v211, s[44:47], s75 offen offset:3072 lds
v_accvgpr_read_b32 v252, a158
MV 92,v,16,v,60
TR 16,216,8192
TR 18,216,9216
MV 108,v,20,v,60
TR 20,217,8192
TR 22,217,9216
MV 124,v,24,v,60
ds_read_b128 v[68:71], v227 offset:2048
s_add_u32 s75, s65, s74
MV 140,v,28,v,60
v_accvgpr_read_b32 v253, a159
v_cvt_pk_bf16_f32 v242, v246, v247
MV 120,v,24,v,56
v_cvt_pk_bf16_f32 v243, v248, v249
MV 136,v,28,v,56
s_add_u32 m0, s67, 36864
v_cvt_pk_bf16_f32 v244, v250, v251
MV 116,v,24,v,52
ds_read_b128 v[72:75], v227 offset:4096
v_cvt_pk_bf16_f32 v245, v252, v253
MV 132,v,28,v,52
MV 112,v,24,v,48
TR 24,218,8192
TR 26,218,9216
MV 128,v,28,v,48
TR 28,219,8192
TR 30,219,9216
MV 144,v,32,v,48
buffer_load_dwordx4 v208, s[44:47], s75 offen offset:0 lds
buffer_load_dwordx4 v209, s[44:47], s75 offen offset:1024 lds
MV 160,v,36,v,48
buffer_store_dwordx4 v[242:245], v228, s[16:19], s24 offen offset:3072 sc1
v_accvgpr_read_b32 v234, a160
MV 148,v,32,v,52
ds_read_b128 v[76:79], v227 offset:6144
v_accvgpr_read_b32 v235, a161
MV 164,v,36,v,52
buffer_load_dwordx4 v210, s[44:47], s75 offen offset:2048 lds
v_accvgpr_read_b32 v236, a162
MV 152,v,32,v,56
v_accvgpr_read_b32 v237, a163
MV 168,v,36,v,56
v_accvgpr_read_b32 v238, a164
MV 156,v,32,v,60
TR 32,220,8192
TR 34,220,9216
MV 172,v,36,v,60
TR 36,221,8192
TR 38,221,9216
s_waitcnt lgkmcnt(15)
MV 188,v,40,v,60
buffer_load_dwordx4 v211, s[44:47], s75 offen offset:3072 lds
v_accvgpr_read_b32 v239, a165
MV 204,v,44,v,60
s_add_u32 s74, s74, 128
v_accvgpr_read_b32 v240, a166
MV 184,v,40,v,56
v_accvgpr_read_b32 v241, a167
MV 200,v,44,v,56
v_cvt_pk_bf16_f32 v230, v234, v235
MV 180,v,40,v,52
s_and_b32 s74, s74, 2047
v_cvt_pk_bf16_f32 v231, v236, v237
MV 196,v,44,v,52
MV 176,v,40,v,48
TR 40,222,8192
TR 42,222,9216
MV 192,v,44,v,48
TR 44,223,8192
TR 46,223,9216
s_waitcnt lgkmcnt(4)
MV 80,v,16,v,64
v_cvt_pk_bf16_f32 v232, v238, v239
MV 96,v,20,v,64
v_cvt_pk_bf16_f32 v233, v240, v241
MV 84,v,16,v,68
s_add_u32 s24, s24, 4096
MV 100,v,20,v,68
MV 88,v,16,v,72
buffer_store_dwordx4 v[230:233], v228, s[16:19], s24 offen offset:0 sc1
MV 104,v,20,v,72
v_accvgpr_read_b32 v246, a168
MV 92,v,16,v,76
v_accvgpr_read_b32 v247, a169
MV 108,v,20,v,76
s_waitcnt vmcnt(16) lgkmcnt(0)
s_barrier
MV 124,v,24,v,76
TR 16,216,16384
TR 18,216,17408
MV 140,v,28,v,76
ds_read_b128 v[48:51], v224 offset:0
s_add_u32 m0, s68, 98304
MV 120,v,24,v,72
TR 20,217,16384
TR 22,217,17408
MV 136,v,28,v,72
buffer_load_dwordx4 v212, s[48:51], s66 offen offset:0 lds
v_accvgpr_read_b32 v248, a170
MV 116,v,24,v,68
ds_read_b128 v[52:55], v224 offset:2048
buffer_load_dwordx4 v213, s[48:51], s66 offen offset:1024 lds
MV 132,v,28,v,68
v_accvgpr_read_b32 v249, a171
v_accvgpr_read_b32 v250, a172
MV 112,v,24,v,64
TR 24,218,16384
TR 26,218,17408
MV 128,v,28,v,64
TR 28,219,16384
TR 30,219,17408
MV 144,v,32,v,64
ds_read_b128 v[56:59], v224 offset:4096
buffer_load_dwordx4 v214, s[48:51], s66 offen offset:2048 lds
MV 160,v,36,v,64
buffer_load_dwordx4 v215, s[48:51], s66 offen offset:3072 lds
v_accvgpr_read_b32 v251, a173
MV 148,v,32,v,68
v_accvgpr_read_b32 v252, a174
v_accvgpr_read_b32 v253, a175
MV 164,v,36,v,68
s_add_u32 s66, s66, 524288
v_cvt_pk_bf16_f32 v242, v246, v247
MV 152,v,32,v,72
ds_read_b128 v[60:63], v224 offset:6144
v_cvt_pk_bf16_f32 v243, v248, v249
MV 168,v,36,v,72
s_and_b32 s66, s66, 8388607
v_cvt_pk_bf16_f32 v244, v250, v251
MV 156,v,32,v,76
TR 32,220,16384
TR 34,220,17408
MV 172,v,36,v,76
TR 36,221,16384
TR 38,221,17408
MV 188,v,40,v,76
s_add_u32 s75, s64, s74
v_cvt_pk_bf16_f32 v245, v252, v253
MV 204,v,44,v,76
buffer_store_dwordx4 v[242:245], v228, s[16:19], s24 offen offset:1024 sc1
v_accvgpr_read_b32 v234, a176
MV 184,v,40,v,72
s_add_u32 m0, s67, 65536
v_accvgpr_read_b32 v235, a177
MV 200,v,44,v,72
v_accvgpr_read_b32 v236, a178
v_accvgpr_read_b32 v237, a179
MV 180,v,40,v,68
buffer_load_dwordx4 v208, s[44:47], s75 offen offset:0 lds
v_accvgpr_read_b32 v238, a180
MV 196,v,44,v,68
MV 176,v,40,v,64
TR 40,222,16384
TR 42,222,17408
MV 192,v,44,v,64
TR 44,223,16384
TR 46,223,17408
s_waitcnt lgkmcnt(4)
MV 80,v,16,v,48
buffer_load_dwordx4 v209, s[44:47], s75 offen offset:1024 lds
v_accvgpr_read_b32 v239, a181
MV 96,v,20,v,48
ds_read_b128 v[64:67], v225 offset:0
v_accvgpr_read_b32 v240, a182
MV 84,v,16,v,52
buffer_load_dwordx4 v210, s[44:47], s75 offen offset:2048 lds
v_accvgpr_read_b32 v241, a183
MV 100,v,20,v,52
MV 88,v,16,v,56
v_cvt_pk_bf16_f32 v230, v234, v235
MV 104,v,20,v,56
buffer_load_dwordx4 v211, s[44:47], s75 offen offset:3072 lds
v_cvt_pk_bf16_f32 v231, v236, v237
MV 92,v,16,v,60
TR 16,216,24576
TR 18,216,25600
MV 108,v,20,v,60
TR 20,217,24576
TR 22,217,25600
MV 124,v,24,v,60
ds_read_b128 v[68:71], v225 offset:2048
s_add_u32 s75, s65, s74
MV 140,v,28,v,60
v_cvt_pk_bf16_f32 v232, v238, v239
v_cvt_pk_bf16_f32 v233, v240, v241
MV 120,v,24,v,56
buffer_store_dwordx4 v[230:233], v228, s[16:19], s24 offen offset:2048 sc1
v_accvgpr_read_b32 v246, a184
MV 136,v,28,v,56
s_add_u32 m0, s67, 69632
MV 116,v,24,v,52
ds_read_b128 v[72:75], v225 offset:4096
v_accvgpr_read_b32 v247, a185
MV 132,v,28,v,52
v_accvgpr_read_b32 v248, a186
MV 112,v,24,v,48
TR 24,218,24576
TR 26,218,25600
MV 128,v,28,v,48
TR 28,219,24576
TR 30,219,25600
MV 144,v,32,v,48
buffer_load_dwordx4 v208, s[44:47], s75 offen offset:0 lds
buffer_load_dwordx4 v209, s[44:47], s75 offen offset:1024 lds
MV 160,v,36,v,48
v_accvgpr_read_b32 v249, a187
v_accvgpr_read_b32 v250, a188
MV 148,v,32,v,52
ds_read_b128 v[76:79], v225 offset:6144
v_accvgpr_read_b32 v251, a189
MV 164,v,36,v,52
buffer_load_dwordx4 v210, s[44:47], s75 offen offset:2048 lds
v_accvgpr_read_b32 v252, a190
MV 152,v,32,v,56
v_accvgpr_read_b32 v253, a191
MV 168,v,36,v,56
v_cvt_pk_bf16_f32 v242, v246, v247
MV 156,v,32,v,60
TR 32,220,24576
TR 34,220,25600
MV 172,v,36,v,60
TR 36,221,24576
TR 38,221,25600
s_waitcnt lgkmcnt(15)
MV 188,v,40,v,60
buffer_load_dwordx4 v211, s[44:47], s75 offen offset:3072 lds
v_cvt_pk_bf16_f32 v243, v248, v249
MV 204,v,44,v,60
s_add_u32 s74, s74, 128
v_cvt_pk_bf16_f32 v244, v250, v251
MV 184,v,40,v,56
v_cvt_pk_bf16_f32 v245, v252, v253
MV 200,v,44,v,56
buffer_store_dwordx4 v[242:245], v228, s[16:19], s24 offen offset:3072 sc1
MV 180,v,40,v,52
s_and_b32 s74, s74, 2047
buffer_load_dword v254, off, s[12:15], 0 sc1
MV 196,v,44,v,52
MV 176,v,40,v,48
TR 40,222,24576
TR 42,222,25600
MV 192,v,44,v,48
TR 44,223,24576
TR 46,223,25600
s_waitcnt lgkmcnt(4)
MV 80,v,16,v,64
v_accvgpr_read_b32 v234, a192
MV 96,v,20,v,64
v_accvgpr_read_b32 v235, a193
MV 84,v,16,v,68
v_accvgpr_read_b32 v236, a194
MV 100,v,20,v,68
MV 88,v,16,v,72
v_accvgpr_read_b32 v237, a195
MV 104,v,20,v,72
v_accvgpr_read_b32 v238, a196
MV 92,v,16,v,76
MV 108,v,20,v,76
s_waitcnt vmcnt(17) lgkmcnt(0)
s_barrier
MV 124,v,24,v,76
TR 16,216,32768
TR 18,216,33792
MV 140,v,28,v,76
ds_read_b128 v[48:51], v224 offset:32768
s_add_u32 m0, s68, 114688
MV 120,v,24,v,72
TR 20,217,32768
TR 22,217,33792
MV 136,v,28,v,72
buffer_load_dwordx4 v212, s[48:51], s66 offen offset:0 lds
v_accvgpr_read_b32 v239, a197
MV 116,v,24,v,68
ds_read_b128 v[52:55], v224 offset:34816
buffer_load_dwordx4 v213, s[48:51], s66 offen offset:1024 lds
MV 132,v,28,v,68
v_accvgpr_read_b32 v240, a198
v_accvgpr_read_b32 v241, a199
MV 112,v,24,v,64
TR 24,218,32768
TR 26,218,33792
MV 128,v,28,v,64
TR 28,219,32768
TR 30,219,33792
MV 144,v,32,v,64
ds_read_b128 v[56:59], v224 offset:36864
buffer_load_dwordx4 v214, s[48:51], s66 offen offset:2048 lds
MV 160,v,36,v,64
buffer_load_dwordx4 v215, s[48:51], s66 offen offset:3072 lds
v_cvt_pk_bf16_f32 v230, v234, v235
MV 148,v,32,v,68
v_cvt_pk_bf16_f32 v231, v236, v237
v_cvt_pk_bf16_f32 v232, v238, v239
MV 164,v,36,v,68
s_add_u32 s66, s66, 524288
v_cvt_pk_bf16_f32 v233, v240, v241
MV 152,v,32,v,72
ds_read_b128 v[60:63], v224 offset:38912
s_add_u32 s24, s24, 4096
MV 168,v,36,v,72
s_and_b32 s66, s66, 8388607
buffer_store_dwordx4 v[230:233], v228, s[16:19], s24 offen offset:0 sc1
MV 156,v,32,v,76
TR 32,220,32768
TR 34,220,33792
MV 172,v,36,v,76
TR 36,221,32768
TR 38,221,33792
MV 188,v,40,v,76
s_add_u32 s75, s64, s74
v_accvgpr_read_b32 v246, a200
MV 204,v,44,v,76
v_accvgpr_read_b32 v247, a201
v_accvgpr_read_b32 v248, a202
MV 184,v,40,v,72
s_add_u32 m0, s67, 0
v_accvgpr_read_b32 v249, a203
MV 200,v,44,v,72
v_accvgpr_read_b32 v250, a204
v_accvgpr_read_b32 v251, a205
MV 180,v,40,v,68
buffer_load_dwordx4 v208, s[44:47], s75 offen offset:0 lds
v_accvgpr_read_b32 v252, a206
MV 196,v,44,v,68
MV 176,v,40,v,64
TR 40,222,32768
TR 42,222,33792
MV 192,v,44,v,64
TR 44,223,32768
TR 46,223,33792
s_waitcnt lgkmcnt(4)
MV 80,v,16,v,48
buffer_load_dwordx4 v209, s[44:47], s75 offen offset:1024 lds
v_accvgpr_read_b32 v253, a207
MV 96,v,20,v,48
ds_read_b128 v[64:67], v225 offset:32768
v_cvt_pk_bf16_f32 v242, v246, v247
MV 84,v,16,v,52
buffer_load_dwordx4 v210, s[44:47], s75 offen offset:2048 lds
v_cvt_pk_bf16_f32 v243, v248, v249
MV 100,v,20,v,52
MV 88,v,16,v,56
v_cvt_pk_bf16_f32 v244, v250, v251
MV 104,v,20,v,56
buffer_load_dwordx4 v211, s[44:47], s75 offen offset:3072 lds
v_cvt_pk_bf16_f32 v245, v252, v253
MV 92,v,16,v,60
TR 16,216,40960
TR 18,216,41984
MV 108,v,20,v,60
TR 20,217,40960
TR 22,217,41984
MV 124,v,24,v,60
ds_read_b128 v[68:71], v225 offset:34816
s_add_u32 s75, s65, s74
MV 140,v,28,v,60
buffer_store_dwordx4 v[242:245], v228, s[16:19], s24 offen offset:1024 sc1
v_accvgpr_read_b32 v234, a208
MV 120,v,24,v,56
v_accvgpr_read_b32 v235, a209
MV 136,v,28,v,56
s_add_u32 m0, s67, 4096
v_accvgpr_read_b32 v236, a210
MV 116,v,24,v,52
ds_read_b128 v[72:75], v225 offset:36864
v_accvgpr_read_b32 v237, a211
MV 132,v,28,v,52
MV 112,v,24,v,48
TR 24,218,40960
TR 26,218,41984
MV 128,v,28,v,48
TR 28,219,40960
TR 30,219,41984
MV 144,v,32,v,48
buffer_load_dwordx4 v208, s[44:47], s75 offen offset:0 lds
buffer_load_dwordx4 v209, s[44:47], s75 offen offset:1024 lds
MV 160,v,36,v,48
v_accvgpr_read_b32 v238, a212
v_accvgpr_read_b32 v239, a213
MV 148,v,32,v,52
ds_read_b128 v[76:79], v225 offset:38912
v_accvgpr_read_b32 v240, a214
MV 164,v,36,v,52
buffer_load_dwordx4 v210, s[44:47], s75 offen offset:2048 lds
v_accvgpr_read_b32 v241, a215
MV 152,v,32,v,56
v_cvt_pk_bf16_f32 v230, v234, v235
MV 168,v,36,v,56
v_cvt_pk_bf16_f32 v231, v236, v237
MV 156,v,32,v,60
TR 32,220,40960
TR 34,220,41984
MV 172,v,36,v,60
TR 36,221,40960
TR 38,221,41984
s_waitcnt lgkmcnt(15)
MV 188,v,40,v,60
buffer_load_dwordx4 v211, s[44:47], s75 offen offset:3072 lds
v_cvt_pk_bf16_f32 v232, v238, v239
MV 204,v,44,v,60
s_add_u32 s74, s74, 128
v_cvt_pk_bf16_f32 v233, v240, v241
MV 184,v,40,v,56
buffer_store_dwordx4 v[230:233], v228, s[16:19], s24 offen offset:2048 sc1
MV 200,v,44,v,56
v_accvgpr_read_b32 v246, a216
MV 180,v,40,v,52
s_and_b32 s74, s74, 2047
v_accvgpr_read_b32 v247, a217
MV 196,v,44,v,52
MV 176,v,40,v,48
TR 40,222,40960
TR 42,222,41984
MV 192,v,44,v,48
TR 44,223,40960
TR 46,223,41984
s_waitcnt lgkmcnt(4)
MV 80,v,16,v,64
v_accvgpr_read_b32 v248, a218
MV 96,v,20,v,64
v_accvgpr_read_b32 v249, a219
MV 84,v,16,v,68
v_accvgpr_read_b32 v250, a220
MV 100,v,20,v,68
MV 88,v,16,v,72
v_accvgpr_read_b32 v251, a221
MV 104,v,20,v,72
v_accvgpr_read_b32 v252, a222
MV 92,v,16,v,76
MV 108,v,20,v,76
s_waitcnt vmcnt(17) lgkmcnt(0)
s_barrier
MV 124,v,24,v,76
TR 16,216,0
TR 18,216,1024
MV 140,v,28,v,76
ds_read_b128 v[48:51], v226 offset:0
s_add_u32 m0, s68, 131072
MV 120,v,24,v,72
TR 20,217,0
TR 22,217,1024
MV 136,v,28,v,72
buffer_load_dwordx4 v212, s[48:51], s66 offen offset:0 lds
v_accvgpr_read_b32 v253, a223
MV 116,v,24,v,68
ds_read_b128 v[52:55], v226 offset:2048
buffer_load_dwordx4 v213, s[48:51], s66 offen offset:1024 lds
MV 132,v,28,v,68
v_cvt_pk_bf16_f32 v242, v246, v247
v_cvt_pk_bf16_f32 v243, v248, v249
MV 112,v,24,v,64
TR 24,218,0
TR 26,218,1024
MV 128,v,28,v,64
TR 28,219,0
TR 30,219,1024
MV 144,v,32,v,64
ds_read_b128 v[56:59], v226 offset:4096
buffer_load_dwordx4 v214, s[48:51], s66 offen offset:2048 lds
MV 160,v,36,v,64
buffer_load_dwordx4 v215, s[48:51], s66 offen offset:3072 lds
v_cvt_pk_bf16_f32 v244, v250, v251
MV 148,v,32,v,68
v_cvt_pk_bf16_f32 v245, v252, v253
buffer_store_dwordx4 v[242:245], v228, s[16:19], s24 offen offset:3072 sc1
MV 164,v,36,v,68
s_add_u32 s66, s66, 524288
v_accvgpr_read_b32 v234, a224
MV 152,v,32,v,72
ds_read_b128 v[60:63], v226 offset:6144
v_accvgpr_read_b32 v235, a225
MV 168,v,36,v,72
s_and_b32 s66, s66, 8388607
v_accvgpr_read_b32 v236, a226
MV 156,v,32,v,76
TR 32,220,0
TR 34,220,1024
MV 172,v,36,v,76
TR 36,221,0
TR 38,221,1024
MV 188,v,40,v,76
s_add_u32 s75, s64, s74
v_accvgpr_read_b32 v237, a227
MV 204,v,44,v,76
v_accvgpr_read_b32 v238, a228
v_accvgpr_read_b32 v239, a229
MV 184,v,40,v,72
s_add_u32 m0, s67, 32768
v_accvgpr_read_b32 v240, a230
MV 200,v,44,v,72
v_accvgpr_read_b32 v241, a231
v_cvt_pk_bf16_f32 v230, v234, v235
MV 180,v,40,v,68
buffer_load_dwordx4 v208, s[44:47], s75 offen offset:0 lds
v_cvt_pk_bf16_f32 v231, v236, v237
MV 196,v,44,v,68
MV 176,v,40,v,64
TR 40,222,0
TR 42,222,1024
MV 192,v,44,v,64
TR 44,223,0
TR 46,223,1024
s_waitcnt lgkmcnt(4)
MV 80,v,16,v,48
buffer_load_dwordx4 v209, s[44:47], s75 offen offset:1024 lds
v_cvt_pk_bf16_f32 v232, v238, v239
MV 96,v,20,v,48
ds_read_b128 v[64:67], v227 offset:0
v_cvt_pk_bf16_f32 v233, v240, v241
MV 84,v,16,v,52
buffer_load_dwordx4 v210, s[44:47], s75 offen offset:2048 lds
s_add_u32 s24, s24, 4096
MV 100,v,20,v,52
MV 88,v,16,v,56
buffer_store_dwordx4 v[230:233], v228, s[16:19], s24 offen offset:0 sc1
MV 104,v,20,v,56
buffer_load_dwordx4 v211, s[44:47], s75 offen offset:3072 lds
v_accvgpr_read_b32 v246, a232
MV 92,v,16,v,60
TR 16,216,8192
TR 18,216,9216
MV 108,v,20,v,60
TR 20,217,8192
TR 22,217,9216
MV 124,v,24,v,60
ds_read_b128 v[68:71], v227 offset:2048
s_add_u32 s75, s65, s74
MV 140,v,28,v,60
v_accvgpr_read_b32 v247, a233
v_accvgpr_read_b32 v248, a234
MV 120,v,24,v,56
v_accvgpr_read_b32 v249, a235
MV 136,v,28,v,56
s_add_u32 m0, s67, 36864
v_accvgpr_read_b32 v250, a236
MV 116,v,24,v,52
ds_read_b128 v[72:75], v227 offset:4096
v_accvgpr_read_b32 v251, a237
MV 132,v,28,v,52
MV 112,v,24,v,48
TR 24,218,8192
TR 26,218,9216
MV 128,v,28,v,48
TR 28,219,8192
TR 30,219,9216
MV 144,v,32,v,48
buffer_load_dwordx4 v208, s[44:47], s75 offen offset:0 lds
buffer_load_dwordx4 v209, s[44:47], s75 offen offset:1024 lds
MV 160,v,36,v,48
v_accvgpr_read_b32 v252, a238
v_accvgpr_read_b32 v253, a239
MV 148,v,32,v,52
ds_read_b128 v[76:79], v227 offset:6144
v_cvt_pk_bf16_f32 v242, v246, v247
MV 164,v,36,v,52
buffer_load_dwordx4 v210, s[44:47], s75 offen offset:2048 lds
v_cvt_pk_bf16_f32 v243, v248, v249
MV 152,v,32,v,56
v_cvt_pk_bf16_f32 v244, v250, v251
MV 168,v,36,v,56
v_cvt_pk_bf16_f32 v245, v252, v253
MV 156,v,32,v,60
TR 32,220,8192
TR 34,220,9216
MV 172,v,36,v,60
TR 36,221,8192
TR 38,221,9216
s_waitcnt lgkmcnt(15)
MV 188,v,40,v,60
buffer_load_dwordx4 v211, s[44:47], s75 offen offset:3072 lds
buffer_store_dwordx4 v[242:245], v228, s[16:19], s24 offen offset:1024 sc1
MV 204,v,44,v,60
s_add_u32 s74, s74, 128
v_accvgpr_read_b32 v234, a240
MV 184,v,40,v,56
v_accvgpr_read_b32 v235, a241
MV 200,v,44,v,56
v_accvgpr_read_b32 v236, a242
MV 180,v,40,v,52
s_and_b32 s74, s74, 2047
v_accvgpr_read_b32 v237, a243
MV 196,v,44,v,52
MV 176,v,40,v,48
TR 40,222,8192
TR 42,222,9216
MV 192,v,44,v,48
TR 44,223,8192
TR 46,223,9216
s_waitcnt lgkmcnt(4)
MV 80,v,16,v,64
v_accvgpr_read_b32 v238, a244
MV 96,v,20,v,64
v_accvgpr_read_b32 v239, a245
MV 84,v,16,v,68
v_accvgpr_read_b32 v240, a246
MV 100,v,20,v,68
MV 88,v,16,v,72
v_accvgpr_read_b32 v241, a247
MV 104,v,20,v,72
v_cvt_pk_bf16_f32 v230, v234, v235
MV 92,v,16,v,76
v_cvt_pk_bf16_f32 v231, v236, v237
MV 108,v,20,v,76
s_waitcnt vmcnt(16) lgkmcnt(0)
s_barrier
MV 124,v,24,v,76
TR 16,216,16384
TR 18,216,17408
MV 140,v,28,v,76
ds_read_b128 v[48:51], v224 offset:0
s_add_u32 m0, s68, 98304
MV 120,v,24,v,72
TR 20,217,16384
TR 22,217,17408
MV 136,v,28,v,72
buffer_load_dwordx4 v212, s[48:51], s66 offen offset:0 lds
v_cvt_pk_bf16_f32 v232, v238, v239
MV 116,v,24,v,68
ds_read_b128 v[52:55], v224 offset:2048
buffer_load_dwordx4 v213, s[48:51], s66 offen offset:1024 lds
MV 132,v,28,v,68
v_cvt_pk_bf16_f32 v233, v240, v241
buffer_store_dwordx4 v[230:233], v228, s[16:19], s24 offen offset:2048 sc1
MV 112,v,24,v,64
TR 24,218,16384
TR 26,218,17408
MV 128,v,28,v,64
TR 28,219,16384
TR 30,219,17408
MV 144,v,32,v,64
ds_read_b128 v[56:59], v224 offset:4096
buffer_load_dwordx4 v214, s[48:51], s66 offen offset:2048 lds
MV 160,v,36,v,64
buffer_load_dwordx4 v215, s[48:51], s66 offen offset:3072 lds
v_accvgpr_read_b32 v246, a248
MV 148,v,32,v,68
v_accvgpr_read_b32 v247, a249
v_accvgpr_read_b32 v248, a250
MV 164,v,36,v,68
s_add_u32 s66, s66, 524288
v_accvgpr_read_b32 v249, a251
MV 152,v,32,v,72
ds_read_b128 v[60:63], v224 offset:6144
v_accvgpr_read_b32 v250, a252
MV 168,v,36,v,72
s_and_b32 s66, s66, 8388607
v_accvgpr_read_b32 v251, a253
MV 156,v,32,v,76
TR 32,220,16384
TR 34,220,17408
MV 172,v,36,v,76
TR 36,221,16384
TR 38,221,17408
MV 188,v,40,v,76
s_add_u32 s75, s64, s74
v_accvgpr_read_b32 v252, a254
MV 204,v,44,v,76
v_accvgpr_read_b32 v253, a255
v_cvt_pk_bf16_f32 v242, v246, v247
MV 184,v,40,v,72
s_add_u32 m0, s67, 65536
v_cvt_pk_bf16_f32 v243, v248, v249
MV 200,v,44,v,72
v_cvt_pk_bf16_f32 v244, v250, v251
v_cvt_pk_bf16_f32 v245, v252, v253
MV 180,v,40,v,68
buffer_load_dwordx4 v208, s[44:47], s75 offen offset:0 lds
buffer_store_dwordx4 v[242:245], v228, s[16:19], s24 offen offset:3072 sc1
MV 196,v,44,v,68
MV 176,v,40,v,64
TR 40,222,16384
TR 42,222,17408
MV 192,v,44,v,64
TR 44,223,16384
TR 46,223,17408
s_waitcnt lgkmcnt(4)
MV 80,v,16,v,48
buffer_load_dwordx4 v209, s[44:47], s75 offen offset:1024 lds
v_lshlrev_b32 v255, 20, v1
MV 96,v,20,v,48
ds_read_b128 v[64:67], v225 offset:0
MV 84,v,16,v,52
buffer_load_dwordx4 v210, s[44:47], s75 offen offset:2048 lds
MV 100,v,20,v,52
MV 88,v,16,v,56
MV 104,v,20,v,56
buffer_load_dwordx4 v211, s[44:47], s75 offen offset:3072 lds
MV 92,v,16,v,60
TR 16,216,24576
TR 18,216,25600
MV 108,v,20,v,60
TR 20,217,24576
TR 22,217,25600
MV 124,v,24,v,60
ds_read_b128 v[68:71], v225 offset:2048
s_add_u32 s75, s65, s74
MV 140,v,28,v,60
MV 120,v,24,v,56
s_lshl_b32 s36, s3, 26
MV 136,v,28,v,56
s_add_u32 m0, s67, 69632
MV 116,v,24,v,52
ds_read_b128 v[72:75], v225 offset:4096
MV 132,v,28,v,52
MV 112,v,24,v,48
TR 24,218,24576
TR 26,218,25600
MV 128,v,28,v,48
TR 28,219,24576
TR 30,219,25600
MV 144,v,32,v,48
buffer_load_dwordx4 v208, s[44:47], s75 offen offset:0 lds
buffer_load_dwordx4 v209, s[44:47], s75 offen offset:1024 lds
MV 160,v,36,v,48
MV 148,v,32,v,52
ds_read_b128 v[76:79], v225 offset:6144
MV 164,v,36,v,52
buffer_load_dwordx4 v210, s[44:47], s75 offen offset:2048 lds
MV 152,v,32,v,56
v_add_u32 v255, s36, v255
MV 168,v,36,v,56
MV 156,v,32,v,60
TR 32,220,24576
TR 34,220,25600
MV 172,v,36,v,60
TR 36,221,24576
TR 38,221,25600
s_waitcnt lgkmcnt(15)
MV 188,v,40,v,60
buffer_load_dwordx4 v211, s[44:47], s75 offen offset:3072 lds
MV 204,v,44,v,60
s_add_u32 s74, s74, 128
MV 184,v,40,v,56
MV 200,v,44,v,56
MV 180,v,40,v,52
s_and_b32 s74, s74, 2047
MV 196,v,44,v,52
MV 176,v,40,v,48
TR 40,222,24576
TR 42,222,25600
MV 192,v,44,v,48
TR 44,223,24576
TR 46,223,25600
s_waitcnt lgkmcnt(4)
MV 80,v,16,v,64
v_lshlrev_b32 v230, 4, v1
MV 96,v,20,v,64
s_lshl_b32 s80, s3, 12
MV 84,v,16,v,68
MV 100,v,20,v,68
v_add_u32 v12, s80, v230
MV 88,v,16,v,72
MV 104,v,20,v,72
v_add_u32 v10, 0x8000, v230
MV 92,v,16,v,76
MV 108,v,20,v,76
s_waitcnt vmcnt(15) lgkmcnt(0)
s_barrier
MV 124,v,24,v,76
TR 16,216,32768
TR 18,216,33792
MV 140,v,28,v,76
ds_read_b128 v[48:51], v224 offset:32768
s_add_u32 m0, s68, 114688
MV 120,v,24,v,72
TR 20,217,32768
TR 22,217,33792
MV 136,v,28,v,72
buffer_load_dwordx4 v212, s[48:51], s66 offen offset:0 lds
v_add_u32 v11, 0x18000, v230
MV 116,v,24,v,68
ds_read_b128 v[52:55], v224 offset:34816
buffer_load_dwordx4 v213, s[48:51], s66 offen offset:1024 lds
MV 132,v,28,v,68
s_add_u32 s72, s80, 0x8000
s_add_u32 s73, s80, 0x18000
MV 112,v,24,v,64
TR 24,218,32768
TR 26,218,33792
MV 128,v,28,v,64
TR 28,219,32768
TR 30,219,33792
MV 144,v,32,v,64
ds_read_b128 v[56:59], v224 offset:36864
buffer_load_dwordx4 v214, s[48:51], s66 offen offset:2048 lds
MV 160,v,36,v,64
buffer_load_dwordx4 v215, s[48:51], s66 offen offset:3072 lds
v_mov_b32 v15, v230
MV 148,v,32,v,68
v_and_b32 v230, 15, v1
v_lshrrev_b32 v232, 4, v1
MV 164,v,36,v,68
s_add_u32 s66, s66, 524288
v_lshlrev_b32 v232, 2, v232
MV 152,v,32,v,72
ds_read_b128 v[60:63], v224 offset:38912
v_sub_u32 v230, v230, v232
MV 168,v,36,v,72
s_and_b32 s66, s66, 8388607
s_lshl_b32 s81, s3, 4
MV 156,v,32,v,76
TR 32,220,32768
TR 34,220,33792
MV 172,v,36,v,76
TR 36,221,32768
TR 38,221,33792
MV 188,v,40,v,76
s_add_u32 s75, s64, s74
v_add_u32 v13, s81, v230
MV 204,v,44,v,76
s_sub_u32 s81, 112, s81
MV 184,v,40,v,72
s_add_u32 m0, s67, 0
v_add_u32 v239, s81, v230
MV 200,v,44,v,72
MV 180,v,40,v,68
buffer_load_dwordx4 v208, s[44:47], s75 offen offset:0 lds
v_mov_b32 v14, 0xff800000
MV 196,v,44,v,68
MV 176,v,40,v,64
TR 40,222,32768
TR 42,222,33792
MV 192,v,44,v,64
TR 44,223,32768
TR 46,223,33792
s_waitcnt lgkmcnt(4)
MV 80,v,16,v,48
buffer_load_dwordx4 v209, s[44:47], s75 offen offset:1024 lds
s_getpc_b64 s[38:39]
L_ct_a:
MV 96,v,20,v,48
ds_read_b128 v[64:67], v225 offset:32768
MV 84,v,16,v,52
buffer_load_dwordx4 v210, s[44:47], s75 offen offset:2048 lds
MV 100,v,20,v,52
s_add_u32 s38, s38, L_p3_begin - L_ct_a
s_addc_u32 s39, s39, 0
MV 88,v,16,v,56
MV 104,v,20,v,56
buffer_load_dwordx4 v211, s[44:47], s75 offen offset:3072 lds
v_mov_b32 v229, s39
MV 92,v,16,v,60
TR 16,216,40960
TR 18,216,41984
MV 108,v,20,v,60
TR 20,217,40960
TR 22,217,41984
MV 124,v,24,v,60
ds_read_b128 v[68:71], v225 offset:34816
s_add_u32 s75, s65, s74
MV 140,v,28,v,60
v_mov_b32 v228, s38
s_lshr_b32 s38, s2, 3
MV 120,v,24,v,56
s_lshl_b32 s38, s38, 2
MV 136,v,28,v,56
s_add_u32 m0, s67, 4096
s_add_u32 s38, s38, s3
MV 116,v,24,v,52
ds_read_b128 v[72:75], v225 offset:36864
MV 132,v,28,v,52
s_lshl_b32 s38, s38, 7
MV 112,v,24,v,48
TR 24,218,40960
TR 26,218,41984
MV 128,v,28,v,48
TR 28,219,40960
TR 30,219,41984
MV 144,v,32,v,48
buffer_load_dwordx4 v208, s[44:47], s75 offen offset:0 lds
buffer_load_dwordx4 v209, s[44:47], s75 offen offset:1024 lds
MV 160,v,36,v,48
v_and_b32 v238, 3, v1
v_lshlrev_b32 v238, 14, v238
MV 148,v,32,v,52
ds_read_b128 v[76:79], v225 offset:38912
v_add_u32 v238, s38, v238
MV 164,v,36,v,52
buffer_load_dwordx4 v210, s[44:47], s75 offen offset:2048 lds
MV 152,v,32,v,56
v_min_u32 v238, L_p3_s1m_top - L_p3_begin - 4, v238
MV 168,v,36,v,56
v_add_co_u32 v228, vcc, v228, v238
s_nop 1
v_addc_co_u32 v229, vcc, 0, v229, vcc
MV 156,v,32,v,60
TR 32,220,40960
TR 34,220,41984
MV 172,v,36,v,60
TR 36,221,40960
TR 38,221,41984
s_waitcnt lgkmcnt(15)
MV 188,v,40,v,60
buffer_load_dwordx4 v211, s[44:47], s75 offen offset:3072 lds
MV 204,v,44,v,60
s_add_u32 s74, s74, 128
MV 184,v,40,v,56
MV 200,v,44,v,56
MV 180,v,40,v,52
s_and_b32 s74, s74, 2047
global_load_dword v238, v[228:229], off
MV 196,v,44,v,52
MV 176,v,40,v,48
TR 40,222,40960
TR 42,222,41984
MV 192,v,44,v,48
TR 44,223,40960
TR 46,223,41984
s_waitcnt lgkmcnt(4)
MV 80,v,16,v,64
MV 96,v,20,v,64
MV 84,v,16,v,68
MV 100,v,20,v,68
MV 88,v,16,v,72
MV 104,v,20,v,72
MV 92,v,16,v,76
MV 108,v,20,v,76
s_waitcnt vmcnt(13) lgkmcnt(0)
s_barrier
MV 124,v,24,v,76
v_cmp_gt_u32 vcc, 1, v254
s_nop 4
s_cbranch_vccnz L_spin_go
L_spin_go_ret:
v_mov_b32 v254, 1
s_lshl_b32 s36, s2, 2
buffer_store_dword v254, v255, s[8:11], s36 offen offset:0 sc1
s_load_dwordx4 s[32:35], s[0:1], 32
MV 140,v,28,v,76
TR 16,216,0
TR 18,216,1024
MV 120,v,24,v,72
TR 20,217,0
TR 22,217,1024
MV 136,v,28,v,72
ds_read_b128 v[48:51], v226 offset:0
s_add_u32 m0, s68, 131072
MV 116,v,24,v,68
ds_read_b128 v[52:55], v226 offset:2048
buffer_load_dwordx4 v212, s[48:51], s66 offen offset:0 lds
MV 132,v,28,v,68
buffer_load_dwordx4 v213, s[48:51], s66 offen offset:1024 lds
MV 112,v,24,v,64
TR 24,218,0
TR 26,218,1024
MV 128,v,28,v,64
TR 28,219,0
TR 30,219,1024
MV 144,v,32,v,64
ds_read_b128 v[56:59], v226 offset:4096
buffer_load_dwordx4 v214, s[48:51], s66 offen offset:2048 lds
MV 160,v,36,v,64
buffer_load_dwordx4 v215, s[48:51], s66 offen offset:3072 lds
MV 148,v,32,v,68
MV 164,v,36,v,68
s_add_u32 s66, s66, 524288
MV 152,v,32,v,72
ds_read_b128 v[60:63], v226 offset:6144
MV 168,v,36,v,72
s_and_b32 s66, s66, 8388607
MV 156,v,32,v,76
TR 32,220,0
TR 34,220,1024
MV 172,v,36,v,76
TR 36,221,0
TR 38,221,1024
MV 188,v,40,v,76
s_add_u32 s75, s64, s74
MV 204,v,44,v,76
MV 184,v,40,v,72
s_add_u32 m0, s67, 32768
MV 200,v,44,v,72
MV 180,v,40,v,68
buffer_load_dwordx4 v208, s[44:47], s75 offen offset:0 lds
MV 196,v,44,v,68
MV 176,v,40,v,64
TR 40,222,0
TR 42,222,1024
MV 192,v,44,v,64
TR 44,223,0
TR 46,223,1024
s_waitcnt lgkmcnt(4)
MV 80,v,16,v,48
buffer_load_dwordx4 v209, s[44:47], s75 offen offset:1024 lds
s_and_b32 s36, s2, 3
MV 96,v,20,v,48
ds_read_b128 v[64:67], v227 offset:0
s_lshl_b32 s36, s36, 1
MV 84,v,16,v,52
buffer_load_dwordx4 v210, s[44:47], s75 offen offset:2048 lds
s_sub_u32 s43, 14, s36
MV 100,v,20,v,52
s_bitcmp1_b32 s2, 4
s_cselect_b32 s36, s43, s36
MV 88,v,16,v,56
s_bfe_u32 s43, s2, 0x10003
MV 104,v,20,v,56
buffer_load_dwordx4 v211, s[44:47], s75 offen offset:3072 lds
s_add_u32 s36, s36, s43
MV 92,v,16,v,60
TR 16,216,8192
TR 18,216,9216
MV 108,v,20,v,60
TR 20,217,8192
TR 22,217,9216
MV 124,v,24,v,60
ds_read_b128 v[68:71], v227 offset:2048
s_add_u32 s75, s65, s74
MV 140,v,28,v,60
s_bfe_u32 s37, s2, 0x10002
s_lshr_b32 s43, s2, 5
MV 120,v,24,v,56
s_lshl_b32 s43, s43, 1
s_add_u32 s37, s37, s43
MV 136,v,28,v,56
s_add_u32 m0, s67, 36864
v_and_b32 v230, 15, v1
MV 116,v,24,v,52
ds_read_b128 v[72:75], v227 offset:4096
s_lshl_b32 s36, s36, 4
MV 132,v,28,v,52
v_add_u32 v231, s36, v230
s_lshr_b32 s36, s2, 4
MV 112,v,24,v,48
TR 24,218,8192
TR 26,218,9216
MV 128,v,28,v,48
TR 28,219,8192
TR 30,219,9216
MV 144,v,32,v,48
buffer_load_dwordx4 v208, s[44:47], s75 offen offset:0 lds
buffer_load_dwordx4 v209, s[44:47], s75 offen offset:1024 lds
MV 160,v,36,v,48
v_lshl_add_u32 v232, v230, 4, s36
v_and_b32 v233, 7, v1
MV 148,v,32,v,52
ds_read_b128 v[76:79], v227 offset:6144
v_bfe_u32 v234, v1, 3, 1
MV 164,v,36,v,52
buffer_load_dwordx4 v210, s[44:47], s75 offen offset:2048 lds
v_lshlrev_b32 v233, 3, v233
MV 152,v,32,v,56
v_lshl_add_u32 v233, v234, 7, v233
s_bfe_u32 s36, s69, 0x10001
MV 168,v,36,v,56
s_lshl_b32 s36, s36, 6
s_lshr_b32 s37, s69, 2
MV 156,v,32,v,60
TR 32,220,8192
TR 34,220,9216
MV 172,v,36,v,60
TR 36,221,8192
TR 38,221,9216
s_waitcnt lgkmcnt(15)
MV 188,v,40,v,60
buffer_load_dwordx4 v211, s[44:47], s75 offen offset:3072 lds
s_add_u32 s36, s36, s37
MV 204,v,44,v,60
s_add_u32 s74, s74, 128
v_add_u32 v233, s36, v233
MV 184,v,40,v,56
v_lshrrev_b32 v234, 4, v1
MV 200,v,44,v,56
v_cmp_eq_u32 vcc, 1, v234
s_nop 1
v_cndmask_b32 v233, v233, v232, vcc
MV 180,v,40,v,52
s_and_b32 s74, s74, 2047
MV 196,v,44,v,52
v_cmp_eq_u32 vcc, 2, v234
s_nop 1
v_cndmask_b32 v233, v233, v231, vcc
MV 176,v,40,v,48
TR 40,222,8192
TR 42,222,9216
MV 192,v,44,v,48
TR 44,223,8192
TR 46,223,9216
v_lshlrev_b32 v233, 2, v233
s_waitcnt lgkmcnt(4)
MV 80,v,16,v,64
MV 96,v,20,v,64
MV 84,v,16,v,68
MV 100,v,20,v,68
MV 88,v,16,v,72
MV 104,v,20,v,72
MV 92,v,16,v,76
MV 108,v,20,v,76
s_waitcnt vmcnt(14) lgkmcnt(0)
s_barrier
MV 124,v,24,v,76
TR 16,216,16384
TR 18,216,17408
MV 140,v,28,v,76
ds_read_b128 v[48:51], v224 offset:0
s_add_u32 m0, s68, 98304
MV 120,v,24,v,72
TR 20,217,16384
TR 22,217,17408
MV 136,v,28,v,72
buffer_load_dwordx4 v212, s[48:51], s66 offen offset:0 lds
MV 116,v,24,v,68
ds_read_b128 v[52:55], v224 offset:2048
buffer_load_dwordx4 v213, s[48:51], s66 offen offset:1024 lds
MV 132,v,28,v,68
MV 112,v,24,v,64
TR 24,218,16384
TR 26,218,17408
MV 128,v,28,v,64
TR 28,219,16384
TR 30,219,17408
MV 144,v,32,v,64
ds_read_b128 v[56:59], v224 offset:4096
buffer_load_dwordx4 v214, s[48:51], s66 offen offset:2048 lds
MV 160,v,36,v,64
buffer_load_dwordx4 v215, s[48:51], s66 offen offset:3072 lds
MV 148,v,32,v,68
MV 164,v,36,v,68
s_add_u32 s66, s66, 524288
MV 152,v,32,v,72
ds_read_b128 v[60:63], v224 offset:6144
MV 168,v,36,v,72
s_and_b32 s66, s66, 8388607
MV 156,v,32,v,76
TR 32,220,16384
TR 34,220,17408
MV 172,v,36,v,76
TR 36,221,16384
TR 38,221,17408
MV 188,v,40,v,76
s_add_u32 s75, s64, s74
MV 204,v,44,v,76
MV 184,v,40,v,72
s_add_u32 m0, s67, 65536
MV 200,v,44,v,72
MV 180,v,40,v,68
buffer_load_dwordx4 v208, s[44:47], s75 offen offset:0 lds
MV 196,v,44,v,68
MV 176,v,40,v,64
TR 40,222,16384
TR 42,222,17408
MV 192,v,44,v,64
TR 44,223,16384
TR 46,223,17408
s_waitcnt lgkmcnt(4)
MV 80,v,16,v,48
buffer_load_dwordx4 v209, s[44:47], s75 offen offset:1024 lds
s_lshl_b32 s36, s2, 2
MV 96,v,20,v,48
ds_read_b128 v[64:67], v225 offset:0
s_add_u32 s36, s36, s3
MV 84,v,16,v,52
buffer_load_dwordx4 v210, s[44:47], s75 offen offset:2048 lds
s_lshl_b32 s42, s36, 1
MV 100,v,20,v,52
s_lshl_b32 s37, s36, 12
MV 88,v,16,v,56
s_add_u32 s16, s32, s37
s_addc_u32 s17, s33, 0
MV 104,v,20,v,56
buffer_load_dwordx4 v211, s[44:47], s75 offen offset:3072 lds
MV 92,v,16,v,60
TR 16,216,24576
TR 18,216,25600
MV 108,v,20,v,60
TR 20,217,24576
TR 22,217,25600
MV 124,v,24,v,60
ds_read_b128 v[68:71], v225 offset:2048
s_add_u32 s75, s65, s74
MV 140,v,28,v,60
s_mov_b32 s18, 4096
s_mov_b32 s19, 0x20000
MV 120,v,24,v,56
s_add_u32 s37, s37, 50331648
MV 136,v,28,v,56
s_add_u32 m0, s67, 69632
MV 116,v,24,v,52
ds_read_b128 v[72:75], v225 offset:4096
MV 132,v,28,v,52
s_add_u32 s20, s40, s37
s_addc_u32 s21, s41, 0
MV 112,v,24,v,48
TR 24,218,24576
TR 26,218,25600
MV 128,v,28,v,48
TR 28,219,24576
TR 30,219,25600
MV 144,v,32,v,48
buffer_load_dwordx4 v208, s[44:47], s75 offen offset:0 lds
buffer_load_dwordx4 v209, s[44:47], s75 offen offset:1024 lds
MV 160,v,36,v,48
s_mov_b32 s22, 4096
s_mov_b32 s23, 0x20000
MV 148,v,32,v,52
ds_read_b128 v[76:79], v225 offset:6144
s_lshl_b32 s37, s2, 14
MV 164,v,36,v,52
buffer_load_dwordx4 v210, s[44:47], s75 offen offset:2048 lds
s_add_u32 s37, s37, 54525952
MV 152,v,32,v,56
s_add_u32 s24, s40, s37
s_addc_u32 s25, s41, 0
MV 168,v,36,v,56
s_mov_b32 s26, 16384
s_mov_b32 s27, 0x20000
MV 156,v,32,v,60
TR 32,220,24576
TR 34,220,25600
MV 172,v,36,v,60
TR 36,221,24576
TR 38,221,25600
s_waitcnt lgkmcnt(15)
MV 188,v,40,v,60
buffer_load_dwordx4 v211, s[44:47], s75 offen offset:3072 lds
s_mov_b32 s28, s34
MV 204,v,44,v,60
s_add_u32 s74, s74, 128
s_mov_b32 s29, s35
MV 184,v,40,v,56
s_mov_b32 s30, 2048
s_mov_b32 s31, 0x20000
MV 200,v,44,v,56
s_mul_i32 s43, s3, 4608
MV 180,v,40,v,52
s_and_b32 s74, s74, 2047
s_add_u32 s43, s43, 132096
MV 196,v,44,v,52
MV 176,v,40,v,48
TR 40,222,24576
TR 42,222,25600
MV 192,v,44,v,48
TR 44,223,24576
TR 46,223,25600
s_waitcnt lgkmcnt(4)
MV 80,v,16,v,64
MV 96,v,20,v,64
MV 84,v,16,v,68
MV 100,v,20,v,68
MV 88,v,16,v,72
MV 104,v,20,v,72
MV 92,v,16,v,76
MV 108,v,20,v,76
s_waitcnt vmcnt(12) lgkmcnt(0)
s_barrier
MV 124,v,24,v,76
s_load_dwordx2 s[32:33], s[0:1], 88
TR 16,216,32768
MV 140,v,28,v,76
TR 18,216,33792
ds_read_b128 v[48:51], v224 offset:32768
MV 120,v,24,v,72
TR 20,217,32768
TR 22,217,33792
MV 136,v,28,v,72
MV 116,v,24,v,68
ds_read_b128 v[52:55], v224 offset:34816
MV 132,v,28,v,68
MV 112,v,24,v,64
TR 24,218,32768
TR 26,218,33792
MV 128,v,28,v,64
TR 28,219,32768
TR 30,219,33792
MV 144,v,32,v,64
ds_read_b128 v[56:59], v224 offset:36864
MV 160,v,36,v,64
MV 148,v,32,v,68
MV 164,v,36,v,68
MV 152,v,32,v,72
ds_read_b128 v[60:63], v224 offset:38912
MV 168,v,36,v,72
MV 156,v,32,v,76
TR 32,220,32768
TR 34,220,33792
MV 172,v,36,v,76
TR 36,221,32768
TR 38,221,33792
MV 188,v,40,v,76
MV 204,v,44,v,76
MV 184,v,40,v,72
MV 200,v,44,v,72
MV 180,v,40,v,68
MV 196,v,44,v,68
MV 176,v,40,v,64
TR 40,222,32768
TR 42,222,33792
MV 192,v,44,v,64
TR 44,223,32768
TR 46,223,33792
s_waitcnt lgkmcnt(4)
MV 80,v,16,v,48
s_add_u32 s4, s40, 109051904
s_addc_u32 s5, s41, 0
MV 96,v,20,v,48
ds_read_b128 v[64:67], v225 offset:32768
MV 84,v,16,v,52
MV 100,v,20,v,52
MV 88,v,16,v,56
s_mov_b32 s6, 4194304
MV 104,v,20,v,56
MV 92,v,16,v,60
TR 16,216,40960
TR 18,216,41984
MV 108,v,20,v,60
TR 20,217,40960
TR 22,217,41984
MV 124,v,24,v,60
ds_read_b128 v[68:71], v225 offset:34816
s_mov_b32 s7, 0x20000
MV 140,v,28,v,60
s_lshl_b32 s36, s2, 14
MV 120,v,24,v,56
MV 136,v,28,v,56
v_mov_b32 v244, -1
MV 116,v,24,v,52
ds_read_b128 v[72:75], v225 offset:36864
MV 132,v,28,v,52
v_mov_b32 v245, -1
MV 112,v,24,v,48
TR 24,218,40960
TR 26,218,41984
MV 128,v,28,v,48
TR 28,219,40960
TR 30,219,41984
MV 144,v,32,v,48
v_mov_b32 v246, -1
MV 160,v,36,v,48
MV 148,v,32,v,52
ds_read_b128 v[76:79], v225 offset:38912
v_mov_b32 v247, -1
MV 164,v,36,v,52
MV 152,v,32,v,56
buffer_store_dwordx4 v[244:247], v12, s[4:7], s36 offen offset:0 sc1
MV 168,v,36,v,56
MV 156,v,32,v,60
TR 32,220,40960
TR 34,220,41984
MV 172,v,36,v,60
TR 36,221,40960
TR 38,221,41984
s_waitcnt lgkmcnt(15)
MV 188,v,40,v,60
buffer_store_dwordx4 v[244:247], v12, s[4:7], s36 offen offset:1024 sc1
MV 204,v,44,v,60
buffer_store_dwordx4 v[244:247], v12, s[4:7], s36 offen offset:2048 sc1
MV 184,v,40,v,56
MV 200,v,44,v,56
buffer_store_dwordx4 v[244:247], v12, s[4:7], s36 offen offset:3072 sc1
MV 180,v,40,v,52
MV 196,v,44,v,52
MV 176,v,40,v,48
TR 40,222,40960
TR 42,222,41984
MV 192,v,44,v,48
TR 44,223,40960
TR 46,223,41984
s_waitcnt lgkmcnt(4)
MV 80,v,16,v,64
MV 96,v,20,v,64
MV 84,v,16,v,68
MV 100,v,20,v,68
MV 88,v,16,v,72
MV 104,v,20,v,72
MV 92,v,16,v,76
MV 108,v,20,v,76
s_waitcnt vmcnt(4) lgkmcnt(0)
s_barrier
MV 124,v,24,v,76
TR 16,216,0
TR 18,216,1024
MV 140,v,28,v,76
ds_read_b128 v[48:51], v226 offset:0
MV 120,v,24,v,72
TR 20,217,0
TR 22,217,1024
MV 136,v,28,v,72
MV 116,v,24,v,68
ds_read_b128 v[52:55], v226 offset:2048
MV 132,v,28,v,68
MV 112,v,24,v,64
TR 24,218,0
TR 26,218,1024
MV 128,v,28,v,64
TR 28,219,0
TR 30,219,1024
MV 144,v,32,v,64
ds_read_b128 v[56:59], v226 offset:4096
MV 160,v,36,v,64
MV 148,v,32,v,68
MV 164,v,36,v,68
MV 152,v,32,v,72
ds_read_b128 v[60:63], v226 offset:6144
MV 168,v,36,v,72
MV 156,v,32,v,76
TR 32,220,0
TR 34,220,1024
MV 172,v,36,v,76
TR 36,221,0
TR 38,221,1024
MV 188,v,40,v,76
MV 204,v,44,v,76
MV 184,v,40,v,72
MV 200,v,44,v,72
MV 180,v,40,v,68
MV 196,v,44,v,68
MV 176,v,40,v,64
TR 40,222,0
TR 42,222,1024
MV 192,v,44,v,64
TR 44,223,0
TR 46,223,1024
s_waitcnt lgkmcnt(4)
MV 80,v,16,v,48
buffer_load_dword v237, v233, s[8:11], 0 offen offset:0 sc1
MV 96,v,20,v,48
ds_read_b128 v[64:67], v227 offset:0
MV 84,v,16,v,52
s_lshr_b32 s36, s2, 3
MV 100,v,20,v,52
MV 88,v,16,v,56
MV 104,v,20,v,56
s_lshl_b32 s36, s36, 18
MV 92,v,16,v,60
TR 16,216,8192
TR 18,216,9216
MV 108,v,20,v,60
TR 20,217,8192
TR 22,217,9216
MV 124,v,24,v,60
ds_read_b128 v[68:71], v227 offset:2048
s_and_b32 s37, s2, 7
MV 140,v,28,v,60
MV 120,v,24,v,56
s_lshl_b32 s37, s37, 8
MV 136,v,28,v,56
MV 116,v,24,v,52
ds_read_b128 v[72:75], v227 offset:4096
s_add_u32 s36, s36, s37
MV 132,v,28,v,52
MV 112,v,24,v,48
TR 24,218,8192
TR 26,218,9216
MV 128,v,28,v,48
TR 28,219,8192
TR 30,219,9216
MV 144,v,32,v,48
s_lshl_b32 s37, s3, 16
MV 160,v,36,v,48
s_add_u32 s36, s36, s37
MV 148,v,32,v,52
ds_read_b128 v[76:79], v227 offset:6144
MV 164,v,36,v,52
MV 152,v,32,v,56
s_add_u32 s32, s32, s36
s_addc_u32 s33, s33, 0
MV 168,v,36,v,56
MV 156,v,32,v,60
TR 32,220,8192
TR 34,220,9216
MV 172,v,36,v,60
TR 36,221,8192
TR 38,221,9216
s_waitcnt lgkmcnt(15)
MV 188,v,40,v,60
MV 204,v,44,v,60
s_mov_b32 s34, 65536
MV 184,v,40,v,56
MV 200,v,44,v,56
s_mov_b32 s35, 0x20000
MV 180,v,40,v,52
MV 196,v,44,v,52
MV 176,v,40,v,48
TR 40,222,8192
TR 42,222,9216
MV 192,v,44,v,48
TR 44,223,8192
TR 46,223,9216
s_waitcnt vmcnt(0)
v_cmp_gt_u32 vcc, 1, v237
s_nop 4
s_cbranch_vccnz L_spin_f1
L_spin_f1_ret:
s_waitcnt lgkmcnt(4)
MV 80,v,16,v,64
s_add_u32 m0, s68, 16384
MV 96,v,20,v,64
MV 84,v,16,v,68
s_mov_b32 s80, 0
MV 100,v,20,v,68
MV 88,v,16,v,72
MV 104,v,20,v,72
buffer_load_dwordx4 v12, s[52:55], s80 offen offset:0 sc1 lds
MV 92,v,16,v,76
MV 108,v,20,v,76
buffer_load_dwordx4 v12, s[52:55], s80 offen offset:1024 sc1 lds
MV 124,v,24,v,76
MV 140,v,28,v,76
MV 120,v,24,v,72
buffer_load_dwordx4 v12, s[52:55], s80 offen offset:2048 sc1 lds
MV 136,v,28,v,72
MV 116,v,24,v,68
buffer_load_dwordx4 v12, s[52:55], s80 offen offset:3072 sc1 lds
MV 132,v,28,v,68
MV 112,v,24,v,64
MV 128,v,28,v,64
s_add_u32 m0, s68, 32768
MV 144,v,32,v,64
MV 160,v,36,v,64
s_mov_b32 s80, 16384
MV 148,v,32,v,68
MV 164,v,36,v,68
MV 152,v,32,v,72
buffer_load_dwordx4 v12, s[52:55], s80 offen offset:0 sc1 lds
MV 168,v,36,v,72
MV 156,v,32,v,76
buffer_load_dwordx4 v12, s[52:55], s80 offen offset:1024 sc1 lds
MV 172,v,36,v,76
s_waitcnt lgkmcnt(2)
MV 188,v,40,v,76
s_waitcnt lgkmcnt(0)
MV 204,v,44,v,76
buffer_load_dwordx4 v12, s[52:55], s80 offen offset:2048 sc1 lds
MV 184,v,40,v,72
MV 200,v,44,v,72
buffer_load_dwordx4 v12, s[52:55], s80 offen offset:3072 sc1 lds
MV 180,v,40,v,68
MV 196,v,44,v,68
MV 176,v,40,v,64
MV 192,v,44,v,64
L_p3_begin:
s_waitcnt lgkmcnt(0)
s_barrier
s_mov_b32 s82, 0x3e0293ee
s_mov_b32 s83, 0x3e0293ee
v_pk_mul_f32 v[80:81], v[80:81], s[82:83]
v_pk_mul_f32 v[82:83], v[82:83], s[82:83]
v_pk_mul_f32 v[84:85], v[84:85], s[82:83]
v_pk_mul_f32 v[86:87], v[86:87], s[82:83]
v_pk_mul_f32 v[88:89], v[88:89], s[82:83]
v_pk_mul_f32 v[90:91], v[90:91], s[82:83]
v_pk_mul_f32 v[92:93], v[92:93], s[82:83]
v_pk_mul_f32 v[94:95], v[94:95], s[82:83]
v_pk_mul_f32 v[96:97], v[96:97], s[82:83]
v_pk_mul_f32 v[98:99], v[98:99], s[82:83]
v_pk_mul_f32 v[100:101], v[100:101], s[82:83]
v_pk_mul_f32 v[102:103], v[102:103], s[82:83]
s_add_u32 m0, s68, 114688
v_pk_mul_f32 v[104:105], v[104:105], s[82:83]
v_pk_mul_f32 v[106:107], v[106:107], s[82:83]
v_pk_mul_f32 v[108:109], v[108:109], s[82:83]
v_pk_mul_f32 v[110:111], v[110:111], s[82:83]
v_cvt_pk_bf16_f32 v16, v80, v81
v_cvt_pk_bf16_f32 v17, v82, v83
v_cvt_pk_bf16_f32 v18, v96, v97
v_cvt_pk_bf16_f32 v19, v98, v99
v_cvt_pk_bf16_f32 v32, v84, v85
v_cvt_pk_bf16_f32 v33, v86, v87
v_cvt_pk_bf16_f32 v34, v100, v101
v_cvt_pk_bf16_f32 v35, v102, v103
v_cvt_pk_bf16_f32 v48, v88, v89
v_cvt_pk_bf16_f32 v49, v90, v91
v_cvt_pk_bf16_f32 v50, v104, v105
s_mov_b32 s80, 16384
v_cvt_pk_bf16_f32 v51, v106, v107
v_cvt_pk_bf16_f32 v64, v92, v93
v_cvt_pk_bf16_f32 v65, v94, v95
v_cvt_pk_bf16_f32 v66, v108, v109
v_cvt_pk_bf16_f32 v67, v110, v111
v_pk_mul_f32 v[112:113], v[112:113], s[82:83]
v_pk_mul_f32 v[114:115], v[114:115], s[82:83]
v_pk_mul_f32 v[116:117], v[116:117], s[82:83]
v_pk_mul_f32 v[118:119], v[118:119], s[82:83]
v_pk_mul_f32 v[120:121], v[120:121], s[82:83]
v_pk_mul_f32 v[122:123], v[122:123], s[82:83]
v_pk_mul_f32 v[124:125], v[124:125], s[82:83]
v_pk_mul_f32 v[126:127], v[126:127], s[82:83]
v_pk_mul_f32 v[128:129], v[128:129], s[82:83]
buffer_load_dwordx4 v12, s[56:59], s80 offen offset:0 sc1 lds
v_pk_mul_f32 v[130:131], v[130:131], s[82:83]
v_pk_mul_f32 v[132:133], v[132:133], s[82:83]
v_pk_mul_f32 v[134:135], v[134:135], s[82:83]
v_pk_mul_f32 v[136:137], v[136:137], s[82:83]
v_pk_mul_f32 v[138:139], v[138:139], s[82:83]
v_pk_mul_f32 v[140:141], v[140:141], s[82:83]
v_pk_mul_f32 v[142:143], v[142:143], s[82:83]
v_cvt_pk_bf16_f32 v20, v112, v113
v_cvt_pk_bf16_f32 v21, v114, v115
v_cvt_pk_bf16_f32 v22, v128, v129
v_cvt_pk_bf16_f32 v23, v130, v131
v_cvt_pk_bf16_f32 v36, v116, v117
v_cvt_pk_bf16_f32 v37, v118, v119
v_cvt_pk_bf16_f32 v38, v132, v133
v_cvt_pk_bf16_f32 v39, v134, v135
buffer_load_dwordx4 v12, s[56:59], s80 offen offset:1024 sc1 lds
v_cvt_pk_bf16_f32 v52, v120, v121
v_cvt_pk_bf16_f32 v53, v122, v123
v_cvt_pk_bf16_f32 v54, v136, v137
v_cvt_pk_bf16_f32 v55, v138, v139
v_cvt_pk_bf16_f32 v68, v124, v125
v_cvt_pk_bf16_f32 v69, v126, v127
v_cvt_pk_bf16_f32 v70, v140, v141
v_cvt_pk_bf16_f32 v71, v142, v143
v_pk_mul_f32 v[144:145], v[144:145], s[82:83]
v_pk_mul_f32 v[146:147], v[146:147], s[82:83]
v_pk_mul_f32 v[148:149], v[148:149], s[82:83]
v_pk_mul_f32 v[150:151], v[150:151], s[82:83]
v_pk_mul_f32 v[152:153], v[152:153], s[82:83]
v_pk_mul_f32 v[154:155], v[154:155], s[82:83]
v_pk_mul_f32 v[156:157], v[156:157], s[82:83]
buffer_load_dwordx4 v12, s[56:59], s80 offen offset:2048 sc1 lds
v_pk_mul_f32 v[158:159], v[158:159], s[82:83]
v_pk_mul_f32 v[160:161], v[160:161], s[82:83]
v_pk_mul_f32 v[162:163], v[162:163], s[82:83]
v_pk_mul_f32 v[164:165], v[164:165], s[82:83]
v_pk_mul_f32 v[166:167], v[166:167], s[82:83]
v_pk_mul_f32 v[168:169], v[168:169], s[82:83]
v_pk_mul_f32 v[170:171], v[170:171], s[82:83]
v_pk_mul_f32 v[172:173], v[172:173], s[82:83]
v_pk_mul_f32 v[174:175], v[174:175], s[82:83]
v_cvt_pk_bf16_f32 v24, v144, v145
v_cvt_pk_bf16_f32 v25, v146, v147
v_cvt_pk_bf16_f32 v26, v160, v161
v_cvt_pk_bf16_f32 v27, v162, v163
v_cvt_pk_bf16_f32 v40, v148, v149
buffer_load_dwordx4 v12, s[56:59], s80 offen offset:3072 sc1 lds
v_cvt_pk_bf16_f32 v41, v150, v151
v_cvt_pk_bf16_f32 v42, v164, v165
v_cvt_pk_bf16_f32 v43, v166, v167
v_cvt_pk_bf16_f32 v56, v152, v153
v_cvt_pk_bf16_f32 v57, v154, v155
v_cvt_pk_bf16_f32 v58, v168, v169
v_cvt_pk_bf16_f32 v59, v170, v171
v_cvt_pk_bf16_f32 v72, v156, v157
v_cvt_pk_bf16_f32 v73, v158, v159
v_cvt_pk_bf16_f32 v74, v172, v173
v_cvt_pk_bf16_f32 v75, v174, v175
v_pk_mul_f32 v[176:177], v[176:177], s[82:83]
v_pk_mul_f32 v[178:179], v[178:179], s[82:83]
v_pk_mul_f32 v[180:181], v[180:181], s[82:83]
v_pk_mul_f32 v[182:183], v[182:183], s[82:83]
s_add_u32 m0, s68, 49152
v_pk_mul_f32 v[184:185], v[184:185], s[82:83]
v_pk_mul_f32 v[186:187], v[186:187], s[82:83]
v_pk_mul_f32 v[188:189], v[188:189], s[82:83]
v_pk_mul_f32 v[190:191], v[190:191], s[82:83]
v_pk_mul_f32 v[192:193], v[192:193], s[82:83]
v_pk_mul_f32 v[194:195], v[194:195], s[82:83]
v_pk_mul_f32 v[196:197], v[196:197], s[82:83]
v_pk_mul_f32 v[198:199], v[198:199], s[82:83]
v_pk_mul_f32 v[200:201], v[200:201], s[82:83]
v_pk_mul_f32 v[202:203], v[202:203], s[82:83]
v_pk_mul_f32 v[204:205], v[204:205], s[82:83]
v_pk_mul_f32 v[206:207], v[206:207], s[82:83]
v_cvt_pk_bf16_f32 v28, v176, v177
v_cvt_pk_bf16_f32 v29, v178, v179
s_mov_b32 s80, 32768
v_cvt_pk_bf16_f32 v30, v192, v193
v_cvt_pk_bf16_f32 v31, v194, v195
v_cvt_pk_bf16_f32 v44, v180, v181
v_cvt_pk_bf16_f32 v45, v182, v183
v_cvt_pk_bf16_f32 v46, v196, v197
v_cvt_pk_bf16_f32 v47, v198, v199
v_cvt_pk_bf16_f32 v60, v184, v185
v_cvt_pk_bf16_f32 v61, v186, v187
v_cvt_pk_bf16_f32 v62, v200, v201
v_cvt_pk_bf16_f32 v63, v202, v203
v_cvt_pk_bf16_f32 v76, v188, v189
v_cvt_pk_bf16_f32 v77, v190, v191
v_cvt_pk_bf16_f32 v78, v204, v205
v_cvt_pk_bf16_f32 v79, v206, v207
v_mov_b32 v2, 0
buffer_load_dwordx4 v12, s[52:55], s80 offen offset:0 sc1 lds
v_mov_b32 v3, 0
v_mov_b32 v4, 0
v_mov_b32 v5, 0
v_accvgpr_write_b32 a0, 0
v_accvgpr_write_b32 a1, 0
v_accvgpr_write_b32 a2, 0
v_accvgpr_write_b32 a3, 0
v_accvgpr_write_b32 a4, 0
v_accvgpr_write_b32 a5, 0
v_accvgpr_write_b32 a6, 0
v_accvgpr_write_b32 a7, 0
v_accvgpr_write_b32 a8, 0
v_accvgpr_write_b32 a9, 0
v_accvgpr_write_b32 a10, 0
v_accvgpr_write_b32 a11, 0
buffer_load_dwordx4 v12, s[52:55], s80 offen offset:1024 sc1 lds
v_accvgpr_write_b32 a12, 0
v_accvgpr_write_b32 a13, 0
v_accvgpr_write_b32 a14, 0
v_accvgpr_write_b32 a15, 0
v_accvgpr_write_b32 a16, 0
v_accvgpr_write_b32 a17, 0
v_accvgpr_write_b32 a18, 0
v_accvgpr_write_b32 a19, 0
v_accvgpr_write_b32 a20, 0
v_accvgpr_write_b32 a21, 0
v_accvgpr_write_b32 a22, 0
v_accvgpr_write_b32 a23, 0
v_accvgpr_write_b32 a24, 0
v_accvgpr_write_b32 a25, 0
buffer_load_dwordx4 v12, s[52:55], s80 offen offset:2048 sc1 lds
v_accvgpr_write_b32 a26, 0
v_accvgpr_write_b32 a27, 0
v_accvgpr_write_b32 a28, 0
v_accvgpr_write_b32 a29, 0
v_accvgpr_write_b32 a30, 0
v_accvgpr_write_b32 a31, 0
v_accvgpr_write_b32 a32, 0
v_accvgpr_write_b32 a33, 0
v_accvgpr_write_b32 a34, 0
v_accvgpr_write_b32 a35, 0
v_accvgpr_write_b32 a36, 0
v_accvgpr_write_b32 a37, 0
v_accvgpr_write_b32 a38, 0
v_accvgpr_write_b32 a39, 0
v_accvgpr_write_b32 a40, 0
buffer_load_dwordx4 v12, s[52:55], s80 offen offset:3072 sc1 lds
v_accvgpr_write_b32 a41, 0
v_accvgpr_write_b32 a42, 0
v_accvgpr_write_b32 a43, 0
v_accvgpr_write_b32 a44, 0
v_accvgpr_write_b32 a45, 0
v_accvgpr_write_b32 a46, 0
v_accvgpr_write_b32 a47, 0
v_accvgpr_write_b32 a48, 0
v_accvgpr_write_b32 a49, 0
v_accvgpr_write_b32 a50, 0
v_accvgpr_write_b32 a51, 0
v_accvgpr_write_b32 a52, 0
v_accvgpr_write_b32 a53, 0
v_accvgpr_write_b32 a54, 0
s_add_u32 m0, s68, 65536
v_accvgpr_write_b32 a55, 0
v_accvgpr_write_b32 a56, 0
v_accvgpr_write_b32 a57, 0
v_accvgpr_write_b32 a58, 0
v_accvgpr_write_b32 a59, 0
v_accvgpr_write_b32 a60, 0
v_accvgpr_write_b32 a61, 0
v_accvgpr_write_b32 a62, 0
v_accvgpr_write_b32 a63, 0
v_accvgpr_write_b32 a64, 0
v_accvgpr_write_b32 a65, 0
v_accvgpr_write_b32 a66, 0
v_accvgpr_write_b32 a67, 0
v_accvgpr_write_b32 a68, 0
v_accvgpr_write_b32 a69, 0
s_mov_b32 s80, 32768
v_accvgpr_write_b32 a70, 0
v_accvgpr_write_b32 a71, 0
v_accvgpr_write_b32 a72, 0
v_accvgpr_write_b32 a73, 0
v_accvgpr_write_b32 a74, 0
v_accvgpr_write_b32 a75, 0
v_accvgpr_write_b32 a76, 0
v_accvgpr_write_b32 a77, 0
v_accvgpr_write_b32 a78, 0
v_accvgpr_write_b32 a79, 0
v_accvgpr_write_b32 a80, 0
v_accvgpr_write_b32 a81, 0
v_accvgpr_write_b32 a82, 0
v_accvgpr_write_b32 a83, 0
v_accvgpr_write_b32 a84, 0
buffer_load_dwordx4 v12, s[56:59], s80 offen offset:0 sc1 lds
v_accvgpr_write_b32 a85, 0
v_accvgpr_write_b32 a86, 0
v_accvgpr_write_b32 a87, 0
v_accvgpr_write_b32 a88, 0
v_accvgpr_write_b32 a89, 0
v_accvgpr_write_b32 a90, 0
v_accvgpr_write_b32 a91, 0
v_accvgpr_write_b32 a92, 0
v_accvgpr_write_b32 a93, 0
v_accvgpr_write_b32 a94, 0
v_accvgpr_write_b32 a95, 0
v_accvgpr_write_b32 a96, 0
v_accvgpr_write_b32 a97, 0
v_accvgpr_write_b32 a98, 0
buffer_load_dwordx4 v12, s[56:59], s80 offen offset:1024 sc1 lds
v_accvgpr_write_b32 a99, 0
v_accvgpr_write_b32 a100, 0
v_accvgpr_write_b32 a101, 0
v_accvgpr_write_b32 a102, 0
v_accvgpr_write_b32 a103, 0
v_accvgpr_write_b32 a104, 0
v_accvgpr_write_b32 a105, 0
v_accvgpr_write_b32 a106, 0
v_accvgpr_write_b32 a107, 0
v_accvgpr_write_b32 a108, 0
v_accvgpr_write_b32 a109, 0
v_accvgpr_write_b32 a110, 0
v_accvgpr_write_b32 a111, 0
v_accvgpr_write_b32 a112, 0
v_accvgpr_write_b32 a113, 0
buffer_load_dwordx4 v12, s[56:59], s80 offen offset:2048 sc1 lds
v_accvgpr_write_b32 a114, 0
v_accvgpr_write_b32 a115, 0
v_accvgpr_write_b32 a116, 0
v_accvgpr_write_b32 a117, 0
v_accvgpr_write_b32 a118, 0
v_accvgpr_write_b32 a119, 0
v_accvgpr_write_b32 a120, 0
v_accvgpr_write_b32 a121, 0
v_accvgpr_write_b32 a122, 0
v_accvgpr_write_b32 a123, 0
v_accvgpr_write_b32 a124, 0
v_accvgpr_write_b32 a125, 0
v_accvgpr_write_b32 a126, 0
v_accvgpr_write_b32 a127, 0
v_xor_b32 v244, 0x8000, v10
buffer_load_dwordx4 v12, s[56:59], s80 offen offset:3072 sc1 lds
s_waitcnt vmcnt(16)
s_barrier
ds_read_b128 a[128:131], v244 offset:16384
ds_read_b128 a[132:135], v244 offset:17408
ds_read_b128 a[136:139], v244 offset:18432
ds_read_b128 a[140:143], v244 offset:19456
ds_read_b128 a[144:147], v244 offset:20480
ds_read_b128 a[148:151], v244 offset:21504
ds_read_b128 a[152:155], v244 offset:22528
ds_read_b128 a[156:159], v244 offset:23552
ds_read_b128 a[160:163], v244 offset:24576
ds_read_b128 a[164:167], v244 offset:25600
ds_read_b128 a[168:171], v244 offset:26624
ds_read_b128 a[172:175], v244 offset:27648
ds_read_b128 a[176:179], v244 offset:28672
ds_read_b128 a[180:183], v244 offset:29696
ds_read_b128 a[184:187], v244 offset:30720
ds_read_b128 a[188:191], v244 offset:31744
s_waitcnt lgkmcnt(15)
v_mfma_f32_16x16x32_bf16 v[80:83], a[128:131], v[16:19], 0
s_add_u32 m0, s68, 0
v_mfma_f32_16x16x32_bf16 v[88:91], a[128:131], v[32:35], 0
s_mov_b32 s80, 49152
v_mfma_f32_16x16x32_bf16 v[96:99], a[128:131], v[48:51], 0
v_mfma_f32_16x16x32_bf16 v[104:107], a[128:131], v[64:67], 0
buffer_load_dwordx4 v12, s[52:55], s80 offen offset:0 sc1 lds
s_waitcnt lgkmcnt(14)
MV 80,a,132,v,20
MV 88,a,132,v,36
buffer_load_dwordx4 v12, s[52:55], s80 offen offset:1024 sc1 lds
MV 96,a,132,v,52
MV 104,a,132,v,68
buffer_load_dwordx4 v12, s[52:55], s80 offen offset:2048 sc1 lds
s_waitcnt lgkmcnt(13)
MV 80,a,136,v,24
MV 88,a,136,v,40
buffer_load_dwordx4 v12, s[52:55], s80 offen offset:3072 sc1 lds
MV 96,a,136,v,56
MV 104,a,136,v,72
s_add_u32 m0, s68, 81920
s_waitcnt lgkmcnt(12)
MV 80,a,140,v,28
s_mov_b32 s80, 49152
MV 88,a,140,v,44
MV 96,a,140,v,60
buffer_load_dwordx4 v12, s[56:59], s80 offen offset:0 sc1 lds
MV 104,a,140,v,76
s_waitcnt lgkmcnt(11)
v_mfma_f32_16x16x32_bf16 v[84:87], a[144:147], v[16:19], 0
buffer_load_dwordx4 v12, s[56:59], s80 offen offset:1024 sc1 lds
v_mfma_f32_16x16x32_bf16 v[92:95], a[144:147], v[32:35], 0
v_mfma_f32_16x16x32_bf16 v[100:103], a[144:147], v[48:51], 0
buffer_load_dwordx4 v12, s[56:59], s80 offen offset:2048 sc1 lds
v_mfma_f32_16x16x32_bf16 v[108:111], a[144:147], v[64:67], 0
s_waitcnt lgkmcnt(10)
MV 84,a,148,v,20
buffer_load_dwordx4 v12, s[56:59], s80 offen offset:3072 sc1 lds
MV 92,a,148,v,36
MV 100,a,148,v,52
MV 108,a,148,v,68
s_waitcnt lgkmcnt(9)
MV 84,a,152,v,24
s_waitcnt vmcnt(16) lgkmcnt(0)
s_barrier
MV 92,a,152,v,40
ds_read_b128 a[128:131], v10 offset:0
s_add_u32 m0, s68, 16384
MV 100,a,152,v,56
ds_read_b128 a[132:135], v10 offset:1024
s_mov_b32 s80, 65536
MV 108,a,152,v,72
ds_read_b128 a[136:139], v10 offset:2048
buffer_load_dwordx4 v12, s[52:55], s80 offen offset:0 sc1 lds
MV 84,a,156,v,28
ds_read_b128 a[140:143], v10 offset:3072
buffer_load_dwordx4 v12, s[52:55], s80 offen offset:1024 sc1 lds
MV 92,a,156,v,44
ds_read_b128 a[144:147], v10 offset:4096
buffer_load_dwordx4 v12, s[52:55], s80 offen offset:2048 sc1 lds
MV 100,a,156,v,60
ds_read_b128 a[148:151], v10 offset:5120
buffer_load_dwordx4 v12, s[52:55], s80 offen offset:3072 sc1 lds
MV 108,a,156,v,76
ds_read_b128 a[152:155], v10 offset:6144
s_mov_b32 s71, 65536
v_mfma_f32_16x16x32_bf16 v[112:115], a[160:163], v[16:19], 0
ds_read_b128 a[156:159], v10 offset:7168
v_mfma_f32_16x16x32_bf16 v[120:123], a[160:163], v[32:35], 0
v_lshrrev_b32 v245, 4, v1
v_mfma_f32_16x16x32_bf16 v[128:131], a[160:163], v[48:51], 0
v_and_b32 v246, 15, v1
v_mfma_f32_16x16x32_bf16 v[136:139], a[160:163], v[64:67], 0
ds_read_b128 a[160:163], v10 offset:8192
v_lshlrev_b32 v247, 1, v245
MV 112,a,164,v,20
v_xor_b32 v246, v246, v247
MV 120,a,164,v,36
v_lshlrev_b32 v245, 11, v245
MV 128,a,164,v,52
v_lshl_add_u32 v245, v246, 4, v245
MV 136,a,164,v,68
ds_read_b128 a[164:167], v10 offset:9216
v_xor_b32 v246, 128, v245
MV 112,a,168,v,24
MV 120,a,168,v,40
s_lshl_b32 s36, s3, 13
MV 128,a,168,v,56
s_add_u32 m0, s36, 131072
MV 136,a,168,v,72
ds_read_b128 a[168:171], v10 offset:10240
s_mov_b32 s37, 0
MV 112,a,172,v,28
buffer_load_dwordx4 v245, s[32:35], s37 offen offset:0 lds
MV 120,a,172,v,44
s_mov_b32 s37, 7168
MV 128,a,172,v,60
buffer_load_dwordx4 v246, s[32:35], s37 offen offset:1024 lds
MV 136,a,172,v,76
ds_read_b128 a[172:175], v10 offset:11264
v_mfma_f32_16x16x32_bf16 v[116:119], a[176:179], v[16:19], 0
s_mov_b32 s37, 14336
v_mfma_f32_16x16x32_bf16 v[124:127], a[176:179], v[32:35], 0
buffer_load_dwordx4 v245, s[32:35], s37 offen offset:2048 lds
v_mfma_f32_16x16x32_bf16 v[132:135], a[176:179], v[48:51], 0
s_mov_b32 s37, 21504
v_mfma_f32_16x16x32_bf16 v[140:143], a[176:179], v[64:67], 0
ds_read_b128 a[176:179], v10 offset:12288
buffer_load_dwordx4 v246, s[32:35], s37 offen offset:3072 lds
MV 116,a,180,v,20
s_add_u32 m0, s36, 135168
MV 124,a,180,v,36
s_mov_b32 s37, 32768
MV 132,a,180,v,52
buffer_load_dwordx4 v245, s[32:35], s37 offen offset:0 lds
MV 140,a,180,v,68
ds_read_b128 a[180:183], v10 offset:13312
MV 116,a,184,v,24
s_mov_b32 s37, 39936
MV 124,a,184,v,40
buffer_load_dwordx4 v246, s[32:35], s37 offen offset:1024 lds
MV 132,a,184,v,56
s_mov_b32 s37, 47104
MV 140,a,184,v,72
ds_read_b128 a[184:187], v10 offset:14336
buffer_load_dwordx4 v245, s[32:35], s37 offen offset:2048 lds
MV 116,a,188,v,28
s_mov_b32 s37, 54272
MV 124,a,188,v,44
buffer_load_dwordx4 v246, s[32:35], s37 offen offset:3072 lds
MV 132,a,188,v,60
MV 140,a,188,v,76
ds_read_b128 a[188:191], v10 offset:15360
s_cmp_eq_u32 s70, 0
s_cbranch_scc1 L_p3_pmask
L_p3_pmask_ret:
v_exp_f32 v80, v80
v_exp_f32 v81, v81
v_exp_f32 v82, v82
v_add_f32 v2, v2, v80
v_add_f32 v2, v2, v81
v_exp_f32 v83, v83
v_cvt_pk_bf16_f32 v80, v80, v81
v_exp_f32 v84, v84
v_add_f32 v2, v2, v82
v_add_f32 v2, v2, v83
v_exp_f32 v85, v85
v_cvt_pk_bf16_f32 v81, v82, v83
v_exp_f32 v86, v86
v_add_f32 v2, v2, v84
v_add_f32 v2, v2, v85
v_exp_f32 v87, v87
v_cvt_pk_bf16_f32 v82, v84, v85
v_exp_f32 v88, v88
v_add_f32 v2, v2, v86
v_add_f32 v2, v2, v87
v_exp_f32 v89, v89
v_cvt_pk_bf16_f32 v83, v86, v87
v_exp_f32 v90, v90
v_add_f32 v3, v3, v88
v_add_f32 v3, v3, v89
v_exp_f32 v91, v91
v_cvt_pk_bf16_f32 v88, v88, v89
v_exp_f32 v92, v92
v_add_f32 v3, v3, v90
v_add_f32 v3, v3, v91
v_exp_f32 v93, v93
v_cvt_pk_bf16_f32 v89, v90, v91
v_exp_f32 v94, v94
v_add_f32 v3, v3, v92
v_add_f32 v3, v3, v93
v_exp_f32 v95, v95
v_cvt_pk_bf16_f32 v90, v92, v93
v_exp_f32 v96, v96
v_add_f32 v3, v3, v94
v_add_f32 v3, v3, v95
v_exp_f32 v97, v97
v_cvt_pk_bf16_f32 v91, v94, v95
v_exp_f32 v98, v98
v_add_f32 v4, v4, v96
v_add_f32 v4, v4, v97
v_exp_f32 v99, v99
v_cvt_pk_bf16_f32 v96, v96, v97
v_exp_f32 v100, v100
v_add_f32 v4, v4, v98
v_add_f32 v4, v4, v99
v_exp_f32 v101, v101
v_cvt_pk_bf16_f32 v97, v98, v99
v_exp_f32 v102, v102
v_add_f32 v4, v4, v100
v_add_f32 v4, v4, v101
v_exp_f32 v103, v103
v_cvt_pk_bf16_f32 v98, v100, v101
v_exp_f32 v104, v104
v_add_f32 v4, v4, v102
v_add_f32 v4, v4, v103
v_exp_f32 v105, v105
v_cvt_pk_bf16_f32 v99, v102, v103
v_exp_f32 v106, v106
v_add_f32 v5, v5, v104
v_add_f32 v5, v5, v105
v_exp_f32 v107, v107
v_cvt_pk_bf16_f32 v104, v104, v105
v_exp_f32 v108, v108
v_add_f32 v5, v5, v106
v_add_f32 v5, v5, v107
v_exp_f32 v109, v109
v_cvt_pk_bf16_f32 v105, v106, v107
v_exp_f32 v110, v110
v_add_f32 v5, v5, v108
v_add_f32 v5, v5, v109
v_exp_f32 v111, v111
v_cvt_pk_bf16_f32 v106, v108, v109
v_add_f32 v5, v5, v110
v_add_f32 v5, v5, v111
v_cvt_pk_bf16_f32 v107, v110, v111
s_sub_u32 s74, s70, 1
s_cbranch_scc1 L_p3_d0m_top
.p2align 5
L_p3_d0_top:
s_waitcnt lgkmcnt(0)
v_mfma_f32_16x16x32_bf16 v[144:147], a[128:131], v[16:19], 0
s_add_u32 m0, s73, 0
ds_read_b128 a[192:195], v11 offset:16384
v_mfma_f32_16x16x32_bf16 v[152:155], a[128:131], v[32:35], 0
v_exp_f32 v112, v112
v_mfma_f32_16x16x32_bf16 v[148:151], a[144:147], v[16:19], 0
ds_read_b128 a[196:199], v11 offset:17408
buffer_load_dwordx4 v12, s[56:59], s71 offen offset:0 sc1 lds
v_mfma_f32_16x16x32_bf16 v[156:159], a[144:147], v[32:35], 0
v_exp_f32 v113, v113
v_mfma_f32_16x16x32_bf16 v[176:179], a[160:163], v[16:19], 0
v_exp_f32 v114, v114
v_mfma_f32_16x16x32_bf16 v[184:187], a[160:163], v[32:35], 0
v_add_f32 v2, v2, v112
v_add_f32 v2, v2, v113
v_mfma_f32_16x16x32_bf16 v[180:183], a[176:179], v[16:19], 0
v_exp_f32 v115, v115
v_mfma_f32_16x16x32_bf16 v[188:191], a[176:179], v[32:35], 0
ds_read_b128 a[200:203], v11 offset:18432
v_cvt_pk_bf16_f32 v112, v112, v113
v_mfma_f32_16x16x32_bf16 v[196:199], a[176:179], v[48:51], 0
v_exp_f32 v116, v116
v_mfma_f32_16x16x32_bf16 v[204:207], a[176:179], v[64:67], 0
v_add_f32 v2, v2, v114
v_add_f32 v2, v2, v115
v_mfma_f32_16x16x32_bf16 v[192:195], a[160:163], v[48:51], 0
v_exp_f32 v117, v117
v_mfma_f32_16x16x32_bf16 v[200:203], a[160:163], v[64:67], 0
ds_read_b128 a[204:207], v11 offset:19456
v_cvt_pk_bf16_f32 v113, v114, v115
v_mfma_f32_16x16x32_bf16 v[164:167], a[144:147], v[48:51], 0
v_exp_f32 v118, v118
v_mfma_f32_16x16x32_bf16 v[172:175], a[144:147], v[64:67], 0
ds_read_b128 a[208:211], v11 offset:20480
v_add_f32 v2, v2, v116
v_mfma_f32_16x16x32_bf16 v[160:163], a[128:131], v[48:51], 0
buffer_load_dwordx4 v12, s[56:59], s71 offen offset:1024 sc1 lds
v_add_f32 v2, v2, v117
v_mfma_f32_16x16x32_bf16 v[168:171], a[128:131], v[64:67], 0
v_exp_f32 v119, v119
MV 180,a,180,v,20
ds_read_b128 a[212:215], v11 offset:21504
v_cvt_pk_bf16_f32 v114, v116, v117
MV 188,a,180,v,36
v_exp_f32 v120, v120
MV 176,a,164,v,20
v_add_f32 v2, v2, v118
v_add_f32 v2, v2, v119
MV 184,a,164,v,36
v_exp_f32 v121, v121
MV 148,a,148,v,20
ds_read_b128 a[216:219], v11 offset:22528
v_cvt_pk_bf16_f32 v115, v118, v119
MV 156,a,148,v,36
v_exp_f32 v122, v122
MV 144,a,132,v,20
v_add_f32 v3, v3, v120
v_add_f32 v3, v3, v121
MV 152,a,132,v,36
v_exp_f32 v123, v123
MV 160,a,132,v,52
ds_read_b128 a[220:223], v11 offset:23552
v_cvt_pk_bf16_f32 v120, v120, v121
MV 168,a,132,v,68
v_exp_f32 v124, v124
MV 164,a,148,v,52
ds_read_b128 a[224:227], v11 offset:24576
v_add_f32 v3, v3, v122
MV 172,a,148,v,68
buffer_load_dwordx4 v12, s[56:59], s71 offen offset:2048 sc1 lds
v_add_f32 v3, v3, v123
MV 192,a,164,v,52
v_exp_f32 v125, v125
MV 200,a,164,v,68
ds_read_b128 a[228:231], v11 offset:25600
v_cvt_pk_bf16_f32 v121, v122, v123
MV 196,a,180,v,52
v_exp_f32 v126, v126
MV 204,a,180,v,68
v_add_f32 v3, v3, v124
v_add_f32 v3, v3, v125
MV 144,a,136,v,24
v_exp_f32 v127, v127
MV 152,a,136,v,40
ds_read_b128 a[232:235], v11 offset:26624
v_cvt_pk_bf16_f32 v122, v124, v125
MV 148,a,152,v,24
v_exp_f32 v128, v128
MV 156,a,152,v,40
v_add_f32 v3, v3, v126
v_add_f32 v3, v3, v127
MV 176,a,168,v,24
v_exp_f32 v129, v129
MV 184,a,168,v,40
ds_read_b128 a[236:239], v11 offset:27648
v_cvt_pk_bf16_f32 v123, v126, v127
MV 180,a,184,v,24
v_exp_f32 v130, v130
MV 188,a,184,v,40
ds_read_b128 a[240:243], v11 offset:28672
v_add_f32 v4, v4, v128
MV 196,a,184,v,56
buffer_load_dwordx4 v12, s[56:59], s71 offen offset:3072 sc1 lds
v_add_f32 v4, v4, v129
MV 204,a,184,v,72
v_exp_f32 v131, v131
MV 192,a,168,v,56
ds_read_b128 a[244:247], v11 offset:29696
v_cvt_pk_bf16_f32 v128, v128, v129
MV 200,a,168,v,72
v_exp_f32 v132, v132
MV 164,a,152,v,56
v_add_f32 v4, v4, v130
v_add_f32 v4, v4, v131
MV 172,a,152,v,72
v_exp_f32 v133, v133
MV 160,a,136,v,56
ds_read_b128 a[248:251], v11 offset:30720
v_cvt_pk_bf16_f32 v129, v130, v131
MV 168,a,136,v,72
v_exp_f32 v134, v134
MV 180,a,188,v,28
v_add_f32 v4, v4, v132
v_add_f32 v4, v4, v133
MV 188,a,188,v,44
v_exp_f32 v135, v135
MV 176,a,172,v,28
ds_read_b128 a[252:255], v11 offset:31744
v_cvt_pk_bf16_f32 v130, v132, v133
MV 184,a,172,v,44
v_exp_f32 v136, v136
MV 148,a,156,v,28
v_add_f32 v4, v4, v134
v_add_f32 v4, v4, v135
MV 156,a,156,v,44
v_exp_f32 v137, v137
MV 144,a,140,v,28
s_add_u32 s71, s71, 16384
v_cvt_pk_bf16_f32 v131, v134, v135
MV 152,a,140,v,44
v_exp_f32 v138, v138
MV 160,a,140,v,60
v_add_f32 v5, v5, v136
v_add_f32 v5, v5, v137
MV 168,a,140,v,76
v_exp_f32 v139, v139
MV 164,a,156,v,60
v_cvt_pk_bf16_f32 v136, v136, v137
MV 172,a,156,v,76
v_exp_f32 v140, v140
MV 192,a,172,v,60
v_add_f32 v5, v5, v138
v_add_f32 v5, v5, v139
MV 200,a,172,v,76
v_exp_f32 v141, v141
MV 196,a,188,v,60
v_cvt_pk_bf16_f32 v137, v138, v139
MV 204,a,188,v,76
v_exp_f32 v142, v142
v_add_f32 v5, v5, v140
v_add_f32 v5, v5, v141
v_exp_f32 v143, v143
v_cvt_pk_bf16_f32 v138, v140, v141
v_add_f32 v5, v5, v142
v_add_f32 v5, v5, v143
v_cvt_pk_bf16_f32 v139, v142, v143
s_waitcnt vmcnt(16) lgkmcnt(0)
MA 0,a,192,v,80
s_barrier
MA 32,a,192,v,88
s_add_u32 m0, s72, 0
ds_read_b128 a[128:131], v10 offset:16384
MA 4,a,196,v,80
ds_read_b128 a[132:135], v10 offset:17408
buffer_load_dwordx4 v12, s[52:55], s71 offen offset:0 sc1 lds
MA 36,a,196,v,88
v_exp_f32 v144, v144
MA 8,a,200,v,80
v_exp_f32 v145, v145
MA 40,a,200,v,88
v_exp_f32 v146, v146
MA 12,a,204,v,80
v_add_f32 v2, v2, v144
v_add_f32 v2, v2, v145
MA 44,a,204,v,88
ds_read_b128 a[136:139], v10 offset:18432
ds_read_b128 a[140:143], v10 offset:19456
MA 16,a,208,v,80
v_exp_f32 v147, v147
MA 48,a,208,v,88
ds_read_b128 a[144:147], v10 offset:20480
v_cvt_pk_bf16_f32 v144, v144, v145
MA 20,a,212,v,80
v_exp_f32 v148, v148
MA 52,a,212,v,88
v_add_f32 v2, v2, v146
v_add_f32 v2, v2, v147
MA 24,a,216,v,80
v_exp_f32 v149, v149
MA 56,a,216,v,88
buffer_load_dwordx4 v12, s[52:55], s71 offen offset:1024 sc1 lds
v_cvt_pk_bf16_f32 v145, v146, v147
MA 28,a,220,v,80
v_exp_f32 v150, v150
MA 60,a,220,v,88
v_add_f32 v2, v2, v148
v_add_f32 v2, v2, v149
MA 92,a,220,v,96
v_exp_f32 v151, v151
MA 124,a,220,v,104
ds_read_b128 a[148:151], v10 offset:21504
v_cvt_pk_bf16_f32 v146, v148, v149
MA 88,a,216,v,96
v_exp_f32 v152, v152
MA 120,a,216,v,104
v_add_f32 v2, v2, v150
v_add_f32 v2, v2, v151
MA 84,a,212,v,96
ds_read_b128 a[152:155], v10 offset:22528
ds_read_b128 a[156:159], v10 offset:23552
MA 116,a,212,v,104
v_exp_f32 v153, v153
MA 80,a,208,v,96
ds_read_b128 a[160:163], v10 offset:24576
v_cvt_pk_bf16_f32 v147, v150, v151
MA 112,a,208,v,104
v_exp_f32 v154, v154
MA 76,a,204,v,96
v_add_f32 v3, v3, v152
v_add_f32 v3, v3, v153
MA 108,a,204,v,104
v_exp_f32 v155, v155
MA 72,a,200,v,96
buffer_load_dwordx4 v12, s[52:55], s71 offen offset:2048 sc1 lds
v_cvt_pk_bf16_f32 v152, v152, v153
MA 104,a,200,v,104
v_exp_f32 v156, v156
MA 68,a,196,v,96
v_add_f32 v3, v3, v154
v_add_f32 v3, v3, v155
MA 100,a,196,v,104
v_exp_f32 v157, v157
MA 64,a,192,v,96
ds_read_b128 a[164:167], v10 offset:25600
v_cvt_pk_bf16_f32 v153, v154, v155
MA 96,a,192,v,104
v_exp_f32 v158, v158
MA 0,a,224,v,112
v_add_f32 v3, v3, v156
v_add_f32 v3, v3, v157
MA 32,a,224,v,120
v_exp_f32 v159, v159
MA 4,a,228,v,112
ds_read_b128 a[168:171], v10 offset:26624
v_cvt_pk_bf16_f32 v154, v156, v157
MA 36,a,228,v,120
v_exp_f32 v160, v160
MA 8,a,232,v,112
ds_read_b128 a[172:175], v10 offset:27648
v_add_f32 v3, v3, v158
MA 40,a,232,v,120
ds_read_b128 a[176:179], v10 offset:28672
v_add_f32 v3, v3, v159
MA 12,a,236,v,112
v_exp_f32 v161, v161
MA 44,a,236,v,120
ds_read_b128 a[180:183], v10 offset:29696
v_cvt_pk_bf16_f32 v155, v158, v159
MA 16,a,240,v,112
v_exp_f32 v162, v162
MA 48,a,240,v,120
v_add_f32 v4, v4, v160
v_add_f32 v4, v4, v161
MA 20,a,244,v,112
v_exp_f32 v163, v163
MA 52,a,244,v,120
buffer_load_dwordx4 v12, s[52:55], s71 offen offset:3072 sc1 lds
v_cvt_pk_bf16_f32 v160, v160, v161
MA 24,a,248,v,112
v_exp_f32 v164, v164
MA 56,a,248,v,120
v_add_f32 v4, v4, v162
v_add_f32 v4, v4, v163
MA 28,a,252,v,112
v_exp_f32 v165, v165
MA 60,a,252,v,120
ds_read_b128 a[184:187], v10 offset:30720
v_cvt_pk_bf16_f32 v161, v162, v163
MA 92,a,252,v,128
v_exp_f32 v166, v166
MA 124,a,252,v,136
v_add_f32 v4, v4, v164
v_add_f32 v4, v4, v165
MA 88,a,248,v,128
ds_read_b128 a[188:191], v10 offset:31744
s_sub_u32 s74, s74, 1
MA 120,a,248,v,136
v_exp_f32 v167, v167
MA 84,a,244,v,128
v_cvt_pk_bf16_f32 v162, v164, v165
MA 116,a,244,v,136
v_exp_f32 v168, v168
MA 80,a,240,v,128
v_add_f32 v4, v4, v166
v_add_f32 v4, v4, v167
MA 112,a,240,v,136
v_exp_f32 v169, v169
MA 76,a,236,v,128
v_cvt_pk_bf16_f32 v163, v166, v167
MA 108,a,236,v,136
v_exp_f32 v170, v170
MA 72,a,232,v,128
v_add_f32 v5, v5, v168
v_add_f32 v5, v5, v169
MA 104,a,232,v,136
v_exp_f32 v171, v171
MA 68,a,228,v,128
v_cvt_pk_bf16_f32 v168, v168, v169
MA 100,a,228,v,136
v_exp_f32 v172, v172
MA 64,a,224,v,128
v_add_f32 v5, v5, v170
v_add_f32 v5, v5, v171
MA 96,a,224,v,136
v_exp_f32 v173, v173
v_cvt_pk_bf16_f32 v169, v170, v171
v_exp_f32 v174, v174
v_add_f32 v5, v5, v172
v_add_f32 v5, v5, v173
v_exp_f32 v175, v175
v_cvt_pk_bf16_f32 v170, v172, v173
v_add_f32 v5, v5, v174
v_add_f32 v5, v5, v175
v_cvt_pk_bf16_f32 v171, v174, v175
s_cbranch_scc1 L_p3_d1m_top
s_waitcnt lgkmcnt(0)
v_xor_b32 v11, 0x8000, v11
v_mfma_f32_16x16x32_bf16 v[80:83], a[128:131], v[16:19], 0
s_add_u32 m0, s73, 16384
ds_read_b128 a[192:195], v11 offset:0
v_mfma_f32_16x16x32_bf16 v[88:91], a[128:131], v[32:35], 0
v_exp_f32 v176, v176
v_mfma_f32_16x16x32_bf16 v[84:87], a[144:147], v[16:19], 0
ds_read_b128 a[196:199], v11 offset:1024
buffer_load_dwordx4 v12, s[56:59], s71 offen offset:0 sc1 lds
v_mfma_f32_16x16x32_bf16 v[92:95], a[144:147], v[32:35], 0
v_exp_f32 v177, v177
v_mfma_f32_16x16x32_bf16 v[112:115], a[160:163], v[16:19], 0
v_exp_f32 v178, v178
v_mfma_f32_16x16x32_bf16 v[120:123], a[160:163], v[32:35], 0
v_add_f32 v2, v2, v176
v_add_f32 v2, v2, v177
v_mfma_f32_16x16x32_bf16 v[116:119], a[176:179], v[16:19], 0
v_exp_f32 v179, v179
v_mfma_f32_16x16x32_bf16 v[124:127], a[176:179], v[32:35], 0
ds_read_b128 a[200:203], v11 offset:2048
v_cvt_pk_bf16_f32 v176, v176, v177
v_mfma_f32_16x16x32_bf16 v[132:135], a[176:179], v[48:51], 0
v_exp_f32 v180, v180
v_mfma_f32_16x16x32_bf16 v[140:143], a[176:179], v[64:67], 0
v_add_f32 v2, v2, v178
v_add_f32 v2, v2, v179
v_mfma_f32_16x16x32_bf16 v[128:131], a[160:163], v[48:51], 0
v_exp_f32 v181, v181
v_mfma_f32_16x16x32_bf16 v[136:139], a[160:163], v[64:67], 0
ds_read_b128 a[204:207], v11 offset:3072
v_cvt_pk_bf16_f32 v177, v178, v179
v_mfma_f32_16x16x32_bf16 v[100:103], a[144:147], v[48:51], 0
v_exp_f32 v182, v182
v_mfma_f32_16x16x32_bf16 v[108:111], a[144:147], v[64:67], 0
buffer_load_dwordx4 v12, s[56:59], s71 offen offset:1024 sc1 lds
v_add_f32 v2, v2, v180
v_mfma_f32_16x16x32_bf16 v[96:99], a[128:131], v[48:51], 0
ds_read_b128 a[208:211], v11 offset:4096
v_add_f32 v2, v2, v181
v_mfma_f32_16x16x32_bf16 v[104:107], a[128:131], v[64:67], 0
v_exp_f32 v183, v183
MV 116,a,180,v,20
ds_read_b128 a[212:215], v11 offset:5120
v_cvt_pk_bf16_f32 v178, v180, v181
MV 124,a,180,v,36
v_exp_f32 v184, v184
MV 112,a,164,v,20
v_add_f32 v2, v2, v182
v_add_f32 v2, v2, v183
MV 120,a,164,v,36
v_exp_f32 v185, v185
MV 84,a,148,v,20
ds_read_b128 a[216:219], v11 offset:6144
v_cvt_pk_bf16_f32 v179, v182, v183
MV 92,a,148,v,36
v_exp_f32 v186, v186
MV 80,a,132,v,20
v_add_f32 v3, v3, v184
v_add_f32 v3, v3, v185
MV 88,a,132,v,36
v_exp_f32 v187, v187
MV 96,a,132,v,52
ds_read_b128 a[220:223], v11 offset:7168
v_cvt_pk_bf16_f32 v184, v184, v185
MV 104,a,132,v,68
ds_read_b128 a[224:227], v11 offset:8192
buffer_load_dwordx4 v12, s[56:59], s71 offen offset:2048 sc1 lds
MV 100,a,148,v,52
v_exp_f32 v188, v188
MV 108,a,148,v,68
v_add_f32 v3, v3, v186
v_add_f32 v3, v3, v187
MV 128,a,164,v,52
v_exp_f32 v189, v189
MV 136,a,164,v,68
ds_read_b128 a[228:231], v11 offset:9216
v_cvt_pk_bf16_f32 v185, v186, v187
MV 132,a,180,v,52
v_exp_f32 v190, v190
MV 140,a,180,v,68
v_add_f32 v3, v3, v188
v_add_f32 v3, v3, v189
MV 80,a,136,v,24
v_exp_f32 v191, v191
MV 88,a,136,v,40
ds_read_b128 a[232:235], v11 offset:10240
v_cvt_pk_bf16_f32 v186, v188, v189
MV 84,a,152,v,24
v_exp_f32 v192, v192
MV 92,a,152,v,40
buffer_load_dwordx4 v12, s[56:59], s71 offen offset:3072 sc1 lds
v_add_f32 v3, v3, v190
MV 112,a,168,v,24
ds_read_b128 a[236:239], v11 offset:11264
v_add_f32 v3, v3, v191
MV 120,a,168,v,40
v_exp_f32 v193, v193
MV 116,a,184,v,24
ds_read_b128 a[240:243], v11 offset:12288
v_cvt_pk_bf16_f32 v187, v190, v191
MV 124,a,184,v,40
v_exp_f32 v194, v194
MV 132,a,184,v,56
v_add_f32 v4, v4, v192
v_add_f32 v4, v4, v193
MV 140,a,184,v,72
v_exp_f32 v195, v195
MV 128,a,168,v,56
ds_read_b128 a[244:247], v11 offset:13312
v_cvt_pk_bf16_f32 v192, v192, v193
MV 136,a,168,v,72
v_exp_f32 v196, v196
MV 100,a,152,v,56
v_add_f32 v4, v4, v194
v_add_f32 v4, v4, v195
MV 108,a,152,v,72
v_exp_f32 v197, v197
MV 96,a,136,v,56
ds_read_b128 a[248:251], v11 offset:14336
v_cvt_pk_bf16_f32 v193, v194, v195
MV 104,a,136,v,72
v_exp_f32 v198, v198
MV 116,a,188,v,28
s_add_u32 s71, s71, 16384
v_add_f32 v4, v4, v196
MV 124,a,188,v,44
ds_read_b128 a[252:255], v11 offset:15360
v_add_f32 v4, v4, v197
MV 112,a,172,v,28
v_exp_f32 v199, v199
MV 120,a,172,v,44
s_xor_b32 s73, s73, 0x8000
v_cvt_pk_bf16_f32 v194, v196, v197
MV 84,a,156,v,28
v_exp_f32 v200, v200
MV 92,a,156,v,44
v_add_f32 v4, v4, v198
v_add_f32 v4, v4, v199
MV 80,a,140,v,28
v_exp_f32 v201, v201
MV 88,a,140,v,44
v_cvt_pk_bf16_f32 v195, v198, v199
MV 96,a,140,v,60
v_exp_f32 v202, v202
MV 104,a,140,v,76
v_add_f32 v5, v5, v200
v_add_f32 v5, v5, v201
MV 100,a,156,v,60
v_exp_f32 v203, v203
MV 108,a,156,v,76
v_cvt_pk_bf16_f32 v200, v200, v201
MV 128,a,172,v,60
v_exp_f32 v204, v204
MV 136,a,172,v,76
v_add_f32 v5, v5, v202
v_add_f32 v5, v5, v203
MV 132,a,188,v,60
v_exp_f32 v205, v205
MV 140,a,188,v,76
v_cvt_pk_bf16_f32 v201, v202, v203
v_exp_f32 v206, v206
v_add_f32 v5, v5, v204
v_add_f32 v5, v5, v205
v_exp_f32 v207, v207
v_cvt_pk_bf16_f32 v202, v204, v205
v_add_f32 v5, v5, v206
v_add_f32 v5, v5, v207
v_cvt_pk_bf16_f32 v203, v206, v207
s_waitcnt vmcnt(16) lgkmcnt(0)
MA 0,a,192,v,144
s_barrier
v_xor_b32 v10, 0x8000, v10
MA 32,a,192,v,152
s_add_u32 m0, s72, 16384
ds_read_b128 a[128:131], v10 offset:0
MA 4,a,196,v,144
ds_read_b128 a[132:135], v10 offset:1024
buffer_load_dwordx4 v12, s[52:55], s71 offen offset:0 sc1 lds
MA 36,a,196,v,152
v_exp_f32 v80, v80
MA 8,a,200,v,144
v_exp_f32 v81, v81
MA 40,a,200,v,152
v_exp_f32 v82, v82
MA 12,a,204,v,144
v_add_f32 v2, v2, v80
v_add_f32 v2, v2, v81
MA 44,a,204,v,152
ds_read_b128 a[136:139], v10 offset:2048
ds_read_b128 a[140:143], v10 offset:3072
MA 16,a,208,v,144
v_exp_f32 v83, v83
MA 48,a,208,v,152
ds_read_b128 a[144:147], v10 offset:4096
v_cvt_pk_bf16_f32 v80, v80, v81
MA 20,a,212,v,144
v_exp_f32 v84, v84
MA 52,a,212,v,152
v_add_f32 v2, v2, v82
v_add_f32 v2, v2, v83
MA 24,a,216,v,144
v_exp_f32 v85, v85
MA 56,a,216,v,152
buffer_load_dwordx4 v12, s[52:55], s71 offen offset:1024 sc1 lds
v_cvt_pk_bf16_f32 v81, v82, v83
MA 28,a,220,v,144
v_exp_f32 v86, v86
MA 60,a,220,v,152
v_add_f32 v2, v2, v84
v_add_f32 v2, v2, v85
MA 92,a,220,v,160
v_exp_f32 v87, v87
MA 124,a,220,v,168
ds_read_b128 a[148:151], v10 offset:5120
v_cvt_pk_bf16_f32 v82, v84, v85
MA 88,a,216,v,160
v_exp_f32 v88, v88
MA 120,a,216,v,168
v_add_f32 v2, v2, v86
v_add_f32 v2, v2, v87
MA 84,a,212,v,160
ds_read_b128 a[152:155], v10 offset:6144
ds_read_b128 a[156:159], v10 offset:7168
MA 116,a,212,v,168
v_exp_f32 v89, v89
MA 80,a,208,v,160
ds_read_b128 a[160:163], v10 offset:8192
v_cvt_pk_bf16_f32 v83, v86, v87
MA 112,a,208,v,168
v_exp_f32 v90, v90
MA 76,a,204,v,160
v_add_f32 v3, v3, v88
v_add_f32 v3, v3, v89
MA 108,a,204,v,168
v_exp_f32 v91, v91
MA 72,a,200,v,160
buffer_load_dwordx4 v12, s[52:55], s71 offen offset:2048 sc1 lds
v_cvt_pk_bf16_f32 v88, v88, v89
MA 104,a,200,v,168
v_exp_f32 v92, v92
MA 68,a,196,v,160
v_add_f32 v3, v3, v90
v_add_f32 v3, v3, v91
MA 100,a,196,v,168
v_exp_f32 v93, v93
MA 64,a,192,v,160
ds_read_b128 a[164:167], v10 offset:9216
v_cvt_pk_bf16_f32 v89, v90, v91
MA 96,a,192,v,168
v_exp_f32 v94, v94
MA 0,a,224,v,176
v_add_f32 v3, v3, v92
v_add_f32 v3, v3, v93
MA 32,a,224,v,184
v_exp_f32 v95, v95
MA 4,a,228,v,176
ds_read_b128 a[168:171], v10 offset:10240
v_cvt_pk_bf16_f32 v90, v92, v93
MA 36,a,228,v,184
v_exp_f32 v96, v96
MA 8,a,232,v,176
ds_read_b128 a[172:175], v10 offset:11264
v_add_f32 v3, v3, v94
MA 40,a,232,v,184
ds_read_b128 a[176:179], v10 offset:12288
v_add_f32 v3, v3, v95
MA 12,a,236,v,176
v_exp_f32 v97, v97
MA 44,a,236,v,184
ds_read_b128 a[180:183], v10 offset:13312
v_cvt_pk_bf16_f32 v91, v94, v95
MA 16,a,240,v,176
v_exp_f32 v98, v98
MA 48,a,240,v,184
v_add_f32 v4, v4, v96
v_add_f32 v4, v4, v97
MA 20,a,244,v,176
v_exp_f32 v99, v99
MA 52,a,244,v,184
buffer_load_dwordx4 v12, s[52:55], s71 offen offset:3072 sc1 lds
v_cvt_pk_bf16_f32 v96, v96, v97
MA 24,a,248,v,176
v_exp_f32 v100, v100
MA 56,a,248,v,184
v_add_f32 v4, v4, v98
v_add_f32 v4, v4, v99
MA 28,a,252,v,176
v_exp_f32 v101, v101
MA 60,a,252,v,184
ds_read_b128 a[184:187], v10 offset:14336
v_cvt_pk_bf16_f32 v97, v98, v99
MA 92,a,252,v,192
v_exp_f32 v102, v102
MA 124,a,252,v,200
v_add_f32 v4, v4, v100
v_add_f32 v4, v4, v101
MA 88,a,248,v,192
ds_read_b128 a[188:191], v10 offset:15360
s_xor_b32 s72, s72, 0x8000
MA 120,a,248,v,200
v_exp_f32 v103, v103
MA 84,a,244,v,192
v_cvt_pk_bf16_f32 v98, v100, v101
MA 116,a,244,v,200
v_exp_f32 v104, v104
MA 80,a,240,v,192
v_add_f32 v4, v4, v102
v_add_f32 v4, v4, v103
MA 112,a,240,v,200
v_exp_f32 v105, v105
MA 76,a,236,v,192
v_cvt_pk_bf16_f32 v99, v102, v103
MA 108,a,236,v,200
v_exp_f32 v106, v106
MA 72,a,232,v,192
v_add_f32 v5, v5, v104
v_add_f32 v5, v5, v105
MA 104,a,232,v,200
v_exp_f32 v107, v107
MA 68,a,228,v,192
v_cvt_pk_bf16_f32 v104, v104, v105
MA 100,a,228,v,200
v_exp_f32 v108, v108
MA 64,a,224,v,192
v_add_f32 v5, v5, v106
v_add_f32 v5, v5, v107
MA 96,a,224,v,200
v_exp_f32 v109, v109
v_cvt_pk_bf16_f32 v105, v106, v107
v_exp_f32 v110, v110
v_add_f32 v5, v5, v108
v_add_f32 v5, v5, v109
v_exp_f32 v111, v111
v_cvt_pk_bf16_f32 v106, v108, v109
v_add_f32 v5, v5, v110
v_add_f32 v5, v5, v111
v_cvt_pk_bf16_f32 v107, v110, v111
s_branch L_p3_d0_top
L_p3_d1m_top:
s_waitcnt lgkmcnt(0)
v_xor_b32 v11, 0x8000, v11
v_mfma_f32_16x16x32_bf16 v[80:83], a[128:131], v[16:19], 0
s_add_u32 m0, s73, 16384
ds_read_b128 a[192:195], v11 offset:0
v_mfma_f32_16x16x32_bf16 v[88:91], a[128:131], v[32:35], 0
v_exp_f32 v176, v176
v_mfma_f32_16x16x32_bf16 v[96:99], a[128:131], v[48:51], 0
ds_read_b128 a[196:199], v11 offset:1024
buffer_load_dwordx4 v12, s[56:59], s71 offen offset:0 sc1 lds
v_mfma_f32_16x16x32_bf16 v[104:107], a[128:131], v[64:67], 0
v_exp_f32 v177, v177
MV 80,a,132,v,20
v_exp_f32 v178, v178
MV 88,a,132,v,36
v_add_f32 v2, v2, v176
v_add_f32 v2, v2, v177
MV 96,a,132,v,52
v_exp_f32 v179, v179
MV 104,a,132,v,68
ds_read_b128 a[200:203], v11 offset:2048
v_cvt_pk_bf16_f32 v176, v176, v177
MV 80,a,136,v,24
v_exp_f32 v180, v180
MV 88,a,136,v,40
v_add_f32 v2, v2, v178
v_add_f32 v2, v2, v179
MV 96,a,136,v,56
v_exp_f32 v181, v181
MV 104,a,136,v,72
ds_read_b128 a[204:207], v11 offset:3072
v_cvt_pk_bf16_f32 v177, v178, v179
MV 80,a,140,v,28
v_exp_f32 v182, v182
MV 88,a,140,v,44
buffer_load_dwordx4 v12, s[56:59], s71 offen offset:1024 sc1 lds
v_add_f32 v2, v2, v180
MV 96,a,140,v,60
ds_read_b128 a[208:211], v11 offset:4096
v_add_f32 v2, v2, v181
MV 104,a,140,v,76
v_exp_f32 v183, v183
v_mfma_f32_16x16x32_bf16 v[84:87], a[144:147], v[16:19], 0
ds_read_b128 a[212:215], v11 offset:5120
v_cvt_pk_bf16_f32 v178, v180, v181
v_mfma_f32_16x16x32_bf16 v[92:95], a[144:147], v[32:35], 0
v_exp_f32 v184, v184
v_mfma_f32_16x16x32_bf16 v[100:103], a[144:147], v[48:51], 0
v_add_f32 v2, v2, v182
v_add_f32 v2, v2, v183
v_mfma_f32_16x16x32_bf16 v[108:111], a[144:147], v[64:67], 0
v_exp_f32 v185, v185
MV 84,a,148,v,20
ds_read_b128 a[216:219], v11 offset:6144
v_cvt_pk_bf16_f32 v179, v182, v183
MV 92,a,148,v,36
v_exp_f32 v186, v186
MV 100,a,148,v,52
v_add_f32 v3, v3, v184
v_add_f32 v3, v3, v185
MV 108,a,148,v,68
v_exp_f32 v187, v187
MV 84,a,152,v,24
ds_read_b128 a[220:223], v11 offset:7168
v_cvt_pk_bf16_f32 v184, v184, v185
MV 92,a,152,v,40
ds_read_b128 a[224:227], v11 offset:8192
buffer_load_dwordx4 v12, s[56:59], s71 offen offset:2048 sc1 lds
MV 100,a,152,v,56
v_exp_f32 v188, v188
MV 108,a,152,v,72
v_add_f32 v3, v3, v186
v_add_f32 v3, v3, v187
MV 84,a,156,v,28
v_exp_f32 v189, v189
MV 92,a,156,v,44
ds_read_b128 a[228:231], v11 offset:9216
v_cvt_pk_bf16_f32 v185, v186, v187
MV 100,a,156,v,60
v_exp_f32 v190, v190
MV 108,a,156,v,76
v_add_f32 v3, v3, v188
v_add_f32 v3, v3, v189
v_mfma_f32_16x16x32_bf16 v[112:115], a[160:163], v[16:19], 0
v_exp_f32 v191, v191
v_mfma_f32_16x16x32_bf16 v[120:123], a[160:163], v[32:35], 0
ds_read_b128 a[232:235], v11 offset:10240
v_cvt_pk_bf16_f32 v186, v188, v189
v_mfma_f32_16x16x32_bf16 v[128:131], a[160:163], v[48:51], 0
v_exp_f32 v192, v192
v_mfma_f32_16x16x32_bf16 v[136:139], a[160:163], v[64:67], 0
buffer_load_dwordx4 v12, s[56:59], s71 offen offset:3072 sc1 lds
v_add_f32 v3, v3, v190
MV 112,a,164,v,20
ds_read_b128 a[236:239], v11 offset:11264
v_add_f32 v3, v3, v191
MV 120,a,164,v,36
v_exp_f32 v193, v193
MV 128,a,164,v,52
ds_read_b128 a[240:243], v11 offset:12288
v_cvt_pk_bf16_f32 v187, v190, v191
MV 136,a,164,v,68
v_exp_f32 v194, v194
MV 112,a,168,v,24
v_add_f32 v4, v4, v192
v_add_f32 v4, v4, v193
MV 120,a,168,v,40
v_exp_f32 v195, v195
MV 128,a,168,v,56
v_cvt_pk_bf16_f32 v192, v192, v193
v_add_u32 v246, 0, v13
MV 136,a,168,v,72
v_exp_f32 v196, v196
MV 112,a,172,v,28
ds_read_b128 a[244:247], v11 offset:13312
v_add_f32 v4, v4, v194
MV 120,a,172,v,44
v_add_f32 v4, v4, v195
v_cmp_gt_i32_e64 s[84:85], 0, v246
MV 128,a,172,v,60
ds_read_b128 a[248:251], v11 offset:14336
v_cmp_gt_i32_e64 s[86:87], 1, v246
MV 136,a,172,v,76
v_exp_f32 v197, v197
v_mfma_f32_16x16x32_bf16 v[116:119], a[176:179], v[16:19], 0
v_cvt_pk_bf16_f32 v193, v194, v195
v_cmp_gt_i32_e64 s[88:89], 2, v246
v_mfma_f32_16x16x32_bf16 v[124:127], a[176:179], v[32:35], 0
v_exp_f32 v198, v198
v_mfma_f32_16x16x32_bf16 v[132:135], a[176:179], v[48:51], 0
s_add_u32 s71, s71, 16384
v_add_f32 v4, v4, v196
v_mfma_f32_16x16x32_bf16 v[140:143], a[176:179], v[64:67], 0
v_add_f32 v4, v4, v197
v_cmp_gt_i32_e64 s[90:91], 3, v246
MV 116,a,180,v,20
v_exp_f32 v199, v199
MV 124,a,180,v,36
ds_read_b128 a[252:255], v11 offset:15360
v_cvt_pk_bf16_f32 v194, v196, v197
MV 132,a,180,v,52
v_cndmask_b32_e64 v96, v96, v14, s[84:85]
v_cndmask_b32_e64 v97, v97, v14, s[86:87]
MV 140,a,180,v,68
v_exp_f32 v200, v200
MV 116,a,184,v,24
v_add_f32 v4, v4, v198
v_add_f32 v4, v4, v199
MV 124,a,184,v,40
v_cndmask_b32_e64 v98, v98, v14, s[88:89]
v_cndmask_b32_e64 v99, v99, v14, s[90:91]
MV 132,a,184,v,56
v_exp_f32 v201, v201
MV 140,a,184,v,72
v_cvt_pk_bf16_f32 v195, v198, v199
v_add_u32 v247, -16, v13
MV 116,a,188,v,28
v_exp_f32 v202, v202
MV 124,a,188,v,44
v_add_f32 v5, v5, v200
v_add_f32 v5, v5, v201
MV 132,a,188,v,60
s_xor_b32 s73, s73, 0x8000
v_cmp_gt_i32_e64 s[92:93], 0, v247
MV 140,a,188,v,76
v_exp_f32 v203, v203
v_cvt_pk_bf16_f32 v200, v200, v201
v_cmp_gt_i32_e64 s[94:95], 1, v247
v_exp_f32 v204, v204
v_add_f32 v5, v5, v202
v_cmp_gt_i32_e64 s[96:97], 2, v247
v_add_f32 v5, v5, v203
v_exp_f32 v205, v205
v_cmp_gt_i32_e64 s[98:99], 3, v247
v_cvt_pk_bf16_f32 v201, v202, v203
v_exp_f32 v206, v206
v_cndmask_b32_e64 v100, v100, v14, s[92:93]
v_add_f32 v5, v5, v204
v_cndmask_b32_e64 v101, v101, v14, s[94:95]
v_add_f32 v5, v5, v205
v_exp_f32 v207, v207
v_cvt_pk_bf16_f32 v202, v204, v205
v_cndmask_b32_e64 v102, v102, v14, s[96:97]
v_add_f32 v5, v5, v206
v_add_f32 v5, v5, v207
v_cndmask_b32_e64 v103, v103, v14, s[98:99]
v_cvt_pk_bf16_f32 v203, v206, v207
s_waitcnt vmcnt(16) lgkmcnt(0)
MA 0,a,192,v,144
s_barrier
v_xor_b32 v10, 0x8000, v10
MA 32,a,192,v,152
s_add_u32 m0, s72, 16384
ds_read_b128 a[128:131], v10 offset:0
MA 4,a,196,v,144
ds_read_b128 a[132:135], v10 offset:1024
buffer_load_dwordx4 v12, s[52:55], s71 offen offset:0 sc1 lds
MA 36,a,196,v,152
v_exp_f32 v80, v80
MA 8,a,200,v,144
v_exp_f32 v81, v81
MA 40,a,200,v,152
v_exp_f32 v82, v82
MA 12,a,204,v,144
v_add_f32 v2, v2, v80
v_add_f32 v2, v2, v81
MA 44,a,204,v,152
ds_read_b128 a[136:139], v10 offset:2048
v_add_u32 v246, -32, v13
MA 16,a,208,v,144
v_exp_f32 v83, v83
MA 48,a,208,v,152
ds_read_b128 a[140:143], v10 offset:3072
v_cvt_pk_bf16_f32 v80, v80, v81
MA 20,a,212,v,144
v_exp_f32 v84, v84
MA 52,a,212,v,152
v_add_f32 v2, v2, v82
v_add_f32 v2, v2, v83
MA 24,a,216,v,144
ds_read_b128 a[144:147], v10 offset:4096
v_cmp_gt_i32_e64 s[84:85], 0, v246
MA 56,a,216,v,152
v_exp_f32 v85, v85
MA 28,a,220,v,144
v_cvt_pk_bf16_f32 v81, v82, v83
v_cmp_gt_i32_e64 s[86:87], 1, v246
MA 60,a,220,v,152
v_exp_f32 v86, v86
MA 92,a,220,v,160
v_add_f32 v2, v2, v84
v_add_f32 v2, v2, v85
MA 124,a,220,v,168
ds_read_b128 a[148:151], v10 offset:5120
buffer_load_dwordx4 v12, s[52:55], s71 offen offset:1024 sc1 lds
MA 88,a,216,v,160
v_exp_f32 v87, v87
MA 120,a,216,v,168
v_cvt_pk_bf16_f32 v82, v84, v85
v_cmp_gt_i32_e64 s[88:89], 2, v246
MA 84,a,212,v,160
v_exp_f32 v88, v88
MA 116,a,212,v,168
v_add_f32 v2, v2, v86
v_add_f32 v2, v2, v87
MA 80,a,208,v,160
ds_read_b128 a[152:155], v10 offset:6144
v_cmp_gt_i32_e64 s[90:91], 3, v246
MA 112,a,208,v,168
v_exp_f32 v89, v89
MA 76,a,204,v,160
ds_read_b128 a[156:159], v10 offset:7168
v_cvt_pk_bf16_f32 v83, v86, v87
MA 108,a,204,v,168
v_exp_f32 v90, v90
MA 72,a,200,v,160
v_add_f32 v3, v3, v88
v_add_f32 v3, v3, v89
MA 104,a,200,v,168
v_exp_f32 v91, v91
MA 68,a,196,v,160
v_cvt_pk_bf16_f32 v88, v88, v89
v_cndmask_b32_e64 v128, v128, v14, s[84:85]
MA 100,a,196,v,168
v_exp_f32 v92, v92
MA 64,a,192,v,160
ds_read_b128 a[160:163], v10 offset:8192
v_add_f32 v3, v3, v90
MA 96,a,192,v,168
v_add_f32 v3, v3, v91
v_cndmask_b32_e64 v129, v129, v14, s[86:87]
MA 0,a,224,v,176
v_exp_f32 v93, v93
MA 32,a,224,v,184
buffer_load_dwordx4 v12, s[52:55], s71 offen offset:2048 sc1 lds
v_cvt_pk_bf16_f32 v89, v90, v91
MA 4,a,228,v,176
ds_read_b128 a[164:167], v10 offset:9216
v_cndmask_b32_e64 v130, v130, v14, s[88:89]
MA 36,a,228,v,184
v_exp_f32 v94, v94
MA 8,a,232,v,176
v_add_f32 v3, v3, v92
v_add_f32 v3, v3, v93
MA 40,a,232,v,184
v_exp_f32 v95, v95
MA 12,a,236,v,176
ds_read_b128 a[168:171], v10 offset:10240
v_cvt_pk_bf16_f32 v90, v92, v93
MA 44,a,236,v,184
ds_read_b128 a[172:175], v10 offset:11264
v_cndmask_b32_e64 v131, v131, v14, s[90:91]
MA 16,a,240,v,176
v_exp_f32 v96, v96
MA 48,a,240,v,184
v_add_f32 v3, v3, v94
v_add_f32 v3, v3, v95
MA 20,a,244,v,176
v_exp_f32 v97, v97
MA 52,a,244,v,184
v_cvt_pk_bf16_f32 v91, v94, v95
v_add_u32 v247, -48, v13
MA 24,a,248,v,176
v_exp_f32 v98, v98
MA 56,a,248,v,184
ds_read_b128 a[176:179], v10 offset:12288
v_add_f32 v4, v4, v96
MA 28,a,252,v,176
v_add_f32 v4, v4, v97
v_cmp_gt_i32_e64 s[92:93], 0, v247
MA 60,a,252,v,184
v_exp_f32 v99, v99
MA 92,a,252,v,192
ds_read_b128 a[180:183], v10 offset:13312
v_cvt_pk_bf16_f32 v96, v96, v97
MA 124,a,252,v,200
buffer_load_dwordx4 v12, s[52:55], s71 offen offset:3072 sc1 lds
v_cmp_gt_i32_e64 s[94:95], 1, v247
MA 88,a,248,v,192
v_exp_f32 v100, v100
MA 120,a,248,v,200
v_add_f32 v4, v4, v98
v_add_f32 v4, v4, v99
MA 84,a,244,v,192
v_exp_f32 v101, v101
MA 116,a,244,v,200
ds_read_b128 a[184:187], v10 offset:14336
v_cvt_pk_bf16_f32 v97, v98, v99
MA 80,a,240,v,192
v_exp_f32 v102, v102
MA 112,a,240,v,200
v_add_f32 v4, v4, v100
v_add_f32 v4, v4, v101
MA 76,a,236,v,192
ds_read_b128 a[188:191], v10 offset:15360
v_cmp_gt_i32_e64 s[96:97], 2, v247
MA 108,a,236,v,200
v_exp_f32 v103, v103
MA 72,a,232,v,192
v_cvt_pk_bf16_f32 v98, v100, v101
v_cmp_gt_i32_e64 s[98:99], 3, v247
MA 104,a,232,v,200
v_exp_f32 v104, v104
MA 68,a,228,v,192
v_add_f32 v4, v4, v102
v_add_f32 v4, v4, v103
MA 100,a,228,v,200
v_exp_f32 v105, v105
MA 64,a,224,v,192
s_xor_b32 s72, s72, 0x8000
v_cvt_pk_bf16_f32 v99, v102, v103
MA 96,a,224,v,200
v_exp_f32 v106, v106
v_add_f32 v5, v5, v104
v_cndmask_b32_e64 v132, v132, v14, s[92:93]
v_add_f32 v5, v5, v105
v_exp_f32 v107, v107
v_cvt_pk_bf16_f32 v104, v104, v105
v_exp_f32 v108, v108
v_cndmask_b32_e64 v133, v133, v14, s[94:95]
v_add_f32 v5, v5, v106
v_add_f32 v5, v5, v107
v_exp_f32 v109, v109
v_cvt_pk_bf16_f32 v105, v106, v107
v_cndmask_b32_e64 v134, v134, v14, s[96:97]
v_exp_f32 v110, v110
v_add_f32 v5, v5, v108
v_add_f32 v5, v5, v109
v_exp_f32 v111, v111
v_cndmask_b32_e64 v135, v135, v14, s[98:99]
v_cvt_pk_bf16_f32 v106, v108, v109
v_add_f32 v5, v5, v110
v_add_f32 v5, v5, v111
v_cvt_pk_bf16_f32 v107, v110, v111
L_p3_d0m_top:
s_waitcnt lgkmcnt(0)
v_mfma_f32_16x16x32_bf16 v[144:147], a[128:131], v[16:19], 0
s_add_u32 m0, s73, 0
ds_read_b128 a[192:195], v11 offset:16384
v_mfma_f32_16x16x32_bf16 v[152:155], a[128:131], v[32:35], 0
v_exp_f32 v112, v112
v_mfma_f32_16x16x32_bf16 v[168:171], a[128:131], v[64:67], 0
v_exp_f32 v113, v113
MV 144,a,132,v,20
ds_read_b128 a[196:199], v11 offset:17408
buffer_load_dwordx4 v12, s[56:59], s71 offen offset:0 sc1 lds
MV 152,a,132,v,36
v_exp_f32 v114, v114
MV 168,a,132,v,68
v_add_f32 v2, v2, v112
v_add_f32 v2, v2, v113
MV 144,a,136,v,24
v_exp_f32 v115, v115
MV 152,a,136,v,40
ds_read_b128 a[200:203], v11 offset:18432
v_cvt_pk_bf16_f32 v112, v112, v113
MV 168,a,136,v,72
v_exp_f32 v116, v116
MV 144,a,140,v,28
ds_read_b128 a[204:207], v11 offset:19456
v_add_f32 v2, v2, v114
MV 152,a,140,v,44
ds_read_b128 a[208:211], v11 offset:20480
v_add_f32 v2, v2, v115
MV 168,a,140,v,76
v_exp_f32 v117, v117
v_mfma_f32_16x16x32_bf16 v[148:151], a[144:147], v[16:19], 0
buffer_load_dwordx4 v12, s[56:59], s71 offen offset:1024 sc1 lds
v_cvt_pk_bf16_f32 v113, v114, v115
v_mfma_f32_16x16x32_bf16 v[156:159], a[144:147], v[32:35], 0
v_exp_f32 v118, v118
v_mfma_f32_16x16x32_bf16 v[172:175], a[144:147], v[64:67], 0
v_add_f32 v2, v2, v116
v_add_f32 v2, v2, v117
MV 148,a,148,v,20
v_exp_f32 v119, v119
MV 156,a,148,v,36
ds_read_b128 a[212:215], v11 offset:21504
v_cvt_pk_bf16_f32 v114, v116, v117
MV 172,a,148,v,68
v_exp_f32 v120, v120
MV 148,a,152,v,24
v_add_f32 v2, v2, v118
v_add_f32 v2, v2, v119
MV 156,a,152,v,40
v_exp_f32 v121, v121
MV 172,a,152,v,72
ds_read_b128 a[216:219], v11 offset:22528
v_cvt_pk_bf16_f32 v115, v118, v119
MV 148,a,156,v,28
v_exp_f32 v122, v122
MV 156,a,156,v,44
ds_read_b128 a[220:223], v11 offset:23552
v_add_f32 v3, v3, v120
MV 172,a,156,v,76
ds_read_b128 a[224:227], v11 offset:24576
v_add_f32 v3, v3, v121
v_mfma_f32_16x16x32_bf16 v[176:179], a[160:163], v[16:19], 0
v_exp_f32 v123, v123
v_mfma_f32_16x16x32_bf16 v[184:187], a[160:163], v[32:35], 0
buffer_load_dwordx4 v12, s[56:59], s71 offen offset:2048 sc1 lds
v_cvt_pk_bf16_f32 v120, v120, v121
v_mfma_f32_16x16x32_bf16 v[200:203], a[160:163], v[64:67], 0
v_exp_f32 v124, v124
MV 176,a,164,v,20
v_add_f32 v3, v3, v122
v_add_f32 v3, v3, v123
MV 184,a,164,v,36
v_exp_f32 v125, v125
MV 200,a,164,v,68
ds_read_b128 a[228:231], v11 offset:25600
v_cvt_pk_bf16_f32 v121, v122, v123
MV 176,a,168,v,24
v_exp_f32 v126, v126
MV 184,a,168,v,40
v_add_f32 v3, v3, v124
v_add_f32 v3, v3, v125
MV 200,a,168,v,72
v_exp_f32 v127, v127
MV 176,a,172,v,28
ds_read_b128 a[232:235], v11 offset:26624
v_cvt_pk_bf16_f32 v122, v124, v125
MV 184,a,172,v,44
v_exp_f32 v128, v128
MV 200,a,172,v,76
ds_read_b128 a[236:239], v11 offset:27648
v_add_f32 v3, v3, v126
v_mfma_f32_16x16x32_bf16 v[180:183], a[176:179], v[16:19], 0
ds_read_b128 a[240:243], v11 offset:28672
v_add_f32 v3, v3, v127
v_mfma_f32_16x16x32_bf16 v[188:191], a[176:179], v[32:35], 0
v_exp_f32 v129, v129
v_mfma_f32_16x16x32_bf16 v[204:207], a[176:179], v[64:67], 0
ds_read_b128 a[244:247], v11 offset:29696
v_cvt_pk_bf16_f32 v123, v126, v127
MV 180,a,180,v,20
v_exp_f32 v130, v130
MV 188,a,180,v,36
v_add_f32 v4, v4, v128
v_add_f32 v4, v4, v129
MV 204,a,180,v,68
v_exp_f32 v131, v131
MV 180,a,184,v,24
buffer_load_dwordx4 v12, s[56:59], s71 offen offset:3072 sc1 lds
v_cvt_pk_bf16_f32 v128, v128, v129
MV 188,a,184,v,40
v_exp_f32 v132, v132
MV 204,a,184,v,72
v_add_f32 v4, v4, v130
v_add_f32 v4, v4, v131
MV 180,a,188,v,28
ds_read_b128 a[248:251], v11 offset:30720
v_add_u32 v246, -64, v239
MV 188,a,188,v,44
v_exp_f32 v133, v133
MV 204,a,188,v,76
ds_read_b128 a[252:255], v11 offset:31744
s_add_u32 s71, s71, 16384
v_cvt_pk_bf16_f32 v129, v130, v131
v_exp_f32 v134, v134
v_cmp_gt_i32_e64 s[84:85], 0, v246
v_add_f32 v4, v4, v132
v_cmp_gt_i32_e64 s[86:87], 1, v246
v_add_f32 v4, v4, v133
v_exp_f32 v135, v135
v_cmp_gt_i32_e64 s[88:89], 2, v246
v_cvt_pk_bf16_f32 v130, v132, v133
v_exp_f32 v136, v136
v_cmp_gt_i32_e64 s[90:91], 3, v246
v_add_f32 v4, v4, v134
v_cndmask_b32_e64 v168, v168, v14, s[84:85]
v_add_f32 v4, v4, v135
v_exp_f32 v137, v137
v_cndmask_b32_e64 v169, v169, v14, s[86:87]
v_cvt_pk_bf16_f32 v131, v134, v135
v_exp_f32 v138, v138
v_cndmask_b32_e64 v170, v170, v14, s[88:89]
v_add_f32 v5, v5, v136
v_cndmask_b32_e64 v171, v171, v14, s[90:91]
v_add_f32 v5, v5, v137
v_exp_f32 v139, v139
v_add_u32 v247, -80, v239
v_cvt_pk_bf16_f32 v136, v136, v137
v_exp_f32 v140, v140
v_cmp_gt_i32_e64 s[92:93], 0, v247
v_add_f32 v5, v5, v138
v_cmp_gt_i32_e64 s[94:95], 1, v247
v_add_f32 v5, v5, v139
v_exp_f32 v141, v141
v_cmp_gt_i32_e64 s[96:97], 2, v247
v_cvt_pk_bf16_f32 v137, v138, v139
v_exp_f32 v142, v142
v_cmp_gt_i32_e64 s[98:99], 3, v247
v_add_f32 v5, v5, v140
v_cndmask_b32_e64 v172, v172, v14, s[92:93]
v_add_f32 v5, v5, v141
v_exp_f32 v143, v143
v_cndmask_b32_e64 v173, v173, v14, s[94:95]
v_cvt_pk_bf16_f32 v138, v140, v141
v_add_f32 v5, v5, v142
v_cndmask_b32_e64 v174, v174, v14, s[96:97]
v_add_f32 v5, v5, v143
v_cvt_pk_bf16_f32 v139, v142, v143
v_cndmask_b32_e64 v175, v175, v14, s[98:99]
s_waitcnt vmcnt(16) lgkmcnt(0)
MA 0,a,192,v,80
s_barrier
MA 32,a,192,v,88
s_add_u32 m0, s72, 0
ds_read_b128 a[128:131], v10 offset:16384
MA 4,a,196,v,80
ds_read_b128 a[132:135], v10 offset:17408
buffer_load_dwordx4 v12, s[52:55], s71 offen offset:0 sc1 lds
MA 36,a,196,v,88
v_exp_f32 v144, v144
MA 8,a,200,v,80
v_exp_f32 v145, v145
MA 40,a,200,v,88
v_exp_f32 v146, v146
MA 12,a,204,v,80
ds_read_b128 a[136:139], v10 offset:18432
v_add_f32 v2, v2, v144
MA 44,a,204,v,88
v_add_f32 v2, v2, v145
v_add_u32 v246, -96, v239
MA 16,a,208,v,80
v_exp_f32 v147, v147
MA 48,a,208,v,88
ds_read_b128 a[140:143], v10 offset:19456
v_cvt_pk_bf16_f32 v144, v144, v145
MA 20,a,212,v,80
ds_read_b128 a[144:147], v10 offset:20480
v_cmp_gt_i32_e64 s[84:85], 0, v246
MA 52,a,212,v,88
v_exp_f32 v148, v148
MA 24,a,216,v,80
v_add_f32 v2, v2, v146
v_add_f32 v2, v2, v147
MA 56,a,216,v,88
buffer_load_dwordx4 v12, s[52:55], s71 offen offset:1024 sc1 lds
v_cmp_gt_i32_e64 s[86:87], 1, v246
MA 28,a,220,v,80
v_exp_f32 v149, v149
MA 60,a,220,v,88
ds_read_b128 a[148:151], v10 offset:21504
v_cvt_pk_bf16_f32 v145, v146, v147
MA 92,a,220,v,96
v_exp_f32 v150, v150
MA 124,a,220,v,104
v_add_f32 v2, v2, v148
v_cmp_gt_i32_e64 s[88:89], 2, v246
MA 88,a,216,v,96
ds_read_b128 a[152:155], v10 offset:22528
v_add_f32 v2, v2, v149
MA 120,a,216,v,104
v_exp_f32 v151, v151
MA 84,a,212,v,96
v_cvt_pk_bf16_f32 v146, v148, v149
v_cmp_gt_i32_e64 s[90:91], 3, v246
MA 116,a,212,v,104
v_exp_f32 v152, v152
MA 80,a,208,v,96
ds_read_b128 a[156:159], v10 offset:23552
v_add_f32 v2, v2, v150
MA 112,a,208,v,104
v_add_f32 v2, v2, v151
v_cndmask_b32_e64 v200, v200, v14, s[84:85]
MA 76,a,204,v,96
v_exp_f32 v153, v153
MA 108,a,204,v,104
ds_read_b128 a[160:163], v10 offset:24576
v_cvt_pk_bf16_f32 v147, v150, v151
MA 72,a,200,v,96
buffer_load_dwordx4 v12, s[52:55], s71 offen offset:2048 sc1 lds
v_cndmask_b32_e64 v201, v201, v14, s[86:87]
MA 104,a,200,v,104
v_exp_f32 v154, v154
MA 68,a,196,v,96
ds_read_b128 a[164:167], v10 offset:25600
v_add_f32 v3, v3, v152
MA 100,a,196,v,104
v_add_f32 v3, v3, v153
v_cndmask_b32_e64 v202, v202, v14, s[88:89]
MA 64,a,192,v,96
v_exp_f32 v155, v155
MA 96,a,192,v,104
ds_read_b128 a[168:171], v10 offset:26624
v_cvt_pk_bf16_f32 v152, v152, v153
MA 0,a,224,v,112
v_exp_f32 v156, v156
MA 32,a,224,v,120
v_add_f32 v3, v3, v154
v_cndmask_b32_e64 v203, v203, v14, s[90:91]
MA 4,a,228,v,112
ds_read_b128 a[172:175], v10 offset:27648
v_add_f32 v3, v3, v155
MA 36,a,228,v,120
v_exp_f32 v157, v157
MA 8,a,232,v,112
v_cvt_pk_bf16_f32 v153, v154, v155
v_add_u32 v247, -112, v239
MA 40,a,232,v,120
v_exp_f32 v158, v158
MA 12,a,236,v,112
ds_read_b128 a[176:179], v10 offset:28672
v_add_f32 v3, v3, v156
MA 44,a,236,v,120
v_add_f32 v3, v3, v157
v_cmp_gt_i32_e64 s[92:93], 0, v247
MA 16,a,240,v,112
v_exp_f32 v159, v159
MA 48,a,240,v,120
ds_read_b128 a[180:183], v10 offset:29696
buffer_load_dwordx4 v12, s[52:55], s71 offen offset:3072 sc1 lds
MA 20,a,244,v,112
v_cvt_pk_bf16_f32 v154, v156, v157
v_cmp_gt_i32_e64 s[94:95], 1, v247
MA 52,a,244,v,120
v_exp_f32 v168, v168
MA 24,a,248,v,112
ds_read_b128 a[184:187], v10 offset:30720
v_add_f32 v3, v3, v158
MA 56,a,248,v,120
v_add_f32 v3, v3, v159
v_cmp_gt_i32_e64 s[96:97], 2, v247
MA 28,a,252,v,112
v_exp_f32 v169, v169
MA 60,a,252,v,120
ds_read_b128 a[188:191], v10 offset:31744
v_cvt_pk_bf16_f32 v155, v158, v159
MA 92,a,252,v,128
v_exp_f32 v170, v170
MA 124,a,252,v,136
v_add_f32 v5, v5, v168
v_cmp_gt_i32_e64 s[98:99], 3, v247
MA 88,a,248,v,128
s_cmp_eq_u32 s70, 7
v_add_f32 v5, v5, v169
MA 120,a,248,v,136
v_exp_f32 v171, v171
MA 84,a,244,v,128
v_cvt_pk_bf16_f32 v168, v168, v169
v_cndmask_b32_e64 v204, v204, v14, s[92:93]
MA 116,a,244,v,136
v_exp_f32 v172, v172
MA 80,a,240,v,128
v_add_f32 v5, v5, v170
v_add_f32 v5, v5, v171
MA 112,a,240,v,136
v_exp_f32 v173, v173
MA 76,a,236,v,128
v_cvt_pk_bf16_f32 v169, v170, v171
v_cndmask_b32_e64 v205, v205, v14, s[94:95]
MA 108,a,236,v,136
v_exp_f32 v174, v174
MA 72,a,232,v,128
v_add_f32 v5, v5, v172
v_cndmask_b32_e64 v206, v206, v14, s[96:97]
MA 104,a,232,v,136
v_add_f32 v5, v5, v173
v_cndmask_b32_e64 v207, v207, v14, s[98:99]
MA 68,a,228,v,128
v_exp_f32 v175, v175
MA 100,a,228,v,136
v_cvt_pk_bf16_f32 v170, v172, v173
v_add_f32 v5, v5, v174
MA 64,a,224,v,128
v_add_f32 v5, v5, v175
v_cvt_pk_bf16_f32 v171, v174, v175
MA 96,a,224,v,136
s_cbranch_scc1 L_p3_mxm_top
s_waitcnt lgkmcnt(0)
v_xor_b32 v11, 0x8000, v11
v_mfma_f32_16x16x32_bf16 v[80:83], a[128:131], v[16:19], 0
s_add_u32 m0, s73, 16384
ds_read_b128 a[192:195], v11 offset:0
v_mfma_f32_16x16x32_bf16 v[88:91], a[128:131], v[32:35], 0
v_exp_f32 v176, v176
v_mfma_f32_16x16x32_bf16 v[84:87], a[144:147], v[16:19], 0
v_exp_f32 v177, v177
v_mfma_f32_16x16x32_bf16 v[92:95], a[144:147], v[32:35], 0
ds_read_b128 a[196:199], v11 offset:1024
buffer_load_dwordx4 v12, s[56:59], s71 offen offset:0 sc1 lds
v_mfma_f32_16x16x32_bf16 v[112:115], a[160:163], v[16:19], 0
v_exp_f32 v178, v178
v_mfma_f32_16x16x32_bf16 v[120:123], a[160:163], v[32:35], 0
v_add_f32 v2, v2, v176
v_add_f32 v2, v2, v177
v_mfma_f32_16x16x32_bf16 v[116:119], a[176:179], v[16:19], 0
ds_read_b128 a[200:203], v11 offset:2048
ds_read_b128 a[204:207], v11 offset:3072
v_mfma_f32_16x16x32_bf16 v[124:127], a[176:179], v[32:35], 0
v_exp_f32 v179, v179
MV 116,a,180,v,20
ds_read_b128 a[208:211], v11 offset:4096
v_cvt_pk_bf16_f32 v176, v176, v177
MV 124,a,180,v,36
v_exp_f32 v180, v180
MV 112,a,164,v,20
v_add_f32 v2, v2, v178
v_add_f32 v2, v2, v179
MV 120,a,164,v,36
v_exp_f32 v181, v181
MV 84,a,148,v,20
buffer_load_dwordx4 v12, s[56:59], s71 offen offset:1024 sc1 lds
v_cvt_pk_bf16_f32 v177, v178, v179
MV 92,a,148,v,36
v_exp_f32 v182, v182
MV 80,a,132,v,20
ds_read_b128 a[212:215], v11 offset:5120
v_add_f32 v2, v2, v180
MV 88,a,132,v,36
ds_read_b128 a[216:219], v11 offset:6144
v_add_f32 v2, v2, v181
MV 80,a,136,v,24
v_exp_f32 v183, v183
MV 88,a,136,v,40
ds_read_b128 a[220:223], v11 offset:7168
v_cvt_pk_bf16_f32 v178, v180, v181
MV 84,a,152,v,24
v_exp_f32 v184, v184
MV 92,a,152,v,40
v_add_f32 v2, v2, v182
v_add_f32 v2, v2, v183
MV 112,a,168,v,24
ds_read_b128 a[224:227], v11 offset:8192
buffer_load_dwordx4 v12, s[56:59], s71 offen offset:2048 sc1 lds
MV 120,a,168,v,40
v_exp_f32 v185, v185
MV 116,a,184,v,24
ds_read_b128 a[228:231], v11 offset:9216
v_cvt_pk_bf16_f32 v179, v182, v183
MV 124,a,184,v,40
v_exp_f32 v186, v186
MV 116,a,188,v,28
v_add_f32 v3, v3, v184
v_add_f32 v3, v3, v185
MV 124,a,188,v,44
v_exp_f32 v187, v187
MV 112,a,172,v,28
ds_read_b128 a[232:235], v11 offset:10240
v_cvt_pk_bf16_f32 v184, v184, v185
MV 120,a,172,v,44
v_exp_f32 v188, v188
MV 84,a,156,v,28
ds_read_b128 a[236:239], v11 offset:11264
v_add_f32 v3, v3, v186
MV 92,a,156,v,44
buffer_load_dwordx4 v12, s[56:59], s71 offen offset:3072 sc1 lds
v_add_f32 v3, v3, v187
MV 80,a,140,v,28
v_exp_f32 v189, v189
MV 88,a,140,v,44
ds_read_b128 a[240:243], v11 offset:12288
ds_read_b128 a[244:247], v11 offset:13312
ds_read_b128 a[248:251], v11 offset:14336
ds_read_b128 a[252:255], v11 offset:15360
s_add_u32 s71, s71, 16384
s_xor_b32 s73, s73, 0x8000
v_cvt_pk_bf16_f32 v185, v186, v187
v_exp_f32 v190, v190
v_add_f32 v3, v3, v188
v_add_f32 v3, v3, v189
v_exp_f32 v191, v191
v_cvt_pk_bf16_f32 v186, v188, v189
v_exp_f32 v200, v200
v_add_f32 v3, v3, v190
v_add_f32 v3, v3, v191
v_exp_f32 v201, v201
v_cvt_pk_bf16_f32 v187, v190, v191
v_exp_f32 v202, v202
v_add_f32 v5, v5, v200
v_add_f32 v5, v5, v201
v_exp_f32 v203, v203
v_cvt_pk_bf16_f32 v200, v200, v201
v_exp_f32 v204, v204
v_add_f32 v5, v5, v202
v_add_f32 v5, v5, v203
v_exp_f32 v205, v205
v_cvt_pk_bf16_f32 v201, v202, v203
v_exp_f32 v206, v206
v_add_f32 v5, v5, v204
v_add_f32 v5, v5, v205
v_exp_f32 v207, v207
v_cvt_pk_bf16_f32 v202, v204, v205
v_add_f32 v5, v5, v206
v_add_f32 v5, v5, v207
v_cvt_pk_bf16_f32 v203, v206, v207
s_waitcnt vmcnt(16) lgkmcnt(0)
MA 0,a,192,v,144
s_barrier
v_xor_b32 v10, 0x8000, v10
MA 32,a,192,v,152
s_add_u32 m0, s72, 16384
ds_read_b128 a[128:131], v10 offset:0
MA 4,a,196,v,144
buffer_load_dwordx4 v12, s[52:55], s71 offen offset:0 sc1 lds
v_lshrrev_b32 v249, 2, v1
MA 36,a,196,v,152
ds_read_b128 a[132:135], v10 offset:1024
v_and_b32 v248, 7, v249
MA 8,a,200,v,144
v_exp_f32 v80, v80
MA 40,a,200,v,152
v_lshlrev_b32 v249, 8, v249
v_and_b32 v250, 3, v1
MA 12,a,204,v,144
ds_read_b128 a[136:139], v10 offset:2048
v_lshl_add_u32 v249, v250, 3, v249
MA 44,a,204,v,152
v_exp_f32 v81, v81
MA 16,a,208,v,144
s_lshl_b32 s36, s3, 13
s_add_u32 s36, s36, 131072
MA 48,a,208,v,152
ds_read_b128 a[140:143], v10 offset:3072
v_add_u32 v249, s36, v249
MA 20,a,212,v,144
v_exp_f32 v82, v82
MA 52,a,212,v,152
s_waitcnt vmcnt(13)
v_xor_b32 v250, 0, v248
MA 24,a,216,v,144
ds_read_b128 a[144:147], v10 offset:4096
v_lshl_add_u32 v250, v250, 5, v249
MA 56,a,216,v,152
v_exp_f32 v83, v83
MA 28,a,220,v,144
TR 96,250,0
TR 98,250,4096
MA 60,a,220,v,152
ds_read_b128 a[148:151], v10 offset:5120
v_xor_b32 v250, 1, v248
MA 124,a,220,v,168
buffer_load_dwordx4 v12, s[52:55], s71 offen offset:1024 sc1 lds
v_cvt_pk_bf16_f32 v80, v80, v81
MA 120,a,216,v,168
v_lshl_add_u32 v250, v250, 5, v249
TR 100,250,0
MA 116,a,212,v,168
TR 102,250,4096
v_xor_b32 v250, 2, v248
MA 112,a,208,v,168
v_exp_f32 v84, v84
MA 108,a,204,v,168
ds_read_b128 a[152:155], v10 offset:6144
v_lshl_add_u32 v250, v250, 5, v249
MA 104,a,200,v,168
TR 104,250,0
TR 106,250,4096
MA 100,a,196,v,168
v_exp_f32 v85, v85
MA 96,a,192,v,168
ds_read_b128 a[156:159], v10 offset:7168
v_cvt_pk_bf16_f32 v81, v82, v83
MA 0,a,224,v,176
v_xor_b32 v250, 3, v248
v_lshl_add_u32 v250, v250, 5, v249
MA 32,a,224,v,184
ds_read_b128 a[160:163], v10 offset:8192
TR 108,250,0
MA 4,a,228,v,176
TR 110,250,4096
v_xor_b32 v250, 4, v248
MA 36,a,228,v,184
v_exp_f32 v86, v86
MA 8,a,232,v,176
ds_read_b128 a[164:167], v10 offset:9216
v_lshl_add_u32 v250, v250, 5, v249
MA 40,a,232,v,184
buffer_load_dwordx4 v12, s[52:55], s71 offen offset:2048 sc1 lds
TR 128,250,0
MA 12,a,236,v,176
TR 130,250,4096
v_xor_b32 v250, 5, v248
MA 44,a,236,v,184
v_exp_f32 v87, v87
MA 16,a,240,v,176
ds_read_b128 a[168:171], v10 offset:10240
v_cvt_pk_bf16_f32 v82, v84, v85
MA 48,a,240,v,184
v_lshl_add_u32 v250, v250, 5, v249
TR 132,250,0
MA 20,a,244,v,176
TR 134,250,4096
v_xor_b32 v250, 6, v248
MA 52,a,244,v,184
v_exp_f32 v88, v88
MA 24,a,248,v,176
ds_read_b128 a[172:175], v10 offset:11264
v_lshl_add_u32 v250, v250, 5, v249
MA 56,a,248,v,184
TR 136,250,0
TR 138,250,4096
MA 28,a,252,v,176
v_exp_f32 v89, v89
MA 60,a,252,v,184
ds_read_b128 a[176:179], v10 offset:12288
v_xor_b32 v250, 7, v248
MA 124,a,252,v,200
v_cvt_pk_bf16_f32 v83, v86, v87
v_lshl_add_u32 v250, v250, 5, v249
MA 120,a,248,v,200
ds_read_b128 a[180:183], v10 offset:13312
TR 140,250,0
MA 116,a,244,v,200
buffer_load_dwordx4 v12, s[52:55], s71 offen offset:3072 sc1 lds
TR 142,250,4096
MA 112,a,240,v,200
v_exp_f32 v90, v90
MA 108,a,236,v,200
s_add_u32 s32, s40, 100663296
s_addc_u32 s33, s41, 0
MA 104,a,232,v,200
ds_read_b128 a[184:187], v10 offset:14336
s_mov_b32 s34, 8388608
MA 100,a,228,v,200
s_mov_b32 s35, 0x20000
s_and_b32 s36, s2, 7
MA 96,a,224,v,200
ds_read_b128 a[188:191], v10 offset:15360
s_xor_b32 s72, s72, 0x8000
v_exp_f32 v91, v91
s_lshl_b32 s36, s36, 20
s_lshr_b32 s37, s2, 3
v_cvt_pk_bf16_f32 v88, v88, v89
s_lshl_b32 s37, s37, 15
v_exp_f32 v92, v92
s_add_u32 s36, s36, s37
s_lshl_b32 s37, s3, 12
s_add_u32 s36, s36, s37
v_exp_f32 v93, v93
s_add_u32 s37, s36, 4096
s_waitcnt lgkmcnt(15)
buffer_store_dwordx4 v[96:99], v12, s[32:35], s36 offen offset:0 sc1
buffer_store_dwordx4 v[100:103], v12, s[32:35], s36 offen offset:1024 sc1
v_cvt_pk_bf16_f32 v89, v90, v91
buffer_store_dwordx4 v[104:107], v12, s[32:35], s36 offen offset:2048 sc1
buffer_store_dwordx4 v[108:111], v12, s[32:35], s36 offen offset:3072 sc1
s_waitcnt lgkmcnt(12)
buffer_store_dwordx4 v[128:131], v12, s[32:35], s37 offen offset:0 sc1
v_exp_f32 v94, v94
s_waitcnt lgkmcnt(9)
buffer_store_dwordx4 v[132:135], v12, s[32:35], s37 offen offset:1024 sc1
s_waitcnt lgkmcnt(6)
buffer_store_dwordx4 v[136:139], v12, s[32:35], s37 offen offset:2048 sc1
s_waitcnt lgkmcnt(2)
buffer_store_dwordx4 v[140:143], v12, s[32:35], s37 offen offset:3072 sc1
v_exp_f32 v95, v95
v_lshlrev_b32 v232, 4, v1
v_mov_b32 v235, 0
buffer_load_ushort v234, v235, s[28:31], s42 offen
v_cvt_pk_bf16_f32 v90, v92, v93
buffer_load_dwordx4 v[210:213], v232, s[16:19], 0 offen offset:0
buffer_load_dwordx4 v[216:219], v232, s[16:19], 0 offen offset:1024
v_cvt_pk_bf16_f32 v91, v94, v95
buffer_load_dwordx4 v[222:225], v232, s[16:19], 0 offen offset:2048
buffer_load_dwordx4 v[228:231], v232, s[16:19], 0 offen offset:3072
L_p3_eps:
v_mov_b32 v240, v4
v_mov_b32 v241, v5
s_nop 0
v_permlane32_swap_b32 v4, v240
v_permlane32_swap_b32 v5, v241
v_add_f32 v4, v4, v240
v_add_f32 v5, v5, v241
v_mov_b32 v240, v4
v_mov_b32 v241, v5
s_nop 0
v_permlane16_swap_b32 v4, v240
v_permlane16_swap_b32 v5, v241
v_add_f32 v4, v4, v240
v_add_f32 v5, v5, v241
v_cmp_nle_f32 vcc, 0x30800000, v4
s_nop 0
s_mov_b64 s[78:79], vcc
v_cmp_nge_f32 vcc, 0x4e800000, v4
s_nop 0
s_or_b64 s[78:79], s[78:79], vcc
v_cmp_nle_f32 vcc, 0x30800000, v5
s_nop 0
s_or_b64 s[78:79], s[78:79], vcc
v_cmp_nge_f32 vcc, 0x4e800000, v5
s_nop 0
s_or_b64 s[78:79], s[78:79], vcc
v_rcp_f32 v4, v4
v_rcp_f32 v5, v5
s_add_u32 s80, s101, s76
s_nop 4
v_accvgpr_read_b32 v240, a64
v_accvgpr_read_b32 v241, a65
v_accvgpr_read_b32 v242, a66
v_accvgpr_read_b32 v243, a67
v_accvgpr_read_b32 v244, a68
v_accvgpr_read_b32 v245, a69
v_accvgpr_read_b32 v246, a70
v_accvgpr_read_b32 v247, a71
v_pk_mul_f32 v[240:241], v[240:241], v[4:5] op_sel:[0,0] op_sel_hi:[1,0]
v_pk_mul_f32 v[242:243], v[242:243], v[4:5] op_sel:[0,0] op_sel_hi:[1,0]
v_pk_mul_f32 v[244:245], v[244:245], v[4:5] op_sel:[0,0] op_sel_hi:[1,0]
v_pk_mul_f32 v[246:247], v[246:247], v[4:5] op_sel:[0,0] op_sel_hi:[1,0]
v_cvt_pk_bf16_f32 v248, v240, v241
v_cvt_pk_bf16_f32 v249, v242, v243
v_cvt_pk_bf16_f32 v250, v244, v245
v_cvt_pk_bf16_f32 v251, v246, v247
buffer_store_dwordx4 v[248:251], v15, s[60:63], s101 offen offset:0 sc1
v_accvgpr_read_b32 v240, a72
v_accvgpr_read_b32 v241, a73
v_accvgpr_read_b32 v242, a74
v_accvgpr_read_b32 v243, a75
v_accvgpr_read_b32 v244, a76
v_accvgpr_read_b32 v245, a77
v_accvgpr_read_b32 v246, a78
v_accvgpr_read_b32 v247, a79
v_pk_mul_f32 v[240:241], v[240:241], v[4:5] op_sel:[0,0] op_sel_hi:[1,0]
v_pk_mul_f32 v[242:243], v[242:243], v[4:5] op_sel:[0,0] op_sel_hi:[1,0]
v_pk_mul_f32 v[244:245], v[244:245], v[4:5] op_sel:[0,0] op_sel_hi:[1,0]
v_pk_mul_f32 v[246:247], v[246:247], v[4:5] op_sel:[0,0] op_sel_hi:[1,0]
v_cvt_pk_bf16_f32 v252, v240, v241
v_cvt_pk_bf16_f32 v253, v242, v243
v_cvt_pk_bf16_f32 v254, v244, v245
v_cvt_pk_bf16_f32 v255, v246, v247
buffer_store_dwordx4 v[252:255], v15, s[60:63], s101 offen offset:1024 sc1
v_accvgpr_read_b32 v240, a80
v_accvgpr_read_b32 v241, a81
v_accvgpr_read_b32 v242, a82
v_accvgpr_read_b32 v243, a83
v_accvgpr_read_b32 v244, a84
v_accvgpr_read_b32 v245, a85
v_accvgpr_read_b32 v246, a86
v_accvgpr_read_b32 v247, a87
v_pk_mul_f32 v[240:241], v[240:241], v[4:5] op_sel:[0,0] op_sel_hi:[1,0]
v_pk_mul_f32 v[242:243], v[242:243], v[4:5] op_sel:[0,0] op_sel_hi:[1,0]
v_pk_mul_f32 v[244:245], v[244:245], v[4:5] op_sel:[0,0] op_sel_hi:[1,0]
v_pk_mul_f32 v[246:247], v[246:247], v[4:5] op_sel:[0,0] op_sel_hi:[1,0]
v_cvt_pk_bf16_f32 v248, v240, v241
v_cvt_pk_bf16_f32 v249, v242, v243
v_cvt_pk_bf16_f32 v250, v244, v245
v_cvt_pk_bf16_f32 v251, v246, v247
buffer_store_dwordx4 v[248:251], v15, s[60:63], s101 offen offset:2048 sc1
v_accvgpr_read_b32 v240, a88
v_accvgpr_read_b32 v241, a89
v_accvgpr_read_b32 v242, a90
v_accvgpr_read_b32 v243, a91
v_accvgpr_read_b32 v244, a92
v_accvgpr_read_b32 v245, a93
v_accvgpr_read_b32 v246, a94
v_accvgpr_read_b32 v247, a95
v_pk_mul_f32 v[240:241], v[240:241], v[4:5] op_sel:[0,0] op_sel_hi:[1,0]
v_pk_mul_f32 v[242:243], v[242:243], v[4:5] op_sel:[0,0] op_sel_hi:[1,0]
v_pk_mul_f32 v[244:245], v[244:245], v[4:5] op_sel:[0,0] op_sel_hi:[1,0]
v_pk_mul_f32 v[246:247], v[246:247], v[4:5] op_sel:[0,0] op_sel_hi:[1,0]
v_cvt_pk_bf16_f32 v252, v240, v241
v_cvt_pk_bf16_f32 v253, v242, v243
v_cvt_pk_bf16_f32 v254, v244, v245
v_cvt_pk_bf16_f32 v255, v246, v247
buffer_store_dwordx4 v[252:255], v15, s[60:63], s101 offen offset:3072 sc1
v_accvgpr_read_b32 v240, a96
v_accvgpr_read_b32 v241, a97
v_accvgpr_read_b32 v242, a98
v_accvgpr_read_b32 v243, a99
v_accvgpr_read_b32 v244, a100
v_accvgpr_read_b32 v245, a101
v_accvgpr_read_b32 v246, a102
v_accvgpr_read_b32 v247, a103
v_pk_mul_f32 v[240:241], v[240:241], v[4:5] op_sel:[0,1] op_sel_hi:[1,1]
v_pk_mul_f32 v[242:243], v[242:243], v[4:5] op_sel:[0,1] op_sel_hi:[1,1]
v_pk_mul_f32 v[244:245], v[244:245], v[4:5] op_sel:[0,1] op_sel_hi:[1,1]
v_pk_mul_f32 v[246:247], v[246:247], v[4:5] op_sel:[0,1] op_sel_hi:[1,1]
v_cvt_pk_bf16_f32 v248, v240, v241
v_cvt_pk_bf16_f32 v249, v242, v243
v_cvt_pk_bf16_f32 v250, v244, v245
v_cvt_pk_bf16_f32 v251, v246, v247
buffer_store_dwordx4 v[248:251], v15, s[60:63], s80 offen offset:0 sc1
v_accvgpr_read_b32 v240, a104
v_accvgpr_read_b32 v241, a105
v_accvgpr_read_b32 v242, a106
v_accvgpr_read_b32 v243, a107
v_accvgpr_read_b32 v244, a108
v_accvgpr_read_b32 v245, a109
v_accvgpr_read_b32 v246, a110
v_accvgpr_read_b32 v247, a111
v_pk_mul_f32 v[240:241], v[240:241], v[4:5] op_sel:[0,1] op_sel_hi:[1,1]
v_pk_mul_f32 v[242:243], v[242:243], v[4:5] op_sel:[0,1] op_sel_hi:[1,1]
v_pk_mul_f32 v[244:245], v[244:245], v[4:5] op_sel:[0,1] op_sel_hi:[1,1]
v_pk_mul_f32 v[246:247], v[246:247], v[4:5] op_sel:[0,1] op_sel_hi:[1,1]
v_cvt_pk_bf16_f32 v252, v240, v241
v_cvt_pk_bf16_f32 v253, v242, v243
v_cvt_pk_bf16_f32 v254, v244, v245
v_cvt_pk_bf16_f32 v255, v246, v247
buffer_store_dwordx4 v[252:255], v15, s[60:63], s80 offen offset:1024 sc1
v_accvgpr_read_b32 v240, a112
v_accvgpr_read_b32 v241, a113
v_accvgpr_read_b32 v242, a114
v_accvgpr_read_b32 v243, a115
v_accvgpr_read_b32 v244, a116
v_accvgpr_read_b32 v245, a117
v_accvgpr_read_b32 v246, a118
v_accvgpr_read_b32 v247, a119
v_pk_mul_f32 v[240:241], v[240:241], v[4:5] op_sel:[0,1] op_sel_hi:[1,1]
v_pk_mul_f32 v[242:243], v[242:243], v[4:5] op_sel:[0,1] op_sel_hi:[1,1]
v_pk_mul_f32 v[244:245], v[244:245], v[4:5] op_sel:[0,1] op_sel_hi:[1,1]
v_pk_mul_f32 v[246:247], v[246:247], v[4:5] op_sel:[0,1] op_sel_hi:[1,1]
v_cvt_pk_bf16_f32 v248, v240, v241
v_cvt_pk_bf16_f32 v249, v242, v243
v_cvt_pk_bf16_f32 v250, v244, v245
v_cvt_pk_bf16_f32 v251, v246, v247
buffer_store_dwordx4 v[248:251], v15, s[60:63], s80 offen offset:2048 sc1
v_accvgpr_read_b32 v240, a120
v_accvgpr_read_b32 v241, a121
v_accvgpr_read_b32 v242, a122
v_accvgpr_read_b32 v243, a123
v_accvgpr_read_b32 v244, a124
v_accvgpr_read_b32 v245, a125
v_accvgpr_read_b32 v246, a126
v_accvgpr_read_b32 v247, a127
v_pk_mul_f32 v[240:241], v[240:241], v[4:5] op_sel:[0,1] op_sel_hi:[1,1]
v_pk_mul_f32 v[242:243], v[242:243], v[4:5] op_sel:[0,1] op_sel_hi:[1,1]
v_pk_mul_f32 v[244:245], v[244:245], v[4:5] op_sel:[0,1] op_sel_hi:[1,1]
v_pk_mul_f32 v[246:247], v[246:247], v[4:5] op_sel:[0,1] op_sel_hi:[1,1]
v_cvt_pk_bf16_f32 v252, v240, v241
v_cvt_pk_bf16_f32 v253, v242, v243
v_cvt_pk_bf16_f32 v254, v244, v245
v_cvt_pk_bf16_f32 v255, v246, v247
buffer_store_dwordx4 v[252:255], v15, s[60:63], s80 offen offset:3072 sc1
v_mov_b32 v160, 0x3f803f80
v_mov_b32 v161, 0x3f803f80
v_mov_b32 v162, 0x3f803f80
v_mov_b32 v163, 0x3f803f80
v_mov_b32 v164, 0
v_mov_b32 v165, 0
v_mov_b32 v166, 0
v_mov_b32 v167, 0
v_mov_b32 v168, 0
v_mov_b32 v169, 0
v_mov_b32 v170, 0
v_mov_b32 v171, 0
s_and_b32 s36, s2, 3
s_lshl_b32 s36, s36, 1
s_sub_u32 s32, 14, s36
s_bitcmp1_b32 s2, 4
s_cselect_b32 s36, s32, s36
s_bfe_u32 s32, s2, 0x10003
s_add_u32 s36, s36, s32
s_bfe_u32 s37, s2, 0x10002
s_lshr_b32 s32, s2, 5
s_lshl_b32 s32, s32, 1
s_add_u32 s37, s37, s32
s_lshl_b32 s36, s36, 2
s_add_u32 s36, s36, s3
s_lshl_b32 s37, s37, 7
s_lshl_b32 s32, s36, 16
s_add_u32 s37, s37, s32
s_lshl_b32 s36, s36, 7
v_and_b32 v240, 15, v1
v_bfe_u32 v241, v1, 4, 1
v_lshlrev_b32 v241, 5, v241
v_lshrrev_b32 v242, 5, v1
v_lshl_add_u32 v241, v242, 4, v241
v_lshl_add_u32 v241, v240, 11, v241
v_lshlrev_b32 v240, 2, v240
s_add_u32 s32, s40, 58720256
s_addc_u32 s33, s41, 0
s_mov_b32 s34, 8192
s_mov_b32 s35, 0x20000
buffer_load_dwordx4 v[192:195], v241, s[44:47], s37 offen offset:0
buffer_load_dwordx4 v[196:199], v241, s[44:47], s37 offen offset:64
buffer_load_dword v6, v240, s[32:35], s36 offen offset:0 sc1
s_add_u32 s37, s37, 32768
buffer_load_dwordx4 v[200:203], v241, s[44:47], s37 offen offset:0
buffer_load_dwordx4 v[204:207], v241, s[44:47], s37 offen offset:64
buffer_load_dword v7, v240, s[32:35], s36 offen offset:64 sc1
v_lshlrev_b32 v236, 20, v1
s_lshl_b32 s36, s3, 26
v_add_u32 v236, s36, v236
v_mov_b32 v237, 1
s_lshl_b32 s37, s2, 2
s_getpc_b64 s[38:39]
L_ct_b:
s_add_u32 s38, s38, L_p3_s1m_top - L_ct_b
s_addc_u32 s39, s39, 0
v_mov_b32 v173, s39
v_mov_b32 v172, s38
s_lshr_b32 s38, s2, 3
s_lshl_b32 s38, s38, 2
s_add_u32 s38, s38, s3
s_lshl_b32 s38, s38, 7
v_and_b32 v174, 3, v1
v_lshlrev_b32 v174, 14, v174
v_add_u32 v174, s38, v174
v_min_u32 v174, L_end - L_p3_s1m_top - 4, v174
v_add_co_u32 v172, vcc, v172, v174
s_nop 1
v_addc_co_u32 v173, vcc, 0, v173, vcc
global_load_dword v174, v[172:173], off
s_lshl_b32 s74, s70, 1
s_sub_u32 s74, 13, s74
s_cbranch_scc1 L_p3_s0m_top
.p2align 5
L_p3_s0_top:
s_waitcnt lgkmcnt(0)
v_mfma_f32_16x16x32_bf16 v[144:147], a[128:131], v[16:19], 0
s_add_u32 m0, s73, 0
ds_read_b128 a[192:195], v11 offset:16384
v_mfma_f32_16x16x32_bf16 v[152:155], a[128:131], v[32:35], 0
v_exp_f32 v112, v112
v_mfma_f32_16x16x32_bf16 v[148:151], a[144:147], v[16:19], 0
ds_read_b128 a[196:199], v11 offset:17408
buffer_load_dwordx4 v12, s[56:59], s71 offen offset:0 sc1 lds
v_mfma_f32_16x16x32_bf16 v[156:159], a[144:147], v[32:35], 0
v_exp_f32 v113, v113
v_mfma_f32_16x16x32_bf16 v[176:179], a[160:163], v[16:19], 0
ds_read_b128 a[200:203], v11 offset:18432
ds_read_b128 a[204:207], v11 offset:19456
v_mfma_f32_16x16x32_bf16 v[184:187], a[160:163], v[32:35], 0
v_exp_f32 v114, v114
v_mfma_f32_16x16x32_bf16 v[180:183], a[176:179], v[16:19], 0
v_exp_f32 v115, v115
v_mfma_f32_16x16x32_bf16 v[188:191], a[176:179], v[32:35], 0
ds_read_b128 a[208:211], v11 offset:20480
v_cvt_pk_bf16_f32 v112, v112, v113
MV 180,a,180,v,20
ds_read_b128 a[212:215], v11 offset:21504
buffer_load_dwordx4 v12, s[56:59], s71 offen offset:1024 sc1 lds
MV 188,a,180,v,36
v_exp_f32 v116, v116
MV 176,a,164,v,20
v_exp_f32 v117, v117
MV 184,a,164,v,36
ds_read_b128 a[216:219], v11 offset:22528
ds_read_b128 a[220:223], v11 offset:23552
MV 148,a,148,v,20
ds_read_b128 a[224:227], v11 offset:24576
v_cvt_pk_bf16_f32 v113, v114, v115
MV 156,a,148,v,36
v_exp_f32 v118, v118
MV 144,a,132,v,20
v_exp_f32 v119, v119
MV 152,a,132,v,36
ds_read_b128 a[228:231], v11 offset:25600
buffer_load_dwordx4 v12, s[56:59], s71 offen offset:2048 sc1 lds
MV 144,a,136,v,24
ds_read_b128 a[232:235], v11 offset:26624
v_cvt_pk_bf16_f32 v114, v116, v117
MV 152,a,136,v,40
v_exp_f32 v120, v120
MV 148,a,152,v,24
ds_read_b128 a[236:239], v11 offset:27648
ds_read_b128 a[240:243], v11 offset:28672
MV 156,a,152,v,40
v_exp_f32 v121, v121
MV 176,a,168,v,24
ds_read_b128 a[244:247], v11 offset:29696
v_cvt_pk_bf16_f32 v115, v118, v119
MV 184,a,168,v,40
ds_read_b128 a[248:251], v11 offset:30720
buffer_load_dwordx4 v12, s[56:59], s71 offen offset:3072 sc1 lds
MV 180,a,184,v,24
v_exp_f32 v122, v122
MV 188,a,184,v,40
v_exp_f32 v123, v123
MV 180,a,188,v,28
ds_read_b128 a[252:255], v11 offset:31744
v_cvt_pk_bf16_f32 v120, v120, v121
MV 188,a,188,v,44
v_exp_f32 v124, v124
MV 176,a,172,v,28
v_exp_f32 v125, v125
MV 184,a,172,v,44
s_add_u32 s71, s71, 16384
v_cvt_pk_bf16_f32 v121, v122, v123
MV 148,a,156,v,28
v_exp_f32 v126, v126
MV 156,a,156,v,44
v_exp_f32 v127, v127
MV 144,a,140,v,28
v_cvt_pk_bf16_f32 v122, v124, v125
v_cvt_pk_bf16_f32 v123, v126, v127
MV 152,a,140,v,44
s_waitcnt vmcnt(16) lgkmcnt(0)
MA 0,a,192,v,80
s_barrier
MA 32,a,192,v,88
s_add_u32 m0, s72, 0
ds_read_b128 a[128:131], v10 offset:16384
MA 4,a,196,v,80
ds_read_b128 a[132:135], v10 offset:17408
buffer_load_dwordx4 v12, s[52:55], s71 offen offset:0 sc1 lds
MA 36,a,196,v,88
v_exp_f32 v144, v144
MA 8,a,200,v,80
v_exp_f32 v145, v145
MA 40,a,200,v,88
ds_read_b128 a[136:139], v10 offset:18432
ds_read_b128 a[140:143], v10 offset:19456
MA 12,a,204,v,80
v_exp_f32 v146, v146
MA 44,a,204,v,88
ds_read_b128 a[144:147], v10 offset:20480
buffer_load_dwordx4 v12, s[52:55], s71 offen offset:1024 sc1 lds
MV 164,v,160,v,80
v_exp_f32 v147, v147
MV 168,v,160,v,88
ds_read_b128 a[148:151], v10 offset:21504
v_cvt_pk_bf16_f32 v144, v144, v145
MA 16,a,208,v,80
v_exp_f32 v148, v148
MA 48,a,208,v,88
ds_read_b128 a[152:155], v10 offset:22528
ds_read_b128 a[156:159], v10 offset:23552
MA 20,a,212,v,80
v_exp_f32 v149, v149
MA 52,a,212,v,88
ds_read_b128 a[160:163], v10 offset:24576
v_cvt_pk_bf16_f32 v145, v146, v147
MA 24,a,216,v,80
v_exp_f32 v150, v150
MA 56,a,216,v,88
ds_read_b128 a[164:167], v10 offset:25600
buffer_load_dwordx4 v12, s[52:55], s71 offen offset:2048 sc1 lds
MA 28,a,220,v,80
v_exp_f32 v151, v151
MA 60,a,220,v,88
ds_read_b128 a[168:171], v10 offset:26624
v_cvt_pk_bf16_f32 v146, v148, v149
MA 0,a,224,v,112
ds_read_b128 a[172:175], v10 offset:27648
ds_read_b128 a[176:179], v10 offset:28672
MA 32,a,224,v,120
v_exp_f32 v152, v152
MA 4,a,228,v,112
v_exp_f32 v153, v153
MA 36,a,228,v,120
ds_read_b128 a[180:183], v10 offset:29696
v_cvt_pk_bf16_f32 v147, v150, v151
MA 8,a,232,v,112
ds_read_b128 a[184:187], v10 offset:30720
buffer_load_dwordx4 v12, s[52:55], s71 offen offset:3072 sc1 lds
MA 40,a,232,v,120
v_exp_f32 v154, v154
MA 12,a,236,v,112
v_exp_f32 v155, v155
MA 44,a,236,v,120
ds_read_b128 a[188:191], v10 offset:31744
v_cvt_pk_bf16_f32 v152, v152, v153
MV 164,v,160,v,112
v_exp_f32 v156, v156
MV 168,v,160,v,120
MA 16,a,240,v,112
v_exp_f32 v157, v157
MA 48,a,240,v,120
s_sub_u32 s74, s74, 1
v_cvt_pk_bf16_f32 v153, v154, v155
MA 20,a,244,v,112
v_exp_f32 v158, v158
MA 52,a,244,v,120
MA 24,a,248,v,112
v_exp_f32 v159, v159
MA 56,a,248,v,120
MA 28,a,252,v,112
v_cvt_pk_bf16_f32 v154, v156, v157
v_cvt_pk_bf16_f32 v155, v158, v159
MA 60,a,252,v,120
s_cbranch_scc1 L_p3_s1m_top
s_waitcnt lgkmcnt(0)
v_xor_b32 v11, 0x8000, v11
v_mfma_f32_16x16x32_bf16 v[80:83], a[128:131], v[16:19], 0
s_add_u32 m0, s73, 16384
ds_read_b128 a[192:195], v11 offset:0
v_mfma_f32_16x16x32_bf16 v[88:91], a[128:131], v[32:35], 0
v_exp_f32 v176, v176
v_mfma_f32_16x16x32_bf16 v[84:87], a[144:147], v[16:19], 0
ds_read_b128 a[196:199], v11 offset:1024
buffer_load_dwordx4 v12, s[56:59], s71 offen offset:0 sc1 lds
v_mfma_f32_16x16x32_bf16 v[92:95], a[144:147], v[32:35], 0
v_exp_f32 v177, v177
v_mfma_f32_16x16x32_bf16 v[112:115], a[160:163], v[16:19], 0
ds_read_b128 a[200:203], v11 offset:2048
ds_read_b128 a[204:207], v11 offset:3072
v_mfma_f32_16x16x32_bf16 v[120:123], a[160:163], v[32:35], 0
v_exp_f32 v178, v178
v_mfma_f32_16x16x32_bf16 v[116:119], a[176:179], v[16:19], 0
v_exp_f32 v179, v179
v_mfma_f32_16x16x32_bf16 v[124:127], a[176:179], v[32:35], 0
ds_read_b128 a[208:211], v11 offset:4096
buffer_load_dwordx4 v12, s[56:59], s71 offen offset:1024 sc1 lds
MV 116,a,180,v,20
ds_read_b128 a[212:215], v11 offset:5120
v_cvt_pk_bf16_f32 v176, v176, v177
MV 124,a,180,v,36
v_exp_f32 v180, v180
MV 112,a,164,v,20
v_exp_f32 v181, v181
MV 120,a,164,v,36
ds_read_b128 a[216:219], v11 offset:6144
ds_read_b128 a[220:223], v11 offset:7168
MV 84,a,148,v,20
buffer_load_dwordx4 v12, s[56:59], s71 offen offset:2048 sc1 lds
v_cvt_pk_bf16_f32 v177, v178, v179
MV 92,a,148,v,36
v_exp_f32 v182, v182
MV 80,a,132,v,20
ds_read_b128 a[224:227], v11 offset:8192
ds_read_b128 a[228:231], v11 offset:9216
MV 88,a,132,v,36
v_exp_f32 v183, v183
MV 80,a,136,v,24
ds_read_b128 a[232:235], v11 offset:10240
v_cvt_pk_bf16_f32 v178, v180, v181
MV 88,a,136,v,40
v_exp_f32 v184, v184
MV 84,a,152,v,24
ds_read_b128 a[236:239], v11 offset:11264
buffer_load_dwordx4 v12, s[56:59], s71 offen offset:3072 sc1 lds
MV 92,a,152,v,40
v_exp_f32 v185, v185
MV 112,a,168,v,24
ds_read_b128 a[240:243], v11 offset:12288
v_cvt_pk_bf16_f32 v179, v182, v183
MV 120,a,168,v,40
ds_read_b128 a[244:247], v11 offset:13312
ds_read_b128 a[248:251], v11 offset:14336
MV 116,a,184,v,24
v_exp_f32 v186, v186
MV 124,a,184,v,40
v_exp_f32 v187, v187
MV 116,a,188,v,28
ds_read_b128 a[252:255], v11 offset:15360
s_add_u32 s71, s71, 16384
MV 124,a,188,v,44
s_xor_b32 s73, s73, 0x8000
v_cvt_pk_bf16_f32 v184, v184, v185
MV 112,a,172,v,28
v_exp_f32 v188, v188
MV 120,a,172,v,44
v_exp_f32 v189, v189
MV 84,a,156,v,28
v_cvt_pk_bf16_f32 v185, v186, v187
MV 92,a,156,v,44
v_exp_f32 v190, v190
MV 80,a,140,v,28
v_exp_f32 v191, v191
MV 88,a,140,v,44
v_cvt_pk_bf16_f32 v186, v188, v189
v_cvt_pk_bf16_f32 v187, v190, v191
s_waitcnt vmcnt(16) lgkmcnt(0)
MA 0,a,192,v,144
s_barrier
v_xor_b32 v10, 0x8000, v10
MA 32,a,192,v,152
s_add_u32 m0, s72, 16384
ds_read_b128 a[128:131], v10 offset:0
MA 4,a,196,v,144
ds_read_b128 a[132:135], v10 offset:1024
buffer_load_dwordx4 v12, s[52:55], s71 offen offset:0 sc1 lds
MA 36,a,196,v,152
v_exp_f32 v80, v80
MA 8,a,200,v,144
v_exp_f32 v81, v81
MA 40,a,200,v,152
ds_read_b128 a[136:139], v10 offset:2048
ds_read_b128 a[140:143], v10 offset:3072
MA 12,a,204,v,144
v_exp_f32 v82, v82
MA 44,a,204,v,152
ds_read_b128 a[144:147], v10 offset:4096
buffer_load_dwordx4 v12, s[52:55], s71 offen offset:1024 sc1 lds
MV 164,v,160,v,144
v_exp_f32 v83, v83
MV 168,v,160,v,152
ds_read_b128 a[148:151], v10 offset:5120
v_cvt_pk_bf16_f32 v80, v80, v81
MA 16,a,208,v,144
v_exp_f32 v84, v84
MA 48,a,208,v,152
ds_read_b128 a[152:155], v10 offset:6144
buffer_load_dwordx4 v12, s[52:55], s71 offen offset:2048 sc1 lds
MA 20,a,212,v,144
v_exp_f32 v85, v85
MA 52,a,212,v,152
ds_read_b128 a[156:159], v10 offset:7168
v_cvt_pk_bf16_f32 v81, v82, v83
MA 24,a,216,v,144
v_exp_f32 v86, v86
MA 56,a,216,v,152
ds_read_b128 a[160:163], v10 offset:8192
ds_read_b128 a[164:167], v10 offset:9216
MA 28,a,220,v,144
v_exp_f32 v87, v87
MA 60,a,220,v,152
ds_read_b128 a[168:171], v10 offset:10240
buffer_load_dwordx4 v12, s[52:55], s71 offen offset:3072 sc1 lds
MA 0,a,224,v,176
ds_read_b128 a[172:175], v10 offset:11264
v_cvt_pk_bf16_f32 v82, v84, v85
MA 32,a,224,v,184
v_exp_f32 v88, v88
MA 4,a,228,v,176
v_exp_f32 v89, v89
MA 36,a,228,v,184
ds_read_b128 a[176:179], v10 offset:12288
s_xor_b32 s72, s72, 0x8000
MA 8,a,232,v,176
ds_read_b128 a[180:183], v10 offset:13312
v_cvt_pk_bf16_f32 v83, v86, v87
MA 40,a,232,v,184
v_exp_f32 v90, v90
MA 12,a,236,v,176
ds_read_b128 a[184:187], v10 offset:14336
ds_read_b128 a[188:191], v10 offset:15360
MA 44,a,236,v,184
v_exp_f32 v91, v91
MV 164,v,160,v,176
buffer_store_dword v237, v236, s[8:11], s37 offen offset:1024 sc1
v_cvt_pk_bf16_f32 v88, v88, v89
MV 168,v,160,v,184
v_exp_f32 v92, v92
MA 16,a,240,v,176
v_exp_f32 v93, v93
MA 48,a,240,v,184
MA 20,a,244,v,176
global_load_dword v174, v[172:173], off
v_cvt_pk_bf16_f32 v89, v90, v91
MA 52,a,244,v,184
v_exp_f32 v94, v94
MA 24,a,248,v,176
v_exp_f32 v95, v95
MA 56,a,248,v,184
MA 28,a,252,v,176
v_cvt_pk_bf16_f32 v90, v92, v93
v_cvt_pk_bf16_f32 v91, v94, v95
MA 60,a,252,v,184
s_branch L_p3_s0_top
L_p3_s1m_top:
s_waitcnt lgkmcnt(0)
v_xor_b32 v11, 0x8000, v11
v_mfma_f32_16x16x32_bf16 v[80:83], a[128:131], v[16:19], 0
ds_read_b128 a[192:195], v11 offset:0
ds_read_b128 a[196:199], v11 offset:1024
v_mfma_f32_16x16x32_bf16 v[88:91], a[128:131], v[32:35], 0
v_exp_f32 v176, v176
MV 80,a,132,v,20
v_exp_f32 v177, v177
MV 88,a,132,v,36
ds_read_b128 a[200:203], v11 offset:2048
ds_read_b128 a[204:207], v11 offset:3072
MV 80,a,136,v,24
v_exp_f32 v178, v178
MV 88,a,136,v,40
v_exp_f32 v179, v179
MV 80,a,140,v,28
ds_read_b128 a[208:211], v11 offset:4096
v_cvt_pk_bf16_f32 v176, v176, v177
MV 88,a,140,v,44
ds_read_b128 a[212:215], v11 offset:5120
ds_read_b128 a[216:219], v11 offset:6144
v_mfma_f32_16x16x32_bf16 v[84:87], a[144:147], v[16:19], 0
v_exp_f32 v180, v180
v_mfma_f32_16x16x32_bf16 v[92:95], a[144:147], v[32:35], 0
v_exp_f32 v181, v181
MV 84,a,148,v,20
ds_read_b128 a[220:223], v11 offset:7168
v_cvt_pk_bf16_f32 v177, v178, v179
MV 92,a,148,v,36
v_exp_f32 v182, v182
MV 84,a,152,v,24
ds_read_b128 a[224:227], v11 offset:8192
ds_read_b128 a[228:231], v11 offset:9216
MV 92,a,152,v,40
v_exp_f32 v183, v183
MV 84,a,156,v,28
ds_read_b128 a[232:235], v11 offset:10240
v_cvt_pk_bf16_f32 v178, v180, v181
MV 92,a,156,v,44
v_exp_f32 v184, v184
v_mfma_f32_16x16x32_bf16 v[112:115], a[160:163], v[16:19], 0
ds_read_b128 a[236:239], v11 offset:11264
ds_read_b128 a[240:243], v11 offset:12288
v_mfma_f32_16x16x32_bf16 v[120:123], a[160:163], v[32:35], 0
v_exp_f32 v185, v185
MV 112,a,164,v,20
ds_read_b128 a[244:247], v11 offset:13312
v_cvt_pk_bf16_f32 v179, v182, v183
MV 120,a,164,v,36
v_exp_f32 v186, v186
MV 112,a,168,v,24
v_exp_f32 v187, v187
MV 120,a,168,v,40
ds_read_b128 a[248:251], v11 offset:14336
ds_read_b128 a[252:255], v11 offset:15360
MV 112,a,172,v,28
v_cvt_pk_bf16_f32 v184, v184, v185
v_add_u32 v246, 0, v13
MV 120,a,172,v,44
v_cmp_gt_i32_e64 s[84:85], 0, v246
v_cmp_gt_i32_e64 s[86:87], 1, v246
v_mfma_f32_16x16x32_bf16 v[116:119], a[176:179], v[16:19], 0
v_exp_f32 v188, v188
v_mfma_f32_16x16x32_bf16 v[124:127], a[176:179], v[32:35], 0
v_cmp_gt_i32_e64 s[88:89], 2, v246
v_cmp_gt_i32_e64 s[90:91], 3, v246
MV 116,a,180,v,20
v_cndmask_b32_e64 v80, v80, v14, s[84:85]
v_cndmask_b32_e64 v81, v81, v14, s[86:87]
MV 124,a,180,v,36
v_exp_f32 v189, v189
MV 116,a,184,v,24
v_cvt_pk_bf16_f32 v185, v186, v187
v_cndmask_b32_e64 v82, v82, v14, s[88:89]
MV 124,a,184,v,40
v_cndmask_b32_e64 v83, v83, v14, s[90:91]
v_add_u32 v247, -16, v13
MV 116,a,188,v,28
v_cmp_gt_i32_e64 s[92:93], 0, v247
v_cmp_gt_i32_e64 s[94:95], 1, v247
MV 124,a,188,v,44
v_exp_f32 v190, v190
v_exp_f32 v191, v191
v_cmp_gt_i32_e64 s[96:97], 2, v247
v_cmp_gt_i32_e64 s[98:99], 3, v247
v_cndmask_b32_e64 v84, v84, v14, s[92:93]
v_cvt_pk_bf16_f32 v186, v188, v189
v_cndmask_b32_e64 v85, v85, v14, s[94:95]
v_cndmask_b32_e64 v86, v86, v14, s[96:97]
v_cvt_pk_bf16_f32 v187, v190, v191
v_cndmask_b32_e64 v87, v87, v14, s[98:99]
s_waitcnt vmcnt(12) lgkmcnt(0)
MA 0,a,192,v,144
s_barrier
v_xor_b32 v10, 0x8000, v10
MA 32,a,192,v,152
ds_read_b128 a[128:131], v10 offset:0
ds_read_b128 a[132:135], v10 offset:1024
MA 4,a,196,v,144
v_exp_f32 v80, v80
MA 36,a,196,v,152
v_exp_f32 v81, v81
MA 8,a,200,v,144
ds_read_b128 a[136:139], v10 offset:2048
ds_read_b128 a[140:143], v10 offset:3072
MA 40,a,200,v,152
v_exp_f32 v82, v82
MA 12,a,204,v,144
ds_read_b128 a[144:147], v10 offset:4096
v_add_u32 v246, -32, v13
MA 44,a,204,v,152
v_exp_f32 v83, v83
MV 164,v,160,v,144
v_cvt_pk_bf16_f32 v80, v80, v81
v_cmp_gt_i32_e64 s[84:85], 0, v246
MV 168,v,160,v,152
ds_read_b128 a[148:151], v10 offset:5120
v_cmp_gt_i32_e64 s[86:87], 1, v246
MA 16,a,208,v,144
v_exp_f32 v84, v84
MA 48,a,208,v,152
ds_read_b128 a[152:155], v10 offset:6144
v_cmp_gt_i32_e64 s[88:89], 2, v246
MA 20,a,212,v,144
v_exp_f32 v85, v85
MA 52,a,212,v,152
ds_read_b128 a[156:159], v10 offset:7168
v_cmp_gt_i32_e64 s[90:91], 3, v246
MA 24,a,216,v,144
ds_read_b128 a[160:163], v10 offset:8192
v_cvt_pk_bf16_f32 v81, v82, v83
MA 56,a,216,v,152
v_exp_f32 v86, v86
MA 28,a,220,v,144
ds_read_b128 a[164:167], v10 offset:9216
v_cndmask_b32_e64 v112, v112, v14, s[84:85]
MA 60,a,220,v,152
v_exp_f32 v87, v87
MA 0,a,224,v,176
ds_read_b128 a[168:171], v10 offset:10240
v_cndmask_b32_e64 v113, v113, v14, s[86:87]
MA 32,a,224,v,184
v_cvt_pk_bf16_f32 v82, v84, v85
v_cndmask_b32_e64 v114, v114, v14, s[88:89]
MA 4,a,228,v,176
ds_read_b128 a[172:175], v10 offset:11264
v_cndmask_b32_e64 v115, v115, v14, s[90:91]
MA 36,a,228,v,184
v_exp_f32 v88, v88
MA 8,a,232,v,176
v_exp_f32 v89, v89
MA 40,a,232,v,184
ds_read_b128 a[176:179], v10 offset:12288
v_cvt_pk_bf16_f32 v83, v86, v87
MA 12,a,236,v,176
ds_read_b128 a[180:183], v10 offset:13312
v_add_u32 v247, -48, v13
MA 44,a,236,v,184
ds_read_b128 a[184:187], v10 offset:14336
v_cmp_gt_i32_e64 s[92:93], 0, v247
MV 164,v,160,v,176
v_exp_f32 v90, v90
MV 168,v,160,v,184
ds_read_b128 a[188:191], v10 offset:15360
v_cmp_gt_i32_e64 s[94:95], 1, v247
MA 16,a,240,v,176
v_exp_f32 v91, v91
MA 48,a,240,v,184
v_cvt_pk_bf16_f32 v88, v88, v89
v_cmp_gt_i32_e64 s[96:97], 2, v247
MA 20,a,244,v,176
v_exp_f32 v92, v92
MA 52,a,244,v,184
v_cmp_gt_i32_e64 s[98:99], 3, v247
v_cndmask_b32_e64 v116, v116, v14, s[92:93]
MA 24,a,248,v,176
v_exp_f32 v93, v93
MA 56,a,248,v,184
v_cvt_pk_bf16_f32 v89, v90, v91
v_cndmask_b32_e64 v117, v117, v14, s[94:95]
MA 28,a,252,v,176
v_exp_f32 v94, v94
MA 60,a,252,v,184
v_exp_f32 v95, v95
v_cndmask_b32_e64 v118, v118, v14, s[96:97]
v_cvt_pk_bf16_f32 v90, v92, v93
v_cndmask_b32_e64 v119, v119, v14, s[98:99]
v_cvt_pk_bf16_f32 v91, v94, v95
L_p3_s0m_top:
s_waitcnt lgkmcnt(0)
v_mfma_f32_16x16x32_bf16 v[152:155], a[128:131], v[32:35], 0
ds_read_b128 a[192:195], v11 offset:16384
ds_read_b128 a[196:199], v11 offset:17408
MV 152,a,132,v,36
v_exp_f32 v112, v112
MV 152,a,136,v,40
v_exp_f32 v113, v113
MV 152,a,140,v,44
ds_read_b128 a[200:203], v11 offset:18432
ds_read_b128 a[204:207], v11 offset:19456
v_mfma_f32_16x16x32_bf16 v[156:159], a[144:147], v[32:35], 0
v_exp_f32 v114, v114
MV 156,a,148,v,36
v_exp_f32 v115, v115
MV 156,a,152,v,40
ds_read_b128 a[208:211], v11 offset:20480
ds_read_b128 a[212:215], v11 offset:21504
MV 156,a,156,v,44
ds_read_b128 a[216:219], v11 offset:22528
v_cvt_pk_bf16_f32 v112, v112, v113
v_mfma_f32_16x16x32_bf16 v[184:187], a[160:163], v[32:35], 0
v_exp_f32 v116, v116
MV 184,a,164,v,36
v_exp_f32 v117, v117
MV 184,a,168,v,40
ds_read_b128 a[220:223], v11 offset:23552
v_cvt_pk_bf16_f32 v113, v114, v115
MV 184,a,172,v,44
v_exp_f32 v118, v118
v_mfma_f32_16x16x32_bf16 v[188:191], a[176:179], v[32:35], 0
ds_read_b128 a[224:227], v11 offset:24576
ds_read_b128 a[228:231], v11 offset:25600
MV 188,a,180,v,36
v_exp_f32 v119, v119
MV 188,a,184,v,40
ds_read_b128 a[232:235], v11 offset:26624
v_cvt_pk_bf16_f32 v114, v116, v117
MV 188,a,188,v,44
ds_read_b128 a[236:239], v11 offset:27648
ds_read_b128 a[240:243], v11 offset:28672
ds_read_b128 a[244:247], v11 offset:29696
ds_read_b128 a[248:251], v11 offset:30720
ds_read_b128 a[252:255], v11 offset:31744
v_exp_f32 v120, v120
v_exp_f32 v121, v121
v_cvt_pk_bf16_f32 v115, v118, v119
v_exp_f32 v122, v122
v_exp_f32 v123, v123
v_cvt_pk_bf16_f32 v120, v120, v121
v_exp_f32 v124, v124
v_exp_f32 v125, v125
v_cvt_pk_bf16_f32 v121, v122, v123
v_exp_f32 v126, v126
v_exp_f32 v127, v127
v_add_u32 v246, -64, v239
v_cmp_gt_i32_e64 s[84:85], 0, v246
v_cmp_gt_i32_e64 s[86:87], 1, v246
v_cmp_gt_i32_e64 s[88:89], 2, v246
v_cmp_gt_i32_e64 s[90:91], 3, v246
v_cndmask_b32_e64 v152, v152, v14, s[84:85]
v_cndmask_b32_e64 v153, v153, v14, s[86:87]
v_cndmask_b32_e64 v154, v154, v14, s[88:89]
v_cndmask_b32_e64 v155, v155, v14, s[90:91]
v_cvt_pk_bf16_f32 v122, v124, v125
v_cvt_pk_bf16_f32 v123, v126, v127
v_add_u32 v247, -80, v239
v_cmp_gt_i32_e64 s[92:93], 0, v247
v_cmp_gt_i32_e64 s[94:95], 1, v247
v_cmp_gt_i32_e64 s[96:97], 2, v247
v_cmp_gt_i32_e64 s[98:99], 3, v247
v_cndmask_b32_e64 v156, v156, v14, s[92:93]
v_cndmask_b32_e64 v157, v157, v14, s[94:95]
v_cndmask_b32_e64 v158, v158, v14, s[96:97]
v_cndmask_b32_e64 v159, v159, v14, s[98:99]
s_waitcnt vmcnt(4) lgkmcnt(0)
MA 0,a,192,v,80
s_barrier
MA 32,a,192,v,88
MA 4,a,196,v,80
v_lshlrev_b32 v245, 4, v1
s_mov_b32 m0, s43
MA 36,a,196,v,88
v_exp_f32 v152, v152
MA 8,a,200,v,80
MA 40,a,200,v,88
v_exp_f32 v153, v153
MA 12,a,204,v,80
v_add_u32 v246, -96, v239
v_cmp_gt_i32_e64 s[84:85], 0, v246
MA 44,a,204,v,88
MV 164,v,160,v,80
v_exp_f32 v154, v154
MV 168,v,160,v,88
s_nop 0
v_cmp_gt_i32_e64 s[86:87], 1, v246
MA 16,a,208,v,80
MA 48,a,208,v,88
v_cmp_gt_i32_e64 s[88:89], 2, v246
v_cmp_gt_i32_e64 s[90:91], 3, v246
MA 20,a,212,v,80
v_exp_f32 v155, v155
MA 52,a,212,v,88
MA 24,a,216,v,80
v_cvt_pk_bf16_f32 v152, v152, v153
v_cndmask_b32_e64 v184, v184, v14, s[84:85]
MA 56,a,216,v,88
MA 28,a,220,v,80
buffer_load_dwordx4 v245, s[20:23], 0 offen offset:0 sc1 lds
v_cndmask_b32_e64 v185, v185, v14, s[86:87]
MA 60,a,220,v,88
v_exp_f32 v156, v156
MA 0,a,224,v,112
v_cndmask_b32_e64 v186, v186, v14, s[88:89]
v_cndmask_b32_e64 v187, v187, v14, s[90:91]
MA 32,a,224,v,120
MA 4,a,228,v,112
v_exp_f32 v157, v157
MA 36,a,228,v,120
buffer_load_dwordx4 v245, s[20:23], 0 offen offset:1024 sc1 lds
v_add_u32 v247, -112, v239
MA 8,a,232,v,112
v_cvt_pk_bf16_f32 v153, v154, v155
v_cmp_gt_i32_e64 s[92:93], 0, v247
MA 40,a,232,v,120
MA 12,a,236,v,112
buffer_load_dwordx4 v245, s[20:23], 0 offen offset:2048 sc1 lds
v_cmp_gt_i32_e64 s[94:95], 1, v247
MA 44,a,236,v,120
v_exp_f32 v158, v158
MV 164,v,160,v,112
v_cmp_gt_i32_e64 s[96:97], 2, v247
v_cmp_gt_i32_e64 s[98:99], 3, v247
MV 168,v,160,v,120
MA 16,a,240,v,112
MA 48,a,240,v,120
v_exp_f32 v159, v159
MA 20,a,244,v,112
buffer_load_dwordx4 v245, s[20:23], 0 offen offset:3072 sc1 lds
v_cndmask_b32_e64 v188, v188, v14, s[92:93]
MA 52,a,244,v,120
v_cvt_pk_bf16_f32 v154, v156, v157
v_cndmask_b32_e64 v189, v189, v14, s[94:95]
MA 24,a,248,v,112
v_cvt_pk_bf16_f32 v155, v158, v159
v_cndmask_b32_e64 v190, v190, v14, s[96:97]
MA 56,a,248,v,120
MA 28,a,252,v,112
v_cndmask_b32_e64 v191, v191, v14, s[98:99]
MA 60,a,252,v,120
s_load_dwordx2 s[88:89], s[0:1], 104
s_waitcnt lgkmcnt(0)
v_xor_b32 v11, 0x8000, v11
ds_read_b128 a[192:195], v11 offset:0
ds_read_b128 a[196:199], v11 offset:1024
ds_read_b128 a[200:203], v11 offset:2048
ds_read_b128 a[204:207], v11 offset:3072
ds_read_b128 a[208:211], v11 offset:4096
ds_read_b128 a[212:215], v11 offset:5120
ds_read_b128 a[216:219], v11 offset:6144
ds_read_b128 a[220:223], v11 offset:7168
ds_read_b128 a[224:227], v11 offset:8192
ds_read_b128 a[228:231], v11 offset:9216
ds_read_b128 a[232:235], v11 offset:10240
ds_read_b128 a[236:239], v11 offset:11264
ds_read_b128 a[240:243], v11 offset:12288
ds_read_b128 a[244:247], v11 offset:13312
ds_read_b128 a[248:251], v11 offset:14336
ds_read_b128 a[252:255], v11 offset:15360
v_exp_f32 v184, v184
v_exp_f32 v185, v185
v_exp_f32 v186, v186
v_exp_f32 v187, v187
v_cvt_pk_bf16_f32 v184, v184, v185
v_exp_f32 v188, v188
v_exp_f32 v189, v189
v_cvt_pk_bf16_f32 v185, v186, v187
v_exp_f32 v190, v190
v_exp_f32 v191, v191
v_cvt_pk_bf16_f32 v186, v188, v189
v_cvt_pk_bf16_f32 v187, v190, v191
MV 168,v,160,v,152
s_nop 0
MV 168,v,160,v,184
v_mov_b32 v240, v2
v_mov_b32 v241, v3
s_nop 0
v_permlane32_swap_b32 v2, v240
v_permlane32_swap_b32 v3, v241
v_add_f32 v2, v2, v240
v_add_f32 v3, v3, v241
v_mov_b32 v240, v2
v_mov_b32 v241, v3
s_nop 0
v_permlane16_swap_b32 v2, v240
v_permlane16_swap_b32 v3, v241
v_add_f32 v2, v2, v240
v_add_f32 v3, v3, v241
v_add_f32 v2, v2, v164
v_cmp_nle_f32 vcc, 0x30800000, v2
s_nop 0
s_or_b64 s[78:79], s[78:79], vcc
v_cmp_nge_f32 vcc, 0x4e800000, v2
s_nop 0
s_or_b64 s[78:79], s[78:79], vcc
v_add_f32 v3, v3, v168
v_cmp_nle_f32 vcc, 0x30800000, v3
s_nop 0
s_or_b64 s[78:79], s[78:79], vcc
v_cmp_nge_f32 vcc, 0x4e800000, v3
s_nop 0
s_or_b64 s[78:79], s[78:79], vcc
s_cmp_lg_u64 s[78:79], 0
s_cselect_b32 s80, 1, 0
v_mov_b32 v240, s80
s_lshl_b32 s80, s3, 2
s_add_u32 s80, s80, 163824
v_mov_b32 v241, s80
ds_write_b32 v241, v240
v_mov_b32 v241, 163824
s_waitcnt vmcnt(0) lgkmcnt(0)
s_barrier
ds_read_b128 v[244:247], v241
buffer_store_dword v237, v236, s[8:11], s37 offen offset:1024 sc1
MA 32,a,192,v,152
MA 36,a,196,v,152
MA 40,a,200,v,152
MA 44,a,204,v,152
MA 48,a,208,v,152
MA 52,a,212,v,152
s_waitcnt lgkmcnt(0)
v_or3_b32 v240, v244, v245, v246
v_or_b32 v240, v240, v247
MA 56,a,216,v,152
v_cmp_ne_u32 vcc, 0, v240
MA 60,a,220,v,152
MA 32,a,224,v,184
s_cbranch_vccnz L_fallback
MA 36,a,228,v,184
s_mul_i32 s36, s3, 8320
v_and_b32 v16, 15, v1
MA 40,a,232,v,184
v_lshrrev_b32 v17, 4, v1
v_add_u32 v18, 1, v16
MA 44,a,236,v,184
v_and_b32 v19, 1, v18
v_mul_u32_u24 v19, 4160, v19
MA 48,a,240,v,184
v_add_u32 v18, 2, v16
v_lshrrev_b32 v18, 1, v18
MA 52,a,244,v,184
v_lshl_add_u32 v19, v18, 2, v19
v_lshl_add_u32 v19, v17, 4, v19
MA 56,a,248,v,184
v_add_u32 v40, s36, v19
v_add_u32 v41, 1024, v40
MA 60,a,252,v,184
v_add_u32 v42, 2048, v40
v_add_u32 v43, 3072, v40
v_add_u32 v10, s36, v232
v_lshlrev_b32 v18, 5, v16
v_lshlrev_b32 v19, 4, v17
v_sub_u32 v19, v19, v18
s_add_u32 s37, s43, 480
v_add_u32 v5, s37, v19
v_mov_b32 v20, 0
v_mov_b32 v21, 0
v_mov_b32 v22, 0
v_mov_b32 v23, 0
v_and_b32 v16, 1, v1
v_mul_u32_u24 v16, 4160, v16
v_and_b32 v17, 2, v1
v_lshl_add_u32 v16, v17, 3, v16
v_add_u32 v16, s36, v16
ds_write_b128 v16, v[20:23]
v_and_b32 v17, 31, v1
v_lshlrev_b32 v17, 4, v17
v_add_u32 v17, s43, v17
ds_write_b128 v17, v[20:23] offset:4096
v_mov_b32 v209, 0
ds_write_b128 v10, v[210:213] offset:32
s_nop 0
v_mov_b32_dpp v209, v213 wave_shr:1 row_mask:0xf bank_mask:0xf
v_alignbit_b32 v24, v210, v209, 16
v_alignbit_b32 v25, v211, v210, 16
v_alignbit_b32 v26, v212, v211, 16
v_alignbit_b32 v27, v213, v212, 16
ds_write_b128 v10, v[24:27] offset:4192
v_mov_b32_dpp v215, v213 wave_ror:1 row_mask:0xf bank_mask:0xf
ds_write_b128 v10, v[216:219] offset:1056
s_nop 0
v_mov_b32_dpp v215, v219 wave_shr:1 row_mask:0xf bank_mask:0xf
v_alignbit_b32 v28, v216, v215, 16
v_alignbit_b32 v29, v217, v216, 16
v_alignbit_b32 v30, v218, v217, 16
v_alignbit_b32 v31, v219, v218, 16
ds_write_b128 v10, v[28:31] offset:5216
v_mov_b32_dpp v221, v219 wave_ror:1 row_mask:0xf bank_mask:0xf
ds_write_b128 v10, v[222:225] offset:2080
s_nop 0
v_mov_b32_dpp v221, v225 wave_shr:1 row_mask:0xf bank_mask:0xf
v_alignbit_b32 v24, v222, v221, 16
v_alignbit_b32 v25, v223, v222, 16
v_alignbit_b32 v26, v224, v223, 16
v_alignbit_b32 v27, v225, v224, 16
ds_write_b128 v10, v[24:27] offset:6240
v_mov_b32_dpp v227, v225 wave_ror:1 row_mask:0xf bank_mask:0xf
ds_write_b128 v10, v[228:231] offset:3104
s_nop 0
v_mov_b32_dpp v227, v231 wave_shr:1 row_mask:0xf bank_mask:0xf
v_alignbit_b32 v28, v228, v227, 16
v_alignbit_b32 v29, v229, v228, 16
v_alignbit_b32 v30, v230, v229, 16
v_alignbit_b32 v31, v231, v230, 16
ds_write_b128 v10, v[28:31] offset:7264
ds_read_b128 a[160:163], v5 offset:3584
ds_read2_b32 a[128:129], v40 offset0:0 offset1:1
ds_read2_b32 a[130:131], v40 offset0:2 offset1:3
ds_read_b128 a[164:167], v5 offset:3072
ds_read2_b32 a[132:133], v40 offset0:128 offset1:129
ds_read2_b32 a[134:135], v40 offset0:130 offset1:131
ds_read_b128 a[168:171], v5 offset:2560
ds_read2_b32 a[136:137], v41 offset0:0 offset1:1
ds_read2_b32 a[138:139], v41 offset0:2 offset1:3
ds_read_b128 a[172:175], v5 offset:2048
ds_read2_b32 a[140:141], v41 offset0:128 offset1:129
ds_read2_b32 a[142:143], v41 offset0:130 offset1:131
ds_read_b128 a[176:179], v5 offset:1536
ds_read2_b32 a[144:145], v42 offset0:0 offset1:1
ds_read2_b32 a[146:147], v42 offset0:2 offset1:3
ds_read_b128 a[180:183], v5 offset:1024
ds_read2_b32 a[148:149], v42 offset0:128 offset1:129
ds_read2_b32 a[150:151], v42 offset0:130 offset1:131
ds_read_b128 a[184:187], v5 offset:512
ds_read2_b32 a[152:153], v43 offset0:0 offset1:1
ds_read2_b32 a[154:155], v43 offset0:2 offset1:3
ds_read_b128 a[188:191], v5 offset:0
ds_read2_b32 a[156:157], v43 offset0:128 offset1:129
ds_read2_b32 a[158:159], v43 offset0:130 offset1:131
v_rcp_f32 v2, v2
v_rcp_f32 v3, v3
s_add_u32 s80, s100, s76
s_nop 4
v_accvgpr_read_b32 v240, a0
v_accvgpr_read_b32 v241, a1
v_accvgpr_read_b32 v242, a2
v_accvgpr_read_b32 v243, a3
v_accvgpr_read_b32 v244, a4
v_accvgpr_read_b32 v245, a5
v_accvgpr_read_b32 v246, a6
v_accvgpr_read_b32 v247, a7
v_pk_mul_f32 v[240:241], v[240:241], v[2:3] op_sel:[0,0] op_sel_hi:[1,0]
v_pk_mul_f32 v[242:243], v[242:243], v[2:3] op_sel:[0,0] op_sel_hi:[1,0]
v_pk_mul_f32 v[244:245], v[244:245], v[2:3] op_sel:[0,0] op_sel_hi:[1,0]
v_pk_mul_f32 v[246:247], v[246:247], v[2:3] op_sel:[0,0] op_sel_hi:[1,0]
v_cvt_pk_bf16_f32 v248, v240, v241
v_cvt_pk_bf16_f32 v249, v242, v243
v_cvt_pk_bf16_f32 v250, v244, v245
v_cvt_pk_bf16_f32 v251, v246, v247
buffer_store_dwordx4 v[248:251], v15, s[60:63], s100 offen offset:0 sc1
v_accvgpr_read_b32 v240, a8
v_accvgpr_read_b32 v241, a9
v_accvgpr_read_b32 v242, a10
v_accvgpr_read_b32 v243, a11
v_accvgpr_read_b32 v244, a12
v_accvgpr_read_b32 v245, a13
v_accvgpr_read_b32 v246, a14
v_accvgpr_read_b32 v247, a15
v_pk_mul_f32 v[240:241], v[240:241], v[2:3] op_sel:[0,0] op_sel_hi:[1,0]
v_pk_mul_f32 v[242:243], v[242:243], v[2:3] op_sel:[0,0] op_sel_hi:[1,0]
v_pk_mul_f32 v[244:245], v[244:245], v[2:3] op_sel:[0,0] op_sel_hi:[1,0]
v_pk_mul_f32 v[246:247], v[246:247], v[2:3] op_sel:[0,0] op_sel_hi:[1,0]
v_cvt_pk_bf16_f32 v252, v240, v241
v_cvt_pk_bf16_f32 v253, v242, v243
v_cvt_pk_bf16_f32 v254, v244, v245
v_cvt_pk_bf16_f32 v255, v246, v247
buffer_store_dwordx4 v[252:255], v15, s[60:63], s100 offen offset:1024 sc1
v_accvgpr_read_b32 v240, a16
v_accvgpr_read_b32 v241, a17
v_accvgpr_read_b32 v242, a18
v_accvgpr_read_b32 v243, a19
v_accvgpr_read_b32 v244, a20
v_accvgpr_read_b32 v245, a21
v_accvgpr_read_b32 v246, a22
v_accvgpr_read_b32 v247, a23
v_pk_mul_f32 v[240:241], v[240:241], v[2:3] op_sel:[0,0] op_sel_hi:[1,0]
v_pk_mul_f32 v[242:243], v[242:243], v[2:3] op_sel:[0,0] op_sel_hi:[1,0]
v_pk_mul_f32 v[244:245], v[244:245], v[2:3] op_sel:[0,0] op_sel_hi:[1,0]
v_pk_mul_f32 v[246:247], v[246:247], v[2:3] op_sel:[0,0] op_sel_hi:[1,0]
v_cvt_pk_bf16_f32 v248, v240, v241
v_cvt_pk_bf16_f32 v249, v242, v243
v_cvt_pk_bf16_f32 v250, v244, v245
v_cvt_pk_bf16_f32 v251, v246, v247
buffer_store_dwordx4 v[248:251], v15, s[60:63], s100 offen offset:2048 sc1
v_accvgpr_read_b32 v240, a24
v_accvgpr_read_b32 v241, a25
v_accvgpr_read_b32 v242, a26
v_accvgpr_read_b32 v243, a27
v_accvgpr_read_b32 v244, a28
v_accvgpr_read_b32 v245, a29
v_accvgpr_read_b32 v246, a30
v_accvgpr_read_b32 v247, a31
v_pk_mul_f32 v[240:241], v[240:241], v[2:3] op_sel:[0,0] op_sel_hi:[1,0]
v_pk_mul_f32 v[242:243], v[242:243], v[2:3] op_sel:[0,0] op_sel_hi:[1,0]
v_pk_mul_f32 v[244:245], v[244:245], v[2:3] op_sel:[0,0] op_sel_hi:[1,0]
v_pk_mul_f32 v[246:247], v[246:247], v[2:3] op_sel:[0,0] op_sel_hi:[1,0]
v_cvt_pk_bf16_f32 v252, v240, v241
v_cvt_pk_bf16_f32 v253, v242, v243
v_cvt_pk_bf16_f32 v254, v244, v245
v_cvt_pk_bf16_f32 v255, v246, v247
buffer_store_dwordx4 v[252:255], v15, s[60:63], s100 offen offset:3072 sc1
v_accvgpr_read_b32 v240, a32
v_accvgpr_read_b32 v241, a33
v_accvgpr_read_b32 v242, a34
v_accvgpr_read_b32 v243, a35
v_accvgpr_read_b32 v244, a36
v_accvgpr_read_b32 v245, a37
v_accvgpr_read_b32 v246, a38
v_accvgpr_read_b32 v247, a39
v_pk_mul_f32 v[240:241], v[240:241], v[2:3] op_sel:[0,1] op_sel_hi:[1,1]
v_pk_mul_f32 v[242:243], v[242:243], v[2:3] op_sel:[0,1] op_sel_hi:[1,1]
v_pk_mul_f32 v[244:245], v[244:245], v[2:3] op_sel:[0,1] op_sel_hi:[1,1]
v_pk_mul_f32 v[246:247], v[246:247], v[2:3] op_sel:[0,1] op_sel_hi:[1,1]
v_cvt_pk_bf16_f32 v248, v240, v241
v_cvt_pk_bf16_f32 v249, v242, v243
v_cvt_pk_bf16_f32 v250, v244, v245
v_cvt_pk_bf16_f32 v251, v246, v247
buffer_store_dwordx4 v[248:251], v15, s[60:63], s80 offen offset:0 sc1
v_accvgpr_read_b32 v240, a40
v_accvgpr_read_b32 v241, a41
v_accvgpr_read_b32 v242, a42
v_accvgpr_read_b32 v243, a43
v_accvgpr_read_b32 v244, a44
v_accvgpr_read_b32 v245, a45
v_accvgpr_read_b32 v246, a46
v_accvgpr_read_b32 v247, a47
v_pk_mul_f32 v[240:241], v[240:241], v[2:3] op_sel:[0,1] op_sel_hi:[1,1]
v_pk_mul_f32 v[242:243], v[242:243], v[2:3] op_sel:[0,1] op_sel_hi:[1,1]
v_pk_mul_f32 v[244:245], v[244:245], v[2:3] op_sel:[0,1] op_sel_hi:[1,1]
v_pk_mul_f32 v[246:247], v[246:247], v[2:3] op_sel:[0,1] op_sel_hi:[1,1]
v_cvt_pk_bf16_f32 v252, v240, v241
v_cvt_pk_bf16_f32 v253, v242, v243
v_cvt_pk_bf16_f32 v254, v244, v245
v_cvt_pk_bf16_f32 v255, v246, v247
buffer_store_dwordx4 v[252:255], v15, s[60:63], s80 offen offset:1024 sc1
v_accvgpr_read_b32 v240, a48
v_accvgpr_read_b32 v241, a49
v_accvgpr_read_b32 v242, a50
v_accvgpr_read_b32 v243, a51
v_accvgpr_read_b32 v244, a52
v_accvgpr_read_b32 v245, a53
v_accvgpr_read_b32 v246, a54
v_accvgpr_read_b32 v247, a55
v_pk_mul_f32 v[240:241], v[240:241], v[2:3] op_sel:[0,1] op_sel_hi:[1,1]
v_pk_mul_f32 v[242:243], v[242:243], v[2:3] op_sel:[0,1] op_sel_hi:[1,1]
v_pk_mul_f32 v[244:245], v[244:245], v[2:3] op_sel:[0,1] op_sel_hi:[1,1]
v_pk_mul_f32 v[246:247], v[246:247], v[2:3] op_sel:[0,1] op_sel_hi:[1,1]
v_cvt_pk_bf16_f32 v248, v240, v241
v_cvt_pk_bf16_f32 v249, v242, v243
v_cvt_pk_bf16_f32 v250, v244, v245
v_cvt_pk_bf16_f32 v251, v246, v247
buffer_store_dwordx4 v[248:251], v15, s[60:63], s80 offen offset:2048 sc1
v_accvgpr_read_b32 v240, a56
v_accvgpr_read_b32 v241, a57
v_accvgpr_read_b32 v242, a58
v_accvgpr_read_b32 v243, a59
v_accvgpr_read_b32 v244, a60
v_accvgpr_read_b32 v245, a61
v_accvgpr_read_b32 v246, a62
v_accvgpr_read_b32 v247, a63
v_pk_mul_f32 v[240:241], v[240:241], v[2:3] op_sel:[0,1] op_sel_hi:[1,1]
v_pk_mul_f32 v[242:243], v[242:243], v[2:3] op_sel:[0,1] op_sel_hi:[1,1]
v_pk_mul_f32 v[244:245], v[244:245], v[2:3] op_sel:[0,1] op_sel_hi:[1,1]
v_pk_mul_f32 v[246:247], v[246:247], v[2:3] op_sel:[0,1] op_sel_hi:[1,1]
v_cvt_pk_bf16_f32 v252, v240, v241
v_cvt_pk_bf16_f32 v253, v242, v243
v_cvt_pk_bf16_f32 v254, v244, v245
v_cvt_pk_bf16_f32 v255, v246, v247
buffer_store_dwordx4 v[252:255], v15, s[60:63], s80 offen offset:3072 sc1
L_p3_done:
s_nop 1
v_lshlrev_b32 v255, 20, v1
v_mov_b32 v253, 1
s_lshl_b32 s83, s3, 8
s_add_u32 s83, s83, s2
s_lshl_b32 s83, s83, 2
s_add_u32 s83, s83, 4096
s_waitcnt lgkmcnt(15)
v_mfma_f32_16x16x32_bf16 v[76:79], a[128:131], a[160:163], 0
v_and_b32 v16, 15, v1
v_lshrrev_b32 v17, 4, v1
v_mfma_f32_16x16x32_bf16 v[80:83], a[128:131], a[164:167], 0
v_lshl_add_u32 v18, v17, 3, v16
ds_read_b128 a[224:227], v5 offset:3648
v_mfma_f32_16x16x32_bf16 v[84:87], a[128:131], a[168:171], 0
v_sub_u32 v235, 15, v18
ds_read2_b32 a[192:193], v40 offset0:16 offset1:17
s_waitcnt lgkmcnt(15)
v_mfma_f32_16x16x32_bf16 v[88:91], a[128:131], a[172:175], 0
v_lshlrev_b32 v18, 16, v234
ds_read2_b32 a[194:195], v40 offset0:18 offset1:19
s_waitcnt lgkmcnt(14)
v_mfma_f32_16x16x32_bf16 v[92:95], a[128:131], a[176:179], 0
v_cmp_eq_u32 vcc, 0, v235
v_cmp_eq_u32_e64 s[38:39], 1, v235
s_waitcnt lgkmcnt(11)
v_mfma_f32_16x16x32_bf16 v[96:99], a[128:131], a[180:183], 0
ds_read_b128 a[228:231], v5 offset:3136
ds_read2_b32 a[196:197], v40 offset0:144 offset1:145
s_waitcnt lgkmcnt(10)
v_mfma_f32_16x16x32_bf16 v[100:103], a[128:131], a[184:187], 0
s_nop 0
v_cndmask_b32 v44, 0, v234, vcc
s_waitcnt lgkmcnt(7)
v_mfma_f32_16x16x32_bf16 v[104:107], a[128:131], a[188:191], 0
ds_read2_b32 a[198:199], v40 offset0:146 offset1:147
ds_read_b128 a[232:235], v5 offset:2624
MV 80,a,132,a,160
v_cndmask_b32_e64 v44, v44, v18, s[38:39]
ds_read2_b32 a[200:201], v41 offset0:16 offset1:17
MV 84,a,132,a,164
v_cmp_eq_u32 vcc, 2, v235
v_cmp_eq_u32_e64 s[38:39], 3, v235
MV 88,a,132,a,168
ds_read2_b32 a[202:203], v41 offset0:18 offset1:19
s_and_b32 s81, s2, 3
MV 92,a,132,a,172
s_nop 0
v_cndmask_b32 v45, 0, v234, vcc
MV 96,a,132,a,176
ds_read_b128 a[236:239], v5 offset:2112
ds_read2_b32 a[204:205], v41 offset0:144 offset1:145
MV 100,a,132,a,180
v_cndmask_b32_e64 v45, v45, v18, s[38:39]
ds_read2_b32 a[206:207], v41 offset0:146 offset1:147
MV 104,a,132,a,184
v_cmp_eq_u32 vcc, 4, v235
v_cmp_eq_u32_e64 s[38:39], 5, v235
MV 84,a,136,a,160
ds_read_b128 a[240:243], v5 offset:1600
s_lshl_b32 s81, s81, 1
MV 88,a,136,a,164
s_nop 0
v_cndmask_b32 v46, 0, v234, vcc
MV 92,a,136,a,168
ds_read2_b32 a[208:209], v42 offset0:16 offset1:17
ds_read2_b32 a[210:211], v42 offset0:18 offset1:19
MV 96,a,136,a,172
v_cndmask_b32_e64 v46, v46, v18, s[38:39]
ds_read_b128 a[244:247], v5 offset:1088
MV 100,a,136,a,176
v_cmp_eq_u32 vcc, 6, v235
v_cmp_eq_u32_e64 s[38:39], 7, v235
MV 104,a,136,a,180
ds_read2_b32 a[212:213], v42 offset0:144 offset1:145
s_sub_u32 s74, 14, s81
MV 88,a,140,a,160
s_nop 0
v_cndmask_b32 v47, 0, v234, vcc
MV 92,a,140,a,164
ds_read2_b32 a[214:215], v42 offset0:146 offset1:147
ds_read_b128 a[248:251], v5 offset:576
MV 96,a,140,a,168
v_cndmask_b32_e64 v47, v47, v18, s[38:39]
ds_read2_b32 a[216:217], v43 offset0:16 offset1:17
MV 100,a,140,a,172
s_bitcmp1_b32 s2, 4
s_cselect_b32 s81, s74, s81
MV 104,a,140,a,176
ds_read2_b32 a[218:219], v43 offset0:18 offset1:19
s_bfe_u32 s74, s2, 0x10003
MV 92,a,144,a,160
ds_read_b128 a[252:255], v5 offset:64
s_add_u32 s81, s81, s74
MV 96,a,144,a,164
ds_read2_b32 a[220:221], v43 offset0:144 offset1:145
s_bfe_u32 s82, s2, 0x10002
MV 100,a,144,a,168
ds_read2_b32 a[222:223], v43 offset0:146 offset1:147
s_lshr_b32 s74, s2, 5
MV 104,a,144,a,172
s_lshl_b32 s74, s74, 1
s_add_u32 s82, s82, s74
MV 96,a,148,a,160
s_mov_b32 s72, s81
s_mov_b32 s73, s82
MV 100,a,148,a,164
s_lshl_b32 s74, s72, 2
s_add_u32 s74, s74, s3
MV 104,a,148,a,168
s_lshl_b32 s68, s74, 18
MV 100,a,152,a,160
MV 104,a,152,a,164
s_and_b32 s80, s73, 1
s_waitcnt lgkmcnt(15)
MV 104,a,156,a,160
MV 76,v,44,a,160
s_lshl_b32 s75, s80, 16
MV 80,v,44,a,164
MV 84,v,44,a,168
s_add_u32 s68, s68, s75
MV 88,v,44,a,172
MV 92,v,44,a,176
s_lshl_b32 s69, s73, 19
MV 96,v,44,a,180
MV 100,v,44,a,184
MV 104,v,44,a,188
s_waitcnt vmcnt(0)
buffer_store_dword v253, v255, s[8:11], s83 offen sc1
MV 76,a,192,a,224
ds_read_b128 a[160:163], v5 offset:3712
s_lshl_b32 s75, s73, 7
MV 80,a,196,a,224
ds_read2_b32 a[128:129], v40 offset0:32 offset1:33
s_lshl_b32 s70, s3, 12
MV 80,a,192,a,228
ds_read2_b32 a[130:131], v40 offset0:34 offset1:35
s_lshl_b32 s78, s74, 16
MV 84,a,196,a,228
ds_read_b128 a[164:167], v5 offset:3200
s_add_u32 s78, s78, s75
MV 84,a,192,a,232
s_lshl_b32 s79, s73, 18
s_lshl_b32 s75, s74, 8
MV 88,a,196,a,232
ds_read2_b32 a[132:133], v40 offset0:160 offset1:161
s_add_u32 s79, s79, s75
s_waitcnt lgkmcnt(15)
MV 88,a,192,a,236
ds_read2_b32 a[134:135], v40 offset0:162 offset1:163
v_lshlrev_b32 v236, 4, v1
MV 92,a,196,a,236
ds_read_b128 a[168:171], v5 offset:2688
v_add_u32 v237, 0x20000, v236
MV 92,a,192,a,240
ds_read2_b32 a[136:137], v41 offset0:32 offset1:33
v_add_u32 v238, s70, v236
MV 96,a,196,a,240
s_lshl_b32 s75, s80, 12
v_add_u32 v244, s75, v236
s_waitcnt lgkmcnt(15)
MV 96,a,192,a,244
ds_read2_b32 a[138:139], v41 offset0:34 offset1:35
v_xor_b32 v245, 0x1000, v244
MV 100,a,196,a,244
ds_read_b128 a[172:175], v5 offset:2176
v_add_u32 v242, 66560, v244
s_waitcnt lgkmcnt(15)
MV 100,a,192,a,248
ds_read2_b32 a[140:141], v41 offset0:160 offset1:161
v_add_u32 v243, 66560, v245
MV 104,a,196,a,248
ds_read2_b32 a[142:143], v41 offset0:162 offset1:163
v_bfe_u32 v50, v1, 4, 1
s_waitcnt lgkmcnt(14)
MV 104,a,192,a,252
v_lshrrev_b32 v52, 5, v1
v_and_b32 v48, 15, v1
MV 84,a,200,a,224
ds_read_b128 a[176:179], v5 offset:1664
v_lshlrev_b32 v53, 5, v50
MV 88,a,204,a,224
ds_read2_b32 a[144:145], v42 offset0:32 offset1:33
v_lshl_add_u32 v53, v52, 4, v53
MV 88,a,200,a,228
ds_read2_b32 a[146:147], v42 offset0:34 offset1:35
v_lshl_add_u32 v250, v48, 11, v53
MV 92,a,204,a,228
ds_read_b128 a[180:183], v5 offset:1152
v_lshlrev_b32 v53, 11, v53
MV 92,a,200,a,232
v_lshl_add_u32 v251, v48, 3, v53
MV 96,a,204,a,232
ds_read2_b32 a[148:149], v42 offset0:160 offset1:161
MV 96,a,200,a,236
ds_read2_b32 a[150:151], v42 offset0:162 offset1:163
MV 100,a,204,a,236
ds_read_b128 a[184:187], v5 offset:640
MV 100,a,200,a,240
ds_read2_b32 a[152:153], v43 offset0:32 offset1:33
MV 104,a,204,a,240
s_add_u32 s44, s40, 33554432
s_addc_u32 s45, s41, 0
MV 104,a,200,a,244
ds_read2_b32 a[154:155], v43 offset0:34 offset1:35
s_mov_b32 s46, 16777216
MV 92,a,208,a,224
ds_read_b128 a[188:191], v5 offset:128
s_mov_b32 s47, 0x20000
MV 96,a,212,a,224
ds_read2_b32 a[156:157], v43 offset0:160 offset1:161
MV 96,a,208,a,228
ds_read2_b32 a[158:159], v43 offset0:162 offset1:163
MV 100,a,212,a,228
s_add_u32 s48, s40, 100663296
s_addc_u32 s49, s41, 0
MV 100,a,208,a,232
s_mov_b32 s50, 8388608
s_mov_b32 s51, 0x20000
MV 104,a,212,a,232
s_add_u32 s52, s40, 109051904
s_addc_u32 s53, s41, 0
MV 104,a,208,a,236
s_mov_b32 s54, 4194304
s_mov_b32 s55, 0x20000
MV 100,a,216,a,224
s_add_u32 s56, s40, 54525952
s_addc_u32 s57, s41, 0
s_waitcnt lgkmcnt(15)
MV 104,a,220,a,224
s_mov_b32 s58, 4194304
s_mov_b32 s59, 0x20000
MV 104,a,216,a,228
s_mov_b32 s60, s88
s_mov_b32 s61, s89
s_mov_b32 s62, 4194304
s_mov_b32 s63, 0x20000
s_lshr_b32 s36, s82, 1
s_lshl_b32 s37, s80, 7
s_add_u32 s36, s36, s37
v_lshl_add_u32 v254, v1, 3, s36
s_xor_b32 s36, s2, 4
v_mov_b32 v253, s36
v_cmp_lt_u32 vcc, 15, v1
s_nop 1
v_cndmask_b32 v254, v254, v253, vcc
v_lshlrev_b32 v254, 2, v254
buffer_load_dword v253, v254, s[8:11], 0 offen offset:1024 sc1
MV 76,a,128,a,160
ds_read_b128 a[224:227], v5 offset:3776
s_sub_u32 s36, 15, s81
MV 80,a,132,a,160
ds_read2_b32 a[192:193], v40 offset0:48 offset1:49
s_min_u32 s36, s36, s81
MV 80,a,128,a,164
ds_read2_b32 a[194:195], v40 offset0:50 offset1:51
MV 84,a,132,a,164
ds_read_b128 a[228:231], v5 offset:3264
s_lshr_b32 s37, s36, 1
MV 84,a,128,a,168
MV 88,a,132,a,168
ds_read2_b32 a[196:197], v40 offset0:176 offset1:177
s_xor_b32 s36, s36, s37
s_waitcnt lgkmcnt(15)
MV 88,a,128,a,172
ds_read2_b32 a[198:199], v40 offset0:178 offset1:179
s_and_b32 s36, s36, 1
MV 92,a,132,a,172
ds_read_b128 a[232:235], v5 offset:2752
MV 92,a,128,a,176
ds_read2_b32 a[200:201], v41 offset0:48 offset1:49
s_lshl_b32 s37, s37, 6
MV 96,a,132,a,176
s_waitcnt lgkmcnt(15)
MV 96,a,128,a,180
ds_read2_b32 a[202:203], v41 offset0:50 offset1:51
s_add_u32 s36, s36, s37
MV 100,a,132,a,180
ds_read_b128 a[236:239], v5 offset:2240
s_lshl_b32 s37, s80, 2
s_waitcnt lgkmcnt(15)
MV 100,a,128,a,184
ds_read2_b32 a[204:205], v41 offset0:176 offset1:177
MV 104,a,132,a,184
ds_read2_b32 a[206:207], v41 offset0:178 offset1:179
s_add_u32 s36, s36, s37
s_waitcnt lgkmcnt(14)
MV 104,a,128,a,188
MV 84,a,136,a,160
ds_read_b128 a[240:243], v5 offset:1728
s_add_u32 s36, s36, 1024
MV 88,a,140,a,160
ds_read2_b32 a[208:209], v42 offset0:48 offset1:49
v_bfe_u32 v228, v1, 4, 1
MV 88,a,136,a,164
ds_read2_b32 a[210:211], v42 offset0:50 offset1:51
MV 92,a,140,a,164
ds_read_b128 a[244:247], v5 offset:1216
v_lshl_add_u32 v228, s3, 1, v228
MV 92,a,136,a,168
MV 96,a,140,a,168
ds_read2_b32 a[212:213], v42 offset0:176 offset1:177
v_sub_u32 v229, 7, v228
MV 96,a,136,a,172
ds_read2_b32 a[214:215], v42 offset0:178 offset1:179
v_min_u32 v228, v228, v229
MV 100,a,140,a,172
ds_read_b128 a[248:251], v5 offset:704
MV 100,a,136,a,176
ds_read2_b32 a[216:217], v43 offset0:48 offset1:49
v_lshl_add_u32 v229, v228, 8, s36
MV 104,a,140,a,176
MV 104,a,136,a,180
ds_read2_b32 a[218:219], v43 offset0:50 offset1:51
v_and_b32 v252, 7, v1
MV 92,a,144,a,160
ds_read_b128 a[252:255], v5 offset:192
v_lshlrev_b32 v252, 3, v252
MV 96,a,148,a,160
ds_read2_b32 a[220:221], v43 offset0:176 offset1:177
MV 96,a,144,a,164
ds_read2_b32 a[222:223], v43 offset0:178 offset1:179
v_bfe_u32 v228, v1, 3, 1
MV 100,a,148,a,164
MV 100,a,144,a,168
v_lshlrev_b32 v228, 1, v228
MV 104,a,148,a,168
v_add3_u32 v252, v252, v228, v229
MV 104,a,144,a,172
MV 100,a,152,a,160
v_lshlrev_b32 v252, 2, v252
s_waitcnt lgkmcnt(15)
MV 104,a,156,a,160
MV 104,a,152,a,164
s_waitcnt vmcnt(0)
v_cmp_gt_u32 vcc, 1, v253
s_nop 4
s_cbranch_vccnz L_spin_w
L_spin_w_ret:
MV 76,a,192,a,224
ds_read_b128 a[160:163], v5 offset:3840
s_add_u32 m0, s70, 66560
MV 80,a,196,a,224
ds_read2_b32 a[128:129], v40 offset0:64 offset1:65
v_lshlrev_b32 v255, 20, v1
MV 80,a,192,a,228
ds_read2_b32 a[130:131], v40 offset0:66 offset1:67
buffer_load_dwordx4 v238, s[48:51], s69 offen offset:0 sc1 lds
MV 84,a,196,a,228
ds_read_b128 a[164:167], v5 offset:3328
MV 84,a,192,a,232
MV 88,a,196,a,232
ds_read2_b32 a[132:133], v40 offset0:192 offset1:193
buffer_load_dwordx4 v238, s[48:51], s69 offen offset:1024 sc1 lds
s_waitcnt lgkmcnt(15)
MV 88,a,192,a,236
ds_read2_b32 a[134:135], v40 offset0:194 offset1:195
MV 92,a,196,a,236
ds_read_b128 a[168:171], v5 offset:2816
MV 92,a,192,a,240
ds_read2_b32 a[136:137], v41 offset0:64 offset1:65
buffer_load_dwordx4 v238, s[48:51], s69 offen offset:2048 sc1 lds
MV 96,a,196,a,240
s_waitcnt lgkmcnt(15)
MV 96,a,192,a,244
ds_read2_b32 a[138:139], v41 offset0:66 offset1:67
MV 100,a,196,a,244
ds_read_b128 a[172:175], v5 offset:2304
buffer_load_dwordx4 v238, s[48:51], s69 offen offset:3072 sc1 lds
s_waitcnt lgkmcnt(15)
MV 100,a,192,a,248
ds_read2_b32 a[140:141], v41 offset0:192 offset1:193
s_lshl_b32 s36, s3, 26
MV 104,a,196,a,248
ds_read2_b32 a[142:143], v41 offset0:194 offset1:195
s_waitcnt lgkmcnt(14)
MV 104,a,192,a,252
s_add_u32 s69, s69, 16384
MV 84,a,200,a,224
ds_read_b128 a[176:179], v5 offset:1792
MV 88,a,204,a,224
ds_read2_b32 a[144:145], v42 offset0:64 offset1:65
MV 88,a,200,a,228
ds_read2_b32 a[146:147], v42 offset0:66 offset1:67
s_add_u32 m0, s70, 82944
MV 92,a,204,a,228
ds_read_b128 a[180:183], v5 offset:1280
MV 92,a,200,a,232
MV 96,a,204,a,232
ds_read2_b32 a[148:149], v42 offset0:192 offset1:193
buffer_load_dwordx4 v238, s[48:51], s69 offen offset:0 sc1 lds
MV 96,a,200,a,236
ds_read2_b32 a[150:151], v42 offset0:194 offset1:195
MV 100,a,204,a,236
ds_read_b128 a[184:187], v5 offset:768
MV 100,a,200,a,240
ds_read2_b32 a[152:153], v43 offset0:64 offset1:65
buffer_load_dwordx4 v238, s[48:51], s69 offen offset:1024 sc1 lds
MV 104,a,204,a,240
v_add_u32 v255, s36, v255
MV 104,a,200,a,244
ds_read2_b32 a[154:155], v43 offset0:66 offset1:67
MV 92,a,208,a,224
ds_read_b128 a[188:191], v5 offset:256
buffer_load_dwordx4 v238, s[48:51], s69 offen offset:2048 sc1 lds
MV 96,a,212,a,224
ds_read2_b32 a[156:157], v43 offset0:192 offset1:193
MV 96,a,208,a,228
ds_read2_b32 a[158:159], v43 offset0:194 offset1:195
MV 100,a,212,a,228
buffer_load_dwordx4 v238, s[48:51], s69 offen offset:3072 sc1 lds
MV 100,a,208,a,232
MV 104,a,212,a,232
MV 104,a,208,a,236
s_add_u32 s69, s69, 16384
MV 100,a,216,a,224
s_waitcnt lgkmcnt(15)
MV 104,a,220,a,224
MV 104,a,216,a,228
MV 76,a,128,a,160
ds_read_b128 a[224:227], v5 offset:3904
s_add_u32 m0, s70, 99328
MV 80,a,132,a,160
ds_read2_b32 a[192:193], v40 offset0:80 offset1:81
v_mul_u32_u24 v18, 136, v16
MV 80,a,128,a,164
ds_read2_b32 a[194:195], v40 offset0:82 offset1:83
v_lshl_add_u32 v18, v17, 5, v18
MV 84,a,132,a,164
ds_read_b128 a[228:231], v5 offset:3392
MV 84,a,128,a,168
MV 88,a,132,a,168
ds_read2_b32 a[196:197], v40 offset0:208 offset1:209
buffer_load_dwordx4 v238, s[48:51], s69 offen offset:0 sc1 lds
s_waitcnt lgkmcnt(15)
MV 88,a,128,a,172
ds_read2_b32 a[198:199], v40 offset0:210 offset1:211
s_lshl_b32 s37, s3, 1
MV 92,a,132,a,172
ds_read_b128 a[232:235], v5 offset:2880
s_add_u32 s37, s37, 49152
MV 92,a,128,a,176
ds_read2_b32 a[200:201], v41 offset0:80 offset1:81
MV 96,a,132,a,176
s_waitcnt lgkmcnt(15)
MV 96,a,128,a,180
ds_read2_b32 a[202:203], v41 offset0:82 offset1:83
v_add_u32 v11, s37, v18
MV 100,a,132,a,180
ds_read_b128 a[236:239], v5 offset:2368
buffer_load_dwordx4 v238, s[48:51], s69 offen offset:1024 sc1 lds
s_waitcnt lgkmcnt(15)
MV 100,a,128,a,184
ds_read2_b32 a[204:205], v41 offset0:208 offset1:209
v_lshrrev_b32 v18, 3, v1
MV 104,a,132,a,184
ds_read2_b32 a[206:207], v41 offset0:210 offset1:211
s_waitcnt lgkmcnt(14)
MV 104,a,128,a,188
MV 84,a,136,a,160
ds_read_b128 a[240:243], v5 offset:1856
v_mul_u32_u24 v18, 136, v18
MV 88,a,140,a,160
ds_read2_b32 a[208:209], v42 offset0:80 offset1:81
MV 88,a,136,a,164
ds_read2_b32 a[210:211], v42 offset0:82 offset1:83
buffer_load_dwordx4 v238, s[48:51], s69 offen offset:2048 sc1 lds
MV 92,a,140,a,164
ds_read_b128 a[244:247], v5 offset:1344
v_and_b32 v19, 7, v1
MV 92,a,136,a,168
MV 96,a,140,a,168
ds_read2_b32 a[212:213], v42 offset0:208 offset1:209
v_lshl_add_u32 v18, v19, 4, v18
MV 96,a,136,a,172
ds_read2_b32 a[214:215], v42 offset0:210 offset1:211
MV 100,a,140,a,172
ds_read_b128 a[248:251], v5 offset:832
s_mul_i32 s37, s3, 4352
MV 100,a,136,a,176
ds_read2_b32 a[216:217], v43 offset0:80 offset1:81
buffer_load_dwordx4 v238, s[48:51], s69 offen offset:3072 sc1 lds
MV 104,a,140,a,176
MV 104,a,136,a,180
ds_read2_b32 a[218:219], v43 offset0:82 offset1:83
s_add_u32 s37, s37, 49152
MV 92,a,144,a,160
ds_read_b128 a[252:255], v5 offset:320
MV 96,a,148,a,160
ds_read2_b32 a[220:221], v43 offset0:208 offset1:209
v_add_u32 v12, s37, v18
MV 96,a,144,a,164
ds_read2_b32 a[222:223], v43 offset0:210 offset1:211
MV 100,a,148,a,164
s_add_u32 s69, s69, 16384
MV 100,a,144,a,168
s_lshl_b32 s37, s3, 12
MV 104,a,148,a,168
MV 104,a,144,a,172
v_add_u32 v13, s37, v232
MV 100,a,152,a,160
s_waitcnt lgkmcnt(15)
MV 104,a,156,a,160
MV 104,a,152,a,164
buffer_load_dword v253, v252, s[8:11], 0 offen sc1
MV 76,a,192,a,224
ds_read_b128 a[160:163], v5 offset:3968
MV 80,a,196,a,224
ds_read2_b32 a[128:129], v40 offset0:96 offset1:97
MV 80,a,192,a,228
ds_read2_b32 a[130:131], v40 offset0:98 offset1:99
MV 84,a,196,a,228
ds_read_b128 a[164:167], v5 offset:3456
MV 84,a,192,a,232
MV 88,a,196,a,232
ds_read2_b32 a[132:133], v40 offset0:224 offset1:225
s_waitcnt lgkmcnt(15)
MV 88,a,192,a,236
ds_read2_b32 a[134:135], v40 offset0:226 offset1:227
MV 92,a,196,a,236
ds_read_b128 a[168:171], v5 offset:2944
MV 92,a,192,a,240
ds_read2_b32 a[136:137], v41 offset0:96 offset1:97
MV 96,a,196,a,240
s_waitcnt lgkmcnt(15)
MV 96,a,192,a,244
ds_read2_b32 a[138:139], v41 offset0:98 offset1:99
MV 100,a,196,a,244
ds_read_b128 a[172:175], v5 offset:2432
s_waitcnt lgkmcnt(15)
MV 100,a,192,a,248
ds_read2_b32 a[140:141], v41 offset0:224 offset1:225
MV 104,a,196,a,248
ds_read2_b32 a[142:143], v41 offset0:226 offset1:227
s_waitcnt lgkmcnt(14)
MV 104,a,192,a,252
MV 84,a,200,a,224
ds_read_b128 a[176:179], v5 offset:1920
MV 88,a,204,a,224
ds_read2_b32 a[144:145], v42 offset0:96 offset1:97
MV 88,a,200,a,228
ds_read2_b32 a[146:147], v42 offset0:98 offset1:99
MV 92,a,204,a,228
ds_read_b128 a[180:183], v5 offset:1408
MV 92,a,200,a,232
MV 96,a,204,a,232
ds_read2_b32 a[148:149], v42 offset0:224 offset1:225
MV 96,a,200,a,236
ds_read2_b32 a[150:151], v42 offset0:226 offset1:227
MV 100,a,204,a,236
ds_read_b128 a[184:187], v5 offset:896
MV 100,a,200,a,240
ds_read2_b32 a[152:153], v43 offset0:96 offset1:97
MV 104,a,204,a,240
MV 104,a,200,a,244
ds_read2_b32 a[154:155], v43 offset0:98 offset1:99
MV 92,a,208,a,224
ds_read_b128 a[188:191], v5 offset:384
MV 96,a,212,a,224
ds_read2_b32 a[156:157], v43 offset0:224 offset1:225
MV 96,a,208,a,228
ds_read2_b32 a[158:159], v43 offset0:226 offset1:227
MV 100,a,212,a,228
MV 100,a,208,a,232
MV 104,a,212,a,232
MV 104,a,208,a,236
MV 100,a,216,a,224
s_waitcnt lgkmcnt(15)
MV 104,a,220,a,224
MV 104,a,216,a,228
s_waitcnt vmcnt(0)
v_cmp_gt_u32 vcc, 1, v253
s_nop 4
s_cbranch_vccnz L_spin_f2
L_spin_f2_ret:
buffer_load_dwordx4 a[0:3], v236, s[44:47], s68 offen offset:0 sc1
buffer_load_dwordx4 a[4:7], v237, s[44:47], s68 offen offset:0 sc1
buffer_load_dwordx4 a[8:11], v236, s[44:47], s68 offen offset:1024 sc1
buffer_load_dwordx4 a[12:15], v237, s[44:47], s68 offen offset:1024 sc1
s_add_u32 s68, s68, 2048
MV 76,a,128,a,160
ds_read_b128 a[224:227], v5 offset:4032
buffer_load_dwordx4 a[16:19], v236, s[44:47], s68 offen offset:0 sc1
MV 80,a,132,a,160
ds_read2_b32 a[192:193], v40 offset0:112 offset1:113
MV 80,a,128,a,164
ds_read2_b32 a[194:195], v40 offset0:114 offset1:115
buffer_load_dwordx4 a[20:23], v237, s[44:47], s68 offen offset:0 sc1
MV 84,a,132,a,164
ds_read_b128 a[228:231], v5 offset:3520
MV 84,a,128,a,168
buffer_load_dwordx4 a[24:27], v236, s[44:47], s68 offen offset:1024 sc1
MV 88,a,132,a,168
ds_read2_b32 a[196:197], v40 offset0:240 offset1:241
s_waitcnt lgkmcnt(15)
MV 88,a,128,a,172
ds_read2_b32 a[198:199], v40 offset0:242 offset1:243
MV 92,a,132,a,172
ds_read_b128 a[232:235], v5 offset:3008
buffer_load_dwordx4 a[28:31], v237, s[44:47], s68 offen offset:1024 sc1
MV 92,a,128,a,176
ds_read2_b32 a[200:201], v41 offset0:112 offset1:113
MV 96,a,132,a,176
s_add_u32 s68, s68, 2048
s_waitcnt lgkmcnt(15)
MV 96,a,128,a,180
ds_read2_b32 a[202:203], v41 offset0:114 offset1:115
MV 100,a,132,a,180
ds_read_b128 a[236:239], v5 offset:2496
buffer_load_dwordx4 a[32:35], v236, s[44:47], s68 offen offset:0 sc1
s_waitcnt lgkmcnt(15)
MV 100,a,128,a,184
ds_read2_b32 a[204:205], v41 offset0:240 offset1:241
MV 104,a,132,a,184
ds_read2_b32 a[206:207], v41 offset0:242 offset1:243
s_waitcnt lgkmcnt(14)
MV 104,a,128,a,188
buffer_load_dwordx4 a[36:39], v237, s[44:47], s68 offen offset:0 sc1
MV 84,a,136,a,160
ds_read_b128 a[240:243], v5 offset:1984
MV 88,a,140,a,160
ds_read2_b32 a[208:209], v42 offset0:112 offset1:113
buffer_load_dwordx4 a[40:43], v236, s[44:47], s68 offen offset:1024 sc1
MV 88,a,136,a,164
ds_read2_b32 a[210:211], v42 offset0:114 offset1:115
MV 92,a,140,a,164
ds_read_b128 a[244:247], v5 offset:1472
buffer_load_dwordx4 a[44:47], v237, s[44:47], s68 offen offset:1024 sc1
MV 92,a,136,a,168
MV 96,a,140,a,168
ds_read2_b32 a[212:213], v42 offset0:240 offset1:241
MV 96,a,136,a,172
ds_read2_b32 a[214:215], v42 offset0:242 offset1:243
s_add_u32 s68, s68, 2048
MV 100,a,140,a,172
ds_read_b128 a[248:251], v5 offset:960
MV 100,a,136,a,176
ds_read2_b32 a[216:217], v43 offset0:112 offset1:113
buffer_load_dwordx4 a[48:51], v236, s[44:47], s68 offen offset:0 sc1
MV 104,a,140,a,176
MV 104,a,136,a,180
ds_read2_b32 a[218:219], v43 offset0:114 offset1:115
buffer_load_dwordx4 a[52:55], v237, s[44:47], s68 offen offset:0 sc1
MV 92,a,144,a,160
ds_read_b128 a[252:255], v5 offset:448
MV 96,a,148,a,160
ds_read2_b32 a[220:221], v43 offset0:240 offset1:241
MV 96,a,144,a,164
ds_read2_b32 a[222:223], v43 offset0:242 offset1:243
buffer_load_dwordx4 a[56:59], v236, s[44:47], s68 offen offset:1024 sc1
MV 100,a,148,a,164
MV 100,a,144,a,168
buffer_load_dwordx4 a[60:63], v237, s[44:47], s68 offen offset:1024 sc1
MV 104,a,148,a,168
MV 104,a,144,a,172
s_add_u32 s68, s68, 2048
MV 100,a,152,a,160
s_waitcnt lgkmcnt(15)
MV 104,a,156,a,160
MV 104,a,152,a,164
s_waitcnt lgkmcnt(0)
s_barrier
ds_read_b128 a[64:67], v242 offset:0
ds_read_b128 a[68:71], v242 offset:1024
ds_read_b128 a[72:75], v242 offset:2048
ds_read_b128 a[76:79], v242 offset:3072
ds_read_b128 a[80:83], v243 offset:0
ds_read_b128 a[84:87], v243 offset:1024
ds_read_b128 a[88:91], v243 offset:2048
ds_read_b128 a[92:95], v243 offset:3072
s_waitcnt lgkmcnt(0)
s_waitcnt vmcnt(15)
v_mfma_f32_16x16x32_bf16 v[124:127], a[64:67], a[0:3], 0
ds_read_b128 a[96:99], v242 offset:8192
MV 76,a,192,a,224
s_add_u32 m0, s70, 115712
s_waitcnt vmcnt(14)
v_mfma_f32_16x16x32_bf16 v[128:131], a[64:67], a[4:7], 0
ds_read_b128 a[100:103], v242 offset:9216
MV 80,a,196,a,224
v_mfma_f32_16x16x32_bf16 v[132:135], a[68:71], a[0:3], 0
MV 80,a,192,a,228
ds_read_b128 a[104:107], v242 offset:10240
v_mfma_f32_16x16x32_bf16 v[136:139], a[68:71], a[4:7], 0
v_mfma_f32_16x16x32_bf16 v[140:143], a[72:75], a[0:3], 0
ds_read_b128 a[108:111], v242 offset:11264
MV 84,a,196,a,228
v_mfma_f32_16x16x32_bf16 v[144:147], a[72:75], a[4:7], 0
buffer_load_dwordx4 v238, s[48:51], s69 offen offset:0 sc1 lds
MV 84,a,192,a,232
ds_read_b128 a[112:115], v243 offset:8192
v_mfma_f32_16x16x32_bf16 v[148:151], a[76:79], a[0:3], 0
MV 88,a,196,a,232
v_mfma_f32_16x16x32_bf16 v[152:155], a[76:79], a[4:7], 0
ds_read_b128 a[116:119], v243 offset:9216
v_mfma_f32_16x16x32_bf16 v[156:159], a[80:83], a[0:3], 0
MV 88,a,192,a,236
ds_read_b128 a[120:123], v243 offset:10240
v_mfma_f32_16x16x32_bf16 v[160:163], a[80:83], a[4:7], 0
MV 92,a,196,a,236
buffer_load_dwordx4 v238, s[48:51], s69 offen offset:1024 sc1 lds
v_mfma_f32_16x16x32_bf16 v[164:167], a[84:87], a[0:3], 0
ds_read_b128 a[124:127], v243 offset:11264
MV 92,a,192,a,240
v_mfma_f32_16x16x32_bf16 v[168:171], a[84:87], a[4:7], 0
v_mfma_f32_16x16x32_bf16 v[172:175], a[88:91], a[0:3], 0
MV 96,a,196,a,240
v_mfma_f32_16x16x32_bf16 v[176:179], a[88:91], a[4:7], 0
MV 96,a,192,a,244
v_mfma_f32_16x16x32_bf16 v[180:183], a[92:95], a[0:3], 0
buffer_load_dwordx4 a[0:3], v236, s[44:47], s68 offen offset:0 sc1
MV 100,a,196,a,244
v_mfma_f32_16x16x32_bf16 v[184:187], a[92:95], a[4:7], 0
buffer_load_dwordx4 a[4:7], v237, s[44:47], s68 offen offset:0 sc1
s_waitcnt lgkmcnt(0)
s_barrier
s_waitcnt vmcnt(17)
MV 124,a,96,a,8
ds_read_b128 a[64:67], v242 offset:16384
MV 100,a,192,a,248
buffer_load_dwordx4 v238, s[48:51], s69 offen offset:2048 sc1 lds
s_waitcnt vmcnt(17)
MV 128,a,96,a,12
ds_read_b128 a[68:71], v242 offset:17408
MV 104,a,196,a,248
MV 132,a,100,a,8
MV 104,a,192,a,252
ds_read_b128 a[72:75], v242 offset:18432
MV 136,a,100,a,12
MV 140,a,104,a,8
ds_read_b128 a[76:79], v242 offset:19456
MV 84,a,200,a,224
MV 144,a,104,a,12
buffer_load_dwordx4 v238, s[48:51], s69 offen offset:3072 sc1 lds
MV 88,a,204,a,224
ds_read_b128 a[80:83], v243 offset:16384
MV 148,a,108,a,8
MV 88,a,200,a,228
MV 152,a,108,a,12
ds_read_b128 a[84:87], v243 offset:17408
MV 156,a,112,a,8
MV 92,a,204,a,228
ds_read_b128 a[88:91], v243 offset:18432
MV 160,a,112,a,12
MV 92,a,200,a,232
s_add_u32 s69, s69, 16384
MV 164,a,116,a,8
ds_read_b128 a[92:95], v243 offset:19456
MV 96,a,204,a,232
MV 168,a,116,a,12
MV 172,a,120,a,8
MV 96,a,200,a,236
MV 176,a,120,a,12
MV 100,a,204,a,236
MV 180,a,124,a,8
buffer_load_dwordx4 a[8:11], v236, s[44:47], s68 offen offset:1024 sc1
MV 100,a,200,a,240
MV 184,a,124,a,12
buffer_load_dwordx4 a[12:15], v237, s[44:47], s68 offen offset:1024 sc1
s_add_u32 s68, s68, 2048
s_waitcnt lgkmcnt(0)
s_waitcnt vmcnt(19)
MV 124,a,64,a,16
ds_read_b128 a[96:99], v242 offset:24576
MV 104,a,204,a,240
s_add_u32 m0, s70, 66560
s_waitcnt vmcnt(18)
MV 128,a,64,a,20
ds_read_b128 a[100:103], v242 offset:25600
MV 104,a,200,a,244
MV 132,a,68,a,16
MV 92,a,208,a,224
ds_read_b128 a[104:107], v242 offset:26624
MV 136,a,68,a,20
MV 140,a,72,a,16
ds_read_b128 a[108:111], v242 offset:27648
MV 96,a,212,a,224
MV 144,a,72,a,20
buffer_load_dwordx4 v238, s[48:51], s69 offen offset:0 sc1 lds
MV 96,a,208,a,228
ds_read_b128 a[112:115], v243 offset:24576
MV 148,a,76,a,16
MV 100,a,212,a,228
MV 152,a,76,a,20
ds_read_b128 a[116:119], v243 offset:25600
MV 156,a,80,a,16
MV 100,a,208,a,232
ds_read_b128 a[120:123], v243 offset:26624
MV 160,a,80,a,20
MV 104,a,212,a,232
buffer_load_dwordx4 v238, s[48:51], s69 offen offset:1024 sc1 lds
MV 164,a,84,a,16
ds_read_b128 a[124:127], v243 offset:27648
MV 104,a,208,a,236
MV 168,a,84,a,20
MV 172,a,88,a,16
MV 100,a,216,a,224
MV 176,a,88,a,20
MV 104,a,220,a,224
MV 180,a,92,a,16
buffer_load_dwordx4 a[16:19], v236, s[44:47], s68 offen offset:0 sc1
MV 104,a,216,a,228
MV 184,a,92,a,20
buffer_load_dwordx4 a[20:23], v237, s[44:47], s68 offen offset:0 sc1
s_waitcnt lgkmcnt(0)
s_barrier
s_waitcnt vmcnt(21)
MV 124,a,96,a,24
ds_read_b128 a[64:67], v242 offset:32768
s_waitcnt vmcnt(20)
MV 128,a,96,a,28
ds_read_b128 a[68:71], v242 offset:33792
buffer_load_dwordx4 v238, s[48:51], s69 offen offset:2048 sc1 lds
MV 132,a,100,a,24
MV 136,a,100,a,28
ds_read_b128 a[72:75], v242 offset:34816
MV 140,a,104,a,24
ds_read_b128 a[76:79], v242 offset:35840
MV 144,a,104,a,28
buffer_load_dwordx4 v238, s[48:51], s69 offen offset:3072 sc1 lds
MV 148,a,108,a,24
ds_read_b128 a[80:83], v243 offset:32768
MV 152,a,108,a,28
ds_read_b128 a[84:87], v243 offset:33792
MV 156,a,112,a,24
MV 160,a,112,a,28
ds_read_b128 a[88:91], v243 offset:34816
s_add_u32 s69, s69, 16384
MV 164,a,116,a,24
ds_read_b128 a[92:95], v243 offset:35840
MV 168,a,116,a,28
MV 172,a,120,a,24
MV 176,a,120,a,28
MV 180,a,124,a,24
buffer_load_dwordx4 a[24:27], v236, s[44:47], s68 offen offset:1024 sc1
MV 184,a,124,a,28
buffer_load_dwordx4 a[28:31], v237, s[44:47], s68 offen offset:1024 sc1
s_add_u32 s68, s68, 2048
s_waitcnt lgkmcnt(0)
s_waitcnt vmcnt(23)
MV 124,a,64,a,32
ds_read_b128 a[96:99], v242 offset:40960
v_cvt_pk_bf16_f32 v16, v76, v77
s_waitcnt vmcnt(22)
MV 128,a,64,a,36
ds_read_b128 a[100:103], v242 offset:41984
s_add_u32 m0, s70, 82944
MV 132,a,68,a,32
v_cvt_pk_bf16_f32 v17, v78, v79
MV 136,a,68,a,36
ds_read_b128 a[104:107], v242 offset:43008
ds_write_b16 v11, v16 offset:0
MV 140,a,72,a,32
ds_read_b128 a[108:111], v242 offset:44032
MV 144,a,72,a,36
buffer_load_dwordx4 v238, s[48:51], s69 offen offset:0 sc1 lds
ds_write_b16_d16_hi v11, v16 offset:8
MV 148,a,76,a,32
ds_read_b128 a[112:115], v243 offset:40960
MV 152,a,76,a,36
ds_read_b128 a[116:119], v243 offset:41984
ds_write_b16 v11, v17 offset:16
MV 156,a,80,a,32
ds_write_b16_d16_hi v11, v17 offset:24
MV 160,a,80,a,36
ds_read_b128 a[120:123], v243 offset:43008
buffer_load_dwordx4 v238, s[48:51], s69 offen offset:1024 sc1 lds
MV 164,a,84,a,32
ds_read_b128 a[124:127], v243 offset:44032
v_cvt_pk_bf16_f32 v18, v80, v81
MV 168,a,84,a,36
MV 172,a,88,a,32
v_cvt_pk_bf16_f32 v19, v82, v83
MV 176,a,88,a,36
MV 180,a,92,a,32
buffer_load_dwordx4 a[32:35], v236, s[44:47], s68 offen offset:0 sc1
ds_write_b16 v11, v18 offset:2176
MV 184,a,92,a,36
buffer_load_dwordx4 a[36:39], v237, s[44:47], s68 offen offset:0 sc1
s_waitcnt vmcnt(14) lgkmcnt(0)
s_barrier
MV 124,a,96,a,40
ds_read_b128 a[64:67], v242 offset:49152
ds_write_b16_d16_hi v11, v18 offset:2184
MV 128,a,96,a,44
ds_read_b128 a[68:71], v242 offset:50176
buffer_load_dwordx4 v238, s[48:51], s69 offen offset:2048 sc1 lds
MV 132,a,100,a,40
ds_write_b16 v11, v19 offset:2192
MV 136,a,100,a,44
ds_read_b128 a[72:75], v242 offset:51200
ds_write_b16_d16_hi v11, v19 offset:2200
MV 140,a,104,a,40
ds_read_b128 a[76:79], v242 offset:52224
v_cvt_pk_bf16_f32 v16, v84, v85
MV 144,a,104,a,44
buffer_load_dwordx4 v238, s[48:51], s69 offen offset:3072 sc1 lds
MV 148,a,108,a,40
ds_read_b128 a[80:83], v243 offset:49152
v_cvt_pk_bf16_f32 v17, v86, v87
MV 152,a,108,a,44
ds_read_b128 a[84:87], v243 offset:50176
MV 156,a,112,a,40
ds_write_b16 v11, v16 offset:4352
MV 160,a,112,a,44
ds_read_b128 a[88:91], v243 offset:51200
s_add_u32 s69, s69, 16384
MV 164,a,116,a,40
ds_read_b128 a[92:95], v243 offset:52224
ds_write_b16_d16_hi v11, v16 offset:4360
MV 168,a,116,a,44
ds_write_b16 v11, v17 offset:4368
MV 172,a,120,a,40
ds_write_b16_d16_hi v11, v17 offset:4376
MV 176,a,120,a,44
MV 180,a,124,a,40
buffer_load_dwordx4 a[40:43], v236, s[44:47], s68 offen offset:1024 sc1
v_cvt_pk_bf16_f32 v18, v88, v89
MV 184,a,124,a,44
buffer_load_dwordx4 a[44:47], v237, s[44:47], s68 offen offset:1024 sc1
s_add_u32 s68, s68, 2048
s_waitcnt lgkmcnt(0)
MV 124,a,64,a,48
ds_read_b128 a[96:99], v242 offset:57344
v_cvt_pk_bf16_f32 v19, v90, v91
MV 128,a,64,a,52
ds_read_b128 a[100:103], v242 offset:58368
s_add_u32 m0, s70, 99328
MV 132,a,68,a,48
ds_write_b16 v11, v18 offset:6528
MV 136,a,68,a,52
ds_read_b128 a[104:107], v242 offset:59392
ds_write_b16_d16_hi v11, v18 offset:6536
MV 140,a,72,a,48
ds_read_b128 a[108:111], v242 offset:60416
MV 144,a,72,a,52
buffer_load_dwordx4 v238, s[48:51], s69 offen offset:0 sc1 lds
ds_write_b16 v11, v19 offset:6544
MV 148,a,76,a,48
ds_read_b128 a[112:115], v243 offset:57344
MV 152,a,76,a,52
ds_read_b128 a[116:119], v243 offset:58368
ds_write_b16_d16_hi v11, v19 offset:6552
MV 156,a,80,a,48
v_cvt_pk_bf16_f32 v16, v92, v93
MV 160,a,80,a,52
ds_read_b128 a[120:123], v243 offset:59392
buffer_load_dwordx4 v238, s[48:51], s69 offen offset:1024 sc1 lds
MV 164,a,84,a,48
ds_read_b128 a[124:127], v243 offset:60416
v_cvt_pk_bf16_f32 v17, v94, v95
MV 168,a,84,a,52
MV 172,a,88,a,48
ds_write_b16 v11, v16 offset:8704
MV 176,a,88,a,52
MV 180,a,92,a,48
buffer_load_dwordx4 a[48:51], v236, s[44:47], s68 offen offset:0 sc1
ds_write_b16_d16_hi v11, v16 offset:8712
MV 184,a,92,a,52
buffer_load_dwordx4 a[52:55], v237, s[44:47], s68 offen offset:0 sc1
s_waitcnt vmcnt(14) lgkmcnt(0)
s_barrier
MV 124,a,96,a,56
ds_read_b128 a[64:67], v242 offset:0
ds_write_b16 v11, v17 offset:8720
MV 128,a,96,a,60
ds_read_b128 a[68:71], v242 offset:1024
buffer_load_dwordx4 v238, s[48:51], s69 offen offset:2048 sc1 lds
MV 132,a,100,a,56
ds_write_b16_d16_hi v11, v17 offset:8728
MV 136,a,100,a,60
ds_read_b128 a[72:75], v242 offset:2048
v_cvt_pk_bf16_f32 v18, v96, v97
MV 140,a,104,a,56
ds_read_b128 a[76:79], v242 offset:3072
v_cvt_pk_bf16_f32 v19, v98, v99
MV 144,a,104,a,60
buffer_load_dwordx4 v238, s[48:51], s69 offen offset:3072 sc1 lds
MV 148,a,108,a,56
ds_read_b128 a[80:83], v243 offset:0
ds_write_b16 v11, v18 offset:10880
MV 152,a,108,a,60
ds_read_b128 a[84:87], v243 offset:1024
MV 156,a,112,a,56
ds_write_b16_d16_hi v11, v18 offset:10888
MV 160,a,112,a,60
ds_read_b128 a[88:91], v243 offset:2048
s_add_u32 s69, s69, 16384
MV 164,a,116,a,56
ds_read_b128 a[92:95], v243 offset:3072
ds_write_b16 v11, v19 offset:10896
MV 168,a,116,a,60
ds_write_b16_d16_hi v11, v19 offset:10904
MV 172,a,120,a,56
v_cvt_pk_bf16_f32 v16, v100, v101
MV 176,a,120,a,60
MV 180,a,124,a,56
buffer_load_dwordx4 a[56:59], v236, s[44:47], s68 offen offset:1024 sc1
v_cvt_pk_bf16_f32 v17, v102, v103
MV 184,a,124,a,60
buffer_load_dwordx4 a[60:63], v237, s[44:47], s68 offen offset:1024 sc1
s_add_u32 s68, s68, 2048
s_waitcnt lgkmcnt(0)
MV 124,a,64,a,0
ds_read_b128 a[96:99], v242 offset:8192
ds_write_b16 v11, v16 offset:13056
MV 128,a,64,a,4
ds_read_b128 a[100:103], v242 offset:9216
s_add_u32 m0, s70, 115712
MV 132,a,68,a,0
ds_write_b16_d16_hi v11, v16 offset:13064
MV 136,a,68,a,4
ds_read_b128 a[104:107], v242 offset:10240
ds_write_b16 v11, v17 offset:13072
MV 140,a,72,a,0
ds_read_b128 a[108:111], v242 offset:11264
ds_write_b16_d16_hi v11, v17 offset:13080
MV 144,a,72,a,4
buffer_load_dwordx4 v238, s[48:51], s69 offen offset:0 sc1 lds
MV 148,a,76,a,0
ds_read_b128 a[112:115], v243 offset:8192
v_cvt_pk_bf16_f32 v18, v104, v105
MV 152,a,76,a,4
ds_read_b128 a[116:119], v243 offset:9216
MV 156,a,80,a,0
v_cvt_pk_bf16_f32 v19, v106, v107
MV 160,a,80,a,4
ds_read_b128 a[120:123], v243 offset:10240
buffer_load_dwordx4 v238, s[48:51], s69 offen offset:1024 sc1 lds
MV 164,a,84,a,0
ds_read_b128 a[124:127], v243 offset:11264
ds_write_b16 v11, v18 offset:15232
MV 168,a,84,a,4
ds_write_b16_d16_hi v11, v18 offset:15240
MV 172,a,88,a,0
ds_write_b16 v11, v19 offset:15248
MV 176,a,88,a,4
MV 180,a,92,a,0
buffer_load_dwordx4 a[0:3], v236, s[44:47], s68 offen offset:0 sc1
ds_write_b16_d16_hi v11, v19 offset:15256
MV 184,a,92,a,4
buffer_load_dwordx4 a[4:7], v237, s[44:47], s68 offen offset:0 sc1
s_waitcnt vmcnt(14) lgkmcnt(0)
s_barrier
MV 124,a,96,a,8
ds_read_b128 a[64:67], v242 offset:16384
ds_read_b64 v[108:109], v12 offset:0
MV 128,a,96,a,12
ds_read_b128 a[68:71], v242 offset:17408
buffer_load_dwordx4 v238, s[48:51], s69 offen offset:2048 sc1 lds
MV 132,a,100,a,8
ds_read_b64 v[110:111], v12 offset:8
MV 136,a,100,a,12
ds_read_b128 a[72:75], v242 offset:18432
MV 140,a,104,a,8
ds_read_b128 a[76:79], v242 offset:19456
ds_read_b64 v[112:113], v12 offset:1088
MV 144,a,104,a,12
buffer_load_dwordx4 v238, s[48:51], s69 offen offset:3072 sc1 lds
MV 148,a,108,a,8
ds_read_b128 a[80:83], v243 offset:16384
ds_read_b64 v[114:115], v12 offset:1096
MV 152,a,108,a,12
ds_read_b128 a[84:87], v243 offset:17408
MV 156,a,112,a,8
ds_read_b64 v[116:117], v12 offset:2176
MV 160,a,112,a,12
ds_read_b128 a[88:91], v243 offset:18432
s_add_u32 s69, s69, 16384
MV 164,a,116,a,8
ds_read_b128 a[92:95], v243 offset:19456
ds_read_b64 v[118:119], v12 offset:2184
MV 168,a,116,a,12
MV 172,a,120,a,8
ds_read_b64 v[120:121], v12 offset:3264
MV 176,a,120,a,12
MV 180,a,124,a,8
buffer_load_dwordx4 a[8:11], v236, s[44:47], s68 offen offset:1024 sc1
ds_read_b64 v[122:123], v12 offset:3272
MV 184,a,124,a,12
buffer_load_dwordx4 a[12:15], v237, s[44:47], s68 offen offset:1024 sc1
s_add_u32 s68, s68, 2048
s_waitcnt lgkmcnt(0)
MV 124,a,64,a,16
ds_read_b128 a[96:99], v242 offset:24576
buffer_store_dwordx4 v[108:111], v13, s[24:27], 0 offen offset:0 sc1
MV 128,a,64,a,20
ds_read_b128 a[100:103], v242 offset:25600
s_add_u32 m0, s70, 66560
MV 132,a,68,a,16
MV 136,a,68,a,20
ds_read_b128 a[104:107], v242 offset:26624
MV 140,a,72,a,16
ds_read_b128 a[108:111], v242 offset:27648
MV 144,a,72,a,20
buffer_load_dwordx4 v238, s[48:51], s69 offen offset:0 sc1 lds
MV 148,a,76,a,16
ds_read_b128 a[112:115], v243 offset:24576
MV 152,a,76,a,20
ds_read_b128 a[116:119], v243 offset:25600
MV 156,a,80,a,16
buffer_store_dwordx4 v[112:115], v13, s[24:27], 0 offen offset:1024 sc1
MV 160,a,80,a,20
ds_read_b128 a[120:123], v243 offset:26624
buffer_load_dwordx4 v238, s[48:51], s69 offen offset:1024 sc1 lds
MV 164,a,84,a,16
ds_read_b128 a[124:127], v243 offset:27648
MV 168,a,84,a,20
MV 172,a,88,a,16
MV 176,a,88,a,20
MV 180,a,92,a,16
buffer_load_dwordx4 a[16:19], v236, s[44:47], s68 offen offset:0 sc1
MV 184,a,92,a,20
buffer_load_dwordx4 a[20:23], v237, s[44:47], s68 offen offset:0 sc1
s_waitcnt vmcnt(16) lgkmcnt(0)
s_barrier
MV 124,a,96,a,24
ds_read_b128 a[64:67], v242 offset:32768
buffer_store_dwordx4 v[116:119], v13, s[24:27], 0 offen offset:2048 sc1
MV 128,a,96,a,28
ds_read_b128 a[68:71], v242 offset:33792
buffer_load_dwordx4 v238, s[48:51], s69 offen offset:2048 sc1 lds
MV 132,a,100,a,24
MV 136,a,100,a,28
ds_read_b128 a[72:75], v242 offset:34816
MV 140,a,104,a,24
ds_read_b128 a[76:79], v242 offset:35840
MV 144,a,104,a,28
buffer_load_dwordx4 v238, s[48:51], s69 offen offset:3072 sc1 lds
MV 148,a,108,a,24
ds_read_b128 a[80:83], v243 offset:32768
MV 152,a,108,a,28
ds_read_b128 a[84:87], v243 offset:33792
MV 156,a,112,a,24
buffer_store_dwordx4 v[120:123], v13, s[24:27], 0 offen offset:3072 sc1
MV 160,a,112,a,28
ds_read_b128 a[88:91], v243 offset:34816
s_add_u32 s69, s69, 16384
MV 164,a,116,a,24
ds_read_b128 a[92:95], v243 offset:35840
MV 168,a,116,a,28
MV 172,a,120,a,24
MV 176,a,120,a,28
MV 180,a,124,a,24
buffer_load_dwordx4 a[24:27], v236, s[44:47], s68 offen offset:1024 sc1
MV 184,a,124,a,28
buffer_load_dwordx4 a[28:31], v237, s[44:47], s68 offen offset:1024 sc1
s_add_u32 s68, s68, 2048
s_mov_b32 s71, 3
.p2align 5
L_p5_loop:
s_waitcnt lgkmcnt(0)
MV 124,a,64,a,32
ds_read_b128 a[96:99], v242 offset:40960
MV 128,a,64,a,36
ds_read_b128 a[100:103], v242 offset:41984
s_add_u32 m0, s70, 82944
MV 132,a,68,a,32
MV 136,a,68,a,36
ds_read_b128 a[104:107], v242 offset:43008
MV 140,a,72,a,32
ds_read_b128 a[108:111], v242 offset:44032
MV 144,a,72,a,36
buffer_load_dwordx4 v238, s[48:51], s69 offen offset:0 sc1 lds
MV 148,a,76,a,32
ds_read_b128 a[112:115], v243 offset:40960
MV 152,a,76,a,36
ds_read_b128 a[116:119], v243 offset:41984
MV 156,a,80,a,32
MV 160,a,80,a,36
ds_read_b128 a[120:123], v243 offset:43008
buffer_load_dwordx4 v238, s[48:51], s69 offen offset:1024 sc1 lds
MV 164,a,84,a,32
ds_read_b128 a[124:127], v243 offset:44032
MV 168,a,84,a,36
MV 172,a,88,a,32
MV 176,a,88,a,36
MV 180,a,92,a,32
buffer_load_dwordx4 a[32:35], v236, s[44:47], s68 offen offset:0 sc1
MV 184,a,92,a,36
buffer_load_dwordx4 a[36:39], v237, s[44:47], s68 offen offset:0 sc1
s_waitcnt vmcnt(14) lgkmcnt(0)
s_barrier
MV 124,a,96,a,40
ds_read_b128 a[64:67], v242 offset:49152
MV 128,a,96,a,44
ds_read_b128 a[68:71], v242 offset:50176
buffer_load_dwordx4 v238, s[48:51], s69 offen offset:2048 sc1 lds
MV 132,a,100,a,40
MV 136,a,100,a,44
ds_read_b128 a[72:75], v242 offset:51200
MV 140,a,104,a,40
ds_read_b128 a[76:79], v242 offset:52224
MV 144,a,104,a,44
buffer_load_dwordx4 v238, s[48:51], s69 offen offset:3072 sc1 lds
MV 148,a,108,a,40
ds_read_b128 a[80:83], v243 offset:49152
MV 152,a,108,a,44
ds_read_b128 a[84:87], v243 offset:50176
MV 156,a,112,a,40
MV 160,a,112,a,44
ds_read_b128 a[88:91], v243 offset:51200
s_add_u32 s69, s69, 16384
MV 164,a,116,a,40
ds_read_b128 a[92:95], v243 offset:52224
MV 168,a,116,a,44
MV 172,a,120,a,40
MV 176,a,120,a,44
MV 180,a,124,a,40
buffer_load_dwordx4 a[40:43], v236, s[44:47], s68 offen offset:1024 sc1
MV 184,a,124,a,44
buffer_load_dwordx4 a[44:47], v237, s[44:47], s68 offen offset:1024 sc1
s_add_u32 s68, s68, 2048
s_waitcnt lgkmcnt(0)
MV 124,a,64,a,48
ds_read_b128 a[96:99], v242 offset:57344
MV 128,a,64,a,52
ds_read_b128 a[100:103], v242 offset:58368
s_add_u32 m0, s70, 99328
MV 132,a,68,a,48
MV 136,a,68,a,52
ds_read_b128 a[104:107], v242 offset:59392
MV 140,a,72,a,48
ds_read_b128 a[108:111], v242 offset:60416
MV 144,a,72,a,52
buffer_load_dwordx4 v238, s[48:51], s69 offen offset:0 sc1 lds
MV 148,a,76,a,48
ds_read_b128 a[112:115], v243 offset:57344
MV 152,a,76,a,52
ds_read_b128 a[116:119], v243 offset:58368
MV 156,a,80,a,48
MV 160,a,80,a,52
ds_read_b128 a[120:123], v243 offset:59392
buffer_load_dwordx4 v238, s[48:51], s69 offen offset:1024 sc1 lds
MV 164,a,84,a,48
ds_read_b128 a[124:127], v243 offset:60416
MV 168,a,84,a,52
MV 172,a,88,a,48
MV 176,a,88,a,52
MV 180,a,92,a,48
buffer_load_dwordx4 a[48:51], v236, s[44:47], s68 offen offset:0 sc1
MV 184,a,92,a,52
buffer_load_dwordx4 a[52:55], v237, s[44:47], s68 offen offset:0 sc1
s_waitcnt vmcnt(14) lgkmcnt(0)
s_barrier
MV 124,a,96,a,56
ds_read_b128 a[64:67], v242 offset:0
MV 128,a,96,a,60
ds_read_b128 a[68:71], v242 offset:1024
buffer_load_dwordx4 v238, s[48:51], s69 offen offset:2048 sc1 lds
MV 132,a,100,a,56
MV 136,a,100,a,60
ds_read_b128 a[72:75], v242 offset:2048
MV 140,a,104,a,56
ds_read_b128 a[76:79], v242 offset:3072
MV 144,a,104,a,60
buffer_load_dwordx4 v238, s[48:51], s69 offen offset:3072 sc1 lds
MV 148,a,108,a,56
ds_read_b128 a[80:83], v243 offset:0
MV 152,a,108,a,60
ds_read_b128 a[84:87], v243 offset:1024
MV 156,a,112,a,56
MV 160,a,112,a,60
ds_read_b128 a[88:91], v243 offset:2048
s_add_u32 s69, s69, 16384
MV 164,a,116,a,56
ds_read_b128 a[92:95], v243 offset:3072
MV 168,a,116,a,60
MV 172,a,120,a,56
MV 176,a,120,a,60
MV 180,a,124,a,56
buffer_load_dwordx4 a[56:59], v236, s[44:47], s68 offen offset:1024 sc1
MV 184,a,124,a,60
buffer_load_dwordx4 a[60:63], v237, s[44:47], s68 offen offset:1024 sc1
s_add_u32 s68, s68, 2048
s_waitcnt lgkmcnt(0)
MV 124,a,64,a,0
ds_read_b128 a[96:99], v242 offset:8192
MV 128,a,64,a,4
ds_read_b128 a[100:103], v242 offset:9216
s_add_u32 m0, s70, 115712
MV 132,a,68,a,0
MV 136,a,68,a,4
ds_read_b128 a[104:107], v242 offset:10240
MV 140,a,72,a,0
ds_read_b128 a[108:111], v242 offset:11264
MV 144,a,72,a,4
buffer_load_dwordx4 v238, s[48:51], s69 offen offset:0 sc1 lds
MV 148,a,76,a,0
ds_read_b128 a[112:115], v243 offset:8192
MV 152,a,76,a,4
ds_read_b128 a[116:119], v243 offset:9216
MV 156,a,80,a,0
MV 160,a,80,a,4
ds_read_b128 a[120:123], v243 offset:10240
buffer_load_dwordx4 v238, s[48:51], s69 offen offset:1024 sc1 lds
MV 164,a,84,a,0
ds_read_b128 a[124:127], v243 offset:11264
MV 168,a,84,a,4
MV 172,a,88,a,0
MV 176,a,88,a,4
MV 180,a,92,a,0
buffer_load_dwordx4 a[0:3], v236, s[44:47], s68 offen offset:0 sc1
MV 184,a,92,a,4
buffer_load_dwordx4 a[4:7], v237, s[44:47], s68 offen offset:0 sc1
s_waitcnt vmcnt(14) lgkmcnt(0)
s_barrier
MV 124,a,96,a,8
ds_read_b128 a[64:67], v242 offset:16384
MV 128,a,96,a,12
ds_read_b128 a[68:71], v242 offset:17408
buffer_load_dwordx4 v238, s[48:51], s69 offen offset:2048 sc1 lds
MV 132,a,100,a,8
MV 136,a,100,a,12
ds_read_b128 a[72:75], v242 offset:18432
MV 140,a,104,a,8
ds_read_b128 a[76:79], v242 offset:19456
MV 144,a,104,a,12
buffer_load_dwordx4 v238, s[48:51], s69 offen offset:3072 sc1 lds
MV 148,a,108,a,8
ds_read_b128 a[80:83], v243 offset:16384
MV 152,a,108,a,12
ds_read_b128 a[84:87], v243 offset:17408
MV 156,a,112,a,8
MV 160,a,112,a,12
ds_read_b128 a[88:91], v243 offset:18432
s_add_u32 s69, s69, 16384
MV 164,a,116,a,8
ds_read_b128 a[92:95], v243 offset:19456
MV 168,a,116,a,12
MV 172,a,120,a,8
MV 176,a,120,a,12
MV 180,a,124,a,8
buffer_load_dwordx4 a[8:11], v236, s[44:47], s68 offen offset:1024 sc1
MV 184,a,124,a,12
buffer_load_dwordx4 a[12:15], v237, s[44:47], s68 offen offset:1024 sc1
s_add_u32 s68, s68, 2048
s_waitcnt lgkmcnt(0)
MV 124,a,64,a,16
ds_read_b128 a[96:99], v242 offset:24576
MV 128,a,64,a,20
ds_read_b128 a[100:103], v242 offset:25600
s_add_u32 m0, s70, 66560
MV 132,a,68,a,16
MV 136,a,68,a,20
ds_read_b128 a[104:107], v242 offset:26624
MV 140,a,72,a,16
ds_read_b128 a[108:111], v242 offset:27648
MV 144,a,72,a,20
buffer_load_dwordx4 v238, s[48:51], s69 offen offset:0 sc1 lds
MV 148,a,76,a,16
ds_read_b128 a[112:115], v243 offset:24576
MV 152,a,76,a,20
ds_read_b128 a[116:119], v243 offset:25600
MV 156,a,80,a,16
MV 160,a,80,a,20
ds_read_b128 a[120:123], v243 offset:26624
buffer_load_dwordx4 v238, s[48:51], s69 offen offset:1024 sc1 lds
MV 164,a,84,a,16
ds_read_b128 a[124:127], v243 offset:27648
MV 168,a,84,a,20
MV 172,a,88,a,16
MV 176,a,88,a,20
MV 180,a,92,a,16
buffer_load_dwordx4 a[16:19], v236, s[44:47], s68 offen offset:0 sc1
MV 184,a,92,a,20
buffer_load_dwordx4 a[20:23], v237, s[44:47], s68 offen offset:0 sc1
s_waitcnt vmcnt(14) lgkmcnt(0)
s_barrier
MV 124,a,96,a,24
ds_read_b128 a[64:67], v242 offset:32768
MV 128,a,96,a,28
ds_read_b128 a[68:71], v242 offset:33792
buffer_load_dwordx4 v238, s[48:51], s69 offen offset:2048 sc1 lds
MV 132,a,100,a,24
MV 136,a,100,a,28
ds_read_b128 a[72:75], v242 offset:34816
MV 140,a,104,a,24
ds_read_b128 a[76:79], v242 offset:35840
MV 144,a,104,a,28
buffer_load_dwordx4 v238, s[48:51], s69 offen offset:3072 sc1 lds
MV 148,a,108,a,24
ds_read_b128 a[80:83], v243 offset:32768
MV 152,a,108,a,28
ds_read_b128 a[84:87], v243 offset:33792
MV 156,a,112,a,24
MV 160,a,112,a,28
ds_read_b128 a[88:91], v243 offset:34816
s_add_u32 s69, s69, 16384
MV 164,a,116,a,24
ds_read_b128 a[92:95], v243 offset:35840
MV 168,a,116,a,28
MV 172,a,120,a,24
MV 176,a,120,a,28
MV 180,a,124,a,24
buffer_load_dwordx4 a[24:27], v236, s[44:47], s68 offen offset:1024 sc1
MV 184,a,124,a,28
buffer_load_dwordx4 a[28:31], v237, s[44:47], s68 offen offset:1024 sc1
s_add_u32 s68, s68, 2048
s_sub_u32 s71, s71, 1
s_cbranch_scc1 L_p5_out
s_cmp_eq_u32 s71, 2
s_cbranch_scc1 L_p5_x1
s_cmp_eq_u32 s71, 0
s_cbranch_scc1 L_p5_x2
s_branch L_p5_loop
L_p5_out:
s_waitcnt lgkmcnt(0)
MV 124,a,64,a,32
ds_read_b128 a[96:99], v242 offset:40960
MV 128,a,64,a,36
ds_read_b128 a[100:103], v242 offset:41984
s_add_u32 m0, s70, 82944
MV 132,a,68,a,32
v_cmp_gt_u32 vcc, 1, v253
s_nop 4
s_cbranch_vccnz L_spin_f3
L_spin_f3_ret:
MV 136,a,68,a,36
ds_read_b128 a[104:107], v242 offset:43008
MV 140,a,72,a,32
ds_read_b128 a[108:111], v242 offset:44032
MV 144,a,72,a,36
buffer_load_dwordx4 v238, s[48:51], s69 offen offset:0 sc1 lds
MV 148,a,76,a,32
ds_read_b128 a[112:115], v243 offset:40960
MV 152,a,76,a,36
ds_read_b128 a[116:119], v243 offset:41984
MV 156,a,80,a,32
MV 160,a,80,a,36
ds_read_b128 a[120:123], v243 offset:43008
buffer_load_dwordx4 v238, s[48:51], s69 offen offset:1024 sc1 lds
MV 164,a,84,a,32
ds_read_b128 a[124:127], v243 offset:44032
MV 168,a,84,a,36
MV 172,a,88,a,32
s_add_u32 s72, s79, 0
MV 176,a,88,a,36
MV 180,a,92,a,32
buffer_load_dwordx4 a[32:35], v236, s[44:47], s68 offen offset:0 sc1
buffer_load_dwordx2 v[208:209], v251, s[56:59], s72 offen offset:0 sc1
MV 184,a,92,a,36
buffer_load_dwordx4 a[36:39], v237, s[44:47], s68 offen offset:0 sc1
s_waitcnt vmcnt(15) lgkmcnt(0)
s_barrier
MV 124,a,96,a,40
ds_read_b128 a[64:67], v242 offset:49152
s_add_u32 s72, s79, 16384
MV 128,a,96,a,44
ds_read_b128 a[68:71], v242 offset:50176
buffer_load_dwordx4 v238, s[48:51], s69 offen offset:2048 sc1 lds
MV 132,a,100,a,40
MV 136,a,100,a,44
ds_read_b128 a[72:75], v242 offset:51200
MV 140,a,104,a,40
ds_read_b128 a[76:79], v242 offset:52224
MV 144,a,104,a,44
buffer_load_dwordx4 v238, s[48:51], s69 offen offset:3072 sc1 lds
MV 148,a,108,a,40
ds_read_b128 a[80:83], v243 offset:49152
MV 152,a,108,a,44
ds_read_b128 a[84:87], v243 offset:50176
MV 156,a,112,a,40
buffer_load_dwordx2 v[210:211], v251, s[56:59], s72 offen offset:0 sc1
MV 160,a,112,a,44
ds_read_b128 a[88:91], v243 offset:51200
s_add_u32 s69, s69, 16384
MV 164,a,116,a,40
ds_read_b128 a[92:95], v243 offset:52224
MV 168,a,116,a,44
MV 172,a,120,a,40
MV 176,a,120,a,44
MV 180,a,124,a,40
buffer_load_dwordx4 a[40:43], v236, s[44:47], s68 offen offset:1024 sc1
MV 184,a,124,a,44
buffer_load_dwordx4 a[44:47], v237, s[44:47], s68 offen offset:1024 sc1
s_add_u32 s68, s68, 2048
s_waitcnt lgkmcnt(0)
MV 124,a,64,a,48
ds_read_b128 a[96:99], v242 offset:57344
s_add_u32 s72, s79, 131072
MV 128,a,64,a,52
ds_read_b128 a[100:103], v242 offset:58368
s_add_u32 m0, s70, 99328
MV 132,a,68,a,48
MV 136,a,68,a,52
ds_read_b128 a[104:107], v242 offset:59392
MV 140,a,72,a,48
ds_read_b128 a[108:111], v242 offset:60416
buffer_load_dwordx2 v[212:213], v251, s[56:59], s72 offen offset:0 sc1
MV 144,a,72,a,52
buffer_load_dwordx4 v238, s[48:51], s69 offen offset:0 sc1 lds
MV 148,a,76,a,48
ds_read_b128 a[112:115], v243 offset:57344
MV 152,a,76,a,52
ds_read_b128 a[116:119], v243 offset:58368
MV 156,a,80,a,48
s_add_u32 s72, s79, 147456
MV 160,a,80,a,52
ds_read_b128 a[120:123], v243 offset:59392
buffer_load_dwordx4 v238, s[48:51], s69 offen offset:1024 sc1 lds
MV 164,a,84,a,48
ds_read_b128 a[124:127], v243 offset:60416
MV 168,a,84,a,52
MV 172,a,88,a,48
buffer_load_dwordx2 v[214:215], v251, s[56:59], s72 offen offset:0 sc1
MV 176,a,88,a,52
MV 180,a,92,a,48
buffer_load_dwordx4 a[48:51], v236, s[44:47], s68 offen offset:0 sc1
MV 184,a,92,a,52
buffer_load_dwordx4 a[52:55], v237, s[44:47], s68 offen offset:0 sc1
s_waitcnt vmcnt(18) lgkmcnt(0)
s_barrier
MV 124,a,96,a,56
ds_read_b128 a[64:67], v242 offset:0
s_add_u32 s72, s79, 0
MV 128,a,96,a,60
ds_read_b128 a[68:71], v242 offset:1024
buffer_load_dwordx4 v238, s[48:51], s69 offen offset:2048 sc1 lds
MV 132,a,100,a,56
MV 136,a,100,a,60
ds_read_b128 a[72:75], v242 offset:2048
MV 140,a,104,a,56
ds_read_b128 a[76:79], v242 offset:3072
MV 144,a,104,a,60
buffer_load_dwordx4 v238, s[48:51], s69 offen offset:3072 sc1 lds
MV 148,a,108,a,56
ds_read_b128 a[80:83], v243 offset:0
MV 152,a,108,a,60
ds_read_b128 a[84:87], v243 offset:1024
MV 156,a,112,a,56
buffer_load_dwordx2 v[216:217], v251, s[56:59], s72 offen offset:128 sc1
MV 160,a,112,a,60
ds_read_b128 a[88:91], v243 offset:2048
s_add_u32 s69, s69, 16384
MV 164,a,116,a,56
ds_read_b128 a[92:95], v243 offset:3072
MV 168,a,116,a,60
MV 172,a,120,a,56
MV 176,a,120,a,60
MV 180,a,124,a,56
buffer_load_dwordx4 a[56:59], v236, s[44:47], s68 offen offset:1024 sc1
MV 184,a,124,a,60
buffer_load_dwordx4 a[60:63], v237, s[44:47], s68 offen offset:1024 sc1
s_add_u32 s68, s68, 2048
s_waitcnt lgkmcnt(0)
MV 124,a,64,a,0
ds_read_b128 a[96:99], v242 offset:8192
s_add_u32 s72, s79, 16384
MV 128,a,64,a,4
ds_read_b128 a[100:103], v242 offset:9216
s_add_u32 m0, s70, 115712
MV 132,a,68,a,0
MV 136,a,68,a,4
ds_read_b128 a[104:107], v242 offset:10240
MV 140,a,72,a,0
ds_read_b128 a[108:111], v242 offset:11264
MV 144,a,72,a,4
buffer_load_dwordx4 v238, s[48:51], s69 offen offset:0 sc1 lds
MV 148,a,76,a,0
ds_read_b128 a[112:115], v243 offset:8192
MV 152,a,76,a,4
ds_read_b128 a[116:119], v243 offset:9216
MV 156,a,80,a,0
buffer_load_dwordx2 v[218:219], v251, s[56:59], s72 offen offset:128 sc1
MV 160,a,80,a,4
ds_read_b128 a[120:123], v243 offset:10240
buffer_load_dwordx4 v238, s[48:51], s69 offen offset:1024 sc1 lds
MV 164,a,84,a,0
ds_read_b128 a[124:127], v243 offset:11264
MV 168,a,84,a,4
MV 172,a,88,a,0
MV 176,a,88,a,4
MV 180,a,92,a,0
buffer_load_dwordx4 a[0:3], v236, s[44:47], s68 offen offset:0 sc1
MV 184,a,92,a,4
buffer_load_dwordx4 a[4:7], v237, s[44:47], s68 offen offset:0 sc1
s_waitcnt vmcnt(19) lgkmcnt(0)
s_barrier
MV 124,a,96,a,8
ds_read_b128 a[64:67], v242 offset:16384
s_add_u32 s72, s79, 131072
MV 128,a,96,a,12
ds_read_b128 a[68:71], v242 offset:17408
buffer_load_dwordx4 v238, s[48:51], s69 offen offset:2048 sc1 lds
MV 132,a,100,a,8
MV 136,a,100,a,12
ds_read_b128 a[72:75], v242 offset:18432
MV 140,a,104,a,8
ds_read_b128 a[76:79], v242 offset:19456
buffer_load_dwordx2 v[220:221], v251, s[56:59], s72 offen offset:128 sc1
MV 144,a,104,a,12
buffer_load_dwordx4 v238, s[48:51], s69 offen offset:3072 sc1 lds
MV 148,a,108,a,8
ds_read_b128 a[80:83], v243 offset:16384
MV 152,a,108,a,12
ds_read_b128 a[84:87], v243 offset:17408
MV 156,a,112,a,8
s_add_u32 s72, s79, 147456
MV 160,a,112,a,12
ds_read_b128 a[88:91], v243 offset:18432
s_add_u32 s69, s69, 16384
MV 164,a,116,a,8
ds_read_b128 a[92:95], v243 offset:19456
MV 168,a,116,a,12
MV 172,a,120,a,8
buffer_load_dwordx2 v[222:223], v251, s[56:59], s72 offen offset:128 sc1
MV 176,a,120,a,12
MV 180,a,124,a,8
buffer_load_dwordx4 a[8:11], v236, s[44:47], s68 offen offset:1024 sc1
MV 184,a,124,a,12
buffer_load_dwordx4 a[12:15], v237, s[44:47], s68 offen offset:1024 sc1
s_add_u32 s68, s68, 2048
s_waitcnt lgkmcnt(0)
MV 124,a,64,a,16
ds_read_b128 a[96:99], v242 offset:24576
MV 128,a,64,a,20
ds_read_b128 a[100:103], v242 offset:25600
s_add_u32 m0, s70, 66560
MV 132,a,68,a,16
MV 136,a,68,a,20
ds_read_b128 a[104:107], v242 offset:26624
MV 140,a,72,a,16
ds_read_b128 a[108:111], v242 offset:27648
MV 144,a,72,a,20
buffer_load_dwordx4 v238, s[48:51], s69 offen offset:0 sc1 lds
MV 148,a,76,a,16
ds_read_b128 a[112:115], v243 offset:24576
MV 152,a,76,a,20
ds_read_b128 a[116:119], v243 offset:25600
MV 156,a,80,a,16
MV 160,a,80,a,20
ds_read_b128 a[120:123], v243 offset:26624
buffer_load_dwordx4 v238, s[48:51], s69 offen offset:1024 sc1 lds
MV 164,a,84,a,16
ds_read_b128 a[124:127], v243 offset:27648
MV 168,a,84,a,20
MV 172,a,88,a,16
MV 176,a,88,a,20
MV 180,a,92,a,16
buffer_load_dwordx4 a[16:19], v236, s[44:47], s68 offen offset:0 sc1
MV 184,a,92,a,20
buffer_load_dwordx4 a[20:23], v237, s[44:47], s68 offen offset:0 sc1
s_waitcnt vmcnt(18) lgkmcnt(0)
s_barrier
MV 124,a,96,a,24
ds_read_b128 a[64:67], v242 offset:32768
MV 128,a,96,a,28
ds_read_b128 a[68:71], v242 offset:33792
buffer_load_dwordx4 v238, s[48:51], s69 offen offset:2048 sc1 lds
MV 132,a,100,a,24
MV 136,a,100,a,28
ds_read_b128 a[72:75], v242 offset:34816
MV 140,a,104,a,24
ds_read_b128 a[76:79], v242 offset:35840
MV 144,a,104,a,28
buffer_load_dwordx4 v238, s[48:51], s69 offen offset:3072 sc1 lds
MV 148,a,108,a,24
ds_read_b128 a[80:83], v243 offset:32768
MV 152,a,108,a,28
ds_read_b128 a[84:87], v243 offset:33792
MV 156,a,112,a,24
MV 160,a,112,a,28
ds_read_b128 a[88:91], v243 offset:34816
s_add_u32 s69, s69, 16384
MV 164,a,116,a,24
ds_read_b128 a[92:95], v243 offset:35840
MV 168,a,116,a,28
MV 172,a,120,a,24
MV 176,a,120,a,28
MV 180,a,124,a,24
buffer_load_dwordx4 a[24:27], v236, s[44:47], s68 offen offset:1024 sc1
MV 184,a,124,a,28
buffer_load_dwordx4 a[28:31], v237, s[44:47], s68 offen offset:1024 sc1
s_add_u32 s68, s68, 2048
s_waitcnt lgkmcnt(0)
MV 124,a,64,a,32
ds_read_b128 a[96:99], v242 offset:40960
v_sub_f32 v8, 1.0, v6
MV 128,a,64,a,36
ds_read_b128 a[100:103], v242 offset:41984
s_add_u32 m0, s70, 82944
MV 132,a,68,a,32
v_lshlrev_b32 v36, 16, v192
v_lshlrev_b32 v228, 16, v208
MV 136,a,68,a,36
ds_read_b128 a[104:107], v242 offset:43008
v_and_b32 v37, 0xffff0000, v192
MV 140,a,72,a,32
ds_read_b128 a[108:111], v242 offset:44032
v_and_b32 v229, 0xffff0000, v208
MV 144,a,72,a,36
buffer_load_dwordx4 v238, s[48:51], s69 offen offset:0 sc1 lds
v_mul_f32 v36, v36, v228
MV 148,a,76,a,32
ds_read_b128 a[112:115], v243 offset:40960
v_mul_f32 v37, v37, v229
MV 152,a,76,a,36
ds_read_b128 a[116:119], v243 offset:41984
v_mul_f32 v36, v36, v6
MV 156,a,80,a,32
v_mul_f32 v37, v37, v6
v_lshlrev_b32 v38, 16, v193
MV 160,a,80,a,36
ds_read_b128 a[120:123], v243 offset:43008
buffer_load_dwordx4 v238, s[48:51], s69 offen offset:1024 sc1 lds
MV 164,a,84,a,32
ds_read_b128 a[124:127], v243 offset:44032
v_lshlrev_b32 v228, 16, v209
MV 168,a,84,a,36
v_and_b32 v39, 0xffff0000, v193
v_and_b32 v229, 0xffff0000, v209
MV 172,a,88,a,32
v_mul_f32 v38, v38, v228
v_mul_f32 v39, v39, v229
MV 176,a,88,a,36
v_mul_f32 v38, v38, v6
v_mul_f32 v39, v39, v6
MV 180,a,92,a,32
buffer_load_dwordx4 a[32:35], v236, s[44:47], s68 offen offset:0 sc1
v_lshlrev_b32 v40, 16, v194
MV 184,a,92,a,36
buffer_load_dwordx4 a[36:39], v237, s[44:47], s68 offen offset:0 sc1
v_lshlrev_b32 v228, 16, v210
v_and_b32 v41, 0xffff0000, v194
v_and_b32 v229, 0xffff0000, v210
s_waitcnt vmcnt(15) lgkmcnt(0)
s_barrier
MV 124,a,96,a,40
ds_read_b128 a[64:67], v242 offset:49152
v_mul_f32 v40, v40, v228
MV 128,a,96,a,44
ds_read_b128 a[68:71], v242 offset:50176
buffer_load_dwordx4 v238, s[48:51], s69 offen offset:2048 sc1 lds
MV 132,a,100,a,40
v_mul_f32 v41, v41, v229
v_mul_f32 v40, v40, v6
MV 136,a,100,a,44
ds_read_b128 a[72:75], v242 offset:51200
v_mul_f32 v41, v41, v6
MV 140,a,104,a,40
ds_read_b128 a[76:79], v242 offset:52224
v_lshlrev_b32 v42, 16, v195
MV 144,a,104,a,44
buffer_load_dwordx4 v238, s[48:51], s69 offen offset:3072 sc1 lds
v_lshlrev_b32 v228, 16, v211
MV 148,a,108,a,40
ds_read_b128 a[80:83], v243 offset:49152
v_and_b32 v43, 0xffff0000, v195
MV 152,a,108,a,44
ds_read_b128 a[84:87], v243 offset:50176
v_and_b32 v229, 0xffff0000, v211
MV 156,a,112,a,40
v_mul_f32 v42, v42, v228
v_mul_f32 v43, v43, v229
MV 160,a,112,a,44
ds_read_b128 a[88:91], v243 offset:51200
s_add_u32 s69, s69, 16384
MV 164,a,116,a,40
ds_read_b128 a[92:95], v243 offset:52224
v_mul_f32 v42, v42, v6
MV 168,a,116,a,44
v_mul_f32 v43, v43, v6
v_lshlrev_b32 v44, 16, v196
MV 172,a,120,a,40
v_lshlrev_b32 v228, 16, v212
v_and_b32 v45, 0xffff0000, v196
MV 176,a,120,a,44
v_and_b32 v229, 0xffff0000, v212
v_mul_f32 v44, v44, v228
MV 180,a,124,a,40
buffer_load_dwordx4 a[40:43], v236, s[44:47], s68 offen offset:1024 sc1
v_mul_f32 v45, v45, v229
MV 184,a,124,a,44
buffer_load_dwordx4 a[44:47], v237, s[44:47], s68 offen offset:1024 sc1
s_add_u32 s68, s68, 2048
v_mul_f32 v44, v44, v6
v_mul_f32 v45, v45, v6
v_lshlrev_b32 v46, 16, v197
v_lshlrev_b32 v228, 16, v213
s_waitcnt lgkmcnt(0)
MV 124,a,64,a,48
ds_read_b128 a[96:99], v242 offset:57344
v_and_b32 v47, 0xffff0000, v197
MV 128,a,64,a,52
ds_read_b128 a[100:103], v242 offset:58368
s_add_u32 m0, s70, 99328
MV 132,a,68,a,48
v_and_b32 v229, 0xffff0000, v213
v_mul_f32 v46, v46, v228
MV 136,a,68,a,52
ds_read_b128 a[104:107], v242 offset:59392
v_mul_f32 v47, v47, v229
MV 140,a,72,a,48
ds_read_b128 a[108:111], v242 offset:60416
v_mul_f32 v46, v46, v6
MV 144,a,72,a,52
buffer_load_dwordx4 v238, s[48:51], s69 offen offset:0 sc1 lds
v_mul_f32 v47, v47, v6
MV 148,a,76,a,48
ds_read_b128 a[112:115], v243 offset:57344
v_lshlrev_b32 v48, 16, v198
MV 152,a,76,a,52
ds_read_b128 a[116:119], v243 offset:58368
v_lshlrev_b32 v228, 16, v214
MV 156,a,80,a,48
v_and_b32 v49, 0xffff0000, v198
v_and_b32 v229, 0xffff0000, v214
MV 160,a,80,a,52
ds_read_b128 a[120:123], v243 offset:59392
buffer_load_dwordx4 v238, s[48:51], s69 offen offset:1024 sc1 lds
MV 164,a,84,a,48
ds_read_b128 a[124:127], v243 offset:60416
v_mul_f32 v48, v48, v228
MV 168,a,84,a,52
v_mul_f32 v49, v49, v229
v_mul_f32 v48, v48, v6
MV 172,a,88,a,48
v_mul_f32 v49, v49, v6
v_lshlrev_b32 v50, 16, v199
MV 176,a,88,a,52
v_lshlrev_b32 v228, 16, v215
v_and_b32 v51, 0xffff0000, v199
MV 180,a,92,a,48
buffer_load_dwordx4 a[48:51], v236, s[44:47], s68 offen offset:0 sc1
v_and_b32 v229, 0xffff0000, v215
MV 184,a,92,a,52
buffer_load_dwordx4 a[52:55], v237, s[44:47], s68 offen offset:0 sc1
v_mul_f32 v50, v50, v228
v_mul_f32 v51, v51, v229
v_mul_f32 v50, v50, v6
v_mul_f32 v51, v51, v6
s_waitcnt vmcnt(14) lgkmcnt(0)
s_barrier
MV 124,a,96,a,56
ds_read_b128 a[64:67], v242 offset:0
v_sub_f32 v9, 1.0, v7
MV 128,a,96,a,60
ds_read_b128 a[68:71], v242 offset:1024
buffer_load_dwordx4 v238, s[48:51], s69 offen offset:2048 sc1 lds
MV 132,a,100,a,56
v_lshlrev_b32 v52, 16, v200
v_lshlrev_b32 v228, 16, v216
MV 136,a,100,a,60
ds_read_b128 a[72:75], v242 offset:2048
v_and_b32 v53, 0xffff0000, v200
MV 140,a,104,a,56
ds_read_b128 a[76:79], v242 offset:3072
v_and_b32 v229, 0xffff0000, v216
MV 144,a,104,a,60
buffer_load_dwordx4 v238, s[48:51], s69 offen offset:3072 sc1 lds
v_mul_f32 v52, v52, v228
MV 148,a,108,a,56
ds_read_b128 a[80:83], v243 offset:0
v_mul_f32 v53, v53, v229
MV 152,a,108,a,60
ds_read_b128 a[84:87], v243 offset:1024
v_mul_f32 v52, v52, v7
MV 156,a,112,a,56
v_mul_f32 v53, v53, v7
v_lshlrev_b32 v54, 16, v201
MV 160,a,112,a,60
ds_read_b128 a[88:91], v243 offset:2048
s_add_u32 s69, s69, 16384
MV 164,a,116,a,56
ds_read_b128 a[92:95], v243 offset:3072
v_lshlrev_b32 v228, 16, v217
MV 168,a,116,a,60
v_and_b32 v55, 0xffff0000, v201
v_and_b32 v229, 0xffff0000, v217
MV 172,a,120,a,56
v_mul_f32 v54, v54, v228
v_mul_f32 v55, v55, v229
MV 176,a,120,a,60
v_mul_f32 v54, v54, v7
v_mul_f32 v55, v55, v7
MV 180,a,124,a,56
buffer_load_dwordx4 a[56:59], v236, s[44:47], s68 offen offset:1024 sc1
v_lshlrev_b32 v56, 16, v202
MV 184,a,124,a,60
buffer_load_dwordx4 a[60:63], v237, s[44:47], s68 offen offset:1024 sc1
s_add_u32 s68, s68, 2048
v_lshlrev_b32 v228, 16, v218
v_and_b32 v57, 0xffff0000, v202
v_and_b32 v229, 0xffff0000, v218
s_waitcnt lgkmcnt(0)
MV 124,a,64,a,0
ds_read_b128 a[96:99], v242 offset:8192
v_mul_f32 v56, v56, v228
MV 128,a,64,a,4
ds_read_b128 a[100:103], v242 offset:9216
s_add_u32 m0, s70, 115712
MV 132,a,68,a,0
v_mul_f32 v57, v57, v229
v_mul_f32 v56, v56, v7
MV 136,a,68,a,4
ds_read_b128 a[104:107], v242 offset:10240
v_mul_f32 v57, v57, v7
MV 140,a,72,a,0
ds_read_b128 a[108:111], v242 offset:11264
v_lshlrev_b32 v58, 16, v203
MV 144,a,72,a,4
buffer_load_dwordx4 v238, s[48:51], s69 offen offset:0 sc1 lds
v_lshlrev_b32 v228, 16, v219
MV 148,a,76,a,0
ds_read_b128 a[112:115], v243 offset:8192
v_and_b32 v59, 0xffff0000, v203
MV 152,a,76,a,4
ds_read_b128 a[116:119], v243 offset:9216
v_and_b32 v229, 0xffff0000, v219
MV 156,a,80,a,0
v_mul_f32 v58, v58, v228
v_mul_f32 v59, v59, v229
MV 160,a,80,a,4
ds_read_b128 a[120:123], v243 offset:10240
buffer_load_dwordx4 v238, s[48:51], s69 offen offset:1024 sc1 lds
MV 164,a,84,a,0
ds_read_b128 a[124:127], v243 offset:11264
v_mul_f32 v58, v58, v7
MV 168,a,84,a,4
v_mul_f32 v59, v59, v7
v_lshlrev_b32 v60, 16, v204
MV 172,a,88,a,0
v_lshlrev_b32 v228, 16, v220
v_and_b32 v61, 0xffff0000, v204
MV 176,a,88,a,4
v_and_b32 v229, 0xffff0000, v220
v_mul_f32 v60, v60, v228
MV 180,a,92,a,0
v_mul_f32 v61, v61, v229
v_mul_f32 v60, v60, v7
MV 184,a,92,a,4
v_mul_f32 v61, v61, v7
v_lshlrev_b32 v62, 16, v205
v_lshlrev_b32 v228, 16, v221
s_waitcnt vmcnt(12) lgkmcnt(0)
s_barrier
MV 124,a,96,a,8
ds_read_b128 a[80:83], v243 offset:16384
v_and_b32 v63, 0xffff0000, v205
MV 128,a,96,a,12
buffer_load_dwordx4 v238, s[48:51], s69 offen offset:2048 sc1 lds
v_and_b32 v229, 0xffff0000, v221
MV 132,a,100,a,8
v_mul_f32 v62, v62, v228
v_mul_f32 v63, v63, v229
MV 136,a,100,a,12
ds_read_b128 a[84:87], v243 offset:17408
v_mul_f32 v62, v62, v7
MV 140,a,104,a,8
v_mul_f32 v63, v63, v7
v_lshlrev_b32 v64, 16, v206
MV 144,a,104,a,12
buffer_load_dwordx4 v238, s[48:51], s69 offen offset:3072 sc1 lds
v_lshlrev_b32 v228, 16, v222
MV 148,a,108,a,8
ds_read_b128 a[88:91], v243 offset:18432
v_and_b32 v65, 0xffff0000, v206
MV 152,a,108,a,12
v_and_b32 v229, 0xffff0000, v222
v_mul_f32 v64, v64, v228
MV 156,a,112,a,8
v_mul_f32 v65, v65, v229
v_mul_f32 v64, v64, v7
MV 160,a,112,a,12
ds_read_b128 a[92:95], v243 offset:19456
s_add_u32 s69, s69, 16384
MV 164,a,116,a,8
v_mul_f32 v65, v65, v7
v_lshlrev_b32 v66, 16, v207
MV 168,a,116,a,12
v_lshlrev_b32 v228, 16, v223
v_and_b32 v67, 0xffff0000, v207
MV 172,a,120,a,8
v_and_b32 v229, 0xffff0000, v223
MV 176,a,120,a,12
v_mul_f32 v66, v66, v228
v_mul_f32 v67, v67, v229
MV 180,a,124,a,8
v_mul_f32 v66, v66, v7
MV 184,a,124,a,12
v_mul_f32 v67, v67, v7
s_waitcnt lgkmcnt(0)
MV 156,a,80,a,16
ds_read_b128 a[112:115], v243 offset:24576
s_xor_b32 s72, s2, 4
MV 160,a,80,a,20
ds_read_b128 a[116:119], v243 offset:25600
s_lshl_b32 s72, s72, 14
MV 164,a,84,a,16
ds_read_b128 a[120:123], v243 offset:26624
MV 168,a,84,a,20
ds_read_b128 a[124:127], v243 offset:27648
MV 172,a,88,a,16
MV 176,a,88,a,20
MV 180,a,92,a,16
MV 184,a,92,a,20
s_waitcnt vmcnt(6)
s_barrier
s_waitcnt lgkmcnt(3)
MV 156,a,112,a,24
ds_read_b128 a[80:83], v243 offset:32768
MV 160,a,112,a,28
ds_read_b128 a[84:87], v243 offset:33792
s_waitcnt lgkmcnt(4)
MV 164,a,116,a,24
ds_read_b128 a[88:91], v243 offset:34816
MV 168,a,116,a,28
ds_read_b128 a[92:95], v243 offset:35840
s_waitcnt lgkmcnt(5)
MV 172,a,120,a,24
MV 176,a,120,a,28
s_waitcnt lgkmcnt(4)
MV 180,a,124,a,24
MV 184,a,124,a,28
s_waitcnt lgkmcnt(3)
MV 156,a,80,a,32
ds_read_b128 a[112:115], v243 offset:40960
MV 160,a,80,a,36
ds_read_b128 a[116:119], v243 offset:41984
s_waitcnt lgkmcnt(4)
MV 164,a,84,a,32
ds_read_b128 a[120:123], v243 offset:43008
MV 168,a,84,a,36
ds_read_b128 a[124:127], v243 offset:44032
s_waitcnt lgkmcnt(5)
MV 172,a,88,a,32
MV 176,a,88,a,36
s_waitcnt lgkmcnt(4)
MV 180,a,92,a,32
MV 184,a,92,a,36
s_waitcnt vmcnt(0)
s_barrier
s_waitcnt lgkmcnt(3)
MV 156,a,112,a,40
ds_read_b128 a[80:83], v243 offset:49152
MV 160,a,112,a,44
ds_read_b128 a[84:87], v243 offset:50176
s_waitcnt lgkmcnt(4)
MV 164,a,116,a,40
ds_read_b128 a[88:91], v243 offset:51200
MV 168,a,116,a,44
ds_read_b128 a[92:95], v243 offset:52224
s_waitcnt lgkmcnt(5)
MV 172,a,120,a,40
MV 176,a,120,a,44
s_waitcnt lgkmcnt(4)
MV 180,a,124,a,40
MV 184,a,124,a,44
s_waitcnt lgkmcnt(3)
MV 156,a,80,a,48
ds_read_b128 a[112:115], v243 offset:57344
MV 160,a,80,a,52
ds_read_b128 a[116:119], v243 offset:58368
s_waitcnt lgkmcnt(4)
MV 164,a,84,a,48
ds_read_b128 a[120:123], v243 offset:59392
MV 168,a,84,a,52
ds_read_b128 a[124:127], v243 offset:60416
s_waitcnt lgkmcnt(5)
MV 172,a,88,a,48
MV 176,a,88,a,52
s_waitcnt lgkmcnt(4)
MV 180,a,92,a,48
MV 184,a,92,a,52
s_waitcnt lgkmcnt(3)
MV 156,a,112,a,56
ds_read_b128 a[64:67], v242 offset:16384
MV 160,a,112,a,60
ds_read_b128 a[68:71], v242 offset:17408
s_waitcnt lgkmcnt(4)
MV 164,a,116,a,56
ds_read_b128 a[72:75], v242 offset:18432
MV 168,a,116,a,60
ds_read_b128 a[76:79], v242 offset:19456
s_waitcnt lgkmcnt(5)
MV 172,a,120,a,56
MV 176,a,120,a,60
s_waitcnt lgkmcnt(4)
MV 180,a,124,a,56
MV 184,a,124,a,60
s_waitcnt lgkmcnt(3)
MV 124,a,64,a,16
ds_read_b128 a[96:99], v242 offset:24576
MV 128,a,64,a,20
ds_read_b128 a[100:103], v242 offset:25600
s_waitcnt lgkmcnt(4)
MV 132,a,68,a,16
ds_read_b128 a[104:107], v242 offset:26624
v_permlane16_swap_b32 v156, v164
MV 136,a,68,a,20
ds_read_b128 a[108:111], v242 offset:27648
v_permlane16_swap_b32 v157, v165
s_waitcnt lgkmcnt(5)
MV 140,a,72,a,16
v_permlane16_swap_b32 v158, v166
v_permlane16_swap_b32 v159, v167
MV 144,a,72,a,20
v_cvt_pk_bf16_f32 v156, v156, v157
v_cvt_pk_bf16_f32 v157, v158, v159
s_waitcnt lgkmcnt(4)
MV 148,a,76,a,16
v_cvt_pk_bf16_f32 v158, v164, v165
v_cvt_pk_bf16_f32 v159, v166, v167
MV 152,a,76,a,20
buffer_store_dwordx4 v[156:159], v238, s[52:55], s72 offen offset:0 sc1
v_permlane16_swap_b32 v172, v180
s_waitcnt lgkmcnt(3)
MV 124,a,96,a,24
ds_read_b128 a[64:67], v242 offset:32768
v_permlane16_swap_b32 v173, v181
MV 128,a,96,a,28
ds_read_b128 a[68:71], v242 offset:33792
v_permlane16_swap_b32 v174, v182
s_waitcnt lgkmcnt(4)
MV 132,a,100,a,24
ds_read_b128 a[72:75], v242 offset:34816
v_permlane16_swap_b32 v175, v183
MV 136,a,100,a,28
ds_read_b128 a[76:79], v242 offset:35840
v_cvt_pk_bf16_f32 v172, v172, v173
s_waitcnt lgkmcnt(5)
MV 140,a,104,a,24
v_cvt_pk_bf16_f32 v173, v174, v175
v_cvt_pk_bf16_f32 v174, v180, v181
MV 144,a,104,a,28
v_cvt_pk_bf16_f32 v175, v182, v183
buffer_store_dwordx4 v[172:175], v238, s[52:55], s72 offen offset:1024 sc1
s_waitcnt lgkmcnt(4)
MV 148,a,108,a,24
v_permlane16_swap_b32 v160, v168
v_permlane16_swap_b32 v161, v169
MV 152,a,108,a,28
v_permlane16_swap_b32 v162, v170
v_permlane16_swap_b32 v163, v171
s_waitcnt lgkmcnt(3)
MV 124,a,64,a,32
ds_read_b128 a[96:99], v242 offset:40960
v_cvt_pk_bf16_f32 v160, v160, v161
MV 128,a,64,a,36
ds_read_b128 a[100:103], v242 offset:41984
v_cvt_pk_bf16_f32 v161, v162, v163
s_waitcnt lgkmcnt(4)
MV 132,a,68,a,32
ds_read_b128 a[104:107], v242 offset:43008
v_cvt_pk_bf16_f32 v162, v168, v169
MV 136,a,68,a,36
ds_read_b128 a[108:111], v242 offset:44032
v_cvt_pk_bf16_f32 v163, v170, v171
s_waitcnt lgkmcnt(5)
MV 140,a,72,a,32
buffer_store_dwordx4 v[160:163], v238, s[52:55], s72 offen offset:2048 sc1
v_permlane16_swap_b32 v176, v184
MV 144,a,72,a,36
v_permlane16_swap_b32 v177, v185
v_permlane16_swap_b32 v178, v186
s_waitcnt lgkmcnt(4)
MV 148,a,76,a,32
v_permlane16_swap_b32 v179, v187
v_cvt_pk_bf16_f32 v176, v176, v177
MV 152,a,76,a,36
v_cvt_pk_bf16_f32 v177, v178, v179
v_cvt_pk_bf16_f32 v178, v184, v185
s_waitcnt lgkmcnt(3)
MV 124,a,96,a,40
ds_read_b128 a[64:67], v242 offset:49152
v_cvt_pk_bf16_f32 v179, v186, v187
MV 128,a,96,a,44
ds_read_b128 a[68:71], v242 offset:50176
buffer_store_dwordx4 v[176:179], v238, s[52:55], s72 offen offset:3072 sc1
s_waitcnt lgkmcnt(4)
MV 132,a,100,a,40
ds_read_b128 a[72:75], v242 offset:51200
MV 136,a,100,a,44
ds_read_b128 a[76:79], v242 offset:52224
s_waitcnt lgkmcnt(5)
MV 140,a,104,a,40
MV 144,a,104,a,44
s_waitcnt lgkmcnt(4)
MV 148,a,108,a,40
MV 152,a,108,a,44
s_waitcnt lgkmcnt(3)
MV 124,a,64,a,48
ds_read_b128 a[96:99], v242 offset:57344
MV 128,a,64,a,52
ds_read_b128 a[100:103], v242 offset:58368
s_waitcnt lgkmcnt(4)
MV 132,a,68,a,48
ds_read_b128 a[104:107], v242 offset:59392
MV 136,a,68,a,52
ds_read_b128 a[108:111], v242 offset:60416
s_waitcnt lgkmcnt(5)
MV 140,a,72,a,48
MV 144,a,72,a,52
s_waitcnt lgkmcnt(4)
MV 148,a,76,a,48
MV 152,a,76,a,52
s_waitcnt lgkmcnt(3)
MV 124,a,96,a,56
MV 128,a,96,a,60
s_waitcnt lgkmcnt(2)
MV 132,a,100,a,56
MV 136,a,100,a,60
s_waitcnt lgkmcnt(1)
MV 140,a,104,a,56
MV 144,a,104,a,60
s_waitcnt lgkmcnt(0)
MV 148,a,108,a,56
MV 152,a,108,a,60
s_lshl_b32 s72, s2, 14
s_mov_b32 s73, 400000
buffer_load_dwordx4 v[76:79], v238, s[52:55], s72 offen offset:0 sc1
buffer_load_dwordx4 v[80:83], v238, s[52:55], s72 offen offset:1024 sc1
buffer_load_dwordx4 v[84:87], v238, s[52:55], s72 offen offset:2048 sc1
buffer_load_dwordx4 v[88:91], v238, s[52:55], s72 offen offset:3072 sc1
v_permlane16_swap_b32 v124, v132
v_permlane16_swap_b32 v125, v133
v_permlane16_swap_b32 v126, v134
v_permlane16_swap_b32 v127, v135
v_permlane16_swap_b32 v140, v148
v_permlane16_swap_b32 v141, v149
v_permlane16_swap_b32 v142, v150
v_permlane16_swap_b32 v143, v151
v_permlane16_swap_b32 v128, v136
v_permlane16_swap_b32 v129, v137
v_permlane16_swap_b32 v130, v138
v_permlane16_swap_b32 v131, v139
v_permlane16_swap_b32 v144, v152
v_permlane16_swap_b32 v145, v153
v_permlane16_swap_b32 v146, v154
v_permlane16_swap_b32 v147, v155
v_fma_f32 v36, v124, v8, v36
v_fma_f32 v37, v125, v8, v37
v_fma_f32 v38, v126, v8, v38
v_fma_f32 v39, v127, v8, v39
v_fma_f32 v40, v132, v8, v40
v_fma_f32 v41, v133, v8, v41
v_fma_f32 v42, v134, v8, v42
v_fma_f32 v43, v135, v8, v43
v_fma_f32 v44, v140, v8, v44
v_fma_f32 v45, v141, v8, v45
v_fma_f32 v46, v142, v8, v46
v_fma_f32 v47, v143, v8, v47
v_fma_f32 v48, v148, v8, v48
v_fma_f32 v49, v149, v8, v49
v_fma_f32 v50, v150, v8, v50
v_fma_f32 v51, v151, v8, v51
v_fma_f32 v52, v128, v9, v52
v_fma_f32 v53, v129, v9, v53
v_fma_f32 v54, v130, v9, v54
v_fma_f32 v55, v131, v9, v55
v_fma_f32 v56, v136, v9, v56
v_fma_f32 v57, v137, v9, v57
v_fma_f32 v58, v138, v9, v58
v_fma_f32 v59, v139, v9, v59
v_fma_f32 v60, v144, v9, v60
v_fma_f32 v61, v145, v9, v61
v_fma_f32 v62, v146, v9, v62
v_fma_f32 v63, v147, v9, v63
v_fma_f32 v64, v152, v9, v64
v_fma_f32 v65, v153, v9, v65
v_fma_f32 v66, v154, v9, v66
v_fma_f32 v67, v155, v9, v67
s_branch L_xb_chk
L_xb:
buffer_load_dwordx4 v[76:79], v238, s[52:55], s72 offen offset:0 sc1
buffer_load_dwordx4 v[80:83], v238, s[52:55], s72 offen offset:1024 sc1
buffer_load_dwordx4 v[84:87], v238, s[52:55], s72 offen offset:2048 sc1
buffer_load_dwordx4 v[88:91], v238, s[52:55], s72 offen offset:3072 sc1
s_sub_u32 s73, s73, 1
s_cbranch_scc1 L_xb_done
L_xb_chk:
s_waitcnt vmcnt(3)
v_max3_u32 v228, v76, v77, v78
s_waitcnt vmcnt(2)
v_max3_u32 v228, v228, v79, v80
v_max3_u32 v228, v228, v81, v82
s_waitcnt vmcnt(1)
v_max3_u32 v228, v228, v83, v84
v_max3_u32 v228, v228, v85, v86
s_waitcnt vmcnt(0)
v_max3_u32 v228, v228, v87, v88
v_max3_u32 v228, v228, v89, v90
v_max_u32 v228, v228, v91
v_cmp_eq_u32 vcc, -1, v228
s_nop 4
s_cbranch_vccnz L_xb
L_xb_done:
s_waitcnt vmcnt(0)
s_add_u32 s72, s78, 0
v_lshlrev_b32 v92, 16, v76
v_and_b32 v93, 0xffff0000, v76
v_fmac_f32 v36, v92, v8
v_fmac_f32 v37, v93, v8
v_cvt_pk_bf16_f32 v192, v36, v37
v_lshlrev_b32 v92, 16, v77
v_and_b32 v93, 0xffff0000, v77
v_fmac_f32 v38, v92, v8
v_fmac_f32 v39, v93, v8
v_cvt_pk_bf16_f32 v193, v38, v39
v_lshlrev_b32 v92, 16, v78
v_and_b32 v93, 0xffff0000, v78
v_fmac_f32 v40, v92, v8
v_fmac_f32 v41, v93, v8
v_cvt_pk_bf16_f32 v194, v40, v41
v_lshlrev_b32 v92, 16, v79
v_and_b32 v93, 0xffff0000, v79
v_fmac_f32 v42, v92, v8
v_fmac_f32 v43, v93, v8
v_cvt_pk_bf16_f32 v195, v42, v43
buffer_store_dwordx4 v[192:195], v250, s[60:63], s72 offen offset:0 sc1
v_lshlrev_b32 v92, 16, v80
v_and_b32 v93, 0xffff0000, v80
v_fmac_f32 v44, v92, v8
v_fmac_f32 v45, v93, v8
v_cvt_pk_bf16_f32 v196, v44, v45
v_lshlrev_b32 v92, 16, v81
v_and_b32 v93, 0xffff0000, v81
v_fmac_f32 v46, v92, v8
v_fmac_f32 v47, v93, v8
v_cvt_pk_bf16_f32 v197, v46, v47
v_lshlrev_b32 v92, 16, v82
v_and_b32 v93, 0xffff0000, v82
v_fmac_f32 v48, v92, v8
v_fmac_f32 v49, v93, v8
v_cvt_pk_bf16_f32 v198, v48, v49
v_lshlrev_b32 v92, 16, v83
v_and_b32 v93, 0xffff0000, v83
v_fmac_f32 v50, v92, v8
v_fmac_f32 v51, v93, v8
v_cvt_pk_bf16_f32 v199, v50, v51
buffer_store_dwordx4 v[196:199], v250, s[60:63], s72 offen offset:64 sc1
s_add_u32 s72, s78, 32768
v_lshlrev_b32 v92, 16, v84
v_and_b32 v93, 0xffff0000, v84
v_fmac_f32 v52, v92, v9
v_fmac_f32 v53, v93, v9
v_cvt_pk_bf16_f32 v200, v52, v53
v_lshlrev_b32 v92, 16, v85
v_and_b32 v93, 0xffff0000, v85
v_fmac_f32 v54, v92, v9
v_fmac_f32 v55, v93, v9
v_cvt_pk_bf16_f32 v201, v54, v55
v_lshlrev_b32 v92, 16, v86
v_and_b32 v93, 0xffff0000, v86
v_fmac_f32 v56, v92, v9
v_fmac_f32 v57, v93, v9
v_cvt_pk_bf16_f32 v202, v56, v57
v_lshlrev_b32 v92, 16, v87
v_and_b32 v93, 0xffff0000, v87
v_fmac_f32 v58, v92, v9
v_fmac_f32 v59, v93, v9
v_cvt_pk_bf16_f32 v203, v58, v59
buffer_store_dwordx4 v[200:203], v250, s[60:63], s72 offen offset:0 sc1
v_lshlrev_b32 v92, 16, v88
v_and_b32 v93, 0xffff0000, v88
v_fmac_f32 v60, v92, v9
v_fmac_f32 v61, v93, v9
v_cvt_pk_bf16_f32 v204, v60, v61
v_lshlrev_b32 v92, 16, v89
v_and_b32 v93, 0xffff0000, v89
v_fmac_f32 v62, v92, v9
v_fmac_f32 v63, v93, v9
v_cvt_pk_bf16_f32 v205, v62, v63
v_lshlrev_b32 v92, 16, v90
v_and_b32 v93, 0xffff0000, v90
v_fmac_f32 v64, v92, v9
v_fmac_f32 v65, v93, v9
v_cvt_pk_bf16_f32 v206, v64, v65
v_lshlrev_b32 v92, 16, v91
v_and_b32 v93, 0xffff0000, v91
v_fmac_f32 v66, v92, v9
v_fmac_f32 v67, v93, v9
v_cvt_pk_bf16_f32 v207, v66, v67
buffer_store_dwordx4 v[204:207], v250, s[60:63], s72 offen offset:64 sc1
L_end:
s_endpgm
L_p3_pmask:
s_nop 7
v_add_u32 v246, 0, v13
v_cmp_gt_i32_e64 s[84:85], 0, v246
v_cmp_gt_i32_e64 s[86:87], 1, v246
v_cmp_gt_i32_e64 s[88:89], 2, v246
v_cmp_gt_i32_e64 s[90:91], 3, v246
v_cndmask_b32_e64 v96, v96, v14, s[84:85]
v_cndmask_b32_e64 v97, v97, v14, s[86:87]
v_cndmask_b32_e64 v98, v98, v14, s[88:89]
v_cndmask_b32_e64 v99, v99, v14, s[90:91]
v_add_u32 v247, -16, v13
v_cmp_gt_i32_e64 s[92:93], 0, v247
v_cmp_gt_i32_e64 s[94:95], 1, v247
v_cmp_gt_i32_e64 s[96:97], 2, v247
v_cmp_gt_i32_e64 s[98:99], 3, v247
v_cndmask_b32_e64 v100, v100, v14, s[92:93]
v_cndmask_b32_e64 v101, v101, v14, s[94:95]
v_cndmask_b32_e64 v102, v102, v14, s[96:97]
v_cndmask_b32_e64 v103, v103, v14, s[98:99]
v_add_u32 v246, -32, v13
v_cmp_gt_i32_e64 s[84:85], 0, v246
v_cmp_gt_i32_e64 s[86:87], 1, v246
v_cmp_gt_i32_e64 s[88:89], 2, v246
v_cmp_gt_i32_e64 s[90:91], 3, v246
v_cndmask_b32_e64 v128, v128, v14, s[84:85]
v_cndmask_b32_e64 v129, v129, v14, s[86:87]
v_cndmask_b32_e64 v130, v130, v14, s[88:89]
v_cndmask_b32_e64 v131, v131, v14, s[90:91]
v_add_u32 v247, -48, v13
v_cmp_gt_i32_e64 s[92:93], 0, v247
v_cmp_gt_i32_e64 s[94:95], 1, v247
v_cmp_gt_i32_e64 s[96:97], 2, v247
v_cmp_gt_i32_e64 s[98:99], 3, v247
v_cndmask_b32_e64 v132, v132, v14, s[92:93]
v_cndmask_b32_e64 v133, v133, v14, s[94:95]
v_cndmask_b32_e64 v134, v134, v14, s[96:97]
v_cndmask_b32_e64 v135, v135, v14, s[98:99]
s_branch L_p3_pmask_ret
L_p3_mxm_top:
s_waitcnt lgkmcnt(0)
v_xor_b32 v11, 0x8000, v11
v_mfma_f32_16x16x32_bf16 v[80:83], a[128:131], v[16:19], 0
s_add_u32 m0, s73, 16384
ds_read_b128 a[192:195], v11 offset:0
v_mfma_f32_16x16x32_bf16 v[88:91], a[128:131], v[32:35], 0
v_exp_f32 v176, v176
MV 80,a,132,v,20
v_exp_f32 v177, v177
MV 88,a,132,v,36
ds_read_b128 a[196:199], v11 offset:1024
buffer_load_dwordx4 v12, s[56:59], s71 offen offset:0 sc1 lds
MV 80,a,136,v,24
v_exp_f32 v178, v178
MV 88,a,136,v,40
v_add_f32 v2, v2, v176
v_add_f32 v2, v2, v177
MV 80,a,140,v,28
ds_read_b128 a[200:203], v11 offset:2048
ds_read_b128 a[204:207], v11 offset:3072
MV 88,a,140,v,44
v_exp_f32 v179, v179
v_mfma_f32_16x16x32_bf16 v[84:87], a[144:147], v[16:19], 0
ds_read_b128 a[208:211], v11 offset:4096
v_cvt_pk_bf16_f32 v176, v176, v177
v_mfma_f32_16x16x32_bf16 v[92:95], a[144:147], v[32:35], 0
v_exp_f32 v180, v180
MV 84,a,148,v,20
v_add_f32 v2, v2, v178
v_add_f32 v2, v2, v179
MV 92,a,148,v,36
v_exp_f32 v181, v181
MV 84,a,152,v,24
buffer_load_dwordx4 v12, s[56:59], s71 offen offset:1024 sc1 lds
v_cvt_pk_bf16_f32 v177, v178, v179
MV 92,a,152,v,40
v_exp_f32 v182, v182
MV 84,a,156,v,28
ds_read_b128 a[212:215], v11 offset:5120
v_add_f32 v2, v2, v180
MV 92,a,156,v,44
ds_read_b128 a[216:219], v11 offset:6144
v_add_f32 v2, v2, v181
v_mfma_f32_16x16x32_bf16 v[112:115], a[160:163], v[16:19], 0
v_exp_f32 v183, v183
v_mfma_f32_16x16x32_bf16 v[120:123], a[160:163], v[32:35], 0
ds_read_b128 a[220:223], v11 offset:7168
v_cvt_pk_bf16_f32 v178, v180, v181
MV 112,a,164,v,20
v_exp_f32 v184, v184
MV 120,a,164,v,36
v_add_f32 v2, v2, v182
v_add_f32 v2, v2, v183
MV 112,a,168,v,24
ds_read_b128 a[224:227], v11 offset:8192
buffer_load_dwordx4 v12, s[56:59], s71 offen offset:2048 sc1 lds
MV 120,a,168,v,40
v_exp_f32 v185, v185
MV 112,a,172,v,28
ds_read_b128 a[228:231], v11 offset:9216
v_cvt_pk_bf16_f32 v179, v182, v183
MV 120,a,172,v,44
v_exp_f32 v186, v186
v_mfma_f32_16x16x32_bf16 v[116:119], a[176:179], v[16:19], 0
v_add_f32 v3, v3, v184
v_add_f32 v3, v3, v185
v_mfma_f32_16x16x32_bf16 v[124:127], a[176:179], v[32:35], 0
v_exp_f32 v187, v187
MV 116,a,180,v,20
ds_read_b128 a[232:235], v11 offset:10240
v_cvt_pk_bf16_f32 v184, v184, v185
MV 124,a,180,v,36
v_exp_f32 v188, v188
MV 116,a,184,v,24
ds_read_b128 a[236:239], v11 offset:11264
v_add_f32 v3, v3, v186
MV 124,a,184,v,40
buffer_load_dwordx4 v12, s[56:59], s71 offen offset:3072 sc1 lds
v_add_f32 v3, v3, v187
MV 116,a,188,v,28
v_exp_f32 v189, v189
MV 124,a,188,v,44
ds_read_b128 a[240:243], v11 offset:12288
ds_read_b128 a[244:247], v11 offset:13312
ds_read_b128 a[248:251], v11 offset:14336
ds_read_b128 a[252:255], v11 offset:15360
s_add_u32 s71, s71, 16384
s_xor_b32 s73, s73, 0x8000
v_cvt_pk_bf16_f32 v185, v186, v187
v_exp_f32 v190, v190
v_add_f32 v3, v3, v188
v_add_f32 v3, v3, v189
v_exp_f32 v191, v191
v_cvt_pk_bf16_f32 v186, v188, v189
v_exp_f32 v200, v200
v_add_f32 v3, v3, v190
v_add_f32 v3, v3, v191
v_exp_f32 v201, v201
v_cvt_pk_bf16_f32 v187, v190, v191
v_exp_f32 v202, v202
v_add_u32 v246, 0, v13
v_cmp_gt_i32_e64 s[84:85], 0, v246
v_add_f32 v5, v5, v200
v_cmp_gt_i32_e64 s[86:87], 1, v246
v_cmp_gt_i32_e64 s[88:89], 2, v246
v_add_f32 v5, v5, v201
v_exp_f32 v203, v203
v_cmp_gt_i32_e64 s[90:91], 3, v246
v_cndmask_b32_e64 v80, v80, v14, s[84:85]
v_cvt_pk_bf16_f32 v200, v200, v201
v_exp_f32 v204, v204
v_cndmask_b32_e64 v81, v81, v14, s[86:87]
v_cndmask_b32_e64 v82, v82, v14, s[88:89]
v_add_f32 v5, v5, v202
v_add_f32 v5, v5, v203
v_cndmask_b32_e64 v83, v83, v14, s[90:91]
v_exp_f32 v205, v205
v_cvt_pk_bf16_f32 v201, v202, v203
v_add_u32 v247, -16, v13
v_cmp_gt_i32_e64 s[92:93], 0, v247
v_exp_f32 v206, v206
v_add_f32 v5, v5, v204
v_cmp_gt_i32_e64 s[94:95], 1, v247
v_cmp_gt_i32_e64 s[96:97], 2, v247
v_add_f32 v5, v5, v205
v_exp_f32 v207, v207
v_cmp_gt_i32_e64 s[98:99], 3, v247
v_cndmask_b32_e64 v84, v84, v14, s[92:93]
v_cvt_pk_bf16_f32 v202, v204, v205
v_add_f32 v5, v5, v206
v_cndmask_b32_e64 v85, v85, v14, s[94:95]
v_cndmask_b32_e64 v86, v86, v14, s[96:97]
v_add_f32 v5, v5, v207
v_cvt_pk_bf16_f32 v203, v206, v207
v_cndmask_b32_e64 v87, v87, v14, s[98:99]
s_waitcnt vmcnt(16) lgkmcnt(0)
MA 0,a,192,v,144
s_barrier
v_xor_b32 v10, 0x8000, v10
MA 32,a,192,v,152
s_add_u32 m0, s72, 16384
ds_read_b128 a[128:131], v10 offset:0
MA 4,a,196,v,144
buffer_load_dwordx4 v12, s[52:55], s71 offen offset:0 sc1 lds
v_lshrrev_b32 v249, 2, v1
MA 36,a,196,v,152
ds_read_b128 a[132:135], v10 offset:1024
v_and_b32 v248, 7, v249
MA 8,a,200,v,144
v_exp_f32 v80, v80
MA 40,a,200,v,152
v_lshlrev_b32 v249, 8, v249
v_and_b32 v250, 3, v1
MA 12,a,204,v,144
ds_read_b128 a[136:139], v10 offset:2048
v_lshl_add_u32 v249, v250, 3, v249
MA 44,a,204,v,152
v_exp_f32 v81, v81
MA 16,a,208,v,144
v_add_u32 v246, -32, v13
s_lshl_b32 s36, s3, 13
MA 48,a,208,v,152
s_add_u32 s36, s36, 131072
v_add_u32 v249, s36, v249
MA 20,a,212,v,144
v_exp_f32 v82, v82
MA 52,a,212,v,152
ds_read_b128 a[140:143], v10 offset:3072
s_nop 0
MA 24,a,216,v,144
v_cmp_gt_i32_e64 s[84:85], 0, v246
v_xor_b32 v250, 0, v248
MA 56,a,216,v,152
ds_read_b128 a[144:147], v10 offset:4096
v_lshl_add_u32 v250, v250, 5, v249
MA 28,a,220,v,144
v_exp_f32 v83, v83
MA 60,a,220,v,152
v_cmp_gt_i32_e64 s[86:87], 1, v246
TR 96,250,0
MA 124,a,220,v,168
TR 98,250,4096
v_xor_b32 v250, 1, v248
MA 120,a,216,v,168
ds_read_b128 a[148:151], v10 offset:5120
buffer_load_dwordx4 v12, s[52:55], s71 offen offset:1024 sc1 lds
MA 116,a,212,v,168
v_cvt_pk_bf16_f32 v80, v80, v81
v_lshl_add_u32 v250, v250, 5, v249
MA 112,a,208,v,168
TR 100,250,0
TR 102,250,4096
MA 108,a,204,v,168
v_exp_f32 v84, v84
MA 104,a,200,v,168
v_cmp_gt_i32_e64 s[88:89], 2, v246
v_xor_b32 v250, 2, v248
MA 100,a,196,v,168
ds_read_b128 a[152:155], v10 offset:6144
v_lshl_add_u32 v250, v250, 5, v249
MA 96,a,192,v,168
v_cmp_gt_i32_e64 s[90:91], 3, v246
TR 104,250,0
MA 0,a,224,v,176
v_exp_f32 v85, v85
MA 32,a,224,v,184
ds_read_b128 a[156:159], v10 offset:7168
TR 106,250,4096
MA 4,a,228,v,176
v_cvt_pk_bf16_f32 v81, v82, v83
v_xor_b32 v250, 3, v248
MA 36,a,228,v,184
v_cndmask_b32_e64 v112, v112, v14, s[84:85]
v_lshl_add_u32 v250, v250, 5, v249
MA 8,a,232,v,176
ds_read_b128 a[160:163], v10 offset:8192
TR 108,250,0
MA 40,a,232,v,184
TR 110,250,4096
v_xor_b32 v250, 4, v248
MA 12,a,236,v,176
v_exp_f32 v86, v86
MA 44,a,236,v,184
ds_read_b128 a[164:167], v10 offset:9216
v_lshl_add_u32 v250, v250, 5, v249
MA 16,a,240,v,176
buffer_load_dwordx4 v12, s[52:55], s71 offen offset:2048 sc1 lds
v_cndmask_b32_e64 v113, v113, v14, s[86:87]
MA 48,a,240,v,184
TR 128,250,0
TR 130,250,4096
MA 20,a,244,v,176
v_exp_f32 v87, v87
MA 52,a,244,v,184
ds_read_b128 a[168:171], v10 offset:10240
v_xor_b32 v250, 5, v248
MA 24,a,248,v,176
v_cvt_pk_bf16_f32 v82, v84, v85
v_cndmask_b32_e64 v114, v114, v14, s[88:89]
MA 56,a,248,v,184
v_lshl_add_u32 v250, v250, 5, v249
TR 132,250,0
MA 28,a,252,v,176
v_cndmask_b32_e64 v115, v115, v14, s[90:91]
TR 134,250,4096
MA 60,a,252,v,184
v_exp_f32 v88, v88
MA 124,a,252,v,200
ds_read_b128 a[172:175], v10 offset:11264
v_xor_b32 v250, 6, v248
MA 120,a,248,v,200
v_lshl_add_u32 v250, v250, 5, v249
TR 136,250,0
MA 116,a,244,v,200
ds_read_b128 a[176:179], v10 offset:12288
TR 138,250,4096
MA 112,a,240,v,200
v_exp_f32 v89, v89
MA 108,a,236,v,200
v_add_u32 v247, -48, v13
v_xor_b32 v250, 7, v248
MA 104,a,232,v,200
v_cvt_pk_bf16_f32 v83, v86, v87
v_lshl_add_u32 v250, v250, 5, v249
MA 100,a,228,v,200
ds_read_b128 a[180:183], v10 offset:13312
TR 140,250,0
MA 96,a,224,v,200
ds_read_b128 a[184:187], v10 offset:14336
ds_read_b128 a[188:191], v10 offset:15360
buffer_load_dwordx4 v12, s[52:55], s71 offen offset:3072 sc1 lds
s_xor_b32 s72, s72, 0x8000
v_exp_f32 v90, v90
v_cmp_gt_i32_e64 s[92:93], 0, v247
TR 142,250,4096
s_add_u32 s32, s40, 100663296
s_addc_u32 s33, s41, 0
v_exp_f32 v91, v91
v_cmp_gt_i32_e64 s[94:95], 1, v247
s_mov_b32 s34, 8388608
s_mov_b32 s35, 0x20000
s_and_b32 s36, s2, 7
s_lshl_b32 s36, s36, 20
s_lshr_b32 s37, s2, 3
v_cvt_pk_bf16_f32 v88, v88, v89
v_cmp_gt_i32_e64 s[96:97], 2, v247
s_lshl_b32 s37, s37, 15
v_exp_f32 v92, v92
s_add_u32 s36, s36, s37
s_lshl_b32 s37, s3, 12
v_cmp_gt_i32_e64 s[98:99], 3, v247
s_add_u32 s36, s36, s37
v_exp_f32 v93, v93
s_add_u32 s37, s36, 4096
s_waitcnt lgkmcnt(15)
buffer_store_dwordx4 v[96:99], v12, s[32:35], s36 offen offset:0 sc1
v_cndmask_b32_e64 v116, v116, v14, s[92:93]
buffer_store_dwordx4 v[100:103], v12, s[32:35], s36 offen offset:1024 sc1
v_cvt_pk_bf16_f32 v89, v90, v91
buffer_store_dwordx4 v[104:107], v12, s[32:35], s36 offen offset:2048 sc1
buffer_store_dwordx4 v[108:111], v12, s[32:35], s36 offen offset:3072 sc1
s_waitcnt lgkmcnt(12)
buffer_store_dwordx4 v[128:131], v12, s[32:35], s37 offen offset:0 sc1
v_exp_f32 v94, v94
v_cndmask_b32_e64 v117, v117, v14, s[94:95]
s_waitcnt lgkmcnt(9)
buffer_store_dwordx4 v[132:135], v12, s[32:35], s37 offen offset:1024 sc1
s_waitcnt lgkmcnt(5)
buffer_store_dwordx4 v[136:139], v12, s[32:35], s37 offen offset:2048 sc1
s_waitcnt lgkmcnt(0)
buffer_store_dwordx4 v[140:143], v12, s[32:35], s37 offen offset:3072 sc1
v_exp_f32 v95, v95
v_cndmask_b32_e64 v118, v118, v14, s[96:97]
v_lshlrev_b32 v232, 4, v1
v_mov_b32 v235, 0
buffer_load_ushort v234, v235, s[28:31], s42 offen
v_cvt_pk_bf16_f32 v90, v92, v93
v_cndmask_b32_e64 v119, v119, v14, s[98:99]
buffer_load_dwordx4 v[210:213], v232, s[16:19], 0 offen offset:0
buffer_load_dwordx4 v[216:219], v232, s[16:19], 0 offen offset:1024
v_cvt_pk_bf16_f32 v91, v94, v95
buffer_load_dwordx4 v[222:225], v232, s[16:19], 0 offen offset:2048
buffer_load_dwordx4 v[228:231], v232, s[16:19], 0 offen offset:3072
s_branch L_p3_eps
L_fallback:
s_mov_b32 s81, 0
s_mov_b32 s74, s77
s_mov_b32 s73, s100
s_sub_u32 s72, 15, s70
v_mov_b32 v10, v15
v_add_u32 v11, 16384, v15
s_nop 15
L_fb_set:
s_lshl_b32 s72, s72, 7
s_mov_b32 s71, 0
v_accvgpr_write_b32 a0, 0
v_accvgpr_write_b32 a1, 0
v_accvgpr_write_b32 a2, 0
v_accvgpr_write_b32 a3, 0
v_accvgpr_write_b32 a4, 0
v_accvgpr_write_b32 a5, 0
v_accvgpr_write_b32 a6, 0
v_accvgpr_write_b32 a7, 0
v_accvgpr_write_b32 a8, 0
v_accvgpr_write_b32 a9, 0
v_accvgpr_write_b32 a10, 0
v_accvgpr_write_b32 a11, 0
v_accvgpr_write_b32 a12, 0
v_accvgpr_write_b32 a13, 0
v_accvgpr_write_b32 a14, 0
v_accvgpr_write_b32 a15, 0
v_accvgpr_write_b32 a16, 0
v_accvgpr_write_b32 a17, 0
v_accvgpr_write_b32 a18, 0
v_accvgpr_write_b32 a19, 0
v_accvgpr_write_b32 a20, 0
v_accvgpr_write_b32 a21, 0
v_accvgpr_write_b32 a22, 0
v_accvgpr_write_b32 a23, 0
v_accvgpr_write_b32 a24, 0
v_accvgpr_write_b32 a25, 0
v_accvgpr_write_b32 a26, 0
v_accvgpr_write_b32 a27, 0
v_accvgpr_write_b32 a28, 0
v_accvgpr_write_b32 a29, 0
v_accvgpr_write_b32 a30, 0
v_accvgpr_write_b32 a31, 0
v_accvgpr_write_b32 a32, 0
v_accvgpr_write_b32 a33, 0
v_accvgpr_write_b32 a34, 0
v_accvgpr_write_b32 a35, 0
v_accvgpr_write_b32 a36, 0
v_accvgpr_write_b32 a37, 0
v_accvgpr_write_b32 a38, 0
v_accvgpr_write_b32 a39, 0
v_accvgpr_write_b32 a40, 0
v_accvgpr_write_b32 a41, 0
v_accvgpr_write_b32 a42, 0
v_accvgpr_write_b32 a43, 0
v_accvgpr_write_b32 a44, 0
v_accvgpr_write_b32 a45, 0
v_accvgpr_write_b32 a46, 0
v_accvgpr_write_b32 a47, 0
v_accvgpr_write_b32 a48, 0
v_accvgpr_write_b32 a49, 0
v_accvgpr_write_b32 a50, 0
v_accvgpr_write_b32 a51, 0
v_accvgpr_write_b32 a52, 0
v_accvgpr_write_b32 a53, 0
v_accvgpr_write_b32 a54, 0
v_accvgpr_write_b32 a55, 0
v_accvgpr_write_b32 a56, 0
v_accvgpr_write_b32 a57, 0
v_accvgpr_write_b32 a58, 0
v_accvgpr_write_b32 a59, 0
v_accvgpr_write_b32 a60, 0
v_accvgpr_write_b32 a61, 0
v_accvgpr_write_b32 a62, 0
v_accvgpr_write_b32 a63, 0
v_mov_b32 v2, 0
v_mov_b32 v96, v14
v_mov_b32 v3, 0
v_mov_b32 v97, v14
L_fb_tile:
s_waitcnt vmcnt(0) lgkmcnt(0)
s_barrier
s_mov_b32 m0, s68
s_add_u32 s80, s71, 16384
buffer_load_dwordx4 v12, s[52:55], s71 offen offset:0 sc1 lds
buffer_load_dwordx4 v12, s[52:55], s71 offen offset:1024 sc1 lds
buffer_load_dwordx4 v12, s[52:55], s71 offen offset:2048 sc1 lds
buffer_load_dwordx4 v12, s[52:55], s71 offen offset:3072 sc1 lds
s_add_u32 m0, s68, 16384
s_nop 0
buffer_load_dwordx4 v12, s[56:59], s80 offen offset:0 sc1 lds
buffer_load_dwordx4 v12, s[56:59], s80 offen offset:1024 sc1 lds
buffer_load_dwordx4 v12, s[56:59], s80 offen offset:2048 sc1 lds
buffer_load_dwordx4 v12, s[56:59], s80 offen offset:3072 sc1 lds
s_waitcnt vmcnt(0)
s_barrier
ds_read_b128 a[128:131], v10 offset:0
ds_read_b128 a[132:135], v10 offset:1024
ds_read_b128 a[136:139], v10 offset:2048
ds_read_b128 a[140:143], v10 offset:3072
ds_read_b128 a[144:147], v10 offset:4096
ds_read_b128 a[148:151], v10 offset:5120
ds_read_b128 a[152:155], v10 offset:6144
ds_read_b128 a[156:159], v10 offset:7168
ds_read_b128 a[160:163], v10 offset:8192
ds_read_b128 a[164:167], v10 offset:9216
ds_read_b128 a[168:171], v10 offset:10240
ds_read_b128 a[172:175], v10 offset:11264
ds_read_b128 a[176:179], v10 offset:12288
ds_read_b128 a[180:183], v10 offset:13312
ds_read_b128 a[184:187], v10 offset:14336
ds_read_b128 a[188:191], v10 offset:15360
s_waitcnt lgkmcnt(0)
ds_read_b128 a[192:195], v11 offset:0
ds_read_b128 a[196:199], v11 offset:1024
ds_read_b128 a[200:203], v11 offset:2048
ds_read_b128 a[204:207], v11 offset:3072
ds_read_b128 a[208:211], v11 offset:4096
ds_read_b128 a[212:215], v11 offset:5120
ds_read_b128 a[216:219], v11 offset:6144
ds_read_b128 a[220:223], v11 offset:7168
ds_read_b128 a[224:227], v11 offset:8192
ds_read_b128 a[228:231], v11 offset:9216
ds_read_b128 a[232:235], v11 offset:10240
ds_read_b128 a[236:239], v11 offset:11264
ds_read_b128 a[240:243], v11 offset:12288
ds_read_b128 a[244:247], v11 offset:13312
ds_read_b128 a[248:251], v11 offset:14336
ds_read_b128 a[252:255], v11 offset:15360
v_mfma_f32_16x16x32_bf16 v[80:83], a[128:131], v[16:19], 0
v_mfma_f32_16x16x32_bf16 v[88:91], a[128:131], v[32:35], 0
MV 80,a,132,v,20
MV 88,a,132,v,36
MV 80,a,136,v,24
MV 88,a,136,v,40
MV 80,a,140,v,28
MV 88,a,140,v,44
v_mfma_f32_16x16x32_bf16 v[84:87], a[144:147], v[16:19], 0
v_mfma_f32_16x16x32_bf16 v[92:95], a[144:147], v[32:35], 0
MV 84,a,148,v,20
MV 92,a,148,v,36
MV 84,a,152,v,24
MV 92,a,152,v,40
MV 84,a,156,v,28
MV 92,a,156,v,44
v_mfma_f32_16x16x32_bf16 v[112:115], a[160:163], v[16:19], 0
v_mfma_f32_16x16x32_bf16 v[120:123], a[160:163], v[32:35], 0
MV 112,a,164,v,20
MV 120,a,164,v,36
MV 112,a,168,v,24
MV 120,a,168,v,40
MV 112,a,172,v,28
MV 120,a,172,v,44
v_mfma_f32_16x16x32_bf16 v[116:119], a[176:179], v[16:19], 0
v_mfma_f32_16x16x32_bf16 v[124:127], a[176:179], v[32:35], 0
MV 116,a,180,v,20
MV 124,a,180,v,36
MV 116,a,184,v,24
MV 124,a,184,v,40
MV 116,a,188,v,28
MV 124,a,188,v,44
v_add_u32 v246, s72, v13
v_add_u32 v246, 0, v246
v_cmp_gt_i32_e64 s[84:85], 0, v246
v_cmp_gt_i32_e64 s[86:87], 1, v246
v_cmp_gt_i32_e64 s[88:89], 2, v246
v_cmp_gt_i32_e64 s[90:91], 3, v246
v_cndmask_b32_e64 v80, v80, v14, s[84:85]
v_cndmask_b32_e64 v81, v81, v14, s[86:87]
v_cndmask_b32_e64 v82, v82, v14, s[88:89]
v_cndmask_b32_e64 v83, v83, v14, s[90:91]
v_add_u32 v247, s72, v239
v_add_u32 v247, 0, v247
v_cmp_gt_i32_e64 s[92:93], 0, v247
v_cmp_gt_i32_e64 s[94:95], 1, v247
v_cmp_gt_i32_e64 s[96:97], 2, v247
v_cmp_gt_i32_e64 s[98:99], 3, v247
v_cndmask_b32_e64 v88, v88, v14, s[92:93]
v_cndmask_b32_e64 v89, v89, v14, s[94:95]
v_cndmask_b32_e64 v90, v90, v14, s[96:97]
v_cndmask_b32_e64 v91, v91, v14, s[98:99]
v_add_u32 v246, s72, v13
v_add_u32 v246, -16, v246
v_cmp_gt_i32_e64 s[84:85], 0, v246
v_cmp_gt_i32_e64 s[86:87], 1, v246
v_cmp_gt_i32_e64 s[88:89], 2, v246
v_cmp_gt_i32_e64 s[90:91], 3, v246
v_cndmask_b32_e64 v84, v84, v14, s[84:85]
v_cndmask_b32_e64 v85, v85, v14, s[86:87]
v_cndmask_b32_e64 v86, v86, v14, s[88:89]
v_cndmask_b32_e64 v87, v87, v14, s[90:91]
v_add_u32 v247, s72, v239
v_add_u32 v247, -16, v247
v_cmp_gt_i32_e64 s[92:93], 0, v247
v_cmp_gt_i32_e64 s[94:95], 1, v247
v_cmp_gt_i32_e64 s[96:97], 2, v247
v_cmp_gt_i32_e64 s[98:99], 3, v247
v_cndmask_b32_e64 v92, v92, v14, s[92:93]
v_cndmask_b32_e64 v93, v93, v14, s[94:95]
v_cndmask_b32_e64 v94, v94, v14, s[96:97]
v_cndmask_b32_e64 v95, v95, v14, s[98:99]
v_add_u32 v246, s72, v13
v_add_u32 v246, -32, v246
v_cmp_gt_i32_e64 s[84:85], 0, v246
v_cmp_gt_i32_e64 s[86:87], 1, v246
v_cmp_gt_i32_e64 s[88:89], 2, v246
v_cmp_gt_i32_e64 s[90:91], 3, v246
v_cndmask_b32_e64 v112, v112, v14, s[84:85]
v_cndmask_b32_e64 v113, v113, v14, s[86:87]
v_cndmask_b32_e64 v114, v114, v14, s[88:89]
v_cndmask_b32_e64 v115, v115, v14, s[90:91]
v_add_u32 v247, s72, v239
v_add_u32 v247, -32, v247
v_cmp_gt_i32_e64 s[92:93], 0, v247
v_cmp_gt_i32_e64 s[94:95], 1, v247
v_cmp_gt_i32_e64 s[96:97], 2, v247
v_cmp_gt_i32_e64 s[98:99], 3, v247
v_cndmask_b32_e64 v120, v120, v14, s[92:93]
v_cndmask_b32_e64 v121, v121, v14, s[94:95]
v_cndmask_b32_e64 v122, v122, v14, s[96:97]
v_cndmask_b32_e64 v123, v123, v14, s[98:99]
v_add_u32 v246, s72, v13
v_add_u32 v246, -48, v246
v_cmp_gt_i32_e64 s[84:85], 0, v246
v_cmp_gt_i32_e64 s[86:87], 1, v246
v_cmp_gt_i32_e64 s[88:89], 2, v246
v_cmp_gt_i32_e64 s[90:91], 3, v246
v_cndmask_b32_e64 v116, v116, v14, s[84:85]
v_cndmask_b32_e64 v117, v117, v14, s[86:87]
v_cndmask_b32_e64 v118, v118, v14, s[88:89]
v_cndmask_b32_e64 v119, v119, v14, s[90:91]
v_add_u32 v247, s72, v239
v_add_u32 v247, -48, v247
v_cmp_gt_i32_e64 s[92:93], 0, v247
v_cmp_gt_i32_e64 s[94:95], 1, v247
v_cmp_gt_i32_e64 s[96:97], 2, v247
v_cmp_gt_i32_e64 s[98:99], 3, v247
v_cndmask_b32_e64 v124, v124, v14, s[92:93]
v_cndmask_b32_e64 v125, v125, v14, s[94:95]
v_cndmask_b32_e64 v126, v126, v14, s[96:97]
v_cndmask_b32_e64 v127, v127, v14, s[98:99]
v_mov_b32 v242, v96
v_max3_f32 v242, v242, v80, v81
v_max3_f32 v242, v242, v82, v83
v_max3_f32 v242, v242, v84, v85
v_max3_f32 v242, v242, v86, v87
v_max3_f32 v242, v242, v112, v113
v_max3_f32 v242, v242, v114, v115
v_max3_f32 v242, v242, v116, v117
v_max3_f32 v242, v242, v118, v119
v_mov_b32 v243, v242
s_nop 1
v_permlane32_swap_b32 v242, v243
v_max_f32 v242, v242, v243
v_mov_b32 v243, v242
s_nop 1
v_permlane16_swap_b32 v242, v243
v_max_f32 v242, v242, v243
v_sub_f32 v98, v96, v242
v_exp_f32 v98, v98
v_mov_b32 v96, v242
v_sub_f32 v80, v80, v242
v_sub_f32 v81, v81, v242
v_sub_f32 v82, v82, v242
v_sub_f32 v83, v83, v242
v_sub_f32 v84, v84, v242
v_sub_f32 v85, v85, v242
v_sub_f32 v86, v86, v242
v_sub_f32 v87, v87, v242
v_sub_f32 v112, v112, v242
v_sub_f32 v113, v113, v242
v_sub_f32 v114, v114, v242
v_sub_f32 v115, v115, v242
v_sub_f32 v116, v116, v242
v_sub_f32 v117, v117, v242
v_sub_f32 v118, v118, v242
v_sub_f32 v119, v119, v242
v_mul_f32 v2, v2, v98
v_accvgpr_read_b32 v243, a0
v_mul_f32 v243, v243, v98
v_accvgpr_write_b32 a0, v243
v_accvgpr_read_b32 v243, a1
v_mul_f32 v243, v243, v98
v_accvgpr_write_b32 a1, v243
v_accvgpr_read_b32 v243, a2
v_mul_f32 v243, v243, v98
v_accvgpr_write_b32 a2, v243
v_accvgpr_read_b32 v243, a3
v_mul_f32 v243, v243, v98
v_accvgpr_write_b32 a3, v243
v_accvgpr_read_b32 v243, a4
v_mul_f32 v243, v243, v98
v_accvgpr_write_b32 a4, v243
v_accvgpr_read_b32 v243, a5
v_mul_f32 v243, v243, v98
v_accvgpr_write_b32 a5, v243
v_accvgpr_read_b32 v243, a6
v_mul_f32 v243, v243, v98
v_accvgpr_write_b32 a6, v243
v_accvgpr_read_b32 v243, a7
v_mul_f32 v243, v243, v98
v_accvgpr_write_b32 a7, v243
v_accvgpr_read_b32 v243, a8
v_mul_f32 v243, v243, v98
v_accvgpr_write_b32 a8, v243
v_accvgpr_read_b32 v243, a9
v_mul_f32 v243, v243, v98
v_accvgpr_write_b32 a9, v243
v_accvgpr_read_b32 v243, a10
v_mul_f32 v243, v243, v98
v_accvgpr_write_b32 a10, v243
v_accvgpr_read_b32 v243, a11
v_mul_f32 v243, v243, v98
v_accvgpr_write_b32 a11, v243
v_accvgpr_read_b32 v243, a12
v_mul_f32 v243, v243, v98
v_accvgpr_write_b32 a12, v243
v_accvgpr_read_b32 v243, a13
v_mul_f32 v243, v243, v98
v_accvgpr_write_b32 a13, v243
v_accvgpr_read_b32 v243, a14
v_mul_f32 v243, v243, v98
v_accvgpr_write_b32 a14, v243
v_accvgpr_read_b32 v243, a15
v_mul_f32 v243, v243, v98
v_accvgpr_write_b32 a15, v243
v_accvgpr_read_b32 v243, a16
v_mul_f32 v243, v243, v98
v_accvgpr_write_b32 a16, v243
v_accvgpr_read_b32 v243, a17
v_mul_f32 v243, v243, v98
v_accvgpr_write_b32 a17, v243
v_accvgpr_read_b32 v243, a18
v_mul_f32 v243, v243, v98
v_accvgpr_write_b32 a18, v243
v_accvgpr_read_b32 v243, a19
v_mul_f32 v243, v243, v98
v_accvgpr_write_b32 a19, v243
v_accvgpr_read_b32 v243, a20
v_mul_f32 v243, v243, v98
v_accvgpr_write_b32 a20, v243
v_accvgpr_read_b32 v243, a21
v_mul_f32 v243, v243, v98
v_accvgpr_write_b32 a21, v243
v_accvgpr_read_b32 v243, a22
v_mul_f32 v243, v243, v98
v_accvgpr_write_b32 a22, v243
v_accvgpr_read_b32 v243, a23
v_mul_f32 v243, v243, v98
v_accvgpr_write_b32 a23, v243
v_accvgpr_read_b32 v243, a24
v_mul_f32 v243, v243, v98
v_accvgpr_write_b32 a24, v243
v_accvgpr_read_b32 v243, a25
v_mul_f32 v243, v243, v98
v_accvgpr_write_b32 a25, v243
v_accvgpr_read_b32 v243, a26
v_mul_f32 v243, v243, v98
v_accvgpr_write_b32 a26, v243
v_accvgpr_read_b32 v243, a27
v_mul_f32 v243, v243, v98
v_accvgpr_write_b32 a27, v243
v_accvgpr_read_b32 v243, a28
v_mul_f32 v243, v243, v98
v_accvgpr_write_b32 a28, v243
v_accvgpr_read_b32 v243, a29
v_mul_f32 v243, v243, v98
v_accvgpr_write_b32 a29, v243
v_accvgpr_read_b32 v243, a30
v_mul_f32 v243, v243, v98
v_accvgpr_write_b32 a30, v243
v_accvgpr_read_b32 v243, a31
v_mul_f32 v243, v243, v98
v_accvgpr_write_b32 a31, v243
v_mov_b32 v242, v97
v_max3_f32 v242, v242, v88, v89
v_max3_f32 v242, v242, v90, v91
v_max3_f32 v242, v242, v92, v93
v_max3_f32 v242, v242, v94, v95
v_max3_f32 v242, v242, v120, v121
v_max3_f32 v242, v242, v122, v123
v_max3_f32 v242, v242, v124, v125
v_max3_f32 v242, v242, v126, v127
v_mov_b32 v243, v242
s_nop 1
v_permlane32_swap_b32 v242, v243
v_max_f32 v242, v242, v243
v_mov_b32 v243, v242
s_nop 1
v_permlane16_swap_b32 v242, v243
v_max_f32 v242, v242, v243
v_sub_f32 v99, v97, v242
v_exp_f32 v99, v99
v_mov_b32 v97, v242
v_sub_f32 v88, v88, v242
v_sub_f32 v89, v89, v242
v_sub_f32 v90, v90, v242
v_sub_f32 v91, v91, v242
v_sub_f32 v92, v92, v242
v_sub_f32 v93, v93, v242
v_sub_f32 v94, v94, v242
v_sub_f32 v95, v95, v242
v_sub_f32 v120, v120, v242
v_sub_f32 v121, v121, v242
v_sub_f32 v122, v122, v242
v_sub_f32 v123, v123, v242
v_sub_f32 v124, v124, v242
v_sub_f32 v125, v125, v242
v_sub_f32 v126, v126, v242
v_sub_f32 v127, v127, v242
v_mul_f32 v3, v3, v99
v_accvgpr_read_b32 v243, a32
v_mul_f32 v243, v243, v99
v_accvgpr_write_b32 a32, v243
v_accvgpr_read_b32 v243, a33
v_mul_f32 v243, v243, v99
v_accvgpr_write_b32 a33, v243
v_accvgpr_read_b32 v243, a34
v_mul_f32 v243, v243, v99
v_accvgpr_write_b32 a34, v243
v_accvgpr_read_b32 v243, a35
v_mul_f32 v243, v243, v99
v_accvgpr_write_b32 a35, v243
v_accvgpr_read_b32 v243, a36
v_mul_f32 v243, v243, v99
v_accvgpr_write_b32 a36, v243
v_accvgpr_read_b32 v243, a37
v_mul_f32 v243, v243, v99
v_accvgpr_write_b32 a37, v243
v_accvgpr_read_b32 v243, a38
v_mul_f32 v243, v243, v99
v_accvgpr_write_b32 a38, v243
v_accvgpr_read_b32 v243, a39
v_mul_f32 v243, v243, v99
v_accvgpr_write_b32 a39, v243
v_accvgpr_read_b32 v243, a40
v_mul_f32 v243, v243, v99
v_accvgpr_write_b32 a40, v243
v_accvgpr_read_b32 v243, a41
v_mul_f32 v243, v243, v99
v_accvgpr_write_b32 a41, v243
v_accvgpr_read_b32 v243, a42
v_mul_f32 v243, v243, v99
v_accvgpr_write_b32 a42, v243
v_accvgpr_read_b32 v243, a43
v_mul_f32 v243, v243, v99
v_accvgpr_write_b32 a43, v243
v_accvgpr_read_b32 v243, a44
v_mul_f32 v243, v243, v99
v_accvgpr_write_b32 a44, v243
v_accvgpr_read_b32 v243, a45
v_mul_f32 v243, v243, v99
v_accvgpr_write_b32 a45, v243
v_accvgpr_read_b32 v243, a46
v_mul_f32 v243, v243, v99
v_accvgpr_write_b32 a46, v243
v_accvgpr_read_b32 v243, a47
v_mul_f32 v243, v243, v99
v_accvgpr_write_b32 a47, v243
v_accvgpr_read_b32 v243, a48
v_mul_f32 v243, v243, v99
v_accvgpr_write_b32 a48, v243
v_accvgpr_read_b32 v243, a49
v_mul_f32 v243, v243, v99
v_accvgpr_write_b32 a49, v243
v_accvgpr_read_b32 v243, a50
v_mul_f32 v243, v243, v99
v_accvgpr_write_b32 a50, v243
v_accvgpr_read_b32 v243, a51
v_mul_f32 v243, v243, v99
v_accvgpr_write_b32 a51, v243
v_accvgpr_read_b32 v243, a52
v_mul_f32 v243, v243, v99
v_accvgpr_write_b32 a52, v243
v_accvgpr_read_b32 v243, a53
v_mul_f32 v243, v243, v99
v_accvgpr_write_b32 a53, v243
v_accvgpr_read_b32 v243, a54
v_mul_f32 v243, v243, v99
v_accvgpr_write_b32 a54, v243
v_accvgpr_read_b32 v243, a55
v_mul_f32 v243, v243, v99
v_accvgpr_write_b32 a55, v243
v_accvgpr_read_b32 v243, a56
v_mul_f32 v243, v243, v99
v_accvgpr_write_b32 a56, v243
v_accvgpr_read_b32 v243, a57
v_mul_f32 v243, v243, v99
v_accvgpr_write_b32 a57, v243
v_accvgpr_read_b32 v243, a58
v_mul_f32 v243, v243, v99
v_accvgpr_write_b32 a58, v243
v_accvgpr_read_b32 v243, a59
v_mul_f32 v243, v243, v99
v_accvgpr_write_b32 a59, v243
v_accvgpr_read_b32 v243, a60
v_mul_f32 v243, v243, v99
v_accvgpr_write_b32 a60, v243
v_accvgpr_read_b32 v243, a61
v_mul_f32 v243, v243, v99
v_accvgpr_write_b32 a61, v243
v_accvgpr_read_b32 v243, a62
v_mul_f32 v243, v243, v99
v_accvgpr_write_b32 a62, v243
v_accvgpr_read_b32 v243, a63
v_mul_f32 v243, v243, v99
v_accvgpr_write_b32 a63, v243
v_exp_f32 v80, v80
v_exp_f32 v81, v81
v_exp_f32 v82, v82
v_add_f32 v2, v2, v80
v_add_f32 v2, v2, v81
v_exp_f32 v83, v83
v_cvt_pk_bf16_f32 v80, v80, v81
v_exp_f32 v84, v84
v_add_f32 v2, v2, v82
v_add_f32 v2, v2, v83
v_exp_f32 v85, v85
v_cvt_pk_bf16_f32 v81, v82, v83
v_exp_f32 v86, v86
v_add_f32 v2, v2, v84
v_add_f32 v2, v2, v85
v_exp_f32 v87, v87
v_cvt_pk_bf16_f32 v82, v84, v85
v_exp_f32 v88, v88
v_add_f32 v2, v2, v86
v_add_f32 v2, v2, v87
v_exp_f32 v89, v89
v_cvt_pk_bf16_f32 v83, v86, v87
v_exp_f32 v90, v90
v_add_f32 v3, v3, v88
v_add_f32 v3, v3, v89
v_exp_f32 v91, v91
v_cvt_pk_bf16_f32 v88, v88, v89
v_exp_f32 v92, v92
v_add_f32 v3, v3, v90
v_add_f32 v3, v3, v91
v_exp_f32 v93, v93
v_cvt_pk_bf16_f32 v89, v90, v91
v_exp_f32 v94, v94
v_add_f32 v3, v3, v92
v_add_f32 v3, v3, v93
v_exp_f32 v95, v95
v_cvt_pk_bf16_f32 v90, v92, v93
v_exp_f32 v112, v112
v_add_f32 v3, v3, v94
v_add_f32 v3, v3, v95
v_exp_f32 v113, v113
v_cvt_pk_bf16_f32 v91, v94, v95
v_exp_f32 v114, v114
v_add_f32 v2, v2, v112
v_add_f32 v2, v2, v113
v_exp_f32 v115, v115
v_cvt_pk_bf16_f32 v112, v112, v113
v_exp_f32 v116, v116
v_add_f32 v2, v2, v114
v_add_f32 v2, v2, v115
v_exp_f32 v117, v117
v_cvt_pk_bf16_f32 v113, v114, v115
v_exp_f32 v118, v118
v_add_f32 v2, v2, v116
v_add_f32 v2, v2, v117
v_exp_f32 v119, v119
v_cvt_pk_bf16_f32 v114, v116, v117
v_exp_f32 v120, v120
v_add_f32 v2, v2, v118
v_add_f32 v2, v2, v119
v_exp_f32 v121, v121
v_cvt_pk_bf16_f32 v115, v118, v119
v_exp_f32 v122, v122
v_add_f32 v3, v3, v120
v_add_f32 v3, v3, v121
v_exp_f32 v123, v123
v_cvt_pk_bf16_f32 v120, v120, v121
v_exp_f32 v124, v124
v_add_f32 v3, v3, v122
v_add_f32 v3, v3, v123
v_exp_f32 v125, v125
v_cvt_pk_bf16_f32 v121, v122, v123
v_exp_f32 v126, v126
v_add_f32 v3, v3, v124
v_add_f32 v3, v3, v125
v_exp_f32 v127, v127
v_cvt_pk_bf16_f32 v122, v124, v125
v_add_f32 v3, v3, v126
v_add_f32 v3, v3, v127
v_cvt_pk_bf16_f32 v123, v126, v127
s_waitcnt lgkmcnt(15)
MA 0,a,192,v,80
MA 32,a,192,v,88
s_waitcnt lgkmcnt(14)
MA 4,a,196,v,80
MA 36,a,196,v,88
s_waitcnt lgkmcnt(13)
MA 8,a,200,v,80
MA 40,a,200,v,88
s_waitcnt lgkmcnt(12)
MA 12,a,204,v,80
MA 44,a,204,v,88
s_waitcnt lgkmcnt(11)
MA 16,a,208,v,80
MA 48,a,208,v,88
s_waitcnt lgkmcnt(10)
MA 20,a,212,v,80
MA 52,a,212,v,88
s_waitcnt lgkmcnt(9)
MA 24,a,216,v,80
MA 56,a,216,v,88
s_waitcnt lgkmcnt(8)
MA 28,a,220,v,80
MA 60,a,220,v,88
s_waitcnt lgkmcnt(7)
MA 0,a,224,v,112
MA 32,a,224,v,120
s_waitcnt lgkmcnt(6)
MA 4,a,228,v,112
MA 36,a,228,v,120
s_waitcnt lgkmcnt(5)
MA 8,a,232,v,112
MA 40,a,232,v,120
s_waitcnt lgkmcnt(4)
MA 12,a,236,v,112
MA 44,a,236,v,120
s_waitcnt lgkmcnt(3)
MA 16,a,240,v,112
MA 48,a,240,v,120
s_waitcnt lgkmcnt(2)
MA 20,a,244,v,112
MA 52,a,244,v,120
s_waitcnt lgkmcnt(1)
MA 24,a,248,v,112
MA 56,a,248,v,120
s_waitcnt lgkmcnt(0)
MA 28,a,252,v,112
MA 60,a,252,v,120
s_add_u32 s71, s71, 16384
s_sub_u32 s72, s72, 64
s_sub_u32 s74, s74, 1
s_nop 15
s_cmp_lg_u32 s74, 0
s_cbranch_scc1 L_fb_tile
v_mov_b32 v240, v2
s_nop 1
v_permlane32_swap_b32 v2, v240
v_add_f32 v2, v2, v240
v_mov_b32 v240, v2
s_nop 1
v_permlane16_swap_b32 v2, v240
v_add_f32 v2, v2, v240
v_mov_b32 v240, v3
s_nop 1
v_permlane32_swap_b32 v3, v240
v_add_f32 v3, v3, v240
v_mov_b32 v240, v3
s_nop 1
v_permlane16_swap_b32 v3, v240
v_add_f32 v3, v3, v240
v_rcp_f32 v2, v2
v_rcp_f32 v3, v3
s_add_u32 s80, s73, s76
s_nop 4
v_accvgpr_read_b32 v240, a0
v_accvgpr_read_b32 v241, a1
v_accvgpr_read_b32 v242, a2
v_accvgpr_read_b32 v243, a3
v_accvgpr_read_b32 v244, a4
v_accvgpr_read_b32 v245, a5
v_accvgpr_read_b32 v246, a6
v_accvgpr_read_b32 v247, a7
v_pk_mul_f32 v[240:241], v[240:241], v[2:3] op_sel:[0,0] op_sel_hi:[1,0]
v_pk_mul_f32 v[242:243], v[242:243], v[2:3] op_sel:[0,0] op_sel_hi:[1,0]
v_pk_mul_f32 v[244:245], v[244:245], v[2:3] op_sel:[0,0] op_sel_hi:[1,0]
v_pk_mul_f32 v[246:247], v[246:247], v[2:3] op_sel:[0,0] op_sel_hi:[1,0]
v_cvt_pk_bf16_f32 v248, v240, v241
v_cvt_pk_bf16_f32 v249, v242, v243
v_cvt_pk_bf16_f32 v250, v244, v245
v_cvt_pk_bf16_f32 v251, v246, v247
buffer_store_dwordx4 v[248:251], v15, s[60:63], s73 offen offset:0 sc1
v_accvgpr_read_b32 v240, a8
v_accvgpr_read_b32 v241, a9
v_accvgpr_read_b32 v242, a10
v_accvgpr_read_b32 v243, a11
v_accvgpr_read_b32 v244, a12
v_accvgpr_read_b32 v245, a13
v_accvgpr_read_b32 v246, a14
v_accvgpr_read_b32 v247, a15
v_pk_mul_f32 v[240:241], v[240:241], v[2:3] op_sel:[0,0] op_sel_hi:[1,0]
v_pk_mul_f32 v[242:243], v[242:243], v[2:3] op_sel:[0,0] op_sel_hi:[1,0]
v_pk_mul_f32 v[244:245], v[244:245], v[2:3] op_sel:[0,0] op_sel_hi:[1,0]
v_pk_mul_f32 v[246:247], v[246:247], v[2:3] op_sel:[0,0] op_sel_hi:[1,0]
v_cvt_pk_bf16_f32 v252, v240, v241
v_cvt_pk_bf16_f32 v253, v242, v243
v_cvt_pk_bf16_f32 v254, v244, v245
v_cvt_pk_bf16_f32 v255, v246, v247
buffer_store_dwordx4 v[252:255], v15, s[60:63], s73 offen offset:1024 sc1
v_accvgpr_read_b32 v240, a16
v_accvgpr_read_b32 v241, a17
v_accvgpr_read_b32 v242, a18
v_accvgpr_read_b32 v243, a19
v_accvgpr_read_b32 v244, a20
v_accvgpr_read_b32 v245, a21
v_accvgpr_read_b32 v246, a22
v_accvgpr_read_b32 v247, a23
v_pk_mul_f32 v[240:241], v[240:241], v[2:3] op_sel:[0,0] op_sel_hi:[1,0]
v_pk_mul_f32 v[242:243], v[242:243], v[2:3] op_sel:[0,0] op_sel_hi:[1,0]
v_pk_mul_f32 v[244:245], v[244:245], v[2:3] op_sel:[0,0] op_sel_hi:[1,0]
v_pk_mul_f32 v[246:247], v[246:247], v[2:3] op_sel:[0,0] op_sel_hi:[1,0]
v_cvt_pk_bf16_f32 v248, v240, v241
v_cvt_pk_bf16_f32 v249, v242, v243
v_cvt_pk_bf16_f32 v250, v244, v245
v_cvt_pk_bf16_f32 v251, v246, v247
buffer_store_dwordx4 v[248:251], v15, s[60:63], s73 offen offset:2048 sc1
v_accvgpr_read_b32 v240, a24
v_accvgpr_read_b32 v241, a25
v_accvgpr_read_b32 v242, a26
v_accvgpr_read_b32 v243, a27
v_accvgpr_read_b32 v244, a28
v_accvgpr_read_b32 v245, a29
v_accvgpr_read_b32 v246, a30
v_accvgpr_read_b32 v247, a31
v_pk_mul_f32 v[240:241], v[240:241], v[2:3] op_sel:[0,0] op_sel_hi:[1,0]
v_pk_mul_f32 v[242:243], v[242:243], v[2:3] op_sel:[0,0] op_sel_hi:[1,0]
v_pk_mul_f32 v[244:245], v[244:245], v[2:3] op_sel:[0,0] op_sel_hi:[1,0]
v_pk_mul_f32 v[246:247], v[246:247], v[2:3] op_sel:[0,0] op_sel_hi:[1,0]
v_cvt_pk_bf16_f32 v252, v240, v241
v_cvt_pk_bf16_f32 v253, v242, v243
v_cvt_pk_bf16_f32 v254, v244, v245
v_cvt_pk_bf16_f32 v255, v246, v247
buffer_store_dwordx4 v[252:255], v15, s[60:63], s73 offen offset:3072 sc1
v_accvgpr_read_b32 v240, a32
v_accvgpr_read_b32 v241, a33
v_accvgpr_read_b32 v242, a34
v_accvgpr_read_b32 v243, a35
v_accvgpr_read_b32 v244, a36
v_accvgpr_read_b32 v245, a37
v_accvgpr_read_b32 v246, a38
v_accvgpr_read_b32 v247, a39
v_pk_mul_f32 v[240:241], v[240:241], v[2:3] op_sel:[0,1] op_sel_hi:[1,1]
v_pk_mul_f32 v[242:243], v[242:243], v[2:3] op_sel:[0,1] op_sel_hi:[1,1]
v_pk_mul_f32 v[244:245], v[244:245], v[2:3] op_sel:[0,1] op_sel_hi:[1,1]
v_pk_mul_f32 v[246:247], v[246:247], v[2:3] op_sel:[0,1] op_sel_hi:[1,1]
v_cvt_pk_bf16_f32 v248, v240, v241
v_cvt_pk_bf16_f32 v249, v242, v243
v_cvt_pk_bf16_f32 v250, v244, v245
v_cvt_pk_bf16_f32 v251, v246, v247
buffer_store_dwordx4 v[248:251], v15, s[60:63], s80 offen offset:0 sc1
v_accvgpr_read_b32 v240, a40
v_accvgpr_read_b32 v241, a41
v_accvgpr_read_b32 v242, a42
v_accvgpr_read_b32 v243, a43
v_accvgpr_read_b32 v244, a44
v_accvgpr_read_b32 v245, a45
v_accvgpr_read_b32 v246, a46
v_accvgpr_read_b32 v247, a47
v_pk_mul_f32 v[240:241], v[240:241], v[2:3] op_sel:[0,1] op_sel_hi:[1,1]
v_pk_mul_f32 v[242:243], v[242:243], v[2:3] op_sel:[0,1] op_sel_hi:[1,1]
v_pk_mul_f32 v[244:245], v[244:245], v[2:3] op_sel:[0,1] op_sel_hi:[1,1]
v_pk_mul_f32 v[246:247], v[246:247], v[2:3] op_sel:[0,1] op_sel_hi:[1,1]
v_cvt_pk_bf16_f32 v252, v240, v241
v_cvt_pk_bf16_f32 v253, v242, v243
v_cvt_pk_bf16_f32 v254, v244, v245
v_cvt_pk_bf16_f32 v255, v246, v247
buffer_store_dwordx4 v[252:255], v15, s[60:63], s80 offen offset:1024 sc1
v_accvgpr_read_b32 v240, a48
v_accvgpr_read_b32 v241, a49
v_accvgpr_read_b32 v242, a50
v_accvgpr_read_b32 v243, a51
v_accvgpr_read_b32 v244, a52
v_accvgpr_read_b32 v245, a53
v_accvgpr_read_b32 v246, a54
v_accvgpr_read_b32 v247, a55
v_pk_mul_f32 v[240:241], v[240:241], v[2:3] op_sel:[0,1] op_sel_hi:[1,1]
v_pk_mul_f32 v[242:243], v[242:243], v[2:3] op_sel:[0,1] op_sel_hi:[1,1]
v_pk_mul_f32 v[244:245], v[244:245], v[2:3] op_sel:[0,1] op_sel_hi:[1,1]
v_pk_mul_f32 v[246:247], v[246:247], v[2:3] op_sel:[0,1] op_sel_hi:[1,1]
v_cvt_pk_bf16_f32 v248, v240, v241
v_cvt_pk_bf16_f32 v249, v242, v243
v_cvt_pk_bf16_f32 v250, v244, v245
v_cvt_pk_bf16_f32 v251, v246, v247
buffer_store_dwordx4 v[248:251], v15, s[60:63], s80 offen offset:2048 sc1
v_accvgpr_read_b32 v240, a56
v_accvgpr_read_b32 v241, a57
v_accvgpr_read_b32 v242, a58
v_accvgpr_read_b32 v243, a59
v_accvgpr_read_b32 v244, a60
v_accvgpr_read_b32 v245, a61
v_accvgpr_read_b32 v246, a62
v_accvgpr_read_b32 v247, a63
v_pk_mul_f32 v[240:241], v[240:241], v[2:3] op_sel:[0,1] op_sel_hi:[1,1]
v_pk_mul_f32 v[242:243], v[242:243], v[2:3] op_sel:[0,1] op_sel_hi:[1,1]
v_pk_mul_f32 v[244:245], v[244:245], v[2:3] op_sel:[0,1] op_sel_hi:[1,1]
v_pk_mul_f32 v[246:247], v[246:247], v[2:3] op_sel:[0,1] op_sel_hi:[1,1]
v_cvt_pk_bf16_f32 v252, v240, v241
v_cvt_pk_bf16_f32 v253, v242, v243
v_cvt_pk_bf16_f32 v254, v244, v245
v_cvt_pk_bf16_f32 v255, v246, v247
buffer_store_dwordx4 v[252:255], v15, s[60:63], s80 offen offset:3072 sc1
s_cmp_lg_u32 s81, 0
s_cbranch_scc1 L_fb_done
s_mov_b32 s81, 1
s_sub_u32 s74, 34, s77
s_mov_b32 s73, s101
s_mov_b32 s72, s70
v_mov_b32 v16, v48
v_mov_b32 v17, v49
v_mov_b32 v18, v50
v_mov_b32 v19, v51
v_mov_b32 v20, v52
v_mov_b32 v21, v53
v_mov_b32 v22, v54
v_mov_b32 v23, v55
v_mov_b32 v24, v56
v_mov_b32 v25, v57
v_mov_b32 v26, v58
v_mov_b32 v27, v59
v_mov_b32 v28, v60
v_mov_b32 v29, v61
v_mov_b32 v30, v62
v_mov_b32 v31, v63
v_mov_b32 v32, v64
v_mov_b32 v33, v65
v_mov_b32 v34, v66
v_mov_b32 v35, v67
v_mov_b32 v36, v68
v_mov_b32 v37, v69
v_mov_b32 v38, v70
v_mov_b32 v39, v71
v_mov_b32 v40, v72
v_mov_b32 v41, v73
v_mov_b32 v42, v74
v_mov_b32 v43, v75
v_mov_b32 v44, v76
v_mov_b32 v45, v77
v_mov_b32 v46, v78
v_mov_b32 v47, v79
s_branch L_fb_set
L_fb_done:
s_waitcnt vmcnt(0) lgkmcnt(0)
s_barrier
s_load_dwordx2 s[88:89], s[0:1], 104
s_mul_i32 s36, s3, 8320
v_and_b32 v16, 15, v1
v_lshrrev_b32 v17, 4, v1
v_add_u32 v18, 1, v16
v_and_b32 v19, 1, v18
v_mul_u32_u24 v19, 4160, v19
v_add_u32 v18, 2, v16
v_lshrrev_b32 v18, 1, v18
v_lshl_add_u32 v19, v18, 2, v19
v_lshl_add_u32 v19, v17, 4, v19
v_add_u32 v40, s36, v19
v_add_u32 v41, 1024, v40
v_add_u32 v42, 2048, v40
v_add_u32 v43, 3072, v40
v_add_u32 v10, s36, v232
v_lshlrev_b32 v18, 5, v16
v_lshlrev_b32 v19, 4, v17
v_sub_u32 v19, v19, v18
s_add_u32 s37, s43, 480
v_add_u32 v5, s37, v19
v_mov_b32 v20, 0
v_mov_b32 v21, 0
v_mov_b32 v22, 0
v_mov_b32 v23, 0
v_and_b32 v16, 1, v1
v_mul_u32_u24 v16, 4160, v16
v_and_b32 v17, 2, v1
v_lshl_add_u32 v16, v17, 3, v16
v_add_u32 v16, s36, v16
ds_write_b128 v16, v[20:23]
v_and_b32 v17, 31, v1
v_lshlrev_b32 v17, 4, v17
v_add_u32 v17, s43, v17
ds_write_b128 v17, v[20:23] offset:4096
v_mov_b32 v209, 0
ds_write_b128 v10, v[210:213] offset:32
s_nop 0
v_mov_b32_dpp v209, v213 wave_shr:1 row_mask:0xf bank_mask:0xf
v_alignbit_b32 v24, v210, v209, 16
v_alignbit_b32 v25, v211, v210, 16
v_alignbit_b32 v26, v212, v211, 16
v_alignbit_b32 v27, v213, v212, 16
ds_write_b128 v10, v[24:27] offset:4192
v_mov_b32_dpp v215, v213 wave_ror:1 row_mask:0xf bank_mask:0xf
ds_write_b128 v10, v[216:219] offset:1056
s_nop 0
v_mov_b32_dpp v215, v219 wave_shr:1 row_mask:0xf bank_mask:0xf
v_alignbit_b32 v28, v216, v215, 16
v_alignbit_b32 v29, v217, v216, 16
v_alignbit_b32 v30, v218, v217, 16
v_alignbit_b32 v31, v219, v218, 16
ds_write_b128 v10, v[28:31] offset:5216
v_mov_b32_dpp v221, v219 wave_ror:1 row_mask:0xf bank_mask:0xf
ds_write_b128 v10, v[222:225] offset:2080
s_nop 0
v_mov_b32_dpp v221, v225 wave_shr:1 row_mask:0xf bank_mask:0xf
v_alignbit_b32 v24, v222, v221, 16
v_alignbit_b32 v25, v223, v222, 16
v_alignbit_b32 v26, v224, v223, 16
v_alignbit_b32 v27, v225, v224, 16
ds_write_b128 v10, v[24:27] offset:6240
v_mov_b32_dpp v227, v225 wave_ror:1 row_mask:0xf bank_mask:0xf
ds_write_b128 v10, v[228:231] offset:3104
s_nop 0
v_mov_b32_dpp v227, v231 wave_shr:1 row_mask:0xf bank_mask:0xf
v_alignbit_b32 v28, v228, v227, 16
v_alignbit_b32 v29, v229, v228, 16
v_alignbit_b32 v30, v230, v229, 16
v_alignbit_b32 v31, v231, v230, 16
ds_write_b128 v10, v[28:31] offset:7264
ds_read_b128 a[160:163], v5 offset:3584
ds_read2_b32 a[128:129], v40 offset0:0 offset1:1
ds_read2_b32 a[130:131], v40 offset0:2 offset1:3
ds_read_b128 a[164:167], v5 offset:3072
ds_read2_b32 a[132:133], v40 offset0:128 offset1:129
ds_read2_b32 a[134:135], v40 offset0:130 offset1:131
ds_read_b128 a[168:171], v5 offset:2560
ds_read2_b32 a[136:137], v41 offset0:0 offset1:1
ds_read2_b32 a[138:139], v41 offset0:2 offset1:3
ds_read_b128 a[172:175], v5 offset:2048
ds_read2_b32 a[140:141], v41 offset0:128 offset1:129
ds_read2_b32 a[142:143], v41 offset0:130 offset1:131
ds_read_b128 a[176:179], v5 offset:1536
ds_read2_b32 a[144:145], v42 offset0:0 offset1:1
ds_read2_b32 a[146:147], v42 offset0:2 offset1:3
ds_read_b128 a[180:183], v5 offset:1024
ds_read2_b32 a[148:149], v42 offset0:128 offset1:129
ds_read2_b32 a[150:151], v42 offset0:130 offset1:131
ds_read_b128 a[184:187], v5 offset:512
ds_read2_b32 a[152:153], v43 offset0:0 offset1:1
ds_read2_b32 a[154:155], v43 offset0:2 offset1:3
ds_read_b128 a[188:191], v5 offset:0
ds_read2_b32 a[156:157], v43 offset0:128 offset1:129
ds_read2_b32 a[158:159], v43 offset0:130 offset1:131
s_waitcnt lgkmcnt(0)
s_branch L_p3_done
L_spin_go:
s_mov_b32 s36, 400000
L_spin_go_l:
s_sleep 1
buffer_load_dword v254, off, s[12:15], 0 sc1
s_waitcnt vmcnt(0)
v_cmp_gt_u32 vcc, 1, v254
s_nop 4
s_cbranch_vccz L_spin_go_ret
s_sub_u32 s36, s36, 1
s_cmp_lg_u32 s36, 0
s_cbranch_scc1 L_spin_go_l
s_branch L_spin_go_ret
L_spin_f1:
s_mov_b32 s36, 400000
L_spin_f1_l:
s_sleep 1
buffer_load_dword v237, v233, s[8:11], 0 offen offset:0 sc1
s_waitcnt vmcnt(0)
v_cmp_gt_u32 vcc, 1, v237
s_nop 4
s_cbranch_vccz L_spin_f1_ret
s_sub_u32 s36, s36, 1
s_cmp_lg_u32 s36, 0
s_cbranch_scc1 L_spin_f1_l
s_branch L_spin_f1_ret
L_spin_w:
s_mov_b32 s36, 400000
L_spin_w_l:
s_sleep 1
buffer_load_dword v253, v254, s[8:11], 0 offen offset:1024 sc1
s_waitcnt vmcnt(0)
v_cmp_gt_u32 vcc, 1, v253
s_nop 4
s_cbranch_vccz L_spin_w_ret
s_sub_u32 s36, s36, 1
s_cmp_lg_u32 s36, 0
s_cbranch_scc1 L_spin_w_l
s_branch L_spin_w_ret
L_spin_f2:
s_mov_b32 s36, 400000
L_spin_f2_l:
s_sleep 1
buffer_load_dword v253, v252, s[8:11], 0 offen sc1
s_waitcnt vmcnt(0)
v_cmp_gt_u32 vcc, 1, v253
s_nop 4
s_cbranch_vccz L_spin_f2_ret
s_sub_u32 s36, s36, 1
s_cmp_lg_u32 s36, 0
s_cbranch_scc1 L_spin_f2_l
s_branch L_spin_f2_ret
L_p5_x1:
v_mov_b32 v253, 1
s_lshl_b32 s36, s2, 2
buffer_store_dword v253, v255, s[8:11], s36 offen offset:2048 sc1
v_and_b32 v254, 15, v1
s_lshl_b32 s36, s82, 4
v_add_u32 v254, s36, v254
v_lshlrev_b32 v254, 2, v254
s_branch L_p5_loop
L_p5_x2:
buffer_load_dword v253, v254, s[8:11], 0 offen offset:2048 sc1
s_branch L_p5_loop
L_spin_f3:
s_mov_b32 s36, 400000
L_spin_f3_l:
s_sleep 1
buffer_load_dword v253, v254, s[8:11], 0 offen offset:2048 sc1
s_waitcnt vmcnt(0)
v_cmp_gt_u32 vcc, 1, v253
s_nop 4
s_cbranch_vccz L_spin_f3_ret
s_sub_u32 s36, s36, 1
s_cmp_lg_u32 s36, 0
s_cbranch_scc1 L_spin_f3_l
s_branch L_spin_f3_ret
L_code_end:
s_endpgm
.section .rodata,"a"
.p2align 6
.amdhsa_kernel gated_mix__ssm_conv_h3__compressed_kv_cla__prompt_kernel
  .amdhsa_next_free_vgpr 512
  .amdhsa_next_free_sgpr 102
  .amdhsa_accum_offset 256
  .amdhsa_group_segment_fixed_size 0
  .amdhsa_kernarg_size 128
  .amdhsa_user_sgpr_count 2
  .amdhsa_user_sgpr_kernarg_segment_ptr 1
  .amdhsa_system_sgpr_workgroup_id_x 1
  .amdhsa_float_denorm_mode_32 3
.end_amdhsa_kernel
.text
```

```asm
; @launch grid=(256,1,1) block=(256,1,1) lds=163840
.amdgcn_target "amdgcn-amd-amdhsa--gfx950"
.text
.macro MA d,x,a,y,b
v_mfma_f32_16x16x32_bf16 a[\d:\d+3], \x[\a:\a+3], \y[\b:\b+3], a[\d:\d+3]
.endm
.macro MV d,x,a,y,b
v_mfma_f32_16x16x32_bf16 v[\d:\d+3], \x[\a:\a+3], \y[\b:\b+3], v[\d:\d+3]
.endm
.macro TR d,a,o
ds_read_b64_tr_b16 v[\d:\d+1], v\a offset:\o
.endm
.globl gated_mix__ssm_conv_h3__compressed_kv_cla__prompt_kernel
.p2align 8
.type gated_mix__ssm_conv_h3__compressed_kv_cla__prompt_kernel,@function
gated_mix__ssm_conv_h3__compressed_kv_cla__prompt_kernel:
s_cmp_ge_u32 s2, 256
s_cbranch_scc1 L_end
s_load_dwordx2 s[44:45], s[0:1], 56
s_load_dwordx4 s[48:51], s[0:1], 72
s_load_dwordx2 s[40:41], s[0:1], 120
s_load_dwordx2 s[52:53], s[0:1], 112
s_load_dwordx2 s[32:33], s[0:1], 0
s_load_dwordx2 s[34:35], s[0:1], 64
s_load_dwordx2 s[84:85], s[0:1], 8
s_load_dwordx2 s[88:89], s[0:1], 16
s_load_dwordx2 s[92:93], s[0:1], 0
s_load_dwordx2 s[96:97], s[0:1], 24
s_load_dwordx2 s[76:77], s[0:1], 96
v_lshrrev_b32 v2, 6, v0
v_and_b32 v1, 63, v0
v_lshlrev_b32 v3, 4, v0
v_readfirstlane_b32 s3, v2
s_getpc_b64 s[4:5]
L_ct_e:
s_add_u32 s4, s4, L_p1_K - L_ct_e
s_addc_u32 s5, s5, 0
v_mov_b32 v77, s5
v_mov_b32 v76, s4
s_lshr_b32 s4, s2, 3
s_lshl_b32 s4, s4, 2
s_add_u32 s4, s4, s3
s_lshl_b32 s4, s4, 7
v_and_b32 v79, 3, v1
v_lshlrev_b32 v79, 14, v79
v_add_u32 v79, s4, v79
v_min_u32 v79, L_p3_begin - L_p1_K - 4, v79
v_add_co_u32 v76, vcc, v76, v79
s_nop 1
v_addc_co_u32 v77, vcc, 0, v77, vcc
global_load_dword v79, v[76:77], off
s_and_b32 s36, s2, 7
s_lshr_b32 s37, s2, 3
s_and_b32 s38, s37, 7
s_lshr_b32 s37, s37, 3
s_lshr_b32 s42, s37, 1
s_and_b32 s37, s37, 1
s_lshl_b32 s36, s36, 1
s_add_u32 s36, s36, s37
s_lshl_b32 s24, s38, 18
s_lshl_b32 s39, s3, 16
s_add_u32 s24, s24, s39
s_lshl_b32 s25, s3, 17
s_lshl_b32 s39, s36, 9
s_add_u32 s25, s25, s39
s_and_b32 s20, s2, 7
s_lshl_b32 s21, s20, 19
s_lshl_b32 s20, s20, 7
s_lshl_b32 s22, s3, 13
s_add_u32 s23, s22, 98304
v_lshrrev_b32 v204, 3, v1
v_lshlrev_b32 v204, 10, v204
v_lshrrev_b32 v205, 4, v1
v_and_b32 v206, 7, v1
v_xor_b32 v206, v206, v205
v_lshl_add_u32 v204, v206, 4, v204
v_xor_b32 v207, 64, v204
v_add_u32 v176, 0, v204
v_add_u32 v177, 7168, v207
v_add_u32 v178, 14336, v204
v_add_u32 v179, 21504, v207
v_add_u32 v180, 32768, v204
v_add_u32 v181, 39936, v207
v_add_u32 v182, 47104, v204
v_add_u32 v183, 54272, v207
v_lshrrev_b32 v204, 5, v1
v_and_b32 v206, 31, v1
v_lshlrev_b32 v207, 1, v204
v_xor_b32 v206, v206, v207
v_lshlrev_b32 v204, 13, v204
v_xor_b32 v207, 0, v206
v_lshl_add_u32 v207, v207, 4, v204
v_add_u32 v184, 0, v207
v_xor_b32 v207, 4, v206
v_lshl_add_u32 v207, v207, 4, v204
v_add_u32 v185, 15360, v207
v_xor_b32 v207, 0, v206
v_lshl_add_u32 v207, v207, 4, v204
v_add_u32 v186, 30720, v207
v_xor_b32 v207, 4, v206
v_lshl_add_u32 v207, v207, 4, v204
v_add_u32 v187, 46080, v207
v_xor_b32 v207, 8, v206
v_lshl_add_u32 v207, v207, 4, v204
v_add_u32 v188, 65536, v207
v_xor_b32 v207, 12, v206
v_lshl_add_u32 v207, v207, 4, v204
v_add_u32 v189, 80896, v207
v_xor_b32 v207, 8, v206
v_lshl_add_u32 v207, v207, 4, v204
v_add_u32 v190, 96256, v207
v_xor_b32 v207, 12, v206
v_lshl_add_u32 v207, v207, 4, v204
v_add_u32 v191, 111616, v207
s_waitcnt lgkmcnt(0)
s_add_u32 s8, s44, s24
s_addc_u32 s9, s45, 0
s_mov_b32 s10, 65536
s_mov_b32 s11, 0x20000
s_cmp_eq_u32 s42, 0
s_cselect_b32 s12, s48, s50
s_cselect_b32 s13, s49, s51
s_add_u32 s12, s12, s25
s_addc_u32 s13, s13, 0
s_sub_u32 s14, 4194304, s25
s_mov_b32 s15, 0x20000
s_add_u32 s4, s40, 59768832
s_addc_u32 s5, s41, 0
s_mov_b32 s6, 8192
s_mov_b32 s7, 0x20000
s_lshl_b32 s43, s2, 20
v_add_u32 v3, s43, v3
v_mov_b32 v4, 0
v_mov_b32 v5, 0
v_mov_b32 v6, 0
v_mov_b32 v7, 0
s_movk_i32 s43, 4096
buffer_store_dwordx4 v[4:7], v3, s[4:7], 0 offen sc1
buffer_store_dwordx4 v[4:7], v3, s[4:7], s43 offen sc1
s_waitcnt vmcnt(2)
v_lshlrev_b32 v79, 16, v3
s_add_u32 m0, s23, 0
s_nop 0
buffer_load_dwordx4 v184, s[12:15], s21 offen offset:0 lds
buffer_load_dwordx4 v185, s[12:15], s21 offen offset:1024 lds
buffer_load_dwordx4 v186, s[12:15], s21 offen offset:2048 lds
buffer_load_dwordx4 v187, s[12:15], s21 offen offset:3072 lds
s_add_u32 m0, s23, 4096
s_nop 0
buffer_load_dwordx4 v188, s[12:15], s21 offen offset:0 lds
buffer_load_dwordx4 v189, s[12:15], s21 offen offset:1024 lds
buffer_load_dwordx4 v190, s[12:15], s21 offen offset:2048 lds
buffer_load_dwordx4 v191, s[12:15], s21 offen offset:3072 lds
s_add_u32 s21, s21, 524288
s_and_b32 s21, s21, 4194303
s_add_u32 m0, s22, 0
s_nop 0
buffer_load_dwordx4 v176, s[8:11], s20 offen offset:0 lds
buffer_load_dwordx4 v177, s[8:11], s20 offen offset:1024 lds
buffer_load_dwordx4 v178, s[8:11], s20 offen offset:2048 lds
buffer_load_dwordx4 v179, s[8:11], s20 offen offset:3072 lds
s_add_u32 m0, s22, 4096
s_nop 0
buffer_load_dwordx4 v180, s[8:11], s20 offen offset:0 lds
buffer_load_dwordx4 v181, s[8:11], s20 offen offset:1024 lds
buffer_load_dwordx4 v182, s[8:11], s20 offen offset:2048 lds
buffer_load_dwordx4 v183, s[8:11], s20 offen offset:3072 lds
s_add_u32 s20, s20, 128
s_and_b32 s20, s20, 1023
v_and_b32 v204, 15, v1
v_lshrrev_b32 v206, 1, v204
v_xor_b32 v206, v206, v205
v_lshlrev_b32 v206, 4, v206
v_lshl_add_u32 v206, v204, 7, v206
s_and_b32 s39, s3, 1
s_lshl_b32 s39, s39, 14
v_add_u32 v192, s39, v206
v_xor_b32 v193, 64, v192
v_add_u32 v194, 0x10000, v192
v_add_u32 v195, 0x10000, v193
v_bfe_u32 v204, v1, 2, 2
v_and_b32 v206, 1, v205
v_lshl_or_b32 v206, v206, 2, v204
v_lshl_add_u32 v204, v205, 3, v204
v_lshlrev_b32 v204, 9, v204
v_and_b32 v207, 3, v1
v_lshl_add_u32 v204, v207, 3, v204
s_lshr_b32 s39, s3, 1
s_lshl_b32 s39, s39, 8
s_add_u32 s39, s39, 98304
v_add_u32 v204, s39, v204
v_xor_b32 v207, 0, v206
v_lshl_add_u32 v196, v207, 5, v204
v_xor_b32 v207, 1, v206
v_lshl_add_u32 v197, v207, 5, v204
v_xor_b32 v207, 2, v206
v_lshl_add_u32 v198, v207, 5, v204
v_xor_b32 v207, 3, v206
v_lshl_add_u32 v199, v207, 5, v204
v_xor_b32 v207, 4, v206
v_lshl_add_u32 v200, v207, 5, v204
v_xor_b32 v207, 5, v206
v_lshl_add_u32 v201, v207, 5, v204
v_xor_b32 v207, 6, v206
v_lshl_add_u32 v202, v207, 5, v204
v_xor_b32 v207, 7, v206
v_lshl_add_u32 v203, v207, 5, v204
s_lshl_b32 s36, s36, 1
s_lshr_b32 s39, s3, 1
s_add_u32 s36, s36, s39
s_lshl_b32 s24, s36, 19
s_lshl_b32 s38, s38, 16
s_add_u32 s24, s24, s38
s_and_b32 s39, s3, 1
s_lshl_b32 s39, s39, 15
s_add_u32 s24, s24, s39
s_lshl_b32 s36, s42, 24
s_add_u32 s16, s40, s36
s_addc_u32 s17, s41, 0
s_mov_b32 s18, 16777216
s_mov_b32 s19, 0x20000
s_add_u32 m0, s23, 32768
s_nop 0
buffer_load_dwordx4 v184, s[12:15], s21 offen offset:0 lds
buffer_load_dwordx4 v185, s[12:15], s21 offen offset:1024 lds
buffer_load_dwordx4 v186, s[12:15], s21 offen offset:2048 lds
buffer_load_dwordx4 v187, s[12:15], s21 offen offset:3072 lds
s_add_u32 m0, s23, 36864
s_nop 0
buffer_load_dwordx4 v188, s[12:15], s21 offen offset:0 lds
buffer_load_dwordx4 v189, s[12:15], s21 offen offset:1024 lds
buffer_load_dwordx4 v190, s[12:15], s21 offen offset:2048 lds
buffer_load_dwordx4 v191, s[12:15], s21 offen offset:3072 lds
s_add_u32 s21, s21, 524288
s_and_b32 s21, s21, 4194303
s_mov_b32 s54, 256
s_mov_b32 s55, 0x20000
v_mov_b32 v78, 1
s_cmp_lg_u32 s2, 0
s_cselect_b32 s43, 0x10000000, 0
v_or_b32 v79, s43, v79
s_waitcnt vmcnt(8)
s_barrier
buffer_store_dword v78, v79, s[52:55], 0 offen sc1
ds_read_b128 v[80:83], v192 offset:0
ds_read_b128 v[84:87], v192 offset:2048
ds_read_b128 v[88:91], v192 offset:4096
ds_read_b128 v[92:95], v192 offset:6144
ds_read_b128 v[96:99], v192 offset:8192
ds_read_b128 v[100:103], v192 offset:10240
ds_read_b128 v[104:107], v192 offset:12288
ds_read_b128 v[108:111], v192 offset:14336
TR 144,196,0
TR 146,196,2048
TR 148,197,0
TR 150,197,2048
TR 152,198,0
TR 154,198,2048
TR 156,199,0
TR 158,199,2048
TR 160,200,0
TR 162,200,2048
TR 164,201,0
TR 166,201,2048
TR 168,202,0
TR 170,202,2048
TR 172,203,0
TR 174,203,2048
s_cmp_eq_u32 s42, 0
s_cbranch_scc0 L_p1_V
L_p1_K:
s_waitcnt lgkmcnt(14)
v_mfma_f32_16x16x32_bf16 a[0:3], v[144:147], v[80:83], 0
s_add_u32 m0, s22, 32768
s_mov_b32 s86, 4194304
s_waitcnt lgkmcnt(12)
v_mfma_f32_16x16x32_bf16 a[4:7], v[148:151], v[80:83], 0
ds_read_b128 v[112:115], v193 offset:0
s_mov_b32 s87, 0x20000
v_mfma_f32_16x16x32_bf16 a[32:35], v[144:147], v[84:87], 0
v_mfma_f32_16x16x32_bf16 a[36:39], v[148:151], v[84:87], 0
s_mov_b32 s90, 4194304
v_mfma_f32_16x16x32_bf16 a[64:67], v[144:147], v[88:91], 0
s_mov_b32 s91, 0x20000
v_mfma_f32_16x16x32_bf16 a[68:71], v[148:151], v[88:91], 0
buffer_load_dwordx4 v176, s[8:11], s20 offen offset:0 lds
v_mfma_f32_16x16x32_bf16 a[96:99], v[144:147], v[92:95], 0
s_mov_b32 s94, 4194304
v_mfma_f32_16x16x32_bf16 a[100:103], v[148:151], v[92:95], 0
ds_read_b128 v[116:119], v193 offset:2048
s_mov_b32 s95, 0x20000
v_mfma_f32_16x16x32_bf16 a[128:131], v[144:147], v[96:99], 0
v_mfma_f32_16x16x32_bf16 a[132:135], v[148:151], v[96:99], 0
s_mov_b32 s98, 8192
v_mfma_f32_16x16x32_bf16 a[160:163], v[144:147], v[100:103], 0
buffer_load_dwordx4 v177, s[8:11], s20 offen offset:1024 lds
s_mov_b32 s99, 0x20000
v_mfma_f32_16x16x32_bf16 a[164:167], v[148:151], v[100:103], 0
v_mfma_f32_16x16x32_bf16 a[192:195], v[144:147], v[104:107], 0
s_mov_b32 s78, 2048
v_mfma_f32_16x16x32_bf16 a[196:199], v[148:151], v[104:107], 0
ds_read_b128 v[120:123], v193 offset:4096
s_mov_b32 s79, 0x20000
v_mfma_f32_16x16x32_bf16 a[224:227], v[144:147], v[108:111], 0
TR 144,196,16384
TR 146,196,18432
v_mfma_f32_16x16x32_bf16 a[228:231], v[148:151], v[108:111], 0
TR 148,197,16384
TR 150,197,18432
s_waitcnt lgkmcnt(15)
v_mfma_f32_16x16x32_bf16 a[232:235], v[152:155], v[108:111], 0
buffer_load_dwordx4 v178, s[8:11], s20 offen offset:2048 lds
s_and_b32 s36, s2, 15
v_mfma_f32_16x16x32_bf16 a[236:239], v[156:159], v[108:111], 0
s_lshl_b32 s36, s36, 1
v_mfma_f32_16x16x32_bf16 a[200:203], v[152:155], v[104:107], 0
s_lshr_b32 s37, s3, 1
v_mfma_f32_16x16x32_bf16 a[204:207], v[156:159], v[104:107], 0
s_add_u32 s36, s36, s37
v_mfma_f32_16x16x32_bf16 a[168:171], v[152:155], v[100:103], 0
ds_read_b128 v[124:127], v193 offset:6144
buffer_load_dwordx4 v179, s[8:11], s20 offen offset:3072 lds
v_mfma_f32_16x16x32_bf16 a[172:175], v[156:159], v[100:103], 0
s_lshl_b32 s36, s36, 3
v_mfma_f32_16x16x32_bf16 a[136:139], v[152:155], v[96:99], 0
v_and_b32 v252, 7, v1
v_mfma_f32_16x16x32_bf16 a[140:143], v[156:159], v[96:99], 0
v_mfma_f32_16x16x32_bf16 a[104:107], v[152:155], v[92:95], 0
v_add_u32 v252, s36, v252
v_mfma_f32_16x16x32_bf16 a[108:111], v[156:159], v[92:95], 0
s_add_u32 m0, s22, 36864
s_lshr_b32 s36, s2, 4
v_mfma_f32_16x16x32_bf16 a[72:75], v[152:155], v[88:91], 0
ds_read_b128 v[128:131], v193 offset:8192
v_mfma_f32_16x16x32_bf16 a[76:79], v[156:159], v[88:91], 0
s_lshl_b32 s36, s36, 1
v_mfma_f32_16x16x32_bf16 a[40:43], v[152:155], v[84:87], 0
s_and_b32 s37, s3, 1
v_mfma_f32_16x16x32_bf16 a[44:47], v[156:159], v[84:87], 0
v_mfma_f32_16x16x32_bf16 a[8:11], v[152:155], v[80:83], 0
TR 152,198,16384
TR 154,198,18432
v_mfma_f32_16x16x32_bf16 a[12:15], v[156:159], v[80:83], 0
TR 156,199,16384
TR 158,199,18432
s_waitcnt lgkmcnt(15)
v_mfma_f32_16x16x32_bf16 a[16:19], v[160:163], v[80:83], 0
ds_read_b128 v[132:135], v193 offset:10240
buffer_load_dwordx4 v180, s[8:11], s20 offen offset:0 lds
v_mfma_f32_16x16x32_bf16 a[20:23], v[164:167], v[80:83], 0
s_add_u32 s36, s36, s37
s_lshl_b32 s36, s36, 3
v_mfma_f32_16x16x32_bf16 a[48:51], v[160:163], v[84:87], 0
v_lshrrev_b32 v253, 3, v1
v_add_u32 v253, s36, v253
v_mfma_f32_16x16x32_bf16 a[52:55], v[164:167], v[84:87], 0
v_mfma_f32_16x16x32_bf16 a[80:83], v[160:163], v[88:91], 0
buffer_load_dwordx4 v181, s[8:11], s20 offen offset:1024 lds
v_lshlrev_b32 v254, 14, v253
v_mfma_f32_16x16x32_bf16 a[84:87], v[164:167], v[88:91], 0
v_lshl_add_u32 v254, v252, 3, v254
v_mfma_f32_16x16x32_bf16 a[112:115], v[160:163], v[92:95], 0
v_mfma_f32_16x16x32_bf16 a[116:119], v[164:167], v[92:95], 0
ds_read_b128 v[136:139], v193 offset:12288
v_add_u32 v229, -6144, v254
v_mfma_f32_16x16x32_bf16 a[144:147], v[160:163], v[96:99], 0
v_lshlrev_b32 v62, 5, v252
v_mfma_f32_16x16x32_bf16 a[148:151], v[164:167], v[96:99], 0
buffer_load_dwordx4 v182, s[8:11], s20 offen offset:2048 lds
v_mfma_f32_16x16x32_bf16 a[176:179], v[160:163], v[100:103], 0
v_lshlrev_b32 v254, 4, v253
v_mfma_f32_16x16x32_bf16 a[180:183], v[164:167], v[100:103], 0
v_sub_u32 v254, 4080, v254
v_mfma_f32_16x16x32_bf16 a[208:211], v[160:163], v[104:107], 0
v_mfma_f32_16x16x32_bf16 a[212:215], v[164:167], v[104:107], 0
ds_read_b128 v[140:143], v193 offset:14336
v_lshl_add_u32 v10, v252, 14, v254
v_mfma_f32_16x16x32_bf16 a[240:243], v[160:163], v[108:111], 0
TR 160,200,16384
TR 162,200,18432
v_mfma_f32_16x16x32_bf16 a[244:247], v[164:167], v[108:111], 0
TR 164,201,16384
TR 166,201,18432
v_mfma_f32_16x16x32_bf16 a[248:251], v[168:171], v[108:111], 0
buffer_load_dwordx4 v183, s[8:11], s20 offen offset:3072 lds
v_and_b32 v252, 31, v1
s_waitcnt lgkmcnt(15)
v_mfma_f32_16x16x32_bf16 a[252:255], v[172:175], v[108:111], 0
v_lshlrev_b32 v64, 4, v252
s_lshl_b32 s36, s2, 2
v_mfma_f32_16x16x32_bf16 a[216:219], v[168:171], v[104:107], 0
v_mfma_f32_16x16x32_bf16 a[220:223], v[172:175], v[104:107], 0
s_add_u32 s20, s20, 128
s_add_u32 s36, s36, s3
v_mfma_f32_16x16x32_bf16 a[184:187], v[168:171], v[100:103], 0
s_lshl_b32 s36, s36, 1
v_mfma_f32_16x16x32_bf16 a[188:191], v[172:175], v[100:103], 0
v_mfma_f32_16x16x32_bf16 a[152:155], v[168:171], v[96:99], 0
v_lshrrev_b32 v253, 5, v1
v_mfma_f32_16x16x32_bf16 a[156:159], v[172:175], v[96:99], 0
v_add_u32 v253, s36, v253
v_mfma_f32_16x16x32_bf16 a[120:123], v[168:171], v[92:95], 0
s_and_b32 s20, s20, 1023
v_mfma_f32_16x16x32_bf16 a[124:127], v[172:175], v[92:95], 0
v_lshl_add_u32 v63, v253, 11, v64
v_mfma_f32_16x16x32_bf16 a[88:91], v[168:171], v[88:91], 0
v_lshlrev_b32 v253, 2, v253
v_mfma_f32_16x16x32_bf16 a[92:95], v[172:175], v[88:91], 0
v_mfma_f32_16x16x32_bf16 a[56:59], v[168:171], v[84:87], 0
v_lshl_add_u32 v11, v252, 20, v253
v_mfma_f32_16x16x32_bf16 a[60:63], v[172:175], v[84:87], 0
v_mfma_f32_16x16x32_bf16 a[24:27], v[168:171], v[80:83], 0
TR 168,202,16384
TR 170,202,18432
v_mfma_f32_16x16x32_bf16 a[28:31], v[172:175], v[80:83], 0
TR 172,203,16384
TR 174,203,18432
s_waitcnt lgkmcnt(4)
MA 0,v,144,v,112
s_add_u32 m0, s22, 65536
MA 4,v,148,v,112
MA 32,v,144,v,116
buffer_load_dwordx4 v176, s[8:11], s20 offen offset:0 lds
MA 36,v,148,v,116
MA 64,v,144,v,120
buffer_load_dwordx4 v177, s[8:11], s20 offen offset:1024 lds
MA 68,v,148,v,120
MA 96,v,144,v,124
MA 100,v,148,v,124
buffer_load_dwordx4 v178, s[8:11], s20 offen offset:2048 lds
MA 128,v,144,v,128
MA 132,v,148,v,128
buffer_load_dwordx4 v179, s[8:11], s20 offen offset:3072 lds
MA 160,v,144,v,132
MA 164,v,148,v,132
MA 192,v,144,v,136
s_add_u32 m0, s22, 69632
MA 196,v,148,v,136
MA 224,v,144,v,140
buffer_load_dwordx4 v180, s[8:11], s20 offen offset:0 lds
MA 228,v,148,v,140
MA 232,v,152,v,140
buffer_load_dwordx4 v181, s[8:11], s20 offen offset:1024 lds
MA 236,v,156,v,140
MA 200,v,152,v,136
MA 204,v,156,v,136
buffer_load_dwordx4 v182, s[8:11], s20 offen offset:2048 lds
MA 168,v,152,v,132
MA 172,v,156,v,132
buffer_load_dwordx4 v183, s[8:11], s20 offen offset:3072 lds
MA 136,v,152,v,128
MA 140,v,156,v,128
MA 104,v,152,v,124
s_add_u32 s20, s20, 128
MA 108,v,156,v,124
MA 72,v,152,v,120
s_and_b32 s20, s20, 1023
MA 76,v,156,v,120
MA 40,v,152,v,116
MA 44,v,156,v,116
MA 8,v,152,v,112
s_waitcnt vmcnt(8) lgkmcnt(0)
s_barrier
MA 12,v,156,v,112
TR 144,196,32768
TR 146,196,34816
MA 16,v,160,v,112
ds_read_b128 v[80:83], v192 offset:32768
s_add_u32 m0, s23, 0
MA 20,v,164,v,112
TR 148,197,32768
TR 150,197,34816
MA 48,v,160,v,116
ds_read_b128 v[84:87], v192 offset:34816
buffer_load_dwordx4 v184, s[12:15], s21 offen offset:0 lds
MA 52,v,164,v,116
TR 152,198,32768
TR 154,198,34816
MA 80,v,160,v,120
buffer_load_dwordx4 v185, s[12:15], s21 offen offset:1024 lds
MA 84,v,164,v,120
TR 156,199,32768
TR 158,199,34816
MA 112,v,160,v,124
ds_read_b128 v[88:91], v192 offset:36864
buffer_load_dwordx4 v186, s[12:15], s21 offen offset:2048 lds
MA 116,v,164,v,124
ds_read_b128 v[92:95], v192 offset:38912
MA 144,v,160,v,128
MA 148,v,164,v,128
buffer_load_dwordx4 v187, s[12:15], s21 offen offset:3072 lds
MA 176,v,160,v,132
ds_read_b128 v[96:99], v192 offset:40960
MA 180,v,164,v,132
s_add_u32 m0, s23, 4096
MA 208,v,160,v,136
ds_read_b128 v[100:103], v192 offset:43008
MA 212,v,164,v,136
MA 240,v,160,v,140
TR 160,200,32768
TR 162,200,34816
MA 244,v,164,v,140
TR 164,201,32768
TR 166,201,34816
MA 248,v,168,v,140
ds_read_b128 v[104:107], v192 offset:45056
buffer_load_dwordx4 v188, s[12:15], s21 offen offset:0 lds
MA 252,v,172,v,140
ds_read_b128 v[108:111], v192 offset:47104
buffer_load_dwordx4 v189, s[12:15], s21 offen offset:1024 lds
MA 216,v,168,v,136
MA 220,v,172,v,136
buffer_load_dwordx4 v190, s[12:15], s21 offen offset:2048 lds
MA 184,v,168,v,132
MA 188,v,172,v,132
MA 152,v,168,v,128
buffer_load_dwordx4 v191, s[12:15], s21 offen offset:3072 lds
MA 156,v,172,v,128
MA 120,v,168,v,124
s_add_u32 s21, s21, 524288
MA 124,v,172,v,124
MA 88,v,168,v,120
MA 92,v,172,v,120
s_and_b32 s21, s21, 4194303
MA 56,v,168,v,116
MA 60,v,172,v,116
MA 24,v,168,v,112
TR 168,202,32768
TR 170,202,34816
MA 28,v,172,v,112
TR 172,203,32768
TR 174,203,34816
s_waitcnt lgkmcnt(4)
MA 0,v,144,v,80
s_add_u32 m0, s22, 0
buffer_load_dwordx4 v[230:233], v63, s[92:95], 0 offen offset:0
MA 4,v,148,v,80
ds_read_b128 v[112:115], v193 offset:32768
MA 32,v,144,v,84
MA 36,v,148,v,84
MA 64,v,144,v,88
MA 68,v,148,v,88
buffer_load_dwordx4 v176, s[8:11], s20 offen offset:0 lds
MA 96,v,144,v,92
buffer_load_dwordx4 v[2:5], v64, s[76:79], 0 offen offset:0
MA 100,v,148,v,92
ds_read_b128 v[116:119], v193 offset:34816
MA 128,v,144,v,96
MA 132,v,148,v,96
MA 160,v,144,v,100
buffer_load_dwordx4 v177, s[8:11], s20 offen offset:1024 lds
MA 164,v,148,v,100
MA 192,v,144,v,104
buffer_load_dwordx4 v[234:237], v63, s[92:95], 0 offen offset:512
MA 196,v,148,v,104
ds_read_b128 v[120:123], v193 offset:36864
MA 224,v,144,v,108
TR 144,196,49152
TR 146,196,51200
MA 228,v,148,v,108
TR 148,197,49152
TR 150,197,51200
MA 232,v,152,v,108
buffer_load_dwordx4 v178, s[8:11], s20 offen offset:2048 lds
MA 236,v,156,v,108
MA 200,v,152,v,104
buffer_load_dwordx4 v[6:9], v64, s[76:79], 0 offen offset:512
MA 204,v,156,v,104
MA 168,v,152,v,100
ds_read_b128 v[124:127], v193 offset:38912
buffer_load_dwordx4 v179, s[8:11], s20 offen offset:3072 lds
MA 172,v,156,v,100
MA 136,v,152,v,96
MA 140,v,156,v,96
MA 104,v,152,v,92
buffer_load_dwordx4 v[238:241], v63, s[92:95], 0 offen offset:1024
MA 108,v,156,v,92
s_add_u32 m0, s22, 4096
MA 72,v,152,v,88
ds_read_b128 v[128:131], v193 offset:40960
MA 76,v,156,v,88
MA 40,v,152,v,84
MA 44,v,156,v,84
MA 8,v,152,v,80
TR 152,198,49152
TR 154,198,51200
MA 12,v,156,v,80
TR 156,199,49152
TR 158,199,51200
MA 16,v,160,v,80
ds_read_b128 v[132:135], v193 offset:43008
buffer_load_dwordx4 v180, s[8:11], s20 offen offset:0 lds
MA 20,v,164,v,80
buffer_load_dwordx4 v[12:15], v64, s[76:79], 0 offen offset:1024
MA 48,v,160,v,84
MA 52,v,164,v,84
MA 80,v,160,v,88
buffer_load_dwordx4 v181, s[8:11], s20 offen offset:1024 lds
MA 84,v,164,v,88
buffer_load_dwordx4 v[242:245], v63, s[92:95], 0 offen offset:1536
MA 112,v,160,v,92
MA 116,v,164,v,92
ds_read_b128 v[136:139], v193 offset:45056
MA 144,v,160,v,96
MA 148,v,164,v,96
buffer_load_dwordx4 v182, s[8:11], s20 offen offset:2048 lds
MA 176,v,160,v,100
MA 180,v,164,v,100
buffer_load_dwordx4 v[246:249], v64, s[76:79], 0 offen offset:1536
MA 208,v,160,v,104
MA 212,v,164,v,104
ds_read_b128 v[140:143], v193 offset:47104
MA 240,v,160,v,108
TR 160,200,49152
TR 162,200,51200
MA 244,v,164,v,108
TR 164,201,49152
TR 166,201,51200
s_waitcnt lgkmcnt(15)
MA 248,v,168,v,108
buffer_load_dwordx4 v183, s[8:11], s20 offen offset:3072 lds
MA 252,v,172,v,108
buffer_load_dwordx4 v[54:57], v62, s[96:99], 0 offen offset:0
MA 216,v,168,v,104
MA 220,v,172,v,104
s_add_u32 s20, s20, 128
MA 184,v,168,v,100
MA 188,v,172,v,100
MA 152,v,168,v,96
MA 156,v,172,v,96
buffer_load_dwordx4 v[58:61], v62, s[96:99], 0 offen offset:16
MA 120,v,168,v,92
s_and_b32 s20, s20, 1023
MA 124,v,172,v,92
MA 88,v,168,v,88
MA 92,v,172,v,88
MA 56,v,168,v,84
MA 60,v,172,v,84
MA 24,v,168,v,80
TR 168,202,49152
TR 170,202,51200
MA 28,v,172,v,80
TR 172,203,49152
TR 174,203,51200
s_waitcnt lgkmcnt(4)
MA 0,v,144,v,112
MA 4,v,148,v,112
MA 32,v,144,v,116
MA 36,v,148,v,116
MA 64,v,144,v,120
MA 68,v,148,v,120
MA 96,v,144,v,124
MA 100,v,148,v,124
MA 128,v,144,v,128
MA 132,v,148,v,128
s_waitcnt vmcnt(18) lgkmcnt(0)
s_barrier
MA 160,v,144,v,132
s_add_u32 m0, s23, 32768
MA 164,v,148,v,132
ds_read_b128 v[80:83], v194 offset:0
MA 192,v,144,v,136
s_mov_b32 s4, s34
s_mov_b32 s5, s35
MA 196,v,148,v,136
MA 224,v,144,v,140
TR 144,196,0
TR 146,196,2048
MA 228,v,148,v,140
TR 148,197,0
TR 150,197,2048
MA 232,v,152,v,140
ds_read_b128 v[84:87], v194 offset:2048
buffer_load_dwordx4 v184, s[12:15], s21 offen offset:0 lds
MA 236,v,156,v,140
s_mov_b32 s6, 8388608
s_mov_b32 s7, 0x20000
MA 200,v,152,v,136
buffer_load_dwordx4 v185, s[12:15], s21 offen offset:1024 lds
MA 204,v,156,v,136
MA 168,v,152,v,132
MA 172,v,156,v,132
ds_read_b128 v[88:91], v194 offset:4096
MA 136,v,152,v,128
MA 140,v,156,v,128
buffer_load_dwordx4 v186, s[12:15], s21 offen offset:2048 lds
s_lshr_b32 s43, s2, 3
MA 104,v,152,v,124
MA 108,v,156,v,124
MA 72,v,152,v,120
ds_read_b128 v[92:95], v194 offset:6144
s_lshl_b32 s43, s43, 2
MA 76,v,156,v,120
buffer_load_dwordx4 v187, s[12:15], s21 offen offset:3072 lds
MA 40,v,152,v,116
MA 44,v,156,v,116
s_add_u32 s43, s43, s3
MA 8,v,152,v,112
TR 152,198,0
TR 154,198,2048
MA 12,v,156,v,112
TR 156,199,0
TR 158,199,2048
MA 16,v,160,v,112
ds_read_b128 v[96:99], v194 offset:8192
s_add_u32 m0, s23, 36864
MA 20,v,164,v,112
s_lshl_b32 s43, s43, 16
MA 48,v,160,v,116
MA 52,v,164,v,116
MA 80,v,160,v,120
ds_read_b128 v[100:103], v194 offset:10240
buffer_load_dwordx4 v188, s[12:15], s21 offen offset:0 lds
MA 84,v,164,v,120
s_and_b32 s37, s2, 7
MA 112,v,160,v,124
MA 116,v,164,v,124
s_lshl_b32 s37, s37, 10
MA 144,v,160,v,128
buffer_load_dwordx4 v189, s[12:15], s21 offen offset:1024 lds
MA 148,v,164,v,128
ds_read_b128 v[104:107], v194 offset:12288
MA 176,v,160,v,132
s_add_u32 s43, s43, s37
MA 180,v,164,v,132
MA 208,v,160,v,136
buffer_load_dwordx4 v190, s[12:15], s21 offen offset:2048 lds
MA 212,v,164,v,136
v_lshrrev_b32 v78, 3, v1
MA 240,v,160,v,140
TR 160,200,0
TR 162,200,2048
MA 244,v,164,v,140
TR 164,201,0
TR 166,201,2048
MA 248,v,168,v,140
ds_read_b128 v[108:111], v194 offset:14336
MA 252,v,172,v,140
buffer_load_dwordx4 v191, s[12:15], s21 offen offset:3072 lds
v_and_b32 v79, 7, v1
MA 216,v,168,v,136
MA 220,v,172,v,136
MA 184,v,168,v,132
v_lshlrev_b32 v79, 7, v79
MA 188,v,172,v,132
s_add_u32 s21, s21, 524288
MA 152,v,168,v,128
MA 156,v,172,v,128
v_lshl_add_u32 v78, v78, 13, v79
MA 120,v,168,v,124
MA 124,v,172,v,124
s_and_b32 s21, s21, 4194303
MA 88,v,168,v,120
v_add_u32 v78, s43, v78
MA 92,v,172,v,120
MA 56,v,168,v,116
MA 60,v,172,v,116
MA 24,v,168,v,112
TR 168,202,0
TR 170,202,2048
MA 28,v,172,v,112
TR 172,203,0
TR 174,203,2048
s_waitcnt lgkmcnt(4)
MA 0,v,144,v,80
s_add_u32 m0, s22, 32768
v_add_u32 v252, 0, v229
MA 4,v,148,v,80
ds_read_b128 v[112:115], v195 offset:0
MA 32,v,144,v,84
MA 36,v,148,v,84
MA 64,v,144,v,88
MA 68,v,148,v,88
buffer_load_dwordx4 v176, s[8:11], s20 offen offset:0 lds
MA 96,v,144,v,92
buffer_load_dwordx2 v[16:17], v252, s[84:87], 0 offen
MA 100,v,148,v,92
ds_read_b128 v[116:119], v195 offset:2048
MA 128,v,144,v,96
MA 132,v,148,v,96
MA 160,v,144,v,100
buffer_load_dwordx4 v177, s[8:11], s20 offen offset:1024 lds
MA 164,v,148,v,100
MA 192,v,144,v,104
v_add_u32 v253, 2048, v229
MA 196,v,148,v,104
ds_read_b128 v[120:123], v195 offset:4096
MA 224,v,144,v,108
TR 144,196,16384
TR 146,196,18432
MA 228,v,148,v,108
TR 148,197,16384
TR 150,197,18432
MA 232,v,152,v,108
buffer_load_dwordx4 v178, s[8:11], s20 offen offset:2048 lds
MA 236,v,156,v,108
MA 200,v,152,v,104
buffer_load_dwordx2 v[18:19], v253, s[84:87], 0 offen
MA 204,v,156,v,104
MA 168,v,152,v,100
ds_read_b128 v[124:127], v195 offset:6144
buffer_load_dwordx4 v179, s[8:11], s20 offen offset:3072 lds
MA 172,v,156,v,100
MA 136,v,152,v,96
MA 140,v,156,v,96
MA 104,v,152,v,92
v_add_u32 v254, 4096, v229
MA 108,v,156,v,92
s_add_u32 m0, s22, 36864
MA 72,v,152,v,88
ds_read_b128 v[128:131], v195 offset:8192
MA 76,v,156,v,88
MA 40,v,152,v,84
MA 44,v,156,v,84
MA 8,v,152,v,80
TR 152,198,16384
TR 154,198,18432
MA 12,v,156,v,80
TR 156,199,16384
TR 158,199,18432
MA 16,v,160,v,80
ds_read_b128 v[132:135], v195 offset:10240
buffer_load_dwordx4 v180, s[8:11], s20 offen offset:0 lds
MA 20,v,164,v,80
buffer_load_dwordx2 v[20:21], v254, s[84:87], 0 offen
MA 48,v,160,v,84
MA 52,v,164,v,84
MA 80,v,160,v,88
buffer_load_dwordx4 v181, s[8:11], s20 offen offset:1024 lds
MA 84,v,164,v,88
v_add_u32 v255, 6144, v229
MA 112,v,160,v,92
MA 116,v,164,v,92
ds_read_b128 v[136:139], v195 offset:12288
MA 144,v,160,v,96
MA 148,v,164,v,96
buffer_load_dwordx4 v182, s[8:11], s20 offen offset:2048 lds
MA 176,v,160,v,100
MA 180,v,164,v,100
buffer_load_dwordx2 v[22:23], v255, s[84:87], 0 offen
MA 208,v,160,v,104
MA 212,v,164,v,104
ds_read_b128 v[140:143], v195 offset:14336
MA 240,v,160,v,108
TR 160,200,16384
TR 162,200,18432
MA 244,v,164,v,108
TR 164,201,16384
TR 166,201,18432
s_waitcnt lgkmcnt(15)
MA 248,v,168,v,108
buffer_load_dwordx4 v183, s[8:11], s20 offen offset:3072 lds
MA 252,v,172,v,108
buffer_load_dwordx2 v[38:39], v255, s[88:91], 0 offen
MA 216,v,168,v,104
MA 220,v,172,v,104
s_add_u32 s20, s20, 128
MA 184,v,168,v,100
MA 188,v,172,v,100
MA 152,v,168,v,96
MA 156,v,172,v,96
v_add_u32 v252, 8192, v229
MA 120,v,168,v,92
s_and_b32 s20, s20, 1023
MA 124,v,172,v,92
MA 88,v,168,v,88
MA 92,v,172,v,88
MA 56,v,168,v,84
MA 60,v,172,v,84
MA 24,v,168,v,80
TR 168,202,16384
TR 170,202,18432
MA 28,v,172,v,80
TR 172,203,16384
TR 174,203,18432
s_waitcnt lgkmcnt(4)
MA 0,v,144,v,112
MA 4,v,148,v,112
MA 32,v,144,v,116
MA 36,v,148,v,116
MA 64,v,144,v,120
MA 68,v,148,v,120
MA 96,v,144,v,124
MA 100,v,148,v,124
MA 128,v,144,v,128
MA 132,v,148,v,128
s_waitcnt vmcnt(13) lgkmcnt(0)
s_barrier
MA 160,v,144,v,132
s_add_u32 m0, s23, 0
s_bfe_u32 s80, s2, 0x20001
MA 164,v,148,v,132
ds_read_b128 v[80:83], v192 offset:0
s_bfe_u32 s69, s2, 0x30003
MA 192,v,144,v,136
s_lshl_b32 s80, s80, 3
s_add_u32 s69, s69, s80
MA 196,v,148,v,136
s_lshr_b32 s80, s2, 6
MA 224,v,144,v,140
TR 144,196,32768
TR 146,196,34816
MA 228,v,148,v,140
TR 148,197,32768
TR 150,197,34816
MA 232,v,152,v,140
ds_read_b128 v[84:87], v192 offset:2048
buffer_load_dwordx4 v184, s[12:15], s21 offen offset:0 lds
MA 236,v,156,v,140
s_xor_b32 s81, s80, s2
s_and_b32 s81, s81, 1
MA 200,v,152,v,136
buffer_load_dwordx4 v185, s[12:15], s21 offen offset:1024 lds
s_lshl_b32 s70, s80, 1
MA 204,v,156,v,136
s_add_u32 s70, s70, s81
s_lshl_b32 s80, s3, 1
MA 168,v,152,v,132
s_sub_u32 s80, 7, s80
s_lshl_b32 s76, s80, 17
MA 172,v,156,v,132
ds_read_b128 v[88:91], v192 offset:4096
s_lshl_b32 s80, s3, 15
MA 136,v,152,v,128
s_lshl_b32 s65, s70, 18
s_sub_u32 s64, 3932160, s65
MA 140,v,156,v,128
buffer_load_dwordx4 v186, s[12:15], s21 offen offset:2048 lds
s_add_u32 s65, s65, s80
MA 104,v,152,v,124
s_add_u32 s64, s64, s80
MA 108,v,156,v,124
s_lshl_b32 s81, s69, 12
MA 72,v,152,v,120
ds_read_b128 v[92:95], v192 offset:6144
s_lshl_b32 s100, s64, 2
MA 76,v,156,v,120
buffer_load_dwordx4 v187, s[12:15], s21 offen offset:3072 lds
s_add_u32 s100, s100, s81
MA 40,v,152,v,116
s_lshl_b32 s101, s65, 2
MA 44,v,156,v,116
s_add_u32 s101, s101, s81
MA 8,v,152,v,112
TR 152,198,32768
TR 154,198,34816
MA 12,v,156,v,112
TR 156,199,32768
TR 158,199,34816
MA 16,v,160,v,112
ds_read_b128 v[96:99], v192 offset:8192
s_add_u32 m0, s23, 4096
MA 20,v,164,v,112
s_lshl_b32 s66, s3, 17
s_lshl_b32 s81, s69, 8
MA 48,v,160,v,116
s_add_u32 s66, s66, s81
s_and_b32 s74, s2, 7
MA 52,v,164,v,116
s_lshl_b32 s74, s74, 8
s_mov_b32 s82, s66
MA 80,v,160,v,120
ds_read_b128 v[100:103], v192 offset:10240
buffer_load_dwordx4 v188, s[12:15], s21 offen offset:0 lds
MA 84,v,164,v,120
s_lshl_b32 s66, s74, 12
s_lshl_b32 s67, s3, 13
MA 112,v,160,v,124
s_lshl_b32 s68, s3, 12
s_lshl_b32 s77, s70, 1
MA 116,v,164,v,124
s_sub_u32 s77, 32, s77
MA 144,v,160,v,128
buffer_load_dwordx4 v189, s[12:15], s21 offen offset:1024 lds
v_lshrrev_b32 v66, 3, v1
MA 148,v,164,v,128
ds_read_b128 v[104:107], v192 offset:12288
v_lshlrev_b32 v66, 11, v66
MA 176,v,160,v,132
v_lshrrev_b32 v67, 4, v1
v_and_b32 v68, 7, v1
MA 180,v,164,v,132
v_xor_b32 v68, v68, v67
MA 208,v,160,v,136
buffer_load_dwordx4 v190, s[12:15], s21 offen offset:2048 lds
v_lshl_add_u32 v66, v68, 4, v66
MA 212,v,164,v,136
v_xor_b32 v69, 64, v66
MA 240,v,160,v,140
TR 160,200,32768
TR 162,200,34816
MA 244,v,164,v,140
TR 164,201,32768
TR 166,201,34816
MA 248,v,168,v,140
ds_read_b128 v[108:111], v192 offset:14336
s_lshr_b32 s83, s76, 2
MA 252,v,172,v,140
buffer_load_dwordx4 v191, s[12:15], s21 offen offset:3072 lds
v_add_u32 v208, 0, v66
MA 216,v,168,v,136
v_add_u32 v209, 15360, v69
v_add_u32 v210, -2048, v66
MA 220,v,172,v,136
v_add_u32 v210, s83, v210
v_add_u32 v211, 13312, v69
MA 184,v,168,v,132
v_add_u32 v211, s83, v211
v_and_b32 v68, 15, v1
MA 188,v,172,v,132
s_add_u32 s21, s21, 524288
v_lshlrev_b32 v69, 1, v67
MA 152,v,168,v,128
v_xor_b32 v68, v68, v69
MA 156,v,172,v,128
v_lshlrev_b32 v66, 13, v67
MA 120,v,168,v,124
v_xor_b32 v69, 0, v68
MA 124,v,172,v,124
s_and_b32 s21, s21, 4194303
v_lshl_add_u32 v69, v69, 4, v66
MA 88,v,168,v,120
v_add_u32 v212, 0, v69
MA 92,v,172,v,120
v_xor_b32 v69, 0, v68
MA 56,v,168,v,116
v_lshl_add_u32 v69, v69, 4, v66
MA 60,v,172,v,116
v_add_u32 v213, 31744, v69
MA 24,v,168,v,112
TR 168,202,32768
TR 170,202,34816
MA 28,v,172,v,112
TR 172,203,32768
TR 174,203,34816
s_waitcnt lgkmcnt(4)
MA 0,v,144,v,80
s_add_u32 m0, s22, 65536
buffer_load_dwordx2 v[24:25], v252, s[84:87], 0 offen
MA 4,v,148,v,80
ds_read_b128 v[112:115], v193 offset:0
MA 32,v,144,v,84
MA 36,v,148,v,84
MA 64,v,144,v,88
MA 68,v,148,v,88
buffer_load_dwordx4 v176, s[8:11], s20 offen offset:0 lds
MA 96,v,144,v,92
buffer_load_dwordx2 v[40:41], v252, s[88:91], 0 offen
MA 100,v,148,v,92
ds_read_b128 v[116:119], v193 offset:2048
MA 128,v,144,v,96
MA 132,v,148,v,96
MA 160,v,144,v,100
buffer_load_dwordx4 v177, s[8:11], s20 offen offset:1024 lds
MA 164,v,148,v,100
MA 192,v,144,v,104
v_add_u32 v253, 10240, v229
MA 196,v,148,v,104
ds_read_b128 v[120:123], v193 offset:4096
MA 224,v,144,v,108
TR 144,196,49152
TR 146,196,51200
MA 228,v,148,v,108
TR 148,197,49152
TR 150,197,51200
MA 232,v,152,v,108
buffer_load_dwordx4 v178, s[8:11], s20 offen offset:2048 lds
MA 236,v,156,v,108
MA 200,v,152,v,104
buffer_load_dwordx2 v[26:27], v253, s[84:87], 0 offen
MA 204,v,156,v,104
MA 168,v,152,v,100
ds_read_b128 v[124:127], v193 offset:6144
buffer_load_dwordx4 v179, s[8:11], s20 offen offset:3072 lds
MA 172,v,156,v,100
MA 136,v,152,v,96
MA 140,v,156,v,96
MA 104,v,152,v,92
buffer_load_dwordx2 v[42:43], v253, s[88:91], 0 offen
MA 108,v,156,v,92
s_add_u32 m0, s22, 69632
MA 72,v,152,v,88
ds_read_b128 v[128:131], v193 offset:8192
MA 76,v,156,v,88
MA 40,v,152,v,84
MA 44,v,156,v,84
MA 8,v,152,v,80
TR 152,198,49152
TR 154,198,51200
MA 12,v,156,v,80
TR 156,199,49152
TR 158,199,51200
MA 16,v,160,v,80
ds_read_b128 v[132:135], v193 offset:10240
buffer_load_dwordx4 v180, s[8:11], s20 offen offset:0 lds
MA 20,v,164,v,80
v_add_u32 v254, 12288, v229
MA 48,v,160,v,84
MA 52,v,164,v,84
MA 80,v,160,v,88
buffer_load_dwordx4 v181, s[8:11], s20 offen offset:1024 lds
MA 84,v,164,v,88
buffer_load_dwordx2 v[28:29], v254, s[84:87], 0 offen
MA 112,v,160,v,92
MA 116,v,164,v,92
ds_read_b128 v[136:139], v193 offset:12288
MA 144,v,160,v,96
MA 148,v,164,v,96
buffer_load_dwordx4 v182, s[8:11], s20 offen offset:2048 lds
MA 176,v,160,v,100
MA 180,v,164,v,100
buffer_load_dwordx2 v[44:45], v254, s[88:91], 0 offen
MA 208,v,160,v,104
MA 212,v,164,v,104
ds_read_b128 v[140:143], v193 offset:14336
MA 240,v,160,v,108
TR 160,200,49152
TR 162,200,51200
MA 244,v,164,v,108
TR 164,201,49152
TR 166,201,51200
s_waitcnt lgkmcnt(15)
MA 248,v,168,v,108
buffer_load_dwordx4 v183, s[8:11], s20 offen offset:3072 lds
MA 252,v,172,v,108
v_add_u32 v255, 14336, v229
MA 216,v,168,v,104
MA 220,v,172,v,104
s_add_u32 s20, s20, 128
MA 184,v,168,v,100
MA 188,v,172,v,100
MA 152,v,168,v,96
MA 156,v,172,v,96
buffer_load_dwordx2 v[30:31], v255, s[84:87], 0 offen
MA 120,v,168,v,92
s_and_b32 s20, s20, 1023
MA 124,v,172,v,92
MA 88,v,168,v,88
MA 92,v,172,v,88
MA 56,v,168,v,84
MA 60,v,172,v,84
MA 24,v,168,v,80
TR 168,202,49152
TR 170,202,51200
MA 28,v,172,v,80
TR 172,203,49152
TR 174,203,51200
s_waitcnt lgkmcnt(4)
MA 0,v,144,v,112
MA 4,v,148,v,112
MA 32,v,144,v,116
MA 36,v,148,v,116
MA 64,v,144,v,120
MA 68,v,148,v,120
MA 96,v,144,v,124
MA 100,v,148,v,124
MA 128,v,144,v,128
MA 132,v,148,v,128
s_waitcnt vmcnt(15) lgkmcnt(0)
s_barrier
MA 160,v,144,v,132
s_add_u32 m0, s23, 32768
v_xor_b32 v69, 8, v68
MA 164,v,148,v,132
ds_read_b128 v[80:83], v192 offset:32768
v_lshl_add_u32 v69, v69, 4, v66
MA 192,v,144,v,136
v_add_u32 v214, 63488, v69
v_xor_b32 v69, 8, v68
MA 196,v,148,v,136
v_lshl_add_u32 v69, v69, 4, v66
MA 224,v,144,v,140
TR 144,196,0
TR 146,196,2048
MA 228,v,148,v,140
TR 148,197,0
TR 150,197,2048
MA 232,v,152,v,140
ds_read_b128 v[84:87], v192 offset:34816
buffer_load_dwordx4 v184, s[12:15], s21 offen offset:0 lds
MA 236,v,156,v,140
v_add_u32 v215, 95232, v69
v_and_b32 v66, 15, v1
MA 200,v,152,v,136
buffer_load_dwordx4 v185, s[12:15], s21 offen offset:1024 lds
v_lshrrev_b32 v68, 1, v66
MA 204,v,156,v,136
v_xor_b32 v68, v68, v67
v_lshlrev_b32 v68, 4, v68
MA 168,v,152,v,132
v_lshl_add_u32 v68, v66, 7, v68
v_add_u32 v224, s67, v68
MA 172,v,156,v,132
ds_read_b128 v[88:91], v192 offset:36864
v_xor_b32 v225, 64, v224
MA 136,v,152,v,128
v_add_u32 v226, 0x10000, v224
v_add_u32 v227, 0x10000, v225
MA 140,v,156,v,128
buffer_load_dwordx4 v186, s[12:15], s21 offen offset:2048 lds
v_bfe_u32 v66, v1, 2, 2
MA 104,v,152,v,124
v_and_b32 v68, 1, v67
v_lshl_or_b32 v68, v68, 2, v66
MA 108,v,156,v,124
v_lshl_add_u32 v66, v67, 3, v66
v_lshlrev_b32 v66, 8, v66
MA 72,v,152,v,120
ds_read_b128 v[92:95], v192 offset:38912
v_and_b32 v69, 3, v1
MA 76,v,156,v,120
buffer_load_dwordx4 v187, s[12:15], s21 offen offset:3072 lds
v_lshl_add_u32 v66, v69, 3, v66
MA 40,v,152,v,116
v_add_u32 v66, 98304, v66
MA 44,v,156,v,116
v_xor_b32 v69, 0, v68
MA 8,v,152,v,112
TR 152,198,0
TR 154,198,2048
MA 12,v,156,v,112
TR 156,199,0
TR 158,199,2048
MA 16,v,160,v,112
ds_read_b128 v[96:99], v192 offset:40960
s_add_u32 m0, s23, 36864
MA 20,v,164,v,112
v_lshl_add_u32 v216, v69, 5, v66
v_xor_b32 v69, 1, v68
MA 48,v,160,v,116
v_lshl_add_u32 v217, v69, 5, v66
v_xor_b32 v69, 2, v68
MA 52,v,164,v,116
v_lshl_add_u32 v218, v69, 5, v66
v_xor_b32 v69, 3, v68
MA 80,v,160,v,120
ds_read_b128 v[100:103], v192 offset:43008
buffer_load_dwordx4 v188, s[12:15], s21 offen offset:0 lds
MA 84,v,164,v,120
v_lshl_add_u32 v219, v69, 5, v66
v_xor_b32 v69, 4, v68
MA 112,v,160,v,124
v_lshl_add_u32 v220, v69, 5, v66
v_xor_b32 v69, 5, v68
MA 116,v,164,v,124
v_lshl_add_u32 v221, v69, 5, v66
v_xor_b32 v69, 6, v68
MA 144,v,160,v,128
buffer_load_dwordx4 v189, s[12:15], s21 offen offset:1024 lds
v_lshl_add_u32 v222, v69, 5, v66
MA 148,v,164,v,128
ds_read_b128 v[104:107], v192 offset:45056
v_xor_b32 v69, 7, v68
MA 176,v,160,v,132
v_lshl_add_u32 v223, v69, 5, v66
s_mov_b32 s44, s32
MA 180,v,164,v,132
s_mov_b32 s45, s33
MA 208,v,160,v,136
buffer_load_dwordx4 v190, s[12:15], s21 offen offset:2048 lds
s_mov_b32 s46, 4194304
MA 212,v,164,v,136
s_mov_b32 s47, 0x20000
MA 240,v,160,v,140
TR 160,200,0
TR 162,200,2048
MA 244,v,164,v,140
TR 164,201,0
TR 166,201,2048
MA 248,v,168,v,140
ds_read_b128 v[108:111], v192 offset:47104
MA 252,v,172,v,140
buffer_load_dwordx4 v191, s[12:15], s21 offen offset:3072 lds
MA 216,v,168,v,136
s_add_u32 s48, s34, s82
s_addc_u32 s49, s35, 0
MA 220,v,172,v,136
s_sub_u32 s50, 8388608, s82
s_mov_b32 s51, 0x20000
MA 184,v,168,v,132
s_add_u32 s60, s40, 33554432
s_addc_u32 s61, s41, 0
MA 188,v,172,v,132
s_add_u32 s21, s21, 524288
s_mov_b32 s62, 16777216
MA 152,v,168,v,128
s_mov_b32 s63, 0x20000
s_lshl_b32 s80, s69, 19
MA 156,v,172,v,128
s_add_u32 s52, s40, s80
s_addc_u32 s53, s41, 0
MA 120,v,168,v,124
s_lshl_b32 s54, s77, 14
s_mov_b32 s55, 0x20000
MA 124,v,172,v,124
s_and_b32 s21, s21, 4194303
s_add_u32 s80, s80, 16760832
MA 88,v,168,v,120
s_add_u32 s56, s40, s80
s_addc_u32 s57, s41, 0
MA 92,v,172,v,120
s_add_u32 s58, s54, 16384
MA 56,v,168,v,116
s_mov_b32 s59, 0x20000
MA 60,v,172,v,116
s_load_dwordx2 s[38:39], s[0:1], 112
MA 24,v,168,v,112
TR 168,202,0
TR 170,202,2048
MA 28,v,172,v,112
TR 172,203,0
TR 174,203,2048
s_waitcnt lgkmcnt(4)
MA 0,v,144,v,80
s_add_u32 m0, s22, 0
buffer_load_dwordx2 v[46:47], v255, s[88:91], 0 offen
MA 4,v,148,v,80
ds_read_b128 v[112:115], v193 offset:32768
MA 32,v,144,v,84
MA 36,v,148,v,84
MA 64,v,144,v,88
MA 68,v,148,v,88
buffer_load_dwordx4 v176, s[8:11], s20 offen offset:0 lds
MA 96,v,144,v,92
v_add_u32 v252, 16384, v229
MA 100,v,148,v,92
ds_read_b128 v[116:119], v193 offset:34816
MA 128,v,144,v,96
MA 132,v,148,v,96
MA 160,v,144,v,100
buffer_load_dwordx4 v177, s[8:11], s20 offen offset:1024 lds
MA 164,v,148,v,100
MA 192,v,144,v,104
buffer_load_dwordx2 v[32:33], v252, s[84:87], 0 offen
MA 196,v,148,v,104
ds_read_b128 v[120:123], v193 offset:36864
MA 224,v,144,v,108
TR 144,196,16384
TR 146,196,18432
MA 228,v,148,v,108
TR 148,197,16384
TR 150,197,18432
MA 232,v,152,v,108
buffer_load_dwordx4 v178, s[8:11], s20 offen offset:2048 lds
MA 236,v,156,v,108
MA 200,v,152,v,104
buffer_load_dwordx2 v[48:49], v252, s[88:91], 0 offen
MA 204,v,156,v,104
MA 168,v,152,v,100
ds_read_b128 v[124:127], v193 offset:38912
buffer_load_dwordx4 v179, s[8:11], s20 offen offset:3072 lds
MA 172,v,156,v,100
MA 136,v,152,v,96
MA 140,v,156,v,96
MA 104,v,152,v,92
v_add_u32 v253, 18432, v229
MA 108,v,156,v,92
s_add_u32 m0, s22, 4096
MA 72,v,152,v,88
ds_read_b128 v[128:131], v193 offset:40960
MA 76,v,156,v,88
MA 40,v,152,v,84
MA 44,v,156,v,84
MA 8,v,152,v,80
TR 152,198,16384
TR 154,198,18432
MA 12,v,156,v,80
TR 156,199,16384
TR 158,199,18432
MA 16,v,160,v,80
ds_read_b128 v[132:135], v193 offset:43008
buffer_load_dwordx4 v180, s[8:11], s20 offen offset:0 lds
MA 20,v,164,v,80
buffer_load_dwordx2 v[34:35], v253, s[84:87], 0 offen
MA 48,v,160,v,84
MA 52,v,164,v,84
MA 80,v,160,v,88
buffer_load_dwordx4 v181, s[8:11], s20 offen offset:1024 lds
MA 84,v,164,v,88
buffer_load_dwordx2 v[50:51], v253, s[88:91], 0 offen
MA 112,v,160,v,92
MA 116,v,164,v,92
ds_read_b128 v[136:139], v193 offset:45056
MA 144,v,160,v,96
MA 148,v,164,v,96
buffer_load_dwordx4 v182, s[8:11], s20 offen offset:2048 lds
MA 176,v,160,v,100
MA 180,v,164,v,100
v_add_u32 v254, 20480, v229
MA 208,v,160,v,104
MA 212,v,164,v,104
ds_read_b128 v[140:143], v193 offset:47104
MA 240,v,160,v,108
TR 160,200,16384
TR 162,200,18432
MA 244,v,164,v,108
TR 164,201,16384
TR 166,201,18432
s_waitcnt lgkmcnt(15)
MA 248,v,168,v,108
buffer_load_dwordx4 v183, s[8:11], s20 offen offset:3072 lds
MA 252,v,172,v,108
buffer_load_dwordx2 v[36:37], v254, s[84:87], 0 offen
MA 216,v,168,v,104
MA 220,v,172,v,104
s_add_u32 s20, s20, 128
MA 184,v,168,v,100
MA 188,v,172,v,100
MA 152,v,168,v,96
MA 156,v,172,v,96
buffer_load_dwordx2 v[52:53], v254, s[88:91], 0 offen
MA 120,v,168,v,92
s_and_b32 s20, s20, 1023
MA 124,v,172,v,92
MA 88,v,168,v,88
MA 92,v,172,v,88
MA 56,v,168,v,84
MA 60,v,172,v,84
MA 24,v,168,v,80
TR 168,202,16384
TR 170,202,18432
MA 28,v,172,v,80
TR 172,203,16384
TR 174,203,18432
s_waitcnt lgkmcnt(4)
MA 0,v,144,v,112
MA 4,v,148,v,112
MA 32,v,144,v,116
MA 36,v,148,v,116
MA 64,v,144,v,120
MA 68,v,148,v,120
MA 96,v,144,v,124
MA 100,v,148,v,124
MA 128,v,144,v,128
MA 132,v,148,v,128
s_waitcnt vmcnt(15) lgkmcnt(0)
s_barrier
MA 160,v,144,v,132
s_add_u32 m0, s23, 0
s_and_b32 s37, s3, 3
MA 164,v,148,v,132
ds_read_b128 v[80:83], v194 offset:0
MA 192,v,144,v,136
s_cmp_eq_u32 s37, 0
s_cselect_b32 s37, 0, 0x40000000
MA 196,v,148,v,136
MA 224,v,144,v,140
TR 144,196,32768
TR 146,196,34816
MA 228,v,148,v,140
TR 148,197,32768
TR 150,197,34816
MA 232,v,152,v,140
ds_read_b128 v[84:87], v194 offset:2048
buffer_load_dwordx4 v184, s[12:15], s21 offen offset:0 lds
MA 236,v,156,v,140
v_add_u32 v229, s37, v78
MA 200,v,152,v,136
buffer_load_dwordx4 v185, s[12:15], s21 offen offset:1024 lds
MA 204,v,156,v,136
buffer_load_dword v79, v229, s[4:7], 0 offen
MA 168,v,152,v,132
MA 172,v,156,v,132
ds_read_b128 v[88:91], v194 offset:4096
s_getpc_b64 s[82:83]
L_ct_fK:
MA 136,v,152,v,128
MA 140,v,156,v,128
buffer_load_dwordx4 v186, s[12:15], s21 offen offset:2048 lds
MA 104,v,152,v,124
s_add_u32 s82, s82, L_p2 - L_ct_fK
s_addc_u32 s83, s83, 0
MA 108,v,156,v,124
MA 72,v,152,v,120
ds_read_b128 v[92:95], v194 offset:6144
MA 76,v,156,v,120
buffer_load_dwordx4 v187, s[12:15], s21 offen offset:3072 lds
MA 40,v,152,v,116
v_mov_b32 v67, s83
MA 44,v,156,v,116
MA 8,v,152,v,112
TR 152,198,32768
TR 154,198,34816
MA 12,v,156,v,112
TR 156,199,32768
TR 158,199,34816
MA 16,v,160,v,112
ds_read_b128 v[96:99], v194 offset:8192
s_add_u32 m0, s23, 4096
MA 20,v,164,v,112
v_mov_b32 v66, s82
s_lshr_b32 s82, s2, 3
MA 48,v,160,v,116
s_lshl_b32 s82, s82, 2
MA 52,v,164,v,116
MA 80,v,160,v,120
ds_read_b128 v[100:103], v194 offset:10240
buffer_load_dwordx4 v188, s[12:15], s21 offen offset:0 lds
MA 84,v,164,v,120
s_add_u32 s82, s82, s3
MA 112,v,160,v,124
MA 116,v,164,v,124
s_lshl_b32 s82, s82, 7
MA 144,v,160,v,128
buffer_load_dwordx4 v189, s[12:15], s21 offen offset:1024 lds
MA 148,v,164,v,128
ds_read_b128 v[104:107], v194 offset:12288
v_and_b32 v68, 3, v1
MA 176,v,160,v,132
MA 180,v,164,v,132
v_lshlrev_b32 v68, 14, v68
MA 208,v,160,v,136
buffer_load_dwordx4 v190, s[12:15], s21 offen offset:2048 lds
MA 212,v,164,v,136
MA 240,v,160,v,140
TR 160,200,32768
TR 162,200,34816
MA 244,v,164,v,140
TR 164,201,32768
TR 166,201,34816
MA 248,v,168,v,140
ds_read_b128 v[108:111], v194 offset:14336
v_add_u32 v68, s82, v68
MA 252,v,172,v,140
buffer_load_dwordx4 v191, s[12:15], s21 offen offset:3072 lds
v_min_u32 v68, L_p3_begin - L_p2 - 4, v68
MA 216,v,168,v,136
v_add_co_u32 v66, vcc, v66, v68
s_nop 1
v_addc_co_u32 v67, vcc, 0, v67, vcc
MA 220,v,172,v,136
MA 184,v,168,v,132
MA 188,v,172,v,132
s_add_u32 s21, s21, 524288
MA 152,v,168,v,128
MA 156,v,172,v,128
MA 120,v,168,v,124
MA 124,v,172,v,124
s_and_b32 s21, s21, 4194303
MA 88,v,168,v,120
MA 92,v,172,v,120
global_load_dword v68, v[66:67], off
MA 56,v,168,v,116
MA 60,v,172,v,116
MA 24,v,168,v,112
TR 168,202,32768
TR 170,202,34816
MA 28,v,172,v,112
TR 172,203,32768
TR 174,203,34816
s_waitcnt lgkmcnt(4)
MA 0,v,144,v,80
s_add_u32 m0, s22, 32768
s_and_b32 s37, s3, 3
MA 4,v,148,v,80
ds_read_b128 v[112:115], v195 offset:0
MA 32,v,144,v,84
MA 36,v,148,v,84
MA 64,v,144,v,88
MA 68,v,148,v,88
buffer_load_dwordx4 v176, s[8:11], s20 offen offset:0 lds
MA 96,v,144,v,92
MA 100,v,148,v,92
ds_read_b128 v[116:119], v195 offset:2048
MA 128,v,144,v,96
MA 132,v,148,v,96
MA 160,v,144,v,100
buffer_load_dwordx4 v177, s[8:11], s20 offen offset:1024 lds
MA 164,v,148,v,100
MA 192,v,144,v,104
s_cmp_eq_u32 s37, 1
s_cselect_b32 s37, 0, 0x40000000
MA 196,v,148,v,104
ds_read_b128 v[120:123], v195 offset:4096
MA 224,v,144,v,108
TR 144,196,49152
TR 146,196,51200
MA 228,v,148,v,108
TR 148,197,49152
TR 150,197,51200
MA 232,v,152,v,108
buffer_load_dwordx4 v178, s[8:11], s20 offen offset:2048 lds
MA 236,v,156,v,108
MA 200,v,152,v,104
MA 204,v,156,v,104
MA 168,v,152,v,100
ds_read_b128 v[124:127], v195 offset:6144
buffer_load_dwordx4 v179, s[8:11], s20 offen offset:3072 lds
MA 172,v,156,v,100
MA 136,v,152,v,96
MA 140,v,156,v,96
MA 104,v,152,v,92
MA 108,v,156,v,92
s_add_u32 m0, s22, 36864
MA 72,v,152,v,88
ds_read_b128 v[128:131], v195 offset:8192
MA 76,v,156,v,88
MA 40,v,152,v,84
MA 44,v,156,v,84
MA 8,v,152,v,80
TR 152,198,49152
TR 154,198,51200
MA 12,v,156,v,80
TR 156,199,49152
TR 158,199,51200
MA 16,v,160,v,80
ds_read_b128 v[132:135], v195 offset:10240
buffer_load_dwordx4 v180, s[8:11], s20 offen offset:0 lds
MA 20,v,164,v,80
MA 48,v,160,v,84
MA 52,v,164,v,84
MA 80,v,160,v,88
buffer_load_dwordx4 v181, s[8:11], s20 offen offset:1024 lds
MA 84,v,164,v,88
v_add_u32 v229, s37, v78
MA 112,v,160,v,92
MA 116,v,164,v,92
ds_read_b128 v[136:139], v195 offset:12288
MA 144,v,160,v,96
MA 148,v,164,v,96
buffer_load_dwordx4 v182, s[8:11], s20 offen offset:2048 lds
MA 176,v,160,v,100
MA 180,v,164,v,100
MA 208,v,160,v,104
MA 212,v,164,v,104
ds_read_b128 v[140:143], v195 offset:14336
MA 240,v,160,v,108
TR 160,200,49152
TR 162,200,51200
MA 244,v,164,v,108
TR 164,201,49152
TR 166,201,51200
s_waitcnt lgkmcnt(15)
MA 248,v,168,v,108
buffer_load_dwordx4 v183, s[8:11], s20 offen offset:3072 lds
MA 252,v,172,v,108
buffer_load_dword v79, v229, s[4:7], 0 offen
MA 216,v,168,v,104
MA 220,v,172,v,104
s_add_u32 s20, s20, 128
MA 184,v,168,v,100
MA 188,v,172,v,100
MA 152,v,168,v,96
MA 156,v,172,v,96
MA 120,v,168,v,92
s_and_b32 s20, s20, 1023
MA 124,v,172,v,92
MA 88,v,168,v,88
MA 92,v,172,v,88
MA 56,v,168,v,84
MA 60,v,172,v,84
MA 24,v,168,v,80
TR 168,202,49152
TR 170,202,51200
MA 28,v,172,v,80
TR 172,203,49152
TR 174,203,51200
s_waitcnt lgkmcnt(4)
MA 0,v,144,v,112
MA 4,v,148,v,112
MA 32,v,144,v,116
MA 36,v,148,v,116
MA 64,v,144,v,120
MA 68,v,148,v,120
MA 96,v,144,v,124
MA 100,v,148,v,124
MA 128,v,144,v,128
MA 132,v,148,v,128
s_waitcnt vmcnt(10) lgkmcnt(0)
s_barrier
MA 160,v,144,v,132
s_add_u32 m0, s23, 32768
s_and_b32 s37, s3, 3
MA 164,v,148,v,132
ds_read_b128 v[80:83], v192 offset:0
MA 192,v,144,v,136
s_cmp_eq_u32 s37, 2
s_cselect_b32 s37, 0, 0x40000000
MA 196,v,148,v,136
v_add_u32 v229, s37, v78
buffer_load_dword v79, v229, s[4:7], 0 offen
MA 224,v,144,v,140
TR 144,196,0
TR 146,196,2048
MA 228,v,148,v,140
TR 148,197,0
TR 150,197,2048
MA 232,v,152,v,140
ds_read_b128 v[84:87], v192 offset:2048
buffer_load_dwordx4 v184, s[12:15], s21 offen offset:0 lds
MA 236,v,156,v,140
s_add_u32 s84, s40, 50331648
s_addc_u32 s85, s41, 0
MA 200,v,152,v,136
buffer_load_dwordx4 v185, s[12:15], s21 offen offset:1024 lds
s_mov_b32 s86, 4194304
MA 204,v,156,v,136
s_mov_b32 s87, 0x20000
MA 168,v,152,v,132
s_add_u32 s88, s40, 58720256
s_addc_u32 s89, s41, 0
MA 172,v,156,v,132
ds_read_b128 v[88:91], v192 offset:4096
s_mov_b32 s90, 8192
MA 136,v,152,v,128
s_mov_b32 s91, 0x20000
v_mov_b32 v252, 0
MA 140,v,156,v,128
buffer_load_dwordx4 v186, s[12:15], s21 offen offset:2048 lds
v_mov_b32 v253, 0
MA 104,v,152,v,124
v_dot2_f32_bf16 v252, v230, v2, v252
v_dot2_f32_bf16 v253, v231, v3, v253
v_dot2_f32_bf16 v252, v232, v4, v252
v_dot2_f32_bf16 v253, v233, v5, v253
v_dot2_f32_bf16 v252, v234, v6, v252
v_dot2_f32_bf16 v253, v235, v7, v253
v_dot2_f32_bf16 v252, v236, v8, v252
v_dot2_f32_bf16 v253, v237, v9, v253
v_dot2_f32_bf16 v252, v238, v12, v252
v_dot2_f32_bf16 v253, v239, v13, v253
v_dot2_f32_bf16 v252, v240, v14, v252
v_dot2_f32_bf16 v253, v241, v15, v253
v_dot2_f32_bf16 v252, v242, v246, v252
v_dot2_f32_bf16 v253, v243, v247, v253
v_dot2_f32_bf16 v252, v244, v248, v252
v_dot2_f32_bf16 v253, v245, v249, v253
MA 108,v,156,v,124
s_nop 2
v_add_f32 v252, v252, v253
MA 72,v,152,v,120
ds_read_b128 v[92:95], v192 offset:6144
MA 76,v,156,v,120
buffer_load_dwordx4 v187, s[12:15], s21 offen offset:3072 lds
v_add_f32_dpp v252, v252, v252 row_ror:8 row_mask:0xf bank_mask:0xf
MA 40,v,152,v,116
s_nop 0
v_add_f32_dpp v252, v252, v252 row_ror:4 row_mask:0xf bank_mask:0xf
s_nop 1
v_add_f32_dpp v252, v252, v252 row_ror:2 row_mask:0xf bank_mask:0xf
MA 44,v,156,v,116
s_nop 0
v_add_f32_dpp v252, v252, v252 row_ror:1 row_mask:0xf bank_mask:0xf
v_mov_b32 v253, v252
MA 8,v,152,v,112
TR 152,198,0
TR 154,198,2048
MA 12,v,156,v,112
TR 156,199,0
TR 158,199,2048
MA 16,v,160,v,112
ds_read_b128 v[96:99], v192 offset:8192
s_add_u32 m0, s23, 36864
MA 20,v,164,v,112
v_permlane16_swap_b32 v252, v253
v_add_f32 v252, v252, v253
MA 48,v,160,v,116
v_mul_f32 v252, 0xbfb8aa3b, v252
MA 52,v,164,v,116
v_exp_f32 v252, v252
MA 80,v,160,v,120
ds_read_b128 v[100:103], v192 offset:10240
buffer_load_dwordx4 v188, s[12:15], s21 offen offset:0 lds
MA 84,v,164,v,120
v_add_f32 v252, 1.0, v252
MA 112,v,160,v,124
v_rcp_f32 v252, v252
MA 116,v,164,v,124
s_nop 0
buffer_store_dword v252, v11, s[88:91], 0 offen sc1
MA 144,v,160,v,128
buffer_load_dwordx4 v189, s[12:15], s21 offen offset:1024 lds
v_lshlrev_b32 v2, 16, v54
MA 148,v,164,v,128
ds_read_b128 v[104:107], v192 offset:12288
v_and_b32 v3, 0xffff0000, v54
MA 176,v,160,v,132
v_lshlrev_b32 v4, 16, v55
v_and_b32 v5, 0xffff0000, v55
MA 180,v,164,v,132
v_lshlrev_b32 v6, 16, v56
v_and_b32 v7, 0xffff0000, v56
MA 208,v,160,v,136
buffer_load_dwordx4 v190, s[12:15], s21 offen offset:2048 lds
v_lshlrev_b32 v8, 16, v57
MA 212,v,164,v,136
v_and_b32 v9, 0xffff0000, v57
v_lshlrev_b32 v230, 16, v16
MA 240,v,160,v,140
TR 160,200,0
TR 162,200,2048
MA 244,v,164,v,140
TR 164,201,0
TR 166,201,2048
MA 248,v,168,v,140
ds_read_b128 v[108:111], v192 offset:14336
v_and_b32 v231, 0xffff0000, v16
MA 252,v,172,v,140
buffer_load_dwordx4 v191, s[12:15], s21 offen offset:3072 lds
v_lshlrev_b32 v232, 16, v18
MA 216,v,168,v,136
v_and_b32 v233, 0xffff0000, v18
v_lshlrev_b32 v234, 16, v20
MA 220,v,172,v,136
v_and_b32 v235, 0xffff0000, v20
v_lshlrev_b32 v236, 16, v22
MA 184,v,168,v,132
v_and_b32 v237, 0xffff0000, v22
v_lshlrev_b32 v238, 16, v24
MA 188,v,172,v,132
s_add_u32 s21, s21, 524288
v_and_b32 v239, 0xffff0000, v24
MA 152,v,168,v,128
v_lshlrev_b32 v240, 16, v26
v_and_b32 v241, 0xffff0000, v26
MA 156,v,172,v,128
v_lshlrev_b32 v242, 16, v28
v_and_b32 v243, 0xffff0000, v28
MA 120,v,168,v,124
v_lshlrev_b32 v244, 16, v30
v_and_b32 v245, 0xffff0000, v30
MA 124,v,172,v,124
s_and_b32 s21, s21, 4194303
v_lshlrev_b32 v246, 16, v32
MA 88,v,168,v,120
v_and_b32 v247, 0xffff0000, v32
v_lshlrev_b32 v248, 16, v34
MA 92,v,172,v,120
v_and_b32 v249, 0xffff0000, v34
v_lshlrev_b32 v250, 16, v36
MA 56,v,168,v,116
v_and_b32 v251, 0xffff0000, v36
v_lshlrev_b32 v254, 16, v38
MA 60,v,172,v,116
v_and_b32 v255, 0xffff0000, v38
v_mul_f32 v62, v236, v2
MA 24,v,168,v,112
TR 168,202,0
TR 170,202,2048
MA 28,v,172,v,112
TR 172,203,0
TR 174,203,2048
v_mul_f32 v70, v237, v6
v_fmac_f32 v62, v234, v3
v_fmac_f32 v70, v235, v7
v_fmac_f32 v62, v232, v4
v_fmac_f32 v70, v233, v8
v_fmac_f32 v62, v230, v5
v_fmac_f32 v70, v231, v9
v_mul_f32 v62, v62, v254
v_mul_f32 v70, v70, v255
v_lshlrev_b32 v254, 16, v40
v_and_b32 v255, 0xffff0000, v40
v_mul_f32 v63, v238, v2
v_mul_f32 v71, v239, v6
v_fmac_f32 v63, v236, v3
v_fmac_f32 v71, v237, v7
v_fmac_f32 v63, v234, v4
v_fmac_f32 v71, v235, v8
v_fmac_f32 v63, v232, v5
v_fmac_f32 v71, v233, v9
s_waitcnt lgkmcnt(4)
MA 0,v,144,v,80
s_add_u32 s75, s64, s74
s_and_b32 s37, s3, 3
MA 4,v,148,v,80
ds_read_b128 v[112:115], v193 offset:0
MA 32,v,144,v,84
s_cmp_eq_u32 s37, 3
s_cselect_b32 s37, 0, 0x40000000
MA 36,v,148,v,84
v_add_u32 v229, s37, v78
buffer_load_dword v79, v229, s[4:7], 0 offen
MA 64,v,144,v,88
s_add_u32 m0, s67, 65536
v_mul_f32 v63, v63, v254
MA 68,v,148,v,88
v_mul_f32 v71, v71, v255
v_lshlrev_b32 v254, 16, v42
MA 96,v,144,v,92
v_and_b32 v255, 0xffff0000, v42
v_mul_f32 v64, v240, v2
MA 100,v,148,v,92
ds_read_b128 v[116:119], v193 offset:2048
v_mul_f32 v72, v241, v6
MA 128,v,144,v,96
buffer_load_dwordx4 v208, s[44:47], s75 offen offset:0 lds
v_fmac_f32 v64, v238, v3
MA 132,v,148,v,96
v_fmac_f32 v72, v239, v7
MA 160,v,144,v,100
v_fmac_f32 v64, v236, v4
v_fmac_f32 v72, v237, v8
MA 164,v,148,v,100
v_fmac_f32 v64, v234, v5
MA 192,v,144,v,104
v_fmac_f32 v72, v235, v9
MA 196,v,148,v,104
ds_read_b128 v[120:123], v193 offset:4096
buffer_load_dwordx4 v209, s[44:47], s75 offen offset:1024 lds
MA 224,v,144,v,108
TR 144,196,16384
TR 146,196,18432
MA 228,v,148,v,108
TR 148,197,16384
TR 150,197,18432
MA 232,v,152,v,108
v_mul_f32 v64, v64, v254
v_mul_f32 v72, v72, v255
MA 236,v,156,v,108
buffer_load_dwordx4 v210, s[44:47], s75 offen offset:2048 lds
v_lshlrev_b32 v254, 16, v44
MA 200,v,152,v,104
v_and_b32 v255, 0xffff0000, v44
v_mul_f32 v65, v242, v2
MA 204,v,156,v,104
v_mul_f32 v73, v243, v6
v_fmac_f32 v65, v240, v3
MA 168,v,152,v,100
ds_read_b128 v[124:127], v193 offset:6144
v_fmac_f32 v73, v241, v7
MA 172,v,156,v,100
v_fmac_f32 v65, v238, v4
v_fmac_f32 v73, v239, v8
MA 136,v,152,v,96
buffer_load_dwordx4 v211, s[44:47], s75 offen offset:3072 lds
v_fmac_f32 v65, v236, v5
MA 140,v,156,v,96
v_fmac_f32 v73, v237, v9
v_mul_f32 v65, v65, v254
MA 104,v,152,v,92
v_mul_f32 v73, v73, v255
v_lshlrev_b32 v254, 16, v46
MA 108,v,156,v,92
v_and_b32 v255, 0xffff0000, v46
v_mul_f32 v66, v244, v2
MA 72,v,152,v,88
ds_read_b128 v[128:131], v193 offset:8192
s_add_u32 s75, s65, s74
MA 76,v,156,v,88
v_mul_f32 v74, v245, v6
v_fmac_f32 v66, v242, v3
MA 40,v,152,v,84
v_fmac_f32 v74, v243, v7
v_fmac_f32 v66, v240, v4
MA 44,v,156,v,84
v_fmac_f32 v74, v241, v8
MA 8,v,152,v,80
TR 152,198,16384
TR 154,198,18432
MA 12,v,156,v,80
TR 156,199,16384
TR 158,199,18432
MA 16,v,160,v,80
ds_read_b128 v[132:135], v193 offset:10240
s_add_u32 m0, s67, 69632
MA 20,v,164,v,80
v_fmac_f32 v66, v238, v5
v_fmac_f32 v74, v239, v9
MA 48,v,160,v,84
v_mul_f32 v66, v66, v254
v_mul_f32 v74, v74, v255
MA 52,v,164,v,84
buffer_load_dwordx4 v208, s[44:47], s75 offen offset:0 lds
v_lshlrev_b32 v254, 16, v48
MA 80,v,160,v,88
v_and_b32 v255, 0xffff0000, v48
v_mul_f32 v67, v246, v2
MA 84,v,164,v,88
v_mul_f32 v75, v247, v6
v_fmac_f32 v67, v244, v3
MA 112,v,160,v,92
v_fmac_f32 v75, v245, v7
v_fmac_f32 v67, v242, v4
MA 116,v,164,v,92
ds_read_b128 v[136:139], v193 offset:12288
buffer_load_dwordx4 v209, s[44:47], s75 offen offset:1024 lds
MA 144,v,160,v,96
v_fmac_f32 v75, v243, v8
v_fmac_f32 v67, v240, v5
MA 148,v,164,v,96
v_fmac_f32 v75, v241, v9
v_mul_f32 v67, v67, v254
MA 176,v,160,v,100
v_mul_f32 v75, v75, v255
v_lshlrev_b32 v254, 16, v50
MA 180,v,164,v,100
v_and_b32 v255, 0xffff0000, v50
MA 208,v,160,v,104
buffer_load_dwordx4 v210, s[44:47], s75 offen offset:2048 lds
s_waitcnt vmcnt(27)
v_mul_f32 v68, v248, v2
MA 212,v,164,v,104
ds_read_b128 v[140:143], v193 offset:14336
v_mul_f32 v76, v249, v6
MA 240,v,160,v,108
TR 160,200,16384
TR 162,200,18432
MA 244,v,164,v,108
TR 164,201,16384
TR 166,201,18432
s_waitcnt lgkmcnt(15)
MA 248,v,168,v,108
buffer_load_dwordx4 v211, s[44:47], s75 offen offset:3072 lds
v_fmac_f32 v68, v246, v3
MA 252,v,172,v,108
v_fmac_f32 v76, v247, v7
v_fmac_f32 v68, v244, v4
MA 216,v,168,v,104
v_fmac_f32 v76, v245, v8
v_fmac_f32 v68, v242, v5
MA 220,v,172,v,104
v_fmac_f32 v76, v243, v9
v_mul_f32 v68, v68, v254
MA 184,v,168,v,100
v_mul_f32 v76, v76, v255
v_lshlrev_b32 v254, 16, v52
MA 188,v,172,v,100
s_add_u32 s74, s74, 128
v_and_b32 v255, 0xffff0000, v52
MA 152,v,168,v,96
v_mul_f32 v69, v250, v2
v_mul_f32 v77, v251, v6
MA 156,v,172,v,96
v_fmac_f32 v69, v248, v3
v_fmac_f32 v77, v249, v7
MA 120,v,168,v,92
v_fmac_f32 v69, v246, v4
MA 124,v,172,v,92
s_and_b32 s74, s74, 2047
v_fmac_f32 v77, v247, v8
MA 88,v,168,v,88
v_fmac_f32 v69, v244, v5
v_fmac_f32 v77, v245, v9
MA 92,v,172,v,88
v_mul_f32 v69, v69, v254
MA 56,v,168,v,84
v_mul_f32 v77, v77, v255
MA 60,v,172,v,84
v_cvt_pk_bf16_f32 v12, v69, v68
MA 24,v,168,v,80
TR 168,202,16384
TR 170,202,18432
MA 28,v,172,v,80
TR 172,203,16384
TR 174,203,18432
s_waitcnt lgkmcnt(4)
MA 0,v,144,v,112
MA 4,v,148,v,112
MA 32,v,144,v,116
MA 36,v,148,v,116
MA 64,v,144,v,120
MA 68,v,148,v,120
MA 96,v,144,v,124
MA 100,v,148,v,124
MA 128,v,144,v,128
MA 132,v,148,v,128
s_waitcnt vmcnt(9) lgkmcnt(0)
s_barrier
MA 160,v,144,v,132
s_add_u32 m0, s68, 98304
v_cvt_pk_bf16_f32 v13, v67, v66
MA 164,v,148,v,132
ds_read_b128 v[80:83], v192 offset:32768
v_cvt_pk_bf16_f32 v14, v65, v64
MA 192,v,144,v,136
v_cvt_pk_bf16_f32 v15, v63, v62
s_mov_b32 s36, 0
MA 196,v,148,v,136
buffer_load_dwordx4 v212, s[48:51], s66 offen offset:0 lds
buffer_store_dwordx4 v[12:15], v10, s[84:87], s36 offen sc1
MA 224,v,144,v,140
TR 144,196,32768
TR 146,196,34816
MA 228,v,148,v,140
TR 148,197,32768
TR 150,197,34816
MA 232,v,152,v,140
ds_read_b128 v[84:87], v192 offset:34816
v_cvt_pk_bf16_f32 v54, v77, v76
MA 236,v,156,v,140
buffer_load_dwordx4 v213, s[48:51], s66 offen offset:1024 lds
v_cvt_pk_bf16_f32 v55, v75, v74
MA 200,v,152,v,136
v_cvt_pk_bf16_f32 v56, v73, v72
v_cvt_pk_bf16_f32 v57, v71, v70
MA 204,v,156,v,136
s_mov_b32 s36, 4096
buffer_store_dwordx4 v[54:57], v10, s[84:87], s36 offen sc1
MA 168,v,152,v,132
v_lshlrev_b32 v2, 16, v58
v_and_b32 v3, 0xffff0000, v58
MA 172,v,156,v,132
ds_read_b128 v[88:91], v192 offset:36864
buffer_load_dwordx4 v214, s[48:51], s66 offen offset:2048 lds
MA 136,v,152,v,128
v_lshlrev_b32 v4, 16, v59
v_and_b32 v5, 0xffff0000, v59
MA 140,v,156,v,128
v_lshlrev_b32 v6, 16, v60
v_and_b32 v7, 0xffff0000, v60
MA 104,v,152,v,124
buffer_load_dwordx4 v215, s[48:51], s66 offen offset:3072 lds
v_lshlrev_b32 v8, 16, v61
MA 108,v,156,v,124
v_and_b32 v9, 0xffff0000, v61
v_lshlrev_b32 v230, 16, v17
MA 72,v,152,v,120
ds_read_b128 v[92:95], v192 offset:38912
v_and_b32 v231, 0xffff0000, v17
MA 76,v,156,v,120
v_lshlrev_b32 v232, 16, v19
v_and_b32 v233, 0xffff0000, v19
MA 40,v,152,v,116
s_add_u32 s66, s66, 524288
v_lshlrev_b32 v234, 16, v21
MA 44,v,156,v,116
v_and_b32 v235, 0xffff0000, v21
v_lshlrev_b32 v236, 16, v23
MA 8,v,152,v,112
TR 152,198,32768
TR 154,198,34816
MA 12,v,156,v,112
TR 156,199,32768
TR 158,199,34816
MA 16,v,160,v,112
ds_read_b128 v[96:99], v192 offset:40960
s_and_b32 s66, s66, 8388607
MA 20,v,164,v,112
v_and_b32 v237, 0xffff0000, v23
v_lshlrev_b32 v238, 16, v25
MA 48,v,160,v,116
v_and_b32 v239, 0xffff0000, v25
v_lshlrev_b32 v240, 16, v27
MA 52,v,164,v,116
v_and_b32 v241, 0xffff0000, v27
v_lshlrev_b32 v242, 16, v29
MA 80,v,160,v,120
ds_read_b128 v[100:103], v192 offset:43008
s_add_u32 m0, s68, 114688
MA 84,v,164,v,120
v_and_b32 v243, 0xffff0000, v29
v_lshlrev_b32 v244, 16, v31
MA 112,v,160,v,124
v_and_b32 v245, 0xffff0000, v31
v_lshlrev_b32 v246, 16, v33
MA 116,v,164,v,124
buffer_load_dwordx4 v212, s[48:51], s66 offen offset:0 lds
v_and_b32 v247, 0xffff0000, v33
MA 144,v,160,v,128
v_lshlrev_b32 v248, 16, v35
v_and_b32 v249, 0xffff0000, v35
MA 148,v,164,v,128
ds_read_b128 v[104:107], v192 offset:45056
v_lshlrev_b32 v250, 16, v37
MA 176,v,160,v,132
v_and_b32 v251, 0xffff0000, v37
v_lshlrev_b32 v254, 16, v39
MA 180,v,164,v,132
buffer_load_dwordx4 v213, s[48:51], s66 offen offset:1024 lds
v_and_b32 v255, 0xffff0000, v39
MA 208,v,160,v,136
v_mul_f32 v62, v236, v2
v_mul_f32 v70, v237, v6
MA 212,v,164,v,136
v_fmac_f32 v62, v234, v3
v_fmac_f32 v70, v235, v7
MA 240,v,160,v,140
TR 160,200,32768
TR 162,200,34816
MA 244,v,164,v,140
TR 164,201,32768
TR 166,201,34816
MA 248,v,168,v,140
ds_read_b128 v[108:111], v192 offset:47104
buffer_load_dwordx4 v214, s[48:51], s66 offen offset:2048 lds
MA 252,v,172,v,140
v_fmac_f32 v62, v232, v4
v_fmac_f32 v70, v233, v8
MA 216,v,168,v,136
buffer_load_dwordx4 v215, s[48:51], s66 offen offset:3072 lds
v_fmac_f32 v62, v230, v5
MA 220,v,172,v,136
v_fmac_f32 v70, v231, v9
v_mul_f32 v62, v62, v254
MA 184,v,168,v,132
v_mul_f32 v70, v70, v255
v_lshlrev_b32 v254, 16, v41
MA 188,v,172,v,132
v_and_b32 v255, 0xffff0000, v41
v_mul_f32 v63, v238, v2
MA 152,v,168,v,128
s_add_u32 s66, s66, 524288
v_mul_f32 v71, v239, v6
MA 156,v,172,v,128
v_fmac_f32 v63, v236, v3
v_fmac_f32 v71, v237, v7
MA 120,v,168,v,124
v_fmac_f32 v63, v234, v4
v_fmac_f32 v71, v235, v8
MA 124,v,172,v,124
v_fmac_f32 v63, v232, v5
v_fmac_f32 v71, v233, v9
MA 88,v,168,v,120
s_and_b32 s66, s66, 8388607
v_mul_f32 v63, v63, v254
MA 92,v,172,v,120
v_mul_f32 v71, v71, v255
v_lshlrev_b32 v254, 16, v43
MA 56,v,168,v,116
v_and_b32 v255, 0xffff0000, v43
v_mul_f32 v64, v240, v2
MA 60,v,172,v,116
v_mul_f32 v72, v241, v6
v_fmac_f32 v64, v238, v3
MA 24,v,168,v,112
TR 168,202,32768
TR 170,202,34816
MA 28,v,172,v,112
TR 172,203,32768
TR 174,203,34816
v_fmac_f32 v72, v239, v7
v_fmac_f32 v64, v236, v4
v_fmac_f32 v72, v237, v8
v_fmac_f32 v64, v234, v5
s_waitcnt lgkmcnt(4)
MA 0,v,144,v,80
s_add_u32 s75, s64, s74
v_fmac_f32 v72, v235, v9
MA 4,v,148,v,80
ds_read_b128 v[112:115], v193 offset:32768
v_mul_f32 v64, v64, v254
MA 32,v,144,v,84
v_mul_f32 v72, v72, v255
v_lshlrev_b32 v254, 16, v45
MA 36,v,148,v,84
v_and_b32 v255, 0xffff0000, v45
MA 64,v,144,v,88
s_add_u32 m0, s67, 0
v_mul_f32 v65, v242, v2
MA 68,v,148,v,88
v_mul_f32 v73, v243, v6
v_fmac_f32 v65, v240, v3
MA 96,v,144,v,92
v_fmac_f32 v73, v241, v7
MA 100,v,148,v,92
ds_read_b128 v[116:119], v193 offset:34816
v_fmac_f32 v65, v238, v4
MA 128,v,144,v,96
buffer_load_dwordx4 v208, s[44:47], s75 offen offset:0 lds
v_fmac_f32 v73, v239, v8
MA 132,v,148,v,96
v_fmac_f32 v65, v236, v5
v_fmac_f32 v73, v237, v9
MA 160,v,144,v,100
v_mul_f32 v65, v65, v254
MA 164,v,148,v,100
v_mul_f32 v73, v73, v255
MA 192,v,144,v,104
v_lshlrev_b32 v254, 16, v47
MA 196,v,148,v,104
ds_read_b128 v[120:123], v193 offset:36864
buffer_load_dwordx4 v209, s[44:47], s75 offen offset:1024 lds
MA 224,v,144,v,108
TR 144,196,49152
TR 146,196,51200
MA 228,v,148,v,108
TR 148,197,49152
TR 150,197,51200
MA 232,v,152,v,108
v_and_b32 v255, 0xffff0000, v47
v_mul_f32 v66, v244, v2
MA 236,v,156,v,108
buffer_load_dwordx4 v210, s[44:47], s75 offen offset:2048 lds
v_mul_f32 v74, v245, v6
MA 200,v,152,v,104
v_fmac_f32 v66, v242, v3
v_fmac_f32 v74, v243, v7
MA 204,v,156,v,104
v_fmac_f32 v66, v240, v4
v_fmac_f32 v74, v241, v8
MA 168,v,152,v,100
ds_read_b128 v[124:127], v193 offset:38912
v_fmac_f32 v66, v238, v5
MA 172,v,156,v,100
v_fmac_f32 v74, v239, v9
v_mul_f32 v66, v66, v254
MA 136,v,152,v,96
buffer_load_dwordx4 v211, s[44:47], s75 offen offset:3072 lds
v_mul_f32 v74, v74, v255
MA 140,v,156,v,96
v_lshlrev_b32 v254, 16, v49
v_and_b32 v255, 0xffff0000, v49
MA 104,v,152,v,92
v_mul_f32 v67, v246, v2
v_mul_f32 v75, v247, v6
MA 108,v,156,v,92
v_fmac_f32 v67, v244, v3
MA 72,v,152,v,88
ds_read_b128 v[128:131], v193 offset:40960
s_add_u32 s75, s65, s74
MA 76,v,156,v,88
v_fmac_f32 v75, v245, v7
v_fmac_f32 v67, v242, v4
MA 40,v,152,v,84
v_fmac_f32 v75, v243, v8
v_fmac_f32 v67, v240, v5
MA 44,v,156,v,84
v_fmac_f32 v75, v241, v9
MA 8,v,152,v,80
TR 152,198,49152
TR 154,198,51200
MA 12,v,156,v,80
TR 156,199,49152
TR 158,199,51200
MA 16,v,160,v,80
ds_read_b128 v[132:135], v193 offset:43008
s_add_u32 m0, s67, 4096
MA 20,v,164,v,80
v_mul_f32 v67, v67, v254
v_mul_f32 v75, v75, v255
MA 48,v,160,v,84
v_lshlrev_b32 v254, 16, v51
v_and_b32 v255, 0xffff0000, v51
MA 52,v,164,v,84
buffer_load_dwordx4 v208, s[44:47], s75 offen offset:0 lds
v_mul_f32 v68, v248, v2
MA 80,v,160,v,88
v_mul_f32 v76, v249, v6
v_fmac_f32 v68, v246, v3
MA 84,v,164,v,88
v_fmac_f32 v76, v247, v7
v_fmac_f32 v68, v244, v4
MA 112,v,160,v,92
v_fmac_f32 v76, v245, v8
v_fmac_f32 v68, v242, v5
MA 116,v,164,v,92
ds_read_b128 v[136:139], v193 offset:45056
buffer_load_dwordx4 v209, s[44:47], s75 offen offset:1024 lds
MA 144,v,160,v,96
v_fmac_f32 v76, v243, v9
v_mul_f32 v68, v68, v254
MA 148,v,164,v,96
v_mul_f32 v76, v76, v255
v_lshlrev_b32 v254, 16, v53
MA 176,v,160,v,100
v_and_b32 v255, 0xffff0000, v53
MA 180,v,164,v,100
v_mul_f32 v69, v250, v2
MA 208,v,160,v,104
buffer_load_dwordx4 v210, s[44:47], s75 offen offset:2048 lds
v_mul_f32 v77, v251, v6
MA 212,v,164,v,104
ds_read_b128 v[140:143], v193 offset:47104
v_fmac_f32 v69, v248, v3
MA 240,v,160,v,108
TR 160,200,49152
TR 162,200,51200
MA 244,v,164,v,108
TR 164,201,49152
TR 166,201,51200
s_waitcnt lgkmcnt(15)
MA 248,v,168,v,108
buffer_load_dwordx4 v211, s[44:47], s75 offen offset:3072 lds
v_fmac_f32 v77, v249, v7
MA 252,v,172,v,108
v_fmac_f32 v69, v246, v4
v_fmac_f32 v77, v247, v8
MA 216,v,168,v,104
v_fmac_f32 v69, v244, v5
v_fmac_f32 v77, v245, v9
MA 220,v,172,v,104
v_mul_f32 v69, v69, v254
v_mul_f32 v77, v77, v255
MA 184,v,168,v,100
v_cvt_pk_bf16_f32 v230, v69, v68
v_cvt_pk_bf16_f32 v231, v67, v66
MA 188,v,172,v,100
s_add_u32 s74, s74, 128
v_cvt_pk_bf16_f32 v232, v65, v64
MA 152,v,168,v,96
v_cvt_pk_bf16_f32 v233, v63, v62
s_mov_b32 s36, 8192
MA 156,v,172,v,96
buffer_store_dwordx4 v[230:233], v10, s[84:87], s36 offen sc1
MA 120,v,168,v,92
v_cvt_pk_bf16_f32 v234, v77, v76
MA 124,v,172,v,92
s_and_b32 s74, s74, 2047
v_cvt_pk_bf16_f32 v235, v75, v74
MA 88,v,168,v,88
v_cvt_pk_bf16_f32 v236, v73, v72
v_cvt_pk_bf16_f32 v237, v71, v70
MA 92,v,172,v,88
s_mov_b32 s36, 12288
MA 56,v,168,v,84
buffer_store_dwordx4 v[234:237], v10, s[84:87], s36 offen sc1
MA 60,v,172,v,84
v_lshlrev_b32 v228, 4, v1
MA 24,v,168,v,80
TR 168,202,49152
TR 170,202,51200
MA 28,v,172,v,80
TR 172,203,49152
TR 174,203,51200
s_waitcnt lgkmcnt(4)
MA 0,v,144,v,112
MA 4,v,148,v,112
MA 32,v,144,v,116
MA 36,v,148,v,116
MA 64,v,144,v,120
MA 68,v,148,v,120
MA 96,v,144,v,124
MA 100,v,148,v,124
MA 128,v,144,v,128
MA 132,v,148,v,128
s_waitcnt vmcnt(14) lgkmcnt(0)
s_barrier
MA 160,v,144,v,132
ds_read_b128 v[48:51], v226 offset:0
s_add_u32 m0, s68, 131072
MA 164,v,148,v,132
MA 192,v,144,v,136
ds_read_b128 v[52:55], v226 offset:2048
buffer_load_dwordx4 v212, s[48:51], s66 offen offset:0 lds
MA 196,v,148,v,136
MA 224,v,144,v,140
ds_read_b128 v[56:59], v226 offset:4096
buffer_load_dwordx4 v213, s[48:51], s66 offen offset:1024 lds
MA 228,v,148,v,140
MA 232,v,152,v,140
ds_read_b128 v[60:63], v226 offset:6144
MA 236,v,156,v,140
buffer_load_dwordx4 v214, s[48:51], s66 offen offset:2048 lds
MA 200,v,152,v,136
TR 16,216,0
MA 204,v,156,v,136
buffer_load_dwordx4 v215, s[48:51], s66 offen offset:3072 lds
MA 168,v,152,v,132
TR 18,216,1024
MA 172,v,156,v,132
MA 136,v,152,v,128
TR 20,217,0
s_add_u32 s66, s66, 524288
MA 140,v,156,v,128
MA 104,v,152,v,124
TR 22,217,1024
s_and_b32 s66, s66, 8388607
MA 108,v,156,v,124
MA 72,v,152,v,120
TR 24,218,0
MA 76,v,156,v,120
s_add_u32 s75, s64, s74
MA 40,v,152,v,116
TR 26,218,1024
MA 44,v,156,v,116
s_add_u32 m0, s67, 32768
MA 8,v,152,v,112
TR 28,219,0
MA 12,v,156,v,112
MA 16,v,160,v,112
TR 30,219,1024
buffer_load_dwordx4 v208, s[44:47], s75 offen offset:0 lds
MA 20,v,164,v,112
MA 48,v,160,v,116
TR 32,220,0
buffer_load_dwordx4 v209, s[44:47], s75 offen offset:1024 lds
MA 52,v,164,v,116
MA 80,v,160,v,120
TR 34,220,1024
MA 84,v,164,v,120
buffer_load_dwordx4 v210, s[44:47], s75 offen offset:2048 lds
MA 112,v,160,v,124
TR 36,221,0
MA 116,v,164,v,124
buffer_load_dwordx4 v211, s[44:47], s75 offen offset:3072 lds
MA 144,v,160,v,128
TR 38,221,1024
MA 148,v,164,v,128
MA 176,v,160,v,132
TR 40,222,0
s_add_u32 s75, s65, s74
MA 180,v,164,v,132
MA 208,v,160,v,136
TR 42,222,1024
s_add_u32 m0, s67, 36864
MA 212,v,164,v,136
MA 240,v,160,v,140
TR 44,223,0
MA 244,v,164,v,140
buffer_load_dwordx4 v208, s[44:47], s75 offen offset:0 lds
MA 248,v,168,v,140
TR 46,223,1024
MA 252,v,172,v,140
buffer_load_dwordx4 v209, s[44:47], s75 offen offset:1024 lds
MA 216,v,168,v,136
MA 220,v,172,v,136
MA 184,v,168,v,132
buffer_load_dwordx4 v210, s[44:47], s75 offen offset:2048 lds
MA 188,v,172,v,132
MA 152,v,168,v,128
buffer_load_dwordx4 v211, s[44:47], s75 offen offset:3072 lds
MA 156,v,172,v,128
MA 120,v,168,v,124
MA 124,v,172,v,124
s_add_u32 s74, s74, 128
MA 88,v,168,v,120
MA 92,v,172,v,120
s_and_b32 s74, s74, 2047
MA 56,v,168,v,116
MA 60,v,172,v,116
MA 24,v,168,v,112
MA 28,v,172,v,112
s_branch L_p2
L_p1_V:
s_waitcnt lgkmcnt(14)
v_mfma_f32_16x16x32_bf16 a[0:3], v[80:83], v[144:147], 0
s_add_u32 m0, s22, 32768
s_mov_b32 s86, 4194304
s_waitcnt lgkmcnt(12)
v_mfma_f32_16x16x32_bf16 a[8:11], v[80:83], v[148:151], 0
ds_read_b128 v[112:115], v193 offset:0
s_mov_b32 s87, 0x20000
v_mfma_f32_16x16x32_bf16 a[4:7], v[84:87], v[144:147], 0
v_mfma_f32_16x16x32_bf16 a[12:15], v[84:87], v[148:151], 0
s_mov_b32 s90, 4194304
v_mfma_f32_16x16x32_bf16 a[64:67], v[88:91], v[144:147], 0
s_mov_b32 s91, 0x20000
v_mfma_f32_16x16x32_bf16 a[72:75], v[88:91], v[148:151], 0
buffer_load_dwordx4 v176, s[8:11], s20 offen offset:0 lds
v_mfma_f32_16x16x32_bf16 a[68:71], v[92:95], v[144:147], 0
s_mov_b32 s94, 4194304
v_mfma_f32_16x16x32_bf16 a[76:79], v[92:95], v[148:151], 0
ds_read_b128 v[116:119], v193 offset:2048
s_mov_b32 s95, 0x20000
v_mfma_f32_16x16x32_bf16 a[128:131], v[96:99], v[144:147], 0
v_mfma_f32_16x16x32_bf16 a[136:139], v[96:99], v[148:151], 0
s_mov_b32 s98, 8192
v_mfma_f32_16x16x32_bf16 a[132:135], v[100:103], v[144:147], 0
buffer_load_dwordx4 v177, s[8:11], s20 offen offset:1024 lds
s_mov_b32 s99, 0x20000
v_mfma_f32_16x16x32_bf16 a[140:143], v[100:103], v[148:151], 0
v_mfma_f32_16x16x32_bf16 a[192:195], v[104:107], v[144:147], 0
s_mov_b32 s78, 2048
v_mfma_f32_16x16x32_bf16 a[200:203], v[104:107], v[148:151], 0
ds_read_b128 v[120:123], v193 offset:4096
s_mov_b32 s79, 0x20000
v_mfma_f32_16x16x32_bf16 a[196:199], v[108:111], v[144:147], 0
TR 144,196,16384
TR 146,196,18432
v_mfma_f32_16x16x32_bf16 a[204:207], v[108:111], v[148:151], 0
TR 148,197,16384
TR 150,197,18432
s_waitcnt lgkmcnt(15)
v_mfma_f32_16x16x32_bf16 a[212:215], v[108:111], v[152:155], 0
buffer_load_dwordx4 v178, s[8:11], s20 offen offset:2048 lds
s_and_b32 s36, s2, 15
v_mfma_f32_16x16x32_bf16 a[220:223], v[108:111], v[156:159], 0
s_lshl_b32 s36, s36, 1
v_mfma_f32_16x16x32_bf16 a[208:211], v[104:107], v[152:155], 0
s_lshr_b32 s37, s3, 1
v_mfma_f32_16x16x32_bf16 a[216:219], v[104:107], v[156:159], 0
s_add_u32 s36, s36, s37
v_mfma_f32_16x16x32_bf16 a[148:151], v[100:103], v[152:155], 0
ds_read_b128 v[124:127], v193 offset:6144
buffer_load_dwordx4 v179, s[8:11], s20 offen offset:3072 lds
v_mfma_f32_16x16x32_bf16 a[156:159], v[100:103], v[156:159], 0
s_lshl_b32 s36, s36, 3
v_mfma_f32_16x16x32_bf16 a[144:147], v[96:99], v[152:155], 0
v_and_b32 v252, 7, v1
v_mfma_f32_16x16x32_bf16 a[152:155], v[96:99], v[156:159], 0
v_mfma_f32_16x16x32_bf16 a[84:87], v[92:95], v[152:155], 0
v_add_u32 v252, s36, v252
v_mfma_f32_16x16x32_bf16 a[92:95], v[92:95], v[156:159], 0
s_add_u32 m0, s22, 36864
s_lshr_b32 s36, s2, 4
v_mfma_f32_16x16x32_bf16 a[80:83], v[88:91], v[152:155], 0
ds_read_b128 v[128:131], v193 offset:8192
v_mfma_f32_16x16x32_bf16 a[88:91], v[88:91], v[156:159], 0
s_lshl_b32 s36, s36, 1
v_mfma_f32_16x16x32_bf16 a[20:23], v[84:87], v[152:155], 0
s_and_b32 s37, s3, 1
v_mfma_f32_16x16x32_bf16 a[28:31], v[84:87], v[156:159], 0
v_mfma_f32_16x16x32_bf16 a[16:19], v[80:83], v[152:155], 0
TR 152,198,16384
TR 154,198,18432
v_mfma_f32_16x16x32_bf16 a[24:27], v[80:83], v[156:159], 0
TR 156,199,16384
TR 158,199,18432
s_waitcnt lgkmcnt(15)
v_mfma_f32_16x16x32_bf16 a[32:35], v[80:83], v[160:163], 0
ds_read_b128 v[132:135], v193 offset:10240
buffer_load_dwordx4 v180, s[8:11], s20 offen offset:0 lds
v_mfma_f32_16x16x32_bf16 a[40:43], v[80:83], v[164:167], 0
s_add_u32 s36, s36, s37
s_lshl_b32 s36, s36, 3
v_mfma_f32_16x16x32_bf16 a[36:39], v[84:87], v[160:163], 0
v_lshrrev_b32 v253, 3, v1
v_add_u32 v253, s36, v253
v_mfma_f32_16x16x32_bf16 a[44:47], v[84:87], v[164:167], 0
v_mfma_f32_16x16x32_bf16 a[96:99], v[88:91], v[160:163], 0
buffer_load_dwordx4 v181, s[8:11], s20 offen offset:1024 lds
v_lshlrev_b32 v254, 14, v253
v_mfma_f32_16x16x32_bf16 a[104:107], v[88:91], v[164:167], 0
v_lshl_add_u32 v254, v252, 3, v254
v_mfma_f32_16x16x32_bf16 a[100:103], v[92:95], v[160:163], 0
v_mfma_f32_16x16x32_bf16 a[108:111], v[92:95], v[164:167], 0
ds_read_b128 v[136:139], v193 offset:12288
v_add_u32 v229, -6144, v254
v_mfma_f32_16x16x32_bf16 a[160:163], v[96:99], v[160:163], 0
v_lshlrev_b32 v62, 5, v252
v_mfma_f32_16x16x32_bf16 a[168:171], v[96:99], v[164:167], 0
buffer_load_dwordx4 v182, s[8:11], s20 offen offset:2048 lds
v_mfma_f32_16x16x32_bf16 a[164:167], v[100:103], v[160:163], 0
v_lshlrev_b32 v254, 4, v253
v_mfma_f32_16x16x32_bf16 a[172:175], v[100:103], v[164:167], 0
v_sub_u32 v254, 4080, v254
v_mfma_f32_16x16x32_bf16 a[224:227], v[104:107], v[160:163], 0
v_mfma_f32_16x16x32_bf16 a[232:235], v[104:107], v[164:167], 0
ds_read_b128 v[140:143], v193 offset:14336
v_lshl_add_u32 v10, v252, 14, v254
v_mfma_f32_16x16x32_bf16 a[228:231], v[108:111], v[160:163], 0
TR 160,200,16384
TR 162,200,18432
v_mfma_f32_16x16x32_bf16 a[236:239], v[108:111], v[164:167], 0
TR 164,201,16384
TR 166,201,18432
v_mfma_f32_16x16x32_bf16 a[244:247], v[108:111], v[168:171], 0
buffer_load_dwordx4 v183, s[8:11], s20 offen offset:3072 lds
v_and_b32 v252, 31, v1
s_waitcnt lgkmcnt(15)
v_mfma_f32_16x16x32_bf16 a[252:255], v[108:111], v[172:175], 0
v_lshlrev_b32 v64, 4, v252
s_lshl_b32 s36, s2, 2
v_mfma_f32_16x16x32_bf16 a[240:243], v[104:107], v[168:171], 0
v_mfma_f32_16x16x32_bf16 a[248:251], v[104:107], v[172:175], 0
s_add_u32 s20, s20, 128
s_add_u32 s36, s36, s3
v_mfma_f32_16x16x32_bf16 a[180:183], v[100:103], v[168:171], 0
s_lshl_b32 s36, s36, 1
v_mfma_f32_16x16x32_bf16 a[188:191], v[100:103], v[172:175], 0
v_mfma_f32_16x16x32_bf16 a[176:179], v[96:99], v[168:171], 0
v_lshrrev_b32 v253, 5, v1
v_mfma_f32_16x16x32_bf16 a[184:187], v[96:99], v[172:175], 0
v_add_u32 v253, s36, v253
v_mfma_f32_16x16x32_bf16 a[116:119], v[92:95], v[168:171], 0
s_and_b32 s20, s20, 1023
v_mfma_f32_16x16x32_bf16 a[124:127], v[92:95], v[172:175], 0
v_lshl_add_u32 v63, v253, 11, v64
v_mfma_f32_16x16x32_bf16 a[112:115], v[88:91], v[168:171], 0
v_lshlrev_b32 v253, 2, v253
v_mfma_f32_16x16x32_bf16 a[120:123], v[88:91], v[172:175], 0
v_mfma_f32_16x16x32_bf16 a[52:55], v[84:87], v[168:171], 0
v_lshl_add_u32 v11, v252, 20, v253
v_mfma_f32_16x16x32_bf16 a[60:63], v[84:87], v[172:175], 0
v_mfma_f32_16x16x32_bf16 a[48:51], v[80:83], v[168:171], 0
TR 168,202,16384
TR 170,202,18432
v_mfma_f32_16x16x32_bf16 a[56:59], v[80:83], v[172:175], 0
TR 172,203,16384
TR 174,203,18432
s_waitcnt lgkmcnt(4)
MA 0,v,112,v,144
s_add_u32 m0, s22, 65536
MA 8,v,112,v,148
MA 4,v,116,v,144
buffer_load_dwordx4 v176, s[8:11], s20 offen offset:0 lds
MA 12,v,116,v,148
MA 64,v,120,v,144
buffer_load_dwordx4 v177, s[8:11], s20 offen offset:1024 lds
MA 72,v,120,v,148
MA 68,v,124,v,144
MA 76,v,124,v,148
buffer_load_dwordx4 v178, s[8:11], s20 offen offset:2048 lds
MA 128,v,128,v,144
MA 136,v,128,v,148
buffer_load_dwordx4 v179, s[8:11], s20 offen offset:3072 lds
MA 132,v,132,v,144
MA 140,v,132,v,148
MA 192,v,136,v,144
s_add_u32 m0, s22, 69632
MA 200,v,136,v,148
MA 196,v,140,v,144
buffer_load_dwordx4 v180, s[8:11], s20 offen offset:0 lds
MA 204,v,140,v,148
MA 212,v,140,v,152
buffer_load_dwordx4 v181, s[8:11], s20 offen offset:1024 lds
MA 220,v,140,v,156
MA 208,v,136,v,152
MA 216,v,136,v,156
buffer_load_dwordx4 v182, s[8:11], s20 offen offset:2048 lds
MA 148,v,132,v,152
MA 156,v,132,v,156
buffer_load_dwordx4 v183, s[8:11], s20 offen offset:3072 lds
MA 144,v,128,v,152
MA 152,v,128,v,156
MA 84,v,124,v,152
s_add_u32 s20, s20, 128
MA 92,v,124,v,156
MA 80,v,120,v,152
s_and_b32 s20, s20, 1023
MA 88,v,120,v,156
MA 20,v,116,v,152
MA 28,v,116,v,156
MA 16,v,112,v,152
s_waitcnt vmcnt(8) lgkmcnt(0)
s_barrier
MA 24,v,112,v,156
TR 144,196,32768
TR 146,196,34816
MA 32,v,112,v,160
ds_read_b128 v[80:83], v192 offset:32768
s_add_u32 m0, s23, 0
MA 40,v,112,v,164
TR 148,197,32768
TR 150,197,34816
MA 36,v,116,v,160
ds_read_b128 v[84:87], v192 offset:34816
buffer_load_dwordx4 v184, s[12:15], s21 offen offset:0 lds
MA 44,v,116,v,164
TR 152,198,32768
TR 154,198,34816
MA 96,v,120,v,160
buffer_load_dwordx4 v185, s[12:15], s21 offen offset:1024 lds
MA 104,v,120,v,164
TR 156,199,32768
TR 158,199,34816
MA 100,v,124,v,160
ds_read_b128 v[88:91], v192 offset:36864
buffer_load_dwordx4 v186, s[12:15], s21 offen offset:2048 lds
MA 108,v,124,v,164
ds_read_b128 v[92:95], v192 offset:38912
MA 160,v,128,v,160
MA 168,v,128,v,164
buffer_load_dwordx4 v187, s[12:15], s21 offen offset:3072 lds
MA 164,v,132,v,160
ds_read_b128 v[96:99], v192 offset:40960
MA 172,v,132,v,164
s_add_u32 m0, s23, 4096
MA 224,v,136,v,160
ds_read_b128 v[100:103], v192 offset:43008
MA 232,v,136,v,164
MA 228,v,140,v,160
TR 160,200,32768
TR 162,200,34816
MA 236,v,140,v,164
TR 164,201,32768
TR 166,201,34816
MA 244,v,140,v,168
ds_read_b128 v[104:107], v192 offset:45056
buffer_load_dwordx4 v188, s[12:15], s21 offen offset:0 lds
MA 252,v,140,v,172
ds_read_b128 v[108:111], v192 offset:47104
buffer_load_dwordx4 v189, s[12:15], s21 offen offset:1024 lds
MA 240,v,136,v,168
MA 248,v,136,v,172
buffer_load_dwordx4 v190, s[12:15], s21 offen offset:2048 lds
MA 180,v,132,v,168
MA 188,v,132,v,172
MA 176,v,128,v,168
buffer_load_dwordx4 v191, s[12:15], s21 offen offset:3072 lds
MA 184,v,128,v,172
MA 116,v,124,v,168
s_add_u32 s21, s21, 524288
MA 124,v,124,v,172
MA 112,v,120,v,168
MA 120,v,120,v,172
s_and_b32 s21, s21, 4194303
MA 52,v,116,v,168
MA 60,v,116,v,172
MA 48,v,112,v,168
TR 168,202,32768
TR 170,202,34816
MA 56,v,112,v,172
TR 172,203,32768
TR 174,203,34816
s_waitcnt lgkmcnt(4)
MA 0,v,80,v,144
s_add_u32 m0, s22, 0
buffer_load_dwordx4 v[230:233], v63, s[92:95], 0 offen offset:0
MA 8,v,80,v,148
ds_read_b128 v[112:115], v193 offset:32768
MA 4,v,84,v,144
MA 12,v,84,v,148
MA 64,v,88,v,144
MA 72,v,88,v,148
buffer_load_dwordx4 v176, s[8:11], s20 offen offset:0 lds
MA 68,v,92,v,144
buffer_load_dwordx4 v[2:5], v64, s[76:79], 0 offen offset:0
MA 76,v,92,v,148
ds_read_b128 v[116:119], v193 offset:34816
MA 128,v,96,v,144
MA 136,v,96,v,148
MA 132,v,100,v,144
buffer_load_dwordx4 v177, s[8:11], s20 offen offset:1024 lds
MA 140,v,100,v,148
MA 192,v,104,v,144
buffer_load_dwordx4 v[234:237], v63, s[92:95], 0 offen offset:512
MA 200,v,104,v,148
ds_read_b128 v[120:123], v193 offset:36864
MA 196,v,108,v,144
TR 144,196,49152
TR 146,196,51200
MA 204,v,108,v,148
TR 148,197,49152
TR 150,197,51200
MA 212,v,108,v,152
buffer_load_dwordx4 v178, s[8:11], s20 offen offset:2048 lds
MA 220,v,108,v,156
MA 208,v,104,v,152
buffer_load_dwordx4 v[6:9], v64, s[76:79], 0 offen offset:512
MA 216,v,104,v,156
MA 148,v,100,v,152
ds_read_b128 v[124:127], v193 offset:38912
buffer_load_dwordx4 v179, s[8:11], s20 offen offset:3072 lds
MA 156,v,100,v,156
MA 144,v,96,v,152
MA 152,v,96,v,156
MA 84,v,92,v,152
buffer_load_dwordx4 v[238:241], v63, s[92:95], 0 offen offset:1024
MA 92,v,92,v,156
s_add_u32 m0, s22, 4096
MA 80,v,88,v,152
ds_read_b128 v[128:131], v193 offset:40960
MA 88,v,88,v,156
MA 20,v,84,v,152
MA 28,v,84,v,156
MA 16,v,80,v,152
TR 152,198,49152
TR 154,198,51200
MA 24,v,80,v,156
TR 156,199,49152
TR 158,199,51200
MA 32,v,80,v,160
ds_read_b128 v[132:135], v193 offset:43008
buffer_load_dwordx4 v180, s[8:11], s20 offen offset:0 lds
MA 40,v,80,v,164
buffer_load_dwordx4 v[12:15], v64, s[76:79], 0 offen offset:1024
MA 36,v,84,v,160
MA 44,v,84,v,164
MA 96,v,88,v,160
buffer_load_dwordx4 v181, s[8:11], s20 offen offset:1024 lds
MA 104,v,88,v,164
buffer_load_dwordx4 v[242:245], v63, s[92:95], 0 offen offset:1536
MA 100,v,92,v,160
MA 108,v,92,v,164
ds_read_b128 v[136:139], v193 offset:45056
MA 160,v,96,v,160
MA 168,v,96,v,164
buffer_load_dwordx4 v182, s[8:11], s20 offen offset:2048 lds
MA 164,v,100,v,160
MA 172,v,100,v,164
buffer_load_dwordx4 v[246:249], v64, s[76:79], 0 offen offset:1536
MA 224,v,104,v,160
MA 232,v,104,v,164
ds_read_b128 v[140:143], v193 offset:47104
MA 228,v,108,v,160
TR 160,200,49152
TR 162,200,51200
MA 236,v,108,v,164
TR 164,201,49152
TR 166,201,51200
s_waitcnt lgkmcnt(15)
MA 244,v,108,v,168
buffer_load_dwordx4 v183, s[8:11], s20 offen offset:3072 lds
MA 252,v,108,v,172
buffer_load_dwordx4 v[54:57], v62, s[96:99], 0 offen offset:0
MA 240,v,104,v,168
MA 248,v,104,v,172
s_add_u32 s20, s20, 128
MA 180,v,100,v,168
MA 188,v,100,v,172
MA 176,v,96,v,168
MA 184,v,96,v,172
buffer_load_dwordx4 v[58:61], v62, s[96:99], 0 offen offset:16
MA 116,v,92,v,168
s_and_b32 s20, s20, 1023
MA 124,v,92,v,172
MA 112,v,88,v,168
MA 120,v,88,v,172
MA 52,v,84,v,168
MA 60,v,84,v,172
MA 48,v,80,v,168
TR 168,202,49152
TR 170,202,51200
MA 56,v,80,v,172
TR 172,203,49152
TR 174,203,51200
s_waitcnt lgkmcnt(4)
MA 0,v,112,v,144
MA 8,v,112,v,148
MA 4,v,116,v,144
MA 12,v,116,v,148
MA 64,v,120,v,144
MA 72,v,120,v,148
MA 68,v,124,v,144
MA 76,v,124,v,148
MA 128,v,128,v,144
MA 136,v,128,v,148
s_waitcnt vmcnt(18) lgkmcnt(0)
s_barrier
MA 132,v,132,v,144
s_add_u32 m0, s23, 32768
MA 140,v,132,v,148
ds_read_b128 v[80:83], v194 offset:0
MA 192,v,136,v,144
s_mov_b32 s4, s34
s_mov_b32 s5, s35
MA 200,v,136,v,148
MA 196,v,140,v,144
TR 144,196,0
TR 146,196,2048
MA 204,v,140,v,148
TR 148,197,0
TR 150,197,2048
MA 212,v,140,v,152
ds_read_b128 v[84:87], v194 offset:2048
buffer_load_dwordx4 v184, s[12:15], s21 offen offset:0 lds
MA 220,v,140,v,156
s_mov_b32 s6, 8388608
s_mov_b32 s7, 0x20000
MA 208,v,136,v,152
buffer_load_dwordx4 v185, s[12:15], s21 offen offset:1024 lds
MA 216,v,136,v,156
MA 148,v,132,v,152
MA 156,v,132,v,156
ds_read_b128 v[88:91], v194 offset:4096
MA 144,v,128,v,152
MA 152,v,128,v,156
buffer_load_dwordx4 v186, s[12:15], s21 offen offset:2048 lds
s_lshr_b32 s43, s2, 3
MA 84,v,124,v,152
MA 92,v,124,v,156
MA 80,v,120,v,152
ds_read_b128 v[92:95], v194 offset:6144
s_lshl_b32 s43, s43, 2
MA 88,v,120,v,156
buffer_load_dwordx4 v187, s[12:15], s21 offen offset:3072 lds
MA 20,v,116,v,152
MA 28,v,116,v,156
s_add_u32 s43, s43, s3
MA 16,v,112,v,152
TR 152,198,0
TR 154,198,2048
MA 24,v,112,v,156
TR 156,199,0
TR 158,199,2048
MA 32,v,112,v,160
ds_read_b128 v[96:99], v194 offset:8192
s_add_u32 m0, s23, 36864
MA 40,v,112,v,164
s_lshl_b32 s43, s43, 16
MA 36,v,116,v,160
MA 44,v,116,v,164
MA 96,v,120,v,160
ds_read_b128 v[100:103], v194 offset:10240
buffer_load_dwordx4 v188, s[12:15], s21 offen offset:0 lds
MA 104,v,120,v,164
s_and_b32 s37, s2, 7
MA 100,v,124,v,160
MA 108,v,124,v,164
s_lshl_b32 s37, s37, 10
MA 160,v,128,v,160
buffer_load_dwordx4 v189, s[12:15], s21 offen offset:1024 lds
MA 168,v,128,v,164
ds_read_b128 v[104:107], v194 offset:12288
MA 164,v,132,v,160
s_add_u32 s43, s43, s37
MA 172,v,132,v,164
MA 224,v,136,v,160
buffer_load_dwordx4 v190, s[12:15], s21 offen offset:2048 lds
MA 232,v,136,v,164
v_lshrrev_b32 v78, 3, v1
MA 228,v,140,v,160
TR 160,200,0
TR 162,200,2048
MA 236,v,140,v,164
TR 164,201,0
TR 166,201,2048
MA 244,v,140,v,168
ds_read_b128 v[108:111], v194 offset:14336
MA 252,v,140,v,172
buffer_load_dwordx4 v191, s[12:15], s21 offen offset:3072 lds
v_and_b32 v79, 7, v1
MA 240,v,136,v,168
MA 248,v,136,v,172
MA 180,v,132,v,168
v_lshlrev_b32 v79, 7, v79
MA 188,v,132,v,172
s_add_u32 s21, s21, 524288
MA 176,v,128,v,168
MA 184,v,128,v,172
v_lshl_add_u32 v78, v78, 13, v79
MA 116,v,124,v,168
MA 124,v,124,v,172
s_and_b32 s21, s21, 4194303
MA 112,v,120,v,168
v_add_u32 v78, s43, v78
MA 120,v,120,v,172
MA 52,v,116,v,168
MA 60,v,116,v,172
MA 48,v,112,v,168
TR 168,202,0
TR 170,202,2048
MA 56,v,112,v,172
TR 172,203,0
TR 174,203,2048
s_waitcnt lgkmcnt(4)
MA 0,v,80,v,144
s_add_u32 m0, s22, 32768
v_add_u32 v252, 0, v229
MA 8,v,80,v,148
ds_read_b128 v[112:115], v195 offset:0
MA 4,v,84,v,144
MA 12,v,84,v,148
MA 64,v,88,v,144
MA 72,v,88,v,148
buffer_load_dwordx4 v176, s[8:11], s20 offen offset:0 lds
MA 68,v,92,v,144
buffer_load_dwordx2 v[16:17], v252, s[84:87], 0 offen
MA 76,v,92,v,148
ds_read_b128 v[116:119], v195 offset:2048
MA 128,v,96,v,144
MA 136,v,96,v,148
MA 132,v,100,v,144
buffer_load_dwordx4 v177, s[8:11], s20 offen offset:1024 lds
MA 140,v,100,v,148
MA 192,v,104,v,144
v_add_u32 v253, 2048, v229
MA 200,v,104,v,148
ds_read_b128 v[120:123], v195 offset:4096
MA 196,v,108,v,144
TR 144,196,16384
TR 146,196,18432
MA 204,v,108,v,148
TR 148,197,16384
TR 150,197,18432
MA 212,v,108,v,152
buffer_load_dwordx4 v178, s[8:11], s20 offen offset:2048 lds
MA 220,v,108,v,156
MA 208,v,104,v,152
buffer_load_dwordx2 v[18:19], v253, s[84:87], 0 offen
MA 216,v,104,v,156
MA 148,v,100,v,152
ds_read_b128 v[124:127], v195 offset:6144
buffer_load_dwordx4 v179, s[8:11], s20 offen offset:3072 lds
MA 156,v,100,v,156
MA 144,v,96,v,152
MA 152,v,96,v,156
MA 84,v,92,v,152
v_add_u32 v254, 4096, v229
MA 92,v,92,v,156
s_add_u32 m0, s22, 36864
MA 80,v,88,v,152
ds_read_b128 v[128:131], v195 offset:8192
MA 88,v,88,v,156
MA 20,v,84,v,152
MA 28,v,84,v,156
MA 16,v,80,v,152
TR 152,198,16384
TR 154,198,18432
MA 24,v,80,v,156
TR 156,199,16384
TR 158,199,18432
MA 32,v,80,v,160
ds_read_b128 v[132:135], v195 offset:10240
buffer_load_dwordx4 v180, s[8:11], s20 offen offset:0 lds
MA 40,v,80,v,164
buffer_load_dwordx2 v[20:21], v254, s[84:87], 0 offen
MA 36,v,84,v,160
MA 44,v,84,v,164
MA 96,v,88,v,160
buffer_load_dwordx4 v181, s[8:11], s20 offen offset:1024 lds
MA 104,v,88,v,164
v_add_u32 v255, 6144, v229
MA 100,v,92,v,160
MA 108,v,92,v,164
ds_read_b128 v[136:139], v195 offset:12288
MA 160,v,96,v,160
MA 168,v,96,v,164
buffer_load_dwordx4 v182, s[8:11], s20 offen offset:2048 lds
MA 164,v,100,v,160
MA 172,v,100,v,164
buffer_load_dwordx2 v[22:23], v255, s[84:87], 0 offen
MA 224,v,104,v,160
MA 232,v,104,v,164
ds_read_b128 v[140:143], v195 offset:14336
MA 228,v,108,v,160
TR 160,200,16384
TR 162,200,18432
MA 236,v,108,v,164
TR 164,201,16384
TR 166,201,18432
s_waitcnt lgkmcnt(15)
MA 244,v,108,v,168
buffer_load_dwordx4 v183, s[8:11], s20 offen offset:3072 lds
MA 252,v,108,v,172
buffer_load_dwordx2 v[38:39], v255, s[88:91], 0 offen
MA 240,v,104,v,168
MA 248,v,104,v,172
s_add_u32 s20, s20, 128
MA 180,v,100,v,168
MA 188,v,100,v,172
MA 176,v,96,v,168
MA 184,v,96,v,172
v_add_u32 v252, 8192, v229
MA 116,v,92,v,168
s_and_b32 s20, s20, 1023
MA 124,v,92,v,172
MA 112,v,88,v,168
MA 120,v,88,v,172
MA 52,v,84,v,168
MA 60,v,84,v,172
MA 48,v,80,v,168
TR 168,202,16384
TR 170,202,18432
MA 56,v,80,v,172
TR 172,203,16384
TR 174,203,18432
s_waitcnt lgkmcnt(4)
MA 0,v,112,v,144
MA 8,v,112,v,148
MA 4,v,116,v,144
MA 12,v,116,v,148
MA 64,v,120,v,144
MA 72,v,120,v,148
MA 68,v,124,v,144
MA 76,v,124,v,148
MA 128,v,128,v,144
MA 136,v,128,v,148
s_waitcnt vmcnt(13) lgkmcnt(0)
s_barrier
MA 132,v,132,v,144
s_add_u32 m0, s23, 0
s_bfe_u32 s80, s2, 0x20001
MA 140,v,132,v,148
ds_read_b128 v[80:83], v192 offset:0
s_bfe_u32 s69, s2, 0x30003
MA 192,v,136,v,144
s_lshl_b32 s80, s80, 3
s_add_u32 s69, s69, s80
MA 200,v,136,v,148
s_lshr_b32 s80, s2, 6
MA 196,v,140,v,144
TR 144,196,32768
TR 146,196,34816
MA 204,v,140,v,148
TR 148,197,32768
TR 150,197,34816
MA 212,v,140,v,152
ds_read_b128 v[84:87], v192 offset:2048
buffer_load_dwordx4 v184, s[12:15], s21 offen offset:0 lds
MA 220,v,140,v,156
s_xor_b32 s81, s80, s2
s_and_b32 s81, s81, 1
MA 208,v,136,v,152
buffer_load_dwordx4 v185, s[12:15], s21 offen offset:1024 lds
s_lshl_b32 s70, s80, 1
MA 216,v,136,v,156
s_add_u32 s70, s70, s81
s_lshl_b32 s80, s3, 1
MA 148,v,132,v,152
s_sub_u32 s80, 7, s80
s_lshl_b32 s76, s80, 17
MA 156,v,132,v,156
ds_read_b128 v[88:91], v192 offset:4096
s_lshl_b32 s80, s3, 15
MA 144,v,128,v,152
s_lshl_b32 s65, s70, 18
s_sub_u32 s64, 3932160, s65
MA 152,v,128,v,156
buffer_load_dwordx4 v186, s[12:15], s21 offen offset:2048 lds
s_add_u32 s65, s65, s80
MA 84,v,124,v,152
s_add_u32 s64, s64, s80
MA 92,v,124,v,156
s_lshl_b32 s81, s69, 12
MA 80,v,120,v,152
ds_read_b128 v[92:95], v192 offset:6144
s_lshl_b32 s100, s64, 2
MA 88,v,120,v,156
buffer_load_dwordx4 v187, s[12:15], s21 offen offset:3072 lds
s_add_u32 s100, s100, s81
MA 20,v,116,v,152
s_lshl_b32 s101, s65, 2
MA 28,v,116,v,156
s_add_u32 s101, s101, s81
MA 16,v,112,v,152
TR 152,198,32768
TR 154,198,34816
MA 24,v,112,v,156
TR 156,199,32768
TR 158,199,34816
MA 32,v,112,v,160
ds_read_b128 v[96:99], v192 offset:8192
s_add_u32 m0, s23, 4096
MA 40,v,112,v,164
s_lshl_b32 s66, s3, 17
s_lshl_b32 s81, s69, 8
MA 36,v,116,v,160
s_add_u32 s66, s66, s81
s_and_b32 s74, s2, 7
MA 44,v,116,v,164
s_lshl_b32 s74, s74, 8
s_mov_b32 s82, s66
MA 96,v,120,v,160
ds_read_b128 v[100:103], v192 offset:10240
buffer_load_dwordx4 v188, s[12:15], s21 offen offset:0 lds
MA 104,v,120,v,164
s_lshl_b32 s66, s74, 12
s_lshl_b32 s67, s3, 13
MA 100,v,124,v,160
s_lshl_b32 s68, s3, 12
s_lshl_b32 s77, s70, 1
MA 108,v,124,v,164
s_sub_u32 s77, 32, s77
MA 160,v,128,v,160
buffer_load_dwordx4 v189, s[12:15], s21 offen offset:1024 lds
v_lshrrev_b32 v66, 3, v1
MA 168,v,128,v,164
ds_read_b128 v[104:107], v192 offset:12288
v_lshlrev_b32 v66, 11, v66
MA 164,v,132,v,160
v_lshrrev_b32 v67, 4, v1
v_and_b32 v68, 7, v1
MA 172,v,132,v,164
v_xor_b32 v68, v68, v67
MA 224,v,136,v,160
buffer_load_dwordx4 v190, s[12:15], s21 offen offset:2048 lds
v_lshl_add_u32 v66, v68, 4, v66
MA 232,v,136,v,164
v_xor_b32 v69, 64, v66
MA 228,v,140,v,160
TR 160,200,32768
TR 162,200,34816
MA 236,v,140,v,164
TR 164,201,32768
TR 166,201,34816
MA 244,v,140,v,168
ds_read_b128 v[108:111], v192 offset:14336
s_lshr_b32 s83, s76, 2
MA 252,v,140,v,172
buffer_load_dwordx4 v191, s[12:15], s21 offen offset:3072 lds
v_add_u32 v208, 0, v66
MA 240,v,136,v,168
v_add_u32 v209, 15360, v69
v_add_u32 v210, -2048, v66
MA 248,v,136,v,172
v_add_u32 v210, s83, v210
v_add_u32 v211, 13312, v69
MA 180,v,132,v,168
v_add_u32 v211, s83, v211
v_and_b32 v68, 15, v1
MA 188,v,132,v,172
s_add_u32 s21, s21, 524288
v_lshlrev_b32 v69, 1, v67
MA 176,v,128,v,168
v_xor_b32 v68, v68, v69
MA 184,v,128,v,172
v_lshlrev_b32 v66, 13, v67
MA 116,v,124,v,168
v_xor_b32 v69, 0, v68
MA 124,v,124,v,172
s_and_b32 s21, s21, 4194303
v_lshl_add_u32 v69, v69, 4, v66
MA 112,v,120,v,168
v_add_u32 v212, 0, v69
MA 120,v,120,v,172
v_xor_b32 v69, 0, v68
MA 52,v,116,v,168
v_lshl_add_u32 v69, v69, 4, v66
MA 60,v,116,v,172
v_add_u32 v213, 31744, v69
MA 48,v,112,v,168
TR 168,202,32768
TR 170,202,34816
MA 56,v,112,v,172
TR 172,203,32768
TR 174,203,34816
s_waitcnt lgkmcnt(4)
MA 0,v,80,v,144
s_add_u32 m0, s22, 65536
buffer_load_dwordx2 v[24:25], v252, s[84:87], 0 offen
MA 8,v,80,v,148
ds_read_b128 v[112:115], v193 offset:0
MA 4,v,84,v,144
MA 12,v,84,v,148
MA 64,v,88,v,144
MA 72,v,88,v,148
buffer_load_dwordx4 v176, s[8:11], s20 offen offset:0 lds
MA 68,v,92,v,144
buffer_load_dwordx2 v[40:41], v252, s[88:91], 0 offen
MA 76,v,92,v,148
ds_read_b128 v[116:119], v193 offset:2048
MA 128,v,96,v,144
MA 136,v,96,v,148
MA 132,v,100,v,144
buffer_load_dwordx4 v177, s[8:11], s20 offen offset:1024 lds
MA 140,v,100,v,148
MA 192,v,104,v,144
v_add_u32 v253, 10240, v229
MA 200,v,104,v,148
ds_read_b128 v[120:123], v193 offset:4096
MA 196,v,108,v,144
TR 144,196,49152
TR 146,196,51200
MA 204,v,108,v,148
TR 148,197,49152
TR 150,197,51200
MA 212,v,108,v,152
buffer_load_dwordx4 v178, s[8:11], s20 offen offset:2048 lds
MA 220,v,108,v,156
MA 208,v,104,v,152
buffer_load_dwordx2 v[26:27], v253, s[84:87], 0 offen
MA 216,v,104,v,156
MA 148,v,100,v,152
ds_read_b128 v[124:127], v193 offset:6144
buffer_load_dwordx4 v179, s[8:11], s20 offen offset:3072 lds
MA 156,v,100,v,156
MA 144,v,96,v,152
MA 152,v,96,v,156
MA 84,v,92,v,152
buffer_load_dwordx2 v[42:43], v253, s[88:91], 0 offen
MA 92,v,92,v,156
s_add_u32 m0, s22, 69632
MA 80,v,88,v,152
ds_read_b128 v[128:131], v193 offset:8192
MA 88,v,88,v,156
MA 20,v,84,v,152
MA 28,v,84,v,156
MA 16,v,80,v,152
TR 152,198,49152
TR 154,198,51200
MA 24,v,80,v,156
TR 156,199,49152
TR 158,199,51200
MA 32,v,80,v,160
ds_read_b128 v[132:135], v193 offset:10240
buffer_load_dwordx4 v180, s[8:11], s20 offen offset:0 lds
MA 40,v,80,v,164
v_add_u32 v254, 12288, v229
MA 36,v,84,v,160
MA 44,v,84,v,164
MA 96,v,88,v,160
buffer_load_dwordx4 v181, s[8:11], s20 offen offset:1024 lds
MA 104,v,88,v,164
buffer_load_dwordx2 v[28:29], v254, s[84:87], 0 offen
MA 100,v,92,v,160
MA 108,v,92,v,164
ds_read_b128 v[136:139], v193 offset:12288
MA 160,v,96,v,160
MA 168,v,96,v,164
buffer_load_dwordx4 v182, s[8:11], s20 offen offset:2048 lds
MA 164,v,100,v,160
MA 172,v,100,v,164
buffer_load_dwordx2 v[44:45], v254, s[88:91], 0 offen
MA 224,v,104,v,160
MA 232,v,104,v,164
ds_read_b128 v[140:143], v193 offset:14336
MA 228,v,108,v,160
TR 160,200,49152
TR 162,200,51200
MA 236,v,108,v,164
TR 164,201,49152
TR 166,201,51200
s_waitcnt lgkmcnt(15)
MA 244,v,108,v,168
buffer_load_dwordx4 v183, s[8:11], s20 offen offset:3072 lds
MA 252,v,108,v,172
v_add_u32 v255, 14336, v229
MA 240,v,104,v,168
MA 248,v,104,v,172
s_add_u32 s20, s20, 128
MA 180,v,100,v,168
MA 188,v,100,v,172
MA 176,v,96,v,168
MA 184,v,96,v,172
buffer_load_dwordx2 v[30:31], v255, s[84:87], 0 offen
MA 116,v,92,v,168
s_and_b32 s20, s20, 1023
MA 124,v,92,v,172
MA 112,v,88,v,168
MA 120,v,88,v,172
MA 52,v,84,v,168
MA 60,v,84,v,172
MA 48,v,80,v,168
TR 168,202,49152
TR 170,202,51200
MA 56,v,80,v,172
TR 172,203,49152
TR 174,203,51200
s_waitcnt lgkmcnt(4)
MA 0,v,112,v,144
MA 8,v,112,v,148
MA 4,v,116,v,144
MA 12,v,116,v,148
MA 64,v,120,v,144
MA 72,v,120,v,148
MA 68,v,124,v,144
MA 76,v,124,v,148
MA 128,v,128,v,144
MA 136,v,128,v,148
s_waitcnt vmcnt(15) lgkmcnt(0)
s_barrier
MA 132,v,132,v,144
s_add_u32 m0, s23, 32768
v_xor_b32 v69, 8, v68
MA 140,v,132,v,148
ds_read_b128 v[80:83], v192 offset:32768
v_lshl_add_u32 v69, v69, 4, v66
MA 192,v,136,v,144
v_add_u32 v214, 63488, v69
v_xor_b32 v69, 8, v68
MA 200,v,136,v,148
v_lshl_add_u32 v69, v69, 4, v66
MA 196,v,140,v,144
TR 144,196,0
TR 146,196,2048
MA 204,v,140,v,148
TR 148,197,0
TR 150,197,2048
MA 212,v,140,v,152
ds_read_b128 v[84:87], v192 offset:34816
buffer_load_dwordx4 v184, s[12:15], s21 offen offset:0 lds
MA 220,v,140,v,156
v_add_u32 v215, 95232, v69
v_and_b32 v66, 15, v1
MA 208,v,136,v,152
buffer_load_dwordx4 v185, s[12:15], s21 offen offset:1024 lds
v_lshrrev_b32 v68, 1, v66
MA 216,v,136,v,156
v_xor_b32 v68, v68, v67
v_lshlrev_b32 v68, 4, v68
MA 148,v,132,v,152
v_lshl_add_u32 v68, v66, 7, v68
v_add_u32 v224, s67, v68
MA 156,v,132,v,156
ds_read_b128 v[88:91], v192 offset:36864
v_xor_b32 v225, 64, v224
MA 144,v,128,v,152
v_add_u32 v226, 0x10000, v224
v_add_u32 v227, 0x10000, v225
MA 152,v,128,v,156
buffer_load_dwordx4 v186, s[12:15], s21 offen offset:2048 lds
v_bfe_u32 v66, v1, 2, 2
MA 84,v,124,v,152
v_and_b32 v68, 1, v67
v_lshl_or_b32 v68, v68, 2, v66
MA 92,v,124,v,156
v_lshl_add_u32 v66, v67, 3, v66
v_lshlrev_b32 v66, 8, v66
MA 80,v,120,v,152
ds_read_b128 v[92:95], v192 offset:38912
v_and_b32 v69, 3, v1
MA 88,v,120,v,156
buffer_load_dwordx4 v187, s[12:15], s21 offen offset:3072 lds
v_lshl_add_u32 v66, v69, 3, v66
MA 20,v,116,v,152
v_add_u32 v66, 98304, v66
MA 28,v,116,v,156
v_xor_b32 v69, 0, v68
MA 16,v,112,v,152
TR 152,198,0
TR 154,198,2048
MA 24,v,112,v,156
TR 156,199,0
TR 158,199,2048
MA 32,v,112,v,160
ds_read_b128 v[96:99], v192 offset:40960
s_add_u32 m0, s23, 36864
MA 40,v,112,v,164
v_lshl_add_u32 v216, v69, 5, v66
v_xor_b32 v69, 1, v68
MA 36,v,116,v,160
v_lshl_add_u32 v217, v69, 5, v66
v_xor_b32 v69, 2, v68
MA 44,v,116,v,164
v_lshl_add_u32 v218, v69, 5, v66
v_xor_b32 v69, 3, v68
MA 96,v,120,v,160
ds_read_b128 v[100:103], v192 offset:43008
buffer_load_dwordx4 v188, s[12:15], s21 offen offset:0 lds
MA 104,v,120,v,164
v_lshl_add_u32 v219, v69, 5, v66
v_xor_b32 v69, 4, v68
MA 100,v,124,v,160
v_lshl_add_u32 v220, v69, 5, v66
v_xor_b32 v69, 5, v68
MA 108,v,124,v,164
v_lshl_add_u32 v221, v69, 5, v66
v_xor_b32 v69, 6, v68
MA 160,v,128,v,160
buffer_load_dwordx4 v189, s[12:15], s21 offen offset:1024 lds
v_lshl_add_u32 v222, v69, 5, v66
MA 168,v,128,v,164
ds_read_b128 v[104:107], v192 offset:45056
v_xor_b32 v69, 7, v68
MA 164,v,132,v,160
v_lshl_add_u32 v223, v69, 5, v66
s_mov_b32 s44, s32
MA 172,v,132,v,164
s_mov_b32 s45, s33
MA 224,v,136,v,160
buffer_load_dwordx4 v190, s[12:15], s21 offen offset:2048 lds
s_mov_b32 s46, 4194304
MA 232,v,136,v,164
s_mov_b32 s47, 0x20000
MA 228,v,140,v,160
TR 160,200,0
TR 162,200,2048
MA 236,v,140,v,164
TR 164,201,0
TR 166,201,2048
MA 244,v,140,v,168
ds_read_b128 v[108:111], v192 offset:47104
MA 252,v,140,v,172
buffer_load_dwordx4 v191, s[12:15], s21 offen offset:3072 lds
MA 240,v,136,v,168
s_add_u32 s48, s34, s82
s_addc_u32 s49, s35, 0
MA 248,v,136,v,172
s_sub_u32 s50, 8388608, s82
s_mov_b32 s51, 0x20000
MA 180,v,132,v,168
s_add_u32 s60, s40, 33554432
s_addc_u32 s61, s41, 0
MA 188,v,132,v,172
s_add_u32 s21, s21, 524288
s_mov_b32 s62, 16777216
MA 176,v,128,v,168
s_mov_b32 s63, 0x20000
s_lshl_b32 s80, s69, 19
MA 184,v,128,v,172
s_add_u32 s52, s40, s80
s_addc_u32 s53, s41, 0
MA 116,v,124,v,168
s_lshl_b32 s54, s77, 14
s_mov_b32 s55, 0x20000
MA 124,v,124,v,172
s_and_b32 s21, s21, 4194303
s_add_u32 s80, s80, 16760832
MA 112,v,120,v,168
s_add_u32 s56, s40, s80
s_addc_u32 s57, s41, 0
MA 120,v,120,v,172
s_add_u32 s58, s54, 16384
MA 52,v,116,v,168
s_mov_b32 s59, 0x20000
MA 60,v,116,v,172
s_load_dwordx2 s[38:39], s[0:1], 112
MA 48,v,112,v,168
TR 168,202,0
TR 170,202,2048
MA 56,v,112,v,172
TR 172,203,0
TR 174,203,2048
s_waitcnt lgkmcnt(4)
MA 0,v,80,v,144
s_add_u32 m0, s22, 0
buffer_load_dwordx2 v[46:47], v255, s[88:91], 0 offen
MA 8,v,80,v,148
ds_read_b128 v[112:115], v193 offset:32768
MA 4,v,84,v,144
MA 12,v,84,v,148
MA 64,v,88,v,144
MA 72,v,88,v,148
buffer_load_dwordx4 v176, s[8:11], s20 offen offset:0 lds
MA 68,v,92,v,144
v_add_u32 v252, 16384, v229
MA 76,v,92,v,148
ds_read_b128 v[116:119], v193 offset:34816
MA 128,v,96,v,144
MA 136,v,96,v,148
MA 132,v,100,v,144
buffer_load_dwordx4 v177, s[8:11], s20 offen offset:1024 lds
MA 140,v,100,v,148
MA 192,v,104,v,144
buffer_load_dwordx2 v[32:33], v252, s[84:87], 0 offen
MA 200,v,104,v,148
ds_read_b128 v[120:123], v193 offset:36864
MA 196,v,108,v,144
TR 144,196,16384
TR 146,196,18432
MA 204,v,108,v,148
TR 148,197,16384
TR 150,197,18432
MA 212,v,108,v,152
buffer_load_dwordx4 v178, s[8:11], s20 offen offset:2048 lds
MA 220,v,108,v,156
MA 208,v,104,v,152
buffer_load_dwordx2 v[48:49], v252, s[88:91], 0 offen
MA 216,v,104,v,156
MA 148,v,100,v,152
ds_read_b128 v[124:127], v193 offset:38912
buffer_load_dwordx4 v179, s[8:11], s20 offen offset:3072 lds
MA 156,v,100,v,156
MA 144,v,96,v,152
MA 152,v,96,v,156
MA 84,v,92,v,152
v_add_u32 v253, 18432, v229
MA 92,v,92,v,156
s_add_u32 m0, s22, 4096
MA 80,v,88,v,152
ds_read_b128 v[128:131], v193 offset:40960
MA 88,v,88,v,156
MA 20,v,84,v,152
MA 28,v,84,v,156
MA 16,v,80,v,152
TR 152,198,16384
TR 154,198,18432
MA 24,v,80,v,156
TR 156,199,16384
TR 158,199,18432
MA 32,v,80,v,160
ds_read_b128 v[132:135], v193 offset:43008
buffer_load_dwordx4 v180, s[8:11], s20 offen offset:0 lds
MA 40,v,80,v,164
buffer_load_dwordx2 v[34:35], v253, s[84:87], 0 offen
MA 36,v,84,v,160
MA 44,v,84,v,164
MA 96,v,88,v,160
buffer_load_dwordx4 v181, s[8:11], s20 offen offset:1024 lds
MA 104,v,88,v,164
buffer_load_dwordx2 v[50:51], v253, s[88:91], 0 offen
MA 100,v,92,v,160
MA 108,v,92,v,164
ds_read_b128 v[136:139], v193 offset:45056
MA 160,v,96,v,160
MA 168,v,96,v,164
buffer_load_dwordx4 v182, s[8:11], s20 offen offset:2048 lds
MA 164,v,100,v,160
MA 172,v,100,v,164
v_add_u32 v254, 20480, v229
MA 224,v,104,v,160
MA 232,v,104,v,164
ds_read_b128 v[140:143], v193 offset:47104
MA 228,v,108,v,160
TR 160,200,16384
TR 162,200,18432
MA 236,v,108,v,164
TR 164,201,16384
TR 166,201,18432
s_waitcnt lgkmcnt(15)
MA 244,v,108,v,168
buffer_load_dwordx4 v183, s[8:11], s20 offen offset:3072 lds
MA 252,v,108,v,172
buffer_load_dwordx2 v[36:37], v254, s[84:87], 0 offen
MA 240,v,104,v,168
MA 248,v,104,v,172
s_add_u32 s20, s20, 128
MA 180,v,100,v,168
MA 188,v,100,v,172
MA 176,v,96,v,168
MA 184,v,96,v,172
buffer_load_dwordx2 v[52:53], v254, s[88:91], 0 offen
MA 116,v,92,v,168
s_and_b32 s20, s20, 1023
MA 124,v,92,v,172
MA 112,v,88,v,168
MA 120,v,88,v,172
MA 52,v,84,v,168
MA 60,v,84,v,172
MA 48,v,80,v,168
TR 168,202,16384
TR 170,202,18432
MA 56,v,80,v,172
TR 172,203,16384
TR 174,203,18432
s_waitcnt lgkmcnt(4)
MA 0,v,112,v,144
MA 8,v,112,v,148
MA 4,v,116,v,144
MA 12,v,116,v,148
MA 64,v,120,v,144
MA 72,v,120,v,148
MA 68,v,124,v,144
MA 76,v,124,v,148
MA 128,v,128,v,144
MA 136,v,128,v,148
s_waitcnt vmcnt(15) lgkmcnt(0)
s_barrier
MA 132,v,132,v,144
s_add_u32 m0, s23, 0
s_and_b32 s37, s3, 3
MA 140,v,132,v,148
ds_read_b128 v[80:83], v194 offset:0
MA 192,v,136,v,144
s_cmp_eq_u32 s37, 0
s_cselect_b32 s37, 0, 0x40000000
MA 200,v,136,v,148
MA 196,v,140,v,144
TR 144,196,32768
TR 146,196,34816
MA 204,v,140,v,148
TR 148,197,32768
TR 150,197,34816
MA 212,v,140,v,152
ds_read_b128 v[84:87], v194 offset:2048
buffer_load_dwordx4 v184, s[12:15], s21 offen offset:0 lds
MA 220,v,140,v,156
v_add_u32 v229, s37, v78
MA 208,v,136,v,152
buffer_load_dwordx4 v185, s[12:15], s21 offen offset:1024 lds
MA 216,v,136,v,156
buffer_load_dword v79, v229, s[4:7], 0 offen
MA 148,v,132,v,152
MA 156,v,132,v,156
ds_read_b128 v[88:91], v194 offset:4096
s_getpc_b64 s[82:83]
L_ct_fV:
MA 144,v,128,v,152
MA 152,v,128,v,156
buffer_load_dwordx4 v186, s[12:15], s21 offen offset:2048 lds
MA 84,v,124,v,152
s_add_u32 s82, s82, L_p2 - L_ct_fV
s_addc_u32 s83, s83, 0
MA 92,v,124,v,156
MA 80,v,120,v,152
ds_read_b128 v[92:95], v194 offset:6144
MA 88,v,120,v,156
buffer_load_dwordx4 v187, s[12:15], s21 offen offset:3072 lds
MA 20,v,116,v,152
v_mov_b32 v67, s83
MA 28,v,116,v,156
MA 16,v,112,v,152
TR 152,198,32768
TR 154,198,34816
MA 24,v,112,v,156
TR 156,199,32768
TR 158,199,34816
MA 32,v,112,v,160
ds_read_b128 v[96:99], v194 offset:8192
s_add_u32 m0, s23, 4096
MA 40,v,112,v,164
v_mov_b32 v66, s82
s_lshr_b32 s82, s2, 3
MA 36,v,116,v,160
s_lshl_b32 s82, s82, 2
MA 44,v,116,v,164
MA 96,v,120,v,160
ds_read_b128 v[100:103], v194 offset:10240
buffer_load_dwordx4 v188, s[12:15], s21 offen offset:0 lds
MA 104,v,120,v,164
s_add_u32 s82, s82, s3
MA 100,v,124,v,160
MA 108,v,124,v,164
s_lshl_b32 s82, s82, 7
MA 160,v,128,v,160
buffer_load_dwordx4 v189, s[12:15], s21 offen offset:1024 lds
MA 168,v,128,v,164
ds_read_b128 v[104:107], v194 offset:12288
v_and_b32 v68, 3, v1
MA 164,v,132,v,160
MA 172,v,132,v,164
v_lshlrev_b32 v68, 14, v68
MA 224,v,136,v,160
buffer_load_dwordx4 v190, s[12:15], s21 offen offset:2048 lds
MA 232,v,136,v,164
MA 228,v,140,v,160
TR 160,200,32768
TR 162,200,34816
MA 236,v,140,v,164
TR 164,201,32768
TR 166,201,34816
MA 244,v,140,v,168
ds_read_b128 v[108:111], v194 offset:14336
v_add_u32 v68, s82, v68
MA 252,v,140,v,172
buffer_load_dwordx4 v191, s[12:15], s21 offen offset:3072 lds
v_min_u32 v68, L_p3_begin - L_p2 - 4, v68
MA 240,v,136,v,168
v_add_co_u32 v66, vcc, v66, v68
s_nop 1
v_addc_co_u32 v67, vcc, 0, v67, vcc
MA 248,v,136,v,172
MA 180,v,132,v,168
MA 188,v,132,v,172
s_add_u32 s21, s21, 524288
MA 176,v,128,v,168
MA 184,v,128,v,172
MA 116,v,124,v,168
MA 124,v,124,v,172
s_and_b32 s21, s21, 4194303
MA 112,v,120,v,168
MA 120,v,120,v,172
global_load_dword v68, v[66:67], off
MA 52,v,116,v,168
MA 60,v,116,v,172
MA 48,v,112,v,168
TR 168,202,32768
TR 170,202,34816
MA 56,v,112,v,172
TR 172,203,32768
TR 174,203,34816
s_waitcnt lgkmcnt(4)
MA 0,v,80,v,144
s_add_u32 m0, s22, 32768
s_and_b32 s37, s3, 3
MA 8,v,80,v,148
ds_read_b128 v[112:115], v195 offset:0
MA 4,v,84,v,144
MA 12,v,84,v,148
MA 64,v,88,v,144
MA 72,v,88,v,148
buffer_load_dwordx4 v176, s[8:11], s20 offen offset:0 lds
MA 68,v,92,v,144
MA 76,v,92,v,148
ds_read_b128 v[116:119], v195 offset:2048
MA 128,v,96,v,144
MA 136,v,96,v,148
MA 132,v,100,v,144
buffer_load_dwordx4 v177, s[8:11], s20 offen offset:1024 lds
MA 140,v,100,v,148
MA 192,v,104,v,144
s_cmp_eq_u32 s37, 1
s_cselect_b32 s37, 0, 0x40000000
MA 200,v,104,v,148
ds_read_b128 v[120:123], v195 offset:4096
MA 196,v,108,v,144
TR 144,196,49152
TR 146,196,51200
MA 204,v,108,v,148
TR 148,197,49152
TR 150,197,51200
MA 212,v,108,v,152
buffer_load_dwordx4 v178, s[8:11], s20 offen offset:2048 lds
MA 220,v,108,v,156
MA 208,v,104,v,152
MA 216,v,104,v,156
MA 148,v,100,v,152
ds_read_b128 v[124:127], v195 offset:6144
buffer_load_dwordx4 v179, s[8:11], s20 offen offset:3072 lds
MA 156,v,100,v,156
MA 144,v,96,v,152
MA 152,v,96,v,156
MA 84,v,92,v,152
MA 92,v,92,v,156
s_add_u32 m0, s22, 36864
MA 80,v,88,v,152
ds_read_b128 v[128:131], v195 offset:8192
MA 88,v,88,v,156
MA 20,v,84,v,152
MA 28,v,84,v,156
MA 16,v,80,v,152
TR 152,198,49152
TR 154,198,51200
MA 24,v,80,v,156
TR 156,199,49152
TR 158,199,51200
MA 32,v,80,v,160
ds_read_b128 v[132:135], v195 offset:10240
buffer_load_dwordx4 v180, s[8:11], s20 offen offset:0 lds
MA 40,v,80,v,164
MA 36,v,84,v,160
MA 44,v,84,v,164
MA 96,v,88,v,160
buffer_load_dwordx4 v181, s[8:11], s20 offen offset:1024 lds
MA 104,v,88,v,164
v_add_u32 v229, s37, v78
MA 100,v,92,v,160
MA 108,v,92,v,164
ds_read_b128 v[136:139], v195 offset:12288
MA 160,v,96,v,160
MA 168,v,96,v,164
buffer_load_dwordx4 v182, s[8:11], s20 offen offset:2048 lds
MA 164,v,100,v,160
MA 172,v,100,v,164
MA 224,v,104,v,160
MA 232,v,104,v,164
ds_read_b128 v[140:143], v195 offset:14336
MA 228,v,108,v,160
TR 160,200,49152
TR 162,200,51200
MA 236,v,108,v,164
TR 164,201,49152
TR 166,201,51200
s_waitcnt lgkmcnt(15)
MA 244,v,108,v,168
buffer_load_dwordx4 v183, s[8:11], s20 offen offset:3072 lds
MA 252,v,108,v,172
buffer_load_dword v79, v229, s[4:7], 0 offen
MA 240,v,104,v,168
MA 248,v,104,v,172
s_add_u32 s20, s20, 128
MA 180,v,100,v,168
MA 188,v,100,v,172
MA 176,v,96,v,168
MA 184,v,96,v,172
MA 116,v,92,v,168
s_and_b32 s20, s20, 1023
MA 124,v,92,v,172
MA 112,v,88,v,168
MA 120,v,88,v,172
MA 52,v,84,v,168
MA 60,v,84,v,172
MA 48,v,80,v,168
TR 168,202,49152
TR 170,202,51200
MA 56,v,80,v,172
TR 172,203,49152
TR 174,203,51200
s_waitcnt lgkmcnt(4)
MA 0,v,112,v,144
MA 8,v,112,v,148
MA 4,v,116,v,144
MA 12,v,116,v,148
MA 64,v,120,v,144
MA 72,v,120,v,148
MA 68,v,124,v,144
MA 76,v,124,v,148
MA 128,v,128,v,144
MA 136,v,128,v,148
s_waitcnt vmcnt(10) lgkmcnt(0)
s_barrier
MA 132,v,132,v,144
s_add_u32 m0, s23, 32768
s_and_b32 s37, s3, 3
MA 140,v,132,v,148
ds_read_b128 v[80:83], v192 offset:0
MA 192,v,136,v,144
s_cmp_eq_u32 s37, 2
s_cselect_b32 s37, 0, 0x40000000
MA 200,v,136,v,148
v_add_u32 v229, s37, v78
buffer_load_dword v79, v229, s[4:7], 0 offen
MA 196,v,140,v,144
TR 144,196,0
TR 146,196,2048
MA 204,v,140,v,148
TR 148,197,0
TR 150,197,2048
MA 212,v,140,v,152
ds_read_b128 v[84:87], v192 offset:2048
buffer_load_dwordx4 v184, s[12:15], s21 offen offset:0 lds
MA 220,v,140,v,156
s_add_u32 s84, s40, 50331648
s_addc_u32 s85, s41, 0
MA 208,v,136,v,152
buffer_load_dwordx4 v185, s[12:15], s21 offen offset:1024 lds
s_mov_b32 s86, 4194304
MA 216,v,136,v,156
s_mov_b32 s87, 0x20000
MA 148,v,132,v,152
s_add_u32 s88, s40, 58720256
s_addc_u32 s89, s41, 0
MA 156,v,132,v,156
ds_read_b128 v[88:91], v192 offset:4096
s_mov_b32 s90, 8192
MA 144,v,128,v,152
s_mov_b32 s91, 0x20000
v_mov_b32 v252, 0
MA 152,v,128,v,156
buffer_load_dwordx4 v186, s[12:15], s21 offen offset:2048 lds
v_mov_b32 v253, 0
MA 84,v,124,v,152
v_dot2_f32_bf16 v252, v230, v2, v252
v_dot2_f32_bf16 v253, v231, v3, v253
v_dot2_f32_bf16 v252, v232, v4, v252
v_dot2_f32_bf16 v253, v233, v5, v253
v_dot2_f32_bf16 v252, v234, v6, v252
v_dot2_f32_bf16 v253, v235, v7, v253
v_dot2_f32_bf16 v252, v236, v8, v252
v_dot2_f32_bf16 v253, v237, v9, v253
v_dot2_f32_bf16 v252, v238, v12, v252
v_dot2_f32_bf16 v253, v239, v13, v253
v_dot2_f32_bf16 v252, v240, v14, v252
v_dot2_f32_bf16 v253, v241, v15, v253
v_dot2_f32_bf16 v252, v242, v246, v252
v_dot2_f32_bf16 v253, v243, v247, v253
v_dot2_f32_bf16 v252, v244, v248, v252
v_dot2_f32_bf16 v253, v245, v249, v253
MA 92,v,124,v,156
s_nop 2
v_add_f32 v252, v252, v253
MA 80,v,120,v,152
ds_read_b128 v[92:95], v192 offset:6144
MA 88,v,120,v,156
buffer_load_dwordx4 v187, s[12:15], s21 offen offset:3072 lds
v_add_f32_dpp v252, v252, v252 row_ror:8 row_mask:0xf bank_mask:0xf
MA 20,v,116,v,152
s_nop 0
v_add_f32_dpp v252, v252, v252 row_ror:4 row_mask:0xf bank_mask:0xf
s_nop 1
v_add_f32_dpp v252, v252, v252 row_ror:2 row_mask:0xf bank_mask:0xf
MA 28,v,116,v,156
s_nop 0
v_add_f32_dpp v252, v252, v252 row_ror:1 row_mask:0xf bank_mask:0xf
v_mov_b32 v253, v252
MA 16,v,112,v,152
TR 152,198,0
TR 154,198,2048
MA 24,v,112,v,156
TR 156,199,0
TR 158,199,2048
MA 32,v,112,v,160
ds_read_b128 v[96:99], v192 offset:8192
s_add_u32 m0, s23, 36864
MA 40,v,112,v,164
v_permlane16_swap_b32 v252, v253
v_add_f32 v252, v252, v253
MA 36,v,116,v,160
v_mul_f32 v252, 0xbfb8aa3b, v252
MA 44,v,116,v,164
v_exp_f32 v252, v252
MA 96,v,120,v,160
ds_read_b128 v[100:103], v192 offset:10240
buffer_load_dwordx4 v188, s[12:15], s21 offen offset:0 lds
MA 104,v,120,v,164
v_add_f32 v252, 1.0, v252
MA 100,v,124,v,160
v_rcp_f32 v252, v252
MA 108,v,124,v,164
s_nop 0
buffer_store_dword v252, v11, s[88:91], 0 offen sc1
MA 160,v,128,v,160
buffer_load_dwordx4 v189, s[12:15], s21 offen offset:1024 lds
v_lshlrev_b32 v2, 16, v54
MA 168,v,128,v,164
ds_read_b128 v[104:107], v192 offset:12288
v_and_b32 v3, 0xffff0000, v54
MA 164,v,132,v,160
v_lshlrev_b32 v4, 16, v55
v_and_b32 v5, 0xffff0000, v55
MA 172,v,132,v,164
v_lshlrev_b32 v6, 16, v56
v_and_b32 v7, 0xffff0000, v56
MA 224,v,136,v,160
buffer_load_dwordx4 v190, s[12:15], s21 offen offset:2048 lds
v_lshlrev_b32 v8, 16, v57
MA 232,v,136,v,164
v_and_b32 v9, 0xffff0000, v57
v_lshlrev_b32 v230, 16, v16
MA 228,v,140,v,160
TR 160,200,0
TR 162,200,2048
MA 236,v,140,v,164
TR 164,201,0
TR 166,201,2048
MA 244,v,140,v,168
ds_read_b128 v[108:111], v192 offset:14336
v_and_b32 v231, 0xffff0000, v16
MA 252,v,140,v,172
buffer_load_dwordx4 v191, s[12:15], s21 offen offset:3072 lds
v_lshlrev_b32 v232, 16, v18
MA 240,v,136,v,168
v_and_b32 v233, 0xffff0000, v18
v_lshlrev_b32 v234, 16, v20
MA 248,v,136,v,172
v_and_b32 v235, 0xffff0000, v20
v_lshlrev_b32 v236, 16, v22
MA 180,v,132,v,168
v_and_b32 v237, 0xffff0000, v22
v_lshlrev_b32 v238, 16, v24
MA 188,v,132,v,172
s_add_u32 s21, s21, 524288
v_and_b32 v239, 0xffff0000, v24
MA 176,v,128,v,168
v_lshlrev_b32 v240, 16, v26
v_and_b32 v241, 0xffff0000, v26
MA 184,v,128,v,172
v_lshlrev_b32 v242, 16, v28
v_and_b32 v243, 0xffff0000, v28
MA 116,v,124,v,168
v_lshlrev_b32 v244, 16, v30
v_and_b32 v245, 0xffff0000, v30
MA 124,v,124,v,172
s_and_b32 s21, s21, 4194303
v_lshlrev_b32 v246, 16, v32
MA 112,v,120,v,168
v_and_b32 v247, 0xffff0000, v32
v_lshlrev_b32 v248, 16, v34
MA 120,v,120,v,172
v_and_b32 v249, 0xffff0000, v34
v_lshlrev_b32 v250, 16, v36
MA 52,v,116,v,168
v_and_b32 v251, 0xffff0000, v36
v_lshlrev_b32 v254, 16, v38
MA 60,v,116,v,172
v_and_b32 v255, 0xffff0000, v38
v_mul_f32 v62, v236, v2
MA 48,v,112,v,168
TR 168,202,0
TR 170,202,2048
MA 56,v,112,v,172
TR 172,203,0
TR 174,203,2048
v_mul_f32 v70, v237, v6
v_fmac_f32 v62, v234, v3
v_fmac_f32 v70, v235, v7
v_fmac_f32 v62, v232, v4
v_fmac_f32 v70, v233, v8
v_fmac_f32 v62, v230, v5
v_fmac_f32 v70, v231, v9
v_mul_f32 v62, v62, v254
v_mul_f32 v70, v70, v255
v_lshlrev_b32 v254, 16, v40
v_and_b32 v255, 0xffff0000, v40
v_mul_f32 v63, v238, v2
v_mul_f32 v71, v239, v6
v_fmac_f32 v63, v236, v3
v_fmac_f32 v71, v237, v7
v_fmac_f32 v63, v234, v4
v_fmac_f32 v71, v235, v8
v_fmac_f32 v63, v232, v5
v_fmac_f32 v71, v233, v9
s_waitcnt lgkmcnt(4)
MA 0,v,80,v,144
s_add_u32 s75, s64, s74
s_and_b32 s37, s3, 3
MA 8,v,80,v,148
ds_read_b128 v[112:115], v193 offset:0
MA 4,v,84,v,144
s_cmp_eq_u32 s37, 3
s_cselect_b32 s37, 0, 0x40000000
MA 12,v,84,v,148
v_add_u32 v229, s37, v78
buffer_load_dword v79, v229, s[4:7], 0 offen
MA 64,v,88,v,144
s_add_u32 m0, s67, 65536
v_mul_f32 v63, v63, v254
MA 72,v,88,v,148
v_mul_f32 v71, v71, v255
v_lshlrev_b32 v254, 16, v42
MA 68,v,92,v,144
v_and_b32 v255, 0xffff0000, v42
v_mul_f32 v64, v240, v2
MA 76,v,92,v,148
ds_read_b128 v[116:119], v193 offset:2048
v_mul_f32 v72, v241, v6
MA 128,v,96,v,144
buffer_load_dwordx4 v208, s[44:47], s75 offen offset:0 lds
v_fmac_f32 v64, v238, v3
MA 136,v,96,v,148
v_fmac_f32 v72, v239, v7
MA 132,v,100,v,144
v_fmac_f32 v64, v236, v4
v_fmac_f32 v72, v237, v8
MA 140,v,100,v,148
v_fmac_f32 v64, v234, v5
MA 192,v,104,v,144
v_fmac_f32 v72, v235, v9
MA 200,v,104,v,148
ds_read_b128 v[120:123], v193 offset:4096
buffer_load_dwordx4 v209, s[44:47], s75 offen offset:1024 lds
MA 196,v,108,v,144
TR 144,196,16384
TR 146,196,18432
MA 204,v,108,v,148
TR 148,197,16384
TR 150,197,18432
MA 212,v,108,v,152
v_mul_f32 v64, v64, v254
v_mul_f32 v72, v72, v255
MA 220,v,108,v,156
buffer_load_dwordx4 v210, s[44:47], s75 offen offset:2048 lds
v_lshlrev_b32 v254, 16, v44
MA 208,v,104,v,152
v_and_b32 v255, 0xffff0000, v44
v_mul_f32 v65, v242, v2
MA 216,v,104,v,156
v_mul_f32 v73, v243, v6
v_fmac_f32 v65, v240, v3
MA 148,v,100,v,152
ds_read_b128 v[124:127], v193 offset:6144
v_fmac_f32 v73, v241, v7
MA 156,v,100,v,156
v_fmac_f32 v65, v238, v4
v_fmac_f32 v73, v239, v8
MA 144,v,96,v,152
buffer_load_dwordx4 v211, s[44:47], s75 offen offset:3072 lds
v_fmac_f32 v65, v236, v5
MA 152,v,96,v,156
v_fmac_f32 v73, v237, v9
v_mul_f32 v65, v65, v254
MA 84,v,92,v,152
v_mul_f32 v73, v73, v255
v_lshlrev_b32 v254, 16, v46
MA 92,v,92,v,156
v_and_b32 v255, 0xffff0000, v46
v_mul_f32 v66, v244, v2
MA 80,v,88,v,152
ds_read_b128 v[128:131], v193 offset:8192
s_add_u32 s75, s65, s74
MA 88,v,88,v,156
v_mul_f32 v74, v245, v6
v_fmac_f32 v66, v242, v3
MA 20,v,84,v,152
v_fmac_f32 v74, v243, v7
v_fmac_f32 v66, v240, v4
MA 28,v,84,v,156
v_fmac_f32 v74, v241, v8
MA 16,v,80,v,152
TR 152,198,16384
TR 154,198,18432
MA 24,v,80,v,156
TR 156,199,16384
TR 158,199,18432
MA 32,v,80,v,160
ds_read_b128 v[132:135], v193 offset:10240
s_add_u32 m0, s67, 69632
MA 40,v,80,v,164
v_fmac_f32 v66, v238, v5
v_fmac_f32 v74, v239, v9
MA 36,v,84,v,160
v_mul_f32 v66, v66, v254
v_mul_f32 v74, v74, v255
MA 44,v,84,v,164
buffer_load_dwordx4 v208, s[44:47], s75 offen offset:0 lds
v_lshlrev_b32 v254, 16, v48
MA 96,v,88,v,160
v_and_b32 v255, 0xffff0000, v48
v_mul_f32 v67, v246, v2
MA 104,v,88,v,164
v_mul_f32 v75, v247, v6
v_fmac_f32 v67, v244, v3
MA 100,v,92,v,160
v_fmac_f32 v75, v245, v7
v_fmac_f32 v67, v242, v4
MA 108,v,92,v,164
ds_read_b128 v[136:139], v193 offset:12288
buffer_load_dwordx4 v209, s[44:47], s75 offen offset:1024 lds
MA 160,v,96,v,160
v_fmac_f32 v75, v243, v8
v_fmac_f32 v67, v240, v5
MA 168,v,96,v,164
v_fmac_f32 v75, v241, v9
v_mul_f32 v67, v67, v254
MA 164,v,100,v,160
v_mul_f32 v75, v75, v255
v_lshlrev_b32 v254, 16, v50
MA 172,v,100,v,164
v_and_b32 v255, 0xffff0000, v50
MA 224,v,104,v,160
buffer_load_dwordx4 v210, s[44:47], s75 offen offset:2048 lds
s_waitcnt vmcnt(27)
v_mul_f32 v68, v248, v2
MA 232,v,104,v,164
ds_read_b128 v[140:143], v193 offset:14336
v_mul_f32 v76, v249, v6
MA 228,v,108,v,160
TR 160,200,16384
TR 162,200,18432
MA 236,v,108,v,164
TR 164,201,16384
TR 166,201,18432
s_waitcnt lgkmcnt(15)
MA 244,v,108,v,168
buffer_load_dwordx4 v211, s[44:47], s75 offen offset:3072 lds
v_fmac_f32 v68, v246, v3
MA 252,v,108,v,172
v_fmac_f32 v76, v247, v7
v_fmac_f32 v68, v244, v4
MA 240,v,104,v,168
v_fmac_f32 v76, v245, v8
v_fmac_f32 v68, v242, v5
MA 248,v,104,v,172
v_fmac_f32 v76, v243, v9
v_mul_f32 v68, v68, v254
MA 180,v,100,v,168
v_mul_f32 v76, v76, v255
v_lshlrev_b32 v254, 16, v52
MA 188,v,100,v,172
s_add_u32 s74, s74, 128
v_and_b32 v255, 0xffff0000, v52
MA 176,v,96,v,168
v_mul_f32 v69, v250, v2
v_mul_f32 v77, v251, v6
MA 184,v,96,v,172
v_fmac_f32 v69, v248, v3
v_fmac_f32 v77, v249, v7
MA 116,v,92,v,168
v_fmac_f32 v69, v246, v4
MA 124,v,92,v,172
s_and_b32 s74, s74, 2047
v_fmac_f32 v77, v247, v8
MA 112,v,88,v,168
v_fmac_f32 v69, v244, v5
v_fmac_f32 v77, v245, v9
MA 120,v,88,v,172
v_mul_f32 v69, v69, v254
MA 52,v,84,v,168
v_mul_f32 v77, v77, v255
MA 60,v,84,v,172
v_cvt_pk_bf16_f32 v12, v69, v68
MA 48,v,80,v,168
TR 168,202,16384
TR 170,202,18432
MA 56,v,80,v,172
TR 172,203,16384
TR 174,203,18432
s_waitcnt lgkmcnt(4)
MA 0,v,112,v,144
MA 8,v,112,v,148
MA 4,v,116,v,144
MA 12,v,116,v,148
MA 64,v,120,v,144
MA 72,v,120,v,148
MA 68,v,124,v,144
MA 76,v,124,v,148
MA 128,v,128,v,144
MA 136,v,128,v,148
s_waitcnt vmcnt(9) lgkmcnt(0)
s_barrier
MA 132,v,132,v,144
s_add_u32 m0, s68, 98304
v_cvt_pk_bf16_f32 v13, v67, v66
MA 140,v,132,v,148
ds_read_b128 v[80:83], v192 offset:32768
v_cvt_pk_bf16_f32 v14, v65, v64
MA 192,v,136,v,144
v_cvt_pk_bf16_f32 v15, v63, v62
s_mov_b32 s36, 0
MA 200,v,136,v,148
buffer_load_dwordx4 v212, s[48:51], s66 offen offset:0 lds
buffer_store_dwordx4 v[12:15], v10, s[84:87], s36 offen sc1
MA 196,v,140,v,144
TR 144,196,32768
TR 146,196,34816
MA 204,v,140,v,148
TR 148,197,32768
TR 150,197,34816
MA 212,v,140,v,152
ds_read_b128 v[84:87], v192 offset:34816
v_cvt_pk_bf16_f32 v54, v77, v76
MA 220,v,140,v,156
buffer_load_dwordx4 v213, s[48:51], s66 offen offset:1024 lds
v_cvt_pk_bf16_f32 v55, v75, v74
MA 208,v,136,v,152
v_cvt_pk_bf16_f32 v56, v73, v72
v_cvt_pk_bf16_f32 v57, v71, v70
MA 216,v,136,v,156
s_mov_b32 s36, 4096
buffer_store_dwordx4 v[54:57], v10, s[84:87], s36 offen sc1
MA 148,v,132,v,152
v_lshlrev_b32 v2, 16, v58
v_and_b32 v3, 0xffff0000, v58
MA 156,v,132,v,156
ds_read_b128 v[88:91], v192 offset:36864
buffer_load_dwordx4 v214, s[48:51], s66 offen offset:2048 lds
MA 144,v,128,v,152
v_lshlrev_b32 v4, 16, v59
v_and_b32 v5, 0xffff0000, v59
MA 152,v,128,v,156
v_lshlrev_b32 v6, 16, v60
v_and_b32 v7, 0xffff0000, v60
MA 84,v,124,v,152
buffer_load_dwordx4 v215, s[48:51], s66 offen offset:3072 lds
v_lshlrev_b32 v8, 16, v61
MA 92,v,124,v,156
v_and_b32 v9, 0xffff0000, v61
v_lshlrev_b32 v230, 16, v17
MA 80,v,120,v,152
ds_read_b128 v[92:95], v192 offset:38912
v_and_b32 v231, 0xffff0000, v17
MA 88,v,120,v,156
v_lshlrev_b32 v232, 16, v19
v_and_b32 v233, 0xffff0000, v19
MA 20,v,116,v,152
s_add_u32 s66, s66, 524288
v_lshlrev_b32 v234, 16, v21
MA 28,v,116,v,156
v_and_b32 v235, 0xffff0000, v21
v_lshlrev_b32 v236, 16, v23
MA 16,v,112,v,152
TR 152,198,32768
TR 154,198,34816
MA 24,v,112,v,156
TR 156,199,32768
TR 158,199,34816
MA 32,v,112,v,160
ds_read_b128 v[96:99], v192 offset:40960
s_and_b32 s66, s66, 8388607
MA 40,v,112,v,164
v_and_b32 v237, 0xffff0000, v23
v_lshlrev_b32 v238, 16, v25
MA 36,v,116,v,160
v_and_b32 v239, 0xffff0000, v25
v_lshlrev_b32 v240, 16, v27
MA 44,v,116,v,164
v_and_b32 v241, 0xffff0000, v27
v_lshlrev_b32 v242, 16, v29
MA 96,v,120,v,160
ds_read_b128 v[100:103], v192 offset:43008
s_add_u32 m0, s68, 114688
MA 104,v,120,v,164
v_and_b32 v243, 0xffff0000, v29
v_lshlrev_b32 v244, 16, v31
MA 100,v,124,v,160
v_and_b32 v245, 0xffff0000, v31
v_lshlrev_b32 v246, 16, v33
MA 108,v,124,v,164
buffer_load_dwordx4 v212, s[48:51], s66 offen offset:0 lds
v_and_b32 v247, 0xffff0000, v33
MA 160,v,128,v,160
v_lshlrev_b32 v248, 16, v35
v_and_b32 v249, 0xffff0000, v35
MA 168,v,128,v,164
ds_read_b128 v[104:107], v192 offset:45056
v_lshlrev_b32 v250, 16, v37
MA 164,v,132,v,160
v_and_b32 v251, 0xffff0000, v37
v_lshlrev_b32 v254, 16, v39
MA 172,v,132,v,164
buffer_load_dwordx4 v213, s[48:51], s66 offen offset:1024 lds
v_and_b32 v255, 0xffff0000, v39
MA 224,v,136,v,160
v_mul_f32 v62, v236, v2
v_mul_f32 v70, v237, v6
MA 232,v,136,v,164
v_fmac_f32 v62, v234, v3
v_fmac_f32 v70, v235, v7
MA 228,v,140,v,160
TR 160,200,32768
TR 162,200,34816
MA 236,v,140,v,164
TR 164,201,32768
TR 166,201,34816
MA 244,v,140,v,168
ds_read_b128 v[108:111], v192 offset:47104
buffer_load_dwordx4 v214, s[48:51], s66 offen offset:2048 lds
MA 252,v,140,v,172
v_fmac_f32 v62, v232, v4
v_fmac_f32 v70, v233, v8
MA 240,v,136,v,168
buffer_load_dwordx4 v215, s[48:51], s66 offen offset:3072 lds
v_fmac_f32 v62, v230, v5
MA 248,v,136,v,172
v_fmac_f32 v70, v231, v9
v_mul_f32 v62, v62, v254
MA 180,v,132,v,168
v_mul_f32 v70, v70, v255
v_lshlrev_b32 v254, 16, v41
MA 188,v,132,v,172
v_and_b32 v255, 0xffff0000, v41
v_mul_f32 v63, v238, v2
MA 176,v,128,v,168
s_add_u32 s66, s66, 524288
v_mul_f32 v71, v239, v6
MA 184,v,128,v,172
v_fmac_f32 v63, v236, v3
v_fmac_f32 v71, v237, v7
MA 116,v,124,v,168
v_fmac_f32 v63, v234, v4
v_fmac_f32 v71, v235, v8
MA 124,v,124,v,172
v_fmac_f32 v63, v232, v5
v_fmac_f32 v71, v233, v9
MA 112,v,120,v,168
s_and_b32 s66, s66, 8388607
v_mul_f32 v63, v63, v254
MA 120,v,120,v,172
v_mul_f32 v71, v71, v255
v_lshlrev_b32 v254, 16, v43
MA 52,v,116,v,168
v_and_b32 v255, 0xffff0000, v43
v_mul_f32 v64, v240, v2
MA 60,v,116,v,172
v_mul_f32 v72, v241, v6
v_fmac_f32 v64, v238, v3
MA 48,v,112,v,168
TR 168,202,32768
TR 170,202,34816
MA 56,v,112,v,172
TR 172,203,32768
TR 174,203,34816
v_fmac_f32 v72, v239, v7
v_fmac_f32 v64, v236, v4
v_fmac_f32 v72, v237, v8
v_fmac_f32 v64, v234, v5
s_waitcnt lgkmcnt(4)
MA 0,v,80,v,144
s_add_u32 s75, s64, s74
v_fmac_f32 v72, v235, v9
MA 8,v,80,v,148
ds_read_b128 v[112:115], v193 offset:32768
v_mul_f32 v64, v64, v254
MA 4,v,84,v,144
v_mul_f32 v72, v72, v255
v_lshlrev_b32 v254, 16, v45
MA 12,v,84,v,148
v_and_b32 v255, 0xffff0000, v45
MA 64,v,88,v,144
s_add_u32 m0, s67, 0
v_mul_f32 v65, v242, v2
MA 72,v,88,v,148
v_mul_f32 v73, v243, v6
v_fmac_f32 v65, v240, v3
MA 68,v,92,v,144
v_fmac_f32 v73, v241, v7
MA 76,v,92,v,148
ds_read_b128 v[116:119], v193 offset:34816
v_fmac_f32 v65, v238, v4
MA 128,v,96,v,144
buffer_load_dwordx4 v208, s[44:47], s75 offen offset:0 lds
v_fmac_f32 v73, v239, v8
MA 136,v,96,v,148
v_fmac_f32 v65, v236, v5
v_fmac_f32 v73, v237, v9
MA 132,v,100,v,144
v_mul_f32 v65, v65, v254
MA 140,v,100,v,148
v_mul_f32 v73, v73, v255
MA 192,v,104,v,144
v_lshlrev_b32 v254, 16, v47
MA 200,v,104,v,148
ds_read_b128 v[120:123], v193 offset:36864
buffer_load_dwordx4 v209, s[44:47], s75 offen offset:1024 lds
MA 196,v,108,v,144
TR 144,196,49152
TR 146,196,51200
MA 204,v,108,v,148
TR 148,197,49152
TR 150,197,51200
MA 212,v,108,v,152
v_and_b32 v255, 0xffff0000, v47
v_mul_f32 v66, v244, v2
MA 220,v,108,v,156
buffer_load_dwordx4 v210, s[44:47], s75 offen offset:2048 lds
v_mul_f32 v74, v245, v6
MA 208,v,104,v,152
v_fmac_f32 v66, v242, v3
v_fmac_f32 v74, v243, v7
MA 216,v,104,v,156
v_fmac_f32 v66, v240, v4
v_fmac_f32 v74, v241, v8
MA 148,v,100,v,152
ds_read_b128 v[124:127], v193 offset:38912
v_fmac_f32 v66, v238, v5
MA 156,v,100,v,156
v_fmac_f32 v74, v239, v9
v_mul_f32 v66, v66, v254
MA 144,v,96,v,152
buffer_load_dwordx4 v211, s[44:47], s75 offen offset:3072 lds
v_mul_f32 v74, v74, v255
MA 152,v,96,v,156
v_lshlrev_b32 v254, 16, v49
v_and_b32 v255, 0xffff0000, v49
MA 84,v,92,v,152
v_mul_f32 v67, v246, v2
v_mul_f32 v75, v247, v6
MA 92,v,92,v,156
v_fmac_f32 v67, v244, v3
MA 80,v,88,v,152
ds_read_b128 v[128:131], v193 offset:40960
s_add_u32 s75, s65, s74
MA 88,v,88,v,156
v_fmac_f32 v75, v245, v7
v_fmac_f32 v67, v242, v4
MA 20,v,84,v,152
v_fmac_f32 v75, v243, v8
v_fmac_f32 v67, v240, v5
MA 28,v,84,v,156
v_fmac_f32 v75, v241, v9
MA 16,v,80,v,152
TR 152,198,49152
TR 154,198,51200
MA 24,v,80,v,156
TR 156,199,49152
TR 158,199,51200
MA 32,v,80,v,160
ds_read_b128 v[132:135], v193 offset:43008
s_add_u32 m0, s67, 4096
MA 40,v,80,v,164
v_mul_f32 v67, v67, v254
v_mul_f32 v75, v75, v255
MA 36,v,84,v,160
v_lshlrev_b32 v254, 16, v51
v_and_b32 v255, 0xffff0000, v51
MA 44,v,84,v,164
buffer_load_dwordx4 v208, s[44:47], s75 offen offset:0 lds
v_mul_f32 v68, v248, v2
MA 96,v,88,v,160
v_mul_f32 v76, v249, v6
v_fmac_f32 v68, v246, v3
MA 104,v,88,v,164
v_fmac_f32 v76, v247, v7
v_fmac_f32 v68, v244, v4
MA 100,v,92,v,160
v_fmac_f32 v76, v245, v8
v_fmac_f32 v68, v242, v5
MA 108,v,92,v,164
ds_read_b128 v[136:139], v193 offset:45056
buffer_load_dwordx4 v209, s[44:47], s75 offen offset:1024 lds
MA 160,v,96,v,160
v_fmac_f32 v76, v243, v9
v_mul_f32 v68, v68, v254
MA 168,v,96,v,164
v_mul_f32 v76, v76, v255
v_lshlrev_b32 v254, 16, v53
MA 164,v,100,v,160
v_and_b32 v255, 0xffff0000, v53
MA 172,v,100,v,164
v_mul_f32 v69, v250, v2
MA 224,v,104,v,160
buffer_load_dwordx4 v210, s[44:47], s75 offen offset:2048 lds
v_mul_f32 v77, v251, v6
MA 232,v,104,v,164
ds_read_b128 v[140:143], v193 offset:47104
v_fmac_f32 v69, v248, v3
MA 228,v,108,v,160
TR 160,200,49152
TR 162,200,51200
MA 236,v,108,v,164
TR 164,201,49152
TR 166,201,51200
s_waitcnt lgkmcnt(15)
MA 244,v,108,v,168
buffer_load_dwordx4 v211, s[44:47], s75 offen offset:3072 lds
v_fmac_f32 v77, v249, v7
MA 252,v,108,v,172
v_fmac_f32 v69, v246, v4
v_fmac_f32 v77, v247, v8
MA 240,v,104,v,168
v_fmac_f32 v69, v244, v5
v_fmac_f32 v77, v245, v9
MA 248,v,104,v,172
v_mul_f32 v69, v69, v254
v_mul_f32 v77, v77, v255
MA 180,v,100,v,168
v_cvt_pk_bf16_f32 v230, v69, v68
v_cvt_pk_bf16_f32 v231, v67, v66
MA 188,v,100,v,172
s_add_u32 s74, s74, 128
v_cvt_pk_bf16_f32 v232, v65, v64
MA 176,v,96,v,168
v_cvt_pk_bf16_f32 v233, v63, v62
s_mov_b32 s36, 8192
MA 184,v,96,v,172
buffer_store_dwordx4 v[230:233], v10, s[84:87], s36 offen sc1
MA 116,v,92,v,168
v_cvt_pk_bf16_f32 v234, v77, v76
MA 124,v,92,v,172
s_and_b32 s74, s74, 2047
v_cvt_pk_bf16_f32 v235, v75, v74
MA 112,v,88,v,168
v_cvt_pk_bf16_f32 v236, v73, v72
v_cvt_pk_bf16_f32 v237, v71, v70
MA 120,v,88,v,172
s_mov_b32 s36, 12288
MA 52,v,84,v,168
buffer_store_dwordx4 v[234:237], v10, s[84:87], s36 offen sc1
MA 60,v,84,v,172
v_lshlrev_b32 v228, 4, v1
MA 48,v,80,v,168
TR 168,202,49152
TR 170,202,51200
MA 56,v,80,v,172
TR 172,203,49152
TR 174,203,51200
s_waitcnt lgkmcnt(4)
MA 0,v,112,v,144
MA 8,v,112,v,148
MA 4,v,116,v,144
MA 12,v,116,v,148
MA 64,v,120,v,144
MA 72,v,120,v,148
MA 68,v,124,v,144
MA 76,v,124,v,148
MA 128,v,128,v,144
MA 136,v,128,v,148
s_waitcnt vmcnt(14) lgkmcnt(0)
s_barrier
MA 132,v,132,v,144
ds_read_b128 v[48:51], v226 offset:0
s_add_u32 m0, s68, 131072
MA 140,v,132,v,148
MA 192,v,136,v,144
ds_read_b128 v[52:55], v226 offset:2048
buffer_load_dwordx4 v212, s[48:51], s66 offen offset:0 lds
MA 200,v,136,v,148
MA 196,v,140,v,144
ds_read_b128 v[56:59], v226 offset:4096
buffer_load_dwordx4 v213, s[48:51], s66 offen offset:1024 lds
MA 204,v,140,v,148
MA 212,v,140,v,152
ds_read_b128 v[60:63], v226 offset:6144
MA 220,v,140,v,156
buffer_load_dwordx4 v214, s[48:51], s66 offen offset:2048 lds
MA 208,v,136,v,152
TR 16,216,0
MA 216,v,136,v,156
buffer_load_dwordx4 v215, s[48:51], s66 offen offset:3072 lds
MA 148,v,132,v,152
TR 18,216,1024
MA 156,v,132,v,156
MA 144,v,128,v,152
TR 20,217,0
s_add_u32 s66, s66, 524288
MA 152,v,128,v,156
MA 84,v,124,v,152
TR 22,217,1024
s_and_b32 s66, s66, 8388607
MA 92,v,124,v,156
MA 80,v,120,v,152
TR 24,218,0
MA 88,v,120,v,156
s_add_u32 s75, s64, s74
MA 20,v,116,v,152
TR 26,218,1024
MA 28,v,116,v,156
s_add_u32 m0, s67, 32768
MA 16,v,112,v,152
TR 28,219,0
MA 24,v,112,v,156
MA 32,v,112,v,160
TR 30,219,1024
buffer_load_dwordx4 v208, s[44:47], s75 offen offset:0 lds
MA 40,v,112,v,164
MA 36,v,116,v,160
TR 32,220,0
buffer_load_dwordx4 v209, s[44:47], s75 offen offset:1024 lds
MA 44,v,116,v,164
MA 96,v,120,v,160
TR 34,220,1024
MA 104,v,120,v,164
buffer_load_dwordx4 v210, s[44:47], s75 offen offset:2048 lds
MA 100,v,124,v,160
TR 36,221,0
MA 108,v,124,v,164
buffer_load_dwordx4 v211, s[44:47], s75 offen offset:3072 lds
MA 160,v,128,v,160
TR 38,221,1024
MA 168,v,128,v,164
MA 164,v,132,v,160
TR 40,222,0
s_add_u32 s75, s65, s74
MA 172,v,132,v,164
MA 224,v,136,v,160
TR 42,222,1024
s_add_u32 m0, s67, 36864
MA 232,v,136,v,164
MA 228,v,140,v,160
TR 44,223,0
MA 236,v,140,v,164
buffer_load_dwordx4 v208, s[44:47], s75 offen offset:0 lds
MA 244,v,140,v,168
TR 46,223,1024
MA 252,v,140,v,172
buffer_load_dwordx4 v209, s[44:47], s75 offen offset:1024 lds
MA 240,v,136,v,168
MA 248,v,136,v,172
MA 180,v,132,v,168
buffer_load_dwordx4 v210, s[44:47], s75 offen offset:2048 lds
MA 188,v,132,v,172
MA 176,v,128,v,168
buffer_load_dwordx4 v211, s[44:47], s75 offen offset:3072 lds
MA 184,v,128,v,172
MA 116,v,124,v,168
MA 124,v,124,v,172
s_add_u32 s74, s74, 128
MA 112,v,120,v,168
MA 120,v,120,v,172
s_and_b32 s74, s74, 2047
MA 52,v,116,v,168
MA 60,v,116,v,172
MA 48,v,112,v,168
MA 56,v,112,v,172
L_p2:
s_waitcnt lgkmcnt(4)
v_mfma_f32_16x16x32_bf16 v[80:83], v[16:19], v[48:51], 0
s_add_u32 s8, s40, 59768832
s_addc_u32 s9, s41, 0
v_mfma_f32_16x16x32_bf16 v[96:99], v[20:23], v[48:51], 0
ds_read_b128 v[64:67], v227 offset:0
v_mfma_f32_16x16x32_bf16 v[84:87], v[16:19], v[52:55], 0
s_mov_b32 s10, 8192
v_mfma_f32_16x16x32_bf16 v[100:103], v[20:23], v[52:55], 0
s_mov_b32 s11, 0x20000
v_mfma_f32_16x16x32_bf16 v[88:91], v[16:19], v[56:59], 0
s_mov_b32 s12, s38
v_mfma_f32_16x16x32_bf16 v[104:107], v[20:23], v[56:59], 0
s_mov_b32 s13, s39
v_mfma_f32_16x16x32_bf16 v[92:95], v[16:19], v[60:63], 0
TR 16,216,8192
TR 18,216,9216
v_mfma_f32_16x16x32_bf16 v[108:111], v[20:23], v[60:63], 0
TR 20,217,8192
TR 22,217,9216
v_mfma_f32_16x16x32_bf16 v[124:127], v[24:27], v[60:63], 0
ds_read_b128 v[68:71], v227 offset:2048
s_mov_b32 s14, 256
v_mfma_f32_16x16x32_bf16 v[140:143], v[28:31], v[60:63], 0
s_mov_b32 s15, 0x20000
v_accvgpr_read_b32 v234, a0
v_mfma_f32_16x16x32_bf16 v[120:123], v[24:27], v[56:59], 0
v_accvgpr_read_b32 v235, a1
v_accvgpr_read_b32 v236, a2
v_mfma_f32_16x16x32_bf16 v[136:139], v[28:31], v[56:59], 0
v_accvgpr_read_b32 v237, a3
v_mfma_f32_16x16x32_bf16 v[116:119], v[24:27], v[52:55], 0
ds_read_b128 v[72:75], v227 offset:4096
v_accvgpr_read_b32 v238, a4
v_mfma_f32_16x16x32_bf16 v[132:135], v[28:31], v[52:55], 0
v_accvgpr_read_b32 v239, a5
v_mfma_f32_16x16x32_bf16 v[112:115], v[24:27], v[48:51], 0
TR 24,218,8192
TR 26,218,9216
v_mfma_f32_16x16x32_bf16 v[128:131], v[28:31], v[48:51], 0
TR 28,219,8192
TR 30,219,9216
v_mfma_f32_16x16x32_bf16 v[144:147], v[32:35], v[48:51], 0
v_accvgpr_read_b32 v240, a6
v_accvgpr_read_b32 v241, a7
v_mfma_f32_16x16x32_bf16 v[160:163], v[36:39], v[48:51], 0
v_cvt_pk_bf16_f32 v230, v234, v235
v_cvt_pk_bf16_f32 v231, v236, v237
v_mfma_f32_16x16x32_bf16 v[148:151], v[32:35], v[52:55], 0
ds_read_b128 v[76:79], v227 offset:6144
v_cvt_pk_bf16_f32 v232, v238, v239
v_mfma_f32_16x16x32_bf16 v[164:167], v[36:39], v[52:55], 0
v_cvt_pk_bf16_f32 v233, v240, v241
v_mfma_f32_16x16x32_bf16 v[152:155], v[32:35], v[56:59], 0
buffer_store_dwordx4 v[230:233], v228, s[16:19], s24 offen offset:0 sc1
v_mfma_f32_16x16x32_bf16 v[168:171], v[36:39], v[56:59], 0
v_accvgpr_read_b32 v246, a8
v_mfma_f32_16x16x32_bf16 v[156:159], v[32:35], v[60:63], 0
TR 32,220,8192
TR 34,220,9216
v_mfma_f32_16x16x32_bf16 v[172:175], v[36:39], v[60:63], 0
TR 36,221,8192
TR 38,221,9216
s_waitcnt lgkmcnt(15)
v_mfma_f32_16x16x32_bf16 v[188:191], v[40:43], v[60:63], 0
v_accvgpr_read_b32 v247, a9
v_accvgpr_read_b32 v248, a10
v_mfma_f32_16x16x32_bf16 v[204:207], v[44:47], v[60:63], 0
v_accvgpr_read_b32 v249, a11
v_accvgpr_read_b32 v250, a12
v_mfma_f32_16x16x32_bf16 v[184:187], v[40:43], v[56:59], 0
v_accvgpr_read_b32 v251, a13
v_mfma_f32_16x16x32_bf16 v[200:203], v[44:47], v[56:59], 0
v_accvgpr_read_b32 v252, a14
v_mfma_f32_16x16x32_bf16 v[180:183], v[40:43], v[52:55], 0
v_accvgpr_read_b32 v253, a15
v_mfma_f32_16x16x32_bf16 v[196:199], v[44:47], v[52:55], 0
v_mfma_f32_16x16x32_bf16 v[176:179], v[40:43], v[48:51], 0
TR 40,222,8192
TR 42,222,9216
v_mfma_f32_16x16x32_bf16 v[192:195], v[44:47], v[48:51], 0
TR 44,223,8192
TR 46,223,9216
s_waitcnt lgkmcnt(4)
MV 80,v,16,v,64
v_cvt_pk_bf16_f32 v242, v246, v247
MV 96,v,20,v,64
v_cvt_pk_bf16_f32 v243, v248, v249
MV 84,v,16,v,68
v_cvt_pk_bf16_f32 v244, v250, v251
MV 100,v,20,v,68
MV 88,v,16,v,72
v_cvt_pk_bf16_f32 v245, v252, v253
MV 104,v,20,v,72
buffer_store_dwordx4 v[242:245], v228, s[16:19], s24 offen offset:1024 sc1
MV 92,v,16,v,76
MV 108,v,20,v,76
s_waitcnt vmcnt(16) lgkmcnt(0)
s_barrier
MV 124,v,24,v,76
TR 16,216,16384
TR 18,216,17408
MV 140,v,28,v,76
ds_read_b128 v[48:51], v224 offset:0
s_add_u32 m0, s68, 98304
MV 120,v,24,v,72
TR 20,217,16384
TR 22,217,17408
MV 136,v,28,v,72
buffer_load_dwordx4 v212, s[48:51], s66 offen offset:0 lds
v_accvgpr_read_b32 v234, a16
MV 116,v,24,v,68
ds_read_b128 v[52:55], v224 offset:2048
buffer_load_dwordx4 v213, s[48:51], s66 offen offset:1024 lds
MV 132,v,28,v,68
v_accvgpr_read_b32 v235, a17
v_accvgpr_read_b32 v236, a18
MV 112,v,24,v,64
TR 24,218,16384
TR 26,218,17408
MV 128,v,28,v,64
TR 28,219,16384
TR 30,219,17408
MV 144,v,32,v,64
ds_read_b128 v[56:59], v224 offset:4096
buffer_load_dwordx4 v214, s[48:51], s66 offen offset:2048 lds
MV 160,v,36,v,64
buffer_load_dwordx4 v215, s[48:51], s66 offen offset:3072 lds
v_accvgpr_read_b32 v237, a19
MV 148,v,32,v,68
v_accvgpr_read_b32 v238, a20
v_accvgpr_read_b32 v239, a21
MV 164,v,36,v,68
s_add_u32 s66, s66, 524288
v_accvgpr_read_b32 v240, a22
MV 152,v,32,v,72
ds_read_b128 v[60:63], v224 offset:6144
v_accvgpr_read_b32 v241, a23
MV 168,v,36,v,72
s_and_b32 s66, s66, 8388607
v_cvt_pk_bf16_f32 v230, v234, v235
MV 156,v,32,v,76
TR 32,220,16384
TR 34,220,17408
MV 172,v,36,v,76
TR 36,221,16384
TR 38,221,17408
MV 188,v,40,v,76
s_add_u32 s75, s64, s74
v_cvt_pk_bf16_f32 v231, v236, v237
MV 204,v,44,v,76
v_cvt_pk_bf16_f32 v232, v238, v239
v_cvt_pk_bf16_f32 v233, v240, v241
MV 184,v,40,v,72
s_add_u32 m0, s67, 65536
buffer_store_dwordx4 v[230:233], v228, s[16:19], s24 offen offset:2048 sc1
MV 200,v,44,v,72
v_accvgpr_read_b32 v246, a24
v_accvgpr_read_b32 v247, a25
MV 180,v,40,v,68
buffer_load_dwordx4 v208, s[44:47], s75 offen offset:0 lds
v_accvgpr_read_b32 v248, a26
MV 196,v,44,v,68
MV 176,v,40,v,64
TR 40,222,16384
TR 42,222,17408
MV 192,v,44,v,64
TR 44,223,16384
TR 46,223,17408
s_waitcnt lgkmcnt(4)
MV 80,v,16,v,48
buffer_load_dwordx4 v209, s[44:47], s75 offen offset:1024 lds
v_accvgpr_read_b32 v249, a27
MV 96,v,20,v,48
ds_read_b128 v[64:67], v225 offset:0
v_accvgpr_read_b32 v250, a28
MV 84,v,16,v,52
buffer_load_dwordx4 v210, s[44:47], s75 offen offset:2048 lds
v_accvgpr_read_b32 v251, a29
MV 100,v,20,v,52
MV 88,v,16,v,56
v_accvgpr_read_b32 v252, a30
MV 104,v,20,v,56
buffer_load_dwordx4 v211, s[44:47], s75 offen offset:3072 lds
v_accvgpr_read_b32 v253, a31
MV 92,v,16,v,60
TR 16,216,24576
TR 18,216,25600
MV 108,v,20,v,60
TR 20,217,24576
TR 22,217,25600
MV 124,v,24,v,60
ds_read_b128 v[68:71], v225 offset:2048
s_add_u32 s75, s65, s74
MV 140,v,28,v,60
v_cvt_pk_bf16_f32 v242, v246, v247
v_cvt_pk_bf16_f32 v243, v248, v249
MV 120,v,24,v,56
v_cvt_pk_bf16_f32 v244, v250, v251
MV 136,v,28,v,56
s_add_u32 m0, s67, 69632
v_cvt_pk_bf16_f32 v245, v252, v253
MV 116,v,24,v,52
ds_read_b128 v[72:75], v225 offset:4096
buffer_store_dwordx4 v[242:245], v228, s[16:19], s24 offen offset:3072 sc1
MV 132,v,28,v,52
MV 112,v,24,v,48
TR 24,218,24576
TR 26,218,25600
MV 128,v,28,v,48
TR 28,219,24576
TR 30,219,25600
MV 144,v,32,v,48
buffer_load_dwordx4 v208, s[44:47], s75 offen offset:0 lds
buffer_load_dwordx4 v209, s[44:47], s75 offen offset:1024 lds
MV 160,v,36,v,48
v_accvgpr_read_b32 v234, a32
v_accvgpr_read_b32 v235, a33
MV 148,v,32,v,52
ds_read_b128 v[76:79], v225 offset:6144
v_accvgpr_read_b32 v236, a34
MV 164,v,36,v,52
buffer_load_dwordx4 v210, s[44:47], s75 offen offset:2048 lds
v_accvgpr_read_b32 v237, a35
MV 152,v,32,v,56
v_accvgpr_read_b32 v238, a36
MV 168,v,36,v,56
v_accvgpr_read_b32 v239, a37
MV 156,v,32,v,60
TR 32,220,24576
TR 34,220,25600
MV 172,v,36,v,60
TR 36,221,24576
TR 38,221,25600
s_waitcnt lgkmcnt(15)
MV 188,v,40,v,60
buffer_load_dwordx4 v211, s[44:47], s75 offen offset:3072 lds
v_accvgpr_read_b32 v240, a38
MV 204,v,44,v,60
s_add_u32 s74, s74, 128
v_accvgpr_read_b32 v241, a39
MV 184,v,40,v,56
v_cvt_pk_bf16_f32 v230, v234, v235
MV 200,v,44,v,56
v_cvt_pk_bf16_f32 v231, v236, v237
MV 180,v,40,v,52
s_and_b32 s74, s74, 2047
v_cvt_pk_bf16_f32 v232, v238, v239
MV 196,v,44,v,52
MV 176,v,40,v,48
TR 40,222,24576
TR 42,222,25600
MV 192,v,44,v,48
TR 44,223,24576
TR 46,223,25600
s_waitcnt lgkmcnt(4)
MV 80,v,16,v,64
v_cvt_pk_bf16_f32 v233, v240, v241
MV 96,v,20,v,64
s_add_u32 s24, s24, 4096
MV 84,v,16,v,68
buffer_store_dwordx4 v[230:233], v228, s[16:19], s24 offen offset:0 sc1
MV 100,v,20,v,68
MV 88,v,16,v,72
v_accvgpr_read_b32 v246, a40
MV 104,v,20,v,72
v_accvgpr_read_b32 v247, a41
MV 92,v,16,v,76
MV 108,v,20,v,76
s_waitcnt vmcnt(17) lgkmcnt(0)
s_barrier
MV 124,v,24,v,76
TR 16,216,32768
TR 18,216,33792
MV 140,v,28,v,76
ds_read_b128 v[48:51], v224 offset:32768
s_add_u32 m0, s68, 114688
MV 120,v,24,v,72
TR 20,217,32768
TR 22,217,33792
MV 136,v,28,v,72
buffer_load_dwordx4 v212, s[48:51], s66 offen offset:0 lds
v_accvgpr_read_b32 v248, a42
MV 116,v,24,v,68
ds_read_b128 v[52:55], v224 offset:34816
buffer_load_dwordx4 v213, s[48:51], s66 offen offset:1024 lds
MV 132,v,28,v,68
v_accvgpr_read_b32 v249, a43
v_accvgpr_read_b32 v250, a44
MV 112,v,24,v,64
TR 24,218,32768
TR 26,218,33792
MV 128,v,28,v,64
TR 28,219,32768
TR 30,219,33792
MV 144,v,32,v,64
ds_read_b128 v[56:59], v224 offset:36864
buffer_load_dwordx4 v214, s[48:51], s66 offen offset:2048 lds
MV 160,v,36,v,64
buffer_load_dwordx4 v215, s[48:51], s66 offen offset:3072 lds
v_accvgpr_read_b32 v251, a45
MV 148,v,32,v,68
v_accvgpr_read_b32 v252, a46
v_accvgpr_read_b32 v253, a47
MV 164,v,36,v,68
s_add_u32 s66, s66, 524288
v_cvt_pk_bf16_f32 v242, v246, v247
MV 152,v,32,v,72
ds_read_b128 v[60:63], v224 offset:38912
v_cvt_pk_bf16_f32 v243, v248, v249
MV 168,v,36,v,72
s_and_b32 s66, s66, 8388607
v_cvt_pk_bf16_f32 v244, v250, v251
MV 156,v,32,v,76
TR 32,220,32768
TR 34,220,33792
MV 172,v,36,v,76
TR 36,221,32768
TR 38,221,33792
MV 188,v,40,v,76
s_add_u32 s75, s64, s74
v_cvt_pk_bf16_f32 v245, v252, v253
MV 204,v,44,v,76
buffer_store_dwordx4 v[242:245], v228, s[16:19], s24 offen offset:1024 sc1
v_accvgpr_read_b32 v234, a48
MV 184,v,40,v,72
s_add_u32 m0, s67, 0
v_accvgpr_read_b32 v235, a49
MV 200,v,44,v,72
v_accvgpr_read_b32 v236, a50
v_accvgpr_read_b32 v237, a51
MV 180,v,40,v,68
buffer_load_dwordx4 v208, s[44:47], s75 offen offset:0 lds
v_accvgpr_read_b32 v238, a52
MV 196,v,44,v,68
MV 176,v,40,v,64
TR 40,222,32768
TR 42,222,33792
MV 192,v,44,v,64
TR 44,223,32768
TR 46,223,33792
s_waitcnt lgkmcnt(4)
MV 80,v,16,v,48
buffer_load_dwordx4 v209, s[44:47], s75 offen offset:1024 lds
v_accvgpr_read_b32 v239, a53
MV 96,v,20,v,48
ds_read_b128 v[64:67], v225 offset:32768
v_accvgpr_read_b32 v240, a54
MV 84,v,16,v,52
buffer_load_dwordx4 v210, s[44:47], s75 offen offset:2048 lds
v_accvgpr_read_b32 v241, a55
MV 100,v,20,v,52
MV 88,v,16,v,56
v_cvt_pk_bf16_f32 v230, v234, v235
MV 104,v,20,v,56
buffer_load_dwordx4 v211, s[44:47], s75 offen offset:3072 lds
v_cvt_pk_bf16_f32 v231, v236, v237
MV 92,v,16,v,60
TR 16,216,40960
TR 18,216,41984
MV 108,v,20,v,60
TR 20,217,40960
TR 22,217,41984
MV 124,v,24,v,60
ds_read_b128 v[68:71], v225 offset:34816
s_add_u32 s75, s65, s74
MV 140,v,28,v,60
v_cvt_pk_bf16_f32 v232, v238, v239
v_cvt_pk_bf16_f32 v233, v240, v241
MV 120,v,24,v,56
buffer_store_dwordx4 v[230:233], v228, s[16:19], s24 offen offset:2048 sc1
MV 136,v,28,v,56
s_add_u32 m0, s67, 4096
v_accvgpr_read_b32 v246, a56
MV 116,v,24,v,52
ds_read_b128 v[72:75], v225 offset:36864
v_accvgpr_read_b32 v247, a57
MV 132,v,28,v,52
MV 112,v,24,v,48
TR 24,218,40960
TR 26,218,41984
MV 128,v,28,v,48
TR 28,219,40960
TR 30,219,41984
MV 144,v,32,v,48
buffer_load_dwordx4 v208, s[44:47], s75 offen offset:0 lds
buffer_load_dwordx4 v209, s[44:47], s75 offen offset:1024 lds
MV 160,v,36,v,48
v_accvgpr_read_b32 v248, a58
v_accvgpr_read_b32 v249, a59
MV 148,v,32,v,52
ds_read_b128 v[76:79], v225 offset:38912
v_accvgpr_read_b32 v250, a60
MV 164,v,36,v,52
buffer_load_dwordx4 v210, s[44:47], s75 offen offset:2048 lds
v_accvgpr_read_b32 v251, a61
MV 152,v,32,v,56
v_accvgpr_read_b32 v252, a62
MV 168,v,36,v,56
v_accvgpr_read_b32 v253, a63
MV 156,v,32,v,60
TR 32,220,40960
TR 34,220,41984
MV 172,v,36,v,60
TR 36,221,40960
TR 38,221,41984
s_waitcnt lgkmcnt(15)
MV 188,v,40,v,60
buffer_load_dwordx4 v211, s[44:47], s75 offen offset:3072 lds
v_cvt_pk_bf16_f32 v242, v246, v247
MV 204,v,44,v,60
s_add_u32 s74, s74, 128
v_cvt_pk_bf16_f32 v243, v248, v249
MV 184,v,40,v,56
v_cvt_pk_bf16_f32 v244, v250, v251
MV 200,v,44,v,56
v_cvt_pk_bf16_f32 v245, v252, v253
MV 180,v,40,v,52
s_and_b32 s74, s74, 2047
buffer_store_dwordx4 v[242:245], v228, s[16:19], s24 offen offset:3072 sc1
MV 196,v,44,v,52
MV 176,v,40,v,48
TR 40,222,40960
TR 42,222,41984
MV 192,v,44,v,48
TR 44,223,40960
TR 46,223,41984
s_waitcnt lgkmcnt(4)
MV 80,v,16,v,64
v_accvgpr_read_b32 v234, a64
MV 96,v,20,v,64
v_accvgpr_read_b32 v235, a65
MV 84,v,16,v,68
v_accvgpr_read_b32 v236, a66
MV 100,v,20,v,68
MV 88,v,16,v,72
v_accvgpr_read_b32 v237, a67
MV 104,v,20,v,72
v_accvgpr_read_b32 v238, a68
MV 92,v,16,v,76
MV 108,v,20,v,76
s_waitcnt vmcnt(16) lgkmcnt(0)
s_barrier
MV 124,v,24,v,76
TR 16,216,0
TR 18,216,1024
MV 140,v,28,v,76
ds_read_b128 v[48:51], v226 offset:0
s_add_u32 m0, s68, 131072
MV 120,v,24,v,72
TR 20,217,0
TR 22,217,1024
MV 136,v,28,v,72
buffer_load_dwordx4 v212, s[48:51], s66 offen offset:0 lds
v_accvgpr_read_b32 v239, a69
MV 116,v,24,v,68
ds_read_b128 v[52:55], v226 offset:2048
buffer_load_dwordx4 v213, s[48:51], s66 offen offset:1024 lds
MV 132,v,28,v,68
v_accvgpr_read_b32 v240, a70
v_accvgpr_read_b32 v241, a71
MV 112,v,24,v,64
TR 24,218,0
TR 26,218,1024
MV 128,v,28,v,64
TR 28,219,0
TR 30,219,1024
MV 144,v,32,v,64
ds_read_b128 v[56:59], v226 offset:4096
buffer_load_dwordx4 v214, s[48:51], s66 offen offset:2048 lds
MV 160,v,36,v,64
buffer_load_dwordx4 v215, s[48:51], s66 offen offset:3072 lds
v_cvt_pk_bf16_f32 v230, v234, v235
MV 148,v,32,v,68
v_cvt_pk_bf16_f32 v231, v236, v237
v_cvt_pk_bf16_f32 v232, v238, v239
MV 164,v,36,v,68
s_add_u32 s66, s66, 524288
v_cvt_pk_bf16_f32 v233, v240, v241
MV 152,v,32,v,72
ds_read_b128 v[60:63], v226 offset:6144
s_add_u32 s24, s24, 4096
MV 168,v,36,v,72
s_and_b32 s66, s66, 8388607
buffer_store_dwordx4 v[230:233], v228, s[16:19], s24 offen offset:0 sc1
MV 156,v,32,v,76
TR 32,220,0
TR 34,220,1024
MV 172,v,36,v,76
TR 36,221,0
TR 38,221,1024
MV 188,v,40,v,76
s_add_u32 s75, s64, s74
v_accvgpr_read_b32 v246, a72
MV 204,v,44,v,76
v_accvgpr_read_b32 v247, a73
v_accvgpr_read_b32 v248, a74
MV 184,v,40,v,72
s_add_u32 m0, s67, 32768
v_accvgpr_read_b32 v249, a75
MV 200,v,44,v,72
v_accvgpr_read_b32 v250, a76
v_accvgpr_read_b32 v251, a77
MV 180,v,40,v,68
buffer_load_dwordx4 v208, s[44:47], s75 offen offset:0 lds
v_accvgpr_read_b32 v252, a78
MV 196,v,44,v,68
MV 176,v,40,v,64
TR 40,222,0
TR 42,222,1024
MV 192,v,44,v,64
TR 44,223,0
TR 46,223,1024
s_waitcnt lgkmcnt(4)
MV 80,v,16,v,48
buffer_load_dwordx4 v209, s[44:47], s75 offen offset:1024 lds
v_accvgpr_read_b32 v253, a79
MV 96,v,20,v,48
ds_read_b128 v[64:67], v227 offset:0
v_cvt_pk_bf16_f32 v242, v246, v247
MV 84,v,16,v,52
buffer_load_dwordx4 v210, s[44:47], s75 offen offset:2048 lds
v_cvt_pk_bf16_f32 v243, v248, v249
MV 100,v,20,v,52
MV 88,v,16,v,56
v_cvt_pk_bf16_f32 v244, v250, v251
MV 104,v,20,v,56
buffer_load_dwordx4 v211, s[44:47], s75 offen offset:3072 lds
v_cvt_pk_bf16_f32 v245, v252, v253
MV 92,v,16,v,60
TR 16,216,8192
TR 18,216,9216
MV 108,v,20,v,60
TR 20,217,8192
TR 22,217,9216
MV 124,v,24,v,60
ds_read_b128 v[68:71], v227 offset:2048
s_add_u32 s75, s65, s74
MV 140,v,28,v,60
buffer_store_dwordx4 v[242:245], v228, s[16:19], s24 offen offset:1024 sc1
v_accvgpr_read_b32 v234, a80
MV 120,v,24,v,56
v_accvgpr_read_b32 v235, a81
v_accvgpr_read_b32 v236, a82
MV 136,v,28,v,56
s_add_u32 m0, s67, 36864
MV 116,v,24,v,52
ds_read_b128 v[72:75], v227 offset:4096
v_accvgpr_read_b32 v237, a83
MV 132,v,28,v,52
v_accvgpr_read_b32 v238, a84
MV 112,v,24,v,48
TR 24,218,8192
TR 26,218,9216
MV 128,v,28,v,48
TR 28,219,8192
TR 30,219,9216
MV 144,v,32,v,48
buffer_load_dwordx4 v208, s[44:47], s75 offen offset:0 lds
buffer_load_dwordx4 v209, s[44:47], s75 offen offset:1024 lds
MV 160,v,36,v,48
v_accvgpr_read_b32 v239, a85
v_accvgpr_read_b32 v240, a86
MV 148,v,32,v,52
ds_read_b128 v[76:79], v227 offset:6144
v_accvgpr_read_b32 v241, a87
MV 164,v,36,v,52
buffer_load_dwordx4 v210, s[44:47], s75 offen offset:2048 lds
v_cvt_pk_bf16_f32 v230, v234, v235
MV 152,v,32,v,56
v_cvt_pk_bf16_f32 v231, v236, v237
MV 168,v,36,v,56
v_cvt_pk_bf16_f32 v232, v238, v239
MV 156,v,32,v,60
TR 32,220,8192
TR 34,220,9216
MV 172,v,36,v,60
TR 36,221,8192
TR 38,221,9216
s_waitcnt lgkmcnt(15)
MV 188,v,40,v,60
buffer_load_dwordx4 v211, s[44:47], s75 offen offset:3072 lds
v_cvt_pk_bf16_f32 v233, v240, v241
MV 204,v,44,v,60
s_add_u32 s74, s74, 128
buffer_store_dwordx4 v[230:233], v228, s[16:19], s24 offen offset:2048 sc1
MV 184,v,40,v,56
v_accvgpr_read_b32 v246, a88
MV 200,v,44,v,56
v_accvgpr_read_b32 v247, a89
MV 180,v,40,v,52
s_and_b32 s74, s74, 2047
v_accvgpr_read_b32 v248, a90
MV 196,v,44,v,52
MV 176,v,40,v,48
TR 40,222,8192
TR 42,222,9216
MV 192,v,44,v,48
TR 44,223,8192
TR 46,223,9216
s_waitcnt lgkmcnt(4)
MV 80,v,16,v,64
v_accvgpr_read_b32 v249, a91
MV 96,v,20,v,64
v_accvgpr_read_b32 v250, a92
MV 84,v,16,v,68
v_accvgpr_read_b32 v251, a93
MV 100,v,20,v,68
MV 88,v,16,v,72
v_accvgpr_read_b32 v252, a94
MV 104,v,20,v,72
v_accvgpr_read_b32 v253, a95
MV 92,v,16,v,76
MV 108,v,20,v,76
s_waitcnt vmcnt(16) lgkmcnt(0)
s_barrier
MV 124,v,24,v,76
TR 16,216,16384
TR 18,216,17408
MV 140,v,28,v,76
ds_read_b128 v[48:51], v224 offset:0
s_add_u32 m0, s68, 98304
MV 120,v,24,v,72
TR 20,217,16384
TR 22,217,17408
MV 136,v,28,v,72
buffer_load_dwordx4 v212, s[48:51], s66 offen offset:0 lds
v_cvt_pk_bf16_f32 v242, v246, v247
MV 116,v,24,v,68
ds_read_b128 v[52:55], v224 offset:2048
buffer_load_dwordx4 v213, s[48:51], s66 offen offset:1024 lds
MV 132,v,28,v,68
v_cvt_pk_bf16_f32 v243, v248, v249
v_cvt_pk_bf16_f32 v244, v250, v251
MV 112,v,24,v,64
TR 24,218,16384
TR 26,218,17408
MV 128,v,28,v,64
TR 28,219,16384
TR 30,219,17408
MV 144,v,32,v,64
ds_read_b128 v[56:59], v224 offset:4096
buffer_load_dwordx4 v214, s[48:51], s66 offen offset:2048 lds
MV 160,v,36,v,64
buffer_load_dwordx4 v215, s[48:51], s66 offen offset:3072 lds
v_cvt_pk_bf16_f32 v245, v252, v253
MV 148,v,32,v,68
buffer_store_dwordx4 v[242:245], v228, s[16:19], s24 offen offset:3072 sc1
v_accvgpr_read_b32 v234, a96
MV 164,v,36,v,68
s_add_u32 s66, s66, 524288
v_accvgpr_read_b32 v235, a97
MV 152,v,32,v,72
ds_read_b128 v[60:63], v224 offset:6144
v_accvgpr_read_b32 v236, a98
MV 168,v,36,v,72
s_and_b32 s66, s66, 8388607
v_accvgpr_read_b32 v237, a99
MV 156,v,32,v,76
TR 32,220,16384
TR 34,220,17408
MV 172,v,36,v,76
TR 36,221,16384
TR 38,221,17408
MV 188,v,40,v,76
s_add_u32 s75, s64, s74
v_accvgpr_read_b32 v238, a100
MV 204,v,44,v,76
v_accvgpr_read_b32 v239, a101
v_accvgpr_read_b32 v240, a102
MV 184,v,40,v,72
s_add_u32 m0, s67, 65536
v_accvgpr_read_b32 v241, a103
MV 200,v,44,v,72
v_cvt_pk_bf16_f32 v230, v234, v235
v_cvt_pk_bf16_f32 v231, v236, v237
MV 180,v,40,v,68
buffer_load_dwordx4 v208, s[44:47], s75 offen offset:0 lds
v_cvt_pk_bf16_f32 v232, v238, v239
MV 196,v,44,v,68
MV 176,v,40,v,64
TR 40,222,16384
TR 42,222,17408
MV 192,v,44,v,64
TR 44,223,16384
TR 46,223,17408
s_waitcnt lgkmcnt(4)
MV 80,v,16,v,48
buffer_load_dwordx4 v209, s[44:47], s75 offen offset:1024 lds
v_cvt_pk_bf16_f32 v233, v240, v241
MV 96,v,20,v,48
ds_read_b128 v[64:67], v225 offset:0
s_add_u32 s24, s24, 4096
MV 84,v,16,v,52
buffer_load_dwordx4 v210, s[44:47], s75 offen offset:2048 lds
buffer_store_dwordx4 v[230:233], v228, s[16:19], s24 offen offset:0 sc1
MV 100,v,20,v,52
MV 88,v,16,v,56
v_accvgpr_read_b32 v246, a104
MV 104,v,20,v,56
buffer_load_dwordx4 v211, s[44:47], s75 offen offset:3072 lds
v_accvgpr_read_b32 v247, a105
MV 92,v,16,v,60
TR 16,216,24576
TR 18,216,25600
MV 108,v,20,v,60
TR 20,217,24576
TR 22,217,25600
MV 124,v,24,v,60
ds_read_b128 v[68:71], v225 offset:2048
s_add_u32 s75, s65, s74
MV 140,v,28,v,60
v_accvgpr_read_b32 v248, a106
v_accvgpr_read_b32 v249, a107
MV 120,v,24,v,56
v_accvgpr_read_b32 v250, a108
MV 136,v,28,v,56
s_add_u32 m0, s67, 69632
v_accvgpr_read_b32 v251, a109
MV 116,v,24,v,52
ds_read_b128 v[72:75], v225 offset:4096
v_accvgpr_read_b32 v252, a110
MV 132,v,28,v,52
MV 112,v,24,v,48
TR 24,218,24576
TR 26,218,25600
MV 128,v,28,v,48
TR 28,219,24576
TR 30,219,25600
MV 144,v,32,v,48
buffer_load_dwordx4 v208, s[44:47], s75 offen offset:0 lds
buffer_load_dwordx4 v209, s[44:47], s75 offen offset:1024 lds
MV 160,v,36,v,48
v_accvgpr_read_b32 v253, a111
v_cvt_pk_bf16_f32 v242, v246, v247
MV 148,v,32,v,52
ds_read_b128 v[76:79], v225 offset:6144
v_cvt_pk_bf16_f32 v243, v248, v249
MV 164,v,36,v,52
buffer_load_dwordx4 v210, s[44:47], s75 offen offset:2048 lds
v_cvt_pk_bf16_f32 v244, v250, v251
MV 152,v,32,v,56
v_cvt_pk_bf16_f32 v245, v252, v253
MV 168,v,36,v,56
buffer_store_dwordx4 v[242:245], v228, s[16:19], s24 offen offset:1024 sc1
MV 156,v,32,v,60
TR 32,220,24576
TR 34,220,25600
MV 172,v,36,v,60
TR 36,221,24576
TR 38,221,25600
s_waitcnt lgkmcnt(15)
MV 188,v,40,v,60
buffer_load_dwordx4 v211, s[44:47], s75 offen offset:3072 lds
v_accvgpr_read_b32 v234, a112
MV 204,v,44,v,60
s_add_u32 s74, s74, 128
v_accvgpr_read_b32 v235, a113
MV 184,v,40,v,56
v_accvgpr_read_b32 v236, a114
MV 200,v,44,v,56
v_accvgpr_read_b32 v237, a115
MV 180,v,40,v,52
s_and_b32 s74, s74, 2047
v_accvgpr_read_b32 v238, a116
MV 196,v,44,v,52
MV 176,v,40,v,48
TR 40,222,24576
TR 42,222,25600
MV 192,v,44,v,48
TR 44,223,24576
TR 46,223,25600
s_waitcnt lgkmcnt(4)
MV 80,v,16,v,64
v_accvgpr_read_b32 v239, a117
MV 96,v,20,v,64
v_accvgpr_read_b32 v240, a118
MV 84,v,16,v,68
v_accvgpr_read_b32 v241, a119
MV 100,v,20,v,68
MV 88,v,16,v,72
v_cvt_pk_bf16_f32 v230, v234, v235
MV 104,v,20,v,72
v_cvt_pk_bf16_f32 v231, v236, v237
MV 92,v,16,v,76
MV 108,v,20,v,76
s_waitcnt vmcnt(16) lgkmcnt(0)
s_barrier
MV 124,v,24,v,76
TR 16,216,32768
TR 18,216,33792
MV 140,v,28,v,76
ds_read_b128 v[48:51], v224 offset:32768
s_add_u32 m0, s68, 114688
MV 120,v,24,v,72
TR 20,217,32768
TR 22,217,33792
MV 136,v,28,v,72
buffer_load_dwordx4 v212, s[48:51], s66 offen offset:0 lds
v_cvt_pk_bf16_f32 v232, v238, v239
MV 116,v,24,v,68
ds_read_b128 v[52:55], v224 offset:34816
buffer_load_dwordx4 v213, s[48:51], s66 offen offset:1024 lds
MV 132,v,28,v,68
v_cvt_pk_bf16_f32 v233, v240, v241
buffer_store_dwordx4 v[230:233], v228, s[16:19], s24 offen offset:2048 sc1
MV 112,v,24,v,64
TR 24,218,32768
TR 26,218,33792
MV 128,v,28,v,64
TR 28,219,32768
TR 30,219,33792
MV 144,v,32,v,64
ds_read_b128 v[56:59], v224 offset:36864
buffer_load_dwordx4 v214, s[48:51], s66 offen offset:2048 lds
MV 160,v,36,v,64
buffer_load_dwordx4 v215, s[48:51], s66 offen offset:3072 lds
v_accvgpr_read_b32 v246, a120
MV 148,v,32,v,68
v_accvgpr_read_b32 v247, a121
v_accvgpr_read_b32 v248, a122
MV 164,v,36,v,68
s_add_u32 s66, s66, 524288
v_accvgpr_read_b32 v249, a123
MV 152,v,32,v,72
ds_read_b128 v[60:63], v224 offset:38912
v_accvgpr_read_b32 v250, a124
MV 168,v,36,v,72
s_and_b32 s66, s66, 8388607
v_accvgpr_read_b32 v251, a125
MV 156,v,32,v,76
TR 32,220,32768
TR 34,220,33792
MV 172,v,36,v,76
TR 36,221,32768
TR 38,221,33792
MV 188,v,40,v,76
s_add_u32 s75, s64, s74
v_accvgpr_read_b32 v252, a126
MV 204,v,44,v,76
v_accvgpr_read_b32 v253, a127
v_cvt_pk_bf16_f32 v242, v246, v247
MV 184,v,40,v,72
s_add_u32 m0, s67, 0
v_cvt_pk_bf16_f32 v243, v248, v249
MV 200,v,44,v,72
v_cvt_pk_bf16_f32 v244, v250, v251
v_cvt_pk_bf16_f32 v245, v252, v253
MV 180,v,40,v,68
buffer_load_dwordx4 v208, s[44:47], s75 offen offset:0 lds
buffer_store_dwordx4 v[242:245], v228, s[16:19], s24 offen offset:3072 sc1
MV 196,v,44,v,68
MV 176,v,40,v,64
TR 40,222,32768
TR 42,222,33792
MV 192,v,44,v,64
TR 44,223,32768
TR 46,223,33792
s_waitcnt lgkmcnt(4)
MV 80,v,16,v,48
buffer_load_dwordx4 v209, s[44:47], s75 offen offset:1024 lds
v_accvgpr_read_b32 v234, a128
MV 96,v,20,v,48
ds_read_b128 v[64:67], v225 offset:32768
v_accvgpr_read_b32 v235, a129
MV 84,v,16,v,52
buffer_load_dwordx4 v210, s[44:47], s75 offen offset:2048 lds
v_accvgpr_read_b32 v236, a130
MV 100,v,20,v,52
MV 88,v,16,v,56
v_accvgpr_read_b32 v237, a131
MV 104,v,20,v,56
buffer_load_dwordx4 v211, s[44:47], s75 offen offset:3072 lds
v_accvgpr_read_b32 v238, a132
MV 92,v,16,v,60
TR 16,216,40960
TR 18,216,41984
MV 108,v,20,v,60
TR 20,217,40960
TR 22,217,41984
MV 124,v,24,v,60
ds_read_b128 v[68:71], v225 offset:34816
s_add_u32 s75, s65, s74
MV 140,v,28,v,60
v_accvgpr_read_b32 v239, a133
v_accvgpr_read_b32 v240, a134
MV 120,v,24,v,56
v_accvgpr_read_b32 v241, a135
MV 136,v,28,v,56
s_add_u32 m0, s67, 4096
v_cvt_pk_bf16_f32 v230, v234, v235
MV 116,v,24,v,52
ds_read_b128 v[72:75], v225 offset:36864
v_cvt_pk_bf16_f32 v231, v236, v237
MV 132,v,28,v,52
MV 112,v,24,v,48
TR 24,218,40960
TR 26,218,41984
MV 128,v,28,v,48
TR 28,219,40960
TR 30,219,41984
MV 144,v,32,v,48
buffer_load_dwordx4 v208, s[44:47], s75 offen offset:0 lds
buffer_load_dwordx4 v209, s[44:47], s75 offen offset:1024 lds
MV 160,v,36,v,48
v_cvt_pk_bf16_f32 v232, v238, v239
v_cvt_pk_bf16_f32 v233, v240, v241
MV 148,v,32,v,52
ds_read_b128 v[76:79], v225 offset:38912
s_add_u32 s24, s24, 4096
MV 164,v,36,v,52
buffer_load_dwordx4 v210, s[44:47], s75 offen offset:2048 lds
buffer_store_dwordx4 v[230:233], v228, s[16:19], s24 offen offset:0 sc1
MV 152,v,32,v,56
v_accvgpr_read_b32 v246, a136
MV 168,v,36,v,56
v_accvgpr_read_b32 v247, a137
MV 156,v,32,v,60
TR 32,220,40960
TR 34,220,41984
MV 172,v,36,v,60
TR 36,221,40960
TR 38,221,41984
s_waitcnt lgkmcnt(15)
MV 188,v,40,v,60
buffer_load_dwordx4 v211, s[44:47], s75 offen offset:3072 lds
v_accvgpr_read_b32 v248, a138
MV 204,v,44,v,60
s_add_u32 s74, s74, 128
v_accvgpr_read_b32 v249, a139
MV 184,v,40,v,56
v_accvgpr_read_b32 v250, a140
MV 200,v,44,v,56
v_accvgpr_read_b32 v251, a141
MV 180,v,40,v,52
s_and_b32 s74, s74, 2047
v_accvgpr_read_b32 v252, a142
MV 196,v,44,v,52
MV 176,v,40,v,48
TR 40,222,40960
TR 42,222,41984
MV 192,v,44,v,48
TR 44,223,40960
TR 46,223,41984
s_waitcnt lgkmcnt(4)
MV 80,v,16,v,64
v_accvgpr_read_b32 v253, a143
MV 96,v,20,v,64
v_cvt_pk_bf16_f32 v242, v246, v247
MV 84,v,16,v,68
v_cvt_pk_bf16_f32 v243, v248, v249
MV 100,v,20,v,68
MV 88,v,16,v,72
v_cvt_pk_bf16_f32 v244, v250, v251
MV 104,v,20,v,72
v_cvt_pk_bf16_f32 v245, v252, v253
MV 92,v,16,v,76
MV 108,v,20,v,76
s_waitcnt vmcnt(15) lgkmcnt(0)
s_barrier
MV 124,v,24,v,76
TR 16,216,0
TR 18,216,1024
MV 140,v,28,v,76
ds_read_b128 v[48:51], v226 offset:0
s_add_u32 m0, s68, 131072
MV 120,v,24,v,72
TR 20,217,0
TR 22,217,1024
MV 136,v,28,v,72
buffer_load_dwordx4 v212, s[48:51], s66 offen offset:0 lds
buffer_store_dwordx4 v[242:245], v228, s[16:19], s24 offen offset:1024 sc1
MV 116,v,24,v,68
ds_read_b128 v[52:55], v226 offset:2048
buffer_load_dwordx4 v213, s[48:51], s66 offen offset:1024 lds
MV 132,v,28,v,68
v_accvgpr_read_b32 v234, a144
v_accvgpr_read_b32 v235, a145
MV 112,v,24,v,64
TR 24,218,0
TR 26,218,1024
MV 128,v,28,v,64
TR 28,219,0
TR 30,219,1024
MV 144,v,32,v,64
ds_read_b128 v[56:59], v226 offset:4096
buffer_load_dwordx4 v214, s[48:51], s66 offen offset:2048 lds
MV 160,v,36,v,64
buffer_load_dwordx4 v215, s[48:51], s66 offen offset:3072 lds
v_accvgpr_read_b32 v236, a146
MV 148,v,32,v,68
v_accvgpr_read_b32 v237, a147
v_accvgpr_read_b32 v238, a148
MV 164,v,36,v,68
s_add_u32 s66, s66, 524288
v_accvgpr_read_b32 v239, a149
MV 152,v,32,v,72
ds_read_b128 v[60:63], v226 offset:6144
v_accvgpr_read_b32 v240, a150
MV 168,v,36,v,72
s_and_b32 s66, s66, 8388607
v_accvgpr_read_b32 v241, a151
MV 156,v,32,v,76
TR 32,220,0
TR 34,220,1024
MV 172,v,36,v,76
TR 36,221,0
TR 38,221,1024
MV 188,v,40,v,76
s_add_u32 s75, s64, s74
v_cvt_pk_bf16_f32 v230, v234, v235
MV 204,v,44,v,76
v_cvt_pk_bf16_f32 v231, v236, v237
v_cvt_pk_bf16_f32 v232, v238, v239
MV 184,v,40,v,72
s_add_u32 m0, s67, 32768
v_cvt_pk_bf16_f32 v233, v240, v241
MV 200,v,44,v,72
buffer_store_dwordx4 v[230:233], v228, s[16:19], s24 offen offset:2048 sc1
v_accvgpr_read_b32 v246, a152
MV 180,v,40,v,68
buffer_load_dwordx4 v208, s[44:47], s75 offen offset:0 lds
v_accvgpr_read_b32 v247, a153
MV 196,v,44,v,68
MV 176,v,40,v,64
TR 40,222,0
TR 42,222,1024
MV 192,v,44,v,64
TR 44,223,0
TR 46,223,1024
s_waitcnt lgkmcnt(4)
MV 80,v,16,v,48
buffer_load_dwordx4 v209, s[44:47], s75 offen offset:1024 lds
v_accvgpr_read_b32 v248, a154
MV 96,v,20,v,48
ds_read_b128 v[64:67], v227 offset:0
v_accvgpr_read_b32 v249, a155
MV 84,v,16,v,52
buffer_load_dwordx4 v210, s[44:47], s75 offen offset:2048 lds
v_accvgpr_read_b32 v250, a156
MV 100,v,20,v,52
MV 88,v,16,v,56
v_accvgpr_read_b32 v251, a157
MV 104,v,20,v,56
buffer_load_dwordx4 v211, s[44:47], s75 offen offset:3072 lds
v_accvgpr_read_b32 v252, a158
MV 92,v,16,v,60
TR 16,216,8192
TR 18,216,9216
MV 108,v,20,v,60
TR 20,217,8192
TR 22,217,9216
MV 124,v,24,v,60
ds_read_b128 v[68:71], v227 offset:2048
s_add_u32 s75, s65, s74
MV 140,v,28,v,60
v_accvgpr_read_b32 v253, a159
v_cvt_pk_bf16_f32 v242, v246, v247
MV 120,v,24,v,56
v_cvt_pk_bf16_f32 v243, v248, v249
MV 136,v,28,v,56
s_add_u32 m0, s67, 36864
v_cvt_pk_bf16_f32 v244, v250, v251
MV 116,v,24,v,52
ds_read_b128 v[72:75], v227 offset:4096
v_cvt_pk_bf16_f32 v245, v252, v253
MV 132,v,28,v,52
MV 112,v,24,v,48
TR 24,218,8192
TR 26,218,9216
MV 128,v,28,v,48
TR 28,219,8192
TR 30,219,9216
MV 144,v,32,v,48
buffer_load_dwordx4 v208, s[44:47], s75 offen offset:0 lds
buffer_load_dwordx4 v209, s[44:47], s75 offen offset:1024 lds
MV 160,v,36,v,48
buffer_store_dwordx4 v[242:245], v228, s[16:19], s24 offen offset:3072 sc1
v_accvgpr_read_b32 v234, a160
MV 148,v,32,v,52
ds_read_b128 v[76:79], v227 offset:6144
v_accvgpr_read_b32 v235, a161
MV 164,v,36,v,52
buffer_load_dwordx4 v210, s[44:47], s75 offen offset:2048 lds
v_accvgpr_read_b32 v236, a162
MV 152,v,32,v,56
v_accvgpr_read_b32 v237, a163
MV 168,v,36,v,56
v_accvgpr_read_b32 v238, a164
MV 156,v,32,v,60
TR 32,220,8192
TR 34,220,9216
MV 172,v,36,v,60
TR 36,221,8192
TR 38,221,9216
s_waitcnt lgkmcnt(15)
MV 188,v,40,v,60
buffer_load_dwordx4 v211, s[44:47], s75 offen offset:3072 lds
v_accvgpr_read_b32 v239, a165
MV 204,v,44,v,60
s_add_u32 s74, s74, 128
v_accvgpr_read_b32 v240, a166
MV 184,v,40,v,56
v_accvgpr_read_b32 v241, a167
MV 200,v,44,v,56
v_cvt_pk_bf16_f32 v230, v234, v235
MV 180,v,40,v,52
s_and_b32 s74, s74, 2047
v_cvt_pk_bf16_f32 v231, v236, v237
MV 196,v,44,v,52
MV 176,v,40,v,48
TR 40,222,8192
TR 42,222,9216
MV 192,v,44,v,48
TR 44,223,8192
TR 46,223,9216
s_waitcnt lgkmcnt(4)
MV 80,v,16,v,64
v_cvt_pk_bf16_f32 v232, v238, v239
MV 96,v,20,v,64
v_cvt_pk_bf16_f32 v233, v240, v241
MV 84,v,16,v,68
s_add_u32 s24, s24, 4096
MV 100,v,20,v,68
MV 88,v,16,v,72
buffer_store_dwordx4 v[230:233], v228, s[16:19], s24 offen offset:0 sc1
MV 104,v,20,v,72
v_accvgpr_read_b32 v246, a168
MV 92,v,16,v,76
v_accvgpr_read_b32 v247, a169
MV 108,v,20,v,76
s_waitcnt vmcnt(16) lgkmcnt(0)
s_barrier
MV 124,v,24,v,76
TR 16,216,16384
TR 18,216,17408
MV 140,v,28,v,76
ds_read_b128 v[48:51], v224 offset:0
s_add_u32 m0, s68, 98304
MV 120,v,24,v,72
TR 20,217,16384
TR 22,217,17408
MV 136,v,28,v,72
buffer_load_dwordx4 v212, s[48:51], s66 offen offset:0 lds
v_accvgpr_read_b32 v248, a170
MV 116,v,24,v,68
ds_read_b128 v[52:55], v224 offset:2048
buffer_load_dwordx4 v213, s[48:51], s66 offen offset:1024 lds
MV 132,v,28,v,68
v_accvgpr_read_b32 v249, a171
v_accvgpr_read_b32 v250, a172
MV 112,v,24,v,64
TR 24,218,16384
TR 26,218,17408
MV 128,v,28,v,64
TR 28,219,16384
TR 30,219,17408
MV 144,v,32,v,64
ds_read_b128 v[56:59], v224 offset:4096
buffer_load_dwordx4 v214, s[48:51], s66 offen offset:2048 lds
MV 160,v,36,v,64
buffer_load_dwordx4 v215, s[48:51], s66 offen offset:3072 lds
v_accvgpr_read_b32 v251, a173
MV 148,v,32,v,68
v_accvgpr_read_b32 v252, a174
v_accvgpr_read_b32 v253, a175
MV 164,v,36,v,68
s_add_u32 s66, s66, 524288
v_cvt_pk_bf16_f32 v242, v246, v247
MV 152,v,32,v,72
ds_read_b128 v[60:63], v224 offset:6144
v_cvt_pk_bf16_f32 v243, v248, v249
MV 168,v,36,v,72
s_and_b32 s66, s66, 8388607
v_cvt_pk_bf16_f32 v244, v250, v251
MV 156,v,32,v,76
TR 32,220,16384
TR 34,220,17408
MV 172,v,36,v,76
TR 36,221,16384
TR 38,221,17408
MV 188,v,40,v,76
s_add_u32 s75, s64, s74
v_cvt_pk_bf16_f32 v245, v252, v253
MV 204,v,44,v,76
buffer_store_dwordx4 v[242:245], v228, s[16:19], s24 offen offset:1024 sc1
v_accvgpr_read_b32 v234, a176
MV 184,v,40,v,72
s_add_u32 m0, s67, 65536
v_accvgpr_read_b32 v235, a177
MV 200,v,44,v,72
v_accvgpr_read_b32 v236, a178
v_accvgpr_read_b32 v237, a179
MV 180,v,40,v,68
buffer_load_dwordx4 v208, s[44:47], s75 offen offset:0 lds
v_accvgpr_read_b32 v238, a180
MV 196,v,44,v,68
MV 176,v,40,v,64
TR 40,222,16384
TR 42,222,17408
MV 192,v,44,v,64
TR 44,223,16384
TR 46,223,17408
s_waitcnt lgkmcnt(4)
MV 80,v,16,v,48
buffer_load_dwordx4 v209, s[44:47], s75 offen offset:1024 lds
v_accvgpr_read_b32 v239, a181
MV 96,v,20,v,48
ds_read_b128 v[64:67], v225 offset:0
v_accvgpr_read_b32 v240, a182
MV 84,v,16,v,52
buffer_load_dwordx4 v210, s[44:47], s75 offen offset:2048 lds
v_accvgpr_read_b32 v241, a183
MV 100,v,20,v,52
MV 88,v,16,v,56
v_cvt_pk_bf16_f32 v230, v234, v235
MV 104,v,20,v,56
buffer_load_dwordx4 v211, s[44:47], s75 offen offset:3072 lds
v_cvt_pk_bf16_f32 v231, v236, v237
MV 92,v,16,v,60
TR 16,216,24576
TR 18,216,25600
MV 108,v,20,v,60
TR 20,217,24576
TR 22,217,25600
MV 124,v,24,v,60
ds_read_b128 v[68:71], v225 offset:2048
s_add_u32 s75, s65, s74
MV 140,v,28,v,60
v_cvt_pk_bf16_f32 v232, v238, v239
v_cvt_pk_bf16_f32 v233, v240, v241
MV 120,v,24,v,56
buffer_store_dwordx4 v[230:233], v228, s[16:19], s24 offen offset:2048 sc1
v_accvgpr_read_b32 v246, a184
MV 136,v,28,v,56
s_add_u32 m0, s67, 69632
MV 116,v,24,v,52
ds_read_b128 v[72:75], v225 offset:4096
v_accvgpr_read_b32 v247, a185
MV 132,v,28,v,52
v_accvgpr_read_b32 v248, a186
MV 112,v,24,v,48
TR 24,218,24576
TR 26,218,25600
MV 128,v,28,v,48
TR 28,219,24576
TR 30,219,25600
MV 144,v,32,v,48
buffer_load_dwordx4 v208, s[44:47], s75 offen offset:0 lds
buffer_load_dwordx4 v209, s[44:47], s75 offen offset:1024 lds
MV 160,v,36,v,48
v_accvgpr_read_b32 v249, a187
v_accvgpr_read_b32 v250, a188
MV 148,v,32,v,52
ds_read_b128 v[76:79], v225 offset:6144
v_accvgpr_read_b32 v251, a189
MV 164,v,36,v,52
buffer_load_dwordx4 v210, s[44:47], s75 offen offset:2048 lds
v_accvgpr_read_b32 v252, a190
MV 152,v,32,v,56
v_accvgpr_read_b32 v253, a191
MV 168,v,36,v,56
v_cvt_pk_bf16_f32 v242, v246, v247
MV 156,v,32,v,60
TR 32,220,24576
TR 34,220,25600
MV 172,v,36,v,60
TR 36,221,24576
TR 38,221,25600
s_waitcnt lgkmcnt(15)
MV 188,v,40,v,60
buffer_load_dwordx4 v211, s[44:47], s75 offen offset:3072 lds
v_cvt_pk_bf16_f32 v243, v248, v249
MV 204,v,44,v,60
s_add_u32 s74, s74, 128
v_cvt_pk_bf16_f32 v244, v250, v251
MV 184,v,40,v,56
v_cvt_pk_bf16_f32 v245, v252, v253
MV 200,v,44,v,56
buffer_store_dwordx4 v[242:245], v228, s[16:19], s24 offen offset:3072 sc1
MV 180,v,40,v,52
s_and_b32 s74, s74, 2047
buffer_load_dword v254, off, s[12:15], 0 sc1
MV 196,v,44,v,52
MV 176,v,40,v,48
TR 40,222,24576
TR 42,222,25600
MV 192,v,44,v,48
TR 44,223,24576
TR 46,223,25600
s_waitcnt lgkmcnt(4)
MV 80,v,16,v,64
v_accvgpr_read_b32 v234, a192
MV 96,v,20,v,64
v_accvgpr_read_b32 v235, a193
MV 84,v,16,v,68
v_accvgpr_read_b32 v236, a194
MV 100,v,20,v,68
MV 88,v,16,v,72
v_accvgpr_read_b32 v237, a195
MV 104,v,20,v,72
v_accvgpr_read_b32 v238, a196
MV 92,v,16,v,76
MV 108,v,20,v,76
s_waitcnt vmcnt(17) lgkmcnt(0)
s_barrier
MV 124,v,24,v,76
TR 16,216,32768
TR 18,216,33792
MV 140,v,28,v,76
ds_read_b128 v[48:51], v224 offset:32768
s_add_u32 m0, s68, 114688
MV 120,v,24,v,72
TR 20,217,32768
TR 22,217,33792
MV 136,v,28,v,72
buffer_load_dwordx4 v212, s[48:51], s66 offen offset:0 lds
v_accvgpr_read_b32 v239, a197
MV 116,v,24,v,68
ds_read_b128 v[52:55], v224 offset:34816
buffer_load_dwordx4 v213, s[48:51], s66 offen offset:1024 lds
MV 132,v,28,v,68
v_accvgpr_read_b32 v240, a198
v_accvgpr_read_b32 v241, a199
MV 112,v,24,v,64
TR 24,218,32768
TR 26,218,33792
MV 128,v,28,v,64
TR 28,219,32768
TR 30,219,33792
MV 144,v,32,v,64
ds_read_b128 v[56:59], v224 offset:36864
buffer_load_dwordx4 v214, s[48:51], s66 offen offset:2048 lds
MV 160,v,36,v,64
buffer_load_dwordx4 v215, s[48:51], s66 offen offset:3072 lds
v_cvt_pk_bf16_f32 v230, v234, v235
MV 148,v,32,v,68
v_cvt_pk_bf16_f32 v231, v236, v237
v_cvt_pk_bf16_f32 v232, v238, v239
MV 164,v,36,v,68
s_add_u32 s66, s66, 524288
v_cvt_pk_bf16_f32 v233, v240, v241
MV 152,v,32,v,72
ds_read_b128 v[60:63], v224 offset:38912
s_add_u32 s24, s24, 4096
MV 168,v,36,v,72
s_and_b32 s66, s66, 8388607
buffer_store_dwordx4 v[230:233], v228, s[16:19], s24 offen offset:0 sc1
MV 156,v,32,v,76
TR 32,220,32768
TR 34,220,33792
MV 172,v,36,v,76
TR 36,221,32768
TR 38,221,33792
MV 188,v,40,v,76
s_add_u32 s75, s64, s74
v_accvgpr_read_b32 v246, a200
MV 204,v,44,v,76
v_accvgpr_read_b32 v247, a201
v_accvgpr_read_b32 v248, a202
MV 184,v,40,v,72
s_add_u32 m0, s67, 0
v_accvgpr_read_b32 v249, a203
MV 200,v,44,v,72
v_accvgpr_read_b32 v250, a204
v_accvgpr_read_b32 v251, a205
MV 180,v,40,v,68
buffer_load_dwordx4 v208, s[44:47], s75 offen offset:0 lds
v_accvgpr_read_b32 v252, a206
MV 196,v,44,v,68
MV 176,v,40,v,64
TR 40,222,32768
TR 42,222,33792
MV 192,v,44,v,64
TR 44,223,32768
TR 46,223,33792
s_waitcnt lgkmcnt(4)
MV 80,v,16,v,48
buffer_load_dwordx4 v209, s[44:47], s75 offen offset:1024 lds
v_accvgpr_read_b32 v253, a207
MV 96,v,20,v,48
ds_read_b128 v[64:67], v225 offset:32768
v_cvt_pk_bf16_f32 v242, v246, v247
MV 84,v,16,v,52
buffer_load_dwordx4 v210, s[44:47], s75 offen offset:2048 lds
v_cvt_pk_bf16_f32 v243, v248, v249
MV 100,v,20,v,52
MV 88,v,16,v,56
v_cvt_pk_bf16_f32 v244, v250, v251
MV 104,v,20,v,56
buffer_load_dwordx4 v211, s[44:47], s75 offen offset:3072 lds
v_cvt_pk_bf16_f32 v245, v252, v253
MV 92,v,16,v,60
TR 16,216,40960
TR 18,216,41984
MV 108,v,20,v,60
TR 20,217,40960
TR 22,217,41984
MV 124,v,24,v,60
ds_read_b128 v[68:71], v225 offset:34816
s_add_u32 s75, s65, s74
MV 140,v,28,v,60
buffer_store_dwordx4 v[242:245], v228, s[16:19], s24 offen offset:1024 sc1
v_accvgpr_read_b32 v234, a208
MV 120,v,24,v,56
v_accvgpr_read_b32 v235, a209
MV 136,v,28,v,56
s_add_u32 m0, s67, 4096
v_accvgpr_read_b32 v236, a210
MV 116,v,24,v,52
ds_read_b128 v[72:75], v225 offset:36864
v_accvgpr_read_b32 v237, a211
MV 132,v,28,v,52
MV 112,v,24,v,48
TR 24,218,40960
TR 26,218,41984
MV 128,v,28,v,48
TR 28,219,40960
TR 30,219,41984
MV 144,v,32,v,48
buffer_load_dwordx4 v208, s[44:47], s75 offen offset:0 lds
buffer_load_dwordx4 v209, s[44:47], s75 offen offset:1024 lds
MV 160,v,36,v,48
v_accvgpr_read_b32 v238, a212
v_accvgpr_read_b32 v239, a213
MV 148,v,32,v,52
ds_read_b128 v[76:79], v225 offset:38912
v_accvgpr_read_b32 v240, a214
MV 164,v,36,v,52
buffer_load_dwordx4 v210, s[44:47], s75 offen offset:2048 lds
v_accvgpr_read_b32 v241, a215
MV 152,v,32,v,56
v_cvt_pk_bf16_f32 v230, v234, v235
MV 168,v,36,v,56
v_cvt_pk_bf16_f32 v231, v236, v237
MV 156,v,32,v,60
TR 32,220,40960
TR 34,220,41984
MV 172,v,36,v,60
TR 36,221,40960
TR 38,221,41984
s_waitcnt lgkmcnt(15)
MV 188,v,40,v,60
buffer_load_dwordx4 v211, s[44:47], s75 offen offset:3072 lds
v_cvt_pk_bf16_f32 v232, v238, v239
MV 204,v,44,v,60
s_add_u32 s74, s74, 128
v_cvt_pk_bf16_f32 v233, v240, v241
MV 184,v,40,v,56
buffer_store_dwordx4 v[230:233], v228, s[16:19], s24 offen offset:2048 sc1
MV 200,v,44,v,56
v_accvgpr_read_b32 v246, a216
MV 180,v,40,v,52
s_and_b32 s74, s74, 2047
v_accvgpr_read_b32 v247, a217
MV 196,v,44,v,52
MV 176,v,40,v,48
TR 40,222,40960
TR 42,222,41984
MV 192,v,44,v,48
TR 44,223,40960
TR 46,223,41984
s_waitcnt lgkmcnt(4)
MV 80,v,16,v,64
v_accvgpr_read_b32 v248, a218
MV 96,v,20,v,64
v_accvgpr_read_b32 v249, a219
MV 84,v,16,v,68
v_accvgpr_read_b32 v250, a220
MV 100,v,20,v,68
MV 88,v,16,v,72
v_accvgpr_read_b32 v251, a221
MV 104,v,20,v,72
v_accvgpr_read_b32 v252, a222
MV 92,v,16,v,76
MV 108,v,20,v,76
s_waitcnt vmcnt(17) lgkmcnt(0)
s_barrier
MV 124,v,24,v,76
TR 16,216,0
TR 18,216,1024
MV 140,v,28,v,76
ds_read_b128 v[48:51], v226 offset:0
s_add_u32 m0, s68, 131072
MV 120,v,24,v,72
TR 20,217,0
TR 22,217,1024
MV 136,v,28,v,72
buffer_load_dwordx4 v212, s[48:51], s66 offen offset:0 lds
v_accvgpr_read_b32 v253, a223
MV 116,v,24,v,68
ds_read_b128 v[52:55], v226 offset:2048
buffer_load_dwordx4 v213, s[48:51], s66 offen offset:1024 lds
MV 132,v,28,v,68
v_cvt_pk_bf16_f32 v242, v246, v247
v_cvt_pk_bf16_f32 v243, v248, v249
MV 112,v,24,v,64
TR 24,218,0
TR 26,218,1024
MV 128,v,28,v,64
TR 28,219,0
TR 30,219,1024
MV 144,v,32,v,64
ds_read_b128 v[56:59], v226 offset:4096
buffer_load_dwordx4 v214, s[48:51], s66 offen offset:2048 lds
MV 160,v,36,v,64
buffer_load_dwordx4 v215, s[48:51], s66 offen offset:3072 lds
v_cvt_pk_bf16_f32 v244, v250, v251
MV 148,v,32,v,68
v_cvt_pk_bf16_f32 v245, v252, v253
buffer_store_dwordx4 v[242:245], v228, s[16:19], s24 offen offset:3072 sc1
MV 164,v,36,v,68
s_add_u32 s66, s66, 524288
v_accvgpr_read_b32 v234, a224
MV 152,v,32,v,72
ds_read_b128 v[60:63], v226 offset:6144
v_accvgpr_read_b32 v235, a225
MV 168,v,36,v,72
s_and_b32 s66, s66, 8388607
v_accvgpr_read_b32 v236, a226
MV 156,v,32,v,76
TR 32,220,0
TR 34,220,1024
MV 172,v,36,v,76
TR 36,221,0
TR 38,221,1024
MV 188,v,40,v,76
s_add_u32 s75, s64, s74
v_accvgpr_read_b32 v237, a227
MV 204,v,44,v,76
v_accvgpr_read_b32 v238, a228
v_accvgpr_read_b32 v239, a229
MV 184,v,40,v,72
s_add_u32 m0, s67, 32768
v_accvgpr_read_b32 v240, a230
MV 200,v,44,v,72
v_accvgpr_read_b32 v241, a231
v_cvt_pk_bf16_f32 v230, v234, v235
MV 180,v,40,v,68
buffer_load_dwordx4 v208, s[44:47], s75 offen offset:0 lds
v_cvt_pk_bf16_f32 v231, v236, v237
MV 196,v,44,v,68
MV 176,v,40,v,64
TR 40,222,0
TR 42,222,1024
MV 192,v,44,v,64
TR 44,223,0
TR 46,223,1024
s_waitcnt lgkmcnt(4)
MV 80,v,16,v,48
buffer_load_dwordx4 v209, s[44:47], s75 offen offset:1024 lds
v_cvt_pk_bf16_f32 v232, v238, v239
MV 96,v,20,v,48
ds_read_b128 v[64:67], v227 offset:0
v_cvt_pk_bf16_f32 v233, v240, v241
MV 84,v,16,v,52
buffer_load_dwordx4 v210, s[44:47], s75 offen offset:2048 lds
s_add_u32 s24, s24, 4096
MV 100,v,20,v,52
MV 88,v,16,v,56
buffer_store_dwordx4 v[230:233], v228, s[16:19], s24 offen offset:0 sc1
MV 104,v,20,v,56
buffer_load_dwordx4 v211, s[44:47], s75 offen offset:3072 lds
v_accvgpr_read_b32 v246, a232
MV 92,v,16,v,60
TR 16,216,8192
TR 18,216,9216
MV 108,v,20,v,60
TR 20,217,8192
TR 22,217,9216
MV 124,v,24,v,60
ds_read_b128 v[68:71], v227 offset:2048
s_add_u32 s75, s65, s74
MV 140,v,28,v,60
v_accvgpr_read_b32 v247, a233
v_accvgpr_read_b32 v248, a234
MV 120,v,24,v,56
v_accvgpr_read_b32 v249, a235
MV 136,v,28,v,56
s_add_u32 m0, s67, 36864
v_accvgpr_read_b32 v250, a236
MV 116,v,24,v,52
ds_read_b128 v[72:75], v227 offset:4096
v_accvgpr_read_b32 v251, a237
MV 132,v,28,v,52
MV 112,v,24,v,48
TR 24,218,8192
TR 26,218,9216
MV 128,v,28,v,48
TR 28,219,8192
TR 30,219,9216
MV 144,v,32,v,48
buffer_load_dwordx4 v208, s[44:47], s75 offen offset:0 lds
buffer_load_dwordx4 v209, s[44:47], s75 offen offset:1024 lds
MV 160,v,36,v,48
v_accvgpr_read_b32 v252, a238
v_accvgpr_read_b32 v253, a239
MV 148,v,32,v,52
ds_read_b128 v[76:79], v227 offset:6144
v_cvt_pk_bf16_f32 v242, v246, v247
MV 164,v,36,v,52
buffer_load_dwordx4 v210, s[44:47], s75 offen offset:2048 lds
v_cvt_pk_bf16_f32 v243, v248, v249
MV 152,v,32,v,56
v_cvt_pk_bf16_f32 v244, v250, v251
MV 168,v,36,v,56
v_cvt_pk_bf16_f32 v245, v252, v253
MV 156,v,32,v,60
TR 32,220,8192
TR 34,220,9216
MV 172,v,36,v,60
TR 36,221,8192
TR 38,221,9216
s_waitcnt lgkmcnt(15)
MV 188,v,40,v,60
buffer_load_dwordx4 v211, s[44:47], s75 offen offset:3072 lds
buffer_store_dwordx4 v[242:245], v228, s[16:19], s24 offen offset:1024 sc1
MV 204,v,44,v,60
s_add_u32 s74, s74, 128
v_accvgpr_read_b32 v234, a240
MV 184,v,40,v,56
v_accvgpr_read_b32 v235, a241
MV 200,v,44,v,56
v_accvgpr_read_b32 v236, a242
MV 180,v,40,v,52
s_and_b32 s74, s74, 2047
v_accvgpr_read_b32 v237, a243
MV 196,v,44,v,52
MV 176,v,40,v,48
TR 40,222,8192
TR 42,222,9216
MV 192,v,44,v,48
TR 44,223,8192
TR 46,223,9216
s_waitcnt lgkmcnt(4)
MV 80,v,16,v,64
v_accvgpr_read_b32 v238, a244
MV 96,v,20,v,64
v_accvgpr_read_b32 v239, a245
MV 84,v,16,v,68
v_accvgpr_read_b32 v240, a246
MV 100,v,20,v,68
MV 88,v,16,v,72
v_accvgpr_read_b32 v241, a247
MV 104,v,20,v,72
v_cvt_pk_bf16_f32 v230, v234, v235
MV 92,v,16,v,76
v_cvt_pk_bf16_f32 v231, v236, v237
MV 108,v,20,v,76
s_waitcnt vmcnt(16) lgkmcnt(0)
s_barrier
MV 124,v,24,v,76
TR 16,216,16384
TR 18,216,17408
MV 140,v,28,v,76
ds_read_b128 v[48:51], v224 offset:0
s_add_u32 m0, s68, 98304
MV 120,v,24,v,72
TR 20,217,16384
TR 22,217,17408
MV 136,v,28,v,72
buffer_load_dwordx4 v212, s[48:51], s66 offen offset:0 lds
v_cvt_pk_bf16_f32 v232, v238, v239
MV 116,v,24,v,68
ds_read_b128 v[52:55], v224 offset:2048
buffer_load_dwordx4 v213, s[48:51], s66 offen offset:1024 lds
MV 132,v,28,v,68
v_cvt_pk_bf16_f32 v233, v240, v241
buffer_store_dwordx4 v[230:233], v228, s[16:19], s24 offen offset:2048 sc1
MV 112,v,24,v,64
TR 24,218,16384
TR 26,218,17408
MV 128,v,28,v,64
TR 28,219,16384
TR 30,219,17408
MV 144,v,32,v,64
ds_read_b128 v[56:59], v224 offset:4096
buffer_load_dwordx4 v214, s[48:51], s66 offen offset:2048 lds
MV 160,v,36,v,64
buffer_load_dwordx4 v215, s[48:51], s66 offen offset:3072 lds
v_accvgpr_read_b32 v246, a248
MV 148,v,32,v,68
v_accvgpr_read_b32 v247, a249
v_accvgpr_read_b32 v248, a250
MV 164,v,36,v,68
s_add_u32 s66, s66, 524288
v_accvgpr_read_b32 v249, a251
MV 152,v,32,v,72
ds_read_b128 v[60:63], v224 offset:6144
v_accvgpr_read_b32 v250, a252
MV 168,v,36,v,72
s_and_b32 s66, s66, 8388607
v_accvgpr_read_b32 v251, a253
MV 156,v,32,v,76
TR 32,220,16384
TR 34,220,17408
MV 172,v,36,v,76
TR 36,221,16384
TR 38,221,17408
MV 188,v,40,v,76
s_add_u32 s75, s64, s74
v_accvgpr_read_b32 v252, a254
MV 204,v,44,v,76
v_accvgpr_read_b32 v253, a255
v_cvt_pk_bf16_f32 v242, v246, v247
MV 184,v,40,v,72
s_add_u32 m0, s67, 65536
v_cvt_pk_bf16_f32 v243, v248, v249
MV 200,v,44,v,72
v_cvt_pk_bf16_f32 v244, v250, v251
v_cvt_pk_bf16_f32 v245, v252, v253
MV 180,v,40,v,68
buffer_load_dwordx4 v208, s[44:47], s75 offen offset:0 lds
buffer_store_dwordx4 v[242:245], v228, s[16:19], s24 offen offset:3072 sc1
MV 196,v,44,v,68
MV 176,v,40,v,64
TR 40,222,16384
TR 42,222,17408
MV 192,v,44,v,64
TR 44,223,16384
TR 46,223,17408
s_waitcnt lgkmcnt(4)
MV 80,v,16,v,48
buffer_load_dwordx4 v209, s[44:47], s75 offen offset:1024 lds
v_lshlrev_b32 v255, 20, v1
MV 96,v,20,v,48
ds_read_b128 v[64:67], v225 offset:0
MV 84,v,16,v,52
buffer_load_dwordx4 v210, s[44:47], s75 offen offset:2048 lds
MV 100,v,20,v,52
MV 88,v,16,v,56
MV 104,v,20,v,56
buffer_load_dwordx4 v211, s[44:47], s75 offen offset:3072 lds
MV 92,v,16,v,60
TR 16,216,24576
TR 18,216,25600
MV 108,v,20,v,60
TR 20,217,24576
TR 22,217,25600
MV 124,v,24,v,60
ds_read_b128 v[68:71], v225 offset:2048
s_add_u32 s75, s65, s74
MV 140,v,28,v,60
MV 120,v,24,v,56
s_lshl_b32 s36, s3, 26
MV 136,v,28,v,56
s_add_u32 m0, s67, 69632
MV 116,v,24,v,52
ds_read_b128 v[72:75], v225 offset:4096
MV 132,v,28,v,52
MV 112,v,24,v,48
TR 24,218,24576
TR 26,218,25600
MV 128,v,28,v,48
TR 28,219,24576
TR 30,219,25600
MV 144,v,32,v,48
buffer_load_dwordx4 v208, s[44:47], s75 offen offset:0 lds
buffer_load_dwordx4 v209, s[44:47], s75 offen offset:1024 lds
MV 160,v,36,v,48
MV 148,v,32,v,52
ds_read_b128 v[76:79], v225 offset:6144
MV 164,v,36,v,52
buffer_load_dwordx4 v210, s[44:47], s75 offen offset:2048 lds
MV 152,v,32,v,56
v_add_u32 v255, s36, v255
MV 168,v,36,v,56
MV 156,v,32,v,60
TR 32,220,24576
TR 34,220,25600
MV 172,v,36,v,60
TR 36,221,24576
TR 38,221,25600
s_waitcnt lgkmcnt(15)
MV 188,v,40,v,60
buffer_load_dwordx4 v211, s[44:47], s75 offen offset:3072 lds
MV 204,v,44,v,60
s_add_u32 s74, s74, 128
MV 184,v,40,v,56
MV 200,v,44,v,56
MV 180,v,40,v,52
s_and_b32 s74, s74, 2047
MV 196,v,44,v,52
MV 176,v,40,v,48
TR 40,222,24576
TR 42,222,25600
MV 192,v,44,v,48
TR 44,223,24576
TR 46,223,25600
s_waitcnt lgkmcnt(4)
MV 80,v,16,v,64
v_lshlrev_b32 v230, 4, v1
MV 96,v,20,v,64
s_lshl_b32 s80, s3, 12
MV 84,v,16,v,68
MV 100,v,20,v,68
v_add_u32 v12, s80, v230
MV 88,v,16,v,72
MV 104,v,20,v,72
v_add_u32 v10, 0x8000, v230
MV 92,v,16,v,76
MV 108,v,20,v,76
s_waitcnt vmcnt(15) lgkmcnt(0)
s_barrier
MV 124,v,24,v,76
TR 16,216,32768
TR 18,216,33792
MV 140,v,28,v,76
ds_read_b128 v[48:51], v224 offset:32768
s_add_u32 m0, s68, 114688
MV 120,v,24,v,72
TR 20,217,32768
TR 22,217,33792
MV 136,v,28,v,72
buffer_load_dwordx4 v212, s[48:51], s66 offen offset:0 lds
v_add_u32 v11, 0x18000, v230
MV 116,v,24,v,68
ds_read_b128 v[52:55], v224 offset:34816
buffer_load_dwordx4 v213, s[48:51], s66 offen offset:1024 lds
MV 132,v,28,v,68
s_add_u32 s72, s80, 0x8000
s_add_u32 s73, s80, 0x18000
MV 112,v,24,v,64
TR 24,218,32768
TR 26,218,33792
MV 128,v,28,v,64
TR 28,219,32768
TR 30,219,33792
MV 144,v,32,v,64
ds_read_b128 v[56:59], v224 offset:36864
buffer_load_dwordx4 v214, s[48:51], s66 offen offset:2048 lds
MV 160,v,36,v,64
buffer_load_dwordx4 v215, s[48:51], s66 offen offset:3072 lds
v_mov_b32 v15, v230
MV 148,v,32,v,68
v_and_b32 v230, 15, v1
v_lshrrev_b32 v232, 4, v1
MV 164,v,36,v,68
s_add_u32 s66, s66, 524288
v_lshlrev_b32 v232, 2, v232
MV 152,v,32,v,72
ds_read_b128 v[60:63], v224 offset:38912
v_sub_u32 v230, v230, v232
MV 168,v,36,v,72
s_and_b32 s66, s66, 8388607
s_lshl_b32 s81, s3, 4
MV 156,v,32,v,76
TR 32,220,32768
TR 34,220,33792
MV 172,v,36,v,76
TR 36,221,32768
TR 38,221,33792
MV 188,v,40,v,76
s_add_u32 s75, s64, s74
v_add_u32 v13, s81, v230
MV 204,v,44,v,76
s_sub_u32 s81, 112, s81
MV 184,v,40,v,72
s_add_u32 m0, s67, 0
v_add_u32 v239, s81, v230
MV 200,v,44,v,72
MV 180,v,40,v,68
buffer_load_dwordx4 v208, s[44:47], s75 offen offset:0 lds
v_mov_b32 v14, 0xff800000
MV 196,v,44,v,68
MV 176,v,40,v,64
TR 40,222,32768
TR 42,222,33792
MV 192,v,44,v,64
TR 44,223,32768
TR 46,223,33792
s_waitcnt lgkmcnt(4)
MV 80,v,16,v,48
buffer_load_dwordx4 v209, s[44:47], s75 offen offset:1024 lds
s_getpc_b64 s[38:39]
L_ct_a:
MV 96,v,20,v,48
ds_read_b128 v[64:67], v225 offset:32768
MV 84,v,16,v,52
buffer_load_dwordx4 v210, s[44:47], s75 offen offset:2048 lds
MV 100,v,20,v,52
s_add_u32 s38, s38, L_p3_begin - L_ct_a
s_addc_u32 s39, s39, 0
MV 88,v,16,v,56
MV 104,v,20,v,56
buffer_load_dwordx4 v211, s[44:47], s75 offen offset:3072 lds
v_mov_b32 v229, s39
MV 92,v,16,v,60
TR 16,216,40960
TR 18,216,41984
MV 108,v,20,v,60
TR 20,217,40960
TR 22,217,41984
MV 124,v,24,v,60
ds_read_b128 v[68:71], v225 offset:34816
s_add_u32 s75, s65, s74
MV 140,v,28,v,60
v_mov_b32 v228, s38
s_lshr_b32 s38, s2, 3
MV 120,v,24,v,56
s_lshl_b32 s38, s38, 2
MV 136,v,28,v,56
s_add_u32 m0, s67, 4096
s_add_u32 s38, s38, s3
MV 116,v,24,v,52
ds_read_b128 v[72:75], v225 offset:36864
MV 132,v,28,v,52
s_lshl_b32 s38, s38, 7
MV 112,v,24,v,48
TR 24,218,40960
TR 26,218,41984
MV 128,v,28,v,48
TR 28,219,40960
TR 30,219,41984
MV 144,v,32,v,48
buffer_load_dwordx4 v208, s[44:47], s75 offen offset:0 lds
buffer_load_dwordx4 v209, s[44:47], s75 offen offset:1024 lds
MV 160,v,36,v,48
v_and_b32 v238, 3, v1
v_lshlrev_b32 v238, 14, v238
MV 148,v,32,v,52
ds_read_b128 v[76:79], v225 offset:38912
v_add_u32 v238, s38, v238
MV 164,v,36,v,52
buffer_load_dwordx4 v210, s[44:47], s75 offen offset:2048 lds
MV 152,v,32,v,56
v_min_u32 v238, L_p3_s1m_top - L_p3_begin - 4, v238
MV 168,v,36,v,56
v_add_co_u32 v228, vcc, v228, v238
s_nop 1
v_addc_co_u32 v229, vcc, 0, v229, vcc
MV 156,v,32,v,60
TR 32,220,40960
TR 34,220,41984
MV 172,v,36,v,60
TR 36,221,40960
TR 38,221,41984
s_waitcnt lgkmcnt(15)
MV 188,v,40,v,60
buffer_load_dwordx4 v211, s[44:47], s75 offen offset:3072 lds
MV 204,v,44,v,60
s_add_u32 s74, s74, 128
MV 184,v,40,v,56
MV 200,v,44,v,56
MV 180,v,40,v,52
s_and_b32 s74, s74, 2047
global_load_dword v238, v[228:229], off
MV 196,v,44,v,52
MV 176,v,40,v,48
TR 40,222,40960
TR 42,222,41984
MV 192,v,44,v,48
TR 44,223,40960
TR 46,223,41984
s_waitcnt lgkmcnt(4)
MV 80,v,16,v,64
MV 96,v,20,v,64
MV 84,v,16,v,68
MV 100,v,20,v,68
MV 88,v,16,v,72
MV 104,v,20,v,72
MV 92,v,16,v,76
MV 108,v,20,v,76
s_waitcnt vmcnt(13) lgkmcnt(0)
s_barrier
MV 124,v,24,v,76
v_cmp_gt_u32 vcc, 1, v254
s_nop 4
s_cbranch_vccnz L_spin_go
L_spin_go_ret:
v_mov_b32 v254, 1
s_lshl_b32 s36, s2, 2
buffer_store_dword v254, v255, s[8:11], s36 offen offset:0 sc1
s_load_dwordx4 s[32:35], s[0:1], 32
MV 140,v,28,v,76
TR 16,216,0
TR 18,216,1024
MV 120,v,24,v,72
TR 20,217,0
TR 22,217,1024
MV 136,v,28,v,72
ds_read_b128 v[48:51], v226 offset:0
s_add_u32 m0, s68, 131072
MV 116,v,24,v,68
ds_read_b128 v[52:55], v226 offset:2048
buffer_load_dwordx4 v212, s[48:51], s66 offen offset:0 lds
MV 132,v,28,v,68
buffer_load_dwordx4 v213, s[48:51], s66 offen offset:1024 lds
MV 112,v,24,v,64
TR 24,218,0
TR 26,218,1024
MV 128,v,28,v,64
TR 28,219,0
TR 30,219,1024
MV 144,v,32,v,64
ds_read_b128 v[56:59], v226 offset:4096
buffer_load_dwordx4 v214, s[48:51], s66 offen offset:2048 lds
MV 160,v,36,v,64
buffer_load_dwordx4 v215, s[48:51], s66 offen offset:3072 lds
MV 148,v,32,v,68
MV 164,v,36,v,68
s_add_u32 s66, s66, 524288
MV 152,v,32,v,72
ds_read_b128 v[60:63], v226 offset:6144
MV 168,v,36,v,72
s_and_b32 s66, s66, 8388607
MV 156,v,32,v,76
TR 32,220,0
TR 34,220,1024
MV 172,v,36,v,76
TR 36,221,0
TR 38,221,1024
MV 188,v,40,v,76
s_add_u32 s75, s64, s74
MV 204,v,44,v,76
MV 184,v,40,v,72
s_add_u32 m0, s67, 32768
MV 200,v,44,v,72
MV 180,v,40,v,68
buffer_load_dwordx4 v208, s[44:47], s75 offen offset:0 lds
MV 196,v,44,v,68
MV 176,v,40,v,64
TR 40,222,0
TR 42,222,1024
MV 192,v,44,v,64
TR 44,223,0
TR 46,223,1024
s_waitcnt lgkmcnt(4)
MV 80,v,16,v,48
buffer_load_dwordx4 v209, s[44:47], s75 offen offset:1024 lds
s_and_b32 s36, s2, 3
MV 96,v,20,v,48
ds_read_b128 v[64:67], v227 offset:0
s_lshl_b32 s36, s36, 1
MV 84,v,16,v,52
buffer_load_dwordx4 v210, s[44:47], s75 offen offset:2048 lds
s_sub_u32 s43, 14, s36
MV 100,v,20,v,52
s_bitcmp1_b32 s2, 4
s_cselect_b32 s36, s43, s36
MV 88,v,16,v,56
s_bfe_u32 s43, s2, 0x10003
MV 104,v,20,v,56
buffer_load_dwordx4 v211, s[44:47], s75 offen offset:3072 lds
s_add_u32 s36, s36, s43
MV 92,v,16,v,60
TR 16,216,8192
TR 18,216,9216
MV 108,v,20,v,60
TR 20,217,8192
TR 22,217,9216
MV 124,v,24,v,60
ds_read_b128 v[68:71], v227 offset:2048
s_add_u32 s75, s65, s74
MV 140,v,28,v,60
s_bfe_u32 s37, s2, 0x10002
s_lshr_b32 s43, s2, 5
MV 120,v,24,v,56
s_lshl_b32 s43, s43, 1
s_add_u32 s37, s37, s43
MV 136,v,28,v,56
s_add_u32 m0, s67, 36864
v_and_b32 v230, 15, v1
MV 116,v,24,v,52
ds_read_b128 v[72:75], v227 offset:4096
s_lshl_b32 s36, s36, 4
MV 132,v,28,v,52
v_add_u32 v231, s36, v230
s_lshr_b32 s36, s2, 4
MV 112,v,24,v,48
TR 24,218,8192
TR 26,218,9216
MV 128,v,28,v,48
TR 28,219,8192
TR 30,219,9216
MV 144,v,32,v,48
buffer_load_dwordx4 v208, s[44:47], s75 offen offset:0 lds
buffer_load_dwordx4 v209, s[44:47], s75 offen offset:1024 lds
MV 160,v,36,v,48
v_lshl_add_u32 v232, v230, 4, s36
v_and_b32 v233, 7, v1
MV 148,v,32,v,52
ds_read_b128 v[76:79], v227 offset:6144
v_bfe_u32 v234, v1, 3, 1
MV 164,v,36,v,52
buffer_load_dwordx4 v210, s[44:47], s75 offen offset:2048 lds
v_lshlrev_b32 v233, 3, v233
MV 152,v,32,v,56
v_lshl_add_u32 v233, v234, 7, v233
s_bfe_u32 s36, s69, 0x10001
MV 168,v,36,v,56
s_lshl_b32 s36, s36, 6
s_lshr_b32 s37, s69, 2
MV 156,v,32,v,60
TR 32,220,8192
TR 34,220,9216
MV 172,v,36,v,60
TR 36,221,8192
TR 38,221,9216
s_waitcnt lgkmcnt(15)
MV 188,v,40,v,60
buffer_load_dwordx4 v211, s[44:47], s75 offen offset:3072 lds
s_add_u32 s36, s36, s37
MV 204,v,44,v,60
s_add_u32 s74, s74, 128
v_add_u32 v233, s36, v233
MV 184,v,40,v,56
v_lshrrev_b32 v234, 4, v1
MV 200,v,44,v,56
v_cmp_eq_u32 vcc, 1, v234
s_nop 1
v_cndmask_b32 v233, v233, v232, vcc
MV 180,v,40,v,52
s_and_b32 s74, s74, 2047
MV 196,v,44,v,52
v_cmp_eq_u32 vcc, 2, v234
s_nop 1
v_cndmask_b32 v233, v233, v231, vcc
MV 176,v,40,v,48
TR 40,222,8192
TR 42,222,9216
MV 192,v,44,v,48
TR 44,223,8192
TR 46,223,9216
v_lshlrev_b32 v233, 2, v233
s_waitcnt lgkmcnt(4)
MV 80,v,16,v,64
MV 96,v,20,v,64
MV 84,v,16,v,68
MV 100,v,20,v,68
MV 88,v,16,v,72
MV 104,v,20,v,72
MV 92,v,16,v,76
MV 108,v,20,v,76
s_waitcnt vmcnt(14) lgkmcnt(0)
s_barrier
MV 124,v,24,v,76
TR 16,216,16384
TR 18,216,17408
MV 140,v,28,v,76
ds_read_b128 v[48:51], v224 offset:0
s_add_u32 m0, s68, 98304
MV 120,v,24,v,72
TR 20,217,16384
TR 22,217,17408
MV 136,v,28,v,72
buffer_load_dwordx4 v212, s[48:51], s66 offen offset:0 lds
MV 116,v,24,v,68
ds_read_b128 v[52:55], v224 offset:2048
buffer_load_dwordx4 v213, s[48:51], s66 offen offset:1024 lds
MV 132,v,28,v,68
MV 112,v,24,v,64
TR 24,218,16384
TR 26,218,17408
MV 128,v,28,v,64
TR 28,219,16384
TR 30,219,17408
MV 144,v,32,v,64
ds_read_b128 v[56:59], v224 offset:4096
buffer_load_dwordx4 v214, s[48:51], s66 offen offset:2048 lds
MV 160,v,36,v,64
buffer_load_dwordx4 v215, s[48:51], s66 offen offset:3072 lds
MV 148,v,32,v,68
MV 164,v,36,v,68
s_add_u32 s66, s66, 524288
MV 152,v,32,v,72
ds_read_b128 v[60:63], v224 offset:6144
MV 168,v,36,v,72
s_and_b32 s66, s66, 8388607
MV 156,v,32,v,76
TR 32,220,16384
TR 34,220,17408
MV 172,v,36,v,76
TR 36,221,16384
TR 38,221,17408
MV 188,v,40,v,76
s_add_u32 s75, s64, s74
MV 204,v,44,v,76
MV 184,v,40,v,72
s_add_u32 m0, s67, 65536
MV 200,v,44,v,72
MV 180,v,40,v,68
buffer_load_dwordx4 v208, s[44:47], s75 offen offset:0 lds
MV 196,v,44,v,68
MV 176,v,40,v,64
TR 40,222,16384
TR 42,222,17408
MV 192,v,44,v,64
TR 44,223,16384
TR 46,223,17408
s_waitcnt lgkmcnt(4)
MV 80,v,16,v,48
buffer_load_dwordx4 v209, s[44:47], s75 offen offset:1024 lds
s_lshl_b32 s36, s2, 2
MV 96,v,20,v,48
ds_read_b128 v[64:67], v225 offset:0
s_add_u32 s36, s36, s3
MV 84,v,16,v,52
buffer_load_dwordx4 v210, s[44:47], s75 offen offset:2048 lds
s_lshl_b32 s42, s36, 1
MV 100,v,20,v,52
s_lshl_b32 s37, s36, 12
MV 88,v,16,v,56
s_add_u32 s16, s32, s37
s_addc_u32 s17, s33, 0
MV 104,v,20,v,56
buffer_load_dwordx4 v211, s[44:47], s75 offen offset:3072 lds
MV 92,v,16,v,60
TR 16,216,24576
TR 18,216,25600
MV 108,v,20,v,60
TR 20,217,24576
TR 22,217,25600
MV 124,v,24,v,60
ds_read_b128 v[68:71], v225 offset:2048
s_add_u32 s75, s65, s74
MV 140,v,28,v,60
s_mov_b32 s18, 4096
s_mov_b32 s19, 0x20000
MV 120,v,24,v,56
s_add_u32 s37, s37, 50331648
MV 136,v,28,v,56
s_add_u32 m0, s67, 69632
MV 116,v,24,v,52
ds_read_b128 v[72:75], v225 offset:4096
MV 132,v,28,v,52
s_add_u32 s20, s40, s37
s_addc_u32 s21, s41, 0
MV 112,v,24,v,48
TR 24,218,24576
TR 26,218,25600
MV 128,v,28,v,48
TR 28,219,24576
TR 30,219,25600
MV 144,v,32,v,48
buffer_load_dwordx4 v208, s[44:47], s75 offen offset:0 lds
buffer_load_dwordx4 v209, s[44:47], s75 offen offset:1024 lds
MV 160,v,36,v,48
s_mov_b32 s22, 4096
s_mov_b32 s23, 0x20000
MV 148,v,32,v,52
ds_read_b128 v[76:79], v225 offset:6144
s_lshl_b32 s37, s2, 14
MV 164,v,36,v,52
buffer_load_dwordx4 v210, s[44:47], s75 offen offset:2048 lds
s_add_u32 s37, s37, 54525952
MV 152,v,32,v,56
s_add_u32 s24, s40, s37
s_addc_u32 s25, s41, 0
MV 168,v,36,v,56
s_mov_b32 s26, 16384
s_mov_b32 s27, 0x20000
MV 156,v,32,v,60
TR 32,220,24576
TR 34,220,25600
MV 172,v,36,v,60
TR 36,221,24576
TR 38,221,25600
s_waitcnt lgkmcnt(15)
MV 188,v,40,v,60
buffer_load_dwordx4 v211, s[44:47], s75 offen offset:3072 lds
s_mov_b32 s28, s34
MV 204,v,44,v,60
s_add_u32 s74, s74, 128
s_mov_b32 s29, s35
MV 184,v,40,v,56
s_mov_b32 s30, 2048
s_mov_b32 s31, 0x20000
MV 200,v,44,v,56
s_mul_i32 s43, s3, 4608
MV 180,v,40,v,52
s_and_b32 s74, s74, 2047
s_add_u32 s43, s43, 132096
MV 196,v,44,v,52
MV 176,v,40,v,48
TR 40,222,24576
TR 42,222,25600
MV 192,v,44,v,48
TR 44,223,24576
TR 46,223,25600
s_waitcnt lgkmcnt(4)
MV 80,v,16,v,64
MV 96,v,20,v,64
MV 84,v,16,v,68
MV 100,v,20,v,68
MV 88,v,16,v,72
MV 104,v,20,v,72
MV 92,v,16,v,76
MV 108,v,20,v,76
s_waitcnt vmcnt(12) lgkmcnt(0)
s_barrier
MV 124,v,24,v,76
s_load_dwordx2 s[32:33], s[0:1], 88
TR 16,216,32768
MV 140,v,28,v,76
TR 18,216,33792
ds_read_b128 v[48:51], v224 offset:32768
MV 120,v,24,v,72
TR 20,217,32768
TR 22,217,33792
MV 136,v,28,v,72
MV 116,v,24,v,68
ds_read_b128 v[52:55], v224 offset:34816
MV 132,v,28,v,68
MV 112,v,24,v,64
TR 24,218,32768
TR 26,218,33792
MV 128,v,28,v,64
TR 28,219,32768
TR 30,219,33792
MV 144,v,32,v,64
ds_read_b128 v[56:59], v224 offset:36864
MV 160,v,36,v,64
MV 148,v,32,v,68
MV 164,v,36,v,68
MV 152,v,32,v,72
ds_read_b128 v[60:63], v224 offset:38912
MV 168,v,36,v,72
MV 156,v,32,v,76
TR 32,220,32768
TR 34,220,33792
MV 172,v,36,v,76
TR 36,221,32768
TR 38,221,33792
MV 188,v,40,v,76
MV 204,v,44,v,76
MV 184,v,40,v,72
MV 200,v,44,v,72
MV 180,v,40,v,68
MV 196,v,44,v,68
MV 176,v,40,v,64
TR 40,222,32768
TR 42,222,33792
MV 192,v,44,v,64
TR 44,223,32768
TR 46,223,33792
s_waitcnt lgkmcnt(4)
MV 80,v,16,v,48
s_add_u32 s4, s40, 109051904
s_addc_u32 s5, s41, 0
MV 96,v,20,v,48
ds_read_b128 v[64:67], v225 offset:32768
MV 84,v,16,v,52
MV 100,v,20,v,52
MV 88,v,16,v,56
s_mov_b32 s6, 4194304
MV 104,v,20,v,56
MV 92,v,16,v,60
TR 16,216,40960
TR 18,216,41984
MV 108,v,20,v,60
TR 20,217,40960
TR 22,217,41984
MV 124,v,24,v,60
ds_read_b128 v[68:71], v225 offset:34816
s_mov_b32 s7, 0x20000
MV 140,v,28,v,60
s_lshl_b32 s36, s2, 14
MV 120,v,24,v,56
MV 136,v,28,v,56
v_mov_b32 v244, -1
MV 116,v,24,v,52
ds_read_b128 v[72:75], v225 offset:36864
MV 132,v,28,v,52
v_mov_b32 v245, -1
MV 112,v,24,v,48
TR 24,218,40960
TR 26,218,41984
MV 128,v,28,v,48
TR 28,219,40960
TR 30,219,41984
MV 144,v,32,v,48
v_mov_b32 v246, -1
MV 160,v,36,v,48
MV 148,v,32,v,52
ds_read_b128 v[76:79], v225 offset:38912
v_mov_b32 v247, -1
MV 164,v,36,v,52
MV 152,v,32,v,56
buffer_store_dwordx4 v[244:247], v12, s[4:7], s36 offen offset:0 sc1
MV 168,v,36,v,56
MV 156,v,32,v,60
TR 32,220,40960
TR 34,220,41984
MV 172,v,36,v,60
TR 36,221,40960
TR 38,221,41984
s_waitcnt lgkmcnt(15)
MV 188,v,40,v,60
buffer_store_dwordx4 v[244:247], v12, s[4:7], s36 offen offset:1024 sc1
MV 204,v,44,v,60
buffer_store_dwordx4 v[244:247], v12, s[4:7], s36 offen offset:2048 sc1
MV 184,v,40,v,56
MV 200,v,44,v,56
buffer_store_dwordx4 v[244:247], v12, s[4:7], s36 offen offset:3072 sc1
MV 180,v,40,v,52
MV 196,v,44,v,52
MV 176,v,40,v,48
TR 40,222,40960
TR 42,222,41984
MV 192,v,44,v,48
TR 44,223,40960
TR 46,223,41984
s_waitcnt lgkmcnt(4)
MV 80,v,16,v,64
MV 96,v,20,v,64
MV 84,v,16,v,68
MV 100,v,20,v,68
MV 88,v,16,v,72
MV 104,v,20,v,72
MV 92,v,16,v,76
MV 108,v,20,v,76
s_waitcnt vmcnt(4) lgkmcnt(0)
s_barrier
MV 124,v,24,v,76
TR 16,216,0
TR 18,216,1024
MV 140,v,28,v,76
ds_read_b128 v[48:51], v226 offset:0
MV 120,v,24,v,72
TR 20,217,0
TR 22,217,1024
MV 136,v,28,v,72
MV 116,v,24,v,68
ds_read_b128 v[52:55], v226 offset:2048
MV 132,v,28,v,68
MV 112,v,24,v,64
TR 24,218,0
TR 26,218,1024
MV 128,v,28,v,64
TR 28,219,0
TR 30,219,1024
MV 144,v,32,v,64
ds_read_b128 v[56:59], v226 offset:4096
MV 160,v,36,v,64
MV 148,v,32,v,68
MV 164,v,36,v,68
MV 152,v,32,v,72
ds_read_b128 v[60:63], v226 offset:6144
MV 168,v,36,v,72
MV 156,v,32,v,76
TR 32,220,0
TR 34,220,1024
MV 172,v,36,v,76
TR 36,221,0
TR 38,221,1024
MV 188,v,40,v,76
MV 204,v,44,v,76
MV 184,v,40,v,72
MV 200,v,44,v,72
MV 180,v,40,v,68
MV 196,v,44,v,68
MV 176,v,40,v,64
TR 40,222,0
TR 42,222,1024
MV 192,v,44,v,64
TR 44,223,0
TR 46,223,1024
s_waitcnt lgkmcnt(4)
MV 80,v,16,v,48
buffer_load_dword v237, v233, s[8:11], 0 offen offset:0 sc1
MV 96,v,20,v,48
ds_read_b128 v[64:67], v227 offset:0
MV 84,v,16,v,52
s_lshr_b32 s36, s2, 3
MV 100,v,20,v,52
MV 88,v,16,v,56
MV 104,v,20,v,56
s_lshl_b32 s36, s36, 18
MV 92,v,16,v,60
TR 16,216,8192
TR 18,216,9216
MV 108,v,20,v,60
TR 20,217,8192
TR 22,217,9216
MV 124,v,24,v,60
ds_read_b128 v[68:71], v227 offset:2048
s_and_b32 s37, s2, 7
MV 140,v,28,v,60
MV 120,v,24,v,56
s_lshl_b32 s37, s37, 8
MV 136,v,28,v,56
MV 116,v,24,v,52
ds_read_b128 v[72:75], v227 offset:4096
s_add_u32 s36, s36, s37
MV 132,v,28,v,52
MV 112,v,24,v,48
TR 24,218,8192
TR 26,218,9216
MV 128,v,28,v,48
TR 28,219,8192
TR 30,219,9216
MV 144,v,32,v,48
s_lshl_b32 s37, s3, 16
MV 160,v,36,v,48
s_add_u32 s36, s36, s37
MV 148,v,32,v,52
ds_read_b128 v[76:79], v227 offset:6144
MV 164,v,36,v,52
MV 152,v,32,v,56
s_add_u32 s32, s32, s36
s_addc_u32 s33, s33, 0
MV 168,v,36,v,56
MV 156,v,32,v,60
TR 32,220,8192
TR 34,220,9216
MV 172,v,36,v,60
TR 36,221,8192
TR 38,221,9216
s_waitcnt lgkmcnt(15)
MV 188,v,40,v,60
MV 204,v,44,v,60
s_mov_b32 s34, 65536
MV 184,v,40,v,56
MV 200,v,44,v,56
s_mov_b32 s35, 0x20000
MV 180,v,40,v,52
MV 196,v,44,v,52
MV 176,v,40,v,48
TR 40,222,8192
TR 42,222,9216
MV 192,v,44,v,48
TR 44,223,8192
TR 46,223,9216
s_waitcnt vmcnt(0)
v_cmp_gt_u32 vcc, 1, v237
s_nop 4
s_cbranch_vccnz L_spin_f1
L_spin_f1_ret:
s_waitcnt lgkmcnt(4)
MV 80,v,16,v,64
s_add_u32 m0, s68, 16384
MV 96,v,20,v,64
MV 84,v,16,v,68
s_mov_b32 s80, 0
MV 100,v,20,v,68
MV 88,v,16,v,72
MV 104,v,20,v,72
buffer_load_dwordx4 v12, s[52:55], s80 offen offset:0 sc1 lds
MV 92,v,16,v,76
MV 108,v,20,v,76
buffer_load_dwordx4 v12, s[52:55], s80 offen offset:1024 sc1 lds
MV 124,v,24,v,76
MV 140,v,28,v,76
MV 120,v,24,v,72
buffer_load_dwordx4 v12, s[52:55], s80 offen offset:2048 sc1 lds
MV 136,v,28,v,72
MV 116,v,24,v,68
buffer_load_dwordx4 v12, s[52:55], s80 offen offset:3072 sc1 lds
MV 132,v,28,v,68
MV 112,v,24,v,64
MV 128,v,28,v,64
s_add_u32 m0, s68, 32768
MV 144,v,32,v,64
MV 160,v,36,v,64
s_mov_b32 s80, 16384
MV 148,v,32,v,68
MV 164,v,36,v,68
MV 152,v,32,v,72
buffer_load_dwordx4 v12, s[52:55], s80 offen offset:0 sc1 lds
MV 168,v,36,v,72
MV 156,v,32,v,76
buffer_load_dwordx4 v12, s[52:55], s80 offen offset:1024 sc1 lds
MV 172,v,36,v,76
s_waitcnt lgkmcnt(2)
MV 188,v,40,v,76
s_waitcnt lgkmcnt(0)
MV 204,v,44,v,76
buffer_load_dwordx4 v12, s[52:55], s80 offen offset:2048 sc1 lds
MV 184,v,40,v,72
MV 200,v,44,v,72
buffer_load_dwordx4 v12, s[52:55], s80 offen offset:3072 sc1 lds
MV 180,v,40,v,68
MV 196,v,44,v,68
MV 176,v,40,v,64
MV 192,v,44,v,64
L_p3_begin:
s_waitcnt lgkmcnt(0)
s_barrier
s_mov_b32 s82, 0x3e0293ee
s_mov_b32 s83, 0x3e0293ee
v_pk_mul_f32 v[80:81], v[80:81], s[82:83]
v_pk_mul_f32 v[82:83], v[82:83], s[82:83]
v_pk_mul_f32 v[84:85], v[84:85], s[82:83]
v_pk_mul_f32 v[86:87], v[86:87], s[82:83]
v_pk_mul_f32 v[88:89], v[88:89], s[82:83]
v_pk_mul_f32 v[90:91], v[90:91], s[82:83]
v_pk_mul_f32 v[92:93], v[92:93], s[82:83]
v_pk_mul_f32 v[94:95], v[94:95], s[82:83]
v_pk_mul_f32 v[96:97], v[96:97], s[82:83]
v_pk_mul_f32 v[98:99], v[98:99], s[82:83]
v_pk_mul_f32 v[100:101], v[100:101], s[82:83]
v_pk_mul_f32 v[102:103], v[102:103], s[82:83]
s_add_u32 m0, s68, 114688
v_pk_mul_f32 v[104:105], v[104:105], s[82:83]
v_pk_mul_f32 v[106:107], v[106:107], s[82:83]
v_pk_mul_f32 v[108:109], v[108:109], s[82:83]
v_pk_mul_f32 v[110:111], v[110:111], s[82:83]
v_cvt_pk_bf16_f32 v16, v80, v81
v_cvt_pk_bf16_f32 v17, v82, v83
v_cvt_pk_bf16_f32 v18, v96, v97
v_cvt_pk_bf16_f32 v19, v98, v99
v_cvt_pk_bf16_f32 v32, v84, v85
v_cvt_pk_bf16_f32 v33, v86, v87
v_cvt_pk_bf16_f32 v34, v100, v101
v_cvt_pk_bf16_f32 v35, v102, v103
v_cvt_pk_bf16_f32 v48, v88, v89
v_cvt_pk_bf16_f32 v49, v90, v91
v_cvt_pk_bf16_f32 v50, v104, v105
s_mov_b32 s80, 16384
v_cvt_pk_bf16_f32 v51, v106, v107
v_cvt_pk_bf16_f32 v64, v92, v93
v_cvt_pk_bf16_f32 v65, v94, v95
v_cvt_pk_bf16_f32 v66, v108, v109
v_cvt_pk_bf16_f32 v67, v110, v111
v_pk_mul_f32 v[112:113], v[112:113], s[82:83]
v_pk_mul_f32 v[114:115], v[114:115], s[82:83]
v_pk_mul_f32 v[116:117], v[116:117], s[82:83]
v_pk_mul_f32 v[118:119], v[118:119], s[82:83]
v_pk_mul_f32 v[120:121], v[120:121], s[82:83]
v_pk_mul_f32 v[122:123], v[122:123], s[82:83]
v_pk_mul_f32 v[124:125], v[124:125], s[82:83]
v_pk_mul_f32 v[126:127], v[126:127], s[82:83]
v_pk_mul_f32 v[128:129], v[128:129], s[82:83]
buffer_load_dwordx4 v12, s[56:59], s80 offen offset:0 sc1 lds
v_pk_mul_f32 v[130:131], v[130:131], s[82:83]
v_pk_mul_f32 v[132:133], v[132:133], s[82:83]
v_pk_mul_f32 v[134:135], v[134:135], s[82:83]
v_pk_mul_f32 v[136:137], v[136:137], s[82:83]
v_pk_mul_f32 v[138:139], v[138:139], s[82:83]
v_pk_mul_f32 v[140:141], v[140:141], s[82:83]
v_pk_mul_f32 v[142:143], v[142:143], s[82:83]
v_cvt_pk_bf16_f32 v20, v112, v113
v_cvt_pk_bf16_f32 v21, v114, v115
v_cvt_pk_bf16_f32 v22, v128, v129
v_cvt_pk_bf16_f32 v23, v130, v131
v_cvt_pk_bf16_f32 v36, v116, v117
v_cvt_pk_bf16_f32 v37, v118, v119
v_cvt_pk_bf16_f32 v38, v132, v133
v_cvt_pk_bf16_f32 v39, v134, v135
buffer_load_dwordx4 v12, s[56:59], s80 offen offset:1024 sc1 lds
v_cvt_pk_bf16_f32 v52, v120, v121
v_cvt_pk_bf16_f32 v53, v122, v123
v_cvt_pk_bf16_f32 v54, v136, v137
v_cvt_pk_bf16_f32 v55, v138, v139
v_cvt_pk_bf16_f32 v68, v124, v125
v_cvt_pk_bf16_f32 v69, v126, v127
v_cvt_pk_bf16_f32 v70, v140, v141
v_cvt_pk_bf16_f32 v71, v142, v143
v_pk_mul_f32 v[144:145], v[144:145], s[82:83]
v_pk_mul_f32 v[146:147], v[146:147], s[82:83]
v_pk_mul_f32 v[148:149], v[148:149], s[82:83]
v_pk_mul_f32 v[150:151], v[150:151], s[82:83]
v_pk_mul_f32 v[152:153], v[152:153], s[82:83]
v_pk_mul_f32 v[154:155], v[154:155], s[82:83]
v_pk_mul_f32 v[156:157], v[156:157], s[82:83]
buffer_load_dwordx4 v12, s[56:59], s80 offen offset:2048 sc1 lds
v_pk_mul_f32 v[158:159], v[158:159], s[82:83]
v_pk_mul_f32 v[160:161], v[160:161], s[82:83]
v_pk_mul_f32 v[162:163], v[162:163], s[82:83]
v_pk_mul_f32 v[164:165], v[164:165], s[82:83]
v_pk_mul_f32 v[166:167], v[166:167], s[82:83]
v_pk_mul_f32 v[168:169], v[168:169], s[82:83]
v_pk_mul_f32 v[170:171], v[170:171], s[82:83]
v_pk_mul_f32 v[172:173], v[172:173], s[82:83]
v_pk_mul_f32 v[174:175], v[174:175], s[82:83]
v_cvt_pk_bf16_f32 v24, v144, v145
v_cvt_pk_bf16_f32 v25, v146, v147
v_cvt_pk_bf16_f32 v26, v160, v161
v_cvt_pk_bf16_f32 v27, v162, v163
v_cvt_pk_bf16_f32 v40, v148, v149
buffer_load_dwordx4 v12, s[56:59], s80 offen offset:3072 sc1 lds
v_cvt_pk_bf16_f32 v41, v150, v151
v_cvt_pk_bf16_f32 v42, v164, v165
v_cvt_pk_bf16_f32 v43, v166, v167
v_cvt_pk_bf16_f32 v56, v152, v153
v_cvt_pk_bf16_f32 v57, v154, v155
v_cvt_pk_bf16_f32 v58, v168, v169
v_cvt_pk_bf16_f32 v59, v170, v171
v_cvt_pk_bf16_f32 v72, v156, v157
v_cvt_pk_bf16_f32 v73, v158, v159
v_cvt_pk_bf16_f32 v74, v172, v173
v_cvt_pk_bf16_f32 v75, v174, v175
v_pk_mul_f32 v[176:177], v[176:177], s[82:83]
v_pk_mul_f32 v[178:179], v[178:179], s[82:83]
v_pk_mul_f32 v[180:181], v[180:181], s[82:83]
v_pk_mul_f32 v[182:183], v[182:183], s[82:83]
s_add_u32 m0, s68, 49152
v_pk_mul_f32 v[184:185], v[184:185], s[82:83]
v_pk_mul_f32 v[186:187], v[186:187], s[82:83]
v_pk_mul_f32 v[188:189], v[188:189], s[82:83]
v_pk_mul_f32 v[190:191], v[190:191], s[82:83]
v_pk_mul_f32 v[192:193], v[192:193], s[82:83]
v_pk_mul_f32 v[194:195], v[194:195], s[82:83]
v_pk_mul_f32 v[196:197], v[196:197], s[82:83]
v_pk_mul_f32 v[198:199], v[198:199], s[82:83]
v_pk_mul_f32 v[200:201], v[200:201], s[82:83]
v_pk_mul_f32 v[202:203], v[202:203], s[82:83]
v_pk_mul_f32 v[204:205], v[204:205], s[82:83]
v_pk_mul_f32 v[206:207], v[206:207], s[82:83]
v_cvt_pk_bf16_f32 v28, v176, v177
v_cvt_pk_bf16_f32 v29, v178, v179
s_mov_b32 s80, 32768
v_cvt_pk_bf16_f32 v30, v192, v193
v_cvt_pk_bf16_f32 v31, v194, v195
v_cvt_pk_bf16_f32 v44, v180, v181
v_cvt_pk_bf16_f32 v45, v182, v183
v_cvt_pk_bf16_f32 v46, v196, v197
v_cvt_pk_bf16_f32 v47, v198, v199
v_cvt_pk_bf16_f32 v60, v184, v185
v_cvt_pk_bf16_f32 v61, v186, v187
v_cvt_pk_bf16_f32 v62, v200, v201
v_cvt_pk_bf16_f32 v63, v202, v203
v_cvt_pk_bf16_f32 v76, v188, v189
v_cvt_pk_bf16_f32 v77, v190, v191
v_cvt_pk_bf16_f32 v78, v204, v205
v_cvt_pk_bf16_f32 v79, v206, v207
v_mov_b32 v2, 0
buffer_load_dwordx4 v12, s[52:55], s80 offen offset:0 sc1 lds
v_mov_b32 v3, 0
v_mov_b32 v4, 0
v_mov_b32 v5, 0
v_accvgpr_write_b32 a0, 0
v_accvgpr_write_b32 a1, 0
v_accvgpr_write_b32 a2, 0
v_accvgpr_write_b32 a3, 0
v_accvgpr_write_b32 a4, 0
v_accvgpr_write_b32 a5, 0
v_accvgpr_write_b32 a6, 0
v_accvgpr_write_b32 a7, 0
v_accvgpr_write_b32 a8, 0
v_accvgpr_write_b32 a9, 0
v_accvgpr_write_b32 a10, 0
v_accvgpr_write_b32 a11, 0
buffer_load_dwordx4 v12, s[52:55], s80 offen offset:1024 sc1 lds
v_accvgpr_write_b32 a12, 0
v_accvgpr_write_b32 a13, 0
v_accvgpr_write_b32 a14, 0
v_accvgpr_write_b32 a15, 0
v_accvgpr_write_b32 a16, 0
v_accvgpr_write_b32 a17, 0
v_accvgpr_write_b32 a18, 0
v_accvgpr_write_b32 a19, 0
v_accvgpr_write_b32 a20, 0
v_accvgpr_write_b32 a21, 0
v_accvgpr_write_b32 a22, 0
v_accvgpr_write_b32 a23, 0
v_accvgpr_write_b32 a24, 0
v_accvgpr_write_b32 a25, 0
buffer_load_dwordx4 v12, s[52:55], s80 offen offset:2048 sc1 lds
v_accvgpr_write_b32 a26, 0
v_accvgpr_write_b32 a27, 0
v_accvgpr_write_b32 a28, 0
v_accvgpr_write_b32 a29, 0
v_accvgpr_write_b32 a30, 0
v_accvgpr_write_b32 a31, 0
v_accvgpr_write_b32 a32, 0
v_accvgpr_write_b32 a33, 0
v_accvgpr_write_b32 a34, 0
v_accvgpr_write_b32 a35, 0
v_accvgpr_write_b32 a36, 0
v_accvgpr_write_b32 a37, 0
v_accvgpr_write_b32 a38, 0
v_accvgpr_write_b32 a39, 0
v_accvgpr_write_b32 a40, 0
buffer_load_dwordx4 v12, s[52:55], s80 offen offset:3072 sc1 lds
v_accvgpr_write_b32 a41, 0
v_accvgpr_write_b32 a42, 0
v_accvgpr_write_b32 a43, 0
v_accvgpr_write_b32 a44, 0
v_accvgpr_write_b32 a45, 0
v_accvgpr_write_b32 a46, 0
v_accvgpr_write_b32 a47, 0
v_accvgpr_write_b32 a48, 0
v_accvgpr_write_b32 a49, 0
v_accvgpr_write_b32 a50, 0
v_accvgpr_write_b32 a51, 0
v_accvgpr_write_b32 a52, 0
v_accvgpr_write_b32 a53, 0
v_accvgpr_write_b32 a54, 0
s_add_u32 m0, s68, 65536
v_accvgpr_write_b32 a55, 0
v_accvgpr_write_b32 a56, 0
v_accvgpr_write_b32 a57, 0
v_accvgpr_write_b32 a58, 0
v_accvgpr_write_b32 a59, 0
v_accvgpr_write_b32 a60, 0
v_accvgpr_write_b32 a61, 0
v_accvgpr_write_b32 a62, 0
v_accvgpr_write_b32 a63, 0
v_accvgpr_write_b32 a64, 0
v_accvgpr_write_b32 a65, 0
v_accvgpr_write_b32 a66, 0
v_accvgpr_write_b32 a67, 0
v_accvgpr_write_b32 a68, 0
v_accvgpr_write_b32 a69, 0
s_mov_b32 s80, 32768
v_accvgpr_write_b32 a70, 0
v_accvgpr_write_b32 a71, 0
v_accvgpr_write_b32 a72, 0
v_accvgpr_write_b32 a73, 0
v_accvgpr_write_b32 a74, 0
v_accvgpr_write_b32 a75, 0
v_accvgpr_write_b32 a76, 0
v_accvgpr_write_b32 a77, 0
v_accvgpr_write_b32 a78, 0
v_accvgpr_write_b32 a79, 0
v_accvgpr_write_b32 a80, 0
v_accvgpr_write_b32 a81, 0
v_accvgpr_write_b32 a82, 0
v_accvgpr_write_b32 a83, 0
v_accvgpr_write_b32 a84, 0
buffer_load_dwordx4 v12, s[56:59], s80 offen offset:0 sc1 lds
v_accvgpr_write_b32 a85, 0
v_accvgpr_write_b32 a86, 0
v_accvgpr_write_b32 a87, 0
v_accvgpr_write_b32 a88, 0
v_accvgpr_write_b32 a89, 0
v_accvgpr_write_b32 a90, 0
v_accvgpr_write_b32 a91, 0
v_accvgpr_write_b32 a92, 0
v_accvgpr_write_b32 a93, 0
v_accvgpr_write_b32 a94, 0
v_accvgpr_write_b32 a95, 0
v_accvgpr_write_b32 a96, 0
v_accvgpr_write_b32 a97, 0
v_accvgpr_write_b32 a98, 0
buffer_load_dwordx4 v12, s[56:59], s80 offen offset:1024 sc1 lds
v_accvgpr_write_b32 a99, 0
v_accvgpr_write_b32 a100, 0
v_accvgpr_write_b32 a101, 0
v_accvgpr_write_b32 a102, 0
v_accvgpr_write_b32 a103, 0
v_accvgpr_write_b32 a104, 0
v_accvgpr_write_b32 a105, 0
v_accvgpr_write_b32 a106, 0
v_accvgpr_write_b32 a107, 0
v_accvgpr_write_b32 a108, 0
v_accvgpr_write_b32 a109, 0
v_accvgpr_write_b32 a110, 0
v_accvgpr_write_b32 a111, 0
v_accvgpr_write_b32 a112, 0
v_accvgpr_write_b32 a113, 0
buffer_load_dwordx4 v12, s[56:59], s80 offen offset:2048 sc1 lds
v_accvgpr_write_b32 a114, 0
v_accvgpr_write_b32 a115, 0
v_accvgpr_write_b32 a116, 0
v_accvgpr_write_b32 a117, 0
v_accvgpr_write_b32 a118, 0
v_accvgpr_write_b32 a119, 0
v_accvgpr_write_b32 a120, 0
v_accvgpr_write_b32 a121, 0
v_accvgpr_write_b32 a122, 0
v_accvgpr_write_b32 a123, 0
v_accvgpr_write_b32 a124, 0
v_accvgpr_write_b32 a125, 0
v_accvgpr_write_b32 a126, 0
v_accvgpr_write_b32 a127, 0
v_xor_b32 v244, 0x8000, v10
buffer_load_dwordx4 v12, s[56:59], s80 offen offset:3072 sc1 lds
s_waitcnt vmcnt(16)
s_barrier
ds_read_b128 a[128:131], v244 offset:16384
ds_read_b128 a[132:135], v244 offset:17408
ds_read_b128 a[136:139], v244 offset:18432
ds_read_b128 a[140:143], v244 offset:19456
ds_read_b128 a[144:147], v244 offset:20480
ds_read_b128 a[148:151], v244 offset:21504
ds_read_b128 a[152:155], v244 offset:22528
ds_read_b128 a[156:159], v244 offset:23552
ds_read_b128 a[160:163], v244 offset:24576
ds_read_b128 a[164:167], v244 offset:25600
ds_read_b128 a[168:171], v244 offset:26624
ds_read_b128 a[172:175], v244 offset:27648
ds_read_b128 a[176:179], v244 offset:28672
ds_read_b128 a[180:183], v244 offset:29696
ds_read_b128 a[184:187], v244 offset:30720
ds_read_b128 a[188:191], v244 offset:31744
s_waitcnt lgkmcnt(15)
v_mfma_f32_16x16x32_bf16 v[80:83], a[128:131], v[16:19], 0
s_add_u32 m0, s68, 0
v_mfma_f32_16x16x32_bf16 v[88:91], a[128:131], v[32:35], 0
s_mov_b32 s80, 49152
v_mfma_f32_16x16x32_bf16 v[96:99], a[128:131], v[48:51], 0
v_mfma_f32_16x16x32_bf16 v[104:107], a[128:131], v[64:67], 0
buffer_load_dwordx4 v12, s[52:55], s80 offen offset:0 sc1 lds
s_waitcnt lgkmcnt(14)
MV 80,a,132,v,20
MV 88,a,132,v,36
buffer_load_dwordx4 v12, s[52:55], s80 offen offset:1024 sc1 lds
MV 96,a,132,v,52
MV 104,a,132,v,68
buffer_load_dwordx4 v12, s[52:55], s80 offen offset:2048 sc1 lds
s_waitcnt lgkmcnt(13)
MV 80,a,136,v,24
MV 88,a,136,v,40
buffer_load_dwordx4 v12, s[52:55], s80 offen offset:3072 sc1 lds
MV 96,a,136,v,56
MV 104,a,136,v,72
s_add_u32 m0, s68, 81920
s_waitcnt lgkmcnt(12)
MV 80,a,140,v,28
s_mov_b32 s80, 49152
MV 88,a,140,v,44
MV 96,a,140,v,60
buffer_load_dwordx4 v12, s[56:59], s80 offen offset:0 sc1 lds
MV 104,a,140,v,76
s_waitcnt lgkmcnt(11)
v_mfma_f32_16x16x32_bf16 v[84:87], a[144:147], v[16:19], 0
buffer_load_dwordx4 v12, s[56:59], s80 offen offset:1024 sc1 lds
v_mfma_f32_16x16x32_bf16 v[92:95], a[144:147], v[32:35], 0
v_mfma_f32_16x16x32_bf16 v[100:103], a[144:147], v[48:51], 0
buffer_load_dwordx4 v12, s[56:59], s80 offen offset:2048 sc1 lds
v_mfma_f32_16x16x32_bf16 v[108:111], a[144:147], v[64:67], 0
s_waitcnt lgkmcnt(10)
MV 84,a,148,v,20
buffer_load_dwordx4 v12, s[56:59], s80 offen offset:3072 sc1 lds
MV 92,a,148,v,36
MV 100,a,148,v,52
MV 108,a,148,v,68
s_waitcnt lgkmcnt(9)
MV 84,a,152,v,24
s_waitcnt vmcnt(16) lgkmcnt(0)
s_barrier
MV 92,a,152,v,40
ds_read_b128 a[128:131], v10 offset:0
s_add_u32 m0, s68, 16384
MV 100,a,152,v,56
ds_read_b128 a[132:135], v10 offset:1024
s_mov_b32 s80, 65536
MV 108,a,152,v,72
ds_read_b128 a[136:139], v10 offset:2048
buffer_load_dwordx4 v12, s[52:55], s80 offen offset:0 sc1 lds
MV 84,a,156,v,28
ds_read_b128 a[140:143], v10 offset:3072
buffer_load_dwordx4 v12, s[52:55], s80 offen offset:1024 sc1 lds
MV 92,a,156,v,44
ds_read_b128 a[144:147], v10 offset:4096
buffer_load_dwordx4 v12, s[52:55], s80 offen offset:2048 sc1 lds
MV 100,a,156,v,60
ds_read_b128 a[148:151], v10 offset:5120
buffer_load_dwordx4 v12, s[52:55], s80 offen offset:3072 sc1 lds
MV 108,a,156,v,76
ds_read_b128 a[152:155], v10 offset:6144
s_mov_b32 s71, 65536
v_mfma_f32_16x16x32_bf16 v[112:115], a[160:163], v[16:19], 0
ds_read_b128 a[156:159], v10 offset:7168
v_mfma_f32_16x16x32_bf16 v[120:123], a[160:163], v[32:35], 0
v_lshrrev_b32 v245, 4, v1
v_mfma_f32_16x16x32_bf16 v[128:131], a[160:163], v[48:51], 0
v_and_b32 v246, 15, v1
v_mfma_f32_16x16x32_bf16 v[136:139], a[160:163], v[64:67], 0
ds_read_b128 a[160:163], v10 offset:8192
v_lshlrev_b32 v247, 1, v245
MV 112,a,164,v,20
v_xor_b32 v246, v246, v247
MV 120,a,164,v,36
v_lshlrev_b32 v245, 11, v245
MV 128,a,164,v,52
v_lshl_add_u32 v245, v246, 4, v245
MV 136,a,164,v,68
ds_read_b128 a[164:167], v10 offset:9216
v_xor_b32 v246, 128, v245
MV 112,a,168,v,24
MV 120,a,168,v,40
s_lshl_b32 s36, s3, 13
MV 128,a,168,v,56
s_add_u32 m0, s36, 131072
MV 136,a,168,v,72
ds_read_b128 a[168:171], v10 offset:10240
s_mov_b32 s37, 0
MV 112,a,172,v,28
buffer_load_dwordx4 v245, s[32:35], s37 offen offset:0 lds
MV 120,a,172,v,44
s_mov_b32 s37, 7168
MV 128,a,172,v,60
buffer_load_dwordx4 v246, s[32:35], s37 offen offset:1024 lds
MV 136,a,172,v,76
ds_read_b128 a[172:175], v10 offset:11264
v_mfma_f32_16x16x32_bf16 v[116:119], a[176:179], v[16:19], 0
s_mov_b32 s37, 14336
v_mfma_f32_16x16x32_bf16 v[124:127], a[176:179], v[32:35], 0
buffer_load_dwordx4 v245, s[32:35], s37 offen offset:2048 lds
v_mfma_f32_16x16x32_bf16 v[132:135], a[176:179], v[48:51], 0
s_mov_b32 s37, 21504
v_mfma_f32_16x16x32_bf16 v[140:143], a[176:179], v[64:67], 0
ds_read_b128 a[176:179], v10 offset:12288
buffer_load_dwordx4 v246, s[32:35], s37 offen offset:3072 lds
MV 116,a,180,v,20
s_add_u32 m0, s36, 135168
MV 124,a,180,v,36
s_mov_b32 s37, 32768
MV 132,a,180,v,52
buffer_load_dwordx4 v245, s[32:35], s37 offen offset:0 lds
MV 140,a,180,v,68
ds_read_b128 a[180:183], v10 offset:13312
MV 116,a,184,v,24
s_mov_b32 s37, 39936
MV 124,a,184,v,40
buffer_load_dwordx4 v246, s[32:35], s37 offen offset:1024 lds
MV 132,a,184,v,56
s_mov_b32 s37, 47104
MV 140,a,184,v,72
ds_read_b128 a[184:187], v10 offset:14336
buffer_load_dwordx4 v245, s[32:35], s37 offen offset:2048 lds
MV 116,a,188,v,28
s_mov_b32 s37, 54272
MV 124,a,188,v,44
buffer_load_dwordx4 v246, s[32:35], s37 offen offset:3072 lds
MV 132,a,188,v,60
MV 140,a,188,v,76
ds_read_b128 a[188:191], v10 offset:15360
s_cmp_eq_u32 s70, 0
s_cbranch_scc1 L_p3_pmask
L_p3_pmask_ret:
v_exp_f32 v80, v80
v_exp_f32 v81, v81
v_exp_f32 v82, v82
v_add_f32 v2, v2, v80
v_add_f32 v2, v2, v81
v_exp_f32 v83, v83
v_cvt_pk_bf16_f32 v80, v80, v81
v_exp_f32 v84, v84
v_add_f32 v2, v2, v82
v_add_f32 v2, v2, v83
v_exp_f32 v85, v85
v_cvt_pk_bf16_f32 v81, v82, v83
v_exp_f32 v86, v86
v_add_f32 v2, v2, v84
v_add_f32 v2, v2, v85
v_exp_f32 v87, v87
v_cvt_pk_bf16_f32 v82, v84, v85
v_exp_f32 v88, v88
v_add_f32 v2, v2, v86
v_add_f32 v2, v2, v87
v_exp_f32 v89, v89
v_cvt_pk_bf16_f32 v83, v86, v87
v_exp_f32 v90, v90
v_add_f32 v3, v3, v88
v_add_f32 v3, v3, v89
v_exp_f32 v91, v91
v_cvt_pk_bf16_f32 v88, v88, v89
v_exp_f32 v92, v92
v_add_f32 v3, v3, v90
v_add_f32 v3, v3, v91
v_exp_f32 v93, v93
v_cvt_pk_bf16_f32 v89, v90, v91
v_exp_f32 v94, v94
v_add_f32 v3, v3, v92
v_add_f32 v3, v3, v93
v_exp_f32 v95, v95
v_cvt_pk_bf16_f32 v90, v92, v93
v_exp_f32 v96, v96
v_add_f32 v3, v3, v94
v_add_f32 v3, v3, v95
v_exp_f32 v97, v97
v_cvt_pk_bf16_f32 v91, v94, v95
v_exp_f32 v98, v98
v_add_f32 v4, v4, v96
v_add_f32 v4, v4, v97
v_exp_f32 v99, v99
v_cvt_pk_bf16_f32 v96, v96, v97
v_exp_f32 v100, v100
v_add_f32 v4, v4, v98
v_add_f32 v4, v4, v99
v_exp_f32 v101, v101
v_cvt_pk_bf16_f32 v97, v98, v99
v_exp_f32 v102, v102
v_add_f32 v4, v4, v100
v_add_f32 v4, v4, v101
v_exp_f32 v103, v103
v_cvt_pk_bf16_f32 v98, v100, v101
v_exp_f32 v104, v104
v_add_f32 v4, v4, v102
v_add_f32 v4, v4, v103
v_exp_f32 v105, v105
v_cvt_pk_bf16_f32 v99, v102, v103
v_exp_f32 v106, v106
v_add_f32 v5, v5, v104
v_add_f32 v5, v5, v105
v_exp_f32 v107, v107
v_cvt_pk_bf16_f32 v104, v104, v105
v_exp_f32 v108, v108
v_add_f32 v5, v5, v106
v_add_f32 v5, v5, v107
v_exp_f32 v109, v109
v_cvt_pk_bf16_f32 v105, v106, v107
v_exp_f32 v110, v110
v_add_f32 v5, v5, v108
v_add_f32 v5, v5, v109
v_exp_f32 v111, v111
v_cvt_pk_bf16_f32 v106, v108, v109
v_add_f32 v5, v5, v110
v_add_f32 v5, v5, v111
v_cvt_pk_bf16_f32 v107, v110, v111
s_sub_u32 s74, s70, 1
s_cbranch_scc1 L_p3_d0m_top
.p2align 5
L_p3_d0_top:
s_waitcnt lgkmcnt(0)
v_mfma_f32_16x16x32_bf16 v[144:147], a[128:131], v[16:19], 0
s_add_u32 m0, s73, 0
ds_read_b128 a[192:195], v11 offset:16384
v_mfma_f32_16x16x32_bf16 v[152:155], a[128:131], v[32:35], 0
v_exp_f32 v112, v112
v_mfma_f32_16x16x32_bf16 v[148:151], a[144:147], v[16:19], 0
ds_read_b128 a[196:199], v11 offset:17408
buffer_load_dwordx4 v12, s[56:59], s71 offen offset:0 sc1 lds
v_mfma_f32_16x16x32_bf16 v[156:159], a[144:147], v[32:35], 0
v_exp_f32 v113, v113
v_mfma_f32_16x16x32_bf16 v[176:179], a[160:163], v[16:19], 0
v_exp_f32 v114, v114
v_mfma_f32_16x16x32_bf16 v[184:187], a[160:163], v[32:35], 0
v_add_f32 v2, v2, v112
v_add_f32 v2, v2, v113
v_mfma_f32_16x16x32_bf16 v[180:183], a[176:179], v[16:19], 0
v_exp_f32 v115, v115
v_mfma_f32_16x16x32_bf16 v[188:191], a[176:179], v[32:35], 0
ds_read_b128 a[200:203], v11 offset:18432
v_cvt_pk_bf16_f32 v112, v112, v113
v_mfma_f32_16x16x32_bf16 v[196:199], a[176:179], v[48:51], 0
v_exp_f32 v116, v116
v_mfma_f32_16x16x32_bf16 v[204:207], a[176:179], v[64:67], 0
v_add_f32 v2, v2, v114
v_add_f32 v2, v2, v115
v_mfma_f32_16x16x32_bf16 v[192:195], a[160:163], v[48:51], 0
v_exp_f32 v117, v117
v_mfma_f32_16x16x32_bf16 v[200:203], a[160:163], v[64:67], 0
ds_read_b128 a[204:207], v11 offset:19456
v_cvt_pk_bf16_f32 v113, v114, v115
v_mfma_f32_16x16x32_bf16 v[164:167], a[144:147], v[48:51], 0
v_exp_f32 v118, v118
v_mfma_f32_16x16x32_bf16 v[172:175], a[144:147], v[64:67], 0
ds_read_b128 a[208:211], v11 offset:20480
v_add_f32 v2, v2, v116
v_mfma_f32_16x16x32_bf16 v[160:163], a[128:131], v[48:51], 0
buffer_load_dwordx4 v12, s[56:59], s71 offen offset:1024 sc1 lds
v_add_f32 v2, v2, v117
v_mfma_f32_16x16x32_bf16 v[168:171], a[128:131], v[64:67], 0
v_exp_f32 v119, v119
MV 180,a,180,v,20
ds_read_b128 a[212:215], v11 offset:21504
v_cvt_pk_bf16_f32 v114, v116, v117
MV 188,a,180,v,36
v_exp_f32 v120, v120
MV 176,a,164,v,20
v_add_f32 v2, v2, v118
v_add_f32 v2, v2, v119
MV 184,a,164,v,36
v_exp_f32 v121, v121
MV 148,a,148,v,20
ds_read_b128 a[216:219], v11 offset:22528
v_cvt_pk_bf16_f32 v115, v118, v119
MV 156,a,148,v,36
v_exp_f32 v122, v122
MV 144,a,132,v,20
v_add_f32 v3, v3, v120
v_add_f32 v3, v3, v121
MV 152,a,132,v,36
v_exp_f32 v123, v123
MV 160,a,132,v,52
ds_read_b128 a[220:223], v11 offset:23552
v_cvt_pk_bf16_f32 v120, v120, v121
MV 168,a,132,v,68
v_exp_f32 v124, v124
MV 164,a,148,v,52
ds_read_b128 a[224:227], v11 offset:24576
v_add_f32 v3, v3, v122
MV 172,a,148,v,68
buffer_load_dwordx4 v12, s[56:59], s71 offen offset:2048 sc1 lds
v_add_f32 v3, v3, v123
MV 192,a,164,v,52
v_exp_f32 v125, v125
MV 200,a,164,v,68
ds_read_b128 a[228:231], v11 offset:25600
v_cvt_pk_bf16_f32 v121, v122, v123
MV 196,a,180,v,52
v_exp_f32 v126, v126
MV 204,a,180,v,68
v_add_f32 v3, v3, v124
v_add_f32 v3, v3, v125
MV 144,a,136,v,24
v_exp_f32 v127, v127
MV 152,a,136,v,40
ds_read_b128 a[232:235], v11 offset:26624
v_cvt_pk_bf16_f32 v122, v124, v125
MV 148,a,152,v,24
v_exp_f32 v128, v128
MV 156,a,152,v,40
v_add_f32 v3, v3, v126
v_add_f32 v3, v3, v127
MV 176,a,168,v,24
v_exp_f32 v129, v129
MV 184,a,168,v,40
ds_read_b128 a[236:239], v11 offset:27648
v_cvt_pk_bf16_f32 v123, v126, v127
MV 180,a,184,v,24
v_exp_f32 v130, v130
MV 188,a,184,v,40
ds_read_b128 a[240:243], v11 offset:28672
v_add_f32 v4, v4, v128
MV 196,a,184,v,56
buffer_load_dwordx4 v12, s[56:59], s71 offen offset:3072 sc1 lds
v_add_f32 v4, v4, v129
MV 204,a,184,v,72
v_exp_f32 v131, v131
MV 192,a,168,v,56
ds_read_b128 a[244:247], v11 offset:29696
v_cvt_pk_bf16_f32 v128, v128, v129
MV 200,a,168,v,72
v_exp_f32 v132, v132
MV 164,a,152,v,56
v_add_f32 v4, v4, v130
v_add_f32 v4, v4, v131
MV 172,a,152,v,72
v_exp_f32 v133, v133
MV 160,a,136,v,56
ds_read_b128 a[248:251], v11 offset:30720
v_cvt_pk_bf16_f32 v129, v130, v131
MV 168,a,136,v,72
v_exp_f32 v134, v134
MV 180,a,188,v,28
v_add_f32 v4, v4, v132
v_add_f32 v4, v4, v133
MV 188,a,188,v,44
v_exp_f32 v135, v135
MV 176,a,172,v,28
ds_read_b128 a[252:255], v11 offset:31744
v_cvt_pk_bf16_f32 v130, v132, v133
MV 184,a,172,v,44
v_exp_f32 v136, v136
MV 148,a,156,v,28
v_add_f32 v4, v4, v134
v_add_f32 v4, v4, v135
MV 156,a,156,v,44
v_exp_f32 v137, v137
MV 144,a,140,v,28
s_add_u32 s71, s71, 16384
v_cvt_pk_bf16_f32 v131, v134, v135
MV 152,a,140,v,44
v_exp_f32 v138, v138
MV 160,a,140,v,60
v_add_f32 v5, v5, v136
v_add_f32 v5, v5, v137
MV 168,a,140,v,76
v_exp_f32 v139, v139
MV 164,a,156,v,60
v_cvt_pk_bf16_f32 v136, v136, v137
MV 172,a,156,v,76
v_exp_f32 v140, v140
MV 192,a,172,v,60
v_add_f32 v5, v5, v138
v_add_f32 v5, v5, v139
MV 200,a,172,v,76
v_exp_f32 v141, v141
MV 196,a,188,v,60
v_cvt_pk_bf16_f32 v137, v138, v139
MV 204,a,188,v,76
v_exp_f32 v142, v142
v_add_f32 v5, v5, v140
v_add_f32 v5, v5, v141
v_exp_f32 v143, v143
v_cvt_pk_bf16_f32 v138, v140, v141
v_add_f32 v5, v5, v142
v_add_f32 v5, v5, v143
v_cvt_pk_bf16_f32 v139, v142, v143
s_waitcnt vmcnt(16) lgkmcnt(0)
MA 0,a,192,v,80
s_barrier
MA 32,a,192,v,88
s_add_u32 m0, s72, 0
ds_read_b128 a[128:131], v10 offset:16384
MA 4,a,196,v,80
ds_read_b128 a[132:135], v10 offset:17408
buffer_load_dwordx4 v12, s[52:55], s71 offen offset:0 sc1 lds
MA 36,a,196,v,88
v_exp_f32 v144, v144
MA 8,a,200,v,80
v_exp_f32 v145, v145
MA 40,a,200,v,88
v_exp_f32 v146, v146
MA 12,a,204,v,80
v_add_f32 v2, v2, v144
v_add_f32 v2, v2, v145
MA 44,a,204,v,88
ds_read_b128 a[136:139], v10 offset:18432
ds_read_b128 a[140:143], v10 offset:19456
MA 16,a,208,v,80
v_exp_f32 v147, v147
MA 48,a,208,v,88
ds_read_b128 a[144:147], v10 offset:20480
v_cvt_pk_bf16_f32 v144, v144, v145
MA 20,a,212,v,80
v_exp_f32 v148, v148
MA 52,a,212,v,88
v_add_f32 v2, v2, v146
v_add_f32 v2, v2, v147
MA 24,a,216,v,80
v_exp_f32 v149, v149
MA 56,a,216,v,88
buffer_load_dwordx4 v12, s[52:55], s71 offen offset:1024 sc1 lds
v_cvt_pk_bf16_f32 v145, v146, v147
MA 28,a,220,v,80
v_exp_f32 v150, v150
MA 60,a,220,v,88
v_add_f32 v2, v2, v148
v_add_f32 v2, v2, v149
MA 92,a,220,v,96
v_exp_f32 v151, v151
MA 124,a,220,v,104
ds_read_b128 a[148:151], v10 offset:21504
v_cvt_pk_bf16_f32 v146, v148, v149
MA 88,a,216,v,96
v_exp_f32 v152, v152
MA 120,a,216,v,104
v_add_f32 v2, v2, v150
v_add_f32 v2, v2, v151
MA 84,a,212,v,96
ds_read_b128 a[152:155], v10 offset:22528
ds_read_b128 a[156:159], v10 offset:23552
MA 116,a,212,v,104
v_exp_f32 v153, v153
MA 80,a,208,v,96
ds_read_b128 a[160:163], v10 offset:24576
v_cvt_pk_bf16_f32 v147, v150, v151
MA 112,a,208,v,104
v_exp_f32 v154, v154
MA 76,a,204,v,96
v_add_f32 v3, v3, v152
v_add_f32 v3, v3, v153
MA 108,a,204,v,104
v_exp_f32 v155, v155
MA 72,a,200,v,96
buffer_load_dwordx4 v12, s[52:55], s71 offen offset:2048 sc1 lds
v_cvt_pk_bf16_f32 v152, v152, v153
MA 104,a,200,v,104
v_exp_f32 v156, v156
MA 68,a,196,v,96
v_add_f32 v3, v3, v154
v_add_f32 v3, v3, v155
MA 100,a,196,v,104
v_exp_f32 v157, v157
MA 64,a,192,v,96
ds_read_b128 a[164:167], v10 offset:25600
v_cvt_pk_bf16_f32 v153, v154, v155
MA 96,a,192,v,104
v_exp_f32 v158, v158
MA 0,a,224,v,112
v_add_f32 v3, v3, v156
v_add_f32 v3, v3, v157
MA 32,a,224,v,120
v_exp_f32 v159, v159
MA 4,a,228,v,112
ds_read_b128 a[168:171], v10 offset:26624
v_cvt_pk_bf16_f32 v154, v156, v157
MA 36,a,228,v,120
v_exp_f32 v160, v160
MA 8,a,232,v,112
ds_read_b128 a[172:175], v10 offset:27648
v_add_f32 v3, v3, v158
MA 40,a,232,v,120
ds_read_b128 a[176:179], v10 offset:28672
v_add_f32 v3, v3, v159
MA 12,a,236,v,112
v_exp_f32 v161, v161
MA 44,a,236,v,120
ds_read_b128 a[180:183], v10 offset:29696
v_cvt_pk_bf16_f32 v155, v158, v159
MA 16,a,240,v,112
v_exp_f32 v162, v162
MA 48,a,240,v,120
v_add_f32 v4, v4, v160
v_add_f32 v4, v4, v161
MA 20,a,244,v,112
v_exp_f32 v163, v163
MA 52,a,244,v,120
buffer_load_dwordx4 v12, s[52:55], s71 offen offset:3072 sc1 lds
v_cvt_pk_bf16_f32 v160, v160, v161
MA 24,a,248,v,112
v_exp_f32 v164, v164
MA 56,a,248,v,120
v_add_f32 v4, v4, v162
v_add_f32 v4, v4, v163
MA 28,a,252,v,112
v_exp_f32 v165, v165
MA 60,a,252,v,120
ds_read_b128 a[184:187], v10 offset:30720
v_cvt_pk_bf16_f32 v161, v162, v163
MA 92,a,252,v,128
v_exp_f32 v166, v166
MA 124,a,252,v,136
v_add_f32 v4, v4, v164
v_add_f32 v4, v4, v165
MA 88,a,248,v,128
ds_read_b128 a[188:191], v10 offset:31744
s_sub_u32 s74, s74, 1
MA 120,a,248,v,136
v_exp_f32 v167, v167
MA 84,a,244,v,128
v_cvt_pk_bf16_f32 v162, v164, v165
MA 116,a,244,v,136
v_exp_f32 v168, v168
MA 80,a,240,v,128
v_add_f32 v4, v4, v166
v_add_f32 v4, v4, v167
MA 112,a,240,v,136
v_exp_f32 v169, v169
MA 76,a,236,v,128
v_cvt_pk_bf16_f32 v163, v166, v167
MA 108,a,236,v,136
v_exp_f32 v170, v170
MA 72,a,232,v,128
v_add_f32 v5, v5, v168
v_add_f32 v5, v5, v169
MA 104,a,232,v,136
v_exp_f32 v171, v171
MA 68,a,228,v,128
v_cvt_pk_bf16_f32 v168, v168, v169
MA 100,a,228,v,136
v_exp_f32 v172, v172
MA 64,a,224,v,128
v_add_f32 v5, v5, v170
v_add_f32 v5, v5, v171
MA 96,a,224,v,136
v_exp_f32 v173, v173
v_cvt_pk_bf16_f32 v169, v170, v171
v_exp_f32 v174, v174
v_add_f32 v5, v5, v172
v_add_f32 v5, v5, v173
v_exp_f32 v175, v175
v_cvt_pk_bf16_f32 v170, v172, v173
v_add_f32 v5, v5, v174
v_add_f32 v5, v5, v175
v_cvt_pk_bf16_f32 v171, v174, v175
s_cbranch_scc1 L_p3_d1m_top
s_waitcnt lgkmcnt(0)
v_xor_b32 v11, 0x8000, v11
v_mfma_f32_16x16x32_bf16 v[80:83], a[128:131], v[16:19], 0
s_add_u32 m0, s73, 16384
ds_read_b128 a[192:195], v11 offset:0
v_mfma_f32_16x16x32_bf16 v[88:91], a[128:131], v[32:35], 0
v_exp_f32 v176, v176
v_mfma_f32_16x16x32_bf16 v[84:87], a[144:147], v[16:19], 0
ds_read_b128 a[196:199], v11 offset:1024
buffer_load_dwordx4 v12, s[56:59], s71 offen offset:0 sc1 lds
v_mfma_f32_16x16x32_bf16 v[92:95], a[144:147], v[32:35], 0
v_exp_f32 v177, v177
v_mfma_f32_16x16x32_bf16 v[112:115], a[160:163], v[16:19], 0
v_exp_f32 v178, v178
v_mfma_f32_16x16x32_bf16 v[120:123], a[160:163], v[32:35], 0
v_add_f32 v2, v2, v176
v_add_f32 v2, v2, v177
v_mfma_f32_16x16x32_bf16 v[116:119], a[176:179], v[16:19], 0
v_exp_f32 v179, v179
v_mfma_f32_16x16x32_bf16 v[124:127], a[176:179], v[32:35], 0
ds_read_b128 a[200:203], v11 offset:2048
v_cvt_pk_bf16_f32 v176, v176, v177
v_mfma_f32_16x16x32_bf16 v[132:135], a[176:179], v[48:51], 0
v_exp_f32 v180, v180
v_mfma_f32_16x16x32_bf16 v[140:143], a[176:179], v[64:67], 0
v_add_f32 v2, v2, v178
v_add_f32 v2, v2, v179
v_mfma_f32_16x16x32_bf16 v[128:131], a[160:163], v[48:51], 0
v_exp_f32 v181, v181
v_mfma_f32_16x16x32_bf16 v[136:139], a[160:163], v[64:67], 0
ds_read_b128 a[204:207], v11 offset:3072
v_cvt_pk_bf16_f32 v177, v178, v179
v_mfma_f32_16x16x32_bf16 v[100:103], a[144:147], v[48:51], 0
v_exp_f32 v182, v182
v_mfma_f32_16x16x32_bf16 v[108:111], a[144:147], v[64:67], 0
buffer_load_dwordx4 v12, s[56:59], s71 offen offset:1024 sc1 lds
v_add_f32 v2, v2, v180
v_mfma_f32_16x16x32_bf16 v[96:99], a[128:131], v[48:51], 0
ds_read_b128 a[208:211], v11 offset:4096
v_add_f32 v2, v2, v181
v_mfma_f32_16x16x32_bf16 v[104:107], a[128:131], v[64:67], 0
v_exp_f32 v183, v183
MV 116,a,180,v,20
ds_read_b128 a[212:215], v11 offset:5120
v_cvt_pk_bf16_f32 v178, v180, v181
MV 124,a,180,v,36
v_exp_f32 v184, v184
MV 112,a,164,v,20
v_add_f32 v2, v2, v182
v_add_f32 v2, v2, v183
MV 120,a,164,v,36
v_exp_f32 v185, v185
MV 84,a,148,v,20
ds_read_b128 a[216:219], v11 offset:6144
v_cvt_pk_bf16_f32 v179, v182, v183
MV 92,a,148,v,36
v_exp_f32 v186, v186
MV 80,a,132,v,20
v_add_f32 v3, v3, v184
v_add_f32 v3, v3, v185
MV 88,a,132,v,36
v_exp_f32 v187, v187
MV 96,a,132,v,52
ds_read_b128 a[220:223], v11 offset:7168
v_cvt_pk_bf16_f32 v184, v184, v185
MV 104,a,132,v,68
ds_read_b128 a[224:227], v11 offset:8192
buffer_load_dwordx4 v12, s[56:59], s71 offen offset:2048 sc1 lds
MV 100,a,148,v,52
v_exp_f32 v188, v188
MV 108,a,148,v,68
v_add_f32 v3, v3, v186
v_add_f32 v3, v3, v187
MV 128,a,164,v,52
v_exp_f32 v189, v189
MV 136,a,164,v,68
ds_read_b128 a[228:231], v11 offset:9216
v_cvt_pk_bf16_f32 v185, v186, v187
MV 132,a,180,v,52
v_exp_f32 v190, v190
MV 140,a,180,v,68
v_add_f32 v3, v3, v188
v_add_f32 v3, v3, v189
MV 80,a,136,v,24
v_exp_f32 v191, v191
MV 88,a,136,v,40
ds_read_b128 a[232:235], v11 offset:10240
v_cvt_pk_bf16_f32 v186, v188, v189
MV 84,a,152,v,24
v_exp_f32 v192, v192
MV 92,a,152,v,40
buffer_load_dwordx4 v12, s[56:59], s71 offen offset:3072 sc1 lds
v_add_f32 v3, v3, v190
MV 112,a,168,v,24
ds_read_b128 a[236:239], v11 offset:11264
v_add_f32 v3, v3, v191
MV 120,a,168,v,40
v_exp_f32 v193, v193
MV 116,a,184,v,24
ds_read_b128 a[240:243], v11 offset:12288
v_cvt_pk_bf16_f32 v187, v190, v191
MV 124,a,184,v,40
v_exp_f32 v194, v194
MV 132,a,184,v,56
v_add_f32 v4, v4, v192
v_add_f32 v4, v4, v193
MV 140,a,184,v,72
v_exp_f32 v195, v195
MV 128,a,168,v,56
ds_read_b128 a[244:247], v11 offset:13312
v_cvt_pk_bf16_f32 v192, v192, v193
MV 136,a,168,v,72
v_exp_f32 v196, v196
MV 100,a,152,v,56
v_add_f32 v4, v4, v194
v_add_f32 v4, v4, v195
MV 108,a,152,v,72
v_exp_f32 v197, v197
MV 96,a,136,v,56
ds_read_b128 a[248:251], v11 offset:14336
v_cvt_pk_bf16_f32 v193, v194, v195
MV 104,a,136,v,72
v_exp_f32 v198, v198
MV 116,a,188,v,28
s_add_u32 s71, s71, 16384
v_add_f32 v4, v4, v196
MV 124,a,188,v,44
ds_read_b128 a[252:255], v11 offset:15360
v_add_f32 v4, v4, v197
MV 112,a,172,v,28
v_exp_f32 v199, v199
MV 120,a,172,v,44
s_xor_b32 s73, s73, 0x8000
v_cvt_pk_bf16_f32 v194, v196, v197
MV 84,a,156,v,28
v_exp_f32 v200, v200
MV 92,a,156,v,44
v_add_f32 v4, v4, v198
v_add_f32 v4, v4, v199
MV 80,a,140,v,28
v_exp_f32 v201, v201
MV 88,a,140,v,44
v_cvt_pk_bf16_f32 v195, v198, v199
MV 96,a,140,v,60
v_exp_f32 v202, v202
MV 104,a,140,v,76
v_add_f32 v5, v5, v200
v_add_f32 v5, v5, v201
MV 100,a,156,v,60
v_exp_f32 v203, v203
MV 108,a,156,v,76
v_cvt_pk_bf16_f32 v200, v200, v201
MV 128,a,172,v,60
v_exp_f32 v204, v204
MV 136,a,172,v,76
v_add_f32 v5, v5, v202
v_add_f32 v5, v5, v203
MV 132,a,188,v,60
v_exp_f32 v205, v205
MV 140,a,188,v,76
v_cvt_pk_bf16_f32 v201, v202, v203
v_exp_f32 v206, v206
v_add_f32 v5, v5, v204
v_add_f32 v5, v5, v205
v_exp_f32 v207, v207
v_cvt_pk_bf16_f32 v202, v204, v205
v_add_f32 v5, v5, v206
v_add_f32 v5, v5, v207
v_cvt_pk_bf16_f32 v203, v206, v207
s_waitcnt vmcnt(16) lgkmcnt(0)
MA 0,a,192,v,144
s_barrier
v_xor_b32 v10, 0x8000, v10
MA 32,a,192,v,152
s_add_u32 m0, s72, 16384
ds_read_b128 a[128:131], v10 offset:0
MA 4,a,196,v,144
ds_read_b128 a[132:135], v10 offset:1024
buffer_load_dwordx4 v12, s[52:55], s71 offen offset:0 sc1 lds
MA 36,a,196,v,152
v_exp_f32 v80, v80
MA 8,a,200,v,144
v_exp_f32 v81, v81
MA 40,a,200,v,152
v_exp_f32 v82, v82
MA 12,a,204,v,144
v_add_f32 v2, v2, v80
v_add_f32 v2, v2, v81
MA 44,a,204,v,152
ds_read_b128 a[136:139], v10 offset:2048
ds_read_b128 a[140:143], v10 offset:3072
MA 16,a,208,v,144
v_exp_f32 v83, v83
MA 48,a,208,v,152
ds_read_b128 a[144:147], v10 offset:4096
v_cvt_pk_bf16_f32 v80, v80, v81
MA 20,a,212,v,144
v_exp_f32 v84, v84
MA 52,a,212,v,152
v_add_f32 v2, v2, v82
v_add_f32 v2, v2, v83
MA 24,a,216,v,144
v_exp_f32 v85, v85
MA 56,a,216,v,152
buffer_load_dwordx4 v12, s[52:55], s71 offen offset:1024 sc1 lds
v_cvt_pk_bf16_f32 v81, v82, v83
MA 28,a,220,v,144
v_exp_f32 v86, v86
MA 60,a,220,v,152
v_add_f32 v2, v2, v84
v_add_f32 v2, v2, v85
MA 92,a,220,v,160
v_exp_f32 v87, v87
MA 124,a,220,v,168
ds_read_b128 a[148:151], v10 offset:5120
v_cvt_pk_bf16_f32 v82, v84, v85
MA 88,a,216,v,160
v_exp_f32 v88, v88
MA 120,a,216,v,168
v_add_f32 v2, v2, v86
v_add_f32 v2, v2, v87
MA 84,a,212,v,160
ds_read_b128 a[152:155], v10 offset:6144
ds_read_b128 a[156:159], v10 offset:7168
MA 116,a,212,v,168
v_exp_f32 v89, v89
MA 80,a,208,v,160
ds_read_b128 a[160:163], v10 offset:8192
v_cvt_pk_bf16_f32 v83, v86, v87
MA 112,a,208,v,168
v_exp_f32 v90, v90
MA 76,a,204,v,160
v_add_f32 v3, v3, v88
v_add_f32 v3, v3, v89
MA 108,a,204,v,168
v_exp_f32 v91, v91
MA 72,a,200,v,160
buffer_load_dwordx4 v12, s[52:55], s71 offen offset:2048 sc1 lds
v_cvt_pk_bf16_f32 v88, v88, v89
MA 104,a,200,v,168
v_exp_f32 v92, v92
MA 68,a,196,v,160
v_add_f32 v3, v3, v90
v_add_f32 v3, v3, v91
MA 100,a,196,v,168
v_exp_f32 v93, v93
MA 64,a,192,v,160
ds_read_b128 a[164:167], v10 offset:9216
v_cvt_pk_bf16_f32 v89, v90, v91
MA 96,a,192,v,168
v_exp_f32 v94, v94
MA 0,a,224,v,176
v_add_f32 v3, v3, v92
v_add_f32 v3, v3, v93
MA 32,a,224,v,184
v_exp_f32 v95, v95
MA 4,a,228,v,176
ds_read_b128 a[168:171], v10 offset:10240
v_cvt_pk_bf16_f32 v90, v92, v93
MA 36,a,228,v,184
v_exp_f32 v96, v96
MA 8,a,232,v,176
ds_read_b128 a[172:175], v10 offset:11264
v_add_f32 v3, v3, v94
MA 40,a,232,v,184
ds_read_b128 a[176:179], v10 offset:12288
v_add_f32 v3, v3, v95
MA 12,a,236,v,176
v_exp_f32 v97, v97
MA 44,a,236,v,184
ds_read_b128 a[180:183], v10 offset:13312
v_cvt_pk_bf16_f32 v91, v94, v95
MA 16,a,240,v,176
v_exp_f32 v98, v98
MA 48,a,240,v,184
v_add_f32 v4, v4, v96
v_add_f32 v4, v4, v97
MA 20,a,244,v,176
v_exp_f32 v99, v99
MA 52,a,244,v,184
buffer_load_dwordx4 v12, s[52:55], s71 offen offset:3072 sc1 lds
v_cvt_pk_bf16_f32 v96, v96, v97
MA 24,a,248,v,176
v_exp_f32 v100, v100
MA 56,a,248,v,184
v_add_f32 v4, v4, v98
v_add_f32 v4, v4, v99
MA 28,a,252,v,176
v_exp_f32 v101, v101
MA 60,a,252,v,184
ds_read_b128 a[184:187], v10 offset:14336
v_cvt_pk_bf16_f32 v97, v98, v99
MA 92,a,252,v,192
v_exp_f32 v102, v102
MA 124,a,252,v,200
v_add_f32 v4, v4, v100
v_add_f32 v4, v4, v101
MA 88,a,248,v,192
ds_read_b128 a[188:191], v10 offset:15360
s_xor_b32 s72, s72, 0x8000
MA 120,a,248,v,200
v_exp_f32 v103, v103
MA 84,a,244,v,192
v_cvt_pk_bf16_f32 v98, v100, v101
MA 116,a,244,v,200
v_exp_f32 v104, v104
MA 80,a,240,v,192
v_add_f32 v4, v4, v102
v_add_f32 v4, v4, v103
MA 112,a,240,v,200
v_exp_f32 v105, v105
MA 76,a,236,v,192
v_cvt_pk_bf16_f32 v99, v102, v103
MA 108,a,236,v,200
v_exp_f32 v106, v106
MA 72,a,232,v,192
v_add_f32 v5, v5, v104
v_add_f32 v5, v5, v105
MA 104,a,232,v,200
v_exp_f32 v107, v107
MA 68,a,228,v,192
v_cvt_pk_bf16_f32 v104, v104, v105
MA 100,a,228,v,200
v_exp_f32 v108, v108
MA 64,a,224,v,192
v_add_f32 v5, v5, v106
v_add_f32 v5, v5, v107
MA 96,a,224,v,200
v_exp_f32 v109, v109
v_cvt_pk_bf16_f32 v105, v106, v107
v_exp_f32 v110, v110
v_add_f32 v5, v5, v108
v_add_f32 v5, v5, v109
v_exp_f32 v111, v111
v_cvt_pk_bf16_f32 v106, v108, v109
v_add_f32 v5, v5, v110
v_add_f32 v5, v5, v111
v_cvt_pk_bf16_f32 v107, v110, v111
s_branch L_p3_d0_top
L_p3_d1m_top:
s_waitcnt lgkmcnt(0)
v_xor_b32 v11, 0x8000, v11
v_mfma_f32_16x16x32_bf16 v[80:83], a[128:131], v[16:19], 0
s_add_u32 m0, s73, 16384
ds_read_b128 a[192:195], v11 offset:0
v_mfma_f32_16x16x32_bf16 v[88:91], a[128:131], v[32:35], 0
v_exp_f32 v176, v176
v_mfma_f32_16x16x32_bf16 v[96:99], a[128:131], v[48:51], 0
ds_read_b128 a[196:199], v11 offset:1024
buffer_load_dwordx4 v12, s[56:59], s71 offen offset:0 sc1 lds
v_mfma_f32_16x16x32_bf16 v[104:107], a[128:131], v[64:67], 0
v_exp_f32 v177, v177
MV 80,a,132,v,20
v_exp_f32 v178, v178
MV 88,a,132,v,36
v_add_f32 v2, v2, v176
v_add_f32 v2, v2, v177
MV 96,a,132,v,52
v_exp_f32 v179, v179
MV 104,a,132,v,68
ds_read_b128 a[200:203], v11 offset:2048
v_cvt_pk_bf16_f32 v176, v176, v177
MV 80,a,136,v,24
v_exp_f32 v180, v180
MV 88,a,136,v,40
v_add_f32 v2, v2, v178
v_add_f32 v2, v2, v179
MV 96,a,136,v,56
v_exp_f32 v181, v181
MV 104,a,136,v,72
ds_read_b128 a[204:207], v11 offset:3072
v_cvt_pk_bf16_f32 v177, v178, v179
MV 80,a,140,v,28
v_exp_f32 v182, v182
MV 88,a,140,v,44
buffer_load_dwordx4 v12, s[56:59], s71 offen offset:1024 sc1 lds
v_add_f32 v2, v2, v180
MV 96,a,140,v,60
ds_read_b128 a[208:211], v11 offset:4096
v_add_f32 v2, v2, v181
MV 104,a,140,v,76
v_exp_f32 v183, v183
v_mfma_f32_16x16x32_bf16 v[84:87], a[144:147], v[16:19], 0
ds_read_b128 a[212:215], v11 offset:5120
v_cvt_pk_bf16_f32 v178, v180, v181
v_mfma_f32_16x16x32_bf16 v[92:95], a[144:147], v[32:35], 0
v_exp_f32 v184, v184
v_mfma_f32_16x16x32_bf16 v[100:103], a[144:147], v[48:51], 0
v_add_f32 v2, v2, v182
v_add_f32 v2, v2, v183
v_mfma_f32_16x16x32_bf16 v[108:111], a[144:147], v[64:67], 0
v_exp_f32 v185, v185
MV 84,a,148,v,20
ds_read_b128 a[216:219], v11 offset:6144
v_cvt_pk_bf16_f32 v179, v182, v183
MV 92,a,148,v,36
v_exp_f32 v186, v186
MV 100,a,148,v,52
v_add_f32 v3, v3, v184
v_add_f32 v3, v3, v185
MV 108,a,148,v,68
v_exp_f32 v187, v187
MV 84,a,152,v,24
ds_read_b128 a[220:223], v11 offset:7168
v_cvt_pk_bf16_f32 v184, v184, v185
MV 92,a,152,v,40
ds_read_b128 a[224:227], v11 offset:8192
buffer_load_dwordx4 v12, s[56:59], s71 offen offset:2048 sc1 lds
MV 100,a,152,v,56
v_exp_f32 v188, v188
MV 108,a,152,v,72
v_add_f32 v3, v3, v186
v_add_f32 v3, v3, v187
MV 84,a,156,v,28
v_exp_f32 v189, v189
MV 92,a,156,v,44
ds_read_b128 a[228:231], v11 offset:9216
v_cvt_pk_bf16_f32 v185, v186, v187
MV 100,a,156,v,60
v_exp_f32 v190, v190
MV 108,a,156,v,76
v_add_f32 v3, v3, v188
v_add_f32 v3, v3, v189
v_mfma_f32_16x16x32_bf16 v[112:115], a[160:163], v[16:19], 0
v_exp_f32 v191, v191
v_mfma_f32_16x16x32_bf16 v[120:123], a[160:163], v[32:35], 0
ds_read_b128 a[232:235], v11 offset:10240
v_cvt_pk_bf16_f32 v186, v188, v189
v_mfma_f32_16x16x32_bf16 v[128:131], a[160:163], v[48:51], 0
v_exp_f32 v192, v192
v_mfma_f32_16x16x32_bf16 v[136:139], a[160:163], v[64:67], 0
buffer_load_dwordx4 v12, s[56:59], s71 offen offset:3072 sc1 lds
v_add_f32 v3, v3, v190
MV 112,a,164,v,20
ds_read_b128 a[236:239], v11 offset:11264
v_add_f32 v3, v3, v191
MV 120,a,164,v,36
v_exp_f32 v193, v193
MV 128,a,164,v,52
ds_read_b128 a[240:243], v11 offset:12288
v_cvt_pk_bf16_f32 v187, v190, v191
MV 136,a,164,v,68
v_exp_f32 v194, v194
MV 112,a,168,v,24
v_add_f32 v4, v4, v192
v_add_f32 v4, v4, v193
MV 120,a,168,v,40
v_exp_f32 v195, v195
MV 128,a,168,v,56
v_cvt_pk_bf16_f32 v192, v192, v193
v_add_u32 v246, 0, v13
MV 136,a,168,v,72
v_exp_f32 v196, v196
MV 112,a,172,v,28
ds_read_b128 a[244:247], v11 offset:13312
v_add_f32 v4, v4, v194
MV 120,a,172,v,44
v_add_f32 v4, v4, v195
v_cmp_gt_i32_e64 s[84:85], 0, v246
MV 128,a,172,v,60
ds_read_b128 a[248:251], v11 offset:14336
v_cmp_gt_i32_e64 s[86:87], 1, v246
MV 136,a,172,v,76
v_exp_f32 v197, v197
v_mfma_f32_16x16x32_bf16 v[116:119], a[176:179], v[16:19], 0
v_cvt_pk_bf16_f32 v193, v194, v195
v_cmp_gt_i32_e64 s[88:89], 2, v246
v_mfma_f32_16x16x32_bf16 v[124:127], a[176:179], v[32:35], 0
v_exp_f32 v198, v198
v_mfma_f32_16x16x32_bf16 v[132:135], a[176:179], v[48:51], 0
s_add_u32 s71, s71, 16384
v_add_f32 v4, v4, v196
v_mfma_f32_16x16x32_bf16 v[140:143], a[176:179], v[64:67], 0
v_add_f32 v4, v4, v197
v_cmp_gt_i32_e64 s[90:91], 3, v246
MV 116,a,180,v,20
v_exp_f32 v199, v199
MV 124,a,180,v,36
ds_read_b128 a[252:255], v11 offset:15360
v_cvt_pk_bf16_f32 v194, v196, v197
MV 132,a,180,v,52
v_cndmask_b32_e64 v96, v96, v14, s[84:85]
v_cndmask_b32_e64 v97, v97, v14, s[86:87]
MV 140,a,180,v,68
v_exp_f32 v200, v200
MV 116,a,184,v,24
v_add_f32 v4, v4, v198
v_add_f32 v4, v4, v199
MV 124,a,184,v,40
v_cndmask_b32_e64 v98, v98, v14, s[88:89]
v_cndmask_b32_e64 v99, v99, v14, s[90:91]
MV 132,a,184,v,56
v_exp_f32 v201, v201
MV 140,a,184,v,72
v_cvt_pk_bf16_f32 v195, v198, v199
v_add_u32 v247, -16, v13
MV 116,a,188,v,28
v_exp_f32 v202, v202
MV 124,a,188,v,44
v_add_f32 v5, v5, v200
v_add_f32 v5, v5, v201
MV 132,a,188,v,60
s_xor_b32 s73, s73, 0x8000
v_cmp_gt_i32_e64 s[92:93], 0, v247
MV 140,a,188,v,76
v_exp_f32 v203, v203
v_cvt_pk_bf16_f32 v200, v200, v201
v_cmp_gt_i32_e64 s[94:95], 1, v247
v_exp_f32 v204, v204
v_add_f32 v5, v5, v202
v_cmp_gt_i32_e64 s[96:97], 2, v247
v_add_f32 v5, v5, v203
v_exp_f32 v205, v205
v_cmp_gt_i32_e64 s[98:99], 3, v247
v_cvt_pk_bf16_f32 v201, v202, v203
v_exp_f32 v206, v206
v_cndmask_b32_e64 v100, v100, v14, s[92:93]
v_add_f32 v5, v5, v204
v_cndmask_b32_e64 v101, v101, v14, s[94:95]
v_add_f32 v5, v5, v205
v_exp_f32 v207, v207
v_cvt_pk_bf16_f32 v202, v204, v205
v_cndmask_b32_e64 v102, v102, v14, s[96:97]
v_add_f32 v5, v5, v206
v_add_f32 v5, v5, v207
v_cndmask_b32_e64 v103, v103, v14, s[98:99]
v_cvt_pk_bf16_f32 v203, v206, v207
s_waitcnt vmcnt(16) lgkmcnt(0)
MA 0,a,192,v,144
s_barrier
v_xor_b32 v10, 0x8000, v10
MA 32,a,192,v,152
s_add_u32 m0, s72, 16384
ds_read_b128 a[128:131], v10 offset:0
MA 4,a,196,v,144
ds_read_b128 a[132:135], v10 offset:1024
buffer_load_dwordx4 v12, s[52:55], s71 offen offset:0 sc1 lds
MA 36,a,196,v,152
v_exp_f32 v80, v80
MA 8,a,200,v,144
v_exp_f32 v81, v81
MA 40,a,200,v,152
v_exp_f32 v82, v82
MA 12,a,204,v,144
v_add_f32 v2, v2, v80
v_add_f32 v2, v2, v81
MA 44,a,204,v,152
ds_read_b128 a[136:139], v10 offset:2048
v_add_u32 v246, -32, v13
MA 16,a,208,v,144
v_exp_f32 v83, v83
MA 48,a,208,v,152
ds_read_b128 a[140:143], v10 offset:3072
v_cvt_pk_bf16_f32 v80, v80, v81
MA 20,a,212,v,144
v_exp_f32 v84, v84
MA 52,a,212,v,152
v_add_f32 v2, v2, v82
v_add_f32 v2, v2, v83
MA 24,a,216,v,144
ds_read_b128 a[144:147], v10 offset:4096
v_cmp_gt_i32_e64 s[84:85], 0, v246
MA 56,a,216,v,152
v_exp_f32 v85, v85
MA 28,a,220,v,144
v_cvt_pk_bf16_f32 v81, v82, v83
v_cmp_gt_i32_e64 s[86:87], 1, v246
MA 60,a,220,v,152
v_exp_f32 v86, v86
MA 92,a,220,v,160
v_add_f32 v2, v2, v84
v_add_f32 v2, v2, v85
MA 124,a,220,v,168
ds_read_b128 a[148:151], v10 offset:5120
buffer_load_dwordx4 v12, s[52:55], s71 offen offset:1024 sc1 lds
MA 88,a,216,v,160
v_exp_f32 v87, v87
MA 120,a,216,v,168
v_cvt_pk_bf16_f32 v82, v84, v85
v_cmp_gt_i32_e64 s[88:89], 2, v246
MA 84,a,212,v,160
v_exp_f32 v88, v88
MA 116,a,212,v,168
v_add_f32 v2, v2, v86
v_add_f32 v2, v2, v87
MA 80,a,208,v,160
ds_read_b128 a[152:155], v10 offset:6144
v_cmp_gt_i32_e64 s[90:91], 3, v246
MA 112,a,208,v,168
v_exp_f32 v89, v89
MA 76,a,204,v,160
ds_read_b128 a[156:159], v10 offset:7168
v_cvt_pk_bf16_f32 v83, v86, v87
MA 108,a,204,v,168
v_exp_f32 v90, v90
MA 72,a,200,v,160
v_add_f32 v3, v3, v88
v_add_f32 v3, v3, v89
MA 104,a,200,v,168
v_exp_f32 v91, v91
MA 68,a,196,v,160
v_cvt_pk_bf16_f32 v88, v88, v89
v_cndmask_b32_e64 v128, v128, v14, s[84:85]
MA 100,a,196,v,168
v_exp_f32 v92, v92
MA 64,a,192,v,160
ds_read_b128 a[160:163], v10 offset:8192
v_add_f32 v3, v3, v90
MA 96,a,192,v,168
v_add_f32 v3, v3, v91
v_cndmask_b32_e64 v129, v129, v14, s[86:87]
MA 0,a,224,v,176
v_exp_f32 v93, v93
MA 32,a,224,v,184
buffer_load_dwordx4 v12, s[52:55], s71 offen offset:2048 sc1 lds
v_cvt_pk_bf16_f32 v89, v90, v91
MA 4,a,228,v,176
ds_read_b128 a[164:167], v10 offset:9216
v_cndmask_b32_e64 v130, v130, v14, s[88:89]
MA 36,a,228,v,184
v_exp_f32 v94, v94
MA 8,a,232,v,176
v_add_f32 v3, v3, v92
v_add_f32 v3, v3, v93
MA 40,a,232,v,184
v_exp_f32 v95, v95
MA 12,a,236,v,176
ds_read_b128 a[168:171], v10 offset:10240
v_cvt_pk_bf16_f32 v90, v92, v93
MA 44,a,236,v,184
ds_read_b128 a[172:175], v10 offset:11264
v_cndmask_b32_e64 v131, v131, v14, s[90:91]
MA 16,a,240,v,176
v_exp_f32 v96, v96
MA 48,a,240,v,184
v_add_f32 v3, v3, v94
v_add_f32 v3, v3, v95
MA 20,a,244,v,176
v_exp_f32 v97, v97
MA 52,a,244,v,184
v_cvt_pk_bf16_f32 v91, v94, v95
v_add_u32 v247, -48, v13
MA 24,a,248,v,176
v_exp_f32 v98, v98
MA 56,a,248,v,184
ds_read_b128 a[176:179], v10 offset:12288
v_add_f32 v4, v4, v96
MA 28,a,252,v,176
v_add_f32 v4, v4, v97
v_cmp_gt_i32_e64 s[92:93], 0, v247
MA 60,a,252,v,184
v_exp_f32 v99, v99
MA 92,a,252,v,192
ds_read_b128 a[180:183], v10 offset:13312
v_cvt_pk_bf16_f32 v96, v96, v97
MA 124,a,252,v,200
buffer_load_dwordx4 v12, s[52:55], s71 offen offset:3072 sc1 lds
v_cmp_gt_i32_e64 s[94:95], 1, v247
MA 88,a,248,v,192
v_exp_f32 v100, v100
MA 120,a,248,v,200
v_add_f32 v4, v4, v98
v_add_f32 v4, v4, v99
MA 84,a,244,v,192
v_exp_f32 v101, v101
MA 116,a,244,v,200
ds_read_b128 a[184:187], v10 offset:14336
v_cvt_pk_bf16_f32 v97, v98, v99
MA 80,a,240,v,192
v_exp_f32 v102, v102
MA 112,a,240,v,200
v_add_f32 v4, v4, v100
v_add_f32 v4, v4, v101
MA 76,a,236,v,192
ds_read_b128 a[188:191], v10 offset:15360
v_cmp_gt_i32_e64 s[96:97], 2, v247
MA 108,a,236,v,200
v_exp_f32 v103, v103
MA 72,a,232,v,192
v_cvt_pk_bf16_f32 v98, v100, v101
v_cmp_gt_i32_e64 s[98:99], 3, v247
MA 104,a,232,v,200
v_exp_f32 v104, v104
MA 68,a,228,v,192
v_add_f32 v4, v4, v102
v_add_f32 v4, v4, v103
MA 100,a,228,v,200
v_exp_f32 v105, v105
MA 64,a,224,v,192
s_xor_b32 s72, s72, 0x8000
v_cvt_pk_bf16_f32 v99, v102, v103
MA 96,a,224,v,200
v_exp_f32 v106, v106
v_add_f32 v5, v5, v104
v_cndmask_b32_e64 v132, v132, v14, s[92:93]
v_add_f32 v5, v5, v105
v_exp_f32 v107, v107
v_cvt_pk_bf16_f32 v104, v104, v105
v_exp_f32 v108, v108
v_cndmask_b32_e64 v133, v133, v14, s[94:95]
v_add_f32 v5, v5, v106
v_add_f32 v5, v5, v107
v_exp_f32 v109, v109
v_cvt_pk_bf16_f32 v105, v106, v107
v_cndmask_b32_e64 v134, v134, v14, s[96:97]
v_exp_f32 v110, v110
v_add_f32 v5, v5, v108
v_add_f32 v5, v5, v109
v_exp_f32 v111, v111
v_cndmask_b32_e64 v135, v135, v14, s[98:99]
v_cvt_pk_bf16_f32 v106, v108, v109
v_add_f32 v5, v5, v110
v_add_f32 v5, v5, v111
v_cvt_pk_bf16_f32 v107, v110, v111
L_p3_d0m_top:
s_waitcnt lgkmcnt(0)
v_mfma_f32_16x16x32_bf16 v[144:147], a[128:131], v[16:19], 0
s_add_u32 m0, s73, 0
ds_read_b128 a[192:195], v11 offset:16384
v_mfma_f32_16x16x32_bf16 v[152:155], a[128:131], v[32:35], 0
v_exp_f32 v112, v112
v_mfma_f32_16x16x32_bf16 v[168:171], a[128:131], v[64:67], 0
v_exp_f32 v113, v113
MV 144,a,132,v,20
ds_read_b128 a[196:199], v11 offset:17408
buffer_load_dwordx4 v12, s[56:59], s71 offen offset:0 sc1 lds
MV 152,a,132,v,36
v_exp_f32 v114, v114
MV 168,a,132,v,68
v_add_f32 v2, v2, v112
v_add_f32 v2, v2, v113
MV 144,a,136,v,24
v_exp_f32 v115, v115
MV 152,a,136,v,40
ds_read_b128 a[200:203], v11 offset:18432
v_cvt_pk_bf16_f32 v112, v112, v113
MV 168,a,136,v,72
v_exp_f32 v116, v116
MV 144,a,140,v,28
ds_read_b128 a[204:207], v11 offset:19456
v_add_f32 v2, v2, v114
MV 152,a,140,v,44
ds_read_b128 a[208:211], v11 offset:20480
v_add_f32 v2, v2, v115
MV 168,a,140,v,76
v_exp_f32 v117, v117
v_mfma_f32_16x16x32_bf16 v[148:151], a[144:147], v[16:19], 0
buffer_load_dwordx4 v12, s[56:59], s71 offen offset:1024 sc1 lds
v_cvt_pk_bf16_f32 v113, v114, v115
v_mfma_f32_16x16x32_bf16 v[156:159], a[144:147], v[32:35], 0
v_exp_f32 v118, v118
v_mfma_f32_16x16x32_bf16 v[172:175], a[144:147], v[64:67], 0
v_add_f32 v2, v2, v116
v_add_f32 v2, v2, v117
MV 148,a,148,v,20
v_exp_f32 v119, v119
MV 156,a,148,v,36
ds_read_b128 a[212:215], v11 offset:21504
v_cvt_pk_bf16_f32 v114, v116, v117
MV 172,a,148,v,68
v_exp_f32 v120, v120
MV 148,a,152,v,24
v_add_f32 v2, v2, v118
v_add_f32 v2, v2, v119
MV 156,a,152,v,40
v_exp_f32 v121, v121
MV 172,a,152,v,72
ds_read_b128 a[216:219], v11 offset:22528
v_cvt_pk_bf16_f32 v115, v118, v119
MV 148,a,156,v,28
v_exp_f32 v122, v122
MV 156,a,156,v,44
ds_read_b128 a[220:223], v11 offset:23552
v_add_f32 v3, v3, v120
MV 172,a,156,v,76
ds_read_b128 a[224:227], v11 offset:24576
v_add_f32 v3, v3, v121
v_mfma_f32_16x16x32_bf16 v[176:179], a[160:163], v[16:19], 0
v_exp_f32 v123, v123
v_mfma_f32_16x16x32_bf16 v[184:187], a[160:163], v[32:35], 0
buffer_load_dwordx4 v12, s[56:59], s71 offen offset:2048 sc1 lds
v_cvt_pk_bf16_f32 v120, v120, v121
v_mfma_f32_16x16x32_bf16 v[200:203], a[160:163], v[64:67], 0
v_exp_f32 v124, v124
MV 176,a,164,v,20
v_add_f32 v3, v3, v122
v_add_f32 v3, v3, v123
MV 184,a,164,v,36
v_exp_f32 v125, v125
MV 200,a,164,v,68
ds_read_b128 a[228:231], v11 offset:25600
v_cvt_pk_bf16_f32 v121, v122, v123
MV 176,a,168,v,24
v_exp_f32 v126, v126
MV 184,a,168,v,40
v_add_f32 v3, v3, v124
v_add_f32 v3, v3, v125
MV 200,a,168,v,72
v_exp_f32 v127, v127
MV 176,a,172,v,28
ds_read_b128 a[232:235], v11 offset:26624
v_cvt_pk_bf16_f32 v122, v124, v125
MV 184,a,172,v,44
v_exp_f32 v128, v128
MV 200,a,172,v,76
ds_read_b128 a[236:239], v11 offset:27648
v_add_f32 v3, v3, v126
v_mfma_f32_16x16x32_bf16 v[180:183], a[176:179], v[16:19], 0
ds_read_b128 a[240:243], v11 offset:28672
v_add_f32 v3, v3, v127
v_mfma_f32_16x16x32_bf16 v[188:191], a[176:179], v[32:35], 0
v_exp_f32 v129, v129
v_mfma_f32_16x16x32_bf16 v[204:207], a[176:179], v[64:67], 0
ds_read_b128 a[244:247], v11 offset:29696
v_cvt_pk_bf16_f32 v123, v126, v127
MV 180,a,180,v,20
v_exp_f32 v130, v130
MV 188,a,180,v,36
v_add_f32 v4, v4, v128
v_add_f32 v4, v4, v129
MV 204,a,180,v,68
v_exp_f32 v131, v131
MV 180,a,184,v,24
buffer_load_dwordx4 v12, s[56:59], s71 offen offset:3072 sc1 lds
v_cvt_pk_bf16_f32 v128, v128, v129
MV 188,a,184,v,40
v_exp_f32 v132, v132
MV 204,a,184,v,72
v_add_f32 v4, v4, v130
v_add_f32 v4, v4, v131
MV 180,a,188,v,28
ds_read_b128 a[248:251], v11 offset:30720
v_add_u32 v246, -64, v239
MV 188,a,188,v,44
v_exp_f32 v133, v133
MV 204,a,188,v,76
ds_read_b128 a[252:255], v11 offset:31744
s_add_u32 s71, s71, 16384
v_cvt_pk_bf16_f32 v129, v130, v131
v_exp_f32 v134, v134
v_cmp_gt_i32_e64 s[84:85], 0, v246
v_add_f32 v4, v4, v132
v_cmp_gt_i32_e64 s[86:87], 1, v246
v_add_f32 v4, v4, v133
v_exp_f32 v135, v135
v_cmp_gt_i32_e64 s[88:89], 2, v246
v_cvt_pk_bf16_f32 v130, v132, v133
v_exp_f32 v136, v136
v_cmp_gt_i32_e64 s[90:91], 3, v246
v_add_f32 v4, v4, v134
v_cndmask_b32_e64 v168, v168, v14, s[84:85]
v_add_f32 v4, v4, v135
v_exp_f32 v137, v137
v_cndmask_b32_e64 v169, v169, v14, s[86:87]
v_cvt_pk_bf16_f32 v131, v134, v135
v_exp_f32 v138, v138
v_cndmask_b32_e64 v170, v170, v14, s[88:89]
v_add_f32 v5, v5, v136
v_cndmask_b32_e64 v171, v171, v14, s[90:91]
v_add_f32 v5, v5, v137
v_exp_f32 v139, v139
v_add_u32 v247, -80, v239
v_cvt_pk_bf16_f32 v136, v136, v137
v_exp_f32 v140, v140
v_cmp_gt_i32_e64 s[92:93], 0, v247
v_add_f32 v5, v5, v138
v_cmp_gt_i32_e64 s[94:95], 1, v247
v_add_f32 v5, v5, v139
v_exp_f32 v141, v141
v_cmp_gt_i32_e64 s[96:97], 2, v247
v_cvt_pk_bf16_f32 v137, v138, v139
v_exp_f32 v142, v142
v_cmp_gt_i32_e64 s[98:99], 3, v247
v_add_f32 v5, v5, v140
v_cndmask_b32_e64 v172, v172, v14, s[92:93]
v_add_f32 v5, v5, v141
v_exp_f32 v143, v143
v_cndmask_b32_e64 v173, v173, v14, s[94:95]
v_cvt_pk_bf16_f32 v138, v140, v141
v_add_f32 v5, v5, v142
v_cndmask_b32_e64 v174, v174, v14, s[96:97]
v_add_f32 v5, v5, v143
v_cvt_pk_bf16_f32 v139, v142, v143
v_cndmask_b32_e64 v175, v175, v14, s[98:99]
s_waitcnt vmcnt(16) lgkmcnt(0)
MA 0,a,192,v,80
s_barrier
MA 32,a,192,v,88
s_add_u32 m0, s72, 0
ds_read_b128 a[128:131], v10 offset:16384
MA 4,a,196,v,80
ds_read_b128 a[132:135], v10 offset:17408
buffer_load_dwordx4 v12, s[52:55], s71 offen offset:0 sc1 lds
MA 36,a,196,v,88
v_exp_f32 v144, v144
MA 8,a,200,v,80
v_exp_f32 v145, v145
MA 40,a,200,v,88
v_exp_f32 v146, v146
MA 12,a,204,v,80
ds_read_b128 a[136:139], v10 offset:18432
v_add_f32 v2, v2, v144
MA 44,a,204,v,88
v_add_f32 v2, v2, v145
v_add_u32 v246, -96, v239
MA 16,a,208,v,80
v_exp_f32 v147, v147
MA 48,a,208,v,88
ds_read_b128 a[140:143], v10 offset:19456
v_cvt_pk_bf16_f32 v144, v144, v145
MA 20,a,212,v,80
ds_read_b128 a[144:147], v10 offset:20480
v_cmp_gt_i32_e64 s[84:85], 0, v246
MA 52,a,212,v,88
v_exp_f32 v148, v148
MA 24,a,216,v,80
v_add_f32 v2, v2, v146
v_add_f32 v2, v2, v147
MA 56,a,216,v,88
buffer_load_dwordx4 v12, s[52:55], s71 offen offset:1024 sc1 lds
v_cmp_gt_i32_e64 s[86:87], 1, v246
MA 28,a,220,v,80
v_exp_f32 v149, v149
MA 60,a,220,v,88
ds_read_b128 a[148:151], v10 offset:21504
v_cvt_pk_bf16_f32 v145, v146, v147
MA 92,a,220,v,96
v_exp_f32 v150, v150
MA 124,a,220,v,104
v_add_f32 v2, v2, v148
v_cmp_gt_i32_e64 s[88:89], 2, v246
MA 88,a,216,v,96
ds_read_b128 a[152:155], v10 offset:22528
v_add_f32 v2, v2, v149
MA 120,a,216,v,104
v_exp_f32 v151, v151
MA 84,a,212,v,96
v_cvt_pk_bf16_f32 v146, v148, v149
v_cmp_gt_i32_e64 s[90:91], 3, v246
MA 116,a,212,v,104
v_exp_f32 v152, v152
MA 80,a,208,v,96
ds_read_b128 a[156:159], v10 offset:23552
v_add_f32 v2, v2, v150
MA 112,a,208,v,104
v_add_f32 v2, v2, v151
v_cndmask_b32_e64 v200, v200, v14, s[84:85]
MA 76,a,204,v,96
v_exp_f32 v153, v153
MA 108,a,204,v,104
ds_read_b128 a[160:163], v10 offset:24576
v_cvt_pk_bf16_f32 v147, v150, v151
MA 72,a,200,v,96
buffer_load_dwordx4 v12, s[52:55], s71 offen offset:2048 sc1 lds
v_cndmask_b32_e64 v201, v201, v14, s[86:87]
MA 104,a,200,v,104
v_exp_f32 v154, v154
MA 68,a,196,v,96
ds_read_b128 a[164:167], v10 offset:25600
v_add_f32 v3, v3, v152
MA 100,a,196,v,104
v_add_f32 v3, v3, v153
v_cndmask_b32_e64 v202, v202, v14, s[88:89]
MA 64,a,192,v,96
v_exp_f32 v155, v155
MA 96,a,192,v,104
ds_read_b128 a[168:171], v10 offset:26624
v_cvt_pk_bf16_f32 v152, v152, v153
MA 0,a,224,v,112
v_exp_f32 v156, v156
MA 32,a,224,v,120
v_add_f32 v3, v3, v154
v_cndmask_b32_e64 v203, v203, v14, s[90:91]
MA 4,a,228,v,112
ds_read_b128 a[172:175], v10 offset:27648
v_add_f32 v3, v3, v155
MA 36,a,228,v,120
v_exp_f32 v157, v157
MA 8,a,232,v,112
v_cvt_pk_bf16_f32 v153, v154, v155
v_add_u32 v247, -112, v239
MA 40,a,232,v,120
v_exp_f32 v158, v158
MA 12,a,236,v,112
ds_read_b128 a[176:179], v10 offset:28672
v_add_f32 v3, v3, v156
MA 44,a,236,v,120
v_add_f32 v3, v3, v157
v_cmp_gt_i32_e64 s[92:93], 0, v247
MA 16,a,240,v,112
v_exp_f32 v159, v159
MA 48,a,240,v,120
ds_read_b128 a[180:183], v10 offset:29696
buffer_load_dwordx4 v12, s[52:55], s71 offen offset:3072 sc1 lds
MA 20,a,244,v,112
v_cvt_pk_bf16_f32 v154, v156, v157
v_cmp_gt_i32_e64 s[94:95], 1, v247
MA 52,a,244,v,120
v_exp_f32 v168, v168
MA 24,a,248,v,112
ds_read_b128 a[184:187], v10 offset:30720
v_add_f32 v3, v3, v158
MA 56,a,248,v,120
v_add_f32 v3, v3, v159
v_cmp_gt_i32_e64 s[96:97], 2, v247
MA 28,a,252,v,112
v_exp_f32 v169, v169
MA 60,a,252,v,120
ds_read_b128 a[188:191], v10 offset:31744
v_cvt_pk_bf16_f32 v155, v158, v159
MA 92,a,252,v,128
v_exp_f32 v170, v170
MA 124,a,252,v,136
v_add_f32 v5, v5, v168
v_cmp_gt_i32_e64 s[98:99], 3, v247
MA 88,a,248,v,128
s_cmp_eq_u32 s70, 7
v_add_f32 v5, v5, v169
MA 120,a,248,v,136
v_exp_f32 v171, v171
MA 84,a,244,v,128
v_cvt_pk_bf16_f32 v168, v168, v169
v_cndmask_b32_e64 v204, v204, v14, s[92:93]
MA 116,a,244,v,136
v_exp_f32 v172, v172
MA 80,a,240,v,128
v_add_f32 v5, v5, v170
v_add_f32 v5, v5, v171
MA 112,a,240,v,136
v_exp_f32 v173, v173
MA 76,a,236,v,128
v_cvt_pk_bf16_f32 v169, v170, v171
v_cndmask_b32_e64 v205, v205, v14, s[94:95]
MA 108,a,236,v,136
v_exp_f32 v174, v174
MA 72,a,232,v,128
v_add_f32 v5, v5, v172
v_cndmask_b32_e64 v206, v206, v14, s[96:97]
MA 104,a,232,v,136
v_add_f32 v5, v5, v173
v_cndmask_b32_e64 v207, v207, v14, s[98:99]
MA 68,a,228,v,128
v_exp_f32 v175, v175
MA 100,a,228,v,136
v_cvt_pk_bf16_f32 v170, v172, v173
v_add_f32 v5, v5, v174
MA 64,a,224,v,128
v_add_f32 v5, v5, v175
v_cvt_pk_bf16_f32 v171, v174, v175
MA 96,a,224,v,136
s_cbranch_scc1 L_p3_mxm_top
s_waitcnt lgkmcnt(0)
v_xor_b32 v11, 0x8000, v11
v_mfma_f32_16x16x32_bf16 v[80:83], a[128:131], v[16:19], 0
s_add_u32 m0, s73, 16384
ds_read_b128 a[192:195], v11 offset:0
v_mfma_f32_16x16x32_bf16 v[88:91], a[128:131], v[32:35], 0
v_exp_f32 v176, v176
v_mfma_f32_16x16x32_bf16 v[84:87], a[144:147], v[16:19], 0
v_exp_f32 v177, v177
v_mfma_f32_16x16x32_bf16 v[92:95], a[144:147], v[32:35], 0
ds_read_b128 a[196:199], v11 offset:1024
buffer_load_dwordx4 v12, s[56:59], s71 offen offset:0 sc1 lds
v_mfma_f32_16x16x32_bf16 v[112:115], a[160:163], v[16:19], 0
v_exp_f32 v178, v178
v_mfma_f32_16x16x32_bf16 v[120:123], a[160:163], v[32:35], 0
v_add_f32 v2, v2, v176
v_add_f32 v2, v2, v177
v_mfma_f32_16x16x32_bf16 v[116:119], a[176:179], v[16:19], 0
ds_read_b128 a[200:203], v11 offset:2048
ds_read_b128 a[204:207], v11 offset:3072
v_mfma_f32_16x16x32_bf16 v[124:127], a[176:179], v[32:35], 0
v_exp_f32 v179, v179
MV 116,a,180,v,20
ds_read_b128 a[208:211], v11 offset:4096
v_cvt_pk_bf16_f32 v176, v176, v177
MV 124,a,180,v,36
v_exp_f32 v180, v180
MV 112,a,164,v,20
v_add_f32 v2, v2, v178
v_add_f32 v2, v2, v179
MV 120,a,164,v,36
v_exp_f32 v181, v181
MV 84,a,148,v,20
buffer_load_dwordx4 v12, s[56:59], s71 offen offset:1024 sc1 lds
v_cvt_pk_bf16_f32 v177, v178, v179
MV 92,a,148,v,36
v_exp_f32 v182, v182
MV 80,a,132,v,20
ds_read_b128 a[212:215], v11 offset:5120
v_add_f32 v2, v2, v180
MV 88,a,132,v,36
ds_read_b128 a[216:219], v11 offset:6144
v_add_f32 v2, v2, v181
MV 80,a,136,v,24
v_exp_f32 v183, v183
MV 88,a,136,v,40
ds_read_b128 a[220:223], v11 offset:7168
v_cvt_pk_bf16_f32 v178, v180, v181
MV 84,a,152,v,24
v_exp_f32 v184, v184
MV 92,a,152,v,40
v_add_f32 v2, v2, v182
v_add_f32 v2, v2, v183
MV 112,a,168,v,24
ds_read_b128 a[224:227], v11 offset:8192
buffer_load_dwordx4 v12, s[56:59], s71 offen offset:2048 sc1 lds
MV 120,a,168,v,40
v_exp_f32 v185, v185
MV 116,a,184,v,24
ds_read_b128 a[228:231], v11 offset:9216
v_cvt_pk_bf16_f32 v179, v182, v183
MV 124,a,184,v,40
v_exp_f32 v186, v186
MV 116,a,188,v,28
v_add_f32 v3, v3, v184
v_add_f32 v3, v3, v185
MV 124,a,188,v,44
v_exp_f32 v187, v187
MV 112,a,172,v,28
ds_read_b128 a[232:235], v11 offset:10240
v_cvt_pk_bf16_f32 v184, v184, v185
MV 120,a,172,v,44
v_exp_f32 v188, v188
MV 84,a,156,v,28
ds_read_b128 a[236:239], v11 offset:11264
v_add_f32 v3, v3, v186
MV 92,a,156,v,44
buffer_load_dwordx4 v12, s[56:59], s71 offen offset:3072 sc1 lds
v_add_f32 v3, v3, v187
MV 80,a,140,v,28
v_exp_f32 v189, v189
MV 88,a,140,v,44
ds_read_b128 a[240:243], v11 offset:12288
ds_read_b128 a[244:247], v11 offset:13312
ds_read_b128 a[248:251], v11 offset:14336
ds_read_b128 a[252:255], v11 offset:15360
s_add_u32 s71, s71, 16384
s_xor_b32 s73, s73, 0x8000
v_cvt_pk_bf16_f32 v185, v186, v187
v_exp_f32 v190, v190
v_add_f32 v3, v3, v188
v_add_f32 v3, v3, v189
v_exp_f32 v191, v191
v_cvt_pk_bf16_f32 v186, v188, v189
v_exp_f32 v200, v200
v_add_f32 v3, v3, v190
v_add_f32 v3, v3, v191
v_exp_f32 v201, v201
v_cvt_pk_bf16_f32 v187, v190, v191
v_exp_f32 v202, v202
v_add_f32 v5, v5, v200
v_add_f32 v5, v5, v201
v_exp_f32 v203, v203
v_cvt_pk_bf16_f32 v200, v200, v201
v_exp_f32 v204, v204
v_add_f32 v5, v5, v202
v_add_f32 v5, v5, v203
v_exp_f32 v205, v205
v_cvt_pk_bf16_f32 v201, v202, v203
v_exp_f32 v206, v206
v_add_f32 v5, v5, v204
v_add_f32 v5, v5, v205
v_exp_f32 v207, v207
v_cvt_pk_bf16_f32 v202, v204, v205
v_add_f32 v5, v5, v206
v_add_f32 v5, v5, v207
v_cvt_pk_bf16_f32 v203, v206, v207
s_waitcnt vmcnt(16) lgkmcnt(0)
MA 0,a,192,v,144
s_barrier
v_xor_b32 v10, 0x8000, v10
MA 32,a,192,v,152
s_add_u32 m0, s72, 16384
ds_read_b128 a[128:131], v10 offset:0
MA 4,a,196,v,144
buffer_load_dwordx4 v12, s[52:55], s71 offen offset:0 sc1 lds
v_lshrrev_b32 v249, 2, v1
MA 36,a,196,v,152
ds_read_b128 a[132:135], v10 offset:1024
v_and_b32 v248, 7, v249
MA 8,a,200,v,144
v_exp_f32 v80, v80
MA 40,a,200,v,152
v_lshlrev_b32 v249, 8, v249
v_and_b32 v250, 3, v1
MA 12,a,204,v,144
ds_read_b128 a[136:139], v10 offset:2048
v_lshl_add_u32 v249, v250, 3, v249
MA 44,a,204,v,152
v_exp_f32 v81, v81
MA 16,a,208,v,144
s_lshl_b32 s36, s3, 13
s_add_u32 s36, s36, 131072
MA 48,a,208,v,152
ds_read_b128 a[140:143], v10 offset:3072
v_add_u32 v249, s36, v249
MA 20,a,212,v,144
v_exp_f32 v82, v82
MA 52,a,212,v,152
s_waitcnt vmcnt(13)
v_xor_b32 v250, 0, v248
MA 24,a,216,v,144
ds_read_b128 a[144:147], v10 offset:4096
v_lshl_add_u32 v250, v250, 5, v249
MA 56,a,216,v,152
v_exp_f32 v83, v83
MA 28,a,220,v,144
TR 96,250,0
TR 98,250,4096
MA 60,a,220,v,152
ds_read_b128 a[148:151], v10 offset:5120
v_xor_b32 v250, 1, v248
MA 124,a,220,v,168
buffer_load_dwordx4 v12, s[52:55], s71 offen offset:1024 sc1 lds
v_cvt_pk_bf16_f32 v80, v80, v81
MA 120,a,216,v,168
v_lshl_add_u32 v250, v250, 5, v249
TR 100,250,0
MA 116,a,212,v,168
TR 102,250,4096
v_xor_b32 v250, 2, v248
MA 112,a,208,v,168
v_exp_f32 v84, v84
MA 108,a,204,v,168
ds_read_b128 a[152:155], v10 offset:6144
v_lshl_add_u32 v250, v250, 5, v249
MA 104,a,200,v,168
TR 104,250,0
TR 106,250,4096
MA 100,a,196,v,168
v_exp_f32 v85, v85
MA 96,a,192,v,168
ds_read_b128 a[156:159], v10 offset:7168
v_cvt_pk_bf16_f32 v81, v82, v83
MA 0,a,224,v,176
v_xor_b32 v250, 3, v248
v_lshl_add_u32 v250, v250, 5, v249
MA 32,a,224,v,184
ds_read_b128 a[160:163], v10 offset:8192
TR 108,250,0
MA 4,a,228,v,176
TR 110,250,4096
v_xor_b32 v250, 4, v248
MA 36,a,228,v,184
v_exp_f32 v86, v86
MA 8,a,232,v,176
ds_read_b128 a[164:167], v10 offset:9216
v_lshl_add_u32 v250, v250, 5, v249
MA 40,a,232,v,184
buffer_load_dwordx4 v12, s[52:55], s71 offen offset:2048 sc1 lds
TR 128,250,0
MA 12,a,236,v,176
TR 130,250,4096
v_xor_b32 v250, 5, v248
MA 44,a,236,v,184
v_exp_f32 v87, v87
MA 16,a,240,v,176
ds_read_b128 a[168:171], v10 offset:10240
v_cvt_pk_bf16_f32 v82, v84, v85
MA 48,a,240,v,184
v_lshl_add_u32 v250, v250, 5, v249
TR 132,250,0
MA 20,a,244,v,176
TR 134,250,4096
v_xor_b32 v250, 6, v248
MA 52,a,244,v,184
v_exp_f32 v88, v88
MA 24,a,248,v,176
ds_read_b128 a[172:175], v10 offset:11264
v_lshl_add_u32 v250, v250, 5, v249
MA 56,a,248,v,184
TR 136,250,0
TR 138,250,4096
MA 28,a,252,v,176
v_exp_f32 v89, v89
MA 60,a,252,v,184
ds_read_b128 a[176:179], v10 offset:12288
v_xor_b32 v250, 7, v248
MA 124,a,252,v,200
v_cvt_pk_bf16_f32 v83, v86, v87
v_lshl_add_u32 v250, v250, 5, v249
MA 120,a,248,v,200
ds_read_b128 a[180:183], v10 offset:13312
TR 140,250,0
MA 116,a,244,v,200
buffer_load_dwordx4 v12, s[52:55], s71 offen offset:3072 sc1 lds
TR 142,250,4096
MA 112,a,240,v,200
v_exp_f32 v90, v90
MA 108,a,236,v,200
s_add_u32 s32, s40, 100663296
s_addc_u32 s33, s41, 0
MA 104,a,232,v,200
ds_read_b128 a[184:187], v10 offset:14336
s_mov_b32 s34, 8388608
MA 100,a,228,v,200
s_mov_b32 s35, 0x20000
s_and_b32 s36, s2, 7
MA 96,a,224,v,200
ds_read_b128 a[188:191], v10 offset:15360
s_xor_b32 s72, s72, 0x8000
v_exp_f32 v91, v91
s_lshl_b32 s36, s36, 20
s_lshr_b32 s37, s2, 3
v_cvt_pk_bf16_f32 v88, v88, v89
s_lshl_b32 s37, s37, 15
v_exp_f32 v92, v92
s_add_u32 s36, s36, s37
s_lshl_b32 s37, s3, 12
s_add_u32 s36, s36, s37
v_exp_f32 v93, v93
s_add_u32 s37, s36, 4096
s_waitcnt lgkmcnt(15)
buffer_store_dwordx4 v[96:99], v12, s[32:35], s36 offen offset:0 sc1
buffer_store_dwordx4 v[100:103], v12, s[32:35], s36 offen offset:1024 sc1
v_cvt_pk_bf16_f32 v89, v90, v91
buffer_store_dwordx4 v[104:107], v12, s[32:35], s36 offen offset:2048 sc1
buffer_store_dwordx4 v[108:111], v12, s[32:35], s36 offen offset:3072 sc1
s_waitcnt lgkmcnt(12)
buffer_store_dwordx4 v[128:131], v12, s[32:35], s37 offen offset:0 sc1
v_exp_f32 v94, v94
s_waitcnt lgkmcnt(9)
buffer_store_dwordx4 v[132:135], v12, s[32:35], s37 offen offset:1024 sc1
s_waitcnt lgkmcnt(6)
buffer_store_dwordx4 v[136:139], v12, s[32:35], s37 offen offset:2048 sc1
s_waitcnt lgkmcnt(2)
buffer_store_dwordx4 v[140:143], v12, s[32:35], s37 offen offset:3072 sc1
v_exp_f32 v95, v95
v_lshlrev_b32 v232, 4, v1
v_mov_b32 v235, 0
buffer_load_ushort v234, v235, s[28:31], s42 offen
v_cvt_pk_bf16_f32 v90, v92, v93
buffer_load_dwordx4 v[210:213], v232, s[16:19], 0 offen offset:0
buffer_load_dwordx4 v[216:219], v232, s[16:19], 0 offen offset:1024
v_cvt_pk_bf16_f32 v91, v94, v95
buffer_load_dwordx4 v[222:225], v232, s[16:19], 0 offen offset:2048
buffer_load_dwordx4 v[228:231], v232, s[16:19], 0 offen offset:3072
L_p3_eps:
v_mov_b32 v240, v4
v_mov_b32 v241, v5
s_nop 0
v_permlane32_swap_b32 v4, v240
v_permlane32_swap_b32 v5, v241
v_add_f32 v4, v4, v240
v_add_f32 v5, v5, v241
v_mov_b32 v240, v4
v_mov_b32 v241, v5
s_nop 0
v_permlane16_swap_b32 v4, v240
v_permlane16_swap_b32 v5, v241
v_add_f32 v4, v4, v240
v_add_f32 v5, v5, v241
v_cmp_nle_f32 vcc, 0x30800000, v4
s_nop 0
s_mov_b64 s[78:79], vcc
v_cmp_nge_f32 vcc, 0x4e800000, v4
s_nop 0
s_or_b64 s[78:79], s[78:79], vcc
v_cmp_nle_f32 vcc, 0x30800000, v5
s_nop 0
s_or_b64 s[78:79], s[78:79], vcc
v_cmp_nge_f32 vcc, 0x4e800000, v5
s_nop 0
s_or_b64 s[78:79], s[78:79], vcc
v_rcp_f32 v4, v4
v_rcp_f32 v5, v5
s_add_u32 s80, s101, s76
s_nop 4
v_accvgpr_read_b32 v240, a64
v_accvgpr_read_b32 v241, a65
v_accvgpr_read_b32 v242, a66
v_accvgpr_read_b32 v243, a67
v_accvgpr_read_b32 v244, a68
v_accvgpr_read_b32 v245, a69
v_accvgpr_read_b32 v246, a70
v_accvgpr_read_b32 v247, a71
v_pk_mul_f32 v[240:241], v[240:241], v[4:5] op_sel:[0,0] op_sel_hi:[1,0]
v_pk_mul_f32 v[242:243], v[242:243], v[4:5] op_sel:[0,0] op_sel_hi:[1,0]
v_pk_mul_f32 v[244:245], v[244:245], v[4:5] op_sel:[0,0] op_sel_hi:[1,0]
v_pk_mul_f32 v[246:247], v[246:247], v[4:5] op_sel:[0,0] op_sel_hi:[1,0]
v_cvt_pk_bf16_f32 v248, v240, v241
v_cvt_pk_bf16_f32 v249, v242, v243
v_cvt_pk_bf16_f32 v250, v244, v245
v_cvt_pk_bf16_f32 v251, v246, v247
buffer_store_dwordx4 v[248:251], v15, s[60:63], s101 offen offset:0 sc1
v_accvgpr_read_b32 v240, a72
v_accvgpr_read_b32 v241, a73
v_accvgpr_read_b32 v242, a74
v_accvgpr_read_b32 v243, a75
v_accvgpr_read_b32 v244, a76
v_accvgpr_read_b32 v245, a77
v_accvgpr_read_b32 v246, a78
v_accvgpr_read_b32 v247, a79
v_pk_mul_f32 v[240:241], v[240:241], v[4:5] op_sel:[0,0] op_sel_hi:[1,0]
v_pk_mul_f32 v[242:243], v[242:243], v[4:5] op_sel:[0,0] op_sel_hi:[1,0]
v_pk_mul_f32 v[244:245], v[244:245], v[4:5] op_sel:[0,0] op_sel_hi:[1,0]
v_pk_mul_f32 v[246:247], v[246:247], v[4:5] op_sel:[0,0] op_sel_hi:[1,0]
v_cvt_pk_bf16_f32 v252, v240, v241
v_cvt_pk_bf16_f32 v253, v242, v243
v_cvt_pk_bf16_f32 v254, v244, v245
v_cvt_pk_bf16_f32 v255, v246, v247
buffer_store_dwordx4 v[252:255], v15, s[60:63], s101 offen offset:1024 sc1
v_accvgpr_read_b32 v240, a80
v_accvgpr_read_b32 v241, a81
v_accvgpr_read_b32 v242, a82
v_accvgpr_read_b32 v243, a83
v_accvgpr_read_b32 v244, a84
v_accvgpr_read_b32 v245, a85
v_accvgpr_read_b32 v246, a86
v_accvgpr_read_b32 v247, a87
v_pk_mul_f32 v[240:241], v[240:241], v[4:5] op_sel:[0,0] op_sel_hi:[1,0]
v_pk_mul_f32 v[242:243], v[242:243], v[4:5] op_sel:[0,0] op_sel_hi:[1,0]
v_pk_mul_f32 v[244:245], v[244:245], v[4:5] op_sel:[0,0] op_sel_hi:[1,0]
v_pk_mul_f32 v[246:247], v[246:247], v[4:5] op_sel:[0,0] op_sel_hi:[1,0]
v_cvt_pk_bf16_f32 v248, v240, v241
v_cvt_pk_bf16_f32 v249, v242, v243
v_cvt_pk_bf16_f32 v250, v244, v245
v_cvt_pk_bf16_f32 v251, v246, v247
buffer_store_dwordx4 v[248:251], v15, s[60:63], s101 offen offset:2048 sc1
v_accvgpr_read_b32 v240, a88
v_accvgpr_read_b32 v241, a89
v_accvgpr_read_b32 v242, a90
v_accvgpr_read_b32 v243, a91
v_accvgpr_read_b32 v244, a92
v_accvgpr_read_b32 v245, a93
v_accvgpr_read_b32 v246, a94
v_accvgpr_read_b32 v247, a95
v_pk_mul_f32 v[240:241], v[240:241], v[4:5] op_sel:[0,0] op_sel_hi:[1,0]
v_pk_mul_f32 v[242:243], v[242:243], v[4:5] op_sel:[0,0] op_sel_hi:[1,0]
v_pk_mul_f32 v[244:245], v[244:245], v[4:5] op_sel:[0,0] op_sel_hi:[1,0]
v_pk_mul_f32 v[246:247], v[246:247], v[4:5] op_sel:[0,0] op_sel_hi:[1,0]
v_cvt_pk_bf16_f32 v252, v240, v241
v_cvt_pk_bf16_f32 v253, v242, v243
v_cvt_pk_bf16_f32 v254, v244, v245
v_cvt_pk_bf16_f32 v255, v246, v247
buffer_store_dwordx4 v[252:255], v15, s[60:63], s101 offen offset:3072 sc1
v_accvgpr_read_b32 v240, a96
v_accvgpr_read_b32 v241, a97
v_accvgpr_read_b32 v242, a98
v_accvgpr_read_b32 v243, a99
v_accvgpr_read_b32 v244, a100
v_accvgpr_read_b32 v245, a101
v_accvgpr_read_b32 v246, a102
v_accvgpr_read_b32 v247, a103
v_pk_mul_f32 v[240:241], v[240:241], v[4:5] op_sel:[0,1] op_sel_hi:[1,1]
v_pk_mul_f32 v[242:243], v[242:243], v[4:5] op_sel:[0,1] op_sel_hi:[1,1]
v_pk_mul_f32 v[244:245], v[244:245], v[4:5] op_sel:[0,1] op_sel_hi:[1,1]
v_pk_mul_f32 v[246:247], v[246:247], v[4:5] op_sel:[0,1] op_sel_hi:[1,1]
v_cvt_pk_bf16_f32 v248, v240, v241
v_cvt_pk_bf16_f32 v249, v242, v243
v_cvt_pk_bf16_f32 v250, v244, v245
v_cvt_pk_bf16_f32 v251, v246, v247
buffer_store_dwordx4 v[248:251], v15, s[60:63], s80 offen offset:0 sc1
v_accvgpr_read_b32 v240, a104
v_accvgpr_read_b32 v241, a105
v_accvgpr_read_b32 v242, a106
v_accvgpr_read_b32 v243, a107
v_accvgpr_read_b32 v244, a108
v_accvgpr_read_b32 v245, a109
v_accvgpr_read_b32 v246, a110
v_accvgpr_read_b32 v247, a111
v_pk_mul_f32 v[240:241], v[240:241], v[4:5] op_sel:[0,1] op_sel_hi:[1,1]
v_pk_mul_f32 v[242:243], v[242:243], v[4:5] op_sel:[0,1] op_sel_hi:[1,1]
v_pk_mul_f32 v[244:245], v[244:245], v[4:5] op_sel:[0,1] op_sel_hi:[1,1]
v_pk_mul_f32 v[246:247], v[246:247], v[4:5] op_sel:[0,1] op_sel_hi:[1,1]
v_cvt_pk_bf16_f32 v252, v240, v241
v_cvt_pk_bf16_f32 v253, v242, v243
v_cvt_pk_bf16_f32 v254, v244, v245
v_cvt_pk_bf16_f32 v255, v246, v247
buffer_store_dwordx4 v[252:255], v15, s[60:63], s80 offen offset:1024 sc1
v_accvgpr_read_b32 v240, a112
v_accvgpr_read_b32 v241, a113
v_accvgpr_read_b32 v242, a114
v_accvgpr_read_b32 v243, a115
v_accvgpr_read_b32 v244, a116
v_accvgpr_read_b32 v245, a117
v_accvgpr_read_b32 v246, a118
v_accvgpr_read_b32 v247, a119
v_pk_mul_f32 v[240:241], v[240:241], v[4:5] op_sel:[0,1] op_sel_hi:[1,1]
v_pk_mul_f32 v[242:243], v[242:243], v[4:5] op_sel:[0,1] op_sel_hi:[1,1]
v_pk_mul_f32 v[244:245], v[244:245], v[4:5] op_sel:[0,1] op_sel_hi:[1,1]
v_pk_mul_f32 v[246:247], v[246:247], v[4:5] op_sel:[0,1] op_sel_hi:[1,1]
v_cvt_pk_bf16_f32 v248, v240, v241
v_cvt_pk_bf16_f32 v249, v242, v243
v_cvt_pk_bf16_f32 v250, v244, v245
v_cvt_pk_bf16_f32 v251, v246, v247
buffer_store_dwordx4 v[248:251], v15, s[60:63], s80 offen offset:2048 sc1
v_accvgpr_read_b32 v240, a120
v_accvgpr_read_b32 v241, a121
v_accvgpr_read_b32 v242, a122
v_accvgpr_read_b32 v243, a123
v_accvgpr_read_b32 v244, a124
v_accvgpr_read_b32 v245, a125
v_accvgpr_read_b32 v246, a126
v_accvgpr_read_b32 v247, a127
v_pk_mul_f32 v[240:241], v[240:241], v[4:5] op_sel:[0,1] op_sel_hi:[1,1]
v_pk_mul_f32 v[242:243], v[242:243], v[4:5] op_sel:[0,1] op_sel_hi:[1,1]
v_pk_mul_f32 v[244:245], v[244:245], v[4:5] op_sel:[0,1] op_sel_hi:[1,1]
v_pk_mul_f32 v[246:247], v[246:247], v[4:5] op_sel:[0,1] op_sel_hi:[1,1]
v_cvt_pk_bf16_f32 v252, v240, v241
v_cvt_pk_bf16_f32 v253, v242, v243
v_cvt_pk_bf16_f32 v254, v244, v245
v_cvt_pk_bf16_f32 v255, v246, v247
buffer_store_dwordx4 v[252:255], v15, s[60:63], s80 offen offset:3072 sc1
v_mov_b32 v160, 0x3f803f80
v_mov_b32 v161, 0x3f803f80
v_mov_b32 v162, 0x3f803f80
v_mov_b32 v163, 0x3f803f80
v_mov_b32 v164, 0
v_mov_b32 v165, 0
v_mov_b32 v166, 0
v_mov_b32 v167, 0
v_mov_b32 v168, 0
v_mov_b32 v169, 0
v_mov_b32 v170, 0
v_mov_b32 v171, 0
s_and_b32 s36, s2, 3
s_lshl_b32 s36, s36, 1
s_sub_u32 s32, 14, s36
s_bitcmp1_b32 s2, 4
s_cselect_b32 s36, s32, s36
s_bfe_u32 s32, s2, 0x10003
s_add_u32 s36, s36, s32
s_bfe_u32 s37, s2, 0x10002
s_lshr_b32 s32, s2, 5
s_lshl_b32 s32, s32, 1
s_add_u32 s37, s37, s32
s_lshl_b32 s36, s36, 2
s_add_u32 s36, s36, s3
s_lshl_b32 s37, s37, 7
s_lshl_b32 s32, s36, 16
s_add_u32 s37, s37, s32
s_lshl_b32 s36, s36, 7
v_and_b32 v240, 15, v1
v_bfe_u32 v241, v1, 4, 1
v_lshlrev_b32 v241, 5, v241
v_lshrrev_b32 v242, 5, v1
v_lshl_add_u32 v241, v242, 4, v241
v_lshl_add_u32 v241, v240, 11, v241
v_lshlrev_b32 v240, 2, v240
s_add_u32 s32, s40, 58720256
s_addc_u32 s33, s41, 0
s_mov_b32 s34, 8192
s_mov_b32 s35, 0x20000
buffer_load_dwordx4 v[192:195], v241, s[44:47], s37 offen offset:0
buffer_load_dwordx4 v[196:199], v241, s[44:47], s37 offen offset:64
buffer_load_dword v6, v240, s[32:35], s36 offen offset:0 sc1
s_add_u32 s37, s37, 32768
buffer_load_dwordx4 v[200:203], v241, s[44:47], s37 offen offset:0
buffer_load_dwordx4 v[204:207], v241, s[44:47], s37 offen offset:64
buffer_load_dword v7, v240, s[32:35], s36 offen offset:64 sc1
v_lshlrev_b32 v236, 20, v1
s_lshl_b32 s36, s3, 26
v_add_u32 v236, s36, v236
v_mov_b32 v237, 1
s_lshl_b32 s37, s2, 2
s_getpc_b64 s[38:39]
L_ct_b:
s_add_u32 s38, s38, L_p3_s1m_top - L_ct_b
s_addc_u32 s39, s39, 0
v_mov_b32 v173, s39
v_mov_b32 v172, s38
s_lshr_b32 s38, s2, 3
s_lshl_b32 s38, s38, 2
s_add_u32 s38, s38, s3
s_lshl_b32 s38, s38, 7
v_and_b32 v174, 3, v1
v_lshlrev_b32 v174, 14, v174
v_add_u32 v174, s38, v174
v_min_u32 v174, L_end - L_p3_s1m_top - 4, v174
v_add_co_u32 v172, vcc, v172, v174
s_nop 1
v_addc_co_u32 v173, vcc, 0, v173, vcc
global_load_dword v174, v[172:173], off
s_lshl_b32 s74, s70, 1
s_sub_u32 s74, 13, s74
s_cbranch_scc1 L_p3_s0m_top
.p2align 5
L_p3_s0_top:
s_waitcnt lgkmcnt(0)
v_mfma_f32_16x16x32_bf16 v[144:147], a[128:131], v[16:19], 0
s_add_u32 m0, s73, 0
ds_read_b128 a[192:195], v11 offset:16384
v_mfma_f32_16x16x32_bf16 v[152:155], a[128:131], v[32:35], 0
v_exp_f32 v112, v112
v_mfma_f32_16x16x32_bf16 v[148:151], a[144:147], v[16:19], 0
ds_read_b128 a[196:199], v11 offset:17408
buffer_load_dwordx4 v12, s[56:59], s71 offen offset:0 sc1 lds
v_mfma_f32_16x16x32_bf16 v[156:159], a[144:147], v[32:35], 0
v_exp_f32 v113, v113
v_mfma_f32_16x16x32_bf16 v[176:179], a[160:163], v[16:19], 0
ds_read_b128 a[200:203], v11 offset:18432
ds_read_b128 a[204:207], v11 offset:19456
v_mfma_f32_16x16x32_bf16 v[184:187], a[160:163], v[32:35], 0
v_exp_f32 v114, v114
v_mfma_f32_16x16x32_bf16 v[180:183], a[176:179], v[16:19], 0
v_exp_f32 v115, v115
v_mfma_f32_16x16x32_bf16 v[188:191], a[176:179], v[32:35], 0
ds_read_b128 a[208:211], v11 offset:20480
v_cvt_pk_bf16_f32 v112, v112, v113
MV 180,a,180,v,20
ds_read_b128 a[212:215], v11 offset:21504
buffer_load_dwordx4 v12, s[56:59], s71 offen offset:1024 sc1 lds
MV 188,a,180,v,36
v_exp_f32 v116, v116
MV 176,a,164,v,20
v_exp_f32 v117, v117
MV 184,a,164,v,36
ds_read_b128 a[216:219], v11 offset:22528
ds_read_b128 a[220:223], v11 offset:23552
MV 148,a,148,v,20
ds_read_b128 a[224:227], v11 offset:24576
v_cvt_pk_bf16_f32 v113, v114, v115
MV 156,a,148,v,36
v_exp_f32 v118, v118
MV 144,a,132,v,20
v_exp_f32 v119, v119
MV 152,a,132,v,36
ds_read_b128 a[228:231], v11 offset:25600
buffer_load_dwordx4 v12, s[56:59], s71 offen offset:2048 sc1 lds
MV 144,a,136,v,24
ds_read_b128 a[232:235], v11 offset:26624
v_cvt_pk_bf16_f32 v114, v116, v117
MV 152,a,136,v,40
v_exp_f32 v120, v120
MV 148,a,152,v,24
ds_read_b128 a[236:239], v11 offset:27648
ds_read_b128 a[240:243], v11 offset:28672
MV 156,a,152,v,40
v_exp_f32 v121, v121
MV 176,a,168,v,24
ds_read_b128 a[244:247], v11 offset:29696
v_cvt_pk_bf16_f32 v115, v118, v119
MV 184,a,168,v,40
ds_read_b128 a[248:251], v11 offset:30720
buffer_load_dwordx4 v12, s[56:59], s71 offen offset:3072 sc1 lds
MV 180,a,184,v,24
v_exp_f32 v122, v122
MV 188,a,184,v,40
v_exp_f32 v123, v123
MV 180,a,188,v,28
ds_read_b128 a[252:255], v11 offset:31744
v_cvt_pk_bf16_f32 v120, v120, v121
MV 188,a,188,v,44
v_exp_f32 v124, v124
MV 176,a,172,v,28
v_exp_f32 v125, v125
MV 184,a,172,v,44
s_add_u32 s71, s71, 16384
v_cvt_pk_bf16_f32 v121, v122, v123
MV 148,a,156,v,28
v_exp_f32 v126, v126
MV 156,a,156,v,44
v_exp_f32 v127, v127
MV 144,a,140,v,28
v_cvt_pk_bf16_f32 v122, v124, v125
v_cvt_pk_bf16_f32 v123, v126, v127
MV 152,a,140,v,44
s_waitcnt vmcnt(16) lgkmcnt(0)
MA 0,a,192,v,80
s_barrier
MA 32,a,192,v,88
s_add_u32 m0, s72, 0
ds_read_b128 a[128:131], v10 offset:16384
MA 4,a,196,v,80
ds_read_b128 a[132:135], v10 offset:17408
buffer_load_dwordx4 v12, s[52:55], s71 offen offset:0 sc1 lds
MA 36,a,196,v,88
v_exp_f32 v144, v144
MA 8,a,200,v,80
v_exp_f32 v145, v145
MA 40,a,200,v,88
ds_read_b128 a[136:139], v10 offset:18432
ds_read_b128 a[140:143], v10 offset:19456
MA 12,a,204,v,80
v_exp_f32 v146, v146
MA 44,a,204,v,88
ds_read_b128 a[144:147], v10 offset:20480
buffer_load_dwordx4 v12, s[52:55], s71 offen offset:1024 sc1 lds
MV 164,v,160,v,80
v_exp_f32 v147, v147
MV 168,v,160,v,88
ds_read_b128 a[148:151], v10 offset:21504
v_cvt_pk_bf16_f32 v144, v144, v145
MA 16,a,208,v,80
v_exp_f32 v148, v148
MA 48,a,208,v,88
ds_read_b128 a[152:155], v10 offset:22528
ds_read_b128 a[156:159], v10 offset:23552
MA 20,a,212,v,80
v_exp_f32 v149, v149
MA 52,a,212,v,88
ds_read_b128 a[160:163], v10 offset:24576
v_cvt_pk_bf16_f32 v145, v146, v147
MA 24,a,216,v,80
v_exp_f32 v150, v150
MA 56,a,216,v,88
ds_read_b128 a[164:167], v10 offset:25600
buffer_load_dwordx4 v12, s[52:55], s71 offen offset:2048 sc1 lds
MA 28,a,220,v,80
v_exp_f32 v151, v151
MA 60,a,220,v,88
ds_read_b128 a[168:171], v10 offset:26624
v_cvt_pk_bf16_f32 v146, v148, v149
MA 0,a,224,v,112
ds_read_b128 a[172:175], v10 offset:27648
ds_read_b128 a[176:179], v10 offset:28672
MA 32,a,224,v,120
v_exp_f32 v152, v152
MA 4,a,228,v,112
v_exp_f32 v153, v153
MA 36,a,228,v,120
ds_read_b128 a[180:183], v10 offset:29696
v_cvt_pk_bf16_f32 v147, v150, v151
MA 8,a,232,v,112
ds_read_b128 a[184:187], v10 offset:30720
buffer_load_dwordx4 v12, s[52:55], s71 offen offset:3072 sc1 lds
MA 40,a,232,v,120
v_exp_f32 v154, v154
MA 12,a,236,v,112
v_exp_f32 v155, v155
MA 44,a,236,v,120
ds_read_b128 a[188:191], v10 offset:31744
v_cvt_pk_bf16_f32 v152, v152, v153
MV 164,v,160,v,112
v_exp_f32 v156, v156
MV 168,v,160,v,120
MA 16,a,240,v,112
v_exp_f32 v157, v157
MA 48,a,240,v,120
s_sub_u32 s74, s74, 1
v_cvt_pk_bf16_f32 v153, v154, v155
MA 20,a,244,v,112
v_exp_f32 v158, v158
MA 52,a,244,v,120
MA 24,a,248,v,112
v_exp_f32 v159, v159
MA 56,a,248,v,120
MA 28,a,252,v,112
v_cvt_pk_bf16_f32 v154, v156, v157
v_cvt_pk_bf16_f32 v155, v158, v159
MA 60,a,252,v,120
s_cbranch_scc1 L_p3_s1m_top
s_waitcnt lgkmcnt(0)
v_xor_b32 v11, 0x8000, v11
v_mfma_f32_16x16x32_bf16 v[80:83], a[128:131], v[16:19], 0
s_add_u32 m0, s73, 16384
ds_read_b128 a[192:195], v11 offset:0
v_mfma_f32_16x16x32_bf16 v[88:91], a[128:131], v[32:35], 0
v_exp_f32 v176, v176
v_mfma_f32_16x16x32_bf16 v[84:87], a[144:147], v[16:19], 0
ds_read_b128 a[196:199], v11 offset:1024
buffer_load_dwordx4 v12, s[56:59], s71 offen offset:0 sc1 lds
v_mfma_f32_16x16x32_bf16 v[92:95], a[144:147], v[32:35], 0
v_exp_f32 v177, v177
v_mfma_f32_16x16x32_bf16 v[112:115], a[160:163], v[16:19], 0
ds_read_b128 a[200:203], v11 offset:2048
ds_read_b128 a[204:207], v11 offset:3072
v_mfma_f32_16x16x32_bf16 v[120:123], a[160:163], v[32:35], 0
v_exp_f32 v178, v178
v_mfma_f32_16x16x32_bf16 v[116:119], a[176:179], v[16:19], 0
v_exp_f32 v179, v179
v_mfma_f32_16x16x32_bf16 v[124:127], a[176:179], v[32:35], 0
ds_read_b128 a[208:211], v11 offset:4096
buffer_load_dwordx4 v12, s[56:59], s71 offen offset:1024 sc1 lds
MV 116,a,180,v,20
ds_read_b128 a[212:215], v11 offset:5120
v_cvt_pk_bf16_f32 v176, v176, v177
MV 124,a,180,v,36
v_exp_f32 v180, v180
MV 112,a,164,v,20
v_exp_f32 v181, v181
MV 120,a,164,v,36
ds_read_b128 a[216:219], v11 offset:6144
ds_read_b128 a[220:223], v11 offset:7168
MV 84,a,148,v,20
buffer_load_dwordx4 v12, s[56:59], s71 offen offset:2048 sc1 lds
v_cvt_pk_bf16_f32 v177, v178, v179
MV 92,a,148,v,36
v_exp_f32 v182, v182
MV 80,a,132,v,20
ds_read_b128 a[224:227], v11 offset:8192
ds_read_b128 a[228:231], v11 offset:9216
MV 88,a,132,v,36
v_exp_f32 v183, v183
MV 80,a,136,v,24
ds_read_b128 a[232:235], v11 offset:10240
v_cvt_pk_bf16_f32 v178, v180, v181
MV 88,a,136,v,40
v_exp_f32 v184, v184
MV 84,a,152,v,24
ds_read_b128 a[236:239], v11 offset:11264
buffer_load_dwordx4 v12, s[56:59], s71 offen offset:3072 sc1 lds
MV 92,a,152,v,40
v_exp_f32 v185, v185
MV 112,a,168,v,24
ds_read_b128 a[240:243], v11 offset:12288
v_cvt_pk_bf16_f32 v179, v182, v183
MV 120,a,168,v,40
ds_read_b128 a[244:247], v11 offset:13312
ds_read_b128 a[248:251], v11 offset:14336
MV 116,a,184,v,24
v_exp_f32 v186, v186
MV 124,a,184,v,40
v_exp_f32 v187, v187
MV 116,a,188,v,28
ds_read_b128 a[252:255], v11 offset:15360
s_add_u32 s71, s71, 16384
MV 124,a,188,v,44
s_xor_b32 s73, s73, 0x8000
v_cvt_pk_bf16_f32 v184, v184, v185
MV 112,a,172,v,28
v_exp_f32 v188, v188
MV 120,a,172,v,44
v_exp_f32 v189, v189
MV 84,a,156,v,28
v_cvt_pk_bf16_f32 v185, v186, v187
MV 92,a,156,v,44
v_exp_f32 v190, v190
MV 80,a,140,v,28
v_exp_f32 v191, v191
MV 88,a,140,v,44
v_cvt_pk_bf16_f32 v186, v188, v189
v_cvt_pk_bf16_f32 v187, v190, v191
s_waitcnt vmcnt(16) lgkmcnt(0)
MA 0,a,192,v,144
s_barrier
v_xor_b32 v10, 0x8000, v10
MA 32,a,192,v,152
s_add_u32 m0, s72, 16384
ds_read_b128 a[128:131], v10 offset:0
MA 4,a,196,v,144
ds_read_b128 a[132:135], v10 offset:1024
buffer_load_dwordx4 v12, s[52:55], s71 offen offset:0 sc1 lds
MA 36,a,196,v,152
v_exp_f32 v80, v80
MA 8,a,200,v,144
v_exp_f32 v81, v81
MA 40,a,200,v,152
ds_read_b128 a[136:139], v10 offset:2048
ds_read_b128 a[140:143], v10 offset:3072
MA 12,a,204,v,144
v_exp_f32 v82, v82
MA 44,a,204,v,152
ds_read_b128 a[144:147], v10 offset:4096
buffer_load_dwordx4 v12, s[52:55], s71 offen offset:1024 sc1 lds
MV 164,v,160,v,144
v_exp_f32 v83, v83
MV 168,v,160,v,152
ds_read_b128 a[148:151], v10 offset:5120
v_cvt_pk_bf16_f32 v80, v80, v81
MA 16,a,208,v,144
v_exp_f32 v84, v84
MA 48,a,208,v,152
ds_read_b128 a[152:155], v10 offset:6144
buffer_load_dwordx4 v12, s[52:55], s71 offen offset:2048 sc1 lds
MA 20,a,212,v,144
v_exp_f32 v85, v85
MA 52,a,212,v,152
ds_read_b128 a[156:159], v10 offset:7168
v_cvt_pk_bf16_f32 v81, v82, v83
MA 24,a,216,v,144
v_exp_f32 v86, v86
MA 56,a,216,v,152
ds_read_b128 a[160:163], v10 offset:8192
ds_read_b128 a[164:167], v10 offset:9216
MA 28,a,220,v,144
v_exp_f32 v87, v87
MA 60,a,220,v,152
ds_read_b128 a[168:171], v10 offset:10240
buffer_load_dwordx4 v12, s[52:55], s71 offen offset:3072 sc1 lds
MA 0,a,224,v,176
ds_read_b128 a[172:175], v10 offset:11264
v_cvt_pk_bf16_f32 v82, v84, v85
MA 32,a,224,v,184
v_exp_f32 v88, v88
MA 4,a,228,v,176
v_exp_f32 v89, v89
MA 36,a,228,v,184
ds_read_b128 a[176:179], v10 offset:12288
s_xor_b32 s72, s72, 0x8000
MA 8,a,232,v,176
ds_read_b128 a[180:183], v10 offset:13312
v_cvt_pk_bf16_f32 v83, v86, v87
MA 40,a,232,v,184
v_exp_f32 v90, v90
MA 12,a,236,v,176
ds_read_b128 a[184:187], v10 offset:14336
ds_read_b128 a[188:191], v10 offset:15360
MA 44,a,236,v,184
v_exp_f32 v91, v91
MV 164,v,160,v,176
buffer_store_dword v237, v236, s[8:11], s37 offen offset:1024 sc1
v_cvt_pk_bf16_f32 v88, v88, v89
MV 168,v,160,v,184
v_exp_f32 v92, v92
MA 16,a,240,v,176
v_exp_f32 v93, v93
MA 48,a,240,v,184
MA 20,a,244,v,176
global_load_dword v174, v[172:173], off
v_cvt_pk_bf16_f32 v89, v90, v91
MA 52,a,244,v,184
v_exp_f32 v94, v94
MA 24,a,248,v,176
v_exp_f32 v95, v95
MA 56,a,248,v,184
MA 28,a,252,v,176
v_cvt_pk_bf16_f32 v90, v92, v93
v_cvt_pk_bf16_f32 v91, v94, v95
MA 60,a,252,v,184
s_branch L_p3_s0_top
L_p3_s1m_top:
s_waitcnt lgkmcnt(0)
v_xor_b32 v11, 0x8000, v11
v_mfma_f32_16x16x32_bf16 v[80:83], a[128:131], v[16:19], 0
ds_read_b128 a[192:195], v11 offset:0
ds_read_b128 a[196:199], v11 offset:1024
v_mfma_f32_16x16x32_bf16 v[88:91], a[128:131], v[32:35], 0
v_exp_f32 v176, v176
MV 80,a,132,v,20
v_exp_f32 v177, v177
MV 88,a,132,v,36
ds_read_b128 a[200:203], v11 offset:2048
ds_read_b128 a[204:207], v11 offset:3072
MV 80,a,136,v,24
v_exp_f32 v178, v178
MV 88,a,136,v,40
v_exp_f32 v179, v179
MV 80,a,140,v,28
ds_read_b128 a[208:211], v11 offset:4096
v_cvt_pk_bf16_f32 v176, v176, v177
MV 88,a,140,v,44
ds_read_b128 a[212:215], v11 offset:5120
ds_read_b128 a[216:219], v11 offset:6144
v_mfma_f32_16x16x32_bf16 v[84:87], a[144:147], v[16:19], 0
v_exp_f32 v180, v180
v_mfma_f32_16x16x32_bf16 v[92:95], a[144:147], v[32:35], 0
v_exp_f32 v181, v181
MV 84,a,148,v,20
ds_read_b128 a[220:223], v11 offset:7168
v_cvt_pk_bf16_f32 v177, v178, v179
MV 92,a,148,v,36
v_exp_f32 v182, v182
MV 84,a,152,v,24
ds_read_b128 a[224:227], v11 offset:8192
ds_read_b128 a[228:231], v11 offset:9216
MV 92,a,152,v,40
v_exp_f32 v183, v183
MV 84,a,156,v,28
ds_read_b128 a[232:235], v11 offset:10240
v_cvt_pk_bf16_f32 v178, v180, v181
MV 92,a,156,v,44
v_exp_f32 v184, v184
v_mfma_f32_16x16x32_bf16 v[112:115], a[160:163], v[16:19], 0
ds_read_b128 a[236:239], v11 offset:11264
ds_read_b128 a[240:243], v11 offset:12288
v_mfma_f32_16x16x32_bf16 v[120:123], a[160:163], v[32:35], 0
v_exp_f32 v185, v185
MV 112,a,164,v,20
ds_read_b128 a[244:247], v11 offset:13312
v_cvt_pk_bf16_f32 v179, v182, v183
MV 120,a,164,v,36
v_exp_f32 v186, v186
MV 112,a,168,v,24
v_exp_f32 v187, v187
MV 120,a,168,v,40
ds_read_b128 a[248:251], v11 offset:14336
ds_read_b128 a[252:255], v11 offset:15360
MV 112,a,172,v,28
v_cvt_pk_bf16_f32 v184, v184, v185
v_add_u32 v246, 0, v13
MV 120,a,172,v,44
v_cmp_gt_i32_e64 s[84:85], 0, v246
v_cmp_gt_i32_e64 s[86:87], 1, v246
v_mfma_f32_16x16x32_bf16 v[116:119], a[176:179], v[16:19], 0
v_exp_f32 v188, v188
v_mfma_f32_16x16x32_bf16 v[124:127], a[176:179], v[32:35], 0
v_cmp_gt_i32_e64 s[88:89], 2, v246
v_cmp_gt_i32_e64 s[90:91], 3, v246
MV 116,a,180,v,20
v_cndmask_b32_e64 v80, v80, v14, s[84:85]
v_cndmask_b32_e64 v81, v81, v14, s[86:87]
MV 124,a,180,v,36
v_exp_f32 v189, v189
MV 116,a,184,v,24
v_cvt_pk_bf16_f32 v185, v186, v187
v_cndmask_b32_e64 v82, v82, v14, s[88:89]
MV 124,a,184,v,40
v_cndmask_b32_e64 v83, v83, v14, s[90:91]
v_add_u32 v247, -16, v13
MV 116,a,188,v,28
v_cmp_gt_i32_e64 s[92:93], 0, v247
v_cmp_gt_i32_e64 s[94:95], 1, v247
MV 124,a,188,v,44
v_exp_f32 v190, v190
v_exp_f32 v191, v191
v_cmp_gt_i32_e64 s[96:97], 2, v247
v_cmp_gt_i32_e64 s[98:99], 3, v247
v_cndmask_b32_e64 v84, v84, v14, s[92:93]
v_cvt_pk_bf16_f32 v186, v188, v189
v_cndmask_b32_e64 v85, v85, v14, s[94:95]
v_cndmask_b32_e64 v86, v86, v14, s[96:97]
v_cvt_pk_bf16_f32 v187, v190, v191
v_cndmask_b32_e64 v87, v87, v14, s[98:99]
s_waitcnt vmcnt(12) lgkmcnt(0)
MA 0,a,192,v,144
s_barrier
v_xor_b32 v10, 0x8000, v10
MA 32,a,192,v,152
ds_read_b128 a[128:131], v10 offset:0
ds_read_b128 a[132:135], v10 offset:1024
MA 4,a,196,v,144
v_exp_f32 v80, v80
MA 36,a,196,v,152
v_exp_f32 v81, v81
MA 8,a,200,v,144
ds_read_b128 a[136:139], v10 offset:2048
ds_read_b128 a[140:143], v10 offset:3072
MA 40,a,200,v,152
v_exp_f32 v82, v82
MA 12,a,204,v,144
ds_read_b128 a[144:147], v10 offset:4096
v_add_u32 v246, -32, v13
MA 44,a,204,v,152
v_exp_f32 v83, v83
MV 164,v,160,v,144
v_cvt_pk_bf16_f32 v80, v80, v81
v_cmp_gt_i32_e64 s[84:85], 0, v246
MV 168,v,160,v,152
ds_read_b128 a[148:151], v10 offset:5120
v_cmp_gt_i32_e64 s[86:87], 1, v246
MA 16,a,208,v,144
v_exp_f32 v84, v84
MA 48,a,208,v,152
ds_read_b128 a[152:155], v10 offset:6144
v_cmp_gt_i32_e64 s[88:89], 2, v246
MA 20,a,212,v,144
v_exp_f32 v85, v85
MA 52,a,212,v,152
ds_read_b128 a[156:159], v10 offset:7168
v_cmp_gt_i32_e64 s[90:91], 3, v246
MA 24,a,216,v,144
ds_read_b128 a[160:163], v10 offset:8192
v_cvt_pk_bf16_f32 v81, v82, v83
MA 56,a,216,v,152
v_exp_f32 v86, v86
MA 28,a,220,v,144
ds_read_b128 a[164:167], v10 offset:9216
v_cndmask_b32_e64 v112, v112, v14, s[84:85]
MA 60,a,220,v,152
v_exp_f32 v87, v87
MA 0,a,224,v,176
ds_read_b128 a[168:171], v10 offset:10240
v_cndmask_b32_e64 v113, v113, v14, s[86:87]
MA 32,a,224,v,184
v_cvt_pk_bf16_f32 v82, v84, v85
v_cndmask_b32_e64 v114, v114, v14, s[88:89]
MA 4,a,228,v,176
ds_read_b128 a[172:175], v10 offset:11264
v_cndmask_b32_e64 v115, v115, v14, s[90:91]
MA 36,a,228,v,184
v_exp_f32 v88, v88
MA 8,a,232,v,176
v_exp_f32 v89, v89
MA 40,a,232,v,184
ds_read_b128 a[176:179], v10 offset:12288
v_cvt_pk_bf16_f32 v83, v86, v87
MA 12,a,236,v,176
ds_read_b128 a[180:183], v10 offset:13312
v_add_u32 v247, -48, v13
MA 44,a,236,v,184
ds_read_b128 a[184:187], v10 offset:14336
v_cmp_gt_i32_e64 s[92:93], 0, v247
MV 164,v,160,v,176
v_exp_f32 v90, v90
MV 168,v,160,v,184
ds_read_b128 a[188:191], v10 offset:15360
v_cmp_gt_i32_e64 s[94:95], 1, v247
MA 16,a,240,v,176
v_exp_f32 v91, v91
MA 48,a,240,v,184
v_cvt_pk_bf16_f32 v88, v88, v89
v_cmp_gt_i32_e64 s[96:97], 2, v247
MA 20,a,244,v,176
v_exp_f32 v92, v92
MA 52,a,244,v,184
v_cmp_gt_i32_e64 s[98:99], 3, v247
v_cndmask_b32_e64 v116, v116, v14, s[92:93]
MA 24,a,248,v,176
v_exp_f32 v93, v93
MA 56,a,248,v,184
v_cvt_pk_bf16_f32 v89, v90, v91
v_cndmask_b32_e64 v117, v117, v14, s[94:95]
MA 28,a,252,v,176
v_exp_f32 v94, v94
MA 60,a,252,v,184
v_exp_f32 v95, v95
v_cndmask_b32_e64 v118, v118, v14, s[96:97]
v_cvt_pk_bf16_f32 v90, v92, v93
v_cndmask_b32_e64 v119, v119, v14, s[98:99]
v_cvt_pk_bf16_f32 v91, v94, v95
L_p3_s0m_top:
s_waitcnt lgkmcnt(0)
v_mfma_f32_16x16x32_bf16 v[152:155], a[128:131], v[32:35], 0
ds_read_b128 a[192:195], v11 offset:16384
ds_read_b128 a[196:199], v11 offset:17408
MV 152,a,132,v,36
v_exp_f32 v112, v112
MV 152,a,136,v,40
v_exp_f32 v113, v113
MV 152,a,140,v,44
ds_read_b128 a[200:203], v11 offset:18432
ds_read_b128 a[204:207], v11 offset:19456
v_mfma_f32_16x16x32_bf16 v[156:159], a[144:147], v[32:35], 0
v_exp_f32 v114, v114
MV 156,a,148,v,36
v_exp_f32 v115, v115
MV 156,a,152,v,40
ds_read_b128 a[208:211], v11 offset:20480
ds_read_b128 a[212:215], v11 offset:21504
MV 156,a,156,v,44
ds_read_b128 a[216:219], v11 offset:22528
v_cvt_pk_bf16_f32 v112, v112, v113
v_mfma_f32_16x16x32_bf16 v[184:187], a[160:163], v[32:35], 0
v_exp_f32 v116, v116
MV 184,a,164,v,36
v_exp_f32 v117, v117
MV 184,a,168,v,40
ds_read_b128 a[220:223], v11 offset:23552
v_cvt_pk_bf16_f32 v113, v114, v115
MV 184,a,172,v,44
v_exp_f32 v118, v118
v_mfma_f32_16x16x32_bf16 v[188:191], a[176:179], v[32:35], 0
ds_read_b128 a[224:227], v11 offset:24576
ds_read_b128 a[228:231], v11 offset:25600
MV 188,a,180,v,36
v_exp_f32 v119, v119
MV 188,a,184,v,40
ds_read_b128 a[232:235], v11 offset:26624
v_cvt_pk_bf16_f32 v114, v116, v117
MV 188,a,188,v,44
ds_read_b128 a[236:239], v11 offset:27648
ds_read_b128 a[240:243], v11 offset:28672
ds_read_b128 a[244:247], v11 offset:29696
ds_read_b128 a[248:251], v11 offset:30720
ds_read_b128 a[252:255], v11 offset:31744
v_exp_f32 v120, v120
v_exp_f32 v121, v121
v_cvt_pk_bf16_f32 v115, v118, v119
v_exp_f32 v122, v122
v_exp_f32 v123, v123
v_cvt_pk_bf16_f32 v120, v120, v121
v_exp_f32 v124, v124
v_exp_f32 v125, v125
v_cvt_pk_bf16_f32 v121, v122, v123
v_exp_f32 v126, v126
v_exp_f32 v127, v127
v_add_u32 v246, -64, v239
v_cmp_gt_i32_e64 s[84:85], 0, v246
v_cmp_gt_i32_e64 s[86:87], 1, v246
v_cmp_gt_i32_e64 s[88:89], 2, v246
v_cmp_gt_i32_e64 s[90:91], 3, v246
v_cndmask_b32_e64 v152, v152, v14, s[84:85]
v_cndmask_b32_e64 v153, v153, v14, s[86:87]
v_cndmask_b32_e64 v154, v154, v14, s[88:89]
v_cndmask_b32_e64 v155, v155, v14, s[90:91]
v_cvt_pk_bf16_f32 v122, v124, v125
v_cvt_pk_bf16_f32 v123, v126, v127
v_add_u32 v247, -80, v239
v_cmp_gt_i32_e64 s[92:93], 0, v247
v_cmp_gt_i32_e64 s[94:95], 1, v247
v_cmp_gt_i32_e64 s[96:97], 2, v247
v_cmp_gt_i32_e64 s[98:99], 3, v247
v_cndmask_b32_e64 v156, v156, v14, s[92:93]
v_cndmask_b32_e64 v157, v157, v14, s[94:95]
v_cndmask_b32_e64 v158, v158, v14, s[96:97]
v_cndmask_b32_e64 v159, v159, v14, s[98:99]
s_waitcnt vmcnt(4) lgkmcnt(0)
MA 0,a,192,v,80
s_barrier
MA 32,a,192,v,88
MA 4,a,196,v,80
v_lshlrev_b32 v245, 4, v1
s_mov_b32 m0, s43
MA 36,a,196,v,88
v_exp_f32 v152, v152
MA 8,a,200,v,80
MA 40,a,200,v,88
v_exp_f32 v153, v153
MA 12,a,204,v,80
v_add_u32 v246, -96, v239
v_cmp_gt_i32_e64 s[84:85], 0, v246
MA 44,a,204,v,88
MV 164,v,160,v,80
v_exp_f32 v154, v154
MV 168,v,160,v,88
s_nop 0
v_cmp_gt_i32_e64 s[86:87], 1, v246
MA 16,a,208,v,80
MA 48,a,208,v,88
v_cmp_gt_i32_e64 s[88:89], 2, v246
v_cmp_gt_i32_e64 s[90:91], 3, v246
MA 20,a,212,v,80
v_exp_f32 v155, v155
MA 52,a,212,v,88
MA 24,a,216,v,80
v_cvt_pk_bf16_f32 v152, v152, v153
v_cndmask_b32_e64 v184, v184, v14, s[84:85]
MA 56,a,216,v,88
MA 28,a,220,v,80
buffer_load_dwordx4 v245, s[20:23], 0 offen offset:0 sc1 lds
v_cndmask_b32_e64 v185, v185, v14, s[86:87]
MA 60,a,220,v,88
v_exp_f32 v156, v156
MA 0,a,224,v,112
v_cndmask_b32_e64 v186, v186, v14, s[88:89]
v_cndmask_b32_e64 v187, v187, v14, s[90:91]
MA 32,a,224,v,120
MA 4,a,228,v,112
v_exp_f32 v157, v157
MA 36,a,228,v,120
buffer_load_dwordx4 v245, s[20:23], 0 offen offset:1024 sc1 lds
v_add_u32 v247, -112, v239
MA 8,a,232,v,112
v_cvt_pk_bf16_f32 v153, v154, v155
v_cmp_gt_i32_e64 s[92:93], 0, v247
MA 40,a,232,v,120
MA 12,a,236,v,112
buffer_load_dwordx4 v245, s[20:23], 0 offen offset:2048 sc1 lds
v_cmp_gt_i32_e64 s[94:95], 1, v247
MA 44,a,236,v,120
v_exp_f32 v158, v158
MV 164,v,160,v,112
v_cmp_gt_i32_e64 s[96:97], 2, v247
v_cmp_gt_i32_e64 s[98:99], 3, v247
MV 168,v,160,v,120
MA 16,a,240,v,112
MA 48,a,240,v,120
v_exp_f32 v159, v159
MA 20,a,244,v,112
buffer_load_dwordx4 v245, s[20:23], 0 offen offset:3072 sc1 lds
v_cndmask_b32_e64 v188, v188, v14, s[92:93]
MA 52,a,244,v,120
v_cvt_pk_bf16_f32 v154, v156, v157
v_cndmask_b32_e64 v189, v189, v14, s[94:95]
MA 24,a,248,v,112
v_cvt_pk_bf16_f32 v155, v158, v159
v_cndmask_b32_e64 v190, v190, v14, s[96:97]
MA 56,a,248,v,120
MA 28,a,252,v,112
v_cndmask_b32_e64 v191, v191, v14, s[98:99]
MA 60,a,252,v,120
s_load_dwordx2 s[88:89], s[0:1], 104
s_waitcnt lgkmcnt(0)
v_xor_b32 v11, 0x8000, v11
ds_read_b128 a[192:195], v11 offset:0
ds_read_b128 a[196:199], v11 offset:1024
ds_read_b128 a[200:203], v11 offset:2048
ds_read_b128 a[204:207], v11 offset:3072
ds_read_b128 a[208:211], v11 offset:4096
ds_read_b128 a[212:215], v11 offset:5120
ds_read_b128 a[216:219], v11 offset:6144
ds_read_b128 a[220:223], v11 offset:7168
ds_read_b128 a[224:227], v11 offset:8192
ds_read_b128 a[228:231], v11 offset:9216
ds_read_b128 a[232:235], v11 offset:10240
ds_read_b128 a[236:239], v11 offset:11264
ds_read_b128 a[240:243], v11 offset:12288
ds_read_b128 a[244:247], v11 offset:13312
ds_read_b128 a[248:251], v11 offset:14336
ds_read_b128 a[252:255], v11 offset:15360
v_exp_f32 v184, v184
v_exp_f32 v185, v185
v_exp_f32 v186, v186
v_exp_f32 v187, v187
v_cvt_pk_bf16_f32 v184, v184, v185
v_exp_f32 v188, v188
v_exp_f32 v189, v189
v_cvt_pk_bf16_f32 v185, v186, v187
v_exp_f32 v190, v190
v_exp_f32 v191, v191
v_cvt_pk_bf16_f32 v186, v188, v189
v_cvt_pk_bf16_f32 v187, v190, v191
MV 168,v,160,v,152
s_nop 0
MV 168,v,160,v,184
v_mov_b32 v240, v2
v_mov_b32 v241, v3
s_nop 0
v_permlane32_swap_b32 v2, v240
v_permlane32_swap_b32 v3, v241
v_add_f32 v2, v2, v240
v_add_f32 v3, v3, v241
v_mov_b32 v240, v2
v_mov_b32 v241, v3
s_nop 0
v_permlane16_swap_b32 v2, v240
v_permlane16_swap_b32 v3, v241
v_add_f32 v2, v2, v240
v_add_f32 v3, v3, v241
v_add_f32 v2, v2, v164
v_cmp_nle_f32 vcc, 0x30800000, v2
s_nop 0
s_or_b64 s[78:79], s[78:79], vcc
v_cmp_nge_f32 vcc, 0x4e800000, v2
s_nop 0
s_or_b64 s[78:79], s[78:79], vcc
v_add_f32 v3, v3, v168
v_cmp_nle_f32 vcc, 0x30800000, v3
s_nop 0
s_or_b64 s[78:79], s[78:79], vcc
v_cmp_nge_f32 vcc, 0x4e800000, v3
s_nop 0
s_or_b64 s[78:79], s[78:79], vcc
s_cmp_lg_u64 s[78:79], 0
s_cselect_b32 s80, 1, 0
v_mov_b32 v240, s80
s_lshl_b32 s80, s3, 2
s_add_u32 s80, s80, 163824
v_mov_b32 v241, s80
ds_write_b32 v241, v240
v_mov_b32 v241, 163824
s_waitcnt vmcnt(0) lgkmcnt(0)
s_barrier
ds_read_b128 v[244:247], v241
buffer_store_dword v237, v236, s[8:11], s37 offen offset:1024 sc1
MA 32,a,192,v,152
MA 36,a,196,v,152
MA 40,a,200,v,152
MA 44,a,204,v,152
MA 48,a,208,v,152
MA 52,a,212,v,152
s_waitcnt lgkmcnt(0)
v_or3_b32 v240, v244, v245, v246
v_or_b32 v240, v240, v247
MA 56,a,216,v,152
v_cmp_ne_u32 vcc, 0, v240
MA 60,a,220,v,152
MA 32,a,224,v,184
s_cbranch_vccnz L_fallback
MA 36,a,228,v,184
s_mul_i32 s36, s3, 8320
v_and_b32 v16, 15, v1
MA 40,a,232,v,184
v_lshrrev_b32 v17, 4, v1
v_add_u32 v18, 1, v16
MA 44,a,236,v,184
v_and_b32 v19, 1, v18
v_mul_u32_u24 v19, 4160, v19
MA 48,a,240,v,184
v_add_u32 v18, 2, v16
v_lshrrev_b32 v18, 1, v18
MA 52,a,244,v,184
v_lshl_add_u32 v19, v18, 2, v19
v_lshl_add_u32 v19, v17, 4, v19
MA 56,a,248,v,184
v_add_u32 v40, s36, v19
v_add_u32 v41, 1024, v40
MA 60,a,252,v,184
v_add_u32 v42, 2048, v40
v_add_u32 v43, 3072, v40
v_add_u32 v10, s36, v232
v_lshlrev_b32 v18, 5, v16
v_lshlrev_b32 v19, 4, v17
v_sub_u32 v19, v19, v18
s_add_u32 s37, s43, 480
v_add_u32 v5, s37, v19
v_mov_b32 v20, 0
v_mov_b32 v21, 0
v_mov_b32 v22, 0
v_mov_b32 v23, 0
v_and_b32 v16, 1, v1
v_mul_u32_u24 v16, 4160, v16
v_and_b32 v17, 2, v1
v_lshl_add_u32 v16, v17, 3, v16
v_add_u32 v16, s36, v16
ds_write_b128 v16, v[20:23]
v_and_b32 v17, 31, v1
v_lshlrev_b32 v17, 4, v17
v_add_u32 v17, s43, v17
ds_write_b128 v17, v[20:23] offset:4096
v_mov_b32 v209, 0
ds_write_b128 v10, v[210:213] offset:32
s_nop 0
v_mov_b32_dpp v209, v213 wave_shr:1 row_mask:0xf bank_mask:0xf
v_alignbit_b32 v24, v210, v209, 16
v_alignbit_b32 v25, v211, v210, 16
v_alignbit_b32 v26, v212, v211, 16
v_alignbit_b32 v27, v213, v212, 16
ds_write_b128 v10, v[24:27] offset:4192
v_mov_b32_dpp v215, v213 wave_ror:1 row_mask:0xf bank_mask:0xf
ds_write_b128 v10, v[216:219] offset:1056
s_nop 0
v_mov_b32_dpp v215, v219 wave_shr:1 row_mask:0xf bank_mask:0xf
v_alignbit_b32 v28, v216, v215, 16
v_alignbit_b32 v29, v217, v216, 16
v_alignbit_b32 v30, v218, v217, 16
v_alignbit_b32 v31, v219, v218, 16
ds_write_b128 v10, v[28:31] offset:5216
v_mov_b32_dpp v221, v219 wave_ror:1 row_mask:0xf bank_mask:0xf
ds_write_b128 v10, v[222:225] offset:2080
s_nop 0
v_mov_b32_dpp v221, v225 wave_shr:1 row_mask:0xf bank_mask:0xf
v_alignbit_b32 v24, v222, v221, 16
v_alignbit_b32 v25, v223, v222, 16
v_alignbit_b32 v26, v224, v223, 16
v_alignbit_b32 v27, v225, v224, 16
ds_write_b128 v10, v[24:27] offset:6240
v_mov_b32_dpp v227, v225 wave_ror:1 row_mask:0xf bank_mask:0xf
ds_write_b128 v10, v[228:231] offset:3104
s_nop 0
v_mov_b32_dpp v227, v231 wave_shr:1 row_mask:0xf bank_mask:0xf
v_alignbit_b32 v28, v228, v227, 16
v_alignbit_b32 v29, v229, v228, 16
v_alignbit_b32 v30, v230, v229, 16
v_alignbit_b32 v31, v231, v230, 16
ds_write_b128 v10, v[28:31] offset:7264
ds_read_b128 a[160:163], v5 offset:3584
ds_read2_b32 a[128:129], v40 offset0:0 offset1:1
ds_read2_b32 a[130:131], v40 offset0:2 offset1:3
ds_read_b128 a[164:167], v5 offset:3072
ds_read2_b32 a[132:133], v40 offset0:128 offset1:129
ds_read2_b32 a[134:135], v40 offset0:130 offset1:131
ds_read_b128 a[168:171], v5 offset:2560
ds_read2_b32 a[136:137], v41 offset0:0 offset1:1
ds_read2_b32 a[138:139], v41 offset0:2 offset1:3
ds_read_b128 a[172:175], v5 offset:2048
ds_read2_b32 a[140:141], v41 offset0:128 offset1:129
ds_read2_b32 a[142:143], v41 offset0:130 offset1:131
ds_read_b128 a[176:179], v5 offset:1536
ds_read2_b32 a[144:145], v42 offset0:0 offset1:1
ds_read2_b32 a[146:147], v42 offset0:2 offset1:3
ds_read_b128 a[180:183], v5 offset:1024
ds_read2_b32 a[148:149], v42 offset0:128 offset1:129
ds_read2_b32 a[150:151], v42 offset0:130 offset1:131
ds_read_b128 a[184:187], v5 offset:512
ds_read2_b32 a[152:153], v43 offset0:0 offset1:1
ds_read2_b32 a[154:155], v43 offset0:2 offset1:3
ds_read_b128 a[188:191], v5 offset:0
ds_read2_b32 a[156:157], v43 offset0:128 offset1:129
ds_read2_b32 a[158:159], v43 offset0:130 offset1:131
v_rcp_f32 v2, v2
v_rcp_f32 v3, v3
s_add_u32 s80, s100, s76
s_nop 4
v_accvgpr_read_b32 v240, a0
v_accvgpr_read_b32 v241, a1
v_accvgpr_read_b32 v242, a2
v_accvgpr_read_b32 v243, a3
v_accvgpr_read_b32 v244, a4
v_accvgpr_read_b32 v245, a5
v_accvgpr_read_b32 v246, a6
v_accvgpr_read_b32 v247, a7
v_pk_mul_f32 v[240:241], v[240:241], v[2:3] op_sel:[0,0] op_sel_hi:[1,0]
v_pk_mul_f32 v[242:243], v[242:243], v[2:3] op_sel:[0,0] op_sel_hi:[1,0]
v_pk_mul_f32 v[244:245], v[244:245], v[2:3] op_sel:[0,0] op_sel_hi:[1,0]
v_pk_mul_f32 v[246:247], v[246:247], v[2:3] op_sel:[0,0] op_sel_hi:[1,0]
v_cvt_pk_bf16_f32 v248, v240, v241
v_cvt_pk_bf16_f32 v249, v242, v243
v_cvt_pk_bf16_f32 v250, v244, v245
v_cvt_pk_bf16_f32 v251, v246, v247
buffer_store_dwordx4 v[248:251], v15, s[60:63], s100 offen offset:0 sc1
v_accvgpr_read_b32 v240, a8
v_accvgpr_read_b32 v241, a9
v_accvgpr_read_b32 v242, a10
v_accvgpr_read_b32 v243, a11
v_accvgpr_read_b32 v244, a12
v_accvgpr_read_b32 v245, a13
v_accvgpr_read_b32 v246, a14
v_accvgpr_read_b32 v247, a15
v_pk_mul_f32 v[240:241], v[240:241], v[2:3] op_sel:[0,0] op_sel_hi:[1,0]
v_pk_mul_f32 v[242:243], v[242:243], v[2:3] op_sel:[0,0] op_sel_hi:[1,0]
v_pk_mul_f32 v[244:245], v[244:245], v[2:3] op_sel:[0,0] op_sel_hi:[1,0]
v_pk_mul_f32 v[246:247], v[246:247], v[2:3] op_sel:[0,0] op_sel_hi:[1,0]
v_cvt_pk_bf16_f32 v252, v240, v241
v_cvt_pk_bf16_f32 v253, v242, v243
v_cvt_pk_bf16_f32 v254, v244, v245
v_cvt_pk_bf16_f32 v255, v246, v247
buffer_store_dwordx4 v[252:255], v15, s[60:63], s100 offen offset:1024 sc1
v_accvgpr_read_b32 v240, a16
v_accvgpr_read_b32 v241, a17
v_accvgpr_read_b32 v242, a18
v_accvgpr_read_b32 v243, a19
v_accvgpr_read_b32 v244, a20
v_accvgpr_read_b32 v245, a21
v_accvgpr_read_b32 v246, a22
v_accvgpr_read_b32 v247, a23
v_pk_mul_f32 v[240:241], v[240:241], v[2:3] op_sel:[0,0] op_sel_hi:[1,0]
v_pk_mul_f32 v[242:243], v[242:243], v[2:3] op_sel:[0,0] op_sel_hi:[1,0]
v_pk_mul_f32 v[244:245], v[244:245], v[2:3] op_sel:[0,0] op_sel_hi:[1,0]
v_pk_mul_f32 v[246:247], v[246:247], v[2:3] op_sel:[0,0] op_sel_hi:[1,0]
v_cvt_pk_bf16_f32 v248, v240, v241
v_cvt_pk_bf16_f32 v249, v242, v243
v_cvt_pk_bf16_f32 v250, v244, v245
v_cvt_pk_bf16_f32 v251, v246, v247
buffer_store_dwordx4 v[248:251], v15, s[60:63], s100 offen offset:2048 sc1
v_accvgpr_read_b32 v240, a24
v_accvgpr_read_b32 v241, a25
v_accvgpr_read_b32 v242, a26
v_accvgpr_read_b32 v243, a27
v_accvgpr_read_b32 v244, a28
v_accvgpr_read_b32 v245, a29
v_accvgpr_read_b32 v246, a30
v_accvgpr_read_b32 v247, a31
v_pk_mul_f32 v[240:241], v[240:241], v[2:3] op_sel:[0,0] op_sel_hi:[1,0]
v_pk_mul_f32 v[242:243], v[242:243], v[2:3] op_sel:[0,0] op_sel_hi:[1,0]
v_pk_mul_f32 v[244:245], v[244:245], v[2:3] op_sel:[0,0] op_sel_hi:[1,0]
v_pk_mul_f32 v[246:247], v[246:247], v[2:3] op_sel:[0,0] op_sel_hi:[1,0]
v_cvt_pk_bf16_f32 v252, v240, v241
v_cvt_pk_bf16_f32 v253, v242, v243
v_cvt_pk_bf16_f32 v254, v244, v245
v_cvt_pk_bf16_f32 v255, v246, v247
buffer_store_dwordx4 v[252:255], v15, s[60:63], s100 offen offset:3072 sc1
v_accvgpr_read_b32 v240, a32
v_accvgpr_read_b32 v241, a33
v_accvgpr_read_b32 v242, a34
v_accvgpr_read_b32 v243, a35
v_accvgpr_read_b32 v244, a36
v_accvgpr_read_b32 v245, a37
v_accvgpr_read_b32 v246, a38
v_accvgpr_read_b32 v247, a39
v_pk_mul_f32 v[240:241], v[240:241], v[2:3] op_sel:[0,1] op_sel_hi:[1,1]
v_pk_mul_f32 v[242:243], v[242:243], v[2:3] op_sel:[0,1] op_sel_hi:[1,1]
v_pk_mul_f32 v[244:245], v[244:245], v[2:3] op_sel:[0,1] op_sel_hi:[1,1]
v_pk_mul_f32 v[246:247], v[246:247], v[2:3] op_sel:[0,1] op_sel_hi:[1,1]
v_cvt_pk_bf16_f32 v248, v240, v241
v_cvt_pk_bf16_f32 v249, v242, v243
v_cvt_pk_bf16_f32 v250, v244, v245
v_cvt_pk_bf16_f32 v251, v246, v247
buffer_store_dwordx4 v[248:251], v15, s[60:63], s80 offen offset:0 sc1
v_accvgpr_read_b32 v240, a40
v_accvgpr_read_b32 v241, a41
v_accvgpr_read_b32 v242, a42
v_accvgpr_read_b32 v243, a43
v_accvgpr_read_b32 v244, a44
v_accvgpr_read_b32 v245, a45
v_accvgpr_read_b32 v246, a46
v_accvgpr_read_b32 v247, a47
v_pk_mul_f32 v[240:241], v[240:241], v[2:3] op_sel:[0,1] op_sel_hi:[1,1]
v_pk_mul_f32 v[242:243], v[242:243], v[2:3] op_sel:[0,1] op_sel_hi:[1,1]
v_pk_mul_f32 v[244:245], v[244:245], v[2:3] op_sel:[0,1] op_sel_hi:[1,1]
v_pk_mul_f32 v[246:247], v[246:247], v[2:3] op_sel:[0,1] op_sel_hi:[1,1]
v_cvt_pk_bf16_f32 v252, v240, v241
v_cvt_pk_bf16_f32 v253, v242, v243
v_cvt_pk_bf16_f32 v254, v244, v245
v_cvt_pk_bf16_f32 v255, v246, v247
buffer_store_dwordx4 v[252:255], v15, s[60:63], s80 offen offset:1024 sc1
v_accvgpr_read_b32 v240, a48
v_accvgpr_read_b32 v241, a49
v_accvgpr_read_b32 v242, a50
v_accvgpr_read_b32 v243, a51
v_accvgpr_read_b32 v244, a52
v_accvgpr_read_b32 v245, a53
v_accvgpr_read_b32 v246, a54
v_accvgpr_read_b32 v247, a55
v_pk_mul_f32 v[240:241], v[240:241], v[2:3] op_sel:[0,1] op_sel_hi:[1,1]
v_pk_mul_f32 v[242:243], v[242:243], v[2:3] op_sel:[0,1] op_sel_hi:[1,1]
v_pk_mul_f32 v[244:245], v[244:245], v[2:3] op_sel:[0,1] op_sel_hi:[1,1]
v_pk_mul_f32 v[246:247], v[246:247], v[2:3] op_sel:[0,1] op_sel_hi:[1,1]
v_cvt_pk_bf16_f32 v248, v240, v241
v_cvt_pk_bf16_f32 v249, v242, v243
v_cvt_pk_bf16_f32 v250, v244, v245
v_cvt_pk_bf16_f32 v251, v246, v247
buffer_store_dwordx4 v[248:251], v15, s[60:63], s80 offen offset:2048 sc1
v_accvgpr_read_b32 v240, a56
v_accvgpr_read_b32 v241, a57
v_accvgpr_read_b32 v242, a58
v_accvgpr_read_b32 v243, a59
v_accvgpr_read_b32 v244, a60
v_accvgpr_read_b32 v245, a61
v_accvgpr_read_b32 v246, a62
v_accvgpr_read_b32 v247, a63
v_pk_mul_f32 v[240:241], v[240:241], v[2:3] op_sel:[0,1] op_sel_hi:[1,1]
v_pk_mul_f32 v[242:243], v[242:243], v[2:3] op_sel:[0,1] op_sel_hi:[1,1]
v_pk_mul_f32 v[244:245], v[244:245], v[2:3] op_sel:[0,1] op_sel_hi:[1,1]
v_pk_mul_f32 v[246:247], v[246:247], v[2:3] op_sel:[0,1] op_sel_hi:[1,1]
v_cvt_pk_bf16_f32 v252, v240, v241
v_cvt_pk_bf16_f32 v253, v242, v243
v_cvt_pk_bf16_f32 v254, v244, v245
v_cvt_pk_bf16_f32 v255, v246, v247
buffer_store_dwordx4 v[252:255], v15, s[60:63], s80 offen offset:3072 sc1
L_p3_done:
s_nop 1
v_lshlrev_b32 v255, 20, v1
v_mov_b32 v253, 1
s_lshl_b32 s83, s3, 8
s_add_u32 s83, s83, s2
s_lshl_b32 s83, s83, 2
s_add_u32 s83, s83, 4096
s_waitcnt lgkmcnt(15)
v_mfma_f32_16x16x32_bf16 v[76:79], a[128:131], a[160:163], 0
v_and_b32 v16, 15, v1
v_lshrrev_b32 v17, 4, v1
v_mfma_f32_16x16x32_bf16 v[80:83], a[128:131], a[164:167], 0
v_lshl_add_u32 v18, v17, 3, v16
ds_read_b128 a[224:227], v5 offset:3648
v_mfma_f32_16x16x32_bf16 v[84:87], a[128:131], a[168:171], 0
v_sub_u32 v235, 15, v18
ds_read2_b32 a[192:193], v40 offset0:16 offset1:17
s_waitcnt lgkmcnt(15)
v_mfma_f32_16x16x32_bf16 v[88:91], a[128:131], a[172:175], 0
v_lshlrev_b32 v18, 16, v234
ds_read2_b32 a[194:195], v40 offset0:18 offset1:19
s_waitcnt lgkmcnt(14)
v_mfma_f32_16x16x32_bf16 v[92:95], a[128:131], a[176:179], 0
v_cmp_eq_u32 vcc, 0, v235
v_cmp_eq_u32_e64 s[38:39], 1, v235
s_waitcnt lgkmcnt(11)
v_mfma_f32_16x16x32_bf16 v[96:99], a[128:131], a[180:183], 0
ds_read_b128 a[228:231], v5 offset:3136
ds_read2_b32 a[196:197], v40 offset0:144 offset1:145
s_waitcnt lgkmcnt(10)
v_mfma_f32_16x16x32_bf16 v[100:103], a[128:131], a[184:187], 0
s_nop 0
v_cndmask_b32 v44, 0, v234, vcc
s_waitcnt lgkmcnt(7)
v_mfma_f32_16x16x32_bf16 v[104:107], a[128:131], a[188:191], 0
ds_read2_b32 a[198:199], v40 offset0:146 offset1:147
ds_read_b128 a[232:235], v5 offset:2624
MV 80,a,132,a,160
v_cndmask_b32_e64 v44, v44, v18, s[38:39]
ds_read2_b32 a[200:201], v41 offset0:16 offset1:17
MV 84,a,132,a,164
v_cmp_eq_u32 vcc, 2, v235
v_cmp_eq_u32_e64 s[38:39], 3, v235
MV 88,a,132,a,168
ds_read2_b32 a[202:203], v41 offset0:18 offset1:19
s_and_b32 s81, s2, 3
MV 92,a,132,a,172
s_nop 0
v_cndmask_b32 v45, 0, v234, vcc
MV 96,a,132,a,176
ds_read_b128 a[236:239], v5 offset:2112
ds_read2_b32 a[204:205], v41 offset0:144 offset1:145
MV 100,a,132,a,180
v_cndmask_b32_e64 v45, v45, v18, s[38:39]
ds_read2_b32 a[206:207], v41 offset0:146 offset1:147
MV 104,a,132,a,184
v_cmp_eq_u32 vcc, 4, v235
v_cmp_eq_u32_e64 s[38:39], 5, v235
MV 84,a,136,a,160
ds_read_b128 a[240:243], v5 offset:1600
s_lshl_b32 s81, s81, 1
MV 88,a,136,a,164
s_nop 0
v_cndmask_b32 v46, 0, v234, vcc
MV 92,a,136,a,168
ds_read2_b32 a[208:209], v42 offset0:16 offset1:17
ds_read2_b32 a[210:211], v42 offset0:18 offset1:19
MV 96,a,136,a,172
v_cndmask_b32_e64 v46, v46, v18, s[38:39]
ds_read_b128 a[244:247], v5 offset:1088
MV 100,a,136,a,176
v_cmp_eq_u32 vcc, 6, v235
v_cmp_eq_u32_e64 s[38:39], 7, v235
MV 104,a,136,a,180
ds_read2_b32 a[212:213], v42 offset0:144 offset1:145
s_sub_u32 s74, 14, s81
MV 88,a,140,a,160
s_nop 0
v_cndmask_b32 v47, 0, v234, vcc
MV 92,a,140,a,164
ds_read2_b32 a[214:215], v42 offset0:146 offset1:147
ds_read_b128 a[248:251], v5 offset:576
MV 96,a,140,a,168
v_cndmask_b32_e64 v47, v47, v18, s[38:39]
ds_read2_b32 a[216:217], v43 offset0:16 offset1:17
MV 100,a,140,a,172
s_bitcmp1_b32 s2, 4
s_cselect_b32 s81, s74, s81
MV 104,a,140,a,176
ds_read2_b32 a[218:219], v43 offset0:18 offset1:19
s_bfe_u32 s74, s2, 0x10003
MV 92,a,144,a,160
ds_read_b128 a[252:255], v5 offset:64
s_add_u32 s81, s81, s74
MV 96,a,144,a,164
ds_read2_b32 a[220:221], v43 offset0:144 offset1:145
s_bfe_u32 s82, s2, 0x10002
MV 100,a,144,a,168
ds_read2_b32 a[222:223], v43 offset0:146 offset1:147
s_lshr_b32 s74, s2, 5
MV 104,a,144,a,172
s_lshl_b32 s74, s74, 1
s_add_u32 s82, s82, s74
MV 96,a,148,a,160
s_mov_b32 s72, s81
s_mov_b32 s73, s82
MV 100,a,148,a,164
s_lshl_b32 s74, s72, 2
s_add_u32 s74, s74, s3
MV 104,a,148,a,168
s_lshl_b32 s68, s74, 18
MV 100,a,152,a,160
MV 104,a,152,a,164
s_and_b32 s80, s73, 1
s_waitcnt lgkmcnt(15)
MV 104,a,156,a,160
MV 76,v,44,a,160
s_lshl_b32 s75, s80, 16
MV 80,v,44,a,164
MV 84,v,44,a,168
s_add_u32 s68, s68, s75
MV 88,v,44,a,172
MV 92,v,44,a,176
s_lshl_b32 s69, s73, 19
MV 96,v,44,a,180
MV 100,v,44,a,184
MV 104,v,44,a,188
s_waitcnt vmcnt(0)
buffer_store_dword v253, v255, s[8:11], s83 offen sc1
MV 76,a,192,a,224
ds_read_b128 a[160:163], v5 offset:3712
s_lshl_b32 s75, s73, 7
MV 80,a,196,a,224
ds_read2_b32 a[128:129], v40 offset0:32 offset1:33
s_lshl_b32 s70, s3, 12
MV 80,a,192,a,228
ds_read2_b32 a[130:131], v40 offset0:34 offset1:35
s_lshl_b32 s78, s74, 16
MV 84,a,196,a,228
ds_read_b128 a[164:167], v5 offset:3200
s_add_u32 s78, s78, s75
MV 84,a,192,a,232
s_lshl_b32 s79, s73, 18
s_lshl_b32 s75, s74, 8
MV 88,a,196,a,232
ds_read2_b32 a[132:133], v40 offset0:160 offset1:161
s_add_u32 s79, s79, s75
s_waitcnt lgkmcnt(15)
MV 88,a,192,a,236
ds_read2_b32 a[134:135], v40 offset0:162 offset1:163
v_lshlrev_b32 v236, 4, v1
MV 92,a,196,a,236
ds_read_b128 a[168:171], v5 offset:2688
v_add_u32 v237, 0x20000, v236
MV 92,a,192,a,240
ds_read2_b32 a[136:137], v41 offset0:32 offset1:33
v_add_u32 v238, s70, v236
MV 96,a,196,a,240
s_lshl_b32 s75, s80, 12
v_add_u32 v244, s75, v236
s_waitcnt lgkmcnt(15)
MV 96,a,192,a,244
ds_read2_b32 a[138:139], v41 offset0:34 offset1:35
v_xor_b32 v245, 0x1000, v244
MV 100,a,196,a,244
ds_read_b128 a[172:175], v5 offset:2176
v_add_u32 v242, 66560, v244
s_waitcnt lgkmcnt(15)
MV 100,a,192,a,248
ds_read2_b32 a[140:141], v41 offset0:160 offset1:161
v_add_u32 v243, 66560, v245
MV 104,a,196,a,248
ds_read2_b32 a[142:143], v41 offset0:162 offset1:163
v_bfe_u32 v50, v1, 4, 1
s_waitcnt lgkmcnt(14)
MV 104,a,192,a,252
v_lshrrev_b32 v52, 5, v1
v_and_b32 v48, 15, v1
MV 84,a,200,a,224
ds_read_b128 a[176:179], v5 offset:1664
v_lshlrev_b32 v53, 5, v50
MV 88,a,204,a,224
ds_read2_b32 a[144:145], v42 offset0:32 offset1:33
v_lshl_add_u32 v53, v52, 4, v53
MV 88,a,200,a,228
ds_read2_b32 a[146:147], v42 offset0:34 offset1:35
v_lshl_add_u32 v250, v48, 11, v53
MV 92,a,204,a,228
ds_read_b128 a[180:183], v5 offset:1152
v_lshlrev_b32 v53, 11, v53
MV 92,a,200,a,232
v_lshl_add_u32 v251, v48, 3, v53
MV 96,a,204,a,232
ds_read2_b32 a[148:149], v42 offset0:160 offset1:161
MV 96,a,200,a,236
ds_read2_b32 a[150:151], v42 offset0:162 offset1:163
MV 100,a,204,a,236
ds_read_b128 a[184:187], v5 offset:640
MV 100,a,200,a,240
ds_read2_b32 a[152:153], v43 offset0:32 offset1:33
MV 104,a,204,a,240
s_add_u32 s44, s40, 33554432
s_addc_u32 s45, s41, 0
MV 104,a,200,a,244
ds_read2_b32 a[154:155], v43 offset0:34 offset1:35
s_mov_b32 s46, 16777216
MV 92,a,208,a,224
ds_read_b128 a[188:191], v5 offset:128
s_mov_b32 s47, 0x20000
MV 96,a,212,a,224
ds_read2_b32 a[156:157], v43 offset0:160 offset1:161
MV 96,a,208,a,228
ds_read2_b32 a[158:159], v43 offset0:162 offset1:163
MV 100,a,212,a,228
s_add_u32 s48, s40, 100663296
s_addc_u32 s49, s41, 0
MV 100,a,208,a,232
s_mov_b32 s50, 8388608
s_mov_b32 s51, 0x20000
MV 104,a,212,a,232
s_add_u32 s52, s40, 109051904
s_addc_u32 s53, s41, 0
MV 104,a,208,a,236
s_mov_b32 s54, 4194304
s_mov_b32 s55, 0x20000
MV 100,a,216,a,224
s_add_u32 s56, s40, 54525952
s_addc_u32 s57, s41, 0
s_waitcnt lgkmcnt(15)
MV 104,a,220,a,224
s_mov_b32 s58, 4194304
s_mov_b32 s59, 0x20000
MV 104,a,216,a,228
s_mov_b32 s60, s88
s_mov_b32 s61, s89
s_mov_b32 s62, 4194304
s_mov_b32 s63, 0x20000
s_lshr_b32 s36, s82, 1
s_lshl_b32 s37, s80, 7
s_add_u32 s36, s36, s37
v_lshl_add_u32 v254, v1, 3, s36
s_xor_b32 s36, s2, 4
v_mov_b32 v253, s36
v_cmp_lt_u32 vcc, 15, v1
s_nop 1
v_cndmask_b32 v254, v254, v253, vcc
v_lshlrev_b32 v254, 2, v254
buffer_load_dword v253, v254, s[8:11], 0 offen offset:1024 sc1
MV 76,a,128,a,160
ds_read_b128 a[224:227], v5 offset:3776
s_sub_u32 s36, 15, s81
MV 80,a,132,a,160
ds_read2_b32 a[192:193], v40 offset0:48 offset1:49
s_min_u32 s36, s36, s81
MV 80,a,128,a,164
ds_read2_b32 a[194:195], v40 offset0:50 offset1:51
MV 84,a,132,a,164
ds_read_b128 a[228:231], v5 offset:3264
s_lshr_b32 s37, s36, 1
MV 84,a,128,a,168
MV 88,a,132,a,168
ds_read2_b32 a[196:197], v40 offset0:176 offset1:177
s_xor_b32 s36, s36, s37
s_waitcnt lgkmcnt(15)
MV 88,a,128,a,172
ds_read2_b32 a[198:199], v40 offset0:178 offset1:179
s_and_b32 s36, s36, 1
MV 92,a,132,a,172
ds_read_b128 a[232:235], v5 offset:2752
MV 92,a,128,a,176
ds_read2_b32 a[200:201], v41 offset0:48 offset1:49
s_lshl_b32 s37, s37, 6
MV 96,a,132,a,176
s_waitcnt lgkmcnt(15)
MV 96,a,128,a,180
ds_read2_b32 a[202:203], v41 offset0:50 offset1:51
s_add_u32 s36, s36, s37
MV 100,a,132,a,180
ds_read_b128 a[236:239], v5 offset:2240
s_lshl_b32 s37, s80, 2
s_waitcnt lgkmcnt(15)
MV 100,a,128,a,184
ds_read2_b32 a[204:205], v41 offset0:176 offset1:177
MV 104,a,132,a,184
ds_read2_b32 a[206:207], v41 offset0:178 offset1:179
s_add_u32 s36, s36, s37
s_waitcnt lgkmcnt(14)
MV 104,a,128,a,188
MV 84,a,136,a,160
ds_read_b128 a[240:243], v5 offset:1728
s_add_u32 s36, s36, 1024
MV 88,a,140,a,160
ds_read2_b32 a[208:209], v42 offset0:48 offset1:49
v_bfe_u32 v228, v1, 4, 1
MV 88,a,136,a,164
ds_read2_b32 a[210:211], v42 offset0:50 offset1:51
MV 92,a,140,a,164
ds_read_b128 a[244:247], v5 offset:1216
v_lshl_add_u32 v228, s3, 1, v228
MV 92,a,136,a,168
MV 96,a,140,a,168
ds_read2_b32 a[212:213], v42 offset0:176 offset1:177
v_sub_u32 v229, 7, v228
MV 96,a,136,a,172
ds_read2_b32 a[214:215], v42 offset0:178 offset1:179
v_min_u32 v228, v228, v229
MV 100,a,140,a,172
ds_read_b128 a[248:251], v5 offset:704
MV 100,a,136,a,176
ds_read2_b32 a[216:217], v43 offset0:48 offset1:49
v_lshl_add_u32 v229, v228, 8, s36
MV 104,a,140,a,176
MV 104,a,136,a,180
ds_read2_b32 a[218:219], v43 offset0:50 offset1:51
v_and_b32 v252, 7, v1
MV 92,a,144,a,160
ds_read_b128 a[252:255], v5 offset:192
v_lshlrev_b32 v252, 3, v252
MV 96,a,148,a,160
ds_read2_b32 a[220:221], v43 offset0:176 offset1:177
MV 96,a,144,a,164
ds_read2_b32 a[222:223], v43 offset0:178 offset1:179
v_bfe_u32 v228, v1, 3, 1
MV 100,a,148,a,164
MV 100,a,144,a,168
v_lshlrev_b32 v228, 1, v228
MV 104,a,148,a,168
v_add3_u32 v252, v252, v228, v229
MV 104,a,144,a,172
MV 100,a,152,a,160
v_lshlrev_b32 v252, 2, v252
s_waitcnt lgkmcnt(15)
MV 104,a,156,a,160
MV 104,a,152,a,164
s_waitcnt vmcnt(0)
v_cmp_gt_u32 vcc, 1, v253
s_nop 4
s_cbranch_vccnz L_spin_w
L_spin_w_ret:
MV 76,a,192,a,224
ds_read_b128 a[160:163], v5 offset:3840
s_add_u32 m0, s70, 66560
MV 80,a,196,a,224
ds_read2_b32 a[128:129], v40 offset0:64 offset1:65
v_lshlrev_b32 v255, 20, v1
MV 80,a,192,a,228
ds_read2_b32 a[130:131], v40 offset0:66 offset1:67
buffer_load_dwordx4 v238, s[48:51], s69 offen offset:0 sc1 lds
MV 84,a,196,a,228
ds_read_b128 a[164:167], v5 offset:3328
MV 84,a,192,a,232
MV 88,a,196,a,232
ds_read2_b32 a[132:133], v40 offset0:192 offset1:193
buffer_load_dwordx4 v238, s[48:51], s69 offen offset:1024 sc1 lds
s_waitcnt lgkmcnt(15)
MV 88,a,192,a,236
ds_read2_b32 a[134:135], v40 offset0:194 offset1:195
MV 92,a,196,a,236
ds_read_b128 a[168:171], v5 offset:2816
MV 92,a,192,a,240
ds_read2_b32 a[136:137], v41 offset0:64 offset1:65
buffer_load_dwordx4 v238, s[48:51], s69 offen offset:2048 sc1 lds
MV 96,a,196,a,240
s_waitcnt lgkmcnt(15)
MV 96,a,192,a,244
ds_read2_b32 a[138:139], v41 offset0:66 offset1:67
MV 100,a,196,a,244
ds_read_b128 a[172:175], v5 offset:2304
buffer_load_dwordx4 v238, s[48:51], s69 offen offset:3072 sc1 lds
s_waitcnt lgkmcnt(15)
MV 100,a,192,a,248
ds_read2_b32 a[140:141], v41 offset0:192 offset1:193
s_lshl_b32 s36, s3, 26
MV 104,a,196,a,248
ds_read2_b32 a[142:143], v41 offset0:194 offset1:195
s_waitcnt lgkmcnt(14)
MV 104,a,192,a,252
s_add_u32 s69, s69, 16384
MV 84,a,200,a,224
ds_read_b128 a[176:179], v5 offset:1792
MV 88,a,204,a,224
ds_read2_b32 a[144:145], v42 offset0:64 offset1:65
MV 88,a,200,a,228
ds_read2_b32 a[146:147], v42 offset0:66 offset1:67
s_add_u32 m0, s70, 82944
MV 92,a,204,a,228
ds_read_b128 a[180:183], v5 offset:1280
MV 92,a,200,a,232
MV 96,a,204,a,232
ds_read2_b32 a[148:149], v42 offset0:192 offset1:193
buffer_load_dwordx4 v238, s[48:51], s69 offen offset:0 sc1 lds
MV 96,a,200,a,236
ds_read2_b32 a[150:151], v42 offset0:194 offset1:195
MV 100,a,204,a,236
ds_read_b128 a[184:187], v5 offset:768
MV 100,a,200,a,240
ds_read2_b32 a[152:153], v43 offset0:64 offset1:65
buffer_load_dwordx4 v238, s[48:51], s69 offen offset:1024 sc1 lds
MV 104,a,204,a,240
v_add_u32 v255, s36, v255
MV 104,a,200,a,244
ds_read2_b32 a[154:155], v43 offset0:66 offset1:67
MV 92,a,208,a,224
ds_read_b128 a[188:191], v5 offset:256
buffer_load_dwordx4 v238, s[48:51], s69 offen offset:2048 sc1 lds
MV 96,a,212,a,224
ds_read2_b32 a[156:157], v43 offset0:192 offset1:193
MV 96,a,208,a,228
ds_read2_b32 a[158:159], v43 offset0:194 offset1:195
MV 100,a,212,a,228
buffer_load_dwordx4 v238, s[48:51], s69 offen offset:3072 sc1 lds
MV 100,a,208,a,232
MV 104,a,212,a,232
MV 104,a,208,a,236
s_add_u32 s69, s69, 16384
MV 100,a,216,a,224
s_waitcnt lgkmcnt(15)
MV 104,a,220,a,224
MV 104,a,216,a,228
MV 76,a,128,a,160
ds_read_b128 a[224:227], v5 offset:3904
s_add_u32 m0, s70, 99328
MV 80,a,132,a,160
ds_read2_b32 a[192:193], v40 offset0:80 offset1:81
v_mul_u32_u24 v18, 136, v16
MV 80,a,128,a,164
ds_read2_b32 a[194:195], v40 offset0:82 offset1:83
v_lshl_add_u32 v18, v17, 5, v18
MV 84,a,132,a,164
ds_read_b128 a[228:231], v5 offset:3392
MV 84,a,128,a,168
MV 88,a,132,a,168
ds_read2_b32 a[196:197], v40 offset0:208 offset1:209
buffer_load_dwordx4 v238, s[48:51], s69 offen offset:0 sc1 lds
s_waitcnt lgkmcnt(15)
MV 88,a,128,a,172
ds_read2_b32 a[198:199], v40 offset0:210 offset1:211
s_lshl_b32 s37, s3, 1
MV 92,a,132,a,172
ds_read_b128 a[232:235], v5 offset:2880
s_add_u32 s37, s37, 49152
MV 92,a,128,a,176
ds_read2_b32 a[200:201], v41 offset0:80 offset1:81
MV 96,a,132,a,176
s_waitcnt lgkmcnt(15)
MV 96,a,128,a,180
ds_read2_b32 a[202:203], v41 offset0:82 offset1:83
v_add_u32 v11, s37, v18
MV 100,a,132,a,180
ds_read_b128 a[236:239], v5 offset:2368
buffer_load_dwordx4 v238, s[48:51], s69 offen offset:1024 sc1 lds
s_waitcnt lgkmcnt(15)
MV 100,a,128,a,184
ds_read2_b32 a[204:205], v41 offset0:208 offset1:209
v_lshrrev_b32 v18, 3, v1
MV 104,a,132,a,184
ds_read2_b32 a[206:207], v41 offset0:210 offset1:211
s_waitcnt lgkmcnt(14)
MV 104,a,128,a,188
MV 84,a,136,a,160
ds_read_b128 a[240:243], v5 offset:1856
v_mul_u32_u24 v18, 136, v18
MV 88,a,140,a,160
ds_read2_b32 a[208:209], v42 offset0:80 offset1:81
MV 88,a,136,a,164
ds_read2_b32 a[210:211], v42 offset0:82 offset1:83
buffer_load_dwordx4 v238, s[48:51], s69 offen offset:2048 sc1 lds
MV 92,a,140,a,164
ds_read_b128 a[244:247], v5 offset:1344
v_and_b32 v19, 7, v1
MV 92,a,136,a,168
MV 96,a,140,a,168
ds_read2_b32 a[212:213], v42 offset0:208 offset1:209
v_lshl_add_u32 v18, v19, 4, v18
MV 96,a,136,a,172
ds_read2_b32 a[214:215], v42 offset0:210 offset1:211
MV 100,a,140,a,172
ds_read_b128 a[248:251], v5 offset:832
s_mul_i32 s37, s3, 4352
MV 100,a,136,a,176
ds_read2_b32 a[216:217], v43 offset0:80 offset1:81
buffer_load_dwordx4 v238, s[48:51], s69 offen offset:3072 sc1 lds
MV 104,a,140,a,176
MV 104,a,136,a,180
ds_read2_b32 a[218:219], v43 offset0:82 offset1:83
s_add_u32 s37, s37, 49152
MV 92,a,144,a,160
ds_read_b128 a[252:255], v5 offset:320
MV 96,a,148,a,160
ds_read2_b32 a[220:221], v43 offset0:208 offset1:209
v_add_u32 v12, s37, v18
MV 96,a,144,a,164
ds_read2_b32 a[222:223], v43 offset0:210 offset1:211
MV 100,a,148,a,164
s_add_u32 s69, s69, 16384
MV 100,a,144,a,168
s_lshl_b32 s37, s3, 12
MV 104,a,148,a,168
MV 104,a,144,a,172
v_add_u32 v13, s37, v232
MV 100,a,152,a,160
s_waitcnt lgkmcnt(15)
MV 104,a,156,a,160
MV 104,a,152,a,164
buffer_load_dword v253, v252, s[8:11], 0 offen sc1
MV 76,a,192,a,224
ds_read_b128 a[160:163], v5 offset:3968
MV 80,a,196,a,224
ds_read2_b32 a[128:129], v40 offset0:96 offset1:97
MV 80,a,192,a,228
ds_read2_b32 a[130:131], v40 offset0:98 offset1:99
MV 84,a,196,a,228
ds_read_b128 a[164:167], v5 offset:3456
MV 84,a,192,a,232
MV 88,a,196,a,232
ds_read2_b32 a[132:133], v40 offset0:224 offset1:225
s_waitcnt lgkmcnt(15)
MV 88,a,192,a,236
ds_read2_b32 a[134:135], v40 offset0:226 offset1:227
MV 92,a,196,a,236
ds_read_b128 a[168:171], v5 offset:2944
MV 92,a,192,a,240
ds_read2_b32 a[136:137], v41 offset0:96 offset1:97
MV 96,a,196,a,240
s_waitcnt lgkmcnt(15)
MV 96,a,192,a,244
ds_read2_b32 a[138:139], v41 offset0:98 offset1:99
MV 100,a,196,a,244
ds_read_b128 a[172:175], v5 offset:2432
s_waitcnt lgkmcnt(15)
MV 100,a,192,a,248
ds_read2_b32 a[140:141], v41 offset0:224 offset1:225
MV 104,a,196,a,248
ds_read2_b32 a[142:143], v41 offset0:226 offset1:227
s_waitcnt lgkmcnt(14)
MV 104,a,192,a,252
MV 84,a,200,a,224
ds_read_b128 a[176:179], v5 offset:1920
MV 88,a,204,a,224
ds_read2_b32 a[144:145], v42 offset0:96 offset1:97
MV 88,a,200,a,228
ds_read2_b32 a[146:147], v42 offset0:98 offset1:99
MV 92,a,204,a,228
ds_read_b128 a[180:183], v5 offset:1408
MV 92,a,200,a,232
MV 96,a,204,a,232
ds_read2_b32 a[148:149], v42 offset0:224 offset1:225
MV 96,a,200,a,236
ds_read2_b32 a[150:151], v42 offset0:226 offset1:227
MV 100,a,204,a,236
ds_read_b128 a[184:187], v5 offset:896
MV 100,a,200,a,240
ds_read2_b32 a[152:153], v43 offset0:96 offset1:97
MV 104,a,204,a,240
MV 104,a,200,a,244
ds_read2_b32 a[154:155], v43 offset0:98 offset1:99
MV 92,a,208,a,224
ds_read_b128 a[188:191], v5 offset:384
MV 96,a,212,a,224
ds_read2_b32 a[156:157], v43 offset0:224 offset1:225
MV 96,a,208,a,228
ds_read2_b32 a[158:159], v43 offset0:226 offset1:227
MV 100,a,212,a,228
MV 100,a,208,a,232
MV 104,a,212,a,232
MV 104,a,208,a,236
MV 100,a,216,a,224
s_waitcnt lgkmcnt(15)
MV 104,a,220,a,224
MV 104,a,216,a,228
s_waitcnt vmcnt(0)
v_cmp_gt_u32 vcc, 1, v253
s_nop 4
s_cbranch_vccnz L_spin_f2
L_spin_f2_ret:
buffer_load_dwordx4 a[0:3], v236, s[44:47], s68 offen offset:0 sc1
buffer_load_dwordx4 a[4:7], v237, s[44:47], s68 offen offset:0 sc1
buffer_load_dwordx4 a[8:11], v236, s[44:47], s68 offen offset:1024 sc1
buffer_load_dwordx4 a[12:15], v237, s[44:47], s68 offen offset:1024 sc1
s_add_u32 s68, s68, 2048
MV 76,a,128,a,160
ds_read_b128 a[224:227], v5 offset:4032
buffer_load_dwordx4 a[16:19], v236, s[44:47], s68 offen offset:0 sc1
MV 80,a,132,a,160
ds_read2_b32 a[192:193], v40 offset0:112 offset1:113
MV 80,a,128,a,164
ds_read2_b32 a[194:195], v40 offset0:114 offset1:115
buffer_load_dwordx4 a[20:23], v237, s[44:47], s68 offen offset:0 sc1
MV 84,a,132,a,164
ds_read_b128 a[228:231], v5 offset:3520
MV 84,a,128,a,168
buffer_load_dwordx4 a[24:27], v236, s[44:47], s68 offen offset:1024 sc1
MV 88,a,132,a,168
ds_read2_b32 a[196:197], v40 offset0:240 offset1:241
s_waitcnt lgkmcnt(15)
MV 88,a,128,a,172
ds_read2_b32 a[198:199], v40 offset0:242 offset1:243
MV 92,a,132,a,172
ds_read_b128 a[232:235], v5 offset:3008
buffer_load_dwordx4 a[28:31], v237, s[44:47], s68 offen offset:1024 sc1
MV 92,a,128,a,176
ds_read2_b32 a[200:201], v41 offset0:112 offset1:113
MV 96,a,132,a,176
s_add_u32 s68, s68, 2048
s_waitcnt lgkmcnt(15)
MV 96,a,128,a,180
ds_read2_b32 a[202:203], v41 offset0:114 offset1:115
MV 100,a,132,a,180
ds_read_b128 a[236:239], v5 offset:2496
buffer_load_dwordx4 a[32:35], v236, s[44:47], s68 offen offset:0 sc1
s_waitcnt lgkmcnt(15)
MV 100,a,128,a,184
ds_read2_b32 a[204:205], v41 offset0:240 offset1:241
MV 104,a,132,a,184
ds_read2_b32 a[206:207], v41 offset0:242 offset1:243
s_waitcnt lgkmcnt(14)
MV 104,a,128,a,188
buffer_load_dwordx4 a[36:39], v237, s[44:47], s68 offen offset:0 sc1
MV 84,a,136,a,160
ds_read_b128 a[240:243], v5 offset:1984
MV 88,a,140,a,160
ds_read2_b32 a[208:209], v42 offset0:112 offset1:113
buffer_load_dwordx4 a[40:43], v236, s[44:47], s68 offen offset:1024 sc1
MV 88,a,136,a,164
ds_read2_b32 a[210:211], v42 offset0:114 offset1:115
MV 92,a,140,a,164
ds_read_b128 a[244:247], v5 offset:1472
buffer_load_dwordx4 a[44:47], v237, s[44:47], s68 offen offset:1024 sc1
MV 92,a,136,a,168
MV 96,a,140,a,168
ds_read2_b32 a[212:213], v42 offset0:240 offset1:241
MV 96,a,136,a,172
ds_read2_b32 a[214:215], v42 offset0:242 offset1:243
s_add_u32 s68, s68, 2048
MV 100,a,140,a,172
ds_read_b128 a[248:251], v5 offset:960
MV 100,a,136,a,176
ds_read2_b32 a[216:217], v43 offset0:112 offset1:113
buffer_load_dwordx4 a[48:51], v236, s[44:47], s68 offen offset:0 sc1
MV 104,a,140,a,176
MV 104,a,136,a,180
ds_read2_b32 a[218:219], v43 offset0:114 offset1:115
buffer_load_dwordx4 a[52:55], v237, s[44:47], s68 offen offset:0 sc1
MV 92,a,144,a,160
ds_read_b128 a[252:255], v5 offset:448
MV 96,a,148,a,160
ds_read2_b32 a[220:221], v43 offset0:240 offset1:241
MV 96,a,144,a,164
ds_read2_b32 a[222:223], v43 offset0:242 offset1:243
buffer_load_dwordx4 a[56:59], v236, s[44:47], s68 offen offset:1024 sc1
MV 100,a,148,a,164
MV 100,a,144,a,168
buffer_load_dwordx4 a[60:63], v237, s[44:47], s68 offen offset:1024 sc1
MV 104,a,148,a,168
MV 104,a,144,a,172
s_add_u32 s68, s68, 2048
MV 100,a,152,a,160
s_waitcnt lgkmcnt(15)
MV 104,a,156,a,160
MV 104,a,152,a,164
s_waitcnt lgkmcnt(0)
s_barrier
ds_read_b128 a[64:67], v242 offset:0
ds_read_b128 a[68:71], v242 offset:1024
ds_read_b128 a[72:75], v242 offset:2048
ds_read_b128 a[76:79], v242 offset:3072
ds_read_b128 a[80:83], v243 offset:0
ds_read_b128 a[84:87], v243 offset:1024
ds_read_b128 a[88:91], v243 offset:2048
ds_read_b128 a[92:95], v243 offset:3072
s_waitcnt lgkmcnt(0)
s_waitcnt vmcnt(15)
v_mfma_f32_16x16x32_bf16 v[124:127], a[64:67], a[0:3], 0
ds_read_b128 a[96:99], v242 offset:8192
MV 76,a,192,a,224
s_add_u32 m0, s70, 115712
s_waitcnt vmcnt(14)
v_mfma_f32_16x16x32_bf16 v[128:131], a[64:67], a[4:7], 0
ds_read_b128 a[100:103], v242 offset:9216
MV 80,a,196,a,224
v_mfma_f32_16x16x32_bf16 v[132:135], a[68:71], a[0:3], 0
MV 80,a,192,a,228
ds_read_b128 a[104:107], v242 offset:10240
v_mfma_f32_16x16x32_bf16 v[136:139], a[68:71], a[4:7], 0
v_mfma_f32_16x16x32_bf16 v[140:143], a[72:75], a[0:3], 0
ds_read_b128 a[108:111], v242 offset:11264
MV 84,a,196,a,228
v_mfma_f32_16x16x32_bf16 v[144:147], a[72:75], a[4:7], 0
buffer_load_dwordx4 v238, s[48:51], s69 offen offset:0 sc1 lds
MV 84,a,192,a,232
ds_read_b128 a[112:115], v243 offset:8192
v_mfma_f32_16x16x32_bf16 v[148:151], a[76:79], a[0:3], 0
MV 88,a,196,a,232
v_mfma_f32_16x16x32_bf16 v[152:155], a[76:79], a[4:7], 0
ds_read_b128 a[116:119], v243 offset:9216
v_mfma_f32_16x16x32_bf16 v[156:159], a[80:83], a[0:3], 0
MV 88,a,192,a,236
ds_read_b128 a[120:123], v243 offset:10240
v_mfma_f32_16x16x32_bf16 v[160:163], a[80:83], a[4:7], 0
MV 92,a,196,a,236
buffer_load_dwordx4 v238, s[48:51], s69 offen offset:1024 sc1 lds
v_mfma_f32_16x16x32_bf16 v[164:167], a[84:87], a[0:3], 0
ds_read_b128 a[124:127], v243 offset:11264
MV 92,a,192,a,240
v_mfma_f32_16x16x32_bf16 v[168:171], a[84:87], a[4:7], 0
v_mfma_f32_16x16x32_bf16 v[172:175], a[88:91], a[0:3], 0
MV 96,a,196,a,240
v_mfma_f32_16x16x32_bf16 v[176:179], a[88:91], a[4:7], 0
MV 96,a,192,a,244
v_mfma_f32_16x16x32_bf16 v[180:183], a[92:95], a[0:3], 0
buffer_load_dwordx4 a[0:3], v236, s[44:47], s68 offen offset:0 sc1
MV 100,a,196,a,244
v_mfma_f32_16x16x32_bf16 v[184:187], a[92:95], a[4:7], 0
buffer_load_dwordx4 a[4:7], v237, s[44:47], s68 offen offset:0 sc1
s_waitcnt lgkmcnt(0)
s_barrier
s_waitcnt vmcnt(17)
MV 124,a,96,a,8
ds_read_b128 a[64:67], v242 offset:16384
MV 100,a,192,a,248
buffer_load_dwordx4 v238, s[48:51], s69 offen offset:2048 sc1 lds
s_waitcnt vmcnt(17)
MV 128,a,96,a,12
ds_read_b128 a[68:71], v242 offset:17408
MV 104,a,196,a,248
MV 132,a,100,a,8
MV 104,a,192,a,252
ds_read_b128 a[72:75], v242 offset:18432
MV 136,a,100,a,12
MV 140,a,104,a,8
ds_read_b128 a[76:79], v242 offset:19456
MV 84,a,200,a,224
MV 144,a,104,a,12
buffer_load_dwordx4 v238, s[48:51], s69 offen offset:3072 sc1 lds
MV 88,a,204,a,224
ds_read_b128 a[80:83], v243 offset:16384
MV 148,a,108,a,8
MV 88,a,200,a,228
MV 152,a,108,a,12
ds_read_b128 a[84:87], v243 offset:17408
MV 156,a,112,a,8
MV 92,a,204,a,228
ds_read_b128 a[88:91], v243 offset:18432
MV 160,a,112,a,12
MV 92,a,200,a,232
s_add_u32 s69, s69, 16384
MV 164,a,116,a,8
ds_read_b128 a[92:95], v243 offset:19456
MV 96,a,204,a,232
MV 168,a,116,a,12
MV 172,a,120,a,8
MV 96,a,200,a,236
MV 176,a,120,a,12
MV 100,a,204,a,236
MV 180,a,124,a,8
buffer_load_dwordx4 a[8:11], v236, s[44:47], s68 offen offset:1024 sc1
MV 100,a,200,a,240
MV 184,a,124,a,12
buffer_load_dwordx4 a[12:15], v237, s[44:47], s68 offen offset:1024 sc1
s_add_u32 s68, s68, 2048
s_waitcnt lgkmcnt(0)
s_waitcnt vmcnt(19)
MV 124,a,64,a,16
ds_read_b128 a[96:99], v242 offset:24576
MV 104,a,204,a,240
s_add_u32 m0, s70, 66560
s_waitcnt vmcnt(18)
MV 128,a,64,a,20
ds_read_b128 a[100:103], v242 offset:25600
MV 104,a,200,a,244
MV 132,a,68,a,16
MV 92,a,208,a,224
ds_read_b128 a[104:107], v242 offset:26624
MV 136,a,68,a,20
MV 140,a,72,a,16
ds_read_b128 a[108:111], v242 offset:27648
MV 96,a,212,a,224
MV 144,a,72,a,20
buffer_load_dwordx4 v238, s[48:51], s69 offen offset:0 sc1 lds
MV 96,a,208,a,228
ds_read_b128 a[112:115], v243 offset:24576
MV 148,a,76,a,16
MV 100,a,212,a,228
MV 152,a,76,a,20
ds_read_b128 a[116:119], v243 offset:25600
MV 156,a,80,a,16
MV 100,a,208,a,232
ds_read_b128 a[120:123], v243 offset:26624
MV 160,a,80,a,20
MV 104,a,212,a,232
buffer_load_dwordx4 v238, s[48:51], s69 offen offset:1024 sc1 lds
MV 164,a,84,a,16
ds_read_b128 a[124:127], v243 offset:27648
MV 104,a,208,a,236
MV 168,a,84,a,20
MV 172,a,88,a,16
MV 100,a,216,a,224
MV 176,a,88,a,20
MV 104,a,220,a,224
MV 180,a,92,a,16
buffer_load_dwordx4 a[16:19], v236, s[44:47], s68 offen offset:0 sc1
MV 104,a,216,a,228
MV 184,a,92,a,20
buffer_load_dwordx4 a[20:23], v237, s[44:47], s68 offen offset:0 sc1
s_waitcnt lgkmcnt(0)
s_barrier
s_waitcnt vmcnt(21)
MV 124,a,96,a,24
ds_read_b128 a[64:67], v242 offset:32768
s_waitcnt vmcnt(20)
MV 128,a,96,a,28
ds_read_b128 a[68:71], v242 offset:33792
buffer_load_dwordx4 v238, s[48:51], s69 offen offset:2048 sc1 lds
MV 132,a,100,a,24
MV 136,a,100,a,28
ds_read_b128 a[72:75], v242 offset:34816
MV 140,a,104,a,24
ds_read_b128 a[76:79], v242 offset:35840
MV 144,a,104,a,28
buffer_load_dwordx4 v238, s[48:51], s69 offen offset:3072 sc1 lds
MV 148,a,108,a,24
ds_read_b128 a[80:83], v243 offset:32768
MV 152,a,108,a,28
ds_read_b128 a[84:87], v243 offset:33792
MV 156,a,112,a,24
MV 160,a,112,a,28
ds_read_b128 a[88:91], v243 offset:34816
s_add_u32 s69, s69, 16384
MV 164,a,116,a,24
ds_read_b128 a[92:95], v243 offset:35840
MV 168,a,116,a,28
MV 172,a,120,a,24
MV 176,a,120,a,28
MV 180,a,124,a,24
buffer_load_dwordx4 a[24:27], v236, s[44:47], s68 offen offset:1024 sc1
MV 184,a,124,a,28
buffer_load_dwordx4 a[28:31], v237, s[44:47], s68 offen offset:1024 sc1
s_add_u32 s68, s68, 2048
s_waitcnt lgkmcnt(0)
s_waitcnt vmcnt(23)
MV 124,a,64,a,32
ds_read_b128 a[96:99], v242 offset:40960
v_cvt_pk_bf16_f32 v16, v76, v77
s_waitcnt vmcnt(22)
MV 128,a,64,a,36
ds_read_b128 a[100:103], v242 offset:41984
s_add_u32 m0, s70, 82944
MV 132,a,68,a,32
v_cvt_pk_bf16_f32 v17, v78, v79
MV 136,a,68,a,36
ds_read_b128 a[104:107], v242 offset:43008
ds_write_b16 v11, v16 offset:0
MV 140,a,72,a,32
ds_read_b128 a[108:111], v242 offset:44032
MV 144,a,72,a,36
buffer_load_dwordx4 v238, s[48:51], s69 offen offset:0 sc1 lds
ds_write_b16_d16_hi v11, v16 offset:8
MV 148,a,76,a,32
ds_read_b128 a[112:115], v243 offset:40960
MV 152,a,76,a,36
ds_read_b128 a[116:119], v243 offset:41984
ds_write_b16 v11, v17 offset:16
MV 156,a,80,a,32
ds_write_b16_d16_hi v11, v17 offset:24
MV 160,a,80,a,36
ds_read_b128 a[120:123], v243 offset:43008
buffer_load_dwordx4 v238, s[48:51], s69 offen offset:1024 sc1 lds
MV 164,a,84,a,32
ds_read_b128 a[124:127], v243 offset:44032
v_cvt_pk_bf16_f32 v18, v80, v81
MV 168,a,84,a,36
MV 172,a,88,a,32
v_cvt_pk_bf16_f32 v19, v82, v83
MV 176,a,88,a,36
MV 180,a,92,a,32
buffer_load_dwordx4 a[32:35], v236, s[44:47], s68 offen offset:0 sc1
ds_write_b16 v11, v18 offset:2176
MV 184,a,92,a,36
buffer_load_dwordx4 a[36:39], v237, s[44:47], s68 offen offset:0 sc1
s_waitcnt vmcnt(14) lgkmcnt(0)
s_barrier
MV 124,a,96,a,40
ds_read_b128 a[64:67], v242 offset:49152
ds_write_b16_d16_hi v11, v18 offset:2184
MV 128,a,96,a,44
ds_read_b128 a[68:71], v242 offset:50176
buffer_load_dwordx4 v238, s[48:51], s69 offen offset:2048 sc1 lds
MV 132,a,100,a,40
ds_write_b16 v11, v19 offset:2192
MV 136,a,100,a,44
ds_read_b128 a[72:75], v242 offset:51200
ds_write_b16_d16_hi v11, v19 offset:2200
MV 140,a,104,a,40
ds_read_b128 a[76:79], v242 offset:52224
v_cvt_pk_bf16_f32 v16, v84, v85
MV 144,a,104,a,44
buffer_load_dwordx4 v238, s[48:51], s69 offen offset:3072 sc1 lds
MV 148,a,108,a,40
ds_read_b128 a[80:83], v243 offset:49152
v_cvt_pk_bf16_f32 v17, v86, v87
MV 152,a,108,a,44
ds_read_b128 a[84:87], v243 offset:50176
MV 156,a,112,a,40
ds_write_b16 v11, v16 offset:4352
MV 160,a,112,a,44
ds_read_b128 a[88:91], v243 offset:51200
s_add_u32 s69, s69, 16384
MV 164,a,116,a,40
ds_read_b128 a[92:95], v243 offset:52224
ds_write_b16_d16_hi v11, v16 offset:4360
MV 168,a,116,a,44
ds_write_b16 v11, v17 offset:4368
MV 172,a,120,a,40
ds_write_b16_d16_hi v11, v17 offset:4376
MV 176,a,120,a,44
MV 180,a,124,a,40
buffer_load_dwordx4 a[40:43], v236, s[44:47], s68 offen offset:1024 sc1
v_cvt_pk_bf16_f32 v18, v88, v89
MV 184,a,124,a,44
buffer_load_dwordx4 a[44:47], v237, s[44:47], s68 offen offset:1024 sc1
s_add_u32 s68, s68, 2048
s_waitcnt lgkmcnt(0)
MV 124,a,64,a,48
ds_read_b128 a[96:99], v242 offset:57344
v_cvt_pk_bf16_f32 v19, v90, v91
MV 128,a,64,a,52
ds_read_b128 a[100:103], v242 offset:58368
s_add_u32 m0, s70, 99328
MV 132,a,68,a,48
ds_write_b16 v11, v18 offset:6528
MV 136,a,68,a,52
ds_read_b128 a[104:107], v242 offset:59392
ds_write_b16_d16_hi v11, v18 offset:6536
MV 140,a,72,a,48
ds_read_b128 a[108:111], v242 offset:60416
MV 144,a,72,a,52
buffer_load_dwordx4 v238, s[48:51], s69 offen offset:0 sc1 lds
ds_write_b16 v11, v19 offset:6544
MV 148,a,76,a,48
ds_read_b128 a[112:115], v243 offset:57344
MV 152,a,76,a,52
ds_read_b128 a[116:119], v243 offset:58368
ds_write_b16_d16_hi v11, v19 offset:6552
MV 156,a,80,a,48
v_cvt_pk_bf16_f32 v16, v92, v93
MV 160,a,80,a,52
ds_read_b128 a[120:123], v243 offset:59392
buffer_load_dwordx4 v238, s[48:51], s69 offen offset:1024 sc1 lds
MV 164,a,84,a,48
ds_read_b128 a[124:127], v243 offset:60416
v_cvt_pk_bf16_f32 v17, v94, v95
MV 168,a,84,a,52
MV 172,a,88,a,48
ds_write_b16 v11, v16 offset:8704
MV 176,a,88,a,52
MV 180,a,92,a,48
buffer_load_dwordx4 a[48:51], v236, s[44:47], s68 offen offset:0 sc1
ds_write_b16_d16_hi v11, v16 offset:8712
MV 184,a,92,a,52
buffer_load_dwordx4 a[52:55], v237, s[44:47], s68 offen offset:0 sc1
s_waitcnt vmcnt(14) lgkmcnt(0)
s_barrier
MV 124,a,96,a,56
ds_read_b128 a[64:67], v242 offset:0
ds_write_b16 v11, v17 offset:8720
MV 128,a,96,a,60
ds_read_b128 a[68:71], v242 offset:1024
buffer_load_dwordx4 v238, s[48:51], s69 offen offset:2048 sc1 lds
MV 132,a,100,a,56
ds_write_b16_d16_hi v11, v17 offset:8728
MV 136,a,100,a,60
ds_read_b128 a[72:75], v242 offset:2048
v_cvt_pk_bf16_f32 v18, v96, v97
MV 140,a,104,a,56
ds_read_b128 a[76:79], v242 offset:3072
v_cvt_pk_bf16_f32 v19, v98, v99
MV 144,a,104,a,60
buffer_load_dwordx4 v238, s[48:51], s69 offen offset:3072 sc1 lds
MV 148,a,108,a,56
ds_read_b128 a[80:83], v243 offset:0
ds_write_b16 v11, v18 offset:10880
MV 152,a,108,a,60
ds_read_b128 a[84:87], v243 offset:1024
MV 156,a,112,a,56
ds_write_b16_d16_hi v11, v18 offset:10888
MV 160,a,112,a,60
ds_read_b128 a[88:91], v243 offset:2048
s_add_u32 s69, s69, 16384
MV 164,a,116,a,56
ds_read_b128 a[92:95], v243 offset:3072
ds_write_b16 v11, v19 offset:10896
MV 168,a,116,a,60
ds_write_b16_d16_hi v11, v19 offset:10904
MV 172,a,120,a,56
v_cvt_pk_bf16_f32 v16, v100, v101
MV 176,a,120,a,60
MV 180,a,124,a,56
buffer_load_dwordx4 a[56:59], v236, s[44:47], s68 offen offset:1024 sc1
v_cvt_pk_bf16_f32 v17, v102, v103
MV 184,a,124,a,60
buffer_load_dwordx4 a[60:63], v237, s[44:47], s68 offen offset:1024 sc1
s_add_u32 s68, s68, 2048
s_waitcnt lgkmcnt(0)
MV 124,a,64,a,0
ds_read_b128 a[96:99], v242 offset:8192
ds_write_b16 v11, v16 offset:13056
MV 128,a,64,a,4
ds_read_b128 a[100:103], v242 offset:9216
s_add_u32 m0, s70, 115712
MV 132,a,68,a,0
ds_write_b16_d16_hi v11, v16 offset:13064
MV 136,a,68,a,4
ds_read_b128 a[104:107], v242 offset:10240
ds_write_b16 v11, v17 offset:13072
MV 140,a,72,a,0
ds_read_b128 a[108:111], v242 offset:11264
ds_write_b16_d16_hi v11, v17 offset:13080
MV 144,a,72,a,4
buffer_load_dwordx4 v238, s[48:51], s69 offen offset:0 sc1 lds
MV 148,a,76,a,0
ds_read_b128 a[112:115], v243 offset:8192
v_cvt_pk_bf16_f32 v18, v104, v105
MV 152,a,76,a,4
ds_read_b128 a[116:119], v243 offset:9216
MV 156,a,80,a,0
v_cvt_pk_bf16_f32 v19, v106, v107
MV 160,a,80,a,4
ds_read_b128 a[120:123], v243 offset:10240
buffer_load_dwordx4 v238, s[48:51], s69 offen offset:1024 sc1 lds
MV 164,a,84,a,0
ds_read_b128 a[124:127], v243 offset:11264
ds_write_b16 v11, v18 offset:15232
MV 168,a,84,a,4
ds_write_b16_d16_hi v11, v18 offset:15240
MV 172,a,88,a,0
ds_write_b16 v11, v19 offset:15248
MV 176,a,88,a,4
MV 180,a,92,a,0
buffer_load_dwordx4 a[0:3], v236, s[44:47], s68 offen offset:0 sc1
ds_write_b16_d16_hi v11, v19 offset:15256
MV 184,a,92,a,4
buffer_load_dwordx4 a[4:7], v237, s[44:47], s68 offen offset:0 sc1
s_waitcnt vmcnt(14) lgkmcnt(0)
s_barrier
MV 124,a,96,a,8
ds_read_b128 a[64:67], v242 offset:16384
ds_read_b64 v[108:109], v12 offset:0
MV 128,a,96,a,12
ds_read_b128 a[68:71], v242 offset:17408
buffer_load_dwordx4 v238, s[48:51], s69 offen offset:2048 sc1 lds
MV 132,a,100,a,8
ds_read_b64 v[110:111], v12 offset:8
MV 136,a,100,a,12
ds_read_b128 a[72:75], v242 offset:18432
MV 140,a,104,a,8
ds_read_b128 a[76:79], v242 offset:19456
ds_read_b64 v[112:113], v12 offset:1088
MV 144,a,104,a,12
buffer_load_dwordx4 v238, s[48:51], s69 offen offset:3072 sc1 lds
MV 148,a,108,a,8
ds_read_b128 a[80:83], v243 offset:16384
ds_read_b64 v[114:115], v12 offset:1096
MV 152,a,108,a,12
ds_read_b128 a[84:87], v243 offset:17408
MV 156,a,112,a,8
ds_read_b64 v[116:117], v12 offset:2176
MV 160,a,112,a,12
ds_read_b128 a[88:91], v243 offset:18432
s_add_u32 s69, s69, 16384
MV 164,a,116,a,8
ds_read_b128 a[92:95], v243 offset:19456
ds_read_b64 v[118:119], v12 offset:2184
MV 168,a,116,a,12
MV 172,a,120,a,8
ds_read_b64 v[120:121], v12 offset:3264
MV 176,a,120,a,12
MV 180,a,124,a,8
buffer_load_dwordx4 a[8:11], v236, s[44:47], s68 offen offset:1024 sc1
ds_read_b64 v[122:123], v12 offset:3272
MV 184,a,124,a,12
buffer_load_dwordx4 a[12:15], v237, s[44:47], s68 offen offset:1024 sc1
s_add_u32 s68, s68, 2048
s_waitcnt lgkmcnt(0)
MV 124,a,64,a,16
ds_read_b128 a[96:99], v242 offset:24576
buffer_store_dwordx4 v[108:111], v13, s[24:27], 0 offen offset:0 sc1
MV 128,a,64,a,20
ds_read_b128 a[100:103], v242 offset:25600
s_add_u32 m0, s70, 66560
MV 132,a,68,a,16
MV 136,a,68,a,20
ds_read_b128 a[104:107], v242 offset:26624
MV 140,a,72,a,16
ds_read_b128 a[108:111], v242 offset:27648
MV 144,a,72,a,20
buffer_load_dwordx4 v238, s[48:51], s69 offen offset:0 sc1 lds
MV 148,a,76,a,16
ds_read_b128 a[112:115], v243 offset:24576
MV 152,a,76,a,20
ds_read_b128 a[116:119], v243 offset:25600
MV 156,a,80,a,16
buffer_store_dwordx4 v[112:115], v13, s[24:27], 0 offen offset:1024 sc1
MV 160,a,80,a,20
ds_read_b128 a[120:123], v243 offset:26624
buffer_load_dwordx4 v238, s[48:51], s69 offen offset:1024 sc1 lds
MV 164,a,84,a,16
ds_read_b128 a[124:127], v243 offset:27648
MV 168,a,84,a,20
MV 172,a,88,a,16
MV 176,a,88,a,20
MV 180,a,92,a,16
buffer_load_dwordx4 a[16:19], v236, s[44:47], s68 offen offset:0 sc1
MV 184,a,92,a,20
buffer_load_dwordx4 a[20:23], v237, s[44:47], s68 offen offset:0 sc1
s_waitcnt vmcnt(16) lgkmcnt(0)
s_barrier
MV 124,a,96,a,24
ds_read_b128 a[64:67], v242 offset:32768
buffer_store_dwordx4 v[116:119], v13, s[24:27], 0 offen offset:2048 sc1
MV 128,a,96,a,28
ds_read_b128 a[68:71], v242 offset:33792
buffer_load_dwordx4 v238, s[48:51], s69 offen offset:2048 sc1 lds
MV 132,a,100,a,24
MV 136,a,100,a,28
ds_read_b128 a[72:75], v242 offset:34816
MV 140,a,104,a,24
ds_read_b128 a[76:79], v242 offset:35840
MV 144,a,104,a,28
buffer_load_dwordx4 v238, s[48:51], s69 offen offset:3072 sc1 lds
MV 148,a,108,a,24
ds_read_b128 a[80:83], v243 offset:32768
MV 152,a,108,a,28
ds_read_b128 a[84:87], v243 offset:33792
MV 156,a,112,a,24
buffer_store_dwordx4 v[120:123], v13, s[24:27], 0 offen offset:3072 sc1
MV 160,a,112,a,28
ds_read_b128 a[88:91], v243 offset:34816
s_add_u32 s69, s69, 16384
MV 164,a,116,a,24
ds_read_b128 a[92:95], v243 offset:35840
MV 168,a,116,a,28
MV 172,a,120,a,24
MV 176,a,120,a,28
MV 180,a,124,a,24
buffer_load_dwordx4 a[24:27], v236, s[44:47], s68 offen offset:1024 sc1
MV 184,a,124,a,28
buffer_load_dwordx4 a[28:31], v237, s[44:47], s68 offen offset:1024 sc1
s_add_u32 s68, s68, 2048
s_mov_b32 s71, 3
.p2align 5
L_p5_loop:
s_waitcnt lgkmcnt(0)
MV 124,a,64,a,32
ds_read_b128 a[96:99], v242 offset:40960
MV 128,a,64,a,36
ds_read_b128 a[100:103], v242 offset:41984
s_add_u32 m0, s70, 82944
MV 132,a,68,a,32
MV 136,a,68,a,36
ds_read_b128 a[104:107], v242 offset:43008
MV 140,a,72,a,32
ds_read_b128 a[108:111], v242 offset:44032
MV 144,a,72,a,36
buffer_load_dwordx4 v238, s[48:51], s69 offen offset:0 sc1 lds
MV 148,a,76,a,32
ds_read_b128 a[112:115], v243 offset:40960
MV 152,a,76,a,36
ds_read_b128 a[116:119], v243 offset:41984
MV 156,a,80,a,32
MV 160,a,80,a,36
ds_read_b128 a[120:123], v243 offset:43008
buffer_load_dwordx4 v238, s[48:51], s69 offen offset:1024 sc1 lds
MV 164,a,84,a,32
ds_read_b128 a[124:127], v243 offset:44032
MV 168,a,84,a,36
MV 172,a,88,a,32
MV 176,a,88,a,36
MV 180,a,92,a,32
buffer_load_dwordx4 a[32:35], v236, s[44:47], s68 offen offset:0 sc1
MV 184,a,92,a,36
buffer_load_dwordx4 a[36:39], v237, s[44:47], s68 offen offset:0 sc1
s_waitcnt vmcnt(14) lgkmcnt(0)
s_barrier
MV 124,a,96,a,40
ds_read_b128 a[64:67], v242 offset:49152
MV 128,a,96,a,44
ds_read_b128 a[68:71], v242 offset:50176
buffer_load_dwordx4 v238, s[48:51], s69 offen offset:2048 sc1 lds
MV 132,a,100,a,40
MV 136,a,100,a,44
ds_read_b128 a[72:75], v242 offset:51200
MV 140,a,104,a,40
ds_read_b128 a[76:79], v242 offset:52224
MV 144,a,104,a,44
buffer_load_dwordx4 v238, s[48:51], s69 offen offset:3072 sc1 lds
MV 148,a,108,a,40
ds_read_b128 a[80:83], v243 offset:49152
MV 152,a,108,a,44
ds_read_b128 a[84:87], v243 offset:50176
MV 156,a,112,a,40
MV 160,a,112,a,44
ds_read_b128 a[88:91], v243 offset:51200
s_add_u32 s69, s69, 16384
MV 164,a,116,a,40
ds_read_b128 a[92:95], v243 offset:52224
MV 168,a,116,a,44
MV 172,a,120,a,40
MV 176,a,120,a,44
MV 180,a,124,a,40
buffer_load_dwordx4 a[40:43], v236, s[44:47], s68 offen offset:1024 sc1
MV 184,a,124,a,44
buffer_load_dwordx4 a[44:47], v237, s[44:47], s68 offen offset:1024 sc1
s_add_u32 s68, s68, 2048
s_waitcnt lgkmcnt(0)
MV 124,a,64,a,48
ds_read_b128 a[96:99], v242 offset:57344
MV 128,a,64,a,52
ds_read_b128 a[100:103], v242 offset:58368
s_add_u32 m0, s70, 99328
MV 132,a,68,a,48
MV 136,a,68,a,52
ds_read_b128 a[104:107], v242 offset:59392
MV 140,a,72,a,48
ds_read_b128 a[108:111], v242 offset:60416
MV 144,a,72,a,52
buffer_load_dwordx4 v238, s[48:51], s69 offen offset:0 sc1 lds
MV 148,a,76,a,48
ds_read_b128 a[112:115], v243 offset:57344
MV 152,a,76,a,52
ds_read_b128 a[116:119], v243 offset:58368
MV 156,a,80,a,48
MV 160,a,80,a,52
ds_read_b128 a[120:123], v243 offset:59392
buffer_load_dwordx4 v238, s[48:51], s69 offen offset:1024 sc1 lds
MV 164,a,84,a,48
ds_read_b128 a[124:127], v243 offset:60416
MV 168,a,84,a,52
MV 172,a,88,a,48
MV 176,a,88,a,52
MV 180,a,92,a,48
buffer_load_dwordx4 a[48:51], v236, s[44:47], s68 offen offset:0 sc1
MV 184,a,92,a,52
buffer_load_dwordx4 a[52:55], v237, s[44:47], s68 offen offset:0 sc1
s_waitcnt vmcnt(14) lgkmcnt(0)
s_barrier
MV 124,a,96,a,56
ds_read_b128 a[64:67], v242 offset:0
MV 128,a,96,a,60
ds_read_b128 a[68:71], v242 offset:1024
buffer_load_dwordx4 v238, s[48:51], s69 offen offset:2048 sc1 lds
MV 132,a,100,a,56
MV 136,a,100,a,60
ds_read_b128 a[72:75], v242 offset:2048
MV 140,a,104,a,56
ds_read_b128 a[76:79], v242 offset:3072
MV 144,a,104,a,60
buffer_load_dwordx4 v238, s[48:51], s69 offen offset:3072 sc1 lds
MV 148,a,108,a,56
ds_read_b128 a[80:83], v243 offset:0
MV 152,a,108,a,60
ds_read_b128 a[84:87], v243 offset:1024
MV 156,a,112,a,56
MV 160,a,112,a,60
ds_read_b128 a[88:91], v243 offset:2048
s_add_u32 s69, s69, 16384
MV 164,a,116,a,56
ds_read_b128 a[92:95], v243 offset:3072
MV 168,a,116,a,60
MV 172,a,120,a,56
MV 176,a,120,a,60
MV 180,a,124,a,56
buffer_load_dwordx4 a[56:59], v236, s[44:47], s68 offen offset:1024 sc1
MV 184,a,124,a,60
buffer_load_dwordx4 a[60:63], v237, s[44:47], s68 offen offset:1024 sc1
s_add_u32 s68, s68, 2048
s_waitcnt lgkmcnt(0)
MV 124,a,64,a,0
ds_read_b128 a[96:99], v242 offset:8192
MV 128,a,64,a,4
ds_read_b128 a[100:103], v242 offset:9216
s_add_u32 m0, s70, 115712
MV 132,a,68,a,0
MV 136,a,68,a,4
ds_read_b128 a[104:107], v242 offset:10240
MV 140,a,72,a,0
ds_read_b128 a[108:111], v242 offset:11264
MV 144,a,72,a,4
buffer_load_dwordx4 v238, s[48:51], s69 offen offset:0 sc1 lds
MV 148,a,76,a,0
ds_read_b128 a[112:115], v243 offset:8192
MV 152,a,76,a,4
ds_read_b128 a[116:119], v243 offset:9216
MV 156,a,80,a,0
MV 160,a,80,a,4
ds_read_b128 a[120:123], v243 offset:10240
buffer_load_dwordx4 v238, s[48:51], s69 offen offset:1024 sc1 lds
MV 164,a,84,a,0
ds_read_b128 a[124:127], v243 offset:11264
MV 168,a,84,a,4
MV 172,a,88,a,0
MV 176,a,88,a,4
MV 180,a,92,a,0
buffer_load_dwordx4 a[0:3], v236, s[44:47], s68 offen offset:0 sc1
MV 184,a,92,a,4
buffer_load_dwordx4 a[4:7], v237, s[44:47], s68 offen offset:0 sc1
s_waitcnt vmcnt(14) lgkmcnt(0)
s_barrier
MV 124,a,96,a,8
ds_read_b128 a[64:67], v242 offset:16384
MV 128,a,96,a,12
ds_read_b128 a[68:71], v242 offset:17408
buffer_load_dwordx4 v238, s[48:51], s69 offen offset:2048 sc1 lds
MV 132,a,100,a,8
MV 136,a,100,a,12
ds_read_b128 a[72:75], v242 offset:18432
MV 140,a,104,a,8
ds_read_b128 a[76:79], v242 offset:19456
MV 144,a,104,a,12
buffer_load_dwordx4 v238, s[48:51], s69 offen offset:3072 sc1 lds
MV 148,a,108,a,8
ds_read_b128 a[80:83], v243 offset:16384
MV 152,a,108,a,12
ds_read_b128 a[84:87], v243 offset:17408
MV 156,a,112,a,8
MV 160,a,112,a,12
ds_read_b128 a[88:91], v243 offset:18432
s_add_u32 s69, s69, 16384
MV 164,a,116,a,8
ds_read_b128 a[92:95], v243 offset:19456
MV 168,a,116,a,12
MV 172,a,120,a,8
MV 176,a,120,a,12
MV 180,a,124,a,8
buffer_load_dwordx4 a[8:11], v236, s[44:47], s68 offen offset:1024 sc1
MV 184,a,124,a,12
buffer_load_dwordx4 a[12:15], v237, s[44:47], s68 offen offset:1024 sc1
s_add_u32 s68, s68, 2048
s_waitcnt lgkmcnt(0)
MV 124,a,64,a,16
ds_read_b128 a[96:99], v242 offset:24576
MV 128,a,64,a,20
ds_read_b128 a[100:103], v242 offset:25600
s_add_u32 m0, s70, 66560
MV 132,a,68,a,16
MV 136,a,68,a,20
ds_read_b128 a[104:107], v242 offset:26624
MV 140,a,72,a,16
ds_read_b128 a[108:111], v242 offset:27648
MV 144,a,72,a,20
buffer_load_dwordx4 v238, s[48:51], s69 offen offset:0 sc1 lds
MV 148,a,76,a,16
ds_read_b128 a[112:115], v243 offset:24576
MV 152,a,76,a,20
ds_read_b128 a[116:119], v243 offset:25600
MV 156,a,80,a,16
MV 160,a,80,a,20
ds_read_b128 a[120:123], v243 offset:26624
buffer_load_dwordx4 v238, s[48:51], s69 offen offset:1024 sc1 lds
MV 164,a,84,a,16
ds_read_b128 a[124:127], v243 offset:27648
MV 168,a,84,a,20
MV 172,a,88,a,16
MV 176,a,88,a,20
MV 180,a,92,a,16
buffer_load_dwordx4 a[16:19], v236, s[44:47], s68 offen offset:0 sc1
MV 184,a,92,a,20
buffer_load_dwordx4 a[20:23], v237, s[44:47], s68 offen offset:0 sc1
s_waitcnt vmcnt(14) lgkmcnt(0)
s_barrier
MV 124,a,96,a,24
ds_read_b128 a[64:67], v242 offset:32768
MV 128,a,96,a,28
ds_read_b128 a[68:71], v242 offset:33792
buffer_load_dwordx4 v238, s[48:51], s69 offen offset:2048 sc1 lds
MV 132,a,100,a,24
MV 136,a,100,a,28
ds_read_b128 a[72:75], v242 offset:34816
MV 140,a,104,a,24
ds_read_b128 a[76:79], v242 offset:35840
MV 144,a,104,a,28
buffer_load_dwordx4 v238, s[48:51], s69 offen offset:3072 sc1 lds
MV 148,a,108,a,24
ds_read_b128 a[80:83], v243 offset:32768
MV 152,a,108,a,28
ds_read_b128 a[84:87], v243 offset:33792
MV 156,a,112,a,24
MV 160,a,112,a,28
ds_read_b128 a[88:91], v243 offset:34816
s_add_u32 s69, s69, 16384
MV 164,a,116,a,24
ds_read_b128 a[92:95], v243 offset:35840
MV 168,a,116,a,28
MV 172,a,120,a,24
MV 176,a,120,a,28
MV 180,a,124,a,24
buffer_load_dwordx4 a[24:27], v236, s[44:47], s68 offen offset:1024 sc1
MV 184,a,124,a,28
buffer_load_dwordx4 a[28:31], v237, s[44:47], s68 offen offset:1024 sc1
s_add_u32 s68, s68, 2048
s_sub_u32 s71, s71, 1
s_cbranch_scc1 L_p5_out
s_cmp_eq_u32 s71, 2
s_cbranch_scc1 L_p5_x1
s_cmp_eq_u32 s71, 0
s_cbranch_scc1 L_p5_x2
s_branch L_p5_loop
L_p5_out:
s_waitcnt lgkmcnt(0)
MV 124,a,64,a,32
ds_read_b128 a[96:99], v242 offset:40960
MV 128,a,64,a,36
ds_read_b128 a[100:103], v242 offset:41984
s_add_u32 m0, s70, 82944
MV 132,a,68,a,32
v_cmp_gt_u32 vcc, 1, v253
s_nop 4
s_cbranch_vccnz L_spin_f3
L_spin_f3_ret:
MV 136,a,68,a,36
ds_read_b128 a[104:107], v242 offset:43008
MV 140,a,72,a,32
ds_read_b128 a[108:111], v242 offset:44032
MV 144,a,72,a,36
buffer_load_dwordx4 v238, s[48:51], s69 offen offset:0 sc1 lds
MV 148,a,76,a,32
ds_read_b128 a[112:115], v243 offset:40960
MV 152,a,76,a,36
ds_read_b128 a[116:119], v243 offset:41984
MV 156,a,80,a,32
MV 160,a,80,a,36
ds_read_b128 a[120:123], v243 offset:43008
buffer_load_dwordx4 v238, s[48:51], s69 offen offset:1024 sc1 lds
MV 164,a,84,a,32
ds_read_b128 a[124:127], v243 offset:44032
MV 168,a,84,a,36
MV 172,a,88,a,32
s_add_u32 s72, s79, 0
MV 176,a,88,a,36
MV 180,a,92,a,32
buffer_load_dwordx4 a[32:35], v236, s[44:47], s68 offen offset:0 sc1
buffer_load_dwordx2 v[208:209], v251, s[56:59], s72 offen offset:0 sc1
MV 184,a,92,a,36
buffer_load_dwordx4 a[36:39], v237, s[44:47], s68 offen offset:0 sc1
s_waitcnt vmcnt(15) lgkmcnt(0)
s_barrier
MV 124,a,96,a,40
ds_read_b128 a[64:67], v242 offset:49152
s_add_u32 s72, s79, 16384
MV 128,a,96,a,44
ds_read_b128 a[68:71], v242 offset:50176
buffer_load_dwordx4 v238, s[48:51], s69 offen offset:2048 sc1 lds
MV 132,a,100,a,40
MV 136,a,100,a,44
ds_read_b128 a[72:75], v242 offset:51200
MV 140,a,104,a,40
ds_read_b128 a[76:79], v242 offset:52224
MV 144,a,104,a,44
buffer_load_dwordx4 v238, s[48:51], s69 offen offset:3072 sc1 lds
MV 148,a,108,a,40
ds_read_b128 a[80:83], v243 offset:49152
MV 152,a,108,a,44
ds_read_b128 a[84:87], v243 offset:50176
MV 156,a,112,a,40
buffer_load_dwordx2 v[210:211], v251, s[56:59], s72 offen offset:0 sc1
MV 160,a,112,a,44
ds_read_b128 a[88:91], v243 offset:51200
s_add_u32 s69, s69, 16384
MV 164,a,116,a,40
ds_read_b128 a[92:95], v243 offset:52224
MV 168,a,116,a,44
MV 172,a,120,a,40
MV 176,a,120,a,44
MV 180,a,124,a,40
buffer_load_dwordx4 a[40:43], v236, s[44:47], s68 offen offset:1024 sc1
MV 184,a,124,a,44
buffer_load_dwordx4 a[44:47], v237, s[44:47], s68 offen offset:1024 sc1
s_add_u32 s68, s68, 2048
s_waitcnt lgkmcnt(0)
MV 124,a,64,a,48
ds_read_b128 a[96:99], v242 offset:57344
s_add_u32 s72, s79, 131072
MV 128,a,64,a,52
ds_read_b128 a[100:103], v242 offset:58368
s_add_u32 m0, s70, 99328
MV 132,a,68,a,48
MV 136,a,68,a,52
ds_read_b128 a[104:107], v242 offset:59392
MV 140,a,72,a,48
ds_read_b128 a[108:111], v242 offset:60416
buffer_load_dwordx2 v[212:213], v251, s[56:59], s72 offen offset:0 sc1
MV 144,a,72,a,52
buffer_load_dwordx4 v238, s[48:51], s69 offen offset:0 sc1 lds
MV 148,a,76,a,48
ds_read_b128 a[112:115], v243 offset:57344
MV 152,a,76,a,52
ds_read_b128 a[116:119], v243 offset:58368
MV 156,a,80,a,48
s_add_u32 s72, s79, 147456
MV 160,a,80,a,52
ds_read_b128 a[120:123], v243 offset:59392
buffer_load_dwordx4 v238, s[48:51], s69 offen offset:1024 sc1 lds
MV 164,a,84,a,48
ds_read_b128 a[124:127], v243 offset:60416
MV 168,a,84,a,52
MV 172,a,88,a,48
buffer_load_dwordx2 v[214:215], v251, s[56:59], s72 offen offset:0 sc1
MV 176,a,88,a,52
MV 180,a,92,a,48
buffer_load_dwordx4 a[48:51], v236, s[44:47], s68 offen offset:0 sc1
MV 184,a,92,a,52
buffer_load_dwordx4 a[52:55], v237, s[44:47], s68 offen offset:0 sc1
s_waitcnt vmcnt(18) lgkmcnt(0)
s_barrier
MV 124,a,96,a,56
ds_read_b128 a[64:67], v242 offset:0
s_add_u32 s72, s79, 0
MV 128,a,96,a,60
ds_read_b128 a[68:71], v242 offset:1024
buffer_load_dwordx4 v238, s[48:51], s69 offen offset:2048 sc1 lds
MV 132,a,100,a,56
MV 136,a,100,a,60
ds_read_b128 a[72:75], v242 offset:2048
MV 140,a,104,a,56
ds_read_b128 a[76:79], v242 offset:3072
MV 144,a,104,a,60
buffer_load_dwordx4 v238, s[48:51], s69 offen offset:3072 sc1 lds
MV 148,a,108,a,56
ds_read_b128 a[80:83], v243 offset:0
MV 152,a,108,a,60
ds_read_b128 a[84:87], v243 offset:1024
MV 156,a,112,a,56
buffer_load_dwordx2 v[216:217], v251, s[56:59], s72 offen offset:128 sc1
MV 160,a,112,a,60
ds_read_b128 a[88:91], v243 offset:2048
s_add_u32 s69, s69, 16384
MV 164,a,116,a,56
ds_read_b128 a[92:95], v243 offset:3072
MV 168,a,116,a,60
MV 172,a,120,a,56
MV 176,a,120,a,60
MV 180,a,124,a,56
buffer_load_dwordx4 a[56:59], v236, s[44:47], s68 offen offset:1024 sc1
MV 184,a,124,a,60
buffer_load_dwordx4 a[60:63], v237, s[44:47], s68 offen offset:1024 sc1
s_add_u32 s68, s68, 2048
s_waitcnt lgkmcnt(0)
MV 124,a,64,a,0
ds_read_b128 a[96:99], v242 offset:8192
s_add_u32 s72, s79, 16384
MV 128,a,64,a,4
ds_read_b128 a[100:103], v242 offset:9216
s_add_u32 m0, s70, 115712
MV 132,a,68,a,0
MV 136,a,68,a,4
ds_read_b128 a[104:107], v242 offset:10240
MV 140,a,72,a,0
ds_read_b128 a[108:111], v242 offset:11264
MV 144,a,72,a,4
buffer_load_dwordx4 v238, s[48:51], s69 offen offset:0 sc1 lds
MV 148,a,76,a,0
ds_read_b128 a[112:115], v243 offset:8192
MV 152,a,76,a,4
ds_read_b128 a[116:119], v243 offset:9216
MV 156,a,80,a,0
buffer_load_dwordx2 v[218:219], v251, s[56:59], s72 offen offset:128 sc1
MV 160,a,80,a,4
ds_read_b128 a[120:123], v243 offset:10240
buffer_load_dwordx4 v238, s[48:51], s69 offen offset:1024 sc1 lds
MV 164,a,84,a,0
ds_read_b128 a[124:127], v243 offset:11264
MV 168,a,84,a,4
MV 172,a,88,a,0
MV 176,a,88,a,4
MV 180,a,92,a,0
buffer_load_dwordx4 a[0:3], v236, s[44:47], s68 offen offset:0 sc1
MV 184,a,92,a,4
buffer_load_dwordx4 a[4:7], v237, s[44:47], s68 offen offset:0 sc1
s_waitcnt vmcnt(19) lgkmcnt(0)
s_barrier
MV 124,a,96,a,8
ds_read_b128 a[64:67], v242 offset:16384
s_add_u32 s72, s79, 131072
MV 128,a,96,a,12
ds_read_b128 a[68:71], v242 offset:17408
buffer_load_dwordx4 v238, s[48:51], s69 offen offset:2048 sc1 lds
MV 132,a,100,a,8
MV 136,a,100,a,12
ds_read_b128 a[72:75], v242 offset:18432
MV 140,a,104,a,8
ds_read_b128 a[76:79], v242 offset:19456
buffer_load_dwordx2 v[220:221], v251, s[56:59], s72 offen offset:128 sc1
MV 144,a,104,a,12
buffer_load_dwordx4 v238, s[48:51], s69 offen offset:3072 sc1 lds
MV 148,a,108,a,8
ds_read_b128 a[80:83], v243 offset:16384
MV 152,a,108,a,12
ds_read_b128 a[84:87], v243 offset:17408
MV 156,a,112,a,8
s_add_u32 s72, s79, 147456
MV 160,a,112,a,12
ds_read_b128 a[88:91], v243 offset:18432
s_add_u32 s69, s69, 16384
MV 164,a,116,a,8
ds_read_b128 a[92:95], v243 offset:19456
MV 168,a,116,a,12
MV 172,a,120,a,8
buffer_load_dwordx2 v[222:223], v251, s[56:59], s72 offen offset:128 sc1
MV 176,a,120,a,12
MV 180,a,124,a,8
buffer_load_dwordx4 a[8:11], v236, s[44:47], s68 offen offset:1024 sc1
MV 184,a,124,a,12
buffer_load_dwordx4 a[12:15], v237, s[44:47], s68 offen offset:1024 sc1
s_add_u32 s68, s68, 2048
s_waitcnt lgkmcnt(0)
MV 124,a,64,a,16
ds_read_b128 a[96:99], v242 offset:24576
MV 128,a,64,a,20
ds_read_b128 a[100:103], v242 offset:25600
s_add_u32 m0, s70, 66560
MV 132,a,68,a,16
MV 136,a,68,a,20
ds_read_b128 a[104:107], v242 offset:26624
MV 140,a,72,a,16
ds_read_b128 a[108:111], v242 offset:27648
MV 144,a,72,a,20
buffer_load_dwordx4 v238, s[48:51], s69 offen offset:0 sc1 lds
MV 148,a,76,a,16
ds_read_b128 a[112:115], v243 offset:24576
MV 152,a,76,a,20
ds_read_b128 a[116:119], v243 offset:25600
MV 156,a,80,a,16
MV 160,a,80,a,20
ds_read_b128 a[120:123], v243 offset:26624
buffer_load_dwordx4 v238, s[48:51], s69 offen offset:1024 sc1 lds
MV 164,a,84,a,16
ds_read_b128 a[124:127], v243 offset:27648
MV 168,a,84,a,20
MV 172,a,88,a,16
MV 176,a,88,a,20
MV 180,a,92,a,16
buffer_load_dwordx4 a[16:19], v236, s[44:47], s68 offen offset:0 sc1
MV 184,a,92,a,20
buffer_load_dwordx4 a[20:23], v237, s[44:47], s68 offen offset:0 sc1
s_waitcnt vmcnt(18) lgkmcnt(0)
s_barrier
MV 124,a,96,a,24
ds_read_b128 a[64:67], v242 offset:32768
MV 128,a,96,a,28
ds_read_b128 a[68:71], v242 offset:33792
buffer_load_dwordx4 v238, s[48:51], s69 offen offset:2048 sc1 lds
MV 132,a,100,a,24
MV 136,a,100,a,28
ds_read_b128 a[72:75], v242 offset:34816
MV 140,a,104,a,24
ds_read_b128 a[76:79], v242 offset:35840
MV 144,a,104,a,28
buffer_load_dwordx4 v238, s[48:51], s69 offen offset:3072 sc1 lds
MV 148,a,108,a,24
ds_read_b128 a[80:83], v243 offset:32768
MV 152,a,108,a,28
ds_read_b128 a[84:87], v243 offset:33792
MV 156,a,112,a,24
MV 160,a,112,a,28
ds_read_b128 a[88:91], v243 offset:34816
s_add_u32 s69, s69, 16384
MV 164,a,116,a,24
ds_read_b128 a[92:95], v243 offset:35840
MV 168,a,116,a,28
MV 172,a,120,a,24
MV 176,a,120,a,28
MV 180,a,124,a,24
buffer_load_dwordx4 a[24:27], v236, s[44:47], s68 offen offset:1024 sc1
MV 184,a,124,a,28
buffer_load_dwordx4 a[28:31], v237, s[44:47], s68 offen offset:1024 sc1
s_add_u32 s68, s68, 2048
s_waitcnt lgkmcnt(0)
MV 124,a,64,a,32
ds_read_b128 a[96:99], v242 offset:40960
v_sub_f32 v8, 1.0, v6
MV 128,a,64,a,36
ds_read_b128 a[100:103], v242 offset:41984
s_add_u32 m0, s70, 82944
MV 132,a,68,a,32
v_lshlrev_b32 v36, 16, v192
v_lshlrev_b32 v228, 16, v208
MV 136,a,68,a,36
ds_read_b128 a[104:107], v242 offset:43008
v_and_b32 v37, 0xffff0000, v192
MV 140,a,72,a,32
ds_read_b128 a[108:111], v242 offset:44032
v_and_b32 v229, 0xffff0000, v208
MV 144,a,72,a,36
buffer_load_dwordx4 v238, s[48:51], s69 offen offset:0 sc1 lds
v_mul_f32 v36, v36, v228
MV 148,a,76,a,32
ds_read_b128 a[112:115], v243 offset:40960
v_mul_f32 v37, v37, v229
MV 152,a,76,a,36
ds_read_b128 a[116:119], v243 offset:41984
v_mul_f32 v36, v36, v6
MV 156,a,80,a,32
v_mul_f32 v37, v37, v6
v_lshlrev_b32 v38, 16, v193
MV 160,a,80,a,36
ds_read_b128 a[120:123], v243 offset:43008
buffer_load_dwordx4 v238, s[48:51], s69 offen offset:1024 sc1 lds
MV 164,a,84,a,32
ds_read_b128 a[124:127], v243 offset:44032
v_lshlrev_b32 v228, 16, v209
MV 168,a,84,a,36
v_and_b32 v39, 0xffff0000, v193
v_and_b32 v229, 0xffff0000, v209
MV 172,a,88,a,32
v_mul_f32 v38, v38, v228
v_mul_f32 v39, v39, v229
MV 176,a,88,a,36
v_mul_f32 v38, v38, v6
v_mul_f32 v39, v39, v6
MV 180,a,92,a,32
buffer_load_dwordx4 a[32:35], v236, s[44:47], s68 offen offset:0 sc1
v_lshlrev_b32 v40, 16, v194
MV 184,a,92,a,36
buffer_load_dwordx4 a[36:39], v237, s[44:47], s68 offen offset:0 sc1
v_lshlrev_b32 v228, 16, v210
v_and_b32 v41, 0xffff0000, v194
v_and_b32 v229, 0xffff0000, v210
s_waitcnt vmcnt(15) lgkmcnt(0)
s_barrier
MV 124,a,96,a,40
ds_read_b128 a[64:67], v242 offset:49152
v_mul_f32 v40, v40, v228
MV 128,a,96,a,44
ds_read_b128 a[68:71], v242 offset:50176
buffer_load_dwordx4 v238, s[48:51], s69 offen offset:2048 sc1 lds
MV 132,a,100,a,40
v_mul_f32 v41, v41, v229
v_mul_f32 v40, v40, v6
MV 136,a,100,a,44
ds_read_b128 a[72:75], v242 offset:51200
v_mul_f32 v41, v41, v6
MV 140,a,104,a,40
ds_read_b128 a[76:79], v242 offset:52224
v_lshlrev_b32 v42, 16, v195
MV 144,a,104,a,44
buffer_load_dwordx4 v238, s[48:51], s69 offen offset:3072 sc1 lds
v_lshlrev_b32 v228, 16, v211
MV 148,a,108,a,40
ds_read_b128 a[80:83], v243 offset:49152
v_and_b32 v43, 0xffff0000, v195
MV 152,a,108,a,44
ds_read_b128 a[84:87], v243 offset:50176
v_and_b32 v229, 0xffff0000, v211
MV 156,a,112,a,40
v_mul_f32 v42, v42, v228
v_mul_f32 v43, v43, v229
MV 160,a,112,a,44
ds_read_b128 a[88:91], v243 offset:51200
s_add_u32 s69, s69, 16384
MV 164,a,116,a,40
ds_read_b128 a[92:95], v243 offset:52224
v_mul_f32 v42, v42, v6
MV 168,a,116,a,44
v_mul_f32 v43, v43, v6
v_lshlrev_b32 v44, 16, v196
MV 172,a,120,a,40
v_lshlrev_b32 v228, 16, v212
v_and_b32 v45, 0xffff0000, v196
MV 176,a,120,a,44
v_and_b32 v229, 0xffff0000, v212
v_mul_f32 v44, v44, v228
MV 180,a,124,a,40
buffer_load_dwordx4 a[40:43], v236, s[44:47], s68 offen offset:1024 sc1
v_mul_f32 v45, v45, v229
MV 184,a,124,a,44
buffer_load_dwordx4 a[44:47], v237, s[44:47], s68 offen offset:1024 sc1
s_add_u32 s68, s68, 2048
v_mul_f32 v44, v44, v6
v_mul_f32 v45, v45, v6
v_lshlrev_b32 v46, 16, v197
v_lshlrev_b32 v228, 16, v213
s_waitcnt lgkmcnt(0)
MV 124,a,64,a,48
ds_read_b128 a[96:99], v242 offset:57344
v_and_b32 v47, 0xffff0000, v197
MV 128,a,64,a,52
ds_read_b128 a[100:103], v242 offset:58368
s_add_u32 m0, s70, 99328
MV 132,a,68,a,48
v_and_b32 v229, 0xffff0000, v213
v_mul_f32 v46, v46, v228
MV 136,a,68,a,52
ds_read_b128 a[104:107], v242 offset:59392
v_mul_f32 v47, v47, v229
MV 140,a,72,a,48
ds_read_b128 a[108:111], v242 offset:60416
v_mul_f32 v46, v46, v6
MV 144,a,72,a,52
buffer_load_dwordx4 v238, s[48:51], s69 offen offset:0 sc1 lds
v_mul_f32 v47, v47, v6
MV 148,a,76,a,48
ds_read_b128 a[112:115], v243 offset:57344
v_lshlrev_b32 v48, 16, v198
MV 152,a,76,a,52
ds_read_b128 a[116:119], v243 offset:58368
v_lshlrev_b32 v228, 16, v214
MV 156,a,80,a,48
v_and_b32 v49, 0xffff0000, v198
v_and_b32 v229, 0xffff0000, v214
MV 160,a,80,a,52
ds_read_b128 a[120:123], v243 offset:59392
buffer_load_dwordx4 v238, s[48:51], s69 offen offset:1024 sc1 lds
MV 164,a,84,a,48
ds_read_b128 a[124:127], v243 offset:60416
v_mul_f32 v48, v48, v228
MV 168,a,84,a,52
v_mul_f32 v49, v49, v229
v_mul_f32 v48, v48, v6
MV 172,a,88,a,48
v_mul_f32 v49, v49, v6
v_lshlrev_b32 v50, 16, v199
MV 176,a,88,a,52
v_lshlrev_b32 v228, 16, v215
v_and_b32 v51, 0xffff0000, v199
MV 180,a,92,a,48
buffer_load_dwordx4 a[48:51], v236, s[44:47], s68 offen offset:0 sc1
v_and_b32 v229, 0xffff0000, v215
MV 184,a,92,a,52
buffer_load_dwordx4 a[52:55], v237, s[44:47], s68 offen offset:0 sc1
v_mul_f32 v50, v50, v228
v_mul_f32 v51, v51, v229
v_mul_f32 v50, v50, v6
v_mul_f32 v51, v51, v6
s_waitcnt vmcnt(14) lgkmcnt(0)
s_barrier
MV 124,a,96,a,56
ds_read_b128 a[64:67], v242 offset:0
v_sub_f32 v9, 1.0, v7
MV 128,a,96,a,60
ds_read_b128 a[68:71], v242 offset:1024
buffer_load_dwordx4 v238, s[48:51], s69 offen offset:2048 sc1 lds
MV 132,a,100,a,56
v_lshlrev_b32 v52, 16, v200
v_lshlrev_b32 v228, 16, v216
MV 136,a,100,a,60
ds_read_b128 a[72:75], v242 offset:2048
v_and_b32 v53, 0xffff0000, v200
MV 140,a,104,a,56
ds_read_b128 a[76:79], v242 offset:3072
v_and_b32 v229, 0xffff0000, v216
MV 144,a,104,a,60
buffer_load_dwordx4 v238, s[48:51], s69 offen offset:3072 sc1 lds
v_mul_f32 v52, v52, v228
MV 148,a,108,a,56
ds_read_b128 a[80:83], v243 offset:0
v_mul_f32 v53, v53, v229
MV 152,a,108,a,60
ds_read_b128 a[84:87], v243 offset:1024
v_mul_f32 v52, v52, v7
MV 156,a,112,a,56
v_mul_f32 v53, v53, v7
v_lshlrev_b32 v54, 16, v201
MV 160,a,112,a,60
ds_read_b128 a[88:91], v243 offset:2048
s_add_u32 s69, s69, 16384
MV 164,a,116,a,56
ds_read_b128 a[92:95], v243 offset:3072
v_lshlrev_b32 v228, 16, v217
MV 168,a,116,a,60
v_and_b32 v55, 0xffff0000, v201
v_and_b32 v229, 0xffff0000, v217
MV 172,a,120,a,56
v_mul_f32 v54, v54, v228
v_mul_f32 v55, v55, v229
MV 176,a,120,a,60
v_mul_f32 v54, v54, v7
v_mul_f32 v55, v55, v7
MV 180,a,124,a,56
buffer_load_dwordx4 a[56:59], v236, s[44:47], s68 offen offset:1024 sc1
v_lshlrev_b32 v56, 16, v202
MV 184,a,124,a,60
buffer_load_dwordx4 a[60:63], v237, s[44:47], s68 offen offset:1024 sc1
s_add_u32 s68, s68, 2048
v_lshlrev_b32 v228, 16, v218
v_and_b32 v57, 0xffff0000, v202
v_and_b32 v229, 0xffff0000, v218
s_waitcnt lgkmcnt(0)
MV 124,a,64,a,0
ds_read_b128 a[96:99], v242 offset:8192
v_mul_f32 v56, v56, v228
MV 128,a,64,a,4
ds_read_b128 a[100:103], v242 offset:9216
s_add_u32 m0, s70, 115712
MV 132,a,68,a,0
v_mul_f32 v57, v57, v229
v_mul_f32 v56, v56, v7
MV 136,a,68,a,4
ds_read_b128 a[104:107], v242 offset:10240
v_mul_f32 v57, v57, v7
MV 140,a,72,a,0
ds_read_b128 a[108:111], v242 offset:11264
v_lshlrev_b32 v58, 16, v203
MV 144,a,72,a,4
buffer_load_dwordx4 v238, s[48:51], s69 offen offset:0 sc1 lds
v_lshlrev_b32 v228, 16, v219
MV 148,a,76,a,0
ds_read_b128 a[112:115], v243 offset:8192
v_and_b32 v59, 0xffff0000, v203
MV 152,a,76,a,4
ds_read_b128 a[116:119], v243 offset:9216
v_and_b32 v229, 0xffff0000, v219
MV 156,a,80,a,0
v_mul_f32 v58, v58, v228
v_mul_f32 v59, v59, v229
MV 160,a,80,a,4
ds_read_b128 a[120:123], v243 offset:10240
buffer_load_dwordx4 v238, s[48:51], s69 offen offset:1024 sc1 lds
MV 164,a,84,a,0
ds_read_b128 a[124:127], v243 offset:11264
v_mul_f32 v58, v58, v7
MV 168,a,84,a,4
v_mul_f32 v59, v59, v7
v_lshlrev_b32 v60, 16, v204
MV 172,a,88,a,0
v_lshlrev_b32 v228, 16, v220
v_and_b32 v61, 0xffff0000, v204
MV 176,a,88,a,4
v_and_b32 v229, 0xffff0000, v220
v_mul_f32 v60, v60, v228
MV 180,a,92,a,0
v_mul_f32 v61, v61, v229
v_mul_f32 v60, v60, v7
MV 184,a,92,a,4
v_mul_f32 v61, v61, v7
v_lshlrev_b32 v62, 16, v205
v_lshlrev_b32 v228, 16, v221
s_waitcnt vmcnt(12) lgkmcnt(0)
s_barrier
MV 124,a,96,a,8
ds_read_b128 a[80:83], v243 offset:16384
v_and_b32 v63, 0xffff0000, v205
MV 128,a,96,a,12
buffer_load_dwordx4 v238, s[48:51], s69 offen offset:2048 sc1 lds
v_and_b32 v229, 0xffff0000, v221
MV 132,a,100,a,8
v_mul_f32 v62, v62, v228
v_mul_f32 v63, v63, v229
MV 136,a,100,a,12
ds_read_b128 a[84:87], v243 offset:17408
v_mul_f32 v62, v62, v7
MV 140,a,104,a,8
v_mul_f32 v63, v63, v7
v_lshlrev_b32 v64, 16, v206
MV 144,a,104,a,12
buffer_load_dwordx4 v238, s[48:51], s69 offen offset:3072 sc1 lds
v_lshlrev_b32 v228, 16, v222
MV 148,a,108,a,8
ds_read_b128 a[88:91], v243 offset:18432
v_and_b32 v65, 0xffff0000, v206
MV 152,a,108,a,12
v_and_b32 v229, 0xffff0000, v222
v_mul_f32 v64, v64, v228
MV 156,a,112,a,8
v_mul_f32 v65, v65, v229
v_mul_f32 v64, v64, v7
MV 160,a,112,a,12
ds_read_b128 a[92:95], v243 offset:19456
s_add_u32 s69, s69, 16384
MV 164,a,116,a,8
v_mul_f32 v65, v65, v7
v_lshlrev_b32 v66, 16, v207
MV 168,a,116,a,12
v_lshlrev_b32 v228, 16, v223
v_and_b32 v67, 0xffff0000, v207
MV 172,a,120,a,8
v_and_b32 v229, 0xffff0000, v223
MV 176,a,120,a,12
v_mul_f32 v66, v66, v228
v_mul_f32 v67, v67, v229
MV 180,a,124,a,8
v_mul_f32 v66, v66, v7
MV 184,a,124,a,12
v_mul_f32 v67, v67, v7
s_waitcnt lgkmcnt(0)
MV 156,a,80,a,16
ds_read_b128 a[112:115], v243 offset:24576
s_xor_b32 s72, s2, 4
MV 160,a,80,a,20
ds_read_b128 a[116:119], v243 offset:25600
s_lshl_b32 s72, s72, 14
MV 164,a,84,a,16
ds_read_b128 a[120:123], v243 offset:26624
MV 168,a,84,a,20
ds_read_b128 a[124:127], v243 offset:27648
MV 172,a,88,a,16
MV 176,a,88,a,20
MV 180,a,92,a,16
MV 184,a,92,a,20
s_waitcnt vmcnt(6)
s_barrier
s_waitcnt lgkmcnt(3)
MV 156,a,112,a,24
ds_read_b128 a[80:83], v243 offset:32768
MV 160,a,112,a,28
ds_read_b128 a[84:87], v243 offset:33792
s_waitcnt lgkmcnt(4)
MV 164,a,116,a,24
ds_read_b128 a[88:91], v243 offset:34816
MV 168,a,116,a,28
ds_read_b128 a[92:95], v243 offset:35840
s_waitcnt lgkmcnt(5)
MV 172,a,120,a,24
MV 176,a,120,a,28
s_waitcnt lgkmcnt(4)
MV 180,a,124,a,24
MV 184,a,124,a,28
s_waitcnt lgkmcnt(3)
MV 156,a,80,a,32
ds_read_b128 a[112:115], v243 offset:40960
MV 160,a,80,a,36
ds_read_b128 a[116:119], v243 offset:41984
s_waitcnt lgkmcnt(4)
MV 164,a,84,a,32
ds_read_b128 a[120:123], v243 offset:43008
MV 168,a,84,a,36
ds_read_b128 a[124:127], v243 offset:44032
s_waitcnt lgkmcnt(5)
MV 172,a,88,a,32
MV 176,a,88,a,36
s_waitcnt lgkmcnt(4)
MV 180,a,92,a,32
MV 184,a,92,a,36
s_waitcnt vmcnt(0)
s_barrier
s_waitcnt lgkmcnt(3)
MV 156,a,112,a,40
ds_read_b128 a[80:83], v243 offset:49152
MV 160,a,112,a,44
ds_read_b128 a[84:87], v243 offset:50176
s_waitcnt lgkmcnt(4)
MV 164,a,116,a,40
ds_read_b128 a[88:91], v243 offset:51200
MV 168,a,116,a,44
ds_read_b128 a[92:95], v243 offset:52224
s_waitcnt lgkmcnt(5)
MV 172,a,120,a,40
MV 176,a,120,a,44
s_waitcnt lgkmcnt(4)
MV 180,a,124,a,40
MV 184,a,124,a,44
s_waitcnt lgkmcnt(3)
MV 156,a,80,a,48
ds_read_b128 a[112:115], v243 offset:57344
MV 160,a,80,a,52
ds_read_b128 a[116:119], v243 offset:58368
s_waitcnt lgkmcnt(4)
MV 164,a,84,a,48
ds_read_b128 a[120:123], v243 offset:59392
MV 168,a,84,a,52
ds_read_b128 a[124:127], v243 offset:60416
s_waitcnt lgkmcnt(5)
MV 172,a,88,a,48
MV 176,a,88,a,52
s_waitcnt lgkmcnt(4)
MV 180,a,92,a,48
MV 184,a,92,a,52
s_waitcnt lgkmcnt(3)
MV 156,a,112,a,56
ds_read_b128 a[64:67], v242 offset:16384
MV 160,a,112,a,60
ds_read_b128 a[68:71], v242 offset:17408
s_waitcnt lgkmcnt(4)
MV 164,a,116,a,56
ds_read_b128 a[72:75], v242 offset:18432
MV 168,a,116,a,60
ds_read_b128 a[76:79], v242 offset:19456
s_waitcnt lgkmcnt(5)
MV 172,a,120,a,56
MV 176,a,120,a,60
s_waitcnt lgkmcnt(4)
MV 180,a,124,a,56
MV 184,a,124,a,60
s_waitcnt lgkmcnt(3)
MV 124,a,64,a,16
ds_read_b128 a[96:99], v242 offset:24576
MV 128,a,64,a,20
ds_read_b128 a[100:103], v242 offset:25600
s_waitcnt lgkmcnt(4)
MV 132,a,68,a,16
ds_read_b128 a[104:107], v242 offset:26624
v_permlane16_swap_b32 v156, v164
MV 136,a,68,a,20
ds_read_b128 a[108:111], v242 offset:27648
v_permlane16_swap_b32 v157, v165
s_waitcnt lgkmcnt(5)
MV 140,a,72,a,16
v_permlane16_swap_b32 v158, v166
v_permlane16_swap_b32 v159, v167
MV 144,a,72,a,20
v_cvt_pk_bf16_f32 v156, v156, v157
v_cvt_pk_bf16_f32 v157, v158, v159
s_waitcnt lgkmcnt(4)
MV 148,a,76,a,16
v_cvt_pk_bf16_f32 v158, v164, v165
v_cvt_pk_bf16_f32 v159, v166, v167
MV 152,a,76,a,20
buffer_store_dwordx4 v[156:159], v238, s[52:55], s72 offen offset:0 sc1
v_permlane16_swap_b32 v172, v180
s_waitcnt lgkmcnt(3)
MV 124,a,96,a,24
ds_read_b128 a[64:67], v242 offset:32768
v_permlane16_swap_b32 v173, v181
MV 128,a,96,a,28
ds_read_b128 a[68:71], v242 offset:33792
v_permlane16_swap_b32 v174, v182
s_waitcnt lgkmcnt(4)
MV 132,a,100,a,24
ds_read_b128 a[72:75], v242 offset:34816
v_permlane16_swap_b32 v175, v183
MV 136,a,100,a,28
ds_read_b128 a[76:79], v242 offset:35840
v_cvt_pk_bf16_f32 v172, v172, v173
s_waitcnt lgkmcnt(5)
MV 140,a,104,a,24
v_cvt_pk_bf16_f32 v173, v174, v175
v_cvt_pk_bf16_f32 v174, v180, v181
MV 144,a,104,a,28
v_cvt_pk_bf16_f32 v175, v182, v183
buffer_store_dwordx4 v[172:175], v238, s[52:55], s72 offen offset:1024 sc1
s_waitcnt lgkmcnt(4)
MV 148,a,108,a,24
v_permlane16_swap_b32 v160, v168
v_permlane16_swap_b32 v161, v169
MV 152,a,108,a,28
v_permlane16_swap_b32 v162, v170
v_permlane16_swap_b32 v163, v171
s_waitcnt lgkmcnt(3)
MV 124,a,64,a,32
ds_read_b128 a[96:99], v242 offset:40960
v_cvt_pk_bf16_f32 v160, v160, v161
MV 128,a,64,a,36
ds_read_b128 a[100:103], v242 offset:41984
v_cvt_pk_bf16_f32 v161, v162, v163
s_waitcnt lgkmcnt(4)
MV 132,a,68,a,32
ds_read_b128 a[104:107], v242 offset:43008
v_cvt_pk_bf16_f32 v162, v168, v169
MV 136,a,68,a,36
ds_read_b128 a[108:111], v242 offset:44032
v_cvt_pk_bf16_f32 v163, v170, v171
s_waitcnt lgkmcnt(5)
MV 140,a,72,a,32
buffer_store_dwordx4 v[160:163], v238, s[52:55], s72 offen offset:2048 sc1
v_permlane16_swap_b32 v176, v184
MV 144,a,72,a,36
v_permlane16_swap_b32 v177, v185
v_permlane16_swap_b32 v178, v186
s_waitcnt lgkmcnt(4)
MV 148,a,76,a,32
v_permlane16_swap_b32 v179, v187
v_cvt_pk_bf16_f32 v176, v176, v177
MV 152,a,76,a,36
v_cvt_pk_bf16_f32 v177, v178, v179
v_cvt_pk_bf16_f32 v178, v184, v185
s_waitcnt lgkmcnt(3)
MV 124,a,96,a,40
ds_read_b128 a[64:67], v242 offset:49152
v_cvt_pk_bf16_f32 v179, v186, v187
MV 128,a,96,a,44
ds_read_b128 a[68:71], v242 offset:50176
buffer_store_dwordx4 v[176:179], v238, s[52:55], s72 offen offset:3072 sc1
s_waitcnt lgkmcnt(4)
MV 132,a,100,a,40
ds_read_b128 a[72:75], v242 offset:51200
MV 136,a,100,a,44
ds_read_b128 a[76:79], v242 offset:52224
s_waitcnt lgkmcnt(5)
MV 140,a,104,a,40
MV 144,a,104,a,44
s_waitcnt lgkmcnt(4)
MV 148,a,108,a,40
MV 152,a,108,a,44
s_waitcnt lgkmcnt(3)
MV 124,a,64,a,48
ds_read_b128 a[96:99], v242 offset:57344
MV 128,a,64,a,52
ds_read_b128 a[100:103], v242 offset:58368
s_waitcnt lgkmcnt(4)
MV 132,a,68,a,48
ds_read_b128 a[104:107], v242 offset:59392
MV 136,a,68,a,52
ds_read_b128 a[108:111], v242 offset:60416
s_waitcnt lgkmcnt(5)
MV 140,a,72,a,48
MV 144,a,72,a,52
s_waitcnt lgkmcnt(4)
MV 148,a,76,a,48
MV 152,a,76,a,52
s_waitcnt lgkmcnt(3)
MV 124,a,96,a,56
MV 128,a,96,a,60
s_waitcnt lgkmcnt(2)
MV 132,a,100,a,56
MV 136,a,100,a,60
s_waitcnt lgkmcnt(1)
MV 140,a,104,a,56
MV 144,a,104,a,60
s_waitcnt lgkmcnt(0)
MV 148,a,108,a,56
MV 152,a,108,a,60
s_lshl_b32 s72, s2, 14
s_mov_b32 s73, 400000
buffer_load_dwordx4 v[76:79], v238, s[52:55], s72 offen offset:0 sc1
buffer_load_dwordx4 v[80:83], v238, s[52:55], s72 offen offset:1024 sc1
buffer_load_dwordx4 v[84:87], v238, s[52:55], s72 offen offset:2048 sc1
buffer_load_dwordx4 v[88:91], v238, s[52:55], s72 offen offset:3072 sc1
v_permlane16_swap_b32 v124, v132
v_permlane16_swap_b32 v125, v133
v_permlane16_swap_b32 v126, v134
v_permlane16_swap_b32 v127, v135
v_permlane16_swap_b32 v140, v148
v_permlane16_swap_b32 v141, v149
v_permlane16_swap_b32 v142, v150
v_permlane16_swap_b32 v143, v151
v_permlane16_swap_b32 v128, v136
v_permlane16_swap_b32 v129, v137
v_permlane16_swap_b32 v130, v138
v_permlane16_swap_b32 v131, v139
v_permlane16_swap_b32 v144, v152
v_permlane16_swap_b32 v145, v153
v_permlane16_swap_b32 v146, v154
v_permlane16_swap_b32 v147, v155
v_fma_f32 v36, v124, v8, v36
v_fma_f32 v37, v125, v8, v37
v_fma_f32 v38, v126, v8, v38
v_fma_f32 v39, v127, v8, v39
v_fma_f32 v40, v132, v8, v40
v_fma_f32 v41, v133, v8, v41
v_fma_f32 v42, v134, v8, v42
v_fma_f32 v43, v135, v8, v43
v_fma_f32 v44, v140, v8, v44
v_fma_f32 v45, v141, v8, v45
v_fma_f32 v46, v142, v8, v46
v_fma_f32 v47, v143, v8, v47
v_fma_f32 v48, v148, v8, v48
v_fma_f32 v49, v149, v8, v49
v_fma_f32 v50, v150, v8, v50
v_fma_f32 v51, v151, v8, v51
v_fma_f32 v52, v128, v9, v52
v_fma_f32 v53, v129, v9, v53
v_fma_f32 v54, v130, v9, v54
v_fma_f32 v55, v131, v9, v55
v_fma_f32 v56, v136, v9, v56
v_fma_f32 v57, v137, v9, v57
v_fma_f32 v58, v138, v9, v58
v_fma_f32 v59, v139, v9, v59
v_fma_f32 v60, v144, v9, v60
v_fma_f32 v61, v145, v9, v61
v_fma_f32 v62, v146, v9, v62
v_fma_f32 v63, v147, v9, v63
v_fma_f32 v64, v152, v9, v64
v_fma_f32 v65, v153, v9, v65
v_fma_f32 v66, v154, v9, v66
v_fma_f32 v67, v155, v9, v67
s_branch L_xb_chk
L_xb:
buffer_load_dwordx4 v[76:79], v238, s[52:55], s72 offen offset:0 sc1
buffer_load_dwordx4 v[80:83], v238, s[52:55], s72 offen offset:1024 sc1
buffer_load_dwordx4 v[84:87], v238, s[52:55], s72 offen offset:2048 sc1
buffer_load_dwordx4 v[88:91], v238, s[52:55], s72 offen offset:3072 sc1
s_sub_u32 s73, s73, 1
s_cbranch_scc1 L_xb_done
L_xb_chk:
s_waitcnt vmcnt(3)
v_max3_u32 v228, v76, v77, v78
s_waitcnt vmcnt(2)
v_max3_u32 v228, v228, v79, v80
v_max3_u32 v228, v228, v81, v82
s_waitcnt vmcnt(1)
v_max3_u32 v228, v228, v83, v84
v_max3_u32 v228, v228, v85, v86
s_waitcnt vmcnt(0)
v_max3_u32 v228, v228, v87, v88
v_max3_u32 v228, v228, v89, v90
v_max_u32 v228, v228, v91
v_cmp_eq_u32 vcc, -1, v228
s_nop 4
s_cbranch_vccnz L_xb
L_xb_done:
s_waitcnt vmcnt(0)
s_add_u32 s72, s78, 0
v_lshlrev_b32 v92, 16, v76
v_and_b32 v93, 0xffff0000, v76
v_fmac_f32 v36, v92, v8
v_fmac_f32 v37, v93, v8
v_cvt_pk_bf16_f32 v192, v36, v37
v_lshlrev_b32 v92, 16, v77
v_and_b32 v93, 0xffff0000, v77
v_fmac_f32 v38, v92, v8
v_fmac_f32 v39, v93, v8
v_cvt_pk_bf16_f32 v193, v38, v39
v_lshlrev_b32 v92, 16, v78
v_and_b32 v93, 0xffff0000, v78
v_fmac_f32 v40, v92, v8
v_fmac_f32 v41, v93, v8
v_cvt_pk_bf16_f32 v194, v40, v41
v_lshlrev_b32 v92, 16, v79
v_and_b32 v93, 0xffff0000, v79
v_fmac_f32 v42, v92, v8
v_fmac_f32 v43, v93, v8
v_cvt_pk_bf16_f32 v195, v42, v43
buffer_store_dwordx4 v[192:195], v250, s[60:63], s72 offen offset:0 sc1
v_lshlrev_b32 v92, 16, v80
v_and_b32 v93, 0xffff0000, v80
v_fmac_f32 v44, v92, v8
v_fmac_f32 v45, v93, v8
v_cvt_pk_bf16_f32 v196, v44, v45
v_lshlrev_b32 v92, 16, v81
v_and_b32 v93, 0xffff0000, v81
v_fmac_f32 v46, v92, v8
v_fmac_f32 v47, v93, v8
v_cvt_pk_bf16_f32 v197, v46, v47
v_lshlrev_b32 v92, 16, v82
v_and_b32 v93, 0xffff0000, v82
v_fmac_f32 v48, v92, v8
v_fmac_f32 v49, v93, v8
v_cvt_pk_bf16_f32 v198, v48, v49
v_lshlrev_b32 v92, 16, v83
v_and_b32 v93, 0xffff0000, v83
v_fmac_f32 v50, v92, v8
v_fmac_f32 v51, v93, v8
v_cvt_pk_bf16_f32 v199, v50, v51
buffer_store_dwordx4 v[196:199], v250, s[60:63], s72 offen offset:64 sc1
s_add_u32 s72, s78, 32768
v_lshlrev_b32 v92, 16, v84
v_and_b32 v93, 0xffff0000, v84
v_fmac_f32 v52, v92, v9
v_fmac_f32 v53, v93, v9
v_cvt_pk_bf16_f32 v200, v52, v53
v_lshlrev_b32 v92, 16, v85
v_and_b32 v93, 0xffff0000, v85
v_fmac_f32 v54, v92, v9
v_fmac_f32 v55, v93, v9
v_cvt_pk_bf16_f32 v201, v54, v55
v_lshlrev_b32 v92, 16, v86
v_and_b32 v93, 0xffff0000, v86
v_fmac_f32 v56, v92, v9
v_fmac_f32 v57, v93, v9
v_cvt_pk_bf16_f32 v202, v56, v57
v_lshlrev_b32 v92, 16, v87
v_and_b32 v93, 0xffff0000, v87
v_fmac_f32 v58, v92, v9
v_fmac_f32 v59, v93, v9
v_cvt_pk_bf16_f32 v203, v58, v59
buffer_store_dwordx4 v[200:203], v250, s[60:63], s72 offen offset:0 sc1
v_lshlrev_b32 v92, 16, v88
v_and_b32 v93, 0xffff0000, v88
v_fmac_f32 v60, v92, v9
v_fmac_f32 v61, v93, v9
v_cvt_pk_bf16_f32 v204, v60, v61
v_lshlrev_b32 v92, 16, v89
v_and_b32 v93, 0xffff0000, v89
v_fmac_f32 v62, v92, v9
v_fmac_f32 v63, v93, v9
v_cvt_pk_bf16_f32 v205, v62, v63
v_lshlrev_b32 v92, 16, v90
v_and_b32 v93, 0xffff0000, v90
v_fmac_f32 v64, v92, v9
v_fmac_f32 v65, v93, v9
v_cvt_pk_bf16_f32 v206, v64, v65
v_lshlrev_b32 v92, 16, v91
v_and_b32 v93, 0xffff0000, v91
v_fmac_f32 v66, v92, v9
v_fmac_f32 v67, v93, v9
v_cvt_pk_bf16_f32 v207, v66, v67
buffer_store_dwordx4 v[204:207], v250, s[60:63], s72 offen offset:64 sc1
L_end:
s_endpgm
L_p3_pmask:
s_nop 7
v_add_u32 v246, 0, v13
v_cmp_gt_i32_e64 s[84:85], 0, v246
v_cmp_gt_i32_e64 s[86:87], 1, v246
v_cmp_gt_i32_e64 s[88:89], 2, v246
v_cmp_gt_i32_e64 s[90:91], 3, v246
v_cndmask_b32_e64 v96, v96, v14, s[84:85]
v_cndmask_b32_e64 v97, v97, v14, s[86:87]
v_cndmask_b32_e64 v98, v98, v14, s[88:89]
v_cndmask_b32_e64 v99, v99, v14, s[90:91]
v_add_u32 v247, -16, v13
v_cmp_gt_i32_e64 s[92:93], 0, v247
v_cmp_gt_i32_e64 s[94:95], 1, v247
v_cmp_gt_i32_e64 s[96:97], 2, v247
v_cmp_gt_i32_e64 s[98:99], 3, v247
v_cndmask_b32_e64 v100, v100, v14, s[92:93]
v_cndmask_b32_e64 v101, v101, v14, s[94:95]
v_cndmask_b32_e64 v102, v102, v14, s[96:97]
v_cndmask_b32_e64 v103, v103, v14, s[98:99]
v_add_u32 v246, -32, v13
v_cmp_gt_i32_e64 s[84:85], 0, v246
v_cmp_gt_i32_e64 s[86:87], 1, v246
v_cmp_gt_i32_e64 s[88:89], 2, v246
v_cmp_gt_i32_e64 s[90:91], 3, v246
v_cndmask_b32_e64 v128, v128, v14, s[84:85]
v_cndmask_b32_e64 v129, v129, v14, s[86:87]
v_cndmask_b32_e64 v130, v130, v14, s[88:89]
v_cndmask_b32_e64 v131, v131, v14, s[90:91]
v_add_u32 v247, -48, v13
v_cmp_gt_i32_e64 s[92:93], 0, v247
v_cmp_gt_i32_e64 s[94:95], 1, v247
v_cmp_gt_i32_e64 s[96:97], 2, v247
v_cmp_gt_i32_e64 s[98:99], 3, v247
v_cndmask_b32_e64 v132, v132, v14, s[92:93]
v_cndmask_b32_e64 v133, v133, v14, s[94:95]
v_cndmask_b32_e64 v134, v134, v14, s[96:97]
v_cndmask_b32_e64 v135, v135, v14, s[98:99]
s_branch L_p3_pmask_ret
L_p3_mxm_top:
s_waitcnt lgkmcnt(0)
v_xor_b32 v11, 0x8000, v11
v_mfma_f32_16x16x32_bf16 v[80:83], a[128:131], v[16:19], 0
s_add_u32 m0, s73, 16384
ds_read_b128 a[192:195], v11 offset:0
v_mfma_f32_16x16x32_bf16 v[88:91], a[128:131], v[32:35], 0
v_exp_f32 v176, v176
MV 80,a,132,v,20
v_exp_f32 v177, v177
MV 88,a,132,v,36
ds_read_b128 a[196:199], v11 offset:1024
buffer_load_dwordx4 v12, s[56:59], s71 offen offset:0 sc1 lds
MV 80,a,136,v,24
v_exp_f32 v178, v178
MV 88,a,136,v,40
v_add_f32 v2, v2, v176
v_add_f32 v2, v2, v177
MV 80,a,140,v,28
ds_read_b128 a[200:203], v11 offset:2048
ds_read_b128 a[204:207], v11 offset:3072
MV 88,a,140,v,44
v_exp_f32 v179, v179
v_mfma_f32_16x16x32_bf16 v[84:87], a[144:147], v[16:19], 0
ds_read_b128 a[208:211], v11 offset:4096
v_cvt_pk_bf16_f32 v176, v176, v177
v_mfma_f32_16x16x32_bf16 v[92:95], a[144:147], v[32:35], 0
v_exp_f32 v180, v180
MV 84,a,148,v,20
v_add_f32 v2, v2, v178
v_add_f32 v2, v2, v179
MV 92,a,148,v,36
v_exp_f32 v181, v181
MV 84,a,152,v,24
buffer_load_dwordx4 v12, s[56:59], s71 offen offset:1024 sc1 lds
v_cvt_pk_bf16_f32 v177, v178, v179
MV 92,a,152,v,40
v_exp_f32 v182, v182
MV 84,a,156,v,28
ds_read_b128 a[212:215], v11 offset:5120
v_add_f32 v2, v2, v180
MV 92,a,156,v,44
ds_read_b128 a[216:219], v11 offset:6144
v_add_f32 v2, v2, v181
v_mfma_f32_16x16x32_bf16 v[112:115], a[160:163], v[16:19], 0
v_exp_f32 v183, v183
v_mfma_f32_16x16x32_bf16 v[120:123], a[160:163], v[32:35], 0
ds_read_b128 a[220:223], v11 offset:7168
v_cvt_pk_bf16_f32 v178, v180, v181
MV 112,a,164,v,20
v_exp_f32 v184, v184
MV 120,a,164,v,36
v_add_f32 v2, v2, v182
v_add_f32 v2, v2, v183
MV 112,a,168,v,24
ds_read_b128 a[224:227], v11 offset:8192
buffer_load_dwordx4 v12, s[56:59], s71 offen offset:2048 sc1 lds
MV 120,a,168,v,40
v_exp_f32 v185, v185
MV 112,a,172,v,28
ds_read_b128 a[228:231], v11 offset:9216
v_cvt_pk_bf16_f32 v179, v182, v183
MV 120,a,172,v,44
v_exp_f32 v186, v186
v_mfma_f32_16x16x32_bf16 v[116:119], a[176:179], v[16:19], 0
v_add_f32 v3, v3, v184
v_add_f32 v3, v3, v185
v_mfma_f32_16x16x32_bf16 v[124:127], a[176:179], v[32:35], 0
v_exp_f32 v187, v187
MV 116,a,180,v,20
ds_read_b128 a[232:235], v11 offset:10240
v_cvt_pk_bf16_f32 v184, v184, v185
MV 124,a,180,v,36
v_exp_f32 v188, v188
MV 116,a,184,v,24
ds_read_b128 a[236:239], v11 offset:11264
v_add_f32 v3, v3, v186
MV 124,a,184,v,40
buffer_load_dwordx4 v12, s[56:59], s71 offen offset:3072 sc1 lds
v_add_f32 v3, v3, v187
MV 116,a,188,v,28
v_exp_f32 v189, v189
MV 124,a,188,v,44
ds_read_b128 a[240:243], v11 offset:12288
ds_read_b128 a[244:247], v11 offset:13312
ds_read_b128 a[248:251], v11 offset:14336
ds_read_b128 a[252:255], v11 offset:15360
s_add_u32 s71, s71, 16384
s_xor_b32 s73, s73, 0x8000
v_cvt_pk_bf16_f32 v185, v186, v187
v_exp_f32 v190, v190
v_add_f32 v3, v3, v188
v_add_f32 v3, v3, v189
v_exp_f32 v191, v191
v_cvt_pk_bf16_f32 v186, v188, v189
v_exp_f32 v200, v200
v_add_f32 v3, v3, v190
v_add_f32 v3, v3, v191
v_exp_f32 v201, v201
v_cvt_pk_bf16_f32 v187, v190, v191
v_exp_f32 v202, v202
v_add_u32 v246, 0, v13
v_cmp_gt_i32_e64 s[84:85], 0, v246
v_add_f32 v5, v5, v200
v_cmp_gt_i32_e64 s[86:87], 1, v246
v_cmp_gt_i32_e64 s[88:89], 2, v246
v_add_f32 v5, v5, v201
v_exp_f32 v203, v203
v_cmp_gt_i32_e64 s[90:91], 3, v246
v_cndmask_b32_e64 v80, v80, v14, s[84:85]
v_cvt_pk_bf16_f32 v200, v200, v201
v_exp_f32 v204, v204
v_cndmask_b32_e64 v81, v81, v14, s[86:87]
v_cndmask_b32_e64 v82, v82, v14, s[88:89]
v_add_f32 v5, v5, v202
v_add_f32 v5, v5, v203
v_cndmask_b32_e64 v83, v83, v14, s[90:91]
v_exp_f32 v205, v205
v_cvt_pk_bf16_f32 v201, v202, v203
v_add_u32 v247, -16, v13
v_cmp_gt_i32_e64 s[92:93], 0, v247
v_exp_f32 v206, v206
v_add_f32 v5, v5, v204
v_cmp_gt_i32_e64 s[94:95], 1, v247
v_cmp_gt_i32_e64 s[96:97], 2, v247
v_add_f32 v5, v5, v205
v_exp_f32 v207, v207
v_cmp_gt_i32_e64 s[98:99], 3, v247
v_cndmask_b32_e64 v84, v84, v14, s[92:93]
v_cvt_pk_bf16_f32 v202, v204, v205
v_add_f32 v5, v5, v206
v_cndmask_b32_e64 v85, v85, v14, s[94:95]
v_cndmask_b32_e64 v86, v86, v14, s[96:97]
v_add_f32 v5, v5, v207
v_cvt_pk_bf16_f32 v203, v206, v207
v_cndmask_b32_e64 v87, v87, v14, s[98:99]
s_waitcnt vmcnt(16) lgkmcnt(0)
MA 0,a,192,v,144
s_barrier
v_xor_b32 v10, 0x8000, v10
MA 32,a,192,v,152
s_add_u32 m0, s72, 16384
ds_read_b128 a[128:131], v10 offset:0
MA 4,a,196,v,144
buffer_load_dwordx4 v12, s[52:55], s71 offen offset:0 sc1 lds
v_lshrrev_b32 v249, 2, v1
MA 36,a,196,v,152
ds_read_b128 a[132:135], v10 offset:1024
v_and_b32 v248, 7, v249
MA 8,a,200,v,144
v_exp_f32 v80, v80
MA 40,a,200,v,152
v_lshlrev_b32 v249, 8, v249
v_and_b32 v250, 3, v1
MA 12,a,204,v,144
ds_read_b128 a[136:139], v10 offset:2048
v_lshl_add_u32 v249, v250, 3, v249
MA 44,a,204,v,152
v_exp_f32 v81, v81
MA 16,a,208,v,144
v_add_u32 v246, -32, v13
s_lshl_b32 s36, s3, 13
MA 48,a,208,v,152
s_add_u32 s36, s36, 131072
v_add_u32 v249, s36, v249
MA 20,a,212,v,144
v_exp_f32 v82, v82
MA 52,a,212,v,152
ds_read_b128 a[140:143], v10 offset:3072
s_nop 0
MA 24,a,216,v,144
v_cmp_gt_i32_e64 s[84:85], 0, v246
v_xor_b32 v250, 0, v248
MA 56,a,216,v,152
ds_read_b128 a[144:147], v10 offset:4096
v_lshl_add_u32 v250, v250, 5, v249
MA 28,a,220,v,144
v_exp_f32 v83, v83
MA 60,a,220,v,152
v_cmp_gt_i32_e64 s[86:87], 1, v246
TR 96,250,0
MA 124,a,220,v,168
TR 98,250,4096
v_xor_b32 v250, 1, v248
MA 120,a,216,v,168
ds_read_b128 a[148:151], v10 offset:5120
buffer_load_dwordx4 v12, s[52:55], s71 offen offset:1024 sc1 lds
MA 116,a,212,v,168
v_cvt_pk_bf16_f32 v80, v80, v81
v_lshl_add_u32 v250, v250, 5, v249
MA 112,a,208,v,168
TR 100,250,0
TR 102,250,4096
MA 108,a,204,v,168
v_exp_f32 v84, v84
MA 104,a,200,v,168
v_cmp_gt_i32_e64 s[88:89], 2, v246
v_xor_b32 v250, 2, v248
MA 100,a,196,v,168
ds_read_b128 a[152:155], v10 offset:6144
v_lshl_add_u32 v250, v250, 5, v249
MA 96,a,192,v,168
v_cmp_gt_i32_e64 s[90:91], 3, v246
TR 104,250,0
MA 0,a,224,v,176
v_exp_f32 v85, v85
MA 32,a,224,v,184
ds_read_b128 a[156:159], v10 offset:7168
TR 106,250,4096
MA 4,a,228,v,176
v_cvt_pk_bf16_f32 v81, v82, v83
v_xor_b32 v250, 3, v248
MA 36,a,228,v,184
v_cndmask_b32_e64 v112, v112, v14, s[84:85]
v_lshl_add_u32 v250, v250, 5, v249
MA 8,a,232,v,176
ds_read_b128 a[160:163], v10 offset:8192
TR 108,250,0
MA 40,a,232,v,184
TR 110,250,4096
v_xor_b32 v250, 4, v248
MA 12,a,236,v,176
v_exp_f32 v86, v86
MA 44,a,236,v,184
ds_read_b128 a[164:167], v10 offset:9216
v_lshl_add_u32 v250, v250, 5, v249
MA 16,a,240,v,176
buffer_load_dwordx4 v12, s[52:55], s71 offen offset:2048 sc1 lds
v_cndmask_b32_e64 v113, v113, v14, s[86:87]
MA 48,a,240,v,184
TR 128,250,0
TR 130,250,4096
MA 20,a,244,v,176
v_exp_f32 v87, v87
MA 52,a,244,v,184
ds_read_b128 a[168:171], v10 offset:10240
v_xor_b32 v250, 5, v248
MA 24,a,248,v,176
v_cvt_pk_bf16_f32 v82, v84, v85
v_cndmask_b32_e64 v114, v114, v14, s[88:89]
MA 56,a,248,v,184
v_lshl_add_u32 v250, v250, 5, v249
TR 132,250,0
MA 28,a,252,v,176
v_cndmask_b32_e64 v115, v115, v14, s[90:91]
TR 134,250,4096
MA 60,a,252,v,184
v_exp_f32 v88, v88
MA 124,a,252,v,200
ds_read_b128 a[172:175], v10 offset:11264
v_xor_b32 v250, 6, v248
MA 120,a,248,v,200
v_lshl_add_u32 v250, v250, 5, v249
TR 136,250,0
MA 116,a,244,v,200
ds_read_b128 a[176:179], v10 offset:12288
TR 138,250,4096
MA 112,a,240,v,200
v_exp_f32 v89, v89
MA 108,a,236,v,200
v_add_u32 v247, -48, v13
v_xor_b32 v250, 7, v248
MA 104,a,232,v,200
v_cvt_pk_bf16_f32 v83, v86, v87
v_lshl_add_u32 v250, v250, 5, v249
MA 100,a,228,v,200
ds_read_b128 a[180:183], v10 offset:13312
TR 140,250,0
MA 96,a,224,v,200
ds_read_b128 a[184:187], v10 offset:14336
ds_read_b128 a[188:191], v10 offset:15360
buffer_load_dwordx4 v12, s[52:55], s71 offen offset:3072 sc1 lds
s_xor_b32 s72, s72, 0x8000
v_exp_f32 v90, v90
v_cmp_gt_i32_e64 s[92:93], 0, v247
TR 142,250,4096
s_add_u32 s32, s40, 100663296
s_addc_u32 s33, s41, 0
v_exp_f32 v91, v91
v_cmp_gt_i32_e64 s[94:95], 1, v247
s_mov_b32 s34, 8388608
s_mov_b32 s35, 0x20000
s_and_b32 s36, s2, 7
s_lshl_b32 s36, s36, 20
s_lshr_b32 s37, s2, 3
v_cvt_pk_bf16_f32 v88, v88, v89
v_cmp_gt_i32_e64 s[96:97], 2, v247
s_lshl_b32 s37, s37, 15
v_exp_f32 v92, v92
s_add_u32 s36, s36, s37
s_lshl_b32 s37, s3, 12
v_cmp_gt_i32_e64 s[98:99], 3, v247
s_add_u32 s36, s36, s37
v_exp_f32 v93, v93
s_add_u32 s37, s36, 4096
s_waitcnt lgkmcnt(15)
buffer_store_dwordx4 v[96:99], v12, s[32:35], s36 offen offset:0 sc1
v_cndmask_b32_e64 v116, v116, v14, s[92:93]
buffer_store_dwordx4 v[100:103], v12, s[32:35], s36 offen offset:1024 sc1
v_cvt_pk_bf16_f32 v89, v90, v91
buffer_store_dwordx4 v[104:107], v12, s[32:35], s36 offen offset:2048 sc1
buffer_store_dwordx4 v[108:111], v12, s[32:35], s36 offen offset:3072 sc1
s_waitcnt lgkmcnt(12)
buffer_store_dwordx4 v[128:131], v12, s[32:35], s37 offen offset:0 sc1
v_exp_f32 v94, v94
v_cndmask_b32_e64 v117, v117, v14, s[94:95]
s_waitcnt lgkmcnt(9)
buffer_store_dwordx4 v[132:135], v12, s[32:35], s37 offen offset:1024 sc1
s_waitcnt lgkmcnt(5)
buffer_store_dwordx4 v[136:139], v12, s[32:35], s37 offen offset:2048 sc1
s_waitcnt lgkmcnt(0)
buffer_store_dwordx4 v[140:143], v12, s[32:35], s37 offen offset:3072 sc1
v_exp_f32 v95, v95
v_cndmask_b32_e64 v118, v118, v14, s[96:97]
v_lshlrev_b32 v232, 4, v1
v_mov_b32 v235, 0
buffer_load_ushort v234, v235, s[28:31], s42 offen
v_cvt_pk_bf16_f32 v90, v92, v93
v_cndmask_b32_e64 v119, v119, v14, s[98:99]
buffer_load_dwordx4 v[210:213], v232, s[16:19], 0 offen offset:0
buffer_load_dwordx4 v[216:219], v232, s[16:19], 0 offen offset:1024
v_cvt_pk_bf16_f32 v91, v94, v95
buffer_load_dwordx4 v[222:225], v232, s[16:19], 0 offen offset:2048
buffer_load_dwordx4 v[228:231], v232, s[16:19], 0 offen offset:3072
s_branch L_p3_eps
L_fallback:
s_mov_b32 s81, 0
s_mov_b32 s74, s77
s_mov_b32 s73, s100
s_sub_u32 s72, 15, s70
v_mov_b32 v10, v15
v_add_u32 v11, 16384, v15
s_nop 15
L_fb_set:
s_lshl_b32 s72, s72, 7
s_mov_b32 s71, 0
v_accvgpr_write_b32 a0, 0
v_accvgpr_write_b32 a1, 0
v_accvgpr_write_b32 a2, 0
v_accvgpr_write_b32 a3, 0
v_accvgpr_write_b32 a4, 0
v_accvgpr_write_b32 a5, 0
v_accvgpr_write_b32 a6, 0
v_accvgpr_write_b32 a7, 0
v_accvgpr_write_b32 a8, 0
v_accvgpr_write_b32 a9, 0
v_accvgpr_write_b32 a10, 0
v_accvgpr_write_b32 a11, 0
v_accvgpr_write_b32 a12, 0
v_accvgpr_write_b32 a13, 0
v_accvgpr_write_b32 a14, 0
v_accvgpr_write_b32 a15, 0
v_accvgpr_write_b32 a16, 0
v_accvgpr_write_b32 a17, 0
v_accvgpr_write_b32 a18, 0
v_accvgpr_write_b32 a19, 0
v_accvgpr_write_b32 a20, 0
v_accvgpr_write_b32 a21, 0
v_accvgpr_write_b32 a22, 0
v_accvgpr_write_b32 a23, 0
v_accvgpr_write_b32 a24, 0
v_accvgpr_write_b32 a25, 0
v_accvgpr_write_b32 a26, 0
v_accvgpr_write_b32 a27, 0
v_accvgpr_write_b32 a28, 0
v_accvgpr_write_b32 a29, 0
v_accvgpr_write_b32 a30, 0
v_accvgpr_write_b32 a31, 0
v_accvgpr_write_b32 a32, 0
v_accvgpr_write_b32 a33, 0
v_accvgpr_write_b32 a34, 0
v_accvgpr_write_b32 a35, 0
v_accvgpr_write_b32 a36, 0
v_accvgpr_write_b32 a37, 0
v_accvgpr_write_b32 a38, 0
v_accvgpr_write_b32 a39, 0
v_accvgpr_write_b32 a40, 0
v_accvgpr_write_b32 a41, 0
v_accvgpr_write_b32 a42, 0
v_accvgpr_write_b32 a43, 0
v_accvgpr_write_b32 a44, 0
v_accvgpr_write_b32 a45, 0
v_accvgpr_write_b32 a46, 0
v_accvgpr_write_b32 a47, 0
v_accvgpr_write_b32 a48, 0
v_accvgpr_write_b32 a49, 0
v_accvgpr_write_b32 a50, 0
v_accvgpr_write_b32 a51, 0
v_accvgpr_write_b32 a52, 0
v_accvgpr_write_b32 a53, 0
v_accvgpr_write_b32 a54, 0
v_accvgpr_write_b32 a55, 0
v_accvgpr_write_b32 a56, 0
v_accvgpr_write_b32 a57, 0
v_accvgpr_write_b32 a58, 0
v_accvgpr_write_b32 a59, 0
v_accvgpr_write_b32 a60, 0
v_accvgpr_write_b32 a61, 0
v_accvgpr_write_b32 a62, 0
v_accvgpr_write_b32 a63, 0
v_mov_b32 v2, 0
v_mov_b32 v96, v14
v_mov_b32 v3, 0
v_mov_b32 v97, v14
L_fb_tile:
s_waitcnt vmcnt(0) lgkmcnt(0)
s_barrier
s_mov_b32 m0, s68
s_add_u32 s80, s71, 16384
buffer_load_dwordx4 v12, s[52:55], s71 offen offset:0 sc1 lds
buffer_load_dwordx4 v12, s[52:55], s71 offen offset:1024 sc1 lds
buffer_load_dwordx4 v12, s[52:55], s71 offen offset:2048 sc1 lds
buffer_load_dwordx4 v12, s[52:55], s71 offen offset:3072 sc1 lds
s_add_u32 m0, s68, 16384
s_nop 0
buffer_load_dwordx4 v12, s[56:59], s80 offen offset:0 sc1 lds
buffer_load_dwordx4 v12, s[56:59], s80 offen offset:1024 sc1 lds
buffer_load_dwordx4 v12, s[56:59], s80 offen offset:2048 sc1 lds
buffer_load_dwordx4 v12, s[56:59], s80 offen offset:3072 sc1 lds
s_waitcnt vmcnt(0)
s_barrier
ds_read_b128 a[128:131], v10 offset:0
ds_read_b128 a[132:135], v10 offset:1024
ds_read_b128 a[136:139], v10 offset:2048
ds_read_b128 a[140:143], v10 offset:3072
ds_read_b128 a[144:147], v10 offset:4096
ds_read_b128 a[148:151], v10 offset:5120
ds_read_b128 a[152:155], v10 offset:6144
ds_read_b128 a[156:159], v10 offset:7168
ds_read_b128 a[160:163], v10 offset:8192
ds_read_b128 a[164:167], v10 offset:9216
ds_read_b128 a[168:171], v10 offset:10240
ds_read_b128 a[172:175], v10 offset:11264
ds_read_b128 a[176:179], v10 offset:12288
ds_read_b128 a[180:183], v10 offset:13312
ds_read_b128 a[184:187], v10 offset:14336
ds_read_b128 a[188:191], v10 offset:15360
s_waitcnt lgkmcnt(0)
ds_read_b128 a[192:195], v11 offset:0
ds_read_b128 a[196:199], v11 offset:1024
ds_read_b128 a[200:203], v11 offset:2048
ds_read_b128 a[204:207], v11 offset:3072
ds_read_b128 a[208:211], v11 offset:4096
ds_read_b128 a[212:215], v11 offset:5120
ds_read_b128 a[216:219], v11 offset:6144
ds_read_b128 a[220:223], v11 offset:7168
ds_read_b128 a[224:227], v11 offset:8192
ds_read_b128 a[228:231], v11 offset:9216
ds_read_b128 a[232:235], v11 offset:10240
ds_read_b128 a[236:239], v11 offset:11264
ds_read_b128 a[240:243], v11 offset:12288
ds_read_b128 a[244:247], v11 offset:13312
ds_read_b128 a[248:251], v11 offset:14336
ds_read_b128 a[252:255], v11 offset:15360
v_mfma_f32_16x16x32_bf16 v[80:83], a[128:131], v[16:19], 0
v_mfma_f32_16x16x32_bf16 v[88:91], a[128:131], v[32:35], 0
MV 80,a,132,v,20
MV 88,a,132,v,36
MV 80,a,136,v,24
MV 88,a,136,v,40
MV 80,a,140,v,28
MV 88,a,140,v,44
v_mfma_f32_16x16x32_bf16 v[84:87], a[144:147], v[16:19], 0
v_mfma_f32_16x16x32_bf16 v[92:95], a[144:147], v[32:35], 0
MV 84,a,148,v,20
MV 92,a,148,v,36
MV 84,a,152,v,24
MV 92,a,152,v,40
MV 84,a,156,v,28
MV 92,a,156,v,44
v_mfma_f32_16x16x32_bf16 v[112:115], a[160:163], v[16:19], 0
v_mfma_f32_16x16x32_bf16 v[120:123], a[160:163], v[32:35], 0
MV 112,a,164,v,20
MV 120,a,164,v,36
MV 112,a,168,v,24
MV 120,a,168,v,40
MV 112,a,172,v,28
MV 120,a,172,v,44
v_mfma_f32_16x16x32_bf16 v[116:119], a[176:179], v[16:19], 0
v_mfma_f32_16x16x32_bf16 v[124:127], a[176:179], v[32:35], 0
MV 116,a,180,v,20
MV 124,a,180,v,36
MV 116,a,184,v,24
MV 124,a,184,v,40
MV 116,a,188,v,28
MV 124,a,188,v,44
v_add_u32 v246, s72, v13
v_add_u32 v246, 0, v246
v_cmp_gt_i32_e64 s[84:85], 0, v246
v_cmp_gt_i32_e64 s[86:87], 1, v246
v_cmp_gt_i32_e64 s[88:89], 2, v246
v_cmp_gt_i32_e64 s[90:91], 3, v246
v_cndmask_b32_e64 v80, v80, v14, s[84:85]
v_cndmask_b32_e64 v81, v81, v14, s[86:87]
v_cndmask_b32_e64 v82, v82, v14, s[88:89]
v_cndmask_b32_e64 v83, v83, v14, s[90:91]
v_add_u32 v247, s72, v239
v_add_u32 v247, 0, v247
v_cmp_gt_i32_e64 s[92:93], 0, v247
v_cmp_gt_i32_e64 s[94:95], 1, v247
v_cmp_gt_i32_e64 s[96:97], 2, v247
v_cmp_gt_i32_e64 s[98:99], 3, v247
v_cndmask_b32_e64 v88, v88, v14, s[92:93]
v_cndmask_b32_e64 v89, v89, v14, s[94:95]
v_cndmask_b32_e64 v90, v90, v14, s[96:97]
v_cndmask_b32_e64 v91, v91, v14, s[98:99]
v_add_u32 v246, s72, v13
v_add_u32 v246, -16, v246
v_cmp_gt_i32_e64 s[84:85], 0, v246
v_cmp_gt_i32_e64 s[86:87], 1, v246
v_cmp_gt_i32_e64 s[88:89], 2, v246
v_cmp_gt_i32_e64 s[90:91], 3, v246
v_cndmask_b32_e64 v84, v84, v14, s[84:85]
v_cndmask_b32_e64 v85, v85, v14, s[86:87]
v_cndmask_b32_e64 v86, v86, v14, s[88:89]
v_cndmask_b32_e64 v87, v87, v14, s[90:91]
v_add_u32 v247, s72, v239
v_add_u32 v247, -16, v247
v_cmp_gt_i32_e64 s[92:93], 0, v247
v_cmp_gt_i32_e64 s[94:95], 1, v247
v_cmp_gt_i32_e64 s[96:97], 2, v247
v_cmp_gt_i32_e64 s[98:99], 3, v247
v_cndmask_b32_e64 v92, v92, v14, s[92:93]
v_cndmask_b32_e64 v93, v93, v14, s[94:95]
v_cndmask_b32_e64 v94, v94, v14, s[96:97]
v_cndmask_b32_e64 v95, v95, v14, s[98:99]
v_add_u32 v246, s72, v13
v_add_u32 v246, -32, v246
v_cmp_gt_i32_e64 s[84:85], 0, v246
v_cmp_gt_i32_e64 s[86:87], 1, v246
v_cmp_gt_i32_e64 s[88:89], 2, v246
v_cmp_gt_i32_e64 s[90:91], 3, v246
v_cndmask_b32_e64 v112, v112, v14, s[84:85]
v_cndmask_b32_e64 v113, v113, v14, s[86:87]
v_cndmask_b32_e64 v114, v114, v14, s[88:89]
v_cndmask_b32_e64 v115, v115, v14, s[90:91]
v_add_u32 v247, s72, v239
v_add_u32 v247, -32, v247
v_cmp_gt_i32_e64 s[92:93], 0, v247
v_cmp_gt_i32_e64 s[94:95], 1, v247
v_cmp_gt_i32_e64 s[96:97], 2, v247
v_cmp_gt_i32_e64 s[98:99], 3, v247
v_cndmask_b32_e64 v120, v120, v14, s[92:93]
v_cndmask_b32_e64 v121, v121, v14, s[94:95]
v_cndmask_b32_e64 v122, v122, v14, s[96:97]
v_cndmask_b32_e64 v123, v123, v14, s[98:99]
v_add_u32 v246, s72, v13
v_add_u32 v246, -48, v246
v_cmp_gt_i32_e64 s[84:85], 0, v246
v_cmp_gt_i32_e64 s[86:87], 1, v246
v_cmp_gt_i32_e64 s[88:89], 2, v246
v_cmp_gt_i32_e64 s[90:91], 3, v246
v_cndmask_b32_e64 v116, v116, v14, s[84:85]
v_cndmask_b32_e64 v117, v117, v14, s[86:87]
v_cndmask_b32_e64 v118, v118, v14, s[88:89]
v_cndmask_b32_e64 v119, v119, v14, s[90:91]
v_add_u32 v247, s72, v239
v_add_u32 v247, -48, v247
v_cmp_gt_i32_e64 s[92:93], 0, v247
v_cmp_gt_i32_e64 s[94:95], 1, v247
v_cmp_gt_i32_e64 s[96:97], 2, v247
v_cmp_gt_i32_e64 s[98:99], 3, v247
v_cndmask_b32_e64 v124, v124, v14, s[92:93]
v_cndmask_b32_e64 v125, v125, v14, s[94:95]
v_cndmask_b32_e64 v126, v126, v14, s[96:97]
v_cndmask_b32_e64 v127, v127, v14, s[98:99]
v_mov_b32 v242, v96
v_max3_f32 v242, v242, v80, v81
v_max3_f32 v242, v242, v82, v83
v_max3_f32 v242, v242, v84, v85
v_max3_f32 v242, v242, v86, v87
v_max3_f32 v242, v242, v112, v113
v_max3_f32 v242, v242, v114, v115
v_max3_f32 v242, v242, v116, v117
v_max3_f32 v242, v242, v118, v119
v_mov_b32 v243, v242
s_nop 1
v_permlane32_swap_b32 v242, v243
v_max_f32 v242, v242, v243
v_mov_b32 v243, v242
s_nop 1
v_permlane16_swap_b32 v242, v243
v_max_f32 v242, v242, v243
v_sub_f32 v98, v96, v242
v_exp_f32 v98, v98
v_mov_b32 v96, v242
v_sub_f32 v80, v80, v242
v_sub_f32 v81, v81, v242
v_sub_f32 v82, v82, v242
v_sub_f32 v83, v83, v242
v_sub_f32 v84, v84, v242
v_sub_f32 v85, v85, v242
v_sub_f32 v86, v86, v242
v_sub_f32 v87, v87, v242
v_sub_f32 v112, v112, v242
v_sub_f32 v113, v113, v242
v_sub_f32 v114, v114, v242
v_sub_f32 v115, v115, v242
v_sub_f32 v116, v116, v242
v_sub_f32 v117, v117, v242
v_sub_f32 v118, v118, v242
v_sub_f32 v119, v119, v242
v_mul_f32 v2, v2, v98
v_accvgpr_read_b32 v243, a0
v_mul_f32 v243, v243, v98
v_accvgpr_write_b32 a0, v243
v_accvgpr_read_b32 v243, a1
v_mul_f32 v243, v243, v98
v_accvgpr_write_b32 a1, v243
v_accvgpr_read_b32 v243, a2
v_mul_f32 v243, v243, v98
v_accvgpr_write_b32 a2, v243
v_accvgpr_read_b32 v243, a3
v_mul_f32 v243, v243, v98
v_accvgpr_write_b32 a3, v243
v_accvgpr_read_b32 v243, a4
v_mul_f32 v243, v243, v98
v_accvgpr_write_b32 a4, v243
v_accvgpr_read_b32 v243, a5
v_mul_f32 v243, v243, v98
v_accvgpr_write_b32 a5, v243
v_accvgpr_read_b32 v243, a6
v_mul_f32 v243, v243, v98
v_accvgpr_write_b32 a6, v243
v_accvgpr_read_b32 v243, a7
v_mul_f32 v243, v243, v98
v_accvgpr_write_b32 a7, v243
v_accvgpr_read_b32 v243, a8
v_mul_f32 v243, v243, v98
v_accvgpr_write_b32 a8, v243
v_accvgpr_read_b32 v243, a9
v_mul_f32 v243, v243, v98
v_accvgpr_write_b32 a9, v243
v_accvgpr_read_b32 v243, a10
v_mul_f32 v243, v243, v98
v_accvgpr_write_b32 a10, v243
v_accvgpr_read_b32 v243, a11
v_mul_f32 v243, v243, v98
v_accvgpr_write_b32 a11, v243
v_accvgpr_read_b32 v243, a12
v_mul_f32 v243, v243, v98
v_accvgpr_write_b32 a12, v243
v_accvgpr_read_b32 v243, a13
v_mul_f32 v243, v243, v98
v_accvgpr_write_b32 a13, v243
v_accvgpr_read_b32 v243, a14
v_mul_f32 v243, v243, v98
v_accvgpr_write_b32 a14, v243
v_accvgpr_read_b32 v243, a15
v_mul_f32 v243, v243, v98
v_accvgpr_write_b32 a15, v243
v_accvgpr_read_b32 v243, a16
v_mul_f32 v243, v243, v98
v_accvgpr_write_b32 a16, v243
v_accvgpr_read_b32 v243, a17
v_mul_f32 v243, v243, v98
v_accvgpr_write_b32 a17, v243
v_accvgpr_read_b32 v243, a18
v_mul_f32 v243, v243, v98
v_accvgpr_write_b32 a18, v243
v_accvgpr_read_b32 v243, a19
v_mul_f32 v243, v243, v98
v_accvgpr_write_b32 a19, v243
v_accvgpr_read_b32 v243, a20
v_mul_f32 v243, v243, v98
v_accvgpr_write_b32 a20, v243
v_accvgpr_read_b32 v243, a21
v_mul_f32 v243, v243, v98
v_accvgpr_write_b32 a21, v243
v_accvgpr_read_b32 v243, a22
v_mul_f32 v243, v243, v98
v_accvgpr_write_b32 a22, v243
v_accvgpr_read_b32 v243, a23
v_mul_f32 v243, v243, v98
v_accvgpr_write_b32 a23, v243
v_accvgpr_read_b32 v243, a24
v_mul_f32 v243, v243, v98
v_accvgpr_write_b32 a24, v243
v_accvgpr_read_b32 v243, a25
v_mul_f32 v243, v243, v98
v_accvgpr_write_b32 a25, v243
v_accvgpr_read_b32 v243, a26
v_mul_f32 v243, v243, v98
v_accvgpr_write_b32 a26, v243
v_accvgpr_read_b32 v243, a27
v_mul_f32 v243, v243, v98
v_accvgpr_write_b32 a27, v243
v_accvgpr_read_b32 v243, a28
v_mul_f32 v243, v243, v98
v_accvgpr_write_b32 a28, v243
v_accvgpr_read_b32 v243, a29
v_mul_f32 v243, v243, v98
v_accvgpr_write_b32 a29, v243
v_accvgpr_read_b32 v243, a30
v_mul_f32 v243, v243, v98
v_accvgpr_write_b32 a30, v243
v_accvgpr_read_b32 v243, a31
v_mul_f32 v243, v243, v98
v_accvgpr_write_b32 a31, v243
v_mov_b32 v242, v97
v_max3_f32 v242, v242, v88, v89
v_max3_f32 v242, v242, v90, v91
v_max3_f32 v242, v242, v92, v93
v_max3_f32 v242, v242, v94, v95
v_max3_f32 v242, v242, v120, v121
v_max3_f32 v242, v242, v122, v123
v_max3_f32 v242, v242, v124, v125
v_max3_f32 v242, v242, v126, v127
v_mov_b32 v243, v242
s_nop 1
v_permlane32_swap_b32 v242, v243
v_max_f32 v242, v242, v243
v_mov_b32 v243, v242
s_nop 1
v_permlane16_swap_b32 v242, v243
v_max_f32 v242, v242, v243
v_sub_f32 v99, v97, v242
v_exp_f32 v99, v99
v_mov_b32 v97, v242
v_sub_f32 v88, v88, v242
v_sub_f32 v89, v89, v242
v_sub_f32 v90, v90, v242
v_sub_f32 v91, v91, v242
v_sub_f32 v92, v92, v242
v_sub_f32 v93, v93, v242
v_sub_f32 v94, v94, v242
v_sub_f32 v95, v95, v242
v_sub_f32 v120, v120, v242
v_sub_f32 v121, v121, v242
v_sub_f32 v122, v122, v242
v_sub_f32 v123, v123, v242
v_sub_f32 v124, v124, v242
v_sub_f32 v125, v125, v242
v_sub_f32 v126, v126, v242
v_sub_f32 v127, v127, v242
v_mul_f32 v3, v3, v99
v_accvgpr_read_b32 v243, a32
v_mul_f32 v243, v243, v99
v_accvgpr_write_b32 a32, v243
v_accvgpr_read_b32 v243, a33
v_mul_f32 v243, v243, v99
v_accvgpr_write_b32 a33, v243
v_accvgpr_read_b32 v243, a34
v_mul_f32 v243, v243, v99
v_accvgpr_write_b32 a34, v243
v_accvgpr_read_b32 v243, a35
v_mul_f32 v243, v243, v99
v_accvgpr_write_b32 a35, v243
v_accvgpr_read_b32 v243, a36
v_mul_f32 v243, v243, v99
v_accvgpr_write_b32 a36, v243
v_accvgpr_read_b32 v243, a37
v_mul_f32 v243, v243, v99
v_accvgpr_write_b32 a37, v243
v_accvgpr_read_b32 v243, a38
v_mul_f32 v243, v243, v99
v_accvgpr_write_b32 a38, v243
v_accvgpr_read_b32 v243, a39
v_mul_f32 v243, v243, v99
v_accvgpr_write_b32 a39, v243
v_accvgpr_read_b32 v243, a40
v_mul_f32 v243, v243, v99
v_accvgpr_write_b32 a40, v243
v_accvgpr_read_b32 v243, a41
v_mul_f32 v243, v243, v99
v_accvgpr_write_b32 a41, v243
v_accvgpr_read_b32 v243, a42
v_mul_f32 v243, v243, v99
v_accvgpr_write_b32 a42, v243
v_accvgpr_read_b32 v243, a43
v_mul_f32 v243, v243, v99
v_accvgpr_write_b32 a43, v243
v_accvgpr_read_b32 v243, a44
v_mul_f32 v243, v243, v99
v_accvgpr_write_b32 a44, v243
v_accvgpr_read_b32 v243, a45
v_mul_f32 v243, v243, v99
v_accvgpr_write_b32 a45, v243
v_accvgpr_read_b32 v243, a46
v_mul_f32 v243, v243, v99
v_accvgpr_write_b32 a46, v243
v_accvgpr_read_b32 v243, a47
v_mul_f32 v243, v243, v99
v_accvgpr_write_b32 a47, v243
v_accvgpr_read_b32 v243, a48
v_mul_f32 v243, v243, v99
v_accvgpr_write_b32 a48, v243
v_accvgpr_read_b32 v243, a49
v_mul_f32 v243, v243, v99
v_accvgpr_write_b32 a49, v243
v_accvgpr_read_b32 v243, a50
v_mul_f32 v243, v243, v99
v_accvgpr_write_b32 a50, v243
v_accvgpr_read_b32 v243, a51
v_mul_f32 v243, v243, v99
v_accvgpr_write_b32 a51, v243
v_accvgpr_read_b32 v243, a52
v_mul_f32 v243, v243, v99
v_accvgpr_write_b32 a52, v243
v_accvgpr_read_b32 v243, a53
v_mul_f32 v243, v243, v99
v_accvgpr_write_b32 a53, v243
v_accvgpr_read_b32 v243, a54
v_mul_f32 v243, v243, v99
v_accvgpr_write_b32 a54, v243
v_accvgpr_read_b32 v243, a55
v_mul_f32 v243, v243, v99
v_accvgpr_write_b32 a55, v243
v_accvgpr_read_b32 v243, a56
v_mul_f32 v243, v243, v99
v_accvgpr_write_b32 a56, v243
v_accvgpr_read_b32 v243, a57
v_mul_f32 v243, v243, v99
v_accvgpr_write_b32 a57, v243
v_accvgpr_read_b32 v243, a58
v_mul_f32 v243, v243, v99
v_accvgpr_write_b32 a58, v243
v_accvgpr_read_b32 v243, a59
v_mul_f32 v243, v243, v99
v_accvgpr_write_b32 a59, v243
v_accvgpr_read_b32 v243, a60
v_mul_f32 v243, v243, v99
v_accvgpr_write_b32 a60, v243
v_accvgpr_read_b32 v243, a61
v_mul_f32 v243, v243, v99
v_accvgpr_write_b32 a61, v243
v_accvgpr_read_b32 v243, a62
v_mul_f32 v243, v243, v99
v_accvgpr_write_b32 a62, v243
v_accvgpr_read_b32 v243, a63
v_mul_f32 v243, v243, v99
v_accvgpr_write_b32 a63, v243
v_exp_f32 v80, v80
v_exp_f32 v81, v81
v_exp_f32 v82, v82
v_add_f32 v2, v2, v80
v_add_f32 v2, v2, v81
v_exp_f32 v83, v83
v_cvt_pk_bf16_f32 v80, v80, v81
v_exp_f32 v84, v84
v_add_f32 v2, v2, v82
v_add_f32 v2, v2, v83
v_exp_f32 v85, v85
v_cvt_pk_bf16_f32 v81, v82, v83
v_exp_f32 v86, v86
v_add_f32 v2, v2, v84
v_add_f32 v2, v2, v85
v_exp_f32 v87, v87
v_cvt_pk_bf16_f32 v82, v84, v85
v_exp_f32 v88, v88
v_add_f32 v2, v2, v86
v_add_f32 v2, v2, v87
v_exp_f32 v89, v89
v_cvt_pk_bf16_f32 v83, v86, v87
v_exp_f32 v90, v90
v_add_f32 v3, v3, v88
v_add_f32 v3, v3, v89
v_exp_f32 v91, v91
v_cvt_pk_bf16_f32 v88, v88, v89
v_exp_f32 v92, v92
v_add_f32 v3, v3, v90
v_add_f32 v3, v3, v91
v_exp_f32 v93, v93
v_cvt_pk_bf16_f32 v89, v90, v91
v_exp_f32 v94, v94
v_add_f32 v3, v3, v92
v_add_f32 v3, v3, v93
v_exp_f32 v95, v95
v_cvt_pk_bf16_f32 v90, v92, v93
v_exp_f32 v112, v112
v_add_f32 v3, v3, v94
v_add_f32 v3, v3, v95
v_exp_f32 v113, v113
v_cvt_pk_bf16_f32 v91, v94, v95
v_exp_f32 v114, v114
v_add_f32 v2, v2, v112
v_add_f32 v2, v2, v113
v_exp_f32 v115, v115
v_cvt_pk_bf16_f32 v112, v112, v113
v_exp_f32 v116, v116
v_add_f32 v2, v2, v114
v_add_f32 v2, v2, v115
v_exp_f32 v117, v117
v_cvt_pk_bf16_f32 v113, v114, v115
v_exp_f32 v118, v118
v_add_f32 v2, v2, v116
v_add_f32 v2, v2, v117
v_exp_f32 v119, v119
v_cvt_pk_bf16_f32 v114, v116, v117
v_exp_f32 v120, v120
v_add_f32 v2, v2, v118
v_add_f32 v2, v2, v119
v_exp_f32 v121, v121
v_cvt_pk_bf16_f32 v115, v118, v119
v_exp_f32 v122, v122
v_add_f32 v3, v3, v120
v_add_f32 v3, v3, v121
v_exp_f32 v123, v123
v_cvt_pk_bf16_f32 v120, v120, v121
v_exp_f32 v124, v124
v_add_f32 v3, v3, v122
v_add_f32 v3, v3, v123
v_exp_f32 v125, v125
v_cvt_pk_bf16_f32 v121, v122, v123
v_exp_f32 v126, v126
v_add_f32 v3, v3, v124
v_add_f32 v3, v3, v125
v_exp_f32 v127, v127
v_cvt_pk_bf16_f32 v122, v124, v125
v_add_f32 v3, v3, v126
v_add_f32 v3, v3, v127
v_cvt_pk_bf16_f32 v123, v126, v127
s_waitcnt lgkmcnt(15)
MA 0,a,192,v,80
MA 32,a,192,v,88
s_waitcnt lgkmcnt(14)
MA 4,a,196,v,80
MA 36,a,196,v,88
s_waitcnt lgkmcnt(13)
MA 8,a,200,v,80
MA 40,a,200,v,88
s_waitcnt lgkmcnt(12)
MA 12,a,204,v,80
MA 44,a,204,v,88
s_waitcnt lgkmcnt(11)
MA 16,a,208,v,80
MA 48,a,208,v,88
s_waitcnt lgkmcnt(10)
MA 20,a,212,v,80
MA 52,a,212,v,88
s_waitcnt lgkmcnt(9)
MA 24,a,216,v,80
MA 56,a,216,v,88
s_waitcnt lgkmcnt(8)
MA 28,a,220,v,80
MA 60,a,220,v,88
s_waitcnt lgkmcnt(7)
MA 0,a,224,v,112
MA 32,a,224,v,120
s_waitcnt lgkmcnt(6)
MA 4,a,228,v,112
MA 36,a,228,v,120
s_waitcnt lgkmcnt(5)
MA 8,a,232,v,112
MA 40,a,232,v,120
s_waitcnt lgkmcnt(4)
MA 12,a,236,v,112
MA 44,a,236,v,120
s_waitcnt lgkmcnt(3)
MA 16,a,240,v,112
MA 48,a,240,v,120
s_waitcnt lgkmcnt(2)
MA 20,a,244,v,112
MA 52,a,244,v,120
s_waitcnt lgkmcnt(1)
MA 24,a,248,v,112
MA 56,a,248,v,120
s_waitcnt lgkmcnt(0)
MA 28,a,252,v,112
MA 60,a,252,v,120
s_add_u32 s71, s71, 16384
s_sub_u32 s72, s72, 64
s_sub_u32 s74, s74, 1
s_nop 15
s_cmp_lg_u32 s74, 0
s_cbranch_scc1 L_fb_tile
v_mov_b32 v240, v2
s_nop 1
v_permlane32_swap_b32 v2, v240
v_add_f32 v2, v2, v240
v_mov_b32 v240, v2
s_nop 1
v_permlane16_swap_b32 v2, v240
v_add_f32 v2, v2, v240
v_mov_b32 v240, v3
s_nop 1
v_permlane32_swap_b32 v3, v240
v_add_f32 v3, v3, v240
v_mov_b32 v240, v3
s_nop 1
v_permlane16_swap_b32 v3, v240
v_add_f32 v3, v3, v240
v_rcp_f32 v2, v2
v_rcp_f32 v3, v3
s_add_u32 s80, s73, s76
s_nop 4
v_accvgpr_read_b32 v240, a0
v_accvgpr_read_b32 v241, a1
v_accvgpr_read_b32 v242, a2
v_accvgpr_read_b32 v243, a3
v_accvgpr_read_b32 v244, a4
v_accvgpr_read_b32 v245, a5
v_accvgpr_read_b32 v246, a6
v_accvgpr_read_b32 v247, a7
v_pk_mul_f32 v[240:241], v[240:241], v[2:3] op_sel:[0,0] op_sel_hi:[1,0]
v_pk_mul_f32 v[242:243], v[242:243], v[2:3] op_sel:[0,0] op_sel_hi:[1,0]
v_pk_mul_f32 v[244:245], v[244:245], v[2:3] op_sel:[0,0] op_sel_hi:[1,0]
v_pk_mul_f32 v[246:247], v[246:247], v[2:3] op_sel:[0,0] op_sel_hi:[1,0]
v_cvt_pk_bf16_f32 v248, v240, v241
v_cvt_pk_bf16_f32 v249, v242, v243
v_cvt_pk_bf16_f32 v250, v244, v245
v_cvt_pk_bf16_f32 v251, v246, v247
buffer_store_dwordx4 v[248:251], v15, s[60:63], s73 offen offset:0 sc1
v_accvgpr_read_b32 v240, a8
v_accvgpr_read_b32 v241, a9
v_accvgpr_read_b32 v242, a10
v_accvgpr_read_b32 v243, a11
v_accvgpr_read_b32 v244, a12
v_accvgpr_read_b32 v245, a13
v_accvgpr_read_b32 v246, a14
v_accvgpr_read_b32 v247, a15
v_pk_mul_f32 v[240:241], v[240:241], v[2:3] op_sel:[0,0] op_sel_hi:[1,0]
v_pk_mul_f32 v[242:243], v[242:243], v[2:3] op_sel:[0,0] op_sel_hi:[1,0]
v_pk_mul_f32 v[244:245], v[244:245], v[2:3] op_sel:[0,0] op_sel_hi:[1,0]
v_pk_mul_f32 v[246:247], v[246:247], v[2:3] op_sel:[0,0] op_sel_hi:[1,0]
v_cvt_pk_bf16_f32 v252, v240, v241
v_cvt_pk_bf16_f32 v253, v242, v243
v_cvt_pk_bf16_f32 v254, v244, v245
v_cvt_pk_bf16_f32 v255, v246, v247
buffer_store_dwordx4 v[252:255], v15, s[60:63], s73 offen offset:1024 sc1
v_accvgpr_read_b32 v240, a16
v_accvgpr_read_b32 v241, a17
v_accvgpr_read_b32 v242, a18
v_accvgpr_read_b32 v243, a19
v_accvgpr_read_b32 v244, a20
v_accvgpr_read_b32 v245, a21
v_accvgpr_read_b32 v246, a22
v_accvgpr_read_b32 v247, a23
v_pk_mul_f32 v[240:241], v[240:241], v[2:3] op_sel:[0,0] op_sel_hi:[1,0]
v_pk_mul_f32 v[242:243], v[242:243], v[2:3] op_sel:[0,0] op_sel_hi:[1,0]
v_pk_mul_f32 v[244:245], v[244:245], v[2:3] op_sel:[0,0] op_sel_hi:[1,0]
v_pk_mul_f32 v[246:247], v[246:247], v[2:3] op_sel:[0,0] op_sel_hi:[1,0]
v_cvt_pk_bf16_f32 v248, v240, v241
v_cvt_pk_bf16_f32 v249, v242, v243
v_cvt_pk_bf16_f32 v250, v244, v245
v_cvt_pk_bf16_f32 v251, v246, v247
buffer_store_dwordx4 v[248:251], v15, s[60:63], s73 offen offset:2048 sc1
v_accvgpr_read_b32 v240, a24
v_accvgpr_read_b32 v241, a25
v_accvgpr_read_b32 v242, a26
v_accvgpr_read_b32 v243, a27
v_accvgpr_read_b32 v244, a28
v_accvgpr_read_b32 v245, a29
v_accvgpr_read_b32 v246, a30
v_accvgpr_read_b32 v247, a31
v_pk_mul_f32 v[240:241], v[240:241], v[2:3] op_sel:[0,0] op_sel_hi:[1,0]
v_pk_mul_f32 v[242:243], v[242:243], v[2:3] op_sel:[0,0] op_sel_hi:[1,0]
v_pk_mul_f32 v[244:245], v[244:245], v[2:3] op_sel:[0,0] op_sel_hi:[1,0]
v_pk_mul_f32 v[246:247], v[246:247], v[2:3] op_sel:[0,0] op_sel_hi:[1,0]
v_cvt_pk_bf16_f32 v252, v240, v241
v_cvt_pk_bf16_f32 v253, v242, v243
v_cvt_pk_bf16_f32 v254, v244, v245
v_cvt_pk_bf16_f32 v255, v246, v247
buffer_store_dwordx4 v[252:255], v15, s[60:63], s73 offen offset:3072 sc1
v_accvgpr_read_b32 v240, a32
v_accvgpr_read_b32 v241, a33
v_accvgpr_read_b32 v242, a34
v_accvgpr_read_b32 v243, a35
v_accvgpr_read_b32 v244, a36
v_accvgpr_read_b32 v245, a37
v_accvgpr_read_b32 v246, a38
v_accvgpr_read_b32 v247, a39
v_pk_mul_f32 v[240:241], v[240:241], v[2:3] op_sel:[0,1] op_sel_hi:[1,1]
v_pk_mul_f32 v[242:243], v[242:243], v[2:3] op_sel:[0,1] op_sel_hi:[1,1]
v_pk_mul_f32 v[244:245], v[244:245], v[2:3] op_sel:[0,1] op_sel_hi:[1,1]
v_pk_mul_f32 v[246:247], v[246:247], v[2:3] op_sel:[0,1] op_sel_hi:[1,1]
v_cvt_pk_bf16_f32 v248, v240, v241
v_cvt_pk_bf16_f32 v249, v242, v243
v_cvt_pk_bf16_f32 v250, v244, v245
v_cvt_pk_bf16_f32 v251, v246, v247
buffer_store_dwordx4 v[248:251], v15, s[60:63], s80 offen offset:0 sc1
v_accvgpr_read_b32 v240, a40
v_accvgpr_read_b32 v241, a41
v_accvgpr_read_b32 v242, a42
v_accvgpr_read_b32 v243, a43
v_accvgpr_read_b32 v244, a44
v_accvgpr_read_b32 v245, a45
v_accvgpr_read_b32 v246, a46
v_accvgpr_read_b32 v247, a47
v_pk_mul_f32 v[240:241], v[240:241], v[2:3] op_sel:[0,1] op_sel_hi:[1,1]
v_pk_mul_f32 v[242:243], v[242:243], v[2:3] op_sel:[0,1] op_sel_hi:[1,1]
v_pk_mul_f32 v[244:245], v[244:245], v[2:3] op_sel:[0,1] op_sel_hi:[1,1]
v_pk_mul_f32 v[246:247], v[246:247], v[2:3] op_sel:[0,1] op_sel_hi:[1,1]
v_cvt_pk_bf16_f32 v252, v240, v241
v_cvt_pk_bf16_f32 v253, v242, v243
v_cvt_pk_bf16_f32 v254, v244, v245
v_cvt_pk_bf16_f32 v255, v246, v247
buffer_store_dwordx4 v[252:255], v15, s[60:63], s80 offen offset:1024 sc1
v_accvgpr_read_b32 v240, a48
v_accvgpr_read_b32 v241, a49
v_accvgpr_read_b32 v242, a50
v_accvgpr_read_b32 v243, a51
v_accvgpr_read_b32 v244, a52
v_accvgpr_read_b32 v245, a53
v_accvgpr_read_b32 v246, a54
v_accvgpr_read_b32 v247, a55
v_pk_mul_f32 v[240:241], v[240:241], v[2:3] op_sel:[0,1] op_sel_hi:[1,1]
v_pk_mul_f32 v[242:243], v[242:243], v[2:3] op_sel:[0,1] op_sel_hi:[1,1]
v_pk_mul_f32 v[244:245], v[244:245], v[2:3] op_sel:[0,1] op_sel_hi:[1,1]
v_pk_mul_f32 v[246:247], v[246:247], v[2:3] op_sel:[0,1] op_sel_hi:[1,1]
v_cvt_pk_bf16_f32 v248, v240, v241
v_cvt_pk_bf16_f32 v249, v242, v243
v_cvt_pk_bf16_f32 v250, v244, v245
v_cvt_pk_bf16_f32 v251, v246, v247
buffer_store_dwordx4 v[248:251], v15, s[60:63], s80 offen offset:2048 sc1
v_accvgpr_read_b32 v240, a56
v_accvgpr_read_b32 v241, a57
v_accvgpr_read_b32 v242, a58
v_accvgpr_read_b32 v243, a59
v_accvgpr_read_b32 v244, a60
v_accvgpr_read_b32 v245, a61
v_accvgpr_read_b32 v246, a62
v_accvgpr_read_b32 v247, a63
v_pk_mul_f32 v[240:241], v[240:241], v[2:3] op_sel:[0,1] op_sel_hi:[1,1]
v_pk_mul_f32 v[242:243], v[242:243], v[2:3] op_sel:[0,1] op_sel_hi:[1,1]
v_pk_mul_f32 v[244:245], v[244:245], v[2:3] op_sel:[0,1] op_sel_hi:[1,1]
v_pk_mul_f32 v[246:247], v[246:247], v[2:3] op_sel:[0,1] op_sel_hi:[1,1]
v_cvt_pk_bf16_f32 v252, v240, v241
v_cvt_pk_bf16_f32 v253, v242, v243
v_cvt_pk_bf16_f32 v254, v244, v245
v_cvt_pk_bf16_f32 v255, v246, v247
buffer_store_dwordx4 v[252:255], v15, s[60:63], s80 offen offset:3072 sc1
s_cmp_lg_u32 s81, 0
s_cbranch_scc1 L_fb_done
s_mov_b32 s81, 1
s_sub_u32 s74, 34, s77
s_mov_b32 s73, s101
s_mov_b32 s72, s70
v_mov_b32 v16, v48
v_mov_b32 v17, v49
v_mov_b32 v18, v50
v_mov_b32 v19, v51
v_mov_b32 v20, v52
v_mov_b32 v21, v53
v_mov_b32 v22, v54
v_mov_b32 v23, v55
v_mov_b32 v24, v56
v_mov_b32 v25, v57
v_mov_b32 v26, v58
v_mov_b32 v27, v59
v_mov_b32 v28, v60
v_mov_b32 v29, v61
v_mov_b32 v30, v62
v_mov_b32 v31, v63
v_mov_b32 v32, v64
v_mov_b32 v33, v65
v_mov_b32 v34, v66
v_mov_b32 v35, v67
v_mov_b32 v36, v68
v_mov_b32 v37, v69
v_mov_b32 v38, v70
v_mov_b32 v39, v71
v_mov_b32 v40, v72
v_mov_b32 v41, v73
v_mov_b32 v42, v74
v_mov_b32 v43, v75
v_mov_b32 v44, v76
v_mov_b32 v45, v77
v_mov_b32 v46, v78
v_mov_b32 v47, v79
s_branch L_fb_set
L_fb_done:
s_waitcnt vmcnt(0) lgkmcnt(0)
s_barrier
s_load_dwordx2 s[88:89], s[0:1], 104
s_mul_i32 s36, s3, 8320
v_and_b32 v16, 15, v1
v_lshrrev_b32 v17, 4, v1
v_add_u32 v18, 1, v16
v_and_b32 v19, 1, v18
v_mul_u32_u24 v19, 4160, v19
v_add_u32 v18, 2, v16
v_lshrrev_b32 v18, 1, v18
v_lshl_add_u32 v19, v18, 2, v19
v_lshl_add_u32 v19, v17, 4, v19
v_add_u32 v40, s36, v19
v_add_u32 v41, 1024, v40
v_add_u32 v42, 2048, v40
v_add_u32 v43, 3072, v40
v_add_u32 v10, s36, v232
v_lshlrev_b32 v18, 5, v16
v_lshlrev_b32 v19, 4, v17
v_sub_u32 v19, v19, v18
s_add_u32 s37, s43, 480
v_add_u32 v5, s37, v19
v_mov_b32 v20, 0
v_mov_b32 v21, 0
v_mov_b32 v22, 0
v_mov_b32 v23, 0
v_and_b32 v16, 1, v1
v_mul_u32_u24 v16, 4160, v16
v_and_b32 v17, 2, v1
v_lshl_add_u32 v16, v17, 3, v16
v_add_u32 v16, s36, v16
ds_write_b128 v16, v[20:23]
v_and_b32 v17, 31, v1
v_lshlrev_b32 v17, 4, v17
v_add_u32 v17, s43, v17
ds_write_b128 v17, v[20:23] offset:4096
v_mov_b32 v209, 0
ds_write_b128 v10, v[210:213] offset:32
s_nop 0
v_mov_b32_dpp v209, v213 wave_shr:1 row_mask:0xf bank_mask:0xf
v_alignbit_b32 v24, v210, v209, 16
v_alignbit_b32 v25, v211, v210, 16
v_alignbit_b32 v26, v212, v211, 16
v_alignbit_b32 v27, v213, v212, 16
ds_write_b128 v10, v[24:27] offset:4192
v_mov_b32_dpp v215, v213 wave_ror:1 row_mask:0xf bank_mask:0xf
ds_write_b128 v10, v[216:219] offset:1056
s_nop 0
v_mov_b32_dpp v215, v219 wave_shr:1 row_mask:0xf bank_mask:0xf
v_alignbit_b32 v28, v216, v215, 16
v_alignbit_b32 v29, v217, v216, 16
v_alignbit_b32 v30, v218, v217, 16
v_alignbit_b32 v31, v219, v218, 16
ds_write_b128 v10, v[28:31] offset:5216
v_mov_b32_dpp v221, v219 wave_ror:1 row_mask:0xf bank_mask:0xf
ds_write_b128 v10, v[222:225] offset:2080
s_nop 0
v_mov_b32_dpp v221, v225 wave_shr:1 row_mask:0xf bank_mask:0xf
v_alignbit_b32 v24, v222, v221, 16
v_alignbit_b32 v25, v223, v222, 16
v_alignbit_b32 v26, v224, v223, 16
v_alignbit_b32 v27, v225, v224, 16
ds_write_b128 v10, v[24:27] offset:6240
v_mov_b32_dpp v227, v225 wave_ror:1 row_mask:0xf bank_mask:0xf
ds_write_b128 v10, v[228:231] offset:3104
s_nop 0
v_mov_b32_dpp v227, v231 wave_shr:1 row_mask:0xf bank_mask:0xf
v_alignbit_b32 v28, v228, v227, 16
v_alignbit_b32 v29, v229, v228, 16
v_alignbit_b32 v30, v230, v229, 16
v_alignbit_b32 v31, v231, v230, 16
ds_write_b128 v10, v[28:31] offset:7264
ds_read_b128 a[160:163], v5 offset:3584
ds_read2_b32 a[128:129], v40 offset0:0 offset1:1
ds_read2_b32 a[130:131], v40 offset0:2 offset1:3
ds_read_b128 a[164:167], v5 offset:3072
ds_read2_b32 a[132:133], v40 offset0:128 offset1:129
ds_read2_b32 a[134:135], v40 offset0:130 offset1:131
ds_read_b128 a[168:171], v5 offset:2560
ds_read2_b32 a[136:137], v41 offset0:0 offset1:1
ds_read2_b32 a[138:139], v41 offset0:2 offset1:3
ds_read_b128 a[172:175], v5 offset:2048
ds_read2_b32 a[140:141], v41 offset0:128 offset1:129
ds_read2_b32 a[142:143], v41 offset0:130 offset1:131
ds_read_b128 a[176:179], v5 offset:1536
ds_read2_b32 a[144:145], v42 offset0:0 offset1:1
ds_read2_b32 a[146:147], v42 offset0:2 offset1:3
ds_read_b128 a[180:183], v5 offset:1024
ds_read2_b32 a[148:149], v42 offset0:128 offset1:129
ds_read2_b32 a[150:151], v42 offset0:130 offset1:131
ds_read_b128 a[184:187], v5 offset:512
ds_read2_b32 a[152:153], v43 offset0:0 offset1:1
ds_read2_b32 a[154:155], v43 offset0:2 offset1:3
ds_read_b128 a[188:191], v5 offset:0
ds_read2_b32 a[156:157], v43 offset0:128 offset1:129
ds_read2_b32 a[158:159], v43 offset0:130 offset1:131
s_waitcnt lgkmcnt(0)
s_branch L_p3_done
L_spin_go:
s_mov_b32 s36, 400000
L_spin_go_l:
s_sleep 1
buffer_load_dword v254, off, s[12:15], 0 sc1
s_waitcnt vmcnt(0)
v_cmp_gt_u32 vcc, 1, v254
s_nop 4
s_cbranch_vccz L_spin_go_ret
s_sub_u32 s36, s36, 1
s_cmp_lg_u32 s36, 0
s_cbranch_scc1 L_spin_go_l
s_branch L_spin_go_ret
L_spin_f1:
s_mov_b32 s36, 400000
L_spin_f1_l:
s_sleep 1
buffer_load_dword v237, v233, s[8:11], 0 offen offset:0 sc1
s_waitcnt vmcnt(0)
v_cmp_gt_u32 vcc, 1, v237
s_nop 4
s_cbranch_vccz L_spin_f1_ret
s_sub_u32 s36, s36, 1
s_cmp_lg_u32 s36, 0
s_cbranch_scc1 L_spin_f1_l
s_branch L_spin_f1_ret
L_spin_w:
s_mov_b32 s36, 400000
L_spin_w_l:
s_sleep 1
buffer_load_dword v253, v254, s[8:11], 0 offen offset:1024 sc1
s_waitcnt vmcnt(0)
v_cmp_gt_u32 vcc, 1, v253
s_nop 4
s_cbranch_vccz L_spin_w_ret
s_sub_u32 s36, s36, 1
s_cmp_lg_u32 s36, 0
s_cbranch_scc1 L_spin_w_l
s_branch L_spin_w_ret
L_spin_f2:
s_mov_b32 s36, 400000
L_spin_f2_l:
s_sleep 1
buffer_load_dword v253, v252, s[8:11], 0 offen sc1
s_waitcnt vmcnt(0)
v_cmp_gt_u32 vcc, 1, v253
s_nop 4
s_cbranch_vccz L_spin_f2_ret
s_sub_u32 s36, s36, 1
s_cmp_lg_u32 s36, 0
s_cbranch_scc1 L_spin_f2_l
s_branch L_spin_f2_ret
L_p5_x1:
v_mov_b32 v253, 1
s_lshl_b32 s36, s2, 2
buffer_store_dword v253, v255, s[8:11], s36 offen offset:2048 sc1
v_and_b32 v254, 15, v1
s_lshl_b32 s36, s82, 4
v_add_u32 v254, s36, v254
v_lshlrev_b32 v254, 2, v254
s_branch L_p5_loop
L_p5_x2:
buffer_load_dword v253, v254, s[8:11], 0 offen offset:2048 sc1
s_branch L_p5_loop
L_spin_f3:
s_mov_b32 s36, 400000
L_spin_f3_l:
s_sleep 1
buffer_load_dword v253, v254, s[8:11], 0 offen offset:2048 sc1
s_waitcnt vmcnt(0)
v_cmp_gt_u32 vcc, 1, v253
s_nop 4
s_cbranch_vccz L_spin_f3_ret
s_sub_u32 s36, s36, 1
s_cmp_lg_u32 s36, 0
s_cbranch_scc1 L_spin_f3_l
s_branch L_spin_f3_ret
L_code_end:
s_endpgm
.section .rodata,"a"
.p2align 6
.amdhsa_kernel gated_mix__ssm_conv_h3__compressed_kv_cla__prompt_kernel
  .amdhsa_next_free_vgpr 512
  .amdhsa_next_free_sgpr 102
  .amdhsa_accum_offset 256
  .amdhsa_group_segment_fixed_size 0
  .amdhsa_kernarg_size 128
  .amdhsa_user_sgpr_count 2
  .amdhsa_user_sgpr_kernarg_segment_ptr 1
  .amdhsa_system_sgpr_workgroup_id_x 1
  .amdhsa_float_denorm_mode_32 3
.end_amdhsa_kernel
.text
```

```asm
; @launch grid=(256,1,1) block=(256,1,1) lds=163840
.amdgcn_target "amdgcn-amd-amdhsa--gfx950"
.text
.macro MA d,x,a,y,b
v_mfma_f32_16x16x32_bf16 a[\d:\d+3], \x[\a:\a+3], \y[\b:\b+3], a[\d:\d+3]
.endm
.macro MV d,x,a,y,b
v_mfma_f32_16x16x32_bf16 v[\d:\d+3], \x[\a:\a+3], \y[\b:\b+3], v[\d:\d+3]
.endm
.macro TR d,a,o
ds_read_b64_tr_b16 v[\d:\d+1], v\a offset:\o
.endm
.globl gated_mix__ssm_conv_h3__compressed_kv_cla__prompt_kernel
.p2align 8
.type gated_mix__ssm_conv_h3__compressed_kv_cla__prompt_kernel,@function
gated_mix__ssm_conv_h3__compressed_kv_cla__prompt_kernel:
s_cmp_ge_u32 s2, 256
s_cbranch_scc1 L_end
s_load_dwordx8 s[44:51], s[0:1], 56
s_load_dwordx4 s[52:55], s[0:1], 112
v_lshrrev_b32 v2, 6, v0
v_and_b32 v1, 63, v0
v_lshlrev_b32 v3, 4, v0
v_readfirstlane_b32 s3, v2
s_getpc_b64 s[4:5]
L_ct_e:
s_add_u32 s4, s4, L_p1_K - L_ct_e
s_addc_u32 s5, s5, 0
v_mov_b32 v77, s5
v_mov_b32 v76, s4
s_lshr_b32 s4, s2, 3
s_lshl_b32 s4, s4, 2
s_add_u32 s4, s4, s3
s_lshl_b32 s4, s4, 7
v_and_b32 v79, 3, v1
v_lshlrev_b32 v79, 14, v79
v_add_u32 v79, s4, v79
v_min_u32 v79, L_p3_begin - L_p1_K - 4, v79
v_add_co_u32 v76, vcc, v76, v79
s_nop 1
v_addc_co_u32 v77, vcc, 0, v77, vcc
global_load_dword v79, v[76:77], off
s_and_b32 s36, s2, 7
s_lshr_b32 s37, s2, 3
s_and_b32 s38, s37, 7
s_lshr_b32 s37, s37, 3
s_lshr_b32 s42, s37, 1
s_and_b32 s37, s37, 1
s_lshl_b32 s36, s36, 1
s_add_u32 s36, s36, s37
s_lshl_b32 s24, s38, 18
s_lshl_b32 s39, s3, 16
s_add_u32 s24, s24, s39
s_lshl_b32 s25, s3, 17
s_lshl_b32 s39, s36, 9
s_add_u32 s25, s25, s39
s_and_b32 s20, s2, 7
s_lshl_b32 s21, s20, 19
s_lshl_b32 s20, s20, 7
s_lshl_b32 s22, s3, 13
s_add_u32 s23, s22, 98304
v_lshrrev_b32 v204, 3, v1
v_lshlrev_b32 v204, 10, v204
v_lshrrev_b32 v205, 4, v1
v_and_b32 v206, 7, v1
v_xor_b32 v206, v206, v205
v_lshl_add_u32 v204, v206, 4, v204
v_xor_b32 v207, 64, v204
v_add_u32 v176, 0, v204
v_add_u32 v177, 7168, v207
v_add_u32 v178, 14336, v204
v_add_u32 v179, 21504, v207
v_add_u32 v180, 32768, v204
v_add_u32 v181, 39936, v207
v_add_u32 v182, 47104, v204
v_add_u32 v183, 54272, v207
v_lshrrev_b32 v204, 5, v1
v_and_b32 v206, 31, v1
v_lshlrev_b32 v207, 1, v204
v_xor_b32 v206, v206, v207
v_lshlrev_b32 v204, 13, v204
v_xor_b32 v207, 0, v206
v_lshl_add_u32 v207, v207, 4, v204
v_add_u32 v184, 0, v207
v_xor_b32 v207, 4, v206
v_lshl_add_u32 v207, v207, 4, v204
v_add_u32 v185, 15360, v207
v_xor_b32 v207, 0, v206
v_lshl_add_u32 v207, v207, 4, v204
v_add_u32 v186, 30720, v207
v_xor_b32 v207, 4, v206
v_lshl_add_u32 v207, v207, 4, v204
v_add_u32 v187, 46080, v207
v_xor_b32 v207, 8, v206
v_lshl_add_u32 v207, v207, 4, v204
v_add_u32 v188, 65536, v207
v_xor_b32 v207, 12, v206
v_lshl_add_u32 v207, v207, 4, v204
v_add_u32 v189, 80896, v207
v_xor_b32 v207, 8, v206
v_lshl_add_u32 v207, v207, 4, v204
v_add_u32 v190, 96256, v207
v_xor_b32 v207, 12, v206
v_lshl_add_u32 v207, v207, 4, v204
v_add_u32 v191, 111616, v207
s_waitcnt lgkmcnt(0)
s_add_u32 s8, s44, s24
s_addc_u32 s9, s45, 0
s_mov_b32 s10, 65536
s_mov_b32 s11, 0x20000
s_cmp_eq_u32 s42, 0
s_cselect_b32 s12, s48, s50
s_cselect_b32 s13, s49, s51
s_add_u32 s12, s12, s25
s_addc_u32 s13, s13, 0
s_sub_u32 s14, 4194304, s25
s_mov_b32 s15, 0x20000
s_add_u32 m0, s23, 0
s_nop 0
buffer_load_dwordx4 v184, s[12:15], s21 offen offset:0 lds
buffer_load_dwordx4 v185, s[12:15], s21 offen offset:1024 lds
buffer_load_dwordx4 v186, s[12:15], s21 offen offset:2048 lds
buffer_load_dwordx4 v187, s[12:15], s21 offen offset:3072 lds
s_add_u32 m0, s23, 4096
s_nop 0
buffer_load_dwordx4 v188, s[12:15], s21 offen offset:0 lds
buffer_load_dwordx4 v189, s[12:15], s21 offen offset:1024 lds
buffer_load_dwordx4 v190, s[12:15], s21 offen offset:2048 lds
buffer_load_dwordx4 v191, s[12:15], s21 offen offset:3072 lds
s_add_u32 s21, s21, 524288
s_and_b32 s21, s21, 4194303
s_add_u32 m0, s22, 0
s_nop 0
buffer_load_dwordx4 v176, s[8:11], s20 offen offset:0 lds
buffer_load_dwordx4 v177, s[8:11], s20 offen offset:1024 lds
buffer_load_dwordx4 v178, s[8:11], s20 offen offset:2048 lds
buffer_load_dwordx4 v179, s[8:11], s20 offen offset:3072 lds
s_add_u32 m0, s22, 4096
s_nop 0
buffer_load_dwordx4 v180, s[8:11], s20 offen offset:0 lds
buffer_load_dwordx4 v181, s[8:11], s20 offen offset:1024 lds
buffer_load_dwordx4 v182, s[8:11], s20 offen offset:2048 lds
buffer_load_dwordx4 v183, s[8:11], s20 offen offset:3072 lds
s_add_u32 s20, s20, 128
s_and_b32 s20, s20, 1023
s_mov_b64 s[40:41], s[54:55]
s_mov_b64 s[34:35], s[46:47]
s_load_dwordx2 s[32:33], s[0:1], 0
s_load_dwordx2 s[84:85], s[0:1], 8
s_load_dwordx2 s[88:89], s[0:1], 16
s_load_dwordx2 s[92:93], s[0:1], 0
s_load_dwordx2 s[96:97], s[0:1], 24
s_load_dwordx2 s[76:77], s[0:1], 96
s_add_u32 s4, s40, 59768832
s_addc_u32 s5, s41, 0
s_mov_b32 s6, 8192
s_mov_b32 s7, 0x20000
s_lshl_b32 s43, s2, 20
v_add_u32 v3, s43, v3
v_mov_b32 v4, 0
v_mov_b32 v5, 0
v_mov_b32 v6, 0
v_mov_b32 v7, 0
s_movk_i32 s43, 4096
buffer_store_dwordx4 v[4:7], v3, s[4:7], 0 offen sc1
buffer_store_dwordx4 v[4:7], v3, s[4:7], s43 offen sc1
s_waitcnt vmcnt(18)
v_lshlrev_b32 v79, 16, v3
v_and_b32 v204, 15, v1
v_lshrrev_b32 v206, 1, v204
v_xor_b32 v206, v206, v205
v_lshlrev_b32 v206, 4, v206
v_lshl_add_u32 v206, v204, 7, v206
s_and_b32 s39, s3, 1
s_lshl_b32 s39, s39, 14
v_add_u32 v192, s39, v206
v_xor_b32 v193, 64, v192
v_add_u32 v194, 0x10000, v192
v_add_u32 v195, 0x10000, v193
v_bfe_u32 v204, v1, 2, 2
v_and_b32 v206, 1, v205
v_lshl_or_b32 v206, v206, 2, v204
v_lshl_add_u32 v204, v205, 3, v204
v_lshlrev_b32 v204, 9, v204
v_and_b32 v207, 3, v1
v_lshl_add_u32 v204, v207, 3, v204
s_lshr_b32 s39, s3, 1
s_lshl_b32 s39, s39, 8
s_add_u32 s39, s39, 98304
v_add_u32 v204, s39, v204
v_xor_b32 v207, 0, v206
v_lshl_add_u32 v196, v207, 5, v204
v_xor_b32 v207, 1, v206
v_lshl_add_u32 v197, v207, 5, v204
v_xor_b32 v207, 2, v206
v_lshl_add_u32 v198, v207, 5, v204
v_xor_b32 v207, 3, v206
v_lshl_add_u32 v199, v207, 5, v204
v_xor_b32 v207, 4, v206
v_lshl_add_u32 v200, v207, 5, v204
v_xor_b32 v207, 5, v206
v_lshl_add_u32 v201, v207, 5, v204
v_xor_b32 v207, 6, v206
v_lshl_add_u32 v202, v207, 5, v204
v_xor_b32 v207, 7, v206
v_lshl_add_u32 v203, v207, 5, v204
s_lshl_b32 s36, s36, 1
s_lshr_b32 s39, s3, 1
s_add_u32 s36, s36, s39
s_lshl_b32 s24, s36, 19
s_lshl_b32 s38, s38, 16
s_add_u32 s24, s24, s38
s_and_b32 s39, s3, 1
s_lshl_b32 s39, s39, 15
s_add_u32 s24, s24, s39
s_lshl_b32 s36, s42, 24
s_add_u32 s16, s40, s36
s_addc_u32 s17, s41, 0
s_mov_b32 s18, 16777216
s_mov_b32 s19, 0x20000
s_add_u32 m0, s23, 32768
s_nop 0
buffer_load_dwordx4 v184, s[12:15], s21 offen offset:0 lds
buffer_load_dwordx4 v185, s[12:15], s21 offen offset:1024 lds
buffer_load_dwordx4 v186, s[12:15], s21 offen offset:2048 lds
buffer_load_dwordx4 v187, s[12:15], s21 offen offset:3072 lds
s_add_u32 m0, s23, 36864
s_nop 0
buffer_load_dwordx4 v188, s[12:15], s21 offen offset:0 lds
buffer_load_dwordx4 v189, s[12:15], s21 offen offset:1024 lds
buffer_load_dwordx4 v190, s[12:15], s21 offen offset:2048 lds
buffer_load_dwordx4 v191, s[12:15], s21 offen offset:3072 lds
s_add_u32 s21, s21, 524288
s_and_b32 s21, s21, 4194303
s_mov_b32 s54, 256
s_mov_b32 s55, 0x20000
v_mov_b32 v78, 1
s_cmp_lg_u32 s2, 0
s_cselect_b32 s43, 0x10000000, 0
v_or_b32 v79, s43, v79
s_waitcnt vmcnt(8)
s_barrier
buffer_store_dword v78, v79, s[52:55], 0 offen sc1
ds_read_b128 v[80:83], v192 offset:0
ds_read_b128 v[84:87], v192 offset:2048
ds_read_b128 v[88:91], v192 offset:4096
ds_read_b128 v[92:95], v192 offset:6144
ds_read_b128 v[96:99], v192 offset:8192
ds_read_b128 v[100:103], v192 offset:10240
ds_read_b128 v[104:107], v192 offset:12288
ds_read_b128 v[108:111], v192 offset:14336
TR 144,196,0
TR 146,196,2048
TR 148,197,0
TR 150,197,2048
TR 152,198,0
TR 154,198,2048
TR 156,199,0
TR 158,199,2048
TR 160,200,0
TR 162,200,2048
TR 164,201,0
TR 166,201,2048
TR 168,202,0
TR 170,202,2048
TR 172,203,0
TR 174,203,2048
s_cmp_eq_u32 s42, 0
s_cbranch_scc0 L_p1_V
L_p1_K:
s_waitcnt lgkmcnt(14)
v_mfma_f32_16x16x32_bf16 a[0:3], v[144:147], v[80:83], 0
s_add_u32 m0, s22, 32768
s_mov_b32 s86, 4194304
s_waitcnt lgkmcnt(12)
v_mfma_f32_16x16x32_bf16 a[4:7], v[148:151], v[80:83], 0
ds_read_b128 v[112:115], v193 offset:0
s_mov_b32 s87, 0x20000
v_mfma_f32_16x16x32_bf16 a[32:35], v[144:147], v[84:87], 0
v_mfma_f32_16x16x32_bf16 a[36:39], v[148:151], v[84:87], 0
s_mov_b32 s90, 4194304
v_mfma_f32_16x16x32_bf16 a[64:67], v[144:147], v[88:91], 0
s_mov_b32 s91, 0x20000
v_mfma_f32_16x16x32_bf16 a[68:71], v[148:151], v[88:91], 0
buffer_load_dwordx4 v176, s[8:11], s20 offen offset:0 lds
v_mfma_f32_16x16x32_bf16 a[96:99], v[144:147], v[92:95], 0
s_mov_b32 s94, 4194304
v_mfma_f32_16x16x32_bf16 a[100:103], v[148:151], v[92:95], 0
ds_read_b128 v[116:119], v193 offset:2048
s_mov_b32 s95, 0x20000
v_mfma_f32_16x16x32_bf16 a[128:131], v[144:147], v[96:99], 0
v_mfma_f32_16x16x32_bf16 a[132:135], v[148:151], v[96:99], 0
s_mov_b32 s98, 8192
v_mfma_f32_16x16x32_bf16 a[160:163], v[144:147], v[100:103], 0
buffer_load_dwordx4 v177, s[8:11], s20 offen offset:1024 lds
s_mov_b32 s99, 0x20000
v_mfma_f32_16x16x32_bf16 a[164:167], v[148:151], v[100:103], 0
v_mfma_f32_16x16x32_bf16 a[192:195], v[144:147], v[104:107], 0
s_mov_b32 s78, 2048
v_mfma_f32_16x16x32_bf16 a[196:199], v[148:151], v[104:107], 0
ds_read_b128 v[120:123], v193 offset:4096
s_mov_b32 s79, 0x20000
v_mfma_f32_16x16x32_bf16 a[224:227], v[144:147], v[108:111], 0
TR 144,196,16384
TR 146,196,18432
v_mfma_f32_16x16x32_bf16 a[228:231], v[148:151], v[108:111], 0
TR 148,197,16384
TR 150,197,18432
s_waitcnt lgkmcnt(15)
v_mfma_f32_16x16x32_bf16 a[232:235], v[152:155], v[108:111], 0
buffer_load_dwordx4 v178, s[8:11], s20 offen offset:2048 lds
s_and_b32 s36, s2, 15
v_mfma_f32_16x16x32_bf16 a[236:239], v[156:159], v[108:111], 0
s_lshl_b32 s36, s36, 1
v_mfma_f32_16x16x32_bf16 a[200:203], v[152:155], v[104:107], 0
s_lshr_b32 s37, s3, 1
v_mfma_f32_16x16x32_bf16 a[204:207], v[156:159], v[104:107], 0
s_add_u32 s36, s36, s37
v_mfma_f32_16x16x32_bf16 a[168:171], v[152:155], v[100:103], 0
ds_read_b128 v[124:127], v193 offset:6144
buffer_load_dwordx4 v179, s[8:11], s20 offen offset:3072 lds
v_mfma_f32_16x16x32_bf16 a[172:175], v[156:159], v[100:103], 0
s_lshl_b32 s36, s36, 3
v_mfma_f32_16x16x32_bf16 a[136:139], v[152:155], v[96:99], 0
v_and_b32 v252, 7, v1
v_mfma_f32_16x16x32_bf16 a[140:143], v[156:159], v[96:99], 0
v_mfma_f32_16x16x32_bf16 a[104:107], v[152:155], v[92:95], 0
v_add_u32 v252, s36, v252
v_mfma_f32_16x16x32_bf16 a[108:111], v[156:159], v[92:95], 0
s_add_u32 m0, s22, 36864
s_lshr_b32 s36, s2, 4
v_mfma_f32_16x16x32_bf16 a[72:75], v[152:155], v[88:91], 0
ds_read_b128 v[128:131], v193 offset:8192
v_mfma_f32_16x16x32_bf16 a[76:79], v[156:159], v[88:91], 0
s_lshl_b32 s36, s36, 1
v_mfma_f32_16x16x32_bf16 a[40:43], v[152:155], v[84:87], 0
s_and_b32 s37, s3, 1
v_mfma_f32_16x16x32_bf16 a[44:47], v[156:159], v[84:87], 0
v_mfma_f32_16x16x32_bf16 a[8:11], v[152:155], v[80:83], 0
TR 152,198,16384
TR 154,198,18432
v_mfma_f32_16x16x32_bf16 a[12:15], v[156:159], v[80:83], 0
TR 156,199,16384
TR 158,199,18432
s_waitcnt lgkmcnt(15)
v_mfma_f32_16x16x32_bf16 a[16:19], v[160:163], v[80:83], 0
ds_read_b128 v[132:135], v193 offset:10240
buffer_load_dwordx4 v180, s[8:11], s20 offen offset:0 lds
v_mfma_f32_16x16x32_bf16 a[20:23], v[164:167], v[80:83], 0
s_add_u32 s36, s36, s37
s_lshl_b32 s36, s36, 3
v_mfma_f32_16x16x32_bf16 a[48:51], v[160:163], v[84:87], 0
v_lshrrev_b32 v253, 3, v1
v_add_u32 v253, s36, v253
v_mfma_f32_16x16x32_bf16 a[52:55], v[164:167], v[84:87], 0
v_mfma_f32_16x16x32_bf16 a[80:83], v[160:163], v[88:91], 0
buffer_load_dwordx4 v181, s[8:11], s20 offen offset:1024 lds
v_lshlrev_b32 v254, 14, v253
v_mfma_f32_16x16x32_bf16 a[84:87], v[164:167], v[88:91], 0
v_lshl_add_u32 v254, v252, 3, v254
v_mfma_f32_16x16x32_bf16 a[112:115], v[160:163], v[92:95], 0
v_mfma_f32_16x16x32_bf16 a[116:119], v[164:167], v[92:95], 0
ds_read_b128 v[136:139], v193 offset:12288
v_add_u32 v229, -6144, v254
v_mfma_f32_16x16x32_bf16 a[144:147], v[160:163], v[96:99], 0
v_lshlrev_b32 v62, 5, v252
v_mfma_f32_16x16x32_bf16 a[148:151], v[164:167], v[96:99], 0
buffer_load_dwordx4 v182, s[8:11], s20 offen offset:2048 lds
v_mfma_f32_16x16x32_bf16 a[176:179], v[160:163], v[100:103], 0
v_lshlrev_b32 v254, 4, v253
v_mfma_f32_16x16x32_bf16 a[180:183], v[164:167], v[100:103], 0
v_sub_u32 v254, 4080, v254
v_mfma_f32_16x16x32_bf16 a[208:211], v[160:163], v[104:107], 0
v_mfma_f32_16x16x32_bf16 a[212:215], v[164:167], v[104:107], 0
ds_read_b128 v[140:143], v193 offset:14336
v_lshl_add_u32 v10, v252, 14, v254
v_mfma_f32_16x16x32_bf16 a[240:243], v[160:163], v[108:111], 0
TR 160,200,16384
TR 162,200,18432
v_mfma_f32_16x16x32_bf16 a[244:247], v[164:167], v[108:111], 0
TR 164,201,16384
TR 166,201,18432
v_mfma_f32_16x16x32_bf16 a[248:251], v[168:171], v[108:111], 0
buffer_load_dwordx4 v183, s[8:11], s20 offen offset:3072 lds
v_and_b32 v252, 31, v1
s_waitcnt lgkmcnt(15)
v_mfma_f32_16x16x32_bf16 a[252:255], v[172:175], v[108:111], 0
v_lshlrev_b32 v64, 4, v252
s_lshl_b32 s36, s2, 2
v_mfma_f32_16x16x32_bf16 a[216:219], v[168:171], v[104:107], 0
v_mfma_f32_16x16x32_bf16 a[220:223], v[172:175], v[104:107], 0
s_add_u32 s20, s20, 128
s_add_u32 s36, s36, s3
v_mfma_f32_16x16x32_bf16 a[184:187], v[168:171], v[100:103], 0
s_lshl_b32 s36, s36, 1
v_mfma_f32_16x16x32_bf16 a[188:191], v[172:175], v[100:103], 0
v_mfma_f32_16x16x32_bf16 a[152:155], v[168:171], v[96:99], 0
v_lshrrev_b32 v253, 5, v1
v_mfma_f32_16x16x32_bf16 a[156:159], v[172:175], v[96:99], 0
v_add_u32 v253, s36, v253
v_mfma_f32_16x16x32_bf16 a[120:123], v[168:171], v[92:95], 0
s_and_b32 s20, s20, 1023
v_mfma_f32_16x16x32_bf16 a[124:127], v[172:175], v[92:95], 0
v_lshl_add_u32 v63, v253, 11, v64
v_mfma_f32_16x16x32_bf16 a[88:91], v[168:171], v[88:91], 0
v_lshlrev_b32 v253, 2, v253
v_mfma_f32_16x16x32_bf16 a[92:95], v[172:175], v[88:91], 0
v_mfma_f32_16x16x32_bf16 a[56:59], v[168:171], v[84:87], 0
v_lshl_add_u32 v11, v252, 20, v253
v_mfma_f32_16x16x32_bf16 a[60:63], v[172:175], v[84:87], 0
v_mfma_f32_16x16x32_bf16 a[24:27], v[168:171], v[80:83], 0
TR 168,202,16384
TR 170,202,18432
v_mfma_f32_16x16x32_bf16 a[28:31], v[172:175], v[80:83], 0
TR 172,203,16384
TR 174,203,18432
s_waitcnt lgkmcnt(4)
MA 0,v,144,v,112
s_add_u32 m0, s22, 65536
MA 4,v,148,v,112
MA 32,v,144,v,116
buffer_load_dwordx4 v176, s[8:11], s20 offen offset:0 lds
MA 36,v,148,v,116
MA 64,v,144,v,120
buffer_load_dwordx4 v177, s[8:11], s20 offen offset:1024 lds
MA 68,v,148,v,120
MA 96,v,144,v,124
MA 100,v,148,v,124
buffer_load_dwordx4 v178, s[8:11], s20 offen offset:2048 lds
MA 128,v,144,v,128
MA 132,v,148,v,128
buffer_load_dwordx4 v179, s[8:11], s20 offen offset:3072 lds
MA 160,v,144,v,132
MA 164,v,148,v,132
MA 192,v,144,v,136
s_add_u32 m0, s22, 69632
MA 196,v,148,v,136
MA 224,v,144,v,140
buffer_load_dwordx4 v180, s[8:11], s20 offen offset:0 lds
MA 228,v,148,v,140
MA 232,v,152,v,140
buffer_load_dwordx4 v181, s[8:11], s20 offen offset:1024 lds
MA 236,v,156,v,140
MA 200,v,152,v,136
MA 204,v,156,v,136
buffer_load_dwordx4 v182, s[8:11], s20 offen offset:2048 lds
MA 168,v,152,v,132
MA 172,v,156,v,132
buffer_load_dwordx4 v183, s[8:11], s20 offen offset:3072 lds
MA 136,v,152,v,128
MA 140,v,156,v,128
MA 104,v,152,v,124
s_add_u32 s20, s20, 128
MA 108,v,156,v,124
MA 72,v,152,v,120
s_and_b32 s20, s20, 1023
MA 76,v,156,v,120
MA 40,v,152,v,116
MA 44,v,156,v,116
MA 8,v,152,v,112
s_waitcnt vmcnt(8) lgkmcnt(0)
s_barrier
MA 12,v,156,v,112
TR 144,196,32768
TR 146,196,34816
MA 16,v,160,v,112
ds_read_b128 v[80:83], v192 offset:32768
s_add_u32 m0, s23, 0
MA 20,v,164,v,112
TR 148,197,32768
TR 150,197,34816
MA 48,v,160,v,116
ds_read_b128 v[84:87], v192 offset:34816
buffer_load_dwordx4 v184, s[12:15], s21 offen offset:0 lds
MA 52,v,164,v,116
TR 152,198,32768
TR 154,198,34816
MA 80,v,160,v,120
buffer_load_dwordx4 v185, s[12:15], s21 offen offset:1024 lds
MA 84,v,164,v,120
TR 156,199,32768
TR 158,199,34816
MA 112,v,160,v,124
ds_read_b128 v[88:91], v192 offset:36864
buffer_load_dwordx4 v186, s[12:15], s21 offen offset:2048 lds
MA 116,v,164,v,124
ds_read_b128 v[92:95], v192 offset:38912
MA 144,v,160,v,128
MA 148,v,164,v,128
buffer_load_dwordx4 v187, s[12:15], s21 offen offset:3072 lds
MA 176,v,160,v,132
ds_read_b128 v[96:99], v192 offset:40960
MA 180,v,164,v,132
s_add_u32 m0, s23, 4096
MA 208,v,160,v,136
ds_read_b128 v[100:103], v192 offset:43008
MA 212,v,164,v,136
MA 240,v,160,v,140
TR 160,200,32768
TR 162,200,34816
MA 244,v,164,v,140
TR 164,201,32768
TR 166,201,34816
MA 248,v,168,v,140
ds_read_b128 v[104:107], v192 offset:45056
buffer_load_dwordx4 v188, s[12:15], s21 offen offset:0 lds
MA 252,v,172,v,140
ds_read_b128 v[108:111], v192 offset:47104
buffer_load_dwordx4 v189, s[12:15], s21 offen offset:1024 lds
MA 216,v,168,v,136
MA 220,v,172,v,136
buffer_load_dwordx4 v190, s[12:15], s21 offen offset:2048 lds
MA 184,v,168,v,132
MA 188,v,172,v,132
MA 152,v,168,v,128
buffer_load_dwordx4 v191, s[12:15], s21 offen offset:3072 lds
MA 156,v,172,v,128
MA 120,v,168,v,124
s_add_u32 s21, s21, 524288
MA 124,v,172,v,124
MA 88,v,168,v,120
MA 92,v,172,v,120
s_and_b32 s21, s21, 4194303
MA 56,v,168,v,116
MA 60,v,172,v,116
MA 24,v,168,v,112
TR 168,202,32768
TR 170,202,34816
MA 28,v,172,v,112
TR 172,203,32768
TR 174,203,34816
s_waitcnt lgkmcnt(4)
MA 0,v,144,v,80
s_add_u32 m0, s22, 0
buffer_load_dwordx4 v[230:233], v63, s[92:95], 0 offen offset:0
MA 4,v,148,v,80
ds_read_b128 v[112:115], v193 offset:32768
MA 32,v,144,v,84
MA 36,v,148,v,84
MA 64,v,144,v,88
MA 68,v,148,v,88
buffer_load_dwordx4 v176, s[8:11], s20 offen offset:0 lds
MA 96,v,144,v,92
buffer_load_dwordx4 v[2:5], v64, s[76:79], 0 offen offset:0
MA 100,v,148,v,92
ds_read_b128 v[116:119], v193 offset:34816
MA 128,v,144,v,96
MA 132,v,148,v,96
MA 160,v,144,v,100
buffer_load_dwordx4 v177, s[8:11], s20 offen offset:1024 lds
MA 164,v,148,v,100
MA 192,v,144,v,104
buffer_load_dwordx4 v[234:237], v63, s[92:95], 0 offen offset:512
MA 196,v,148,v,104
ds_read_b128 v[120:123], v193 offset:36864
MA 224,v,144,v,108
TR 144,196,49152
TR 146,196,51200
MA 228,v,148,v,108
TR 148,197,49152
TR 150,197,51200
MA 232,v,152,v,108
buffer_load_dwordx4 v178, s[8:11], s20 offen offset:2048 lds
MA 236,v,156,v,108
MA 200,v,152,v,104
buffer_load_dwordx4 v[6:9], v64, s[76:79], 0 offen offset:512
MA 204,v,156,v,104
MA 168,v,152,v,100
ds_read_b128 v[124:127], v193 offset:38912
buffer_load_dwordx4 v179, s[8:11], s20 offen offset:3072 lds
MA 172,v,156,v,100
MA 136,v,152,v,96
MA 140,v,156,v,96
MA 104,v,152,v,92
buffer_load_dwordx4 v[238:241], v63, s[92:95], 0 offen offset:1024
MA 108,v,156,v,92
s_add_u32 m0, s22, 4096
MA 72,v,152,v,88
ds_read_b128 v[128:131], v193 offset:40960
MA 76,v,156,v,88
MA 40,v,152,v,84
MA 44,v,156,v,84
MA 8,v,152,v,80
TR 152,198,49152
TR 154,198,51200
MA 12,v,156,v,80
TR 156,199,49152
TR 158,199,51200
MA 16,v,160,v,80
ds_read_b128 v[132:135], v193 offset:43008
buffer_load_dwordx4 v180, s[8:11], s20 offen offset:0 lds
MA 20,v,164,v,80
buffer_load_dwordx4 v[12:15], v64, s[76:79], 0 offen offset:1024
MA 48,v,160,v,84
MA 52,v,164,v,84
MA 80,v,160,v,88
buffer_load_dwordx4 v181, s[8:11], s20 offen offset:1024 lds
MA 84,v,164,v,88
buffer_load_dwordx4 v[242:245], v63, s[92:95], 0 offen offset:1536
MA 112,v,160,v,92
MA 116,v,164,v,92
ds_read_b128 v[136:139], v193 offset:45056
MA 144,v,160,v,96
MA 148,v,164,v,96
buffer_load_dwordx4 v182, s[8:11], s20 offen offset:2048 lds
MA 176,v,160,v,100
MA 180,v,164,v,100
buffer_load_dwordx4 v[246:249], v64, s[76:79], 0 offen offset:1536
MA 208,v,160,v,104
MA 212,v,164,v,104
ds_read_b128 v[140:143], v193 offset:47104
MA 240,v,160,v,108
TR 160,200,49152
TR 162,200,51200
MA 244,v,164,v,108
TR 164,201,49152
TR 166,201,51200
s_waitcnt lgkmcnt(15)
MA 248,v,168,v,108
buffer_load_dwordx4 v183, s[8:11], s20 offen offset:3072 lds
MA 252,v,172,v,108
buffer_load_dwordx4 v[54:57], v62, s[96:99], 0 offen offset:0
MA 216,v,168,v,104
MA 220,v,172,v,104
s_add_u32 s20, s20, 128
MA 184,v,168,v,100
MA 188,v,172,v,100
MA 152,v,168,v,96
MA 156,v,172,v,96
buffer_load_dwordx4 v[58:61], v62, s[96:99], 0 offen offset:16
MA 120,v,168,v,92
s_and_b32 s20, s20, 1023
MA 124,v,172,v,92
MA 88,v,168,v,88
MA 92,v,172,v,88
MA 56,v,168,v,84
MA 60,v,172,v,84
MA 24,v,168,v,80
TR 168,202,49152
TR 170,202,51200
MA 28,v,172,v,80
TR 172,203,49152
TR 174,203,51200
s_waitcnt lgkmcnt(4)
MA 0,v,144,v,112
MA 4,v,148,v,112
MA 32,v,144,v,116
MA 36,v,148,v,116
MA 64,v,144,v,120
MA 68,v,148,v,120
MA 96,v,144,v,124
MA 100,v,148,v,124
MA 128,v,144,v,128
MA 132,v,148,v,128
s_waitcnt vmcnt(18) lgkmcnt(0)
s_barrier
MA 160,v,144,v,132
s_add_u32 m0, s23, 32768
MA 164,v,148,v,132
ds_read_b128 v[80:83], v194 offset:0
MA 192,v,144,v,136
s_mov_b32 s4, s34
s_mov_b32 s5, s35
MA 196,v,148,v,136
MA 224,v,144,v,140
TR 144,196,0
TR 146,196,2048
MA 228,v,148,v,140
TR 148,197,0
TR 150,197,2048
MA 232,v,152,v,140
ds_read_b128 v[84:87], v194 offset:2048
buffer_load_dwordx4 v184, s[12:15], s21 offen offset:0 lds
MA 236,v,156,v,140
s_mov_b32 s6, 8388608
s_mov_b32 s7, 0x20000
MA 200,v,152,v,136
buffer_load_dwordx4 v185, s[12:15], s21 offen offset:1024 lds
MA 204,v,156,v,136
MA 168,v,152,v,132
MA 172,v,156,v,132
ds_read_b128 v[88:91], v194 offset:4096
MA 136,v,152,v,128
MA 140,v,156,v,128
buffer_load_dwordx4 v186, s[12:15], s21 offen offset:2048 lds
s_lshr_b32 s43, s2, 3
MA 104,v,152,v,124
MA 108,v,156,v,124
MA 72,v,152,v,120
ds_read_b128 v[92:95], v194 offset:6144
s_lshl_b32 s43, s43, 2
MA 76,v,156,v,120
buffer_load_dwordx4 v187, s[12:15], s21 offen offset:3072 lds
MA 40,v,152,v,116
MA 44,v,156,v,116
s_add_u32 s43, s43, s3
MA 8,v,152,v,112
TR 152,198,0
TR 154,198,2048
MA 12,v,156,v,112
TR 156,199,0
TR 158,199,2048
MA 16,v,160,v,112
ds_read_b128 v[96:99], v194 offset:8192
s_add_u32 m0, s23, 36864
MA 20,v,164,v,112
s_lshl_b32 s43, s43, 16
MA 48,v,160,v,116
MA 52,v,164,v,116
MA 80,v,160,v,120
ds_read_b128 v[100:103], v194 offset:10240
buffer_load_dwordx4 v188, s[12:15], s21 offen offset:0 lds
MA 84,v,164,v,120
s_and_b32 s37, s2, 7
MA 112,v,160,v,124
MA 116,v,164,v,124
s_lshl_b32 s37, s37, 10
MA 144,v,160,v,128
buffer_load_dwordx4 v189, s[12:15], s21 offen offset:1024 lds
MA 148,v,164,v,128
ds_read_b128 v[104:107], v194 offset:12288
MA 176,v,160,v,132
s_add_u32 s43, s43, s37
MA 180,v,164,v,132
MA 208,v,160,v,136
buffer_load_dwordx4 v190, s[12:15], s21 offen offset:2048 lds
MA 212,v,164,v,136
v_lshrrev_b32 v78, 3, v1
MA 240,v,160,v,140
TR 160,200,0
TR 162,200,2048
MA 244,v,164,v,140
TR 164,201,0
TR 166,201,2048
MA 248,v,168,v,140
ds_read_b128 v[108:111], v194 offset:14336
MA 252,v,172,v,140
buffer_load_dwordx4 v191, s[12:15], s21 offen offset:3072 lds
v_and_b32 v79, 7, v1
MA 216,v,168,v,136
MA 220,v,172,v,136
MA 184,v,168,v,132
v_lshlrev_b32 v79, 7, v79
MA 188,v,172,v,132
s_add_u32 s21, s21, 524288
MA 152,v,168,v,128
MA 156,v,172,v,128
v_lshl_add_u32 v78, v78, 13, v79
MA 120,v,168,v,124
MA 124,v,172,v,124
s_and_b32 s21, s21, 4194303
MA 88,v,168,v,120
v_add_u32 v78, s43, v78
MA 92,v,172,v,120
MA 56,v,168,v,116
MA 60,v,172,v,116
MA 24,v,168,v,112
TR 168,202,0
TR 170,202,2048
MA 28,v,172,v,112
TR 172,203,0
TR 174,203,2048
s_waitcnt lgkmcnt(4)
MA 0,v,144,v,80
s_add_u32 m0, s22, 32768
v_add_u32 v252, 0, v229
MA 4,v,148,v,80
ds_read_b128 v[112:115], v195 offset:0
MA 32,v,144,v,84
MA 36,v,148,v,84
MA 64,v,144,v,88
MA 68,v,148,v,88
buffer_load_dwordx4 v176, s[8:11], s20 offen offset:0 lds
MA 96,v,144,v,92
buffer_load_dwordx2 v[16:17], v252, s[84:87], 0 offen
MA 100,v,148,v,92
ds_read_b128 v[116:119], v195 offset:2048
MA 128,v,144,v,96
MA 132,v,148,v,96
MA 160,v,144,v,100
buffer_load_dwordx4 v177, s[8:11], s20 offen offset:1024 lds
MA 164,v,148,v,100
MA 192,v,144,v,104
v_add_u32 v253, 2048, v229
MA 196,v,148,v,104
ds_read_b128 v[120:123], v195 offset:4096
MA 224,v,144,v,108
TR 144,196,16384
TR 146,196,18432
MA 228,v,148,v,108
TR 148,197,16384
TR 150,197,18432
MA 232,v,152,v,108
buffer_load_dwordx4 v178, s[8:11], s20 offen offset:2048 lds
MA 236,v,156,v,108
MA 200,v,152,v,104
buffer_load_dwordx2 v[18:19], v253, s[84:87], 0 offen
MA 204,v,156,v,104
MA 168,v,152,v,100
ds_read_b128 v[124:127], v195 offset:6144
buffer_load_dwordx4 v179, s[8:11], s20 offen offset:3072 lds
MA 172,v,156,v,100
MA 136,v,152,v,96
MA 140,v,156,v,96
MA 104,v,152,v,92
v_add_u32 v254, 4096, v229
MA 108,v,156,v,92
s_add_u32 m0, s22, 36864
MA 72,v,152,v,88
ds_read_b128 v[128:131], v195 offset:8192
MA 76,v,156,v,88
MA 40,v,152,v,84
MA 44,v,156,v,84
MA 8,v,152,v,80
TR 152,198,16384
TR 154,198,18432
MA 12,v,156,v,80
TR 156,199,16384
TR 158,199,18432
MA 16,v,160,v,80
ds_read_b128 v[132:135], v195 offset:10240
buffer_load_dwordx4 v180, s[8:11], s20 offen offset:0 lds
MA 20,v,164,v,80
buffer_load_dwordx2 v[20:21], v254, s[84:87], 0 offen
MA 48,v,160,v,84
MA 52,v,164,v,84
MA 80,v,160,v,88
buffer_load_dwordx4 v181, s[8:11], s20 offen offset:1024 lds
MA 84,v,164,v,88
v_add_u32 v255, 6144, v229
MA 112,v,160,v,92
MA 116,v,164,v,92
ds_read_b128 v[136:139], v195 offset:12288
MA 144,v,160,v,96
MA 148,v,164,v,96
buffer_load_dwordx4 v182, s[8:11], s20 offen offset:2048 lds
MA 176,v,160,v,100
MA 180,v,164,v,100
buffer_load_dwordx2 v[22:23], v255, s[84:87], 0 offen
MA 208,v,160,v,104
MA 212,v,164,v,104
ds_read_b128 v[140:143], v195 offset:14336
MA 240,v,160,v,108
TR 160,200,16384
TR 162,200,18432
MA 244,v,164,v,108
TR 164,201,16384
TR 166,201,18432
s_waitcnt lgkmcnt(15)
MA 248,v,168,v,108
buffer_load_dwordx4 v183, s[8:11], s20 offen offset:3072 lds
MA 252,v,172,v,108
buffer_load_dwordx2 v[38:39], v255, s[88:91], 0 offen
MA 216,v,168,v,104
MA 220,v,172,v,104
s_add_u32 s20, s20, 128
MA 184,v,168,v,100
MA 188,v,172,v,100
MA 152,v,168,v,96
MA 156,v,172,v,96
v_add_u32 v252, 8192, v229
MA 120,v,168,v,92
s_and_b32 s20, s20, 1023
MA 124,v,172,v,92
MA 88,v,168,v,88
MA 92,v,172,v,88
MA 56,v,168,v,84
MA 60,v,172,v,84
MA 24,v,168,v,80
TR 168,202,16384
TR 170,202,18432
MA 28,v,172,v,80
TR 172,203,16384
TR 174,203,18432
s_waitcnt lgkmcnt(4)
MA 0,v,144,v,112
MA 4,v,148,v,112
MA 32,v,144,v,116
MA 36,v,148,v,116
MA 64,v,144,v,120
MA 68,v,148,v,120
MA 96,v,144,v,124
MA 100,v,148,v,124
MA 128,v,144,v,128
MA 132,v,148,v,128
s_waitcnt vmcnt(13) lgkmcnt(0)
s_barrier
MA 160,v,144,v,132
s_add_u32 m0, s23, 0
s_bfe_u32 s80, s2, 0x20001
MA 164,v,148,v,132
ds_read_b128 v[80:83], v192 offset:0
s_bfe_u32 s69, s2, 0x30003
MA 192,v,144,v,136
s_lshl_b32 s80, s80, 3
s_add_u32 s69, s69, s80
MA 196,v,148,v,136
s_lshr_b32 s80, s2, 6
MA 224,v,144,v,140
TR 144,196,32768
TR 146,196,34816
MA 228,v,148,v,140
TR 148,197,32768
TR 150,197,34816
MA 232,v,152,v,140
ds_read_b128 v[84:87], v192 offset:2048
buffer_load_dwordx4 v184, s[12:15], s21 offen offset:0 lds
MA 236,v,156,v,140
s_xor_b32 s81, s80, s2
s_and_b32 s81, s81, 1
MA 200,v,152,v,136
buffer_load_dwordx4 v185, s[12:15], s21 offen offset:1024 lds
s_lshl_b32 s70, s80, 1
MA 204,v,156,v,136
s_add_u32 s70, s70, s81
s_lshl_b32 s80, s3, 1
MA 168,v,152,v,132
s_sub_u32 s80, 7, s80
s_lshl_b32 s76, s80, 17
MA 172,v,156,v,132
ds_read_b128 v[88:91], v192 offset:4096
s_lshl_b32 s80, s3, 15
MA 136,v,152,v,128
s_lshl_b32 s65, s70, 18
s_sub_u32 s64, 3932160, s65
MA 140,v,156,v,128
buffer_load_dwordx4 v186, s[12:15], s21 offen offset:2048 lds
s_add_u32 s65, s65, s80
MA 104,v,152,v,124
s_add_u32 s64, s64, s80
MA 108,v,156,v,124
s_lshl_b32 s81, s69, 12
MA 72,v,152,v,120
ds_read_b128 v[92:95], v192 offset:6144
s_lshl_b32 s100, s64, 2
MA 76,v,156,v,120
buffer_load_dwordx4 v187, s[12:15], s21 offen offset:3072 lds
s_add_u32 s100, s100, s81
MA 40,v,152,v,116
s_lshl_b32 s101, s65, 2
MA 44,v,156,v,116
s_add_u32 s101, s101, s81
MA 8,v,152,v,112
TR 152,198,32768
TR 154,198,34816
MA 12,v,156,v,112
TR 156,199,32768
TR 158,199,34816
MA 16,v,160,v,112
ds_read_b128 v[96:99], v192 offset:8192
s_add_u32 m0, s23, 4096
MA 20,v,164,v,112
s_lshl_b32 s66, s3, 17
s_lshl_b32 s81, s69, 8
MA 48,v,160,v,116
s_add_u32 s66, s66, s81
s_and_b32 s74, s2, 7
MA 52,v,164,v,116
s_lshl_b32 s74, s74, 8
s_mov_b32 s82, s66
MA 80,v,160,v,120
ds_read_b128 v[100:103], v192 offset:10240
buffer_load_dwordx4 v188, s[12:15], s21 offen offset:0 lds
MA 84,v,164,v,120
s_lshl_b32 s66, s74, 12
s_lshl_b32 s67, s3, 13
MA 112,v,160,v,124
s_lshl_b32 s68, s3, 12
s_lshl_b32 s77, s70, 1
MA 116,v,164,v,124
s_sub_u32 s77, 32, s77
MA 144,v,160,v,128
buffer_load_dwordx4 v189, s[12:15], s21 offen offset:1024 lds
v_lshrrev_b32 v66, 3, v1
MA 148,v,164,v,128
ds_read_b128 v[104:107], v192 offset:12288
v_lshlrev_b32 v66, 11, v66
MA 176,v,160,v,132
v_lshrrev_b32 v67, 4, v1
v_and_b32 v68, 7, v1
MA 180,v,164,v,132
v_xor_b32 v68, v68, v67
MA 208,v,160,v,136
buffer_load_dwordx4 v190, s[12:15], s21 offen offset:2048 lds
v_lshl_add_u32 v66, v68, 4, v66
MA 212,v,164,v,136
v_xor_b32 v69, 64, v66
MA 240,v,160,v,140
TR 160,200,32768
TR 162,200,34816
MA 244,v,164,v,140
TR 164,201,32768
TR 166,201,34816
MA 248,v,168,v,140
ds_read_b128 v[108:111], v192 offset:14336
s_lshr_b32 s83, s76, 2
MA 252,v,172,v,140
buffer_load_dwordx4 v191, s[12:15], s21 offen offset:3072 lds
v_add_u32 v208, 0, v66
MA 216,v,168,v,136
v_add_u32 v209, 15360, v69
v_add_u32 v210, -2048, v66
MA 220,v,172,v,136
v_add_u32 v210, s83, v210
v_add_u32 v211, 13312, v69
MA 184,v,168,v,132
v_add_u32 v211, s83, v211
v_and_b32 v68, 15, v1
MA 188,v,172,v,132
s_add_u32 s21, s21, 524288
v_lshlrev_b32 v69, 1, v67
MA 152,v,168,v,128
v_xor_b32 v68, v68, v69
MA 156,v,172,v,128
v_lshlrev_b32 v66, 13, v67
MA 120,v,168,v,124
v_xor_b32 v69, 0, v68
MA 124,v,172,v,124
s_and_b32 s21, s21, 4194303
v_lshl_add_u32 v69, v69, 4, v66
MA 88,v,168,v,120
v_add_u32 v212, 0, v69
MA 92,v,172,v,120
v_xor_b32 v69, 0, v68
MA 56,v,168,v,116
v_lshl_add_u32 v69, v69, 4, v66
MA 60,v,172,v,116
v_add_u32 v213, 31744, v69
MA 24,v,168,v,112
TR 168,202,32768
TR 170,202,34816
MA 28,v,172,v,112
TR 172,203,32768
TR 174,203,34816
s_waitcnt lgkmcnt(4)
MA 0,v,144,v,80
s_add_u32 m0, s22, 65536
buffer_load_dwordx2 v[24:25], v252, s[84:87], 0 offen
MA 4,v,148,v,80
ds_read_b128 v[112:115], v193 offset:0
MA 32,v,144,v,84
MA 36,v,148,v,84
MA 64,v,144,v,88
MA 68,v,148,v,88
buffer_load_dwordx4 v176, s[8:11], s20 offen offset:0 lds
MA 96,v,144,v,92
buffer_load_dwordx2 v[40:41], v252, s[88:91], 0 offen
MA 100,v,148,v,92
ds_read_b128 v[116:119], v193 offset:2048
MA 128,v,144,v,96
MA 132,v,148,v,96
MA 160,v,144,v,100
buffer_load_dwordx4 v177, s[8:11], s20 offen offset:1024 lds
MA 164,v,148,v,100
MA 192,v,144,v,104
v_add_u32 v253, 10240, v229
MA 196,v,148,v,104
ds_read_b128 v[120:123], v193 offset:4096
MA 224,v,144,v,108
TR 144,196,49152
TR 146,196,51200
MA 228,v,148,v,108
TR 148,197,49152
TR 150,197,51200
MA 232,v,152,v,108
buffer_load_dwordx4 v178, s[8:11], s20 offen offset:2048 lds
MA 236,v,156,v,108
MA 200,v,152,v,104
buffer_load_dwordx2 v[26:27], v253, s[84:87], 0 offen
MA 204,v,156,v,104
MA 168,v,152,v,100
ds_read_b128 v[124:127], v193 offset:6144
buffer_load_dwordx4 v179, s[8:11], s20 offen offset:3072 lds
MA 172,v,156,v,100
MA 136,v,152,v,96
MA 140,v,156,v,96
MA 104,v,152,v,92
buffer_load_dwordx2 v[42:43], v253, s[88:91], 0 offen
MA 108,v,156,v,92
s_add_u32 m0, s22, 69632
MA 72,v,152,v,88
ds_read_b128 v[128:131], v193 offset:8192
MA 76,v,156,v,88
MA 40,v,152,v,84
MA 44,v,156,v,84
MA 8,v,152,v,80
TR 152,198,49152
TR 154,198,51200
MA 12,v,156,v,80
TR 156,199,49152
TR 158,199,51200
MA 16,v,160,v,80
ds_read_b128 v[132:135], v193 offset:10240
buffer_load_dwordx4 v180, s[8:11], s20 offen offset:0 lds
MA 20,v,164,v,80
v_add_u32 v254, 12288, v229
MA 48,v,160,v,84
MA 52,v,164,v,84
MA 80,v,160,v,88
buffer_load_dwordx4 v181, s[8:11], s20 offen offset:1024 lds
MA 84,v,164,v,88
buffer_load_dwordx2 v[28:29], v254, s[84:87], 0 offen
MA 112,v,160,v,92
MA 116,v,164,v,92
ds_read_b128 v[136:139], v193 offset:12288
MA 144,v,160,v,96
MA 148,v,164,v,96
buffer_load_dwordx4 v182, s[8:11], s20 offen offset:2048 lds
MA 176,v,160,v,100
MA 180,v,164,v,100
buffer_load_dwordx2 v[44:45], v254, s[88:91], 0 offen
MA 208,v,160,v,104
MA 212,v,164,v,104
ds_read_b128 v[140:143], v193 offset:14336
MA 240,v,160,v,108
TR 160,200,49152
TR 162,200,51200
MA 244,v,164,v,108
TR 164,201,49152
TR 166,201,51200
s_waitcnt lgkmcnt(15)
MA 248,v,168,v,108
buffer_load_dwordx4 v183, s[8:11], s20 offen offset:3072 lds
MA 252,v,172,v,108
v_add_u32 v255, 14336, v229
MA 216,v,168,v,104
MA 220,v,172,v,104
s_add_u32 s20, s20, 128
MA 184,v,168,v,100
MA 188,v,172,v,100
MA 152,v,168,v,96
MA 156,v,172,v,96
buffer_load_dwordx2 v[30:31], v255, s[84:87], 0 offen
MA 120,v,168,v,92
s_and_b32 s20, s20, 1023
MA 124,v,172,v,92
MA 88,v,168,v,88
MA 92,v,172,v,88
MA 56,v,168,v,84
MA 60,v,172,v,84
MA 24,v,168,v,80
TR 168,202,49152
TR 170,202,51200
MA 28,v,172,v,80
TR 172,203,49152
TR 174,203,51200
s_waitcnt lgkmcnt(4)
MA 0,v,144,v,112
MA 4,v,148,v,112
MA 32,v,144,v,116
MA 36,v,148,v,116
MA 64,v,144,v,120
MA 68,v,148,v,120
MA 96,v,144,v,124
MA 100,v,148,v,124
MA 128,v,144,v,128
MA 132,v,148,v,128
s_waitcnt vmcnt(15) lgkmcnt(0)
s_barrier
MA 160,v,144,v,132
s_add_u32 m0, s23, 32768
v_xor_b32 v69, 8, v68
MA 164,v,148,v,132
ds_read_b128 v[80:83], v192 offset:32768
v_lshl_add_u32 v69, v69, 4, v66
MA 192,v,144,v,136
v_add_u32 v214, 63488, v69
v_xor_b32 v69, 8, v68
MA 196,v,148,v,136
v_lshl_add_u32 v69, v69, 4, v66
MA 224,v,144,v,140
TR 144,196,0
TR 146,196,2048
MA 228,v,148,v,140
TR 148,197,0
TR 150,197,2048
MA 232,v,152,v,140
ds_read_b128 v[84:87], v192 offset:34816
buffer_load_dwordx4 v184, s[12:15], s21 offen offset:0 lds
MA 236,v,156,v,140
v_add_u32 v215, 95232, v69
v_and_b32 v66, 15, v1
MA 200,v,152,v,136
buffer_load_dwordx4 v185, s[12:15], s21 offen offset:1024 lds
v_lshrrev_b32 v68, 1, v66
MA 204,v,156,v,136
v_xor_b32 v68, v68, v67
v_lshlrev_b32 v68, 4, v68
MA 168,v,152,v,132
v_lshl_add_u32 v68, v66, 7, v68
v_add_u32 v224, s67, v68
MA 172,v,156,v,132
ds_read_b128 v[88:91], v192 offset:36864
v_xor_b32 v225, 64, v224
MA 136,v,152,v,128
v_add_u32 v226, 0x10000, v224
v_add_u32 v227, 0x10000, v225
MA 140,v,156,v,128
buffer_load_dwordx4 v186, s[12:15], s21 offen offset:2048 lds
v_bfe_u32 v66, v1, 2, 2
MA 104,v,152,v,124
v_and_b32 v68, 1, v67
v_lshl_or_b32 v68, v68, 2, v66
MA 108,v,156,v,124
v_lshl_add_u32 v66, v67, 3, v66
v_lshlrev_b32 v66, 8, v66
MA 72,v,152,v,120
ds_read_b128 v[92:95], v192 offset:38912
v_and_b32 v69, 3, v1
MA 76,v,156,v,120
buffer_load_dwordx4 v187, s[12:15], s21 offen offset:3072 lds
v_lshl_add_u32 v66, v69, 3, v66
MA 40,v,152,v,116
v_add_u32 v66, 98304, v66
MA 44,v,156,v,116
v_xor_b32 v69, 0, v68
MA 8,v,152,v,112
TR 152,198,0
TR 154,198,2048
MA 12,v,156,v,112
TR 156,199,0
TR 158,199,2048
MA 16,v,160,v,112
ds_read_b128 v[96:99], v192 offset:40960
s_add_u32 m0, s23, 36864
MA 20,v,164,v,112
v_lshl_add_u32 v216, v69, 5, v66
v_xor_b32 v69, 1, v68
MA 48,v,160,v,116
v_lshl_add_u32 v217, v69, 5, v66
v_xor_b32 v69, 2, v68
MA 52,v,164,v,116
v_lshl_add_u32 v218, v69, 5, v66
v_xor_b32 v69, 3, v68
MA 80,v,160,v,120
ds_read_b128 v[100:103], v192 offset:43008
buffer_load_dwordx4 v188, s[12:15], s21 offen offset:0 lds
MA 84,v,164,v,120
v_lshl_add_u32 v219, v69, 5, v66
v_xor_b32 v69, 4, v68
MA 112,v,160,v,124
v_lshl_add_u32 v220, v69, 5, v66
v_xor_b32 v69, 5, v68
MA 116,v,164,v,124
v_lshl_add_u32 v221, v69, 5, v66
v_xor_b32 v69, 6, v68
MA 144,v,160,v,128
buffer_load_dwordx4 v189, s[12:15], s21 offen offset:1024 lds
v_lshl_add_u32 v222, v69, 5, v66
MA 148,v,164,v,128
ds_read_b128 v[104:107], v192 offset:45056
v_xor_b32 v69, 7, v68
MA 176,v,160,v,132
v_lshl_add_u32 v223, v69, 5, v66
s_mov_b32 s44, s32
MA 180,v,164,v,132
s_mov_b32 s45, s33
MA 208,v,160,v,136
buffer_load_dwordx4 v190, s[12:15], s21 offen offset:2048 lds
s_mov_b32 s46, 4194304
MA 212,v,164,v,136
s_mov_b32 s47, 0x20000
MA 240,v,160,v,140
TR 160,200,0
TR 162,200,2048
MA 244,v,164,v,140
TR 164,201,0
TR 166,201,2048
MA 248,v,168,v,140
ds_read_b128 v[108:111], v192 offset:47104
MA 252,v,172,v,140
buffer_load_dwordx4 v191, s[12:15], s21 offen offset:3072 lds
MA 216,v,168,v,136
s_add_u32 s48, s34, s82
s_addc_u32 s49, s35, 0
MA 220,v,172,v,136
s_sub_u32 s50, 8388608, s82
s_mov_b32 s51, 0x20000
MA 184,v,168,v,132
s_add_u32 s60, s40, 33554432
s_addc_u32 s61, s41, 0
MA 188,v,172,v,132
s_add_u32 s21, s21, 524288
s_mov_b32 s62, 16777216
MA 152,v,168,v,128
s_mov_b32 s63, 0x20000
s_lshl_b32 s80, s69, 19
MA 156,v,172,v,128
s_add_u32 s52, s40, s80
s_addc_u32 s53, s41, 0
MA 120,v,168,v,124
s_lshl_b32 s54, s77, 14
s_mov_b32 s55, 0x20000
MA 124,v,172,v,124
s_and_b32 s21, s21, 4194303
s_add_u32 s80, s80, 16760832
MA 88,v,168,v,120
s_add_u32 s56, s40, s80
s_addc_u32 s57, s41, 0
MA 92,v,172,v,120
s_add_u32 s58, s54, 16384
MA 56,v,168,v,116
s_mov_b32 s59, 0x20000
MA 60,v,172,v,116
s_load_dwordx2 s[38:39], s[0:1], 112
MA 24,v,168,v,112
TR 168,202,0
TR 170,202,2048
MA 28,v,172,v,112
TR 172,203,0
TR 174,203,2048
s_waitcnt lgkmcnt(4)
MA 0,v,144,v,80
s_add_u32 m0, s22, 0
buffer_load_dwordx2 v[46:47], v255, s[88:91], 0 offen
MA 4,v,148,v,80
ds_read_b128 v[112:115], v193 offset:32768
MA 32,v,144,v,84
MA 36,v,148,v,84
MA 64,v,144,v,88
MA 68,v,148,v,88
buffer_load_dwordx4 v176, s[8:11], s20 offen offset:0 lds
MA 96,v,144,v,92
v_add_u32 v252, 16384, v229
MA 100,v,148,v,92
ds_read_b128 v[116:119], v193 offset:34816
MA 128,v,144,v,96
MA 132,v,148,v,96
MA 160,v,144,v,100
buffer_load_dwordx4 v177, s[8:11], s20 offen offset:1024 lds
MA 164,v,148,v,100
MA 192,v,144,v,104
buffer_load_dwordx2 v[32:33], v252, s[84:87], 0 offen
MA 196,v,148,v,104
ds_read_b128 v[120:123], v193 offset:36864
MA 224,v,144,v,108
TR 144,196,16384
TR 146,196,18432
MA 228,v,148,v,108
TR 148,197,16384
TR 150,197,18432
MA 232,v,152,v,108
buffer_load_dwordx4 v178, s[8:11], s20 offen offset:2048 lds
MA 236,v,156,v,108
MA 200,v,152,v,104
buffer_load_dwordx2 v[48:49], v252, s[88:91], 0 offen
MA 204,v,156,v,104
MA 168,v,152,v,100
ds_read_b128 v[124:127], v193 offset:38912
buffer_load_dwordx4 v179, s[8:11], s20 offen offset:3072 lds
MA 172,v,156,v,100
MA 136,v,152,v,96
MA 140,v,156,v,96
MA 104,v,152,v,92
v_add_u32 v253, 18432, v229
MA 108,v,156,v,92
s_add_u32 m0, s22, 4096
MA 72,v,152,v,88
ds_read_b128 v[128:131], v193 offset:40960
MA 76,v,156,v,88
MA 40,v,152,v,84
MA 44,v,156,v,84
MA 8,v,152,v,80
TR 152,198,16384
TR 154,198,18432
MA 12,v,156,v,80
TR 156,199,16384
TR 158,199,18432
MA 16,v,160,v,80
ds_read_b128 v[132:135], v193 offset:43008
buffer_load_dwordx4 v180, s[8:11], s20 offen offset:0 lds
MA 20,v,164,v,80
buffer_load_dwordx2 v[34:35], v253, s[84:87], 0 offen
MA 48,v,160,v,84
MA 52,v,164,v,84
MA 80,v,160,v,88
buffer_load_dwordx4 v181, s[8:11], s20 offen offset:1024 lds
MA 84,v,164,v,88
buffer_load_dwordx2 v[50:51], v253, s[88:91], 0 offen
MA 112,v,160,v,92
MA 116,v,164,v,92
ds_read_b128 v[136:139], v193 offset:45056
MA 144,v,160,v,96
MA 148,v,164,v,96
buffer_load_dwordx4 v182, s[8:11], s20 offen offset:2048 lds
MA 176,v,160,v,100
MA 180,v,164,v,100
v_add_u32 v254, 20480, v229
MA 208,v,160,v,104
MA 212,v,164,v,104
ds_read_b128 v[140:143], v193 offset:47104
MA 240,v,160,v,108
TR 160,200,16384
TR 162,200,18432
MA 244,v,164,v,108
TR 164,201,16384
TR 166,201,18432
s_waitcnt lgkmcnt(15)
MA 248,v,168,v,108
buffer_load_dwordx4 v183, s[8:11], s20 offen offset:3072 lds
MA 252,v,172,v,108
buffer_load_dwordx2 v[36:37], v254, s[84:87], 0 offen
MA 216,v,168,v,104
MA 220,v,172,v,104
s_add_u32 s20, s20, 128
MA 184,v,168,v,100
MA 188,v,172,v,100
MA 152,v,168,v,96
MA 156,v,172,v,96
buffer_load_dwordx2 v[52:53], v254, s[88:91], 0 offen
MA 120,v,168,v,92
s_and_b32 s20, s20, 1023
MA 124,v,172,v,92
MA 88,v,168,v,88
MA 92,v,172,v,88
MA 56,v,168,v,84
MA 60,v,172,v,84
MA 24,v,168,v,80
TR 168,202,16384
TR 170,202,18432
MA 28,v,172,v,80
TR 172,203,16384
TR 174,203,18432
s_waitcnt lgkmcnt(4)
MA 0,v,144,v,112
MA 4,v,148,v,112
MA 32,v,144,v,116
MA 36,v,148,v,116
MA 64,v,144,v,120
MA 68,v,148,v,120
MA 96,v,144,v,124
MA 100,v,148,v,124
MA 128,v,144,v,128
MA 132,v,148,v,128
s_waitcnt vmcnt(15) lgkmcnt(0)
s_barrier
MA 160,v,144,v,132
s_add_u32 m0, s23, 0
s_and_b32 s37, s3, 3
MA 164,v,148,v,132
ds_read_b128 v[80:83], v194 offset:0
MA 192,v,144,v,136
s_cmp_eq_u32 s37, 0
s_cselect_b32 s37, 0, 0x40000000
MA 196,v,148,v,136
v_add_u32 v229, s37, v78
buffer_load_dword v79, v229, s[4:7], 0 offen
MA 224,v,144,v,140
TR 144,196,32768
TR 146,196,34816
MA 228,v,148,v,140
TR 148,197,32768
TR 150,197,34816
MA 232,v,152,v,140
ds_read_b128 v[84:87], v194 offset:2048
buffer_load_dwordx4 v184, s[12:15], s21 offen offset:0 lds
MA 236,v,156,v,140
s_add_u32 s84, s40, 50331648
s_addc_u32 s85, s41, 0
MA 200,v,152,v,136
buffer_load_dwordx4 v185, s[12:15], s21 offen offset:1024 lds
s_mov_b32 s86, 4194304
MA 204,v,156,v,136
s_mov_b32 s87, 0x20000
MA 168,v,152,v,132
s_add_u32 s88, s40, 58720256
s_addc_u32 s89, s41, 0
MA 172,v,156,v,132
ds_read_b128 v[88:91], v194 offset:4096
s_mov_b32 s90, 8192
MA 136,v,152,v,128
s_mov_b32 s91, 0x20000
v_mov_b32 v252, 0
MA 140,v,156,v,128
buffer_load_dwordx4 v186, s[12:15], s21 offen offset:2048 lds
v_mov_b32 v253, 0
MA 104,v,152,v,124
v_dot2_f32_bf16 v252, v230, v2, v252
v_dot2_f32_bf16 v253, v231, v3, v253
v_dot2_f32_bf16 v252, v232, v4, v252
v_dot2_f32_bf16 v253, v233, v5, v253
v_dot2_f32_bf16 v252, v234, v6, v252
v_dot2_f32_bf16 v253, v235, v7, v253
v_dot2_f32_bf16 v252, v236, v8, v252
v_dot2_f32_bf16 v253, v237, v9, v253
v_dot2_f32_bf16 v252, v238, v12, v252
v_dot2_f32_bf16 v253, v239, v13, v253
v_dot2_f32_bf16 v252, v240, v14, v252
v_dot2_f32_bf16 v253, v241, v15, v253
v_dot2_f32_bf16 v252, v242, v246, v252
v_dot2_f32_bf16 v253, v243, v247, v253
v_dot2_f32_bf16 v252, v244, v248, v252
v_dot2_f32_bf16 v253, v245, v249, v253
MA 108,v,156,v,124
MA 72,v,152,v,120
ds_read_b128 v[92:95], v194 offset:6144
MA 76,v,156,v,120
buffer_load_dwordx4 v187, s[12:15], s21 offen offset:3072 lds
MA 40,v,152,v,116
MA 44,v,156,v,116
MA 8,v,152,v,112
TR 152,198,32768
TR 154,198,34816
MA 12,v,156,v,112
TR 156,199,32768
TR 158,199,34816
MA 16,v,160,v,112
ds_read_b128 v[96:99], v194 offset:8192
s_add_u32 m0, s23, 4096
MA 20,v,164,v,112
s_nop 2
v_add_f32 v252, v252, v253
MA 48,v,160,v,116
MA 52,v,164,v,116
MA 80,v,160,v,120
ds_read_b128 v[100:103], v194 offset:10240
buffer_load_dwordx4 v188, s[12:15], s21 offen offset:0 lds
MA 84,v,164,v,120
v_add_f32_dpp v252, v252, v252 row_ror:8 row_mask:0xf bank_mask:0xf
s_nop 1
v_add_f32_dpp v252, v252, v252 row_ror:4 row_mask:0xf bank_mask:0xf
MA 112,v,160,v,124
s_nop 0
v_add_f32_dpp v252, v252, v252 row_ror:2 row_mask:0xf bank_mask:0xf
MA 116,v,164,v,124
s_nop 0
v_add_f32_dpp v252, v252, v252 row_ror:1 row_mask:0xf bank_mask:0xf
v_mov_b32 v253, v252
MA 144,v,160,v,128
buffer_load_dwordx4 v189, s[12:15], s21 offen offset:1024 lds
v_permlane16_swap_b32 v252, v253
MA 148,v,164,v,128
ds_read_b128 v[104:107], v194 offset:12288
v_add_f32 v252, v252, v253
MA 176,v,160,v,132
v_mul_f32 v252, 0xbfb8aa3b, v252
MA 180,v,164,v,132
v_exp_f32 v252, v252
MA 208,v,160,v,136
buffer_load_dwordx4 v190, s[12:15], s21 offen offset:2048 lds
v_add_f32 v252, 1.0, v252
MA 212,v,164,v,136
v_rcp_f32 v252, v252
MA 240,v,160,v,140
TR 160,200,32768
TR 162,200,34816
MA 244,v,164,v,140
TR 164,201,32768
TR 166,201,34816
MA 248,v,168,v,140
ds_read_b128 v[108:111], v194 offset:14336
MA 252,v,172,v,140
buffer_load_dwordx4 v191, s[12:15], s21 offen offset:3072 lds
MA 216,v,168,v,136
s_nop 0
buffer_store_dword v252, v11, s[88:91], 0 offen sc1
MA 220,v,172,v,136
s_getpc_b64 s[82:83]
L_ct_fK:
MA 184,v,168,v,132
s_add_u32 s82, s82, L_p2 - L_ct_fK
s_addc_u32 s83, s83, 0
MA 188,v,172,v,132
s_add_u32 s21, s21, 524288
v_mov_b32 v67, s83
MA 152,v,168,v,128
v_mov_b32 v66, s82
s_lshr_b32 s82, s2, 3
MA 156,v,172,v,128
s_lshl_b32 s82, s82, 2
s_add_u32 s82, s82, s3
MA 120,v,168,v,124
s_lshl_b32 s82, s82, 7
v_and_b32 v68, 3, v1
MA 124,v,172,v,124
s_and_b32 s21, s21, 4194303
v_lshlrev_b32 v68, 14, v68
MA 88,v,168,v,120
v_add_u32 v68, s82, v68
v_min_u32 v68, L_p3_begin - L_p2 - 4, v68
MA 92,v,172,v,120
v_add_co_u32 v66, vcc, v66, v68
s_nop 1
v_addc_co_u32 v67, vcc, 0, v67, vcc
MA 56,v,168,v,116
MA 60,v,172,v,116
global_load_dword v68, v[66:67], off
MA 24,v,168,v,112
TR 168,202,32768
TR 170,202,34816
MA 28,v,172,v,112
TR 172,203,32768
TR 174,203,34816
s_waitcnt lgkmcnt(4)
MA 0,v,144,v,80
s_add_u32 m0, s22, 32768
s_and_b32 s37, s3, 3
MA 4,v,148,v,80
ds_read_b128 v[112:115], v195 offset:0
MA 32,v,144,v,84
MA 36,v,148,v,84
MA 64,v,144,v,88
MA 68,v,148,v,88
buffer_load_dwordx4 v176, s[8:11], s20 offen offset:0 lds
MA 96,v,144,v,92
MA 100,v,148,v,92
ds_read_b128 v[116:119], v195 offset:2048
MA 128,v,144,v,96
MA 132,v,148,v,96
MA 160,v,144,v,100
buffer_load_dwordx4 v177, s[8:11], s20 offen offset:1024 lds
MA 164,v,148,v,100
MA 192,v,144,v,104
s_cmp_eq_u32 s37, 1
s_cselect_b32 s37, 0, 0x40000000
MA 196,v,148,v,104
ds_read_b128 v[120:123], v195 offset:4096
MA 224,v,144,v,108
TR 144,196,49152
TR 146,196,51200
MA 228,v,148,v,108
TR 148,197,49152
TR 150,197,51200
MA 232,v,152,v,108
buffer_load_dwordx4 v178, s[8:11], s20 offen offset:2048 lds
MA 236,v,156,v,108
MA 200,v,152,v,104
MA 204,v,156,v,104
MA 168,v,152,v,100
ds_read_b128 v[124:127], v195 offset:6144
buffer_load_dwordx4 v179, s[8:11], s20 offen offset:3072 lds
MA 172,v,156,v,100
MA 136,v,152,v,96
MA 140,v,156,v,96
MA 104,v,152,v,92
MA 108,v,156,v,92
s_add_u32 m0, s22, 36864
MA 72,v,152,v,88
ds_read_b128 v[128:131], v195 offset:8192
MA 76,v,156,v,88
MA 40,v,152,v,84
MA 44,v,156,v,84
MA 8,v,152,v,80
TR 152,198,49152
TR 154,198,51200
MA 12,v,156,v,80
TR 156,199,49152
TR 158,199,51200
MA 16,v,160,v,80
ds_read_b128 v[132:135], v195 offset:10240
buffer_load_dwordx4 v180, s[8:11], s20 offen offset:0 lds
MA 20,v,164,v,80
MA 48,v,160,v,84
MA 52,v,164,v,84
MA 80,v,160,v,88
buffer_load_dwordx4 v181, s[8:11], s20 offen offset:1024 lds
MA 84,v,164,v,88
v_add_u32 v229, s37, v78
MA 112,v,160,v,92
MA 116,v,164,v,92
ds_read_b128 v[136:139], v195 offset:12288
MA 144,v,160,v,96
MA 148,v,164,v,96
buffer_load_dwordx4 v182, s[8:11], s20 offen offset:2048 lds
MA 176,v,160,v,100
MA 180,v,164,v,100
MA 208,v,160,v,104
MA 212,v,164,v,104
ds_read_b128 v[140:143], v195 offset:14336
MA 240,v,160,v,108
TR 160,200,49152
TR 162,200,51200
MA 244,v,164,v,108
TR 164,201,49152
TR 166,201,51200
s_waitcnt lgkmcnt(15)
MA 248,v,168,v,108
buffer_load_dwordx4 v183, s[8:11], s20 offen offset:3072 lds
MA 252,v,172,v,108
buffer_load_dword v79, v229, s[4:7], 0 offen
MA 216,v,168,v,104
MA 220,v,172,v,104
s_add_u32 s20, s20, 128
MA 184,v,168,v,100
MA 188,v,172,v,100
MA 152,v,168,v,96
MA 156,v,172,v,96
MA 120,v,168,v,92
s_and_b32 s20, s20, 1023
MA 124,v,172,v,92
MA 88,v,168,v,88
MA 92,v,172,v,88
MA 56,v,168,v,84
MA 60,v,172,v,84
MA 24,v,168,v,80
TR 168,202,49152
TR 170,202,51200
MA 28,v,172,v,80
TR 172,203,49152
TR 174,203,51200
s_waitcnt lgkmcnt(4)
MA 0,v,144,v,112
MA 4,v,148,v,112
MA 32,v,144,v,116
MA 36,v,148,v,116
MA 64,v,144,v,120
MA 68,v,148,v,120
MA 96,v,144,v,124
MA 100,v,148,v,124
MA 128,v,144,v,128
MA 132,v,148,v,128
s_waitcnt vmcnt(11) lgkmcnt(0)
s_barrier
MA 160,v,144,v,132
s_add_u32 m0, s23, 32768
s_and_b32 s37, s3, 3
MA 164,v,148,v,132
ds_read_b128 v[80:83], v192 offset:0
MA 192,v,144,v,136
s_cmp_eq_u32 s37, 2
s_cselect_b32 s37, 0, 0x40000000
MA 196,v,148,v,136
v_add_u32 v229, s37, v78
buffer_load_dword v79, v229, s[4:7], 0 offen
MA 224,v,144,v,140
TR 144,196,0
TR 146,196,2048
MA 228,v,148,v,140
TR 148,197,0
TR 150,197,2048
MA 232,v,152,v,140
ds_read_b128 v[84:87], v192 offset:2048
buffer_load_dwordx4 v184, s[12:15], s21 offen offset:0 lds
MA 236,v,156,v,140
v_lshlrev_b32 v2, 16, v54
v_and_b32 v3, 0xffff0000, v54
MA 200,v,152,v,136
buffer_load_dwordx4 v185, s[12:15], s21 offen offset:1024 lds
v_lshlrev_b32 v4, 16, v55
MA 204,v,156,v,136
v_and_b32 v5, 0xffff0000, v55
v_lshlrev_b32 v6, 16, v56
MA 168,v,152,v,132
v_and_b32 v7, 0xffff0000, v56
v_lshlrev_b32 v8, 16, v57
MA 172,v,156,v,132
ds_read_b128 v[88:91], v192 offset:4096
v_and_b32 v9, 0xffff0000, v57
MA 136,v,152,v,128
v_lshlrev_b32 v230, 16, v16
v_and_b32 v231, 0xffff0000, v16
MA 140,v,156,v,128
buffer_load_dwordx4 v186, s[12:15], s21 offen offset:2048 lds
v_lshlrev_b32 v232, 16, v18
MA 104,v,152,v,124
v_and_b32 v233, 0xffff0000, v18
v_lshlrev_b32 v234, 16, v20
MA 108,v,156,v,124
v_and_b32 v235, 0xffff0000, v20
v_lshlrev_b32 v236, 16, v22
MA 72,v,152,v,120
ds_read_b128 v[92:95], v192 offset:6144
v_and_b32 v237, 0xffff0000, v22
MA 76,v,156,v,120
buffer_load_dwordx4 v187, s[12:15], s21 offen offset:3072 lds
v_lshlrev_b32 v238, 16, v24
MA 40,v,152,v,116
v_and_b32 v239, 0xffff0000, v24
v_lshlrev_b32 v240, 16, v26
MA 44,v,156,v,116
v_and_b32 v241, 0xffff0000, v26
v_lshlrev_b32 v242, 16, v28
MA 8,v,152,v,112
TR 152,198,0
TR 154,198,2048
MA 12,v,156,v,112
TR 156,199,0
TR 158,199,2048
MA 16,v,160,v,112
ds_read_b128 v[96:99], v192 offset:8192
s_add_u32 m0, s23, 36864
MA 20,v,164,v,112
v_and_b32 v243, 0xffff0000, v28
v_lshlrev_b32 v244, 16, v30
MA 48,v,160,v,116
v_and_b32 v245, 0xffff0000, v30
v_lshlrev_b32 v246, 16, v32
MA 52,v,164,v,116
v_and_b32 v247, 0xffff0000, v32
v_lshlrev_b32 v248, 16, v34
MA 80,v,160,v,120
ds_read_b128 v[100:103], v192 offset:10240
buffer_load_dwordx4 v188, s[12:15], s21 offen offset:0 lds
MA 84,v,164,v,120
v_and_b32 v249, 0xffff0000, v34
v_lshlrev_b32 v250, 16, v36
MA 112,v,160,v,124
v_and_b32 v251, 0xffff0000, v36
v_lshlrev_b32 v254, 16, v38
MA 116,v,164,v,124
v_and_b32 v255, 0xffff0000, v38
v_mul_f32 v62, v236, v2
MA 144,v,160,v,128
buffer_load_dwordx4 v189, s[12:15], s21 offen offset:1024 lds
v_mul_f32 v70, v237, v6
MA 148,v,164,v,128
ds_read_b128 v[104:107], v192 offset:12288
v_fmac_f32 v62, v234, v3
MA 176,v,160,v,132
v_fmac_f32 v70, v235, v7
v_fmac_f32 v62, v232, v4
MA 180,v,164,v,132
v_fmac_f32 v70, v233, v8
v_fmac_f32 v62, v230, v5
MA 208,v,160,v,136
buffer_load_dwordx4 v190, s[12:15], s21 offen offset:2048 lds
v_fmac_f32 v70, v231, v9
MA 212,v,164,v,136
v_mul_f32 v62, v62, v254
v_mul_f32 v70, v70, v255
MA 240,v,160,v,140
TR 160,200,0
TR 162,200,2048
MA 244,v,164,v,140
TR 164,201,0
TR 166,201,2048
MA 248,v,168,v,140
ds_read_b128 v[108:111], v192 offset:14336
v_lshlrev_b32 v254, 16, v40
MA 252,v,172,v,140
buffer_load_dwordx4 v191, s[12:15], s21 offen offset:3072 lds
v_and_b32 v255, 0xffff0000, v40
MA 216,v,168,v,136
v_mul_f32 v63, v238, v2
v_mul_f32 v71, v239, v6
MA 220,v,172,v,136
v_fmac_f32 v63, v236, v3
v_fmac_f32 v71, v237, v7
MA 184,v,168,v,132
v_fmac_f32 v63, v234, v4
v_fmac_f32 v71, v235, v8
MA 188,v,172,v,132
s_add_u32 s21, s21, 524288
v_fmac_f32 v63, v232, v5
MA 152,v,168,v,128
v_fmac_f32 v71, v233, v9
v_mul_f32 v63, v63, v254
MA 156,v,172,v,128
v_mul_f32 v71, v71, v255
v_lshlrev_b32 v254, 16, v42
MA 120,v,168,v,124
v_and_b32 v255, 0xffff0000, v42
v_mul_f32 v64, v240, v2
MA 124,v,172,v,124
s_and_b32 s21, s21, 4194303
v_mul_f32 v72, v241, v6
MA 88,v,168,v,120
v_fmac_f32 v64, v238, v3
v_fmac_f32 v72, v239, v7
MA 92,v,172,v,120
v_fmac_f32 v64, v236, v4
v_fmac_f32 v72, v237, v8
MA 56,v,168,v,116
v_fmac_f32 v64, v234, v5
v_fmac_f32 v72, v235, v9
MA 60,v,172,v,116
v_mul_f32 v64, v64, v254
v_mul_f32 v72, v72, v255
MA 24,v,168,v,112
TR 168,202,0
TR 170,202,2048
MA 28,v,172,v,112
TR 172,203,0
TR 174,203,2048
v_lshlrev_b32 v254, 16, v44
v_and_b32 v255, 0xffff0000, v44
v_mul_f32 v65, v242, v2
s_waitcnt lgkmcnt(4)
MA 0,v,144,v,80
s_add_u32 s75, s64, s74
s_and_b32 s37, s3, 3
MA 4,v,148,v,80
ds_read_b128 v[112:115], v193 offset:0
MA 32,v,144,v,84
s_cmp_eq_u32 s37, 3
s_cselect_b32 s37, 0, 0x40000000
MA 36,v,148,v,84
v_add_u32 v229, s37, v78
buffer_load_dword v79, v229, s[4:7], 0 offen
MA 64,v,144,v,88
s_add_u32 m0, s67, 65536
v_mul_f32 v73, v243, v6
MA 68,v,148,v,88
v_fmac_f32 v65, v240, v3
v_fmac_f32 v73, v241, v7
MA 96,v,144,v,92
v_fmac_f32 v65, v238, v4
MA 100,v,148,v,92
ds_read_b128 v[116:119], v193 offset:2048
v_fmac_f32 v73, v239, v8
MA 128,v,144,v,96
buffer_load_dwordx4 v208, s[44:47], s75 offen offset:0 lds
v_fmac_f32 v65, v236, v5
MA 132,v,148,v,96
v_fmac_f32 v73, v237, v9
MA 160,v,144,v,100
v_mul_f32 v65, v65, v254
v_mul_f32 v73, v73, v255
MA 164,v,148,v,100
v_lshlrev_b32 v254, 16, v46
MA 192,v,144,v,104
v_and_b32 v255, 0xffff0000, v46
MA 196,v,148,v,104
ds_read_b128 v[120:123], v193 offset:4096
buffer_load_dwordx4 v209, s[44:47], s75 offen offset:1024 lds
MA 224,v,144,v,108
TR 144,196,16384
TR 146,196,18432
MA 228,v,148,v,108
TR 148,197,16384
TR 150,197,18432
MA 232,v,152,v,108
v_mul_f32 v66, v244, v2
v_mul_f32 v74, v245, v6
MA 236,v,156,v,108
buffer_load_dwordx4 v210, s[44:47], s75 offen offset:2048 lds
v_fmac_f32 v66, v242, v3
MA 200,v,152,v,104
v_fmac_f32 v74, v243, v7
v_fmac_f32 v66, v240, v4
MA 204,v,156,v,104
v_fmac_f32 v74, v241, v8
v_fmac_f32 v66, v238, v5
MA 168,v,152,v,100
ds_read_b128 v[124:127], v193 offset:6144
v_fmac_f32 v74, v239, v9
MA 172,v,156,v,100
v_mul_f32 v66, v66, v254
v_mul_f32 v74, v74, v255
MA 136,v,152,v,96
buffer_load_dwordx4 v211, s[44:47], s75 offen offset:3072 lds
v_lshlrev_b32 v254, 16, v48
MA 140,v,156,v,96
v_and_b32 v255, 0xffff0000, v48
v_mul_f32 v67, v246, v2
MA 104,v,152,v,92
v_mul_f32 v75, v247, v6
MA 108,v,156,v,92
v_fmac_f32 v67, v244, v3
v_fmac_f32 v75, v245, v7
MA 72,v,152,v,88
ds_read_b128 v[128:131], v193 offset:8192
s_add_u32 s75, s65, s74
MA 76,v,156,v,88
v_fmac_f32 v67, v242, v4
v_fmac_f32 v75, v243, v8
MA 40,v,152,v,84
v_fmac_f32 v67, v240, v5
MA 44,v,156,v,84
v_fmac_f32 v75, v241, v9
MA 8,v,152,v,80
TR 152,198,16384
TR 154,198,18432
MA 12,v,156,v,80
TR 156,199,16384
TR 158,199,18432
MA 16,v,160,v,80
ds_read_b128 v[132:135], v193 offset:10240
s_add_u32 m0, s67, 69632
MA 20,v,164,v,80
v_mul_f32 v67, v67, v254
v_mul_f32 v75, v75, v255
MA 48,v,160,v,84
v_lshlrev_b32 v254, 16, v50
v_and_b32 v255, 0xffff0000, v50
MA 52,v,164,v,84
buffer_load_dwordx4 v208, s[44:47], s75 offen offset:0 lds
s_waitcnt vmcnt(24)
v_mul_f32 v68, v248, v2
MA 80,v,160,v,88
v_mul_f32 v76, v249, v6
v_fmac_f32 v68, v246, v3
MA 84,v,164,v,88
v_fmac_f32 v76, v247, v7
v_fmac_f32 v68, v244, v4
MA 112,v,160,v,92
v_fmac_f32 v76, v245, v8
v_fmac_f32 v68, v242, v5
MA 116,v,164,v,92
ds_read_b128 v[136:139], v193 offset:12288
buffer_load_dwordx4 v209, s[44:47], s75 offen offset:1024 lds
MA 144,v,160,v,96
v_fmac_f32 v76, v243, v9
v_mul_f32 v68, v68, v254
MA 148,v,164,v,96
v_mul_f32 v76, v76, v255
v_lshlrev_b32 v254, 16, v52
MA 176,v,160,v,100
v_and_b32 v255, 0xffff0000, v52
MA 180,v,164,v,100
v_mul_f32 v69, v250, v2
MA 208,v,160,v,104
buffer_load_dwordx4 v210, s[44:47], s75 offen offset:2048 lds
v_mul_f32 v77, v251, v6
MA 212,v,164,v,104
ds_read_b128 v[140:143], v193 offset:14336
v_fmac_f32 v69, v248, v3
MA 240,v,160,v,108
TR 160,200,16384
TR 162,200,18432
MA 244,v,164,v,108
TR 164,201,16384
TR 166,201,18432
s_waitcnt lgkmcnt(15)
MA 248,v,168,v,108
buffer_load_dwordx4 v211, s[44:47], s75 offen offset:3072 lds
v_fmac_f32 v77, v249, v7
MA 252,v,172,v,108
v_fmac_f32 v69, v246, v4
v_fmac_f32 v77, v247, v8
MA 216,v,168,v,104
v_fmac_f32 v69, v244, v5
v_fmac_f32 v77, v245, v9
MA 220,v,172,v,104
v_mul_f32 v69, v69, v254
v_mul_f32 v77, v77, v255
MA 184,v,168,v,100
v_cvt_pk_bf16_f32 v12, v69, v68
v_cvt_pk_bf16_f32 v13, v67, v66
MA 188,v,172,v,100
s_add_u32 s74, s74, 128
v_cvt_pk_bf16_f32 v14, v65, v64
MA 152,v,168,v,96
v_cvt_pk_bf16_f32 v15, v63, v62
MA 156,v,172,v,96
s_mov_b32 s36, 0
MA 120,v,168,v,92
buffer_store_dwordx4 v[12:15], v10, s[84:87], s36 offen sc1
v_cvt_pk_bf16_f32 v54, v77, v76
MA 124,v,172,v,92
s_and_b32 s74, s74, 2047
v_cvt_pk_bf16_f32 v55, v75, v74
MA 88,v,168,v,88
v_cvt_pk_bf16_f32 v56, v73, v72
MA 92,v,172,v,88
v_cvt_pk_bf16_f32 v57, v71, v70
MA 56,v,168,v,84
s_mov_b32 s36, 4096
MA 60,v,172,v,84
buffer_store_dwordx4 v[54:57], v10, s[84:87], s36 offen sc1
MA 24,v,168,v,80
TR 168,202,16384
TR 170,202,18432
MA 28,v,172,v,80
TR 172,203,16384
TR 174,203,18432
s_waitcnt lgkmcnt(4)
MA 0,v,144,v,112
MA 4,v,148,v,112
MA 32,v,144,v,116
MA 36,v,148,v,116
MA 64,v,144,v,120
MA 68,v,148,v,120
MA 96,v,144,v,124
MA 100,v,148,v,124
MA 128,v,144,v,128
MA 132,v,148,v,128
s_waitcnt vmcnt(11) lgkmcnt(0)
s_barrier
MA 160,v,144,v,132
s_add_u32 m0, s68, 98304
v_lshlrev_b32 v2, 16, v58
MA 164,v,148,v,132
ds_read_b128 v[80:83], v192 offset:32768
v_and_b32 v3, 0xffff0000, v58
MA 192,v,144,v,136
v_lshlrev_b32 v4, 16, v59
v_and_b32 v5, 0xffff0000, v59
MA 196,v,148,v,136
buffer_load_dwordx4 v212, s[48:51], s66 offen offset:0 lds
v_lshlrev_b32 v6, 16, v60
MA 224,v,144,v,140
TR 144,196,32768
TR 146,196,34816
MA 228,v,148,v,140
TR 148,197,32768
TR 150,197,34816
MA 232,v,152,v,140
ds_read_b128 v[84:87], v192 offset:34816
v_and_b32 v7, 0xffff0000, v60
MA 236,v,156,v,140
buffer_load_dwordx4 v213, s[48:51], s66 offen offset:1024 lds
v_lshlrev_b32 v8, 16, v61
MA 200,v,152,v,136
v_and_b32 v9, 0xffff0000, v61
v_lshlrev_b32 v230, 16, v17
MA 204,v,156,v,136
v_and_b32 v231, 0xffff0000, v17
v_lshlrev_b32 v232, 16, v19
MA 168,v,152,v,132
v_and_b32 v233, 0xffff0000, v19
v_lshlrev_b32 v234, 16, v21
MA 172,v,156,v,132
ds_read_b128 v[88:91], v192 offset:36864
buffer_load_dwordx4 v214, s[48:51], s66 offen offset:2048 lds
MA 136,v,152,v,128
v_and_b32 v235, 0xffff0000, v21
v_lshlrev_b32 v236, 16, v23
MA 140,v,156,v,128
v_and_b32 v237, 0xffff0000, v23
v_lshlrev_b32 v238, 16, v25
MA 104,v,152,v,124
buffer_load_dwordx4 v215, s[48:51], s66 offen offset:3072 lds
v_and_b32 v239, 0xffff0000, v25
MA 108,v,156,v,124
v_lshlrev_b32 v240, 16, v27
v_and_b32 v241, 0xffff0000, v27
MA 72,v,152,v,120
ds_read_b128 v[92:95], v192 offset:38912
v_lshlrev_b32 v242, 16, v29
MA 76,v,156,v,120
v_and_b32 v243, 0xffff0000, v29
v_lshlrev_b32 v244, 16, v31
MA 40,v,152,v,116
s_add_u32 s66, s66, 524288
v_and_b32 v245, 0xffff0000, v31
MA 44,v,156,v,116
v_lshlrev_b32 v246, 16, v33
v_and_b32 v247, 0xffff0000, v33
MA 8,v,152,v,112
TR 152,198,32768
TR 154,198,34816
MA 12,v,156,v,112
TR 156,199,32768
TR 158,199,34816
MA 16,v,160,v,112
ds_read_b128 v[96:99], v192 offset:40960
s_and_b32 s66, s66, 8388607
MA 20,v,164,v,112
v_lshlrev_b32 v248, 16, v35
v_and_b32 v249, 0xffff0000, v35
MA 48,v,160,v,116
v_lshlrev_b32 v250, 16, v37
v_and_b32 v251, 0xffff0000, v37
MA 52,v,164,v,116
v_lshlrev_b32 v254, 16, v39
v_and_b32 v255, 0xffff0000, v39
MA 80,v,160,v,120
ds_read_b128 v[100:103], v192 offset:43008
s_add_u32 m0, s68, 114688
MA 84,v,164,v,120
v_mul_f32 v62, v236, v2
v_mul_f32 v70, v237, v6
MA 112,v,160,v,124
v_fmac_f32 v62, v234, v3
v_fmac_f32 v70, v235, v7
MA 116,v,164,v,124
buffer_load_dwordx4 v212, s[48:51], s66 offen offset:0 lds
v_fmac_f32 v62, v232, v4
MA 144,v,160,v,128
v_fmac_f32 v70, v233, v8
v_fmac_f32 v62, v230, v5
MA 148,v,164,v,128
ds_read_b128 v[104:107], v192 offset:45056
v_fmac_f32 v70, v231, v9
MA 176,v,160,v,132
v_mul_f32 v62, v62, v254
v_mul_f32 v70, v70, v255
MA 180,v,164,v,132
buffer_load_dwordx4 v213, s[48:51], s66 offen offset:1024 lds
v_lshlrev_b32 v254, 16, v41
MA 208,v,160,v,136
v_and_b32 v255, 0xffff0000, v41
v_mul_f32 v63, v238, v2
MA 212,v,164,v,136
v_mul_f32 v71, v239, v6
v_fmac_f32 v63, v236, v3
MA 240,v,160,v,140
TR 160,200,32768
TR 162,200,34816
MA 244,v,164,v,140
TR 164,201,32768
TR 166,201,34816
MA 248,v,168,v,140
ds_read_b128 v[108:111], v192 offset:47104
buffer_load_dwordx4 v214, s[48:51], s66 offen offset:2048 lds
MA 252,v,172,v,140
v_fmac_f32 v71, v237, v7
v_fmac_f32 v63, v234, v4
MA 216,v,168,v,136
buffer_load_dwordx4 v215, s[48:51], s66 offen offset:3072 lds
v_fmac_f32 v71, v235, v8
MA 220,v,172,v,136
v_fmac_f32 v63, v232, v5
v_fmac_f32 v71, v233, v9
MA 184,v,168,v,132
v_mul_f32 v63, v63, v254
v_mul_f32 v71, v71, v255
MA 188,v,172,v,132
v_lshlrev_b32 v254, 16, v43
v_and_b32 v255, 0xffff0000, v43
MA 152,v,168,v,128
s_add_u32 s66, s66, 524288
v_mul_f32 v64, v240, v2
MA 156,v,172,v,128
v_mul_f32 v72, v241, v6
v_fmac_f32 v64, v238, v3
MA 120,v,168,v,124
v_fmac_f32 v72, v239, v7
v_fmac_f32 v64, v236, v4
MA 124,v,172,v,124
v_fmac_f32 v72, v237, v8
v_fmac_f32 v64, v234, v5
MA 88,v,168,v,120
s_and_b32 s66, s66, 8388607
v_fmac_f32 v72, v235, v9
MA 92,v,172,v,120
v_mul_f32 v64, v64, v254
v_mul_f32 v72, v72, v255
MA 56,v,168,v,116
v_lshlrev_b32 v254, 16, v45
v_and_b32 v255, 0xffff0000, v45
MA 60,v,172,v,116
v_mul_f32 v65, v242, v2
MA 24,v,168,v,112
TR 168,202,32768
TR 170,202,34816
MA 28,v,172,v,112
TR 172,203,32768
TR 174,203,34816
s_waitcnt lgkmcnt(4)
MA 0,v,144,v,80
s_add_u32 s75, s64, s74
v_mul_f32 v73, v243, v6
MA 4,v,148,v,80
ds_read_b128 v[112:115], v193 offset:32768
v_fmac_f32 v65, v240, v3
MA 32,v,144,v,84
v_fmac_f32 v73, v241, v7
v_fmac_f32 v65, v238, v4
MA 36,v,148,v,84
v_fmac_f32 v73, v239, v8
MA 64,v,144,v,88
s_add_u32 m0, s67, 0
v_fmac_f32 v65, v236, v5
MA 68,v,148,v,88
v_fmac_f32 v73, v237, v9
MA 96,v,144,v,92
v_mul_f32 v65, v65, v254
MA 100,v,148,v,92
ds_read_b128 v[116:119], v193 offset:34816
v_mul_f32 v73, v73, v255
MA 128,v,144,v,96
buffer_load_dwordx4 v208, s[44:47], s75 offen offset:0 lds
v_lshlrev_b32 v254, 16, v47
MA 132,v,148,v,96
v_and_b32 v255, 0xffff0000, v47
v_mul_f32 v66, v244, v2
MA 160,v,144,v,100
v_mul_f32 v74, v245, v6
MA 164,v,148,v,100
v_fmac_f32 v66, v242, v3
MA 192,v,144,v,104
v_fmac_f32 v74, v243, v7
MA 196,v,148,v,104
ds_read_b128 v[120:123], v193 offset:36864
buffer_load_dwordx4 v209, s[44:47], s75 offen offset:1024 lds
MA 224,v,144,v,108
TR 144,196,49152
TR 146,196,51200
MA 228,v,148,v,108
TR 148,197,49152
TR 150,197,51200
MA 232,v,152,v,108
v_fmac_f32 v66, v240, v4
v_fmac_f32 v74, v241, v8
MA 236,v,156,v,108
buffer_load_dwordx4 v210, s[44:47], s75 offen offset:2048 lds
v_fmac_f32 v66, v238, v5
MA 200,v,152,v,104
v_fmac_f32 v74, v239, v9
v_mul_f32 v66, v66, v254
MA 204,v,156,v,104
v_mul_f32 v74, v74, v255
v_lshlrev_b32 v254, 16, v49
MA 168,v,152,v,100
ds_read_b128 v[124:127], v193 offset:38912
v_and_b32 v255, 0xffff0000, v49
MA 172,v,156,v,100
v_mul_f32 v67, v246, v2
v_mul_f32 v75, v247, v6
MA 136,v,152,v,96
buffer_load_dwordx4 v211, s[44:47], s75 offen offset:3072 lds
v_fmac_f32 v67, v244, v3
MA 140,v,156,v,96
v_fmac_f32 v75, v245, v7
v_fmac_f32 v67, v242, v4
MA 104,v,152,v,92
v_fmac_f32 v75, v243, v8
MA 108,v,156,v,92
v_fmac_f32 v67, v240, v5
MA 72,v,152,v,88
ds_read_b128 v[128:131], v193 offset:40960
s_add_u32 s75, s65, s74
MA 76,v,156,v,88
v_fmac_f32 v75, v241, v9
v_mul_f32 v67, v67, v254
MA 40,v,152,v,84
v_mul_f32 v75, v75, v255
MA 44,v,156,v,84
v_lshlrev_b32 v254, 16, v51
MA 8,v,152,v,80
TR 152,198,49152
TR 154,198,51200
MA 12,v,156,v,80
TR 156,199,49152
TR 158,199,51200
MA 16,v,160,v,80
ds_read_b128 v[132:135], v193 offset:43008
s_add_u32 m0, s67, 4096
MA 20,v,164,v,80
v_and_b32 v255, 0xffff0000, v51
v_mul_f32 v68, v248, v2
MA 48,v,160,v,84
v_mul_f32 v76, v249, v6
v_fmac_f32 v68, v246, v3
MA 52,v,164,v,84
buffer_load_dwordx4 v208, s[44:47], s75 offen offset:0 lds
v_fmac_f32 v76, v247, v7
MA 80,v,160,v,88
v_fmac_f32 v68, v244, v4
v_fmac_f32 v76, v245, v8
MA 84,v,164,v,88
v_fmac_f32 v68, v242, v5
v_fmac_f32 v76, v243, v9
MA 112,v,160,v,92
v_mul_f32 v68, v68, v254
v_mul_f32 v76, v76, v255
MA 116,v,164,v,92
ds_read_b128 v[136:139], v193 offset:45056
buffer_load_dwordx4 v209, s[44:47], s75 offen offset:1024 lds
MA 144,v,160,v,96
v_lshlrev_b32 v254, 16, v53
v_and_b32 v255, 0xffff0000, v53
MA 148,v,164,v,96
v_mul_f32 v69, v250, v2
MA 176,v,160,v,100
v_mul_f32 v77, v251, v6
MA 180,v,164,v,100
v_fmac_f32 v69, v248, v3
MA 208,v,160,v,104
buffer_load_dwordx4 v210, s[44:47], s75 offen offset:2048 lds
v_fmac_f32 v77, v249, v7
MA 212,v,164,v,104
ds_read_b128 v[140:143], v193 offset:47104
v_fmac_f32 v69, v246, v4
MA 240,v,160,v,108
TR 160,200,49152
TR 162,200,51200
MA 244,v,164,v,108
TR 164,201,49152
TR 166,201,51200
s_waitcnt lgkmcnt(15)
MA 248,v,168,v,108
buffer_load_dwordx4 v211, s[44:47], s75 offen offset:3072 lds
v_fmac_f32 v77, v247, v8
MA 252,v,172,v,108
v_fmac_f32 v69, v244, v5
v_fmac_f32 v77, v245, v9
MA 216,v,168,v,104
v_mul_f32 v69, v69, v254
v_mul_f32 v77, v77, v255
MA 220,v,172,v,104
v_cvt_pk_bf16_f32 v230, v69, v68
v_cvt_pk_bf16_f32 v231, v67, v66
MA 184,v,168,v,100
v_cvt_pk_bf16_f32 v232, v65, v64
MA 188,v,172,v,100
s_add_u32 s74, s74, 128
v_cvt_pk_bf16_f32 v233, v63, v62
MA 152,v,168,v,96
s_mov_b32 s36, 8192
buffer_store_dwordx4 v[230:233], v10, s[84:87], s36 offen sc1
MA 156,v,172,v,96
v_cvt_pk_bf16_f32 v234, v77, v76
MA 120,v,168,v,92
v_cvt_pk_bf16_f32 v235, v75, v74
MA 124,v,172,v,92
s_and_b32 s74, s74, 2047
v_cvt_pk_bf16_f32 v236, v73, v72
MA 88,v,168,v,88
v_cvt_pk_bf16_f32 v237, v71, v70
MA 92,v,172,v,88
s_mov_b32 s36, 12288
MA 56,v,168,v,84
buffer_store_dwordx4 v[234:237], v10, s[84:87], s36 offen sc1
MA 60,v,172,v,84
v_lshlrev_b32 v228, 4, v1
MA 24,v,168,v,80
TR 168,202,49152
TR 170,202,51200
MA 28,v,172,v,80
TR 172,203,49152
TR 174,203,51200
s_waitcnt lgkmcnt(4)
MA 0,v,144,v,112
MA 4,v,148,v,112
MA 32,v,144,v,116
MA 36,v,148,v,116
MA 64,v,144,v,120
MA 68,v,148,v,120
MA 96,v,144,v,124
MA 100,v,148,v,124
MA 128,v,144,v,128
MA 132,v,148,v,128
s_waitcnt vmcnt(14) lgkmcnt(0)
s_barrier
MA 160,v,144,v,132
ds_read_b128 v[48:51], v226 offset:0
s_add_u32 m0, s68, 131072
MA 164,v,148,v,132
MA 192,v,144,v,136
ds_read_b128 v[52:55], v226 offset:2048
buffer_load_dwordx4 v212, s[48:51], s66 offen offset:0 lds
MA 196,v,148,v,136
MA 224,v,144,v,140
ds_read_b128 v[56:59], v226 offset:4096
buffer_load_dwordx4 v213, s[48:51], s66 offen offset:1024 lds
MA 228,v,148,v,140
MA 232,v,152,v,140
ds_read_b128 v[60:63], v226 offset:6144
MA 236,v,156,v,140
buffer_load_dwordx4 v214, s[48:51], s66 offen offset:2048 lds
MA 200,v,152,v,136
TR 16,216,0
MA 204,v,156,v,136
buffer_load_dwordx4 v215, s[48:51], s66 offen offset:3072 lds
MA 168,v,152,v,132
TR 18,216,1024
MA 172,v,156,v,132
MA 136,v,152,v,128
TR 20,217,0
s_add_u32 s66, s66, 524288
MA 140,v,156,v,128
MA 104,v,152,v,124
TR 22,217,1024
s_and_b32 s66, s66, 8388607
MA 108,v,156,v,124
MA 72,v,152,v,120
TR 24,218,0
MA 76,v,156,v,120
s_add_u32 s75, s64, s74
MA 40,v,152,v,116
TR 26,218,1024
MA 44,v,156,v,116
s_add_u32 m0, s67, 32768
MA 8,v,152,v,112
TR 28,219,0
MA 12,v,156,v,112
MA 16,v,160,v,112
TR 30,219,1024
buffer_load_dwordx4 v208, s[44:47], s75 offen offset:0 lds
MA 20,v,164,v,112
MA 48,v,160,v,116
TR 32,220,0
buffer_load_dwordx4 v209, s[44:47], s75 offen offset:1024 lds
MA 52,v,164,v,116
MA 80,v,160,v,120
TR 34,220,1024
MA 84,v,164,v,120
buffer_load_dwordx4 v210, s[44:47], s75 offen offset:2048 lds
MA 112,v,160,v,124
TR 36,221,0
MA 116,v,164,v,124
buffer_load_dwordx4 v211, s[44:47], s75 offen offset:3072 lds
MA 144,v,160,v,128
TR 38,221,1024
MA 148,v,164,v,128
MA 176,v,160,v,132
TR 40,222,0
s_add_u32 s75, s65, s74
MA 180,v,164,v,132
MA 208,v,160,v,136
TR 42,222,1024
s_add_u32 m0, s67, 36864
MA 212,v,164,v,136
MA 240,v,160,v,140
TR 44,223,0
MA 244,v,164,v,140
buffer_load_dwordx4 v208, s[44:47], s75 offen offset:0 lds
MA 248,v,168,v,140
TR 46,223,1024
MA 252,v,172,v,140
buffer_load_dwordx4 v209, s[44:47], s75 offen offset:1024 lds
MA 216,v,168,v,136
MA 220,v,172,v,136
MA 184,v,168,v,132
buffer_load_dwordx4 v210, s[44:47], s75 offen offset:2048 lds
MA 188,v,172,v,132
MA 152,v,168,v,128
buffer_load_dwordx4 v211, s[44:47], s75 offen offset:3072 lds
MA 156,v,172,v,128
MA 120,v,168,v,124
MA 124,v,172,v,124
s_add_u32 s74, s74, 128
MA 88,v,168,v,120
MA 92,v,172,v,120
s_and_b32 s74, s74, 2047
MA 56,v,168,v,116
MA 60,v,172,v,116
MA 24,v,168,v,112
MA 28,v,172,v,112
s_branch L_p2
L_p1_V:
s_waitcnt lgkmcnt(14)
v_mfma_f32_16x16x32_bf16 a[0:3], v[80:83], v[144:147], 0
s_add_u32 m0, s22, 32768
s_mov_b32 s86, 4194304
s_waitcnt lgkmcnt(12)
v_mfma_f32_16x16x32_bf16 a[8:11], v[80:83], v[148:151], 0
ds_read_b128 v[112:115], v193 offset:0
s_mov_b32 s87, 0x20000
v_mfma_f32_16x16x32_bf16 a[4:7], v[84:87], v[144:147], 0
v_mfma_f32_16x16x32_bf16 a[12:15], v[84:87], v[148:151], 0
s_mov_b32 s90, 4194304
v_mfma_f32_16x16x32_bf16 a[64:67], v[88:91], v[144:147], 0
s_mov_b32 s91, 0x20000
v_mfma_f32_16x16x32_bf16 a[72:75], v[88:91], v[148:151], 0
buffer_load_dwordx4 v176, s[8:11], s20 offen offset:0 lds
v_mfma_f32_16x16x32_bf16 a[68:71], v[92:95], v[144:147], 0
s_mov_b32 s94, 4194304
v_mfma_f32_16x16x32_bf16 a[76:79], v[92:95], v[148:151], 0
ds_read_b128 v[116:119], v193 offset:2048
s_mov_b32 s95, 0x20000
v_mfma_f32_16x16x32_bf16 a[128:131], v[96:99], v[144:147], 0
v_mfma_f32_16x16x32_bf16 a[136:139], v[96:99], v[148:151], 0
s_mov_b32 s98, 8192
v_mfma_f32_16x16x32_bf16 a[132:135], v[100:103], v[144:147], 0
buffer_load_dwordx4 v177, s[8:11], s20 offen offset:1024 lds
s_mov_b32 s99, 0x20000
v_mfma_f32_16x16x32_bf16 a[140:143], v[100:103], v[148:151], 0
v_mfma_f32_16x16x32_bf16 a[192:195], v[104:107], v[144:147], 0
s_mov_b32 s78, 2048
v_mfma_f32_16x16x32_bf16 a[200:203], v[104:107], v[148:151], 0
ds_read_b128 v[120:123], v193 offset:4096
s_mov_b32 s79, 0x20000
v_mfma_f32_16x16x32_bf16 a[196:199], v[108:111], v[144:147], 0
TR 144,196,16384
TR 146,196,18432
v_mfma_f32_16x16x32_bf16 a[204:207], v[108:111], v[148:151], 0
TR 148,197,16384
TR 150,197,18432
s_waitcnt lgkmcnt(15)
v_mfma_f32_16x16x32_bf16 a[212:215], v[108:111], v[152:155], 0
buffer_load_dwordx4 v178, s[8:11], s20 offen offset:2048 lds
s_and_b32 s36, s2, 15
v_mfma_f32_16x16x32_bf16 a[220:223], v[108:111], v[156:159], 0
s_lshl_b32 s36, s36, 1
v_mfma_f32_16x16x32_bf16 a[208:211], v[104:107], v[152:155], 0
s_lshr_b32 s37, s3, 1
v_mfma_f32_16x16x32_bf16 a[216:219], v[104:107], v[156:159], 0
s_add_u32 s36, s36, s37
v_mfma_f32_16x16x32_bf16 a[148:151], v[100:103], v[152:155], 0
ds_read_b128 v[124:127], v193 offset:6144
buffer_load_dwordx4 v179, s[8:11], s20 offen offset:3072 lds
v_mfma_f32_16x16x32_bf16 a[156:159], v[100:103], v[156:159], 0
s_lshl_b32 s36, s36, 3
v_mfma_f32_16x16x32_bf16 a[144:147], v[96:99], v[152:155], 0
v_and_b32 v252, 7, v1
v_mfma_f32_16x16x32_bf16 a[152:155], v[96:99], v[156:159], 0
v_mfma_f32_16x16x32_bf16 a[84:87], v[92:95], v[152:155], 0
v_add_u32 v252, s36, v252
v_mfma_f32_16x16x32_bf16 a[92:95], v[92:95], v[156:159], 0
s_add_u32 m0, s22, 36864
s_lshr_b32 s36, s2, 4
v_mfma_f32_16x16x32_bf16 a[80:83], v[88:91], v[152:155], 0
ds_read_b128 v[128:131], v193 offset:8192
v_mfma_f32_16x16x32_bf16 a[88:91], v[88:91], v[156:159], 0
s_lshl_b32 s36, s36, 1
v_mfma_f32_16x16x32_bf16 a[20:23], v[84:87], v[152:155], 0
s_and_b32 s37, s3, 1
v_mfma_f32_16x16x32_bf16 a[28:31], v[84:87], v[156:159], 0
v_mfma_f32_16x16x32_bf16 a[16:19], v[80:83], v[152:155], 0
TR 152,198,16384
TR 154,198,18432
v_mfma_f32_16x16x32_bf16 a[24:27], v[80:83], v[156:159], 0
TR 156,199,16384
TR 158,199,18432
s_waitcnt lgkmcnt(15)
v_mfma_f32_16x16x32_bf16 a[32:35], v[80:83], v[160:163], 0
ds_read_b128 v[132:135], v193 offset:10240
buffer_load_dwordx4 v180, s[8:11], s20 offen offset:0 lds
v_mfma_f32_16x16x32_bf16 a[40:43], v[80:83], v[164:167], 0
s_add_u32 s36, s36, s37
s_lshl_b32 s36, s36, 3
v_mfma_f32_16x16x32_bf16 a[36:39], v[84:87], v[160:163], 0
v_lshrrev_b32 v253, 3, v1
v_add_u32 v253, s36, v253
v_mfma_f32_16x16x32_bf16 a[44:47], v[84:87], v[164:167], 0
v_mfma_f32_16x16x32_bf16 a[96:99], v[88:91], v[160:163], 0
buffer_load_dwordx4 v181, s[8:11], s20 offen offset:1024 lds
v_lshlrev_b32 v254, 14, v253
v_mfma_f32_16x16x32_bf16 a[104:107], v[88:91], v[164:167], 0
v_lshl_add_u32 v254, v252, 3, v254
v_mfma_f32_16x16x32_bf16 a[100:103], v[92:95], v[160:163], 0
v_mfma_f32_16x16x32_bf16 a[108:111], v[92:95], v[164:167], 0
ds_read_b128 v[136:139], v193 offset:12288
v_add_u32 v229, -6144, v254
v_mfma_f32_16x16x32_bf16 a[160:163], v[96:99], v[160:163], 0
v_lshlrev_b32 v62, 5, v252
v_mfma_f32_16x16x32_bf16 a[168:171], v[96:99], v[164:167], 0
buffer_load_dwordx4 v182, s[8:11], s20 offen offset:2048 lds
v_mfma_f32_16x16x32_bf16 a[164:167], v[100:103], v[160:163], 0
v_lshlrev_b32 v254, 4, v253
v_mfma_f32_16x16x32_bf16 a[172:175], v[100:103], v[164:167], 0
v_sub_u32 v254, 4080, v254
v_mfma_f32_16x16x32_bf16 a[224:227], v[104:107], v[160:163], 0
v_mfma_f32_16x16x32_bf16 a[232:235], v[104:107], v[164:167], 0
ds_read_b128 v[140:143], v193 offset:14336
v_lshl_add_u32 v10, v252, 14, v254
v_mfma_f32_16x16x32_bf16 a[228:231], v[108:111], v[160:163], 0
TR 160,200,16384
TR 162,200,18432
v_mfma_f32_16x16x32_bf16 a[236:239], v[108:111], v[164:167], 0
TR 164,201,16384
TR 166,201,18432
v_mfma_f32_16x16x32_bf16 a[244:247], v[108:111], v[168:171], 0
buffer_load_dwordx4 v183, s[8:11], s20 offen offset:3072 lds
v_and_b32 v252, 31, v1
s_waitcnt lgkmcnt(15)
v_mfma_f32_16x16x32_bf16 a[252:255], v[108:111], v[172:175], 0
v_lshlrev_b32 v64, 4, v252
s_lshl_b32 s36, s2, 2
v_mfma_f32_16x16x32_bf16 a[240:243], v[104:107], v[168:171], 0
v_mfma_f32_16x16x32_bf16 a[248:251], v[104:107], v[172:175], 0
s_add_u32 s20, s20, 128
s_add_u32 s36, s36, s3
v_mfma_f32_16x16x32_bf16 a[180:183], v[100:103], v[168:171], 0
s_lshl_b32 s36, s36, 1
v_mfma_f32_16x16x32_bf16 a[188:191], v[100:103], v[172:175], 0
v_mfma_f32_16x16x32_bf16 a[176:179], v[96:99], v[168:171], 0
v_lshrrev_b32 v253, 5, v1
v_mfma_f32_16x16x32_bf16 a[184:187], v[96:99], v[172:175], 0
v_add_u32 v253, s36, v253
v_mfma_f32_16x16x32_bf16 a[116:119], v[92:95], v[168:171], 0
s_and_b32 s20, s20, 1023
v_mfma_f32_16x16x32_bf16 a[124:127], v[92:95], v[172:175], 0
v_lshl_add_u32 v63, v253, 11, v64
v_mfma_f32_16x16x32_bf16 a[112:115], v[88:91], v[168:171], 0
v_lshlrev_b32 v253, 2, v253
v_mfma_f32_16x16x32_bf16 a[120:123], v[88:91], v[172:175], 0
v_mfma_f32_16x16x32_bf16 a[52:55], v[84:87], v[168:171], 0
v_lshl_add_u32 v11, v252, 20, v253
v_mfma_f32_16x16x32_bf16 a[60:63], v[84:87], v[172:175], 0
v_mfma_f32_16x16x32_bf16 a[48:51], v[80:83], v[168:171], 0
TR 168,202,16384
TR 170,202,18432
v_mfma_f32_16x16x32_bf16 a[56:59], v[80:83], v[172:175], 0
TR 172,203,16384
TR 174,203,18432
s_waitcnt lgkmcnt(4)
MA 0,v,112,v,144
s_add_u32 m0, s22, 65536
MA 8,v,112,v,148
MA 4,v,116,v,144
buffer_load_dwordx4 v176, s[8:11], s20 offen offset:0 lds
MA 12,v,116,v,148
MA 64,v,120,v,144
buffer_load_dwordx4 v177, s[8:11], s20 offen offset:1024 lds
MA 72,v,120,v,148
MA 68,v,124,v,144
MA 76,v,124,v,148
buffer_load_dwordx4 v178, s[8:11], s20 offen offset:2048 lds
MA 128,v,128,v,144
MA 136,v,128,v,148
buffer_load_dwordx4 v179, s[8:11], s20 offen offset:3072 lds
MA 132,v,132,v,144
MA 140,v,132,v,148
MA 192,v,136,v,144
s_add_u32 m0, s22, 69632
MA 200,v,136,v,148
MA 196,v,140,v,144
buffer_load_dwordx4 v180, s[8:11], s20 offen offset:0 lds
MA 204,v,140,v,148
MA 212,v,140,v,152
buffer_load_dwordx4 v181, s[8:11], s20 offen offset:1024 lds
MA 220,v,140,v,156
MA 208,v,136,v,152
MA 216,v,136,v,156
buffer_load_dwordx4 v182, s[8:11], s20 offen offset:2048 lds
MA 148,v,132,v,152
MA 156,v,132,v,156
buffer_load_dwordx4 v183, s[8:11], s20 offen offset:3072 lds
MA 144,v,128,v,152
MA 152,v,128,v,156
MA 84,v,124,v,152
s_add_u32 s20, s20, 128
MA 92,v,124,v,156
MA 80,v,120,v,152
s_and_b32 s20, s20, 1023
MA 88,v,120,v,156
MA 20,v,116,v,152
MA 28,v,116,v,156
MA 16,v,112,v,152
s_waitcnt vmcnt(8) lgkmcnt(0)
s_barrier
MA 24,v,112,v,156
TR 144,196,32768
TR 146,196,34816
MA 32,v,112,v,160
ds_read_b128 v[80:83], v192 offset:32768
s_add_u32 m0, s23, 0
MA 40,v,112,v,164
TR 148,197,32768
TR 150,197,34816
MA 36,v,116,v,160
ds_read_b128 v[84:87], v192 offset:34816
buffer_load_dwordx4 v184, s[12:15], s21 offen offset:0 lds
MA 44,v,116,v,164
TR 152,198,32768
TR 154,198,34816
MA 96,v,120,v,160
buffer_load_dwordx4 v185, s[12:15], s21 offen offset:1024 lds
MA 104,v,120,v,164
TR 156,199,32768
TR 158,199,34816
MA 100,v,124,v,160
ds_read_b128 v[88:91], v192 offset:36864
buffer_load_dwordx4 v186, s[12:15], s21 offen offset:2048 lds
MA 108,v,124,v,164
ds_read_b128 v[92:95], v192 offset:38912
MA 160,v,128,v,160
MA 168,v,128,v,164
buffer_load_dwordx4 v187, s[12:15], s21 offen offset:3072 lds
MA 164,v,132,v,160
ds_read_b128 v[96:99], v192 offset:40960
MA 172,v,132,v,164
s_add_u32 m0, s23, 4096
MA 224,v,136,v,160
ds_read_b128 v[100:103], v192 offset:43008
MA 232,v,136,v,164
MA 228,v,140,v,160
TR 160,200,32768
TR 162,200,34816
MA 236,v,140,v,164
TR 164,201,32768
TR 166,201,34816
MA 244,v,140,v,168
ds_read_b128 v[104:107], v192 offset:45056
buffer_load_dwordx4 v188, s[12:15], s21 offen offset:0 lds
MA 252,v,140,v,172
ds_read_b128 v[108:111], v192 offset:47104
buffer_load_dwordx4 v189, s[12:15], s21 offen offset:1024 lds
MA 240,v,136,v,168
MA 248,v,136,v,172
buffer_load_dwordx4 v190, s[12:15], s21 offen offset:2048 lds
MA 180,v,132,v,168
MA 188,v,132,v,172
MA 176,v,128,v,168
buffer_load_dwordx4 v191, s[12:15], s21 offen offset:3072 lds
MA 184,v,128,v,172
MA 116,v,124,v,168
s_add_u32 s21, s21, 524288
MA 124,v,124,v,172
MA 112,v,120,v,168
MA 120,v,120,v,172
s_and_b32 s21, s21, 4194303
MA 52,v,116,v,168
MA 60,v,116,v,172
MA 48,v,112,v,168
TR 168,202,32768
TR 170,202,34816
MA 56,v,112,v,172
TR 172,203,32768
TR 174,203,34816
s_waitcnt lgkmcnt(4)
MA 0,v,80,v,144
s_add_u32 m0, s22, 0
buffer_load_dwordx4 v[230:233], v63, s[92:95], 0 offen offset:0
MA 8,v,80,v,148
ds_read_b128 v[112:115], v193 offset:32768
MA 4,v,84,v,144
MA 12,v,84,v,148
MA 64,v,88,v,144
MA 72,v,88,v,148
buffer_load_dwordx4 v176, s[8:11], s20 offen offset:0 lds
MA 68,v,92,v,144
buffer_load_dwordx4 v[2:5], v64, s[76:79], 0 offen offset:0
MA 76,v,92,v,148
ds_read_b128 v[116:119], v193 offset:34816
MA 128,v,96,v,144
MA 136,v,96,v,148
MA 132,v,100,v,144
buffer_load_dwordx4 v177, s[8:11], s20 offen offset:1024 lds
MA 140,v,100,v,148
MA 192,v,104,v,144
buffer_load_dwordx4 v[234:237], v63, s[92:95], 0 offen offset:512
MA 200,v,104,v,148
ds_read_b128 v[120:123], v193 offset:36864
MA 196,v,108,v,144
TR 144,196,49152
TR 146,196,51200
MA 204,v,108,v,148
TR 148,197,49152
TR 150,197,51200
MA 212,v,108,v,152
buffer_load_dwordx4 v178, s[8:11], s20 offen offset:2048 lds
MA 220,v,108,v,156
MA 208,v,104,v,152
buffer_load_dwordx4 v[6:9], v64, s[76:79], 0 offen offset:512
MA 216,v,104,v,156
MA 148,v,100,v,152
ds_read_b128 v[124:127], v193 offset:38912
buffer_load_dwordx4 v179, s[8:11], s20 offen offset:3072 lds
MA 156,v,100,v,156
MA 144,v,96,v,152
MA 152,v,96,v,156
MA 84,v,92,v,152
buffer_load_dwordx4 v[238:241], v63, s[92:95], 0 offen offset:1024
MA 92,v,92,v,156
s_add_u32 m0, s22, 4096
MA 80,v,88,v,152
ds_read_b128 v[128:131], v193 offset:40960
MA 88,v,88,v,156
MA 20,v,84,v,152
MA 28,v,84,v,156
MA 16,v,80,v,152
TR 152,198,49152
TR 154,198,51200
MA 24,v,80,v,156
TR 156,199,49152
TR 158,199,51200
MA 32,v,80,v,160
ds_read_b128 v[132:135], v193 offset:43008
buffer_load_dwordx4 v180, s[8:11], s20 offen offset:0 lds
MA 40,v,80,v,164
buffer_load_dwordx4 v[12:15], v64, s[76:79], 0 offen offset:1024
MA 36,v,84,v,160
MA 44,v,84,v,164
MA 96,v,88,v,160
buffer_load_dwordx4 v181, s[8:11], s20 offen offset:1024 lds
MA 104,v,88,v,164
buffer_load_dwordx4 v[242:245], v63, s[92:95], 0 offen offset:1536
MA 100,v,92,v,160
MA 108,v,92,v,164
ds_read_b128 v[136:139], v193 offset:45056
MA 160,v,96,v,160
MA 168,v,96,v,164
buffer_load_dwordx4 v182, s[8:11], s20 offen offset:2048 lds
MA 164,v,100,v,160
MA 172,v,100,v,164
buffer_load_dwordx4 v[246:249], v64, s[76:79], 0 offen offset:1536
MA 224,v,104,v,160
MA 232,v,104,v,164
ds_read_b128 v[140:143], v193 offset:47104
MA 228,v,108,v,160
TR 160,200,49152
TR 162,200,51200
MA 236,v,108,v,164
TR 164,201,49152
TR 166,201,51200
s_waitcnt lgkmcnt(15)
MA 244,v,108,v,168
buffer_load_dwordx4 v183, s[8:11], s20 offen offset:3072 lds
MA 252,v,108,v,172
buffer_load_dwordx4 v[54:57], v62, s[96:99], 0 offen offset:0
MA 240,v,104,v,168
MA 248,v,104,v,172
s_add_u32 s20, s20, 128
MA 180,v,100,v,168
MA 188,v,100,v,172
MA 176,v,96,v,168
MA 184,v,96,v,172
buffer_load_dwordx4 v[58:61], v62, s[96:99], 0 offen offset:16
MA 116,v,92,v,168
s_and_b32 s20, s20, 1023
MA 124,v,92,v,172
MA 112,v,88,v,168
MA 120,v,88,v,172
MA 52,v,84,v,168
MA 60,v,84,v,172
MA 48,v,80,v,168
TR 168,202,49152
TR 170,202,51200
MA 56,v,80,v,172
TR 172,203,49152
TR 174,203,51200
s_waitcnt lgkmcnt(4)
MA 0,v,112,v,144
MA 8,v,112,v,148
MA 4,v,116,v,144
MA 12,v,116,v,148
MA 64,v,120,v,144
MA 72,v,120,v,148
MA 68,v,124,v,144
MA 76,v,124,v,148
MA 128,v,128,v,144
MA 136,v,128,v,148
s_waitcnt vmcnt(18) lgkmcnt(0)
s_barrier
MA 132,v,132,v,144
s_add_u32 m0, s23, 32768
MA 140,v,132,v,148
ds_read_b128 v[80:83], v194 offset:0
MA 192,v,136,v,144
s_mov_b32 s4, s34
s_mov_b32 s5, s35
MA 200,v,136,v,148
MA 196,v,140,v,144
TR 144,196,0
TR 146,196,2048
MA 204,v,140,v,148
TR 148,197,0
TR 150,197,2048
MA 212,v,140,v,152
ds_read_b128 v[84:87], v194 offset:2048
buffer_load_dwordx4 v184, s[12:15], s21 offen offset:0 lds
MA 220,v,140,v,156
s_mov_b32 s6, 8388608
s_mov_b32 s7, 0x20000
MA 208,v,136,v,152
buffer_load_dwordx4 v185, s[12:15], s21 offen offset:1024 lds
MA 216,v,136,v,156
MA 148,v,132,v,152
MA 156,v,132,v,156
ds_read_b128 v[88:91], v194 offset:4096
MA 144,v,128,v,152
MA 152,v,128,v,156
buffer_load_dwordx4 v186, s[12:15], s21 offen offset:2048 lds
s_lshr_b32 s43, s2, 3
MA 84,v,124,v,152
MA 92,v,124,v,156
MA 80,v,120,v,152
ds_read_b128 v[92:95], v194 offset:6144
s_lshl_b32 s43, s43, 2
MA 88,v,120,v,156
buffer_load_dwordx4 v187, s[12:15], s21 offen offset:3072 lds
MA 20,v,116,v,152
MA 28,v,116,v,156
s_add_u32 s43, s43, s3
MA 16,v,112,v,152
TR 152,198,0
TR 154,198,2048
MA 24,v,112,v,156
TR 156,199,0
TR 158,199,2048
MA 32,v,112,v,160
ds_read_b128 v[96:99], v194 offset:8192
s_add_u32 m0, s23, 36864
MA 40,v,112,v,164
s_lshl_b32 s43, s43, 16
MA 36,v,116,v,160
MA 44,v,116,v,164
MA 96,v,120,v,160
ds_read_b128 v[100:103], v194 offset:10240
buffer_load_dwordx4 v188, s[12:15], s21 offen offset:0 lds
MA 104,v,120,v,164
s_and_b32 s37, s2, 7
MA 100,v,124,v,160
MA 108,v,124,v,164
s_lshl_b32 s37, s37, 10
MA 160,v,128,v,160
buffer_load_dwordx4 v189, s[12:15], s21 offen offset:1024 lds
MA 168,v,128,v,164
ds_read_b128 v[104:107], v194 offset:12288
MA 164,v,132,v,160
s_add_u32 s43, s43, s37
MA 172,v,132,v,164
MA 224,v,136,v,160
buffer_load_dwordx4 v190, s[12:15], s21 offen offset:2048 lds
MA 232,v,136,v,164
v_lshrrev_b32 v78, 3, v1
MA 228,v,140,v,160
TR 160,200,0
TR 162,200,2048
MA 236,v,140,v,164
TR 164,201,0
TR 166,201,2048
MA 244,v,140,v,168
ds_read_b128 v[108:111], v194 offset:14336
MA 252,v,140,v,172
buffer_load_dwordx4 v191, s[12:15], s21 offen offset:3072 lds
v_and_b32 v79, 7, v1
MA 240,v,136,v,168
MA 248,v,136,v,172
MA 180,v,132,v,168
v_lshlrev_b32 v79, 7, v79
MA 188,v,132,v,172
s_add_u32 s21, s21, 524288
MA 176,v,128,v,168
MA 184,v,128,v,172
v_lshl_add_u32 v78, v78, 13, v79
MA 116,v,124,v,168
MA 124,v,124,v,172
s_and_b32 s21, s21, 4194303
MA 112,v,120,v,168
v_add_u32 v78, s43, v78
MA 120,v,120,v,172
MA 52,v,116,v,168
MA 60,v,116,v,172
MA 48,v,112,v,168
TR 168,202,0
TR 170,202,2048
MA 56,v,112,v,172
TR 172,203,0
TR 174,203,2048
s_waitcnt lgkmcnt(4)
MA 0,v,80,v,144
s_add_u32 m0, s22, 32768
v_add_u32 v252, 0, v229
MA 8,v,80,v,148
ds_read_b128 v[112:115], v195 offset:0
MA 4,v,84,v,144
MA 12,v,84,v,148
MA 64,v,88,v,144
MA 72,v,88,v,148
buffer_load_dwordx4 v176, s[8:11], s20 offen offset:0 lds
MA 68,v,92,v,144
buffer_load_dwordx2 v[16:17], v252, s[84:87], 0 offen
MA 76,v,92,v,148
ds_read_b128 v[116:119], v195 offset:2048
MA 128,v,96,v,144
MA 136,v,96,v,148
MA 132,v,100,v,144
buffer_load_dwordx4 v177, s[8:11], s20 offen offset:1024 lds
MA 140,v,100,v,148
MA 192,v,104,v,144
v_add_u32 v253, 2048, v229
MA 200,v,104,v,148
ds_read_b128 v[120:123], v195 offset:4096
MA 196,v,108,v,144
TR 144,196,16384
TR 146,196,18432
MA 204,v,108,v,148
TR 148,197,16384
TR 150,197,18432
MA 212,v,108,v,152
buffer_load_dwordx4 v178, s[8:11], s20 offen offset:2048 lds
MA 220,v,108,v,156
MA 208,v,104,v,152
buffer_load_dwordx2 v[18:19], v253, s[84:87], 0 offen
MA 216,v,104,v,156
MA 148,v,100,v,152
ds_read_b128 v[124:127], v195 offset:6144
buffer_load_dwordx4 v179, s[8:11], s20 offen offset:3072 lds
MA 156,v,100,v,156
MA 144,v,96,v,152
MA 152,v,96,v,156
MA 84,v,92,v,152
v_add_u32 v254, 4096, v229
MA 92,v,92,v,156
s_add_u32 m0, s22, 36864
MA 80,v,88,v,152
ds_read_b128 v[128:131], v195 offset:8192
MA 88,v,88,v,156
MA 20,v,84,v,152
MA 28,v,84,v,156
MA 16,v,80,v,152
TR 152,198,16384
TR 154,198,18432
MA 24,v,80,v,156
TR 156,199,16384
TR 158,199,18432
MA 32,v,80,v,160
ds_read_b128 v[132:135], v195 offset:10240
buffer_load_dwordx4 v180, s[8:11], s20 offen offset:0 lds
MA 40,v,80,v,164
buffer_load_dwordx2 v[20:21], v254, s[84:87], 0 offen
MA 36,v,84,v,160
MA 44,v,84,v,164
MA 96,v,88,v,160
buffer_load_dwordx4 v181, s[8:11], s20 offen offset:1024 lds
MA 104,v,88,v,164
v_add_u32 v255, 6144, v229
MA 100,v,92,v,160
MA 108,v,92,v,164
ds_read_b128 v[136:139], v195 offset:12288
MA 160,v,96,v,160
MA 168,v,96,v,164
buffer_load_dwordx4 v182, s[8:11], s20 offen offset:2048 lds
MA 164,v,100,v,160
MA 172,v,100,v,164
buffer_load_dwordx2 v[22:23], v255, s[84:87], 0 offen
MA 224,v,104,v,160
MA 232,v,104,v,164
ds_read_b128 v[140:143], v195 offset:14336
MA 228,v,108,v,160
TR 160,200,16384
TR 162,200,18432
MA 236,v,108,v,164
TR 164,201,16384
TR 166,201,18432
s_waitcnt lgkmcnt(15)
MA 244,v,108,v,168
buffer_load_dwordx4 v183, s[8:11], s20 offen offset:3072 lds
MA 252,v,108,v,172
buffer_load_dwordx2 v[38:39], v255, s[88:91], 0 offen
MA 240,v,104,v,168
MA 248,v,104,v,172
s_add_u32 s20, s20, 128
MA 180,v,100,v,168
MA 188,v,100,v,172
MA 176,v,96,v,168
MA 184,v,96,v,172
v_add_u32 v252, 8192, v229
MA 116,v,92,v,168
s_and_b32 s20, s20, 1023
MA 124,v,92,v,172
MA 112,v,88,v,168
MA 120,v,88,v,172
MA 52,v,84,v,168
MA 60,v,84,v,172
MA 48,v,80,v,168
TR 168,202,16384
TR 170,202,18432
MA 56,v,80,v,172
TR 172,203,16384
TR 174,203,18432
s_waitcnt lgkmcnt(4)
MA 0,v,112,v,144
MA 8,v,112,v,148
MA 4,v,116,v,144
MA 12,v,116,v,148
MA 64,v,120,v,144
MA 72,v,120,v,148
MA 68,v,124,v,144
MA 76,v,124,v,148
MA 128,v,128,v,144
MA 136,v,128,v,148
s_waitcnt vmcnt(13) lgkmcnt(0)
s_barrier
MA 132,v,132,v,144
s_add_u32 m0, s23, 0
s_bfe_u32 s80, s2, 0x20001
MA 140,v,132,v,148
ds_read_b128 v[80:83], v192 offset:0
s_bfe_u32 s69, s2, 0x30003
MA 192,v,136,v,144
s_lshl_b32 s80, s80, 3
s_add_u32 s69, s69, s80
MA 200,v,136,v,148
s_lshr_b32 s80, s2, 6
MA 196,v,140,v,144
TR 144,196,32768
TR 146,196,34816
MA 204,v,140,v,148
TR 148,197,32768
TR 150,197,34816
MA 212,v,140,v,152
ds_read_b128 v[84:87], v192 offset:2048
buffer_load_dwordx4 v184, s[12:15], s21 offen offset:0 lds
MA 220,v,140,v,156
s_xor_b32 s81, s80, s2
s_and_b32 s81, s81, 1
MA 208,v,136,v,152
buffer_load_dwordx4 v185, s[12:15], s21 offen offset:1024 lds
s_lshl_b32 s70, s80, 1
MA 216,v,136,v,156
s_add_u32 s70, s70, s81
s_lshl_b32 s80, s3, 1
MA 148,v,132,v,152
s_sub_u32 s80, 7, s80
s_lshl_b32 s76, s80, 17
MA 156,v,132,v,156
ds_read_b128 v[88:91], v192 offset:4096
s_lshl_b32 s80, s3, 15
MA 144,v,128,v,152
s_lshl_b32 s65, s70, 18
s_sub_u32 s64, 3932160, s65
MA 152,v,128,v,156
buffer_load_dwordx4 v186, s[12:15], s21 offen offset:2048 lds
s_add_u32 s65, s65, s80
MA 84,v,124,v,152
s_add_u32 s64, s64, s80
MA 92,v,124,v,156
s_lshl_b32 s81, s69, 12
MA 80,v,120,v,152
ds_read_b128 v[92:95], v192 offset:6144
s_lshl_b32 s100, s64, 2
MA 88,v,120,v,156
buffer_load_dwordx4 v187, s[12:15], s21 offen offset:3072 lds
s_add_u32 s100, s100, s81
MA 20,v,116,v,152
s_lshl_b32 s101, s65, 2
MA 28,v,116,v,156
s_add_u32 s101, s101, s81
MA 16,v,112,v,152
TR 152,198,32768
TR 154,198,34816
MA 24,v,112,v,156
TR 156,199,32768
TR 158,199,34816
MA 32,v,112,v,160
ds_read_b128 v[96:99], v192 offset:8192
s_add_u32 m0, s23, 4096
MA 40,v,112,v,164
s_lshl_b32 s66, s3, 17
s_lshl_b32 s81, s69, 8
MA 36,v,116,v,160
s_add_u32 s66, s66, s81
s_and_b32 s74, s2, 7
MA 44,v,116,v,164
s_lshl_b32 s74, s74, 8
s_mov_b32 s82, s66
MA 96,v,120,v,160
ds_read_b128 v[100:103], v192 offset:10240
buffer_load_dwordx4 v188, s[12:15], s21 offen offset:0 lds
MA 104,v,120,v,164
s_lshl_b32 s66, s74, 12
s_lshl_b32 s67, s3, 13
MA 100,v,124,v,160
s_lshl_b32 s68, s3, 12
s_lshl_b32 s77, s70, 1
MA 108,v,124,v,164
s_sub_u32 s77, 32, s77
MA 160,v,128,v,160
buffer_load_dwordx4 v189, s[12:15], s21 offen offset:1024 lds
v_lshrrev_b32 v66, 3, v1
MA 168,v,128,v,164
ds_read_b128 v[104:107], v192 offset:12288
v_lshlrev_b32 v66, 11, v66
MA 164,v,132,v,160
v_lshrrev_b32 v67, 4, v1
v_and_b32 v68, 7, v1
MA 172,v,132,v,164
v_xor_b32 v68, v68, v67
MA 224,v,136,v,160
buffer_load_dwordx4 v190, s[12:15], s21 offen offset:2048 lds
v_lshl_add_u32 v66, v68, 4, v66
MA 232,v,136,v,164
v_xor_b32 v69, 64, v66
MA 228,v,140,v,160
TR 160,200,32768
TR 162,200,34816
MA 236,v,140,v,164
TR 164,201,32768
TR 166,201,34816
MA 244,v,140,v,168
ds_read_b128 v[108:111], v192 offset:14336
s_lshr_b32 s83, s76, 2
MA 252,v,140,v,172
buffer_load_dwordx4 v191, s[12:15], s21 offen offset:3072 lds
v_add_u32 v208, 0, v66
MA 240,v,136,v,168
v_add_u32 v209, 15360, v69
v_add_u32 v210, -2048, v66
MA 248,v,136,v,172
v_add_u32 v210, s83, v210
v_add_u32 v211, 13312, v69
MA 180,v,132,v,168
v_add_u32 v211, s83, v211
v_and_b32 v68, 15, v1
MA 188,v,132,v,172
s_add_u32 s21, s21, 524288
v_lshlrev_b32 v69, 1, v67
MA 176,v,128,v,168
v_xor_b32 v68, v68, v69
MA 184,v,128,v,172
v_lshlrev_b32 v66, 13, v67
MA 116,v,124,v,168
v_xor_b32 v69, 0, v68
MA 124,v,124,v,172
s_and_b32 s21, s21, 4194303
v_lshl_add_u32 v69, v69, 4, v66
MA 112,v,120,v,168
v_add_u32 v212, 0, v69
MA 120,v,120,v,172
v_xor_b32 v69, 0, v68
MA 52,v,116,v,168
v_lshl_add_u32 v69, v69, 4, v66
MA 60,v,116,v,172
v_add_u32 v213, 31744, v69
MA 48,v,112,v,168
TR 168,202,32768
TR 170,202,34816
MA 56,v,112,v,172
TR 172,203,32768
TR 174,203,34816
s_waitcnt lgkmcnt(4)
MA 0,v,80,v,144
s_add_u32 m0, s22, 65536
buffer_load_dwordx2 v[24:25], v252, s[84:87], 0 offen
MA 8,v,80,v,148
ds_read_b128 v[112:115], v193 offset:0
MA 4,v,84,v,144
MA 12,v,84,v,148
MA 64,v,88,v,144
MA 72,v,88,v,148
buffer_load_dwordx4 v176, s[8:11], s20 offen offset:0 lds
MA 68,v,92,v,144
buffer_load_dwordx2 v[40:41], v252, s[88:91], 0 offen
MA 76,v,92,v,148
ds_read_b128 v[116:119], v193 offset:2048
MA 128,v,96,v,144
MA 136,v,96,v,148
MA 132,v,100,v,144
buffer_load_dwordx4 v177, s[8:11], s20 offen offset:1024 lds
MA 140,v,100,v,148
MA 192,v,104,v,144
v_add_u32 v253, 10240, v229
MA 200,v,104,v,148
ds_read_b128 v[120:123], v193 offset:4096
MA 196,v,108,v,144
TR 144,196,49152
TR 146,196,51200
MA 204,v,108,v,148
TR 148,197,49152
TR 150,197,51200
MA 212,v,108,v,152
buffer_load_dwordx4 v178, s[8:11], s20 offen offset:2048 lds
MA 220,v,108,v,156
MA 208,v,104,v,152
buffer_load_dwordx2 v[26:27], v253, s[84:87], 0 offen
MA 216,v,104,v,156
MA 148,v,100,v,152
ds_read_b128 v[124:127], v193 offset:6144
buffer_load_dwordx4 v179, s[8:11], s20 offen offset:3072 lds
MA 156,v,100,v,156
MA 144,v,96,v,152
MA 152,v,96,v,156
MA 84,v,92,v,152
buffer_load_dwordx2 v[42:43], v253, s[88:91], 0 offen
MA 92,v,92,v,156
s_add_u32 m0, s22, 69632
MA 80,v,88,v,152
ds_read_b128 v[128:131], v193 offset:8192
MA 88,v,88,v,156
MA 20,v,84,v,152
MA 28,v,84,v,156
MA 16,v,80,v,152
TR 152,198,49152
TR 154,198,51200
MA 24,v,80,v,156
TR 156,199,49152
TR 158,199,51200
MA 32,v,80,v,160
ds_read_b128 v[132:135], v193 offset:10240
buffer_load_dwordx4 v180, s[8:11], s20 offen offset:0 lds
MA 40,v,80,v,164
v_add_u32 v254, 12288, v229
MA 36,v,84,v,160
MA 44,v,84,v,164
MA 96,v,88,v,160
buffer_load_dwordx4 v181, s[8:11], s20 offen offset:1024 lds
MA 104,v,88,v,164
buffer_load_dwordx2 v[28:29], v254, s[84:87], 0 offen
MA 100,v,92,v,160
MA 108,v,92,v,164
ds_read_b128 v[136:139], v193 offset:12288
MA 160,v,96,v,160
MA 168,v,96,v,164
buffer_load_dwordx4 v182, s[8:11], s20 offen offset:2048 lds
MA 164,v,100,v,160
MA 172,v,100,v,164
buffer_load_dwordx2 v[44:45], v254, s[88:91], 0 offen
MA 224,v,104,v,160
MA 232,v,104,v,164
ds_read_b128 v[140:143], v193 offset:14336
MA 228,v,108,v,160
TR 160,200,49152
TR 162,200,51200
MA 236,v,108,v,164
TR 164,201,49152
TR 166,201,51200
s_waitcnt lgkmcnt(15)
MA 244,v,108,v,168
buffer_load_dwordx4 v183, s[8:11], s20 offen offset:3072 lds
MA 252,v,108,v,172
v_add_u32 v255, 14336, v229
MA 240,v,104,v,168
MA 248,v,104,v,172
s_add_u32 s20, s20, 128
MA 180,v,100,v,168
MA 188,v,100,v,172
MA 176,v,96,v,168
MA 184,v,96,v,172
buffer_load_dwordx2 v[30:31], v255, s[84:87], 0 offen
MA 116,v,92,v,168
s_and_b32 s20, s20, 1023
MA 124,v,92,v,172
MA 112,v,88,v,168
MA 120,v,88,v,172
MA 52,v,84,v,168
MA 60,v,84,v,172
MA 48,v,80,v,168
TR 168,202,49152
TR 170,202,51200
MA 56,v,80,v,172
TR 172,203,49152
TR 174,203,51200
s_waitcnt lgkmcnt(4)
MA 0,v,112,v,144
MA 8,v,112,v,148
MA 4,v,116,v,144
MA 12,v,116,v,148
MA 64,v,120,v,144
MA 72,v,120,v,148
MA 68,v,124,v,144
MA 76,v,124,v,148
MA 128,v,128,v,144
MA 136,v,128,v,148
s_waitcnt vmcnt(15) lgkmcnt(0)
s_barrier
MA 132,v,132,v,144
s_add_u32 m0, s23, 32768
v_xor_b32 v69, 8, v68
MA 140,v,132,v,148
ds_read_b128 v[80:83], v192 offset:32768
v_lshl_add_u32 v69, v69, 4, v66
MA 192,v,136,v,144
v_add_u32 v214, 63488, v69
v_xor_b32 v69, 8, v68
MA 200,v,136,v,148
v_lshl_add_u32 v69, v69, 4, v66
MA 196,v,140,v,144
TR 144,196,0
TR 146,196,2048
MA 204,v,140,v,148
TR 148,197,0
TR 150,197,2048
MA 212,v,140,v,152
ds_read_b128 v[84:87], v192 offset:34816
buffer_load_dwordx4 v184, s[12:15], s21 offen offset:0 lds
MA 220,v,140,v,156
v_add_u32 v215, 95232, v69
v_and_b32 v66, 15, v1
MA 208,v,136,v,152
buffer_load_dwordx4 v185, s[12:15], s21 offen offset:1024 lds
v_lshrrev_b32 v68, 1, v66
MA 216,v,136,v,156
v_xor_b32 v68, v68, v67
v_lshlrev_b32 v68, 4, v68
MA 148,v,132,v,152
v_lshl_add_u32 v68, v66, 7, v68
v_add_u32 v224, s67, v68
MA 156,v,132,v,156
ds_read_b128 v[88:91], v192 offset:36864
v_xor_b32 v225, 64, v224
MA 144,v,128,v,152
v_add_u32 v226, 0x10000, v224
v_add_u32 v227, 0x10000, v225
MA 152,v,128,v,156
buffer_load_dwordx4 v186, s[12:15], s21 offen offset:2048 lds
v_bfe_u32 v66, v1, 2, 2
MA 84,v,124,v,152
v_and_b32 v68, 1, v67
v_lshl_or_b32 v68, v68, 2, v66
MA 92,v,124,v,156
v_lshl_add_u32 v66, v67, 3, v66
v_lshlrev_b32 v66, 8, v66
MA 80,v,120,v,152
ds_read_b128 v[92:95], v192 offset:38912
v_and_b32 v69, 3, v1
MA 88,v,120,v,156
buffer_load_dwordx4 v187, s[12:15], s21 offen offset:3072 lds
v_lshl_add_u32 v66, v69, 3, v66
MA 20,v,116,v,152
v_add_u32 v66, 98304, v66
MA 28,v,116,v,156
v_xor_b32 v69, 0, v68
MA 16,v,112,v,152
TR 152,198,0
TR 154,198,2048
MA 24,v,112,v,156
TR 156,199,0
TR 158,199,2048
MA 32,v,112,v,160
ds_read_b128 v[96:99], v192 offset:40960
s_add_u32 m0, s23, 36864
MA 40,v,112,v,164
v_lshl_add_u32 v216, v69, 5, v66
v_xor_b32 v69, 1, v68
MA 36,v,116,v,160
v_lshl_add_u32 v217, v69, 5, v66
v_xor_b32 v69, 2, v68
MA 44,v,116,v,164
v_lshl_add_u32 v218, v69, 5, v66
v_xor_b32 v69, 3, v68
MA 96,v,120,v,160
ds_read_b128 v[100:103], v192 offset:43008
buffer_load_dwordx4 v188, s[12:15], s21 offen offset:0 lds
MA 104,v,120,v,164
v_lshl_add_u32 v219, v69, 5, v66
v_xor_b32 v69, 4, v68
MA 100,v,124,v,160
v_lshl_add_u32 v220, v69, 5, v66
v_xor_b32 v69, 5, v68
MA 108,v,124,v,164
v_lshl_add_u32 v221, v69, 5, v66
v_xor_b32 v69, 6, v68
MA 160,v,128,v,160
buffer_load_dwordx4 v189, s[12:15], s21 offen offset:1024 lds
v_lshl_add_u32 v222, v69, 5, v66
MA 168,v,128,v,164
ds_read_b128 v[104:107], v192 offset:45056
v_xor_b32 v69, 7, v68
MA 164,v,132,v,160
v_lshl_add_u32 v223, v69, 5, v66
s_mov_b32 s44, s32
MA 172,v,132,v,164
s_mov_b32 s45, s33
MA 224,v,136,v,160
buffer_load_dwordx4 v190, s[12:15], s21 offen offset:2048 lds
s_mov_b32 s46, 4194304
MA 232,v,136,v,164
s_mov_b32 s47, 0x20000
MA 228,v,140,v,160
TR 160,200,0
TR 162,200,2048
MA 236,v,140,v,164
TR 164,201,0
TR 166,201,2048
MA 244,v,140,v,168
ds_read_b128 v[108:111], v192 offset:47104
MA 252,v,140,v,172
buffer_load_dwordx4 v191, s[12:15], s21 offen offset:3072 lds
MA 240,v,136,v,168
s_add_u32 s48, s34, s82
s_addc_u32 s49, s35, 0
MA 248,v,136,v,172
s_sub_u32 s50, 8388608, s82
s_mov_b32 s51, 0x20000
MA 180,v,132,v,168
s_add_u32 s60, s40, 33554432
s_addc_u32 s61, s41, 0
MA 188,v,132,v,172
s_add_u32 s21, s21, 524288
s_mov_b32 s62, 16777216
MA 176,v,128,v,168
s_mov_b32 s63, 0x20000
s_lshl_b32 s80, s69, 19
MA 184,v,128,v,172
s_add_u32 s52, s40, s80
s_addc_u32 s53, s41, 0
MA 116,v,124,v,168
s_lshl_b32 s54, s77, 14
s_mov_b32 s55, 0x20000
MA 124,v,124,v,172
s_and_b32 s21, s21, 4194303
s_add_u32 s80, s80, 16760832
MA 112,v,120,v,168
s_add_u32 s56, s40, s80
s_addc_u32 s57, s41, 0
MA 120,v,120,v,172
s_add_u32 s58, s54, 16384
MA 52,v,116,v,168
s_mov_b32 s59, 0x20000
MA 60,v,116,v,172
s_load_dwordx2 s[38:39], s[0:1], 112
MA 48,v,112,v,168
TR 168,202,0
TR 170,202,2048
MA 56,v,112,v,172
TR 172,203,0
TR 174,203,2048
s_waitcnt lgkmcnt(4)
MA 0,v,80,v,144
s_add_u32 m0, s22, 0
buffer_load_dwordx2 v[46:47], v255, s[88:91], 0 offen
MA 8,v,80,v,148
ds_read_b128 v[112:115], v193 offset:32768
MA 4,v,84,v,144
MA 12,v,84,v,148
MA 64,v,88,v,144
MA 72,v,88,v,148
buffer_load_dwordx4 v176, s[8:11], s20 offen offset:0 lds
MA 68,v,92,v,144
v_add_u32 v252, 16384, v229
MA 76,v,92,v,148
ds_read_b128 v[116:119], v193 offset:34816
MA 128,v,96,v,144
MA 136,v,96,v,148
MA 132,v,100,v,144
buffer_load_dwordx4 v177, s[8:11], s20 offen offset:1024 lds
MA 140,v,100,v,148
MA 192,v,104,v,144
buffer_load_dwordx2 v[32:33], v252, s[84:87], 0 offen
MA 200,v,104,v,148
ds_read_b128 v[120:123], v193 offset:36864
MA 196,v,108,v,144
TR 144,196,16384
TR 146,196,18432
MA 204,v,108,v,148
TR 148,197,16384
TR 150,197,18432
MA 212,v,108,v,152
buffer_load_dwordx4 v178, s[8:11], s20 offen offset:2048 lds
MA 220,v,108,v,156
MA 208,v,104,v,152
buffer_load_dwordx2 v[48:49], v252, s[88:91], 0 offen
MA 216,v,104,v,156
MA 148,v,100,v,152
ds_read_b128 v[124:127], v193 offset:38912
buffer_load_dwordx4 v179, s[8:11], s20 offen offset:3072 lds
MA 156,v,100,v,156
MA 144,v,96,v,152
MA 152,v,96,v,156
MA 84,v,92,v,152
v_add_u32 v253, 18432, v229
MA 92,v,92,v,156
s_add_u32 m0, s22, 4096
MA 80,v,88,v,152
ds_read_b128 v[128:131], v193 offset:40960
MA 88,v,88,v,156
MA 20,v,84,v,152
MA 28,v,84,v,156
MA 16,v,80,v,152
TR 152,198,16384
TR 154,198,18432
MA 24,v,80,v,156
TR 156,199,16384
TR 158,199,18432
MA 32,v,80,v,160
ds_read_b128 v[132:135], v193 offset:43008
buffer_load_dwordx4 v180, s[8:11], s20 offen offset:0 lds
MA 40,v,80,v,164
buffer_load_dwordx2 v[34:35], v253, s[84:87], 0 offen
MA 36,v,84,v,160
MA 44,v,84,v,164
MA 96,v,88,v,160
buffer_load_dwordx4 v181, s[8:11], s20 offen offset:1024 lds
MA 104,v,88,v,164
buffer_load_dwordx2 v[50:51], v253, s[88:91], 0 offen
MA 100,v,92,v,160
MA 108,v,92,v,164
ds_read_b128 v[136:139], v193 offset:45056
MA 160,v,96,v,160
MA 168,v,96,v,164
buffer_load_dwordx4 v182, s[8:11], s20 offen offset:2048 lds
MA 164,v,100,v,160
MA 172,v,100,v,164
v_add_u32 v254, 20480, v229
MA 224,v,104,v,160
MA 232,v,104,v,164
ds_read_b128 v[140:143], v193 offset:47104
MA 228,v,108,v,160
TR 160,200,16384
TR 162,200,18432
MA 236,v,108,v,164
TR 164,201,16384
TR 166,201,18432
s_waitcnt lgkmcnt(15)
MA 244,v,108,v,168
buffer_load_dwordx4 v183, s[8:11], s20 offen offset:3072 lds
MA 252,v,108,v,172
buffer_load_dwordx2 v[36:37], v254, s[84:87], 0 offen
MA 240,v,104,v,168
MA 248,v,104,v,172
s_add_u32 s20, s20, 128
MA 180,v,100,v,168
MA 188,v,100,v,172
MA 176,v,96,v,168
MA 184,v,96,v,172
buffer_load_dwordx2 v[52:53], v254, s[88:91], 0 offen
MA 116,v,92,v,168
s_and_b32 s20, s20, 1023
MA 124,v,92,v,172
MA 112,v,88,v,168
MA 120,v,88,v,172
MA 52,v,84,v,168
MA 60,v,84,v,172
MA 48,v,80,v,168
TR 168,202,16384
TR 170,202,18432
MA 56,v,80,v,172
TR 172,203,16384
TR 174,203,18432
s_waitcnt lgkmcnt(4)
MA 0,v,112,v,144
MA 8,v,112,v,148
MA 4,v,116,v,144
MA 12,v,116,v,148
MA 64,v,120,v,144
MA 72,v,120,v,148
MA 68,v,124,v,144
MA 76,v,124,v,148
MA 128,v,128,v,144
MA 136,v,128,v,148
s_waitcnt vmcnt(15) lgkmcnt(0)
s_barrier
MA 132,v,132,v,144
s_add_u32 m0, s23, 0
s_and_b32 s37, s3, 3
MA 140,v,132,v,148
ds_read_b128 v[80:83], v194 offset:0
MA 192,v,136,v,144
s_cmp_eq_u32 s37, 0
s_cselect_b32 s37, 0, 0x40000000
MA 200,v,136,v,148
v_add_u32 v229, s37, v78
buffer_load_dword v79, v229, s[4:7], 0 offen
MA 196,v,140,v,144
TR 144,196,32768
TR 146,196,34816
MA 204,v,140,v,148
TR 148,197,32768
TR 150,197,34816
MA 212,v,140,v,152
ds_read_b128 v[84:87], v194 offset:2048
buffer_load_dwordx4 v184, s[12:15], s21 offen offset:0 lds
MA 220,v,140,v,156
s_add_u32 s84, s40, 50331648
s_addc_u32 s85, s41, 0
MA 208,v,136,v,152
buffer_load_dwordx4 v185, s[12:15], s21 offen offset:1024 lds
s_mov_b32 s86, 4194304
MA 216,v,136,v,156
s_mov_b32 s87, 0x20000
MA 148,v,132,v,152
s_add_u32 s88, s40, 58720256
s_addc_u32 s89, s41, 0
MA 156,v,132,v,156
ds_read_b128 v[88:91], v194 offset:4096
s_mov_b32 s90, 8192
MA 144,v,128,v,152
s_mov_b32 s91, 0x20000
v_mov_b32 v252, 0
MA 152,v,128,v,156
buffer_load_dwordx4 v186, s[12:15], s21 offen offset:2048 lds
v_mov_b32 v253, 0
MA 84,v,124,v,152
v_dot2_f32_bf16 v252, v230, v2, v252
v_dot2_f32_bf16 v253, v231, v3, v253
v_dot2_f32_bf16 v252, v232, v4, v252
v_dot2_f32_bf16 v253, v233, v5, v253
v_dot2_f32_bf16 v252, v234, v6, v252
v_dot2_f32_bf16 v253, v235, v7, v253
v_dot2_f32_bf16 v252, v236, v8, v252
v_dot2_f32_bf16 v253, v237, v9, v253
v_dot2_f32_bf16 v252, v238, v12, v252
v_dot2_f32_bf16 v253, v239, v13, v253
v_dot2_f32_bf16 v252, v240, v14, v252
v_dot2_f32_bf16 v253, v241, v15, v253
v_dot2_f32_bf16 v252, v242, v246, v252
v_dot2_f32_bf16 v253, v243, v247, v253
v_dot2_f32_bf16 v252, v244, v248, v252
v_dot2_f32_bf16 v253, v245, v249, v253
MA 92,v,124,v,156
MA 80,v,120,v,152
ds_read_b128 v[92:95], v194 offset:6144
MA 88,v,120,v,156
buffer_load_dwordx4 v187, s[12:15], s21 offen offset:3072 lds
MA 20,v,116,v,152
MA 28,v,116,v,156
MA 16,v,112,v,152
TR 152,198,32768
TR 154,198,34816
MA 24,v,112,v,156
TR 156,199,32768
TR 158,199,34816
MA 32,v,112,v,160
ds_read_b128 v[96:99], v194 offset:8192
s_add_u32 m0, s23, 4096
MA 40,v,112,v,164
s_nop 2
v_add_f32 v252, v252, v253
MA 36,v,116,v,160
MA 44,v,116,v,164
MA 96,v,120,v,160
ds_read_b128 v[100:103], v194 offset:10240
buffer_load_dwordx4 v188, s[12:15], s21 offen offset:0 lds
MA 104,v,120,v,164
v_add_f32_dpp v252, v252, v252 row_ror:8 row_mask:0xf bank_mask:0xf
s_nop 1
v_add_f32_dpp v252, v252, v252 row_ror:4 row_mask:0xf bank_mask:0xf
MA 100,v,124,v,160
s_nop 0
v_add_f32_dpp v252, v252, v252 row_ror:2 row_mask:0xf bank_mask:0xf
MA 108,v,124,v,164
s_nop 0
v_add_f32_dpp v252, v252, v252 row_ror:1 row_mask:0xf bank_mask:0xf
v_mov_b32 v253, v252
MA 160,v,128,v,160
buffer_load_dwordx4 v189, s[12:15], s21 offen offset:1024 lds
v_permlane16_swap_b32 v252, v253
MA 168,v,128,v,164
ds_read_b128 v[104:107], v194 offset:12288
v_add_f32 v252, v252, v253
MA 164,v,132,v,160
v_mul_f32 v252, 0xbfb8aa3b, v252
MA 172,v,132,v,164
v_exp_f32 v252, v252
MA 224,v,136,v,160
buffer_load_dwordx4 v190, s[12:15], s21 offen offset:2048 lds
v_add_f32 v252, 1.0, v252
MA 232,v,136,v,164
v_rcp_f32 v252, v252
MA 228,v,140,v,160
TR 160,200,32768
TR 162,200,34816
MA 236,v,140,v,164
TR 164,201,32768
TR 166,201,34816
MA 244,v,140,v,168
ds_read_b128 v[108:111], v194 offset:14336
MA 252,v,140,v,172
buffer_load_dwordx4 v191, s[12:15], s21 offen offset:3072 lds
MA 240,v,136,v,168
s_nop 0
buffer_store_dword v252, v11, s[88:91], 0 offen sc1
MA 248,v,136,v,172
s_getpc_b64 s[82:83]
L_ct_fV:
MA 180,v,132,v,168
s_add_u32 s82, s82, L_p2 - L_ct_fV
s_addc_u32 s83, s83, 0
MA 188,v,132,v,172
s_add_u32 s21, s21, 524288
v_mov_b32 v67, s83
MA 176,v,128,v,168
v_mov_b32 v66, s82
s_lshr_b32 s82, s2, 3
MA 184,v,128,v,172
s_lshl_b32 s82, s82, 2
s_add_u32 s82, s82, s3
MA 116,v,124,v,168
s_lshl_b32 s82, s82, 7
v_and_b32 v68, 3, v1
MA 124,v,124,v,172
s_and_b32 s21, s21, 4194303
v_lshlrev_b32 v68, 14, v68
MA 112,v,120,v,168
v_add_u32 v68, s82, v68
v_min_u32 v68, L_p3_begin - L_p2 - 4, v68
MA 120,v,120,v,172
v_add_co_u32 v66, vcc, v66, v68
s_nop 1
v_addc_co_u32 v67, vcc, 0, v67, vcc
MA 52,v,116,v,168
MA 60,v,116,v,172
global_load_dword v68, v[66:67], off
MA 48,v,112,v,168
TR 168,202,32768
TR 170,202,34816
MA 56,v,112,v,172
TR 172,203,32768
TR 174,203,34816
s_waitcnt lgkmcnt(4)
MA 0,v,80,v,144
s_add_u32 m0, s22, 32768
s_and_b32 s37, s3, 3
MA 8,v,80,v,148
ds_read_b128 v[112:115], v195 offset:0
MA 4,v,84,v,144
MA 12,v,84,v,148
MA 64,v,88,v,144
MA 72,v,88,v,148
buffer_load_dwordx4 v176, s[8:11], s20 offen offset:0 lds
MA 68,v,92,v,144
MA 76,v,92,v,148
ds_read_b128 v[116:119], v195 offset:2048
MA 128,v,96,v,144
MA 136,v,96,v,148
MA 132,v,100,v,144
buffer_load_dwordx4 v177, s[8:11], s20 offen offset:1024 lds
MA 140,v,100,v,148
MA 192,v,104,v,144
s_cmp_eq_u32 s37, 1
s_cselect_b32 s37, 0, 0x40000000
MA 200,v,104,v,148
ds_read_b128 v[120:123], v195 offset:4096
MA 196,v,108,v,144
TR 144,196,49152
TR 146,196,51200
MA 204,v,108,v,148
TR 148,197,49152
TR 150,197,51200
MA 212,v,108,v,152
buffer_load_dwordx4 v178, s[8:11], s20 offen offset:2048 lds
MA 220,v,108,v,156
MA 208,v,104,v,152
MA 216,v,104,v,156
MA 148,v,100,v,152
ds_read_b128 v[124:127], v195 offset:6144
buffer_load_dwordx4 v179, s[8:11], s20 offen offset:3072 lds
MA 156,v,100,v,156
MA 144,v,96,v,152
MA 152,v,96,v,156
MA 84,v,92,v,152
MA 92,v,92,v,156
s_add_u32 m0, s22, 36864
MA 80,v,88,v,152
ds_read_b128 v[128:131], v195 offset:8192
MA 88,v,88,v,156
MA 20,v,84,v,152
MA 28,v,84,v,156
MA 16,v,80,v,152
TR 152,198,49152
TR 154,198,51200
MA 24,v,80,v,156
TR 156,199,49152
TR 158,199,51200
MA 32,v,80,v,160
ds_read_b128 v[132:135], v195 offset:10240
buffer_load_dwordx4 v180, s[8:11], s20 offen offset:0 lds
MA 40,v,80,v,164
MA 36,v,84,v,160
MA 44,v,84,v,164
MA 96,v,88,v,160
buffer_load_dwordx4 v181, s[8:11], s20 offen offset:1024 lds
MA 104,v,88,v,164
v_add_u32 v229, s37, v78
MA 100,v,92,v,160
MA 108,v,92,v,164
ds_read_b128 v[136:139], v195 offset:12288
MA 160,v,96,v,160
MA 168,v,96,v,164
buffer_load_dwordx4 v182, s[8:11], s20 offen offset:2048 lds
MA 164,v,100,v,160
MA 172,v,100,v,164
MA 224,v,104,v,160
MA 232,v,104,v,164
ds_read_b128 v[140:143], v195 offset:14336
MA 228,v,108,v,160
TR 160,200,49152
TR 162,200,51200
MA 236,v,108,v,164
TR 164,201,49152
TR 166,201,51200
s_waitcnt lgkmcnt(15)
MA 244,v,108,v,168
buffer_load_dwordx4 v183, s[8:11], s20 offen offset:3072 lds
MA 252,v,108,v,172
buffer_load_dword v79, v229, s[4:7], 0 offen
MA 240,v,104,v,168
MA 248,v,104,v,172
s_add_u32 s20, s20, 128
MA 180,v,100,v,168
MA 188,v,100,v,172
MA 176,v,96,v,168
MA 184,v,96,v,172
MA 116,v,92,v,168
s_and_b32 s20, s20, 1023
MA 124,v,92,v,172
MA 112,v,88,v,168
MA 120,v,88,v,172
MA 52,v,84,v,168
MA 60,v,84,v,172
MA 48,v,80,v,168
TR 168,202,49152
TR 170,202,51200
MA 56,v,80,v,172
TR 172,203,49152
TR 174,203,51200
s_waitcnt lgkmcnt(4)
MA 0,v,112,v,144
MA 8,v,112,v,148
MA 4,v,116,v,144
MA 12,v,116,v,148
MA 64,v,120,v,144
MA 72,v,120,v,148
MA 68,v,124,v,144
MA 76,v,124,v,148
MA 128,v,128,v,144
MA 136,v,128,v,148
s_waitcnt vmcnt(11) lgkmcnt(0)
s_barrier
MA 132,v,132,v,144
s_add_u32 m0, s23, 32768
s_and_b32 s37, s3, 3
MA 140,v,132,v,148
ds_read_b128 v[80:83], v192 offset:0
MA 192,v,136,v,144
s_cmp_eq_u32 s37, 2
s_cselect_b32 s37, 0, 0x40000000
MA 200,v,136,v,148
v_add_u32 v229, s37, v78
buffer_load_dword v79, v229, s[4:7], 0 offen
MA 196,v,140,v,144
TR 144,196,0
TR 146,196,2048
MA 204,v,140,v,148
TR 148,197,0
TR 150,197,2048
MA 212,v,140,v,152
ds_read_b128 v[84:87], v192 offset:2048
buffer_load_dwordx4 v184, s[12:15], s21 offen offset:0 lds
MA 220,v,140,v,156
v_lshlrev_b32 v2, 16, v54
v_and_b32 v3, 0xffff0000, v54
MA 208,v,136,v,152
buffer_load_dwordx4 v185, s[12:15], s21 offen offset:1024 lds
v_lshlrev_b32 v4, 16, v55
MA 216,v,136,v,156
v_and_b32 v5, 0xffff0000, v55
v_lshlrev_b32 v6, 16, v56
MA 148,v,132,v,152
v_and_b32 v7, 0xffff0000, v56
v_lshlrev_b32 v8, 16, v57
MA 156,v,132,v,156
ds_read_b128 v[88:91], v192 offset:4096
v_and_b32 v9, 0xffff0000, v57
MA 144,v,128,v,152
v_lshlrev_b32 v230, 16, v16
v_and_b32 v231, 0xffff0000, v16
MA 152,v,128,v,156
buffer_load_dwordx4 v186, s[12:15], s21 offen offset:2048 lds
v_lshlrev_b32 v232, 16, v18
MA 84,v,124,v,152
v_and_b32 v233, 0xffff0000, v18
v_lshlrev_b32 v234, 16, v20
MA 92,v,124,v,156
v_and_b32 v235, 0xffff0000, v20
v_lshlrev_b32 v236, 16, v22
MA 80,v,120,v,152
ds_read_b128 v[92:95], v192 offset:6144
v_and_b32 v237, 0xffff0000, v22
MA 88,v,120,v,156
buffer_load_dwordx4 v187, s[12:15], s21 offen offset:3072 lds
v_lshlrev_b32 v238, 16, v24
MA 20,v,116,v,152
v_and_b32 v239, 0xffff0000, v24
v_lshlrev_b32 v240, 16, v26
MA 28,v,116,v,156
v_and_b32 v241, 0xffff0000, v26
v_lshlrev_b32 v242, 16, v28
MA 16,v,112,v,152
TR 152,198,0
TR 154,198,2048
MA 24,v,112,v,156
TR 156,199,0
TR 158,199,2048
MA 32,v,112,v,160
ds_read_b128 v[96:99], v192 offset:8192
s_add_u32 m0, s23, 36864
MA 40,v,112,v,164
v_and_b32 v243, 0xffff0000, v28
v_lshlrev_b32 v244, 16, v30
MA 36,v,116,v,160
v_and_b32 v245, 0xffff0000, v30
v_lshlrev_b32 v246, 16, v32
MA 44,v,116,v,164
v_and_b32 v247, 0xffff0000, v32
v_lshlrev_b32 v248, 16, v34
MA 96,v,120,v,160
ds_read_b128 v[100:103], v192 offset:10240
buffer_load_dwordx4 v188, s[12:15], s21 offen offset:0 lds
MA 104,v,120,v,164
v_and_b32 v249, 0xffff0000, v34
v_lshlrev_b32 v250, 16, v36
MA 100,v,124,v,160
v_and_b32 v251, 0xffff0000, v36
v_lshlrev_b32 v254, 16, v38
MA 108,v,124,v,164
v_and_b32 v255, 0xffff0000, v38
v_mul_f32 v62, v236, v2
MA 160,v,128,v,160
buffer_load_dwordx4 v189, s[12:15], s21 offen offset:1024 lds
v_mul_f32 v70, v237, v6
MA 168,v,128,v,164
ds_read_b128 v[104:107], v192 offset:12288
v_fmac_f32 v62, v234, v3
MA 164,v,132,v,160
v_fmac_f32 v70, v235, v7
v_fmac_f32 v62, v232, v4
MA 172,v,132,v,164
v_fmac_f32 v70, v233, v8
v_fmac_f32 v62, v230, v5
MA 224,v,136,v,160
buffer_load_dwordx4 v190, s[12:15], s21 offen offset:2048 lds
v_fmac_f32 v70, v231, v9
MA 232,v,136,v,164
v_mul_f32 v62, v62, v254
v_mul_f32 v70, v70, v255
MA 228,v,140,v,160
TR 160,200,0
TR 162,200,2048
MA 236,v,140,v,164
TR 164,201,0
TR 166,201,2048
MA 244,v,140,v,168
ds_read_b128 v[108:111], v192 offset:14336
v_lshlrev_b32 v254, 16, v40
MA 252,v,140,v,172
buffer_load_dwordx4 v191, s[12:15], s21 offen offset:3072 lds
v_and_b32 v255, 0xffff0000, v40
MA 240,v,136,v,168
v_mul_f32 v63, v238, v2
v_mul_f32 v71, v239, v6
MA 248,v,136,v,172
v_fmac_f32 v63, v236, v3
v_fmac_f32 v71, v237, v7
MA 180,v,132,v,168
v_fmac_f32 v63, v234, v4
v_fmac_f32 v71, v235, v8
MA 188,v,132,v,172
s_add_u32 s21, s21, 524288
v_fmac_f32 v63, v232, v5
MA 176,v,128,v,168
v_fmac_f32 v71, v233, v9
v_mul_f32 v63, v63, v254
MA 184,v,128,v,172
v_mul_f32 v71, v71, v255
v_lshlrev_b32 v254, 16, v42
MA 116,v,124,v,168
v_and_b32 v255, 0xffff0000, v42
v_mul_f32 v64, v240, v2
MA 124,v,124,v,172
s_and_b32 s21, s21, 4194303
v_mul_f32 v72, v241, v6
MA 112,v,120,v,168
v_fmac_f32 v64, v238, v3
v_fmac_f32 v72, v239, v7
MA 120,v,120,v,172
v_fmac_f32 v64, v236, v4
v_fmac_f32 v72, v237, v8
MA 52,v,116,v,168
v_fmac_f32 v64, v234, v5
v_fmac_f32 v72, v235, v9
MA 60,v,116,v,172
v_mul_f32 v64, v64, v254
v_mul_f32 v72, v72, v255
MA 48,v,112,v,168
TR 168,202,0
TR 170,202,2048
MA 56,v,112,v,172
TR 172,203,0
TR 174,203,2048
v_lshlrev_b32 v254, 16, v44
v_and_b32 v255, 0xffff0000, v44
v_mul_f32 v65, v242, v2
s_waitcnt lgkmcnt(4)
MA 0,v,80,v,144
s_add_u32 s75, s64, s74
s_and_b32 s37, s3, 3
MA 8,v,80,v,148
ds_read_b128 v[112:115], v193 offset:0
MA 4,v,84,v,144
s_cmp_eq_u32 s37, 3
s_cselect_b32 s37, 0, 0x40000000
MA 12,v,84,v,148
v_add_u32 v229, s37, v78
buffer_load_dword v79, v229, s[4:7], 0 offen
MA 64,v,88,v,144
s_add_u32 m0, s67, 65536
v_mul_f32 v73, v243, v6
MA 72,v,88,v,148
v_fmac_f32 v65, v240, v3
v_fmac_f32 v73, v241, v7
MA 68,v,92,v,144
v_fmac_f32 v65, v238, v4
MA 76,v,92,v,148
ds_read_b128 v[116:119], v193 offset:2048
v_fmac_f32 v73, v239, v8
MA 128,v,96,v,144
buffer_load_dwordx4 v208, s[44:47], s75 offen offset:0 lds
v_fmac_f32 v65, v236, v5
MA 136,v,96,v,148
v_fmac_f32 v73, v237, v9
MA 132,v,100,v,144
v_mul_f32 v65, v65, v254
v_mul_f32 v73, v73, v255
MA 140,v,100,v,148
v_lshlrev_b32 v254, 16, v46
MA 192,v,104,v,144
v_and_b32 v255, 0xffff0000, v46
MA 200,v,104,v,148
ds_read_b128 v[120:123], v193 offset:4096
buffer_load_dwordx4 v209, s[44:47], s75 offen offset:1024 lds
MA 196,v,108,v,144
TR 144,196,16384
TR 146,196,18432
MA 204,v,108,v,148
TR 148,197,16384
TR 150,197,18432
MA 212,v,108,v,152
v_mul_f32 v66, v244, v2
v_mul_f32 v74, v245, v6
MA 220,v,108,v,156
buffer_load_dwordx4 v210, s[44:47], s75 offen offset:2048 lds
v_fmac_f32 v66, v242, v3
MA 208,v,104,v,152
v_fmac_f32 v74, v243, v7
v_fmac_f32 v66, v240, v4
MA 216,v,104,v,156
v_fmac_f32 v74, v241, v8
v_fmac_f32 v66, v238, v5
MA 148,v,100,v,152
ds_read_b128 v[124:127], v193 offset:6144
v_fmac_f32 v74, v239, v9
MA 156,v,100,v,156
v_mul_f32 v66, v66, v254
v_mul_f32 v74, v74, v255
MA 144,v,96,v,152
buffer_load_dwordx4 v211, s[44:47], s75 offen offset:3072 lds
v_lshlrev_b32 v254, 16, v48
MA 152,v,96,v,156
v_and_b32 v255, 0xffff0000, v48
v_mul_f32 v67, v246, v2
MA 84,v,92,v,152
v_mul_f32 v75, v247, v6
MA 92,v,92,v,156
v_fmac_f32 v67, v244, v3
v_fmac_f32 v75, v245, v7
MA 80,v,88,v,152
ds_read_b128 v[128:131], v193 offset:8192
s_add_u32 s75, s65, s74
MA 88,v,88,v,156
v_fmac_f32 v67, v242, v4
v_fmac_f32 v75, v243, v8
MA 20,v,84,v,152
v_fmac_f32 v67, v240, v5
MA 28,v,84,v,156
v_fmac_f32 v75, v241, v9
MA 16,v,80,v,152
TR 152,198,16384
TR 154,198,18432
MA 24,v,80,v,156
TR 156,199,16384
TR 158,199,18432
MA 32,v,80,v,160
ds_read_b128 v[132:135], v193 offset:10240
s_add_u32 m0, s67, 69632
MA 40,v,80,v,164
v_mul_f32 v67, v67, v254
v_mul_f32 v75, v75, v255
MA 36,v,84,v,160
v_lshlrev_b32 v254, 16, v50
v_and_b32 v255, 0xffff0000, v50
MA 44,v,84,v,164
buffer_load_dwordx4 v208, s[44:47], s75 offen offset:0 lds
s_waitcnt vmcnt(24)
v_mul_f32 v68, v248, v2
MA 96,v,88,v,160
v_mul_f32 v76, v249, v6
v_fmac_f32 v68, v246, v3
MA 104,v,88,v,164
v_fmac_f32 v76, v247, v7
v_fmac_f32 v68, v244, v4
MA 100,v,92,v,160
v_fmac_f32 v76, v245, v8
v_fmac_f32 v68, v242, v5
MA 108,v,92,v,164
ds_read_b128 v[136:139], v193 offset:12288
buffer_load_dwordx4 v209, s[44:47], s75 offen offset:1024 lds
MA 160,v,96,v,160
v_fmac_f32 v76, v243, v9
v_mul_f32 v68, v68, v254
MA 168,v,96,v,164
v_mul_f32 v76, v76, v255
v_lshlrev_b32 v254, 16, v52
MA 164,v,100,v,160
v_and_b32 v255, 0xffff0000, v52
MA 172,v,100,v,164
v_mul_f32 v69, v250, v2
MA 224,v,104,v,160
buffer_load_dwordx4 v210, s[44:47], s75 offen offset:2048 lds
v_mul_f32 v77, v251, v6
MA 232,v,104,v,164
ds_read_b128 v[140:143], v193 offset:14336
v_fmac_f32 v69, v248, v3
MA 228,v,108,v,160
TR 160,200,16384
TR 162,200,18432
MA 236,v,108,v,164
TR 164,201,16384
TR 166,201,18432
s_waitcnt lgkmcnt(15)
MA 244,v,108,v,168
buffer_load_dwordx4 v211, s[44:47], s75 offen offset:3072 lds
v_fmac_f32 v77, v249, v7
MA 252,v,108,v,172
v_fmac_f32 v69, v246, v4
v_fmac_f32 v77, v247, v8
MA 240,v,104,v,168
v_fmac_f32 v69, v244, v5
v_fmac_f32 v77, v245, v9
MA 248,v,104,v,172
v_mul_f32 v69, v69, v254
v_mul_f32 v77, v77, v255
MA 180,v,100,v,168
v_cvt_pk_bf16_f32 v12, v69, v68
v_cvt_pk_bf16_f32 v13, v67, v66
MA 188,v,100,v,172
s_add_u32 s74, s74, 128
v_cvt_pk_bf16_f32 v14, v65, v64
MA 176,v,96,v,168
v_cvt_pk_bf16_f32 v15, v63, v62
MA 184,v,96,v,172
s_mov_b32 s36, 0
MA 116,v,92,v,168
buffer_store_dwordx4 v[12:15], v10, s[84:87], s36 offen sc1
v_cvt_pk_bf16_f32 v54, v77, v76
MA 124,v,92,v,172
s_and_b32 s74, s74, 2047
v_cvt_pk_bf16_f32 v55, v75, v74
MA 112,v,88,v,168
v_cvt_pk_bf16_f32 v56, v73, v72
MA 120,v,88,v,172
v_cvt_pk_bf16_f32 v57, v71, v70
MA 52,v,84,v,168
s_mov_b32 s36, 4096
MA 60,v,84,v,172
buffer_store_dwordx4 v[54:57], v10, s[84:87], s36 offen sc1
MA 48,v,80,v,168
TR 168,202,16384
TR 170,202,18432
MA 56,v,80,v,172
TR 172,203,16384
TR 174,203,18432
s_waitcnt lgkmcnt(4)
MA 0,v,112,v,144
MA 8,v,112,v,148
MA 4,v,116,v,144
MA 12,v,116,v,148
MA 64,v,120,v,144
MA 72,v,120,v,148
MA 68,v,124,v,144
MA 76,v,124,v,148
MA 128,v,128,v,144
MA 136,v,128,v,148
s_waitcnt vmcnt(11) lgkmcnt(0)
s_barrier
MA 132,v,132,v,144
s_add_u32 m0, s68, 98304
v_lshlrev_b32 v2, 16, v58
MA 140,v,132,v,148
ds_read_b128 v[80:83], v192 offset:32768
v_and_b32 v3, 0xffff0000, v58
MA 192,v,136,v,144
v_lshlrev_b32 v4, 16, v59
v_and_b32 v5, 0xffff0000, v59
MA 200,v,136,v,148
buffer_load_dwordx4 v212, s[48:51], s66 offen offset:0 lds
v_lshlrev_b32 v6, 16, v60
MA 196,v,140,v,144
TR 144,196,32768
TR 146,196,34816
MA 204,v,140,v,148
TR 148,197,32768
TR 150,197,34816
MA 212,v,140,v,152
ds_read_b128 v[84:87], v192 offset:34816
v_and_b32 v7, 0xffff0000, v60
MA 220,v,140,v,156
buffer_load_dwordx4 v213, s[48:51], s66 offen offset:1024 lds
v_lshlrev_b32 v8, 16, v61
MA 208,v,136,v,152
v_and_b32 v9, 0xffff0000, v61
v_lshlrev_b32 v230, 16, v17
MA 216,v,136,v,156
v_and_b32 v231, 0xffff0000, v17
v_lshlrev_b32 v232, 16, v19
MA 148,v,132,v,152
v_and_b32 v233, 0xffff0000, v19
v_lshlrev_b32 v234, 16, v21
MA 156,v,132,v,156
ds_read_b128 v[88:91], v192 offset:36864
buffer_load_dwordx4 v214, s[48:51], s66 offen offset:2048 lds
MA 144,v,128,v,152
v_and_b32 v235, 0xffff0000, v21
v_lshlrev_b32 v236, 16, v23
MA 152,v,128,v,156
v_and_b32 v237, 0xffff0000, v23
v_lshlrev_b32 v238, 16, v25
MA 84,v,124,v,152
buffer_load_dwordx4 v215, s[48:51], s66 offen offset:3072 lds
v_and_b32 v239, 0xffff0000, v25
MA 92,v,124,v,156
v_lshlrev_b32 v240, 16, v27
v_and_b32 v241, 0xffff0000, v27
MA 80,v,120,v,152
ds_read_b128 v[92:95], v192 offset:38912
v_lshlrev_b32 v242, 16, v29
MA 88,v,120,v,156
v_and_b32 v243, 0xffff0000, v29
v_lshlrev_b32 v244, 16, v31
MA 20,v,116,v,152
s_add_u32 s66, s66, 524288
v_and_b32 v245, 0xffff0000, v31
MA 28,v,116,v,156
v_lshlrev_b32 v246, 16, v33
v_and_b32 v247, 0xffff0000, v33
MA 16,v,112,v,152
TR 152,198,32768
TR 154,198,34816
MA 24,v,112,v,156
TR 156,199,32768
TR 158,199,34816
MA 32,v,112,v,160
ds_read_b128 v[96:99], v192 offset:40960
s_and_b32 s66, s66, 8388607
MA 40,v,112,v,164
v_lshlrev_b32 v248, 16, v35
v_and_b32 v249, 0xffff0000, v35
MA 36,v,116,v,160
v_lshlrev_b32 v250, 16, v37
v_and_b32 v251, 0xffff0000, v37
MA 44,v,116,v,164
v_lshlrev_b32 v254, 16, v39
v_and_b32 v255, 0xffff0000, v39
MA 96,v,120,v,160
ds_read_b128 v[100:103], v192 offset:43008
s_add_u32 m0, s68, 114688
MA 104,v,120,v,164
v_mul_f32 v62, v236, v2
v_mul_f32 v70, v237, v6
MA 100,v,124,v,160
v_fmac_f32 v62, v234, v3
v_fmac_f32 v70, v235, v7
MA 108,v,124,v,164
buffer_load_dwordx4 v212, s[48:51], s66 offen offset:0 lds
v_fmac_f32 v62, v232, v4
MA 160,v,128,v,160
v_fmac_f32 v70, v233, v8
v_fmac_f32 v62, v230, v5
MA 168,v,128,v,164
ds_read_b128 v[104:107], v192 offset:45056
v_fmac_f32 v70, v231, v9
MA 164,v,132,v,160
v_mul_f32 v62, v62, v254
v_mul_f32 v70, v70, v255
MA 172,v,132,v,164
buffer_load_dwordx4 v213, s[48:51], s66 offen offset:1024 lds
v_lshlrev_b32 v254, 16, v41
MA 224,v,136,v,160
v_and_b32 v255, 0xffff0000, v41
v_mul_f32 v63, v238, v2
MA 232,v,136,v,164
v_mul_f32 v71, v239, v6
v_fmac_f32 v63, v236, v3
MA 228,v,140,v,160
TR 160,200,32768
TR 162,200,34816
MA 236,v,140,v,164
TR 164,201,32768
TR 166,201,34816
MA 244,v,140,v,168
ds_read_b128 v[108:111], v192 offset:47104
buffer_load_dwordx4 v214, s[48:51], s66 offen offset:2048 lds
MA 252,v,140,v,172
v_fmac_f32 v71, v237, v7
v_fmac_f32 v63, v234, v4
MA 240,v,136,v,168
buffer_load_dwordx4 v215, s[48:51], s66 offen offset:3072 lds
v_fmac_f32 v71, v235, v8
MA 248,v,136,v,172
v_fmac_f32 v63, v232, v5
v_fmac_f32 v71, v233, v9
MA 180,v,132,v,168
v_mul_f32 v63, v63, v254
v_mul_f32 v71, v71, v255
MA 188,v,132,v,172
v_lshlrev_b32 v254, 16, v43
v_and_b32 v255, 0xffff0000, v43
MA 176,v,128,v,168
s_add_u32 s66, s66, 524288
v_mul_f32 v64, v240, v2
MA 184,v,128,v,172
v_mul_f32 v72, v241, v6
v_fmac_f32 v64, v238, v3
MA 116,v,124,v,168
v_fmac_f32 v72, v239, v7
v_fmac_f32 v64, v236, v4
MA 124,v,124,v,172
v_fmac_f32 v72, v237, v8
v_fmac_f32 v64, v234, v5
MA 112,v,120,v,168
s_and_b32 s66, s66, 8388607
v_fmac_f32 v72, v235, v9
MA 120,v,120,v,172
v_mul_f32 v64, v64, v254
v_mul_f32 v72, v72, v255
MA 52,v,116,v,168
v_lshlrev_b32 v254, 16, v45
v_and_b32 v255, 0xffff0000, v45
MA 60,v,116,v,172
v_mul_f32 v65, v242, v2
MA 48,v,112,v,168
TR 168,202,32768
TR 170,202,34816
MA 56,v,112,v,172
TR 172,203,32768
TR 174,203,34816
s_waitcnt lgkmcnt(4)
MA 0,v,80,v,144
s_add_u32 s75, s64, s74
v_mul_f32 v73, v243, v6
MA 8,v,80,v,148
ds_read_b128 v[112:115], v193 offset:32768
v_fmac_f32 v65, v240, v3
MA 4,v,84,v,144
v_fmac_f32 v73, v241, v7
v_fmac_f32 v65, v238, v4
MA 12,v,84,v,148
v_fmac_f32 v73, v239, v8
MA 64,v,88,v,144
s_add_u32 m0, s67, 0
v_fmac_f32 v65, v236, v5
MA 72,v,88,v,148
v_fmac_f32 v73, v237, v9
MA 68,v,92,v,144
v_mul_f32 v65, v65, v254
MA 76,v,92,v,148
ds_read_b128 v[116:119], v193 offset:34816
v_mul_f32 v73, v73, v255
MA 128,v,96,v,144
buffer_load_dwordx4 v208, s[44:47], s75 offen offset:0 lds
v_lshlrev_b32 v254, 16, v47
MA 136,v,96,v,148
v_and_b32 v255, 0xffff0000, v47
v_mul_f32 v66, v244, v2
MA 132,v,100,v,144
v_mul_f32 v74, v245, v6
MA 140,v,100,v,148
v_fmac_f32 v66, v242, v3
MA 192,v,104,v,144
v_fmac_f32 v74, v243, v7
MA 200,v,104,v,148
ds_read_b128 v[120:123], v193 offset:36864
buffer_load_dwordx4 v209, s[44:47], s75 offen offset:1024 lds
MA 196,v,108,v,144
TR 144,196,49152
TR 146,196,51200
MA 204,v,108,v,148
TR 148,197,49152
TR 150,197,51200
MA 212,v,108,v,152
v_fmac_f32 v66, v240, v4
v_fmac_f32 v74, v241, v8
MA 220,v,108,v,156
buffer_load_dwordx4 v210, s[44:47], s75 offen offset:2048 lds
v_fmac_f32 v66, v238, v5
MA 208,v,104,v,152
v_fmac_f32 v74, v239, v9
v_mul_f32 v66, v66, v254
MA 216,v,104,v,156
v_mul_f32 v74, v74, v255
v_lshlrev_b32 v254, 16, v49
MA 148,v,100,v,152
ds_read_b128 v[124:127], v193 offset:38912
v_and_b32 v255, 0xffff0000, v49
MA 156,v,100,v,156
v_mul_f32 v67, v246, v2
v_mul_f32 v75, v247, v6
MA 144,v,96,v,152
buffer_load_dwordx4 v211, s[44:47], s75 offen offset:3072 lds
v_fmac_f32 v67, v244, v3
MA 152,v,96,v,156
v_fmac_f32 v75, v245, v7
v_fmac_f32 v67, v242, v4
MA 84,v,92,v,152
v_fmac_f32 v75, v243, v8
MA 92,v,92,v,156
v_fmac_f32 v67, v240, v5
MA 80,v,88,v,152
ds_read_b128 v[128:131], v193 offset:40960
s_add_u32 s75, s65, s74
MA 88,v,88,v,156
v_fmac_f32 v75, v241, v9
v_mul_f32 v67, v67, v254
MA 20,v,84,v,152
v_mul_f32 v75, v75, v255
MA 28,v,84,v,156
v_lshlrev_b32 v254, 16, v51
MA 16,v,80,v,152
TR 152,198,49152
TR 154,198,51200
MA 24,v,80,v,156
TR 156,199,49152
TR 158,199,51200
MA 32,v,80,v,160
ds_read_b128 v[132:135], v193 offset:43008
s_add_u32 m0, s67, 4096
MA 40,v,80,v,164
v_and_b32 v255, 0xffff0000, v51
v_mul_f32 v68, v248, v2
MA 36,v,84,v,160
v_mul_f32 v76, v249, v6
v_fmac_f32 v68, v246, v3
MA 44,v,84,v,164
buffer_load_dwordx4 v208, s[44:47], s75 offen offset:0 lds
v_fmac_f32 v76, v247, v7
MA 96,v,88,v,160
v_fmac_f32 v68, v244, v4
v_fmac_f32 v76, v245, v8
MA 104,v,88,v,164
v_fmac_f32 v68, v242, v5
v_fmac_f32 v76, v243, v9
MA 100,v,92,v,160
v_mul_f32 v68, v68, v254
v_mul_f32 v76, v76, v255
MA 108,v,92,v,164
ds_read_b128 v[136:139], v193 offset:45056
buffer_load_dwordx4 v209, s[44:47], s75 offen offset:1024 lds
MA 160,v,96,v,160
v_lshlrev_b32 v254, 16, v53
v_and_b32 v255, 0xffff0000, v53
MA 168,v,96,v,164
v_mul_f32 v69, v250, v2
MA 164,v,100,v,160
v_mul_f32 v77, v251, v6
MA 172,v,100,v,164
v_fmac_f32 v69, v248, v3
MA 224,v,104,v,160
buffer_load_dwordx4 v210, s[44:47], s75 offen offset:2048 lds
v_fmac_f32 v77, v249, v7
MA 232,v,104,v,164
ds_read_b128 v[140:143], v193 offset:47104
v_fmac_f32 v69, v246, v4
MA 228,v,108,v,160
TR 160,200,49152
TR 162,200,51200
MA 236,v,108,v,164
TR 164,201,49152
TR 166,201,51200
s_waitcnt lgkmcnt(15)
MA 244,v,108,v,168
buffer_load_dwordx4 v211, s[44:47], s75 offen offset:3072 lds
v_fmac_f32 v77, v247, v8
MA 252,v,108,v,172
v_fmac_f32 v69, v244, v5
v_fmac_f32 v77, v245, v9
MA 240,v,104,v,168
v_mul_f32 v69, v69, v254
v_mul_f32 v77, v77, v255
MA 248,v,104,v,172
v_cvt_pk_bf16_f32 v230, v69, v68
v_cvt_pk_bf16_f32 v231, v67, v66
MA 180,v,100,v,168
v_cvt_pk_bf16_f32 v232, v65, v64
MA 188,v,100,v,172
s_add_u32 s74, s74, 128
v_cvt_pk_bf16_f32 v233, v63, v62
MA 176,v,96,v,168
s_mov_b32 s36, 8192
buffer_store_dwordx4 v[230:233], v10, s[84:87], s36 offen sc1
MA 184,v,96,v,172
v_cvt_pk_bf16_f32 v234, v77, v76
MA 116,v,92,v,168
v_cvt_pk_bf16_f32 v235, v75, v74
MA 124,v,92,v,172
s_and_b32 s74, s74, 2047
v_cvt_pk_bf16_f32 v236, v73, v72
MA 112,v,88,v,168
v_cvt_pk_bf16_f32 v237, v71, v70
MA 120,v,88,v,172
s_mov_b32 s36, 12288
MA 52,v,84,v,168
buffer_store_dwordx4 v[234:237], v10, s[84:87], s36 offen sc1
MA 60,v,84,v,172
v_lshlrev_b32 v228, 4, v1
MA 48,v,80,v,168
TR 168,202,49152
TR 170,202,51200
MA 56,v,80,v,172
TR 172,203,49152
TR 174,203,51200
s_waitcnt lgkmcnt(4)
MA 0,v,112,v,144
MA 8,v,112,v,148
MA 4,v,116,v,144
MA 12,v,116,v,148
MA 64,v,120,v,144
MA 72,v,120,v,148
MA 68,v,124,v,144
MA 76,v,124,v,148
MA 128,v,128,v,144
MA 136,v,128,v,148
s_waitcnt vmcnt(14) lgkmcnt(0)
s_barrier
MA 132,v,132,v,144
ds_read_b128 v[48:51], v226 offset:0
s_add_u32 m0, s68, 131072
MA 140,v,132,v,148
MA 192,v,136,v,144
ds_read_b128 v[52:55], v226 offset:2048
buffer_load_dwordx4 v212, s[48:51], s66 offen offset:0 lds
MA 200,v,136,v,148
MA 196,v,140,v,144
ds_read_b128 v[56:59], v226 offset:4096
buffer_load_dwordx4 v213, s[48:51], s66 offen offset:1024 lds
MA 204,v,140,v,148
MA 212,v,140,v,152
ds_read_b128 v[60:63], v226 offset:6144
MA 220,v,140,v,156
buffer_load_dwordx4 v214, s[48:51], s66 offen offset:2048 lds
MA 208,v,136,v,152
TR 16,216,0
MA 216,v,136,v,156
buffer_load_dwordx4 v215, s[48:51], s66 offen offset:3072 lds
MA 148,v,132,v,152
TR 18,216,1024
MA 156,v,132,v,156
MA 144,v,128,v,152
TR 20,217,0
s_add_u32 s66, s66, 524288
MA 152,v,128,v,156
MA 84,v,124,v,152
TR 22,217,1024
s_and_b32 s66, s66, 8388607
MA 92,v,124,v,156
MA 80,v,120,v,152
TR 24,218,0
MA 88,v,120,v,156
s_add_u32 s75, s64, s74
MA 20,v,116,v,152
TR 26,218,1024
MA 28,v,116,v,156
s_add_u32 m0, s67, 32768
MA 16,v,112,v,152
TR 28,219,0
MA 24,v,112,v,156
MA 32,v,112,v,160
TR 30,219,1024
buffer_load_dwordx4 v208, s[44:47], s75 offen offset:0 lds
MA 40,v,112,v,164
MA 36,v,116,v,160
TR 32,220,0
buffer_load_dwordx4 v209, s[44:47], s75 offen offset:1024 lds
MA 44,v,116,v,164
MA 96,v,120,v,160
TR 34,220,1024
MA 104,v,120,v,164
buffer_load_dwordx4 v210, s[44:47], s75 offen offset:2048 lds
MA 100,v,124,v,160
TR 36,221,0
MA 108,v,124,v,164
buffer_load_dwordx4 v211, s[44:47], s75 offen offset:3072 lds
MA 160,v,128,v,160
TR 38,221,1024
MA 168,v,128,v,164
MA 164,v,132,v,160
TR 40,222,0
s_add_u32 s75, s65, s74
MA 172,v,132,v,164
MA 224,v,136,v,160
TR 42,222,1024
s_add_u32 m0, s67, 36864
MA 232,v,136,v,164
MA 228,v,140,v,160
TR 44,223,0
MA 236,v,140,v,164
buffer_load_dwordx4 v208, s[44:47], s75 offen offset:0 lds
MA 244,v,140,v,168
TR 46,223,1024
MA 252,v,140,v,172
buffer_load_dwordx4 v209, s[44:47], s75 offen offset:1024 lds
MA 240,v,136,v,168
MA 248,v,136,v,172
MA 180,v,132,v,168
buffer_load_dwordx4 v210, s[44:47], s75 offen offset:2048 lds
MA 188,v,132,v,172
MA 176,v,128,v,168
buffer_load_dwordx4 v211, s[44:47], s75 offen offset:3072 lds
MA 184,v,128,v,172
MA 116,v,124,v,168
MA 124,v,124,v,172
s_add_u32 s74, s74, 128
MA 112,v,120,v,168
MA 120,v,120,v,172
s_and_b32 s74, s74, 2047
MA 52,v,116,v,168
MA 60,v,116,v,172
MA 48,v,112,v,168
MA 56,v,112,v,172
L_p2:
s_waitcnt lgkmcnt(4)
v_mfma_f32_16x16x32_bf16 v[80:83], v[16:19], v[48:51], 0
s_add_u32 s8, s40, 59768832
s_addc_u32 s9, s41, 0
v_mfma_f32_16x16x32_bf16 v[96:99], v[20:23], v[48:51], 0
ds_read_b128 v[64:67], v227 offset:0
v_mfma_f32_16x16x32_bf16 v[84:87], v[16:19], v[52:55], 0
s_mov_b32 s10, 8192
v_mfma_f32_16x16x32_bf16 v[100:103], v[20:23], v[52:55], 0
s_mov_b32 s11, 0x20000
v_mfma_f32_16x16x32_bf16 v[88:91], v[16:19], v[56:59], 0
s_mov_b32 s12, s38
v_mfma_f32_16x16x32_bf16 v[104:107], v[20:23], v[56:59], 0
s_mov_b32 s13, s39
v_mfma_f32_16x16x32_bf16 v[92:95], v[16:19], v[60:63], 0
TR 16,216,8192
TR 18,216,9216
v_mfma_f32_16x16x32_bf16 v[108:111], v[20:23], v[60:63], 0
TR 20,217,8192
TR 22,217,9216
v_mfma_f32_16x16x32_bf16 v[124:127], v[24:27], v[60:63], 0
ds_read_b128 v[68:71], v227 offset:2048
s_mov_b32 s14, 256
v_mfma_f32_16x16x32_bf16 v[140:143], v[28:31], v[60:63], 0
s_mov_b32 s15, 0x20000
v_accvgpr_read_b32 v234, a0
v_mfma_f32_16x16x32_bf16 v[120:123], v[24:27], v[56:59], 0
v_accvgpr_read_b32 v235, a1
v_accvgpr_read_b32 v236, a2
v_mfma_f32_16x16x32_bf16 v[136:139], v[28:31], v[56:59], 0
v_accvgpr_read_b32 v237, a3
v_mfma_f32_16x16x32_bf16 v[116:119], v[24:27], v[52:55], 0
ds_read_b128 v[72:75], v227 offset:4096
v_accvgpr_read_b32 v238, a4
v_mfma_f32_16x16x32_bf16 v[132:135], v[28:31], v[52:55], 0
v_accvgpr_read_b32 v239, a5
v_mfma_f32_16x16x32_bf16 v[112:115], v[24:27], v[48:51], 0
TR 24,218,8192
TR 26,218,9216
v_mfma_f32_16x16x32_bf16 v[128:131], v[28:31], v[48:51], 0
TR 28,219,8192
TR 30,219,9216
v_mfma_f32_16x16x32_bf16 v[144:147], v[32:35], v[48:51], 0
v_accvgpr_read_b32 v240, a6
v_accvgpr_read_b32 v241, a7
v_mfma_f32_16x16x32_bf16 v[160:163], v[36:39], v[48:51], 0
v_cvt_pk_bf16_f32 v230, v234, v235
v_cvt_pk_bf16_f32 v231, v236, v237
v_mfma_f32_16x16x32_bf16 v[148:151], v[32:35], v[52:55], 0
ds_read_b128 v[76:79], v227 offset:6144
v_cvt_pk_bf16_f32 v232, v238, v239
v_mfma_f32_16x16x32_bf16 v[164:167], v[36:39], v[52:55], 0
v_cvt_pk_bf16_f32 v233, v240, v241
v_mfma_f32_16x16x32_bf16 v[152:155], v[32:35], v[56:59], 0
buffer_store_dwordx4 v[230:233], v228, s[16:19], s24 offen offset:0 sc1
v_mfma_f32_16x16x32_bf16 v[168:171], v[36:39], v[56:59], 0
v_accvgpr_read_b32 v246, a8
v_mfma_f32_16x16x32_bf16 v[156:159], v[32:35], v[60:63], 0
TR 32,220,8192
TR 34,220,9216
v_mfma_f32_16x16x32_bf16 v[172:175], v[36:39], v[60:63], 0
TR 36,221,8192
TR 38,221,9216
s_waitcnt lgkmcnt(15)
v_mfma_f32_16x16x32_bf16 v[188:191], v[40:43], v[60:63], 0
v_accvgpr_read_b32 v247, a9
v_accvgpr_read_b32 v248, a10
v_mfma_f32_16x16x32_bf16 v[204:207], v[44:47], v[60:63], 0
v_accvgpr_read_b32 v249, a11
v_accvgpr_read_b32 v250, a12
v_mfma_f32_16x16x32_bf16 v[184:187], v[40:43], v[56:59], 0
v_accvgpr_read_b32 v251, a13
v_mfma_f32_16x16x32_bf16 v[200:203], v[44:47], v[56:59], 0
v_accvgpr_read_b32 v252, a14
v_mfma_f32_16x16x32_bf16 v[180:183], v[40:43], v[52:55], 0
v_accvgpr_read_b32 v253, a15
v_mfma_f32_16x16x32_bf16 v[196:199], v[44:47], v[52:55], 0
v_mfma_f32_16x16x32_bf16 v[176:179], v[40:43], v[48:51], 0
TR 40,222,8192
TR 42,222,9216
v_mfma_f32_16x16x32_bf16 v[192:195], v[44:47], v[48:51], 0
TR 44,223,8192
TR 46,223,9216
s_waitcnt lgkmcnt(4)
MV 80,v,16,v,64
v_cvt_pk_bf16_f32 v242, v246, v247
MV 96,v,20,v,64
v_cvt_pk_bf16_f32 v243, v248, v249
MV 84,v,16,v,68
v_cvt_pk_bf16_f32 v244, v250, v251
MV 100,v,20,v,68
MV 88,v,16,v,72
v_cvt_pk_bf16_f32 v245, v252, v253
MV 104,v,20,v,72
buffer_store_dwordx4 v[242:245], v228, s[16:19], s24 offen offset:1024 sc1
MV 92,v,16,v,76
MV 108,v,20,v,76
s_waitcnt vmcnt(16) lgkmcnt(0)
s_barrier
MV 124,v,24,v,76
TR 16,216,16384
TR 18,216,17408
MV 140,v,28,v,76
ds_read_b128 v[48:51], v224 offset:0
s_add_u32 m0, s68, 98304
MV 120,v,24,v,72
TR 20,217,16384
TR 22,217,17408
MV 136,v,28,v,72
buffer_load_dwordx4 v212, s[48:51], s66 offen offset:0 lds
v_accvgpr_read_b32 v234, a16
MV 116,v,24,v,68
ds_read_b128 v[52:55], v224 offset:2048
buffer_load_dwordx4 v213, s[48:51], s66 offen offset:1024 lds
MV 132,v,28,v,68
v_accvgpr_read_b32 v235, a17
v_accvgpr_read_b32 v236, a18
MV 112,v,24,v,64
TR 24,218,16384
TR 26,218,17408
MV 128,v,28,v,64
TR 28,219,16384
TR 30,219,17408
MV 144,v,32,v,64
ds_read_b128 v[56:59], v224 offset:4096
buffer_load_dwordx4 v214, s[48:51], s66 offen offset:2048 lds
MV 160,v,36,v,64
buffer_load_dwordx4 v215, s[48:51], s66 offen offset:3072 lds
v_accvgpr_read_b32 v237, a19
MV 148,v,32,v,68
v_accvgpr_read_b32 v238, a20
v_accvgpr_read_b32 v239, a21
MV 164,v,36,v,68
s_add_u32 s66, s66, 524288
v_accvgpr_read_b32 v240, a22
MV 152,v,32,v,72
ds_read_b128 v[60:63], v224 offset:6144
v_accvgpr_read_b32 v241, a23
MV 168,v,36,v,72
s_and_b32 s66, s66, 8388607
v_cvt_pk_bf16_f32 v230, v234, v235
MV 156,v,32,v,76
TR 32,220,16384
TR 34,220,17408
MV 172,v,36,v,76
TR 36,221,16384
TR 38,221,17408
MV 188,v,40,v,76
s_add_u32 s75, s64, s74
v_cvt_pk_bf16_f32 v231, v236, v237
MV 204,v,44,v,76
v_cvt_pk_bf16_f32 v232, v238, v239
v_cvt_pk_bf16_f32 v233, v240, v241
MV 184,v,40,v,72
s_add_u32 m0, s67, 65536
buffer_store_dwordx4 v[230:233], v228, s[16:19], s24 offen offset:2048 sc1
MV 200,v,44,v,72
v_accvgpr_read_b32 v246, a24
v_accvgpr_read_b32 v247, a25
MV 180,v,40,v,68
buffer_load_dwordx4 v208, s[44:47], s75 offen offset:0 lds
v_accvgpr_read_b32 v248, a26
MV 196,v,44,v,68
MV 176,v,40,v,64
TR 40,222,16384
TR 42,222,17408
MV 192,v,44,v,64
TR 44,223,16384
TR 46,223,17408
s_waitcnt lgkmcnt(4)
MV 80,v,16,v,48
buffer_load_dwordx4 v209, s[44:47], s75 offen offset:1024 lds
v_accvgpr_read_b32 v249, a27
MV 96,v,20,v,48
ds_read_b128 v[64:67], v225 offset:0
v_accvgpr_read_b32 v250, a28
MV 84,v,16,v,52
buffer_load_dwordx4 v210, s[44:47], s75 offen offset:2048 lds
v_accvgpr_read_b32 v251, a29
MV 100,v,20,v,52
MV 88,v,16,v,56
v_accvgpr_read_b32 v252, a30
MV 104,v,20,v,56
buffer_load_dwordx4 v211, s[44:47], s75 offen offset:3072 lds
v_accvgpr_read_b32 v253, a31
MV 92,v,16,v,60
TR 16,216,24576
TR 18,216,25600
MV 108,v,20,v,60
TR 20,217,24576
TR 22,217,25600
MV 124,v,24,v,60
ds_read_b128 v[68:71], v225 offset:2048
s_add_u32 s75, s65, s74
MV 140,v,28,v,60
v_cvt_pk_bf16_f32 v242, v246, v247
v_cvt_pk_bf16_f32 v243, v248, v249
MV 120,v,24,v,56
v_cvt_pk_bf16_f32 v244, v250, v251
MV 136,v,28,v,56
s_add_u32 m0, s67, 69632
v_cvt_pk_bf16_f32 v245, v252, v253
MV 116,v,24,v,52
ds_read_b128 v[72:75], v225 offset:4096
buffer_store_dwordx4 v[242:245], v228, s[16:19], s24 offen offset:3072 sc1
MV 132,v,28,v,52
MV 112,v,24,v,48
TR 24,218,24576
TR 26,218,25600
MV 128,v,28,v,48
TR 28,219,24576
TR 30,219,25600
MV 144,v,32,v,48
buffer_load_dwordx4 v208, s[44:47], s75 offen offset:0 lds
buffer_load_dwordx4 v209, s[44:47], s75 offen offset:1024 lds
MV 160,v,36,v,48
v_accvgpr_read_b32 v234, a32
v_accvgpr_read_b32 v235, a33
MV 148,v,32,v,52
ds_read_b128 v[76:79], v225 offset:6144
v_accvgpr_read_b32 v236, a34
MV 164,v,36,v,52
buffer_load_dwordx4 v210, s[44:47], s75 offen offset:2048 lds
v_accvgpr_read_b32 v237, a35
MV 152,v,32,v,56
v_accvgpr_read_b32 v238, a36
MV 168,v,36,v,56
v_accvgpr_read_b32 v239, a37
MV 156,v,32,v,60
TR 32,220,24576
TR 34,220,25600
MV 172,v,36,v,60
TR 36,221,24576
TR 38,221,25600
s_waitcnt lgkmcnt(15)
MV 188,v,40,v,60
buffer_load_dwordx4 v211, s[44:47], s75 offen offset:3072 lds
v_accvgpr_read_b32 v240, a38
MV 204,v,44,v,60
s_add_u32 s74, s74, 128
v_accvgpr_read_b32 v241, a39
MV 184,v,40,v,56
v_cvt_pk_bf16_f32 v230, v234, v235
MV 200,v,44,v,56
v_cvt_pk_bf16_f32 v231, v236, v237
MV 180,v,40,v,52
s_and_b32 s74, s74, 2047
v_cvt_pk_bf16_f32 v232, v238, v239
MV 196,v,44,v,52
MV 176,v,40,v,48
TR 40,222,24576
TR 42,222,25600
MV 192,v,44,v,48
TR 44,223,24576
TR 46,223,25600
s_waitcnt lgkmcnt(4)
MV 80,v,16,v,64
v_cvt_pk_bf16_f32 v233, v240, v241
MV 96,v,20,v,64
s_add_u32 s24, s24, 4096
MV 84,v,16,v,68
buffer_store_dwordx4 v[230:233], v228, s[16:19], s24 offen offset:0 sc1
MV 100,v,20,v,68
MV 88,v,16,v,72
v_accvgpr_read_b32 v246, a40
MV 104,v,20,v,72
v_accvgpr_read_b32 v247, a41
MV 92,v,16,v,76
MV 108,v,20,v,76
s_waitcnt vmcnt(17) lgkmcnt(0)
s_barrier
MV 124,v,24,v,76
TR 16,216,32768
TR 18,216,33792
MV 140,v,28,v,76
ds_read_b128 v[48:51], v224 offset:32768
s_add_u32 m0, s68, 114688
MV 120,v,24,v,72
TR 20,217,32768
TR 22,217,33792
MV 136,v,28,v,72
buffer_load_dwordx4 v212, s[48:51], s66 offen offset:0 lds
v_accvgpr_read_b32 v248, a42
MV 116,v,24,v,68
ds_read_b128 v[52:55], v224 offset:34816
buffer_load_dwordx4 v213, s[48:51], s66 offen offset:1024 lds
MV 132,v,28,v,68
v_accvgpr_read_b32 v249, a43
v_accvgpr_read_b32 v250, a44
MV 112,v,24,v,64
TR 24,218,32768
TR 26,218,33792
MV 128,v,28,v,64
TR 28,219,32768
TR 30,219,33792
MV 144,v,32,v,64
ds_read_b128 v[56:59], v224 offset:36864
buffer_load_dwordx4 v214, s[48:51], s66 offen offset:2048 lds
MV 160,v,36,v,64
buffer_load_dwordx4 v215, s[48:51], s66 offen offset:3072 lds
v_accvgpr_read_b32 v251, a45
MV 148,v,32,v,68
v_accvgpr_read_b32 v252, a46
v_accvgpr_read_b32 v253, a47
MV 164,v,36,v,68
s_add_u32 s66, s66, 524288
v_cvt_pk_bf16_f32 v242, v246, v247
MV 152,v,32,v,72
ds_read_b128 v[60:63], v224 offset:38912
v_cvt_pk_bf16_f32 v243, v248, v249
MV 168,v,36,v,72
s_and_b32 s66, s66, 8388607
v_cvt_pk_bf16_f32 v244, v250, v251
MV 156,v,32,v,76
TR 32,220,32768
TR 34,220,33792
MV 172,v,36,v,76
TR 36,221,32768
TR 38,221,33792
MV 188,v,40,v,76
s_add_u32 s75, s64, s74
v_cvt_pk_bf16_f32 v245, v252, v253
MV 204,v,44,v,76
buffer_store_dwordx4 v[242:245], v228, s[16:19], s24 offen offset:1024 sc1
v_accvgpr_read_b32 v234, a48
MV 184,v,40,v,72
s_add_u32 m0, s67, 0
v_accvgpr_read_b32 v235, a49
MV 200,v,44,v,72
v_accvgpr_read_b32 v236, a50
v_accvgpr_read_b32 v237, a51
MV 180,v,40,v,68
buffer_load_dwordx4 v208, s[44:47], s75 offen offset:0 lds
v_accvgpr_read_b32 v238, a52
MV 196,v,44,v,68
MV 176,v,40,v,64
TR 40,222,32768
TR 42,222,33792
MV 192,v,44,v,64
TR 44,223,32768
TR 46,223,33792
s_waitcnt lgkmcnt(4)
MV 80,v,16,v,48
buffer_load_dwordx4 v209, s[44:47], s75 offen offset:1024 lds
v_accvgpr_read_b32 v239, a53
MV 96,v,20,v,48
ds_read_b128 v[64:67], v225 offset:32768
v_accvgpr_read_b32 v240, a54
MV 84,v,16,v,52
buffer_load_dwordx4 v210, s[44:47], s75 offen offset:2048 lds
v_accvgpr_read_b32 v241, a55
MV 100,v,20,v,52
MV 88,v,16,v,56
v_cvt_pk_bf16_f32 v230, v234, v235
MV 104,v,20,v,56
buffer_load_dwordx4 v211, s[44:47], s75 offen offset:3072 lds
v_cvt_pk_bf16_f32 v231, v236, v237
MV 92,v,16,v,60
TR 16,216,40960
TR 18,216,41984
MV 108,v,20,v,60
TR 20,217,40960
TR 22,217,41984
MV 124,v,24,v,60
ds_read_b128 v[68:71], v225 offset:34816
s_add_u32 s75, s65, s74
MV 140,v,28,v,60
v_cvt_pk_bf16_f32 v232, v238, v239
v_cvt_pk_bf16_f32 v233, v240, v241
MV 120,v,24,v,56
buffer_store_dwordx4 v[230:233], v228, s[16:19], s24 offen offset:2048 sc1
MV 136,v,28,v,56
s_add_u32 m0, s67, 4096
v_accvgpr_read_b32 v246, a56
MV 116,v,24,v,52
ds_read_b128 v[72:75], v225 offset:36864
v_accvgpr_read_b32 v247, a57
MV 132,v,28,v,52
MV 112,v,24,v,48
TR 24,218,40960
TR 26,218,41984
MV 128,v,28,v,48
TR 28,219,40960
TR 30,219,41984
MV 144,v,32,v,48
buffer_load_dwordx4 v208, s[44:47], s75 offen offset:0 lds
buffer_load_dwordx4 v209, s[44:47], s75 offen offset:1024 lds
MV 160,v,36,v,48
v_accvgpr_read_b32 v248, a58
v_accvgpr_read_b32 v249, a59
MV 148,v,32,v,52
ds_read_b128 v[76:79], v225 offset:38912
v_accvgpr_read_b32 v250, a60
MV 164,v,36,v,52
buffer_load_dwordx4 v210, s[44:47], s75 offen offset:2048 lds
v_accvgpr_read_b32 v251, a61
MV 152,v,32,v,56
v_accvgpr_read_b32 v252, a62
MV 168,v,36,v,56
v_accvgpr_read_b32 v253, a63
MV 156,v,32,v,60
TR 32,220,40960
TR 34,220,41984
MV 172,v,36,v,60
TR 36,221,40960
TR 38,221,41984
s_waitcnt lgkmcnt(15)
MV 188,v,40,v,60
buffer_load_dwordx4 v211, s[44:47], s75 offen offset:3072 lds
v_cvt_pk_bf16_f32 v242, v246, v247
MV 204,v,44,v,60
s_add_u32 s74, s74, 128
v_cvt_pk_bf16_f32 v243, v248, v249
MV 184,v,40,v,56
v_cvt_pk_bf16_f32 v244, v250, v251
MV 200,v,44,v,56
v_cvt_pk_bf16_f32 v245, v252, v253
MV 180,v,40,v,52
s_and_b32 s74, s74, 2047
buffer_store_dwordx4 v[242:245], v228, s[16:19], s24 offen offset:3072 sc1
MV 196,v,44,v,52
MV 176,v,40,v,48
TR 40,222,40960
TR 42,222,41984
MV 192,v,44,v,48
TR 44,223,40960
TR 46,223,41984
s_waitcnt lgkmcnt(4)
MV 80,v,16,v,64
v_accvgpr_read_b32 v234, a64
MV 96,v,20,v,64
v_accvgpr_read_b32 v235, a65
MV 84,v,16,v,68
v_accvgpr_read_b32 v236, a66
MV 100,v,20,v,68
MV 88,v,16,v,72
v_accvgpr_read_b32 v237, a67
MV 104,v,20,v,72
v_accvgpr_read_b32 v238, a68
MV 92,v,16,v,76
MV 108,v,20,v,76
s_waitcnt vmcnt(16) lgkmcnt(0)
s_barrier
MV 124,v,24,v,76
TR 16,216,0
TR 18,216,1024
MV 140,v,28,v,76
ds_read_b128 v[48:51], v226 offset:0
s_add_u32 m0, s68, 131072
MV 120,v,24,v,72
TR 20,217,0
TR 22,217,1024
MV 136,v,28,v,72
buffer_load_dwordx4 v212, s[48:51], s66 offen offset:0 lds
v_accvgpr_read_b32 v239, a69
MV 116,v,24,v,68
ds_read_b128 v[52:55], v226 offset:2048
buffer_load_dwordx4 v213, s[48:51], s66 offen offset:1024 lds
MV 132,v,28,v,68
v_accvgpr_read_b32 v240, a70
v_accvgpr_read_b32 v241, a71
MV 112,v,24,v,64
TR 24,218,0
TR 26,218,1024
MV 128,v,28,v,64
TR 28,219,0
TR 30,219,1024
MV 144,v,32,v,64
ds_read_b128 v[56:59], v226 offset:4096
buffer_load_dwordx4 v214, s[48:51], s66 offen offset:2048 lds
MV 160,v,36,v,64
buffer_load_dwordx4 v215, s[48:51], s66 offen offset:3072 lds
v_cvt_pk_bf16_f32 v230, v234, v235
MV 148,v,32,v,68
v_cvt_pk_bf16_f32 v231, v236, v237
v_cvt_pk_bf16_f32 v232, v238, v239
MV 164,v,36,v,68
s_add_u32 s66, s66, 524288
v_cvt_pk_bf16_f32 v233, v240, v241
MV 152,v,32,v,72
ds_read_b128 v[60:63], v226 offset:6144
s_add_u32 s24, s24, 4096
MV 168,v,36,v,72
s_and_b32 s66, s66, 8388607
buffer_store_dwordx4 v[230:233], v228, s[16:19], s24 offen offset:0 sc1
MV 156,v,32,v,76
TR 32,220,0
TR 34,220,1024
MV 172,v,36,v,76
TR 36,221,0
TR 38,221,1024
MV 188,v,40,v,76
s_add_u32 s75, s64, s74
v_accvgpr_read_b32 v246, a72
MV 204,v,44,v,76
v_accvgpr_read_b32 v247, a73
v_accvgpr_read_b32 v248, a74
MV 184,v,40,v,72
s_add_u32 m0, s67, 32768
v_accvgpr_read_b32 v249, a75
MV 200,v,44,v,72
v_accvgpr_read_b32 v250, a76
v_accvgpr_read_b32 v251, a77
MV 180,v,40,v,68
buffer_load_dwordx4 v208, s[44:47], s75 offen offset:0 lds
v_accvgpr_read_b32 v252, a78
MV 196,v,44,v,68
MV 176,v,40,v,64
TR 40,222,0
TR 42,222,1024
MV 192,v,44,v,64
TR 44,223,0
TR 46,223,1024
s_waitcnt lgkmcnt(4)
MV 80,v,16,v,48
buffer_load_dwordx4 v209, s[44:47], s75 offen offset:1024 lds
v_accvgpr_read_b32 v253, a79
MV 96,v,20,v,48
ds_read_b128 v[64:67], v227 offset:0
v_cvt_pk_bf16_f32 v242, v246, v247
MV 84,v,16,v,52
buffer_load_dwordx4 v210, s[44:47], s75 offen offset:2048 lds
v_cvt_pk_bf16_f32 v243, v248, v249
MV 100,v,20,v,52
MV 88,v,16,v,56
v_cvt_pk_bf16_f32 v244, v250, v251
MV 104,v,20,v,56
buffer_load_dwordx4 v211, s[44:47], s75 offen offset:3072 lds
v_cvt_pk_bf16_f32 v245, v252, v253
MV 92,v,16,v,60
TR 16,216,8192
TR 18,216,9216
MV 108,v,20,v,60
TR 20,217,8192
TR 22,217,9216
MV 124,v,24,v,60
ds_read_b128 v[68:71], v227 offset:2048
s_add_u32 s75, s65, s74
MV 140,v,28,v,60
buffer_store_dwordx4 v[242:245], v228, s[16:19], s24 offen offset:1024 sc1
v_accvgpr_read_b32 v234, a80
MV 120,v,24,v,56
v_accvgpr_read_b32 v235, a81
v_accvgpr_read_b32 v236, a82
MV 136,v,28,v,56
s_add_u32 m0, s67, 36864
MV 116,v,24,v,52
ds_read_b128 v[72:75], v227 offset:4096
v_accvgpr_read_b32 v237, a83
MV 132,v,28,v,52
v_accvgpr_read_b32 v238, a84
MV 112,v,24,v,48
TR 24,218,8192
TR 26,218,9216
MV 128,v,28,v,48
TR 28,219,8192
TR 30,219,9216
MV 144,v,32,v,48
buffer_load_dwordx4 v208, s[44:47], s75 offen offset:0 lds
buffer_load_dwordx4 v209, s[44:47], s75 offen offset:1024 lds
MV 160,v,36,v,48
v_accvgpr_read_b32 v239, a85
v_accvgpr_read_b32 v240, a86
MV 148,v,32,v,52
ds_read_b128 v[76:79], v227 offset:6144
v_accvgpr_read_b32 v241, a87
MV 164,v,36,v,52
buffer_load_dwordx4 v210, s[44:47], s75 offen offset:2048 lds
v_cvt_pk_bf16_f32 v230, v234, v235
MV 152,v,32,v,56
v_cvt_pk_bf16_f32 v231, v236, v237
MV 168,v,36,v,56
v_cvt_pk_bf16_f32 v232, v238, v239
MV 156,v,32,v,60
TR 32,220,8192
TR 34,220,9216
MV 172,v,36,v,60
TR 36,221,8192
TR 38,221,9216
s_waitcnt lgkmcnt(15)
MV 188,v,40,v,60
buffer_load_dwordx4 v211, s[44:47], s75 offen offset:3072 lds
v_cvt_pk_bf16_f32 v233, v240, v241
MV 204,v,44,v,60
s_add_u32 s74, s74, 128
buffer_store_dwordx4 v[230:233], v228, s[16:19], s24 offen offset:2048 sc1
MV 184,v,40,v,56
v_accvgpr_read_b32 v246, a88
MV 200,v,44,v,56
v_accvgpr_read_b32 v247, a89
MV 180,v,40,v,52
s_and_b32 s74, s74, 2047
v_accvgpr_read_b32 v248, a90
MV 196,v,44,v,52
MV 176,v,40,v,48
TR 40,222,8192
TR 42,222,9216
MV 192,v,44,v,48
TR 44,223,8192
TR 46,223,9216
s_waitcnt lgkmcnt(4)
MV 80,v,16,v,64
v_accvgpr_read_b32 v249, a91
MV 96,v,20,v,64
v_accvgpr_read_b32 v250, a92
MV 84,v,16,v,68
v_accvgpr_read_b32 v251, a93
MV 100,v,20,v,68
MV 88,v,16,v,72
v_accvgpr_read_b32 v252, a94
MV 104,v,20,v,72
v_accvgpr_read_b32 v253, a95
MV 92,v,16,v,76
MV 108,v,20,v,76
s_waitcnt vmcnt(16) lgkmcnt(0)
s_barrier
MV 124,v,24,v,76
TR 16,216,16384
TR 18,216,17408
MV 140,v,28,v,76
ds_read_b128 v[48:51], v224 offset:0
s_add_u32 m0, s68, 98304
MV 120,v,24,v,72
TR 20,217,16384
TR 22,217,17408
MV 136,v,28,v,72
buffer_load_dwordx4 v212, s[48:51], s66 offen offset:0 lds
v_cvt_pk_bf16_f32 v242, v246, v247
MV 116,v,24,v,68
ds_read_b128 v[52:55], v224 offset:2048
buffer_load_dwordx4 v213, s[48:51], s66 offen offset:1024 lds
MV 132,v,28,v,68
v_cvt_pk_bf16_f32 v243, v248, v249
v_cvt_pk_bf16_f32 v244, v250, v251
MV 112,v,24,v,64
TR 24,218,16384
TR 26,218,17408
MV 128,v,28,v,64
TR 28,219,16384
TR 30,219,17408
MV 144,v,32,v,64
ds_read_b128 v[56:59], v224 offset:4096
buffer_load_dwordx4 v214, s[48:51], s66 offen offset:2048 lds
MV 160,v,36,v,64
buffer_load_dwordx4 v215, s[48:51], s66 offen offset:3072 lds
v_cvt_pk_bf16_f32 v245, v252, v253
MV 148,v,32,v,68
buffer_store_dwordx4 v[242:245], v228, s[16:19], s24 offen offset:3072 sc1
v_accvgpr_read_b32 v234, a96
MV 164,v,36,v,68
s_add_u32 s66, s66, 524288
v_accvgpr_read_b32 v235, a97
MV 152,v,32,v,72
ds_read_b128 v[60:63], v224 offset:6144
v_accvgpr_read_b32 v236, a98
MV 168,v,36,v,72
s_and_b32 s66, s66, 8388607
v_accvgpr_read_b32 v237, a99
MV 156,v,32,v,76
TR 32,220,16384
TR 34,220,17408
MV 172,v,36,v,76
TR 36,221,16384
TR 38,221,17408
MV 188,v,40,v,76
s_add_u32 s75, s64, s74
v_accvgpr_read_b32 v238, a100
MV 204,v,44,v,76
v_accvgpr_read_b32 v239, a101
v_accvgpr_read_b32 v240, a102
MV 184,v,40,v,72
s_add_u32 m0, s67, 65536
v_accvgpr_read_b32 v241, a103
MV 200,v,44,v,72
v_cvt_pk_bf16_f32 v230, v234, v235
v_cvt_pk_bf16_f32 v231, v236, v237
MV 180,v,40,v,68
buffer_load_dwordx4 v208, s[44:47], s75 offen offset:0 lds
v_cvt_pk_bf16_f32 v232, v238, v239
MV 196,v,44,v,68
MV 176,v,40,v,64
TR 40,222,16384
TR 42,222,17408
MV 192,v,44,v,64
TR 44,223,16384
TR 46,223,17408
s_waitcnt lgkmcnt(4)
MV 80,v,16,v,48
buffer_load_dwordx4 v209, s[44:47], s75 offen offset:1024 lds
v_cvt_pk_bf16_f32 v233, v240, v241
MV 96,v,20,v,48
ds_read_b128 v[64:67], v225 offset:0
s_add_u32 s24, s24, 4096
MV 84,v,16,v,52
buffer_load_dwordx4 v210, s[44:47], s75 offen offset:2048 lds
buffer_store_dwordx4 v[230:233], v228, s[16:19], s24 offen offset:0 sc1
MV 100,v,20,v,52
MV 88,v,16,v,56
v_accvgpr_read_b32 v246, a104
MV 104,v,20,v,56
buffer_load_dwordx4 v211, s[44:47], s75 offen offset:3072 lds
v_accvgpr_read_b32 v247, a105
MV 92,v,16,v,60
TR 16,216,24576
TR 18,216,25600
MV 108,v,20,v,60
TR 20,217,24576
TR 22,217,25600
MV 124,v,24,v,60
ds_read_b128 v[68:71], v225 offset:2048
s_add_u32 s75, s65, s74
MV 140,v,28,v,60
v_accvgpr_read_b32 v248, a106
v_accvgpr_read_b32 v249, a107
MV 120,v,24,v,56
v_accvgpr_read_b32 v250, a108
MV 136,v,28,v,56
s_add_u32 m0, s67, 69632
v_accvgpr_read_b32 v251, a109
MV 116,v,24,v,52
ds_read_b128 v[72:75], v225 offset:4096
v_accvgpr_read_b32 v252, a110
MV 132,v,28,v,52
MV 112,v,24,v,48
TR 24,218,24576
TR 26,218,25600
MV 128,v,28,v,48
TR 28,219,24576
TR 30,219,25600
MV 144,v,32,v,48
buffer_load_dwordx4 v208, s[44:47], s75 offen offset:0 lds
buffer_load_dwordx4 v209, s[44:47], s75 offen offset:1024 lds
MV 160,v,36,v,48
v_accvgpr_read_b32 v253, a111
v_cvt_pk_bf16_f32 v242, v246, v247
MV 148,v,32,v,52
ds_read_b128 v[76:79], v225 offset:6144
v_cvt_pk_bf16_f32 v243, v248, v249
MV 164,v,36,v,52
buffer_load_dwordx4 v210, s[44:47], s75 offen offset:2048 lds
v_cvt_pk_bf16_f32 v244, v250, v251
MV 152,v,32,v,56
v_cvt_pk_bf16_f32 v245, v252, v253
MV 168,v,36,v,56
buffer_store_dwordx4 v[242:245], v228, s[16:19], s24 offen offset:1024 sc1
MV 156,v,32,v,60
TR 32,220,24576
TR 34,220,25600
MV 172,v,36,v,60
TR 36,221,24576
TR 38,221,25600
s_waitcnt lgkmcnt(15)
MV 188,v,40,v,60
buffer_load_dwordx4 v211, s[44:47], s75 offen offset:3072 lds
v_accvgpr_read_b32 v234, a112
MV 204,v,44,v,60
s_add_u32 s74, s74, 128
v_accvgpr_read_b32 v235, a113
MV 184,v,40,v,56
v_accvgpr_read_b32 v236, a114
MV 200,v,44,v,56
v_accvgpr_read_b32 v237, a115
MV 180,v,40,v,52
s_and_b32 s74, s74, 2047
v_accvgpr_read_b32 v238, a116
MV 196,v,44,v,52
MV 176,v,40,v,48
TR 40,222,24576
TR 42,222,25600
MV 192,v,44,v,48
TR 44,223,24576
TR 46,223,25600
s_waitcnt lgkmcnt(4)
MV 80,v,16,v,64
v_accvgpr_read_b32 v239, a117
MV 96,v,20,v,64
v_accvgpr_read_b32 v240, a118
MV 84,v,16,v,68
v_accvgpr_read_b32 v241, a119
MV 100,v,20,v,68
MV 88,v,16,v,72
v_cvt_pk_bf16_f32 v230, v234, v235
MV 104,v,20,v,72
v_cvt_pk_bf16_f32 v231, v236, v237
MV 92,v,16,v,76
MV 108,v,20,v,76
s_waitcnt vmcnt(16) lgkmcnt(0)
s_barrier
MV 124,v,24,v,76
TR 16,216,32768
TR 18,216,33792
MV 140,v,28,v,76
ds_read_b128 v[48:51], v224 offset:32768
s_add_u32 m0, s68, 114688
MV 120,v,24,v,72
TR 20,217,32768
TR 22,217,33792
MV 136,v,28,v,72
buffer_load_dwordx4 v212, s[48:51], s66 offen offset:0 lds
v_cvt_pk_bf16_f32 v232, v238, v239
MV 116,v,24,v,68
ds_read_b128 v[52:55], v224 offset:34816
buffer_load_dwordx4 v213, s[48:51], s66 offen offset:1024 lds
MV 132,v,28,v,68
v_cvt_pk_bf16_f32 v233, v240, v241
buffer_store_dwordx4 v[230:233], v228, s[16:19], s24 offen offset:2048 sc1
MV 112,v,24,v,64
TR 24,218,32768
TR 26,218,33792
MV 128,v,28,v,64
TR 28,219,32768
TR 30,219,33792
MV 144,v,32,v,64
ds_read_b128 v[56:59], v224 offset:36864
buffer_load_dwordx4 v214, s[48:51], s66 offen offset:2048 lds
MV 160,v,36,v,64
buffer_load_dwordx4 v215, s[48:51], s66 offen offset:3072 lds
v_accvgpr_read_b32 v246, a120
MV 148,v,32,v,68
v_accvgpr_read_b32 v247, a121
v_accvgpr_read_b32 v248, a122
MV 164,v,36,v,68
s_add_u32 s66, s66, 524288
v_accvgpr_read_b32 v249, a123
MV 152,v,32,v,72
ds_read_b128 v[60:63], v224 offset:38912
v_accvgpr_read_b32 v250, a124
MV 168,v,36,v,72
s_and_b32 s66, s66, 8388607
v_accvgpr_read_b32 v251, a125
MV 156,v,32,v,76
TR 32,220,32768
TR 34,220,33792
MV 172,v,36,v,76
TR 36,221,32768
TR 38,221,33792
MV 188,v,40,v,76
s_add_u32 s75, s64, s74
v_accvgpr_read_b32 v252, a126
MV 204,v,44,v,76
v_accvgpr_read_b32 v253, a127
v_cvt_pk_bf16_f32 v242, v246, v247
MV 184,v,40,v,72
s_add_u32 m0, s67, 0
v_cvt_pk_bf16_f32 v243, v248, v249
MV 200,v,44,v,72
v_cvt_pk_bf16_f32 v244, v250, v251
v_cvt_pk_bf16_f32 v245, v252, v253
MV 180,v,40,v,68
buffer_load_dwordx4 v208, s[44:47], s75 offen offset:0 lds
buffer_store_dwordx4 v[242:245], v228, s[16:19], s24 offen offset:3072 sc1
MV 196,v,44,v,68
MV 176,v,40,v,64
TR 40,222,32768
TR 42,222,33792
MV 192,v,44,v,64
TR 44,223,32768
TR 46,223,33792
s_waitcnt lgkmcnt(4)
MV 80,v,16,v,48
buffer_load_dwordx4 v209, s[44:47], s75 offen offset:1024 lds
v_accvgpr_read_b32 v234, a128
MV 96,v,20,v,48
ds_read_b128 v[64:67], v225 offset:32768
v_accvgpr_read_b32 v235, a129
MV 84,v,16,v,52
buffer_load_dwordx4 v210, s[44:47], s75 offen offset:2048 lds
v_accvgpr_read_b32 v236, a130
MV 100,v,20,v,52
MV 88,v,16,v,56
v_accvgpr_read_b32 v237, a131
MV 104,v,20,v,56
buffer_load_dwordx4 v211, s[44:47], s75 offen offset:3072 lds
v_accvgpr_read_b32 v238, a132
MV 92,v,16,v,60
TR 16,216,40960
TR 18,216,41984
MV 108,v,20,v,60
TR 20,217,40960
TR 22,217,41984
MV 124,v,24,v,60
ds_read_b128 v[68:71], v225 offset:34816
s_add_u32 s75, s65, s74
MV 140,v,28,v,60
v_accvgpr_read_b32 v239, a133
v_accvgpr_read_b32 v240, a134
MV 120,v,24,v,56
v_accvgpr_read_b32 v241, a135
MV 136,v,28,v,56
s_add_u32 m0, s67, 4096
v_cvt_pk_bf16_f32 v230, v234, v235
MV 116,v,24,v,52
ds_read_b128 v[72:75], v225 offset:36864
v_cvt_pk_bf16_f32 v231, v236, v237
MV 132,v,28,v,52
MV 112,v,24,v,48
TR 24,218,40960
TR 26,218,41984
MV 128,v,28,v,48
TR 28,219,40960
TR 30,219,41984
MV 144,v,32,v,48
buffer_load_dwordx4 v208, s[44:47], s75 offen offset:0 lds
buffer_load_dwordx4 v209, s[44:47], s75 offen offset:1024 lds
MV 160,v,36,v,48
v_cvt_pk_bf16_f32 v232, v238, v239
v_cvt_pk_bf16_f32 v233, v240, v241
MV 148,v,32,v,52
ds_read_b128 v[76:79], v225 offset:38912
s_add_u32 s24, s24, 4096
MV 164,v,36,v,52
buffer_load_dwordx4 v210, s[44:47], s75 offen offset:2048 lds
buffer_store_dwordx4 v[230:233], v228, s[16:19], s24 offen offset:0 sc1
MV 152,v,32,v,56
v_accvgpr_read_b32 v246, a136
MV 168,v,36,v,56
v_accvgpr_read_b32 v247, a137
MV 156,v,32,v,60
TR 32,220,40960
TR 34,220,41984
MV 172,v,36,v,60
TR 36,221,40960
TR 38,221,41984
s_waitcnt lgkmcnt(15)
MV 188,v,40,v,60
buffer_load_dwordx4 v211, s[44:47], s75 offen offset:3072 lds
v_accvgpr_read_b32 v248, a138
MV 204,v,44,v,60
s_add_u32 s74, s74, 128
v_accvgpr_read_b32 v249, a139
MV 184,v,40,v,56
v_accvgpr_read_b32 v250, a140
MV 200,v,44,v,56
v_accvgpr_read_b32 v251, a141
MV 180,v,40,v,52
s_and_b32 s74, s74, 2047
v_accvgpr_read_b32 v252, a142
MV 196,v,44,v,52
MV 176,v,40,v,48
TR 40,222,40960
TR 42,222,41984
MV 192,v,44,v,48
TR 44,223,40960
TR 46,223,41984
s_waitcnt lgkmcnt(4)
MV 80,v,16,v,64
v_accvgpr_read_b32 v253, a143
MV 96,v,20,v,64
v_cvt_pk_bf16_f32 v242, v246, v247
MV 84,v,16,v,68
v_cvt_pk_bf16_f32 v243, v248, v249
MV 100,v,20,v,68
MV 88,v,16,v,72
v_cvt_pk_bf16_f32 v244, v250, v251
MV 104,v,20,v,72
v_cvt_pk_bf16_f32 v245, v252, v253
MV 92,v,16,v,76
MV 108,v,20,v,76
s_waitcnt vmcnt(15) lgkmcnt(0)
s_barrier
MV 124,v,24,v,76
TR 16,216,0
TR 18,216,1024
MV 140,v,28,v,76
ds_read_b128 v[48:51], v226 offset:0
s_add_u32 m0, s68, 131072
MV 120,v,24,v,72
TR 20,217,0
TR 22,217,1024
MV 136,v,28,v,72
buffer_load_dwordx4 v212, s[48:51], s66 offen offset:0 lds
buffer_store_dwordx4 v[242:245], v228, s[16:19], s24 offen offset:1024 sc1
MV 116,v,24,v,68
ds_read_b128 v[52:55], v226 offset:2048
buffer_load_dwordx4 v213, s[48:51], s66 offen offset:1024 lds
MV 132,v,28,v,68
v_accvgpr_read_b32 v234, a144
v_accvgpr_read_b32 v235, a145
MV 112,v,24,v,64
TR 24,218,0
TR 26,218,1024
MV 128,v,28,v,64
TR 28,219,0
TR 30,219,1024
MV 144,v,32,v,64
ds_read_b128 v[56:59], v226 offset:4096
buffer_load_dwordx4 v214, s[48:51], s66 offen offset:2048 lds
MV 160,v,36,v,64
buffer_load_dwordx4 v215, s[48:51], s66 offen offset:3072 lds
v_accvgpr_read_b32 v236, a146
MV 148,v,32,v,68
v_accvgpr_read_b32 v237, a147
v_accvgpr_read_b32 v238, a148
MV 164,v,36,v,68
s_add_u32 s66, s66, 524288
v_accvgpr_read_b32 v239, a149
MV 152,v,32,v,72
ds_read_b128 v[60:63], v226 offset:6144
v_accvgpr_read_b32 v240, a150
MV 168,v,36,v,72
s_and_b32 s66, s66, 8388607
v_accvgpr_read_b32 v241, a151
MV 156,v,32,v,76
TR 32,220,0
TR 34,220,1024
MV 172,v,36,v,76
TR 36,221,0
TR 38,221,1024
MV 188,v,40,v,76
s_add_u32 s75, s64, s74
v_cvt_pk_bf16_f32 v230, v234, v235
MV 204,v,44,v,76
v_cvt_pk_bf16_f32 v231, v236, v237
v_cvt_pk_bf16_f32 v232, v238, v239
MV 184,v,40,v,72
s_add_u32 m0, s67, 32768
v_cvt_pk_bf16_f32 v233, v240, v241
MV 200,v,44,v,72
buffer_store_dwordx4 v[230:233], v228, s[16:19], s24 offen offset:2048 sc1
v_accvgpr_read_b32 v246, a152
MV 180,v,40,v,68
buffer_load_dwordx4 v208, s[44:47], s75 offen offset:0 lds
v_accvgpr_read_b32 v247, a153
MV 196,v,44,v,68
MV 176,v,40,v,64
TR 40,222,0
TR 42,222,1024
MV 192,v,44,v,64
TR 44,223,0
TR 46,223,1024
s_waitcnt lgkmcnt(4)
MV 80,v,16,v,48
buffer_load_dwordx4 v209, s[44:47], s75 offen offset:1024 lds
v_accvgpr_read_b32 v248, a154
MV 96,v,20,v,48
ds_read_b128 v[64:67], v227 offset:0
v_accvgpr_read_b32 v249, a155
MV 84,v,16,v,52
buffer_load_dwordx4 v210, s[44:47], s75 offen offset:2048 lds
v_accvgpr_read_b32 v250, a156
MV 100,v,20,v,52
MV 88,v,16,v,56
v_accvgpr_read_b32 v251, a157
MV 104,v,20,v,56
buffer_load_dwordx4 v211, s[44:47], s75 offen offset:3072 lds
v_accvgpr_read_b32 v252, a158
MV 92,v,16,v,60
TR 16,216,8192
TR 18,216,9216
MV 108,v,20,v,60
TR 20,217,8192
TR 22,217,9216
MV 124,v,24,v,60
ds_read_b128 v[68:71], v227 offset:2048
s_add_u32 s75, s65, s74
MV 140,v,28,v,60
v_accvgpr_read_b32 v253, a159
v_cvt_pk_bf16_f32 v242, v246, v247
MV 120,v,24,v,56
v_cvt_pk_bf16_f32 v243, v248, v249
MV 136,v,28,v,56
s_add_u32 m0, s67, 36864
v_cvt_pk_bf16_f32 v244, v250, v251
MV 116,v,24,v,52
ds_read_b128 v[72:75], v227 offset:4096
v_cvt_pk_bf16_f32 v245, v252, v253
MV 132,v,28,v,52
MV 112,v,24,v,48
TR 24,218,8192
TR 26,218,9216
MV 128,v,28,v,48
TR 28,219,8192
TR 30,219,9216
MV 144,v,32,v,48
buffer_load_dwordx4 v208, s[44:47], s75 offen offset:0 lds
buffer_load_dwordx4 v209, s[44:47], s75 offen offset:1024 lds
MV 160,v,36,v,48
buffer_store_dwordx4 v[242:245], v228, s[16:19], s24 offen offset:3072 sc1
v_accvgpr_read_b32 v234, a160
MV 148,v,32,v,52
ds_read_b128 v[76:79], v227 offset:6144
v_accvgpr_read_b32 v235, a161
MV 164,v,36,v,52
buffer_load_dwordx4 v210, s[44:47], s75 offen offset:2048 lds
v_accvgpr_read_b32 v236, a162
MV 152,v,32,v,56
v_accvgpr_read_b32 v237, a163
MV 168,v,36,v,56
v_accvgpr_read_b32 v238, a164
MV 156,v,32,v,60
TR 32,220,8192
TR 34,220,9216
MV 172,v,36,v,60
TR 36,221,8192
TR 38,221,9216
s_waitcnt lgkmcnt(15)
MV 188,v,40,v,60
buffer_load_dwordx4 v211, s[44:47], s75 offen offset:3072 lds
v_accvgpr_read_b32 v239, a165
MV 204,v,44,v,60
s_add_u32 s74, s74, 128
v_accvgpr_read_b32 v240, a166
MV 184,v,40,v,56
v_accvgpr_read_b32 v241, a167
MV 200,v,44,v,56
v_cvt_pk_bf16_f32 v230, v234, v235
MV 180,v,40,v,52
s_and_b32 s74, s74, 2047
v_cvt_pk_bf16_f32 v231, v236, v237
MV 196,v,44,v,52
MV 176,v,40,v,48
TR 40,222,8192
TR 42,222,9216
MV 192,v,44,v,48
TR 44,223,8192
TR 46,223,9216
s_waitcnt lgkmcnt(4)
MV 80,v,16,v,64
v_cvt_pk_bf16_f32 v232, v238, v239
MV 96,v,20,v,64
v_cvt_pk_bf16_f32 v233, v240, v241
MV 84,v,16,v,68
s_add_u32 s24, s24, 4096
MV 100,v,20,v,68
MV 88,v,16,v,72
buffer_store_dwordx4 v[230:233], v228, s[16:19], s24 offen offset:0 sc1
MV 104,v,20,v,72
v_accvgpr_read_b32 v246, a168
MV 92,v,16,v,76
v_accvgpr_read_b32 v247, a169
MV 108,v,20,v,76
s_waitcnt vmcnt(16) lgkmcnt(0)
s_barrier
MV 124,v,24,v,76
TR 16,216,16384
TR 18,216,17408
MV 140,v,28,v,76
ds_read_b128 v[48:51], v224 offset:0
s_add_u32 m0, s68, 98304
MV 120,v,24,v,72
TR 20,217,16384
TR 22,217,17408
MV 136,v,28,v,72
buffer_load_dwordx4 v212, s[48:51], s66 offen offset:0 lds
v_accvgpr_read_b32 v248, a170
MV 116,v,24,v,68
ds_read_b128 v[52:55], v224 offset:2048
buffer_load_dwordx4 v213, s[48:51], s66 offen offset:1024 lds
MV 132,v,28,v,68
v_accvgpr_read_b32 v249, a171
v_accvgpr_read_b32 v250, a172
MV 112,v,24,v,64
TR 24,218,16384
TR 26,218,17408
MV 128,v,28,v,64
TR 28,219,16384
TR 30,219,17408
MV 144,v,32,v,64
ds_read_b128 v[56:59], v224 offset:4096
buffer_load_dwordx4 v214, s[48:51], s66 offen offset:2048 lds
MV 160,v,36,v,64
buffer_load_dwordx4 v215, s[48:51], s66 offen offset:3072 lds
v_accvgpr_read_b32 v251, a173
MV 148,v,32,v,68
v_accvgpr_read_b32 v252, a174
v_accvgpr_read_b32 v253, a175
MV 164,v,36,v,68
s_add_u32 s66, s66, 524288
v_cvt_pk_bf16_f32 v242, v246, v247
MV 152,v,32,v,72
ds_read_b128 v[60:63], v224 offset:6144
v_cvt_pk_bf16_f32 v243, v248, v249
MV 168,v,36,v,72
s_and_b32 s66, s66, 8388607
v_cvt_pk_bf16_f32 v244, v250, v251
MV 156,v,32,v,76
TR 32,220,16384
TR 34,220,17408
MV 172,v,36,v,76
TR 36,221,16384
TR 38,221,17408
MV 188,v,40,v,76
s_add_u32 s75, s64, s74
v_cvt_pk_bf16_f32 v245, v252, v253
MV 204,v,44,v,76
buffer_store_dwordx4 v[242:245], v228, s[16:19], s24 offen offset:1024 sc1
v_accvgpr_read_b32 v234, a176
MV 184,v,40,v,72
s_add_u32 m0, s67, 65536
v_accvgpr_read_b32 v235, a177
MV 200,v,44,v,72
v_accvgpr_read_b32 v236, a178
v_accvgpr_read_b32 v237, a179
MV 180,v,40,v,68
buffer_load_dwordx4 v208, s[44:47], s75 offen offset:0 lds
v_accvgpr_read_b32 v238, a180
MV 196,v,44,v,68
MV 176,v,40,v,64
TR 40,222,16384
TR 42,222,17408
MV 192,v,44,v,64
TR 44,223,16384
TR 46,223,17408
s_waitcnt lgkmcnt(4)
MV 80,v,16,v,48
buffer_load_dwordx4 v209, s[44:47], s75 offen offset:1024 lds
v_accvgpr_read_b32 v239, a181
MV 96,v,20,v,48
ds_read_b128 v[64:67], v225 offset:0
v_accvgpr_read_b32 v240, a182
MV 84,v,16,v,52
buffer_load_dwordx4 v210, s[44:47], s75 offen offset:2048 lds
v_accvgpr_read_b32 v241, a183
MV 100,v,20,v,52
MV 88,v,16,v,56
v_cvt_pk_bf16_f32 v230, v234, v235
MV 104,v,20,v,56
buffer_load_dwordx4 v211, s[44:47], s75 offen offset:3072 lds
v_cvt_pk_bf16_f32 v231, v236, v237
MV 92,v,16,v,60
TR 16,216,24576
TR 18,216,25600
MV 108,v,20,v,60
TR 20,217,24576
TR 22,217,25600
MV 124,v,24,v,60
ds_read_b128 v[68:71], v225 offset:2048
s_add_u32 s75, s65, s74
MV 140,v,28,v,60
v_cvt_pk_bf16_f32 v232, v238, v239
v_cvt_pk_bf16_f32 v233, v240, v241
MV 120,v,24,v,56
buffer_store_dwordx4 v[230:233], v228, s[16:19], s24 offen offset:2048 sc1
v_accvgpr_read_b32 v246, a184
MV 136,v,28,v,56
s_add_u32 m0, s67, 69632
MV 116,v,24,v,52
ds_read_b128 v[72:75], v225 offset:4096
v_accvgpr_read_b32 v247, a185
MV 132,v,28,v,52
v_accvgpr_read_b32 v248, a186
MV 112,v,24,v,48
TR 24,218,24576
TR 26,218,25600
MV 128,v,28,v,48
TR 28,219,24576
TR 30,219,25600
MV 144,v,32,v,48
buffer_load_dwordx4 v208, s[44:47], s75 offen offset:0 lds
buffer_load_dwordx4 v209, s[44:47], s75 offen offset:1024 lds
MV 160,v,36,v,48
v_accvgpr_read_b32 v249, a187
v_accvgpr_read_b32 v250, a188
MV 148,v,32,v,52
ds_read_b128 v[76:79], v225 offset:6144
v_accvgpr_read_b32 v251, a189
MV 164,v,36,v,52
buffer_load_dwordx4 v210, s[44:47], s75 offen offset:2048 lds
v_accvgpr_read_b32 v252, a190
MV 152,v,32,v,56
v_accvgpr_read_b32 v253, a191
MV 168,v,36,v,56
v_cvt_pk_bf16_f32 v242, v246, v247
MV 156,v,32,v,60
TR 32,220,24576
TR 34,220,25600
MV 172,v,36,v,60
TR 36,221,24576
TR 38,221,25600
s_waitcnt lgkmcnt(15)
MV 188,v,40,v,60
buffer_load_dwordx4 v211, s[44:47], s75 offen offset:3072 lds
v_cvt_pk_bf16_f32 v243, v248, v249
MV 204,v,44,v,60
s_add_u32 s74, s74, 128
v_cvt_pk_bf16_f32 v244, v250, v251
MV 184,v,40,v,56
v_cvt_pk_bf16_f32 v245, v252, v253
MV 200,v,44,v,56
buffer_store_dwordx4 v[242:245], v228, s[16:19], s24 offen offset:3072 sc1
MV 180,v,40,v,52
s_and_b32 s74, s74, 2047
buffer_load_dword v254, off, s[12:15], 0 sc1
MV 196,v,44,v,52
MV 176,v,40,v,48
TR 40,222,24576
TR 42,222,25600
MV 192,v,44,v,48
TR 44,223,24576
TR 46,223,25600
s_waitcnt lgkmcnt(4)
MV 80,v,16,v,64
v_accvgpr_read_b32 v234, a192
MV 96,v,20,v,64
v_accvgpr_read_b32 v235, a193
MV 84,v,16,v,68
v_accvgpr_read_b32 v236, a194
MV 100,v,20,v,68
MV 88,v,16,v,72
v_accvgpr_read_b32 v237, a195
MV 104,v,20,v,72
v_accvgpr_read_b32 v238, a196
MV 92,v,16,v,76
MV 108,v,20,v,76
s_waitcnt vmcnt(17) lgkmcnt(0)
s_barrier
MV 124,v,24,v,76
TR 16,216,32768
TR 18,216,33792
MV 140,v,28,v,76
ds_read_b128 v[48:51], v224 offset:32768
s_add_u32 m0, s68, 114688
MV 120,v,24,v,72
TR 20,217,32768
TR 22,217,33792
MV 136,v,28,v,72
buffer_load_dwordx4 v212, s[48:51], s66 offen offset:0 lds
v_accvgpr_read_b32 v239, a197
MV 116,v,24,v,68
ds_read_b128 v[52:55], v224 offset:34816
buffer_load_dwordx4 v213, s[48:51], s66 offen offset:1024 lds
MV 132,v,28,v,68
v_accvgpr_read_b32 v240, a198
v_accvgpr_read_b32 v241, a199
MV 112,v,24,v,64
TR 24,218,32768
TR 26,218,33792
MV 128,v,28,v,64
TR 28,219,32768
TR 30,219,33792
MV 144,v,32,v,64
ds_read_b128 v[56:59], v224 offset:36864
buffer_load_dwordx4 v214, s[48:51], s66 offen offset:2048 lds
MV 160,v,36,v,64
buffer_load_dwordx4 v215, s[48:51], s66 offen offset:3072 lds
v_cvt_pk_bf16_f32 v230, v234, v235
MV 148,v,32,v,68
v_cvt_pk_bf16_f32 v231, v236, v237
v_cvt_pk_bf16_f32 v232, v238, v239
MV 164,v,36,v,68
s_add_u32 s66, s66, 524288
v_cvt_pk_bf16_f32 v233, v240, v241
MV 152,v,32,v,72
ds_read_b128 v[60:63], v224 offset:38912
s_add_u32 s24, s24, 4096
MV 168,v,36,v,72
s_and_b32 s66, s66, 8388607
buffer_store_dwordx4 v[230:233], v228, s[16:19], s24 offen offset:0 sc1
MV 156,v,32,v,76
TR 32,220,32768
TR 34,220,33792
MV 172,v,36,v,76
TR 36,221,32768
TR 38,221,33792
MV 188,v,40,v,76
s_add_u32 s75, s64, s74
v_accvgpr_read_b32 v246, a200
MV 204,v,44,v,76
v_accvgpr_read_b32 v247, a201
v_accvgpr_read_b32 v248, a202
MV 184,v,40,v,72
s_add_u32 m0, s67, 0
v_accvgpr_read_b32 v249, a203
MV 200,v,44,v,72
v_accvgpr_read_b32 v250, a204
v_accvgpr_read_b32 v251, a205
MV 180,v,40,v,68
buffer_load_dwordx4 v208, s[44:47], s75 offen offset:0 lds
v_accvgpr_read_b32 v252, a206
MV 196,v,44,v,68
MV 176,v,40,v,64
TR 40,222,32768
TR 42,222,33792
MV 192,v,44,v,64
TR 44,223,32768
TR 46,223,33792
s_waitcnt lgkmcnt(4)
MV 80,v,16,v,48
buffer_load_dwordx4 v209, s[44:47], s75 offen offset:1024 lds
v_accvgpr_read_b32 v253, a207
MV 96,v,20,v,48
ds_read_b128 v[64:67], v225 offset:32768
v_cvt_pk_bf16_f32 v242, v246, v247
MV 84,v,16,v,52
buffer_load_dwordx4 v210, s[44:47], s75 offen offset:2048 lds
v_cvt_pk_bf16_f32 v243, v248, v249
MV 100,v,20,v,52
MV 88,v,16,v,56
v_cvt_pk_bf16_f32 v244, v250, v251
MV 104,v,20,v,56
buffer_load_dwordx4 v211, s[44:47], s75 offen offset:3072 lds
v_cvt_pk_bf16_f32 v245, v252, v253
MV 92,v,16,v,60
TR 16,216,40960
TR 18,216,41984
MV 108,v,20,v,60
TR 20,217,40960
TR 22,217,41984
MV 124,v,24,v,60
ds_read_b128 v[68:71], v225 offset:34816
s_add_u32 s75, s65, s74
MV 140,v,28,v,60
buffer_store_dwordx4 v[242:245], v228, s[16:19], s24 offen offset:1024 sc1
v_accvgpr_read_b32 v234, a208
MV 120,v,24,v,56
v_accvgpr_read_b32 v235, a209
MV 136,v,28,v,56
s_add_u32 m0, s67, 4096
v_accvgpr_read_b32 v236, a210
MV 116,v,24,v,52
ds_read_b128 v[72:75], v225 offset:36864
v_accvgpr_read_b32 v237, a211
MV 132,v,28,v,52
MV 112,v,24,v,48
TR 24,218,40960
TR 26,218,41984
MV 128,v,28,v,48
TR 28,219,40960
TR 30,219,41984
MV 144,v,32,v,48
buffer_load_dwordx4 v208, s[44:47], s75 offen offset:0 lds
buffer_load_dwordx4 v209, s[44:47], s75 offen offset:1024 lds
MV 160,v,36,v,48
v_accvgpr_read_b32 v238, a212
v_accvgpr_read_b32 v239, a213
MV 148,v,32,v,52
ds_read_b128 v[76:79], v225 offset:38912
v_accvgpr_read_b32 v240, a214
MV 164,v,36,v,52
buffer_load_dwordx4 v210, s[44:47], s75 offen offset:2048 lds
v_accvgpr_read_b32 v241, a215
MV 152,v,32,v,56
v_cvt_pk_bf16_f32 v230, v234, v235
MV 168,v,36,v,56
v_cvt_pk_bf16_f32 v231, v236, v237
MV 156,v,32,v,60
TR 32,220,40960
TR 34,220,41984
MV 172,v,36,v,60
TR 36,221,40960
TR 38,221,41984
s_waitcnt lgkmcnt(15)
MV 188,v,40,v,60
buffer_load_dwordx4 v211, s[44:47], s75 offen offset:3072 lds
v_cvt_pk_bf16_f32 v232, v238, v239
MV 204,v,44,v,60
s_add_u32 s74, s74, 128
v_cvt_pk_bf16_f32 v233, v240, v241
MV 184,v,40,v,56
buffer_store_dwordx4 v[230:233], v228, s[16:19], s24 offen offset:2048 sc1
MV 200,v,44,v,56
v_accvgpr_read_b32 v246, a216
MV 180,v,40,v,52
s_and_b32 s74, s74, 2047
v_accvgpr_read_b32 v247, a217
MV 196,v,44,v,52
MV 176,v,40,v,48
TR 40,222,40960
TR 42,222,41984
MV 192,v,44,v,48
TR 44,223,40960
TR 46,223,41984
s_waitcnt lgkmcnt(4)
MV 80,v,16,v,64
v_accvgpr_read_b32 v248, a218
MV 96,v,20,v,64
v_accvgpr_read_b32 v249, a219
MV 84,v,16,v,68
v_accvgpr_read_b32 v250, a220
MV 100,v,20,v,68
MV 88,v,16,v,72
v_accvgpr_read_b32 v251, a221
MV 104,v,20,v,72
v_accvgpr_read_b32 v252, a222
MV 92,v,16,v,76
MV 108,v,20,v,76
s_waitcnt vmcnt(17) lgkmcnt(0)
s_barrier
MV 124,v,24,v,76
TR 16,216,0
TR 18,216,1024
MV 140,v,28,v,76
ds_read_b128 v[48:51], v226 offset:0
s_add_u32 m0, s68, 131072
MV 120,v,24,v,72
TR 20,217,0
TR 22,217,1024
MV 136,v,28,v,72
buffer_load_dwordx4 v212, s[48:51], s66 offen offset:0 lds
v_accvgpr_read_b32 v253, a223
MV 116,v,24,v,68
ds_read_b128 v[52:55], v226 offset:2048
buffer_load_dwordx4 v213, s[48:51], s66 offen offset:1024 lds
MV 132,v,28,v,68
v_cvt_pk_bf16_f32 v242, v246, v247
v_cvt_pk_bf16_f32 v243, v248, v249
MV 112,v,24,v,64
TR 24,218,0
TR 26,218,1024
MV 128,v,28,v,64
TR 28,219,0
TR 30,219,1024
MV 144,v,32,v,64
ds_read_b128 v[56:59], v226 offset:4096
buffer_load_dwordx4 v214, s[48:51], s66 offen offset:2048 lds
MV 160,v,36,v,64
buffer_load_dwordx4 v215, s[48:51], s66 offen offset:3072 lds
v_cvt_pk_bf16_f32 v244, v250, v251
MV 148,v,32,v,68
v_cvt_pk_bf16_f32 v245, v252, v253
buffer_store_dwordx4 v[242:245], v228, s[16:19], s24 offen offset:3072 sc1
MV 164,v,36,v,68
s_add_u32 s66, s66, 524288
v_accvgpr_read_b32 v234, a224
MV 152,v,32,v,72
ds_read_b128 v[60:63], v226 offset:6144
v_accvgpr_read_b32 v235, a225
MV 168,v,36,v,72
s_and_b32 s66, s66, 8388607
v_accvgpr_read_b32 v236, a226
MV 156,v,32,v,76
TR 32,220,0
TR 34,220,1024
MV 172,v,36,v,76
TR 36,221,0
TR 38,221,1024
MV 188,v,40,v,76
s_add_u32 s75, s64, s74
v_accvgpr_read_b32 v237, a227
MV 204,v,44,v,76
v_accvgpr_read_b32 v238, a228
v_accvgpr_read_b32 v239, a229
MV 184,v,40,v,72
s_add_u32 m0, s67, 32768
v_accvgpr_read_b32 v240, a230
MV 200,v,44,v,72
v_accvgpr_read_b32 v241, a231
v_cvt_pk_bf16_f32 v230, v234, v235
MV 180,v,40,v,68
buffer_load_dwordx4 v208, s[44:47], s75 offen offset:0 lds
v_cvt_pk_bf16_f32 v231, v236, v237
MV 196,v,44,v,68
MV 176,v,40,v,64
TR 40,222,0
TR 42,222,1024
MV 192,v,44,v,64
TR 44,223,0
TR 46,223,1024
s_waitcnt lgkmcnt(4)
MV 80,v,16,v,48
buffer_load_dwordx4 v209, s[44:47], s75 offen offset:1024 lds
v_cvt_pk_bf16_f32 v232, v238, v239
MV 96,v,20,v,48
ds_read_b128 v[64:67], v227 offset:0
v_cvt_pk_bf16_f32 v233, v240, v241
MV 84,v,16,v,52
buffer_load_dwordx4 v210, s[44:47], s75 offen offset:2048 lds
s_add_u32 s24, s24, 4096
MV 100,v,20,v,52
MV 88,v,16,v,56
buffer_store_dwordx4 v[230:233], v228, s[16:19], s24 offen offset:0 sc1
MV 104,v,20,v,56
buffer_load_dwordx4 v211, s[44:47], s75 offen offset:3072 lds
v_accvgpr_read_b32 v246, a232
MV 92,v,16,v,60
TR 16,216,8192
TR 18,216,9216
MV 108,v,20,v,60
TR 20,217,8192
TR 22,217,9216
MV 124,v,24,v,60
ds_read_b128 v[68:71], v227 offset:2048
s_add_u32 s75, s65, s74
MV 140,v,28,v,60
v_accvgpr_read_b32 v247, a233
v_accvgpr_read_b32 v248, a234
MV 120,v,24,v,56
v_accvgpr_read_b32 v249, a235
MV 136,v,28,v,56
s_add_u32 m0, s67, 36864
v_accvgpr_read_b32 v250, a236
MV 116,v,24,v,52
ds_read_b128 v[72:75], v227 offset:4096
v_accvgpr_read_b32 v251, a237
MV 132,v,28,v,52
MV 112,v,24,v,48
TR 24,218,8192
TR 26,218,9216
MV 128,v,28,v,48
TR 28,219,8192
TR 30,219,9216
MV 144,v,32,v,48
buffer_load_dwordx4 v208, s[44:47], s75 offen offset:0 lds
buffer_load_dwordx4 v209, s[44:47], s75 offen offset:1024 lds
MV 160,v,36,v,48
v_accvgpr_read_b32 v252, a238
v_accvgpr_read_b32 v253, a239
MV 148,v,32,v,52
ds_read_b128 v[76:79], v227 offset:6144
v_cvt_pk_bf16_f32 v242, v246, v247
MV 164,v,36,v,52
buffer_load_dwordx4 v210, s[44:47], s75 offen offset:2048 lds
v_cvt_pk_bf16_f32 v243, v248, v249
MV 152,v,32,v,56
v_cvt_pk_bf16_f32 v244, v250, v251
MV 168,v,36,v,56
v_cvt_pk_bf16_f32 v245, v252, v253
MV 156,v,32,v,60
TR 32,220,8192
TR 34,220,9216
MV 172,v,36,v,60
TR 36,221,8192
TR 38,221,9216
s_waitcnt lgkmcnt(15)
MV 188,v,40,v,60
buffer_load_dwordx4 v211, s[44:47], s75 offen offset:3072 lds
buffer_store_dwordx4 v[242:245], v228, s[16:19], s24 offen offset:1024 sc1
MV 204,v,44,v,60
s_add_u32 s74, s74, 128
v_accvgpr_read_b32 v234, a240
MV 184,v,40,v,56
v_accvgpr_read_b32 v235, a241
MV 200,v,44,v,56
v_accvgpr_read_b32 v236, a242
MV 180,v,40,v,52
s_and_b32 s74, s74, 2047
v_accvgpr_read_b32 v237, a243
MV 196,v,44,v,52
MV 176,v,40,v,48
TR 40,222,8192
TR 42,222,9216
MV 192,v,44,v,48
TR 44,223,8192
TR 46,223,9216
s_waitcnt lgkmcnt(4)
MV 80,v,16,v,64
v_accvgpr_read_b32 v238, a244
MV 96,v,20,v,64
v_accvgpr_read_b32 v239, a245
MV 84,v,16,v,68
v_accvgpr_read_b32 v240, a246
MV 100,v,20,v,68
MV 88,v,16,v,72
v_accvgpr_read_b32 v241, a247
MV 104,v,20,v,72
v_cvt_pk_bf16_f32 v230, v234, v235
MV 92,v,16,v,76
v_cvt_pk_bf16_f32 v231, v236, v237
MV 108,v,20,v,76
s_waitcnt vmcnt(16) lgkmcnt(0)
s_barrier
MV 124,v,24,v,76
TR 16,216,16384
TR 18,216,17408
MV 140,v,28,v,76
ds_read_b128 v[48:51], v224 offset:0
s_add_u32 m0, s68, 98304
MV 120,v,24,v,72
TR 20,217,16384
TR 22,217,17408
MV 136,v,28,v,72
buffer_load_dwordx4 v212, s[48:51], s66 offen offset:0 lds
v_cvt_pk_bf16_f32 v232, v238, v239
MV 116,v,24,v,68
ds_read_b128 v[52:55], v224 offset:2048
buffer_load_dwordx4 v213, s[48:51], s66 offen offset:1024 lds
MV 132,v,28,v,68
v_cvt_pk_bf16_f32 v233, v240, v241
buffer_store_dwordx4 v[230:233], v228, s[16:19], s24 offen offset:2048 sc1
MV 112,v,24,v,64
TR 24,218,16384
TR 26,218,17408
MV 128,v,28,v,64
TR 28,219,16384
TR 30,219,17408
MV 144,v,32,v,64
ds_read_b128 v[56:59], v224 offset:4096
buffer_load_dwordx4 v214, s[48:51], s66 offen offset:2048 lds
MV 160,v,36,v,64
buffer_load_dwordx4 v215, s[48:51], s66 offen offset:3072 lds
v_accvgpr_read_b32 v246, a248
MV 148,v,32,v,68
v_accvgpr_read_b32 v247, a249
v_accvgpr_read_b32 v248, a250
MV 164,v,36,v,68
s_add_u32 s66, s66, 524288
v_accvgpr_read_b32 v249, a251
MV 152,v,32,v,72
ds_read_b128 v[60:63], v224 offset:6144
v_accvgpr_read_b32 v250, a252
MV 168,v,36,v,72
s_and_b32 s66, s66, 8388607
v_accvgpr_read_b32 v251, a253
MV 156,v,32,v,76
TR 32,220,16384
TR 34,220,17408
MV 172,v,36,v,76
TR 36,221,16384
TR 38,221,17408
MV 188,v,40,v,76
s_add_u32 s75, s64, s74
v_accvgpr_read_b32 v252, a254
MV 204,v,44,v,76
v_accvgpr_read_b32 v253, a255
v_cvt_pk_bf16_f32 v242, v246, v247
MV 184,v,40,v,72
s_add_u32 m0, s67, 65536
v_cvt_pk_bf16_f32 v243, v248, v249
MV 200,v,44,v,72
v_cvt_pk_bf16_f32 v244, v250, v251
v_cvt_pk_bf16_f32 v245, v252, v253
MV 180,v,40,v,68
buffer_load_dwordx4 v208, s[44:47], s75 offen offset:0 lds
buffer_store_dwordx4 v[242:245], v228, s[16:19], s24 offen offset:3072 sc1
MV 196,v,44,v,68
MV 176,v,40,v,64
TR 40,222,16384
TR 42,222,17408
MV 192,v,44,v,64
TR 44,223,16384
TR 46,223,17408
s_waitcnt lgkmcnt(4)
MV 80,v,16,v,48
buffer_load_dwordx4 v209, s[44:47], s75 offen offset:1024 lds
v_lshlrev_b32 v255, 20, v1
MV 96,v,20,v,48
ds_read_b128 v[64:67], v225 offset:0
MV 84,v,16,v,52
buffer_load_dwordx4 v210, s[44:47], s75 offen offset:2048 lds
MV 100,v,20,v,52
MV 88,v,16,v,56
MV 104,v,20,v,56
buffer_load_dwordx4 v211, s[44:47], s75 offen offset:3072 lds
MV 92,v,16,v,60
TR 16,216,24576
TR 18,216,25600
MV 108,v,20,v,60
TR 20,217,24576
TR 22,217,25600
MV 124,v,24,v,60
ds_read_b128 v[68:71], v225 offset:2048
s_add_u32 s75, s65, s74
MV 140,v,28,v,60
MV 120,v,24,v,56
s_lshl_b32 s36, s3, 26
MV 136,v,28,v,56
s_add_u32 m0, s67, 69632
MV 116,v,24,v,52
ds_read_b128 v[72:75], v225 offset:4096
MV 132,v,28,v,52
MV 112,v,24,v,48
TR 24,218,24576
TR 26,218,25600
MV 128,v,28,v,48
TR 28,219,24576
TR 30,219,25600
MV 144,v,32,v,48
buffer_load_dwordx4 v208, s[44:47], s75 offen offset:0 lds
buffer_load_dwordx4 v209, s[44:47], s75 offen offset:1024 lds
MV 160,v,36,v,48
MV 148,v,32,v,52
ds_read_b128 v[76:79], v225 offset:6144
MV 164,v,36,v,52
buffer_load_dwordx4 v210, s[44:47], s75 offen offset:2048 lds
MV 152,v,32,v,56
v_add_u32 v255, s36, v255
MV 168,v,36,v,56
MV 156,v,32,v,60
TR 32,220,24576
TR 34,220,25600
MV 172,v,36,v,60
TR 36,221,24576
TR 38,221,25600
s_waitcnt lgkmcnt(15)
MV 188,v,40,v,60
buffer_load_dwordx4 v211, s[44:47], s75 offen offset:3072 lds
MV 204,v,44,v,60
s_add_u32 s74, s74, 128
MV 184,v,40,v,56
MV 200,v,44,v,56
MV 180,v,40,v,52
s_and_b32 s74, s74, 2047
MV 196,v,44,v,52
MV 176,v,40,v,48
TR 40,222,24576
TR 42,222,25600
MV 192,v,44,v,48
TR 44,223,24576
TR 46,223,25600
s_waitcnt lgkmcnt(4)
MV 80,v,16,v,64
v_lshlrev_b32 v230, 4, v1
MV 96,v,20,v,64
s_lshl_b32 s80, s3, 12
MV 84,v,16,v,68
MV 100,v,20,v,68
v_add_u32 v12, s80, v230
MV 88,v,16,v,72
MV 104,v,20,v,72
v_add_u32 v10, 0x8000, v230
MV 92,v,16,v,76
MV 108,v,20,v,76
s_waitcnt vmcnt(15) lgkmcnt(0)
s_barrier
MV 124,v,24,v,76
TR 16,216,32768
TR 18,216,33792
MV 140,v,28,v,76
ds_read_b128 v[48:51], v224 offset:32768
s_add_u32 m0, s68, 114688
MV 120,v,24,v,72
TR 20,217,32768
TR 22,217,33792
MV 136,v,28,v,72
buffer_load_dwordx4 v212, s[48:51], s66 offen offset:0 lds
v_add_u32 v11, 0x18000, v230
MV 116,v,24,v,68
ds_read_b128 v[52:55], v224 offset:34816
buffer_load_dwordx4 v213, s[48:51], s66 offen offset:1024 lds
MV 132,v,28,v,68
s_add_u32 s72, s80, 0x8000
s_add_u32 s73, s80, 0x18000
MV 112,v,24,v,64
TR 24,218,32768
TR 26,218,33792
MV 128,v,28,v,64
TR 28,219,32768
TR 30,219,33792
MV 144,v,32,v,64
ds_read_b128 v[56:59], v224 offset:36864
buffer_load_dwordx4 v214, s[48:51], s66 offen offset:2048 lds
MV 160,v,36,v,64
buffer_load_dwordx4 v215, s[48:51], s66 offen offset:3072 lds
v_mov_b32 v15, v230
MV 148,v,32,v,68
v_and_b32 v230, 15, v1
v_lshrrev_b32 v232, 4, v1
MV 164,v,36,v,68
s_add_u32 s66, s66, 524288
v_lshlrev_b32 v232, 2, v232
MV 152,v,32,v,72
ds_read_b128 v[60:63], v224 offset:38912
v_sub_u32 v230, v230, v232
MV 168,v,36,v,72
s_and_b32 s66, s66, 8388607
s_lshl_b32 s81, s3, 4
MV 156,v,32,v,76
TR 32,220,32768
TR 34,220,33792
MV 172,v,36,v,76
TR 36,221,32768
TR 38,221,33792
MV 188,v,40,v,76
s_add_u32 s75, s64, s74
v_add_u32 v13, s81, v230
MV 204,v,44,v,76
s_sub_u32 s81, 112, s81
MV 184,v,40,v,72
s_add_u32 m0, s67, 0
v_add_u32 v239, s81, v230
MV 200,v,44,v,72
MV 180,v,40,v,68
buffer_load_dwordx4 v208, s[44:47], s75 offen offset:0 lds
v_mov_b32 v14, 0xff800000
MV 196,v,44,v,68
MV 176,v,40,v,64
TR 40,222,32768
TR 42,222,33792
MV 192,v,44,v,64
TR 44,223,32768
TR 46,223,33792
s_waitcnt lgkmcnt(4)
MV 80,v,16,v,48
buffer_load_dwordx4 v209, s[44:47], s75 offen offset:1024 lds
s_getpc_b64 s[38:39]
L_ct_a:
MV 96,v,20,v,48
ds_read_b128 v[64:67], v225 offset:32768
MV 84,v,16,v,52
buffer_load_dwordx4 v210, s[44:47], s75 offen offset:2048 lds
MV 100,v,20,v,52
s_add_u32 s38, s38, L_p3_begin - L_ct_a
s_addc_u32 s39, s39, 0
MV 88,v,16,v,56
MV 104,v,20,v,56
buffer_load_dwordx4 v211, s[44:47], s75 offen offset:3072 lds
v_mov_b32 v229, s39
MV 92,v,16,v,60
TR 16,216,40960
TR 18,216,41984
MV 108,v,20,v,60
TR 20,217,40960
TR 22,217,41984
MV 124,v,24,v,60
ds_read_b128 v[68:71], v225 offset:34816
s_add_u32 s75, s65, s74
MV 140,v,28,v,60
v_mov_b32 v228, s38
s_lshr_b32 s38, s2, 3
MV 120,v,24,v,56
s_lshl_b32 s38, s38, 2
MV 136,v,28,v,56
s_add_u32 m0, s67, 4096
s_add_u32 s38, s38, s3
MV 116,v,24,v,52
ds_read_b128 v[72:75], v225 offset:36864
MV 132,v,28,v,52
s_lshl_b32 s38, s38, 7
MV 112,v,24,v,48
TR 24,218,40960
TR 26,218,41984
MV 128,v,28,v,48
TR 28,219,40960
TR 30,219,41984
MV 144,v,32,v,48
buffer_load_dwordx4 v208, s[44:47], s75 offen offset:0 lds
buffer_load_dwordx4 v209, s[44:47], s75 offen offset:1024 lds
MV 160,v,36,v,48
v_and_b32 v238, 3, v1
v_lshlrev_b32 v238, 14, v238
MV 148,v,32,v,52
ds_read_b128 v[76:79], v225 offset:38912
v_add_u32 v238, s38, v238
MV 164,v,36,v,52
buffer_load_dwordx4 v210, s[44:47], s75 offen offset:2048 lds
MV 152,v,32,v,56
v_min_u32 v238, L_p3_s1m_top - L_p3_begin - 4, v238
MV 168,v,36,v,56
v_add_co_u32 v228, vcc, v228, v238
s_nop 1
v_addc_co_u32 v229, vcc, 0, v229, vcc
MV 156,v,32,v,60
TR 32,220,40960
TR 34,220,41984
MV 172,v,36,v,60
TR 36,221,40960
TR 38,221,41984
s_waitcnt lgkmcnt(15)
MV 188,v,40,v,60
buffer_load_dwordx4 v211, s[44:47], s75 offen offset:3072 lds
MV 204,v,44,v,60
s_add_u32 s74, s74, 128
MV 184,v,40,v,56
MV 200,v,44,v,56
MV 180,v,40,v,52
s_and_b32 s74, s74, 2047
global_load_dword v238, v[228:229], off
MV 196,v,44,v,52
MV 176,v,40,v,48
TR 40,222,40960
TR 42,222,41984
MV 192,v,44,v,48
TR 44,223,40960
TR 46,223,41984
s_waitcnt lgkmcnt(4)
MV 80,v,16,v,64
MV 96,v,20,v,64
MV 84,v,16,v,68
MV 100,v,20,v,68
MV 88,v,16,v,72
MV 104,v,20,v,72
MV 92,v,16,v,76
MV 108,v,20,v,76
s_waitcnt vmcnt(13) lgkmcnt(0)
s_barrier
MV 124,v,24,v,76
v_cmp_gt_u32 vcc, 1, v254
s_nop 4
s_cbranch_vccnz L_spin_go
L_spin_go_ret:
v_mov_b32 v254, 1
s_lshl_b32 s36, s2, 2
buffer_store_dword v254, v255, s[8:11], s36 offen offset:0 sc1
s_load_dwordx4 s[32:35], s[0:1], 32
MV 140,v,28,v,76
TR 16,216,0
TR 18,216,1024
MV 120,v,24,v,72
TR 20,217,0
TR 22,217,1024
MV 136,v,28,v,72
ds_read_b128 v[48:51], v226 offset:0
s_add_u32 m0, s68, 131072
MV 116,v,24,v,68
ds_read_b128 v[52:55], v226 offset:2048
buffer_load_dwordx4 v212, s[48:51], s66 offen offset:0 lds
MV 132,v,28,v,68
buffer_load_dwordx4 v213, s[48:51], s66 offen offset:1024 lds
MV 112,v,24,v,64
TR 24,218,0
TR 26,218,1024
MV 128,v,28,v,64
TR 28,219,0
TR 30,219,1024
MV 144,v,32,v,64
ds_read_b128 v[56:59], v226 offset:4096
buffer_load_dwordx4 v214, s[48:51], s66 offen offset:2048 lds
MV 160,v,36,v,64
buffer_load_dwordx4 v215, s[48:51], s66 offen offset:3072 lds
MV 148,v,32,v,68
MV 164,v,36,v,68
s_add_u32 s66, s66, 524288
MV 152,v,32,v,72
ds_read_b128 v[60:63], v226 offset:6144
MV 168,v,36,v,72
s_and_b32 s66, s66, 8388607
MV 156,v,32,v,76
TR 32,220,0
TR 34,220,1024
MV 172,v,36,v,76
TR 36,221,0
TR 38,221,1024
MV 188,v,40,v,76
s_add_u32 s75, s64, s74
MV 204,v,44,v,76
MV 184,v,40,v,72
s_add_u32 m0, s67, 32768
MV 200,v,44,v,72
MV 180,v,40,v,68
buffer_load_dwordx4 v208, s[44:47], s75 offen offset:0 lds
MV 196,v,44,v,68
MV 176,v,40,v,64
TR 40,222,0
TR 42,222,1024
MV 192,v,44,v,64
TR 44,223,0
TR 46,223,1024
s_waitcnt lgkmcnt(4)
MV 80,v,16,v,48
buffer_load_dwordx4 v209, s[44:47], s75 offen offset:1024 lds
s_and_b32 s36, s2, 3
MV 96,v,20,v,48
ds_read_b128 v[64:67], v227 offset:0
s_lshl_b32 s36, s36, 1
MV 84,v,16,v,52
buffer_load_dwordx4 v210, s[44:47], s75 offen offset:2048 lds
s_sub_u32 s43, 14, s36
MV 100,v,20,v,52
s_bitcmp1_b32 s2, 4
s_cselect_b32 s36, s43, s36
MV 88,v,16,v,56
s_bfe_u32 s43, s2, 0x10003
MV 104,v,20,v,56
buffer_load_dwordx4 v211, s[44:47], s75 offen offset:3072 lds
s_add_u32 s36, s36, s43
MV 92,v,16,v,60
TR 16,216,8192
TR 18,216,9216
MV 108,v,20,v,60
TR 20,217,8192
TR 22,217,9216
MV 124,v,24,v,60
ds_read_b128 v[68:71], v227 offset:2048
s_add_u32 s75, s65, s74
MV 140,v,28,v,60
s_bfe_u32 s37, s2, 0x10002
s_lshr_b32 s43, s2, 5
MV 120,v,24,v,56
s_lshl_b32 s43, s43, 1
s_add_u32 s37, s37, s43
MV 136,v,28,v,56
s_add_u32 m0, s67, 36864
v_and_b32 v230, 15, v1
MV 116,v,24,v,52
ds_read_b128 v[72:75], v227 offset:4096
s_lshl_b32 s36, s36, 4
MV 132,v,28,v,52
v_add_u32 v231, s36, v230
s_lshr_b32 s36, s2, 4
MV 112,v,24,v,48
TR 24,218,8192
TR 26,218,9216
MV 128,v,28,v,48
TR 28,219,8192
TR 30,219,9216
MV 144,v,32,v,48
buffer_load_dwordx4 v208, s[44:47], s75 offen offset:0 lds
buffer_load_dwordx4 v209, s[44:47], s75 offen offset:1024 lds
MV 160,v,36,v,48
v_lshl_add_u32 v232, v230, 4, s36
v_and_b32 v233, 7, v1
MV 148,v,32,v,52
ds_read_b128 v[76:79], v227 offset:6144
v_bfe_u32 v234, v1, 3, 1
MV 164,v,36,v,52
buffer_load_dwordx4 v210, s[44:47], s75 offen offset:2048 lds
v_lshlrev_b32 v233, 3, v233
MV 152,v,32,v,56
v_lshl_add_u32 v233, v234, 7, v233
s_bfe_u32 s36, s69, 0x10001
MV 168,v,36,v,56
s_lshl_b32 s36, s36, 6
s_lshr_b32 s37, s69, 2
MV 156,v,32,v,60
TR 32,220,8192
TR 34,220,9216
MV 172,v,36,v,60
TR 36,221,8192
TR 38,221,9216
s_waitcnt lgkmcnt(15)
MV 188,v,40,v,60
buffer_load_dwordx4 v211, s[44:47], s75 offen offset:3072 lds
s_add_u32 s36, s36, s37
MV 204,v,44,v,60
s_add_u32 s74, s74, 128
v_add_u32 v233, s36, v233
MV 184,v,40,v,56
v_lshrrev_b32 v234, 4, v1
MV 200,v,44,v,56
v_cmp_eq_u32 vcc, 1, v234
s_nop 1
v_cndmask_b32 v233, v233, v232, vcc
MV 180,v,40,v,52
s_and_b32 s74, s74, 2047
MV 196,v,44,v,52
v_cmp_eq_u32 vcc, 2, v234
s_nop 1
v_cndmask_b32 v233, v233, v231, vcc
MV 176,v,40,v,48
TR 40,222,8192
TR 42,222,9216
MV 192,v,44,v,48
TR 44,223,8192
TR 46,223,9216
v_lshlrev_b32 v233, 2, v233
s_waitcnt lgkmcnt(4)
MV 80,v,16,v,64
MV 96,v,20,v,64
MV 84,v,16,v,68
MV 100,v,20,v,68
MV 88,v,16,v,72
MV 104,v,20,v,72
MV 92,v,16,v,76
MV 108,v,20,v,76
s_waitcnt vmcnt(14) lgkmcnt(0)
s_barrier
MV 124,v,24,v,76
TR 16,216,16384
TR 18,216,17408
MV 140,v,28,v,76
ds_read_b128 v[48:51], v224 offset:0
s_add_u32 m0, s68, 98304
MV 120,v,24,v,72
TR 20,217,16384
TR 22,217,17408
MV 136,v,28,v,72
buffer_load_dwordx4 v212, s[48:51], s66 offen offset:0 lds
MV 116,v,24,v,68
ds_read_b128 v[52:55], v224 offset:2048
buffer_load_dwordx4 v213, s[48:51], s66 offen offset:1024 lds
MV 132,v,28,v,68
MV 112,v,24,v,64
TR 24,218,16384
TR 26,218,17408
MV 128,v,28,v,64
TR 28,219,16384
TR 30,219,17408
MV 144,v,32,v,64
ds_read_b128 v[56:59], v224 offset:4096
buffer_load_dwordx4 v214, s[48:51], s66 offen offset:2048 lds
MV 160,v,36,v,64
buffer_load_dwordx4 v215, s[48:51], s66 offen offset:3072 lds
MV 148,v,32,v,68
MV 164,v,36,v,68
s_add_u32 s66, s66, 524288
MV 152,v,32,v,72
ds_read_b128 v[60:63], v224 offset:6144
MV 168,v,36,v,72
s_and_b32 s66, s66, 8388607
MV 156,v,32,v,76
TR 32,220,16384
TR 34,220,17408
MV 172,v,36,v,76
TR 36,221,16384
TR 38,221,17408
MV 188,v,40,v,76
s_add_u32 s75, s64, s74
MV 204,v,44,v,76
MV 184,v,40,v,72
s_add_u32 m0, s67, 65536
MV 200,v,44,v,72
MV 180,v,40,v,68
buffer_load_dwordx4 v208, s[44:47], s75 offen offset:0 lds
MV 196,v,44,v,68
MV 176,v,40,v,64
TR 40,222,16384
TR 42,222,17408
MV 192,v,44,v,64
TR 44,223,16384
TR 46,223,17408
s_waitcnt lgkmcnt(4)
MV 80,v,16,v,48
buffer_load_dwordx4 v209, s[44:47], s75 offen offset:1024 lds
s_lshl_b32 s36, s2, 2
MV 96,v,20,v,48
ds_read_b128 v[64:67], v225 offset:0
s_add_u32 s36, s36, s3
MV 84,v,16,v,52
buffer_load_dwordx4 v210, s[44:47], s75 offen offset:2048 lds
s_lshl_b32 s42, s36, 1
MV 100,v,20,v,52
s_lshl_b32 s37, s36, 12
MV 88,v,16,v,56
s_add_u32 s16, s32, s37
s_addc_u32 s17, s33, 0
MV 104,v,20,v,56
buffer_load_dwordx4 v211, s[44:47], s75 offen offset:3072 lds
MV 92,v,16,v,60
TR 16,216,24576
TR 18,216,25600
MV 108,v,20,v,60
TR 20,217,24576
TR 22,217,25600
MV 124,v,24,v,60
ds_read_b128 v[68:71], v225 offset:2048
s_add_u32 s75, s65, s74
MV 140,v,28,v,60
s_mov_b32 s18, 4096
s_mov_b32 s19, 0x20000
MV 120,v,24,v,56
s_add_u32 s37, s37, 50331648
MV 136,v,28,v,56
s_add_u32 m0, s67, 69632
MV 116,v,24,v,52
ds_read_b128 v[72:75], v225 offset:4096
MV 132,v,28,v,52
s_add_u32 s20, s40, s37
s_addc_u32 s21, s41, 0
MV 112,v,24,v,48
TR 24,218,24576
TR 26,218,25600
MV 128,v,28,v,48
TR 28,219,24576
TR 30,219,25600
MV 144,v,32,v,48
buffer_load_dwordx4 v208, s[44:47], s75 offen offset:0 lds
buffer_load_dwordx4 v209, s[44:47], s75 offen offset:1024 lds
MV 160,v,36,v,48
s_mov_b32 s22, 4096
s_mov_b32 s23, 0x20000
MV 148,v,32,v,52
ds_read_b128 v[76:79], v225 offset:6144
s_lshl_b32 s37, s2, 14
MV 164,v,36,v,52
buffer_load_dwordx4 v210, s[44:47], s75 offen offset:2048 lds
s_add_u32 s37, s37, 54525952
MV 152,v,32,v,56
s_add_u32 s24, s40, s37
s_addc_u32 s25, s41, 0
MV 168,v,36,v,56
s_mov_b32 s26, 16384
s_mov_b32 s27, 0x20000
MV 156,v,32,v,60
TR 32,220,24576
TR 34,220,25600
MV 172,v,36,v,60
TR 36,221,24576
TR 38,221,25600
s_waitcnt lgkmcnt(15)
MV 188,v,40,v,60
buffer_load_dwordx4 v211, s[44:47], s75 offen offset:3072 lds
s_mov_b32 s28, s34
MV 204,v,44,v,60
s_add_u32 s74, s74, 128
s_mov_b32 s29, s35
MV 184,v,40,v,56
s_mov_b32 s30, 2048
s_mov_b32 s31, 0x20000
MV 200,v,44,v,56
s_mul_i32 s43, s3, 4608
MV 180,v,40,v,52
s_and_b32 s74, s74, 2047
s_add_u32 s43, s43, 132096
MV 196,v,44,v,52
MV 176,v,40,v,48
TR 40,222,24576
TR 42,222,25600
MV 192,v,44,v,48
TR 44,223,24576
TR 46,223,25600
s_waitcnt lgkmcnt(4)
MV 80,v,16,v,64
MV 96,v,20,v,64
MV 84,v,16,v,68
MV 100,v,20,v,68
MV 88,v,16,v,72
MV 104,v,20,v,72
MV 92,v,16,v,76
MV 108,v,20,v,76
s_waitcnt vmcnt(12) lgkmcnt(0)
s_barrier
MV 124,v,24,v,76
s_load_dwordx2 s[32:33], s[0:1], 88
TR 16,216,32768
MV 140,v,28,v,76
TR 18,216,33792
ds_read_b128 v[48:51], v224 offset:32768
MV 120,v,24,v,72
TR 20,217,32768
TR 22,217,33792
MV 136,v,28,v,72
MV 116,v,24,v,68
ds_read_b128 v[52:55], v224 offset:34816
MV 132,v,28,v,68
MV 112,v,24,v,64
TR 24,218,32768
TR 26,218,33792
MV 128,v,28,v,64
TR 28,219,32768
TR 30,219,33792
MV 144,v,32,v,64
ds_read_b128 v[56:59], v224 offset:36864
MV 160,v,36,v,64
MV 148,v,32,v,68
MV 164,v,36,v,68
MV 152,v,32,v,72
ds_read_b128 v[60:63], v224 offset:38912
MV 168,v,36,v,72
MV 156,v,32,v,76
TR 32,220,32768
TR 34,220,33792
MV 172,v,36,v,76
TR 36,221,32768
TR 38,221,33792
MV 188,v,40,v,76
MV 204,v,44,v,76
MV 184,v,40,v,72
MV 200,v,44,v,72
MV 180,v,40,v,68
MV 196,v,44,v,68
MV 176,v,40,v,64
TR 40,222,32768
TR 42,222,33792
MV 192,v,44,v,64
TR 44,223,32768
TR 46,223,33792
s_waitcnt lgkmcnt(4)
MV 80,v,16,v,48
s_add_u32 s4, s40, 109051904
s_addc_u32 s5, s41, 0
MV 96,v,20,v,48
ds_read_b128 v[64:67], v225 offset:32768
MV 84,v,16,v,52
MV 100,v,20,v,52
MV 88,v,16,v,56
s_mov_b32 s6, 4194304
MV 104,v,20,v,56
MV 92,v,16,v,60
TR 16,216,40960
TR 18,216,41984
MV 108,v,20,v,60
TR 20,217,40960
TR 22,217,41984
MV 124,v,24,v,60
ds_read_b128 v[68:71], v225 offset:34816
s_mov_b32 s7, 0x20000
MV 140,v,28,v,60
s_lshl_b32 s36, s2, 14
MV 120,v,24,v,56
MV 136,v,28,v,56
v_mov_b32 v244, -1
MV 116,v,24,v,52
ds_read_b128 v[72:75], v225 offset:36864
MV 132,v,28,v,52
v_mov_b32 v245, -1
MV 112,v,24,v,48
TR 24,218,40960
TR 26,218,41984
MV 128,v,28,v,48
TR 28,219,40960
TR 30,219,41984
MV 144,v,32,v,48
v_mov_b32 v246, -1
MV 160,v,36,v,48
MV 148,v,32,v,52
ds_read_b128 v[76:79], v225 offset:38912
v_mov_b32 v247, -1
MV 164,v,36,v,52
MV 152,v,32,v,56
buffer_store_dwordx4 v[244:247], v12, s[4:7], s36 offen offset:0 sc1
MV 168,v,36,v,56
MV 156,v,32,v,60
TR 32,220,40960
TR 34,220,41984
MV 172,v,36,v,60
TR 36,221,40960
TR 38,221,41984
s_waitcnt lgkmcnt(15)
MV 188,v,40,v,60
buffer_store_dwordx4 v[244:247], v12, s[4:7], s36 offen offset:1024 sc1
MV 204,v,44,v,60
buffer_store_dwordx4 v[244:247], v12, s[4:7], s36 offen offset:2048 sc1
MV 184,v,40,v,56
MV 200,v,44,v,56
buffer_store_dwordx4 v[244:247], v12, s[4:7], s36 offen offset:3072 sc1
MV 180,v,40,v,52
MV 196,v,44,v,52
MV 176,v,40,v,48
TR 40,222,40960
TR 42,222,41984
MV 192,v,44,v,48
TR 44,223,40960
TR 46,223,41984
s_waitcnt lgkmcnt(4)
MV 80,v,16,v,64
MV 96,v,20,v,64
MV 84,v,16,v,68
MV 100,v,20,v,68
MV 88,v,16,v,72
MV 104,v,20,v,72
MV 92,v,16,v,76
MV 108,v,20,v,76
s_waitcnt vmcnt(4) lgkmcnt(0)
s_barrier
MV 124,v,24,v,76
TR 16,216,0
TR 18,216,1024
MV 140,v,28,v,76
ds_read_b128 v[48:51], v226 offset:0
MV 120,v,24,v,72
TR 20,217,0
TR 22,217,1024
MV 136,v,28,v,72
MV 116,v,24,v,68
ds_read_b128 v[52:55], v226 offset:2048
MV 132,v,28,v,68
MV 112,v,24,v,64
TR 24,218,0
TR 26,218,1024
MV 128,v,28,v,64
TR 28,219,0
TR 30,219,1024
MV 144,v,32,v,64
ds_read_b128 v[56:59], v226 offset:4096
MV 160,v,36,v,64
MV 148,v,32,v,68
MV 164,v,36,v,68
MV 152,v,32,v,72
ds_read_b128 v[60:63], v226 offset:6144
MV 168,v,36,v,72
MV 156,v,32,v,76
TR 32,220,0
TR 34,220,1024
MV 172,v,36,v,76
TR 36,221,0
TR 38,221,1024
MV 188,v,40,v,76
MV 204,v,44,v,76
MV 184,v,40,v,72
MV 200,v,44,v,72
MV 180,v,40,v,68
MV 196,v,44,v,68
MV 176,v,40,v,64
TR 40,222,0
TR 42,222,1024
MV 192,v,44,v,64
TR 44,223,0
TR 46,223,1024
s_waitcnt lgkmcnt(4)
MV 80,v,16,v,48
buffer_load_dword v237, v233, s[8:11], 0 offen offset:0 sc1
MV 96,v,20,v,48
ds_read_b128 v[64:67], v227 offset:0
MV 84,v,16,v,52
s_lshr_b32 s36, s2, 3
MV 100,v,20,v,52
MV 88,v,16,v,56
MV 104,v,20,v,56
s_lshl_b32 s36, s36, 18
MV 92,v,16,v,60
TR 16,216,8192
TR 18,216,9216
MV 108,v,20,v,60
TR 20,217,8192
TR 22,217,9216
MV 124,v,24,v,60
ds_read_b128 v[68:71], v227 offset:2048
s_and_b32 s37, s2, 7
MV 140,v,28,v,60
MV 120,v,24,v,56
s_lshl_b32 s37, s37, 8
MV 136,v,28,v,56
MV 116,v,24,v,52
ds_read_b128 v[72:75], v227 offset:4096
s_add_u32 s36, s36, s37
MV 132,v,28,v,52
MV 112,v,24,v,48
TR 24,218,8192
TR 26,218,9216
MV 128,v,28,v,48
TR 28,219,8192
TR 30,219,9216
MV 144,v,32,v,48
s_lshl_b32 s37, s3, 16
MV 160,v,36,v,48
s_add_u32 s36, s36, s37
MV 148,v,32,v,52
ds_read_b128 v[76:79], v227 offset:6144
MV 164,v,36,v,52
MV 152,v,32,v,56
s_add_u32 s32, s32, s36
s_addc_u32 s33, s33, 0
MV 168,v,36,v,56
MV 156,v,32,v,60
TR 32,220,8192
TR 34,220,9216
MV 172,v,36,v,60
TR 36,221,8192
TR 38,221,9216
s_waitcnt lgkmcnt(15)
MV 188,v,40,v,60
MV 204,v,44,v,60
s_mov_b32 s34, 65536
MV 184,v,40,v,56
MV 200,v,44,v,56
s_mov_b32 s35, 0x20000
MV 180,v,40,v,52
MV 196,v,44,v,52
MV 176,v,40,v,48
TR 40,222,8192
TR 42,222,9216
MV 192,v,44,v,48
TR 44,223,8192
TR 46,223,9216
s_waitcnt vmcnt(0)
v_cmp_gt_u32 vcc, 1, v237
s_nop 4
s_cbranch_vccnz L_spin_f1
L_spin_f1_ret:
s_waitcnt lgkmcnt(4)
MV 80,v,16,v,64
s_add_u32 m0, s68, 16384
MV 96,v,20,v,64
MV 84,v,16,v,68
s_mov_b32 s80, 0
MV 100,v,20,v,68
MV 88,v,16,v,72
MV 104,v,20,v,72
buffer_load_dwordx4 v12, s[52:55], s80 offen offset:0 sc1 lds
MV 92,v,16,v,76
MV 108,v,20,v,76
buffer_load_dwordx4 v12, s[52:55], s80 offen offset:1024 sc1 lds
MV 124,v,24,v,76
MV 140,v,28,v,76
MV 120,v,24,v,72
buffer_load_dwordx4 v12, s[52:55], s80 offen offset:2048 sc1 lds
MV 136,v,28,v,72
MV 116,v,24,v,68
buffer_load_dwordx4 v12, s[52:55], s80 offen offset:3072 sc1 lds
MV 132,v,28,v,68
MV 112,v,24,v,64
MV 128,v,28,v,64
s_add_u32 m0, s68, 32768
MV 144,v,32,v,64
MV 160,v,36,v,64
s_mov_b32 s80, 16384
MV 148,v,32,v,68
MV 164,v,36,v,68
MV 152,v,32,v,72
buffer_load_dwordx4 v12, s[52:55], s80 offen offset:0 sc1 lds
MV 168,v,36,v,72
MV 156,v,32,v,76
buffer_load_dwordx4 v12, s[52:55], s80 offen offset:1024 sc1 lds
MV 172,v,36,v,76
s_waitcnt lgkmcnt(2)
MV 188,v,40,v,76
s_waitcnt lgkmcnt(0)
MV 204,v,44,v,76
buffer_load_dwordx4 v12, s[52:55], s80 offen offset:2048 sc1 lds
MV 184,v,40,v,72
MV 200,v,44,v,72
buffer_load_dwordx4 v12, s[52:55], s80 offen offset:3072 sc1 lds
MV 180,v,40,v,68
MV 196,v,44,v,68
MV 176,v,40,v,64
MV 192,v,44,v,64
L_p3_begin:
s_waitcnt lgkmcnt(0)
s_barrier
s_mov_b32 s82, 0x3e0293ee
s_mov_b32 s83, 0x3e0293ee
v_pk_mul_f32 v[80:81], v[80:81], s[82:83]
v_pk_mul_f32 v[82:83], v[82:83], s[82:83]
v_pk_mul_f32 v[84:85], v[84:85], s[82:83]
v_pk_mul_f32 v[86:87], v[86:87], s[82:83]
v_pk_mul_f32 v[88:89], v[88:89], s[82:83]
v_pk_mul_f32 v[90:91], v[90:91], s[82:83]
v_pk_mul_f32 v[92:93], v[92:93], s[82:83]
v_pk_mul_f32 v[94:95], v[94:95], s[82:83]
v_pk_mul_f32 v[96:97], v[96:97], s[82:83]
v_pk_mul_f32 v[98:99], v[98:99], s[82:83]
v_pk_mul_f32 v[100:101], v[100:101], s[82:83]
v_pk_mul_f32 v[102:103], v[102:103], s[82:83]
s_add_u32 m0, s68, 114688
v_pk_mul_f32 v[104:105], v[104:105], s[82:83]
v_pk_mul_f32 v[106:107], v[106:107], s[82:83]
v_pk_mul_f32 v[108:109], v[108:109], s[82:83]
v_pk_mul_f32 v[110:111], v[110:111], s[82:83]
v_cvt_pk_bf16_f32 v16, v80, v81
v_cvt_pk_bf16_f32 v17, v82, v83
v_cvt_pk_bf16_f32 v18, v96, v97
v_cvt_pk_bf16_f32 v19, v98, v99
v_cvt_pk_bf16_f32 v32, v84, v85
v_cvt_pk_bf16_f32 v33, v86, v87
v_cvt_pk_bf16_f32 v34, v100, v101
v_cvt_pk_bf16_f32 v35, v102, v103
v_cvt_pk_bf16_f32 v48, v88, v89
v_cvt_pk_bf16_f32 v49, v90, v91
v_cvt_pk_bf16_f32 v50, v104, v105
s_mov_b32 s80, 16384
v_cvt_pk_bf16_f32 v51, v106, v107
v_cvt_pk_bf16_f32 v64, v92, v93
v_cvt_pk_bf16_f32 v65, v94, v95
v_cvt_pk_bf16_f32 v66, v108, v109
v_cvt_pk_bf16_f32 v67, v110, v111
v_pk_mul_f32 v[112:113], v[112:113], s[82:83]
v_pk_mul_f32 v[114:115], v[114:115], s[82:83]
v_pk_mul_f32 v[116:117], v[116:117], s[82:83]
v_pk_mul_f32 v[118:119], v[118:119], s[82:83]
v_pk_mul_f32 v[120:121], v[120:121], s[82:83]
v_pk_mul_f32 v[122:123], v[122:123], s[82:83]
v_pk_mul_f32 v[124:125], v[124:125], s[82:83]
v_pk_mul_f32 v[126:127], v[126:127], s[82:83]
v_pk_mul_f32 v[128:129], v[128:129], s[82:83]
buffer_load_dwordx4 v12, s[56:59], s80 offen offset:0 sc1 lds
v_pk_mul_f32 v[130:131], v[130:131], s[82:83]
v_pk_mul_f32 v[132:133], v[132:133], s[82:83]
v_pk_mul_f32 v[134:135], v[134:135], s[82:83]
v_pk_mul_f32 v[136:137], v[136:137], s[82:83]
v_pk_mul_f32 v[138:139], v[138:139], s[82:83]
v_pk_mul_f32 v[140:141], v[140:141], s[82:83]
v_pk_mul_f32 v[142:143], v[142:143], s[82:83]
v_cvt_pk_bf16_f32 v20, v112, v113
v_cvt_pk_bf16_f32 v21, v114, v115
v_cvt_pk_bf16_f32 v22, v128, v129
v_cvt_pk_bf16_f32 v23, v130, v131
v_cvt_pk_bf16_f32 v36, v116, v117
v_cvt_pk_bf16_f32 v37, v118, v119
v_cvt_pk_bf16_f32 v38, v132, v133
v_cvt_pk_bf16_f32 v39, v134, v135
buffer_load_dwordx4 v12, s[56:59], s80 offen offset:1024 sc1 lds
v_cvt_pk_bf16_f32 v52, v120, v121
v_cvt_pk_bf16_f32 v53, v122, v123
v_cvt_pk_bf16_f32 v54, v136, v137
v_cvt_pk_bf16_f32 v55, v138, v139
v_cvt_pk_bf16_f32 v68, v124, v125
v_cvt_pk_bf16_f32 v69, v126, v127
v_cvt_pk_bf16_f32 v70, v140, v141
v_cvt_pk_bf16_f32 v71, v142, v143
v_pk_mul_f32 v[144:145], v[144:145], s[82:83]
v_pk_mul_f32 v[146:147], v[146:147], s[82:83]
v_pk_mul_f32 v[148:149], v[148:149], s[82:83]
v_pk_mul_f32 v[150:151], v[150:151], s[82:83]
v_pk_mul_f32 v[152:153], v[152:153], s[82:83]
v_pk_mul_f32 v[154:155], v[154:155], s[82:83]
v_pk_mul_f32 v[156:157], v[156:157], s[82:83]
buffer_load_dwordx4 v12, s[56:59], s80 offen offset:2048 sc1 lds
v_pk_mul_f32 v[158:159], v[158:159], s[82:83]
v_pk_mul_f32 v[160:161], v[160:161], s[82:83]
v_pk_mul_f32 v[162:163], v[162:163], s[82:83]
v_pk_mul_f32 v[164:165], v[164:165], s[82:83]
v_pk_mul_f32 v[166:167], v[166:167], s[82:83]
v_pk_mul_f32 v[168:169], v[168:169], s[82:83]
v_pk_mul_f32 v[170:171], v[170:171], s[82:83]
v_pk_mul_f32 v[172:173], v[172:173], s[82:83]
v_pk_mul_f32 v[174:175], v[174:175], s[82:83]
v_cvt_pk_bf16_f32 v24, v144, v145
v_cvt_pk_bf16_f32 v25, v146, v147
v_cvt_pk_bf16_f32 v26, v160, v161
v_cvt_pk_bf16_f32 v27, v162, v163
v_cvt_pk_bf16_f32 v40, v148, v149
buffer_load_dwordx4 v12, s[56:59], s80 offen offset:3072 sc1 lds
v_cvt_pk_bf16_f32 v41, v150, v151
v_cvt_pk_bf16_f32 v42, v164, v165
v_cvt_pk_bf16_f32 v43, v166, v167
v_cvt_pk_bf16_f32 v56, v152, v153
v_cvt_pk_bf16_f32 v57, v154, v155
v_cvt_pk_bf16_f32 v58, v168, v169
v_cvt_pk_bf16_f32 v59, v170, v171
v_cvt_pk_bf16_f32 v72, v156, v157
v_cvt_pk_bf16_f32 v73, v158, v159
v_cvt_pk_bf16_f32 v74, v172, v173
v_cvt_pk_bf16_f32 v75, v174, v175
v_pk_mul_f32 v[176:177], v[176:177], s[82:83]
v_pk_mul_f32 v[178:179], v[178:179], s[82:83]
v_pk_mul_f32 v[180:181], v[180:181], s[82:83]
v_pk_mul_f32 v[182:183], v[182:183], s[82:83]
s_add_u32 m0, s68, 49152
v_pk_mul_f32 v[184:185], v[184:185], s[82:83]
v_pk_mul_f32 v[186:187], v[186:187], s[82:83]
v_pk_mul_f32 v[188:189], v[188:189], s[82:83]
v_pk_mul_f32 v[190:191], v[190:191], s[82:83]
v_pk_mul_f32 v[192:193], v[192:193], s[82:83]
v_pk_mul_f32 v[194:195], v[194:195], s[82:83]
v_pk_mul_f32 v[196:197], v[196:197], s[82:83]
v_pk_mul_f32 v[198:199], v[198:199], s[82:83]
v_pk_mul_f32 v[200:201], v[200:201], s[82:83]
v_pk_mul_f32 v[202:203], v[202:203], s[82:83]
v_pk_mul_f32 v[204:205], v[204:205], s[82:83]
v_pk_mul_f32 v[206:207], v[206:207], s[82:83]
v_cvt_pk_bf16_f32 v28, v176, v177
v_cvt_pk_bf16_f32 v29, v178, v179
s_mov_b32 s80, 32768
v_cvt_pk_bf16_f32 v30, v192, v193
v_cvt_pk_bf16_f32 v31, v194, v195
v_cvt_pk_bf16_f32 v44, v180, v181
v_cvt_pk_bf16_f32 v45, v182, v183
v_cvt_pk_bf16_f32 v46, v196, v197
v_cvt_pk_bf16_f32 v47, v198, v199
v_cvt_pk_bf16_f32 v60, v184, v185
v_cvt_pk_bf16_f32 v61, v186, v187
v_cvt_pk_bf16_f32 v62, v200, v201
v_cvt_pk_bf16_f32 v63, v202, v203
v_cvt_pk_bf16_f32 v76, v188, v189
v_cvt_pk_bf16_f32 v77, v190, v191
v_cvt_pk_bf16_f32 v78, v204, v205
v_cvt_pk_bf16_f32 v79, v206, v207
v_mov_b32 v2, 0
buffer_load_dwordx4 v12, s[52:55], s80 offen offset:0 sc1 lds
v_mov_b32 v3, 0
v_mov_b32 v4, 0
v_mov_b32 v5, 0
v_accvgpr_write_b32 a0, 0
v_accvgpr_write_b32 a1, 0
v_accvgpr_write_b32 a2, 0
v_accvgpr_write_b32 a3, 0
v_accvgpr_write_b32 a4, 0
v_accvgpr_write_b32 a5, 0
v_accvgpr_write_b32 a6, 0
v_accvgpr_write_b32 a7, 0
v_accvgpr_write_b32 a8, 0
v_accvgpr_write_b32 a9, 0
v_accvgpr_write_b32 a10, 0
v_accvgpr_write_b32 a11, 0
buffer_load_dwordx4 v12, s[52:55], s80 offen offset:1024 sc1 lds
v_accvgpr_write_b32 a12, 0
v_accvgpr_write_b32 a13, 0
v_accvgpr_write_b32 a14, 0
v_accvgpr_write_b32 a15, 0
v_accvgpr_write_b32 a16, 0
v_accvgpr_write_b32 a17, 0
v_accvgpr_write_b32 a18, 0
v_accvgpr_write_b32 a19, 0
v_accvgpr_write_b32 a20, 0
v_accvgpr_write_b32 a21, 0
v_accvgpr_write_b32 a22, 0
v_accvgpr_write_b32 a23, 0
v_accvgpr_write_b32 a24, 0
v_accvgpr_write_b32 a25, 0
buffer_load_dwordx4 v12, s[52:55], s80 offen offset:2048 sc1 lds
v_accvgpr_write_b32 a26, 0
v_accvgpr_write_b32 a27, 0
v_accvgpr_write_b32 a28, 0
v_accvgpr_write_b32 a29, 0
v_accvgpr_write_b32 a30, 0
v_accvgpr_write_b32 a31, 0
v_accvgpr_write_b32 a32, 0
v_accvgpr_write_b32 a33, 0
v_accvgpr_write_b32 a34, 0
v_accvgpr_write_b32 a35, 0
v_accvgpr_write_b32 a36, 0
v_accvgpr_write_b32 a37, 0
v_accvgpr_write_b32 a38, 0
v_accvgpr_write_b32 a39, 0
v_accvgpr_write_b32 a40, 0
buffer_load_dwordx4 v12, s[52:55], s80 offen offset:3072 sc1 lds
v_accvgpr_write_b32 a41, 0
v_accvgpr_write_b32 a42, 0
v_accvgpr_write_b32 a43, 0
v_accvgpr_write_b32 a44, 0
v_accvgpr_write_b32 a45, 0
v_accvgpr_write_b32 a46, 0
v_accvgpr_write_b32 a47, 0
v_accvgpr_write_b32 a48, 0
v_accvgpr_write_b32 a49, 0
v_accvgpr_write_b32 a50, 0
v_accvgpr_write_b32 a51, 0
v_accvgpr_write_b32 a52, 0
v_accvgpr_write_b32 a53, 0
v_accvgpr_write_b32 a54, 0
s_add_u32 m0, s68, 65536
v_accvgpr_write_b32 a55, 0
v_accvgpr_write_b32 a56, 0
v_accvgpr_write_b32 a57, 0
v_accvgpr_write_b32 a58, 0
v_accvgpr_write_b32 a59, 0
v_accvgpr_write_b32 a60, 0
v_accvgpr_write_b32 a61, 0
v_accvgpr_write_b32 a62, 0
v_accvgpr_write_b32 a63, 0
v_accvgpr_write_b32 a64, 0
v_accvgpr_write_b32 a65, 0
v_accvgpr_write_b32 a66, 0
v_accvgpr_write_b32 a67, 0
v_accvgpr_write_b32 a68, 0
v_accvgpr_write_b32 a69, 0
s_mov_b32 s80, 32768
v_accvgpr_write_b32 a70, 0
v_accvgpr_write_b32 a71, 0
v_accvgpr_write_b32 a72, 0
v_accvgpr_write_b32 a73, 0
v_accvgpr_write_b32 a74, 0
v_accvgpr_write_b32 a75, 0
v_accvgpr_write_b32 a76, 0
v_accvgpr_write_b32 a77, 0
v_accvgpr_write_b32 a78, 0
v_accvgpr_write_b32 a79, 0
v_accvgpr_write_b32 a80, 0
v_accvgpr_write_b32 a81, 0
v_accvgpr_write_b32 a82, 0
v_accvgpr_write_b32 a83, 0
v_accvgpr_write_b32 a84, 0
buffer_load_dwordx4 v12, s[56:59], s80 offen offset:0 sc1 lds
v_accvgpr_write_b32 a85, 0
v_accvgpr_write_b32 a86, 0
v_accvgpr_write_b32 a87, 0
v_accvgpr_write_b32 a88, 0
v_accvgpr_write_b32 a89, 0
v_accvgpr_write_b32 a90, 0
v_accvgpr_write_b32 a91, 0
v_accvgpr_write_b32 a92, 0
v_accvgpr_write_b32 a93, 0
v_accvgpr_write_b32 a94, 0
v_accvgpr_write_b32 a95, 0
v_accvgpr_write_b32 a96, 0
v_accvgpr_write_b32 a97, 0
v_accvgpr_write_b32 a98, 0
buffer_load_dwordx4 v12, s[56:59], s80 offen offset:1024 sc1 lds
v_accvgpr_write_b32 a99, 0
v_accvgpr_write_b32 a100, 0
v_accvgpr_write_b32 a101, 0
v_accvgpr_write_b32 a102, 0
v_accvgpr_write_b32 a103, 0
v_accvgpr_write_b32 a104, 0
v_accvgpr_write_b32 a105, 0
v_accvgpr_write_b32 a106, 0
v_accvgpr_write_b32 a107, 0
v_accvgpr_write_b32 a108, 0
v_accvgpr_write_b32 a109, 0
v_accvgpr_write_b32 a110, 0
v_accvgpr_write_b32 a111, 0
v_accvgpr_write_b32 a112, 0
v_accvgpr_write_b32 a113, 0
buffer_load_dwordx4 v12, s[56:59], s80 offen offset:2048 sc1 lds
v_accvgpr_write_b32 a114, 0
v_accvgpr_write_b32 a115, 0
v_accvgpr_write_b32 a116, 0
v_accvgpr_write_b32 a117, 0
v_accvgpr_write_b32 a118, 0
v_accvgpr_write_b32 a119, 0
v_accvgpr_write_b32 a120, 0
v_accvgpr_write_b32 a121, 0
v_accvgpr_write_b32 a122, 0
v_accvgpr_write_b32 a123, 0
v_accvgpr_write_b32 a124, 0
v_accvgpr_write_b32 a125, 0
v_accvgpr_write_b32 a126, 0
v_accvgpr_write_b32 a127, 0
v_xor_b32 v244, 0x8000, v10
buffer_load_dwordx4 v12, s[56:59], s80 offen offset:3072 sc1 lds
s_waitcnt vmcnt(16)
s_barrier
ds_read_b128 a[128:131], v244 offset:16384
ds_read_b128 a[132:135], v244 offset:17408
ds_read_b128 a[136:139], v244 offset:18432
ds_read_b128 a[140:143], v244 offset:19456
ds_read_b128 a[144:147], v244 offset:20480
ds_read_b128 a[148:151], v244 offset:21504
ds_read_b128 a[152:155], v244 offset:22528
ds_read_b128 a[156:159], v244 offset:23552
ds_read_b128 a[160:163], v244 offset:24576
ds_read_b128 a[164:167], v244 offset:25600
ds_read_b128 a[168:171], v244 offset:26624
ds_read_b128 a[172:175], v244 offset:27648
ds_read_b128 a[176:179], v244 offset:28672
ds_read_b128 a[180:183], v244 offset:29696
ds_read_b128 a[184:187], v244 offset:30720
ds_read_b128 a[188:191], v244 offset:31744
s_waitcnt lgkmcnt(15)
v_mfma_f32_16x16x32_bf16 v[80:83], a[128:131], v[16:19], 0
s_add_u32 m0, s68, 0
v_mfma_f32_16x16x32_bf16 v[88:91], a[128:131], v[32:35], 0
s_mov_b32 s80, 49152
v_mfma_f32_16x16x32_bf16 v[96:99], a[128:131], v[48:51], 0
v_mfma_f32_16x16x32_bf16 v[104:107], a[128:131], v[64:67], 0
buffer_load_dwordx4 v12, s[52:55], s80 offen offset:0 sc1 lds
s_waitcnt lgkmcnt(14)
MV 80,a,132,v,20
MV 88,a,132,v,36
buffer_load_dwordx4 v12, s[52:55], s80 offen offset:1024 sc1 lds
MV 96,a,132,v,52
MV 104,a,132,v,68
buffer_load_dwordx4 v12, s[52:55], s80 offen offset:2048 sc1 lds
s_waitcnt lgkmcnt(13)
MV 80,a,136,v,24
MV 88,a,136,v,40
buffer_load_dwordx4 v12, s[52:55], s80 offen offset:3072 sc1 lds
MV 96,a,136,v,56
MV 104,a,136,v,72
s_add_u32 m0, s68, 81920
s_waitcnt lgkmcnt(12)
MV 80,a,140,v,28
s_mov_b32 s80, 49152
MV 88,a,140,v,44
MV 96,a,140,v,60
buffer_load_dwordx4 v12, s[56:59], s80 offen offset:0 sc1 lds
MV 104,a,140,v,76
s_waitcnt lgkmcnt(11)
v_mfma_f32_16x16x32_bf16 v[84:87], a[144:147], v[16:19], 0
buffer_load_dwordx4 v12, s[56:59], s80 offen offset:1024 sc1 lds
v_mfma_f32_16x16x32_bf16 v[92:95], a[144:147], v[32:35], 0
v_mfma_f32_16x16x32_bf16 v[100:103], a[144:147], v[48:51], 0
buffer_load_dwordx4 v12, s[56:59], s80 offen offset:2048 sc1 lds
v_mfma_f32_16x16x32_bf16 v[108:111], a[144:147], v[64:67], 0
s_waitcnt lgkmcnt(10)
MV 84,a,148,v,20
buffer_load_dwordx4 v12, s[56:59], s80 offen offset:3072 sc1 lds
MV 92,a,148,v,36
MV 100,a,148,v,52
MV 108,a,148,v,68
s_waitcnt lgkmcnt(9)
MV 84,a,152,v,24
s_waitcnt vmcnt(16) lgkmcnt(0)
s_barrier
MV 92,a,152,v,40
ds_read_b128 a[128:131], v10 offset:0
s_add_u32 m0, s68, 16384
MV 100,a,152,v,56
ds_read_b128 a[132:135], v10 offset:1024
s_mov_b32 s80, 65536
MV 108,a,152,v,72
ds_read_b128 a[136:139], v10 offset:2048
buffer_load_dwordx4 v12, s[52:55], s80 offen offset:0 sc1 lds
MV 84,a,156,v,28
ds_read_b128 a[140:143], v10 offset:3072
buffer_load_dwordx4 v12, s[52:55], s80 offen offset:1024 sc1 lds
MV 92,a,156,v,44
ds_read_b128 a[144:147], v10 offset:4096
buffer_load_dwordx4 v12, s[52:55], s80 offen offset:2048 sc1 lds
MV 100,a,156,v,60
ds_read_b128 a[148:151], v10 offset:5120
buffer_load_dwordx4 v12, s[52:55], s80 offen offset:3072 sc1 lds
MV 108,a,156,v,76
ds_read_b128 a[152:155], v10 offset:6144
s_mov_b32 s71, 65536
v_mfma_f32_16x16x32_bf16 v[112:115], a[160:163], v[16:19], 0
ds_read_b128 a[156:159], v10 offset:7168
v_mfma_f32_16x16x32_bf16 v[120:123], a[160:163], v[32:35], 0
v_lshrrev_b32 v245, 4, v1
v_mfma_f32_16x16x32_bf16 v[128:131], a[160:163], v[48:51], 0
v_and_b32 v246, 15, v1
v_mfma_f32_16x16x32_bf16 v[136:139], a[160:163], v[64:67], 0
ds_read_b128 a[160:163], v10 offset:8192
v_lshlrev_b32 v247, 1, v245
MV 112,a,164,v,20
v_xor_b32 v246, v246, v247
MV 120,a,164,v,36
v_lshlrev_b32 v245, 11, v245
MV 128,a,164,v,52
v_lshl_add_u32 v245, v246, 4, v245
MV 136,a,164,v,68
ds_read_b128 a[164:167], v10 offset:9216
v_xor_b32 v246, 128, v245
MV 112,a,168,v,24
MV 120,a,168,v,40
s_lshl_b32 s36, s3, 13
MV 128,a,168,v,56
s_add_u32 m0, s36, 131072
MV 136,a,168,v,72
ds_read_b128 a[168:171], v10 offset:10240
s_mov_b32 s37, 0
MV 112,a,172,v,28
buffer_load_dwordx4 v245, s[32:35], s37 offen offset:0 lds
MV 120,a,172,v,44
s_mov_b32 s37, 7168
MV 128,a,172,v,60
buffer_load_dwordx4 v246, s[32:35], s37 offen offset:1024 lds
MV 136,a,172,v,76
ds_read_b128 a[172:175], v10 offset:11264
v_mfma_f32_16x16x32_bf16 v[116:119], a[176:179], v[16:19], 0
s_mov_b32 s37, 14336
v_mfma_f32_16x16x32_bf16 v[124:127], a[176:179], v[32:35], 0
buffer_load_dwordx4 v245, s[32:35], s37 offen offset:2048 lds
v_mfma_f32_16x16x32_bf16 v[132:135], a[176:179], v[48:51], 0
s_mov_b32 s37, 21504
v_mfma_f32_16x16x32_bf16 v[140:143], a[176:179], v[64:67], 0
ds_read_b128 a[176:179], v10 offset:12288
buffer_load_dwordx4 v246, s[32:35], s37 offen offset:3072 lds
MV 116,a,180,v,20
s_add_u32 m0, s36, 135168
MV 124,a,180,v,36
s_mov_b32 s37, 32768
MV 132,a,180,v,52
buffer_load_dwordx4 v245, s[32:35], s37 offen offset:0 lds
MV 140,a,180,v,68
ds_read_b128 a[180:183], v10 offset:13312
MV 116,a,184,v,24
s_mov_b32 s37, 39936
MV 124,a,184,v,40
buffer_load_dwordx4 v246, s[32:35], s37 offen offset:1024 lds
MV 132,a,184,v,56
s_mov_b32 s37, 47104
MV 140,a,184,v,72
ds_read_b128 a[184:187], v10 offset:14336
buffer_load_dwordx4 v245, s[32:35], s37 offen offset:2048 lds
MV 116,a,188,v,28
s_mov_b32 s37, 54272
MV 124,a,188,v,44
buffer_load_dwordx4 v246, s[32:35], s37 offen offset:3072 lds
MV 132,a,188,v,60
MV 140,a,188,v,76
ds_read_b128 a[188:191], v10 offset:15360
s_cmp_eq_u32 s70, 0
s_cbranch_scc1 L_p3_pmask
L_p3_pmask_ret:
v_exp_f32 v80, v80
v_exp_f32 v81, v81
v_exp_f32 v82, v82
v_add_f32 v2, v2, v80
v_add_f32 v2, v2, v81
v_exp_f32 v83, v83
v_cvt_pk_bf16_f32 v80, v80, v81
v_exp_f32 v84, v84
v_add_f32 v2, v2, v82
v_add_f32 v2, v2, v83
v_exp_f32 v85, v85
v_cvt_pk_bf16_f32 v81, v82, v83
v_exp_f32 v86, v86
v_add_f32 v2, v2, v84
v_add_f32 v2, v2, v85
v_exp_f32 v87, v87
v_cvt_pk_bf16_f32 v82, v84, v85
v_exp_f32 v88, v88
v_add_f32 v2, v2, v86
v_add_f32 v2, v2, v87
v_exp_f32 v89, v89
v_cvt_pk_bf16_f32 v83, v86, v87
v_exp_f32 v90, v90
v_add_f32 v3, v3, v88
v_add_f32 v3, v3, v89
v_exp_f32 v91, v91
v_cvt_pk_bf16_f32 v88, v88, v89
v_exp_f32 v92, v92
v_add_f32 v3, v3, v90
v_add_f32 v3, v3, v91
v_exp_f32 v93, v93
v_cvt_pk_bf16_f32 v89, v90, v91
v_exp_f32 v94, v94
v_add_f32 v3, v3, v92
v_add_f32 v3, v3, v93
v_exp_f32 v95, v95
v_cvt_pk_bf16_f32 v90, v92, v93
v_exp_f32 v96, v96
v_add_f32 v3, v3, v94
v_add_f32 v3, v3, v95
v_exp_f32 v97, v97
v_cvt_pk_bf16_f32 v91, v94, v95
v_exp_f32 v98, v98
v_add_f32 v4, v4, v96
v_add_f32 v4, v4, v97
v_exp_f32 v99, v99
v_cvt_pk_bf16_f32 v96, v96, v97
v_exp_f32 v100, v100
v_add_f32 v4, v4, v98
v_add_f32 v4, v4, v99
v_exp_f32 v101, v101
v_cvt_pk_bf16_f32 v97, v98, v99
v_exp_f32 v102, v102
v_add_f32 v4, v4, v100
v_add_f32 v4, v4, v101
v_exp_f32 v103, v103
v_cvt_pk_bf16_f32 v98, v100, v101
v_exp_f32 v104, v104
v_add_f32 v4, v4, v102
v_add_f32 v4, v4, v103
v_exp_f32 v105, v105
v_cvt_pk_bf16_f32 v99, v102, v103
v_exp_f32 v106, v106
v_add_f32 v5, v5, v104
v_add_f32 v5, v5, v105
v_exp_f32 v107, v107
v_cvt_pk_bf16_f32 v104, v104, v105
v_exp_f32 v108, v108
v_add_f32 v5, v5, v106
v_add_f32 v5, v5, v107
v_exp_f32 v109, v109
v_cvt_pk_bf16_f32 v105, v106, v107
v_exp_f32 v110, v110
v_add_f32 v5, v5, v108
v_add_f32 v5, v5, v109
v_exp_f32 v111, v111
v_cvt_pk_bf16_f32 v106, v108, v109
v_add_f32 v5, v5, v110
v_add_f32 v5, v5, v111
v_cvt_pk_bf16_f32 v107, v110, v111
s_sub_u32 s74, s70, 1
s_cbranch_scc1 L_p3_d0m_top
.p2align 5
L_p3_d0_top:
s_waitcnt lgkmcnt(0)
v_mfma_f32_16x16x32_bf16 v[144:147], a[128:131], v[16:19], 0
s_add_u32 m0, s73, 0
ds_read_b128 a[192:195], v11 offset:16384
v_mfma_f32_16x16x32_bf16 v[152:155], a[128:131], v[32:35], 0
v_exp_f32 v112, v112
v_mfma_f32_16x16x32_bf16 v[148:151], a[144:147], v[16:19], 0
ds_read_b128 a[196:199], v11 offset:17408
buffer_load_dwordx4 v12, s[56:59], s71 offen offset:0 sc1 lds
v_mfma_f32_16x16x32_bf16 v[156:159], a[144:147], v[32:35], 0
v_exp_f32 v113, v113
v_mfma_f32_16x16x32_bf16 v[176:179], a[160:163], v[16:19], 0
v_exp_f32 v114, v114
v_mfma_f32_16x16x32_bf16 v[184:187], a[160:163], v[32:35], 0
v_add_f32 v2, v2, v112
v_add_f32 v2, v2, v113
v_mfma_f32_16x16x32_bf16 v[180:183], a[176:179], v[16:19], 0
v_exp_f32 v115, v115
v_mfma_f32_16x16x32_bf16 v[188:191], a[176:179], v[32:35], 0
ds_read_b128 a[200:203], v11 offset:18432
v_cvt_pk_bf16_f32 v112, v112, v113
v_mfma_f32_16x16x32_bf16 v[196:199], a[176:179], v[48:51], 0
v_exp_f32 v116, v116
v_mfma_f32_16x16x32_bf16 v[204:207], a[176:179], v[64:67], 0
v_add_f32 v2, v2, v114
v_add_f32 v2, v2, v115
v_mfma_f32_16x16x32_bf16 v[192:195], a[160:163], v[48:51], 0
v_exp_f32 v117, v117
v_mfma_f32_16x16x32_bf16 v[200:203], a[160:163], v[64:67], 0
ds_read_b128 a[204:207], v11 offset:19456
v_cvt_pk_bf16_f32 v113, v114, v115
v_mfma_f32_16x16x32_bf16 v[164:167], a[144:147], v[48:51], 0
v_exp_f32 v118, v118
v_mfma_f32_16x16x32_bf16 v[172:175], a[144:147], v[64:67], 0
ds_read_b128 a[208:211], v11 offset:20480
v_add_f32 v2, v2, v116
v_mfma_f32_16x16x32_bf16 v[160:163], a[128:131], v[48:51], 0
buffer_load_dwordx4 v12, s[56:59], s71 offen offset:1024 sc1 lds
v_add_f32 v2, v2, v117
v_mfma_f32_16x16x32_bf16 v[168:171], a[128:131], v[64:67], 0
v_exp_f32 v119, v119
MV 180,a,180,v,20
ds_read_b128 a[212:215], v11 offset:21504
v_cvt_pk_bf16_f32 v114, v116, v117
MV 188,a,180,v,36
v_exp_f32 v120, v120
MV 176,a,164,v,20
v_add_f32 v2, v2, v118
v_add_f32 v2, v2, v119
MV 184,a,164,v,36
v_exp_f32 v121, v121
MV 148,a,148,v,20
ds_read_b128 a[216:219], v11 offset:22528
v_cvt_pk_bf16_f32 v115, v118, v119
MV 156,a,148,v,36
v_exp_f32 v122, v122
MV 144,a,132,v,20
v_add_f32 v3, v3, v120
v_add_f32 v3, v3, v121
MV 152,a,132,v,36
v_exp_f32 v123, v123
MV 160,a,132,v,52
ds_read_b128 a[220:223], v11 offset:23552
v_cvt_pk_bf16_f32 v120, v120, v121
MV 168,a,132,v,68
v_exp_f32 v124, v124
MV 164,a,148,v,52
ds_read_b128 a[224:227], v11 offset:24576
v_add_f32 v3, v3, v122
MV 172,a,148,v,68
buffer_load_dwordx4 v12, s[56:59], s71 offen offset:2048 sc1 lds
v_add_f32 v3, v3, v123
MV 192,a,164,v,52
v_exp_f32 v125, v125
MV 200,a,164,v,68
ds_read_b128 a[228:231], v11 offset:25600
v_cvt_pk_bf16_f32 v121, v122, v123
MV 196,a,180,v,52
v_exp_f32 v126, v126
MV 204,a,180,v,68
v_add_f32 v3, v3, v124
v_add_f32 v3, v3, v125
MV 144,a,136,v,24
v_exp_f32 v127, v127
MV 152,a,136,v,40
ds_read_b128 a[232:235], v11 offset:26624
v_cvt_pk_bf16_f32 v122, v124, v125
MV 148,a,152,v,24
v_exp_f32 v128, v128
MV 156,a,152,v,40
v_add_f32 v3, v3, v126
v_add_f32 v3, v3, v127
MV 176,a,168,v,24
v_exp_f32 v129, v129
MV 184,a,168,v,40
ds_read_b128 a[236:239], v11 offset:27648
v_cvt_pk_bf16_f32 v123, v126, v127
MV 180,a,184,v,24
v_exp_f32 v130, v130
MV 188,a,184,v,40
ds_read_b128 a[240:243], v11 offset:28672
v_add_f32 v4, v4, v128
MV 196,a,184,v,56
buffer_load_dwordx4 v12, s[56:59], s71 offen offset:3072 sc1 lds
v_add_f32 v4, v4, v129
MV 204,a,184,v,72
v_exp_f32 v131, v131
MV 192,a,168,v,56
ds_read_b128 a[244:247], v11 offset:29696
v_cvt_pk_bf16_f32 v128, v128, v129
MV 200,a,168,v,72
v_exp_f32 v132, v132
MV 164,a,152,v,56
v_add_f32 v4, v4, v130
v_add_f32 v4, v4, v131
MV 172,a,152,v,72
v_exp_f32 v133, v133
MV 160,a,136,v,56
ds_read_b128 a[248:251], v11 offset:30720
v_cvt_pk_bf16_f32 v129, v130, v131
MV 168,a,136,v,72
v_exp_f32 v134, v134
MV 180,a,188,v,28
v_add_f32 v4, v4, v132
v_add_f32 v4, v4, v133
MV 188,a,188,v,44
v_exp_f32 v135, v135
MV 176,a,172,v,28
ds_read_b128 a[252:255], v11 offset:31744
v_cvt_pk_bf16_f32 v130, v132, v133
MV 184,a,172,v,44
v_exp_f32 v136, v136
MV 148,a,156,v,28
v_add_f32 v4, v4, v134
v_add_f32 v4, v4, v135
MV 156,a,156,v,44
v_exp_f32 v137, v137
MV 144,a,140,v,28
s_add_u32 s71, s71, 16384
v_cvt_pk_bf16_f32 v131, v134, v135
MV 152,a,140,v,44
v_exp_f32 v138, v138
MV 160,a,140,v,60
v_add_f32 v5, v5, v136
v_add_f32 v5, v5, v137
MV 168,a,140,v,76
v_exp_f32 v139, v139
MV 164,a,156,v,60
v_cvt_pk_bf16_f32 v136, v136, v137
MV 172,a,156,v,76
v_exp_f32 v140, v140
MV 192,a,172,v,60
v_add_f32 v5, v5, v138
v_add_f32 v5, v5, v139
MV 200,a,172,v,76
v_exp_f32 v141, v141
MV 196,a,188,v,60
v_cvt_pk_bf16_f32 v137, v138, v139
MV 204,a,188,v,76
v_exp_f32 v142, v142
v_add_f32 v5, v5, v140
v_add_f32 v5, v5, v141
v_exp_f32 v143, v143
v_cvt_pk_bf16_f32 v138, v140, v141
v_add_f32 v5, v5, v142
v_add_f32 v5, v5, v143
v_cvt_pk_bf16_f32 v139, v142, v143
s_waitcnt vmcnt(16) lgkmcnt(0)
MA 0,a,192,v,80
s_barrier
MA 32,a,192,v,88
s_add_u32 m0, s72, 0
ds_read_b128 a[128:131], v10 offset:16384
MA 4,a,196,v,80
ds_read_b128 a[132:135], v10 offset:17408
buffer_load_dwordx4 v12, s[52:55], s71 offen offset:0 sc1 lds
MA 36,a,196,v,88
v_exp_f32 v144, v144
MA 8,a,200,v,80
v_exp_f32 v145, v145
MA 40,a,200,v,88
v_exp_f32 v146, v146
MA 12,a,204,v,80
v_add_f32 v2, v2, v144
v_add_f32 v2, v2, v145
MA 44,a,204,v,88
ds_read_b128 a[136:139], v10 offset:18432
ds_read_b128 a[140:143], v10 offset:19456
MA 16,a,208,v,80
v_exp_f32 v147, v147
MA 48,a,208,v,88
ds_read_b128 a[144:147], v10 offset:20480
v_cvt_pk_bf16_f32 v144, v144, v145
MA 20,a,212,v,80
v_exp_f32 v148, v148
MA 52,a,212,v,88
v_add_f32 v2, v2, v146
v_add_f32 v2, v2, v147
MA 24,a,216,v,80
v_exp_f32 v149, v149
MA 56,a,216,v,88
buffer_load_dwordx4 v12, s[52:55], s71 offen offset:1024 sc1 lds
v_cvt_pk_bf16_f32 v145, v146, v147
MA 28,a,220,v,80
v_exp_f32 v150, v150
MA 60,a,220,v,88
v_add_f32 v2, v2, v148
v_add_f32 v2, v2, v149
MA 92,a,220,v,96
v_exp_f32 v151, v151
MA 124,a,220,v,104
ds_read_b128 a[148:151], v10 offset:21504
v_cvt_pk_bf16_f32 v146, v148, v149
MA 88,a,216,v,96
v_exp_f32 v152, v152
MA 120,a,216,v,104
v_add_f32 v2, v2, v150
v_add_f32 v2, v2, v151
MA 84,a,212,v,96
ds_read_b128 a[152:155], v10 offset:22528
ds_read_b128 a[156:159], v10 offset:23552
MA 116,a,212,v,104
v_exp_f32 v153, v153
MA 80,a,208,v,96
ds_read_b128 a[160:163], v10 offset:24576
v_cvt_pk_bf16_f32 v147, v150, v151
MA 112,a,208,v,104
v_exp_f32 v154, v154
MA 76,a,204,v,96
v_add_f32 v3, v3, v152
v_add_f32 v3, v3, v153
MA 108,a,204,v,104
v_exp_f32 v155, v155
MA 72,a,200,v,96
buffer_load_dwordx4 v12, s[52:55], s71 offen offset:2048 sc1 lds
v_cvt_pk_bf16_f32 v152, v152, v153
MA 104,a,200,v,104
v_exp_f32 v156, v156
MA 68,a,196,v,96
v_add_f32 v3, v3, v154
v_add_f32 v3, v3, v155
MA 100,a,196,v,104
v_exp_f32 v157, v157
MA 64,a,192,v,96
ds_read_b128 a[164:167], v10 offset:25600
v_cvt_pk_bf16_f32 v153, v154, v155
MA 96,a,192,v,104
v_exp_f32 v158, v158
MA 0,a,224,v,112
v_add_f32 v3, v3, v156
v_add_f32 v3, v3, v157
MA 32,a,224,v,120
v_exp_f32 v159, v159
MA 4,a,228,v,112
ds_read_b128 a[168:171], v10 offset:26624
v_cvt_pk_bf16_f32 v154, v156, v157
MA 36,a,228,v,120
v_exp_f32 v160, v160
MA 8,a,232,v,112
ds_read_b128 a[172:175], v10 offset:27648
v_add_f32 v3, v3, v158
MA 40,a,232,v,120
ds_read_b128 a[176:179], v10 offset:28672
v_add_f32 v3, v3, v159
MA 12,a,236,v,112
v_exp_f32 v161, v161
MA 44,a,236,v,120
ds_read_b128 a[180:183], v10 offset:29696
v_cvt_pk_bf16_f32 v155, v158, v159
MA 16,a,240,v,112
v_exp_f32 v162, v162
MA 48,a,240,v,120
v_add_f32 v4, v4, v160
v_add_f32 v4, v4, v161
MA 20,a,244,v,112
v_exp_f32 v163, v163
MA 52,a,244,v,120
buffer_load_dwordx4 v12, s[52:55], s71 offen offset:3072 sc1 lds
v_cvt_pk_bf16_f32 v160, v160, v161
MA 24,a,248,v,112
v_exp_f32 v164, v164
MA 56,a,248,v,120
v_add_f32 v4, v4, v162
v_add_f32 v4, v4, v163
MA 28,a,252,v,112
v_exp_f32 v165, v165
MA 60,a,252,v,120
ds_read_b128 a[184:187], v10 offset:30720
v_cvt_pk_bf16_f32 v161, v162, v163
MA 92,a,252,v,128
v_exp_f32 v166, v166
MA 124,a,252,v,136
v_add_f32 v4, v4, v164
v_add_f32 v4, v4, v165
MA 88,a,248,v,128
ds_read_b128 a[188:191], v10 offset:31744
s_sub_u32 s74, s74, 1
MA 120,a,248,v,136
v_exp_f32 v167, v167
MA 84,a,244,v,128
v_cvt_pk_bf16_f32 v162, v164, v165
MA 116,a,244,v,136
v_exp_f32 v168, v168
MA 80,a,240,v,128
v_add_f32 v4, v4, v166
v_add_f32 v4, v4, v167
MA 112,a,240,v,136
v_exp_f32 v169, v169
MA 76,a,236,v,128
v_cvt_pk_bf16_f32 v163, v166, v167
MA 108,a,236,v,136
v_exp_f32 v170, v170
MA 72,a,232,v,128
v_add_f32 v5, v5, v168
v_add_f32 v5, v5, v169
MA 104,a,232,v,136
v_exp_f32 v171, v171
MA 68,a,228,v,128
v_cvt_pk_bf16_f32 v168, v168, v169
MA 100,a,228,v,136
v_exp_f32 v172, v172
MA 64,a,224,v,128
v_add_f32 v5, v5, v170
v_add_f32 v5, v5, v171
MA 96,a,224,v,136
v_exp_f32 v173, v173
v_cvt_pk_bf16_f32 v169, v170, v171
v_exp_f32 v174, v174
v_add_f32 v5, v5, v172
v_add_f32 v5, v5, v173
v_exp_f32 v175, v175
v_cvt_pk_bf16_f32 v170, v172, v173
v_add_f32 v5, v5, v174
v_add_f32 v5, v5, v175
v_cvt_pk_bf16_f32 v171, v174, v175
s_cbranch_scc1 L_p3_d1m_top
s_waitcnt lgkmcnt(0)
v_xor_b32 v11, 0x8000, v11
v_mfma_f32_16x16x32_bf16 v[80:83], a[128:131], v[16:19], 0
s_add_u32 m0, s73, 16384
ds_read_b128 a[192:195], v11 offset:0
v_mfma_f32_16x16x32_bf16 v[88:91], a[128:131], v[32:35], 0
v_exp_f32 v176, v176
v_mfma_f32_16x16x32_bf16 v[84:87], a[144:147], v[16:19], 0
ds_read_b128 a[196:199], v11 offset:1024
buffer_load_dwordx4 v12, s[56:59], s71 offen offset:0 sc1 lds
v_mfma_f32_16x16x32_bf16 v[92:95], a[144:147], v[32:35], 0
v_exp_f32 v177, v177
v_mfma_f32_16x16x32_bf16 v[112:115], a[160:163], v[16:19], 0
v_exp_f32 v178, v178
v_mfma_f32_16x16x32_bf16 v[120:123], a[160:163], v[32:35], 0
v_add_f32 v2, v2, v176
v_add_f32 v2, v2, v177
v_mfma_f32_16x16x32_bf16 v[116:119], a[176:179], v[16:19], 0
v_exp_f32 v179, v179
v_mfma_f32_16x16x32_bf16 v[124:127], a[176:179], v[32:35], 0
ds_read_b128 a[200:203], v11 offset:2048
v_cvt_pk_bf16_f32 v176, v176, v177
v_mfma_f32_16x16x32_bf16 v[132:135], a[176:179], v[48:51], 0
v_exp_f32 v180, v180
v_mfma_f32_16x16x32_bf16 v[140:143], a[176:179], v[64:67], 0
v_add_f32 v2, v2, v178
v_add_f32 v2, v2, v179
v_mfma_f32_16x16x32_bf16 v[128:131], a[160:163], v[48:51], 0
v_exp_f32 v181, v181
v_mfma_f32_16x16x32_bf16 v[136:139], a[160:163], v[64:67], 0
ds_read_b128 a[204:207], v11 offset:3072
v_cvt_pk_bf16_f32 v177, v178, v179
v_mfma_f32_16x16x32_bf16 v[100:103], a[144:147], v[48:51], 0
v_exp_f32 v182, v182
v_mfma_f32_16x16x32_bf16 v[108:111], a[144:147], v[64:67], 0
buffer_load_dwordx4 v12, s[56:59], s71 offen offset:1024 sc1 lds
v_add_f32 v2, v2, v180
v_mfma_f32_16x16x32_bf16 v[96:99], a[128:131], v[48:51], 0
ds_read_b128 a[208:211], v11 offset:4096
v_add_f32 v2, v2, v181
v_mfma_f32_16x16x32_bf16 v[104:107], a[128:131], v[64:67], 0
v_exp_f32 v183, v183
MV 116,a,180,v,20
ds_read_b128 a[212:215], v11 offset:5120
v_cvt_pk_bf16_f32 v178, v180, v181
MV 124,a,180,v,36
v_exp_f32 v184, v184
MV 112,a,164,v,20
v_add_f32 v2, v2, v182
v_add_f32 v2, v2, v183
MV 120,a,164,v,36
v_exp_f32 v185, v185
MV 84,a,148,v,20
ds_read_b128 a[216:219], v11 offset:6144
v_cvt_pk_bf16_f32 v179, v182, v183
MV 92,a,148,v,36
v_exp_f32 v186, v186
MV 80,a,132,v,20
v_add_f32 v3, v3, v184
v_add_f32 v3, v3, v185
MV 88,a,132,v,36
v_exp_f32 v187, v187
MV 96,a,132,v,52
ds_read_b128 a[220:223], v11 offset:7168
v_cvt_pk_bf16_f32 v184, v184, v185
MV 104,a,132,v,68
ds_read_b128 a[224:227], v11 offset:8192
buffer_load_dwordx4 v12, s[56:59], s71 offen offset:2048 sc1 lds
MV 100,a,148,v,52
v_exp_f32 v188, v188
MV 108,a,148,v,68
v_add_f32 v3, v3, v186
v_add_f32 v3, v3, v187
MV 128,a,164,v,52
v_exp_f32 v189, v189
MV 136,a,164,v,68
ds_read_b128 a[228:231], v11 offset:9216
v_cvt_pk_bf16_f32 v185, v186, v187
MV 132,a,180,v,52
v_exp_f32 v190, v190
MV 140,a,180,v,68
v_add_f32 v3, v3, v188
v_add_f32 v3, v3, v189
MV 80,a,136,v,24
v_exp_f32 v191, v191
MV 88,a,136,v,40
ds_read_b128 a[232:235], v11 offset:10240
v_cvt_pk_bf16_f32 v186, v188, v189
MV 84,a,152,v,24
v_exp_f32 v192, v192
MV 92,a,152,v,40
buffer_load_dwordx4 v12, s[56:59], s71 offen offset:3072 sc1 lds
v_add_f32 v3, v3, v190
MV 112,a,168,v,24
ds_read_b128 a[236:239], v11 offset:11264
v_add_f32 v3, v3, v191
MV 120,a,168,v,40
v_exp_f32 v193, v193
MV 116,a,184,v,24
ds_read_b128 a[240:243], v11 offset:12288
v_cvt_pk_bf16_f32 v187, v190, v191
MV 124,a,184,v,40
v_exp_f32 v194, v194
MV 132,a,184,v,56
v_add_f32 v4, v4, v192
v_add_f32 v4, v4, v193
MV 140,a,184,v,72
v_exp_f32 v195, v195
MV 128,a,168,v,56
ds_read_b128 a[244:247], v11 offset:13312
v_cvt_pk_bf16_f32 v192, v192, v193
MV 136,a,168,v,72
v_exp_f32 v196, v196
MV 100,a,152,v,56
v_add_f32 v4, v4, v194
v_add_f32 v4, v4, v195
MV 108,a,152,v,72
v_exp_f32 v197, v197
MV 96,a,136,v,56
ds_read_b128 a[248:251], v11 offset:14336
v_cvt_pk_bf16_f32 v193, v194, v195
MV 104,a,136,v,72
v_exp_f32 v198, v198
MV 116,a,188,v,28
s_add_u32 s71, s71, 16384
v_add_f32 v4, v4, v196
MV 124,a,188,v,44
ds_read_b128 a[252:255], v11 offset:15360
v_add_f32 v4, v4, v197
MV 112,a,172,v,28
v_exp_f32 v199, v199
MV 120,a,172,v,44
s_xor_b32 s73, s73, 0x8000
v_cvt_pk_bf16_f32 v194, v196, v197
MV 84,a,156,v,28
v_exp_f32 v200, v200
MV 92,a,156,v,44
v_add_f32 v4, v4, v198
v_add_f32 v4, v4, v199
MV 80,a,140,v,28
v_exp_f32 v201, v201
MV 88,a,140,v,44
v_cvt_pk_bf16_f32 v195, v198, v199
MV 96,a,140,v,60
v_exp_f32 v202, v202
MV 104,a,140,v,76
v_add_f32 v5, v5, v200
v_add_f32 v5, v5, v201
MV 100,a,156,v,60
v_exp_f32 v203, v203
MV 108,a,156,v,76
v_cvt_pk_bf16_f32 v200, v200, v201
MV 128,a,172,v,60
v_exp_f32 v204, v204
MV 136,a,172,v,76
v_add_f32 v5, v5, v202
v_add_f32 v5, v5, v203
MV 132,a,188,v,60
v_exp_f32 v205, v205
MV 140,a,188,v,76
v_cvt_pk_bf16_f32 v201, v202, v203
v_exp_f32 v206, v206
v_add_f32 v5, v5, v204
v_add_f32 v5, v5, v205
v_exp_f32 v207, v207
v_cvt_pk_bf16_f32 v202, v204, v205
v_add_f32 v5, v5, v206
v_add_f32 v5, v5, v207
v_cvt_pk_bf16_f32 v203, v206, v207
s_waitcnt vmcnt(16) lgkmcnt(0)
MA 0,a,192,v,144
s_barrier
v_xor_b32 v10, 0x8000, v10
MA 32,a,192,v,152
s_add_u32 m0, s72, 16384
ds_read_b128 a[128:131], v10 offset:0
MA 4,a,196,v,144
ds_read_b128 a[132:135], v10 offset:1024
buffer_load_dwordx4 v12, s[52:55], s71 offen offset:0 sc1 lds
MA 36,a,196,v,152
v_exp_f32 v80, v80
MA 8,a,200,v,144
v_exp_f32 v81, v81
MA 40,a,200,v,152
v_exp_f32 v82, v82
MA 12,a,204,v,144
v_add_f32 v2, v2, v80
v_add_f32 v2, v2, v81
MA 44,a,204,v,152
ds_read_b128 a[136:139], v10 offset:2048
ds_read_b128 a[140:143], v10 offset:3072
MA 16,a,208,v,144
v_exp_f32 v83, v83
MA 48,a,208,v,152
ds_read_b128 a[144:147], v10 offset:4096
v_cvt_pk_bf16_f32 v80, v80, v81
MA 20,a,212,v,144
v_exp_f32 v84, v84
MA 52,a,212,v,152
v_add_f32 v2, v2, v82
v_add_f32 v2, v2, v83
MA 24,a,216,v,144
v_exp_f32 v85, v85
MA 56,a,216,v,152
buffer_load_dwordx4 v12, s[52:55], s71 offen offset:1024 sc1 lds
v_cvt_pk_bf16_f32 v81, v82, v83
MA 28,a,220,v,144
v_exp_f32 v86, v86
MA 60,a,220,v,152
v_add_f32 v2, v2, v84
v_add_f32 v2, v2, v85
MA 92,a,220,v,160
v_exp_f32 v87, v87
MA 124,a,220,v,168
ds_read_b128 a[148:151], v10 offset:5120
v_cvt_pk_bf16_f32 v82, v84, v85
MA 88,a,216,v,160
v_exp_f32 v88, v88
MA 120,a,216,v,168
v_add_f32 v2, v2, v86
v_add_f32 v2, v2, v87
MA 84,a,212,v,160
ds_read_b128 a[152:155], v10 offset:6144
ds_read_b128 a[156:159], v10 offset:7168
MA 116,a,212,v,168
v_exp_f32 v89, v89
MA 80,a,208,v,160
ds_read_b128 a[160:163], v10 offset:8192
v_cvt_pk_bf16_f32 v83, v86, v87
MA 112,a,208,v,168
v_exp_f32 v90, v90
MA 76,a,204,v,160
v_add_f32 v3, v3, v88
v_add_f32 v3, v3, v89
MA 108,a,204,v,168
v_exp_f32 v91, v91
MA 72,a,200,v,160
buffer_load_dwordx4 v12, s[52:55], s71 offen offset:2048 sc1 lds
v_cvt_pk_bf16_f32 v88, v88, v89
MA 104,a,200,v,168
v_exp_f32 v92, v92
MA 68,a,196,v,160
v_add_f32 v3, v3, v90
v_add_f32 v3, v3, v91
MA 100,a,196,v,168
v_exp_f32 v93, v93
MA 64,a,192,v,160
ds_read_b128 a[164:167], v10 offset:9216
v_cvt_pk_bf16_f32 v89, v90, v91
MA 96,a,192,v,168
v_exp_f32 v94, v94
MA 0,a,224,v,176
v_add_f32 v3, v3, v92
v_add_f32 v3, v3, v93
MA 32,a,224,v,184
v_exp_f32 v95, v95
MA 4,a,228,v,176
ds_read_b128 a[168:171], v10 offset:10240
v_cvt_pk_bf16_f32 v90, v92, v93
MA 36,a,228,v,184
v_exp_f32 v96, v96
MA 8,a,232,v,176
ds_read_b128 a[172:175], v10 offset:11264
v_add_f32 v3, v3, v94
MA 40,a,232,v,184
ds_read_b128 a[176:179], v10 offset:12288
v_add_f32 v3, v3, v95
MA 12,a,236,v,176
v_exp_f32 v97, v97
MA 44,a,236,v,184
ds_read_b128 a[180:183], v10 offset:13312
v_cvt_pk_bf16_f32 v91, v94, v95
MA 16,a,240,v,176
v_exp_f32 v98, v98
MA 48,a,240,v,184
v_add_f32 v4, v4, v96
v_add_f32 v4, v4, v97
MA 20,a,244,v,176
v_exp_f32 v99, v99
MA 52,a,244,v,184
buffer_load_dwordx4 v12, s[52:55], s71 offen offset:3072 sc1 lds
v_cvt_pk_bf16_f32 v96, v96, v97
MA 24,a,248,v,176
v_exp_f32 v100, v100
MA 56,a,248,v,184
v_add_f32 v4, v4, v98
v_add_f32 v4, v4, v99
MA 28,a,252,v,176
v_exp_f32 v101, v101
MA 60,a,252,v,184
ds_read_b128 a[184:187], v10 offset:14336
v_cvt_pk_bf16_f32 v97, v98, v99
MA 92,a,252,v,192
v_exp_f32 v102, v102
MA 124,a,252,v,200
v_add_f32 v4, v4, v100
v_add_f32 v4, v4, v101
MA 88,a,248,v,192
ds_read_b128 a[188:191], v10 offset:15360
s_xor_b32 s72, s72, 0x8000
MA 120,a,248,v,200
v_exp_f32 v103, v103
MA 84,a,244,v,192
v_cvt_pk_bf16_f32 v98, v100, v101
MA 116,a,244,v,200
v_exp_f32 v104, v104
MA 80,a,240,v,192
v_add_f32 v4, v4, v102
v_add_f32 v4, v4, v103
MA 112,a,240,v,200
v_exp_f32 v105, v105
MA 76,a,236,v,192
v_cvt_pk_bf16_f32 v99, v102, v103
MA 108,a,236,v,200
v_exp_f32 v106, v106
MA 72,a,232,v,192
v_add_f32 v5, v5, v104
v_add_f32 v5, v5, v105
MA 104,a,232,v,200
v_exp_f32 v107, v107
MA 68,a,228,v,192
v_cvt_pk_bf16_f32 v104, v104, v105
MA 100,a,228,v,200
v_exp_f32 v108, v108
MA 64,a,224,v,192
v_add_f32 v5, v5, v106
v_add_f32 v5, v5, v107
MA 96,a,224,v,200
v_exp_f32 v109, v109
v_cvt_pk_bf16_f32 v105, v106, v107
v_exp_f32 v110, v110
v_add_f32 v5, v5, v108
v_add_f32 v5, v5, v109
v_exp_f32 v111, v111
v_cvt_pk_bf16_f32 v106, v108, v109
v_add_f32 v5, v5, v110
v_add_f32 v5, v5, v111
v_cvt_pk_bf16_f32 v107, v110, v111
s_branch L_p3_d0_top
L_p3_d1m_top:
s_waitcnt lgkmcnt(0)
v_xor_b32 v11, 0x8000, v11
v_mfma_f32_16x16x32_bf16 v[80:83], a[128:131], v[16:19], 0
s_add_u32 m0, s73, 16384
ds_read_b128 a[192:195], v11 offset:0
v_mfma_f32_16x16x32_bf16 v[88:91], a[128:131], v[32:35], 0
v_exp_f32 v176, v176
v_mfma_f32_16x16x32_bf16 v[96:99], a[128:131], v[48:51], 0
ds_read_b128 a[196:199], v11 offset:1024
buffer_load_dwordx4 v12, s[56:59], s71 offen offset:0 sc1 lds
v_mfma_f32_16x16x32_bf16 v[104:107], a[128:131], v[64:67], 0
v_exp_f32 v177, v177
MV 80,a,132,v,20
v_exp_f32 v178, v178
MV 88,a,132,v,36
v_add_f32 v2, v2, v176
v_add_f32 v2, v2, v177
MV 96,a,132,v,52
v_exp_f32 v179, v179
MV 104,a,132,v,68
ds_read_b128 a[200:203], v11 offset:2048
v_cvt_pk_bf16_f32 v176, v176, v177
MV 80,a,136,v,24
v_exp_f32 v180, v180
MV 88,a,136,v,40
v_add_f32 v2, v2, v178
v_add_f32 v2, v2, v179
MV 96,a,136,v,56
v_exp_f32 v181, v181
MV 104,a,136,v,72
ds_read_b128 a[204:207], v11 offset:3072
v_cvt_pk_bf16_f32 v177, v178, v179
MV 80,a,140,v,28
v_exp_f32 v182, v182
MV 88,a,140,v,44
buffer_load_dwordx4 v12, s[56:59], s71 offen offset:1024 sc1 lds
v_add_f32 v2, v2, v180
MV 96,a,140,v,60
ds_read_b128 a[208:211], v11 offset:4096
v_add_f32 v2, v2, v181
MV 104,a,140,v,76
v_exp_f32 v183, v183
v_mfma_f32_16x16x32_bf16 v[84:87], a[144:147], v[16:19], 0
ds_read_b128 a[212:215], v11 offset:5120
v_cvt_pk_bf16_f32 v178, v180, v181
v_mfma_f32_16x16x32_bf16 v[92:95], a[144:147], v[32:35], 0
v_exp_f32 v184, v184
v_mfma_f32_16x16x32_bf16 v[100:103], a[144:147], v[48:51], 0
v_add_f32 v2, v2, v182
v_add_f32 v2, v2, v183
v_mfma_f32_16x16x32_bf16 v[108:111], a[144:147], v[64:67], 0
v_exp_f32 v185, v185
MV 84,a,148,v,20
ds_read_b128 a[216:219], v11 offset:6144
v_cvt_pk_bf16_f32 v179, v182, v183
MV 92,a,148,v,36
v_exp_f32 v186, v186
MV 100,a,148,v,52
v_add_f32 v3, v3, v184
v_add_f32 v3, v3, v185
MV 108,a,148,v,68
v_exp_f32 v187, v187
MV 84,a,152,v,24
ds_read_b128 a[220:223], v11 offset:7168
v_cvt_pk_bf16_f32 v184, v184, v185
MV 92,a,152,v,40
ds_read_b128 a[224:227], v11 offset:8192
buffer_load_dwordx4 v12, s[56:59], s71 offen offset:2048 sc1 lds
MV 100,a,152,v,56
v_exp_f32 v188, v188
MV 108,a,152,v,72
v_add_f32 v3, v3, v186
v_add_f32 v3, v3, v187
MV 84,a,156,v,28
v_exp_f32 v189, v189
MV 92,a,156,v,44
ds_read_b128 a[228:231], v11 offset:9216
v_cvt_pk_bf16_f32 v185, v186, v187
MV 100,a,156,v,60
v_exp_f32 v190, v190
MV 108,a,156,v,76
v_add_f32 v3, v3, v188
v_add_f32 v3, v3, v189
v_mfma_f32_16x16x32_bf16 v[112:115], a[160:163], v[16:19], 0
v_exp_f32 v191, v191
v_mfma_f32_16x16x32_bf16 v[120:123], a[160:163], v[32:35], 0
ds_read_b128 a[232:235], v11 offset:10240
v_cvt_pk_bf16_f32 v186, v188, v189
v_mfma_f32_16x16x32_bf16 v[128:131], a[160:163], v[48:51], 0
v_exp_f32 v192, v192
v_mfma_f32_16x16x32_bf16 v[136:139], a[160:163], v[64:67], 0
buffer_load_dwordx4 v12, s[56:59], s71 offen offset:3072 sc1 lds
v_add_f32 v3, v3, v190
MV 112,a,164,v,20
ds_read_b128 a[236:239], v11 offset:11264
v_add_f32 v3, v3, v191
MV 120,a,164,v,36
v_exp_f32 v193, v193
MV 128,a,164,v,52
ds_read_b128 a[240:243], v11 offset:12288
v_cvt_pk_bf16_f32 v187, v190, v191
MV 136,a,164,v,68
v_exp_f32 v194, v194
MV 112,a,168,v,24
v_add_f32 v4, v4, v192
v_add_f32 v4, v4, v193
MV 120,a,168,v,40
v_exp_f32 v195, v195
MV 128,a,168,v,56
v_cvt_pk_bf16_f32 v192, v192, v193
v_add_u32 v246, 0, v13
MV 136,a,168,v,72
v_exp_f32 v196, v196
MV 112,a,172,v,28
ds_read_b128 a[244:247], v11 offset:13312
v_add_f32 v4, v4, v194
MV 120,a,172,v,44
v_add_f32 v4, v4, v195
v_cmp_gt_i32_e64 s[84:85], 0, v246
MV 128,a,172,v,60
ds_read_b128 a[248:251], v11 offset:14336
v_cmp_gt_i32_e64 s[86:87], 1, v246
MV 136,a,172,v,76
v_exp_f32 v197, v197
v_mfma_f32_16x16x32_bf16 v[116:119], a[176:179], v[16:19], 0
v_cvt_pk_bf16_f32 v193, v194, v195
v_cmp_gt_i32_e64 s[88:89], 2, v246
v_mfma_f32_16x16x32_bf16 v[124:127], a[176:179], v[32:35], 0
v_exp_f32 v198, v198
v_mfma_f32_16x16x32_bf16 v[132:135], a[176:179], v[48:51], 0
s_add_u32 s71, s71, 16384
v_add_f32 v4, v4, v196
v_mfma_f32_16x16x32_bf16 v[140:143], a[176:179], v[64:67], 0
v_add_f32 v4, v4, v197
v_cmp_gt_i32_e64 s[90:91], 3, v246
MV 116,a,180,v,20
v_exp_f32 v199, v199
MV 124,a,180,v,36
ds_read_b128 a[252:255], v11 offset:15360
v_cvt_pk_bf16_f32 v194, v196, v197
MV 132,a,180,v,52
v_cndmask_b32_e64 v96, v96, v14, s[84:85]
v_cndmask_b32_e64 v97, v97, v14, s[86:87]
MV 140,a,180,v,68
v_exp_f32 v200, v200
MV 116,a,184,v,24
v_add_f32 v4, v4, v198
v_add_f32 v4, v4, v199
MV 124,a,184,v,40
v_cndmask_b32_e64 v98, v98, v14, s[88:89]
v_cndmask_b32_e64 v99, v99, v14, s[90:91]
MV 132,a,184,v,56
v_exp_f32 v201, v201
MV 140,a,184,v,72
v_cvt_pk_bf16_f32 v195, v198, v199
v_add_u32 v247, -16, v13
MV 116,a,188,v,28
v_exp_f32 v202, v202
MV 124,a,188,v,44
v_add_f32 v5, v5, v200
v_add_f32 v5, v5, v201
MV 132,a,188,v,60
s_xor_b32 s73, s73, 0x8000
v_cmp_gt_i32_e64 s[92:93], 0, v247
MV 140,a,188,v,76
v_exp_f32 v203, v203
v_cvt_pk_bf16_f32 v200, v200, v201
v_cmp_gt_i32_e64 s[94:95], 1, v247
v_exp_f32 v204, v204
v_add_f32 v5, v5, v202
v_cmp_gt_i32_e64 s[96:97], 2, v247
v_add_f32 v5, v5, v203
v_exp_f32 v205, v205
v_cmp_gt_i32_e64 s[98:99], 3, v247
v_cvt_pk_bf16_f32 v201, v202, v203
v_exp_f32 v206, v206
v_cndmask_b32_e64 v100, v100, v14, s[92:93]
v_add_f32 v5, v5, v204
v_cndmask_b32_e64 v101, v101, v14, s[94:95]
v_add_f32 v5, v5, v205
v_exp_f32 v207, v207
v_cvt_pk_bf16_f32 v202, v204, v205
v_cndmask_b32_e64 v102, v102, v14, s[96:97]
v_add_f32 v5, v5, v206
v_add_f32 v5, v5, v207
v_cndmask_b32_e64 v103, v103, v14, s[98:99]
v_cvt_pk_bf16_f32 v203, v206, v207
s_waitcnt vmcnt(16) lgkmcnt(0)
MA 0,a,192,v,144
s_barrier
v_xor_b32 v10, 0x8000, v10
MA 32,a,192,v,152
s_add_u32 m0, s72, 16384
ds_read_b128 a[128:131], v10 offset:0
MA 4,a,196,v,144
ds_read_b128 a[132:135], v10 offset:1024
buffer_load_dwordx4 v12, s[52:55], s71 offen offset:0 sc1 lds
MA 36,a,196,v,152
v_exp_f32 v80, v80
MA 8,a,200,v,144
v_exp_f32 v81, v81
MA 40,a,200,v,152
v_exp_f32 v82, v82
MA 12,a,204,v,144
v_add_f32 v2, v2, v80
v_add_f32 v2, v2, v81
MA 44,a,204,v,152
ds_read_b128 a[136:139], v10 offset:2048
v_add_u32 v246, -32, v13
MA 16,a,208,v,144
v_exp_f32 v83, v83
MA 48,a,208,v,152
ds_read_b128 a[140:143], v10 offset:3072
v_cvt_pk_bf16_f32 v80, v80, v81
MA 20,a,212,v,144
v_exp_f32 v84, v84
MA 52,a,212,v,152
v_add_f32 v2, v2, v82
v_add_f32 v2, v2, v83
MA 24,a,216,v,144
ds_read_b128 a[144:147], v10 offset:4096
v_cmp_gt_i32_e64 s[84:85], 0, v246
MA 56,a,216,v,152
v_exp_f32 v85, v85
MA 28,a,220,v,144
v_cvt_pk_bf16_f32 v81, v82, v83
v_cmp_gt_i32_e64 s[86:87], 1, v246
MA 60,a,220,v,152
v_exp_f32 v86, v86
MA 92,a,220,v,160
v_add_f32 v2, v2, v84
v_add_f32 v2, v2, v85
MA 124,a,220,v,168
ds_read_b128 a[148:151], v10 offset:5120
buffer_load_dwordx4 v12, s[52:55], s71 offen offset:1024 sc1 lds
MA 88,a,216,v,160
v_exp_f32 v87, v87
MA 120,a,216,v,168
v_cvt_pk_bf16_f32 v82, v84, v85
v_cmp_gt_i32_e64 s[88:89], 2, v246
MA 84,a,212,v,160
v_exp_f32 v88, v88
MA 116,a,212,v,168
v_add_f32 v2, v2, v86
v_add_f32 v2, v2, v87
MA 80,a,208,v,160
ds_read_b128 a[152:155], v10 offset:6144
v_cmp_gt_i32_e64 s[90:91], 3, v246
MA 112,a,208,v,168
v_exp_f32 v89, v89
MA 76,a,204,v,160
ds_read_b128 a[156:159], v10 offset:7168
v_cvt_pk_bf16_f32 v83, v86, v87
MA 108,a,204,v,168
v_exp_f32 v90, v90
MA 72,a,200,v,160
v_add_f32 v3, v3, v88
v_add_f32 v3, v3, v89
MA 104,a,200,v,168
v_exp_f32 v91, v91
MA 68,a,196,v,160
v_cvt_pk_bf16_f32 v88, v88, v89
v_cndmask_b32_e64 v128, v128, v14, s[84:85]
MA 100,a,196,v,168
v_exp_f32 v92, v92
MA 64,a,192,v,160
ds_read_b128 a[160:163], v10 offset:8192
v_add_f32 v3, v3, v90
MA 96,a,192,v,168
v_add_f32 v3, v3, v91
v_cndmask_b32_e64 v129, v129, v14, s[86:87]
MA 0,a,224,v,176
v_exp_f32 v93, v93
MA 32,a,224,v,184
buffer_load_dwordx4 v12, s[52:55], s71 offen offset:2048 sc1 lds
v_cvt_pk_bf16_f32 v89, v90, v91
MA 4,a,228,v,176
ds_read_b128 a[164:167], v10 offset:9216
v_cndmask_b32_e64 v130, v130, v14, s[88:89]
MA 36,a,228,v,184
v_exp_f32 v94, v94
MA 8,a,232,v,176
v_add_f32 v3, v3, v92
v_add_f32 v3, v3, v93
MA 40,a,232,v,184
v_exp_f32 v95, v95
MA 12,a,236,v,176
ds_read_b128 a[168:171], v10 offset:10240
v_cvt_pk_bf16_f32 v90, v92, v93
MA 44,a,236,v,184
ds_read_b128 a[172:175], v10 offset:11264
v_cndmask_b32_e64 v131, v131, v14, s[90:91]
MA 16,a,240,v,176
v_exp_f32 v96, v96
MA 48,a,240,v,184
v_add_f32 v3, v3, v94
v_add_f32 v3, v3, v95
MA 20,a,244,v,176
v_exp_f32 v97, v97
MA 52,a,244,v,184
v_cvt_pk_bf16_f32 v91, v94, v95
v_add_u32 v247, -48, v13
MA 24,a,248,v,176
v_exp_f32 v98, v98
MA 56,a,248,v,184
ds_read_b128 a[176:179], v10 offset:12288
v_add_f32 v4, v4, v96
MA 28,a,252,v,176
v_add_f32 v4, v4, v97
v_cmp_gt_i32_e64 s[92:93], 0, v247
MA 60,a,252,v,184
v_exp_f32 v99, v99
MA 92,a,252,v,192
ds_read_b128 a[180:183], v10 offset:13312
v_cvt_pk_bf16_f32 v96, v96, v97
MA 124,a,252,v,200
buffer_load_dwordx4 v12, s[52:55], s71 offen offset:3072 sc1 lds
v_cmp_gt_i32_e64 s[94:95], 1, v247
MA 88,a,248,v,192
v_exp_f32 v100, v100
MA 120,a,248,v,200
v_add_f32 v4, v4, v98
v_add_f32 v4, v4, v99
MA 84,a,244,v,192
v_exp_f32 v101, v101
MA 116,a,244,v,200
ds_read_b128 a[184:187], v10 offset:14336
v_cvt_pk_bf16_f32 v97, v98, v99
MA 80,a,240,v,192
v_exp_f32 v102, v102
MA 112,a,240,v,200
v_add_f32 v4, v4, v100
v_add_f32 v4, v4, v101
MA 76,a,236,v,192
ds_read_b128 a[188:191], v10 offset:15360
v_cmp_gt_i32_e64 s[96:97], 2, v247
MA 108,a,236,v,200
v_exp_f32 v103, v103
MA 72,a,232,v,192
v_cvt_pk_bf16_f32 v98, v100, v101
v_cmp_gt_i32_e64 s[98:99], 3, v247
MA 104,a,232,v,200
v_exp_f32 v104, v104
MA 68,a,228,v,192
v_add_f32 v4, v4, v102
v_add_f32 v4, v4, v103
MA 100,a,228,v,200
v_exp_f32 v105, v105
MA 64,a,224,v,192
s_xor_b32 s72, s72, 0x8000
v_cvt_pk_bf16_f32 v99, v102, v103
MA 96,a,224,v,200
v_exp_f32 v106, v106
v_add_f32 v5, v5, v104
v_cndmask_b32_e64 v132, v132, v14, s[92:93]
v_add_f32 v5, v5, v105
v_exp_f32 v107, v107
v_cvt_pk_bf16_f32 v104, v104, v105
v_exp_f32 v108, v108
v_cndmask_b32_e64 v133, v133, v14, s[94:95]
v_add_f32 v5, v5, v106
v_add_f32 v5, v5, v107
v_exp_f32 v109, v109
v_cvt_pk_bf16_f32 v105, v106, v107
v_cndmask_b32_e64 v134, v134, v14, s[96:97]
v_exp_f32 v110, v110
v_add_f32 v5, v5, v108
v_add_f32 v5, v5, v109
v_exp_f32 v111, v111
v_cndmask_b32_e64 v135, v135, v14, s[98:99]
v_cvt_pk_bf16_f32 v106, v108, v109
v_add_f32 v5, v5, v110
v_add_f32 v5, v5, v111
v_cvt_pk_bf16_f32 v107, v110, v111
L_p3_d0m_top:
s_waitcnt lgkmcnt(0)
v_mfma_f32_16x16x32_bf16 v[144:147], a[128:131], v[16:19], 0
s_add_u32 m0, s73, 0
ds_read_b128 a[192:195], v11 offset:16384
v_mfma_f32_16x16x32_bf16 v[152:155], a[128:131], v[32:35], 0
v_exp_f32 v112, v112
v_mfma_f32_16x16x32_bf16 v[168:171], a[128:131], v[64:67], 0
v_exp_f32 v113, v113
MV 144,a,132,v,20
ds_read_b128 a[196:199], v11 offset:17408
buffer_load_dwordx4 v12, s[56:59], s71 offen offset:0 sc1 lds
MV 152,a,132,v,36
v_exp_f32 v114, v114
MV 168,a,132,v,68
v_add_f32 v2, v2, v112
v_add_f32 v2, v2, v113
MV 144,a,136,v,24
v_exp_f32 v115, v115
MV 152,a,136,v,40
ds_read_b128 a[200:203], v11 offset:18432
v_cvt_pk_bf16_f32 v112, v112, v113
MV 168,a,136,v,72
v_exp_f32 v116, v116
MV 144,a,140,v,28
ds_read_b128 a[204:207], v11 offset:19456
v_add_f32 v2, v2, v114
MV 152,a,140,v,44
ds_read_b128 a[208:211], v11 offset:20480
v_add_f32 v2, v2, v115
MV 168,a,140,v,76
v_exp_f32 v117, v117
v_mfma_f32_16x16x32_bf16 v[148:151], a[144:147], v[16:19], 0
buffer_load_dwordx4 v12, s[56:59], s71 offen offset:1024 sc1 lds
v_cvt_pk_bf16_f32 v113, v114, v115
v_mfma_f32_16x16x32_bf16 v[156:159], a[144:147], v[32:35], 0
v_exp_f32 v118, v118
v_mfma_f32_16x16x32_bf16 v[172:175], a[144:147], v[64:67], 0
v_add_f32 v2, v2, v116
v_add_f32 v2, v2, v117
MV 148,a,148,v,20
v_exp_f32 v119, v119
MV 156,a,148,v,36
ds_read_b128 a[212:215], v11 offset:21504
v_cvt_pk_bf16_f32 v114, v116, v117
MV 172,a,148,v,68
v_exp_f32 v120, v120
MV 148,a,152,v,24
v_add_f32 v2, v2, v118
v_add_f32 v2, v2, v119
MV 156,a,152,v,40
v_exp_f32 v121, v121
MV 172,a,152,v,72
ds_read_b128 a[216:219], v11 offset:22528
v_cvt_pk_bf16_f32 v115, v118, v119
MV 148,a,156,v,28
v_exp_f32 v122, v122
MV 156,a,156,v,44
ds_read_b128 a[220:223], v11 offset:23552
v_add_f32 v3, v3, v120
MV 172,a,156,v,76
ds_read_b128 a[224:227], v11 offset:24576
v_add_f32 v3, v3, v121
v_mfma_f32_16x16x32_bf16 v[176:179], a[160:163], v[16:19], 0
v_exp_f32 v123, v123
v_mfma_f32_16x16x32_bf16 v[184:187], a[160:163], v[32:35], 0
buffer_load_dwordx4 v12, s[56:59], s71 offen offset:2048 sc1 lds
v_cvt_pk_bf16_f32 v120, v120, v121
v_mfma_f32_16x16x32_bf16 v[200:203], a[160:163], v[64:67], 0
v_exp_f32 v124, v124
MV 176,a,164,v,20
v_add_f32 v3, v3, v122
v_add_f32 v3, v3, v123
MV 184,a,164,v,36
v_exp_f32 v125, v125
MV 200,a,164,v,68
ds_read_b128 a[228:231], v11 offset:25600
v_cvt_pk_bf16_f32 v121, v122, v123
MV 176,a,168,v,24
v_exp_f32 v126, v126
MV 184,a,168,v,40
v_add_f32 v3, v3, v124
v_add_f32 v3, v3, v125
MV 200,a,168,v,72
v_exp_f32 v127, v127
MV 176,a,172,v,28
ds_read_b128 a[232:235], v11 offset:26624
v_cvt_pk_bf16_f32 v122, v124, v125
MV 184,a,172,v,44
v_exp_f32 v128, v128
MV 200,a,172,v,76
ds_read_b128 a[236:239], v11 offset:27648
v_add_f32 v3, v3, v126
v_mfma_f32_16x16x32_bf16 v[180:183], a[176:179], v[16:19], 0
ds_read_b128 a[240:243], v11 offset:28672
v_add_f32 v3, v3, v127
v_mfma_f32_16x16x32_bf16 v[188:191], a[176:179], v[32:35], 0
v_exp_f32 v129, v129
v_mfma_f32_16x16x32_bf16 v[204:207], a[176:179], v[64:67], 0
ds_read_b128 a[244:247], v11 offset:29696
v_cvt_pk_bf16_f32 v123, v126, v127
MV 180,a,180,v,20
v_exp_f32 v130, v130
MV 188,a,180,v,36
v_add_f32 v4, v4, v128
v_add_f32 v4, v4, v129
MV 204,a,180,v,68
v_exp_f32 v131, v131
MV 180,a,184,v,24
buffer_load_dwordx4 v12, s[56:59], s71 offen offset:3072 sc1 lds
v_cvt_pk_bf16_f32 v128, v128, v129
MV 188,a,184,v,40
v_exp_f32 v132, v132
MV 204,a,184,v,72
v_add_f32 v4, v4, v130
v_add_f32 v4, v4, v131
MV 180,a,188,v,28
ds_read_b128 a[248:251], v11 offset:30720
v_add_u32 v246, -64, v239
MV 188,a,188,v,44
v_exp_f32 v133, v133
MV 204,a,188,v,76
ds_read_b128 a[252:255], v11 offset:31744
s_add_u32 s71, s71, 16384
v_cvt_pk_bf16_f32 v129, v130, v131
v_exp_f32 v134, v134
v_cmp_gt_i32_e64 s[84:85], 0, v246
v_add_f32 v4, v4, v132
v_cmp_gt_i32_e64 s[86:87], 1, v246
v_add_f32 v4, v4, v133
v_exp_f32 v135, v135
v_cmp_gt_i32_e64 s[88:89], 2, v246
v_cvt_pk_bf16_f32 v130, v132, v133
v_exp_f32 v136, v136
v_cmp_gt_i32_e64 s[90:91], 3, v246
v_add_f32 v4, v4, v134
v_cndmask_b32_e64 v168, v168, v14, s[84:85]
v_add_f32 v4, v4, v135
v_exp_f32 v137, v137
v_cndmask_b32_e64 v169, v169, v14, s[86:87]
v_cvt_pk_bf16_f32 v131, v134, v135
v_exp_f32 v138, v138
v_cndmask_b32_e64 v170, v170, v14, s[88:89]
v_add_f32 v5, v5, v136
v_cndmask_b32_e64 v171, v171, v14, s[90:91]
v_add_f32 v5, v5, v137
v_exp_f32 v139, v139
v_add_u32 v247, -80, v239
v_cvt_pk_bf16_f32 v136, v136, v137
v_exp_f32 v140, v140
v_cmp_gt_i32_e64 s[92:93], 0, v247
v_add_f32 v5, v5, v138
v_cmp_gt_i32_e64 s[94:95], 1, v247
v_add_f32 v5, v5, v139
v_exp_f32 v141, v141
v_cmp_gt_i32_e64 s[96:97], 2, v247
v_cvt_pk_bf16_f32 v137, v138, v139
v_exp_f32 v142, v142
v_cmp_gt_i32_e64 s[98:99], 3, v247
v_add_f32 v5, v5, v140
v_cndmask_b32_e64 v172, v172, v14, s[92:93]
v_add_f32 v5, v5, v141
v_exp_f32 v143, v143
v_cndmask_b32_e64 v173, v173, v14, s[94:95]
v_cvt_pk_bf16_f32 v138, v140, v141
v_add_f32 v5, v5, v142
v_cndmask_b32_e64 v174, v174, v14, s[96:97]
v_add_f32 v5, v5, v143
v_cvt_pk_bf16_f32 v139, v142, v143
v_cndmask_b32_e64 v175, v175, v14, s[98:99]
s_waitcnt vmcnt(16) lgkmcnt(0)
MA 0,a,192,v,80
s_barrier
MA 32,a,192,v,88
s_add_u32 m0, s72, 0
ds_read_b128 a[128:131], v10 offset:16384
MA 4,a,196,v,80
ds_read_b128 a[132:135], v10 offset:17408
buffer_load_dwordx4 v12, s[52:55], s71 offen offset:0 sc1 lds
MA 36,a,196,v,88
v_exp_f32 v144, v144
MA 8,a,200,v,80
v_exp_f32 v145, v145
MA 40,a,200,v,88
v_exp_f32 v146, v146
MA 12,a,204,v,80
ds_read_b128 a[136:139], v10 offset:18432
v_add_f32 v2, v2, v144
MA 44,a,204,v,88
v_add_f32 v2, v2, v145
v_add_u32 v246, -96, v239
MA 16,a,208,v,80
v_exp_f32 v147, v147
MA 48,a,208,v,88
ds_read_b128 a[140:143], v10 offset:19456
v_cvt_pk_bf16_f32 v144, v144, v145
MA 20,a,212,v,80
ds_read_b128 a[144:147], v10 offset:20480
v_cmp_gt_i32_e64 s[84:85], 0, v246
MA 52,a,212,v,88
v_exp_f32 v148, v148
MA 24,a,216,v,80
v_add_f32 v2, v2, v146
v_add_f32 v2, v2, v147
MA 56,a,216,v,88
buffer_load_dwordx4 v12, s[52:55], s71 offen offset:1024 sc1 lds
v_cmp_gt_i32_e64 s[86:87], 1, v246
MA 28,a,220,v,80
v_exp_f32 v149, v149
MA 60,a,220,v,88
ds_read_b128 a[148:151], v10 offset:21504
v_cvt_pk_bf16_f32 v145, v146, v147
MA 92,a,220,v,96
v_exp_f32 v150, v150
MA 124,a,220,v,104
v_add_f32 v2, v2, v148
v_cmp_gt_i32_e64 s[88:89], 2, v246
MA 88,a,216,v,96
ds_read_b128 a[152:155], v10 offset:22528
v_add_f32 v2, v2, v149
MA 120,a,216,v,104
v_exp_f32 v151, v151
MA 84,a,212,v,96
v_cvt_pk_bf16_f32 v146, v148, v149
v_cmp_gt_i32_e64 s[90:91], 3, v246
MA 116,a,212,v,104
v_exp_f32 v152, v152
MA 80,a,208,v,96
ds_read_b128 a[156:159], v10 offset:23552
v_add_f32 v2, v2, v150
MA 112,a,208,v,104
v_add_f32 v2, v2, v151
v_cndmask_b32_e64 v200, v200, v14, s[84:85]
MA 76,a,204,v,96
v_exp_f32 v153, v153
MA 108,a,204,v,104
ds_read_b128 a[160:163], v10 offset:24576
v_cvt_pk_bf16_f32 v147, v150, v151
MA 72,a,200,v,96
buffer_load_dwordx4 v12, s[52:55], s71 offen offset:2048 sc1 lds
v_cndmask_b32_e64 v201, v201, v14, s[86:87]
MA 104,a,200,v,104
v_exp_f32 v154, v154
MA 68,a,196,v,96
ds_read_b128 a[164:167], v10 offset:25600
v_add_f32 v3, v3, v152
MA 100,a,196,v,104
v_add_f32 v3, v3, v153
v_cndmask_b32_e64 v202, v202, v14, s[88:89]
MA 64,a,192,v,96
v_exp_f32 v155, v155
MA 96,a,192,v,104
ds_read_b128 a[168:171], v10 offset:26624
v_cvt_pk_bf16_f32 v152, v152, v153
MA 0,a,224,v,112
v_exp_f32 v156, v156
MA 32,a,224,v,120
v_add_f32 v3, v3, v154
v_cndmask_b32_e64 v203, v203, v14, s[90:91]
MA 4,a,228,v,112
ds_read_b128 a[172:175], v10 offset:27648
v_add_f32 v3, v3, v155
MA 36,a,228,v,120
v_exp_f32 v157, v157
MA 8,a,232,v,112
v_cvt_pk_bf16_f32 v153, v154, v155
v_add_u32 v247, -112, v239
MA 40,a,232,v,120
v_exp_f32 v158, v158
MA 12,a,236,v,112
ds_read_b128 a[176:179], v10 offset:28672
v_add_f32 v3, v3, v156
MA 44,a,236,v,120
v_add_f32 v3, v3, v157
v_cmp_gt_i32_e64 s[92:93], 0, v247
MA 16,a,240,v,112
v_exp_f32 v159, v159
MA 48,a,240,v,120
ds_read_b128 a[180:183], v10 offset:29696
buffer_load_dwordx4 v12, s[52:55], s71 offen offset:3072 sc1 lds
MA 20,a,244,v,112
v_cvt_pk_bf16_f32 v154, v156, v157
v_cmp_gt_i32_e64 s[94:95], 1, v247
MA 52,a,244,v,120
v_exp_f32 v168, v168
MA 24,a,248,v,112
ds_read_b128 a[184:187], v10 offset:30720
v_add_f32 v3, v3, v158
MA 56,a,248,v,120
v_add_f32 v3, v3, v159
v_cmp_gt_i32_e64 s[96:97], 2, v247
MA 28,a,252,v,112
v_exp_f32 v169, v169
MA 60,a,252,v,120
ds_read_b128 a[188:191], v10 offset:31744
v_cvt_pk_bf16_f32 v155, v158, v159
MA 92,a,252,v,128
v_exp_f32 v170, v170
MA 124,a,252,v,136
v_add_f32 v5, v5, v168
v_cmp_gt_i32_e64 s[98:99], 3, v247
MA 88,a,248,v,128
s_cmp_eq_u32 s70, 7
v_add_f32 v5, v5, v169
MA 120,a,248,v,136
v_exp_f32 v171, v171
MA 84,a,244,v,128
v_cvt_pk_bf16_f32 v168, v168, v169
v_cndmask_b32_e64 v204, v204, v14, s[92:93]
MA 116,a,244,v,136
v_exp_f32 v172, v172
MA 80,a,240,v,128
v_add_f32 v5, v5, v170
v_add_f32 v5, v5, v171
MA 112,a,240,v,136
v_exp_f32 v173, v173
MA 76,a,236,v,128
v_cvt_pk_bf16_f32 v169, v170, v171
v_cndmask_b32_e64 v205, v205, v14, s[94:95]
MA 108,a,236,v,136
v_exp_f32 v174, v174
MA 72,a,232,v,128
v_add_f32 v5, v5, v172
v_cndmask_b32_e64 v206, v206, v14, s[96:97]
MA 104,a,232,v,136
v_add_f32 v5, v5, v173
v_cndmask_b32_e64 v207, v207, v14, s[98:99]
MA 68,a,228,v,128
v_exp_f32 v175, v175
MA 100,a,228,v,136
v_cvt_pk_bf16_f32 v170, v172, v173
v_add_f32 v5, v5, v174
MA 64,a,224,v,128
v_add_f32 v5, v5, v175
v_cvt_pk_bf16_f32 v171, v174, v175
MA 96,a,224,v,136
s_cbranch_scc1 L_p3_mxm_top
s_waitcnt lgkmcnt(0)
v_xor_b32 v11, 0x8000, v11
v_mfma_f32_16x16x32_bf16 v[80:83], a[128:131], v[16:19], 0
s_add_u32 m0, s73, 16384
ds_read_b128 a[192:195], v11 offset:0
v_mfma_f32_16x16x32_bf16 v[88:91], a[128:131], v[32:35], 0
v_exp_f32 v176, v176
v_mfma_f32_16x16x32_bf16 v[84:87], a[144:147], v[16:19], 0
v_exp_f32 v177, v177
v_mfma_f32_16x16x32_bf16 v[92:95], a[144:147], v[32:35], 0
ds_read_b128 a[196:199], v11 offset:1024
buffer_load_dwordx4 v12, s[56:59], s71 offen offset:0 sc1 lds
v_mfma_f32_16x16x32_bf16 v[112:115], a[160:163], v[16:19], 0
v_exp_f32 v178, v178
v_mfma_f32_16x16x32_bf16 v[120:123], a[160:163], v[32:35], 0
v_add_f32 v2, v2, v176
v_add_f32 v2, v2, v177
v_mfma_f32_16x16x32_bf16 v[116:119], a[176:179], v[16:19], 0
ds_read_b128 a[200:203], v11 offset:2048
ds_read_b128 a[204:207], v11 offset:3072
v_mfma_f32_16x16x32_bf16 v[124:127], a[176:179], v[32:35], 0
v_exp_f32 v179, v179
MV 116,a,180,v,20
ds_read_b128 a[208:211], v11 offset:4096
v_cvt_pk_bf16_f32 v176, v176, v177
MV 124,a,180,v,36
v_exp_f32 v180, v180
MV 112,a,164,v,20
v_add_f32 v2, v2, v178
v_add_f32 v2, v2, v179
MV 120,a,164,v,36
v_exp_f32 v181, v181
MV 84,a,148,v,20
buffer_load_dwordx4 v12, s[56:59], s71 offen offset:1024 sc1 lds
v_cvt_pk_bf16_f32 v177, v178, v179
MV 92,a,148,v,36
v_exp_f32 v182, v182
MV 80,a,132,v,20
ds_read_b128 a[212:215], v11 offset:5120
v_add_f32 v2, v2, v180
MV 88,a,132,v,36
ds_read_b128 a[216:219], v11 offset:6144
v_add_f32 v2, v2, v181
MV 80,a,136,v,24
v_exp_f32 v183, v183
MV 88,a,136,v,40
ds_read_b128 a[220:223], v11 offset:7168
v_cvt_pk_bf16_f32 v178, v180, v181
MV 84,a,152,v,24
v_exp_f32 v184, v184
MV 92,a,152,v,40
v_add_f32 v2, v2, v182
v_add_f32 v2, v2, v183
MV 112,a,168,v,24
ds_read_b128 a[224:227], v11 offset:8192
buffer_load_dwordx4 v12, s[56:59], s71 offen offset:2048 sc1 lds
MV 120,a,168,v,40
v_exp_f32 v185, v185
MV 116,a,184,v,24
ds_read_b128 a[228:231], v11 offset:9216
v_cvt_pk_bf16_f32 v179, v182, v183
MV 124,a,184,v,40
v_exp_f32 v186, v186
MV 116,a,188,v,28
v_add_f32 v3, v3, v184
v_add_f32 v3, v3, v185
MV 124,a,188,v,44
v_exp_f32 v187, v187
MV 112,a,172,v,28
ds_read_b128 a[232:235], v11 offset:10240
v_cvt_pk_bf16_f32 v184, v184, v185
MV 120,a,172,v,44
v_exp_f32 v188, v188
MV 84,a,156,v,28
ds_read_b128 a[236:239], v11 offset:11264
v_add_f32 v3, v3, v186
MV 92,a,156,v,44
buffer_load_dwordx4 v12, s[56:59], s71 offen offset:3072 sc1 lds
v_add_f32 v3, v3, v187
MV 80,a,140,v,28
v_exp_f32 v189, v189
MV 88,a,140,v,44
ds_read_b128 a[240:243], v11 offset:12288
ds_read_b128 a[244:247], v11 offset:13312
ds_read_b128 a[248:251], v11 offset:14336
ds_read_b128 a[252:255], v11 offset:15360
s_add_u32 s71, s71, 16384
s_xor_b32 s73, s73, 0x8000
v_cvt_pk_bf16_f32 v185, v186, v187
v_exp_f32 v190, v190
v_add_f32 v3, v3, v188
v_add_f32 v3, v3, v189
v_exp_f32 v191, v191
v_cvt_pk_bf16_f32 v186, v188, v189
v_exp_f32 v200, v200
v_add_f32 v3, v3, v190
v_add_f32 v3, v3, v191
v_exp_f32 v201, v201
v_cvt_pk_bf16_f32 v187, v190, v191
v_exp_f32 v202, v202
v_add_f32 v5, v5, v200
v_add_f32 v5, v5, v201
v_exp_f32 v203, v203
v_cvt_pk_bf16_f32 v200, v200, v201
v_exp_f32 v204, v204
v_add_f32 v5, v5, v202
v_add_f32 v5, v5, v203
v_exp_f32 v205, v205
v_cvt_pk_bf16_f32 v201, v202, v203
v_exp_f32 v206, v206
v_add_f32 v5, v5, v204
v_add_f32 v5, v5, v205
v_exp_f32 v207, v207
v_cvt_pk_bf16_f32 v202, v204, v205
v_add_f32 v5, v5, v206
v_add_f32 v5, v5, v207
v_cvt_pk_bf16_f32 v203, v206, v207
s_waitcnt vmcnt(16) lgkmcnt(0)
MA 0,a,192,v,144
s_barrier
v_xor_b32 v10, 0x8000, v10
MA 32,a,192,v,152
s_add_u32 m0, s72, 16384
ds_read_b128 a[128:131], v10 offset:0
MA 4,a,196,v,144
buffer_load_dwordx4 v12, s[52:55], s71 offen offset:0 sc1 lds
v_lshrrev_b32 v249, 2, v1
MA 36,a,196,v,152
ds_read_b128 a[132:135], v10 offset:1024
v_and_b32 v248, 7, v249
MA 8,a,200,v,144
v_exp_f32 v80, v80
MA 40,a,200,v,152
v_lshlrev_b32 v249, 8, v249
v_and_b32 v250, 3, v1
MA 12,a,204,v,144
ds_read_b128 a[136:139], v10 offset:2048
v_lshl_add_u32 v249, v250, 3, v249
MA 44,a,204,v,152
v_exp_f32 v81, v81
MA 16,a,208,v,144
s_lshl_b32 s36, s3, 13
s_add_u32 s36, s36, 131072
MA 48,a,208,v,152
ds_read_b128 a[140:143], v10 offset:3072
v_add_u32 v249, s36, v249
MA 20,a,212,v,144
v_exp_f32 v82, v82
MA 52,a,212,v,152
s_waitcnt vmcnt(13)
v_xor_b32 v250, 0, v248
MA 24,a,216,v,144
ds_read_b128 a[144:147], v10 offset:4096
v_lshl_add_u32 v250, v250, 5, v249
MA 56,a,216,v,152
v_exp_f32 v83, v83
MA 28,a,220,v,144
TR 96,250,0
TR 98,250,4096
MA 60,a,220,v,152
ds_read_b128 a[148:151], v10 offset:5120
v_xor_b32 v250, 1, v248
MA 124,a,220,v,168
buffer_load_dwordx4 v12, s[52:55], s71 offen offset:1024 sc1 lds
v_cvt_pk_bf16_f32 v80, v80, v81
MA 120,a,216,v,168
v_lshl_add_u32 v250, v250, 5, v249
TR 100,250,0
MA 116,a,212,v,168
TR 102,250,4096
v_xor_b32 v250, 2, v248
MA 112,a,208,v,168
v_exp_f32 v84, v84
MA 108,a,204,v,168
ds_read_b128 a[152:155], v10 offset:6144
v_lshl_add_u32 v250, v250, 5, v249
MA 104,a,200,v,168
TR 104,250,0
TR 106,250,4096
MA 100,a,196,v,168
v_exp_f32 v85, v85
MA 96,a,192,v,168
ds_read_b128 a[156:159], v10 offset:7168
v_cvt_pk_bf16_f32 v81, v82, v83
MA 0,a,224,v,176
v_xor_b32 v250, 3, v248
v_lshl_add_u32 v250, v250, 5, v249
MA 32,a,224,v,184
ds_read_b128 a[160:163], v10 offset:8192
TR 108,250,0
MA 4,a,228,v,176
TR 110,250,4096
v_xor_b32 v250, 4, v248
MA 36,a,228,v,184
v_exp_f32 v86, v86
MA 8,a,232,v,176
ds_read_b128 a[164:167], v10 offset:9216
v_lshl_add_u32 v250, v250, 5, v249
MA 40,a,232,v,184
buffer_load_dwordx4 v12, s[52:55], s71 offen offset:2048 sc1 lds
TR 128,250,0
MA 12,a,236,v,176
TR 130,250,4096
v_xor_b32 v250, 5, v248
MA 44,a,236,v,184
v_exp_f32 v87, v87
MA 16,a,240,v,176
ds_read_b128 a[168:171], v10 offset:10240
v_cvt_pk_bf16_f32 v82, v84, v85
MA 48,a,240,v,184
v_lshl_add_u32 v250, v250, 5, v249
TR 132,250,0
MA 20,a,244,v,176
TR 134,250,4096
v_xor_b32 v250, 6, v248
MA 52,a,244,v,184
v_exp_f32 v88, v88
MA 24,a,248,v,176
ds_read_b128 a[172:175], v10 offset:11264
v_lshl_add_u32 v250, v250, 5, v249
MA 56,a,248,v,184
TR 136,250,0
TR 138,250,4096
MA 28,a,252,v,176
v_exp_f32 v89, v89
MA 60,a,252,v,184
ds_read_b128 a[176:179], v10 offset:12288
v_xor_b32 v250, 7, v248
MA 124,a,252,v,200
v_cvt_pk_bf16_f32 v83, v86, v87
v_lshl_add_u32 v250, v250, 5, v249
MA 120,a,248,v,200
ds_read_b128 a[180:183], v10 offset:13312
TR 140,250,0
MA 116,a,244,v,200
buffer_load_dwordx4 v12, s[52:55], s71 offen offset:3072 sc1 lds
TR 142,250,4096
MA 112,a,240,v,200
v_exp_f32 v90, v90
MA 108,a,236,v,200
s_add_u32 s32, s40, 100663296
s_addc_u32 s33, s41, 0
MA 104,a,232,v,200
ds_read_b128 a[184:187], v10 offset:14336
s_mov_b32 s34, 8388608
MA 100,a,228,v,200
s_mov_b32 s35, 0x20000
s_and_b32 s36, s2, 7
MA 96,a,224,v,200
ds_read_b128 a[188:191], v10 offset:15360
s_xor_b32 s72, s72, 0x8000
v_exp_f32 v91, v91
s_lshl_b32 s36, s36, 20
s_lshr_b32 s37, s2, 3
v_cvt_pk_bf16_f32 v88, v88, v89
s_lshl_b32 s37, s37, 15
v_exp_f32 v92, v92
s_add_u32 s36, s36, s37
s_lshl_b32 s37, s3, 12
s_add_u32 s36, s36, s37
v_exp_f32 v93, v93
s_add_u32 s37, s36, 4096
s_waitcnt lgkmcnt(15)
buffer_store_dwordx4 v[96:99], v12, s[32:35], s36 offen offset:0 sc1
buffer_store_dwordx4 v[100:103], v12, s[32:35], s36 offen offset:1024 sc1
v_cvt_pk_bf16_f32 v89, v90, v91
buffer_store_dwordx4 v[104:107], v12, s[32:35], s36 offen offset:2048 sc1
buffer_store_dwordx4 v[108:111], v12, s[32:35], s36 offen offset:3072 sc1
s_waitcnt lgkmcnt(12)
buffer_store_dwordx4 v[128:131], v12, s[32:35], s37 offen offset:0 sc1
v_exp_f32 v94, v94
s_waitcnt lgkmcnt(9)
buffer_store_dwordx4 v[132:135], v12, s[32:35], s37 offen offset:1024 sc1
s_waitcnt lgkmcnt(6)
buffer_store_dwordx4 v[136:139], v12, s[32:35], s37 offen offset:2048 sc1
s_waitcnt lgkmcnt(2)
buffer_store_dwordx4 v[140:143], v12, s[32:35], s37 offen offset:3072 sc1
v_exp_f32 v95, v95
v_lshlrev_b32 v232, 4, v1
v_mov_b32 v235, 0
buffer_load_ushort v234, v235, s[28:31], s42 offen
v_cvt_pk_bf16_f32 v90, v92, v93
buffer_load_dwordx4 v[210:213], v232, s[16:19], 0 offen offset:0
buffer_load_dwordx4 v[216:219], v232, s[16:19], 0 offen offset:1024
v_cvt_pk_bf16_f32 v91, v94, v95
buffer_load_dwordx4 v[222:225], v232, s[16:19], 0 offen offset:2048
buffer_load_dwordx4 v[228:231], v232, s[16:19], 0 offen offset:3072
L_p3_eps:
v_mov_b32 v240, v4
v_mov_b32 v241, v5
s_nop 0
v_permlane32_swap_b32 v4, v240
v_permlane32_swap_b32 v5, v241
v_add_f32 v4, v4, v240
v_add_f32 v5, v5, v241
v_mov_b32 v240, v4
v_mov_b32 v241, v5
s_nop 0
v_permlane16_swap_b32 v4, v240
v_permlane16_swap_b32 v5, v241
v_add_f32 v4, v4, v240
v_add_f32 v5, v5, v241
v_cmp_nle_f32 vcc, 0x30800000, v4
s_nop 0
s_mov_b64 s[78:79], vcc
v_cmp_nge_f32 vcc, 0x4e800000, v4
s_nop 0
s_or_b64 s[78:79], s[78:79], vcc
v_cmp_nle_f32 vcc, 0x30800000, v5
s_nop 0
s_or_b64 s[78:79], s[78:79], vcc
v_cmp_nge_f32 vcc, 0x4e800000, v5
s_nop 0
s_or_b64 s[78:79], s[78:79], vcc
v_rcp_f32 v4, v4
v_rcp_f32 v5, v5
s_add_u32 s80, s101, s76
s_nop 4
v_accvgpr_read_b32 v240, a64
v_accvgpr_read_b32 v241, a65
v_accvgpr_read_b32 v242, a66
v_accvgpr_read_b32 v243, a67
v_accvgpr_read_b32 v244, a68
v_accvgpr_read_b32 v245, a69
v_accvgpr_read_b32 v246, a70
v_accvgpr_read_b32 v247, a71
v_pk_mul_f32 v[240:241], v[240:241], v[4:5] op_sel:[0,0] op_sel_hi:[1,0]
v_pk_mul_f32 v[242:243], v[242:243], v[4:5] op_sel:[0,0] op_sel_hi:[1,0]
v_pk_mul_f32 v[244:245], v[244:245], v[4:5] op_sel:[0,0] op_sel_hi:[1,0]
v_pk_mul_f32 v[246:247], v[246:247], v[4:5] op_sel:[0,0] op_sel_hi:[1,0]
v_cvt_pk_bf16_f32 v248, v240, v241
v_cvt_pk_bf16_f32 v249, v242, v243
v_cvt_pk_bf16_f32 v250, v244, v245
v_cvt_pk_bf16_f32 v251, v246, v247
buffer_store_dwordx4 v[248:251], v15, s[60:63], s101 offen offset:0 sc1
v_accvgpr_read_b32 v240, a72
v_accvgpr_read_b32 v241, a73
v_accvgpr_read_b32 v242, a74
v_accvgpr_read_b32 v243, a75
v_accvgpr_read_b32 v244, a76
v_accvgpr_read_b32 v245, a77
v_accvgpr_read_b32 v246, a78
v_accvgpr_read_b32 v247, a79
v_pk_mul_f32 v[240:241], v[240:241], v[4:5] op_sel:[0,0] op_sel_hi:[1,0]
v_pk_mul_f32 v[242:243], v[242:243], v[4:5] op_sel:[0,0] op_sel_hi:[1,0]
v_pk_mul_f32 v[244:245], v[244:245], v[4:5] op_sel:[0,0] op_sel_hi:[1,0]
v_pk_mul_f32 v[246:247], v[246:247], v[4:5] op_sel:[0,0] op_sel_hi:[1,0]
v_cvt_pk_bf16_f32 v252, v240, v241
v_cvt_pk_bf16_f32 v253, v242, v243
v_cvt_pk_bf16_f32 v254, v244, v245
v_cvt_pk_bf16_f32 v255, v246, v247
buffer_store_dwordx4 v[252:255], v15, s[60:63], s101 offen offset:1024 sc1
v_accvgpr_read_b32 v240, a80
v_accvgpr_read_b32 v241, a81
v_accvgpr_read_b32 v242, a82
v_accvgpr_read_b32 v243, a83
v_accvgpr_read_b32 v244, a84
v_accvgpr_read_b32 v245, a85
v_accvgpr_read_b32 v246, a86
v_accvgpr_read_b32 v247, a87
v_pk_mul_f32 v[240:241], v[240:241], v[4:5] op_sel:[0,0] op_sel_hi:[1,0]
v_pk_mul_f32 v[242:243], v[242:243], v[4:5] op_sel:[0,0] op_sel_hi:[1,0]
v_pk_mul_f32 v[244:245], v[244:245], v[4:5] op_sel:[0,0] op_sel_hi:[1,0]
v_pk_mul_f32 v[246:247], v[246:247], v[4:5] op_sel:[0,0] op_sel_hi:[1,0]
v_cvt_pk_bf16_f32 v248, v240, v241
v_cvt_pk_bf16_f32 v249, v242, v243
v_cvt_pk_bf16_f32 v250, v244, v245
v_cvt_pk_bf16_f32 v251, v246, v247
buffer_store_dwordx4 v[248:251], v15, s[60:63], s101 offen offset:2048 sc1
v_accvgpr_read_b32 v240, a88
v_accvgpr_read_b32 v241, a89
v_accvgpr_read_b32 v242, a90
v_accvgpr_read_b32 v243, a91
v_accvgpr_read_b32 v244, a92
v_accvgpr_read_b32 v245, a93
v_accvgpr_read_b32 v246, a94
v_accvgpr_read_b32 v247, a95
v_pk_mul_f32 v[240:241], v[240:241], v[4:5] op_sel:[0,0] op_sel_hi:[1,0]
v_pk_mul_f32 v[242:243], v[242:243], v[4:5] op_sel:[0,0] op_sel_hi:[1,0]
v_pk_mul_f32 v[244:245], v[244:245], v[4:5] op_sel:[0,0] op_sel_hi:[1,0]
v_pk_mul_f32 v[246:247], v[246:247], v[4:5] op_sel:[0,0] op_sel_hi:[1,0]
v_cvt_pk_bf16_f32 v252, v240, v241
v_cvt_pk_bf16_f32 v253, v242, v243
v_cvt_pk_bf16_f32 v254, v244, v245
v_cvt_pk_bf16_f32 v255, v246, v247
buffer_store_dwordx4 v[252:255], v15, s[60:63], s101 offen offset:3072 sc1
v_accvgpr_read_b32 v240, a96
v_accvgpr_read_b32 v241, a97
v_accvgpr_read_b32 v242, a98
v_accvgpr_read_b32 v243, a99
v_accvgpr_read_b32 v244, a100
v_accvgpr_read_b32 v245, a101
v_accvgpr_read_b32 v246, a102
v_accvgpr_read_b32 v247, a103
v_pk_mul_f32 v[240:241], v[240:241], v[4:5] op_sel:[0,1] op_sel_hi:[1,1]
v_pk_mul_f32 v[242:243], v[242:243], v[4:5] op_sel:[0,1] op_sel_hi:[1,1]
v_pk_mul_f32 v[244:245], v[244:245], v[4:5] op_sel:[0,1] op_sel_hi:[1,1]
v_pk_mul_f32 v[246:247], v[246:247], v[4:5] op_sel:[0,1] op_sel_hi:[1,1]
v_cvt_pk_bf16_f32 v248, v240, v241
v_cvt_pk_bf16_f32 v249, v242, v243
v_cvt_pk_bf16_f32 v250, v244, v245
v_cvt_pk_bf16_f32 v251, v246, v247
buffer_store_dwordx4 v[248:251], v15, s[60:63], s80 offen offset:0 sc1
v_accvgpr_read_b32 v240, a104
v_accvgpr_read_b32 v241, a105
v_accvgpr_read_b32 v242, a106
v_accvgpr_read_b32 v243, a107
v_accvgpr_read_b32 v244, a108
v_accvgpr_read_b32 v245, a109
v_accvgpr_read_b32 v246, a110
v_accvgpr_read_b32 v247, a111
v_pk_mul_f32 v[240:241], v[240:241], v[4:5] op_sel:[0,1] op_sel_hi:[1,1]
v_pk_mul_f32 v[242:243], v[242:243], v[4:5] op_sel:[0,1] op_sel_hi:[1,1]
v_pk_mul_f32 v[244:245], v[244:245], v[4:5] op_sel:[0,1] op_sel_hi:[1,1]
v_pk_mul_f32 v[246:247], v[246:247], v[4:5] op_sel:[0,1] op_sel_hi:[1,1]
v_cvt_pk_bf16_f32 v252, v240, v241
v_cvt_pk_bf16_f32 v253, v242, v243
v_cvt_pk_bf16_f32 v254, v244, v245
v_cvt_pk_bf16_f32 v255, v246, v247
buffer_store_dwordx4 v[252:255], v15, s[60:63], s80 offen offset:1024 sc1
v_accvgpr_read_b32 v240, a112
v_accvgpr_read_b32 v241, a113
v_accvgpr_read_b32 v242, a114
v_accvgpr_read_b32 v243, a115
v_accvgpr_read_b32 v244, a116
v_accvgpr_read_b32 v245, a117
v_accvgpr_read_b32 v246, a118
v_accvgpr_read_b32 v247, a119
v_pk_mul_f32 v[240:241], v[240:241], v[4:5] op_sel:[0,1] op_sel_hi:[1,1]
v_pk_mul_f32 v[242:243], v[242:243], v[4:5] op_sel:[0,1] op_sel_hi:[1,1]
v_pk_mul_f32 v[244:245], v[244:245], v[4:5] op_sel:[0,1] op_sel_hi:[1,1]
v_pk_mul_f32 v[246:247], v[246:247], v[4:5] op_sel:[0,1] op_sel_hi:[1,1]
v_cvt_pk_bf16_f32 v248, v240, v241
v_cvt_pk_bf16_f32 v249, v242, v243
v_cvt_pk_bf16_f32 v250, v244, v245
v_cvt_pk_bf16_f32 v251, v246, v247
buffer_store_dwordx4 v[248:251], v15, s[60:63], s80 offen offset:2048 sc1
v_accvgpr_read_b32 v240, a120
v_accvgpr_read_b32 v241, a121
v_accvgpr_read_b32 v242, a122
v_accvgpr_read_b32 v243, a123
v_accvgpr_read_b32 v244, a124
v_accvgpr_read_b32 v245, a125
v_accvgpr_read_b32 v246, a126
v_accvgpr_read_b32 v247, a127
v_pk_mul_f32 v[240:241], v[240:241], v[4:5] op_sel:[0,1] op_sel_hi:[1,1]
v_pk_mul_f32 v[242:243], v[242:243], v[4:5] op_sel:[0,1] op_sel_hi:[1,1]
v_pk_mul_f32 v[244:245], v[244:245], v[4:5] op_sel:[0,1] op_sel_hi:[1,1]
v_pk_mul_f32 v[246:247], v[246:247], v[4:5] op_sel:[0,1] op_sel_hi:[1,1]
v_cvt_pk_bf16_f32 v252, v240, v241
v_cvt_pk_bf16_f32 v253, v242, v243
v_cvt_pk_bf16_f32 v254, v244, v245
v_cvt_pk_bf16_f32 v255, v246, v247
buffer_store_dwordx4 v[252:255], v15, s[60:63], s80 offen offset:3072 sc1
v_mov_b32 v160, 0x3f803f80
v_mov_b32 v161, 0x3f803f80
v_mov_b32 v162, 0x3f803f80
v_mov_b32 v163, 0x3f803f80
v_mov_b32 v164, 0
v_mov_b32 v165, 0
v_mov_b32 v166, 0
v_mov_b32 v167, 0
v_mov_b32 v168, 0
v_mov_b32 v169, 0
v_mov_b32 v170, 0
v_mov_b32 v171, 0
s_and_b32 s36, s2, 3
s_lshl_b32 s36, s36, 1
s_sub_u32 s32, 14, s36
s_bitcmp1_b32 s2, 4
s_cselect_b32 s36, s32, s36
s_bfe_u32 s32, s2, 0x10003
s_add_u32 s36, s36, s32
s_bfe_u32 s37, s2, 0x10002
s_lshr_b32 s32, s2, 5
s_lshl_b32 s32, s32, 1
s_add_u32 s37, s37, s32
s_lshl_b32 s36, s36, 2
s_add_u32 s36, s36, s3
s_lshl_b32 s37, s37, 7
s_lshl_b32 s32, s36, 16
s_add_u32 s37, s37, s32
s_lshl_b32 s36, s36, 7
v_and_b32 v240, 15, v1
v_bfe_u32 v241, v1, 4, 1
v_lshlrev_b32 v241, 5, v241
v_lshrrev_b32 v242, 5, v1
v_lshl_add_u32 v241, v242, 4, v241
v_lshl_add_u32 v241, v240, 11, v241
v_lshlrev_b32 v240, 2, v240
s_add_u32 s32, s40, 58720256
s_addc_u32 s33, s41, 0
s_mov_b32 s34, 8192
s_mov_b32 s35, 0x20000
buffer_load_dwordx4 v[192:195], v241, s[44:47], s37 offen offset:0
buffer_load_dwordx4 v[196:199], v241, s[44:47], s37 offen offset:64
buffer_load_dword v6, v240, s[32:35], s36 offen offset:0 sc1
s_add_u32 s37, s37, 32768
buffer_load_dwordx4 v[200:203], v241, s[44:47], s37 offen offset:0
buffer_load_dwordx4 v[204:207], v241, s[44:47], s37 offen offset:64
buffer_load_dword v7, v240, s[32:35], s36 offen offset:64 sc1
v_lshlrev_b32 v236, 20, v1
s_lshl_b32 s36, s3, 26
v_add_u32 v236, s36, v236
v_mov_b32 v237, 1
s_lshl_b32 s37, s2, 2
s_getpc_b64 s[38:39]
L_ct_b:
s_add_u32 s38, s38, L_p3_s1m_top - L_ct_b
s_addc_u32 s39, s39, 0
v_mov_b32 v173, s39
v_mov_b32 v172, s38
s_lshr_b32 s38, s2, 3
s_lshl_b32 s38, s38, 2
s_add_u32 s38, s38, s3
s_lshl_b32 s38, s38, 7
v_and_b32 v174, 3, v1
v_lshlrev_b32 v174, 14, v174
v_add_u32 v174, s38, v174
v_min_u32 v174, L_end - L_p3_s1m_top - 4, v174
v_add_co_u32 v172, vcc, v172, v174
s_nop 1
v_addc_co_u32 v173, vcc, 0, v173, vcc
global_load_dword v174, v[172:173], off
s_lshl_b32 s74, s70, 1
s_sub_u32 s74, 13, s74
s_cbranch_scc1 L_p3_s0m_top
.p2align 5
L_p3_s0_top:
s_waitcnt lgkmcnt(0)
v_mfma_f32_16x16x32_bf16 v[144:147], a[128:131], v[16:19], 0
s_add_u32 m0, s73, 0
ds_read_b128 a[192:195], v11 offset:16384
v_mfma_f32_16x16x32_bf16 v[152:155], a[128:131], v[32:35], 0
v_exp_f32 v112, v112
v_mfma_f32_16x16x32_bf16 v[148:151], a[144:147], v[16:19], 0
ds_read_b128 a[196:199], v11 offset:17408
buffer_load_dwordx4 v12, s[56:59], s71 offen offset:0 sc1 lds
v_mfma_f32_16x16x32_bf16 v[156:159], a[144:147], v[32:35], 0
v_exp_f32 v113, v113
v_mfma_f32_16x16x32_bf16 v[176:179], a[160:163], v[16:19], 0
ds_read_b128 a[200:203], v11 offset:18432
ds_read_b128 a[204:207], v11 offset:19456
v_mfma_f32_16x16x32_bf16 v[184:187], a[160:163], v[32:35], 0
v_exp_f32 v114, v114
v_mfma_f32_16x16x32_bf16 v[180:183], a[176:179], v[16:19], 0
v_exp_f32 v115, v115
v_mfma_f32_16x16x32_bf16 v[188:191], a[176:179], v[32:35], 0
ds_read_b128 a[208:211], v11 offset:20480
v_cvt_pk_bf16_f32 v112, v112, v113
MV 180,a,180,v,20
ds_read_b128 a[212:215], v11 offset:21504
buffer_load_dwordx4 v12, s[56:59], s71 offen offset:1024 sc1 lds
MV 188,a,180,v,36
v_exp_f32 v116, v116
MV 176,a,164,v,20
v_exp_f32 v117, v117
MV 184,a,164,v,36
ds_read_b128 a[216:219], v11 offset:22528
ds_read_b128 a[220:223], v11 offset:23552
MV 148,a,148,v,20
ds_read_b128 a[224:227], v11 offset:24576
v_cvt_pk_bf16_f32 v113, v114, v115
MV 156,a,148,v,36
v_exp_f32 v118, v118
MV 144,a,132,v,20
v_exp_f32 v119, v119
MV 152,a,132,v,36
ds_read_b128 a[228:231], v11 offset:25600
buffer_load_dwordx4 v12, s[56:59], s71 offen offset:2048 sc1 lds
MV 144,a,136,v,24
ds_read_b128 a[232:235], v11 offset:26624
v_cvt_pk_bf16_f32 v114, v116, v117
MV 152,a,136,v,40
v_exp_f32 v120, v120
MV 148,a,152,v,24
ds_read_b128 a[236:239], v11 offset:27648
ds_read_b128 a[240:243], v11 offset:28672
MV 156,a,152,v,40
v_exp_f32 v121, v121
MV 176,a,168,v,24
ds_read_b128 a[244:247], v11 offset:29696
v_cvt_pk_bf16_f32 v115, v118, v119
MV 184,a,168,v,40
ds_read_b128 a[248:251], v11 offset:30720
buffer_load_dwordx4 v12, s[56:59], s71 offen offset:3072 sc1 lds
MV 180,a,184,v,24
v_exp_f32 v122, v122
MV 188,a,184,v,40
v_exp_f32 v123, v123
MV 180,a,188,v,28
ds_read_b128 a[252:255], v11 offset:31744
v_cvt_pk_bf16_f32 v120, v120, v121
MV 188,a,188,v,44
v_exp_f32 v124, v124
MV 176,a,172,v,28
v_exp_f32 v125, v125
MV 184,a,172,v,44
s_add_u32 s71, s71, 16384
v_cvt_pk_bf16_f32 v121, v122, v123
MV 148,a,156,v,28
v_exp_f32 v126, v126
MV 156,a,156,v,44
v_exp_f32 v127, v127
MV 144,a,140,v,28
v_cvt_pk_bf16_f32 v122, v124, v125
v_cvt_pk_bf16_f32 v123, v126, v127
MV 152,a,140,v,44
s_waitcnt vmcnt(16) lgkmcnt(0)
MA 0,a,192,v,80
s_barrier
MA 32,a,192,v,88
s_add_u32 m0, s72, 0
ds_read_b128 a[128:131], v10 offset:16384
MA 4,a,196,v,80
ds_read_b128 a[132:135], v10 offset:17408
buffer_load_dwordx4 v12, s[52:55], s71 offen offset:0 sc1 lds
MA 36,a,196,v,88
v_exp_f32 v144, v144
MA 8,a,200,v,80
v_exp_f32 v145, v145
MA 40,a,200,v,88
ds_read_b128 a[136:139], v10 offset:18432
ds_read_b128 a[140:143], v10 offset:19456
MA 12,a,204,v,80
v_exp_f32 v146, v146
MA 44,a,204,v,88
ds_read_b128 a[144:147], v10 offset:20480
buffer_load_dwordx4 v12, s[52:55], s71 offen offset:1024 sc1 lds
MV 164,v,160,v,80
v_exp_f32 v147, v147
MV 168,v,160,v,88
ds_read_b128 a[148:151], v10 offset:21504
v_cvt_pk_bf16_f32 v144, v144, v145
MA 16,a,208,v,80
v_exp_f32 v148, v148
MA 48,a,208,v,88
ds_read_b128 a[152:155], v10 offset:22528
ds_read_b128 a[156:159], v10 offset:23552
MA 20,a,212,v,80
v_exp_f32 v149, v149
MA 52,a,212,v,88
ds_read_b128 a[160:163], v10 offset:24576
v_cvt_pk_bf16_f32 v145, v146, v147
MA 24,a,216,v,80
v_exp_f32 v150, v150
MA 56,a,216,v,88
ds_read_b128 a[164:167], v10 offset:25600
buffer_load_dwordx4 v12, s[52:55], s71 offen offset:2048 sc1 lds
MA 28,a,220,v,80
v_exp_f32 v151, v151
MA 60,a,220,v,88
ds_read_b128 a[168:171], v10 offset:26624
v_cvt_pk_bf16_f32 v146, v148, v149
MA 0,a,224,v,112
ds_read_b128 a[172:175], v10 offset:27648
ds_read_b128 a[176:179], v10 offset:28672
MA 32,a,224,v,120
v_exp_f32 v152, v152
MA 4,a,228,v,112
v_exp_f32 v153, v153
MA 36,a,228,v,120
ds_read_b128 a[180:183], v10 offset:29696
v_cvt_pk_bf16_f32 v147, v150, v151
MA 8,a,232,v,112
ds_read_b128 a[184:187], v10 offset:30720
buffer_load_dwordx4 v12, s[52:55], s71 offen offset:3072 sc1 lds
MA 40,a,232,v,120
v_exp_f32 v154, v154
MA 12,a,236,v,112
v_exp_f32 v155, v155
MA 44,a,236,v,120
ds_read_b128 a[188:191], v10 offset:31744
v_cvt_pk_bf16_f32 v152, v152, v153
MV 164,v,160,v,112
v_exp_f32 v156, v156
MV 168,v,160,v,120
MA 16,a,240,v,112
v_exp_f32 v157, v157
MA 48,a,240,v,120
s_sub_u32 s74, s74, 1
v_cvt_pk_bf16_f32 v153, v154, v155
MA 20,a,244,v,112
v_exp_f32 v158, v158
MA 52,a,244,v,120
MA 24,a,248,v,112
v_exp_f32 v159, v159
MA 56,a,248,v,120
MA 28,a,252,v,112
v_cvt_pk_bf16_f32 v154, v156, v157
v_cvt_pk_bf16_f32 v155, v158, v159
MA 60,a,252,v,120
s_cbranch_scc1 L_p3_s1m_top
s_waitcnt lgkmcnt(0)
v_xor_b32 v11, 0x8000, v11
v_mfma_f32_16x16x32_bf16 v[80:83], a[128:131], v[16:19], 0
s_add_u32 m0, s73, 16384
ds_read_b128 a[192:195], v11 offset:0
v_mfma_f32_16x16x32_bf16 v[88:91], a[128:131], v[32:35], 0
v_exp_f32 v176, v176
v_mfma_f32_16x16x32_bf16 v[84:87], a[144:147], v[16:19], 0
ds_read_b128 a[196:199], v11 offset:1024
buffer_load_dwordx4 v12, s[56:59], s71 offen offset:0 sc1 lds
v_mfma_f32_16x16x32_bf16 v[92:95], a[144:147], v[32:35], 0
v_exp_f32 v177, v177
v_mfma_f32_16x16x32_bf16 v[112:115], a[160:163], v[16:19], 0
ds_read_b128 a[200:203], v11 offset:2048
ds_read_b128 a[204:207], v11 offset:3072
v_mfma_f32_16x16x32_bf16 v[120:123], a[160:163], v[32:35], 0
v_exp_f32 v178, v178
v_mfma_f32_16x16x32_bf16 v[116:119], a[176:179], v[16:19], 0
v_exp_f32 v179, v179
v_mfma_f32_16x16x32_bf16 v[124:127], a[176:179], v[32:35], 0
ds_read_b128 a[208:211], v11 offset:4096
buffer_load_dwordx4 v12, s[56:59], s71 offen offset:1024 sc1 lds
MV 116,a,180,v,20
ds_read_b128 a[212:215], v11 offset:5120
v_cvt_pk_bf16_f32 v176, v176, v177
MV 124,a,180,v,36
v_exp_f32 v180, v180
MV 112,a,164,v,20
v_exp_f32 v181, v181
MV 120,a,164,v,36
ds_read_b128 a[216:219], v11 offset:6144
ds_read_b128 a[220:223], v11 offset:7168
MV 84,a,148,v,20
buffer_load_dwordx4 v12, s[56:59], s71 offen offset:2048 sc1 lds
v_cvt_pk_bf16_f32 v177, v178, v179
MV 92,a,148,v,36
v_exp_f32 v182, v182
MV 80,a,132,v,20
ds_read_b128 a[224:227], v11 offset:8192
ds_read_b128 a[228:231], v11 offset:9216
MV 88,a,132,v,36
v_exp_f32 v183, v183
MV 80,a,136,v,24
ds_read_b128 a[232:235], v11 offset:10240
v_cvt_pk_bf16_f32 v178, v180, v181
MV 88,a,136,v,40
v_exp_f32 v184, v184
MV 84,a,152,v,24
ds_read_b128 a[236:239], v11 offset:11264
buffer_load_dwordx4 v12, s[56:59], s71 offen offset:3072 sc1 lds
MV 92,a,152,v,40
v_exp_f32 v185, v185
MV 112,a,168,v,24
ds_read_b128 a[240:243], v11 offset:12288
v_cvt_pk_bf16_f32 v179, v182, v183
MV 120,a,168,v,40
ds_read_b128 a[244:247], v11 offset:13312
ds_read_b128 a[248:251], v11 offset:14336
MV 116,a,184,v,24
v_exp_f32 v186, v186
MV 124,a,184,v,40
v_exp_f32 v187, v187
MV 116,a,188,v,28
ds_read_b128 a[252:255], v11 offset:15360
s_add_u32 s71, s71, 16384
MV 124,a,188,v,44
s_xor_b32 s73, s73, 0x8000
v_cvt_pk_bf16_f32 v184, v184, v185
MV 112,a,172,v,28
v_exp_f32 v188, v188
MV 120,a,172,v,44
v_exp_f32 v189, v189
MV 84,a,156,v,28
v_cvt_pk_bf16_f32 v185, v186, v187
MV 92,a,156,v,44
v_exp_f32 v190, v190
MV 80,a,140,v,28
v_exp_f32 v191, v191
MV 88,a,140,v,44
v_cvt_pk_bf16_f32 v186, v188, v189
v_cvt_pk_bf16_f32 v187, v190, v191
s_waitcnt vmcnt(16) lgkmcnt(0)
MA 0,a,192,v,144
s_barrier
v_xor_b32 v10, 0x8000, v10
MA 32,a,192,v,152
s_add_u32 m0, s72, 16384
ds_read_b128 a[128:131], v10 offset:0
MA 4,a,196,v,144
ds_read_b128 a[132:135], v10 offset:1024
buffer_load_dwordx4 v12, s[52:55], s71 offen offset:0 sc1 lds
MA 36,a,196,v,152
v_exp_f32 v80, v80
MA 8,a,200,v,144
v_exp_f32 v81, v81
MA 40,a,200,v,152
ds_read_b128 a[136:139], v10 offset:2048
ds_read_b128 a[140:143], v10 offset:3072
MA 12,a,204,v,144
v_exp_f32 v82, v82
MA 44,a,204,v,152
ds_read_b128 a[144:147], v10 offset:4096
buffer_load_dwordx4 v12, s[52:55], s71 offen offset:1024 sc1 lds
MV 164,v,160,v,144
v_exp_f32 v83, v83
MV 168,v,160,v,152
ds_read_b128 a[148:151], v10 offset:5120
v_cvt_pk_bf16_f32 v80, v80, v81
MA 16,a,208,v,144
v_exp_f32 v84, v84
MA 48,a,208,v,152
ds_read_b128 a[152:155], v10 offset:6144
buffer_load_dwordx4 v12, s[52:55], s71 offen offset:2048 sc1 lds
MA 20,a,212,v,144
v_exp_f32 v85, v85
MA 52,a,212,v,152
ds_read_b128 a[156:159], v10 offset:7168
v_cvt_pk_bf16_f32 v81, v82, v83
MA 24,a,216,v,144
v_exp_f32 v86, v86
MA 56,a,216,v,152
ds_read_b128 a[160:163], v10 offset:8192
ds_read_b128 a[164:167], v10 offset:9216
MA 28,a,220,v,144
v_exp_f32 v87, v87
MA 60,a,220,v,152
ds_read_b128 a[168:171], v10 offset:10240
buffer_load_dwordx4 v12, s[52:55], s71 offen offset:3072 sc1 lds
MA 0,a,224,v,176
ds_read_b128 a[172:175], v10 offset:11264
v_cvt_pk_bf16_f32 v82, v84, v85
MA 32,a,224,v,184
v_exp_f32 v88, v88
MA 4,a,228,v,176
v_exp_f32 v89, v89
MA 36,a,228,v,184
ds_read_b128 a[176:179], v10 offset:12288
s_xor_b32 s72, s72, 0x8000
MA 8,a,232,v,176
ds_read_b128 a[180:183], v10 offset:13312
v_cvt_pk_bf16_f32 v83, v86, v87
MA 40,a,232,v,184
v_exp_f32 v90, v90
MA 12,a,236,v,176
ds_read_b128 a[184:187], v10 offset:14336
ds_read_b128 a[188:191], v10 offset:15360
MA 44,a,236,v,184
v_exp_f32 v91, v91
MV 164,v,160,v,176
buffer_store_dword v237, v236, s[8:11], s37 offen offset:1024 sc1
v_cvt_pk_bf16_f32 v88, v88, v89
MV 168,v,160,v,184
v_exp_f32 v92, v92
MA 16,a,240,v,176
v_exp_f32 v93, v93
MA 48,a,240,v,184
MA 20,a,244,v,176
global_load_dword v174, v[172:173], off
v_cvt_pk_bf16_f32 v89, v90, v91
MA 52,a,244,v,184
v_exp_f32 v94, v94
MA 24,a,248,v,176
v_exp_f32 v95, v95
MA 56,a,248,v,184
MA 28,a,252,v,176
v_cvt_pk_bf16_f32 v90, v92, v93
v_cvt_pk_bf16_f32 v91, v94, v95
MA 60,a,252,v,184
s_branch L_p3_s0_top
L_p3_s1m_top:
s_waitcnt lgkmcnt(0)
v_xor_b32 v11, 0x8000, v11
v_mfma_f32_16x16x32_bf16 v[80:83], a[128:131], v[16:19], 0
ds_read_b128 a[192:195], v11 offset:0
ds_read_b128 a[196:199], v11 offset:1024
v_mfma_f32_16x16x32_bf16 v[88:91], a[128:131], v[32:35], 0
v_exp_f32 v176, v176
MV 80,a,132,v,20
v_exp_f32 v177, v177
MV 88,a,132,v,36
ds_read_b128 a[200:203], v11 offset:2048
ds_read_b128 a[204:207], v11 offset:3072
MV 80,a,136,v,24
v_exp_f32 v178, v178
MV 88,a,136,v,40
v_exp_f32 v179, v179
MV 80,a,140,v,28
ds_read_b128 a[208:211], v11 offset:4096
v_cvt_pk_bf16_f32 v176, v176, v177
MV 88,a,140,v,44
ds_read_b128 a[212:215], v11 offset:5120
ds_read_b128 a[216:219], v11 offset:6144
v_mfma_f32_16x16x32_bf16 v[84:87], a[144:147], v[16:19], 0
v_exp_f32 v180, v180
v_mfma_f32_16x16x32_bf16 v[92:95], a[144:147], v[32:35], 0
v_exp_f32 v181, v181
MV 84,a,148,v,20
ds_read_b128 a[220:223], v11 offset:7168
v_cvt_pk_bf16_f32 v177, v178, v179
MV 92,a,148,v,36
v_exp_f32 v182, v182
MV 84,a,152,v,24
ds_read_b128 a[224:227], v11 offset:8192
ds_read_b128 a[228:231], v11 offset:9216
MV 92,a,152,v,40
v_exp_f32 v183, v183
MV 84,a,156,v,28
ds_read_b128 a[232:235], v11 offset:10240
v_cvt_pk_bf16_f32 v178, v180, v181
MV 92,a,156,v,44
v_exp_f32 v184, v184
v_mfma_f32_16x16x32_bf16 v[112:115], a[160:163], v[16:19], 0
ds_read_b128 a[236:239], v11 offset:11264
ds_read_b128 a[240:243], v11 offset:12288
v_mfma_f32_16x16x32_bf16 v[120:123], a[160:163], v[32:35], 0
v_exp_f32 v185, v185
MV 112,a,164,v,20
ds_read_b128 a[244:247], v11 offset:13312
v_cvt_pk_bf16_f32 v179, v182, v183
MV 120,a,164,v,36
v_exp_f32 v186, v186
MV 112,a,168,v,24
v_exp_f32 v187, v187
MV 120,a,168,v,40
ds_read_b128 a[248:251], v11 offset:14336
ds_read_b128 a[252:255], v11 offset:15360
MV 112,a,172,v,28
v_cvt_pk_bf16_f32 v184, v184, v185
v_add_u32 v246, 0, v13
MV 120,a,172,v,44
v_cmp_gt_i32_e64 s[84:85], 0, v246
v_cmp_gt_i32_e64 s[86:87], 1, v246
v_mfma_f32_16x16x32_bf16 v[116:119], a[176:179], v[16:19], 0
v_exp_f32 v188, v188
v_mfma_f32_16x16x32_bf16 v[124:127], a[176:179], v[32:35], 0
v_cmp_gt_i32_e64 s[88:89], 2, v246
v_cmp_gt_i32_e64 s[90:91], 3, v246
MV 116,a,180,v,20
v_cndmask_b32_e64 v80, v80, v14, s[84:85]
v_cndmask_b32_e64 v81, v81, v14, s[86:87]
MV 124,a,180,v,36
v_exp_f32 v189, v189
MV 116,a,184,v,24
v_cvt_pk_bf16_f32 v185, v186, v187
v_cndmask_b32_e64 v82, v82, v14, s[88:89]
MV 124,a,184,v,40
v_cndmask_b32_e64 v83, v83, v14, s[90:91]
v_add_u32 v247, -16, v13
MV 116,a,188,v,28
v_cmp_gt_i32_e64 s[92:93], 0, v247
v_cmp_gt_i32_e64 s[94:95], 1, v247
MV 124,a,188,v,44
v_exp_f32 v190, v190
v_exp_f32 v191, v191
v_cmp_gt_i32_e64 s[96:97], 2, v247
v_cmp_gt_i32_e64 s[98:99], 3, v247
v_cndmask_b32_e64 v84, v84, v14, s[92:93]
v_cvt_pk_bf16_f32 v186, v188, v189
v_cndmask_b32_e64 v85, v85, v14, s[94:95]
v_cndmask_b32_e64 v86, v86, v14, s[96:97]
v_cvt_pk_bf16_f32 v187, v190, v191
v_cndmask_b32_e64 v87, v87, v14, s[98:99]
s_waitcnt vmcnt(12) lgkmcnt(0)
MA 0,a,192,v,144
s_barrier
v_xor_b32 v10, 0x8000, v10
MA 32,a,192,v,152
ds_read_b128 a[128:131], v10 offset:0
ds_read_b128 a[132:135], v10 offset:1024
MA 4,a,196,v,144
v_exp_f32 v80, v80
MA 36,a,196,v,152
v_exp_f32 v81, v81
MA 8,a,200,v,144
ds_read_b128 a[136:139], v10 offset:2048
ds_read_b128 a[140:143], v10 offset:3072
MA 40,a,200,v,152
v_exp_f32 v82, v82
MA 12,a,204,v,144
ds_read_b128 a[144:147], v10 offset:4096
v_add_u32 v246, -32, v13
MA 44,a,204,v,152
v_exp_f32 v83, v83
MV 164,v,160,v,144
v_cvt_pk_bf16_f32 v80, v80, v81
v_cmp_gt_i32_e64 s[84:85], 0, v246
MV 168,v,160,v,152
ds_read_b128 a[148:151], v10 offset:5120
v_cmp_gt_i32_e64 s[86:87], 1, v246
MA 16,a,208,v,144
v_exp_f32 v84, v84
MA 48,a,208,v,152
ds_read_b128 a[152:155], v10 offset:6144
v_cmp_gt_i32_e64 s[88:89], 2, v246
MA 20,a,212,v,144
v_exp_f32 v85, v85
MA 52,a,212,v,152
ds_read_b128 a[156:159], v10 offset:7168
v_cmp_gt_i32_e64 s[90:91], 3, v246
MA 24,a,216,v,144
ds_read_b128 a[160:163], v10 offset:8192
v_cvt_pk_bf16_f32 v81, v82, v83
MA 56,a,216,v,152
v_exp_f32 v86, v86
MA 28,a,220,v,144
ds_read_b128 a[164:167], v10 offset:9216
v_cndmask_b32_e64 v112, v112, v14, s[84:85]
MA 60,a,220,v,152
v_exp_f32 v87, v87
MA 0,a,224,v,176
ds_read_b128 a[168:171], v10 offset:10240
v_cndmask_b32_e64 v113, v113, v14, s[86:87]
MA 32,a,224,v,184
v_cvt_pk_bf16_f32 v82, v84, v85
v_cndmask_b32_e64 v114, v114, v14, s[88:89]
MA 4,a,228,v,176
ds_read_b128 a[172:175], v10 offset:11264
v_cndmask_b32_e64 v115, v115, v14, s[90:91]
MA 36,a,228,v,184
v_exp_f32 v88, v88
MA 8,a,232,v,176
v_exp_f32 v89, v89
MA 40,a,232,v,184
ds_read_b128 a[176:179], v10 offset:12288
v_cvt_pk_bf16_f32 v83, v86, v87
MA 12,a,236,v,176
ds_read_b128 a[180:183], v10 offset:13312
v_add_u32 v247, -48, v13
MA 44,a,236,v,184
ds_read_b128 a[184:187], v10 offset:14336
v_cmp_gt_i32_e64 s[92:93], 0, v247
MV 164,v,160,v,176
v_exp_f32 v90, v90
MV 168,v,160,v,184
ds_read_b128 a[188:191], v10 offset:15360
v_cmp_gt_i32_e64 s[94:95], 1, v247
MA 16,a,240,v,176
v_exp_f32 v91, v91
MA 48,a,240,v,184
v_cvt_pk_bf16_f32 v88, v88, v89
v_cmp_gt_i32_e64 s[96:97], 2, v247
MA 20,a,244,v,176
v_exp_f32 v92, v92
MA 52,a,244,v,184
v_cmp_gt_i32_e64 s[98:99], 3, v247
v_cndmask_b32_e64 v116, v116, v14, s[92:93]
MA 24,a,248,v,176
v_exp_f32 v93, v93
MA 56,a,248,v,184
v_cvt_pk_bf16_f32 v89, v90, v91
v_cndmask_b32_e64 v117, v117, v14, s[94:95]
MA 28,a,252,v,176
v_exp_f32 v94, v94
MA 60,a,252,v,184
v_exp_f32 v95, v95
v_cndmask_b32_e64 v118, v118, v14, s[96:97]
v_cvt_pk_bf16_f32 v90, v92, v93
v_cndmask_b32_e64 v119, v119, v14, s[98:99]
v_cvt_pk_bf16_f32 v91, v94, v95
L_p3_s0m_top:
s_waitcnt lgkmcnt(0)
v_mfma_f32_16x16x32_bf16 v[152:155], a[128:131], v[32:35], 0
ds_read_b128 a[192:195], v11 offset:16384
ds_read_b128 a[196:199], v11 offset:17408
MV 152,a,132,v,36
v_exp_f32 v112, v112
MV 152,a,136,v,40
v_exp_f32 v113, v113
MV 152,a,140,v,44
ds_read_b128 a[200:203], v11 offset:18432
ds_read_b128 a[204:207], v11 offset:19456
v_mfma_f32_16x16x32_bf16 v[156:159], a[144:147], v[32:35], 0
v_exp_f32 v114, v114
MV 156,a,148,v,36
v_exp_f32 v115, v115
MV 156,a,152,v,40
ds_read_b128 a[208:211], v11 offset:20480
ds_read_b128 a[212:215], v11 offset:21504
MV 156,a,156,v,44
ds_read_b128 a[216:219], v11 offset:22528
v_cvt_pk_bf16_f32 v112, v112, v113
v_mfma_f32_16x16x32_bf16 v[184:187], a[160:163], v[32:35], 0
v_exp_f32 v116, v116
MV 184,a,164,v,36
v_exp_f32 v117, v117
MV 184,a,168,v,40
ds_read_b128 a[220:223], v11 offset:23552
v_cvt_pk_bf16_f32 v113, v114, v115
MV 184,a,172,v,44
v_exp_f32 v118, v118
v_mfma_f32_16x16x32_bf16 v[188:191], a[176:179], v[32:35], 0
ds_read_b128 a[224:227], v11 offset:24576
ds_read_b128 a[228:231], v11 offset:25600
MV 188,a,180,v,36
v_exp_f32 v119, v119
MV 188,a,184,v,40
ds_read_b128 a[232:235], v11 offset:26624
v_cvt_pk_bf16_f32 v114, v116, v117
MV 188,a,188,v,44
ds_read_b128 a[236:239], v11 offset:27648
ds_read_b128 a[240:243], v11 offset:28672
ds_read_b128 a[244:247], v11 offset:29696
ds_read_b128 a[248:251], v11 offset:30720
ds_read_b128 a[252:255], v11 offset:31744
v_exp_f32 v120, v120
v_exp_f32 v121, v121
v_cvt_pk_bf16_f32 v115, v118, v119
v_exp_f32 v122, v122
v_exp_f32 v123, v123
v_cvt_pk_bf16_f32 v120, v120, v121
v_exp_f32 v124, v124
v_exp_f32 v125, v125
v_cvt_pk_bf16_f32 v121, v122, v123
v_exp_f32 v126, v126
v_exp_f32 v127, v127
v_add_u32 v246, -64, v239
v_cmp_gt_i32_e64 s[84:85], 0, v246
v_cmp_gt_i32_e64 s[86:87], 1, v246
v_cmp_gt_i32_e64 s[88:89], 2, v246
v_cmp_gt_i32_e64 s[90:91], 3, v246
v_cndmask_b32_e64 v152, v152, v14, s[84:85]
v_cndmask_b32_e64 v153, v153, v14, s[86:87]
v_cndmask_b32_e64 v154, v154, v14, s[88:89]
v_cndmask_b32_e64 v155, v155, v14, s[90:91]
v_cvt_pk_bf16_f32 v122, v124, v125
v_cvt_pk_bf16_f32 v123, v126, v127
v_add_u32 v247, -80, v239
v_cmp_gt_i32_e64 s[92:93], 0, v247
v_cmp_gt_i32_e64 s[94:95], 1, v247
v_cmp_gt_i32_e64 s[96:97], 2, v247
v_cmp_gt_i32_e64 s[98:99], 3, v247
v_cndmask_b32_e64 v156, v156, v14, s[92:93]
v_cndmask_b32_e64 v157, v157, v14, s[94:95]
v_cndmask_b32_e64 v158, v158, v14, s[96:97]
v_cndmask_b32_e64 v159, v159, v14, s[98:99]
s_waitcnt vmcnt(4) lgkmcnt(0)
MA 0,a,192,v,80
s_barrier
MA 32,a,192,v,88
MA 4,a,196,v,80
v_lshlrev_b32 v245, 4, v1
s_mov_b32 m0, s43
MA 36,a,196,v,88
v_exp_f32 v152, v152
MA 8,a,200,v,80
MA 40,a,200,v,88
v_exp_f32 v153, v153
MA 12,a,204,v,80
v_add_u32 v246, -96, v239
v_cmp_gt_i32_e64 s[84:85], 0, v246
MA 44,a,204,v,88
MV 164,v,160,v,80
v_exp_f32 v154, v154
MV 168,v,160,v,88
s_nop 0
v_cmp_gt_i32_e64 s[86:87], 1, v246
MA 16,a,208,v,80
MA 48,a,208,v,88
v_cmp_gt_i32_e64 s[88:89], 2, v246
v_cmp_gt_i32_e64 s[90:91], 3, v246
MA 20,a,212,v,80
v_exp_f32 v155, v155
MA 52,a,212,v,88
MA 24,a,216,v,80
v_cvt_pk_bf16_f32 v152, v152, v153
v_cndmask_b32_e64 v184, v184, v14, s[84:85]
MA 56,a,216,v,88
MA 28,a,220,v,80
buffer_load_dwordx4 v245, s[20:23], 0 offen offset:0 sc1 lds
v_cndmask_b32_e64 v185, v185, v14, s[86:87]
MA 60,a,220,v,88
v_exp_f32 v156, v156
MA 0,a,224,v,112
v_cndmask_b32_e64 v186, v186, v14, s[88:89]
v_cndmask_b32_e64 v187, v187, v14, s[90:91]
MA 32,a,224,v,120
MA 4,a,228,v,112
v_exp_f32 v157, v157
MA 36,a,228,v,120
buffer_load_dwordx4 v245, s[20:23], 0 offen offset:1024 sc1 lds
v_add_u32 v247, -112, v239
MA 8,a,232,v,112
v_cvt_pk_bf16_f32 v153, v154, v155
v_cmp_gt_i32_e64 s[92:93], 0, v247
MA 40,a,232,v,120
MA 12,a,236,v,112
buffer_load_dwordx4 v245, s[20:23], 0 offen offset:2048 sc1 lds
v_cmp_gt_i32_e64 s[94:95], 1, v247
MA 44,a,236,v,120
v_exp_f32 v158, v158
MV 164,v,160,v,112
v_cmp_gt_i32_e64 s[96:97], 2, v247
v_cmp_gt_i32_e64 s[98:99], 3, v247
MV 168,v,160,v,120
MA 16,a,240,v,112
MA 48,a,240,v,120
v_exp_f32 v159, v159
MA 20,a,244,v,112
buffer_load_dwordx4 v245, s[20:23], 0 offen offset:3072 sc1 lds
v_cndmask_b32_e64 v188, v188, v14, s[92:93]
MA 52,a,244,v,120
v_cvt_pk_bf16_f32 v154, v156, v157
v_cndmask_b32_e64 v189, v189, v14, s[94:95]
MA 24,a,248,v,112
v_cvt_pk_bf16_f32 v155, v158, v159
v_cndmask_b32_e64 v190, v190, v14, s[96:97]
MA 56,a,248,v,120
MA 28,a,252,v,112
v_cndmask_b32_e64 v191, v191, v14, s[98:99]
MA 60,a,252,v,120
s_load_dwordx2 s[88:89], s[0:1], 104
s_waitcnt lgkmcnt(0)
v_xor_b32 v11, 0x8000, v11
ds_read_b128 a[192:195], v11 offset:0
ds_read_b128 a[196:199], v11 offset:1024
ds_read_b128 a[200:203], v11 offset:2048
ds_read_b128 a[204:207], v11 offset:3072
ds_read_b128 a[208:211], v11 offset:4096
ds_read_b128 a[212:215], v11 offset:5120
ds_read_b128 a[216:219], v11 offset:6144
ds_read_b128 a[220:223], v11 offset:7168
ds_read_b128 a[224:227], v11 offset:8192
ds_read_b128 a[228:231], v11 offset:9216
ds_read_b128 a[232:235], v11 offset:10240
ds_read_b128 a[236:239], v11 offset:11264
ds_read_b128 a[240:243], v11 offset:12288
ds_read_b128 a[244:247], v11 offset:13312
ds_read_b128 a[248:251], v11 offset:14336
ds_read_b128 a[252:255], v11 offset:15360
v_exp_f32 v184, v184
v_exp_f32 v185, v185
v_exp_f32 v186, v186
v_exp_f32 v187, v187
v_cvt_pk_bf16_f32 v184, v184, v185
v_exp_f32 v188, v188
v_exp_f32 v189, v189
v_cvt_pk_bf16_f32 v185, v186, v187
v_exp_f32 v190, v190
v_exp_f32 v191, v191
v_cvt_pk_bf16_f32 v186, v188, v189
v_cvt_pk_bf16_f32 v187, v190, v191
MV 168,v,160,v,152
s_nop 0
MV 168,v,160,v,184
v_mov_b32 v240, v2
v_mov_b32 v241, v3
s_nop 0
v_permlane32_swap_b32 v2, v240
v_permlane32_swap_b32 v3, v241
v_add_f32 v2, v2, v240
v_add_f32 v3, v3, v241
v_mov_b32 v240, v2
v_mov_b32 v241, v3
s_nop 0
v_permlane16_swap_b32 v2, v240
v_permlane16_swap_b32 v3, v241
v_add_f32 v2, v2, v240
v_add_f32 v3, v3, v241
v_add_f32 v2, v2, v164
v_cmp_nle_f32 vcc, 0x30800000, v2
s_nop 0
s_or_b64 s[78:79], s[78:79], vcc
v_cmp_nge_f32 vcc, 0x4e800000, v2
s_nop 0
s_or_b64 s[78:79], s[78:79], vcc
v_add_f32 v3, v3, v168
v_cmp_nle_f32 vcc, 0x30800000, v3
s_nop 0
s_or_b64 s[78:79], s[78:79], vcc
v_cmp_nge_f32 vcc, 0x4e800000, v3
s_nop 0
s_or_b64 s[78:79], s[78:79], vcc
s_cmp_lg_u64 s[78:79], 0
s_cselect_b32 s80, 1, 0
v_mov_b32 v240, s80
s_lshl_b32 s80, s3, 2
s_add_u32 s80, s80, 163824
v_mov_b32 v241, s80
ds_write_b32 v241, v240
v_mov_b32 v241, 163824
s_waitcnt vmcnt(0) lgkmcnt(0)
s_barrier
ds_read_b128 v[244:247], v241
buffer_store_dword v237, v236, s[8:11], s37 offen offset:1024 sc1
MA 32,a,192,v,152
MA 36,a,196,v,152
MA 40,a,200,v,152
MA 44,a,204,v,152
MA 48,a,208,v,152
MA 52,a,212,v,152
s_waitcnt lgkmcnt(0)
v_or3_b32 v240, v244, v245, v246
v_or_b32 v240, v240, v247
MA 56,a,216,v,152
v_cmp_ne_u32 vcc, 0, v240
MA 60,a,220,v,152
MA 32,a,224,v,184
s_cbranch_vccnz L_fallback
MA 36,a,228,v,184
s_mul_i32 s36, s3, 8320
v_and_b32 v16, 15, v1
MA 40,a,232,v,184
v_lshrrev_b32 v17, 4, v1
v_add_u32 v18, 1, v16
MA 44,a,236,v,184
v_and_b32 v19, 1, v18
v_mul_u32_u24 v19, 4160, v19
MA 48,a,240,v,184
v_add_u32 v18, 2, v16
v_lshrrev_b32 v18, 1, v18
MA 52,a,244,v,184
v_lshl_add_u32 v19, v18, 2, v19
v_lshl_add_u32 v19, v17, 4, v19
MA 56,a,248,v,184
v_add_u32 v40, s36, v19
v_add_u32 v41, 1024, v40
MA 60,a,252,v,184
v_add_u32 v42, 2048, v40
v_add_u32 v43, 3072, v40
v_add_u32 v10, s36, v232
v_lshlrev_b32 v18, 5, v16
v_lshlrev_b32 v19, 4, v17
v_sub_u32 v19, v19, v18
s_add_u32 s37, s43, 480
v_add_u32 v5, s37, v19
v_mov_b32 v20, 0
v_mov_b32 v21, 0
v_mov_b32 v22, 0
v_mov_b32 v23, 0
v_and_b32 v16, 1, v1
v_mul_u32_u24 v16, 4160, v16
v_and_b32 v17, 2, v1
v_lshl_add_u32 v16, v17, 3, v16
v_add_u32 v16, s36, v16
ds_write_b128 v16, v[20:23]
v_and_b32 v17, 31, v1
v_lshlrev_b32 v17, 4, v17
v_add_u32 v17, s43, v17
ds_write_b128 v17, v[20:23] offset:4096
v_mov_b32 v209, 0
ds_write_b128 v10, v[210:213] offset:32
s_nop 0
v_mov_b32_dpp v209, v213 wave_shr:1 row_mask:0xf bank_mask:0xf
v_alignbit_b32 v24, v210, v209, 16
v_alignbit_b32 v25, v211, v210, 16
v_alignbit_b32 v26, v212, v211, 16
v_alignbit_b32 v27, v213, v212, 16
ds_write_b128 v10, v[24:27] offset:4192
v_mov_b32_dpp v215, v213 wave_ror:1 row_mask:0xf bank_mask:0xf
ds_write_b128 v10, v[216:219] offset:1056
s_nop 0
v_mov_b32_dpp v215, v219 wave_shr:1 row_mask:0xf bank_mask:0xf
v_alignbit_b32 v28, v216, v215, 16
v_alignbit_b32 v29, v217, v216, 16
v_alignbit_b32 v30, v218, v217, 16
v_alignbit_b32 v31, v219, v218, 16
ds_write_b128 v10, v[28:31] offset:5216
v_mov_b32_dpp v221, v219 wave_ror:1 row_mask:0xf bank_mask:0xf
ds_write_b128 v10, v[222:225] offset:2080
s_nop 0
v_mov_b32_dpp v221, v225 wave_shr:1 row_mask:0xf bank_mask:0xf
v_alignbit_b32 v24, v222, v221, 16
v_alignbit_b32 v25, v223, v222, 16
v_alignbit_b32 v26, v224, v223, 16
v_alignbit_b32 v27, v225, v224, 16
ds_write_b128 v10, v[24:27] offset:6240
v_mov_b32_dpp v227, v225 wave_ror:1 row_mask:0xf bank_mask:0xf
ds_write_b128 v10, v[228:231] offset:3104
s_nop 0
v_mov_b32_dpp v227, v231 wave_shr:1 row_mask:0xf bank_mask:0xf
v_alignbit_b32 v28, v228, v227, 16
v_alignbit_b32 v29, v229, v228, 16
v_alignbit_b32 v30, v230, v229, 16
v_alignbit_b32 v31, v231, v230, 16
ds_write_b128 v10, v[28:31] offset:7264
ds_read_b128 a[160:163], v5 offset:3584
ds_read2_b32 a[128:129], v40 offset0:0 offset1:1
ds_read2_b32 a[130:131], v40 offset0:2 offset1:3
ds_read_b128 a[164:167], v5 offset:3072
ds_read2_b32 a[132:133], v40 offset0:128 offset1:129
ds_read2_b32 a[134:135], v40 offset0:130 offset1:131
ds_read_b128 a[168:171], v5 offset:2560
ds_read2_b32 a[136:137], v41 offset0:0 offset1:1
ds_read2_b32 a[138:139], v41 offset0:2 offset1:3
ds_read_b128 a[172:175], v5 offset:2048
ds_read2_b32 a[140:141], v41 offset0:128 offset1:129
ds_read2_b32 a[142:143], v41 offset0:130 offset1:131
ds_read_b128 a[176:179], v5 offset:1536
ds_read2_b32 a[144:145], v42 offset0:0 offset1:1
ds_read2_b32 a[146:147], v42 offset0:2 offset1:3
ds_read_b128 a[180:183], v5 offset:1024
ds_read2_b32 a[148:149], v42 offset0:128 offset1:129
ds_read2_b32 a[150:151], v42 offset0:130 offset1:131
ds_read_b128 a[184:187], v5 offset:512
ds_read2_b32 a[152:153], v43 offset0:0 offset1:1
ds_read2_b32 a[154:155], v43 offset0:2 offset1:3
ds_read_b128 a[188:191], v5 offset:0
ds_read2_b32 a[156:157], v43 offset0:128 offset1:129
ds_read2_b32 a[158:159], v43 offset0:130 offset1:131
v_rcp_f32 v2, v2
v_rcp_f32 v3, v3
s_add_u32 s80, s100, s76
s_nop 4
v_accvgpr_read_b32 v240, a0
v_accvgpr_read_b32 v241, a1
v_accvgpr_read_b32 v242, a2
v_accvgpr_read_b32 v243, a3
v_accvgpr_read_b32 v244, a4
v_accvgpr_read_b32 v245, a5
v_accvgpr_read_b32 v246, a6
v_accvgpr_read_b32 v247, a7
v_pk_mul_f32 v[240:241], v[240:241], v[2:3] op_sel:[0,0] op_sel_hi:[1,0]
v_pk_mul_f32 v[242:243], v[242:243], v[2:3] op_sel:[0,0] op_sel_hi:[1,0]
v_pk_mul_f32 v[244:245], v[244:245], v[2:3] op_sel:[0,0] op_sel_hi:[1,0]
v_pk_mul_f32 v[246:247], v[246:247], v[2:3] op_sel:[0,0] op_sel_hi:[1,0]
v_cvt_pk_bf16_f32 v248, v240, v241
v_cvt_pk_bf16_f32 v249, v242, v243
v_cvt_pk_bf16_f32 v250, v244, v245
v_cvt_pk_bf16_f32 v251, v246, v247
buffer_store_dwordx4 v[248:251], v15, s[60:63], s100 offen offset:0 sc1
v_accvgpr_read_b32 v240, a8
v_accvgpr_read_b32 v241, a9
v_accvgpr_read_b32 v242, a10
v_accvgpr_read_b32 v243, a11
v_accvgpr_read_b32 v244, a12
v_accvgpr_read_b32 v245, a13
v_accvgpr_read_b32 v246, a14
v_accvgpr_read_b32 v247, a15
v_pk_mul_f32 v[240:241], v[240:241], v[2:3] op_sel:[0,0] op_sel_hi:[1,0]
v_pk_mul_f32 v[242:243], v[242:243], v[2:3] op_sel:[0,0] op_sel_hi:[1,0]
v_pk_mul_f32 v[244:245], v[244:245], v[2:3] op_sel:[0,0] op_sel_hi:[1,0]
v_pk_mul_f32 v[246:247], v[246:247], v[2:3] op_sel:[0,0] op_sel_hi:[1,0]
v_cvt_pk_bf16_f32 v252, v240, v241
v_cvt_pk_bf16_f32 v253, v242, v243
v_cvt_pk_bf16_f32 v254, v244, v245
v_cvt_pk_bf16_f32 v255, v246, v247
buffer_store_dwordx4 v[252:255], v15, s[60:63], s100 offen offset:1024 sc1
v_accvgpr_read_b32 v240, a16
v_accvgpr_read_b32 v241, a17
v_accvgpr_read_b32 v242, a18
v_accvgpr_read_b32 v243, a19
v_accvgpr_read_b32 v244, a20
v_accvgpr_read_b32 v245, a21
v_accvgpr_read_b32 v246, a22
v_accvgpr_read_b32 v247, a23
v_pk_mul_f32 v[240:241], v[240:241], v[2:3] op_sel:[0,0] op_sel_hi:[1,0]
v_pk_mul_f32 v[242:243], v[242:243], v[2:3] op_sel:[0,0] op_sel_hi:[1,0]
v_pk_mul_f32 v[244:245], v[244:245], v[2:3] op_sel:[0,0] op_sel_hi:[1,0]
v_pk_mul_f32 v[246:247], v[246:247], v[2:3] op_sel:[0,0] op_sel_hi:[1,0]
v_cvt_pk_bf16_f32 v248, v240, v241
v_cvt_pk_bf16_f32 v249, v242, v243
v_cvt_pk_bf16_f32 v250, v244, v245
v_cvt_pk_bf16_f32 v251, v246, v247
buffer_store_dwordx4 v[248:251], v15, s[60:63], s100 offen offset:2048 sc1
v_accvgpr_read_b32 v240, a24
v_accvgpr_read_b32 v241, a25
v_accvgpr_read_b32 v242, a26
v_accvgpr_read_b32 v243, a27
v_accvgpr_read_b32 v244, a28
v_accvgpr_read_b32 v245, a29
v_accvgpr_read_b32 v246, a30
v_accvgpr_read_b32 v247, a31
v_pk_mul_f32 v[240:241], v[240:241], v[2:3] op_sel:[0,0] op_sel_hi:[1,0]
v_pk_mul_f32 v[242:243], v[242:243], v[2:3] op_sel:[0,0] op_sel_hi:[1,0]
v_pk_mul_f32 v[244:245], v[244:245], v[2:3] op_sel:[0,0] op_sel_hi:[1,0]
v_pk_mul_f32 v[246:247], v[246:247], v[2:3] op_sel:[0,0] op_sel_hi:[1,0]
v_cvt_pk_bf16_f32 v252, v240, v241
v_cvt_pk_bf16_f32 v253, v242, v243
v_cvt_pk_bf16_f32 v254, v244, v245
v_cvt_pk_bf16_f32 v255, v246, v247
buffer_store_dwordx4 v[252:255], v15, s[60:63], s100 offen offset:3072 sc1
v_accvgpr_read_b32 v240, a32
v_accvgpr_read_b32 v241, a33
v_accvgpr_read_b32 v242, a34
v_accvgpr_read_b32 v243, a35
v_accvgpr_read_b32 v244, a36
v_accvgpr_read_b32 v245, a37
v_accvgpr_read_b32 v246, a38
v_accvgpr_read_b32 v247, a39
v_pk_mul_f32 v[240:241], v[240:241], v[2:3] op_sel:[0,1] op_sel_hi:[1,1]
v_pk_mul_f32 v[242:243], v[242:243], v[2:3] op_sel:[0,1] op_sel_hi:[1,1]
v_pk_mul_f32 v[244:245], v[244:245], v[2:3] op_sel:[0,1] op_sel_hi:[1,1]
v_pk_mul_f32 v[246:247], v[246:247], v[2:3] op_sel:[0,1] op_sel_hi:[1,1]
v_cvt_pk_bf16_f32 v248, v240, v241
v_cvt_pk_bf16_f32 v249, v242, v243
v_cvt_pk_bf16_f32 v250, v244, v245
v_cvt_pk_bf16_f32 v251, v246, v247
buffer_store_dwordx4 v[248:251], v15, s[60:63], s80 offen offset:0 sc1
v_accvgpr_read_b32 v240, a40
v_accvgpr_read_b32 v241, a41
v_accvgpr_read_b32 v242, a42
v_accvgpr_read_b32 v243, a43
v_accvgpr_read_b32 v244, a44
v_accvgpr_read_b32 v245, a45
v_accvgpr_read_b32 v246, a46
v_accvgpr_read_b32 v247, a47
v_pk_mul_f32 v[240:241], v[240:241], v[2:3] op_sel:[0,1] op_sel_hi:[1,1]
v_pk_mul_f32 v[242:243], v[242:243], v[2:3] op_sel:[0,1] op_sel_hi:[1,1]
v_pk_mul_f32 v[244:245], v[244:245], v[2:3] op_sel:[0,1] op_sel_hi:[1,1]
v_pk_mul_f32 v[246:247], v[246:247], v[2:3] op_sel:[0,1] op_sel_hi:[1,1]
v_cvt_pk_bf16_f32 v252, v240, v241
v_cvt_pk_bf16_f32 v253, v242, v243
v_cvt_pk_bf16_f32 v254, v244, v245
v_cvt_pk_bf16_f32 v255, v246, v247
buffer_store_dwordx4 v[252:255], v15, s[60:63], s80 offen offset:1024 sc1
v_accvgpr_read_b32 v240, a48
v_accvgpr_read_b32 v241, a49
v_accvgpr_read_b32 v242, a50
v_accvgpr_read_b32 v243, a51
v_accvgpr_read_b32 v244, a52
v_accvgpr_read_b32 v245, a53
v_accvgpr_read_b32 v246, a54
v_accvgpr_read_b32 v247, a55
v_pk_mul_f32 v[240:241], v[240:241], v[2:3] op_sel:[0,1] op_sel_hi:[1,1]
v_pk_mul_f32 v[242:243], v[242:243], v[2:3] op_sel:[0,1] op_sel_hi:[1,1]
v_pk_mul_f32 v[244:245], v[244:245], v[2:3] op_sel:[0,1] op_sel_hi:[1,1]
v_pk_mul_f32 v[246:247], v[246:247], v[2:3] op_sel:[0,1] op_sel_hi:[1,1]
v_cvt_pk_bf16_f32 v248, v240, v241
v_cvt_pk_bf16_f32 v249, v242, v243
v_cvt_pk_bf16_f32 v250, v244, v245
v_cvt_pk_bf16_f32 v251, v246, v247
buffer_store_dwordx4 v[248:251], v15, s[60:63], s80 offen offset:2048 sc1
v_accvgpr_read_b32 v240, a56
v_accvgpr_read_b32 v241, a57
v_accvgpr_read_b32 v242, a58
v_accvgpr_read_b32 v243, a59
v_accvgpr_read_b32 v244, a60
v_accvgpr_read_b32 v245, a61
v_accvgpr_read_b32 v246, a62
v_accvgpr_read_b32 v247, a63
v_pk_mul_f32 v[240:241], v[240:241], v[2:3] op_sel:[0,1] op_sel_hi:[1,1]
v_pk_mul_f32 v[242:243], v[242:243], v[2:3] op_sel:[0,1] op_sel_hi:[1,1]
v_pk_mul_f32 v[244:245], v[244:245], v[2:3] op_sel:[0,1] op_sel_hi:[1,1]
v_pk_mul_f32 v[246:247], v[246:247], v[2:3] op_sel:[0,1] op_sel_hi:[1,1]
v_cvt_pk_bf16_f32 v252, v240, v241
v_cvt_pk_bf16_f32 v253, v242, v243
v_cvt_pk_bf16_f32 v254, v244, v245
v_cvt_pk_bf16_f32 v255, v246, v247
buffer_store_dwordx4 v[252:255], v15, s[60:63], s80 offen offset:3072 sc1
L_p3_done:
s_nop 1
v_lshlrev_b32 v255, 20, v1
v_mov_b32 v253, 1
s_lshl_b32 s83, s3, 8
s_add_u32 s83, s83, s2
s_lshl_b32 s83, s83, 2
s_add_u32 s83, s83, 4096
s_waitcnt lgkmcnt(15)
v_mfma_f32_16x16x32_bf16 v[76:79], a[128:131], a[160:163], 0
v_and_b32 v16, 15, v1
v_lshrrev_b32 v17, 4, v1
v_mfma_f32_16x16x32_bf16 v[80:83], a[128:131], a[164:167], 0
v_lshl_add_u32 v18, v17, 3, v16
ds_read_b128 a[224:227], v5 offset:3648
v_mfma_f32_16x16x32_bf16 v[84:87], a[128:131], a[168:171], 0
v_sub_u32 v235, 15, v18
ds_read2_b32 a[192:193], v40 offset0:16 offset1:17
s_waitcnt lgkmcnt(15)
v_mfma_f32_16x16x32_bf16 v[88:91], a[128:131], a[172:175], 0
v_lshlrev_b32 v18, 16, v234
ds_read2_b32 a[194:195], v40 offset0:18 offset1:19
s_waitcnt lgkmcnt(14)
v_mfma_f32_16x16x32_bf16 v[92:95], a[128:131], a[176:179], 0
v_cmp_eq_u32 vcc, 0, v235
v_cmp_eq_u32_e64 s[38:39], 1, v235
s_waitcnt lgkmcnt(11)
v_mfma_f32_16x16x32_bf16 v[96:99], a[128:131], a[180:183], 0
ds_read_b128 a[228:231], v5 offset:3136
ds_read2_b32 a[196:197], v40 offset0:144 offset1:145
s_waitcnt lgkmcnt(10)
v_mfma_f32_16x16x32_bf16 v[100:103], a[128:131], a[184:187], 0
s_nop 0
v_cndmask_b32 v44, 0, v234, vcc
s_waitcnt lgkmcnt(7)
v_mfma_f32_16x16x32_bf16 v[104:107], a[128:131], a[188:191], 0
ds_read2_b32 a[198:199], v40 offset0:146 offset1:147
ds_read_b128 a[232:235], v5 offset:2624
MV 80,a,132,a,160
v_cndmask_b32_e64 v44, v44, v18, s[38:39]
ds_read2_b32 a[200:201], v41 offset0:16 offset1:17
MV 84,a,132,a,164
v_cmp_eq_u32 vcc, 2, v235
v_cmp_eq_u32_e64 s[38:39], 3, v235
MV 88,a,132,a,168
ds_read2_b32 a[202:203], v41 offset0:18 offset1:19
s_and_b32 s81, s2, 3
MV 92,a,132,a,172
s_nop 0
v_cndmask_b32 v45, 0, v234, vcc
MV 96,a,132,a,176
ds_read_b128 a[236:239], v5 offset:2112
ds_read2_b32 a[204:205], v41 offset0:144 offset1:145
MV 100,a,132,a,180
v_cndmask_b32_e64 v45, v45, v18, s[38:39]
ds_read2_b32 a[206:207], v41 offset0:146 offset1:147
MV 104,a,132,a,184
v_cmp_eq_u32 vcc, 4, v235
v_cmp_eq_u32_e64 s[38:39], 5, v235
MV 84,a,136,a,160
ds_read_b128 a[240:243], v5 offset:1600
s_lshl_b32 s81, s81, 1
MV 88,a,136,a,164
s_nop 0
v_cndmask_b32 v46, 0, v234, vcc
MV 92,a,136,a,168
ds_read2_b32 a[208:209], v42 offset0:16 offset1:17
ds_read2_b32 a[210:211], v42 offset0:18 offset1:19
MV 96,a,136,a,172
v_cndmask_b32_e64 v46, v46, v18, s[38:39]
ds_read_b128 a[244:247], v5 offset:1088
MV 100,a,136,a,176
v_cmp_eq_u32 vcc, 6, v235
v_cmp_eq_u32_e64 s[38:39], 7, v235
MV 104,a,136,a,180
ds_read2_b32 a[212:213], v42 offset0:144 offset1:145
s_sub_u32 s74, 14, s81
MV 88,a,140,a,160
s_nop 0
v_cndmask_b32 v47, 0, v234, vcc
MV 92,a,140,a,164
ds_read2_b32 a[214:215], v42 offset0:146 offset1:147
ds_read_b128 a[248:251], v5 offset:576
MV 96,a,140,a,168
v_cndmask_b32_e64 v47, v47, v18, s[38:39]
ds_read2_b32 a[216:217], v43 offset0:16 offset1:17
MV 100,a,140,a,172
s_bitcmp1_b32 s2, 4
s_cselect_b32 s81, s74, s81
MV 104,a,140,a,176
ds_read2_b32 a[218:219], v43 offset0:18 offset1:19
s_bfe_u32 s74, s2, 0x10003
MV 92,a,144,a,160
ds_read_b128 a[252:255], v5 offset:64
s_add_u32 s81, s81, s74
MV 96,a,144,a,164
ds_read2_b32 a[220:221], v43 offset0:144 offset1:145
s_bfe_u32 s82, s2, 0x10002
MV 100,a,144,a,168
ds_read2_b32 a[222:223], v43 offset0:146 offset1:147
s_lshr_b32 s74, s2, 5
MV 104,a,144,a,172
s_lshl_b32 s74, s74, 1
s_add_u32 s82, s82, s74
MV 96,a,148,a,160
s_mov_b32 s72, s81
s_mov_b32 s73, s82
MV 100,a,148,a,164
s_lshl_b32 s74, s72, 2
s_add_u32 s74, s74, s3
MV 104,a,148,a,168
s_lshl_b32 s68, s74, 18
MV 100,a,152,a,160
MV 104,a,152,a,164
s_and_b32 s80, s73, 1
s_waitcnt lgkmcnt(15)
MV 104,a,156,a,160
MV 76,v,44,a,160
s_lshl_b32 s75, s80, 16
MV 80,v,44,a,164
MV 84,v,44,a,168
s_add_u32 s68, s68, s75
MV 88,v,44,a,172
MV 92,v,44,a,176
s_lshl_b32 s69, s73, 19
MV 96,v,44,a,180
MV 100,v,44,a,184
MV 104,v,44,a,188
s_waitcnt vmcnt(0)
buffer_store_dword v253, v255, s[8:11], s83 offen sc1
MV 76,a,192,a,224
ds_read_b128 a[160:163], v5 offset:3712
s_lshl_b32 s75, s73, 7
MV 80,a,196,a,224
ds_read2_b32 a[128:129], v40 offset0:32 offset1:33
s_lshl_b32 s70, s3, 12
MV 80,a,192,a,228
ds_read2_b32 a[130:131], v40 offset0:34 offset1:35
s_lshl_b32 s78, s74, 16
MV 84,a,196,a,228
ds_read_b128 a[164:167], v5 offset:3200
s_add_u32 s78, s78, s75
MV 84,a,192,a,232
s_lshl_b32 s79, s73, 18
s_lshl_b32 s75, s74, 8
MV 88,a,196,a,232
ds_read2_b32 a[132:133], v40 offset0:160 offset1:161
s_add_u32 s79, s79, s75
s_waitcnt lgkmcnt(15)
MV 88,a,192,a,236
ds_read2_b32 a[134:135], v40 offset0:162 offset1:163
v_lshlrev_b32 v236, 4, v1
MV 92,a,196,a,236
ds_read_b128 a[168:171], v5 offset:2688
v_add_u32 v237, 0x20000, v236
MV 92,a,192,a,240
ds_read2_b32 a[136:137], v41 offset0:32 offset1:33
v_add_u32 v238, s70, v236
MV 96,a,196,a,240
s_lshl_b32 s75, s80, 12
v_add_u32 v244, s75, v236
s_waitcnt lgkmcnt(15)
MV 96,a,192,a,244
ds_read2_b32 a[138:139], v41 offset0:34 offset1:35
v_xor_b32 v245, 0x1000, v244
MV 100,a,196,a,244
ds_read_b128 a[172:175], v5 offset:2176
v_add_u32 v242, 66560, v244
s_waitcnt lgkmcnt(15)
MV 100,a,192,a,248
ds_read2_b32 a[140:141], v41 offset0:160 offset1:161
v_add_u32 v243, 66560, v245
MV 104,a,196,a,248
ds_read2_b32 a[142:143], v41 offset0:162 offset1:163
v_bfe_u32 v50, v1, 4, 1
s_waitcnt lgkmcnt(14)
MV 104,a,192,a,252
v_lshrrev_b32 v52, 5, v1
v_and_b32 v48, 15, v1
MV 84,a,200,a,224
ds_read_b128 a[176:179], v5 offset:1664
v_lshlrev_b32 v53, 5, v50
MV 88,a,204,a,224
ds_read2_b32 a[144:145], v42 offset0:32 offset1:33
v_lshl_add_u32 v53, v52, 4, v53
MV 88,a,200,a,228
ds_read2_b32 a[146:147], v42 offset0:34 offset1:35
v_lshl_add_u32 v250, v48, 11, v53
MV 92,a,204,a,228
ds_read_b128 a[180:183], v5 offset:1152
v_lshlrev_b32 v53, 11, v53
MV 92,a,200,a,232
v_lshl_add_u32 v251, v48, 3, v53
MV 96,a,204,a,232
ds_read2_b32 a[148:149], v42 offset0:160 offset1:161
MV 96,a,200,a,236
ds_read2_b32 a[150:151], v42 offset0:162 offset1:163
MV 100,a,204,a,236
ds_read_b128 a[184:187], v5 offset:640
MV 100,a,200,a,240
ds_read2_b32 a[152:153], v43 offset0:32 offset1:33
MV 104,a,204,a,240
s_add_u32 s44, s40, 33554432
s_addc_u32 s45, s41, 0
MV 104,a,200,a,244
ds_read2_b32 a[154:155], v43 offset0:34 offset1:35
s_mov_b32 s46, 16777216
MV 92,a,208,a,224
ds_read_b128 a[188:191], v5 offset:128
s_mov_b32 s47, 0x20000
MV 96,a,212,a,224
ds_read2_b32 a[156:157], v43 offset0:160 offset1:161
MV 96,a,208,a,228
ds_read2_b32 a[158:159], v43 offset0:162 offset1:163
MV 100,a,212,a,228
s_add_u32 s48, s40, 100663296
s_addc_u32 s49, s41, 0
MV 100,a,208,a,232
s_mov_b32 s50, 8388608
s_mov_b32 s51, 0x20000
MV 104,a,212,a,232
s_add_u32 s52, s40, 109051904
s_addc_u32 s53, s41, 0
MV 104,a,208,a,236
s_mov_b32 s54, 4194304
s_mov_b32 s55, 0x20000
MV 100,a,216,a,224
s_add_u32 s56, s40, 54525952
s_addc_u32 s57, s41, 0
s_waitcnt lgkmcnt(15)
MV 104,a,220,a,224
s_mov_b32 s58, 4194304
s_mov_b32 s59, 0x20000
MV 104,a,216,a,228
s_mov_b32 s60, s88
s_mov_b32 s61, s89
s_mov_b32 s62, 4194304
s_mov_b32 s63, 0x20000
s_lshr_b32 s36, s82, 1
s_lshl_b32 s37, s80, 7
s_add_u32 s36, s36, s37
v_lshl_add_u32 v254, v1, 3, s36
s_xor_b32 s36, s2, 4
v_mov_b32 v253, s36
v_cmp_lt_u32 vcc, 15, v1
s_nop 1
v_cndmask_b32 v254, v254, v253, vcc
v_lshlrev_b32 v254, 2, v254
buffer_load_dword v253, v254, s[8:11], 0 offen offset:1024 sc1
MV 76,a,128,a,160
ds_read_b128 a[224:227], v5 offset:3776
s_sub_u32 s36, 15, s81
MV 80,a,132,a,160
ds_read2_b32 a[192:193], v40 offset0:48 offset1:49
s_min_u32 s36, s36, s81
MV 80,a,128,a,164
ds_read2_b32 a[194:195], v40 offset0:50 offset1:51
MV 84,a,132,a,164
ds_read_b128 a[228:231], v5 offset:3264
s_lshr_b32 s37, s36, 1
MV 84,a,128,a,168
MV 88,a,132,a,168
ds_read2_b32 a[196:197], v40 offset0:176 offset1:177
s_xor_b32 s36, s36, s37
s_waitcnt lgkmcnt(15)
MV 88,a,128,a,172
ds_read2_b32 a[198:199], v40 offset0:178 offset1:179
s_and_b32 s36, s36, 1
MV 92,a,132,a,172
ds_read_b128 a[232:235], v5 offset:2752
MV 92,a,128,a,176
ds_read2_b32 a[200:201], v41 offset0:48 offset1:49
s_lshl_b32 s37, s37, 6
MV 96,a,132,a,176
s_waitcnt lgkmcnt(15)
MV 96,a,128,a,180
ds_read2_b32 a[202:203], v41 offset0:50 offset1:51
s_add_u32 s36, s36, s37
MV 100,a,132,a,180
ds_read_b128 a[236:239], v5 offset:2240
s_lshl_b32 s37, s80, 2
s_waitcnt lgkmcnt(15)
MV 100,a,128,a,184
ds_read2_b32 a[204:205], v41 offset0:176 offset1:177
MV 104,a,132,a,184
ds_read2_b32 a[206:207], v41 offset0:178 offset1:179
s_add_u32 s36, s36, s37
s_waitcnt lgkmcnt(14)
MV 104,a,128,a,188
MV 84,a,136,a,160
ds_read_b128 a[240:243], v5 offset:1728
s_add_u32 s36, s36, 1024
MV 88,a,140,a,160
ds_read2_b32 a[208:209], v42 offset0:48 offset1:49
v_bfe_u32 v228, v1, 4, 1
MV 88,a,136,a,164
ds_read2_b32 a[210:211], v42 offset0:50 offset1:51
MV 92,a,140,a,164
ds_read_b128 a[244:247], v5 offset:1216
v_lshl_add_u32 v228, s3, 1, v228
MV 92,a,136,a,168
MV 96,a,140,a,168
ds_read2_b32 a[212:213], v42 offset0:176 offset1:177
v_sub_u32 v229, 7, v228
MV 96,a,136,a,172
ds_read2_b32 a[214:215], v42 offset0:178 offset1:179
v_min_u32 v228, v228, v229
MV 100,a,140,a,172
ds_read_b128 a[248:251], v5 offset:704
MV 100,a,136,a,176
ds_read2_b32 a[216:217], v43 offset0:48 offset1:49
v_lshl_add_u32 v229, v228, 8, s36
MV 104,a,140,a,176
MV 104,a,136,a,180
ds_read2_b32 a[218:219], v43 offset0:50 offset1:51
v_and_b32 v252, 7, v1
MV 92,a,144,a,160
ds_read_b128 a[252:255], v5 offset:192
v_lshlrev_b32 v252, 3, v252
MV 96,a,148,a,160
ds_read2_b32 a[220:221], v43 offset0:176 offset1:177
MV 96,a,144,a,164
ds_read2_b32 a[222:223], v43 offset0:178 offset1:179
v_bfe_u32 v228, v1, 3, 1
MV 100,a,148,a,164
MV 100,a,144,a,168
v_lshlrev_b32 v228, 1, v228
MV 104,a,148,a,168
v_add3_u32 v252, v252, v228, v229
MV 104,a,144,a,172
MV 100,a,152,a,160
v_lshlrev_b32 v252, 2, v252
s_waitcnt lgkmcnt(15)
MV 104,a,156,a,160
MV 104,a,152,a,164
s_waitcnt vmcnt(0)
v_cmp_gt_u32 vcc, 1, v253
s_nop 4
s_cbranch_vccnz L_spin_w
L_spin_w_ret:
MV 76,a,192,a,224
ds_read_b128 a[160:163], v5 offset:3840
s_add_u32 m0, s70, 66560
MV 80,a,196,a,224
ds_read2_b32 a[128:129], v40 offset0:64 offset1:65
v_lshlrev_b32 v255, 20, v1
MV 80,a,192,a,228
ds_read2_b32 a[130:131], v40 offset0:66 offset1:67
buffer_load_dwordx4 v238, s[48:51], s69 offen offset:0 sc1 lds
MV 84,a,196,a,228
ds_read_b128 a[164:167], v5 offset:3328
MV 84,a,192,a,232
MV 88,a,196,a,232
ds_read2_b32 a[132:133], v40 offset0:192 offset1:193
buffer_load_dwordx4 v238, s[48:51], s69 offen offset:1024 sc1 lds
s_waitcnt lgkmcnt(15)
MV 88,a,192,a,236
ds_read2_b32 a[134:135], v40 offset0:194 offset1:195
MV 92,a,196,a,236
ds_read_b128 a[168:171], v5 offset:2816
MV 92,a,192,a,240
ds_read2_b32 a[136:137], v41 offset0:64 offset1:65
buffer_load_dwordx4 v238, s[48:51], s69 offen offset:2048 sc1 lds
MV 96,a,196,a,240
s_waitcnt lgkmcnt(15)
MV 96,a,192,a,244
ds_read2_b32 a[138:139], v41 offset0:66 offset1:67
MV 100,a,196,a,244
ds_read_b128 a[172:175], v5 offset:2304
buffer_load_dwordx4 v238, s[48:51], s69 offen offset:3072 sc1 lds
s_waitcnt lgkmcnt(15)
MV 100,a,192,a,248
ds_read2_b32 a[140:141], v41 offset0:192 offset1:193
s_lshl_b32 s36, s3, 26
MV 104,a,196,a,248
ds_read2_b32 a[142:143], v41 offset0:194 offset1:195
s_waitcnt lgkmcnt(14)
MV 104,a,192,a,252
s_add_u32 s69, s69, 16384
MV 84,a,200,a,224
ds_read_b128 a[176:179], v5 offset:1792
MV 88,a,204,a,224
ds_read2_b32 a[144:145], v42 offset0:64 offset1:65
MV 88,a,200,a,228
ds_read2_b32 a[146:147], v42 offset0:66 offset1:67
s_add_u32 m0, s70, 82944
MV 92,a,204,a,228
ds_read_b128 a[180:183], v5 offset:1280
MV 92,a,200,a,232
MV 96,a,204,a,232
ds_read2_b32 a[148:149], v42 offset0:192 offset1:193
buffer_load_dwordx4 v238, s[48:51], s69 offen offset:0 sc1 lds
MV 96,a,200,a,236
ds_read2_b32 a[150:151], v42 offset0:194 offset1:195
MV 100,a,204,a,236
ds_read_b128 a[184:187], v5 offset:768
MV 100,a,200,a,240
ds_read2_b32 a[152:153], v43 offset0:64 offset1:65
buffer_load_dwordx4 v238, s[48:51], s69 offen offset:1024 sc1 lds
MV 104,a,204,a,240
v_add_u32 v255, s36, v255
MV 104,a,200,a,244
ds_read2_b32 a[154:155], v43 offset0:66 offset1:67
MV 92,a,208,a,224
ds_read_b128 a[188:191], v5 offset:256
buffer_load_dwordx4 v238, s[48:51], s69 offen offset:2048 sc1 lds
MV 96,a,212,a,224
ds_read2_b32 a[156:157], v43 offset0:192 offset1:193
MV 96,a,208,a,228
ds_read2_b32 a[158:159], v43 offset0:194 offset1:195
MV 100,a,212,a,228
buffer_load_dwordx4 v238, s[48:51], s69 offen offset:3072 sc1 lds
MV 100,a,208,a,232
MV 104,a,212,a,232
MV 104,a,208,a,236
s_add_u32 s69, s69, 16384
MV 100,a,216,a,224
s_waitcnt lgkmcnt(15)
MV 104,a,220,a,224
MV 104,a,216,a,228
MV 76,a,128,a,160
ds_read_b128 a[224:227], v5 offset:3904
s_add_u32 m0, s70, 99328
MV 80,a,132,a,160
ds_read2_b32 a[192:193], v40 offset0:80 offset1:81
v_mul_u32_u24 v18, 136, v16
MV 80,a,128,a,164
ds_read2_b32 a[194:195], v40 offset0:82 offset1:83
v_lshl_add_u32 v18, v17, 5, v18
MV 84,a,132,a,164
ds_read_b128 a[228:231], v5 offset:3392
MV 84,a,128,a,168
MV 88,a,132,a,168
ds_read2_b32 a[196:197], v40 offset0:208 offset1:209
buffer_load_dwordx4 v238, s[48:51], s69 offen offset:0 sc1 lds
s_waitcnt lgkmcnt(15)
MV 88,a,128,a,172
ds_read2_b32 a[198:199], v40 offset0:210 offset1:211
s_lshl_b32 s37, s3, 1
MV 92,a,132,a,172
ds_read_b128 a[232:235], v5 offset:2880
s_add_u32 s37, s37, 49152
MV 92,a,128,a,176
ds_read2_b32 a[200:201], v41 offset0:80 offset1:81
MV 96,a,132,a,176
s_waitcnt lgkmcnt(15)
MV 96,a,128,a,180
ds_read2_b32 a[202:203], v41 offset0:82 offset1:83
v_add_u32 v11, s37, v18
MV 100,a,132,a,180
ds_read_b128 a[236:239], v5 offset:2368
buffer_load_dwordx4 v238, s[48:51], s69 offen offset:1024 sc1 lds
s_waitcnt lgkmcnt(15)
MV 100,a,128,a,184
ds_read2_b32 a[204:205], v41 offset0:208 offset1:209
v_lshrrev_b32 v18, 3, v1
MV 104,a,132,a,184
ds_read2_b32 a[206:207], v41 offset0:210 offset1:211
s_waitcnt lgkmcnt(14)
MV 104,a,128,a,188
MV 84,a,136,a,160
ds_read_b128 a[240:243], v5 offset:1856
v_mul_u32_u24 v18, 136, v18
MV 88,a,140,a,160
ds_read2_b32 a[208:209], v42 offset0:80 offset1:81
MV 88,a,136,a,164
ds_read2_b32 a[210:211], v42 offset0:82 offset1:83
buffer_load_dwordx4 v238, s[48:51], s69 offen offset:2048 sc1 lds
MV 92,a,140,a,164
ds_read_b128 a[244:247], v5 offset:1344
v_and_b32 v19, 7, v1
MV 92,a,136,a,168
MV 96,a,140,a,168
ds_read2_b32 a[212:213], v42 offset0:208 offset1:209
v_lshl_add_u32 v18, v19, 4, v18
MV 96,a,136,a,172
ds_read2_b32 a[214:215], v42 offset0:210 offset1:211
MV 100,a,140,a,172
ds_read_b128 a[248:251], v5 offset:832
s_mul_i32 s37, s3, 4352
MV 100,a,136,a,176
ds_read2_b32 a[216:217], v43 offset0:80 offset1:81
buffer_load_dwordx4 v238, s[48:51], s69 offen offset:3072 sc1 lds
MV 104,a,140,a,176
MV 104,a,136,a,180
ds_read2_b32 a[218:219], v43 offset0:82 offset1:83
s_add_u32 s37, s37, 49152
MV 92,a,144,a,160
ds_read_b128 a[252:255], v5 offset:320
MV 96,a,148,a,160
ds_read2_b32 a[220:221], v43 offset0:208 offset1:209
v_add_u32 v12, s37, v18
MV 96,a,144,a,164
ds_read2_b32 a[222:223], v43 offset0:210 offset1:211
MV 100,a,148,a,164
s_add_u32 s69, s69, 16384
MV 100,a,144,a,168
s_lshl_b32 s37, s3, 12
MV 104,a,148,a,168
MV 104,a,144,a,172
v_add_u32 v13, s37, v232
MV 100,a,152,a,160
s_waitcnt lgkmcnt(15)
MV 104,a,156,a,160
MV 104,a,152,a,164
buffer_load_dword v253, v252, s[8:11], 0 offen sc1
MV 76,a,192,a,224
ds_read_b128 a[160:163], v5 offset:3968
MV 80,a,196,a,224
ds_read2_b32 a[128:129], v40 offset0:96 offset1:97
MV 80,a,192,a,228
ds_read2_b32 a[130:131], v40 offset0:98 offset1:99
MV 84,a,196,a,228
ds_read_b128 a[164:167], v5 offset:3456
MV 84,a,192,a,232
MV 88,a,196,a,232
ds_read2_b32 a[132:133], v40 offset0:224 offset1:225
s_waitcnt lgkmcnt(15)
MV 88,a,192,a,236
ds_read2_b32 a[134:135], v40 offset0:226 offset1:227
MV 92,a,196,a,236
ds_read_b128 a[168:171], v5 offset:2944
MV 92,a,192,a,240
ds_read2_b32 a[136:137], v41 offset0:96 offset1:97
MV 96,a,196,a,240
s_waitcnt lgkmcnt(15)
MV 96,a,192,a,244
ds_read2_b32 a[138:139], v41 offset0:98 offset1:99
MV 100,a,196,a,244
ds_read_b128 a[172:175], v5 offset:2432
s_waitcnt lgkmcnt(15)
MV 100,a,192,a,248
ds_read2_b32 a[140:141], v41 offset0:224 offset1:225
MV 104,a,196,a,248
ds_read2_b32 a[142:143], v41 offset0:226 offset1:227
s_waitcnt lgkmcnt(14)
MV 104,a,192,a,252
MV 84,a,200,a,224
ds_read_b128 a[176:179], v5 offset:1920
MV 88,a,204,a,224
ds_read2_b32 a[144:145], v42 offset0:96 offset1:97
MV 88,a,200,a,228
ds_read2_b32 a[146:147], v42 offset0:98 offset1:99
MV 92,a,204,a,228
ds_read_b128 a[180:183], v5 offset:1408
MV 92,a,200,a,232
MV 96,a,204,a,232
ds_read2_b32 a[148:149], v42 offset0:224 offset1:225
MV 96,a,200,a,236
ds_read2_b32 a[150:151], v42 offset0:226 offset1:227
MV 100,a,204,a,236
ds_read_b128 a[184:187], v5 offset:896
MV 100,a,200,a,240
ds_read2_b32 a[152:153], v43 offset0:96 offset1:97
MV 104,a,204,a,240
MV 104,a,200,a,244
ds_read2_b32 a[154:155], v43 offset0:98 offset1:99
MV 92,a,208,a,224
ds_read_b128 a[188:191], v5 offset:384
MV 96,a,212,a,224
ds_read2_b32 a[156:157], v43 offset0:224 offset1:225
MV 96,a,208,a,228
ds_read2_b32 a[158:159], v43 offset0:226 offset1:227
MV 100,a,212,a,228
MV 100,a,208,a,232
MV 104,a,212,a,232
MV 104,a,208,a,236
MV 100,a,216,a,224
s_waitcnt lgkmcnt(15)
MV 104,a,220,a,224
MV 104,a,216,a,228
s_waitcnt vmcnt(0)
v_cmp_gt_u32 vcc, 1, v253
s_nop 4
s_cbranch_vccnz L_spin_f2
L_spin_f2_ret:
buffer_load_dwordx4 a[0:3], v236, s[44:47], s68 offen offset:0 sc1
buffer_load_dwordx4 a[4:7], v237, s[44:47], s68 offen offset:0 sc1
buffer_load_dwordx4 a[8:11], v236, s[44:47], s68 offen offset:1024 sc1
buffer_load_dwordx4 a[12:15], v237, s[44:47], s68 offen offset:1024 sc1
s_add_u32 s68, s68, 2048
MV 76,a,128,a,160
ds_read_b128 a[224:227], v5 offset:4032
buffer_load_dwordx4 a[16:19], v236, s[44:47], s68 offen offset:0 sc1
MV 80,a,132,a,160
ds_read2_b32 a[192:193], v40 offset0:112 offset1:113
MV 80,a,128,a,164
ds_read2_b32 a[194:195], v40 offset0:114 offset1:115
buffer_load_dwordx4 a[20:23], v237, s[44:47], s68 offen offset:0 sc1
MV 84,a,132,a,164
ds_read_b128 a[228:231], v5 offset:3520
MV 84,a,128,a,168
buffer_load_dwordx4 a[24:27], v236, s[44:47], s68 offen offset:1024 sc1
MV 88,a,132,a,168
ds_read2_b32 a[196:197], v40 offset0:240 offset1:241
s_waitcnt lgkmcnt(15)
MV 88,a,128,a,172
ds_read2_b32 a[198:199], v40 offset0:242 offset1:243
MV 92,a,132,a,172
ds_read_b128 a[232:235], v5 offset:3008
buffer_load_dwordx4 a[28:31], v237, s[44:47], s68 offen offset:1024 sc1
MV 92,a,128,a,176
ds_read2_b32 a[200:201], v41 offset0:112 offset1:113
MV 96,a,132,a,176
s_add_u32 s68, s68, 2048
s_waitcnt lgkmcnt(15)
MV 96,a,128,a,180
ds_read2_b32 a[202:203], v41 offset0:114 offset1:115
MV 100,a,132,a,180
ds_read_b128 a[236:239], v5 offset:2496
buffer_load_dwordx4 a[32:35], v236, s[44:47], s68 offen offset:0 sc1
s_waitcnt lgkmcnt(15)
MV 100,a,128,a,184
ds_read2_b32 a[204:205], v41 offset0:240 offset1:241
MV 104,a,132,a,184
ds_read2_b32 a[206:207], v41 offset0:242 offset1:243
s_waitcnt lgkmcnt(14)
MV 104,a,128,a,188
buffer_load_dwordx4 a[36:39], v237, s[44:47], s68 offen offset:0 sc1
MV 84,a,136,a,160
ds_read_b128 a[240:243], v5 offset:1984
MV 88,a,140,a,160
ds_read2_b32 a[208:209], v42 offset0:112 offset1:113
buffer_load_dwordx4 a[40:43], v236, s[44:47], s68 offen offset:1024 sc1
MV 88,a,136,a,164
ds_read2_b32 a[210:211], v42 offset0:114 offset1:115
MV 92,a,140,a,164
ds_read_b128 a[244:247], v5 offset:1472
buffer_load_dwordx4 a[44:47], v237, s[44:47], s68 offen offset:1024 sc1
MV 92,a,136,a,168
MV 96,a,140,a,168
ds_read2_b32 a[212:213], v42 offset0:240 offset1:241
MV 96,a,136,a,172
ds_read2_b32 a[214:215], v42 offset0:242 offset1:243
s_add_u32 s68, s68, 2048
MV 100,a,140,a,172
ds_read_b128 a[248:251], v5 offset:960
MV 100,a,136,a,176
ds_read2_b32 a[216:217], v43 offset0:112 offset1:113
buffer_load_dwordx4 a[48:51], v236, s[44:47], s68 offen offset:0 sc1
MV 104,a,140,a,176
MV 104,a,136,a,180
ds_read2_b32 a[218:219], v43 offset0:114 offset1:115
buffer_load_dwordx4 a[52:55], v237, s[44:47], s68 offen offset:0 sc1
MV 92,a,144,a,160
ds_read_b128 a[252:255], v5 offset:448
MV 96,a,148,a,160
ds_read2_b32 a[220:221], v43 offset0:240 offset1:241
MV 96,a,144,a,164
ds_read2_b32 a[222:223], v43 offset0:242 offset1:243
buffer_load_dwordx4 a[56:59], v236, s[44:47], s68 offen offset:1024 sc1
MV 100,a,148,a,164
MV 100,a,144,a,168
buffer_load_dwordx4 a[60:63], v237, s[44:47], s68 offen offset:1024 sc1
MV 104,a,148,a,168
MV 104,a,144,a,172
s_add_u32 s68, s68, 2048
MV 100,a,152,a,160
s_waitcnt lgkmcnt(15)
MV 104,a,156,a,160
MV 104,a,152,a,164
s_waitcnt lgkmcnt(0)
s_barrier
ds_read_b128 a[64:67], v242 offset:0
ds_read_b128 a[68:71], v242 offset:1024
ds_read_b128 a[72:75], v242 offset:2048
ds_read_b128 a[76:79], v242 offset:3072
ds_read_b128 a[80:83], v243 offset:0
ds_read_b128 a[84:87], v243 offset:1024
ds_read_b128 a[88:91], v243 offset:2048
ds_read_b128 a[92:95], v243 offset:3072
s_waitcnt lgkmcnt(0)
s_waitcnt vmcnt(15)
v_mfma_f32_16x16x32_bf16 v[124:127], a[64:67], a[0:3], 0
ds_read_b128 a[96:99], v242 offset:8192
MV 76,a,192,a,224
s_add_u32 m0, s70, 115712
s_waitcnt vmcnt(14)
v_mfma_f32_16x16x32_bf16 v[128:131], a[64:67], a[4:7], 0
ds_read_b128 a[100:103], v242 offset:9216
MV 80,a,196,a,224
v_mfma_f32_16x16x32_bf16 v[132:135], a[68:71], a[0:3], 0
MV 80,a,192,a,228
ds_read_b128 a[104:107], v242 offset:10240
v_mfma_f32_16x16x32_bf16 v[136:139], a[68:71], a[4:7], 0
v_mfma_f32_16x16x32_bf16 v[140:143], a[72:75], a[0:3], 0
ds_read_b128 a[108:111], v242 offset:11264
MV 84,a,196,a,228
v_mfma_f32_16x16x32_bf16 v[144:147], a[72:75], a[4:7], 0
buffer_load_dwordx4 v238, s[48:51], s69 offen offset:0 sc1 lds
MV 84,a,192,a,232
ds_read_b128 a[112:115], v243 offset:8192
v_mfma_f32_16x16x32_bf16 v[148:151], a[76:79], a[0:3], 0
MV 88,a,196,a,232
v_mfma_f32_16x16x32_bf16 v[152:155], a[76:79], a[4:7], 0
ds_read_b128 a[116:119], v243 offset:9216
v_mfma_f32_16x16x32_bf16 v[156:159], a[80:83], a[0:3], 0
MV 88,a,192,a,236
ds_read_b128 a[120:123], v243 offset:10240
v_mfma_f32_16x16x32_bf16 v[160:163], a[80:83], a[4:7], 0
MV 92,a,196,a,236
buffer_load_dwordx4 v238, s[48:51], s69 offen offset:1024 sc1 lds
v_mfma_f32_16x16x32_bf16 v[164:167], a[84:87], a[0:3], 0
ds_read_b128 a[124:127], v243 offset:11264
MV 92,a,192,a,240
v_mfma_f32_16x16x32_bf16 v[168:171], a[84:87], a[4:7], 0
v_mfma_f32_16x16x32_bf16 v[172:175], a[88:91], a[0:3], 0
MV 96,a,196,a,240
v_mfma_f32_16x16x32_bf16 v[176:179], a[88:91], a[4:7], 0
MV 96,a,192,a,244
v_mfma_f32_16x16x32_bf16 v[180:183], a[92:95], a[0:3], 0
buffer_load_dwordx4 a[0:3], v236, s[44:47], s68 offen offset:0 sc1
MV 100,a,196,a,244
v_mfma_f32_16x16x32_bf16 v[184:187], a[92:95], a[4:7], 0
buffer_load_dwordx4 a[4:7], v237, s[44:47], s68 offen offset:0 sc1
s_waitcnt lgkmcnt(0)
s_barrier
s_waitcnt vmcnt(17)
MV 124,a,96,a,8
ds_read_b128 a[64:67], v242 offset:16384
MV 100,a,192,a,248
buffer_load_dwordx4 v238, s[48:51], s69 offen offset:2048 sc1 lds
s_waitcnt vmcnt(17)
MV 128,a,96,a,12
ds_read_b128 a[68:71], v242 offset:17408
MV 104,a,196,a,248
MV 132,a,100,a,8
MV 104,a,192,a,252
ds_read_b128 a[72:75], v242 offset:18432
MV 136,a,100,a,12
MV 140,a,104,a,8
ds_read_b128 a[76:79], v242 offset:19456
MV 84,a,200,a,224
MV 144,a,104,a,12
buffer_load_dwordx4 v238, s[48:51], s69 offen offset:3072 sc1 lds
MV 88,a,204,a,224
ds_read_b128 a[80:83], v243 offset:16384
MV 148,a,108,a,8
MV 88,a,200,a,228
MV 152,a,108,a,12
ds_read_b128 a[84:87], v243 offset:17408
MV 156,a,112,a,8
MV 92,a,204,a,228
ds_read_b128 a[88:91], v243 offset:18432
MV 160,a,112,a,12
MV 92,a,200,a,232
s_add_u32 s69, s69, 16384
MV 164,a,116,a,8
ds_read_b128 a[92:95], v243 offset:19456
MV 96,a,204,a,232
MV 168,a,116,a,12
MV 172,a,120,a,8
MV 96,a,200,a,236
MV 176,a,120,a,12
MV 100,a,204,a,236
MV 180,a,124,a,8
buffer_load_dwordx4 a[8:11], v236, s[44:47], s68 offen offset:1024 sc1
MV 100,a,200,a,240
MV 184,a,124,a,12
buffer_load_dwordx4 a[12:15], v237, s[44:47], s68 offen offset:1024 sc1
s_add_u32 s68, s68, 2048
s_waitcnt lgkmcnt(0)
s_waitcnt vmcnt(19)
MV 124,a,64,a,16
ds_read_b128 a[96:99], v242 offset:24576
MV 104,a,204,a,240
s_add_u32 m0, s70, 66560
s_waitcnt vmcnt(18)
MV 128,a,64,a,20
ds_read_b128 a[100:103], v242 offset:25600
MV 104,a,200,a,244
MV 132,a,68,a,16
MV 92,a,208,a,224
ds_read_b128 a[104:107], v242 offset:26624
MV 136,a,68,a,20
MV 140,a,72,a,16
ds_read_b128 a[108:111], v242 offset:27648
MV 96,a,212,a,224
MV 144,a,72,a,20
buffer_load_dwordx4 v238, s[48:51], s69 offen offset:0 sc1 lds
MV 96,a,208,a,228
ds_read_b128 a[112:115], v243 offset:24576
MV 148,a,76,a,16
MV 100,a,212,a,228
MV 152,a,76,a,20
ds_read_b128 a[116:119], v243 offset:25600
MV 156,a,80,a,16
MV 100,a,208,a,232
ds_read_b128 a[120:123], v243 offset:26624
MV 160,a,80,a,20
MV 104,a,212,a,232
buffer_load_dwordx4 v238, s[48:51], s69 offen offset:1024 sc1 lds
MV 164,a,84,a,16
ds_read_b128 a[124:127], v243 offset:27648
MV 104,a,208,a,236
MV 168,a,84,a,20
MV 172,a,88,a,16
MV 100,a,216,a,224
MV 176,a,88,a,20
MV 104,a,220,a,224
MV 180,a,92,a,16
buffer_load_dwordx4 a[16:19], v236, s[44:47], s68 offen offset:0 sc1
MV 104,a,216,a,228
MV 184,a,92,a,20
buffer_load_dwordx4 a[20:23], v237, s[44:47], s68 offen offset:0 sc1
s_waitcnt lgkmcnt(0)
s_barrier
s_waitcnt vmcnt(21)
MV 124,a,96,a,24
ds_read_b128 a[64:67], v242 offset:32768
s_waitcnt vmcnt(20)
MV 128,a,96,a,28
ds_read_b128 a[68:71], v242 offset:33792
buffer_load_dwordx4 v238, s[48:51], s69 offen offset:2048 sc1 lds
MV 132,a,100,a,24
MV 136,a,100,a,28
ds_read_b128 a[72:75], v242 offset:34816
MV 140,a,104,a,24
ds_read_b128 a[76:79], v242 offset:35840
MV 144,a,104,a,28
buffer_load_dwordx4 v238, s[48:51], s69 offen offset:3072 sc1 lds
MV 148,a,108,a,24
ds_read_b128 a[80:83], v243 offset:32768
MV 152,a,108,a,28
ds_read_b128 a[84:87], v243 offset:33792
MV 156,a,112,a,24
MV 160,a,112,a,28
ds_read_b128 a[88:91], v243 offset:34816
s_add_u32 s69, s69, 16384
MV 164,a,116,a,24
ds_read_b128 a[92:95], v243 offset:35840
MV 168,a,116,a,28
MV 172,a,120,a,24
MV 176,a,120,a,28
MV 180,a,124,a,24
buffer_load_dwordx4 a[24:27], v236, s[44:47], s68 offen offset:1024 sc1
MV 184,a,124,a,28
buffer_load_dwordx4 a[28:31], v237, s[44:47], s68 offen offset:1024 sc1
s_add_u32 s68, s68, 2048
s_waitcnt lgkmcnt(0)
s_waitcnt vmcnt(23)
MV 124,a,64,a,32
ds_read_b128 a[96:99], v242 offset:40960
v_cvt_pk_bf16_f32 v16, v76, v77
s_waitcnt vmcnt(22)
MV 128,a,64,a,36
ds_read_b128 a[100:103], v242 offset:41984
s_add_u32 m0, s70, 82944
MV 132,a,68,a,32
v_cvt_pk_bf16_f32 v17, v78, v79
MV 136,a,68,a,36
ds_read_b128 a[104:107], v242 offset:43008
ds_write_b16 v11, v16 offset:0
MV 140,a,72,a,32
ds_read_b128 a[108:111], v242 offset:44032
MV 144,a,72,a,36
buffer_load_dwordx4 v238, s[48:51], s69 offen offset:0 sc1 lds
ds_write_b16_d16_hi v11, v16 offset:8
MV 148,a,76,a,32
ds_read_b128 a[112:115], v243 offset:40960
MV 152,a,76,a,36
ds_read_b128 a[116:119], v243 offset:41984
ds_write_b16 v11, v17 offset:16
MV 156,a,80,a,32
ds_write_b16_d16_hi v11, v17 offset:24
MV 160,a,80,a,36
ds_read_b128 a[120:123], v243 offset:43008
buffer_load_dwordx4 v238, s[48:51], s69 offen offset:1024 sc1 lds
MV 164,a,84,a,32
ds_read_b128 a[124:127], v243 offset:44032
v_cvt_pk_bf16_f32 v18, v80, v81
MV 168,a,84,a,36
MV 172,a,88,a,32
v_cvt_pk_bf16_f32 v19, v82, v83
MV 176,a,88,a,36
MV 180,a,92,a,32
buffer_load_dwordx4 a[32:35], v236, s[44:47], s68 offen offset:0 sc1
ds_write_b16 v11, v18 offset:2176
MV 184,a,92,a,36
buffer_load_dwordx4 a[36:39], v237, s[44:47], s68 offen offset:0 sc1
s_waitcnt vmcnt(14) lgkmcnt(0)
s_barrier
MV 124,a,96,a,40
ds_read_b128 a[64:67], v242 offset:49152
ds_write_b16_d16_hi v11, v18 offset:2184
MV 128,a,96,a,44
ds_read_b128 a[68:71], v242 offset:50176
buffer_load_dwordx4 v238, s[48:51], s69 offen offset:2048 sc1 lds
MV 132,a,100,a,40
ds_write_b16 v11, v19 offset:2192
MV 136,a,100,a,44
ds_read_b128 a[72:75], v242 offset:51200
ds_write_b16_d16_hi v11, v19 offset:2200
MV 140,a,104,a,40
ds_read_b128 a[76:79], v242 offset:52224
v_cvt_pk_bf16_f32 v16, v84, v85
MV 144,a,104,a,44
buffer_load_dwordx4 v238, s[48:51], s69 offen offset:3072 sc1 lds
MV 148,a,108,a,40
ds_read_b128 a[80:83], v243 offset:49152
v_cvt_pk_bf16_f32 v17, v86, v87
MV 152,a,108,a,44
ds_read_b128 a[84:87], v243 offset:50176
MV 156,a,112,a,40
ds_write_b16 v11, v16 offset:4352
MV 160,a,112,a,44
ds_read_b128 a[88:91], v243 offset:51200
s_add_u32 s69, s69, 16384
MV 164,a,116,a,40
ds_read_b128 a[92:95], v243 offset:52224
ds_write_b16_d16_hi v11, v16 offset:4360
MV 168,a,116,a,44
ds_write_b16 v11, v17 offset:4368
MV 172,a,120,a,40
ds_write_b16_d16_hi v11, v17 offset:4376
MV 176,a,120,a,44
MV 180,a,124,a,40
buffer_load_dwordx4 a[40:43], v236, s[44:47], s68 offen offset:1024 sc1
v_cvt_pk_bf16_f32 v18, v88, v89
MV 184,a,124,a,44
buffer_load_dwordx4 a[44:47], v237, s[44:47], s68 offen offset:1024 sc1
s_add_u32 s68, s68, 2048
s_waitcnt lgkmcnt(0)
MV 124,a,64,a,48
ds_read_b128 a[96:99], v242 offset:57344
v_cvt_pk_bf16_f32 v19, v90, v91
MV 128,a,64,a,52
ds_read_b128 a[100:103], v242 offset:58368
s_add_u32 m0, s70, 99328
MV 132,a,68,a,48
ds_write_b16 v11, v18 offset:6528
MV 136,a,68,a,52
ds_read_b128 a[104:107], v242 offset:59392
ds_write_b16_d16_hi v11, v18 offset:6536
MV 140,a,72,a,48
ds_read_b128 a[108:111], v242 offset:60416
MV 144,a,72,a,52
buffer_load_dwordx4 v238, s[48:51], s69 offen offset:0 sc1 lds
ds_write_b16 v11, v19 offset:6544
MV 148,a,76,a,48
ds_read_b128 a[112:115], v243 offset:57344
MV 152,a,76,a,52
ds_read_b128 a[116:119], v243 offset:58368
ds_write_b16_d16_hi v11, v19 offset:6552
MV 156,a,80,a,48
v_cvt_pk_bf16_f32 v16, v92, v93
MV 160,a,80,a,52
ds_read_b128 a[120:123], v243 offset:59392
buffer_load_dwordx4 v238, s[48:51], s69 offen offset:1024 sc1 lds
MV 164,a,84,a,48
ds_read_b128 a[124:127], v243 offset:60416
v_cvt_pk_bf16_f32 v17, v94, v95
MV 168,a,84,a,52
MV 172,a,88,a,48
ds_write_b16 v11, v16 offset:8704
MV 176,a,88,a,52
MV 180,a,92,a,48
buffer_load_dwordx4 a[48:51], v236, s[44:47], s68 offen offset:0 sc1
ds_write_b16_d16_hi v11, v16 offset:8712
MV 184,a,92,a,52
buffer_load_dwordx4 a[52:55], v237, s[44:47], s68 offen offset:0 sc1
s_waitcnt vmcnt(14) lgkmcnt(0)
s_barrier
MV 124,a,96,a,56
ds_read_b128 a[64:67], v242 offset:0
ds_write_b16 v11, v17 offset:8720
MV 128,a,96,a,60
ds_read_b128 a[68:71], v242 offset:1024
buffer_load_dwordx4 v238, s[48:51], s69 offen offset:2048 sc1 lds
MV 132,a,100,a,56
ds_write_b16_d16_hi v11, v17 offset:8728
MV 136,a,100,a,60
ds_read_b128 a[72:75], v242 offset:2048
v_cvt_pk_bf16_f32 v18, v96, v97
MV 140,a,104,a,56
ds_read_b128 a[76:79], v242 offset:3072
v_cvt_pk_bf16_f32 v19, v98, v99
MV 144,a,104,a,60
buffer_load_dwordx4 v238, s[48:51], s69 offen offset:3072 sc1 lds
MV 148,a,108,a,56
ds_read_b128 a[80:83], v243 offset:0
ds_write_b16 v11, v18 offset:10880
MV 152,a,108,a,60
ds_read_b128 a[84:87], v243 offset:1024
MV 156,a,112,a,56
ds_write_b16_d16_hi v11, v18 offset:10888
MV 160,a,112,a,60
ds_read_b128 a[88:91], v243 offset:2048
s_add_u32 s69, s69, 16384
MV 164,a,116,a,56
ds_read_b128 a[92:95], v243 offset:3072
ds_write_b16 v11, v19 offset:10896
MV 168,a,116,a,60
ds_write_b16_d16_hi v11, v19 offset:10904
MV 172,a,120,a,56
v_cvt_pk_bf16_f32 v16, v100, v101
MV 176,a,120,a,60
MV 180,a,124,a,56
buffer_load_dwordx4 a[56:59], v236, s[44:47], s68 offen offset:1024 sc1
v_cvt_pk_bf16_f32 v17, v102, v103
MV 184,a,124,a,60
buffer_load_dwordx4 a[60:63], v237, s[44:47], s68 offen offset:1024 sc1
s_add_u32 s68, s68, 2048
s_waitcnt lgkmcnt(0)
MV 124,a,64,a,0
ds_read_b128 a[96:99], v242 offset:8192
ds_write_b16 v11, v16 offset:13056
MV 128,a,64,a,4
ds_read_b128 a[100:103], v242 offset:9216
s_add_u32 m0, s70, 115712
MV 132,a,68,a,0
ds_write_b16_d16_hi v11, v16 offset:13064
MV 136,a,68,a,4
ds_read_b128 a[104:107], v242 offset:10240
ds_write_b16 v11, v17 offset:13072
MV 140,a,72,a,0
ds_read_b128 a[108:111], v242 offset:11264
ds_write_b16_d16_hi v11, v17 offset:13080
MV 144,a,72,a,4
buffer_load_dwordx4 v238, s[48:51], s69 offen offset:0 sc1 lds
MV 148,a,76,a,0
ds_read_b128 a[112:115], v243 offset:8192
v_cvt_pk_bf16_f32 v18, v104, v105
MV 152,a,76,a,4
ds_read_b128 a[116:119], v243 offset:9216
MV 156,a,80,a,0
v_cvt_pk_bf16_f32 v19, v106, v107
MV 160,a,80,a,4
ds_read_b128 a[120:123], v243 offset:10240
buffer_load_dwordx4 v238, s[48:51], s69 offen offset:1024 sc1 lds
MV 164,a,84,a,0
ds_read_b128 a[124:127], v243 offset:11264
ds_write_b16 v11, v18 offset:15232
MV 168,a,84,a,4
ds_write_b16_d16_hi v11, v18 offset:15240
MV 172,a,88,a,0
ds_write_b16 v11, v19 offset:15248
MV 176,a,88,a,4
MV 180,a,92,a,0
buffer_load_dwordx4 a[0:3], v236, s[44:47], s68 offen offset:0 sc1
ds_write_b16_d16_hi v11, v19 offset:15256
MV 184,a,92,a,4
buffer_load_dwordx4 a[4:7], v237, s[44:47], s68 offen offset:0 sc1
s_waitcnt vmcnt(14) lgkmcnt(0)
s_barrier
MV 124,a,96,a,8
ds_read_b128 a[64:67], v242 offset:16384
ds_read_b64 v[108:109], v12 offset:0
MV 128,a,96,a,12
ds_read_b128 a[68:71], v242 offset:17408
buffer_load_dwordx4 v238, s[48:51], s69 offen offset:2048 sc1 lds
MV 132,a,100,a,8
ds_read_b64 v[110:111], v12 offset:8
MV 136,a,100,a,12
ds_read_b128 a[72:75], v242 offset:18432
MV 140,a,104,a,8
ds_read_b128 a[76:79], v242 offset:19456
ds_read_b64 v[112:113], v12 offset:1088
MV 144,a,104,a,12
buffer_load_dwordx4 v238, s[48:51], s69 offen offset:3072 sc1 lds
MV 148,a,108,a,8
ds_read_b128 a[80:83], v243 offset:16384
ds_read_b64 v[114:115], v12 offset:1096
MV 152,a,108,a,12
ds_read_b128 a[84:87], v243 offset:17408
MV 156,a,112,a,8
ds_read_b64 v[116:117], v12 offset:2176
MV 160,a,112,a,12
ds_read_b128 a[88:91], v243 offset:18432
s_add_u32 s69, s69, 16384
MV 164,a,116,a,8
ds_read_b128 a[92:95], v243 offset:19456
ds_read_b64 v[118:119], v12 offset:2184
MV 168,a,116,a,12
MV 172,a,120,a,8
ds_read_b64 v[120:121], v12 offset:3264
MV 176,a,120,a,12
MV 180,a,124,a,8
buffer_load_dwordx4 a[8:11], v236, s[44:47], s68 offen offset:1024 sc1
ds_read_b64 v[122:123], v12 offset:3272
MV 184,a,124,a,12
buffer_load_dwordx4 a[12:15], v237, s[44:47], s68 offen offset:1024 sc1
s_add_u32 s68, s68, 2048
s_waitcnt lgkmcnt(0)
MV 124,a,64,a,16
ds_read_b128 a[96:99], v242 offset:24576
buffer_store_dwordx4 v[108:111], v13, s[24:27], 0 offen offset:0 sc1
MV 128,a,64,a,20
ds_read_b128 a[100:103], v242 offset:25600
s_add_u32 m0, s70, 66560
MV 132,a,68,a,16
MV 136,a,68,a,20
ds_read_b128 a[104:107], v242 offset:26624
MV 140,a,72,a,16
ds_read_b128 a[108:111], v242 offset:27648
MV 144,a,72,a,20
buffer_load_dwordx4 v238, s[48:51], s69 offen offset:0 sc1 lds
MV 148,a,76,a,16
ds_read_b128 a[112:115], v243 offset:24576
MV 152,a,76,a,20
ds_read_b128 a[116:119], v243 offset:25600
MV 156,a,80,a,16
buffer_store_dwordx4 v[112:115], v13, s[24:27], 0 offen offset:1024 sc1
MV 160,a,80,a,20
ds_read_b128 a[120:123], v243 offset:26624
buffer_load_dwordx4 v238, s[48:51], s69 offen offset:1024 sc1 lds
MV 164,a,84,a,16
ds_read_b128 a[124:127], v243 offset:27648
MV 168,a,84,a,20
MV 172,a,88,a,16
MV 176,a,88,a,20
MV 180,a,92,a,16
buffer_load_dwordx4 a[16:19], v236, s[44:47], s68 offen offset:0 sc1
MV 184,a,92,a,20
buffer_load_dwordx4 a[20:23], v237, s[44:47], s68 offen offset:0 sc1
s_waitcnt vmcnt(16) lgkmcnt(0)
s_barrier
MV 124,a,96,a,24
ds_read_b128 a[64:67], v242 offset:32768
buffer_store_dwordx4 v[116:119], v13, s[24:27], 0 offen offset:2048 sc1
MV 128,a,96,a,28
ds_read_b128 a[68:71], v242 offset:33792
buffer_load_dwordx4 v238, s[48:51], s69 offen offset:2048 sc1 lds
MV 132,a,100,a,24
MV 136,a,100,a,28
ds_read_b128 a[72:75], v242 offset:34816
MV 140,a,104,a,24
ds_read_b128 a[76:79], v242 offset:35840
MV 144,a,104,a,28
buffer_load_dwordx4 v238, s[48:51], s69 offen offset:3072 sc1 lds
MV 148,a,108,a,24
ds_read_b128 a[80:83], v243 offset:32768
MV 152,a,108,a,28
ds_read_b128 a[84:87], v243 offset:33792
MV 156,a,112,a,24
buffer_store_dwordx4 v[120:123], v13, s[24:27], 0 offen offset:3072 sc1
MV 160,a,112,a,28
ds_read_b128 a[88:91], v243 offset:34816
s_add_u32 s69, s69, 16384
MV 164,a,116,a,24
ds_read_b128 a[92:95], v243 offset:35840
MV 168,a,116,a,28
MV 172,a,120,a,24
MV 176,a,120,a,28
MV 180,a,124,a,24
buffer_load_dwordx4 a[24:27], v236, s[44:47], s68 offen offset:1024 sc1
MV 184,a,124,a,28
buffer_load_dwordx4 a[28:31], v237, s[44:47], s68 offen offset:1024 sc1
s_add_u32 s68, s68, 2048
s_mov_b32 s71, 3
.p2align 5
L_p5_loop:
s_waitcnt lgkmcnt(0)
MV 124,a,64,a,32
ds_read_b128 a[96:99], v242 offset:40960
MV 128,a,64,a,36
ds_read_b128 a[100:103], v242 offset:41984
s_add_u32 m0, s70, 82944
MV 132,a,68,a,32
MV 136,a,68,a,36
ds_read_b128 a[104:107], v242 offset:43008
MV 140,a,72,a,32
ds_read_b128 a[108:111], v242 offset:44032
MV 144,a,72,a,36
buffer_load_dwordx4 v238, s[48:51], s69 offen offset:0 sc1 lds
MV 148,a,76,a,32
ds_read_b128 a[112:115], v243 offset:40960
MV 152,a,76,a,36
ds_read_b128 a[116:119], v243 offset:41984
MV 156,a,80,a,32
MV 160,a,80,a,36
ds_read_b128 a[120:123], v243 offset:43008
buffer_load_dwordx4 v238, s[48:51], s69 offen offset:1024 sc1 lds
MV 164,a,84,a,32
ds_read_b128 a[124:127], v243 offset:44032
MV 168,a,84,a,36
MV 172,a,88,a,32
MV 176,a,88,a,36
MV 180,a,92,a,32
buffer_load_dwordx4 a[32:35], v236, s[44:47], s68 offen offset:0 sc1
MV 184,a,92,a,36
buffer_load_dwordx4 a[36:39], v237, s[44:47], s68 offen offset:0 sc1
s_waitcnt vmcnt(14) lgkmcnt(0)
s_barrier
MV 124,a,96,a,40
ds_read_b128 a[64:67], v242 offset:49152
MV 128,a,96,a,44
ds_read_b128 a[68:71], v242 offset:50176
buffer_load_dwordx4 v238, s[48:51], s69 offen offset:2048 sc1 lds
MV 132,a,100,a,40
MV 136,a,100,a,44
ds_read_b128 a[72:75], v242 offset:51200
MV 140,a,104,a,40
ds_read_b128 a[76:79], v242 offset:52224
MV 144,a,104,a,44
buffer_load_dwordx4 v238, s[48:51], s69 offen offset:3072 sc1 lds
MV 148,a,108,a,40
ds_read_b128 a[80:83], v243 offset:49152
MV 152,a,108,a,44
ds_read_b128 a[84:87], v243 offset:50176
MV 156,a,112,a,40
MV 160,a,112,a,44
ds_read_b128 a[88:91], v243 offset:51200
s_add_u32 s69, s69, 16384
MV 164,a,116,a,40
ds_read_b128 a[92:95], v243 offset:52224
MV 168,a,116,a,44
MV 172,a,120,a,40
MV 176,a,120,a,44
MV 180,a,124,a,40
buffer_load_dwordx4 a[40:43], v236, s[44:47], s68 offen offset:1024 sc1
MV 184,a,124,a,44
buffer_load_dwordx4 a[44:47], v237, s[44:47], s68 offen offset:1024 sc1
s_add_u32 s68, s68, 2048
s_waitcnt lgkmcnt(0)
MV 124,a,64,a,48
ds_read_b128 a[96:99], v242 offset:57344
MV 128,a,64,a,52
ds_read_b128 a[100:103], v242 offset:58368
s_add_u32 m0, s70, 99328
MV 132,a,68,a,48
MV 136,a,68,a,52
ds_read_b128 a[104:107], v242 offset:59392
MV 140,a,72,a,48
ds_read_b128 a[108:111], v242 offset:60416
MV 144,a,72,a,52
buffer_load_dwordx4 v238, s[48:51], s69 offen offset:0 sc1 lds
MV 148,a,76,a,48
ds_read_b128 a[112:115], v243 offset:57344
MV 152,a,76,a,52
ds_read_b128 a[116:119], v243 offset:58368
MV 156,a,80,a,48
MV 160,a,80,a,52
ds_read_b128 a[120:123], v243 offset:59392
buffer_load_dwordx4 v238, s[48:51], s69 offen offset:1024 sc1 lds
MV 164,a,84,a,48
ds_read_b128 a[124:127], v243 offset:60416
MV 168,a,84,a,52
MV 172,a,88,a,48
MV 176,a,88,a,52
MV 180,a,92,a,48
buffer_load_dwordx4 a[48:51], v236, s[44:47], s68 offen offset:0 sc1
MV 184,a,92,a,52
buffer_load_dwordx4 a[52:55], v237, s[44:47], s68 offen offset:0 sc1
s_waitcnt vmcnt(14) lgkmcnt(0)
s_barrier
MV 124,a,96,a,56
ds_read_b128 a[64:67], v242 offset:0
MV 128,a,96,a,60
ds_read_b128 a[68:71], v242 offset:1024
buffer_load_dwordx4 v238, s[48:51], s69 offen offset:2048 sc1 lds
MV 132,a,100,a,56
MV 136,a,100,a,60
ds_read_b128 a[72:75], v242 offset:2048
MV 140,a,104,a,56
ds_read_b128 a[76:79], v242 offset:3072
MV 144,a,104,a,60
buffer_load_dwordx4 v238, s[48:51], s69 offen offset:3072 sc1 lds
MV 148,a,108,a,56
ds_read_b128 a[80:83], v243 offset:0
MV 152,a,108,a,60
ds_read_b128 a[84:87], v243 offset:1024
MV 156,a,112,a,56
MV 160,a,112,a,60
ds_read_b128 a[88:91], v243 offset:2048
s_add_u32 s69, s69, 16384
MV 164,a,116,a,56
ds_read_b128 a[92:95], v243 offset:3072
MV 168,a,116,a,60
MV 172,a,120,a,56
MV 176,a,120,a,60
MV 180,a,124,a,56
buffer_load_dwordx4 a[56:59], v236, s[44:47], s68 offen offset:1024 sc1
MV 184,a,124,a,60
buffer_load_dwordx4 a[60:63], v237, s[44:47], s68 offen offset:1024 sc1
s_add_u32 s68, s68, 2048
s_waitcnt lgkmcnt(0)
MV 124,a,64,a,0
ds_read_b128 a[96:99], v242 offset:8192
MV 128,a,64,a,4
ds_read_b128 a[100:103], v242 offset:9216
s_add_u32 m0, s70, 115712
MV 132,a,68,a,0
MV 136,a,68,a,4
ds_read_b128 a[104:107], v242 offset:10240
MV 140,a,72,a,0
ds_read_b128 a[108:111], v242 offset:11264
MV 144,a,72,a,4
buffer_load_dwordx4 v238, s[48:51], s69 offen offset:0 sc1 lds
MV 148,a,76,a,0
ds_read_b128 a[112:115], v243 offset:8192
MV 152,a,76,a,4
ds_read_b128 a[116:119], v243 offset:9216
MV 156,a,80,a,0
MV 160,a,80,a,4
ds_read_b128 a[120:123], v243 offset:10240
buffer_load_dwordx4 v238, s[48:51], s69 offen offset:1024 sc1 lds
MV 164,a,84,a,0
ds_read_b128 a[124:127], v243 offset:11264
MV 168,a,84,a,4
MV 172,a,88,a,0
MV 176,a,88,a,4
MV 180,a,92,a,0
buffer_load_dwordx4 a[0:3], v236, s[44:47], s68 offen offset:0 sc1
MV 184,a,92,a,4
buffer_load_dwordx4 a[4:7], v237, s[44:47], s68 offen offset:0 sc1
s_waitcnt vmcnt(14) lgkmcnt(0)
s_barrier
MV 124,a,96,a,8
ds_read_b128 a[64:67], v242 offset:16384
MV 128,a,96,a,12
ds_read_b128 a[68:71], v242 offset:17408
buffer_load_dwordx4 v238, s[48:51], s69 offen offset:2048 sc1 lds
MV 132,a,100,a,8
MV 136,a,100,a,12
ds_read_b128 a[72:75], v242 offset:18432
MV 140,a,104,a,8
ds_read_b128 a[76:79], v242 offset:19456
MV 144,a,104,a,12
buffer_load_dwordx4 v238, s[48:51], s69 offen offset:3072 sc1 lds
MV 148,a,108,a,8
ds_read_b128 a[80:83], v243 offset:16384
MV 152,a,108,a,12
ds_read_b128 a[84:87], v243 offset:17408
MV 156,a,112,a,8
MV 160,a,112,a,12
ds_read_b128 a[88:91], v243 offset:18432
s_add_u32 s69, s69, 16384
MV 164,a,116,a,8
ds_read_b128 a[92:95], v243 offset:19456
MV 168,a,116,a,12
MV 172,a,120,a,8
MV 176,a,120,a,12
MV 180,a,124,a,8
buffer_load_dwordx4 a[8:11], v236, s[44:47], s68 offen offset:1024 sc1
MV 184,a,124,a,12
buffer_load_dwordx4 a[12:15], v237, s[44:47], s68 offen offset:1024 sc1
s_add_u32 s68, s68, 2048
s_waitcnt lgkmcnt(0)
MV 124,a,64,a,16
ds_read_b128 a[96:99], v242 offset:24576
MV 128,a,64,a,20
ds_read_b128 a[100:103], v242 offset:25600
s_add_u32 m0, s70, 66560
MV 132,a,68,a,16
MV 136,a,68,a,20
ds_read_b128 a[104:107], v242 offset:26624
MV 140,a,72,a,16
ds_read_b128 a[108:111], v242 offset:27648
MV 144,a,72,a,20
buffer_load_dwordx4 v238, s[48:51], s69 offen offset:0 sc1 lds
MV 148,a,76,a,16
ds_read_b128 a[112:115], v243 offset:24576
MV 152,a,76,a,20
ds_read_b128 a[116:119], v243 offset:25600
MV 156,a,80,a,16
MV 160,a,80,a,20
ds_read_b128 a[120:123], v243 offset:26624
buffer_load_dwordx4 v238, s[48:51], s69 offen offset:1024 sc1 lds
MV 164,a,84,a,16
ds_read_b128 a[124:127], v243 offset:27648
MV 168,a,84,a,20
MV 172,a,88,a,16
MV 176,a,88,a,20
MV 180,a,92,a,16
buffer_load_dwordx4 a[16:19], v236, s[44:47], s68 offen offset:0 sc1
MV 184,a,92,a,20
buffer_load_dwordx4 a[20:23], v237, s[44:47], s68 offen offset:0 sc1
s_waitcnt vmcnt(14) lgkmcnt(0)
s_barrier
MV 124,a,96,a,24
ds_read_b128 a[64:67], v242 offset:32768
MV 128,a,96,a,28
ds_read_b128 a[68:71], v242 offset:33792
buffer_load_dwordx4 v238, s[48:51], s69 offen offset:2048 sc1 lds
MV 132,a,100,a,24
MV 136,a,100,a,28
ds_read_b128 a[72:75], v242 offset:34816
MV 140,a,104,a,24
ds_read_b128 a[76:79], v242 offset:35840
MV 144,a,104,a,28
buffer_load_dwordx4 v238, s[48:51], s69 offen offset:3072 sc1 lds
MV 148,a,108,a,24
ds_read_b128 a[80:83], v243 offset:32768
MV 152,a,108,a,28
ds_read_b128 a[84:87], v243 offset:33792
MV 156,a,112,a,24
MV 160,a,112,a,28
ds_read_b128 a[88:91], v243 offset:34816
s_add_u32 s69, s69, 16384
MV 164,a,116,a,24
ds_read_b128 a[92:95], v243 offset:35840
MV 168,a,116,a,28
MV 172,a,120,a,24
MV 176,a,120,a,28
MV 180,a,124,a,24
buffer_load_dwordx4 a[24:27], v236, s[44:47], s68 offen offset:1024 sc1
MV 184,a,124,a,28
buffer_load_dwordx4 a[28:31], v237, s[44:47], s68 offen offset:1024 sc1
s_add_u32 s68, s68, 2048
s_sub_u32 s71, s71, 1
s_cbranch_scc1 L_p5_out
s_cmp_eq_u32 s71, 2
s_cbranch_scc1 L_p5_x1
s_cmp_eq_u32 s71, 0
s_cbranch_scc1 L_p5_x2
s_branch L_p5_loop
L_p5_out:
s_waitcnt lgkmcnt(0)
MV 124,a,64,a,32
ds_read_b128 a[96:99], v242 offset:40960
MV 128,a,64,a,36
ds_read_b128 a[100:103], v242 offset:41984
s_add_u32 m0, s70, 82944
MV 132,a,68,a,32
v_cmp_gt_u32 vcc, 1, v253
s_nop 4
s_cbranch_vccnz L_spin_f3
L_spin_f3_ret:
MV 136,a,68,a,36
ds_read_b128 a[104:107], v242 offset:43008
MV 140,a,72,a,32
ds_read_b128 a[108:111], v242 offset:44032
MV 144,a,72,a,36
buffer_load_dwordx4 v238, s[48:51], s69 offen offset:0 sc1 lds
MV 148,a,76,a,32
ds_read_b128 a[112:115], v243 offset:40960
MV 152,a,76,a,36
ds_read_b128 a[116:119], v243 offset:41984
MV 156,a,80,a,32
MV 160,a,80,a,36
ds_read_b128 a[120:123], v243 offset:43008
buffer_load_dwordx4 v238, s[48:51], s69 offen offset:1024 sc1 lds
MV 164,a,84,a,32
ds_read_b128 a[124:127], v243 offset:44032
MV 168,a,84,a,36
MV 172,a,88,a,32
s_add_u32 s72, s79, 0
MV 176,a,88,a,36
MV 180,a,92,a,32
buffer_load_dwordx4 a[32:35], v236, s[44:47], s68 offen offset:0 sc1
buffer_load_dwordx2 v[208:209], v251, s[56:59], s72 offen offset:0 sc1
MV 184,a,92,a,36
buffer_load_dwordx4 a[36:39], v237, s[44:47], s68 offen offset:0 sc1
s_waitcnt vmcnt(15) lgkmcnt(0)
s_barrier
MV 124,a,96,a,40
ds_read_b128 a[64:67], v242 offset:49152
s_add_u32 s72, s79, 16384
MV 128,a,96,a,44
ds_read_b128 a[68:71], v242 offset:50176
buffer_load_dwordx4 v238, s[48:51], s69 offen offset:2048 sc1 lds
MV 132,a,100,a,40
MV 136,a,100,a,44
ds_read_b128 a[72:75], v242 offset:51200
MV 140,a,104,a,40
ds_read_b128 a[76:79], v242 offset:52224
MV 144,a,104,a,44
buffer_load_dwordx4 v238, s[48:51], s69 offen offset:3072 sc1 lds
MV 148,a,108,a,40
ds_read_b128 a[80:83], v243 offset:49152
MV 152,a,108,a,44
ds_read_b128 a[84:87], v243 offset:50176
MV 156,a,112,a,40
buffer_load_dwordx2 v[210:211], v251, s[56:59], s72 offen offset:0 sc1
MV 160,a,112,a,44
ds_read_b128 a[88:91], v243 offset:51200
s_add_u32 s69, s69, 16384
MV 164,a,116,a,40
ds_read_b128 a[92:95], v243 offset:52224
MV 168,a,116,a,44
MV 172,a,120,a,40
MV 176,a,120,a,44
MV 180,a,124,a,40
buffer_load_dwordx4 a[40:43], v236, s[44:47], s68 offen offset:1024 sc1
MV 184,a,124,a,44
buffer_load_dwordx4 a[44:47], v237, s[44:47], s68 offen offset:1024 sc1
s_add_u32 s68, s68, 2048
s_waitcnt lgkmcnt(0)
MV 124,a,64,a,48
ds_read_b128 a[96:99], v242 offset:57344
s_add_u32 s72, s79, 131072
MV 128,a,64,a,52
ds_read_b128 a[100:103], v242 offset:58368
s_add_u32 m0, s70, 99328
MV 132,a,68,a,48
MV 136,a,68,a,52
ds_read_b128 a[104:107], v242 offset:59392
MV 140,a,72,a,48
ds_read_b128 a[108:111], v242 offset:60416
buffer_load_dwordx2 v[212:213], v251, s[56:59], s72 offen offset:0 sc1
MV 144,a,72,a,52
buffer_load_dwordx4 v238, s[48:51], s69 offen offset:0 sc1 lds
MV 148,a,76,a,48
ds_read_b128 a[112:115], v243 offset:57344
MV 152,a,76,a,52
ds_read_b128 a[116:119], v243 offset:58368
MV 156,a,80,a,48
s_add_u32 s72, s79, 147456
MV 160,a,80,a,52
ds_read_b128 a[120:123], v243 offset:59392
buffer_load_dwordx4 v238, s[48:51], s69 offen offset:1024 sc1 lds
MV 164,a,84,a,48
ds_read_b128 a[124:127], v243 offset:60416
MV 168,a,84,a,52
MV 172,a,88,a,48
buffer_load_dwordx2 v[214:215], v251, s[56:59], s72 offen offset:0 sc1
MV 176,a,88,a,52
MV 180,a,92,a,48
buffer_load_dwordx4 a[48:51], v236, s[44:47], s68 offen offset:0 sc1
MV 184,a,92,a,52
buffer_load_dwordx4 a[52:55], v237, s[44:47], s68 offen offset:0 sc1
s_waitcnt vmcnt(18) lgkmcnt(0)
s_barrier
MV 124,a,96,a,56
ds_read_b128 a[64:67], v242 offset:0
s_add_u32 s72, s79, 0
MV 128,a,96,a,60
ds_read_b128 a[68:71], v242 offset:1024
buffer_load_dwordx4 v238, s[48:51], s69 offen offset:2048 sc1 lds
MV 132,a,100,a,56
MV 136,a,100,a,60
ds_read_b128 a[72:75], v242 offset:2048
MV 140,a,104,a,56
ds_read_b128 a[76:79], v242 offset:3072
MV 144,a,104,a,60
buffer_load_dwordx4 v238, s[48:51], s69 offen offset:3072 sc1 lds
MV 148,a,108,a,56
ds_read_b128 a[80:83], v243 offset:0
MV 152,a,108,a,60
ds_read_b128 a[84:87], v243 offset:1024
MV 156,a,112,a,56
buffer_load_dwordx2 v[216:217], v251, s[56:59], s72 offen offset:128 sc1
MV 160,a,112,a,60
ds_read_b128 a[88:91], v243 offset:2048
s_add_u32 s69, s69, 16384
MV 164,a,116,a,56
ds_read_b128 a[92:95], v243 offset:3072
MV 168,a,116,a,60
MV 172,a,120,a,56
MV 176,a,120,a,60
MV 180,a,124,a,56
buffer_load_dwordx4 a[56:59], v236, s[44:47], s68 offen offset:1024 sc1
MV 184,a,124,a,60
buffer_load_dwordx4 a[60:63], v237, s[44:47], s68 offen offset:1024 sc1
s_add_u32 s68, s68, 2048
s_waitcnt lgkmcnt(0)
MV 124,a,64,a,0
ds_read_b128 a[96:99], v242 offset:8192
s_add_u32 s72, s79, 16384
MV 128,a,64,a,4
ds_read_b128 a[100:103], v242 offset:9216
s_add_u32 m0, s70, 115712
MV 132,a,68,a,0
MV 136,a,68,a,4
ds_read_b128 a[104:107], v242 offset:10240
MV 140,a,72,a,0
ds_read_b128 a[108:111], v242 offset:11264
MV 144,a,72,a,4
buffer_load_dwordx4 v238, s[48:51], s69 offen offset:0 sc1 lds
MV 148,a,76,a,0
ds_read_b128 a[112:115], v243 offset:8192
MV 152,a,76,a,4
ds_read_b128 a[116:119], v243 offset:9216
MV 156,a,80,a,0
buffer_load_dwordx2 v[218:219], v251, s[56:59], s72 offen offset:128 sc1
MV 160,a,80,a,4
ds_read_b128 a[120:123], v243 offset:10240
buffer_load_dwordx4 v238, s[48:51], s69 offen offset:1024 sc1 lds
MV 164,a,84,a,0
ds_read_b128 a[124:127], v243 offset:11264
MV 168,a,84,a,4
MV 172,a,88,a,0
MV 176,a,88,a,4
MV 180,a,92,a,0
buffer_load_dwordx4 a[0:3], v236, s[44:47], s68 offen offset:0 sc1
MV 184,a,92,a,4
buffer_load_dwordx4 a[4:7], v237, s[44:47], s68 offen offset:0 sc1
s_waitcnt vmcnt(19) lgkmcnt(0)
s_barrier
MV 124,a,96,a,8
ds_read_b128 a[64:67], v242 offset:16384
s_add_u32 s72, s79, 131072
MV 128,a,96,a,12
ds_read_b128 a[68:71], v242 offset:17408
buffer_load_dwordx4 v238, s[48:51], s69 offen offset:2048 sc1 lds
MV 132,a,100,a,8
MV 136,a,100,a,12
ds_read_b128 a[72:75], v242 offset:18432
MV 140,a,104,a,8
ds_read_b128 a[76:79], v242 offset:19456
buffer_load_dwordx2 v[220:221], v251, s[56:59], s72 offen offset:128 sc1
MV 144,a,104,a,12
buffer_load_dwordx4 v238, s[48:51], s69 offen offset:3072 sc1 lds
MV 148,a,108,a,8
ds_read_b128 a[80:83], v243 offset:16384
MV 152,a,108,a,12
ds_read_b128 a[84:87], v243 offset:17408
MV 156,a,112,a,8
s_add_u32 s72, s79, 147456
MV 160,a,112,a,12
ds_read_b128 a[88:91], v243 offset:18432
s_add_u32 s69, s69, 16384
MV 164,a,116,a,8
ds_read_b128 a[92:95], v243 offset:19456
MV 168,a,116,a,12
MV 172,a,120,a,8
buffer_load_dwordx2 v[222:223], v251, s[56:59], s72 offen offset:128 sc1
MV 176,a,120,a,12
MV 180,a,124,a,8
buffer_load_dwordx4 a[8:11], v236, s[44:47], s68 offen offset:1024 sc1
MV 184,a,124,a,12
buffer_load_dwordx4 a[12:15], v237, s[44:47], s68 offen offset:1024 sc1
s_add_u32 s68, s68, 2048
s_waitcnt lgkmcnt(0)
MV 124,a,64,a,16
ds_read_b128 a[96:99], v242 offset:24576
MV 128,a,64,a,20
ds_read_b128 a[100:103], v242 offset:25600
s_add_u32 m0, s70, 66560
MV 132,a,68,a,16
MV 136,a,68,a,20
ds_read_b128 a[104:107], v242 offset:26624
MV 140,a,72,a,16
ds_read_b128 a[108:111], v242 offset:27648
MV 144,a,72,a,20
buffer_load_dwordx4 v238, s[48:51], s69 offen offset:0 sc1 lds
MV 148,a,76,a,16
ds_read_b128 a[112:115], v243 offset:24576
MV 152,a,76,a,20
ds_read_b128 a[116:119], v243 offset:25600
MV 156,a,80,a,16
MV 160,a,80,a,20
ds_read_b128 a[120:123], v243 offset:26624
buffer_load_dwordx4 v238, s[48:51], s69 offen offset:1024 sc1 lds
MV 164,a,84,a,16
ds_read_b128 a[124:127], v243 offset:27648
MV 168,a,84,a,20
MV 172,a,88,a,16
MV 176,a,88,a,20
MV 180,a,92,a,16
buffer_load_dwordx4 a[16:19], v236, s[44:47], s68 offen offset:0 sc1
MV 184,a,92,a,20
buffer_load_dwordx4 a[20:23], v237, s[44:47], s68 offen offset:0 sc1
s_waitcnt vmcnt(18) lgkmcnt(0)
s_barrier
MV 124,a,96,a,24
ds_read_b128 a[64:67], v242 offset:32768
MV 128,a,96,a,28
ds_read_b128 a[68:71], v242 offset:33792
buffer_load_dwordx4 v238, s[48:51], s69 offen offset:2048 sc1 lds
MV 132,a,100,a,24
MV 136,a,100,a,28
ds_read_b128 a[72:75], v242 offset:34816
MV 140,a,104,a,24
ds_read_b128 a[76:79], v242 offset:35840
MV 144,a,104,a,28
buffer_load_dwordx4 v238, s[48:51], s69 offen offset:3072 sc1 lds
MV 148,a,108,a,24
ds_read_b128 a[80:83], v243 offset:32768
MV 152,a,108,a,28
ds_read_b128 a[84:87], v243 offset:33792
MV 156,a,112,a,24
MV 160,a,112,a,28
ds_read_b128 a[88:91], v243 offset:34816
s_add_u32 s69, s69, 16384
MV 164,a,116,a,24
ds_read_b128 a[92:95], v243 offset:35840
MV 168,a,116,a,28
MV 172,a,120,a,24
MV 176,a,120,a,28
MV 180,a,124,a,24
buffer_load_dwordx4 a[24:27], v236, s[44:47], s68 offen offset:1024 sc1
MV 184,a,124,a,28
buffer_load_dwordx4 a[28:31], v237, s[44:47], s68 offen offset:1024 sc1
s_add_u32 s68, s68, 2048
s_waitcnt lgkmcnt(0)
MV 124,a,64,a,32
ds_read_b128 a[96:99], v242 offset:40960
v_sub_f32 v8, 1.0, v6
MV 128,a,64,a,36
ds_read_b128 a[100:103], v242 offset:41984
s_add_u32 m0, s70, 82944
MV 132,a,68,a,32
v_lshlrev_b32 v36, 16, v192
v_lshlrev_b32 v228, 16, v208
MV 136,a,68,a,36
ds_read_b128 a[104:107], v242 offset:43008
v_and_b32 v37, 0xffff0000, v192
MV 140,a,72,a,32
ds_read_b128 a[108:111], v242 offset:44032
v_and_b32 v229, 0xffff0000, v208
MV 144,a,72,a,36
buffer_load_dwordx4 v238, s[48:51], s69 offen offset:0 sc1 lds
v_mul_f32 v36, v36, v228
MV 148,a,76,a,32
ds_read_b128 a[112:115], v243 offset:40960
v_mul_f32 v37, v37, v229
MV 152,a,76,a,36
ds_read_b128 a[116:119], v243 offset:41984
v_mul_f32 v36, v36, v6
MV 156,a,80,a,32
v_mul_f32 v37, v37, v6
v_lshlrev_b32 v38, 16, v193
MV 160,a,80,a,36
ds_read_b128 a[120:123], v243 offset:43008
buffer_load_dwordx4 v238, s[48:51], s69 offen offset:1024 sc1 lds
MV 164,a,84,a,32
ds_read_b128 a[124:127], v243 offset:44032
v_lshlrev_b32 v228, 16, v209
MV 168,a,84,a,36
v_and_b32 v39, 0xffff0000, v193
v_and_b32 v229, 0xffff0000, v209
MV 172,a,88,a,32
v_mul_f32 v38, v38, v228
v_mul_f32 v39, v39, v229
MV 176,a,88,a,36
v_mul_f32 v38, v38, v6
v_mul_f32 v39, v39, v6
MV 180,a,92,a,32
buffer_load_dwordx4 a[32:35], v236, s[44:47], s68 offen offset:0 sc1
v_lshlrev_b32 v40, 16, v194
MV 184,a,92,a,36
buffer_load_dwordx4 a[36:39], v237, s[44:47], s68 offen offset:0 sc1
v_lshlrev_b32 v228, 16, v210
v_and_b32 v41, 0xffff0000, v194
v_and_b32 v229, 0xffff0000, v210
s_waitcnt vmcnt(15) lgkmcnt(0)
s_barrier
MV 124,a,96,a,40
ds_read_b128 a[64:67], v242 offset:49152
v_mul_f32 v40, v40, v228
MV 128,a,96,a,44
ds_read_b128 a[68:71], v242 offset:50176
buffer_load_dwordx4 v238, s[48:51], s69 offen offset:2048 sc1 lds
MV 132,a,100,a,40
v_mul_f32 v41, v41, v229
v_mul_f32 v40, v40, v6
MV 136,a,100,a,44
ds_read_b128 a[72:75], v242 offset:51200
v_mul_f32 v41, v41, v6
MV 140,a,104,a,40
ds_read_b128 a[76:79], v242 offset:52224
v_lshlrev_b32 v42, 16, v195
MV 144,a,104,a,44
buffer_load_dwordx4 v238, s[48:51], s69 offen offset:3072 sc1 lds
v_lshlrev_b32 v228, 16, v211
MV 148,a,108,a,40
ds_read_b128 a[80:83], v243 offset:49152
v_and_b32 v43, 0xffff0000, v195
MV 152,a,108,a,44
ds_read_b128 a[84:87], v243 offset:50176
v_and_b32 v229, 0xffff0000, v211
MV 156,a,112,a,40
v_mul_f32 v42, v42, v228
v_mul_f32 v43, v43, v229
MV 160,a,112,a,44
ds_read_b128 a[88:91], v243 offset:51200
s_add_u32 s69, s69, 16384
MV 164,a,116,a,40
ds_read_b128 a[92:95], v243 offset:52224
v_mul_f32 v42, v42, v6
MV 168,a,116,a,44
v_mul_f32 v43, v43, v6
v_lshlrev_b32 v44, 16, v196
MV 172,a,120,a,40
v_lshlrev_b32 v228, 16, v212
v_and_b32 v45, 0xffff0000, v196
MV 176,a,120,a,44
v_and_b32 v229, 0xffff0000, v212
v_mul_f32 v44, v44, v228
MV 180,a,124,a,40
buffer_load_dwordx4 a[40:43], v236, s[44:47], s68 offen offset:1024 sc1
v_mul_f32 v45, v45, v229
MV 184,a,124,a,44
buffer_load_dwordx4 a[44:47], v237, s[44:47], s68 offen offset:1024 sc1
s_add_u32 s68, s68, 2048
v_mul_f32 v44, v44, v6
v_mul_f32 v45, v45, v6
v_lshlrev_b32 v46, 16, v197
v_lshlrev_b32 v228, 16, v213
s_waitcnt lgkmcnt(0)
MV 124,a,64,a,48
ds_read_b128 a[96:99], v242 offset:57344
v_and_b32 v47, 0xffff0000, v197
MV 128,a,64,a,52
ds_read_b128 a[100:103], v242 offset:58368
s_add_u32 m0, s70, 99328
MV 132,a,68,a,48
v_and_b32 v229, 0xffff0000, v213
v_mul_f32 v46, v46, v228
MV 136,a,68,a,52
ds_read_b128 a[104:107], v242 offset:59392
v_mul_f32 v47, v47, v229
MV 140,a,72,a,48
ds_read_b128 a[108:111], v242 offset:60416
v_mul_f32 v46, v46, v6
MV 144,a,72,a,52
buffer_load_dwordx4 v238, s[48:51], s69 offen offset:0 sc1 lds
v_mul_f32 v47, v47, v6
MV 148,a,76,a,48
ds_read_b128 a[112:115], v243 offset:57344
v_lshlrev_b32 v48, 16, v198
MV 152,a,76,a,52
ds_read_b128 a[116:119], v243 offset:58368
v_lshlrev_b32 v228, 16, v214
MV 156,a,80,a,48
v_and_b32 v49, 0xffff0000, v198
v_and_b32 v229, 0xffff0000, v214
MV 160,a,80,a,52
ds_read_b128 a[120:123], v243 offset:59392
buffer_load_dwordx4 v238, s[48:51], s69 offen offset:1024 sc1 lds
MV 164,a,84,a,48
ds_read_b128 a[124:127], v243 offset:60416
v_mul_f32 v48, v48, v228
MV 168,a,84,a,52
v_mul_f32 v49, v49, v229
v_mul_f32 v48, v48, v6
MV 172,a,88,a,48
v_mul_f32 v49, v49, v6
v_lshlrev_b32 v50, 16, v199
MV 176,a,88,a,52
v_lshlrev_b32 v228, 16, v215
v_and_b32 v51, 0xffff0000, v199
MV 180,a,92,a,48
buffer_load_dwordx4 a[48:51], v236, s[44:47], s68 offen offset:0 sc1
v_and_b32 v229, 0xffff0000, v215
MV 184,a,92,a,52
buffer_load_dwordx4 a[52:55], v237, s[44:47], s68 offen offset:0 sc1
v_mul_f32 v50, v50, v228
v_mul_f32 v51, v51, v229
v_mul_f32 v50, v50, v6
v_mul_f32 v51, v51, v6
s_waitcnt vmcnt(14) lgkmcnt(0)
s_barrier
MV 124,a,96,a,56
ds_read_b128 a[64:67], v242 offset:0
v_sub_f32 v9, 1.0, v7
MV 128,a,96,a,60
ds_read_b128 a[68:71], v242 offset:1024
buffer_load_dwordx4 v238, s[48:51], s69 offen offset:2048 sc1 lds
MV 132,a,100,a,56
v_lshlrev_b32 v52, 16, v200
v_lshlrev_b32 v228, 16, v216
MV 136,a,100,a,60
ds_read_b128 a[72:75], v242 offset:2048
v_and_b32 v53, 0xffff0000, v200
MV 140,a,104,a,56
ds_read_b128 a[76:79], v242 offset:3072
v_and_b32 v229, 0xffff0000, v216
MV 144,a,104,a,60
buffer_load_dwordx4 v238, s[48:51], s69 offen offset:3072 sc1 lds
v_mul_f32 v52, v52, v228
MV 148,a,108,a,56
ds_read_b128 a[80:83], v243 offset:0
v_mul_f32 v53, v53, v229
MV 152,a,108,a,60
ds_read_b128 a[84:87], v243 offset:1024
v_mul_f32 v52, v52, v7
MV 156,a,112,a,56
v_mul_f32 v53, v53, v7
v_lshlrev_b32 v54, 16, v201
MV 160,a,112,a,60
ds_read_b128 a[88:91], v243 offset:2048
s_add_u32 s69, s69, 16384
MV 164,a,116,a,56
ds_read_b128 a[92:95], v243 offset:3072
v_lshlrev_b32 v228, 16, v217
MV 168,a,116,a,60
v_and_b32 v55, 0xffff0000, v201
v_and_b32 v229, 0xffff0000, v217
MV 172,a,120,a,56
v_mul_f32 v54, v54, v228
v_mul_f32 v55, v55, v229
MV 176,a,120,a,60
v_mul_f32 v54, v54, v7
v_mul_f32 v55, v55, v7
MV 180,a,124,a,56
buffer_load_dwordx4 a[56:59], v236, s[44:47], s68 offen offset:1024 sc1
v_lshlrev_b32 v56, 16, v202
MV 184,a,124,a,60
buffer_load_dwordx4 a[60:63], v237, s[44:47], s68 offen offset:1024 sc1
s_add_u32 s68, s68, 2048
v_lshlrev_b32 v228, 16, v218
v_and_b32 v57, 0xffff0000, v202
v_and_b32 v229, 0xffff0000, v218
s_waitcnt lgkmcnt(0)
MV 124,a,64,a,0
ds_read_b128 a[96:99], v242 offset:8192
v_mul_f32 v56, v56, v228
MV 128,a,64,a,4
ds_read_b128 a[100:103], v242 offset:9216
s_add_u32 m0, s70, 115712
MV 132,a,68,a,0
v_mul_f32 v57, v57, v229
v_mul_f32 v56, v56, v7
MV 136,a,68,a,4
ds_read_b128 a[104:107], v242 offset:10240
v_mul_f32 v57, v57, v7
MV 140,a,72,a,0
ds_read_b128 a[108:111], v242 offset:11264
v_lshlrev_b32 v58, 16, v203
MV 144,a,72,a,4
buffer_load_dwordx4 v238, s[48:51], s69 offen offset:0 sc1 lds
v_lshlrev_b32 v228, 16, v219
MV 148,a,76,a,0
ds_read_b128 a[112:115], v243 offset:8192
v_and_b32 v59, 0xffff0000, v203
MV 152,a,76,a,4
ds_read_b128 a[116:119], v243 offset:9216
v_and_b32 v229, 0xffff0000, v219
MV 156,a,80,a,0
v_mul_f32 v58, v58, v228
v_mul_f32 v59, v59, v229
MV 160,a,80,a,4
ds_read_b128 a[120:123], v243 offset:10240
buffer_load_dwordx4 v238, s[48:51], s69 offen offset:1024 sc1 lds
MV 164,a,84,a,0
ds_read_b128 a[124:127], v243 offset:11264
v_mul_f32 v58, v58, v7
MV 168,a,84,a,4
v_mul_f32 v59, v59, v7
v_lshlrev_b32 v60, 16, v204
MV 172,a,88,a,0
v_lshlrev_b32 v228, 16, v220
v_and_b32 v61, 0xffff0000, v204
MV 176,a,88,a,4
v_and_b32 v229, 0xffff0000, v220
v_mul_f32 v60, v60, v228
MV 180,a,92,a,0
v_mul_f32 v61, v61, v229
v_mul_f32 v60, v60, v7
MV 184,a,92,a,4
v_mul_f32 v61, v61, v7
v_lshlrev_b32 v62, 16, v205
v_lshlrev_b32 v228, 16, v221
s_waitcnt vmcnt(12) lgkmcnt(0)
s_barrier
MV 124,a,96,a,8
ds_read_b128 a[80:83], v243 offset:16384
v_and_b32 v63, 0xffff0000, v205
MV 128,a,96,a,12
buffer_load_dwordx4 v238, s[48:51], s69 offen offset:2048 sc1 lds
v_and_b32 v229, 0xffff0000, v221
MV 132,a,100,a,8
v_mul_f32 v62, v62, v228
v_mul_f32 v63, v63, v229
MV 136,a,100,a,12
ds_read_b128 a[84:87], v243 offset:17408
v_mul_f32 v62, v62, v7
MV 140,a,104,a,8
v_mul_f32 v63, v63, v7
v_lshlrev_b32 v64, 16, v206
MV 144,a,104,a,12
buffer_load_dwordx4 v238, s[48:51], s69 offen offset:3072 sc1 lds
v_lshlrev_b32 v228, 16, v222
MV 148,a,108,a,8
ds_read_b128 a[88:91], v243 offset:18432
v_and_b32 v65, 0xffff0000, v206
MV 152,a,108,a,12
v_and_b32 v229, 0xffff0000, v222
v_mul_f32 v64, v64, v228
MV 156,a,112,a,8
v_mul_f32 v65, v65, v229
v_mul_f32 v64, v64, v7
MV 160,a,112,a,12
ds_read_b128 a[92:95], v243 offset:19456
s_add_u32 s69, s69, 16384
MV 164,a,116,a,8
v_mul_f32 v65, v65, v7
v_lshlrev_b32 v66, 16, v207
MV 168,a,116,a,12
v_lshlrev_b32 v228, 16, v223
v_and_b32 v67, 0xffff0000, v207
MV 172,a,120,a,8
v_and_b32 v229, 0xffff0000, v223
MV 176,a,120,a,12
v_mul_f32 v66, v66, v228
v_mul_f32 v67, v67, v229
MV 180,a,124,a,8
v_mul_f32 v66, v66, v7
MV 184,a,124,a,12
v_mul_f32 v67, v67, v7
s_waitcnt lgkmcnt(0)
MV 156,a,80,a,16
ds_read_b128 a[112:115], v243 offset:24576
s_xor_b32 s72, s2, 4
MV 160,a,80,a,20
ds_read_b128 a[116:119], v243 offset:25600
s_lshl_b32 s72, s72, 14
MV 164,a,84,a,16
ds_read_b128 a[120:123], v243 offset:26624
MV 168,a,84,a,20
ds_read_b128 a[124:127], v243 offset:27648
MV 172,a,88,a,16
MV 176,a,88,a,20
MV 180,a,92,a,16
MV 184,a,92,a,20
s_waitcnt vmcnt(6)
s_barrier
s_waitcnt lgkmcnt(3)
MV 156,a,112,a,24
ds_read_b128 a[80:83], v243 offset:32768
MV 160,a,112,a,28
ds_read_b128 a[84:87], v243 offset:33792
s_waitcnt lgkmcnt(4)
MV 164,a,116,a,24
ds_read_b128 a[88:91], v243 offset:34816
MV 168,a,116,a,28
ds_read_b128 a[92:95], v243 offset:35840
s_waitcnt lgkmcnt(5)
MV 172,a,120,a,24
MV 176,a,120,a,28
s_waitcnt lgkmcnt(4)
MV 180,a,124,a,24
MV 184,a,124,a,28
s_waitcnt lgkmcnt(3)
MV 156,a,80,a,32
ds_read_b128 a[112:115], v243 offset:40960
MV 160,a,80,a,36
ds_read_b128 a[116:119], v243 offset:41984
s_waitcnt lgkmcnt(4)
MV 164,a,84,a,32
ds_read_b128 a[120:123], v243 offset:43008
MV 168,a,84,a,36
ds_read_b128 a[124:127], v243 offset:44032
s_waitcnt lgkmcnt(5)
MV 172,a,88,a,32
MV 176,a,88,a,36
s_waitcnt lgkmcnt(4)
MV 180,a,92,a,32
MV 184,a,92,a,36
s_waitcnt vmcnt(0)
s_barrier
s_waitcnt lgkmcnt(3)
MV 156,a,112,a,40
ds_read_b128 a[80:83], v243 offset:49152
MV 160,a,112,a,44
ds_read_b128 a[84:87], v243 offset:50176
s_waitcnt lgkmcnt(4)
MV 164,a,116,a,40
ds_read_b128 a[88:91], v243 offset:51200
MV 168,a,116,a,44
ds_read_b128 a[92:95], v243 offset:52224
s_waitcnt lgkmcnt(5)
MV 172,a,120,a,40
MV 176,a,120,a,44
s_waitcnt lgkmcnt(4)
MV 180,a,124,a,40
MV 184,a,124,a,44
s_waitcnt lgkmcnt(3)
MV 156,a,80,a,48
ds_read_b128 a[112:115], v243 offset:57344
MV 160,a,80,a,52
ds_read_b128 a[116:119], v243 offset:58368
s_waitcnt lgkmcnt(4)
MV 164,a,84,a,48
ds_read_b128 a[120:123], v243 offset:59392
MV 168,a,84,a,52
ds_read_b128 a[124:127], v243 offset:60416
s_waitcnt lgkmcnt(5)
MV 172,a,88,a,48
MV 176,a,88,a,52
s_waitcnt lgkmcnt(4)
MV 180,a,92,a,48
MV 184,a,92,a,52
s_waitcnt lgkmcnt(3)
MV 156,a,112,a,56
ds_read_b128 a[64:67], v242 offset:16384
MV 160,a,112,a,60
ds_read_b128 a[68:71], v242 offset:17408
s_waitcnt lgkmcnt(4)
MV 164,a,116,a,56
ds_read_b128 a[72:75], v242 offset:18432
MV 168,a,116,a,60
ds_read_b128 a[76:79], v242 offset:19456
s_waitcnt lgkmcnt(5)
MV 172,a,120,a,56
MV 176,a,120,a,60
s_waitcnt lgkmcnt(4)
MV 180,a,124,a,56
MV 184,a,124,a,60
s_waitcnt lgkmcnt(3)
MV 124,a,64,a,16
ds_read_b128 a[96:99], v242 offset:24576
MV 128,a,64,a,20
ds_read_b128 a[100:103], v242 offset:25600
s_waitcnt lgkmcnt(4)
MV 132,a,68,a,16
ds_read_b128 a[104:107], v242 offset:26624
v_permlane16_swap_b32 v156, v164
MV 136,a,68,a,20
ds_read_b128 a[108:111], v242 offset:27648
v_permlane16_swap_b32 v157, v165
s_waitcnt lgkmcnt(5)
MV 140,a,72,a,16
v_permlane16_swap_b32 v158, v166
v_permlane16_swap_b32 v159, v167
MV 144,a,72,a,20
v_cvt_pk_bf16_f32 v156, v156, v157
v_cvt_pk_bf16_f32 v157, v158, v159
s_waitcnt lgkmcnt(4)
MV 148,a,76,a,16
v_cvt_pk_bf16_f32 v158, v164, v165
v_cvt_pk_bf16_f32 v159, v166, v167
MV 152,a,76,a,20
buffer_store_dwordx4 v[156:159], v238, s[52:55], s72 offen offset:0 sc1
v_permlane16_swap_b32 v172, v180
s_waitcnt lgkmcnt(3)
MV 124,a,96,a,24
ds_read_b128 a[64:67], v242 offset:32768
v_permlane16_swap_b32 v173, v181
MV 128,a,96,a,28
ds_read_b128 a[68:71], v242 offset:33792
v_permlane16_swap_b32 v174, v182
s_waitcnt lgkmcnt(4)
MV 132,a,100,a,24
ds_read_b128 a[72:75], v242 offset:34816
v_permlane16_swap_b32 v175, v183
MV 136,a,100,a,28
ds_read_b128 a[76:79], v242 offset:35840
v_cvt_pk_bf16_f32 v172, v172, v173
s_waitcnt lgkmcnt(5)
MV 140,a,104,a,24
v_cvt_pk_bf16_f32 v173, v174, v175
v_cvt_pk_bf16_f32 v174, v180, v181
MV 144,a,104,a,28
v_cvt_pk_bf16_f32 v175, v182, v183
buffer_store_dwordx4 v[172:175], v238, s[52:55], s72 offen offset:1024 sc1
s_waitcnt lgkmcnt(4)
MV 148,a,108,a,24
v_permlane16_swap_b32 v160, v168
v_permlane16_swap_b32 v161, v169
MV 152,a,108,a,28
v_permlane16_swap_b32 v162, v170
v_permlane16_swap_b32 v163, v171
s_waitcnt lgkmcnt(3)
MV 124,a,64,a,32
ds_read_b128 a[96:99], v242 offset:40960
v_cvt_pk_bf16_f32 v160, v160, v161
MV 128,a,64,a,36
ds_read_b128 a[100:103], v242 offset:41984
v_cvt_pk_bf16_f32 v161, v162, v163
s_waitcnt lgkmcnt(4)
MV 132,a,68,a,32
ds_read_b128 a[104:107], v242 offset:43008
v_cvt_pk_bf16_f32 v162, v168, v169
MV 136,a,68,a,36
ds_read_b128 a[108:111], v242 offset:44032
v_cvt_pk_bf16_f32 v163, v170, v171
s_waitcnt lgkmcnt(5)
MV 140,a,72,a,32
buffer_store_dwordx4 v[160:163], v238, s[52:55], s72 offen offset:2048 sc1
v_permlane16_swap_b32 v176, v184
MV 144,a,72,a,36
v_permlane16_swap_b32 v177, v185
v_permlane16_swap_b32 v178, v186
s_waitcnt lgkmcnt(4)
MV 148,a,76,a,32
v_permlane16_swap_b32 v179, v187
v_cvt_pk_bf16_f32 v176, v176, v177
MV 152,a,76,a,36
v_cvt_pk_bf16_f32 v177, v178, v179
v_cvt_pk_bf16_f32 v178, v184, v185
s_waitcnt lgkmcnt(3)
MV 124,a,96,a,40
ds_read_b128 a[64:67], v242 offset:49152
v_cvt_pk_bf16_f32 v179, v186, v187
MV 128,a,96,a,44
ds_read_b128 a[68:71], v242 offset:50176
buffer_store_dwordx4 v[176:179], v238, s[52:55], s72 offen offset:3072 sc1
s_waitcnt lgkmcnt(4)
MV 132,a,100,a,40
ds_read_b128 a[72:75], v242 offset:51200
MV 136,a,100,a,44
ds_read_b128 a[76:79], v242 offset:52224
s_waitcnt lgkmcnt(5)
MV 140,a,104,a,40
MV 144,a,104,a,44
s_waitcnt lgkmcnt(4)
MV 148,a,108,a,40
MV 152,a,108,a,44
s_waitcnt lgkmcnt(3)
MV 124,a,64,a,48
ds_read_b128 a[96:99], v242 offset:57344
MV 128,a,64,a,52
ds_read_b128 a[100:103], v242 offset:58368
s_waitcnt lgkmcnt(4)
MV 132,a,68,a,48
ds_read_b128 a[104:107], v242 offset:59392
MV 136,a,68,a,52
ds_read_b128 a[108:111], v242 offset:60416
s_waitcnt lgkmcnt(5)
MV 140,a,72,a,48
MV 144,a,72,a,52
s_waitcnt lgkmcnt(4)
MV 148,a,76,a,48
MV 152,a,76,a,52
s_waitcnt lgkmcnt(3)
MV 124,a,96,a,56
MV 128,a,96,a,60
s_waitcnt lgkmcnt(2)
MV 132,a,100,a,56
MV 136,a,100,a,60
s_waitcnt lgkmcnt(1)
MV 140,a,104,a,56
MV 144,a,104,a,60
s_waitcnt lgkmcnt(0)
MV 148,a,108,a,56
MV 152,a,108,a,60
s_lshl_b32 s72, s2, 14
s_mov_b32 s73, 400000
buffer_load_dwordx4 v[76:79], v238, s[52:55], s72 offen offset:0 sc1
buffer_load_dwordx4 v[80:83], v238, s[52:55], s72 offen offset:1024 sc1
buffer_load_dwordx4 v[84:87], v238, s[52:55], s72 offen offset:2048 sc1
buffer_load_dwordx4 v[88:91], v238, s[52:55], s72 offen offset:3072 sc1
v_permlane16_swap_b32 v124, v132
v_permlane16_swap_b32 v125, v133
v_permlane16_swap_b32 v126, v134
v_permlane16_swap_b32 v127, v135
v_permlane16_swap_b32 v140, v148
v_permlane16_swap_b32 v141, v149
v_permlane16_swap_b32 v142, v150
v_permlane16_swap_b32 v143, v151
v_permlane16_swap_b32 v128, v136
v_permlane16_swap_b32 v129, v137
v_permlane16_swap_b32 v130, v138
v_permlane16_swap_b32 v131, v139
v_permlane16_swap_b32 v144, v152
v_permlane16_swap_b32 v145, v153
v_permlane16_swap_b32 v146, v154
v_permlane16_swap_b32 v147, v155
v_fma_f32 v36, v124, v8, v36
v_fma_f32 v37, v125, v8, v37
v_fma_f32 v38, v126, v8, v38
v_fma_f32 v39, v127, v8, v39
v_fma_f32 v40, v132, v8, v40
v_fma_f32 v41, v133, v8, v41
v_fma_f32 v42, v134, v8, v42
v_fma_f32 v43, v135, v8, v43
v_fma_f32 v44, v140, v8, v44
v_fma_f32 v45, v141, v8, v45
v_fma_f32 v46, v142, v8, v46
v_fma_f32 v47, v143, v8, v47
v_fma_f32 v48, v148, v8, v48
v_fma_f32 v49, v149, v8, v49
v_fma_f32 v50, v150, v8, v50
v_fma_f32 v51, v151, v8, v51
v_fma_f32 v52, v128, v9, v52
v_fma_f32 v53, v129, v9, v53
v_fma_f32 v54, v130, v9, v54
v_fma_f32 v55, v131, v9, v55
v_fma_f32 v56, v136, v9, v56
v_fma_f32 v57, v137, v9, v57
v_fma_f32 v58, v138, v9, v58
v_fma_f32 v59, v139, v9, v59
v_fma_f32 v60, v144, v9, v60
v_fma_f32 v61, v145, v9, v61
v_fma_f32 v62, v146, v9, v62
v_fma_f32 v63, v147, v9, v63
v_fma_f32 v64, v152, v9, v64
v_fma_f32 v65, v153, v9, v65
v_fma_f32 v66, v154, v9, v66
v_fma_f32 v67, v155, v9, v67
s_branch L_xb_chk
L_xb:
buffer_load_dwordx4 v[76:79], v238, s[52:55], s72 offen offset:0 sc1
buffer_load_dwordx4 v[80:83], v238, s[52:55], s72 offen offset:1024 sc1
buffer_load_dwordx4 v[84:87], v238, s[52:55], s72 offen offset:2048 sc1
buffer_load_dwordx4 v[88:91], v238, s[52:55], s72 offen offset:3072 sc1
s_sub_u32 s73, s73, 1
s_cbranch_scc1 L_xb_done
L_xb_chk:
s_waitcnt vmcnt(3)
v_max3_u32 v228, v76, v77, v78
s_waitcnt vmcnt(2)
v_max3_u32 v228, v228, v79, v80
v_max3_u32 v228, v228, v81, v82
s_waitcnt vmcnt(1)
v_max3_u32 v228, v228, v83, v84
v_max3_u32 v228, v228, v85, v86
s_waitcnt vmcnt(0)
v_max3_u32 v228, v228, v87, v88
v_max3_u32 v228, v228, v89, v90
v_max_u32 v228, v228, v91
v_cmp_eq_u32 vcc, -1, v228
s_nop 4
s_cbranch_vccnz L_xb
L_xb_done:
s_waitcnt vmcnt(0)
s_add_u32 s72, s78, 0
v_lshlrev_b32 v92, 16, v76
v_and_b32 v93, 0xffff0000, v76
v_fmac_f32 v36, v92, v8
v_fmac_f32 v37, v93, v8
v_cvt_pk_bf16_f32 v192, v36, v37
v_lshlrev_b32 v92, 16, v77
v_and_b32 v93, 0xffff0000, v77
v_fmac_f32 v38, v92, v8
v_fmac_f32 v39, v93, v8
v_cvt_pk_bf16_f32 v193, v38, v39
v_lshlrev_b32 v92, 16, v78
v_and_b32 v93, 0xffff0000, v78
v_fmac_f32 v40, v92, v8
v_fmac_f32 v41, v93, v8
v_cvt_pk_bf16_f32 v194, v40, v41
v_lshlrev_b32 v92, 16, v79
v_and_b32 v93, 0xffff0000, v79
v_fmac_f32 v42, v92, v8
v_fmac_f32 v43, v93, v8
v_cvt_pk_bf16_f32 v195, v42, v43
buffer_store_dwordx4 v[192:195], v250, s[60:63], s72 offen offset:0 sc1
v_lshlrev_b32 v92, 16, v80
v_and_b32 v93, 0xffff0000, v80
v_fmac_f32 v44, v92, v8
v_fmac_f32 v45, v93, v8
v_cvt_pk_bf16_f32 v196, v44, v45
v_lshlrev_b32 v92, 16, v81
v_and_b32 v93, 0xffff0000, v81
v_fmac_f32 v46, v92, v8
v_fmac_f32 v47, v93, v8
v_cvt_pk_bf16_f32 v197, v46, v47
v_lshlrev_b32 v92, 16, v82
v_and_b32 v93, 0xffff0000, v82
v_fmac_f32 v48, v92, v8
v_fmac_f32 v49, v93, v8
v_cvt_pk_bf16_f32 v198, v48, v49
v_lshlrev_b32 v92, 16, v83
v_and_b32 v93, 0xffff0000, v83
v_fmac_f32 v50, v92, v8
v_fmac_f32 v51, v93, v8
v_cvt_pk_bf16_f32 v199, v50, v51
buffer_store_dwordx4 v[196:199], v250, s[60:63], s72 offen offset:64 sc1
s_add_u32 s72, s78, 32768
v_lshlrev_b32 v92, 16, v84
v_and_b32 v93, 0xffff0000, v84
v_fmac_f32 v52, v92, v9
v_fmac_f32 v53, v93, v9
v_cvt_pk_bf16_f32 v200, v52, v53
v_lshlrev_b32 v92, 16, v85
v_and_b32 v93, 0xffff0000, v85
v_fmac_f32 v54, v92, v9
v_fmac_f32 v55, v93, v9
v_cvt_pk_bf16_f32 v201, v54, v55
v_lshlrev_b32 v92, 16, v86
v_and_b32 v93, 0xffff0000, v86
v_fmac_f32 v56, v92, v9
v_fmac_f32 v57, v93, v9
v_cvt_pk_bf16_f32 v202, v56, v57
v_lshlrev_b32 v92, 16, v87
v_and_b32 v93, 0xffff0000, v87
v_fmac_f32 v58, v92, v9
v_fmac_f32 v59, v93, v9
v_cvt_pk_bf16_f32 v203, v58, v59
buffer_store_dwordx4 v[200:203], v250, s[60:63], s72 offen offset:0 sc1
v_lshlrev_b32 v92, 16, v88
v_and_b32 v93, 0xffff0000, v88
v_fmac_f32 v60, v92, v9
v_fmac_f32 v61, v93, v9
v_cvt_pk_bf16_f32 v204, v60, v61
v_lshlrev_b32 v92, 16, v89
v_and_b32 v93, 0xffff0000, v89
v_fmac_f32 v62, v92, v9
v_fmac_f32 v63, v93, v9
v_cvt_pk_bf16_f32 v205, v62, v63
v_lshlrev_b32 v92, 16, v90
v_and_b32 v93, 0xffff0000, v90
v_fmac_f32 v64, v92, v9
v_fmac_f32 v65, v93, v9
v_cvt_pk_bf16_f32 v206, v64, v65
v_lshlrev_b32 v92, 16, v91
v_and_b32 v93, 0xffff0000, v91
v_fmac_f32 v66, v92, v9
v_fmac_f32 v67, v93, v9
v_cvt_pk_bf16_f32 v207, v66, v67
buffer_store_dwordx4 v[204:207], v250, s[60:63], s72 offen offset:64 sc1
L_end:
s_endpgm
L_p3_pmask:
s_nop 7
v_add_u32 v246, 0, v13
v_cmp_gt_i32_e64 s[84:85], 0, v246
v_cmp_gt_i32_e64 s[86:87], 1, v246
v_cmp_gt_i32_e64 s[88:89], 2, v246
v_cmp_gt_i32_e64 s[90:91], 3, v246
v_cndmask_b32_e64 v96, v96, v14, s[84:85]
v_cndmask_b32_e64 v97, v97, v14, s[86:87]
v_cndmask_b32_e64 v98, v98, v14, s[88:89]
v_cndmask_b32_e64 v99, v99, v14, s[90:91]
v_add_u32 v247, -16, v13
v_cmp_gt_i32_e64 s[92:93], 0, v247
v_cmp_gt_i32_e64 s[94:95], 1, v247
v_cmp_gt_i32_e64 s[96:97], 2, v247
v_cmp_gt_i32_e64 s[98:99], 3, v247
v_cndmask_b32_e64 v100, v100, v14, s[92:93]
v_cndmask_b32_e64 v101, v101, v14, s[94:95]
v_cndmask_b32_e64 v102, v102, v14, s[96:97]
v_cndmask_b32_e64 v103, v103, v14, s[98:99]
v_add_u32 v246, -32, v13
v_cmp_gt_i32_e64 s[84:85], 0, v246
v_cmp_gt_i32_e64 s[86:87], 1, v246
v_cmp_gt_i32_e64 s[88:89], 2, v246
v_cmp_gt_i32_e64 s[90:91], 3, v246
v_cndmask_b32_e64 v128, v128, v14, s[84:85]
v_cndmask_b32_e64 v129, v129, v14, s[86:87]
v_cndmask_b32_e64 v130, v130, v14, s[88:89]
v_cndmask_b32_e64 v131, v131, v14, s[90:91]
v_add_u32 v247, -48, v13
v_cmp_gt_i32_e64 s[92:93], 0, v247
v_cmp_gt_i32_e64 s[94:95], 1, v247
v_cmp_gt_i32_e64 s[96:97], 2, v247
v_cmp_gt_i32_e64 s[98:99], 3, v247
v_cndmask_b32_e64 v132, v132, v14, s[92:93]
v_cndmask_b32_e64 v133, v133, v14, s[94:95]
v_cndmask_b32_e64 v134, v134, v14, s[96:97]
v_cndmask_b32_e64 v135, v135, v14, s[98:99]
s_branch L_p3_pmask_ret
L_p3_mxm_top:
s_waitcnt lgkmcnt(0)
v_xor_b32 v11, 0x8000, v11
v_mfma_f32_16x16x32_bf16 v[80:83], a[128:131], v[16:19], 0
s_add_u32 m0, s73, 16384
ds_read_b128 a[192:195], v11 offset:0
v_mfma_f32_16x16x32_bf16 v[88:91], a[128:131], v[32:35], 0
v_exp_f32 v176, v176
MV 80,a,132,v,20
v_exp_f32 v177, v177
MV 88,a,132,v,36
ds_read_b128 a[196:199], v11 offset:1024
buffer_load_dwordx4 v12, s[56:59], s71 offen offset:0 sc1 lds
MV 80,a,136,v,24
v_exp_f32 v178, v178
MV 88,a,136,v,40
v_add_f32 v2, v2, v176
v_add_f32 v2, v2, v177
MV 80,a,140,v,28
ds_read_b128 a[200:203], v11 offset:2048
ds_read_b128 a[204:207], v11 offset:3072
MV 88,a,140,v,44
v_exp_f32 v179, v179
v_mfma_f32_16x16x32_bf16 v[84:87], a[144:147], v[16:19], 0
ds_read_b128 a[208:211], v11 offset:4096
v_cvt_pk_bf16_f32 v176, v176, v177
v_mfma_f32_16x16x32_bf16 v[92:95], a[144:147], v[32:35], 0
v_exp_f32 v180, v180
MV 84,a,148,v,20
v_add_f32 v2, v2, v178
v_add_f32 v2, v2, v179
MV 92,a,148,v,36
v_exp_f32 v181, v181
MV 84,a,152,v,24
buffer_load_dwordx4 v12, s[56:59], s71 offen offset:1024 sc1 lds
v_cvt_pk_bf16_f32 v177, v178, v179
MV 92,a,152,v,40
v_exp_f32 v182, v182
MV 84,a,156,v,28
ds_read_b128 a[212:215], v11 offset:5120
v_add_f32 v2, v2, v180
MV 92,a,156,v,44
ds_read_b128 a[216:219], v11 offset:6144
v_add_f32 v2, v2, v181
v_mfma_f32_16x16x32_bf16 v[112:115], a[160:163], v[16:19], 0
v_exp_f32 v183, v183
v_mfma_f32_16x16x32_bf16 v[120:123], a[160:163], v[32:35], 0
ds_read_b128 a[220:223], v11 offset:7168
v_cvt_pk_bf16_f32 v178, v180, v181
MV 112,a,164,v,20
v_exp_f32 v184, v184
MV 120,a,164,v,36
v_add_f32 v2, v2, v182
v_add_f32 v2, v2, v183
MV 112,a,168,v,24
ds_read_b128 a[224:227], v11 offset:8192
buffer_load_dwordx4 v12, s[56:59], s71 offen offset:2048 sc1 lds
MV 120,a,168,v,40
v_exp_f32 v185, v185
MV 112,a,172,v,28
ds_read_b128 a[228:231], v11 offset:9216
v_cvt_pk_bf16_f32 v179, v182, v183
MV 120,a,172,v,44
v_exp_f32 v186, v186
v_mfma_f32_16x16x32_bf16 v[116:119], a[176:179], v[16:19], 0
v_add_f32 v3, v3, v184
v_add_f32 v3, v3, v185
v_mfma_f32_16x16x32_bf16 v[124:127], a[176:179], v[32:35], 0
v_exp_f32 v187, v187
MV 116,a,180,v,20
ds_read_b128 a[232:235], v11 offset:10240
v_cvt_pk_bf16_f32 v184, v184, v185
MV 124,a,180,v,36
v_exp_f32 v188, v188
MV 116,a,184,v,24
ds_read_b128 a[236:239], v11 offset:11264
v_add_f32 v3, v3, v186
MV 124,a,184,v,40
buffer_load_dwordx4 v12, s[56:59], s71 offen offset:3072 sc1 lds
v_add_f32 v3, v3, v187
MV 116,a,188,v,28
v_exp_f32 v189, v189
MV 124,a,188,v,44
ds_read_b128 a[240:243], v11 offset:12288
ds_read_b128 a[244:247], v11 offset:13312
ds_read_b128 a[248:251], v11 offset:14336
ds_read_b128 a[252:255], v11 offset:15360
s_add_u32 s71, s71, 16384
s_xor_b32 s73, s73, 0x8000
v_cvt_pk_bf16_f32 v185, v186, v187
v_exp_f32 v190, v190
v_add_f32 v3, v3, v188
v_add_f32 v3, v3, v189
v_exp_f32 v191, v191
v_cvt_pk_bf16_f32 v186, v188, v189
v_exp_f32 v200, v200
v_add_f32 v3, v3, v190
v_add_f32 v3, v3, v191
v_exp_f32 v201, v201
v_cvt_pk_bf16_f32 v187, v190, v191
v_exp_f32 v202, v202
v_add_u32 v246, 0, v13
v_cmp_gt_i32_e64 s[84:85], 0, v246
v_add_f32 v5, v5, v200
v_cmp_gt_i32_e64 s[86:87], 1, v246
v_cmp_gt_i32_e64 s[88:89], 2, v246
v_add_f32 v5, v5, v201
v_exp_f32 v203, v203
v_cmp_gt_i32_e64 s[90:91], 3, v246
v_cndmask_b32_e64 v80, v80, v14, s[84:85]
v_cvt_pk_bf16_f32 v200, v200, v201
v_exp_f32 v204, v204
v_cndmask_b32_e64 v81, v81, v14, s[86:87]
v_cndmask_b32_e64 v82, v82, v14, s[88:89]
v_add_f32 v5, v5, v202
v_add_f32 v5, v5, v203
v_cndmask_b32_e64 v83, v83, v14, s[90:91]
v_exp_f32 v205, v205
v_cvt_pk_bf16_f32 v201, v202, v203
v_add_u32 v247, -16, v13
v_cmp_gt_i32_e64 s[92:93], 0, v247
v_exp_f32 v206, v206
v_add_f32 v5, v5, v204
v_cmp_gt_i32_e64 s[94:95], 1, v247
v_cmp_gt_i32_e64 s[96:97], 2, v247
v_add_f32 v5, v5, v205
v_exp_f32 v207, v207
v_cmp_gt_i32_e64 s[98:99], 3, v247
v_cndmask_b32_e64 v84, v84, v14, s[92:93]
v_cvt_pk_bf16_f32 v202, v204, v205
v_add_f32 v5, v5, v206
v_cndmask_b32_e64 v85, v85, v14, s[94:95]
v_cndmask_b32_e64 v86, v86, v14, s[96:97]
v_add_f32 v5, v5, v207
v_cvt_pk_bf16_f32 v203, v206, v207
v_cndmask_b32_e64 v87, v87, v14, s[98:99]
s_waitcnt vmcnt(16) lgkmcnt(0)
MA 0,a,192,v,144
s_barrier
v_xor_b32 v10, 0x8000, v10
MA 32,a,192,v,152
s_add_u32 m0, s72, 16384
ds_read_b128 a[128:131], v10 offset:0
MA 4,a,196,v,144
buffer_load_dwordx4 v12, s[52:55], s71 offen offset:0 sc1 lds
v_lshrrev_b32 v249, 2, v1
MA 36,a,196,v,152
ds_read_b128 a[132:135], v10 offset:1024
v_and_b32 v248, 7, v249
MA 8,a,200,v,144
v_exp_f32 v80, v80
MA 40,a,200,v,152
v_lshlrev_b32 v249, 8, v249
v_and_b32 v250, 3, v1
MA 12,a,204,v,144
ds_read_b128 a[136:139], v10 offset:2048
v_lshl_add_u32 v249, v250, 3, v249
MA 44,a,204,v,152
v_exp_f32 v81, v81
MA 16,a,208,v,144
v_add_u32 v246, -32, v13
s_lshl_b32 s36, s3, 13
MA 48,a,208,v,152
s_add_u32 s36, s36, 131072
v_add_u32 v249, s36, v249
MA 20,a,212,v,144
v_exp_f32 v82, v82
MA 52,a,212,v,152
ds_read_b128 a[140:143], v10 offset:3072
s_nop 0
MA 24,a,216,v,144
v_cmp_gt_i32_e64 s[84:85], 0, v246
v_xor_b32 v250, 0, v248
MA 56,a,216,v,152
ds_read_b128 a[144:147], v10 offset:4096
v_lshl_add_u32 v250, v250, 5, v249
MA 28,a,220,v,144
v_exp_f32 v83, v83
MA 60,a,220,v,152
v_cmp_gt_i32_e64 s[86:87], 1, v246
TR 96,250,0
MA 124,a,220,v,168
TR 98,250,4096
v_xor_b32 v250, 1, v248
MA 120,a,216,v,168
ds_read_b128 a[148:151], v10 offset:5120
buffer_load_dwordx4 v12, s[52:55], s71 offen offset:1024 sc1 lds
MA 116,a,212,v,168
v_cvt_pk_bf16_f32 v80, v80, v81
v_lshl_add_u32 v250, v250, 5, v249
MA 112,a,208,v,168
TR 100,250,0
TR 102,250,4096
MA 108,a,204,v,168
v_exp_f32 v84, v84
MA 104,a,200,v,168
v_cmp_gt_i32_e64 s[88:89], 2, v246
v_xor_b32 v250, 2, v248
MA 100,a,196,v,168
ds_read_b128 a[152:155], v10 offset:6144
v_lshl_add_u32 v250, v250, 5, v249
MA 96,a,192,v,168
v_cmp_gt_i32_e64 s[90:91], 3, v246
TR 104,250,0
MA 0,a,224,v,176
v_exp_f32 v85, v85
MA 32,a,224,v,184
ds_read_b128 a[156:159], v10 offset:7168
TR 106,250,4096
MA 4,a,228,v,176
v_cvt_pk_bf16_f32 v81, v82, v83
v_xor_b32 v250, 3, v248
MA 36,a,228,v,184
v_cndmask_b32_e64 v112, v112, v14, s[84:85]
v_lshl_add_u32 v250, v250, 5, v249
MA 8,a,232,v,176
ds_read_b128 a[160:163], v10 offset:8192
TR 108,250,0
MA 40,a,232,v,184
TR 110,250,4096
v_xor_b32 v250, 4, v248
MA 12,a,236,v,176
v_exp_f32 v86, v86
MA 44,a,236,v,184
ds_read_b128 a[164:167], v10 offset:9216
v_lshl_add_u32 v250, v250, 5, v249
MA 16,a,240,v,176
buffer_load_dwordx4 v12, s[52:55], s71 offen offset:2048 sc1 lds
v_cndmask_b32_e64 v113, v113, v14, s[86:87]
MA 48,a,240,v,184
TR 128,250,0
TR 130,250,4096
MA 20,a,244,v,176
v_exp_f32 v87, v87
MA 52,a,244,v,184
ds_read_b128 a[168:171], v10 offset:10240
v_xor_b32 v250, 5, v248
MA 24,a,248,v,176
v_cvt_pk_bf16_f32 v82, v84, v85
v_cndmask_b32_e64 v114, v114, v14, s[88:89]
MA 56,a,248,v,184
v_lshl_add_u32 v250, v250, 5, v249
TR 132,250,0
MA 28,a,252,v,176
v_cndmask_b32_e64 v115, v115, v14, s[90:91]
TR 134,250,4096
MA 60,a,252,v,184
v_exp_f32 v88, v88
MA 124,a,252,v,200
ds_read_b128 a[172:175], v10 offset:11264
v_xor_b32 v250, 6, v248
MA 120,a,248,v,200
v_lshl_add_u32 v250, v250, 5, v249
TR 136,250,0
MA 116,a,244,v,200
ds_read_b128 a[176:179], v10 offset:12288
TR 138,250,4096
MA 112,a,240,v,200
v_exp_f32 v89, v89
MA 108,a,236,v,200
v_add_u32 v247, -48, v13
v_xor_b32 v250, 7, v248
MA 104,a,232,v,200
v_cvt_pk_bf16_f32 v83, v86, v87
v_lshl_add_u32 v250, v250, 5, v249
MA 100,a,228,v,200
ds_read_b128 a[180:183], v10 offset:13312
TR 140,250,0
MA 96,a,224,v,200
ds_read_b128 a[184:187], v10 offset:14336
ds_read_b128 a[188:191], v10 offset:15360
buffer_load_dwordx4 v12, s[52:55], s71 offen offset:3072 sc1 lds
s_xor_b32 s72, s72, 0x8000
v_exp_f32 v90, v90
v_cmp_gt_i32_e64 s[92:93], 0, v247
TR 142,250,4096
s_add_u32 s32, s40, 100663296
s_addc_u32 s33, s41, 0
v_exp_f32 v91, v91
v_cmp_gt_i32_e64 s[94:95], 1, v247
s_mov_b32 s34, 8388608
s_mov_b32 s35, 0x20000
s_and_b32 s36, s2, 7
s_lshl_b32 s36, s36, 20
s_lshr_b32 s37, s2, 3
v_cvt_pk_bf16_f32 v88, v88, v89
v_cmp_gt_i32_e64 s[96:97], 2, v247
s_lshl_b32 s37, s37, 15
v_exp_f32 v92, v92
s_add_u32 s36, s36, s37
s_lshl_b32 s37, s3, 12
v_cmp_gt_i32_e64 s[98:99], 3, v247
s_add_u32 s36, s36, s37
v_exp_f32 v93, v93
s_add_u32 s37, s36, 4096
s_waitcnt lgkmcnt(15)
buffer_store_dwordx4 v[96:99], v12, s[32:35], s36 offen offset:0 sc1
v_cndmask_b32_e64 v116, v116, v14, s[92:93]
buffer_store_dwordx4 v[100:103], v12, s[32:35], s36 offen offset:1024 sc1
v_cvt_pk_bf16_f32 v89, v90, v91
buffer_store_dwordx4 v[104:107], v12, s[32:35], s36 offen offset:2048 sc1
buffer_store_dwordx4 v[108:111], v12, s[32:35], s36 offen offset:3072 sc1
s_waitcnt lgkmcnt(12)
buffer_store_dwordx4 v[128:131], v12, s[32:35], s37 offen offset:0 sc1
v_exp_f32 v94, v94
v_cndmask_b32_e64 v117, v117, v14, s[94:95]
s_waitcnt lgkmcnt(9)
buffer_store_dwordx4 v[132:135], v12, s[32:35], s37 offen offset:1024 sc1
s_waitcnt lgkmcnt(5)
buffer_store_dwordx4 v[136:139], v12, s[32:35], s37 offen offset:2048 sc1
s_waitcnt lgkmcnt(0)
buffer_store_dwordx4 v[140:143], v12, s[32:35], s37 offen offset:3072 sc1
v_exp_f32 v95, v95
v_cndmask_b32_e64 v118, v118, v14, s[96:97]
v_lshlrev_b32 v232, 4, v1
v_mov_b32 v235, 0
buffer_load_ushort v234, v235, s[28:31], s42 offen
v_cvt_pk_bf16_f32 v90, v92, v93
v_cndmask_b32_e64 v119, v119, v14, s[98:99]
buffer_load_dwordx4 v[210:213], v232, s[16:19], 0 offen offset:0
buffer_load_dwordx4 v[216:219], v232, s[16:19], 0 offen offset:1024
v_cvt_pk_bf16_f32 v91, v94, v95
buffer_load_dwordx4 v[222:225], v232, s[16:19], 0 offen offset:2048
buffer_load_dwordx4 v[228:231], v232, s[16:19], 0 offen offset:3072
s_branch L_p3_eps
L_fallback:
s_mov_b32 s81, 0
s_mov_b32 s74, s77
s_mov_b32 s73, s100
s_sub_u32 s72, 15, s70
v_mov_b32 v10, v15
v_add_u32 v11, 16384, v15
s_nop 15
L_fb_set:
s_lshl_b32 s72, s72, 7
s_mov_b32 s71, 0
v_accvgpr_write_b32 a0, 0
v_accvgpr_write_b32 a1, 0
v_accvgpr_write_b32 a2, 0
v_accvgpr_write_b32 a3, 0
v_accvgpr_write_b32 a4, 0
v_accvgpr_write_b32 a5, 0
v_accvgpr_write_b32 a6, 0
v_accvgpr_write_b32 a7, 0
v_accvgpr_write_b32 a8, 0
v_accvgpr_write_b32 a9, 0
v_accvgpr_write_b32 a10, 0
v_accvgpr_write_b32 a11, 0
v_accvgpr_write_b32 a12, 0
v_accvgpr_write_b32 a13, 0
v_accvgpr_write_b32 a14, 0
v_accvgpr_write_b32 a15, 0
v_accvgpr_write_b32 a16, 0
v_accvgpr_write_b32 a17, 0
v_accvgpr_write_b32 a18, 0
v_accvgpr_write_b32 a19, 0
v_accvgpr_write_b32 a20, 0
v_accvgpr_write_b32 a21, 0
v_accvgpr_write_b32 a22, 0
v_accvgpr_write_b32 a23, 0
v_accvgpr_write_b32 a24, 0
v_accvgpr_write_b32 a25, 0
v_accvgpr_write_b32 a26, 0
v_accvgpr_write_b32 a27, 0
v_accvgpr_write_b32 a28, 0
v_accvgpr_write_b32 a29, 0
v_accvgpr_write_b32 a30, 0
v_accvgpr_write_b32 a31, 0
v_accvgpr_write_b32 a32, 0
v_accvgpr_write_b32 a33, 0
v_accvgpr_write_b32 a34, 0
v_accvgpr_write_b32 a35, 0
v_accvgpr_write_b32 a36, 0
v_accvgpr_write_b32 a37, 0
v_accvgpr_write_b32 a38, 0
v_accvgpr_write_b32 a39, 0
v_accvgpr_write_b32 a40, 0
v_accvgpr_write_b32 a41, 0
v_accvgpr_write_b32 a42, 0
v_accvgpr_write_b32 a43, 0
v_accvgpr_write_b32 a44, 0
v_accvgpr_write_b32 a45, 0
v_accvgpr_write_b32 a46, 0
v_accvgpr_write_b32 a47, 0
v_accvgpr_write_b32 a48, 0
v_accvgpr_write_b32 a49, 0
v_accvgpr_write_b32 a50, 0
v_accvgpr_write_b32 a51, 0
v_accvgpr_write_b32 a52, 0
v_accvgpr_write_b32 a53, 0
v_accvgpr_write_b32 a54, 0
v_accvgpr_write_b32 a55, 0
v_accvgpr_write_b32 a56, 0
v_accvgpr_write_b32 a57, 0
v_accvgpr_write_b32 a58, 0
v_accvgpr_write_b32 a59, 0
v_accvgpr_write_b32 a60, 0
v_accvgpr_write_b32 a61, 0
v_accvgpr_write_b32 a62, 0
v_accvgpr_write_b32 a63, 0
v_mov_b32 v2, 0
v_mov_b32 v96, v14
v_mov_b32 v3, 0
v_mov_b32 v97, v14
L_fb_tile:
s_waitcnt vmcnt(0) lgkmcnt(0)
s_barrier
s_mov_b32 m0, s68
s_add_u32 s80, s71, 16384
buffer_load_dwordx4 v12, s[52:55], s71 offen offset:0 sc1 lds
buffer_load_dwordx4 v12, s[52:55], s71 offen offset:1024 sc1 lds
buffer_load_dwordx4 v12, s[52:55], s71 offen offset:2048 sc1 lds
buffer_load_dwordx4 v12, s[52:55], s71 offen offset:3072 sc1 lds
s_add_u32 m0, s68, 16384
s_nop 0
buffer_load_dwordx4 v12, s[56:59], s80 offen offset:0 sc1 lds
buffer_load_dwordx4 v12, s[56:59], s80 offen offset:1024 sc1 lds
buffer_load_dwordx4 v12, s[56:59], s80 offen offset:2048 sc1 lds
buffer_load_dwordx4 v12, s[56:59], s80 offen offset:3072 sc1 lds
s_waitcnt vmcnt(0)
s_barrier
ds_read_b128 a[128:131], v10 offset:0
ds_read_b128 a[132:135], v10 offset:1024
ds_read_b128 a[136:139], v10 offset:2048
ds_read_b128 a[140:143], v10 offset:3072
ds_read_b128 a[144:147], v10 offset:4096
ds_read_b128 a[148:151], v10 offset:5120
ds_read_b128 a[152:155], v10 offset:6144
ds_read_b128 a[156:159], v10 offset:7168
ds_read_b128 a[160:163], v10 offset:8192
ds_read_b128 a[164:167], v10 offset:9216
ds_read_b128 a[168:171], v10 offset:10240
ds_read_b128 a[172:175], v10 offset:11264
ds_read_b128 a[176:179], v10 offset:12288
ds_read_b128 a[180:183], v10 offset:13312
ds_read_b128 a[184:187], v10 offset:14336
ds_read_b128 a[188:191], v10 offset:15360
s_waitcnt lgkmcnt(0)
ds_read_b128 a[192:195], v11 offset:0
ds_read_b128 a[196:199], v11 offset:1024
ds_read_b128 a[200:203], v11 offset:2048
ds_read_b128 a[204:207], v11 offset:3072
ds_read_b128 a[208:211], v11 offset:4096
ds_read_b128 a[212:215], v11 offset:5120
ds_read_b128 a[216:219], v11 offset:6144
ds_read_b128 a[220:223], v11 offset:7168
ds_read_b128 a[224:227], v11 offset:8192
ds_read_b128 a[228:231], v11 offset:9216
ds_read_b128 a[232:235], v11 offset:10240
ds_read_b128 a[236:239], v11 offset:11264
ds_read_b128 a[240:243], v11 offset:12288
ds_read_b128 a[244:247], v11 offset:13312
ds_read_b128 a[248:251], v11 offset:14336
ds_read_b128 a[252:255], v11 offset:15360
v_mfma_f32_16x16x32_bf16 v[80:83], a[128:131], v[16:19], 0
v_mfma_f32_16x16x32_bf16 v[88:91], a[128:131], v[32:35], 0
MV 80,a,132,v,20
MV 88,a,132,v,36
MV 80,a,136,v,24
MV 88,a,136,v,40
MV 80,a,140,v,28
MV 88,a,140,v,44
v_mfma_f32_16x16x32_bf16 v[84:87], a[144:147], v[16:19], 0
v_mfma_f32_16x16x32_bf16 v[92:95], a[144:147], v[32:35], 0
MV 84,a,148,v,20
MV 92,a,148,v,36
MV 84,a,152,v,24
MV 92,a,152,v,40
MV 84,a,156,v,28
MV 92,a,156,v,44
v_mfma_f32_16x16x32_bf16 v[112:115], a[160:163], v[16:19], 0
v_mfma_f32_16x16x32_bf16 v[120:123], a[160:163], v[32:35], 0
MV 112,a,164,v,20
MV 120,a,164,v,36
MV 112,a,168,v,24
MV 120,a,168,v,40
MV 112,a,172,v,28
MV 120,a,172,v,44
v_mfma_f32_16x16x32_bf16 v[116:119], a[176:179], v[16:19], 0
v_mfma_f32_16x16x32_bf16 v[124:127], a[176:179], v[32:35], 0
MV 116,a,180,v,20
MV 124,a,180,v,36
MV 116,a,184,v,24
MV 124,a,184,v,40
MV 116,a,188,v,28
MV 124,a,188,v,44
v_add_u32 v246, s72, v13
v_add_u32 v246, 0, v246
v_cmp_gt_i32_e64 s[84:85], 0, v246
v_cmp_gt_i32_e64 s[86:87], 1, v246
v_cmp_gt_i32_e64 s[88:89], 2, v246
v_cmp_gt_i32_e64 s[90:91], 3, v246
v_cndmask_b32_e64 v80, v80, v14, s[84:85]
v_cndmask_b32_e64 v81, v81, v14, s[86:87]
v_cndmask_b32_e64 v82, v82, v14, s[88:89]
v_cndmask_b32_e64 v83, v83, v14, s[90:91]
v_add_u32 v247, s72, v239
v_add_u32 v247, 0, v247
v_cmp_gt_i32_e64 s[92:93], 0, v247
v_cmp_gt_i32_e64 s[94:95], 1, v247
v_cmp_gt_i32_e64 s[96:97], 2, v247
v_cmp_gt_i32_e64 s[98:99], 3, v247
v_cndmask_b32_e64 v88, v88, v14, s[92:93]
v_cndmask_b32_e64 v89, v89, v14, s[94:95]
v_cndmask_b32_e64 v90, v90, v14, s[96:97]
v_cndmask_b32_e64 v91, v91, v14, s[98:99]
v_add_u32 v246, s72, v13
v_add_u32 v246, -16, v246
v_cmp_gt_i32_e64 s[84:85], 0, v246
v_cmp_gt_i32_e64 s[86:87], 1, v246
v_cmp_gt_i32_e64 s[88:89], 2, v246
v_cmp_gt_i32_e64 s[90:91], 3, v246
v_cndmask_b32_e64 v84, v84, v14, s[84:85]
v_cndmask_b32_e64 v85, v85, v14, s[86:87]
v_cndmask_b32_e64 v86, v86, v14, s[88:89]
v_cndmask_b32_e64 v87, v87, v14, s[90:91]
v_add_u32 v247, s72, v239
v_add_u32 v247, -16, v247
v_cmp_gt_i32_e64 s[92:93], 0, v247
v_cmp_gt_i32_e64 s[94:95], 1, v247
v_cmp_gt_i32_e64 s[96:97], 2, v247
v_cmp_gt_i32_e64 s[98:99], 3, v247
v_cndmask_b32_e64 v92, v92, v14, s[92:93]
v_cndmask_b32_e64 v93, v93, v14, s[94:95]
v_cndmask_b32_e64 v94, v94, v14, s[96:97]
v_cndmask_b32_e64 v95, v95, v14, s[98:99]
v_add_u32 v246, s72, v13
v_add_u32 v246, -32, v246
v_cmp_gt_i32_e64 s[84:85], 0, v246
v_cmp_gt_i32_e64 s[86:87], 1, v246
v_cmp_gt_i32_e64 s[88:89], 2, v246
v_cmp_gt_i32_e64 s[90:91], 3, v246
v_cndmask_b32_e64 v112, v112, v14, s[84:85]
v_cndmask_b32_e64 v113, v113, v14, s[86:87]
v_cndmask_b32_e64 v114, v114, v14, s[88:89]
v_cndmask_b32_e64 v115, v115, v14, s[90:91]
v_add_u32 v247, s72, v239
v_add_u32 v247, -32, v247
v_cmp_gt_i32_e64 s[92:93], 0, v247
v_cmp_gt_i32_e64 s[94:95], 1, v247
v_cmp_gt_i32_e64 s[96:97], 2, v247
v_cmp_gt_i32_e64 s[98:99], 3, v247
v_cndmask_b32_e64 v120, v120, v14, s[92:93]
v_cndmask_b32_e64 v121, v121, v14, s[94:95]
v_cndmask_b32_e64 v122, v122, v14, s[96:97]
v_cndmask_b32_e64 v123, v123, v14, s[98:99]
v_add_u32 v246, s72, v13
v_add_u32 v246, -48, v246
v_cmp_gt_i32_e64 s[84:85], 0, v246
v_cmp_gt_i32_e64 s[86:87], 1, v246
v_cmp_gt_i32_e64 s[88:89], 2, v246
v_cmp_gt_i32_e64 s[90:91], 3, v246
v_cndmask_b32_e64 v116, v116, v14, s[84:85]
v_cndmask_b32_e64 v117, v117, v14, s[86:87]
v_cndmask_b32_e64 v118, v118, v14, s[88:89]
v_cndmask_b32_e64 v119, v119, v14, s[90:91]
v_add_u32 v247, s72, v239
v_add_u32 v247, -48, v247
v_cmp_gt_i32_e64 s[92:93], 0, v247
v_cmp_gt_i32_e64 s[94:95], 1, v247
v_cmp_gt_i32_e64 s[96:97], 2, v247
v_cmp_gt_i32_e64 s[98:99], 3, v247
v_cndmask_b32_e64 v124, v124, v14, s[92:93]
v_cndmask_b32_e64 v125, v125, v14, s[94:95]
v_cndmask_b32_e64 v126, v126, v14, s[96:97]
v_cndmask_b32_e64 v127, v127, v14, s[98:99]
v_mov_b32 v242, v96
v_max3_f32 v242, v242, v80, v81
v_max3_f32 v242, v242, v82, v83
v_max3_f32 v242, v242, v84, v85
v_max3_f32 v242, v242, v86, v87
v_max3_f32 v242, v242, v112, v113
v_max3_f32 v242, v242, v114, v115
v_max3_f32 v242, v242, v116, v117
v_max3_f32 v242, v242, v118, v119
v_mov_b32 v243, v242
s_nop 1
v_permlane32_swap_b32 v242, v243
v_max_f32 v242, v242, v243
v_mov_b32 v243, v242
s_nop 1
v_permlane16_swap_b32 v242, v243
v_max_f32 v242, v242, v243
v_sub_f32 v98, v96, v242
v_exp_f32 v98, v98
v_mov_b32 v96, v242
v_sub_f32 v80, v80, v242
v_sub_f32 v81, v81, v242
v_sub_f32 v82, v82, v242
v_sub_f32 v83, v83, v242
v_sub_f32 v84, v84, v242
v_sub_f32 v85, v85, v242
v_sub_f32 v86, v86, v242
v_sub_f32 v87, v87, v242
v_sub_f32 v112, v112, v242
v_sub_f32 v113, v113, v242
v_sub_f32 v114, v114, v242
v_sub_f32 v115, v115, v242
v_sub_f32 v116, v116, v242
v_sub_f32 v117, v117, v242
v_sub_f32 v118, v118, v242
v_sub_f32 v119, v119, v242
v_mul_f32 v2, v2, v98
v_accvgpr_read_b32 v243, a0
v_mul_f32 v243, v243, v98
v_accvgpr_write_b32 a0, v243
v_accvgpr_read_b32 v243, a1
v_mul_f32 v243, v243, v98
v_accvgpr_write_b32 a1, v243
v_accvgpr_read_b32 v243, a2
v_mul_f32 v243, v243, v98
v_accvgpr_write_b32 a2, v243
v_accvgpr_read_b32 v243, a3
v_mul_f32 v243, v243, v98
v_accvgpr_write_b32 a3, v243
v_accvgpr_read_b32 v243, a4
v_mul_f32 v243, v243, v98
v_accvgpr_write_b32 a4, v243
v_accvgpr_read_b32 v243, a5
v_mul_f32 v243, v243, v98
v_accvgpr_write_b32 a5, v243
v_accvgpr_read_b32 v243, a6
v_mul_f32 v243, v243, v98
v_accvgpr_write_b32 a6, v243
v_accvgpr_read_b32 v243, a7
v_mul_f32 v243, v243, v98
v_accvgpr_write_b32 a7, v243
v_accvgpr_read_b32 v243, a8
v_mul_f32 v243, v243, v98
v_accvgpr_write_b32 a8, v243
v_accvgpr_read_b32 v243, a9
v_mul_f32 v243, v243, v98
v_accvgpr_write_b32 a9, v243
v_accvgpr_read_b32 v243, a10
v_mul_f32 v243, v243, v98
v_accvgpr_write_b32 a10, v243
v_accvgpr_read_b32 v243, a11
v_mul_f32 v243, v243, v98
v_accvgpr_write_b32 a11, v243
v_accvgpr_read_b32 v243, a12
v_mul_f32 v243, v243, v98
v_accvgpr_write_b32 a12, v243
v_accvgpr_read_b32 v243, a13
v_mul_f32 v243, v243, v98
v_accvgpr_write_b32 a13, v243
v_accvgpr_read_b32 v243, a14
v_mul_f32 v243, v243, v98
v_accvgpr_write_b32 a14, v243
v_accvgpr_read_b32 v243, a15
v_mul_f32 v243, v243, v98
v_accvgpr_write_b32 a15, v243
v_accvgpr_read_b32 v243, a16
v_mul_f32 v243, v243, v98
v_accvgpr_write_b32 a16, v243
v_accvgpr_read_b32 v243, a17
v_mul_f32 v243, v243, v98
v_accvgpr_write_b32 a17, v243
v_accvgpr_read_b32 v243, a18
v_mul_f32 v243, v243, v98
v_accvgpr_write_b32 a18, v243
v_accvgpr_read_b32 v243, a19
v_mul_f32 v243, v243, v98
v_accvgpr_write_b32 a19, v243
v_accvgpr_read_b32 v243, a20
v_mul_f32 v243, v243, v98
v_accvgpr_write_b32 a20, v243
v_accvgpr_read_b32 v243, a21
v_mul_f32 v243, v243, v98
v_accvgpr_write_b32 a21, v243
v_accvgpr_read_b32 v243, a22
v_mul_f32 v243, v243, v98
v_accvgpr_write_b32 a22, v243
v_accvgpr_read_b32 v243, a23
v_mul_f32 v243, v243, v98
v_accvgpr_write_b32 a23, v243
v_accvgpr_read_b32 v243, a24
v_mul_f32 v243, v243, v98
v_accvgpr_write_b32 a24, v243
v_accvgpr_read_b32 v243, a25
v_mul_f32 v243, v243, v98
v_accvgpr_write_b32 a25, v243
v_accvgpr_read_b32 v243, a26
v_mul_f32 v243, v243, v98
v_accvgpr_write_b32 a26, v243
v_accvgpr_read_b32 v243, a27
v_mul_f32 v243, v243, v98
v_accvgpr_write_b32 a27, v243
v_accvgpr_read_b32 v243, a28
v_mul_f32 v243, v243, v98
v_accvgpr_write_b32 a28, v243
v_accvgpr_read_b32 v243, a29
v_mul_f32 v243, v243, v98
v_accvgpr_write_b32 a29, v243
v_accvgpr_read_b32 v243, a30
v_mul_f32 v243, v243, v98
v_accvgpr_write_b32 a30, v243
v_accvgpr_read_b32 v243, a31
v_mul_f32 v243, v243, v98
v_accvgpr_write_b32 a31, v243
v_mov_b32 v242, v97
v_max3_f32 v242, v242, v88, v89
v_max3_f32 v242, v242, v90, v91
v_max3_f32 v242, v242, v92, v93
v_max3_f32 v242, v242, v94, v95
v_max3_f32 v242, v242, v120, v121
v_max3_f32 v242, v242, v122, v123
v_max3_f32 v242, v242, v124, v125
v_max3_f32 v242, v242, v126, v127
v_mov_b32 v243, v242
s_nop 1
v_permlane32_swap_b32 v242, v243
v_max_f32 v242, v242, v243
v_mov_b32 v243, v242
s_nop 1
v_permlane16_swap_b32 v242, v243
v_max_f32 v242, v242, v243
v_sub_f32 v99, v97, v242
v_exp_f32 v99, v99
v_mov_b32 v97, v242
v_sub_f32 v88, v88, v242
v_sub_f32 v89, v89, v242
v_sub_f32 v90, v90, v242
v_sub_f32 v91, v91, v242
v_sub_f32 v92, v92, v242
v_sub_f32 v93, v93, v242
v_sub_f32 v94, v94, v242
v_sub_f32 v95, v95, v242
v_sub_f32 v120, v120, v242
v_sub_f32 v121, v121, v242
v_sub_f32 v122, v122, v242
v_sub_f32 v123, v123, v242
v_sub_f32 v124, v124, v242
v_sub_f32 v125, v125, v242
v_sub_f32 v126, v126, v242
v_sub_f32 v127, v127, v242
v_mul_f32 v3, v3, v99
v_accvgpr_read_b32 v243, a32
v_mul_f32 v243, v243, v99
v_accvgpr_write_b32 a32, v243
v_accvgpr_read_b32 v243, a33
v_mul_f32 v243, v243, v99
v_accvgpr_write_b32 a33, v243
v_accvgpr_read_b32 v243, a34
v_mul_f32 v243, v243, v99
v_accvgpr_write_b32 a34, v243
v_accvgpr_read_b32 v243, a35
v_mul_f32 v243, v243, v99
v_accvgpr_write_b32 a35, v243
v_accvgpr_read_b32 v243, a36
v_mul_f32 v243, v243, v99
v_accvgpr_write_b32 a36, v243
v_accvgpr_read_b32 v243, a37
v_mul_f32 v243, v243, v99
v_accvgpr_write_b32 a37, v243
v_accvgpr_read_b32 v243, a38
v_mul_f32 v243, v243, v99
v_accvgpr_write_b32 a38, v243
v_accvgpr_read_b32 v243, a39
v_mul_f32 v243, v243, v99
v_accvgpr_write_b32 a39, v243
v_accvgpr_read_b32 v243, a40
v_mul_f32 v243, v243, v99
v_accvgpr_write_b32 a40, v243
v_accvgpr_read_b32 v243, a41
v_mul_f32 v243, v243, v99
v_accvgpr_write_b32 a41, v243
v_accvgpr_read_b32 v243, a42
v_mul_f32 v243, v243, v99
v_accvgpr_write_b32 a42, v243
v_accvgpr_read_b32 v243, a43
v_mul_f32 v243, v243, v99
v_accvgpr_write_b32 a43, v243
v_accvgpr_read_b32 v243, a44
v_mul_f32 v243, v243, v99
v_accvgpr_write_b32 a44, v243
v_accvgpr_read_b32 v243, a45
v_mul_f32 v243, v243, v99
v_accvgpr_write_b32 a45, v243
v_accvgpr_read_b32 v243, a46
v_mul_f32 v243, v243, v99
v_accvgpr_write_b32 a46, v243
v_accvgpr_read_b32 v243, a47
v_mul_f32 v243, v243, v99
v_accvgpr_write_b32 a47, v243
v_accvgpr_read_b32 v243, a48
v_mul_f32 v243, v243, v99
v_accvgpr_write_b32 a48, v243
v_accvgpr_read_b32 v243, a49
v_mul_f32 v243, v243, v99
v_accvgpr_write_b32 a49, v243
v_accvgpr_read_b32 v243, a50
v_mul_f32 v243, v243, v99
v_accvgpr_write_b32 a50, v243
v_accvgpr_read_b32 v243, a51
v_mul_f32 v243, v243, v99
v_accvgpr_write_b32 a51, v243
v_accvgpr_read_b32 v243, a52
v_mul_f32 v243, v243, v99
v_accvgpr_write_b32 a52, v243
v_accvgpr_read_b32 v243, a53
v_mul_f32 v243, v243, v99
v_accvgpr_write_b32 a53, v243
v_accvgpr_read_b32 v243, a54
v_mul_f32 v243, v243, v99
v_accvgpr_write_b32 a54, v243
v_accvgpr_read_b32 v243, a55
v_mul_f32 v243, v243, v99
v_accvgpr_write_b32 a55, v243
v_accvgpr_read_b32 v243, a56
v_mul_f32 v243, v243, v99
v_accvgpr_write_b32 a56, v243
v_accvgpr_read_b32 v243, a57
v_mul_f32 v243, v243, v99
v_accvgpr_write_b32 a57, v243
v_accvgpr_read_b32 v243, a58
v_mul_f32 v243, v243, v99
v_accvgpr_write_b32 a58, v243
v_accvgpr_read_b32 v243, a59
v_mul_f32 v243, v243, v99
v_accvgpr_write_b32 a59, v243
v_accvgpr_read_b32 v243, a60
v_mul_f32 v243, v243, v99
v_accvgpr_write_b32 a60, v243
v_accvgpr_read_b32 v243, a61
v_mul_f32 v243, v243, v99
v_accvgpr_write_b32 a61, v243
v_accvgpr_read_b32 v243, a62
v_mul_f32 v243, v243, v99
v_accvgpr_write_b32 a62, v243
v_accvgpr_read_b32 v243, a63
v_mul_f32 v243, v243, v99
v_accvgpr_write_b32 a63, v243
v_exp_f32 v80, v80
v_exp_f32 v81, v81
v_exp_f32 v82, v82
v_add_f32 v2, v2, v80
v_add_f32 v2, v2, v81
v_exp_f32 v83, v83
v_cvt_pk_bf16_f32 v80, v80, v81
v_exp_f32 v84, v84
v_add_f32 v2, v2, v82
v_add_f32 v2, v2, v83
v_exp_f32 v85, v85
v_cvt_pk_bf16_f32 v81, v82, v83
v_exp_f32 v86, v86
v_add_f32 v2, v2, v84
v_add_f32 v2, v2, v85
v_exp_f32 v87, v87
v_cvt_pk_bf16_f32 v82, v84, v85
v_exp_f32 v88, v88
v_add_f32 v2, v2, v86
v_add_f32 v2, v2, v87
v_exp_f32 v89, v89
v_cvt_pk_bf16_f32 v83, v86, v87
v_exp_f32 v90, v90
v_add_f32 v3, v3, v88
v_add_f32 v3, v3, v89
v_exp_f32 v91, v91
v_cvt_pk_bf16_f32 v88, v88, v89
v_exp_f32 v92, v92
v_add_f32 v3, v3, v90
v_add_f32 v3, v3, v91
v_exp_f32 v93, v93
v_cvt_pk_bf16_f32 v89, v90, v91
v_exp_f32 v94, v94
v_add_f32 v3, v3, v92
v_add_f32 v3, v3, v93
v_exp_f32 v95, v95
v_cvt_pk_bf16_f32 v90, v92, v93
v_exp_f32 v112, v112
v_add_f32 v3, v3, v94
v_add_f32 v3, v3, v95
v_exp_f32 v113, v113
v_cvt_pk_bf16_f32 v91, v94, v95
v_exp_f32 v114, v114
v_add_f32 v2, v2, v112
v_add_f32 v2, v2, v113
v_exp_f32 v115, v115
v_cvt_pk_bf16_f32 v112, v112, v113
v_exp_f32 v116, v116
v_add_f32 v2, v2, v114
v_add_f32 v2, v2, v115
v_exp_f32 v117, v117
v_cvt_pk_bf16_f32 v113, v114, v115
v_exp_f32 v118, v118
v_add_f32 v2, v2, v116
v_add_f32 v2, v2, v117
v_exp_f32 v119, v119
v_cvt_pk_bf16_f32 v114, v116, v117
v_exp_f32 v120, v120
v_add_f32 v2, v2, v118
v_add_f32 v2, v2, v119
v_exp_f32 v121, v121
v_cvt_pk_bf16_f32 v115, v118, v119
v_exp_f32 v122, v122
v_add_f32 v3, v3, v120
v_add_f32 v3, v3, v121
v_exp_f32 v123, v123
v_cvt_pk_bf16_f32 v120, v120, v121
v_exp_f32 v124, v124
v_add_f32 v3, v3, v122
v_add_f32 v3, v3, v123
v_exp_f32 v125, v125
v_cvt_pk_bf16_f32 v121, v122, v123
v_exp_f32 v126, v126
v_add_f32 v3, v3, v124
v_add_f32 v3, v3, v125
v_exp_f32 v127, v127
v_cvt_pk_bf16_f32 v122, v124, v125
v_add_f32 v3, v3, v126
v_add_f32 v3, v3, v127
v_cvt_pk_bf16_f32 v123, v126, v127
s_waitcnt lgkmcnt(15)
MA 0,a,192,v,80
MA 32,a,192,v,88
s_waitcnt lgkmcnt(14)
MA 4,a,196,v,80
MA 36,a,196,v,88
s_waitcnt lgkmcnt(13)
MA 8,a,200,v,80
MA 40,a,200,v,88
s_waitcnt lgkmcnt(12)
MA 12,a,204,v,80
MA 44,a,204,v,88
s_waitcnt lgkmcnt(11)
MA 16,a,208,v,80
MA 48,a,208,v,88
s_waitcnt lgkmcnt(10)
MA 20,a,212,v,80
MA 52,a,212,v,88
s_waitcnt lgkmcnt(9)
MA 24,a,216,v,80
MA 56,a,216,v,88
s_waitcnt lgkmcnt(8)
MA 28,a,220,v,80
MA 60,a,220,v,88
s_waitcnt lgkmcnt(7)
MA 0,a,224,v,112
MA 32,a,224,v,120
s_waitcnt lgkmcnt(6)
MA 4,a,228,v,112
MA 36,a,228,v,120
s_waitcnt lgkmcnt(5)
MA 8,a,232,v,112
MA 40,a,232,v,120
s_waitcnt lgkmcnt(4)
MA 12,a,236,v,112
MA 44,a,236,v,120
s_waitcnt lgkmcnt(3)
MA 16,a,240,v,112
MA 48,a,240,v,120
s_waitcnt lgkmcnt(2)
MA 20,a,244,v,112
MA 52,a,244,v,120
s_waitcnt lgkmcnt(1)
MA 24,a,248,v,112
MA 56,a,248,v,120
s_waitcnt lgkmcnt(0)
MA 28,a,252,v,112
MA 60,a,252,v,120
s_add_u32 s71, s71, 16384
s_sub_u32 s72, s72, 64
s_sub_u32 s74, s74, 1
s_nop 15
s_cmp_lg_u32 s74, 0
s_cbranch_scc1 L_fb_tile
v_mov_b32 v240, v2
s_nop 1
v_permlane32_swap_b32 v2, v240
v_add_f32 v2, v2, v240
v_mov_b32 v240, v2
s_nop 1
v_permlane16_swap_b32 v2, v240
v_add_f32 v2, v2, v240
v_mov_b32 v240, v3
s_nop 1
v_permlane32_swap_b32 v3, v240
v_add_f32 v3, v3, v240
v_mov_b32 v240, v3
s_nop 1
v_permlane16_swap_b32 v3, v240
v_add_f32 v3, v3, v240
v_rcp_f32 v2, v2
v_rcp_f32 v3, v3
s_add_u32 s80, s73, s76
s_nop 4
v_accvgpr_read_b32 v240, a0
v_accvgpr_read_b32 v241, a1
v_accvgpr_read_b32 v242, a2
v_accvgpr_read_b32 v243, a3
v_accvgpr_read_b32 v244, a4
v_accvgpr_read_b32 v245, a5
v_accvgpr_read_b32 v246, a6
v_accvgpr_read_b32 v247, a7
v_pk_mul_f32 v[240:241], v[240:241], v[2:3] op_sel:[0,0] op_sel_hi:[1,0]
v_pk_mul_f32 v[242:243], v[242:243], v[2:3] op_sel:[0,0] op_sel_hi:[1,0]
v_pk_mul_f32 v[244:245], v[244:245], v[2:3] op_sel:[0,0] op_sel_hi:[1,0]
v_pk_mul_f32 v[246:247], v[246:247], v[2:3] op_sel:[0,0] op_sel_hi:[1,0]
v_cvt_pk_bf16_f32 v248, v240, v241
v_cvt_pk_bf16_f32 v249, v242, v243
v_cvt_pk_bf16_f32 v250, v244, v245
v_cvt_pk_bf16_f32 v251, v246, v247
buffer_store_dwordx4 v[248:251], v15, s[60:63], s73 offen offset:0 sc1
v_accvgpr_read_b32 v240, a8
v_accvgpr_read_b32 v241, a9
v_accvgpr_read_b32 v242, a10
v_accvgpr_read_b32 v243, a11
v_accvgpr_read_b32 v244, a12
v_accvgpr_read_b32 v245, a13
v_accvgpr_read_b32 v246, a14
v_accvgpr_read_b32 v247, a15
v_pk_mul_f32 v[240:241], v[240:241], v[2:3] op_sel:[0,0] op_sel_hi:[1,0]
v_pk_mul_f32 v[242:243], v[242:243], v[2:3] op_sel:[0,0] op_sel_hi:[1,0]
v_pk_mul_f32 v[244:245], v[244:245], v[2:3] op_sel:[0,0] op_sel_hi:[1,0]
v_pk_mul_f32 v[246:247], v[246:247], v[2:3] op_sel:[0,0] op_sel_hi:[1,0]
v_cvt_pk_bf16_f32 v252, v240, v241
v_cvt_pk_bf16_f32 v253, v242, v243
v_cvt_pk_bf16_f32 v254, v244, v245
v_cvt_pk_bf16_f32 v255, v246, v247
buffer_store_dwordx4 v[252:255], v15, s[60:63], s73 offen offset:1024 sc1
v_accvgpr_read_b32 v240, a16
v_accvgpr_read_b32 v241, a17
v_accvgpr_read_b32 v242, a18
v_accvgpr_read_b32 v243, a19
v_accvgpr_read_b32 v244, a20
v_accvgpr_read_b32 v245, a21
v_accvgpr_read_b32 v246, a22
v_accvgpr_read_b32 v247, a23
v_pk_mul_f32 v[240:241], v[240:241], v[2:3] op_sel:[0,0] op_sel_hi:[1,0]
v_pk_mul_f32 v[242:243], v[242:243], v[2:3] op_sel:[0,0] op_sel_hi:[1,0]
v_pk_mul_f32 v[244:245], v[244:245], v[2:3] op_sel:[0,0] op_sel_hi:[1,0]
v_pk_mul_f32 v[246:247], v[246:247], v[2:3] op_sel:[0,0] op_sel_hi:[1,0]
v_cvt_pk_bf16_f32 v248, v240, v241
v_cvt_pk_bf16_f32 v249, v242, v243
v_cvt_pk_bf16_f32 v250, v244, v245
v_cvt_pk_bf16_f32 v251, v246, v247
buffer_store_dwordx4 v[248:251], v15, s[60:63], s73 offen offset:2048 sc1
v_accvgpr_read_b32 v240, a24
v_accvgpr_read_b32 v241, a25
v_accvgpr_read_b32 v242, a26
v_accvgpr_read_b32 v243, a27
v_accvgpr_read_b32 v244, a28
v_accvgpr_read_b32 v245, a29
v_accvgpr_read_b32 v246, a30
v_accvgpr_read_b32 v247, a31
v_pk_mul_f32 v[240:241], v[240:241], v[2:3] op_sel:[0,0] op_sel_hi:[1,0]
v_pk_mul_f32 v[242:243], v[242:243], v[2:3] op_sel:[0,0] op_sel_hi:[1,0]
v_pk_mul_f32 v[244:245], v[244:245], v[2:3] op_sel:[0,0] op_sel_hi:[1,0]
v_pk_mul_f32 v[246:247], v[246:247], v[2:3] op_sel:[0,0] op_sel_hi:[1,0]
v_cvt_pk_bf16_f32 v252, v240, v241
v_cvt_pk_bf16_f32 v253, v242, v243
v_cvt_pk_bf16_f32 v254, v244, v245
v_cvt_pk_bf16_f32 v255, v246, v247
buffer_store_dwordx4 v[252:255], v15, s[60:63], s73 offen offset:3072 sc1
v_accvgpr_read_b32 v240, a32
v_accvgpr_read_b32 v241, a33
v_accvgpr_read_b32 v242, a34
v_accvgpr_read_b32 v243, a35
v_accvgpr_read_b32 v244, a36
v_accvgpr_read_b32 v245, a37
v_accvgpr_read_b32 v246, a38
v_accvgpr_read_b32 v247, a39
v_pk_mul_f32 v[240:241], v[240:241], v[2:3] op_sel:[0,1] op_sel_hi:[1,1]
v_pk_mul_f32 v[242:243], v[242:243], v[2:3] op_sel:[0,1] op_sel_hi:[1,1]
v_pk_mul_f32 v[244:245], v[244:245], v[2:3] op_sel:[0,1] op_sel_hi:[1,1]
v_pk_mul_f32 v[246:247], v[246:247], v[2:3] op_sel:[0,1] op_sel_hi:[1,1]
v_cvt_pk_bf16_f32 v248, v240, v241
v_cvt_pk_bf16_f32 v249, v242, v243
v_cvt_pk_bf16_f32 v250, v244, v245
v_cvt_pk_bf16_f32 v251, v246, v247
buffer_store_dwordx4 v[248:251], v15, s[60:63], s80 offen offset:0 sc1
v_accvgpr_read_b32 v240, a40
v_accvgpr_read_b32 v241, a41
v_accvgpr_read_b32 v242, a42
v_accvgpr_read_b32 v243, a43
v_accvgpr_read_b32 v244, a44
v_accvgpr_read_b32 v245, a45
v_accvgpr_read_b32 v246, a46
v_accvgpr_read_b32 v247, a47
v_pk_mul_f32 v[240:241], v[240:241], v[2:3] op_sel:[0,1] op_sel_hi:[1,1]
v_pk_mul_f32 v[242:243], v[242:243], v[2:3] op_sel:[0,1] op_sel_hi:[1,1]
v_pk_mul_f32 v[244:245], v[244:245], v[2:3] op_sel:[0,1] op_sel_hi:[1,1]
v_pk_mul_f32 v[246:247], v[246:247], v[2:3] op_sel:[0,1] op_sel_hi:[1,1]
v_cvt_pk_bf16_f32 v252, v240, v241
v_cvt_pk_bf16_f32 v253, v242, v243
v_cvt_pk_bf16_f32 v254, v244, v245
v_cvt_pk_bf16_f32 v255, v246, v247
buffer_store_dwordx4 v[252:255], v15, s[60:63], s80 offen offset:1024 sc1
v_accvgpr_read_b32 v240, a48
v_accvgpr_read_b32 v241, a49
v_accvgpr_read_b32 v242, a50
v_accvgpr_read_b32 v243, a51
v_accvgpr_read_b32 v244, a52
v_accvgpr_read_b32 v245, a53
v_accvgpr_read_b32 v246, a54
v_accvgpr_read_b32 v247, a55
v_pk_mul_f32 v[240:241], v[240:241], v[2:3] op_sel:[0,1] op_sel_hi:[1,1]
v_pk_mul_f32 v[242:243], v[242:243], v[2:3] op_sel:[0,1] op_sel_hi:[1,1]
v_pk_mul_f32 v[244:245], v[244:245], v[2:3] op_sel:[0,1] op_sel_hi:[1,1]
v_pk_mul_f32 v[246:247], v[246:247], v[2:3] op_sel:[0,1] op_sel_hi:[1,1]
v_cvt_pk_bf16_f32 v248, v240, v241
v_cvt_pk_bf16_f32 v249, v242, v243
v_cvt_pk_bf16_f32 v250, v244, v245
v_cvt_pk_bf16_f32 v251, v246, v247
buffer_store_dwordx4 v[248:251], v15, s[60:63], s80 offen offset:2048 sc1
v_accvgpr_read_b32 v240, a56
v_accvgpr_read_b32 v241, a57
v_accvgpr_read_b32 v242, a58
v_accvgpr_read_b32 v243, a59
v_accvgpr_read_b32 v244, a60
v_accvgpr_read_b32 v245, a61
v_accvgpr_read_b32 v246, a62
v_accvgpr_read_b32 v247, a63
v_pk_mul_f32 v[240:241], v[240:241], v[2:3] op_sel:[0,1] op_sel_hi:[1,1]
v_pk_mul_f32 v[242:243], v[242:243], v[2:3] op_sel:[0,1] op_sel_hi:[1,1]
v_pk_mul_f32 v[244:245], v[244:245], v[2:3] op_sel:[0,1] op_sel_hi:[1,1]
v_pk_mul_f32 v[246:247], v[246:247], v[2:3] op_sel:[0,1] op_sel_hi:[1,1]
v_cvt_pk_bf16_f32 v252, v240, v241
v_cvt_pk_bf16_f32 v253, v242, v243
v_cvt_pk_bf16_f32 v254, v244, v245
v_cvt_pk_bf16_f32 v255, v246, v247
buffer_store_dwordx4 v[252:255], v15, s[60:63], s80 offen offset:3072 sc1
s_cmp_lg_u32 s81, 0
s_cbranch_scc1 L_fb_done
s_mov_b32 s81, 1
s_sub_u32 s74, 34, s77
s_mov_b32 s73, s101
s_mov_b32 s72, s70
v_mov_b32 v16, v48
v_mov_b32 v17, v49
v_mov_b32 v18, v50
v_mov_b32 v19, v51
v_mov_b32 v20, v52
v_mov_b32 v21, v53
v_mov_b32 v22, v54
v_mov_b32 v23, v55
v_mov_b32 v24, v56
v_mov_b32 v25, v57
v_mov_b32 v26, v58
v_mov_b32 v27, v59
v_mov_b32 v28, v60
v_mov_b32 v29, v61
v_mov_b32 v30, v62
v_mov_b32 v31, v63
v_mov_b32 v32, v64
v_mov_b32 v33, v65
v_mov_b32 v34, v66
v_mov_b32 v35, v67
v_mov_b32 v36, v68
v_mov_b32 v37, v69
v_mov_b32 v38, v70
v_mov_b32 v39, v71
v_mov_b32 v40, v72
v_mov_b32 v41, v73
v_mov_b32 v42, v74
v_mov_b32 v43, v75
v_mov_b32 v44, v76
v_mov_b32 v45, v77
v_mov_b32 v46, v78
v_mov_b32 v47, v79
s_branch L_fb_set
L_fb_done:
s_waitcnt vmcnt(0) lgkmcnt(0)
s_barrier
s_load_dwordx2 s[88:89], s[0:1], 104
s_mul_i32 s36, s3, 8320
v_and_b32 v16, 15, v1
v_lshrrev_b32 v17, 4, v1
v_add_u32 v18, 1, v16
v_and_b32 v19, 1, v18
v_mul_u32_u24 v19, 4160, v19
v_add_u32 v18, 2, v16
v_lshrrev_b32 v18, 1, v18
v_lshl_add_u32 v19, v18, 2, v19
v_lshl_add_u32 v19, v17, 4, v19
v_add_u32 v40, s36, v19
v_add_u32 v41, 1024, v40
v_add_u32 v42, 2048, v40
v_add_u32 v43, 3072, v40
v_add_u32 v10, s36, v232
v_lshlrev_b32 v18, 5, v16
v_lshlrev_b32 v19, 4, v17
v_sub_u32 v19, v19, v18
s_add_u32 s37, s43, 480
v_add_u32 v5, s37, v19
v_mov_b32 v20, 0
v_mov_b32 v21, 0
v_mov_b32 v22, 0
v_mov_b32 v23, 0
v_and_b32 v16, 1, v1
v_mul_u32_u24 v16, 4160, v16
v_and_b32 v17, 2, v1
v_lshl_add_u32 v16, v17, 3, v16
v_add_u32 v16, s36, v16
ds_write_b128 v16, v[20:23]
v_and_b32 v17, 31, v1
v_lshlrev_b32 v17, 4, v17
v_add_u32 v17, s43, v17
ds_write_b128 v17, v[20:23] offset:4096
v_mov_b32 v209, 0
ds_write_b128 v10, v[210:213] offset:32
s_nop 0
v_mov_b32_dpp v209, v213 wave_shr:1 row_mask:0xf bank_mask:0xf
v_alignbit_b32 v24, v210, v209, 16
v_alignbit_b32 v25, v211, v210, 16
v_alignbit_b32 v26, v212, v211, 16
v_alignbit_b32 v27, v213, v212, 16
ds_write_b128 v10, v[24:27] offset:4192
v_mov_b32_dpp v215, v213 wave_ror:1 row_mask:0xf bank_mask:0xf
ds_write_b128 v10, v[216:219] offset:1056
s_nop 0
v_mov_b32_dpp v215, v219 wave_shr:1 row_mask:0xf bank_mask:0xf
v_alignbit_b32 v28, v216, v215, 16
v_alignbit_b32 v29, v217, v216, 16
v_alignbit_b32 v30, v218, v217, 16
v_alignbit_b32 v31, v219, v218, 16
ds_write_b128 v10, v[28:31] offset:5216
v_mov_b32_dpp v221, v219 wave_ror:1 row_mask:0xf bank_mask:0xf
ds_write_b128 v10, v[222:225] offset:2080
s_nop 0
v_mov_b32_dpp v221, v225 wave_shr:1 row_mask:0xf bank_mask:0xf
v_alignbit_b32 v24, v222, v221, 16
v_alignbit_b32 v25, v223, v222, 16
v_alignbit_b32 v26, v224, v223, 16
v_alignbit_b32 v27, v225, v224, 16
ds_write_b128 v10, v[24:27] offset:6240
v_mov_b32_dpp v227, v225 wave_ror:1 row_mask:0xf bank_mask:0xf
ds_write_b128 v10, v[228:231] offset:3104
s_nop 0
v_mov_b32_dpp v227, v231 wave_shr:1 row_mask:0xf bank_mask:0xf
v_alignbit_b32 v28, v228, v227, 16
v_alignbit_b32 v29, v229, v228, 16
v_alignbit_b32 v30, v230, v229, 16
v_alignbit_b32 v31, v231, v230, 16
ds_write_b128 v10, v[28:31] offset:7264
ds_read_b128 a[160:163], v5 offset:3584
ds_read2_b32 a[128:129], v40 offset0:0 offset1:1
ds_read2_b32 a[130:131], v40 offset0:2 offset1:3
ds_read_b128 a[164:167], v5 offset:3072
ds_read2_b32 a[132:133], v40 offset0:128 offset1:129
ds_read2_b32 a[134:135], v40 offset0:130 offset1:131
ds_read_b128 a[168:171], v5 offset:2560
ds_read2_b32 a[136:137], v41 offset0:0 offset1:1
ds_read2_b32 a[138:139], v41 offset0:2 offset1:3
ds_read_b128 a[172:175], v5 offset:2048
ds_read2_b32 a[140:141], v41 offset0:128 offset1:129
ds_read2_b32 a[142:143], v41 offset0:130 offset1:131
ds_read_b128 a[176:179], v5 offset:1536
ds_read2_b32 a[144:145], v42 offset0:0 offset1:1
ds_read2_b32 a[146:147], v42 offset0:2 offset1:3
ds_read_b128 a[180:183], v5 offset:1024
ds_read2_b32 a[148:149], v42 offset0:128 offset1:129
ds_read2_b32 a[150:151], v42 offset0:130 offset1:131
ds_read_b128 a[184:187], v5 offset:512
ds_read2_b32 a[152:153], v43 offset0:0 offset1:1
ds_read2_b32 a[154:155], v43 offset0:2 offset1:3
ds_read_b128 a[188:191], v5 offset:0
ds_read2_b32 a[156:157], v43 offset0:128 offset1:129
ds_read2_b32 a[158:159], v43 offset0:130 offset1:131
s_waitcnt lgkmcnt(0)
s_branch L_p3_done
L_spin_go:
s_mov_b32 s36, 400000
L_spin_go_l:
s_sleep 1
buffer_load_dword v254, off, s[12:15], 0 sc1
s_waitcnt vmcnt(0)
v_cmp_gt_u32 vcc, 1, v254
s_nop 4
s_cbranch_vccz L_spin_go_ret
s_sub_u32 s36, s36, 1
s_cmp_lg_u32 s36, 0
s_cbranch_scc1 L_spin_go_l
s_branch L_spin_go_ret
L_spin_f1:
s_mov_b32 s36, 400000
L_spin_f1_l:
s_sleep 1
buffer_load_dword v237, v233, s[8:11], 0 offen offset:0 sc1
s_waitcnt vmcnt(0)
v_cmp_gt_u32 vcc, 1, v237
s_nop 4
s_cbranch_vccz L_spin_f1_ret
s_sub_u32 s36, s36, 1
s_cmp_lg_u32 s36, 0
s_cbranch_scc1 L_spin_f1_l
s_branch L_spin_f1_ret
L_spin_w:
s_mov_b32 s36, 400000
L_spin_w_l:
s_sleep 1
buffer_load_dword v253, v254, s[8:11], 0 offen offset:1024 sc1
s_waitcnt vmcnt(0)
v_cmp_gt_u32 vcc, 1, v253
s_nop 4
s_cbranch_vccz L_spin_w_ret
s_sub_u32 s36, s36, 1
s_cmp_lg_u32 s36, 0
s_cbranch_scc1 L_spin_w_l
s_branch L_spin_w_ret
L_spin_f2:
s_mov_b32 s36, 400000
L_spin_f2_l:
s_sleep 1
buffer_load_dword v253, v252, s[8:11], 0 offen sc1
s_waitcnt vmcnt(0)
v_cmp_gt_u32 vcc, 1, v253
s_nop 4
s_cbranch_vccz L_spin_f2_ret
s_sub_u32 s36, s36, 1
s_cmp_lg_u32 s36, 0
s_cbranch_scc1 L_spin_f2_l
s_branch L_spin_f2_ret
L_p5_x1:
v_mov_b32 v253, 1
s_lshl_b32 s36, s2, 2
buffer_store_dword v253, v255, s[8:11], s36 offen offset:2048 sc1
v_and_b32 v254, 15, v1
s_lshl_b32 s36, s82, 4
v_add_u32 v254, s36, v254
v_lshlrev_b32 v254, 2, v254
s_branch L_p5_loop
L_p5_x2:
buffer_load_dword v253, v254, s[8:11], 0 offen offset:2048 sc1
s_branch L_p5_loop
L_spin_f3:
s_mov_b32 s36, 400000
L_spin_f3_l:
s_sleep 1
buffer_load_dword v253, v254, s[8:11], 0 offen offset:2048 sc1
s_waitcnt vmcnt(0)
v_cmp_gt_u32 vcc, 1, v253
s_nop 4
s_cbranch_vccz L_spin_f3_ret
s_sub_u32 s36, s36, 1
s_cmp_lg_u32 s36, 0
s_cbranch_scc1 L_spin_f3_l
s_branch L_spin_f3_ret
L_code_end:
s_endpgm
.section .rodata,"a"
.p2align 6
.amdhsa_kernel gated_mix__ssm_conv_h3__compressed_kv_cla__prompt_kernel
  .amdhsa_next_free_vgpr 512
  .amdhsa_next_free_sgpr 102
  .amdhsa_accum_offset 256
  .amdhsa_group_segment_fixed_size 0
  .amdhsa_kernarg_size 128
  .amdhsa_user_sgpr_count 2
  .amdhsa_user_sgpr_kernarg_segment_ptr 1
  .amdhsa_system_sgpr_workgroup_id_x 1
  .amdhsa_float_denorm_mode_32 3
.end_amdhsa_kernel
.text
```

```asm
; @launch grid=(256,1,1) block=(256,1,1) lds=163840
.amdgcn_target "amdgcn-amd-amdhsa--gfx950"
.text
.macro MA d,x,a,y,b
v_mfma_f32_16x16x32_bf16 a[\d:\d+3], \x[\a:\a+3], \y[\b:\b+3], a[\d:\d+3]
.endm
.macro MV d,x,a,y,b
v_mfma_f32_16x16x32_bf16 v[\d:\d+3], \x[\a:\a+3], \y[\b:\b+3], v[\d:\d+3]
.endm
.macro TR d,a,o
ds_read_b64_tr_b16 v[\d:\d+1], v\a offset:\o
.endm
.globl gated_mix__ssm_conv_h3__compressed_kv_cla__prompt_kernel
.p2align 8
.type gated_mix__ssm_conv_h3__compressed_kv_cla__prompt_kernel,@function
gated_mix__ssm_conv_h3__compressed_kv_cla__prompt_kernel:
s_cmp_ge_u32 s2, 256
s_cbranch_scc1 L_end
s_load_dwordx8 s[44:51], s[0:1], 56
s_load_dwordx4 s[52:55], s[0:1], 112
v_lshrrev_b32 v2, 6, v0
v_and_b32 v1, 63, v0
v_lshlrev_b32 v3, 4, v0
v_readfirstlane_b32 s3, v2
s_getpc_b64 s[4:5]
L_ct_e:
s_add_u32 s4, s4, L_p1_K - L_ct_e
s_addc_u32 s5, s5, 0
v_mov_b32 v77, s5
v_mov_b32 v76, s4
s_lshr_b32 s4, s2, 3
s_lshl_b32 s4, s4, 2
s_add_u32 s4, s4, s3
s_lshl_b32 s4, s4, 7
v_and_b32 v79, 3, v1
v_lshlrev_b32 v79, 14, v79
v_add_u32 v79, s4, v79
v_min_u32 v79, L_p3_begin - L_p1_K - 4, v79
v_add_co_u32 v76, vcc, v76, v79
s_nop 1
v_addc_co_u32 v77, vcc, 0, v77, vcc
global_load_dword v79, v[76:77], off
s_and_b32 s36, s2, 7
s_lshr_b32 s37, s2, 3
s_and_b32 s38, s37, 7
s_lshr_b32 s37, s37, 3
s_lshr_b32 s42, s37, 1
s_and_b32 s37, s37, 1
s_lshl_b32 s36, s36, 1
s_add_u32 s36, s36, s37
s_lshl_b32 s24, s38, 18
s_lshl_b32 s39, s3, 16
s_add_u32 s24, s24, s39
s_lshl_b32 s25, s3, 17
s_lshl_b32 s39, s36, 9
s_add_u32 s25, s25, s39
s_and_b32 s20, s2, 7
s_lshl_b32 s21, s20, 19
s_lshl_b32 s20, s20, 7
s_lshl_b32 s22, s3, 13
s_add_u32 s23, s22, 98304
v_lshrrev_b32 v204, 3, v1
v_lshlrev_b32 v204, 10, v204
v_lshrrev_b32 v205, 4, v1
v_and_b32 v206, 7, v1
v_xor_b32 v206, v206, v205
v_lshl_add_u32 v204, v206, 4, v204
v_xor_b32 v207, 64, v204
v_add_u32 v176, 0, v204
v_add_u32 v177, 7168, v207
v_add_u32 v178, 14336, v204
v_add_u32 v179, 21504, v207
v_add_u32 v180, 32768, v204
v_add_u32 v181, 39936, v207
v_add_u32 v182, 47104, v204
v_add_u32 v183, 54272, v207
v_lshrrev_b32 v204, 5, v1
v_and_b32 v206, 31, v1
v_lshlrev_b32 v207, 1, v204
v_xor_b32 v206, v206, v207
v_lshlrev_b32 v204, 13, v204
v_xor_b32 v207, 0, v206
v_lshl_add_u32 v207, v207, 4, v204
v_add_u32 v184, 0, v207
v_xor_b32 v207, 4, v206
v_lshl_add_u32 v207, v207, 4, v204
v_add_u32 v185, 15360, v207
v_xor_b32 v207, 0, v206
v_lshl_add_u32 v207, v207, 4, v204
v_add_u32 v186, 30720, v207
v_xor_b32 v207, 4, v206
v_lshl_add_u32 v207, v207, 4, v204
v_add_u32 v187, 46080, v207
v_xor_b32 v207, 8, v206
v_lshl_add_u32 v207, v207, 4, v204
v_add_u32 v188, 65536, v207
v_xor_b32 v207, 12, v206
v_lshl_add_u32 v207, v207, 4, v204
v_add_u32 v189, 80896, v207
v_xor_b32 v207, 8, v206
v_lshl_add_u32 v207, v207, 4, v204
v_add_u32 v190, 96256, v207
v_xor_b32 v207, 12, v206
v_lshl_add_u32 v207, v207, 4, v204
v_add_u32 v191, 111616, v207
s_waitcnt lgkmcnt(0)
s_add_u32 s8, s44, s24
s_addc_u32 s9, s45, 0
s_mov_b32 s10, 65536
s_mov_b32 s11, 0x20000
s_cmp_eq_u32 s42, 0
s_cselect_b32 s12, s48, s50
s_cselect_b32 s13, s49, s51
s_add_u32 s12, s12, s25
s_addc_u32 s13, s13, 0
s_sub_u32 s14, 4194304, s25
s_mov_b32 s15, 0x20000
s_add_u32 m0, s23, 0
s_nop 0
buffer_load_dwordx4 v184, s[12:15], s21 offen offset:0 lds
buffer_load_dwordx4 v185, s[12:15], s21 offen offset:1024 lds
buffer_load_dwordx4 v186, s[12:15], s21 offen offset:2048 lds
buffer_load_dwordx4 v187, s[12:15], s21 offen offset:3072 lds
s_add_u32 m0, s23, 4096
s_nop 0
buffer_load_dwordx4 v188, s[12:15], s21 offen offset:0 lds
buffer_load_dwordx4 v189, s[12:15], s21 offen offset:1024 lds
buffer_load_dwordx4 v190, s[12:15], s21 offen offset:2048 lds
buffer_load_dwordx4 v191, s[12:15], s21 offen offset:3072 lds
s_add_u32 s21, s21, 524288
s_and_b32 s21, s21, 4194303
s_add_u32 m0, s22, 0
s_nop 0
buffer_load_dwordx4 v176, s[8:11], s20 offen offset:0 lds
buffer_load_dwordx4 v177, s[8:11], s20 offen offset:1024 lds
buffer_load_dwordx4 v178, s[8:11], s20 offen offset:2048 lds
buffer_load_dwordx4 v179, s[8:11], s20 offen offset:3072 lds
s_add_u32 m0, s22, 4096
s_nop 0
buffer_load_dwordx4 v180, s[8:11], s20 offen offset:0 lds
buffer_load_dwordx4 v181, s[8:11], s20 offen offset:1024 lds
buffer_load_dwordx4 v182, s[8:11], s20 offen offset:2048 lds
buffer_load_dwordx4 v183, s[8:11], s20 offen offset:3072 lds
s_add_u32 s20, s20, 128
s_and_b32 s20, s20, 1023
s_mov_b64 s[40:41], s[54:55]
s_mov_b64 s[34:35], s[46:47]
s_load_dwordx2 s[32:33], s[0:1], 0
s_load_dwordx2 s[84:85], s[0:1], 8
s_load_dwordx2 s[88:89], s[0:1], 16
s_load_dwordx2 s[92:93], s[0:1], 0
s_load_dwordx2 s[96:97], s[0:1], 24
s_load_dwordx2 s[76:77], s[0:1], 96
s_add_u32 s4, s40, 59768832
s_addc_u32 s5, s41, 0
s_mov_b32 s6, 8192
s_mov_b32 s7, 0x20000
s_lshl_b32 s43, s2, 20
v_add_u32 v3, s43, v3
v_mov_b32 v4, 0
v_mov_b32 v5, 0
v_mov_b32 v6, 0
v_mov_b32 v7, 0
s_movk_i32 s43, 4096
buffer_store_dwordx4 v[4:7], v3, s[4:7], 0 offen sc1
buffer_store_dwordx4 v[4:7], v3, s[4:7], s43 offen sc1
s_waitcnt vmcnt(18)
v_lshlrev_b32 v79, 16, v3
v_and_b32 v204, 15, v1
v_lshrrev_b32 v206, 1, v204
v_xor_b32 v206, v206, v205
v_lshlrev_b32 v206, 4, v206
v_lshl_add_u32 v206, v204, 7, v206
s_and_b32 s39, s3, 1
s_lshl_b32 s39, s39, 14
v_add_u32 v192, s39, v206
v_xor_b32 v193, 64, v192
v_add_u32 v194, 0x10000, v192
v_add_u32 v195, 0x10000, v193
v_bfe_u32 v204, v1, 2, 2
v_and_b32 v206, 1, v205
v_lshl_or_b32 v206, v206, 2, v204
v_lshl_add_u32 v204, v205, 3, v204
v_lshlrev_b32 v204, 9, v204
v_and_b32 v207, 3, v1
v_lshl_add_u32 v204, v207, 3, v204
s_lshr_b32 s39, s3, 1
s_lshl_b32 s39, s39, 8
s_add_u32 s39, s39, 98304
v_add_u32 v204, s39, v204
v_xor_b32 v207, 0, v206
v_lshl_add_u32 v196, v207, 5, v204
v_xor_b32 v207, 1, v206
v_lshl_add_u32 v197, v207, 5, v204
v_xor_b32 v207, 2, v206
v_lshl_add_u32 v198, v207, 5, v204
v_xor_b32 v207, 3, v206
v_lshl_add_u32 v199, v207, 5, v204
v_xor_b32 v207, 4, v206
v_lshl_add_u32 v200, v207, 5, v204
v_xor_b32 v207, 5, v206
v_lshl_add_u32 v201, v207, 5, v204
v_xor_b32 v207, 6, v206
v_lshl_add_u32 v202, v207, 5, v204
v_xor_b32 v207, 7, v206
v_lshl_add_u32 v203, v207, 5, v204
s_lshl_b32 s36, s36, 1
s_lshr_b32 s39, s3, 1
s_add_u32 s36, s36, s39
s_lshl_b32 s24, s36, 19
s_lshl_b32 s38, s38, 16
s_add_u32 s24, s24, s38
s_and_b32 s39, s3, 1
s_lshl_b32 s39, s39, 15
s_add_u32 s24, s24, s39
s_lshl_b32 s36, s42, 24
s_add_u32 s16, s40, s36
s_addc_u32 s17, s41, 0
s_mov_b32 s18, 16777216
s_mov_b32 s19, 0x20000
s_add_u32 m0, s23, 32768
s_nop 0
buffer_load_dwordx4 v184, s[12:15], s21 offen offset:0 lds
buffer_load_dwordx4 v185, s[12:15], s21 offen offset:1024 lds
buffer_load_dwordx4 v186, s[12:15], s21 offen offset:2048 lds
buffer_load_dwordx4 v187, s[12:15], s21 offen offset:3072 lds
s_add_u32 m0, s23, 36864
s_nop 0
buffer_load_dwordx4 v188, s[12:15], s21 offen offset:0 lds
buffer_load_dwordx4 v189, s[12:15], s21 offen offset:1024 lds
buffer_load_dwordx4 v190, s[12:15], s21 offen offset:2048 lds
buffer_load_dwordx4 v191, s[12:15], s21 offen offset:3072 lds
s_add_u32 s21, s21, 524288
s_and_b32 s21, s21, 4194303
s_mov_b32 s54, 256
s_mov_b32 s55, 0x20000
v_mov_b32 v78, 1
s_cmp_lg_u32 s2, 0
s_cselect_b32 s43, 0x10000000, 0
v_or_b32 v79, s43, v79
s_waitcnt vmcnt(8)
s_barrier
buffer_store_dword v78, v79, s[52:55], 0 offen sc1
ds_read_b128 v[80:83], v192 offset:0
ds_read_b128 v[84:87], v192 offset:2048
ds_read_b128 v[88:91], v192 offset:4096
ds_read_b128 v[92:95], v192 offset:6144
ds_read_b128 v[96:99], v192 offset:8192
ds_read_b128 v[100:103], v192 offset:10240
ds_read_b128 v[104:107], v192 offset:12288
ds_read_b128 v[108:111], v192 offset:14336
TR 144,196,0
TR 146,196,2048
TR 148,197,0
TR 150,197,2048
TR 152,198,0
TR 154,198,2048
TR 156,199,0
TR 158,199,2048
TR 160,200,0
TR 162,200,2048
TR 164,201,0
TR 166,201,2048
TR 168,202,0
TR 170,202,2048
TR 172,203,0
TR 174,203,2048
s_cmp_eq_u32 s42, 0
s_cbranch_scc0 L_p1_V
L_p1_K:
s_waitcnt lgkmcnt(14)
v_mfma_f32_16x16x32_bf16 a[0:3], v[144:147], v[80:83], 0
s_add_u32 m0, s22, 32768
s_mov_b32 s86, 4194304
s_waitcnt lgkmcnt(12)
v_mfma_f32_16x16x32_bf16 a[4:7], v[148:151], v[80:83], 0
ds_read_b128 v[112:115], v193 offset:0
s_mov_b32 s87, 0x20000
v_mfma_f32_16x16x32_bf16 a[32:35], v[144:147], v[84:87], 0
v_mfma_f32_16x16x32_bf16 a[36:39], v[148:151], v[84:87], 0
s_mov_b32 s90, 4194304
v_mfma_f32_16x16x32_bf16 a[64:67], v[144:147], v[88:91], 0
s_mov_b32 s91, 0x20000
v_mfma_f32_16x16x32_bf16 a[68:71], v[148:151], v[88:91], 0
buffer_load_dwordx4 v176, s[8:11], s20 offen offset:0 lds
v_mfma_f32_16x16x32_bf16 a[96:99], v[144:147], v[92:95], 0
s_mov_b32 s94, 4194304
v_mfma_f32_16x16x32_bf16 a[100:103], v[148:151], v[92:95], 0
ds_read_b128 v[116:119], v193 offset:2048
s_mov_b32 s95, 0x20000
v_mfma_f32_16x16x32_bf16 a[128:131], v[144:147], v[96:99], 0
v_mfma_f32_16x16x32_bf16 a[132:135], v[148:151], v[96:99], 0
s_mov_b32 s98, 8192
v_mfma_f32_16x16x32_bf16 a[160:163], v[144:147], v[100:103], 0
buffer_load_dwordx4 v177, s[8:11], s20 offen offset:1024 lds
s_mov_b32 s99, 0x20000
v_mfma_f32_16x16x32_bf16 a[164:167], v[148:151], v[100:103], 0
v_mfma_f32_16x16x32_bf16 a[192:195], v[144:147], v[104:107], 0
s_mov_b32 s78, 2048
v_mfma_f32_16x16x32_bf16 a[196:199], v[148:151], v[104:107], 0
ds_read_b128 v[120:123], v193 offset:4096
s_mov_b32 s79, 0x20000
v_mfma_f32_16x16x32_bf16 a[224:227], v[144:147], v[108:111], 0
TR 144,196,16384
TR 146,196,18432
v_mfma_f32_16x16x32_bf16 a[228:231], v[148:151], v[108:111], 0
TR 148,197,16384
TR 150,197,18432
s_waitcnt lgkmcnt(15)
v_mfma_f32_16x16x32_bf16 a[232:235], v[152:155], v[108:111], 0
buffer_load_dwordx4 v178, s[8:11], s20 offen offset:2048 lds
s_and_b32 s36, s2, 15
v_mfma_f32_16x16x32_bf16 a[236:239], v[156:159], v[108:111], 0
s_lshl_b32 s36, s36, 1
v_mfma_f32_16x16x32_bf16 a[200:203], v[152:155], v[104:107], 0
s_lshr_b32 s37, s3, 1
v_mfma_f32_16x16x32_bf16 a[204:207], v[156:159], v[104:107], 0
s_add_u32 s36, s36, s37
v_mfma_f32_16x16x32_bf16 a[168:171], v[152:155], v[100:103], 0
ds_read_b128 v[124:127], v193 offset:6144
buffer_load_dwordx4 v179, s[8:11], s20 offen offset:3072 lds
v_mfma_f32_16x16x32_bf16 a[172:175], v[156:159], v[100:103], 0
s_lshl_b32 s36, s36, 3
v_mfma_f32_16x16x32_bf16 a[136:139], v[152:155], v[96:99], 0
v_and_b32 v252, 7, v1
v_mfma_f32_16x16x32_bf16 a[140:143], v[156:159], v[96:99], 0
v_mfma_f32_16x16x32_bf16 a[104:107], v[152:155], v[92:95], 0
v_add_u32 v252, s36, v252
v_mfma_f32_16x16x32_bf16 a[108:111], v[156:159], v[92:95], 0
s_add_u32 m0, s22, 36864
s_lshr_b32 s36, s2, 4
v_mfma_f32_16x16x32_bf16 a[72:75], v[152:155], v[88:91], 0
ds_read_b128 v[128:131], v193 offset:8192
v_mfma_f32_16x16x32_bf16 a[76:79], v[156:159], v[88:91], 0
s_lshl_b32 s36, s36, 1
v_mfma_f32_16x16x32_bf16 a[40:43], v[152:155], v[84:87], 0
s_and_b32 s37, s3, 1
v_mfma_f32_16x16x32_bf16 a[44:47], v[156:159], v[84:87], 0
v_mfma_f32_16x16x32_bf16 a[8:11], v[152:155], v[80:83], 0
TR 152,198,16384
TR 154,198,18432
v_mfma_f32_16x16x32_bf16 a[12:15], v[156:159], v[80:83], 0
TR 156,199,16384
TR 158,199,18432
s_waitcnt lgkmcnt(15)
v_mfma_f32_16x16x32_bf16 a[16:19], v[160:163], v[80:83], 0
ds_read_b128 v[132:135], v193 offset:10240
buffer_load_dwordx4 v180, s[8:11], s20 offen offset:0 lds
v_mfma_f32_16x16x32_bf16 a[20:23], v[164:167], v[80:83], 0
s_add_u32 s36, s36, s37
s_lshl_b32 s36, s36, 3
v_mfma_f32_16x16x32_bf16 a[48:51], v[160:163], v[84:87], 0
v_lshrrev_b32 v253, 3, v1
v_add_u32 v253, s36, v253
v_mfma_f32_16x16x32_bf16 a[52:55], v[164:167], v[84:87], 0
v_mfma_f32_16x16x32_bf16 a[80:83], v[160:163], v[88:91], 0
buffer_load_dwordx4 v181, s[8:11], s20 offen offset:1024 lds
v_lshlrev_b32 v254, 14, v253
v_mfma_f32_16x16x32_bf16 a[84:87], v[164:167], v[88:91], 0
v_lshl_add_u32 v254, v252, 3, v254
v_mfma_f32_16x16x32_bf16 a[112:115], v[160:163], v[92:95], 0
v_mfma_f32_16x16x32_bf16 a[116:119], v[164:167], v[92:95], 0
ds_read_b128 v[136:139], v193 offset:12288
v_add_u32 v229, -6144, v254
v_mfma_f32_16x16x32_bf16 a[144:147], v[160:163], v[96:99], 0
v_lshlrev_b32 v62, 5, v252
v_mfma_f32_16x16x32_bf16 a[148:151], v[164:167], v[96:99], 0
buffer_load_dwordx4 v182, s[8:11], s20 offen offset:2048 lds
v_mfma_f32_16x16x32_bf16 a[176:179], v[160:163], v[100:103], 0
v_lshlrev_b32 v254, 4, v253
v_mfma_f32_16x16x32_bf16 a[180:183], v[164:167], v[100:103], 0
v_sub_u32 v254, 4080, v254
v_mfma_f32_16x16x32_bf16 a[208:211], v[160:163], v[104:107], 0
v_mfma_f32_16x16x32_bf16 a[212:215], v[164:167], v[104:107], 0
ds_read_b128 v[140:143], v193 offset:14336
v_lshl_add_u32 v10, v252, 14, v254
v_mfma_f32_16x16x32_bf16 a[240:243], v[160:163], v[108:111], 0
TR 160,200,16384
TR 162,200,18432
v_mfma_f32_16x16x32_bf16 a[244:247], v[164:167], v[108:111], 0
TR 164,201,16384
TR 166,201,18432
v_mfma_f32_16x16x32_bf16 a[248:251], v[168:171], v[108:111], 0
buffer_load_dwordx4 v183, s[8:11], s20 offen offset:3072 lds
v_and_b32 v252, 31, v1
s_waitcnt lgkmcnt(15)
v_mfma_f32_16x16x32_bf16 a[252:255], v[172:175], v[108:111], 0
v_lshlrev_b32 v64, 4, v252
s_lshl_b32 s36, s2, 2
v_mfma_f32_16x16x32_bf16 a[216:219], v[168:171], v[104:107], 0
v_mfma_f32_16x16x32_bf16 a[220:223], v[172:175], v[104:107], 0
s_add_u32 s20, s20, 128
s_add_u32 s36, s36, s3
v_mfma_f32_16x16x32_bf16 a[184:187], v[168:171], v[100:103], 0
s_lshl_b32 s36, s36, 1
v_mfma_f32_16x16x32_bf16 a[188:191], v[172:175], v[100:103], 0
v_mfma_f32_16x16x32_bf16 a[152:155], v[168:171], v[96:99], 0
v_lshrrev_b32 v253, 5, v1
v_mfma_f32_16x16x32_bf16 a[156:159], v[172:175], v[96:99], 0
v_add_u32 v253, s36, v253
v_mfma_f32_16x16x32_bf16 a[120:123], v[168:171], v[92:95], 0
s_and_b32 s20, s20, 1023
v_mfma_f32_16x16x32_bf16 a[124:127], v[172:175], v[92:95], 0
v_lshl_add_u32 v63, v253, 11, v64
v_mfma_f32_16x16x32_bf16 a[88:91], v[168:171], v[88:91], 0
v_lshlrev_b32 v253, 2, v253
v_mfma_f32_16x16x32_bf16 a[92:95], v[172:175], v[88:91], 0
v_mfma_f32_16x16x32_bf16 a[56:59], v[168:171], v[84:87], 0
v_lshl_add_u32 v11, v252, 20, v253
v_mfma_f32_16x16x32_bf16 a[60:63], v[172:175], v[84:87], 0
v_mfma_f32_16x16x32_bf16 a[24:27], v[168:171], v[80:83], 0
TR 168,202,16384
TR 170,202,18432
v_mfma_f32_16x16x32_bf16 a[28:31], v[172:175], v[80:83], 0
TR 172,203,16384
TR 174,203,18432
s_waitcnt lgkmcnt(4)
MA 0,v,144,v,112
s_add_u32 m0, s22, 65536
MA 4,v,148,v,112
MA 32,v,144,v,116
buffer_load_dwordx4 v176, s[8:11], s20 offen offset:0 lds
MA 36,v,148,v,116
MA 64,v,144,v,120
buffer_load_dwordx4 v177, s[8:11], s20 offen offset:1024 lds
MA 68,v,148,v,120
MA 96,v,144,v,124
MA 100,v,148,v,124
buffer_load_dwordx4 v178, s[8:11], s20 offen offset:2048 lds
MA 128,v,144,v,128
MA 132,v,148,v,128
buffer_load_dwordx4 v179, s[8:11], s20 offen offset:3072 lds
MA 160,v,144,v,132
MA 164,v,148,v,132
MA 192,v,144,v,136
s_add_u32 m0, s22, 69632
MA 196,v,148,v,136
MA 224,v,144,v,140
buffer_load_dwordx4 v180, s[8:11], s20 offen offset:0 lds
MA 228,v,148,v,140
MA 232,v,152,v,140
buffer_load_dwordx4 v181, s[8:11], s20 offen offset:1024 lds
MA 236,v,156,v,140
MA 200,v,152,v,136
MA 204,v,156,v,136
buffer_load_dwordx4 v182, s[8:11], s20 offen offset:2048 lds
MA 168,v,152,v,132
MA 172,v,156,v,132
buffer_load_dwordx4 v183, s[8:11], s20 offen offset:3072 lds
MA 136,v,152,v,128
MA 140,v,156,v,128
MA 104,v,152,v,124
s_add_u32 s20, s20, 128
MA 108,v,156,v,124
MA 72,v,152,v,120
s_and_b32 s20, s20, 1023
MA 76,v,156,v,120
MA 40,v,152,v,116
MA 44,v,156,v,116
MA 8,v,152,v,112
s_waitcnt vmcnt(8) lgkmcnt(0)
s_barrier
MA 12,v,156,v,112
TR 144,196,32768
TR 146,196,34816
MA 16,v,160,v,112
ds_read_b128 v[80:83], v192 offset:32768
s_add_u32 m0, s23, 0
MA 20,v,164,v,112
TR 148,197,32768
TR 150,197,34816
MA 48,v,160,v,116
ds_read_b128 v[84:87], v192 offset:34816
buffer_load_dwordx4 v184, s[12:15], s21 offen offset:0 lds
MA 52,v,164,v,116
TR 152,198,32768
TR 154,198,34816
MA 80,v,160,v,120
buffer_load_dwordx4 v185, s[12:15], s21 offen offset:1024 lds
MA 84,v,164,v,120
TR 156,199,32768
TR 158,199,34816
MA 112,v,160,v,124
ds_read_b128 v[88:91], v192 offset:36864
buffer_load_dwordx4 v186, s[12:15], s21 offen offset:2048 lds
MA 116,v,164,v,124
ds_read_b128 v[92:95], v192 offset:38912
MA 144,v,160,v,128
MA 148,v,164,v,128
buffer_load_dwordx4 v187, s[12:15], s21 offen offset:3072 lds
MA 176,v,160,v,132
ds_read_b128 v[96:99], v192 offset:40960
MA 180,v,164,v,132
s_add_u32 m0, s23, 4096
MA 208,v,160,v,136
ds_read_b128 v[100:103], v192 offset:43008
MA 212,v,164,v,136
MA 240,v,160,v,140
TR 160,200,32768
TR 162,200,34816
MA 244,v,164,v,140
TR 164,201,32768
TR 166,201,34816
MA 248,v,168,v,140
ds_read_b128 v[104:107], v192 offset:45056
buffer_load_dwordx4 v188, s[12:15], s21 offen offset:0 lds
MA 252,v,172,v,140
ds_read_b128 v[108:111], v192 offset:47104
buffer_load_dwordx4 v189, s[12:15], s21 offen offset:1024 lds
MA 216,v,168,v,136
MA 220,v,172,v,136
buffer_load_dwordx4 v190, s[12:15], s21 offen offset:2048 lds
MA 184,v,168,v,132
MA 188,v,172,v,132
MA 152,v,168,v,128
buffer_load_dwordx4 v191, s[12:15], s21 offen offset:3072 lds
MA 156,v,172,v,128
MA 120,v,168,v,124
s_add_u32 s21, s21, 524288
MA 124,v,172,v,124
MA 88,v,168,v,120
MA 92,v,172,v,120
s_and_b32 s21, s21, 4194303
MA 56,v,168,v,116
MA 60,v,172,v,116
MA 24,v,168,v,112
TR 168,202,32768
TR 170,202,34816
MA 28,v,172,v,112
TR 172,203,32768
TR 174,203,34816
s_waitcnt lgkmcnt(4)
MA 0,v,144,v,80
s_add_u32 m0, s22, 0
buffer_load_dwordx4 v[230:233], v63, s[92:95], 0 offen offset:0
MA 4,v,148,v,80
ds_read_b128 v[112:115], v193 offset:32768
MA 32,v,144,v,84
MA 36,v,148,v,84
MA 64,v,144,v,88
MA 68,v,148,v,88
buffer_load_dwordx4 v176, s[8:11], s20 offen offset:0 lds
MA 96,v,144,v,92
buffer_load_dwordx4 v[2:5], v64, s[76:79], 0 offen offset:0
MA 100,v,148,v,92
ds_read_b128 v[116:119], v193 offset:34816
MA 128,v,144,v,96
MA 132,v,148,v,96
MA 160,v,144,v,100
buffer_load_dwordx4 v177, s[8:11], s20 offen offset:1024 lds
MA 164,v,148,v,100
MA 192,v,144,v,104
buffer_load_dwordx4 v[234:237], v63, s[92:95], 0 offen offset:512
MA 196,v,148,v,104
ds_read_b128 v[120:123], v193 offset:36864
MA 224,v,144,v,108
TR 144,196,49152
TR 146,196,51200
MA 228,v,148,v,108
TR 148,197,49152
TR 150,197,51200
MA 232,v,152,v,108
buffer_load_dwordx4 v178, s[8:11], s20 offen offset:2048 lds
MA 236,v,156,v,108
MA 200,v,152,v,104
buffer_load_dwordx4 v[6:9], v64, s[76:79], 0 offen offset:512
MA 204,v,156,v,104
MA 168,v,152,v,100
ds_read_b128 v[124:127], v193 offset:38912
buffer_load_dwordx4 v179, s[8:11], s20 offen offset:3072 lds
MA 172,v,156,v,100
MA 136,v,152,v,96
MA 140,v,156,v,96
MA 104,v,152,v,92
buffer_load_dwordx4 v[238:241], v63, s[92:95], 0 offen offset:1024
MA 108,v,156,v,92
s_add_u32 m0, s22, 4096
MA 72,v,152,v,88
ds_read_b128 v[128:131], v193 offset:40960
MA 76,v,156,v,88
MA 40,v,152,v,84
MA 44,v,156,v,84
MA 8,v,152,v,80
TR 152,198,49152
TR 154,198,51200
MA 12,v,156,v,80
TR 156,199,49152
TR 158,199,51200
MA 16,v,160,v,80
ds_read_b128 v[132:135], v193 offset:43008
buffer_load_dwordx4 v180, s[8:11], s20 offen offset:0 lds
MA 20,v,164,v,80
buffer_load_dwordx4 v[12:15], v64, s[76:79], 0 offen offset:1024
MA 48,v,160,v,84
MA 52,v,164,v,84
MA 80,v,160,v,88
buffer_load_dwordx4 v181, s[8:11], s20 offen offset:1024 lds
MA 84,v,164,v,88
buffer_load_dwordx4 v[242:245], v63, s[92:95], 0 offen offset:1536
MA 112,v,160,v,92
MA 116,v,164,v,92
ds_read_b128 v[136:139], v193 offset:45056
MA 144,v,160,v,96
MA 148,v,164,v,96
buffer_load_dwordx4 v182, s[8:11], s20 offen offset:2048 lds
MA 176,v,160,v,100
MA 180,v,164,v,100
buffer_load_dwordx4 v[246:249], v64, s[76:79], 0 offen offset:1536
MA 208,v,160,v,104
MA 212,v,164,v,104
ds_read_b128 v[140:143], v193 offset:47104
MA 240,v,160,v,108
TR 160,200,49152
TR 162,200,51200
MA 244,v,164,v,108
TR 164,201,49152
TR 166,201,51200
s_waitcnt lgkmcnt(15)
MA 248,v,168,v,108
buffer_load_dwordx4 v183, s[8:11], s20 offen offset:3072 lds
MA 252,v,172,v,108
buffer_load_dwordx4 v[54:57], v62, s[96:99], 0 offen offset:0
MA 216,v,168,v,104
MA 220,v,172,v,104
s_add_u32 s20, s20, 128
MA 184,v,168,v,100
MA 188,v,172,v,100
MA 152,v,168,v,96
MA 156,v,172,v,96
buffer_load_dwordx4 v[58:61], v62, s[96:99], 0 offen offset:16
MA 120,v,168,v,92
s_and_b32 s20, s20, 1023
MA 124,v,172,v,92
MA 88,v,168,v,88
MA 92,v,172,v,88
MA 56,v,168,v,84
MA 60,v,172,v,84
MA 24,v,168,v,80
TR 168,202,49152
TR 170,202,51200
MA 28,v,172,v,80
TR 172,203,49152
TR 174,203,51200
s_waitcnt lgkmcnt(4)
MA 0,v,144,v,112
MA 4,v,148,v,112
MA 32,v,144,v,116
MA 36,v,148,v,116
MA 64,v,144,v,120
MA 68,v,148,v,120
MA 96,v,144,v,124
MA 100,v,148,v,124
MA 128,v,144,v,128
MA 132,v,148,v,128
s_waitcnt vmcnt(18) lgkmcnt(0)
s_barrier
MA 160,v,144,v,132
s_add_u32 m0, s23, 32768
MA 164,v,148,v,132
ds_read_b128 v[80:83], v194 offset:0
MA 192,v,144,v,136
s_mov_b32 s4, s34
s_mov_b32 s5, s35
MA 196,v,148,v,136
MA 224,v,144,v,140
TR 144,196,0
TR 146,196,2048
MA 228,v,148,v,140
TR 148,197,0
TR 150,197,2048
MA 232,v,152,v,140
ds_read_b128 v[84:87], v194 offset:2048
buffer_load_dwordx4 v184, s[12:15], s21 offen offset:0 lds
MA 236,v,156,v,140
s_mov_b32 s6, 8388608
s_mov_b32 s7, 0x20000
MA 200,v,152,v,136
buffer_load_dwordx4 v185, s[12:15], s21 offen offset:1024 lds
MA 204,v,156,v,136
MA 168,v,152,v,132
MA 172,v,156,v,132
ds_read_b128 v[88:91], v194 offset:4096
MA 136,v,152,v,128
MA 140,v,156,v,128
buffer_load_dwordx4 v186, s[12:15], s21 offen offset:2048 lds
s_lshr_b32 s43, s2, 3
MA 104,v,152,v,124
MA 108,v,156,v,124
MA 72,v,152,v,120
ds_read_b128 v[92:95], v194 offset:6144
s_lshl_b32 s43, s43, 2
MA 76,v,156,v,120
buffer_load_dwordx4 v187, s[12:15], s21 offen offset:3072 lds
MA 40,v,152,v,116
MA 44,v,156,v,116
s_add_u32 s43, s43, s3
MA 8,v,152,v,112
TR 152,198,0
TR 154,198,2048
MA 12,v,156,v,112
TR 156,199,0
TR 158,199,2048
MA 16,v,160,v,112
ds_read_b128 v[96:99], v194 offset:8192
s_add_u32 m0, s23, 36864
MA 20,v,164,v,112
s_lshl_b32 s43, s43, 16
MA 48,v,160,v,116
MA 52,v,164,v,116
MA 80,v,160,v,120
ds_read_b128 v[100:103], v194 offset:10240
buffer_load_dwordx4 v188, s[12:15], s21 offen offset:0 lds
MA 84,v,164,v,120
s_and_b32 s37, s2, 7
MA 112,v,160,v,124
MA 116,v,164,v,124
s_lshl_b32 s37, s37, 10
MA 144,v,160,v,128
buffer_load_dwordx4 v189, s[12:15], s21 offen offset:1024 lds
MA 148,v,164,v,128
ds_read_b128 v[104:107], v194 offset:12288
MA 176,v,160,v,132
s_add_u32 s43, s43, s37
MA 180,v,164,v,132
MA 208,v,160,v,136
buffer_load_dwordx4 v190, s[12:15], s21 offen offset:2048 lds
MA 212,v,164,v,136
v_lshrrev_b32 v78, 3, v1
MA 240,v,160,v,140
TR 160,200,0
TR 162,200,2048
MA 244,v,164,v,140
TR 164,201,0
TR 166,201,2048
MA 248,v,168,v,140
ds_read_b128 v[108:111], v194 offset:14336
MA 252,v,172,v,140
buffer_load_dwordx4 v191, s[12:15], s21 offen offset:3072 lds
v_and_b32 v79, 7, v1
MA 216,v,168,v,136
MA 220,v,172,v,136
MA 184,v,168,v,132
v_lshlrev_b32 v79, 7, v79
MA 188,v,172,v,132
s_add_u32 s21, s21, 524288
MA 152,v,168,v,128
MA 156,v,172,v,128
v_lshl_add_u32 v78, v78, 13, v79
MA 120,v,168,v,124
MA 124,v,172,v,124
s_and_b32 s21, s21, 4194303
MA 88,v,168,v,120
v_add_u32 v78, s43, v78
MA 92,v,172,v,120
MA 56,v,168,v,116
MA 60,v,172,v,116
MA 24,v,168,v,112
TR 168,202,0
TR 170,202,2048
MA 28,v,172,v,112
TR 172,203,0
TR 174,203,2048
s_waitcnt lgkmcnt(4)
MA 0,v,144,v,80
s_add_u32 m0, s22, 32768
v_add_u32 v252, 0, v229
MA 4,v,148,v,80
ds_read_b128 v[112:115], v195 offset:0
MA 32,v,144,v,84
MA 36,v,148,v,84
MA 64,v,144,v,88
MA 68,v,148,v,88
buffer_load_dwordx4 v176, s[8:11], s20 offen offset:0 lds
MA 96,v,144,v,92
buffer_load_dwordx2 v[16:17], v252, s[84:87], 0 offen
MA 100,v,148,v,92
ds_read_b128 v[116:119], v195 offset:2048
MA 128,v,144,v,96
MA 132,v,148,v,96
MA 160,v,144,v,100
buffer_load_dwordx4 v177, s[8:11], s20 offen offset:1024 lds
MA 164,v,148,v,100
MA 192,v,144,v,104
v_add_u32 v253, 2048, v229
MA 196,v,148,v,104
ds_read_b128 v[120:123], v195 offset:4096
MA 224,v,144,v,108
TR 144,196,16384
TR 146,196,18432
MA 228,v,148,v,108
TR 148,197,16384
TR 150,197,18432
MA 232,v,152,v,108
buffer_load_dwordx4 v178, s[8:11], s20 offen offset:2048 lds
MA 236,v,156,v,108
MA 200,v,152,v,104
buffer_load_dwordx2 v[18:19], v253, s[84:87], 0 offen
MA 204,v,156,v,104
MA 168,v,152,v,100
ds_read_b128 v[124:127], v195 offset:6144
buffer_load_dwordx4 v179, s[8:11], s20 offen offset:3072 lds
MA 172,v,156,v,100
MA 136,v,152,v,96
MA 140,v,156,v,96
MA 104,v,152,v,92
v_add_u32 v254, 4096, v229
MA 108,v,156,v,92
s_add_u32 m0, s22, 36864
MA 72,v,152,v,88
ds_read_b128 v[128:131], v195 offset:8192
MA 76,v,156,v,88
MA 40,v,152,v,84
MA 44,v,156,v,84
MA 8,v,152,v,80
TR 152,198,16384
TR 154,198,18432
MA 12,v,156,v,80
TR 156,199,16384
TR 158,199,18432
MA 16,v,160,v,80
ds_read_b128 v[132:135], v195 offset:10240
buffer_load_dwordx4 v180, s[8:11], s20 offen offset:0 lds
MA 20,v,164,v,80
buffer_load_dwordx2 v[20:21], v254, s[84:87], 0 offen
MA 48,v,160,v,84
MA 52,v,164,v,84
MA 80,v,160,v,88
buffer_load_dwordx4 v181, s[8:11], s20 offen offset:1024 lds
MA 84,v,164,v,88
v_add_u32 v255, 6144, v229
MA 112,v,160,v,92
MA 116,v,164,v,92
ds_read_b128 v[136:139], v195 offset:12288
MA 144,v,160,v,96
MA 148,v,164,v,96
buffer_load_dwordx4 v182, s[8:11], s20 offen offset:2048 lds
MA 176,v,160,v,100
MA 180,v,164,v,100
buffer_load_dwordx2 v[22:23], v255, s[84:87], 0 offen
MA 208,v,160,v,104
MA 212,v,164,v,104
ds_read_b128 v[140:143], v195 offset:14336
MA 240,v,160,v,108
TR 160,200,16384
TR 162,200,18432
MA 244,v,164,v,108
TR 164,201,16384
TR 166,201,18432
s_waitcnt lgkmcnt(15)
MA 248,v,168,v,108
buffer_load_dwordx4 v183, s[8:11], s20 offen offset:3072 lds
MA 252,v,172,v,108
buffer_load_dwordx2 v[38:39], v255, s[88:91], 0 offen
MA 216,v,168,v,104
MA 220,v,172,v,104
s_add_u32 s20, s20, 128
MA 184,v,168,v,100
MA 188,v,172,v,100
MA 152,v,168,v,96
MA 156,v,172,v,96
v_add_u32 v252, 8192, v229
MA 120,v,168,v,92
s_and_b32 s20, s20, 1023
MA 124,v,172,v,92
MA 88,v,168,v,88
MA 92,v,172,v,88
MA 56,v,168,v,84
MA 60,v,172,v,84
MA 24,v,168,v,80
TR 168,202,16384
TR 170,202,18432
MA 28,v,172,v,80
TR 172,203,16384
TR 174,203,18432
s_waitcnt lgkmcnt(4)
MA 0,v,144,v,112
MA 4,v,148,v,112
MA 32,v,144,v,116
MA 36,v,148,v,116
MA 64,v,144,v,120
MA 68,v,148,v,120
MA 96,v,144,v,124
MA 100,v,148,v,124
MA 128,v,144,v,128
MA 132,v,148,v,128
s_waitcnt vmcnt(13) lgkmcnt(0)
s_barrier
MA 160,v,144,v,132
s_add_u32 m0, s23, 0
s_bfe_u32 s80, s2, 0x20001
MA 164,v,148,v,132
ds_read_b128 v[80:83], v192 offset:0
s_bfe_u32 s69, s2, 0x30003
MA 192,v,144,v,136
s_lshl_b32 s80, s80, 3
s_add_u32 s69, s69, s80
MA 196,v,148,v,136
s_lshr_b32 s80, s2, 6
MA 224,v,144,v,140
TR 144,196,32768
TR 146,196,34816
MA 228,v,148,v,140
TR 148,197,32768
TR 150,197,34816
MA 232,v,152,v,140
ds_read_b128 v[84:87], v192 offset:2048
buffer_load_dwordx4 v184, s[12:15], s21 offen offset:0 lds
MA 236,v,156,v,140
s_xor_b32 s81, s80, s2
s_and_b32 s81, s81, 1
MA 200,v,152,v,136
buffer_load_dwordx4 v185, s[12:15], s21 offen offset:1024 lds
s_lshl_b32 s70, s80, 1
MA 204,v,156,v,136
s_add_u32 s70, s70, s81
s_lshl_b32 s80, s3, 1
MA 168,v,152,v,132
s_sub_u32 s80, 7, s80
s_lshl_b32 s76, s80, 17
MA 172,v,156,v,132
ds_read_b128 v[88:91], v192 offset:4096
s_lshl_b32 s80, s3, 15
MA 136,v,152,v,128
s_lshl_b32 s65, s70, 18
s_sub_u32 s64, 3932160, s65
MA 140,v,156,v,128
buffer_load_dwordx4 v186, s[12:15], s21 offen offset:2048 lds
s_add_u32 s65, s65, s80
MA 104,v,152,v,124
s_add_u32 s64, s64, s80
MA 108,v,156,v,124
s_lshl_b32 s81, s69, 12
MA 72,v,152,v,120
ds_read_b128 v[92:95], v192 offset:6144
s_lshl_b32 s100, s64, 2
MA 76,v,156,v,120
buffer_load_dwordx4 v187, s[12:15], s21 offen offset:3072 lds
s_add_u32 s100, s100, s81
MA 40,v,152,v,116
s_lshl_b32 s101, s65, 2
MA 44,v,156,v,116
s_add_u32 s101, s101, s81
MA 8,v,152,v,112
TR 152,198,32768
TR 154,198,34816
MA 12,v,156,v,112
TR 156,199,32768
TR 158,199,34816
MA 16,v,160,v,112
ds_read_b128 v[96:99], v192 offset:8192
s_add_u32 m0, s23, 4096
MA 20,v,164,v,112
s_lshl_b32 s66, s3, 17
s_lshl_b32 s81, s69, 8
MA 48,v,160,v,116
s_add_u32 s66, s66, s81
s_and_b32 s74, s2, 7
MA 52,v,164,v,116
s_lshl_b32 s74, s74, 8
s_mov_b32 s82, s66
MA 80,v,160,v,120
ds_read_b128 v[100:103], v192 offset:10240
buffer_load_dwordx4 v188, s[12:15], s21 offen offset:0 lds
MA 84,v,164,v,120
s_lshl_b32 s66, s74, 12
s_lshl_b32 s67, s3, 13
MA 112,v,160,v,124
s_lshl_b32 s68, s3, 12
s_lshl_b32 s77, s70, 1
MA 116,v,164,v,124
s_sub_u32 s77, 32, s77
MA 144,v,160,v,128
buffer_load_dwordx4 v189, s[12:15], s21 offen offset:1024 lds
v_lshrrev_b32 v66, 3, v1
MA 148,v,164,v,128
ds_read_b128 v[104:107], v192 offset:12288
v_lshlrev_b32 v66, 11, v66
MA 176,v,160,v,132
v_lshrrev_b32 v67, 4, v1
v_and_b32 v68, 7, v1
MA 180,v,164,v,132
v_xor_b32 v68, v68, v67
MA 208,v,160,v,136
buffer_load_dwordx4 v190, s[12:15], s21 offen offset:2048 lds
v_lshl_add_u32 v66, v68, 4, v66
MA 212,v,164,v,136
v_xor_b32 v69, 64, v66
MA 240,v,160,v,140
TR 160,200,32768
TR 162,200,34816
MA 244,v,164,v,140
TR 164,201,32768
TR 166,201,34816
MA 248,v,168,v,140
ds_read_b128 v[108:111], v192 offset:14336
s_lshr_b32 s83, s76, 2
MA 252,v,172,v,140
buffer_load_dwordx4 v191, s[12:15], s21 offen offset:3072 lds
v_add_u32 v208, 0, v66
MA 216,v,168,v,136
v_add_u32 v209, 15360, v69
v_add_u32 v210, -2048, v66
MA 220,v,172,v,136
v_add_u32 v210, s83, v210
v_add_u32 v211, 13312, v69
MA 184,v,168,v,132
v_add_u32 v211, s83, v211
v_and_b32 v68, 15, v1
MA 188,v,172,v,132
s_add_u32 s21, s21, 524288
v_lshlrev_b32 v69, 1, v67
MA 152,v,168,v,128
v_xor_b32 v68, v68, v69
MA 156,v,172,v,128
v_lshlrev_b32 v66, 13, v67
MA 120,v,168,v,124
v_xor_b32 v69, 0, v68
MA 124,v,172,v,124
s_and_b32 s21, s21, 4194303
v_lshl_add_u32 v69, v69, 4, v66
MA 88,v,168,v,120
v_add_u32 v212, 0, v69
MA 92,v,172,v,120
v_xor_b32 v69, 0, v68
MA 56,v,168,v,116
v_lshl_add_u32 v69, v69, 4, v66
MA 60,v,172,v,116
v_add_u32 v213, 31744, v69
MA 24,v,168,v,112
TR 168,202,32768
TR 170,202,34816
MA 28,v,172,v,112
TR 172,203,32768
TR 174,203,34816
s_waitcnt lgkmcnt(4)
MA 0,v,144,v,80
s_add_u32 m0, s22, 65536
buffer_load_dwordx2 v[24:25], v252, s[84:87], 0 offen
MA 4,v,148,v,80
ds_read_b128 v[112:115], v193 offset:0
MA 32,v,144,v,84
MA 36,v,148,v,84
MA 64,v,144,v,88
MA 68,v,148,v,88
buffer_load_dwordx4 v176, s[8:11], s20 offen offset:0 lds
MA 96,v,144,v,92
buffer_load_dwordx2 v[40:41], v252, s[88:91], 0 offen
MA 100,v,148,v,92
ds_read_b128 v[116:119], v193 offset:2048
MA 128,v,144,v,96
MA 132,v,148,v,96
MA 160,v,144,v,100
buffer_load_dwordx4 v177, s[8:11], s20 offen offset:1024 lds
MA 164,v,148,v,100
MA 192,v,144,v,104
v_add_u32 v253, 10240, v229
MA 196,v,148,v,104
ds_read_b128 v[120:123], v193 offset:4096
MA 224,v,144,v,108
TR 144,196,49152
TR 146,196,51200
MA 228,v,148,v,108
TR 148,197,49152
TR 150,197,51200
MA 232,v,152,v,108
buffer_load_dwordx4 v178, s[8:11], s20 offen offset:2048 lds
MA 236,v,156,v,108
MA 200,v,152,v,104
buffer_load_dwordx2 v[26:27], v253, s[84:87], 0 offen
MA 204,v,156,v,104
MA 168,v,152,v,100
ds_read_b128 v[124:127], v193 offset:6144
buffer_load_dwordx4 v179, s[8:11], s20 offen offset:3072 lds
MA 172,v,156,v,100
MA 136,v,152,v,96
MA 140,v,156,v,96
MA 104,v,152,v,92
buffer_load_dwordx2 v[42:43], v253, s[88:91], 0 offen
MA 108,v,156,v,92
s_add_u32 m0, s22, 69632
MA 72,v,152,v,88
ds_read_b128 v[128:131], v193 offset:8192
MA 76,v,156,v,88
MA 40,v,152,v,84
MA 44,v,156,v,84
MA 8,v,152,v,80
TR 152,198,49152
TR 154,198,51200
MA 12,v,156,v,80
TR 156,199,49152
TR 158,199,51200
MA 16,v,160,v,80
ds_read_b128 v[132:135], v193 offset:10240
buffer_load_dwordx4 v180, s[8:11], s20 offen offset:0 lds
MA 20,v,164,v,80
v_add_u32 v254, 12288, v229
MA 48,v,160,v,84
MA 52,v,164,v,84
MA 80,v,160,v,88
buffer_load_dwordx4 v181, s[8:11], s20 offen offset:1024 lds
MA 84,v,164,v,88
buffer_load_dwordx2 v[28:29], v254, s[84:87], 0 offen
MA 112,v,160,v,92
MA 116,v,164,v,92
ds_read_b128 v[136:139], v193 offset:12288
MA 144,v,160,v,96
MA 148,v,164,v,96
buffer_load_dwordx4 v182, s[8:11], s20 offen offset:2048 lds
MA 176,v,160,v,100
MA 180,v,164,v,100
buffer_load_dwordx2 v[44:45], v254, s[88:91], 0 offen
MA 208,v,160,v,104
MA 212,v,164,v,104
ds_read_b128 v[140:143], v193 offset:14336
MA 240,v,160,v,108
TR 160,200,49152
TR 162,200,51200
MA 244,v,164,v,108
TR 164,201,49152
TR 166,201,51200
s_waitcnt lgkmcnt(15)
MA 248,v,168,v,108
buffer_load_dwordx4 v183, s[8:11], s20 offen offset:3072 lds
MA 252,v,172,v,108
v_add_u32 v255, 14336, v229
MA 216,v,168,v,104
MA 220,v,172,v,104
s_add_u32 s20, s20, 128
MA 184,v,168,v,100
MA 188,v,172,v,100
MA 152,v,168,v,96
MA 156,v,172,v,96
buffer_load_dwordx2 v[30:31], v255, s[84:87], 0 offen
MA 120,v,168,v,92
s_and_b32 s20, s20, 1023
MA 124,v,172,v,92
MA 88,v,168,v,88
MA 92,v,172,v,88
MA 56,v,168,v,84
MA 60,v,172,v,84
MA 24,v,168,v,80
TR 168,202,49152
TR 170,202,51200
MA 28,v,172,v,80
TR 172,203,49152
TR 174,203,51200
s_waitcnt lgkmcnt(4)
MA 0,v,144,v,112
MA 4,v,148,v,112
MA 32,v,144,v,116
MA 36,v,148,v,116
MA 64,v,144,v,120
MA 68,v,148,v,120
MA 96,v,144,v,124
MA 100,v,148,v,124
MA 128,v,144,v,128
MA 132,v,148,v,128
s_waitcnt vmcnt(15) lgkmcnt(0)
s_barrier
MA 160,v,144,v,132
s_add_u32 m0, s23, 32768
v_xor_b32 v69, 8, v68
MA 164,v,148,v,132
ds_read_b128 v[80:83], v192 offset:32768
v_lshl_add_u32 v69, v69, 4, v66
MA 192,v,144,v,136
v_add_u32 v214, 63488, v69
v_xor_b32 v69, 8, v68
MA 196,v,148,v,136
v_lshl_add_u32 v69, v69, 4, v66
MA 224,v,144,v,140
TR 144,196,0
TR 146,196,2048
MA 228,v,148,v,140
TR 148,197,0
TR 150,197,2048
MA 232,v,152,v,140
ds_read_b128 v[84:87], v192 offset:34816
buffer_load_dwordx4 v184, s[12:15], s21 offen offset:0 lds
MA 236,v,156,v,140
v_add_u32 v215, 95232, v69
v_and_b32 v66, 15, v1
MA 200,v,152,v,136
buffer_load_dwordx4 v185, s[12:15], s21 offen offset:1024 lds
v_lshrrev_b32 v68, 1, v66
MA 204,v,156,v,136
v_xor_b32 v68, v68, v67
v_lshlrev_b32 v68, 4, v68
MA 168,v,152,v,132
v_lshl_add_u32 v68, v66, 7, v68
v_add_u32 v224, s67, v68
MA 172,v,156,v,132
ds_read_b128 v[88:91], v192 offset:36864
v_xor_b32 v225, 64, v224
MA 136,v,152,v,128
v_add_u32 v226, 0x10000, v224
v_add_u32 v227, 0x10000, v225
MA 140,v,156,v,128
buffer_load_dwordx4 v186, s[12:15], s21 offen offset:2048 lds
v_bfe_u32 v66, v1, 2, 2
MA 104,v,152,v,124
v_and_b32 v68, 1, v67
v_lshl_or_b32 v68, v68, 2, v66
MA 108,v,156,v,124
v_lshl_add_u32 v66, v67, 3, v66
v_lshlrev_b32 v66, 8, v66
MA 72,v,152,v,120
ds_read_b128 v[92:95], v192 offset:38912
v_and_b32 v69, 3, v1
MA 76,v,156,v,120
buffer_load_dwordx4 v187, s[12:15], s21 offen offset:3072 lds
v_lshl_add_u32 v66, v69, 3, v66
MA 40,v,152,v,116
v_add_u32 v66, 98304, v66
MA 44,v,156,v,116
v_xor_b32 v69, 0, v68
MA 8,v,152,v,112
TR 152,198,0
TR 154,198,2048
MA 12,v,156,v,112
TR 156,199,0
TR 158,199,2048
MA 16,v,160,v,112
ds_read_b128 v[96:99], v192 offset:40960
s_add_u32 m0, s23, 36864
MA 20,v,164,v,112
v_lshl_add_u32 v216, v69, 5, v66
v_xor_b32 v69, 1, v68
MA 48,v,160,v,116
v_lshl_add_u32 v217, v69, 5, v66
v_xor_b32 v69, 2, v68
MA 52,v,164,v,116
v_lshl_add_u32 v218, v69, 5, v66
v_xor_b32 v69, 3, v68
MA 80,v,160,v,120
ds_read_b128 v[100:103], v192 offset:43008
buffer_load_dwordx4 v188, s[12:15], s21 offen offset:0 lds
MA 84,v,164,v,120
v_lshl_add_u32 v219, v69, 5, v66
v_xor_b32 v69, 4, v68
MA 112,v,160,v,124
v_lshl_add_u32 v220, v69, 5, v66
v_xor_b32 v69, 5, v68
MA 116,v,164,v,124
v_lshl_add_u32 v221, v69, 5, v66
v_xor_b32 v69, 6, v68
MA 144,v,160,v,128
buffer_load_dwordx4 v189, s[12:15], s21 offen offset:1024 lds
v_lshl_add_u32 v222, v69, 5, v66
MA 148,v,164,v,128
ds_read_b128 v[104:107], v192 offset:45056
v_xor_b32 v69, 7, v68
MA 176,v,160,v,132
v_lshl_add_u32 v223, v69, 5, v66
s_mov_b32 s44, s32
MA 180,v,164,v,132
s_mov_b32 s45, s33
MA 208,v,160,v,136
buffer_load_dwordx4 v190, s[12:15], s21 offen offset:2048 lds
s_mov_b32 s46, 4194304
MA 212,v,164,v,136
s_mov_b32 s47, 0x20000
MA 240,v,160,v,140
TR 160,200,0
TR 162,200,2048
MA 244,v,164,v,140
TR 164,201,0
TR 166,201,2048
MA 248,v,168,v,140
ds_read_b128 v[108:111], v192 offset:47104
MA 252,v,172,v,140
buffer_load_dwordx4 v191, s[12:15], s21 offen offset:3072 lds
MA 216,v,168,v,136
s_add_u32 s48, s34, s82
s_addc_u32 s49, s35, 0
MA 220,v,172,v,136
s_sub_u32 s50, 8388608, s82
s_mov_b32 s51, 0x20000
MA 184,v,168,v,132
s_add_u32 s60, s40, 33554432
s_addc_u32 s61, s41, 0
MA 188,v,172,v,132
s_add_u32 s21, s21, 524288
s_mov_b32 s62, 16777216
MA 152,v,168,v,128
s_mov_b32 s63, 0x20000
s_lshl_b32 s80, s69, 19
MA 156,v,172,v,128
s_add_u32 s52, s40, s80
s_addc_u32 s53, s41, 0
MA 120,v,168,v,124
s_lshl_b32 s54, s77, 14
s_mov_b32 s55, 0x20000
MA 124,v,172,v,124
s_and_b32 s21, s21, 4194303
s_add_u32 s80, s80, 16760832
MA 88,v,168,v,120
s_add_u32 s56, s40, s80
s_addc_u32 s57, s41, 0
MA 92,v,172,v,120
s_add_u32 s58, s54, 16384
MA 56,v,168,v,116
s_mov_b32 s59, 0x20000
MA 60,v,172,v,116
s_load_dwordx2 s[38:39], s[0:1], 112
MA 24,v,168,v,112
TR 168,202,0
TR 170,202,2048
MA 28,v,172,v,112
TR 172,203,0
TR 174,203,2048
s_waitcnt lgkmcnt(4)
MA 0,v,144,v,80
s_add_u32 m0, s22, 0
buffer_load_dwordx2 v[46:47], v255, s[88:91], 0 offen
MA 4,v,148,v,80
ds_read_b128 v[112:115], v193 offset:32768
MA 32,v,144,v,84
MA 36,v,148,v,84
MA 64,v,144,v,88
MA 68,v,148,v,88
buffer_load_dwordx4 v176, s[8:11], s20 offen offset:0 lds
MA 96,v,144,v,92
v_add_u32 v252, 16384, v229
MA 100,v,148,v,92
ds_read_b128 v[116:119], v193 offset:34816
MA 128,v,144,v,96
MA 132,v,148,v,96
MA 160,v,144,v,100
buffer_load_dwordx4 v177, s[8:11], s20 offen offset:1024 lds
MA 164,v,148,v,100
MA 192,v,144,v,104
buffer_load_dwordx2 v[32:33], v252, s[84:87], 0 offen
MA 196,v,148,v,104
ds_read_b128 v[120:123], v193 offset:36864
MA 224,v,144,v,108
TR 144,196,16384
TR 146,196,18432
MA 228,v,148,v,108
TR 148,197,16384
TR 150,197,18432
MA 232,v,152,v,108
buffer_load_dwordx4 v178, s[8:11], s20 offen offset:2048 lds
MA 236,v,156,v,108
MA 200,v,152,v,104
buffer_load_dwordx2 v[48:49], v252, s[88:91], 0 offen
MA 204,v,156,v,104
MA 168,v,152,v,100
ds_read_b128 v[124:127], v193 offset:38912
buffer_load_dwordx4 v179, s[8:11], s20 offen offset:3072 lds
MA 172,v,156,v,100
MA 136,v,152,v,96
MA 140,v,156,v,96
MA 104,v,152,v,92
v_add_u32 v253, 18432, v229
MA 108,v,156,v,92
s_add_u32 m0, s22, 4096
MA 72,v,152,v,88
ds_read_b128 v[128:131], v193 offset:40960
MA 76,v,156,v,88
MA 40,v,152,v,84
MA 44,v,156,v,84
MA 8,v,152,v,80
TR 152,198,16384
TR 154,198,18432
MA 12,v,156,v,80
TR 156,199,16384
TR 158,199,18432
MA 16,v,160,v,80
ds_read_b128 v[132:135], v193 offset:43008
buffer_load_dwordx4 v180, s[8:11], s20 offen offset:0 lds
MA 20,v,164,v,80
buffer_load_dwordx2 v[34:35], v253, s[84:87], 0 offen
MA 48,v,160,v,84
MA 52,v,164,v,84
MA 80,v,160,v,88
buffer_load_dwordx4 v181, s[8:11], s20 offen offset:1024 lds
MA 84,v,164,v,88
buffer_load_dwordx2 v[50:51], v253, s[88:91], 0 offen
MA 112,v,160,v,92
MA 116,v,164,v,92
ds_read_b128 v[136:139], v193 offset:45056
MA 144,v,160,v,96
MA 148,v,164,v,96
buffer_load_dwordx4 v182, s[8:11], s20 offen offset:2048 lds
MA 176,v,160,v,100
MA 180,v,164,v,100
v_add_u32 v254, 20480, v229
MA 208,v,160,v,104
MA 212,v,164,v,104
ds_read_b128 v[140:143], v193 offset:47104
MA 240,v,160,v,108
TR 160,200,16384
TR 162,200,18432
MA 244,v,164,v,108
TR 164,201,16384
TR 166,201,18432
s_waitcnt lgkmcnt(15)
MA 248,v,168,v,108
buffer_load_dwordx4 v183, s[8:11], s20 offen offset:3072 lds
MA 252,v,172,v,108
buffer_load_dwordx2 v[36:37], v254, s[84:87], 0 offen
MA 216,v,168,v,104
MA 220,v,172,v,104
s_add_u32 s20, s20, 128
MA 184,v,168,v,100
MA 188,v,172,v,100
MA 152,v,168,v,96
MA 156,v,172,v,96
buffer_load_dwordx2 v[52:53], v254, s[88:91], 0 offen
MA 120,v,168,v,92
s_and_b32 s20, s20, 1023
MA 124,v,172,v,92
MA 88,v,168,v,88
MA 92,v,172,v,88
MA 56,v,168,v,84
MA 60,v,172,v,84
MA 24,v,168,v,80
TR 168,202,16384
TR 170,202,18432
MA 28,v,172,v,80
TR 172,203,16384
TR 174,203,18432
s_waitcnt lgkmcnt(4)
MA 0,v,144,v,112
MA 4,v,148,v,112
MA 32,v,144,v,116
MA 36,v,148,v,116
MA 64,v,144,v,120
MA 68,v,148,v,120
MA 96,v,144,v,124
MA 100,v,148,v,124
MA 128,v,144,v,128
MA 132,v,148,v,128
s_waitcnt vmcnt(15) lgkmcnt(0)
s_barrier
MA 160,v,144,v,132
s_add_u32 m0, s23, 0
s_and_b32 s37, s3, 3
MA 164,v,148,v,132
ds_read_b128 v[80:83], v194 offset:0
MA 192,v,144,v,136
s_cmp_eq_u32 s37, 0
s_cselect_b32 s37, 0, 0x40000000
MA 196,v,148,v,136
v_add_u32 v229, s37, v78
buffer_load_dword v79, v229, s[4:7], 0 offen
MA 224,v,144,v,140
TR 144,196,32768
TR 146,196,34816
MA 228,v,148,v,140
TR 148,197,32768
TR 150,197,34816
MA 232,v,152,v,140
ds_read_b128 v[84:87], v194 offset:2048
buffer_load_dwordx4 v184, s[12:15], s21 offen offset:0 lds
MA 236,v,156,v,140
s_add_u32 s84, s40, 50331648
s_addc_u32 s85, s41, 0
MA 200,v,152,v,136
buffer_load_dwordx4 v185, s[12:15], s21 offen offset:1024 lds
s_mov_b32 s86, 4194304
MA 204,v,156,v,136
s_mov_b32 s87, 0x20000
MA 168,v,152,v,132
s_add_u32 s88, s40, 58720256
s_addc_u32 s89, s41, 0
MA 172,v,156,v,132
ds_read_b128 v[88:91], v194 offset:4096
s_mov_b32 s90, 8192
MA 136,v,152,v,128
s_mov_b32 s91, 0x20000
v_mov_b32 v252, 0
MA 140,v,156,v,128
buffer_load_dwordx4 v186, s[12:15], s21 offen offset:2048 lds
v_mov_b32 v253, 0
MA 104,v,152,v,124
v_dot2_f32_bf16 v252, v230, v2, v252
v_dot2_f32_bf16 v253, v231, v3, v253
v_dot2_f32_bf16 v252, v232, v4, v252
v_dot2_f32_bf16 v253, v233, v5, v253
v_dot2_f32_bf16 v252, v234, v6, v252
v_dot2_f32_bf16 v253, v235, v7, v253
v_dot2_f32_bf16 v252, v236, v8, v252
v_dot2_f32_bf16 v253, v237, v9, v253
v_dot2_f32_bf16 v252, v238, v12, v252
v_dot2_f32_bf16 v253, v239, v13, v253
v_dot2_f32_bf16 v252, v240, v14, v252
v_dot2_f32_bf16 v253, v241, v15, v253
v_dot2_f32_bf16 v252, v242, v246, v252
v_dot2_f32_bf16 v253, v243, v247, v253
v_dot2_f32_bf16 v252, v244, v248, v252
v_dot2_f32_bf16 v253, v245, v249, v253
MA 108,v,156,v,124
MA 72,v,152,v,120
ds_read_b128 v[92:95], v194 offset:6144
MA 76,v,156,v,120
buffer_load_dwordx4 v187, s[12:15], s21 offen offset:3072 lds
MA 40,v,152,v,116
MA 44,v,156,v,116
MA 8,v,152,v,112
TR 152,198,32768
TR 154,198,34816
MA 12,v,156,v,112
TR 156,199,32768
TR 158,199,34816
MA 16,v,160,v,112
ds_read_b128 v[96:99], v194 offset:8192
s_add_u32 m0, s23, 4096
MA 20,v,164,v,112
s_nop 2
v_add_f32 v252, v252, v253
MA 48,v,160,v,116
MA 52,v,164,v,116
MA 80,v,160,v,120
ds_read_b128 v[100:103], v194 offset:10240
buffer_load_dwordx4 v188, s[12:15], s21 offen offset:0 lds
MA 84,v,164,v,120
v_add_f32_dpp v252, v252, v252 row_ror:8 row_mask:0xf bank_mask:0xf
s_nop 1
v_add_f32_dpp v252, v252, v252 row_ror:4 row_mask:0xf bank_mask:0xf
MA 112,v,160,v,124
s_nop 0
v_add_f32_dpp v252, v252, v252 row_ror:2 row_mask:0xf bank_mask:0xf
MA 116,v,164,v,124
s_nop 0
v_add_f32_dpp v252, v252, v252 row_ror:1 row_mask:0xf bank_mask:0xf
v_mov_b32 v253, v252
MA 144,v,160,v,128
buffer_load_dwordx4 v189, s[12:15], s21 offen offset:1024 lds
v_permlane16_swap_b32 v252, v253
MA 148,v,164,v,128
ds_read_b128 v[104:107], v194 offset:12288
v_add_f32 v252, v252, v253
MA 176,v,160,v,132
v_mul_f32 v252, 0xbfb8aa3b, v252
MA 180,v,164,v,132
v_exp_f32 v252, v252
MA 208,v,160,v,136
buffer_load_dwordx4 v190, s[12:15], s21 offen offset:2048 lds
v_add_f32 v252, 1.0, v252
MA 212,v,164,v,136
v_rcp_f32 v252, v252
MA 240,v,160,v,140
TR 160,200,32768
TR 162,200,34816
MA 244,v,164,v,140
TR 164,201,32768
TR 166,201,34816
MA 248,v,168,v,140
ds_read_b128 v[108:111], v194 offset:14336
MA 252,v,172,v,140
buffer_load_dwordx4 v191, s[12:15], s21 offen offset:3072 lds
MA 216,v,168,v,136
s_nop 0
buffer_store_dword v252, v11, s[88:91], 0 offen sc1
MA 220,v,172,v,136
s_getpc_b64 s[82:83]
L_ct_fK:
MA 184,v,168,v,132
s_add_u32 s82, s82, L_p2 - L_ct_fK
s_addc_u32 s83, s83, 0
MA 188,v,172,v,132
s_add_u32 s21, s21, 524288
v_mov_b32 v67, s83
MA 152,v,168,v,128
v_mov_b32 v66, s82
s_lshr_b32 s82, s2, 3
MA 156,v,172,v,128
s_lshl_b32 s82, s82, 2
s_add_u32 s82, s82, s3
MA 120,v,168,v,124
s_lshl_b32 s82, s82, 7
v_and_b32 v68, 3, v1
MA 124,v,172,v,124
s_and_b32 s21, s21, 4194303
v_lshlrev_b32 v68, 14, v68
MA 88,v,168,v,120
v_add_u32 v68, s82, v68
v_min_u32 v68, L_p3_begin - L_p2 - 4, v68
MA 92,v,172,v,120
v_add_co_u32 v66, vcc, v66, v68
s_nop 1
v_addc_co_u32 v67, vcc, 0, v67, vcc
MA 56,v,168,v,116
MA 60,v,172,v,116
global_load_dword v68, v[66:67], off
MA 24,v,168,v,112
TR 168,202,32768
TR 170,202,34816
MA 28,v,172,v,112
TR 172,203,32768
TR 174,203,34816
s_waitcnt lgkmcnt(4)
MA 0,v,144,v,80
s_add_u32 m0, s22, 32768
s_and_b32 s37, s3, 3
MA 4,v,148,v,80
ds_read_b128 v[112:115], v195 offset:0
MA 32,v,144,v,84
MA 36,v,148,v,84
MA 64,v,144,v,88
MA 68,v,148,v,88
buffer_load_dwordx4 v176, s[8:11], s20 offen offset:0 lds
MA 96,v,144,v,92
MA 100,v,148,v,92
ds_read_b128 v[116:119], v195 offset:2048
MA 128,v,144,v,96
MA 132,v,148,v,96
MA 160,v,144,v,100
buffer_load_dwordx4 v177, s[8:11], s20 offen offset:1024 lds
MA 164,v,148,v,100
MA 192,v,144,v,104
s_cmp_eq_u32 s37, 1
s_cselect_b32 s37, 0, 0x40000000
MA 196,v,148,v,104
ds_read_b128 v[120:123], v195 offset:4096
MA 224,v,144,v,108
TR 144,196,49152
TR 146,196,51200
MA 228,v,148,v,108
TR 148,197,49152
TR 150,197,51200
MA 232,v,152,v,108
buffer_load_dwordx4 v178, s[8:11], s20 offen offset:2048 lds
MA 236,v,156,v,108
MA 200,v,152,v,104
MA 204,v,156,v,104
MA 168,v,152,v,100
ds_read_b128 v[124:127], v195 offset:6144
buffer_load_dwordx4 v179, s[8:11], s20 offen offset:3072 lds
MA 172,v,156,v,100
MA 136,v,152,v,96
MA 140,v,156,v,96
MA 104,v,152,v,92
MA 108,v,156,v,92
s_add_u32 m0, s22, 36864
MA 72,v,152,v,88
ds_read_b128 v[128:131], v195 offset:8192
MA 76,v,156,v,88
MA 40,v,152,v,84
MA 44,v,156,v,84
MA 8,v,152,v,80
TR 152,198,49152
TR 154,198,51200
MA 12,v,156,v,80
TR 156,199,49152
TR 158,199,51200
MA 16,v,160,v,80
ds_read_b128 v[132:135], v195 offset:10240
buffer_load_dwordx4 v180, s[8:11], s20 offen offset:0 lds
MA 20,v,164,v,80
MA 48,v,160,v,84
MA 52,v,164,v,84
MA 80,v,160,v,88
buffer_load_dwordx4 v181, s[8:11], s20 offen offset:1024 lds
MA 84,v,164,v,88
v_add_u32 v229, s37, v78
MA 112,v,160,v,92
MA 116,v,164,v,92
ds_read_b128 v[136:139], v195 offset:12288
MA 144,v,160,v,96
MA 148,v,164,v,96
buffer_load_dwordx4 v182, s[8:11], s20 offen offset:2048 lds
MA 176,v,160,v,100
MA 180,v,164,v,100
MA 208,v,160,v,104
MA 212,v,164,v,104
ds_read_b128 v[140:143], v195 offset:14336
MA 240,v,160,v,108
TR 160,200,49152
TR 162,200,51200
MA 244,v,164,v,108
TR 164,201,49152
TR 166,201,51200
s_waitcnt lgkmcnt(15)
MA 248,v,168,v,108
buffer_load_dwordx4 v183, s[8:11], s20 offen offset:3072 lds
MA 252,v,172,v,108
buffer_load_dword v79, v229, s[4:7], 0 offen
MA 216,v,168,v,104
MA 220,v,172,v,104
s_add_u32 s20, s20, 128
MA 184,v,168,v,100
MA 188,v,172,v,100
MA 152,v,168,v,96
MA 156,v,172,v,96
MA 120,v,168,v,92
s_and_b32 s20, s20, 1023
MA 124,v,172,v,92
MA 88,v,168,v,88
MA 92,v,172,v,88
MA 56,v,168,v,84
MA 60,v,172,v,84
MA 24,v,168,v,80
TR 168,202,49152
TR 170,202,51200
MA 28,v,172,v,80
TR 172,203,49152
TR 174,203,51200
s_waitcnt lgkmcnt(4)
MA 0,v,144,v,112
MA 4,v,148,v,112
MA 32,v,144,v,116
MA 36,v,148,v,116
MA 64,v,144,v,120
MA 68,v,148,v,120
MA 96,v,144,v,124
MA 100,v,148,v,124
MA 128,v,144,v,128
MA 132,v,148,v,128
s_waitcnt vmcnt(11) lgkmcnt(0)
s_barrier
MA 160,v,144,v,132
s_add_u32 m0, s23, 32768
s_and_b32 s37, s3, 3
MA 164,v,148,v,132
ds_read_b128 v[80:83], v192 offset:0
MA 192,v,144,v,136
s_cmp_eq_u32 s37, 2
s_cselect_b32 s37, 0, 0x40000000
MA 196,v,148,v,136
v_add_u32 v229, s37, v78
buffer_load_dword v79, v229, s[4:7], 0 offen
MA 224,v,144,v,140
TR 144,196,0
TR 146,196,2048
MA 228,v,148,v,140
TR 148,197,0
TR 150,197,2048
MA 232,v,152,v,140
ds_read_b128 v[84:87], v192 offset:2048
buffer_load_dwordx4 v184, s[12:15], s21 offen offset:0 lds
MA 236,v,156,v,140
v_lshlrev_b32 v2, 16, v54
v_and_b32 v3, 0xffff0000, v54
MA 200,v,152,v,136
buffer_load_dwordx4 v185, s[12:15], s21 offen offset:1024 lds
v_lshlrev_b32 v4, 16, v55
MA 204,v,156,v,136
v_and_b32 v5, 0xffff0000, v55
v_lshlrev_b32 v6, 16, v56
MA 168,v,152,v,132
v_and_b32 v7, 0xffff0000, v56
v_lshlrev_b32 v8, 16, v57
MA 172,v,156,v,132
ds_read_b128 v[88:91], v192 offset:4096
v_and_b32 v9, 0xffff0000, v57
MA 136,v,152,v,128
v_lshlrev_b32 v230, 16, v16
v_and_b32 v231, 0xffff0000, v16
MA 140,v,156,v,128
buffer_load_dwordx4 v186, s[12:15], s21 offen offset:2048 lds
v_lshlrev_b32 v232, 16, v18
MA 104,v,152,v,124
v_and_b32 v233, 0xffff0000, v18
v_lshlrev_b32 v234, 16, v20
MA 108,v,156,v,124
v_and_b32 v235, 0xffff0000, v20
v_lshlrev_b32 v236, 16, v22
MA 72,v,152,v,120
ds_read_b128 v[92:95], v192 offset:6144
v_and_b32 v237, 0xffff0000, v22
MA 76,v,156,v,120
buffer_load_dwordx4 v187, s[12:15], s21 offen offset:3072 lds
v_lshlrev_b32 v238, 16, v24
MA 40,v,152,v,116
v_and_b32 v239, 0xffff0000, v24
v_lshlrev_b32 v240, 16, v26
MA 44,v,156,v,116
v_and_b32 v241, 0xffff0000, v26
v_lshlrev_b32 v242, 16, v28
MA 8,v,152,v,112
TR 152,198,0
TR 154,198,2048
MA 12,v,156,v,112
TR 156,199,0
TR 158,199,2048
MA 16,v,160,v,112
ds_read_b128 v[96:99], v192 offset:8192
s_add_u32 m0, s23, 36864
MA 20,v,164,v,112
v_and_b32 v243, 0xffff0000, v28
v_lshlrev_b32 v244, 16, v30
MA 48,v,160,v,116
v_and_b32 v245, 0xffff0000, v30
v_lshlrev_b32 v246, 16, v32
MA 52,v,164,v,116
v_and_b32 v247, 0xffff0000, v32
v_lshlrev_b32 v248, 16, v34
MA 80,v,160,v,120
ds_read_b128 v[100:103], v192 offset:10240
buffer_load_dwordx4 v188, s[12:15], s21 offen offset:0 lds
MA 84,v,164,v,120
v_and_b32 v249, 0xffff0000, v34
v_lshlrev_b32 v250, 16, v36
MA 112,v,160,v,124
v_and_b32 v251, 0xffff0000, v36
v_lshlrev_b32 v254, 16, v38
MA 116,v,164,v,124
v_and_b32 v255, 0xffff0000, v38
v_mul_f32 v62, v236, v2
MA 144,v,160,v,128
buffer_load_dwordx4 v189, s[12:15], s21 offen offset:1024 lds
v_mul_f32 v70, v237, v6
MA 148,v,164,v,128
ds_read_b128 v[104:107], v192 offset:12288
v_fmac_f32 v62, v234, v3
MA 176,v,160,v,132
v_fmac_f32 v70, v235, v7
v_fmac_f32 v62, v232, v4
MA 180,v,164,v,132
v_fmac_f32 v70, v233, v8
v_fmac_f32 v62, v230, v5
MA 208,v,160,v,136
buffer_load_dwordx4 v190, s[12:15], s21 offen offset:2048 lds
v_fmac_f32 v70, v231, v9
MA 212,v,164,v,136
v_mul_f32 v62, v62, v254
v_mul_f32 v70, v70, v255
MA 240,v,160,v,140
TR 160,200,0
TR 162,200,2048
MA 244,v,164,v,140
TR 164,201,0
TR 166,201,2048
MA 248,v,168,v,140
ds_read_b128 v[108:111], v192 offset:14336
v_lshlrev_b32 v254, 16, v40
MA 252,v,172,v,140
buffer_load_dwordx4 v191, s[12:15], s21 offen offset:3072 lds
v_and_b32 v255, 0xffff0000, v40
MA 216,v,168,v,136
v_mul_f32 v63, v238, v2
v_mul_f32 v71, v239, v6
MA 220,v,172,v,136
v_fmac_f32 v63, v236, v3
v_fmac_f32 v71, v237, v7
MA 184,v,168,v,132
v_fmac_f32 v63, v234, v4
v_fmac_f32 v71, v235, v8
MA 188,v,172,v,132
s_add_u32 s21, s21, 524288
v_fmac_f32 v63, v232, v5
MA 152,v,168,v,128
v_fmac_f32 v71, v233, v9
v_mul_f32 v63, v63, v254
MA 156,v,172,v,128
v_mul_f32 v71, v71, v255
v_lshlrev_b32 v254, 16, v42
MA 120,v,168,v,124
v_and_b32 v255, 0xffff0000, v42
v_mul_f32 v64, v240, v2
MA 124,v,172,v,124
s_and_b32 s21, s21, 4194303
v_mul_f32 v72, v241, v6
MA 88,v,168,v,120
v_fmac_f32 v64, v238, v3
v_fmac_f32 v72, v239, v7
MA 92,v,172,v,120
v_fmac_f32 v64, v236, v4
v_fmac_f32 v72, v237, v8
MA 56,v,168,v,116
v_fmac_f32 v64, v234, v5
v_fmac_f32 v72, v235, v9
MA 60,v,172,v,116
v_mul_f32 v64, v64, v254
v_mul_f32 v72, v72, v255
MA 24,v,168,v,112
TR 168,202,0
TR 170,202,2048
MA 28,v,172,v,112
TR 172,203,0
TR 174,203,2048
v_lshlrev_b32 v254, 16, v44
v_and_b32 v255, 0xffff0000, v44
v_mul_f32 v65, v242, v2
s_waitcnt lgkmcnt(4)
MA 0,v,144,v,80
s_add_u32 s75, s64, s74
s_and_b32 s37, s3, 3
MA 4,v,148,v,80
ds_read_b128 v[112:115], v193 offset:0
MA 32,v,144,v,84
s_cmp_eq_u32 s37, 3
s_cselect_b32 s37, 0, 0x40000000
MA 36,v,148,v,84
v_add_u32 v229, s37, v78
buffer_load_dword v79, v229, s[4:7], 0 offen
MA 64,v,144,v,88
s_add_u32 m0, s67, 65536
v_mul_f32 v73, v243, v6
MA 68,v,148,v,88
v_fmac_f32 v65, v240, v3
v_fmac_f32 v73, v241, v7
MA 96,v,144,v,92
v_fmac_f32 v65, v238, v4
MA 100,v,148,v,92
ds_read_b128 v[116:119], v193 offset:2048
v_fmac_f32 v73, v239, v8
MA 128,v,144,v,96
buffer_load_dwordx4 v208, s[44:47], s75 offen offset:0 lds
v_fmac_f32 v65, v236, v5
MA 132,v,148,v,96
v_fmac_f32 v73, v237, v9
MA 160,v,144,v,100
v_mul_f32 v65, v65, v254
v_mul_f32 v73, v73, v255
MA 164,v,148,v,100
v_lshlrev_b32 v254, 16, v46
MA 192,v,144,v,104
v_and_b32 v255, 0xffff0000, v46
MA 196,v,148,v,104
ds_read_b128 v[120:123], v193 offset:4096
buffer_load_dwordx4 v209, s[44:47], s75 offen offset:1024 lds
MA 224,v,144,v,108
TR 144,196,16384
TR 146,196,18432
MA 228,v,148,v,108
TR 148,197,16384
TR 150,197,18432
MA 232,v,152,v,108
v_mul_f32 v66, v244, v2
v_mul_f32 v74, v245, v6
MA 236,v,156,v,108
buffer_load_dwordx4 v210, s[44:47], s75 offen offset:2048 lds
v_fmac_f32 v66, v242, v3
MA 200,v,152,v,104
v_fmac_f32 v74, v243, v7
v_fmac_f32 v66, v240, v4
MA 204,v,156,v,104
v_fmac_f32 v74, v241, v8
v_fmac_f32 v66, v238, v5
MA 168,v,152,v,100
ds_read_b128 v[124:127], v193 offset:6144
v_fmac_f32 v74, v239, v9
MA 172,v,156,v,100
v_mul_f32 v66, v66, v254
v_mul_f32 v74, v74, v255
MA 136,v,152,v,96
buffer_load_dwordx4 v211, s[44:47], s75 offen offset:3072 lds
v_lshlrev_b32 v254, 16, v48
MA 140,v,156,v,96
v_and_b32 v255, 0xffff0000, v48
v_mul_f32 v67, v246, v2
MA 104,v,152,v,92
v_mul_f32 v75, v247, v6
MA 108,v,156,v,92
v_fmac_f32 v67, v244, v3
v_fmac_f32 v75, v245, v7
MA 72,v,152,v,88
ds_read_b128 v[128:131], v193 offset:8192
s_add_u32 s75, s65, s74
MA 76,v,156,v,88
v_fmac_f32 v67, v242, v4
v_fmac_f32 v75, v243, v8
MA 40,v,152,v,84
v_fmac_f32 v67, v240, v5
MA 44,v,156,v,84
v_fmac_f32 v75, v241, v9
MA 8,v,152,v,80
TR 152,198,16384
TR 154,198,18432
MA 12,v,156,v,80
TR 156,199,16384
TR 158,199,18432
MA 16,v,160,v,80
ds_read_b128 v[132:135], v193 offset:10240
s_add_u32 m0, s67, 69632
MA 20,v,164,v,80
v_mul_f32 v67, v67, v254
v_mul_f32 v75, v75, v255
MA 48,v,160,v,84
v_lshlrev_b32 v254, 16, v50
v_and_b32 v255, 0xffff0000, v50
MA 52,v,164,v,84
buffer_load_dwordx4 v208, s[44:47], s75 offen offset:0 lds
s_waitcnt vmcnt(24)
v_mul_f32 v68, v248, v2
MA 80,v,160,v,88
v_mul_f32 v76, v249, v6
v_fmac_f32 v68, v246, v3
MA 84,v,164,v,88
v_fmac_f32 v76, v247, v7
v_fmac_f32 v68, v244, v4
MA 112,v,160,v,92
v_fmac_f32 v76, v245, v8
v_fmac_f32 v68, v242, v5
MA 116,v,164,v,92
ds_read_b128 v[136:139], v193 offset:12288
buffer_load_dwordx4 v209, s[44:47], s75 offen offset:1024 lds
MA 144,v,160,v,96
v_fmac_f32 v76, v243, v9
v_mul_f32 v68, v68, v254
MA 148,v,164,v,96
v_mul_f32 v76, v76, v255
v_lshlrev_b32 v254, 16, v52
MA 176,v,160,v,100
v_and_b32 v255, 0xffff0000, v52
MA 180,v,164,v,100
v_mul_f32 v69, v250, v2
MA 208,v,160,v,104
buffer_load_dwordx4 v210, s[44:47], s75 offen offset:2048 lds
v_mul_f32 v77, v251, v6
MA 212,v,164,v,104
ds_read_b128 v[140:143], v193 offset:14336
v_fmac_f32 v69, v248, v3
MA 240,v,160,v,108
TR 160,200,16384
TR 162,200,18432
MA 244,v,164,v,108
TR 164,201,16384
TR 166,201,18432
s_waitcnt lgkmcnt(15)
MA 248,v,168,v,108
buffer_load_dwordx4 v211, s[44:47], s75 offen offset:3072 lds
v_fmac_f32 v77, v249, v7
MA 252,v,172,v,108
v_fmac_f32 v69, v246, v4
v_fmac_f32 v77, v247, v8
MA 216,v,168,v,104
v_fmac_f32 v69, v244, v5
v_fmac_f32 v77, v245, v9
MA 220,v,172,v,104
v_mul_f32 v69, v69, v254
v_mul_f32 v77, v77, v255
MA 184,v,168,v,100
v_cvt_pk_bf16_f32 v12, v69, v68
v_cvt_pk_bf16_f32 v13, v67, v66
MA 188,v,172,v,100
s_add_u32 s74, s74, 128
v_cvt_pk_bf16_f32 v14, v65, v64
MA 152,v,168,v,96
v_cvt_pk_bf16_f32 v15, v63, v62
MA 156,v,172,v,96
s_mov_b32 s36, 0
MA 120,v,168,v,92
buffer_store_dwordx4 v[12:15], v10, s[84:87], s36 offen sc1
v_cvt_pk_bf16_f32 v54, v77, v76
MA 124,v,172,v,92
s_and_b32 s74, s74, 2047
v_cvt_pk_bf16_f32 v55, v75, v74
MA 88,v,168,v,88
v_cvt_pk_bf16_f32 v56, v73, v72
MA 92,v,172,v,88
v_cvt_pk_bf16_f32 v57, v71, v70
MA 56,v,168,v,84
s_mov_b32 s36, 4096
MA 60,v,172,v,84
buffer_store_dwordx4 v[54:57], v10, s[84:87], s36 offen sc1
MA 24,v,168,v,80
TR 168,202,16384
TR 170,202,18432
MA 28,v,172,v,80
TR 172,203,16384
TR 174,203,18432
s_waitcnt lgkmcnt(4)
MA 0,v,144,v,112
MA 4,v,148,v,112
MA 32,v,144,v,116
MA 36,v,148,v,116
MA 64,v,144,v,120
MA 68,v,148,v,120
MA 96,v,144,v,124
MA 100,v,148,v,124
MA 128,v,144,v,128
MA 132,v,148,v,128
s_waitcnt vmcnt(11) lgkmcnt(0)
s_barrier
MA 160,v,144,v,132
s_add_u32 m0, s68, 98304
v_lshlrev_b32 v2, 16, v58
MA 164,v,148,v,132
ds_read_b128 v[80:83], v192 offset:32768
v_and_b32 v3, 0xffff0000, v58
MA 192,v,144,v,136
v_lshlrev_b32 v4, 16, v59
v_and_b32 v5, 0xffff0000, v59
MA 196,v,148,v,136
buffer_load_dwordx4 v212, s[48:51], s66 offen offset:0 lds
v_lshlrev_b32 v6, 16, v60
MA 224,v,144,v,140
TR 144,196,32768
TR 146,196,34816
MA 228,v,148,v,140
TR 148,197,32768
TR 150,197,34816
MA 232,v,152,v,140
ds_read_b128 v[84:87], v192 offset:34816
v_and_b32 v7, 0xffff0000, v60
MA 236,v,156,v,140
buffer_load_dwordx4 v213, s[48:51], s66 offen offset:1024 lds
v_lshlrev_b32 v8, 16, v61
MA 200,v,152,v,136
v_and_b32 v9, 0xffff0000, v61
v_lshlrev_b32 v230, 16, v17
MA 204,v,156,v,136
v_and_b32 v231, 0xffff0000, v17
v_lshlrev_b32 v232, 16, v19
MA 168,v,152,v,132
v_and_b32 v233, 0xffff0000, v19
v_lshlrev_b32 v234, 16, v21
MA 172,v,156,v,132
ds_read_b128 v[88:91], v192 offset:36864
buffer_load_dwordx4 v214, s[48:51], s66 offen offset:2048 lds
MA 136,v,152,v,128
v_and_b32 v235, 0xffff0000, v21
v_lshlrev_b32 v236, 16, v23
MA 140,v,156,v,128
v_and_b32 v237, 0xffff0000, v23
v_lshlrev_b32 v238, 16, v25
MA 104,v,152,v,124
buffer_load_dwordx4 v215, s[48:51], s66 offen offset:3072 lds
v_and_b32 v239, 0xffff0000, v25
MA 108,v,156,v,124
v_lshlrev_b32 v240, 16, v27
v_and_b32 v241, 0xffff0000, v27
MA 72,v,152,v,120
ds_read_b128 v[92:95], v192 offset:38912
v_lshlrev_b32 v242, 16, v29
MA 76,v,156,v,120
v_and_b32 v243, 0xffff0000, v29
v_lshlrev_b32 v244, 16, v31
MA 40,v,152,v,116
s_add_u32 s66, s66, 524288
v_and_b32 v245, 0xffff0000, v31
MA 44,v,156,v,116
v_lshlrev_b32 v246, 16, v33
v_and_b32 v247, 0xffff0000, v33
MA 8,v,152,v,112
TR 152,198,32768
TR 154,198,34816
MA 12,v,156,v,112
TR 156,199,32768
TR 158,199,34816
MA 16,v,160,v,112
ds_read_b128 v[96:99], v192 offset:40960
s_and_b32 s66, s66, 8388607
MA 20,v,164,v,112
v_lshlrev_b32 v248, 16, v35
v_and_b32 v249, 0xffff0000, v35
MA 48,v,160,v,116
v_lshlrev_b32 v250, 16, v37
v_and_b32 v251, 0xffff0000, v37
MA 52,v,164,v,116
v_lshlrev_b32 v254, 16, v39
v_and_b32 v255, 0xffff0000, v39
MA 80,v,160,v,120
ds_read_b128 v[100:103], v192 offset:43008
s_add_u32 m0, s68, 114688
MA 84,v,164,v,120
v_mul_f32 v62, v236, v2
v_mul_f32 v70, v237, v6
MA 112,v,160,v,124
v_fmac_f32 v62, v234, v3
v_fmac_f32 v70, v235, v7
MA 116,v,164,v,124
buffer_load_dwordx4 v212, s[48:51], s66 offen offset:0 lds
v_fmac_f32 v62, v232, v4
MA 144,v,160,v,128
v_fmac_f32 v70, v233, v8
v_fmac_f32 v62, v230, v5
MA 148,v,164,v,128
ds_read_b128 v[104:107], v192 offset:45056
v_fmac_f32 v70, v231, v9
MA 176,v,160,v,132
v_mul_f32 v62, v62, v254
v_mul_f32 v70, v70, v255
MA 180,v,164,v,132
buffer_load_dwordx4 v213, s[48:51], s66 offen offset:1024 lds
v_lshlrev_b32 v254, 16, v41
MA 208,v,160,v,136
v_and_b32 v255, 0xffff0000, v41
v_mul_f32 v63, v238, v2
MA 212,v,164,v,136
v_mul_f32 v71, v239, v6
v_fmac_f32 v63, v236, v3
MA 240,v,160,v,140
TR 160,200,32768
TR 162,200,34816
MA 244,v,164,v,140
TR 164,201,32768
TR 166,201,34816
MA 248,v,168,v,140
ds_read_b128 v[108:111], v192 offset:47104
buffer_load_dwordx4 v214, s[48:51], s66 offen offset:2048 lds
MA 252,v,172,v,140
v_fmac_f32 v71, v237, v7
v_fmac_f32 v63, v234, v4
MA 216,v,168,v,136
buffer_load_dwordx4 v215, s[48:51], s66 offen offset:3072 lds
v_fmac_f32 v71, v235, v8
MA 220,v,172,v,136
v_fmac_f32 v63, v232, v5
v_fmac_f32 v71, v233, v9
MA 184,v,168,v,132
v_mul_f32 v63, v63, v254
v_mul_f32 v71, v71, v255
MA 188,v,172,v,132
v_lshlrev_b32 v254, 16, v43
v_and_b32 v255, 0xffff0000, v43
MA 152,v,168,v,128
s_add_u32 s66, s66, 524288
v_mul_f32 v64, v240, v2
MA 156,v,172,v,128
v_mul_f32 v72, v241, v6
v_fmac_f32 v64, v238, v3
MA 120,v,168,v,124
v_fmac_f32 v72, v239, v7
v_fmac_f32 v64, v236, v4
MA 124,v,172,v,124
v_fmac_f32 v72, v237, v8
v_fmac_f32 v64, v234, v5
MA 88,v,168,v,120
s_and_b32 s66, s66, 8388607
v_fmac_f32 v72, v235, v9
MA 92,v,172,v,120
v_mul_f32 v64, v64, v254
v_mul_f32 v72, v72, v255
MA 56,v,168,v,116
v_lshlrev_b32 v254, 16, v45
v_and_b32 v255, 0xffff0000, v45
MA 60,v,172,v,116
v_mul_f32 v65, v242, v2
MA 24,v,168,v,112
TR 168,202,32768
TR 170,202,34816
MA 28,v,172,v,112
TR 172,203,32768
TR 174,203,34816
s_waitcnt lgkmcnt(4)
MA 0,v,144,v,80
s_add_u32 s75, s64, s74
v_mul_f32 v73, v243, v6
MA 4,v,148,v,80
ds_read_b128 v[112:115], v193 offset:32768
v_fmac_f32 v65, v240, v3
MA 32,v,144,v,84
v_fmac_f32 v73, v241, v7
v_fmac_f32 v65, v238, v4
MA 36,v,148,v,84
v_fmac_f32 v73, v239, v8
MA 64,v,144,v,88
s_add_u32 m0, s67, 0
v_fmac_f32 v65, v236, v5
MA 68,v,148,v,88
v_fmac_f32 v73, v237, v9
MA 96,v,144,v,92
v_mul_f32 v65, v65, v254
MA 100,v,148,v,92
ds_read_b128 v[116:119], v193 offset:34816
v_mul_f32 v73, v73, v255
MA 128,v,144,v,96
buffer_load_dwordx4 v208, s[44:47], s75 offen offset:0 lds
v_lshlrev_b32 v254, 16, v47
MA 132,v,148,v,96
v_and_b32 v255, 0xffff0000, v47
v_mul_f32 v66, v244, v2
MA 160,v,144,v,100
v_mul_f32 v74, v245, v6
MA 164,v,148,v,100
v_fmac_f32 v66, v242, v3
MA 192,v,144,v,104
v_fmac_f32 v74, v243, v7
MA 196,v,148,v,104
ds_read_b128 v[120:123], v193 offset:36864
buffer_load_dwordx4 v209, s[44:47], s75 offen offset:1024 lds
MA 224,v,144,v,108
TR 144,196,49152
TR 146,196,51200
MA 228,v,148,v,108
TR 148,197,49152
TR 150,197,51200
MA 232,v,152,v,108
v_fmac_f32 v66, v240, v4
v_fmac_f32 v74, v241, v8
MA 236,v,156,v,108
buffer_load_dwordx4 v210, s[44:47], s75 offen offset:2048 lds
v_fmac_f32 v66, v238, v5
MA 200,v,152,v,104
v_fmac_f32 v74, v239, v9
v_mul_f32 v66, v66, v254
MA 204,v,156,v,104
v_mul_f32 v74, v74, v255
v_lshlrev_b32 v254, 16, v49
MA 168,v,152,v,100
ds_read_b128 v[124:127], v193 offset:38912
v_and_b32 v255, 0xffff0000, v49
MA 172,v,156,v,100
v_mul_f32 v67, v246, v2
v_mul_f32 v75, v247, v6
MA 136,v,152,v,96
buffer_load_dwordx4 v211, s[44:47], s75 offen offset:3072 lds
v_fmac_f32 v67, v244, v3
MA 140,v,156,v,96
v_fmac_f32 v75, v245, v7
v_fmac_f32 v67, v242, v4
MA 104,v,152,v,92
v_fmac_f32 v75, v243, v8
MA 108,v,156,v,92
v_fmac_f32 v67, v240, v5
MA 72,v,152,v,88
ds_read_b128 v[128:131], v193 offset:40960
s_add_u32 s75, s65, s74
MA 76,v,156,v,88
v_fmac_f32 v75, v241, v9
v_mul_f32 v67, v67, v254
MA 40,v,152,v,84
v_mul_f32 v75, v75, v255
MA 44,v,156,v,84
v_lshlrev_b32 v254, 16, v51
MA 8,v,152,v,80
TR 152,198,49152
TR 154,198,51200
MA 12,v,156,v,80
TR 156,199,49152
TR 158,199,51200
MA 16,v,160,v,80
ds_read_b128 v[132:135], v193 offset:43008
s_add_u32 m0, s67, 4096
MA 20,v,164,v,80
v_and_b32 v255, 0xffff0000, v51
v_mul_f32 v68, v248, v2
MA 48,v,160,v,84
v_mul_f32 v76, v249, v6
v_fmac_f32 v68, v246, v3
MA 52,v,164,v,84
buffer_load_dwordx4 v208, s[44:47], s75 offen offset:0 lds
v_fmac_f32 v76, v247, v7
MA 80,v,160,v,88
v_fmac_f32 v68, v244, v4
v_fmac_f32 v76, v245, v8
MA 84,v,164,v,88
v_fmac_f32 v68, v242, v5
v_fmac_f32 v76, v243, v9
MA 112,v,160,v,92
v_mul_f32 v68, v68, v254
v_mul_f32 v76, v76, v255
MA 116,v,164,v,92
ds_read_b128 v[136:139], v193 offset:45056
buffer_load_dwordx4 v209, s[44:47], s75 offen offset:1024 lds
MA 144,v,160,v,96
v_lshlrev_b32 v254, 16, v53
v_and_b32 v255, 0xffff0000, v53
MA 148,v,164,v,96
v_mul_f32 v69, v250, v2
MA 176,v,160,v,100
v_mul_f32 v77, v251, v6
MA 180,v,164,v,100
v_fmac_f32 v69, v248, v3
MA 208,v,160,v,104
buffer_load_dwordx4 v210, s[44:47], s75 offen offset:2048 lds
v_fmac_f32 v77, v249, v7
MA 212,v,164,v,104
ds_read_b128 v[140:143], v193 offset:47104
v_fmac_f32 v69, v246, v4
MA 240,v,160,v,108
TR 160,200,49152
TR 162,200,51200
MA 244,v,164,v,108
TR 164,201,49152
TR 166,201,51200
s_waitcnt lgkmcnt(15)
MA 248,v,168,v,108
buffer_load_dwordx4 v211, s[44:47], s75 offen offset:3072 lds
v_fmac_f32 v77, v247, v8
MA 252,v,172,v,108
v_fmac_f32 v69, v244, v5
v_fmac_f32 v77, v245, v9
MA 216,v,168,v,104
v_mul_f32 v69, v69, v254
v_mul_f32 v77, v77, v255
MA 220,v,172,v,104
v_cvt_pk_bf16_f32 v230, v69, v68
v_cvt_pk_bf16_f32 v231, v67, v66
MA 184,v,168,v,100
v_cvt_pk_bf16_f32 v232, v65, v64
MA 188,v,172,v,100
s_add_u32 s74, s74, 128
v_cvt_pk_bf16_f32 v233, v63, v62
MA 152,v,168,v,96
s_mov_b32 s36, 8192
buffer_store_dwordx4 v[230:233], v10, s[84:87], s36 offen sc1
MA 156,v,172,v,96
v_cvt_pk_bf16_f32 v234, v77, v76
MA 120,v,168,v,92
v_cvt_pk_bf16_f32 v235, v75, v74
MA 124,v,172,v,92
s_and_b32 s74, s74, 2047
v_cvt_pk_bf16_f32 v236, v73, v72
MA 88,v,168,v,88
v_cvt_pk_bf16_f32 v237, v71, v70
MA 92,v,172,v,88
s_mov_b32 s36, 12288
MA 56,v,168,v,84
buffer_store_dwordx4 v[234:237], v10, s[84:87], s36 offen sc1
MA 60,v,172,v,84
v_lshlrev_b32 v228, 4, v1
MA 24,v,168,v,80
TR 168,202,49152
TR 170,202,51200
MA 28,v,172,v,80
TR 172,203,49152
TR 174,203,51200
s_waitcnt lgkmcnt(4)
MA 0,v,144,v,112
MA 4,v,148,v,112
MA 32,v,144,v,116
MA 36,v,148,v,116
MA 64,v,144,v,120
MA 68,v,148,v,120
MA 96,v,144,v,124
MA 100,v,148,v,124
MA 128,v,144,v,128
MA 132,v,148,v,128
s_waitcnt vmcnt(14) lgkmcnt(0)
s_barrier
MA 160,v,144,v,132
ds_read_b128 v[48:51], v226 offset:0
s_add_u32 m0, s68, 131072
MA 164,v,148,v,132
MA 192,v,144,v,136
ds_read_b128 v[52:55], v226 offset:2048
buffer_load_dwordx4 v212, s[48:51], s66 offen offset:0 lds
MA 196,v,148,v,136
MA 224,v,144,v,140
ds_read_b128 v[56:59], v226 offset:4096
buffer_load_dwordx4 v213, s[48:51], s66 offen offset:1024 lds
MA 228,v,148,v,140
MA 232,v,152,v,140
ds_read_b128 v[60:63], v226 offset:6144
MA 236,v,156,v,140
buffer_load_dwordx4 v214, s[48:51], s66 offen offset:2048 lds
MA 200,v,152,v,136
TR 16,216,0
MA 204,v,156,v,136
buffer_load_dwordx4 v215, s[48:51], s66 offen offset:3072 lds
MA 168,v,152,v,132
TR 18,216,1024
MA 172,v,156,v,132
MA 136,v,152,v,128
TR 20,217,0
s_add_u32 s66, s66, 524288
MA 140,v,156,v,128
MA 104,v,152,v,124
TR 22,217,1024
s_and_b32 s66, s66, 8388607
MA 108,v,156,v,124
MA 72,v,152,v,120
TR 24,218,0
MA 76,v,156,v,120
s_add_u32 s75, s64, s74
MA 40,v,152,v,116
TR 26,218,1024
MA 44,v,156,v,116
s_add_u32 m0, s67, 32768
MA 8,v,152,v,112
TR 28,219,0
MA 12,v,156,v,112
MA 16,v,160,v,112
TR 30,219,1024
buffer_load_dwordx4 v208, s[44:47], s75 offen offset:0 lds
MA 20,v,164,v,112
MA 48,v,160,v,116
TR 32,220,0
buffer_load_dwordx4 v209, s[44:47], s75 offen offset:1024 lds
MA 52,v,164,v,116
MA 80,v,160,v,120
TR 34,220,1024
MA 84,v,164,v,120
buffer_load_dwordx4 v210, s[44:47], s75 offen offset:2048 lds
MA 112,v,160,v,124
TR 36,221,0
MA 116,v,164,v,124
buffer_load_dwordx4 v211, s[44:47], s75 offen offset:3072 lds
MA 144,v,160,v,128
TR 38,221,1024
MA 148,v,164,v,128
MA 176,v,160,v,132
TR 40,222,0
s_add_u32 s75, s65, s74
MA 180,v,164,v,132
MA 208,v,160,v,136
TR 42,222,1024
s_add_u32 m0, s67, 36864
MA 212,v,164,v,136
MA 240,v,160,v,140
TR 44,223,0
MA 244,v,164,v,140
buffer_load_dwordx4 v208, s[44:47], s75 offen offset:0 lds
MA 248,v,168,v,140
TR 46,223,1024
MA 252,v,172,v,140
buffer_load_dwordx4 v209, s[44:47], s75 offen offset:1024 lds
MA 216,v,168,v,136
MA 220,v,172,v,136
MA 184,v,168,v,132
buffer_load_dwordx4 v210, s[44:47], s75 offen offset:2048 lds
MA 188,v,172,v,132
MA 152,v,168,v,128
buffer_load_dwordx4 v211, s[44:47], s75 offen offset:3072 lds
MA 156,v,172,v,128
MA 120,v,168,v,124
MA 124,v,172,v,124
s_add_u32 s74, s74, 128
MA 88,v,168,v,120
MA 92,v,172,v,120
s_and_b32 s74, s74, 2047
MA 56,v,168,v,116
MA 60,v,172,v,116
MA 24,v,168,v,112
MA 28,v,172,v,112
s_branch L_p2
L_p1_V:
s_waitcnt lgkmcnt(14)
v_mfma_f32_16x16x32_bf16 a[0:3], v[80:83], v[144:147], 0
s_add_u32 m0, s22, 32768
s_mov_b32 s86, 4194304
s_waitcnt lgkmcnt(12)
v_mfma_f32_16x16x32_bf16 a[8:11], v[80:83], v[148:151], 0
ds_read_b128 v[112:115], v193 offset:0
s_mov_b32 s87, 0x20000
v_mfma_f32_16x16x32_bf16 a[4:7], v[84:87], v[144:147], 0
v_mfma_f32_16x16x32_bf16 a[12:15], v[84:87], v[148:151], 0
s_mov_b32 s90, 4194304
v_mfma_f32_16x16x32_bf16 a[64:67], v[88:91], v[144:147], 0
s_mov_b32 s91, 0x20000
v_mfma_f32_16x16x32_bf16 a[72:75], v[88:91], v[148:151], 0
buffer_load_dwordx4 v176, s[8:11], s20 offen offset:0 lds
v_mfma_f32_16x16x32_bf16 a[68:71], v[92:95], v[144:147], 0
s_mov_b32 s94, 4194304
v_mfma_f32_16x16x32_bf16 a[76:79], v[92:95], v[148:151], 0
ds_read_b128 v[116:119], v193 offset:2048
s_mov_b32 s95, 0x20000
v_mfma_f32_16x16x32_bf16 a[128:131], v[96:99], v[144:147], 0
v_mfma_f32_16x16x32_bf16 a[136:139], v[96:99], v[148:151], 0
s_mov_b32 s98, 8192
v_mfma_f32_16x16x32_bf16 a[132:135], v[100:103], v[144:147], 0
buffer_load_dwordx4 v177, s[8:11], s20 offen offset:1024 lds
s_mov_b32 s99, 0x20000
v_mfma_f32_16x16x32_bf16 a[140:143], v[100:103], v[148:151], 0
v_mfma_f32_16x16x32_bf16 a[192:195], v[104:107], v[144:147], 0
s_mov_b32 s78, 2048
v_mfma_f32_16x16x32_bf16 a[200:203], v[104:107], v[148:151], 0
ds_read_b128 v[120:123], v193 offset:4096
s_mov_b32 s79, 0x20000
v_mfma_f32_16x16x32_bf16 a[196:199], v[108:111], v[144:147], 0
TR 144,196,16384
TR 146,196,18432
v_mfma_f32_16x16x32_bf16 a[204:207], v[108:111], v[148:151], 0
TR 148,197,16384
TR 150,197,18432
s_waitcnt lgkmcnt(15)
v_mfma_f32_16x16x32_bf16 a[212:215], v[108:111], v[152:155], 0
buffer_load_dwordx4 v178, s[8:11], s20 offen offset:2048 lds
s_and_b32 s36, s2, 15
v_mfma_f32_16x16x32_bf16 a[220:223], v[108:111], v[156:159], 0
s_lshl_b32 s36, s36, 1
v_mfma_f32_16x16x32_bf16 a[208:211], v[104:107], v[152:155], 0
s_lshr_b32 s37, s3, 1
v_mfma_f32_16x16x32_bf16 a[216:219], v[104:107], v[156:159], 0
s_add_u32 s36, s36, s37
v_mfma_f32_16x16x32_bf16 a[148:151], v[100:103], v[152:155], 0
ds_read_b128 v[124:127], v193 offset:6144
buffer_load_dwordx4 v179, s[8:11], s20 offen offset:3072 lds
v_mfma_f32_16x16x32_bf16 a[156:159], v[100:103], v[156:159], 0
s_lshl_b32 s36, s36, 3
v_mfma_f32_16x16x32_bf16 a[144:147], v[96:99], v[152:155], 0
v_and_b32 v252, 7, v1
v_mfma_f32_16x16x32_bf16 a[152:155], v[96:99], v[156:159], 0
v_mfma_f32_16x16x32_bf16 a[84:87], v[92:95], v[152:155], 0
v_add_u32 v252, s36, v252
v_mfma_f32_16x16x32_bf16 a[92:95], v[92:95], v[156:159], 0
s_add_u32 m0, s22, 36864
s_lshr_b32 s36, s2, 4
v_mfma_f32_16x16x32_bf16 a[80:83], v[88:91], v[152:155], 0
ds_read_b128 v[128:131], v193 offset:8192
v_mfma_f32_16x16x32_bf16 a[88:91], v[88:91], v[156:159], 0
s_lshl_b32 s36, s36, 1
v_mfma_f32_16x16x32_bf16 a[20:23], v[84:87], v[152:155], 0
s_and_b32 s37, s3, 1
v_mfma_f32_16x16x32_bf16 a[28:31], v[84:87], v[156:159], 0
v_mfma_f32_16x16x32_bf16 a[16:19], v[80:83], v[152:155], 0
TR 152,198,16384
TR 154,198,18432
v_mfma_f32_16x16x32_bf16 a[24:27], v[80:83], v[156:159], 0
TR 156,199,16384
TR 158,199,18432
s_waitcnt lgkmcnt(15)
v_mfma_f32_16x16x32_bf16 a[32:35], v[80:83], v[160:163], 0
ds_read_b128 v[132:135], v193 offset:10240
buffer_load_dwordx4 v180, s[8:11], s20 offen offset:0 lds
v_mfma_f32_16x16x32_bf16 a[40:43], v[80:83], v[164:167], 0
s_add_u32 s36, s36, s37
s_lshl_b32 s36, s36, 3
v_mfma_f32_16x16x32_bf16 a[36:39], v[84:87], v[160:163], 0
v_lshrrev_b32 v253, 3, v1
v_add_u32 v253, s36, v253
v_mfma_f32_16x16x32_bf16 a[44:47], v[84:87], v[164:167], 0
v_mfma_f32_16x16x32_bf16 a[96:99], v[88:91], v[160:163], 0
buffer_load_dwordx4 v181, s[8:11], s20 offen offset:1024 lds
v_lshlrev_b32 v254, 14, v253
v_mfma_f32_16x16x32_bf16 a[104:107], v[88:91], v[164:167], 0
v_lshl_add_u32 v254, v252, 3, v254
v_mfma_f32_16x16x32_bf16 a[100:103], v[92:95], v[160:163], 0
v_mfma_f32_16x16x32_bf16 a[108:111], v[92:95], v[164:167], 0
ds_read_b128 v[136:139], v193 offset:12288
v_add_u32 v229, -6144, v254
v_mfma_f32_16x16x32_bf16 a[160:163], v[96:99], v[160:163], 0
v_lshlrev_b32 v62, 5, v252
v_mfma_f32_16x16x32_bf16 a[168:171], v[96:99], v[164:167], 0
buffer_load_dwordx4 v182, s[8:11], s20 offen offset:2048 lds
v_mfma_f32_16x16x32_bf16 a[164:167], v[100:103], v[160:163], 0
v_lshlrev_b32 v254, 4, v253
v_mfma_f32_16x16x32_bf16 a[172:175], v[100:103], v[164:167], 0
v_sub_u32 v254, 4080, v254
v_mfma_f32_16x16x32_bf16 a[224:227], v[104:107], v[160:163], 0
v_mfma_f32_16x16x32_bf16 a[232:235], v[104:107], v[164:167], 0
ds_read_b128 v[140:143], v193 offset:14336
v_lshl_add_u32 v10, v252, 14, v254
v_mfma_f32_16x16x32_bf16 a[228:231], v[108:111], v[160:163], 0
TR 160,200,16384
TR 162,200,18432
v_mfma_f32_16x16x32_bf16 a[236:239], v[108:111], v[164:167], 0
TR 164,201,16384
TR 166,201,18432
v_mfma_f32_16x16x32_bf16 a[244:247], v[108:111], v[168:171], 0
buffer_load_dwordx4 v183, s[8:11], s20 offen offset:3072 lds
v_and_b32 v252, 31, v1
s_waitcnt lgkmcnt(15)
v_mfma_f32_16x16x32_bf16 a[252:255], v[108:111], v[172:175], 0
v_lshlrev_b32 v64, 4, v252
s_lshl_b32 s36, s2, 2
v_mfma_f32_16x16x32_bf16 a[240:243], v[104:107], v[168:171], 0
v_mfma_f32_16x16x32_bf16 a[248:251], v[104:107], v[172:175], 0
s_add_u32 s20, s20, 128
s_add_u32 s36, s36, s3
v_mfma_f32_16x16x32_bf16 a[180:183], v[100:103], v[168:171], 0
s_lshl_b32 s36, s36, 1
v_mfma_f32_16x16x32_bf16 a[188:191], v[100:103], v[172:175], 0
v_mfma_f32_16x16x32_bf16 a[176:179], v[96:99], v[168:171], 0
v_lshrrev_b32 v253, 5, v1
v_mfma_f32_16x16x32_bf16 a[184:187], v[96:99], v[172:175], 0
v_add_u32 v253, s36, v253
v_mfma_f32_16x16x32_bf16 a[116:119], v[92:95], v[168:171], 0
s_and_b32 s20, s20, 1023
v_mfma_f32_16x16x32_bf16 a[124:127], v[92:95], v[172:175], 0
v_lshl_add_u32 v63, v253, 11, v64
v_mfma_f32_16x16x32_bf16 a[112:115], v[88:91], v[168:171], 0
v_lshlrev_b32 v253, 2, v253
v_mfma_f32_16x16x32_bf16 a[120:123], v[88:91], v[172:175], 0
v_mfma_f32_16x16x32_bf16 a[52:55], v[84:87], v[168:171], 0
v_lshl_add_u32 v11, v252, 20, v253
v_mfma_f32_16x16x32_bf16 a[60:63], v[84:87], v[172:175], 0
v_mfma_f32_16x16x32_bf16 a[48:51], v[80:83], v[168:171], 0
TR 168,202,16384
TR 170,202,18432
v_mfma_f32_16x16x32_bf16 a[56:59], v[80:83], v[172:175], 0
TR 172,203,16384
TR 174,203,18432
s_waitcnt lgkmcnt(4)
MA 0,v,112,v,144
s_add_u32 m0, s22, 65536
MA 8,v,112,v,148
MA 4,v,116,v,144
buffer_load_dwordx4 v176, s[8:11], s20 offen offset:0 lds
MA 12,v,116,v,148
MA 64,v,120,v,144
buffer_load_dwordx4 v177, s[8:11], s20 offen offset:1024 lds
MA 72,v,120,v,148
MA 68,v,124,v,144
MA 76,v,124,v,148
buffer_load_dwordx4 v178, s[8:11], s20 offen offset:2048 lds
MA 128,v,128,v,144
MA 136,v,128,v,148
buffer_load_dwordx4 v179, s[8:11], s20 offen offset:3072 lds
MA 132,v,132,v,144
MA 140,v,132,v,148
MA 192,v,136,v,144
s_add_u32 m0, s22, 69632
MA 200,v,136,v,148
MA 196,v,140,v,144
buffer_load_dwordx4 v180, s[8:11], s20 offen offset:0 lds
MA 204,v,140,v,148
MA 212,v,140,v,152
buffer_load_dwordx4 v181, s[8:11], s20 offen offset:1024 lds
MA 220,v,140,v,156
MA 208,v,136,v,152
MA 216,v,136,v,156
buffer_load_dwordx4 v182, s[8:11], s20 offen offset:2048 lds
MA 148,v,132,v,152
MA 156,v,132,v,156
buffer_load_dwordx4 v183, s[8:11], s20 offen offset:3072 lds
MA 144,v,128,v,152
MA 152,v,128,v,156
MA 84,v,124,v,152
s_add_u32 s20, s20, 128
MA 92,v,124,v,156
MA 80,v,120,v,152
s_and_b32 s20, s20, 1023
MA 88,v,120,v,156
MA 20,v,116,v,152
MA 28,v,116,v,156
MA 16,v,112,v,152
s_waitcnt vmcnt(8) lgkmcnt(0)
s_barrier
MA 24,v,112,v,156
TR 144,196,32768
TR 146,196,34816
MA 32,v,112,v,160
ds_read_b128 v[80:83], v192 offset:32768
s_add_u32 m0, s23, 0
MA 40,v,112,v,164
TR 148,197,32768
TR 150,197,34816
MA 36,v,116,v,160
ds_read_b128 v[84:87], v192 offset:34816
buffer_load_dwordx4 v184, s[12:15], s21 offen offset:0 lds
MA 44,v,116,v,164
TR 152,198,32768
TR 154,198,34816
MA 96,v,120,v,160
buffer_load_dwordx4 v185, s[12:15], s21 offen offset:1024 lds
MA 104,v,120,v,164
TR 156,199,32768
TR 158,199,34816
MA 100,v,124,v,160
ds_read_b128 v[88:91], v192 offset:36864
buffer_load_dwordx4 v186, s[12:15], s21 offen offset:2048 lds
MA 108,v,124,v,164
ds_read_b128 v[92:95], v192 offset:38912
MA 160,v,128,v,160
MA 168,v,128,v,164
buffer_load_dwordx4 v187, s[12:15], s21 offen offset:3072 lds
MA 164,v,132,v,160
ds_read_b128 v[96:99], v192 offset:40960
MA 172,v,132,v,164
s_add_u32 m0, s23, 4096
MA 224,v,136,v,160
ds_read_b128 v[100:103], v192 offset:43008
MA 232,v,136,v,164
MA 228,v,140,v,160
TR 160,200,32768
TR 162,200,34816
MA 236,v,140,v,164
TR 164,201,32768
TR 166,201,34816
MA 244,v,140,v,168
ds_read_b128 v[104:107], v192 offset:45056
buffer_load_dwordx4 v188, s[12:15], s21 offen offset:0 lds
MA 252,v,140,v,172
ds_read_b128 v[108:111], v192 offset:47104
buffer_load_dwordx4 v189, s[12:15], s21 offen offset:1024 lds
MA 240,v,136,v,168
MA 248,v,136,v,172
buffer_load_dwordx4 v190, s[12:15], s21 offen offset:2048 lds
MA 180,v,132,v,168
MA 188,v,132,v,172
MA 176,v,128,v,168
buffer_load_dwordx4 v191, s[12:15], s21 offen offset:3072 lds
MA 184,v,128,v,172
MA 116,v,124,v,168
s_add_u32 s21, s21, 524288
MA 124,v,124,v,172
MA 112,v,120,v,168
MA 120,v,120,v,172
s_and_b32 s21, s21, 4194303
MA 52,v,116,v,168
MA 60,v,116,v,172
MA 48,v,112,v,168
TR 168,202,32768
TR 170,202,34816
MA 56,v,112,v,172
TR 172,203,32768
TR 174,203,34816
s_waitcnt lgkmcnt(4)
MA 0,v,80,v,144
s_add_u32 m0, s22, 0
buffer_load_dwordx4 v[230:233], v63, s[92:95], 0 offen offset:0
MA 8,v,80,v,148
ds_read_b128 v[112:115], v193 offset:32768
MA 4,v,84,v,144
MA 12,v,84,v,148
MA 64,v,88,v,144
MA 72,v,88,v,148
buffer_load_dwordx4 v176, s[8:11], s20 offen offset:0 lds
MA 68,v,92,v,144
buffer_load_dwordx4 v[2:5], v64, s[76:79], 0 offen offset:0
MA 76,v,92,v,148
ds_read_b128 v[116:119], v193 offset:34816
MA 128,v,96,v,144
MA 136,v,96,v,148
MA 132,v,100,v,144
buffer_load_dwordx4 v177, s[8:11], s20 offen offset:1024 lds
MA 140,v,100,v,148
MA 192,v,104,v,144
buffer_load_dwordx4 v[234:237], v63, s[92:95], 0 offen offset:512
MA 200,v,104,v,148
ds_read_b128 v[120:123], v193 offset:36864
MA 196,v,108,v,144
TR 144,196,49152
TR 146,196,51200
MA 204,v,108,v,148
TR 148,197,49152
TR 150,197,51200
MA 212,v,108,v,152
buffer_load_dwordx4 v178, s[8:11], s20 offen offset:2048 lds
MA 220,v,108,v,156
MA 208,v,104,v,152
buffer_load_dwordx4 v[6:9], v64, s[76:79], 0 offen offset:512
MA 216,v,104,v,156
MA 148,v,100,v,152
ds_read_b128 v[124:127], v193 offset:38912
buffer_load_dwordx4 v179, s[8:11], s20 offen offset:3072 lds
MA 156,v,100,v,156
MA 144,v,96,v,152
MA 152,v,96,v,156
MA 84,v,92,v,152
buffer_load_dwordx4 v[238:241], v63, s[92:95], 0 offen offset:1024
MA 92,v,92,v,156
s_add_u32 m0, s22, 4096
MA 80,v,88,v,152
ds_read_b128 v[128:131], v193 offset:40960
MA 88,v,88,v,156
MA 20,v,84,v,152
MA 28,v,84,v,156
MA 16,v,80,v,152
TR 152,198,49152
TR 154,198,51200
MA 24,v,80,v,156
TR 156,199,49152
TR 158,199,51200
MA 32,v,80,v,160
ds_read_b128 v[132:135], v193 offset:43008
buffer_load_dwordx4 v180, s[8:11], s20 offen offset:0 lds
MA 40,v,80,v,164
buffer_load_dwordx4 v[12:15], v64, s[76:79], 0 offen offset:1024
MA 36,v,84,v,160
MA 44,v,84,v,164
MA 96,v,88,v,160
buffer_load_dwordx4 v181, s[8:11], s20 offen offset:1024 lds
MA 104,v,88,v,164
buffer_load_dwordx4 v[242:245], v63, s[92:95], 0 offen offset:1536
MA 100,v,92,v,160
MA 108,v,92,v,164
ds_read_b128 v[136:139], v193 offset:45056
MA 160,v,96,v,160
MA 168,v,96,v,164
buffer_load_dwordx4 v182, s[8:11], s20 offen offset:2048 lds
MA 164,v,100,v,160
MA 172,v,100,v,164
buffer_load_dwordx4 v[246:249], v64, s[76:79], 0 offen offset:1536
MA 224,v,104,v,160
MA 232,v,104,v,164
ds_read_b128 v[140:143], v193 offset:47104
MA 228,v,108,v,160
TR 160,200,49152
TR 162,200,51200
MA 236,v,108,v,164
TR 164,201,49152
TR 166,201,51200
s_waitcnt lgkmcnt(15)
MA 244,v,108,v,168
buffer_load_dwordx4 v183, s[8:11], s20 offen offset:3072 lds
MA 252,v,108,v,172
buffer_load_dwordx4 v[54:57], v62, s[96:99], 0 offen offset:0
MA 240,v,104,v,168
MA 248,v,104,v,172
s_add_u32 s20, s20, 128
MA 180,v,100,v,168
MA 188,v,100,v,172
MA 176,v,96,v,168
MA 184,v,96,v,172
buffer_load_dwordx4 v[58:61], v62, s[96:99], 0 offen offset:16
MA 116,v,92,v,168
s_and_b32 s20, s20, 1023
MA 124,v,92,v,172
MA 112,v,88,v,168
MA 120,v,88,v,172
MA 52,v,84,v,168
MA 60,v,84,v,172
MA 48,v,80,v,168
TR 168,202,49152
TR 170,202,51200
MA 56,v,80,v,172
TR 172,203,49152
TR 174,203,51200
s_waitcnt lgkmcnt(4)
MA 0,v,112,v,144
MA 8,v,112,v,148
MA 4,v,116,v,144
MA 12,v,116,v,148
MA 64,v,120,v,144
MA 72,v,120,v,148
MA 68,v,124,v,144
MA 76,v,124,v,148
MA 128,v,128,v,144
MA 136,v,128,v,148
s_waitcnt vmcnt(18) lgkmcnt(0)
s_barrier
MA 132,v,132,v,144
s_add_u32 m0, s23, 32768
MA 140,v,132,v,148
ds_read_b128 v[80:83], v194 offset:0
MA 192,v,136,v,144
s_mov_b32 s4, s34
s_mov_b32 s5, s35
MA 200,v,136,v,148
MA 196,v,140,v,144
TR 144,196,0
TR 146,196,2048
MA 204,v,140,v,148
TR 148,197,0
TR 150,197,2048
MA 212,v,140,v,152
ds_read_b128 v[84:87], v194 offset:2048
buffer_load_dwordx4 v184, s[12:15], s21 offen offset:0 lds
MA 220,v,140,v,156
s_mov_b32 s6, 8388608
s_mov_b32 s7, 0x20000
MA 208,v,136,v,152
buffer_load_dwordx4 v185, s[12:15], s21 offen offset:1024 lds
MA 216,v,136,v,156
MA 148,v,132,v,152
MA 156,v,132,v,156
ds_read_b128 v[88:91], v194 offset:4096
MA 144,v,128,v,152
MA 152,v,128,v,156
buffer_load_dwordx4 v186, s[12:15], s21 offen offset:2048 lds
s_lshr_b32 s43, s2, 3
MA 84,v,124,v,152
MA 92,v,124,v,156
MA 80,v,120,v,152
ds_read_b128 v[92:95], v194 offset:6144
s_lshl_b32 s43, s43, 2
MA 88,v,120,v,156
buffer_load_dwordx4 v187, s[12:15], s21 offen offset:3072 lds
MA 20,v,116,v,152
MA 28,v,116,v,156
s_add_u32 s43, s43, s3
MA 16,v,112,v,152
TR 152,198,0
TR 154,198,2048
MA 24,v,112,v,156
TR 156,199,0
TR 158,199,2048
MA 32,v,112,v,160
ds_read_b128 v[96:99], v194 offset:8192
s_add_u32 m0, s23, 36864
MA 40,v,112,v,164
s_lshl_b32 s43, s43, 16
MA 36,v,116,v,160
MA 44,v,116,v,164
MA 96,v,120,v,160
ds_read_b128 v[100:103], v194 offset:10240
buffer_load_dwordx4 v188, s[12:15], s21 offen offset:0 lds
MA 104,v,120,v,164
s_and_b32 s37, s2, 7
MA 100,v,124,v,160
MA 108,v,124,v,164
s_lshl_b32 s37, s37, 10
MA 160,v,128,v,160
buffer_load_dwordx4 v189, s[12:15], s21 offen offset:1024 lds
MA 168,v,128,v,164
ds_read_b128 v[104:107], v194 offset:12288
MA 164,v,132,v,160
s_add_u32 s43, s43, s37
MA 172,v,132,v,164
MA 224,v,136,v,160
buffer_load_dwordx4 v190, s[12:15], s21 offen offset:2048 lds
MA 232,v,136,v,164
v_lshrrev_b32 v78, 3, v1
MA 228,v,140,v,160
TR 160,200,0
TR 162,200,2048
MA 236,v,140,v,164
TR 164,201,0
TR 166,201,2048
MA 244,v,140,v,168
ds_read_b128 v[108:111], v194 offset:14336
MA 252,v,140,v,172
buffer_load_dwordx4 v191, s[12:15], s21 offen offset:3072 lds
v_and_b32 v79, 7, v1
MA 240,v,136,v,168
MA 248,v,136,v,172
MA 180,v,132,v,168
v_lshlrev_b32 v79, 7, v79
MA 188,v,132,v,172
s_add_u32 s21, s21, 524288
MA 176,v,128,v,168
MA 184,v,128,v,172
v_lshl_add_u32 v78, v78, 13, v79
MA 116,v,124,v,168
MA 124,v,124,v,172
s_and_b32 s21, s21, 4194303
MA 112,v,120,v,168
v_add_u32 v78, s43, v78
MA 120,v,120,v,172
MA 52,v,116,v,168
MA 60,v,116,v,172
MA 48,v,112,v,168
TR 168,202,0
TR 170,202,2048
MA 56,v,112,v,172
TR 172,203,0
TR 174,203,2048
s_waitcnt lgkmcnt(4)
MA 0,v,80,v,144
s_add_u32 m0, s22, 32768
v_add_u32 v252, 0, v229
MA 8,v,80,v,148
ds_read_b128 v[112:115], v195 offset:0
MA 4,v,84,v,144
MA 12,v,84,v,148
MA 64,v,88,v,144
MA 72,v,88,v,148
buffer_load_dwordx4 v176, s[8:11], s20 offen offset:0 lds
MA 68,v,92,v,144
buffer_load_dwordx2 v[16:17], v252, s[84:87], 0 offen
MA 76,v,92,v,148
ds_read_b128 v[116:119], v195 offset:2048
MA 128,v,96,v,144
MA 136,v,96,v,148
MA 132,v,100,v,144
buffer_load_dwordx4 v177, s[8:11], s20 offen offset:1024 lds
MA 140,v,100,v,148
MA 192,v,104,v,144
v_add_u32 v253, 2048, v229
MA 200,v,104,v,148
ds_read_b128 v[120:123], v195 offset:4096
MA 196,v,108,v,144
TR 144,196,16384
TR 146,196,18432
MA 204,v,108,v,148
TR 148,197,16384
TR 150,197,18432
MA 212,v,108,v,152
buffer_load_dwordx4 v178, s[8:11], s20 offen offset:2048 lds
MA 220,v,108,v,156
MA 208,v,104,v,152
buffer_load_dwordx2 v[18:19], v253, s[84:87], 0 offen
MA 216,v,104,v,156
MA 148,v,100,v,152
ds_read_b128 v[124:127], v195 offset:6144
buffer_load_dwordx4 v179, s[8:11], s20 offen offset:3072 lds
MA 156,v,100,v,156
MA 144,v,96,v,152
MA 152,v,96,v,156
MA 84,v,92,v,152
v_add_u32 v254, 4096, v229
MA 92,v,92,v,156
s_add_u32 m0, s22, 36864
MA 80,v,88,v,152
ds_read_b128 v[128:131], v195 offset:8192
MA 88,v,88,v,156
MA 20,v,84,v,152
MA 28,v,84,v,156
MA 16,v,80,v,152
TR 152,198,16384
TR 154,198,18432
MA 24,v,80,v,156
TR 156,199,16384
TR 158,199,18432
MA 32,v,80,v,160
ds_read_b128 v[132:135], v195 offset:10240
buffer_load_dwordx4 v180, s[8:11], s20 offen offset:0 lds
MA 40,v,80,v,164
buffer_load_dwordx2 v[20:21], v254, s[84:87], 0 offen
MA 36,v,84,v,160
MA 44,v,84,v,164
MA 96,v,88,v,160
buffer_load_dwordx4 v181, s[8:11], s20 offen offset:1024 lds
MA 104,v,88,v,164
v_add_u32 v255, 6144, v229
MA 100,v,92,v,160
MA 108,v,92,v,164
ds_read_b128 v[136:139], v195 offset:12288
MA 160,v,96,v,160
MA 168,v,96,v,164
buffer_load_dwordx4 v182, s[8:11], s20 offen offset:2048 lds
MA 164,v,100,v,160
MA 172,v,100,v,164
buffer_load_dwordx2 v[22:23], v255, s[84:87], 0 offen
MA 224,v,104,v,160
MA 232,v,104,v,164
ds_read_b128 v[140:143], v195 offset:14336
MA 228,v,108,v,160
TR 160,200,16384
TR 162,200,18432
MA 236,v,108,v,164
TR 164,201,16384
TR 166,201,18432
s_waitcnt lgkmcnt(15)
MA 244,v,108,v,168
buffer_load_dwordx4 v183, s[8:11], s20 offen offset:3072 lds
MA 252,v,108,v,172
buffer_load_dwordx2 v[38:39], v255, s[88:91], 0 offen
MA 240,v,104,v,168
MA 248,v,104,v,172
s_add_u32 s20, s20, 128
MA 180,v,100,v,168
MA 188,v,100,v,172
MA 176,v,96,v,168
MA 184,v,96,v,172
v_add_u32 v252, 8192, v229
MA 116,v,92,v,168
s_and_b32 s20, s20, 1023
MA 124,v,92,v,172
MA 112,v,88,v,168
MA 120,v,88,v,172
MA 52,v,84,v,168
MA 60,v,84,v,172
MA 48,v,80,v,168
TR 168,202,16384
TR 170,202,18432
MA 56,v,80,v,172
TR 172,203,16384
TR 174,203,18432
s_waitcnt lgkmcnt(4)
MA 0,v,112,v,144
MA 8,v,112,v,148
MA 4,v,116,v,144
MA 12,v,116,v,148
MA 64,v,120,v,144
MA 72,v,120,v,148
MA 68,v,124,v,144
MA 76,v,124,v,148
MA 128,v,128,v,144
MA 136,v,128,v,148
s_waitcnt vmcnt(13) lgkmcnt(0)
s_barrier
MA 132,v,132,v,144
s_add_u32 m0, s23, 0
s_bfe_u32 s80, s2, 0x20001
MA 140,v,132,v,148
ds_read_b128 v[80:83], v192 offset:0
s_bfe_u32 s69, s2, 0x30003
MA 192,v,136,v,144
s_lshl_b32 s80, s80, 3
s_add_u32 s69, s69, s80
MA 200,v,136,v,148
s_lshr_b32 s80, s2, 6
MA 196,v,140,v,144
TR 144,196,32768
TR 146,196,34816
MA 204,v,140,v,148
TR 148,197,32768
TR 150,197,34816
MA 212,v,140,v,152
ds_read_b128 v[84:87], v192 offset:2048
buffer_load_dwordx4 v184, s[12:15], s21 offen offset:0 lds
MA 220,v,140,v,156
s_xor_b32 s81, s80, s2
s_and_b32 s81, s81, 1
MA 208,v,136,v,152
buffer_load_dwordx4 v185, s[12:15], s21 offen offset:1024 lds
s_lshl_b32 s70, s80, 1
MA 216,v,136,v,156
s_add_u32 s70, s70, s81
s_lshl_b32 s80, s3, 1
MA 148,v,132,v,152
s_sub_u32 s80, 7, s80
s_lshl_b32 s76, s80, 17
MA 156,v,132,v,156
ds_read_b128 v[88:91], v192 offset:4096
s_lshl_b32 s80, s3, 15
MA 144,v,128,v,152
s_lshl_b32 s65, s70, 18
s_sub_u32 s64, 3932160, s65
MA 152,v,128,v,156
buffer_load_dwordx4 v186, s[12:15], s21 offen offset:2048 lds
s_add_u32 s65, s65, s80
MA 84,v,124,v,152
s_add_u32 s64, s64, s80
MA 92,v,124,v,156
s_lshl_b32 s81, s69, 12
MA 80,v,120,v,152
ds_read_b128 v[92:95], v192 offset:6144
s_lshl_b32 s100, s64, 2
MA 88,v,120,v,156
buffer_load_dwordx4 v187, s[12:15], s21 offen offset:3072 lds
s_add_u32 s100, s100, s81
MA 20,v,116,v,152
s_lshl_b32 s101, s65, 2
MA 28,v,116,v,156
s_add_u32 s101, s101, s81
MA 16,v,112,v,152
TR 152,198,32768
TR 154,198,34816
MA 24,v,112,v,156
TR 156,199,32768
TR 158,199,34816
MA 32,v,112,v,160
ds_read_b128 v[96:99], v192 offset:8192
s_add_u32 m0, s23, 4096
MA 40,v,112,v,164
s_lshl_b32 s66, s3, 17
s_lshl_b32 s81, s69, 8
MA 36,v,116,v,160
s_add_u32 s66, s66, s81
s_and_b32 s74, s2, 7
MA 44,v,116,v,164
s_lshl_b32 s74, s74, 8
s_mov_b32 s82, s66
MA 96,v,120,v,160
ds_read_b128 v[100:103], v192 offset:10240
buffer_load_dwordx4 v188, s[12:15], s21 offen offset:0 lds
MA 104,v,120,v,164
s_lshl_b32 s66, s74, 12
s_lshl_b32 s67, s3, 13
MA 100,v,124,v,160
s_lshl_b32 s68, s3, 12
s_lshl_b32 s77, s70, 1
MA 108,v,124,v,164
s_sub_u32 s77, 32, s77
MA 160,v,128,v,160
buffer_load_dwordx4 v189, s[12:15], s21 offen offset:1024 lds
v_lshrrev_b32 v66, 3, v1
MA 168,v,128,v,164
ds_read_b128 v[104:107], v192 offset:12288
v_lshlrev_b32 v66, 11, v66
MA 164,v,132,v,160
v_lshrrev_b32 v67, 4, v1
v_and_b32 v68, 7, v1
MA 172,v,132,v,164
v_xor_b32 v68, v68, v67
MA 224,v,136,v,160
buffer_load_dwordx4 v190, s[12:15], s21 offen offset:2048 lds
v_lshl_add_u32 v66, v68, 4, v66
MA 232,v,136,v,164
v_xor_b32 v69, 64, v66
MA 228,v,140,v,160
TR 160,200,32768
TR 162,200,34816
MA 236,v,140,v,164
TR 164,201,32768
TR 166,201,34816
MA 244,v,140,v,168
ds_read_b128 v[108:111], v192 offset:14336
s_lshr_b32 s83, s76, 2
MA 252,v,140,v,172
buffer_load_dwordx4 v191, s[12:15], s21 offen offset:3072 lds
v_add_u32 v208, 0, v66
MA 240,v,136,v,168
v_add_u32 v209, 15360, v69
v_add_u32 v210, -2048, v66
MA 248,v,136,v,172
v_add_u32 v210, s83, v210
v_add_u32 v211, 13312, v69
MA 180,v,132,v,168
v_add_u32 v211, s83, v211
v_and_b32 v68, 15, v1
MA 188,v,132,v,172
s_add_u32 s21, s21, 524288
v_lshlrev_b32 v69, 1, v67
MA 176,v,128,v,168
v_xor_b32 v68, v68, v69
MA 184,v,128,v,172
v_lshlrev_b32 v66, 13, v67
MA 116,v,124,v,168
v_xor_b32 v69, 0, v68
MA 124,v,124,v,172
s_and_b32 s21, s21, 4194303
v_lshl_add_u32 v69, v69, 4, v66
MA 112,v,120,v,168
v_add_u32 v212, 0, v69
MA 120,v,120,v,172
v_xor_b32 v69, 0, v68
MA 52,v,116,v,168
v_lshl_add_u32 v69, v69, 4, v66
MA 60,v,116,v,172
v_add_u32 v213, 31744, v69
MA 48,v,112,v,168
TR 168,202,32768
TR 170,202,34816
MA 56,v,112,v,172
TR 172,203,32768
TR 174,203,34816
s_waitcnt lgkmcnt(4)
MA 0,v,80,v,144
s_add_u32 m0, s22, 65536
buffer_load_dwordx2 v[24:25], v252, s[84:87], 0 offen
MA 8,v,80,v,148
ds_read_b128 v[112:115], v193 offset:0
MA 4,v,84,v,144
MA 12,v,84,v,148
MA 64,v,88,v,144
MA 72,v,88,v,148
buffer_load_dwordx4 v176, s[8:11], s20 offen offset:0 lds
MA 68,v,92,v,144
buffer_load_dwordx2 v[40:41], v252, s[88:91], 0 offen
MA 76,v,92,v,148
ds_read_b128 v[116:119], v193 offset:2048
MA 128,v,96,v,144
MA 136,v,96,v,148
MA 132,v,100,v,144
buffer_load_dwordx4 v177, s[8:11], s20 offen offset:1024 lds
MA 140,v,100,v,148
MA 192,v,104,v,144
v_add_u32 v253, 10240, v229
MA 200,v,104,v,148
ds_read_b128 v[120:123], v193 offset:4096
MA 196,v,108,v,144
TR 144,196,49152
TR 146,196,51200
MA 204,v,108,v,148
TR 148,197,49152
TR 150,197,51200
MA 212,v,108,v,152
buffer_load_dwordx4 v178, s[8:11], s20 offen offset:2048 lds
MA 220,v,108,v,156
MA 208,v,104,v,152
buffer_load_dwordx2 v[26:27], v253, s[84:87], 0 offen
MA 216,v,104,v,156
MA 148,v,100,v,152
ds_read_b128 v[124:127], v193 offset:6144
buffer_load_dwordx4 v179, s[8:11], s20 offen offset:3072 lds
MA 156,v,100,v,156
MA 144,v,96,v,152
MA 152,v,96,v,156
MA 84,v,92,v,152
buffer_load_dwordx2 v[42:43], v253, s[88:91], 0 offen
MA 92,v,92,v,156
s_add_u32 m0, s22, 69632
MA 80,v,88,v,152
ds_read_b128 v[128:131], v193 offset:8192
MA 88,v,88,v,156
MA 20,v,84,v,152
MA 28,v,84,v,156
MA 16,v,80,v,152
TR 152,198,49152
TR 154,198,51200
MA 24,v,80,v,156
TR 156,199,49152
TR 158,199,51200
MA 32,v,80,v,160
ds_read_b128 v[132:135], v193 offset:10240
buffer_load_dwordx4 v180, s[8:11], s20 offen offset:0 lds
MA 40,v,80,v,164
v_add_u32 v254, 12288, v229
MA 36,v,84,v,160
MA 44,v,84,v,164
MA 96,v,88,v,160
buffer_load_dwordx4 v181, s[8:11], s20 offen offset:1024 lds
MA 104,v,88,v,164
buffer_load_dwordx2 v[28:29], v254, s[84:87], 0 offen
MA 100,v,92,v,160
MA 108,v,92,v,164
ds_read_b128 v[136:139], v193 offset:12288
MA 160,v,96,v,160
MA 168,v,96,v,164
buffer_load_dwordx4 v182, s[8:11], s20 offen offset:2048 lds
MA 164,v,100,v,160
MA 172,v,100,v,164
buffer_load_dwordx2 v[44:45], v254, s[88:91], 0 offen
MA 224,v,104,v,160
MA 232,v,104,v,164
ds_read_b128 v[140:143], v193 offset:14336
MA 228,v,108,v,160
TR 160,200,49152
TR 162,200,51200
MA 236,v,108,v,164
TR 164,201,49152
TR 166,201,51200
s_waitcnt lgkmcnt(15)
MA 244,v,108,v,168
buffer_load_dwordx4 v183, s[8:11], s20 offen offset:3072 lds
MA 252,v,108,v,172
v_add_u32 v255, 14336, v229
MA 240,v,104,v,168
MA 248,v,104,v,172
s_add_u32 s20, s20, 128
MA 180,v,100,v,168
MA 188,v,100,v,172
MA 176,v,96,v,168
MA 184,v,96,v,172
buffer_load_dwordx2 v[30:31], v255, s[84:87], 0 offen
MA 116,v,92,v,168
s_and_b32 s20, s20, 1023
MA 124,v,92,v,172
MA 112,v,88,v,168
MA 120,v,88,v,172
MA 52,v,84,v,168
MA 60,v,84,v,172
MA 48,v,80,v,168
TR 168,202,49152
TR 170,202,51200
MA 56,v,80,v,172
TR 172,203,49152
TR 174,203,51200
s_waitcnt lgkmcnt(4)
MA 0,v,112,v,144
MA 8,v,112,v,148
MA 4,v,116,v,144
MA 12,v,116,v,148
MA 64,v,120,v,144
MA 72,v,120,v,148
MA 68,v,124,v,144
MA 76,v,124,v,148
MA 128,v,128,v,144
MA 136,v,128,v,148
s_waitcnt vmcnt(15) lgkmcnt(0)
s_barrier
MA 132,v,132,v,144
s_add_u32 m0, s23, 32768
v_xor_b32 v69, 8, v68
MA 140,v,132,v,148
ds_read_b128 v[80:83], v192 offset:32768
v_lshl_add_u32 v69, v69, 4, v66
MA 192,v,136,v,144
v_add_u32 v214, 63488, v69
v_xor_b32 v69, 8, v68
MA 200,v,136,v,148
v_lshl_add_u32 v69, v69, 4, v66
MA 196,v,140,v,144
TR 144,196,0
TR 146,196,2048
MA 204,v,140,v,148
TR 148,197,0
TR 150,197,2048
MA 212,v,140,v,152
ds_read_b128 v[84:87], v192 offset:34816
buffer_load_dwordx4 v184, s[12:15], s21 offen offset:0 lds
MA 220,v,140,v,156
v_add_u32 v215, 95232, v69
v_and_b32 v66, 15, v1
MA 208,v,136,v,152
buffer_load_dwordx4 v185, s[12:15], s21 offen offset:1024 lds
v_lshrrev_b32 v68, 1, v66
MA 216,v,136,v,156
v_xor_b32 v68, v68, v67
v_lshlrev_b32 v68, 4, v68
MA 148,v,132,v,152
v_lshl_add_u32 v68, v66, 7, v68
v_add_u32 v224, s67, v68
MA 156,v,132,v,156
ds_read_b128 v[88:91], v192 offset:36864
v_xor_b32 v225, 64, v224
MA 144,v,128,v,152
v_add_u32 v226, 0x10000, v224
v_add_u32 v227, 0x10000, v225
MA 152,v,128,v,156
buffer_load_dwordx4 v186, s[12:15], s21 offen offset:2048 lds
v_bfe_u32 v66, v1, 2, 2
MA 84,v,124,v,152
v_and_b32 v68, 1, v67
v_lshl_or_b32 v68, v68, 2, v66
MA 92,v,124,v,156
v_lshl_add_u32 v66, v67, 3, v66
v_lshlrev_b32 v66, 8, v66
MA 80,v,120,v,152
ds_read_b128 v[92:95], v192 offset:38912
v_and_b32 v69, 3, v1
MA 88,v,120,v,156
buffer_load_dwordx4 v187, s[12:15], s21 offen offset:3072 lds
v_lshl_add_u32 v66, v69, 3, v66
MA 20,v,116,v,152
v_add_u32 v66, 98304, v66
MA 28,v,116,v,156
v_xor_b32 v69, 0, v68
MA 16,v,112,v,152
TR 152,198,0
TR 154,198,2048
MA 24,v,112,v,156
TR 156,199,0
TR 158,199,2048
MA 32,v,112,v,160
ds_read_b128 v[96:99], v192 offset:40960
s_add_u32 m0, s23, 36864
MA 40,v,112,v,164
v_lshl_add_u32 v216, v69, 5, v66
v_xor_b32 v69, 1, v68
MA 36,v,116,v,160
v_lshl_add_u32 v217, v69, 5, v66
v_xor_b32 v69, 2, v68
MA 44,v,116,v,164
v_lshl_add_u32 v218, v69, 5, v66
v_xor_b32 v69, 3, v68
MA 96,v,120,v,160
ds_read_b128 v[100:103], v192 offset:43008
buffer_load_dwordx4 v188, s[12:15], s21 offen offset:0 lds
MA 104,v,120,v,164
v_lshl_add_u32 v219, v69, 5, v66
v_xor_b32 v69, 4, v68
MA 100,v,124,v,160
v_lshl_add_u32 v220, v69, 5, v66
v_xor_b32 v69, 5, v68
MA 108,v,124,v,164
v_lshl_add_u32 v221, v69, 5, v66
v_xor_b32 v69, 6, v68
MA 160,v,128,v,160
buffer_load_dwordx4 v189, s[12:15], s21 offen offset:1024 lds
v_lshl_add_u32 v222, v69, 5, v66
MA 168,v,128,v,164
ds_read_b128 v[104:107], v192 offset:45056
v_xor_b32 v69, 7, v68
MA 164,v,132,v,160
v_lshl_add_u32 v223, v69, 5, v66
s_mov_b32 s44, s32
MA 172,v,132,v,164
s_mov_b32 s45, s33
MA 224,v,136,v,160
buffer_load_dwordx4 v190, s[12:15], s21 offen offset:2048 lds
s_mov_b32 s46, 4194304
MA 232,v,136,v,164
s_mov_b32 s47, 0x20000
MA 228,v,140,v,160
TR 160,200,0
TR 162,200,2048
MA 236,v,140,v,164
TR 164,201,0
TR 166,201,2048
MA 244,v,140,v,168
ds_read_b128 v[108:111], v192 offset:47104
MA 252,v,140,v,172
buffer_load_dwordx4 v191, s[12:15], s21 offen offset:3072 lds
MA 240,v,136,v,168
s_add_u32 s48, s34, s82
s_addc_u32 s49, s35, 0
MA 248,v,136,v,172
s_sub_u32 s50, 8388608, s82
s_mov_b32 s51, 0x20000
MA 180,v,132,v,168
s_add_u32 s60, s40, 33554432
s_addc_u32 s61, s41, 0
MA 188,v,132,v,172
s_add_u32 s21, s21, 524288
s_mov_b32 s62, 16777216
MA 176,v,128,v,168
s_mov_b32 s63, 0x20000
s_lshl_b32 s80, s69, 19
MA 184,v,128,v,172
s_add_u32 s52, s40, s80
s_addc_u32 s53, s41, 0
MA 116,v,124,v,168
s_lshl_b32 s54, s77, 14
s_mov_b32 s55, 0x20000
MA 124,v,124,v,172
s_and_b32 s21, s21, 4194303
s_add_u32 s80, s80, 16760832
MA 112,v,120,v,168
s_add_u32 s56, s40, s80
s_addc_u32 s57, s41, 0
MA 120,v,120,v,172
s_add_u32 s58, s54, 16384
MA 52,v,116,v,168
s_mov_b32 s59, 0x20000
MA 60,v,116,v,172
s_load_dwordx2 s[38:39], s[0:1], 112
MA 48,v,112,v,168
TR 168,202,0
TR 170,202,2048
MA 56,v,112,v,172
TR 172,203,0
TR 174,203,2048
s_waitcnt lgkmcnt(4)
MA 0,v,80,v,144
s_add_u32 m0, s22, 0
buffer_load_dwordx2 v[46:47], v255, s[88:91], 0 offen
MA 8,v,80,v,148
ds_read_b128 v[112:115], v193 offset:32768
MA 4,v,84,v,144
MA 12,v,84,v,148
MA 64,v,88,v,144
MA 72,v,88,v,148
buffer_load_dwordx4 v176, s[8:11], s20 offen offset:0 lds
MA 68,v,92,v,144
v_add_u32 v252, 16384, v229
MA 76,v,92,v,148
ds_read_b128 v[116:119], v193 offset:34816
MA 128,v,96,v,144
MA 136,v,96,v,148
MA 132,v,100,v,144
buffer_load_dwordx4 v177, s[8:11], s20 offen offset:1024 lds
MA 140,v,100,v,148
MA 192,v,104,v,144
buffer_load_dwordx2 v[32:33], v252, s[84:87], 0 offen
MA 200,v,104,v,148
ds_read_b128 v[120:123], v193 offset:36864
MA 196,v,108,v,144
TR 144,196,16384
TR 146,196,18432
MA 204,v,108,v,148
TR 148,197,16384
TR 150,197,18432
MA 212,v,108,v,152
buffer_load_dwordx4 v178, s[8:11], s20 offen offset:2048 lds
MA 220,v,108,v,156
MA 208,v,104,v,152
buffer_load_dwordx2 v[48:49], v252, s[88:91], 0 offen
MA 216,v,104,v,156
MA 148,v,100,v,152
ds_read_b128 v[124:127], v193 offset:38912
buffer_load_dwordx4 v179, s[8:11], s20 offen offset:3072 lds
MA 156,v,100,v,156
MA 144,v,96,v,152
MA 152,v,96,v,156
MA 84,v,92,v,152
v_add_u32 v253, 18432, v229
MA 92,v,92,v,156
s_add_u32 m0, s22, 4096
MA 80,v,88,v,152
ds_read_b128 v[128:131], v193 offset:40960
MA 88,v,88,v,156
MA 20,v,84,v,152
MA 28,v,84,v,156
MA 16,v,80,v,152
TR 152,198,16384
TR 154,198,18432
MA 24,v,80,v,156
TR 156,199,16384
TR 158,199,18432
MA 32,v,80,v,160
ds_read_b128 v[132:135], v193 offset:43008
buffer_load_dwordx4 v180, s[8:11], s20 offen offset:0 lds
MA 40,v,80,v,164
buffer_load_dwordx2 v[34:35], v253, s[84:87], 0 offen
MA 36,v,84,v,160
MA 44,v,84,v,164
MA 96,v,88,v,160
buffer_load_dwordx4 v181, s[8:11], s20 offen offset:1024 lds
MA 104,v,88,v,164
buffer_load_dwordx2 v[50:51], v253, s[88:91], 0 offen
MA 100,v,92,v,160
MA 108,v,92,v,164
ds_read_b128 v[136:139], v193 offset:45056
MA 160,v,96,v,160
MA 168,v,96,v,164
buffer_load_dwordx4 v182, s[8:11], s20 offen offset:2048 lds
MA 164,v,100,v,160
MA 172,v,100,v,164
v_add_u32 v254, 20480, v229
MA 224,v,104,v,160
MA 232,v,104,v,164
ds_read_b128 v[140:143], v193 offset:47104
MA 228,v,108,v,160
TR 160,200,16384
TR 162,200,18432
MA 236,v,108,v,164
TR 164,201,16384
TR 166,201,18432
s_waitcnt lgkmcnt(15)
MA 244,v,108,v,168
buffer_load_dwordx4 v183, s[8:11], s20 offen offset:3072 lds
MA 252,v,108,v,172
buffer_load_dwordx2 v[36:37], v254, s[84:87], 0 offen
MA 240,v,104,v,168
MA 248,v,104,v,172
s_add_u32 s20, s20, 128
MA 180,v,100,v,168
MA 188,v,100,v,172
MA 176,v,96,v,168
MA 184,v,96,v,172
buffer_load_dwordx2 v[52:53], v254, s[88:91], 0 offen
MA 116,v,92,v,168
s_and_b32 s20, s20, 1023
MA 124,v,92,v,172
MA 112,v,88,v,168
MA 120,v,88,v,172
MA 52,v,84,v,168
MA 60,v,84,v,172
MA 48,v,80,v,168
TR 168,202,16384
TR 170,202,18432
MA 56,v,80,v,172
TR 172,203,16384
TR 174,203,18432
s_waitcnt lgkmcnt(4)
MA 0,v,112,v,144
MA 8,v,112,v,148
MA 4,v,116,v,144
MA 12,v,116,v,148
MA 64,v,120,v,144
MA 72,v,120,v,148
MA 68,v,124,v,144
MA 76,v,124,v,148
MA 128,v,128,v,144
MA 136,v,128,v,148
s_waitcnt vmcnt(15) lgkmcnt(0)
s_barrier
MA 132,v,132,v,144
s_add_u32 m0, s23, 0
s_and_b32 s37, s3, 3
MA 140,v,132,v,148
ds_read_b128 v[80:83], v194 offset:0
MA 192,v,136,v,144
s_cmp_eq_u32 s37, 0
s_cselect_b32 s37, 0, 0x40000000
MA 200,v,136,v,148
v_add_u32 v229, s37, v78
buffer_load_dword v79, v229, s[4:7], 0 offen
MA 196,v,140,v,144
TR 144,196,32768
TR 146,196,34816
MA 204,v,140,v,148
TR 148,197,32768
TR 150,197,34816
MA 212,v,140,v,152
ds_read_b128 v[84:87], v194 offset:2048
buffer_load_dwordx4 v184, s[12:15], s21 offen offset:0 lds
MA 220,v,140,v,156
s_add_u32 s84, s40, 50331648
s_addc_u32 s85, s41, 0
MA 208,v,136,v,152
buffer_load_dwordx4 v185, s[12:15], s21 offen offset:1024 lds
s_mov_b32 s86, 4194304
MA 216,v,136,v,156
s_mov_b32 s87, 0x20000
MA 148,v,132,v,152
s_add_u32 s88, s40, 58720256
s_addc_u32 s89, s41, 0
MA 156,v,132,v,156
ds_read_b128 v[88:91], v194 offset:4096
s_mov_b32 s90, 8192
MA 144,v,128,v,152
s_mov_b32 s91, 0x20000
v_mov_b32 v252, 0
MA 152,v,128,v,156
buffer_load_dwordx4 v186, s[12:15], s21 offen offset:2048 lds
v_mov_b32 v253, 0
MA 84,v,124,v,152
v_dot2_f32_bf16 v252, v230, v2, v252
v_dot2_f32_bf16 v253, v231, v3, v253
v_dot2_f32_bf16 v252, v232, v4, v252
v_dot2_f32_bf16 v253, v233, v5, v253
v_dot2_f32_bf16 v252, v234, v6, v252
v_dot2_f32_bf16 v253, v235, v7, v253
v_dot2_f32_bf16 v252, v236, v8, v252
v_dot2_f32_bf16 v253, v237, v9, v253
v_dot2_f32_bf16 v252, v238, v12, v252
v_dot2_f32_bf16 v253, v239, v13, v253
v_dot2_f32_bf16 v252, v240, v14, v252
v_dot2_f32_bf16 v253, v241, v15, v253
v_dot2_f32_bf16 v252, v242, v246, v252
v_dot2_f32_bf16 v253, v243, v247, v253
v_dot2_f32_bf16 v252, v244, v248, v252
v_dot2_f32_bf16 v253, v245, v249, v253
MA 92,v,124,v,156
MA 80,v,120,v,152
ds_read_b128 v[92:95], v194 offset:6144
MA 88,v,120,v,156
buffer_load_dwordx4 v187, s[12:15], s21 offen offset:3072 lds
MA 20,v,116,v,152
MA 28,v,116,v,156
MA 16,v,112,v,152
TR 152,198,32768
TR 154,198,34816
MA 24,v,112,v,156
TR 156,199,32768
TR 158,199,34816
MA 32,v,112,v,160
ds_read_b128 v[96:99], v194 offset:8192
s_add_u32 m0, s23, 4096
MA 40,v,112,v,164
s_nop 2
v_add_f32 v252, v252, v253
MA 36,v,116,v,160
MA 44,v,116,v,164
MA 96,v,120,v,160
ds_read_b128 v[100:103], v194 offset:10240
buffer_load_dwordx4 v188, s[12:15], s21 offen offset:0 lds
MA 104,v,120,v,164
v_add_f32_dpp v252, v252, v252 row_ror:8 row_mask:0xf bank_mask:0xf
s_nop 1
v_add_f32_dpp v252, v252, v252 row_ror:4 row_mask:0xf bank_mask:0xf
MA 100,v,124,v,160
s_nop 0
v_add_f32_dpp v252, v252, v252 row_ror:2 row_mask:0xf bank_mask:0xf
MA 108,v,124,v,164
s_nop 0
v_add_f32_dpp v252, v252, v252 row_ror:1 row_mask:0xf bank_mask:0xf
v_mov_b32 v253, v252
MA 160,v,128,v,160
buffer_load_dwordx4 v189, s[12:15], s21 offen offset:1024 lds
v_permlane16_swap_b32 v252, v253
MA 168,v,128,v,164
ds_read_b128 v[104:107], v194 offset:12288
v_add_f32 v252, v252, v253
MA 164,v,132,v,160
v_mul_f32 v252, 0xbfb8aa3b, v252
MA 172,v,132,v,164
v_exp_f32 v252, v252
MA 224,v,136,v,160
buffer_load_dwordx4 v190, s[12:15], s21 offen offset:2048 lds
v_add_f32 v252, 1.0, v252
MA 232,v,136,v,164
v_rcp_f32 v252, v252
MA 228,v,140,v,160
TR 160,200,32768
TR 162,200,34816
MA 236,v,140,v,164
TR 164,201,32768
TR 166,201,34816
MA 244,v,140,v,168
ds_read_b128 v[108:111], v194 offset:14336
MA 252,v,140,v,172
buffer_load_dwordx4 v191, s[12:15], s21 offen offset:3072 lds
MA 240,v,136,v,168
s_nop 0
buffer_store_dword v252, v11, s[88:91], 0 offen sc1
MA 248,v,136,v,172
s_getpc_b64 s[82:83]
L_ct_fV:
MA 180,v,132,v,168
s_add_u32 s82, s82, L_p2 - L_ct_fV
s_addc_u32 s83, s83, 0
MA 188,v,132,v,172
s_add_u32 s21, s21, 524288
v_mov_b32 v67, s83
MA 176,v,128,v,168
v_mov_b32 v66, s82
s_lshr_b32 s82, s2, 3
MA 184,v,128,v,172
s_lshl_b32 s82, s82, 2
s_add_u32 s82, s82, s3
MA 116,v,124,v,168
s_lshl_b32 s82, s82, 7
v_and_b32 v68, 3, v1
MA 124,v,124,v,172
s_and_b32 s21, s21, 4194303
v_lshlrev_b32 v68, 14, v68
MA 112,v,120,v,168
v_add_u32 v68, s82, v68
v_min_u32 v68, L_p3_begin - L_p2 - 4, v68
MA 120,v,120,v,172
v_add_co_u32 v66, vcc, v66, v68
s_nop 1
v_addc_co_u32 v67, vcc, 0, v67, vcc
MA 52,v,116,v,168
MA 60,v,116,v,172
global_load_dword v68, v[66:67], off
MA 48,v,112,v,168
TR 168,202,32768
TR 170,202,34816
MA 56,v,112,v,172
TR 172,203,32768
TR 174,203,34816
s_waitcnt lgkmcnt(4)
MA 0,v,80,v,144
s_add_u32 m0, s22, 32768
s_and_b32 s37, s3, 3
MA 8,v,80,v,148
ds_read_b128 v[112:115], v195 offset:0
MA 4,v,84,v,144
MA 12,v,84,v,148
MA 64,v,88,v,144
MA 72,v,88,v,148
buffer_load_dwordx4 v176, s[8:11], s20 offen offset:0 lds
MA 68,v,92,v,144
MA 76,v,92,v,148
ds_read_b128 v[116:119], v195 offset:2048
MA 128,v,96,v,144
MA 136,v,96,v,148
MA 132,v,100,v,144
buffer_load_dwordx4 v177, s[8:11], s20 offen offset:1024 lds
MA 140,v,100,v,148
MA 192,v,104,v,144
s_cmp_eq_u32 s37, 1
s_cselect_b32 s37, 0, 0x40000000
MA 200,v,104,v,148
ds_read_b128 v[120:123], v195 offset:4096
MA 196,v,108,v,144
TR 144,196,49152
TR 146,196,51200
MA 204,v,108,v,148
TR 148,197,49152
TR 150,197,51200
MA 212,v,108,v,152
buffer_load_dwordx4 v178, s[8:11], s20 offen offset:2048 lds
MA 220,v,108,v,156
MA 208,v,104,v,152
MA 216,v,104,v,156
MA 148,v,100,v,152
ds_read_b128 v[124:127], v195 offset:6144
buffer_load_dwordx4 v179, s[8:11], s20 offen offset:3072 lds
MA 156,v,100,v,156
MA 144,v,96,v,152
MA 152,v,96,v,156
MA 84,v,92,v,152
MA 92,v,92,v,156
s_add_u32 m0, s22, 36864
MA 80,v,88,v,152
ds_read_b128 v[128:131], v195 offset:8192
MA 88,v,88,v,156
MA 20,v,84,v,152
MA 28,v,84,v,156
MA 16,v,80,v,152
TR 152,198,49152
TR 154,198,51200
MA 24,v,80,v,156
TR 156,199,49152
TR 158,199,51200
MA 32,v,80,v,160
ds_read_b128 v[132:135], v195 offset:10240
buffer_load_dwordx4 v180, s[8:11], s20 offen offset:0 lds
MA 40,v,80,v,164
MA 36,v,84,v,160
MA 44,v,84,v,164
MA 96,v,88,v,160
buffer_load_dwordx4 v181, s[8:11], s20 offen offset:1024 lds
MA 104,v,88,v,164
v_add_u32 v229, s37, v78
MA 100,v,92,v,160
MA 108,v,92,v,164
ds_read_b128 v[136:139], v195 offset:12288
MA 160,v,96,v,160
MA 168,v,96,v,164
buffer_load_dwordx4 v182, s[8:11], s20 offen offset:2048 lds
MA 164,v,100,v,160
MA 172,v,100,v,164
MA 224,v,104,v,160
MA 232,v,104,v,164
ds_read_b128 v[140:143], v195 offset:14336
MA 228,v,108,v,160
TR 160,200,49152
TR 162,200,51200
MA 236,v,108,v,164
TR 164,201,49152
TR 166,201,51200
s_waitcnt lgkmcnt(15)
MA 244,v,108,v,168
buffer_load_dwordx4 v183, s[8:11], s20 offen offset:3072 lds
MA 252,v,108,v,172
buffer_load_dword v79, v229, s[4:7], 0 offen
MA 240,v,104,v,168
MA 248,v,104,v,172
s_add_u32 s20, s20, 128
MA 180,v,100,v,168
MA 188,v,100,v,172
MA 176,v,96,v,168
MA 184,v,96,v,172
MA 116,v,92,v,168
s_and_b32 s20, s20, 1023
MA 124,v,92,v,172
MA 112,v,88,v,168
MA 120,v,88,v,172
MA 52,v,84,v,168
MA 60,v,84,v,172
MA 48,v,80,v,168
TR 168,202,49152
TR 170,202,51200
MA 56,v,80,v,172
TR 172,203,49152
TR 174,203,51200
s_waitcnt lgkmcnt(4)
MA 0,v,112,v,144
MA 8,v,112,v,148
MA 4,v,116,v,144
MA 12,v,116,v,148
MA 64,v,120,v,144
MA 72,v,120,v,148
MA 68,v,124,v,144
MA 76,v,124,v,148
MA 128,v,128,v,144
MA 136,v,128,v,148
s_waitcnt vmcnt(11) lgkmcnt(0)
s_barrier
MA 132,v,132,v,144
s_add_u32 m0, s23, 32768
s_and_b32 s37, s3, 3
MA 140,v,132,v,148
ds_read_b128 v[80:83], v192 offset:0
MA 192,v,136,v,144
s_cmp_eq_u32 s37, 2
s_cselect_b32 s37, 0, 0x40000000
MA 200,v,136,v,148
v_add_u32 v229, s37, v78
buffer_load_dword v79, v229, s[4:7], 0 offen
MA 196,v,140,v,144
TR 144,196,0
TR 146,196,2048
MA 204,v,140,v,148
TR 148,197,0
TR 150,197,2048
MA 212,v,140,v,152
ds_read_b128 v[84:87], v192 offset:2048
buffer_load_dwordx4 v184, s[12:15], s21 offen offset:0 lds
MA 220,v,140,v,156
v_lshlrev_b32 v2, 16, v54
v_and_b32 v3, 0xffff0000, v54
MA 208,v,136,v,152
buffer_load_dwordx4 v185, s[12:15], s21 offen offset:1024 lds
v_lshlrev_b32 v4, 16, v55
MA 216,v,136,v,156
v_and_b32 v5, 0xffff0000, v55
v_lshlrev_b32 v6, 16, v56
MA 148,v,132,v,152
v_and_b32 v7, 0xffff0000, v56
v_lshlrev_b32 v8, 16, v57
MA 156,v,132,v,156
ds_read_b128 v[88:91], v192 offset:4096
v_and_b32 v9, 0xffff0000, v57
MA 144,v,128,v,152
v_lshlrev_b32 v230, 16, v16
v_and_b32 v231, 0xffff0000, v16
MA 152,v,128,v,156
buffer_load_dwordx4 v186, s[12:15], s21 offen offset:2048 lds
v_lshlrev_b32 v232, 16, v18
MA 84,v,124,v,152
v_and_b32 v233, 0xffff0000, v18
v_lshlrev_b32 v234, 16, v20
MA 92,v,124,v,156
v_and_b32 v235, 0xffff0000, v20
v_lshlrev_b32 v236, 16, v22
MA 80,v,120,v,152
ds_read_b128 v[92:95], v192 offset:6144
v_and_b32 v237, 0xffff0000, v22
MA 88,v,120,v,156
buffer_load_dwordx4 v187, s[12:15], s21 offen offset:3072 lds
v_lshlrev_b32 v238, 16, v24
MA 20,v,116,v,152
v_and_b32 v239, 0xffff0000, v24
v_lshlrev_b32 v240, 16, v26
MA 28,v,116,v,156
v_and_b32 v241, 0xffff0000, v26
v_lshlrev_b32 v242, 16, v28
MA 16,v,112,v,152
TR 152,198,0
TR 154,198,2048
MA 24,v,112,v,156
TR 156,199,0
TR 158,199,2048
MA 32,v,112,v,160
ds_read_b128 v[96:99], v192 offset:8192
s_add_u32 m0, s23, 36864
MA 40,v,112,v,164
v_and_b32 v243, 0xffff0000, v28
v_lshlrev_b32 v244, 16, v30
MA 36,v,116,v,160
v_and_b32 v245, 0xffff0000, v30
v_lshlrev_b32 v246, 16, v32
MA 44,v,116,v,164
v_and_b32 v247, 0xffff0000, v32
v_lshlrev_b32 v248, 16, v34
MA 96,v,120,v,160
ds_read_b128 v[100:103], v192 offset:10240
buffer_load_dwordx4 v188, s[12:15], s21 offen offset:0 lds
MA 104,v,120,v,164
v_and_b32 v249, 0xffff0000, v34
v_lshlrev_b32 v250, 16, v36
MA 100,v,124,v,160
v_and_b32 v251, 0xffff0000, v36
v_lshlrev_b32 v254, 16, v38
MA 108,v,124,v,164
v_and_b32 v255, 0xffff0000, v38
v_mul_f32 v62, v236, v2
MA 160,v,128,v,160
buffer_load_dwordx4 v189, s[12:15], s21 offen offset:1024 lds
v_mul_f32 v70, v237, v6
MA 168,v,128,v,164
ds_read_b128 v[104:107], v192 offset:12288
v_fmac_f32 v62, v234, v3
MA 164,v,132,v,160
v_fmac_f32 v70, v235, v7
v_fmac_f32 v62, v232, v4
MA 172,v,132,v,164
v_fmac_f32 v70, v233, v8
v_fmac_f32 v62, v230, v5
MA 224,v,136,v,160
buffer_load_dwordx4 v190, s[12:15], s21 offen offset:2048 lds
v_fmac_f32 v70, v231, v9
MA 232,v,136,v,164
v_mul_f32 v62, v62, v254
v_mul_f32 v70, v70, v255
MA 228,v,140,v,160
TR 160,200,0
TR 162,200,2048
MA 236,v,140,v,164
TR 164,201,0
TR 166,201,2048
MA 244,v,140,v,168
ds_read_b128 v[108:111], v192 offset:14336
v_lshlrev_b32 v254, 16, v40
MA 252,v,140,v,172
buffer_load_dwordx4 v191, s[12:15], s21 offen offset:3072 lds
v_and_b32 v255, 0xffff0000, v40
MA 240,v,136,v,168
v_mul_f32 v63, v238, v2
v_mul_f32 v71, v239, v6
MA 248,v,136,v,172
v_fmac_f32 v63, v236, v3
v_fmac_f32 v71, v237, v7
MA 180,v,132,v,168
v_fmac_f32 v63, v234, v4
v_fmac_f32 v71, v235, v8
MA 188,v,132,v,172
s_add_u32 s21, s21, 524288
v_fmac_f32 v63, v232, v5
MA 176,v,128,v,168
v_fmac_f32 v71, v233, v9
v_mul_f32 v63, v63, v254
MA 184,v,128,v,172
v_mul_f32 v71, v71, v255
v_lshlrev_b32 v254, 16, v42
MA 116,v,124,v,168
v_and_b32 v255, 0xffff0000, v42
v_mul_f32 v64, v240, v2
MA 124,v,124,v,172
s_and_b32 s21, s21, 4194303
v_mul_f32 v72, v241, v6
MA 112,v,120,v,168
v_fmac_f32 v64, v238, v3
v_fmac_f32 v72, v239, v7
MA 120,v,120,v,172
v_fmac_f32 v64, v236, v4
v_fmac_f32 v72, v237, v8
MA 52,v,116,v,168
v_fmac_f32 v64, v234, v5
v_fmac_f32 v72, v235, v9
MA 60,v,116,v,172
v_mul_f32 v64, v64, v254
v_mul_f32 v72, v72, v255
MA 48,v,112,v,168
TR 168,202,0
TR 170,202,2048
MA 56,v,112,v,172
TR 172,203,0
TR 174,203,2048
v_lshlrev_b32 v254, 16, v44
v_and_b32 v255, 0xffff0000, v44
v_mul_f32 v65, v242, v2
s_waitcnt lgkmcnt(4)
MA 0,v,80,v,144
s_add_u32 s75, s64, s74
s_and_b32 s37, s3, 3
MA 8,v,80,v,148
ds_read_b128 v[112:115], v193 offset:0
MA 4,v,84,v,144
s_cmp_eq_u32 s37, 3
s_cselect_b32 s37, 0, 0x40000000
MA 12,v,84,v,148
v_add_u32 v229, s37, v78
buffer_load_dword v79, v229, s[4:7], 0 offen
MA 64,v,88,v,144
s_add_u32 m0, s67, 65536
v_mul_f32 v73, v243, v6
MA 72,v,88,v,148
v_fmac_f32 v65, v240, v3
v_fmac_f32 v73, v241, v7
MA 68,v,92,v,144
v_fmac_f32 v65, v238, v4
MA 76,v,92,v,148
ds_read_b128 v[116:119], v193 offset:2048
v_fmac_f32 v73, v239, v8
MA 128,v,96,v,144
buffer_load_dwordx4 v208, s[44:47], s75 offen offset:0 lds
v_fmac_f32 v65, v236, v5
MA 136,v,96,v,148
v_fmac_f32 v73, v237, v9
MA 132,v,100,v,144
v_mul_f32 v65, v65, v254
v_mul_f32 v73, v73, v255
MA 140,v,100,v,148
v_lshlrev_b32 v254, 16, v46
MA 192,v,104,v,144
v_and_b32 v255, 0xffff0000, v46
MA 200,v,104,v,148
ds_read_b128 v[120:123], v193 offset:4096
buffer_load_dwordx4 v209, s[44:47], s75 offen offset:1024 lds
MA 196,v,108,v,144
TR 144,196,16384
TR 146,196,18432
MA 204,v,108,v,148
TR 148,197,16384
TR 150,197,18432
MA 212,v,108,v,152
v_mul_f32 v66, v244, v2
v_mul_f32 v74, v245, v6
MA 220,v,108,v,156
buffer_load_dwordx4 v210, s[44:47], s75 offen offset:2048 lds
v_fmac_f32 v66, v242, v3
MA 208,v,104,v,152
v_fmac_f32 v74, v243, v7
v_fmac_f32 v66, v240, v4
MA 216,v,104,v,156
v_fmac_f32 v74, v241, v8
v_fmac_f32 v66, v238, v5
MA 148,v,100,v,152
ds_read_b128 v[124:127], v193 offset:6144
v_fmac_f32 v74, v239, v9
MA 156,v,100,v,156
v_mul_f32 v66, v66, v254
v_mul_f32 v74, v74, v255
MA 144,v,96,v,152
buffer_load_dwordx4 v211, s[44:47], s75 offen offset:3072 lds
v_lshlrev_b32 v254, 16, v48
MA 152,v,96,v,156
v_and_b32 v255, 0xffff0000, v48
v_mul_f32 v67, v246, v2
MA 84,v,92,v,152
v_mul_f32 v75, v247, v6
MA 92,v,92,v,156
v_fmac_f32 v67, v244, v3
v_fmac_f32 v75, v245, v7
MA 80,v,88,v,152
ds_read_b128 v[128:131], v193 offset:8192
s_add_u32 s75, s65, s74
MA 88,v,88,v,156
v_fmac_f32 v67, v242, v4
v_fmac_f32 v75, v243, v8
MA 20,v,84,v,152
v_fmac_f32 v67, v240, v5
MA 28,v,84,v,156
v_fmac_f32 v75, v241, v9
MA 16,v,80,v,152
TR 152,198,16384
TR 154,198,18432
MA 24,v,80,v,156
TR 156,199,16384
TR 158,199,18432
MA 32,v,80,v,160
ds_read_b128 v[132:135], v193 offset:10240
s_add_u32 m0, s67, 69632
MA 40,v,80,v,164
v_mul_f32 v67, v67, v254
v_mul_f32 v75, v75, v255
MA 36,v,84,v,160
v_lshlrev_b32 v254, 16, v50
v_and_b32 v255, 0xffff0000, v50
MA 44,v,84,v,164
buffer_load_dwordx4 v208, s[44:47], s75 offen offset:0 lds
s_waitcnt vmcnt(24)
v_mul_f32 v68, v248, v2
MA 96,v,88,v,160
v_mul_f32 v76, v249, v6
v_fmac_f32 v68, v246, v3
MA 104,v,88,v,164
v_fmac_f32 v76, v247, v7
v_fmac_f32 v68, v244, v4
MA 100,v,92,v,160
v_fmac_f32 v76, v245, v8
v_fmac_f32 v68, v242, v5
MA 108,v,92,v,164
ds_read_b128 v[136:139], v193 offset:12288
buffer_load_dwordx4 v209, s[44:47], s75 offen offset:1024 lds
MA 160,v,96,v,160
v_fmac_f32 v76, v243, v9
v_mul_f32 v68, v68, v254
MA 168,v,96,v,164
v_mul_f32 v76, v76, v255
v_lshlrev_b32 v254, 16, v52
MA 164,v,100,v,160
v_and_b32 v255, 0xffff0000, v52
MA 172,v,100,v,164
v_mul_f32 v69, v250, v2
MA 224,v,104,v,160
buffer_load_dwordx4 v210, s[44:47], s75 offen offset:2048 lds
v_mul_f32 v77, v251, v6
MA 232,v,104,v,164
ds_read_b128 v[140:143], v193 offset:14336
v_fmac_f32 v69, v248, v3
MA 228,v,108,v,160
TR 160,200,16384
TR 162,200,18432
MA 236,v,108,v,164
TR 164,201,16384
TR 166,201,18432
s_waitcnt lgkmcnt(15)
MA 244,v,108,v,168
buffer_load_dwordx4 v211, s[44:47], s75 offen offset:3072 lds
v_fmac_f32 v77, v249, v7
MA 252,v,108,v,172
v_fmac_f32 v69, v246, v4
v_fmac_f32 v77, v247, v8
MA 240,v,104,v,168
v_fmac_f32 v69, v244, v5
v_fmac_f32 v77, v245, v9
MA 248,v,104,v,172
v_mul_f32 v69, v69, v254
v_mul_f32 v77, v77, v255
MA 180,v,100,v,168
v_cvt_pk_bf16_f32 v12, v69, v68
v_cvt_pk_bf16_f32 v13, v67, v66
MA 188,v,100,v,172
s_add_u32 s74, s74, 128
v_cvt_pk_bf16_f32 v14, v65, v64
MA 176,v,96,v,168
v_cvt_pk_bf16_f32 v15, v63, v62
MA 184,v,96,v,172
s_mov_b32 s36, 0
MA 116,v,92,v,168
buffer_store_dwordx4 v[12:15], v10, s[84:87], s36 offen sc1
v_cvt_pk_bf16_f32 v54, v77, v76
MA 124,v,92,v,172
s_and_b32 s74, s74, 2047
v_cvt_pk_bf16_f32 v55, v75, v74
MA 112,v,88,v,168
v_cvt_pk_bf16_f32 v56, v73, v72
MA 120,v,88,v,172
v_cvt_pk_bf16_f32 v57, v71, v70
MA 52,v,84,v,168
s_mov_b32 s36, 4096
MA 60,v,84,v,172
buffer_store_dwordx4 v[54:57], v10, s[84:87], s36 offen sc1
MA 48,v,80,v,168
TR 168,202,16384
TR 170,202,18432
MA 56,v,80,v,172
TR 172,203,16384
TR 174,203,18432
s_waitcnt lgkmcnt(4)
MA 0,v,112,v,144
MA 8,v,112,v,148
MA 4,v,116,v,144
MA 12,v,116,v,148
MA 64,v,120,v,144
MA 72,v,120,v,148
MA 68,v,124,v,144
MA 76,v,124,v,148
MA 128,v,128,v,144
MA 136,v,128,v,148
s_waitcnt vmcnt(11) lgkmcnt(0)
s_barrier
MA 132,v,132,v,144
s_add_u32 m0, s68, 98304
v_lshlrev_b32 v2, 16, v58
MA 140,v,132,v,148
ds_read_b128 v[80:83], v192 offset:32768
v_and_b32 v3, 0xffff0000, v58
MA 192,v,136,v,144
v_lshlrev_b32 v4, 16, v59
v_and_b32 v5, 0xffff0000, v59
MA 200,v,136,v,148
buffer_load_dwordx4 v212, s[48:51], s66 offen offset:0 lds
v_lshlrev_b32 v6, 16, v60
MA 196,v,140,v,144
TR 144,196,32768
TR 146,196,34816
MA 204,v,140,v,148
TR 148,197,32768
TR 150,197,34816
MA 212,v,140,v,152
ds_read_b128 v[84:87], v192 offset:34816
v_and_b32 v7, 0xffff0000, v60
MA 220,v,140,v,156
buffer_load_dwordx4 v213, s[48:51], s66 offen offset:1024 lds
v_lshlrev_b32 v8, 16, v61
MA 208,v,136,v,152
v_and_b32 v9, 0xffff0000, v61
v_lshlrev_b32 v230, 16, v17
MA 216,v,136,v,156
v_and_b32 v231, 0xffff0000, v17
v_lshlrev_b32 v232, 16, v19
MA 148,v,132,v,152
v_and_b32 v233, 0xffff0000, v19
v_lshlrev_b32 v234, 16, v21
MA 156,v,132,v,156
ds_read_b128 v[88:91], v192 offset:36864
buffer_load_dwordx4 v214, s[48:51], s66 offen offset:2048 lds
MA 144,v,128,v,152
v_and_b32 v235, 0xffff0000, v21
v_lshlrev_b32 v236, 16, v23
MA 152,v,128,v,156
v_and_b32 v237, 0xffff0000, v23
v_lshlrev_b32 v238, 16, v25
MA 84,v,124,v,152
buffer_load_dwordx4 v215, s[48:51], s66 offen offset:3072 lds
v_and_b32 v239, 0xffff0000, v25
MA 92,v,124,v,156
v_lshlrev_b32 v240, 16, v27
v_and_b32 v241, 0xffff0000, v27
MA 80,v,120,v,152
ds_read_b128 v[92:95], v192 offset:38912
v_lshlrev_b32 v242, 16, v29
MA 88,v,120,v,156
v_and_b32 v243, 0xffff0000, v29
v_lshlrev_b32 v244, 16, v31
MA 20,v,116,v,152
s_add_u32 s66, s66, 524288
v_and_b32 v245, 0xffff0000, v31
MA 28,v,116,v,156
v_lshlrev_b32 v246, 16, v33
v_and_b32 v247, 0xffff0000, v33
MA 16,v,112,v,152
TR 152,198,32768
TR 154,198,34816
MA 24,v,112,v,156
TR 156,199,32768
TR 158,199,34816
MA 32,v,112,v,160
ds_read_b128 v[96:99], v192 offset:40960
s_and_b32 s66, s66, 8388607
MA 40,v,112,v,164
v_lshlrev_b32 v248, 16, v35
v_and_b32 v249, 0xffff0000, v35
MA 36,v,116,v,160
v_lshlrev_b32 v250, 16, v37
v_and_b32 v251, 0xffff0000, v37
MA 44,v,116,v,164
v_lshlrev_b32 v254, 16, v39
v_and_b32 v255, 0xffff0000, v39
MA 96,v,120,v,160
ds_read_b128 v[100:103], v192 offset:43008
s_add_u32 m0, s68, 114688
MA 104,v,120,v,164
v_mul_f32 v62, v236, v2
v_mul_f32 v70, v237, v6
MA 100,v,124,v,160
v_fmac_f32 v62, v234, v3
v_fmac_f32 v70, v235, v7
MA 108,v,124,v,164
buffer_load_dwordx4 v212, s[48:51], s66 offen offset:0 lds
v_fmac_f32 v62, v232, v4
MA 160,v,128,v,160
v_fmac_f32 v70, v233, v8
v_fmac_f32 v62, v230, v5
MA 168,v,128,v,164
ds_read_b128 v[104:107], v192 offset:45056
v_fmac_f32 v70, v231, v9
MA 164,v,132,v,160
v_mul_f32 v62, v62, v254
v_mul_f32 v70, v70, v255
MA 172,v,132,v,164
buffer_load_dwordx4 v213, s[48:51], s66 offen offset:1024 lds
v_lshlrev_b32 v254, 16, v41
MA 224,v,136,v,160
v_and_b32 v255, 0xffff0000, v41
v_mul_f32 v63, v238, v2
MA 232,v,136,v,164
v_mul_f32 v71, v239, v6
v_fmac_f32 v63, v236, v3
MA 228,v,140,v,160
TR 160,200,32768
TR 162,200,34816
MA 236,v,140,v,164
TR 164,201,32768
TR 166,201,34816
MA 244,v,140,v,168
ds_read_b128 v[108:111], v192 offset:47104
buffer_load_dwordx4 v214, s[48:51], s66 offen offset:2048 lds
MA 252,v,140,v,172
v_fmac_f32 v71, v237, v7
v_fmac_f32 v63, v234, v4
MA 240,v,136,v,168
buffer_load_dwordx4 v215, s[48:51], s66 offen offset:3072 lds
v_fmac_f32 v71, v235, v8
MA 248,v,136,v,172
v_fmac_f32 v63, v232, v5
v_fmac_f32 v71, v233, v9
MA 180,v,132,v,168
v_mul_f32 v63, v63, v254
v_mul_f32 v71, v71, v255
MA 188,v,132,v,172
v_lshlrev_b32 v254, 16, v43
v_and_b32 v255, 0xffff0000, v43
MA 176,v,128,v,168
s_add_u32 s66, s66, 524288
v_mul_f32 v64, v240, v2
MA 184,v,128,v,172
v_mul_f32 v72, v241, v6
v_fmac_f32 v64, v238, v3
MA 116,v,124,v,168
v_fmac_f32 v72, v239, v7
v_fmac_f32 v64, v236, v4
MA 124,v,124,v,172
v_fmac_f32 v72, v237, v8
v_fmac_f32 v64, v234, v5
MA 112,v,120,v,168
s_and_b32 s66, s66, 8388607
v_fmac_f32 v72, v235, v9
MA 120,v,120,v,172
v_mul_f32 v64, v64, v254
v_mul_f32 v72, v72, v255
MA 52,v,116,v,168
v_lshlrev_b32 v254, 16, v45
v_and_b32 v255, 0xffff0000, v45
MA 60,v,116,v,172
v_mul_f32 v65, v242, v2
MA 48,v,112,v,168
TR 168,202,32768
TR 170,202,34816
MA 56,v,112,v,172
TR 172,203,32768
TR 174,203,34816
s_waitcnt lgkmcnt(4)
MA 0,v,80,v,144
s_add_u32 s75, s64, s74
v_mul_f32 v73, v243, v6
MA 8,v,80,v,148
ds_read_b128 v[112:115], v193 offset:32768
v_fmac_f32 v65, v240, v3
MA 4,v,84,v,144
v_fmac_f32 v73, v241, v7
v_fmac_f32 v65, v238, v4
MA 12,v,84,v,148
v_fmac_f32 v73, v239, v8
MA 64,v,88,v,144
s_add_u32 m0, s67, 0
v_fmac_f32 v65, v236, v5
MA 72,v,88,v,148
v_fmac_f32 v73, v237, v9
MA 68,v,92,v,144
v_mul_f32 v65, v65, v254
MA 76,v,92,v,148
ds_read_b128 v[116:119], v193 offset:34816
v_mul_f32 v73, v73, v255
MA 128,v,96,v,144
buffer_load_dwordx4 v208, s[44:47], s75 offen offset:0 lds
v_lshlrev_b32 v254, 16, v47
MA 136,v,96,v,148
v_and_b32 v255, 0xffff0000, v47
v_mul_f32 v66, v244, v2
MA 132,v,100,v,144
v_mul_f32 v74, v245, v6
MA 140,v,100,v,148
v_fmac_f32 v66, v242, v3
MA 192,v,104,v,144
v_fmac_f32 v74, v243, v7
MA 200,v,104,v,148
ds_read_b128 v[120:123], v193 offset:36864
buffer_load_dwordx4 v209, s[44:47], s75 offen offset:1024 lds
MA 196,v,108,v,144
TR 144,196,49152
TR 146,196,51200
MA 204,v,108,v,148
TR 148,197,49152
TR 150,197,51200
MA 212,v,108,v,152
v_fmac_f32 v66, v240, v4
v_fmac_f32 v74, v241, v8
MA 220,v,108,v,156
buffer_load_dwordx4 v210, s[44:47], s75 offen offset:2048 lds
v_fmac_f32 v66, v238, v5
MA 208,v,104,v,152
v_fmac_f32 v74, v239, v9
v_mul_f32 v66, v66, v254
MA 216,v,104,v,156
v_mul_f32 v74, v74, v255
v_lshlrev_b32 v254, 16, v49
MA 148,v,100,v,152
ds_read_b128 v[124:127], v193 offset:38912
v_and_b32 v255, 0xffff0000, v49
MA 156,v,100,v,156
v_mul_f32 v67, v246, v2
v_mul_f32 v75, v247, v6
MA 144,v,96,v,152
buffer_load_dwordx4 v211, s[44:47], s75 offen offset:3072 lds
v_fmac_f32 v67, v244, v3
MA 152,v,96,v,156
v_fmac_f32 v75, v245, v7
v_fmac_f32 v67, v242, v4
MA 84,v,92,v,152
v_fmac_f32 v75, v243, v8
MA 92,v,92,v,156
v_fmac_f32 v67, v240, v5
MA 80,v,88,v,152
ds_read_b128 v[128:131], v193 offset:40960
s_add_u32 s75, s65, s74
MA 88,v,88,v,156
v_fmac_f32 v75, v241, v9
v_mul_f32 v67, v67, v254
MA 20,v,84,v,152
v_mul_f32 v75, v75, v255
MA 28,v,84,v,156
v_lshlrev_b32 v254, 16, v51
MA 16,v,80,v,152
TR 152,198,49152
TR 154,198,51200
MA 24,v,80,v,156
TR 156,199,49152
TR 158,199,51200
MA 32,v,80,v,160
ds_read_b128 v[132:135], v193 offset:43008
s_add_u32 m0, s67, 4096
MA 40,v,80,v,164
v_and_b32 v255, 0xffff0000, v51
v_mul_f32 v68, v248, v2
MA 36,v,84,v,160
v_mul_f32 v76, v249, v6
v_fmac_f32 v68, v246, v3
MA 44,v,84,v,164
buffer_load_dwordx4 v208, s[44:47], s75 offen offset:0 lds
v_fmac_f32 v76, v247, v7
MA 96,v,88,v,160
v_fmac_f32 v68, v244, v4
v_fmac_f32 v76, v245, v8
MA 104,v,88,v,164
v_fmac_f32 v68, v242, v5
v_fmac_f32 v76, v243, v9
MA 100,v,92,v,160
v_mul_f32 v68, v68, v254
v_mul_f32 v76, v76, v255
MA 108,v,92,v,164
ds_read_b128 v[136:139], v193 offset:45056
buffer_load_dwordx4 v209, s[44:47], s75 offen offset:1024 lds
MA 160,v,96,v,160
v_lshlrev_b32 v254, 16, v53
v_and_b32 v255, 0xffff0000, v53
MA 168,v,96,v,164
v_mul_f32 v69, v250, v2
MA 164,v,100,v,160
v_mul_f32 v77, v251, v6
MA 172,v,100,v,164
v_fmac_f32 v69, v248, v3
MA 224,v,104,v,160
buffer_load_dwordx4 v210, s[44:47], s75 offen offset:2048 lds
v_fmac_f32 v77, v249, v7
MA 232,v,104,v,164
ds_read_b128 v[140:143], v193 offset:47104
v_fmac_f32 v69, v246, v4
MA 228,v,108,v,160
TR 160,200,49152
TR 162,200,51200
MA 236,v,108,v,164
TR 164,201,49152
TR 166,201,51200
s_waitcnt lgkmcnt(15)
MA 244,v,108,v,168
buffer_load_dwordx4 v211, s[44:47], s75 offen offset:3072 lds
v_fmac_f32 v77, v247, v8
MA 252,v,108,v,172
v_fmac_f32 v69, v244, v5
v_fmac_f32 v77, v245, v9
MA 240,v,104,v,168
v_mul_f32 v69, v69, v254
v_mul_f32 v77, v77, v255
MA 248,v,104,v,172
v_cvt_pk_bf16_f32 v230, v69, v68
v_cvt_pk_bf16_f32 v231, v67, v66
MA 180,v,100,v,168
v_cvt_pk_bf16_f32 v232, v65, v64
MA 188,v,100,v,172
s_add_u32 s74, s74, 128
v_cvt_pk_bf16_f32 v233, v63, v62
MA 176,v,96,v,168
s_mov_b32 s36, 8192
buffer_store_dwordx4 v[230:233], v10, s[84:87], s36 offen sc1
MA 184,v,96,v,172
v_cvt_pk_bf16_f32 v234, v77, v76
MA 116,v,92,v,168
v_cvt_pk_bf16_f32 v235, v75, v74
MA 124,v,92,v,172
s_and_b32 s74, s74, 2047
v_cvt_pk_bf16_f32 v236, v73, v72
MA 112,v,88,v,168
v_cvt_pk_bf16_f32 v237, v71, v70
MA 120,v,88,v,172
s_mov_b32 s36, 12288
MA 52,v,84,v,168
buffer_store_dwordx4 v[234:237], v10, s[84:87], s36 offen sc1
MA 60,v,84,v,172
v_lshlrev_b32 v228, 4, v1
MA 48,v,80,v,168
TR 168,202,49152
TR 170,202,51200
MA 56,v,80,v,172
TR 172,203,49152
TR 174,203,51200
s_waitcnt lgkmcnt(4)
MA 0,v,112,v,144
MA 8,v,112,v,148
MA 4,v,116,v,144
MA 12,v,116,v,148
MA 64,v,120,v,144
MA 72,v,120,v,148
MA 68,v,124,v,144
MA 76,v,124,v,148
MA 128,v,128,v,144
MA 136,v,128,v,148
s_waitcnt vmcnt(14) lgkmcnt(0)
s_barrier
MA 132,v,132,v,144
ds_read_b128 v[48:51], v226 offset:0
s_add_u32 m0, s68, 131072
MA 140,v,132,v,148
MA 192,v,136,v,144
ds_read_b128 v[52:55], v226 offset:2048
buffer_load_dwordx4 v212, s[48:51], s66 offen offset:0 lds
MA 200,v,136,v,148
MA 196,v,140,v,144
ds_read_b128 v[56:59], v226 offset:4096
buffer_load_dwordx4 v213, s[48:51], s66 offen offset:1024 lds
MA 204,v,140,v,148
MA 212,v,140,v,152
ds_read_b128 v[60:63], v226 offset:6144
MA 220,v,140,v,156
buffer_load_dwordx4 v214, s[48:51], s66 offen offset:2048 lds
MA 208,v,136,v,152
TR 16,216,0
MA 216,v,136,v,156
buffer_load_dwordx4 v215, s[48:51], s66 offen offset:3072 lds
MA 148,v,132,v,152
TR 18,216,1024
MA 156,v,132,v,156
MA 144,v,128,v,152
TR 20,217,0
s_add_u32 s66, s66, 524288
MA 152,v,128,v,156
MA 84,v,124,v,152
TR 22,217,1024
s_and_b32 s66, s66, 8388607
MA 92,v,124,v,156
MA 80,v,120,v,152
TR 24,218,0
MA 88,v,120,v,156
s_add_u32 s75, s64, s74
MA 20,v,116,v,152
TR 26,218,1024
MA 28,v,116,v,156
s_add_u32 m0, s67, 32768
MA 16,v,112,v,152
TR 28,219,0
MA 24,v,112,v,156
MA 32,v,112,v,160
TR 30,219,1024
buffer_load_dwordx4 v208, s[44:47], s75 offen offset:0 lds
MA 40,v,112,v,164
MA 36,v,116,v,160
TR 32,220,0
buffer_load_dwordx4 v209, s[44:47], s75 offen offset:1024 lds
MA 44,v,116,v,164
MA 96,v,120,v,160
TR 34,220,1024
MA 104,v,120,v,164
buffer_load_dwordx4 v210, s[44:47], s75 offen offset:2048 lds
MA 100,v,124,v,160
TR 36,221,0
MA 108,v,124,v,164
buffer_load_dwordx4 v211, s[44:47], s75 offen offset:3072 lds
MA 160,v,128,v,160
TR 38,221,1024
MA 168,v,128,v,164
MA 164,v,132,v,160
TR 40,222,0
s_add_u32 s75, s65, s74
MA 172,v,132,v,164
MA 224,v,136,v,160
TR 42,222,1024
s_add_u32 m0, s67, 36864
MA 232,v,136,v,164
MA 228,v,140,v,160
TR 44,223,0
MA 236,v,140,v,164
buffer_load_dwordx4 v208, s[44:47], s75 offen offset:0 lds
MA 244,v,140,v,168
TR 46,223,1024
MA 252,v,140,v,172
buffer_load_dwordx4 v209, s[44:47], s75 offen offset:1024 lds
MA 240,v,136,v,168
MA 248,v,136,v,172
MA 180,v,132,v,168
buffer_load_dwordx4 v210, s[44:47], s75 offen offset:2048 lds
MA 188,v,132,v,172
MA 176,v,128,v,168
buffer_load_dwordx4 v211, s[44:47], s75 offen offset:3072 lds
MA 184,v,128,v,172
MA 116,v,124,v,168
MA 124,v,124,v,172
s_add_u32 s74, s74, 128
MA 112,v,120,v,168
MA 120,v,120,v,172
s_and_b32 s74, s74, 2047
MA 52,v,116,v,168
MA 60,v,116,v,172
MA 48,v,112,v,168
MA 56,v,112,v,172
L_p2:
s_waitcnt lgkmcnt(4)
v_mfma_f32_16x16x32_bf16 v[80:83], v[16:19], v[48:51], 0
s_add_u32 s8, s40, 59768832
s_addc_u32 s9, s41, 0
v_mfma_f32_16x16x32_bf16 v[96:99], v[20:23], v[48:51], 0
ds_read_b128 v[64:67], v227 offset:0
v_mfma_f32_16x16x32_bf16 v[84:87], v[16:19], v[52:55], 0
s_mov_b32 s10, 8192
v_mfma_f32_16x16x32_bf16 v[100:103], v[20:23], v[52:55], 0
s_mov_b32 s11, 0x20000
v_mfma_f32_16x16x32_bf16 v[88:91], v[16:19], v[56:59], 0
s_mov_b32 s12, s38
v_mfma_f32_16x16x32_bf16 v[104:107], v[20:23], v[56:59], 0
s_mov_b32 s13, s39
v_mfma_f32_16x16x32_bf16 v[92:95], v[16:19], v[60:63], 0
TR 16,216,8192
TR 18,216,9216
v_mfma_f32_16x16x32_bf16 v[108:111], v[20:23], v[60:63], 0
TR 20,217,8192
TR 22,217,9216
v_mfma_f32_16x16x32_bf16 v[124:127], v[24:27], v[60:63], 0
ds_read_b128 v[68:71], v227 offset:2048
s_mov_b32 s14, 256
v_mfma_f32_16x16x32_bf16 v[140:143], v[28:31], v[60:63], 0
s_mov_b32 s15, 0x20000
v_accvgpr_read_b32 v234, a0
v_mfma_f32_16x16x32_bf16 v[120:123], v[24:27], v[56:59], 0
v_accvgpr_read_b32 v235, a1
v_accvgpr_read_b32 v236, a2
v_mfma_f32_16x16x32_bf16 v[136:139], v[28:31], v[56:59], 0
v_accvgpr_read_b32 v237, a3
v_mfma_f32_16x16x32_bf16 v[116:119], v[24:27], v[52:55], 0
ds_read_b128 v[72:75], v227 offset:4096
v_accvgpr_read_b32 v238, a4
v_mfma_f32_16x16x32_bf16 v[132:135], v[28:31], v[52:55], 0
v_accvgpr_read_b32 v239, a5
v_mfma_f32_16x16x32_bf16 v[112:115], v[24:27], v[48:51], 0
TR 24,218,8192
TR 26,218,9216
v_mfma_f32_16x16x32_bf16 v[128:131], v[28:31], v[48:51], 0
TR 28,219,8192
TR 30,219,9216
v_mfma_f32_16x16x32_bf16 v[144:147], v[32:35], v[48:51], 0
v_accvgpr_read_b32 v240, a6
v_accvgpr_read_b32 v241, a7
v_mfma_f32_16x16x32_bf16 v[160:163], v[36:39], v[48:51], 0
v_cvt_pk_bf16_f32 v230, v234, v235
v_cvt_pk_bf16_f32 v231, v236, v237
v_mfma_f32_16x16x32_bf16 v[148:151], v[32:35], v[52:55], 0
ds_read_b128 v[76:79], v227 offset:6144
v_cvt_pk_bf16_f32 v232, v238, v239
v_mfma_f32_16x16x32_bf16 v[164:167], v[36:39], v[52:55], 0
v_cvt_pk_bf16_f32 v233, v240, v241
v_mfma_f32_16x16x32_bf16 v[152:155], v[32:35], v[56:59], 0
buffer_store_dwordx4 v[230:233], v228, s[16:19], s24 offen offset:0 sc1
v_mfma_f32_16x16x32_bf16 v[168:171], v[36:39], v[56:59], 0
v_accvgpr_read_b32 v246, a8
v_mfma_f32_16x16x32_bf16 v[156:159], v[32:35], v[60:63], 0
TR 32,220,8192
TR 34,220,9216
v_mfma_f32_16x16x32_bf16 v[172:175], v[36:39], v[60:63], 0
TR 36,221,8192
TR 38,221,9216
s_waitcnt lgkmcnt(15)
v_mfma_f32_16x16x32_bf16 v[188:191], v[40:43], v[60:63], 0
v_accvgpr_read_b32 v247, a9
v_accvgpr_read_b32 v248, a10
v_mfma_f32_16x16x32_bf16 v[204:207], v[44:47], v[60:63], 0
v_accvgpr_read_b32 v249, a11
v_accvgpr_read_b32 v250, a12
v_mfma_f32_16x16x32_bf16 v[184:187], v[40:43], v[56:59], 0
v_accvgpr_read_b32 v251, a13
v_mfma_f32_16x16x32_bf16 v[200:203], v[44:47], v[56:59], 0
v_accvgpr_read_b32 v252, a14
v_mfma_f32_16x16x32_bf16 v[180:183], v[40:43], v[52:55], 0
v_accvgpr_read_b32 v253, a15
v_mfma_f32_16x16x32_bf16 v[196:199], v[44:47], v[52:55], 0
v_mfma_f32_16x16x32_bf16 v[176:179], v[40:43], v[48:51], 0
TR 40,222,8192
TR 42,222,9216
v_mfma_f32_16x16x32_bf16 v[192:195], v[44:47], v[48:51], 0
TR 44,223,8192
TR 46,223,9216
s_waitcnt lgkmcnt(4)
MV 80,v,16,v,64
v_cvt_pk_bf16_f32 v242, v246, v247
MV 96,v,20,v,64
v_cvt_pk_bf16_f32 v243, v248, v249
MV 84,v,16,v,68
v_cvt_pk_bf16_f32 v244, v250, v251
MV 100,v,20,v,68
MV 88,v,16,v,72
v_cvt_pk_bf16_f32 v245, v252, v253
MV 104,v,20,v,72
buffer_store_dwordx4 v[242:245], v228, s[16:19], s24 offen offset:1024 sc1
MV 92,v,16,v,76
MV 108,v,20,v,76
s_waitcnt vmcnt(16) lgkmcnt(0)
s_barrier
MV 124,v,24,v,76
TR 16,216,16384
TR 18,216,17408
MV 140,v,28,v,76
ds_read_b128 v[48:51], v224 offset:0
s_add_u32 m0, s68, 98304
MV 120,v,24,v,72
TR 20,217,16384
TR 22,217,17408
MV 136,v,28,v,72
buffer_load_dwordx4 v212, s[48:51], s66 offen offset:0 lds
v_accvgpr_read_b32 v234, a16
MV 116,v,24,v,68
ds_read_b128 v[52:55], v224 offset:2048
buffer_load_dwordx4 v213, s[48:51], s66 offen offset:1024 lds
MV 132,v,28,v,68
v_accvgpr_read_b32 v235, a17
v_accvgpr_read_b32 v236, a18
MV 112,v,24,v,64
TR 24,218,16384
TR 26,218,17408
MV 128,v,28,v,64
TR 28,219,16384
TR 30,219,17408
MV 144,v,32,v,64
ds_read_b128 v[56:59], v224 offset:4096
buffer_load_dwordx4 v214, s[48:51], s66 offen offset:2048 lds
MV 160,v,36,v,64
buffer_load_dwordx4 v215, s[48:51], s66 offen offset:3072 lds
v_accvgpr_read_b32 v237, a19
MV 148,v,32,v,68
v_accvgpr_read_b32 v238, a20
v_accvgpr_read_b32 v239, a21
MV 164,v,36,v,68
s_add_u32 s66, s66, 524288
v_accvgpr_read_b32 v240, a22
MV 152,v,32,v,72
ds_read_b128 v[60:63], v224 offset:6144
v_accvgpr_read_b32 v241, a23
MV 168,v,36,v,72
s_and_b32 s66, s66, 8388607
v_cvt_pk_bf16_f32 v230, v234, v235
MV 156,v,32,v,76
TR 32,220,16384
TR 34,220,17408
MV 172,v,36,v,76
TR 36,221,16384
TR 38,221,17408
MV 188,v,40,v,76
s_add_u32 s75, s64, s74
v_cvt_pk_bf16_f32 v231, v236, v237
MV 204,v,44,v,76
v_cvt_pk_bf16_f32 v232, v238, v239
v_cvt_pk_bf16_f32 v233, v240, v241
MV 184,v,40,v,72
s_add_u32 m0, s67, 65536
buffer_store_dwordx4 v[230:233], v228, s[16:19], s24 offen offset:2048 sc1
MV 200,v,44,v,72
v_accvgpr_read_b32 v246, a24
v_accvgpr_read_b32 v247, a25
MV 180,v,40,v,68
buffer_load_dwordx4 v208, s[44:47], s75 offen offset:0 lds
v_accvgpr_read_b32 v248, a26
MV 196,v,44,v,68
MV 176,v,40,v,64
TR 40,222,16384
TR 42,222,17408
MV 192,v,44,v,64
TR 44,223,16384
TR 46,223,17408
s_waitcnt lgkmcnt(4)
MV 80,v,16,v,48
buffer_load_dwordx4 v209, s[44:47], s75 offen offset:1024 lds
v_accvgpr_read_b32 v249, a27
MV 96,v,20,v,48
ds_read_b128 v[64:67], v225 offset:0
v_accvgpr_read_b32 v250, a28
MV 84,v,16,v,52
buffer_load_dwordx4 v210, s[44:47], s75 offen offset:2048 lds
v_accvgpr_read_b32 v251, a29
MV 100,v,20,v,52
MV 88,v,16,v,56
v_accvgpr_read_b32 v252, a30
MV 104,v,20,v,56
buffer_load_dwordx4 v211, s[44:47], s75 offen offset:3072 lds
v_accvgpr_read_b32 v253, a31
MV 92,v,16,v,60
TR 16,216,24576
TR 18,216,25600
MV 108,v,20,v,60
TR 20,217,24576
TR 22,217,25600
MV 124,v,24,v,60
ds_read_b128 v[68:71], v225 offset:2048
s_add_u32 s75, s65, s74
MV 140,v,28,v,60
v_cvt_pk_bf16_f32 v242, v246, v247
v_cvt_pk_bf16_f32 v243, v248, v249
MV 120,v,24,v,56
v_cvt_pk_bf16_f32 v244, v250, v251
MV 136,v,28,v,56
s_add_u32 m0, s67, 69632
v_cvt_pk_bf16_f32 v245, v252, v253
MV 116,v,24,v,52
ds_read_b128 v[72:75], v225 offset:4096
buffer_store_dwordx4 v[242:245], v228, s[16:19], s24 offen offset:3072 sc1
MV 132,v,28,v,52
MV 112,v,24,v,48
TR 24,218,24576
TR 26,218,25600
MV 128,v,28,v,48
TR 28,219,24576
TR 30,219,25600
MV 144,v,32,v,48
buffer_load_dwordx4 v208, s[44:47], s75 offen offset:0 lds
buffer_load_dwordx4 v209, s[44:47], s75 offen offset:1024 lds
MV 160,v,36,v,48
v_accvgpr_read_b32 v234, a32
v_accvgpr_read_b32 v235, a33
MV 148,v,32,v,52
ds_read_b128 v[76:79], v225 offset:6144
v_accvgpr_read_b32 v236, a34
MV 164,v,36,v,52
buffer_load_dwordx4 v210, s[44:47], s75 offen offset:2048 lds
v_accvgpr_read_b32 v237, a35
MV 152,v,32,v,56
v_accvgpr_read_b32 v238, a36
MV 168,v,36,v,56
v_accvgpr_read_b32 v239, a37
MV 156,v,32,v,60
TR 32,220,24576
TR 34,220,25600
MV 172,v,36,v,60
TR 36,221,24576
TR 38,221,25600
s_waitcnt lgkmcnt(15)
MV 188,v,40,v,60
buffer_load_dwordx4 v211, s[44:47], s75 offen offset:3072 lds
v_accvgpr_read_b32 v240, a38
MV 204,v,44,v,60
s_add_u32 s74, s74, 128
v_accvgpr_read_b32 v241, a39
MV 184,v,40,v,56
v_cvt_pk_bf16_f32 v230, v234, v235
MV 200,v,44,v,56
v_cvt_pk_bf16_f32 v231, v236, v237
MV 180,v,40,v,52
s_and_b32 s74, s74, 2047
v_cvt_pk_bf16_f32 v232, v238, v239
MV 196,v,44,v,52
MV 176,v,40,v,48
TR 40,222,24576
TR 42,222,25600
MV 192,v,44,v,48
TR 44,223,24576
TR 46,223,25600
s_waitcnt lgkmcnt(4)
MV 80,v,16,v,64
v_cvt_pk_bf16_f32 v233, v240, v241
MV 96,v,20,v,64
s_add_u32 s24, s24, 4096
MV 84,v,16,v,68
buffer_store_dwordx4 v[230:233], v228, s[16:19], s24 offen offset:0 sc1
MV 100,v,20,v,68
MV 88,v,16,v,72
v_accvgpr_read_b32 v246, a40
MV 104,v,20,v,72
v_accvgpr_read_b32 v247, a41
MV 92,v,16,v,76
MV 108,v,20,v,76
s_waitcnt vmcnt(17) lgkmcnt(0)
s_barrier
MV 124,v,24,v,76
TR 16,216,32768
TR 18,216,33792
MV 140,v,28,v,76
ds_read_b128 v[48:51], v224 offset:32768
s_add_u32 m0, s68, 114688
MV 120,v,24,v,72
TR 20,217,32768
TR 22,217,33792
MV 136,v,28,v,72
buffer_load_dwordx4 v212, s[48:51], s66 offen offset:0 lds
v_accvgpr_read_b32 v248, a42
MV 116,v,24,v,68
ds_read_b128 v[52:55], v224 offset:34816
buffer_load_dwordx4 v213, s[48:51], s66 offen offset:1024 lds
MV 132,v,28,v,68
v_accvgpr_read_b32 v249, a43
v_accvgpr_read_b32 v250, a44
MV 112,v,24,v,64
TR 24,218,32768
TR 26,218,33792
MV 128,v,28,v,64
TR 28,219,32768
TR 30,219,33792
MV 144,v,32,v,64
ds_read_b128 v[56:59], v224 offset:36864
buffer_load_dwordx4 v214, s[48:51], s66 offen offset:2048 lds
MV 160,v,36,v,64
buffer_load_dwordx4 v215, s[48:51], s66 offen offset:3072 lds
v_accvgpr_read_b32 v251, a45
MV 148,v,32,v,68
v_accvgpr_read_b32 v252, a46
v_accvgpr_read_b32 v253, a47
MV 164,v,36,v,68
s_add_u32 s66, s66, 524288
v_cvt_pk_bf16_f32 v242, v246, v247
MV 152,v,32,v,72
ds_read_b128 v[60:63], v224 offset:38912
v_cvt_pk_bf16_f32 v243, v248, v249
MV 168,v,36,v,72
s_and_b32 s66, s66, 8388607
v_cvt_pk_bf16_f32 v244, v250, v251
MV 156,v,32,v,76
TR 32,220,32768
TR 34,220,33792
MV 172,v,36,v,76
TR 36,221,32768
TR 38,221,33792
MV 188,v,40,v,76
s_add_u32 s75, s64, s74
v_cvt_pk_bf16_f32 v245, v252, v253
MV 204,v,44,v,76
buffer_store_dwordx4 v[242:245], v228, s[16:19], s24 offen offset:1024 sc1
v_accvgpr_read_b32 v234, a48
MV 184,v,40,v,72
s_add_u32 m0, s67, 0
v_accvgpr_read_b32 v235, a49
MV 200,v,44,v,72
v_accvgpr_read_b32 v236, a50
v_accvgpr_read_b32 v237, a51
MV 180,v,40,v,68
buffer_load_dwordx4 v208, s[44:47], s75 offen offset:0 lds
v_accvgpr_read_b32 v238, a52
MV 196,v,44,v,68
MV 176,v,40,v,64
TR 40,222,32768
TR 42,222,33792
MV 192,v,44,v,64
TR 44,223,32768
TR 46,223,33792
s_waitcnt lgkmcnt(4)
MV 80,v,16,v,48
buffer_load_dwordx4 v209, s[44:47], s75 offen offset:1024 lds
v_accvgpr_read_b32 v239, a53
MV 96,v,20,v,48
ds_read_b128 v[64:67], v225 offset:32768
v_accvgpr_read_b32 v240, a54
MV 84,v,16,v,52
buffer_load_dwordx4 v210, s[44:47], s75 offen offset:2048 lds
v_accvgpr_read_b32 v241, a55
MV 100,v,20,v,52
MV 88,v,16,v,56
v_cvt_pk_bf16_f32 v230, v234, v235
MV 104,v,20,v,56
buffer_load_dwordx4 v211, s[44:47], s75 offen offset:3072 lds
v_cvt_pk_bf16_f32 v231, v236, v237
MV 92,v,16,v,60
TR 16,216,40960
TR 18,216,41984
MV 108,v,20,v,60
TR 20,217,40960
TR 22,217,41984
MV 124,v,24,v,60
ds_read_b128 v[68:71], v225 offset:34816
s_add_u32 s75, s65, s74
MV 140,v,28,v,60
v_cvt_pk_bf16_f32 v232, v238, v239
v_cvt_pk_bf16_f32 v233, v240, v241
MV 120,v,24,v,56
buffer_store_dwordx4 v[230:233], v228, s[16:19], s24 offen offset:2048 sc1
MV 136,v,28,v,56
s_add_u32 m0, s67, 4096
v_accvgpr_read_b32 v246, a56
MV 116,v,24,v,52
ds_read_b128 v[72:75], v225 offset:36864
v_accvgpr_read_b32 v247, a57
MV 132,v,28,v,52
MV 112,v,24,v,48
TR 24,218,40960
TR 26,218,41984
MV 128,v,28,v,48
TR 28,219,40960
TR 30,219,41984
MV 144,v,32,v,48
buffer_load_dwordx4 v208, s[44:47], s75 offen offset:0 lds
buffer_load_dwordx4 v209, s[44:47], s75 offen offset:1024 lds
MV 160,v,36,v,48
v_accvgpr_read_b32 v248, a58
v_accvgpr_read_b32 v249, a59
MV 148,v,32,v,52
ds_read_b128 v[76:79], v225 offset:38912
v_accvgpr_read_b32 v250, a60
MV 164,v,36,v,52
buffer_load_dwordx4 v210, s[44:47], s75 offen offset:2048 lds
v_accvgpr_read_b32 v251, a61
MV 152,v,32,v,56
v_accvgpr_read_b32 v252, a62
MV 168,v,36,v,56
v_accvgpr_read_b32 v253, a63
MV 156,v,32,v,60
TR 32,220,40960
TR 34,220,41984
MV 172,v,36,v,60
TR 36,221,40960
TR 38,221,41984
s_waitcnt lgkmcnt(15)
MV 188,v,40,v,60
buffer_load_dwordx4 v211, s[44:47], s75 offen offset:3072 lds
v_cvt_pk_bf16_f32 v242, v246, v247
MV 204,v,44,v,60
s_add_u32 s74, s74, 128
v_cvt_pk_bf16_f32 v243, v248, v249
MV 184,v,40,v,56
v_cvt_pk_bf16_f32 v244, v250, v251
MV 200,v,44,v,56
v_cvt_pk_bf16_f32 v245, v252, v253
MV 180,v,40,v,52
s_and_b32 s74, s74, 2047
buffer_store_dwordx4 v[242:245], v228, s[16:19], s24 offen offset:3072 sc1
MV 196,v,44,v,52
MV 176,v,40,v,48
TR 40,222,40960
TR 42,222,41984
MV 192,v,44,v,48
TR 44,223,40960
TR 46,223,41984
s_waitcnt lgkmcnt(4)
MV 80,v,16,v,64
v_accvgpr_read_b32 v234, a64
MV 96,v,20,v,64
v_accvgpr_read_b32 v235, a65
MV 84,v,16,v,68
v_accvgpr_read_b32 v236, a66
MV 100,v,20,v,68
MV 88,v,16,v,72
v_accvgpr_read_b32 v237, a67
MV 104,v,20,v,72
v_accvgpr_read_b32 v238, a68
MV 92,v,16,v,76
MV 108,v,20,v,76
s_waitcnt vmcnt(16) lgkmcnt(0)
s_barrier
MV 124,v,24,v,76
TR 16,216,0
TR 18,216,1024
MV 140,v,28,v,76
ds_read_b128 v[48:51], v226 offset:0
s_add_u32 m0, s68, 131072
MV 120,v,24,v,72
TR 20,217,0
TR 22,217,1024
MV 136,v,28,v,72
buffer_load_dwordx4 v212, s[48:51], s66 offen offset:0 lds
v_accvgpr_read_b32 v239, a69
MV 116,v,24,v,68
ds_read_b128 v[52:55], v226 offset:2048
buffer_load_dwordx4 v213, s[48:51], s66 offen offset:1024 lds
MV 132,v,28,v,68
v_accvgpr_read_b32 v240, a70
v_accvgpr_read_b32 v241, a71
MV 112,v,24,v,64
TR 24,218,0
TR 26,218,1024
MV 128,v,28,v,64
TR 28,219,0
TR 30,219,1024
MV 144,v,32,v,64
ds_read_b128 v[56:59], v226 offset:4096
buffer_load_dwordx4 v214, s[48:51], s66 offen offset:2048 lds
MV 160,v,36,v,64
buffer_load_dwordx4 v215, s[48:51], s66 offen offset:3072 lds
v_cvt_pk_bf16_f32 v230, v234, v235
MV 148,v,32,v,68
v_cvt_pk_bf16_f32 v231, v236, v237
v_cvt_pk_bf16_f32 v232, v238, v239
MV 164,v,36,v,68
s_add_u32 s66, s66, 524288
v_cvt_pk_bf16_f32 v233, v240, v241
MV 152,v,32,v,72
ds_read_b128 v[60:63], v226 offset:6144
s_add_u32 s24, s24, 4096
MV 168,v,36,v,72
s_and_b32 s66, s66, 8388607
buffer_store_dwordx4 v[230:233], v228, s[16:19], s24 offen offset:0 sc1
MV 156,v,32,v,76
TR 32,220,0
TR 34,220,1024
MV 172,v,36,v,76
TR 36,221,0
TR 38,221,1024
MV 188,v,40,v,76
s_add_u32 s75, s64, s74
v_accvgpr_read_b32 v246, a72
MV 204,v,44,v,76
v_accvgpr_read_b32 v247, a73
v_accvgpr_read_b32 v248, a74
MV 184,v,40,v,72
s_add_u32 m0, s67, 32768
v_accvgpr_read_b32 v249, a75
MV 200,v,44,v,72
v_accvgpr_read_b32 v250, a76
v_accvgpr_read_b32 v251, a77
MV 180,v,40,v,68
buffer_load_dwordx4 v208, s[44:47], s75 offen offset:0 lds
v_accvgpr_read_b32 v252, a78
MV 196,v,44,v,68
MV 176,v,40,v,64
TR 40,222,0
TR 42,222,1024
MV 192,v,44,v,64
TR 44,223,0
TR 46,223,1024
s_waitcnt lgkmcnt(4)
MV 80,v,16,v,48
buffer_load_dwordx4 v209, s[44:47], s75 offen offset:1024 lds
v_accvgpr_read_b32 v253, a79
MV 96,v,20,v,48
ds_read_b128 v[64:67], v227 offset:0
v_cvt_pk_bf16_f32 v242, v246, v247
MV 84,v,16,v,52
buffer_load_dwordx4 v210, s[44:47], s75 offen offset:2048 lds
v_cvt_pk_bf16_f32 v243, v248, v249
MV 100,v,20,v,52
MV 88,v,16,v,56
v_cvt_pk_bf16_f32 v244, v250, v251
MV 104,v,20,v,56
buffer_load_dwordx4 v211, s[44:47], s75 offen offset:3072 lds
v_cvt_pk_bf16_f32 v245, v252, v253
MV 92,v,16,v,60
TR 16,216,8192
TR 18,216,9216
MV 108,v,20,v,60
TR 20,217,8192
TR 22,217,9216
MV 124,v,24,v,60
ds_read_b128 v[68:71], v227 offset:2048
s_add_u32 s75, s65, s74
MV 140,v,28,v,60
buffer_store_dwordx4 v[242:245], v228, s[16:19], s24 offen offset:1024 sc1
v_accvgpr_read_b32 v234, a80
MV 120,v,24,v,56
v_accvgpr_read_b32 v235, a81
v_accvgpr_read_b32 v236, a82
MV 136,v,28,v,56
s_add_u32 m0, s67, 36864
MV 116,v,24,v,52
ds_read_b128 v[72:75], v227 offset:4096
v_accvgpr_read_b32 v237, a83
MV 132,v,28,v,52
v_accvgpr_read_b32 v238, a84
MV 112,v,24,v,48
TR 24,218,8192
TR 26,218,9216
MV 128,v,28,v,48
TR 28,219,8192
TR 30,219,9216
MV 144,v,32,v,48
buffer_load_dwordx4 v208, s[44:47], s75 offen offset:0 lds
buffer_load_dwordx4 v209, s[44:47], s75 offen offset:1024 lds
MV 160,v,36,v,48
v_accvgpr_read_b32 v239, a85
v_accvgpr_read_b32 v240, a86
MV 148,v,32,v,52
ds_read_b128 v[76:79], v227 offset:6144
v_accvgpr_read_b32 v241, a87
MV 164,v,36,v,52
buffer_load_dwordx4 v210, s[44:47], s75 offen offset:2048 lds
v_cvt_pk_bf16_f32 v230, v234, v235
MV 152,v,32,v,56
v_cvt_pk_bf16_f32 v231, v236, v237
MV 168,v,36,v,56
v_cvt_pk_bf16_f32 v232, v238, v239
MV 156,v,32,v,60
TR 32,220,8192
TR 34,220,9216
MV 172,v,36,v,60
TR 36,221,8192
TR 38,221,9216
s_waitcnt lgkmcnt(15)
MV 188,v,40,v,60
buffer_load_dwordx4 v211, s[44:47], s75 offen offset:3072 lds
v_cvt_pk_bf16_f32 v233, v240, v241
MV 204,v,44,v,60
s_add_u32 s74, s74, 128
buffer_store_dwordx4 v[230:233], v228, s[16:19], s24 offen offset:2048 sc1
MV 184,v,40,v,56
v_accvgpr_read_b32 v246, a88
MV 200,v,44,v,56
v_accvgpr_read_b32 v247, a89
MV 180,v,40,v,52
s_and_b32 s74, s74, 2047
v_accvgpr_read_b32 v248, a90
MV 196,v,44,v,52
MV 176,v,40,v,48
TR 40,222,8192
TR 42,222,9216
MV 192,v,44,v,48
TR 44,223,8192
TR 46,223,9216
s_waitcnt lgkmcnt(4)
MV 80,v,16,v,64
v_accvgpr_read_b32 v249, a91
MV 96,v,20,v,64
v_accvgpr_read_b32 v250, a92
MV 84,v,16,v,68
v_accvgpr_read_b32 v251, a93
MV 100,v,20,v,68
MV 88,v,16,v,72
v_accvgpr_read_b32 v252, a94
MV 104,v,20,v,72
v_accvgpr_read_b32 v253, a95
MV 92,v,16,v,76
MV 108,v,20,v,76
s_waitcnt vmcnt(16) lgkmcnt(0)
s_barrier
MV 124,v,24,v,76
TR 16,216,16384
TR 18,216,17408
MV 140,v,28,v,76
ds_read_b128 v[48:51], v224 offset:0
s_add_u32 m0, s68, 98304
MV 120,v,24,v,72
TR 20,217,16384
TR 22,217,17408
MV 136,v,28,v,72
buffer_load_dwordx4 v212, s[48:51], s66 offen offset:0 lds
v_cvt_pk_bf16_f32 v242, v246, v247
MV 116,v,24,v,68
ds_read_b128 v[52:55], v224 offset:2048
buffer_load_dwordx4 v213, s[48:51], s66 offen offset:1024 lds
MV 132,v,28,v,68
v_cvt_pk_bf16_f32 v243, v248, v249
v_cvt_pk_bf16_f32 v244, v250, v251
MV 112,v,24,v,64
TR 24,218,16384
TR 26,218,17408
MV 128,v,28,v,64
TR 28,219,16384
TR 30,219,17408
MV 144,v,32,v,64
ds_read_b128 v[56:59], v224 offset:4096
buffer_load_dwordx4 v214, s[48:51], s66 offen offset:2048 lds
MV 160,v,36,v,64
buffer_load_dwordx4 v215, s[48:51], s66 offen offset:3072 lds
v_cvt_pk_bf16_f32 v245, v252, v253
MV 148,v,32,v,68
buffer_store_dwordx4 v[242:245], v228, s[16:19], s24 offen offset:3072 sc1
v_accvgpr_read_b32 v234, a96
MV 164,v,36,v,68
s_add_u32 s66, s66, 524288
v_accvgpr_read_b32 v235, a97
MV 152,v,32,v,72
ds_read_b128 v[60:63], v224 offset:6144
v_accvgpr_read_b32 v236, a98
MV 168,v,36,v,72
s_and_b32 s66, s66, 8388607
v_accvgpr_read_b32 v237, a99
MV 156,v,32,v,76
TR 32,220,16384
TR 34,220,17408
MV 172,v,36,v,76
TR 36,221,16384
TR 38,221,17408
MV 188,v,40,v,76
s_add_u32 s75, s64, s74
v_accvgpr_read_b32 v238, a100
MV 204,v,44,v,76
v_accvgpr_read_b32 v239, a101
v_accvgpr_read_b32 v240, a102
MV 184,v,40,v,72
s_add_u32 m0, s67, 65536
v_accvgpr_read_b32 v241, a103
MV 200,v,44,v,72
v_cvt_pk_bf16_f32 v230, v234, v235
v_cvt_pk_bf16_f32 v231, v236, v237
MV 180,v,40,v,68
buffer_load_dwordx4 v208, s[44:47], s75 offen offset:0 lds
v_cvt_pk_bf16_f32 v232, v238, v239
MV 196,v,44,v,68
MV 176,v,40,v,64
TR 40,222,16384
TR 42,222,17408
MV 192,v,44,v,64
TR 44,223,16384
TR 46,223,17408
s_waitcnt lgkmcnt(4)
MV 80,v,16,v,48
buffer_load_dwordx4 v209, s[44:47], s75 offen offset:1024 lds
v_cvt_pk_bf16_f32 v233, v240, v241
MV 96,v,20,v,48
ds_read_b128 v[64:67], v225 offset:0
s_add_u32 s24, s24, 4096
MV 84,v,16,v,52
buffer_load_dwordx4 v210, s[44:47], s75 offen offset:2048 lds
buffer_store_dwordx4 v[230:233], v228, s[16:19], s24 offen offset:0 sc1
MV 100,v,20,v,52
MV 88,v,16,v,56
v_accvgpr_read_b32 v246, a104
MV 104,v,20,v,56
buffer_load_dwordx4 v211, s[44:47], s75 offen offset:3072 lds
v_accvgpr_read_b32 v247, a105
MV 92,v,16,v,60
TR 16,216,24576
TR 18,216,25600
MV 108,v,20,v,60
TR 20,217,24576
TR 22,217,25600
MV 124,v,24,v,60
ds_read_b128 v[68:71], v225 offset:2048
s_add_u32 s75, s65, s74
MV 140,v,28,v,60
v_accvgpr_read_b32 v248, a106
v_accvgpr_read_b32 v249, a107
MV 120,v,24,v,56
v_accvgpr_read_b32 v250, a108
MV 136,v,28,v,56
s_add_u32 m0, s67, 69632
v_accvgpr_read_b32 v251, a109
MV 116,v,24,v,52
ds_read_b128 v[72:75], v225 offset:4096
v_accvgpr_read_b32 v252, a110
MV 132,v,28,v,52
MV 112,v,24,v,48
TR 24,218,24576
TR 26,218,25600
MV 128,v,28,v,48
TR 28,219,24576
TR 30,219,25600
MV 144,v,32,v,48
buffer_load_dwordx4 v208, s[44:47], s75 offen offset:0 lds
buffer_load_dwordx4 v209, s[44:47], s75 offen offset:1024 lds
MV 160,v,36,v,48
v_accvgpr_read_b32 v253, a111
v_cvt_pk_bf16_f32 v242, v246, v247
MV 148,v,32,v,52
ds_read_b128 v[76:79], v225 offset:6144
v_cvt_pk_bf16_f32 v243, v248, v249
MV 164,v,36,v,52
buffer_load_dwordx4 v210, s[44:47], s75 offen offset:2048 lds
v_cvt_pk_bf16_f32 v244, v250, v251
MV 152,v,32,v,56
v_cvt_pk_bf16_f32 v245, v252, v253
MV 168,v,36,v,56
buffer_store_dwordx4 v[242:245], v228, s[16:19], s24 offen offset:1024 sc1
MV 156,v,32,v,60
TR 32,220,24576
TR 34,220,25600
MV 172,v,36,v,60
TR 36,221,24576
TR 38,221,25600
s_waitcnt lgkmcnt(15)
MV 188,v,40,v,60
buffer_load_dwordx4 v211, s[44:47], s75 offen offset:3072 lds
v_accvgpr_read_b32 v234, a112
MV 204,v,44,v,60
s_add_u32 s74, s74, 128
v_accvgpr_read_b32 v235, a113
MV 184,v,40,v,56
v_accvgpr_read_b32 v236, a114
MV 200,v,44,v,56
v_accvgpr_read_b32 v237, a115
MV 180,v,40,v,52
s_and_b32 s74, s74, 2047
v_accvgpr_read_b32 v238, a116
MV 196,v,44,v,52
MV 176,v,40,v,48
TR 40,222,24576
TR 42,222,25600
MV 192,v,44,v,48
TR 44,223,24576
TR 46,223,25600
s_waitcnt lgkmcnt(4)
MV 80,v,16,v,64
v_accvgpr_read_b32 v239, a117
MV 96,v,20,v,64
v_accvgpr_read_b32 v240, a118
MV 84,v,16,v,68
v_accvgpr_read_b32 v241, a119
MV 100,v,20,v,68
MV 88,v,16,v,72
v_cvt_pk_bf16_f32 v230, v234, v235
MV 104,v,20,v,72
v_cvt_pk_bf16_f32 v231, v236, v237
MV 92,v,16,v,76
MV 108,v,20,v,76
s_waitcnt vmcnt(16) lgkmcnt(0)
s_barrier
MV 124,v,24,v,76
TR 16,216,32768
TR 18,216,33792
MV 140,v,28,v,76
ds_read_b128 v[48:51], v224 offset:32768
s_add_u32 m0, s68, 114688
MV 120,v,24,v,72
TR 20,217,32768
TR 22,217,33792
MV 136,v,28,v,72
buffer_load_dwordx4 v212, s[48:51], s66 offen offset:0 lds
v_cvt_pk_bf16_f32 v232, v238, v239
MV 116,v,24,v,68
ds_read_b128 v[52:55], v224 offset:34816
buffer_load_dwordx4 v213, s[48:51], s66 offen offset:1024 lds
MV 132,v,28,v,68
v_cvt_pk_bf16_f32 v233, v240, v241
buffer_store_dwordx4 v[230:233], v228, s[16:19], s24 offen offset:2048 sc1
MV 112,v,24,v,64
TR 24,218,32768
TR 26,218,33792
MV 128,v,28,v,64
TR 28,219,32768
TR 30,219,33792
MV 144,v,32,v,64
ds_read_b128 v[56:59], v224 offset:36864
buffer_load_dwordx4 v214, s[48:51], s66 offen offset:2048 lds
MV 160,v,36,v,64
buffer_load_dwordx4 v215, s[48:51], s66 offen offset:3072 lds
v_accvgpr_read_b32 v246, a120
MV 148,v,32,v,68
v_accvgpr_read_b32 v247, a121
v_accvgpr_read_b32 v248, a122
MV 164,v,36,v,68
s_add_u32 s66, s66, 524288
v_accvgpr_read_b32 v249, a123
MV 152,v,32,v,72
ds_read_b128 v[60:63], v224 offset:38912
v_accvgpr_read_b32 v250, a124
MV 168,v,36,v,72
s_and_b32 s66, s66, 8388607
v_accvgpr_read_b32 v251, a125
MV 156,v,32,v,76
TR 32,220,32768
TR 34,220,33792
MV 172,v,36,v,76
TR 36,221,32768
TR 38,221,33792
MV 188,v,40,v,76
s_add_u32 s75, s64, s74
v_accvgpr_read_b32 v252, a126
MV 204,v,44,v,76
v_accvgpr_read_b32 v253, a127
v_cvt_pk_bf16_f32 v242, v246, v247
MV 184,v,40,v,72
s_add_u32 m0, s67, 0
v_cvt_pk_bf16_f32 v243, v248, v249
MV 200,v,44,v,72
v_cvt_pk_bf16_f32 v244, v250, v251
v_cvt_pk_bf16_f32 v245, v252, v253
MV 180,v,40,v,68
buffer_load_dwordx4 v208, s[44:47], s75 offen offset:0 lds
buffer_store_dwordx4 v[242:245], v228, s[16:19], s24 offen offset:3072 sc1
MV 196,v,44,v,68
MV 176,v,40,v,64
TR 40,222,32768
TR 42,222,33792
MV 192,v,44,v,64
TR 44,223,32768
TR 46,223,33792
s_waitcnt lgkmcnt(4)
MV 80,v,16,v,48
buffer_load_dwordx4 v209, s[44:47], s75 offen offset:1024 lds
v_accvgpr_read_b32 v234, a128
MV 96,v,20,v,48
ds_read_b128 v[64:67], v225 offset:32768
v_accvgpr_read_b32 v235, a129
MV 84,v,16,v,52
buffer_load_dwordx4 v210, s[44:47], s75 offen offset:2048 lds
v_accvgpr_read_b32 v236, a130
MV 100,v,20,v,52
MV 88,v,16,v,56
v_accvgpr_read_b32 v237, a131
MV 104,v,20,v,56
buffer_load_dwordx4 v211, s[44:47], s75 offen offset:3072 lds
v_accvgpr_read_b32 v238, a132
MV 92,v,16,v,60
TR 16,216,40960
TR 18,216,41984
MV 108,v,20,v,60
TR 20,217,40960
TR 22,217,41984
MV 124,v,24,v,60
ds_read_b128 v[68:71], v225 offset:34816
s_add_u32 s75, s65, s74
MV 140,v,28,v,60
v_accvgpr_read_b32 v239, a133
v_accvgpr_read_b32 v240, a134
MV 120,v,24,v,56
v_accvgpr_read_b32 v241, a135
MV 136,v,28,v,56
s_add_u32 m0, s67, 4096
v_cvt_pk_bf16_f32 v230, v234, v235
MV 116,v,24,v,52
ds_read_b128 v[72:75], v225 offset:36864
v_cvt_pk_bf16_f32 v231, v236, v237
MV 132,v,28,v,52
MV 112,v,24,v,48
TR 24,218,40960
TR 26,218,41984
MV 128,v,28,v,48
TR 28,219,40960
TR 30,219,41984
MV 144,v,32,v,48
buffer_load_dwordx4 v208, s[44:47], s75 offen offset:0 lds
buffer_load_dwordx4 v209, s[44:47], s75 offen offset:1024 lds
MV 160,v,36,v,48
v_cvt_pk_bf16_f32 v232, v238, v239
v_cvt_pk_bf16_f32 v233, v240, v241
MV 148,v,32,v,52
ds_read_b128 v[76:79], v225 offset:38912
s_add_u32 s24, s24, 4096
MV 164,v,36,v,52
buffer_load_dwordx4 v210, s[44:47], s75 offen offset:2048 lds
buffer_store_dwordx4 v[230:233], v228, s[16:19], s24 offen offset:0 sc1
MV 152,v,32,v,56
v_accvgpr_read_b32 v246, a136
MV 168,v,36,v,56
v_accvgpr_read_b32 v247, a137
MV 156,v,32,v,60
TR 32,220,40960
TR 34,220,41984
MV 172,v,36,v,60
TR 36,221,40960
TR 38,221,41984
s_waitcnt lgkmcnt(15)
MV 188,v,40,v,60
buffer_load_dwordx4 v211, s[44:47], s75 offen offset:3072 lds
v_accvgpr_read_b32 v248, a138
MV 204,v,44,v,60
s_add_u32 s74, s74, 128
v_accvgpr_read_b32 v249, a139
MV 184,v,40,v,56
v_accvgpr_read_b32 v250, a140
MV 200,v,44,v,56
v_accvgpr_read_b32 v251, a141
MV 180,v,40,v,52
s_and_b32 s74, s74, 2047
v_accvgpr_read_b32 v252, a142
MV 196,v,44,v,52
MV 176,v,40,v,48
TR 40,222,40960
TR 42,222,41984
MV 192,v,44,v,48
TR 44,223,40960
TR 46,223,41984
s_waitcnt lgkmcnt(4)
MV 80,v,16,v,64
v_accvgpr_read_b32 v253, a143
MV 96,v,20,v,64
v_cvt_pk_bf16_f32 v242, v246, v247
MV 84,v,16,v,68
v_cvt_pk_bf16_f32 v243, v248, v249
MV 100,v,20,v,68
MV 88,v,16,v,72
v_cvt_pk_bf16_f32 v244, v250, v251
MV 104,v,20,v,72
v_cvt_pk_bf16_f32 v245, v252, v253
MV 92,v,16,v,76
MV 108,v,20,v,76
s_waitcnt vmcnt(15) lgkmcnt(0)
s_barrier
MV 124,v,24,v,76
TR 16,216,0
TR 18,216,1024
MV 140,v,28,v,76
ds_read_b128 v[48:51], v226 offset:0
s_add_u32 m0, s68, 131072
MV 120,v,24,v,72
TR 20,217,0
TR 22,217,1024
MV 136,v,28,v,72
buffer_load_dwordx4 v212, s[48:51], s66 offen offset:0 lds
buffer_store_dwordx4 v[242:245], v228, s[16:19], s24 offen offset:1024 sc1
MV 116,v,24,v,68
ds_read_b128 v[52:55], v226 offset:2048
buffer_load_dwordx4 v213, s[48:51], s66 offen offset:1024 lds
MV 132,v,28,v,68
v_accvgpr_read_b32 v234, a144
v_accvgpr_read_b32 v235, a145
MV 112,v,24,v,64
TR 24,218,0
TR 26,218,1024
MV 128,v,28,v,64
TR 28,219,0
TR 30,219,1024
MV 144,v,32,v,64
ds_read_b128 v[56:59], v226 offset:4096
buffer_load_dwordx4 v214, s[48:51], s66 offen offset:2048 lds
MV 160,v,36,v,64
buffer_load_dwordx4 v215, s[48:51], s66 offen offset:3072 lds
v_accvgpr_read_b32 v236, a146
MV 148,v,32,v,68
v_accvgpr_read_b32 v237, a147
v_accvgpr_read_b32 v238, a148
MV 164,v,36,v,68
s_add_u32 s66, s66, 524288
v_accvgpr_read_b32 v239, a149
MV 152,v,32,v,72
ds_read_b128 v[60:63], v226 offset:6144
v_accvgpr_read_b32 v240, a150
MV 168,v,36,v,72
s_and_b32 s66, s66, 8388607
v_accvgpr_read_b32 v241, a151
MV 156,v,32,v,76
TR 32,220,0
TR 34,220,1024
MV 172,v,36,v,76
TR 36,221,0
TR 38,221,1024
MV 188,v,40,v,76
s_add_u32 s75, s64, s74
v_cvt_pk_bf16_f32 v230, v234, v235
MV 204,v,44,v,76
v_cvt_pk_bf16_f32 v231, v236, v237
v_cvt_pk_bf16_f32 v232, v238, v239
MV 184,v,40,v,72
s_add_u32 m0, s67, 32768
v_cvt_pk_bf16_f32 v233, v240, v241
MV 200,v,44,v,72
buffer_store_dwordx4 v[230:233], v228, s[16:19], s24 offen offset:2048 sc1
v_accvgpr_read_b32 v246, a152
MV 180,v,40,v,68
buffer_load_dwordx4 v208, s[44:47], s75 offen offset:0 lds
v_accvgpr_read_b32 v247, a153
MV 196,v,44,v,68
MV 176,v,40,v,64
TR 40,222,0
TR 42,222,1024
MV 192,v,44,v,64
TR 44,223,0
TR 46,223,1024
s_waitcnt lgkmcnt(4)
MV 80,v,16,v,48
buffer_load_dwordx4 v209, s[44:47], s75 offen offset:1024 lds
v_accvgpr_read_b32 v248, a154
MV 96,v,20,v,48
ds_read_b128 v[64:67], v227 offset:0
v_accvgpr_read_b32 v249, a155
MV 84,v,16,v,52
buffer_load_dwordx4 v210, s[44:47], s75 offen offset:2048 lds
v_accvgpr_read_b32 v250, a156
MV 100,v,20,v,52
MV 88,v,16,v,56
v_accvgpr_read_b32 v251, a157
MV 104,v,20,v,56
buffer_load_dwordx4 v211, s[44:47], s75 offen offset:3072 lds
v_accvgpr_read_b32 v252, a158
MV 92,v,16,v,60
TR 16,216,8192
TR 18,216,9216
MV 108,v,20,v,60
TR 20,217,8192
TR 22,217,9216
MV 124,v,24,v,60
ds_read_b128 v[68:71], v227 offset:2048
s_add_u32 s75, s65, s74
MV 140,v,28,v,60
v_accvgpr_read_b32 v253, a159
v_cvt_pk_bf16_f32 v242, v246, v247
MV 120,v,24,v,56
v_cvt_pk_bf16_f32 v243, v248, v249
MV 136,v,28,v,56
s_add_u32 m0, s67, 36864
v_cvt_pk_bf16_f32 v244, v250, v251
MV 116,v,24,v,52
ds_read_b128 v[72:75], v227 offset:4096
v_cvt_pk_bf16_f32 v245, v252, v253
MV 132,v,28,v,52
MV 112,v,24,v,48
TR 24,218,8192
TR 26,218,9216
MV 128,v,28,v,48
TR 28,219,8192
TR 30,219,9216
MV 144,v,32,v,48
buffer_load_dwordx4 v208, s[44:47], s75 offen offset:0 lds
buffer_load_dwordx4 v209, s[44:47], s75 offen offset:1024 lds
MV 160,v,36,v,48
buffer_store_dwordx4 v[242:245], v228, s[16:19], s24 offen offset:3072 sc1
v_accvgpr_read_b32 v234, a160
MV 148,v,32,v,52
ds_read_b128 v[76:79], v227 offset:6144
v_accvgpr_read_b32 v235, a161
MV 164,v,36,v,52
buffer_load_dwordx4 v210, s[44:47], s75 offen offset:2048 lds
v_accvgpr_read_b32 v236, a162
MV 152,v,32,v,56
v_accvgpr_read_b32 v237, a163
MV 168,v,36,v,56
v_accvgpr_read_b32 v238, a164
MV 156,v,32,v,60
TR 32,220,8192
TR 34,220,9216
MV 172,v,36,v,60
TR 36,221,8192
TR 38,221,9216
s_waitcnt lgkmcnt(15)
MV 188,v,40,v,60
buffer_load_dwordx4 v211, s[44:47], s75 offen offset:3072 lds
v_accvgpr_read_b32 v239, a165
MV 204,v,44,v,60
s_add_u32 s74, s74, 128
v_accvgpr_read_b32 v240, a166
MV 184,v,40,v,56
v_accvgpr_read_b32 v241, a167
MV 200,v,44,v,56
v_cvt_pk_bf16_f32 v230, v234, v235
MV 180,v,40,v,52
s_and_b32 s74, s74, 2047
v_cvt_pk_bf16_f32 v231, v236, v237
MV 196,v,44,v,52
MV 176,v,40,v,48
TR 40,222,8192
TR 42,222,9216
MV 192,v,44,v,48
TR 44,223,8192
TR 46,223,9216
s_waitcnt lgkmcnt(4)
MV 80,v,16,v,64
v_cvt_pk_bf16_f32 v232, v238, v239
MV 96,v,20,v,64
v_cvt_pk_bf16_f32 v233, v240, v241
MV 84,v,16,v,68
s_add_u32 s24, s24, 4096
MV 100,v,20,v,68
MV 88,v,16,v,72
buffer_store_dwordx4 v[230:233], v228, s[16:19], s24 offen offset:0 sc1
MV 104,v,20,v,72
v_accvgpr_read_b32 v246, a168
MV 92,v,16,v,76
v_accvgpr_read_b32 v247, a169
MV 108,v,20,v,76
s_waitcnt vmcnt(16) lgkmcnt(0)
s_barrier
MV 124,v,24,v,76
TR 16,216,16384
TR 18,216,17408
MV 140,v,28,v,76
ds_read_b128 v[48:51], v224 offset:0
s_add_u32 m0, s68, 98304
MV 120,v,24,v,72
TR 20,217,16384
TR 22,217,17408
MV 136,v,28,v,72
buffer_load_dwordx4 v212, s[48:51], s66 offen offset:0 lds
v_accvgpr_read_b32 v248, a170
MV 116,v,24,v,68
ds_read_b128 v[52:55], v224 offset:2048
buffer_load_dwordx4 v213, s[48:51], s66 offen offset:1024 lds
MV 132,v,28,v,68
v_accvgpr_read_b32 v249, a171
v_accvgpr_read_b32 v250, a172
MV 112,v,24,v,64
TR 24,218,16384
TR 26,218,17408
MV 128,v,28,v,64
TR 28,219,16384
TR 30,219,17408
MV 144,v,32,v,64
ds_read_b128 v[56:59], v224 offset:4096
buffer_load_dwordx4 v214, s[48:51], s66 offen offset:2048 lds
MV 160,v,36,v,64
buffer_load_dwordx4 v215, s[48:51], s66 offen offset:3072 lds
v_accvgpr_read_b32 v251, a173
MV 148,v,32,v,68
v_accvgpr_read_b32 v252, a174
v_accvgpr_read_b32 v253, a175
MV 164,v,36,v,68
s_add_u32 s66, s66, 524288
v_cvt_pk_bf16_f32 v242, v246, v247
MV 152,v,32,v,72
ds_read_b128 v[60:63], v224 offset:6144
v_cvt_pk_bf16_f32 v243, v248, v249
MV 168,v,36,v,72
s_and_b32 s66, s66, 8388607
v_cvt_pk_bf16_f32 v244, v250, v251
MV 156,v,32,v,76
TR 32,220,16384
TR 34,220,17408
MV 172,v,36,v,76
TR 36,221,16384
TR 38,221,17408
MV 188,v,40,v,76
s_add_u32 s75, s64, s74
v_cvt_pk_bf16_f32 v245, v252, v253
MV 204,v,44,v,76
buffer_store_dwordx4 v[242:245], v228, s[16:19], s24 offen offset:1024 sc1
v_accvgpr_read_b32 v234, a176
MV 184,v,40,v,72
s_add_u32 m0, s67, 65536
v_accvgpr_read_b32 v235, a177
MV 200,v,44,v,72
v_accvgpr_read_b32 v236, a178
v_accvgpr_read_b32 v237, a179
MV 180,v,40,v,68
buffer_load_dwordx4 v208, s[44:47], s75 offen offset:0 lds
v_accvgpr_read_b32 v238, a180
MV 196,v,44,v,68
MV 176,v,40,v,64
TR 40,222,16384
TR 42,222,17408
MV 192,v,44,v,64
TR 44,223,16384
TR 46,223,17408
s_waitcnt lgkmcnt(4)
MV 80,v,16,v,48
buffer_load_dwordx4 v209, s[44:47], s75 offen offset:1024 lds
v_accvgpr_read_b32 v239, a181
MV 96,v,20,v,48
ds_read_b128 v[64:67], v225 offset:0
v_accvgpr_read_b32 v240, a182
MV 84,v,16,v,52
buffer_load_dwordx4 v210, s[44:47], s75 offen offset:2048 lds
v_accvgpr_read_b32 v241, a183
MV 100,v,20,v,52
MV 88,v,16,v,56
v_cvt_pk_bf16_f32 v230, v234, v235
MV 104,v,20,v,56
buffer_load_dwordx4 v211, s[44:47], s75 offen offset:3072 lds
v_cvt_pk_bf16_f32 v231, v236, v237
MV 92,v,16,v,60
TR 16,216,24576
TR 18,216,25600
MV 108,v,20,v,60
TR 20,217,24576
TR 22,217,25600
MV 124,v,24,v,60
ds_read_b128 v[68:71], v225 offset:2048
s_add_u32 s75, s65, s74
MV 140,v,28,v,60
v_cvt_pk_bf16_f32 v232, v238, v239
v_cvt_pk_bf16_f32 v233, v240, v241
MV 120,v,24,v,56
buffer_store_dwordx4 v[230:233], v228, s[16:19], s24 offen offset:2048 sc1
v_accvgpr_read_b32 v246, a184
MV 136,v,28,v,56
s_add_u32 m0, s67, 69632
MV 116,v,24,v,52
ds_read_b128 v[72:75], v225 offset:4096
v_accvgpr_read_b32 v247, a185
MV 132,v,28,v,52
v_accvgpr_read_b32 v248, a186
MV 112,v,24,v,48
TR 24,218,24576
TR 26,218,25600
MV 128,v,28,v,48
TR 28,219,24576
TR 30,219,25600
MV 144,v,32,v,48
buffer_load_dwordx4 v208, s[44:47], s75 offen offset:0 lds
buffer_load_dwordx4 v209, s[44:47], s75 offen offset:1024 lds
MV 160,v,36,v,48
v_accvgpr_read_b32 v249, a187
v_accvgpr_read_b32 v250, a188
MV 148,v,32,v,52
ds_read_b128 v[76:79], v225 offset:6144
v_accvgpr_read_b32 v251, a189
MV 164,v,36,v,52
buffer_load_dwordx4 v210, s[44:47], s75 offen offset:2048 lds
v_accvgpr_read_b32 v252, a190
MV 152,v,32,v,56
v_accvgpr_read_b32 v253, a191
MV 168,v,36,v,56
v_cvt_pk_bf16_f32 v242, v246, v247
MV 156,v,32,v,60
TR 32,220,24576
TR 34,220,25600
MV 172,v,36,v,60
TR 36,221,24576
TR 38,221,25600
s_waitcnt lgkmcnt(15)
MV 188,v,40,v,60
buffer_load_dwordx4 v211, s[44:47], s75 offen offset:3072 lds
v_cvt_pk_bf16_f32 v243, v248, v249
MV 204,v,44,v,60
s_add_u32 s74, s74, 128
v_cvt_pk_bf16_f32 v244, v250, v251
MV 184,v,40,v,56
v_cvt_pk_bf16_f32 v245, v252, v253
MV 200,v,44,v,56
buffer_store_dwordx4 v[242:245], v228, s[16:19], s24 offen offset:3072 sc1
MV 180,v,40,v,52
s_and_b32 s74, s74, 2047
buffer_load_dword v254, off, s[12:15], 0 sc1
MV 196,v,44,v,52
MV 176,v,40,v,48
TR 40,222,24576
TR 42,222,25600
MV 192,v,44,v,48
TR 44,223,24576
TR 46,223,25600
s_waitcnt lgkmcnt(4)
MV 80,v,16,v,64
v_accvgpr_read_b32 v234, a192
MV 96,v,20,v,64
v_accvgpr_read_b32 v235, a193
MV 84,v,16,v,68
v_accvgpr_read_b32 v236, a194
MV 100,v,20,v,68
MV 88,v,16,v,72
v_accvgpr_read_b32 v237, a195
MV 104,v,20,v,72
v_accvgpr_read_b32 v238, a196
MV 92,v,16,v,76
MV 108,v,20,v,76
s_waitcnt vmcnt(17) lgkmcnt(0)
s_barrier
MV 124,v,24,v,76
TR 16,216,32768
TR 18,216,33792
MV 140,v,28,v,76
ds_read_b128 v[48:51], v224 offset:32768
s_add_u32 m0, s68, 114688
MV 120,v,24,v,72
TR 20,217,32768
TR 22,217,33792
MV 136,v,28,v,72
buffer_load_dwordx4 v212, s[48:51], s66 offen offset:0 lds
v_accvgpr_read_b32 v239, a197
MV 116,v,24,v,68
ds_read_b128 v[52:55], v224 offset:34816
buffer_load_dwordx4 v213, s[48:51], s66 offen offset:1024 lds
MV 132,v,28,v,68
v_accvgpr_read_b32 v240, a198
v_accvgpr_read_b32 v241, a199
MV 112,v,24,v,64
TR 24,218,32768
TR 26,218,33792
MV 128,v,28,v,64
TR 28,219,32768
TR 30,219,33792
MV 144,v,32,v,64
ds_read_b128 v[56:59], v224 offset:36864
buffer_load_dwordx4 v214, s[48:51], s66 offen offset:2048 lds
MV 160,v,36,v,64
buffer_load_dwordx4 v215, s[48:51], s66 offen offset:3072 lds
v_cvt_pk_bf16_f32 v230, v234, v235
MV 148,v,32,v,68
v_cvt_pk_bf16_f32 v231, v236, v237
v_cvt_pk_bf16_f32 v232, v238, v239
MV 164,v,36,v,68
s_add_u32 s66, s66, 524288
v_cvt_pk_bf16_f32 v233, v240, v241
MV 152,v,32,v,72
ds_read_b128 v[60:63], v224 offset:38912
s_add_u32 s24, s24, 4096
MV 168,v,36,v,72
s_and_b32 s66, s66, 8388607
buffer_store_dwordx4 v[230:233], v228, s[16:19], s24 offen offset:0 sc1
MV 156,v,32,v,76
TR 32,220,32768
TR 34,220,33792
MV 172,v,36,v,76
TR 36,221,32768
TR 38,221,33792
MV 188,v,40,v,76
s_add_u32 s75, s64, s74
v_accvgpr_read_b32 v246, a200
MV 204,v,44,v,76
v_accvgpr_read_b32 v247, a201
v_accvgpr_read_b32 v248, a202
MV 184,v,40,v,72
s_add_u32 m0, s67, 0
v_accvgpr_read_b32 v249, a203
MV 200,v,44,v,72
v_accvgpr_read_b32 v250, a204
v_accvgpr_read_b32 v251, a205
MV 180,v,40,v,68
buffer_load_dwordx4 v208, s[44:47], s75 offen offset:0 lds
v_accvgpr_read_b32 v252, a206
MV 196,v,44,v,68
MV 176,v,40,v,64
TR 40,222,32768
TR 42,222,33792
MV 192,v,44,v,64
TR 44,223,32768
TR 46,223,33792
s_waitcnt lgkmcnt(4)
MV 80,v,16,v,48
buffer_load_dwordx4 v209, s[44:47], s75 offen offset:1024 lds
v_accvgpr_read_b32 v253, a207
MV 96,v,20,v,48
ds_read_b128 v[64:67], v225 offset:32768
v_cvt_pk_bf16_f32 v242, v246, v247
MV 84,v,16,v,52
buffer_load_dwordx4 v210, s[44:47], s75 offen offset:2048 lds
v_cvt_pk_bf16_f32 v243, v248, v249
MV 100,v,20,v,52
MV 88,v,16,v,56
v_cvt_pk_bf16_f32 v244, v250, v251
MV 104,v,20,v,56
buffer_load_dwordx4 v211, s[44:47], s75 offen offset:3072 lds
v_cvt_pk_bf16_f32 v245, v252, v253
MV 92,v,16,v,60
TR 16,216,40960
TR 18,216,41984
MV 108,v,20,v,60
TR 20,217,40960
TR 22,217,41984
MV 124,v,24,v,60
ds_read_b128 v[68:71], v225 offset:34816
s_add_u32 s75, s65, s74
MV 140,v,28,v,60
buffer_store_dwordx4 v[242:245], v228, s[16:19], s24 offen offset:1024 sc1
v_accvgpr_read_b32 v234, a208
MV 120,v,24,v,56
v_accvgpr_read_b32 v235, a209
MV 136,v,28,v,56
s_add_u32 m0, s67, 4096
v_accvgpr_read_b32 v236, a210
MV 116,v,24,v,52
ds_read_b128 v[72:75], v225 offset:36864
v_accvgpr_read_b32 v237, a211
MV 132,v,28,v,52
MV 112,v,24,v,48
TR 24,218,40960
TR 26,218,41984
MV 128,v,28,v,48
TR 28,219,40960
TR 30,219,41984
MV 144,v,32,v,48
buffer_load_dwordx4 v208, s[44:47], s75 offen offset:0 lds
buffer_load_dwordx4 v209, s[44:47], s75 offen offset:1024 lds
MV 160,v,36,v,48
v_accvgpr_read_b32 v238, a212
v_accvgpr_read_b32 v239, a213
MV 148,v,32,v,52
ds_read_b128 v[76:79], v225 offset:38912
v_accvgpr_read_b32 v240, a214
MV 164,v,36,v,52
buffer_load_dwordx4 v210, s[44:47], s75 offen offset:2048 lds
v_accvgpr_read_b32 v241, a215
MV 152,v,32,v,56
v_cvt_pk_bf16_f32 v230, v234, v235
MV 168,v,36,v,56
v_cvt_pk_bf16_f32 v231, v236, v237
MV 156,v,32,v,60
TR 32,220,40960
TR 34,220,41984
MV 172,v,36,v,60
TR 36,221,40960
TR 38,221,41984
s_waitcnt lgkmcnt(15)
MV 188,v,40,v,60
buffer_load_dwordx4 v211, s[44:47], s75 offen offset:3072 lds
v_cvt_pk_bf16_f32 v232, v238, v239
MV 204,v,44,v,60
s_add_u32 s74, s74, 128
v_cvt_pk_bf16_f32 v233, v240, v241
MV 184,v,40,v,56
buffer_store_dwordx4 v[230:233], v228, s[16:19], s24 offen offset:2048 sc1
MV 200,v,44,v,56
v_accvgpr_read_b32 v246, a216
MV 180,v,40,v,52
s_and_b32 s74, s74, 2047
v_accvgpr_read_b32 v247, a217
MV 196,v,44,v,52
MV 176,v,40,v,48
TR 40,222,40960
TR 42,222,41984
MV 192,v,44,v,48
TR 44,223,40960
TR 46,223,41984
s_waitcnt lgkmcnt(4)
MV 80,v,16,v,64
v_accvgpr_read_b32 v248, a218
MV 96,v,20,v,64
v_accvgpr_read_b32 v249, a219
MV 84,v,16,v,68
v_accvgpr_read_b32 v250, a220
MV 100,v,20,v,68
MV 88,v,16,v,72
v_accvgpr_read_b32 v251, a221
MV 104,v,20,v,72
v_accvgpr_read_b32 v252, a222
MV 92,v,16,v,76
MV 108,v,20,v,76
s_waitcnt vmcnt(17) lgkmcnt(0)
s_barrier
MV 124,v,24,v,76
TR 16,216,0
TR 18,216,1024
MV 140,v,28,v,76
ds_read_b128 v[48:51], v226 offset:0
s_add_u32 m0, s68, 131072
MV 120,v,24,v,72
TR 20,217,0
TR 22,217,1024
MV 136,v,28,v,72
buffer_load_dwordx4 v212, s[48:51], s66 offen offset:0 lds
v_accvgpr_read_b32 v253, a223
MV 116,v,24,v,68
ds_read_b128 v[52:55], v226 offset:2048
buffer_load_dwordx4 v213, s[48:51], s66 offen offset:1024 lds
MV 132,v,28,v,68
v_cvt_pk_bf16_f32 v242, v246, v247
v_cvt_pk_bf16_f32 v243, v248, v249
MV 112,v,24,v,64
TR 24,218,0
TR 26,218,1024
MV 128,v,28,v,64
TR 28,219,0
TR 30,219,1024
MV 144,v,32,v,64
ds_read_b128 v[56:59], v226 offset:4096
buffer_load_dwordx4 v214, s[48:51], s66 offen offset:2048 lds
MV 160,v,36,v,64
buffer_load_dwordx4 v215, s[48:51], s66 offen offset:3072 lds
v_cvt_pk_bf16_f32 v244, v250, v251
MV 148,v,32,v,68
v_cvt_pk_bf16_f32 v245, v252, v253
buffer_store_dwordx4 v[242:245], v228, s[16:19], s24 offen offset:3072 sc1
MV 164,v,36,v,68
s_add_u32 s66, s66, 524288
v_accvgpr_read_b32 v234, a224
MV 152,v,32,v,72
ds_read_b128 v[60:63], v226 offset:6144
v_accvgpr_read_b32 v235, a225
MV 168,v,36,v,72
s_and_b32 s66, s66, 8388607
v_accvgpr_read_b32 v236, a226
MV 156,v,32,v,76
TR 32,220,0
TR 34,220,1024
MV 172,v,36,v,76
TR 36,221,0
TR 38,221,1024
MV 188,v,40,v,76
s_add_u32 s75, s64, s74
v_accvgpr_read_b32 v237, a227
MV 204,v,44,v,76
v_accvgpr_read_b32 v238, a228
v_accvgpr_read_b32 v239, a229
MV 184,v,40,v,72
s_add_u32 m0, s67, 32768
v_accvgpr_read_b32 v240, a230
MV 200,v,44,v,72
v_accvgpr_read_b32 v241, a231
v_cvt_pk_bf16_f32 v230, v234, v235
MV 180,v,40,v,68
buffer_load_dwordx4 v208, s[44:47], s75 offen offset:0 lds
v_cvt_pk_bf16_f32 v231, v236, v237
MV 196,v,44,v,68
MV 176,v,40,v,64
TR 40,222,0
TR 42,222,1024
MV 192,v,44,v,64
TR 44,223,0
TR 46,223,1024
s_waitcnt lgkmcnt(4)
MV 80,v,16,v,48
buffer_load_dwordx4 v209, s[44:47], s75 offen offset:1024 lds
v_cvt_pk_bf16_f32 v232, v238, v239
MV 96,v,20,v,48
ds_read_b128 v[64:67], v227 offset:0
v_cvt_pk_bf16_f32 v233, v240, v241
MV 84,v,16,v,52
buffer_load_dwordx4 v210, s[44:47], s75 offen offset:2048 lds
s_add_u32 s24, s24, 4096
MV 100,v,20,v,52
MV 88,v,16,v,56
buffer_store_dwordx4 v[230:233], v228, s[16:19], s24 offen offset:0 sc1
MV 104,v,20,v,56
buffer_load_dwordx4 v211, s[44:47], s75 offen offset:3072 lds
v_accvgpr_read_b32 v246, a232
MV 92,v,16,v,60
TR 16,216,8192
TR 18,216,9216
MV 108,v,20,v,60
TR 20,217,8192
TR 22,217,9216
MV 124,v,24,v,60
ds_read_b128 v[68:71], v227 offset:2048
s_add_u32 s75, s65, s74
MV 140,v,28,v,60
v_accvgpr_read_b32 v247, a233
v_accvgpr_read_b32 v248, a234
MV 120,v,24,v,56
v_accvgpr_read_b32 v249, a235
MV 136,v,28,v,56
s_add_u32 m0, s67, 36864
v_accvgpr_read_b32 v250, a236
MV 116,v,24,v,52
ds_read_b128 v[72:75], v227 offset:4096
v_accvgpr_read_b32 v251, a237
MV 132,v,28,v,52
MV 112,v,24,v,48
TR 24,218,8192
TR 26,218,9216
MV 128,v,28,v,48
TR 28,219,8192
TR 30,219,9216
MV 144,v,32,v,48
buffer_load_dwordx4 v208, s[44:47], s75 offen offset:0 lds
buffer_load_dwordx4 v209, s[44:47], s75 offen offset:1024 lds
MV 160,v,36,v,48
v_accvgpr_read_b32 v252, a238
v_accvgpr_read_b32 v253, a239
MV 148,v,32,v,52
ds_read_b128 v[76:79], v227 offset:6144
v_cvt_pk_bf16_f32 v242, v246, v247
MV 164,v,36,v,52
buffer_load_dwordx4 v210, s[44:47], s75 offen offset:2048 lds
v_cvt_pk_bf16_f32 v243, v248, v249
MV 152,v,32,v,56
v_cvt_pk_bf16_f32 v244, v250, v251
MV 168,v,36,v,56
v_cvt_pk_bf16_f32 v245, v252, v253
MV 156,v,32,v,60
TR 32,220,8192
TR 34,220,9216
MV 172,v,36,v,60
TR 36,221,8192
TR 38,221,9216
s_waitcnt lgkmcnt(15)
MV 188,v,40,v,60
buffer_load_dwordx4 v211, s[44:47], s75 offen offset:3072 lds
buffer_store_dwordx4 v[242:245], v228, s[16:19], s24 offen offset:1024 sc1
MV 204,v,44,v,60
s_add_u32 s74, s74, 128
v_accvgpr_read_b32 v234, a240
MV 184,v,40,v,56
v_accvgpr_read_b32 v235, a241
MV 200,v,44,v,56
v_accvgpr_read_b32 v236, a242
MV 180,v,40,v,52
s_and_b32 s74, s74, 2047
v_accvgpr_read_b32 v237, a243
MV 196,v,44,v,52
MV 176,v,40,v,48
TR 40,222,8192
TR 42,222,9216
MV 192,v,44,v,48
TR 44,223,8192
TR 46,223,9216
s_waitcnt lgkmcnt(4)
MV 80,v,16,v,64
v_accvgpr_read_b32 v238, a244
MV 96,v,20,v,64
v_accvgpr_read_b32 v239, a245
MV 84,v,16,v,68
v_accvgpr_read_b32 v240, a246
MV 100,v,20,v,68
MV 88,v,16,v,72
v_accvgpr_read_b32 v241, a247
MV 104,v,20,v,72
v_cvt_pk_bf16_f32 v230, v234, v235
MV 92,v,16,v,76
v_cvt_pk_bf16_f32 v231, v236, v237
MV 108,v,20,v,76
s_waitcnt vmcnt(16) lgkmcnt(0)
s_barrier
MV 124,v,24,v,76
TR 16,216,16384
TR 18,216,17408
MV 140,v,28,v,76
ds_read_b128 v[48:51], v224 offset:0
s_add_u32 m0, s68, 98304
MV 120,v,24,v,72
TR 20,217,16384
TR 22,217,17408
MV 136,v,28,v,72
buffer_load_dwordx4 v212, s[48:51], s66 offen offset:0 lds
v_cvt_pk_bf16_f32 v232, v238, v239
MV 116,v,24,v,68
ds_read_b128 v[52:55], v224 offset:2048
buffer_load_dwordx4 v213, s[48:51], s66 offen offset:1024 lds
MV 132,v,28,v,68
v_cvt_pk_bf16_f32 v233, v240, v241
buffer_store_dwordx4 v[230:233], v228, s[16:19], s24 offen offset:2048 sc1
MV 112,v,24,v,64
TR 24,218,16384
TR 26,218,17408
MV 128,v,28,v,64
TR 28,219,16384
TR 30,219,17408
MV 144,v,32,v,64
ds_read_b128 v[56:59], v224 offset:4096
buffer_load_dwordx4 v214, s[48:51], s66 offen offset:2048 lds
MV 160,v,36,v,64
buffer_load_dwordx4 v215, s[48:51], s66 offen offset:3072 lds
v_accvgpr_read_b32 v246, a248
MV 148,v,32,v,68
v_accvgpr_read_b32 v247, a249
v_accvgpr_read_b32 v248, a250
MV 164,v,36,v,68
s_add_u32 s66, s66, 524288
v_accvgpr_read_b32 v249, a251
MV 152,v,32,v,72
ds_read_b128 v[60:63], v224 offset:6144
v_accvgpr_read_b32 v250, a252
MV 168,v,36,v,72
s_and_b32 s66, s66, 8388607
v_accvgpr_read_b32 v251, a253
MV 156,v,32,v,76
TR 32,220,16384
TR 34,220,17408
MV 172,v,36,v,76
TR 36,221,16384
TR 38,221,17408
MV 188,v,40,v,76
s_add_u32 s75, s64, s74
v_accvgpr_read_b32 v252, a254
MV 204,v,44,v,76
v_accvgpr_read_b32 v253, a255
v_cvt_pk_bf16_f32 v242, v246, v247
MV 184,v,40,v,72
s_add_u32 m0, s67, 65536
v_cvt_pk_bf16_f32 v243, v248, v249
MV 200,v,44,v,72
v_cvt_pk_bf16_f32 v244, v250, v251
v_cvt_pk_bf16_f32 v245, v252, v253
MV 180,v,40,v,68
buffer_load_dwordx4 v208, s[44:47], s75 offen offset:0 lds
buffer_store_dwordx4 v[242:245], v228, s[16:19], s24 offen offset:3072 sc1
MV 196,v,44,v,68
MV 176,v,40,v,64
TR 40,222,16384
TR 42,222,17408
MV 192,v,44,v,64
TR 44,223,16384
TR 46,223,17408
s_waitcnt lgkmcnt(4)
MV 80,v,16,v,48
buffer_load_dwordx4 v209, s[44:47], s75 offen offset:1024 lds
v_lshlrev_b32 v255, 20, v1
MV 96,v,20,v,48
ds_read_b128 v[64:67], v225 offset:0
MV 84,v,16,v,52
buffer_load_dwordx4 v210, s[44:47], s75 offen offset:2048 lds
MV 100,v,20,v,52
MV 88,v,16,v,56
MV 104,v,20,v,56
buffer_load_dwordx4 v211, s[44:47], s75 offen offset:3072 lds
MV 92,v,16,v,60
TR 16,216,24576
TR 18,216,25600
MV 108,v,20,v,60
TR 20,217,24576
TR 22,217,25600
MV 124,v,24,v,60
ds_read_b128 v[68:71], v225 offset:2048
s_add_u32 s75, s65, s74
MV 140,v,28,v,60
MV 120,v,24,v,56
s_lshl_b32 s36, s3, 26
MV 136,v,28,v,56
s_add_u32 m0, s67, 69632
MV 116,v,24,v,52
ds_read_b128 v[72:75], v225 offset:4096
MV 132,v,28,v,52
MV 112,v,24,v,48
TR 24,218,24576
TR 26,218,25600
MV 128,v,28,v,48
TR 28,219,24576
TR 30,219,25600
MV 144,v,32,v,48
buffer_load_dwordx4 v208, s[44:47], s75 offen offset:0 lds
buffer_load_dwordx4 v209, s[44:47], s75 offen offset:1024 lds
MV 160,v,36,v,48
MV 148,v,32,v,52
ds_read_b128 v[76:79], v225 offset:6144
MV 164,v,36,v,52
buffer_load_dwordx4 v210, s[44:47], s75 offen offset:2048 lds
MV 152,v,32,v,56
v_add_u32 v255, s36, v255
MV 168,v,36,v,56
MV 156,v,32,v,60
TR 32,220,24576
TR 34,220,25600
MV 172,v,36,v,60
TR 36,221,24576
TR 38,221,25600
s_waitcnt lgkmcnt(15)
MV 188,v,40,v,60
buffer_load_dwordx4 v211, s[44:47], s75 offen offset:3072 lds
MV 204,v,44,v,60
s_add_u32 s74, s74, 128
MV 184,v,40,v,56
MV 200,v,44,v,56
MV 180,v,40,v,52
s_and_b32 s74, s74, 2047
MV 196,v,44,v,52
MV 176,v,40,v,48
TR 40,222,24576
TR 42,222,25600
MV 192,v,44,v,48
TR 44,223,24576
TR 46,223,25600
s_waitcnt lgkmcnt(4)
MV 80,v,16,v,64
v_lshlrev_b32 v230, 4, v1
MV 96,v,20,v,64
s_lshl_b32 s80, s3, 12
MV 84,v,16,v,68
MV 100,v,20,v,68
v_add_u32 v12, s80, v230
MV 88,v,16,v,72
MV 104,v,20,v,72
v_add_u32 v10, 0x8000, v230
MV 92,v,16,v,76
MV 108,v,20,v,76
s_waitcnt vmcnt(15) lgkmcnt(0)
s_barrier
MV 124,v,24,v,76
TR 16,216,32768
TR 18,216,33792
MV 140,v,28,v,76
ds_read_b128 v[48:51], v224 offset:32768
s_add_u32 m0, s68, 114688
MV 120,v,24,v,72
TR 20,217,32768
TR 22,217,33792
MV 136,v,28,v,72
buffer_load_dwordx4 v212, s[48:51], s66 offen offset:0 lds
v_add_u32 v11, 0x18000, v230
MV 116,v,24,v,68
ds_read_b128 v[52:55], v224 offset:34816
buffer_load_dwordx4 v213, s[48:51], s66 offen offset:1024 lds
MV 132,v,28,v,68
s_add_u32 s72, s80, 0x8000
s_add_u32 s73, s80, 0x18000
MV 112,v,24,v,64
TR 24,218,32768
TR 26,218,33792
MV 128,v,28,v,64
TR 28,219,32768
TR 30,219,33792
MV 144,v,32,v,64
ds_read_b128 v[56:59], v224 offset:36864
buffer_load_dwordx4 v214, s[48:51], s66 offen offset:2048 lds
MV 160,v,36,v,64
buffer_load_dwordx4 v215, s[48:51], s66 offen offset:3072 lds
v_mov_b32 v15, v230
MV 148,v,32,v,68
v_and_b32 v230, 15, v1
v_lshrrev_b32 v232, 4, v1
MV 164,v,36,v,68
s_add_u32 s66, s66, 524288
v_lshlrev_b32 v232, 2, v232
MV 152,v,32,v,72
ds_read_b128 v[60:63], v224 offset:38912
v_sub_u32 v230, v230, v232
MV 168,v,36,v,72
s_and_b32 s66, s66, 8388607
s_lshl_b32 s81, s3, 4
MV 156,v,32,v,76
TR 32,220,32768
TR 34,220,33792
MV 172,v,36,v,76
TR 36,221,32768
TR 38,221,33792
MV 188,v,40,v,76
s_add_u32 s75, s64, s74
v_add_u32 v13, s81, v230
MV 204,v,44,v,76
s_sub_u32 s81, 112, s81
MV 184,v,40,v,72
s_add_u32 m0, s67, 0
v_add_u32 v239, s81, v230
MV 200,v,44,v,72
MV 180,v,40,v,68
buffer_load_dwordx4 v208, s[44:47], s75 offen offset:0 lds
v_mov_b32 v14, 0xff800000
MV 196,v,44,v,68
MV 176,v,40,v,64
TR 40,222,32768
TR 42,222,33792
MV 192,v,44,v,64
TR 44,223,32768
TR 46,223,33792
s_waitcnt lgkmcnt(4)
MV 80,v,16,v,48
buffer_load_dwordx4 v209, s[44:47], s75 offen offset:1024 lds
s_getpc_b64 s[38:39]
L_ct_a:
MV 96,v,20,v,48
ds_read_b128 v[64:67], v225 offset:32768
MV 84,v,16,v,52
buffer_load_dwordx4 v210, s[44:47], s75 offen offset:2048 lds
MV 100,v,20,v,52
s_add_u32 s38, s38, L_p3_begin - L_ct_a
s_addc_u32 s39, s39, 0
MV 88,v,16,v,56
MV 104,v,20,v,56
buffer_load_dwordx4 v211, s[44:47], s75 offen offset:3072 lds
v_mov_b32 v229, s39
MV 92,v,16,v,60
TR 16,216,40960
TR 18,216,41984
MV 108,v,20,v,60
TR 20,217,40960
TR 22,217,41984
MV 124,v,24,v,60
ds_read_b128 v[68:71], v225 offset:34816
s_add_u32 s75, s65, s74
MV 140,v,28,v,60
v_mov_b32 v228, s38
s_lshr_b32 s38, s2, 3
MV 120,v,24,v,56
s_lshl_b32 s38, s38, 2
MV 136,v,28,v,56
s_add_u32 m0, s67, 4096
s_add_u32 s38, s38, s3
MV 116,v,24,v,52
ds_read_b128 v[72:75], v225 offset:36864
MV 132,v,28,v,52
s_lshl_b32 s38, s38, 7
MV 112,v,24,v,48
TR 24,218,40960
TR 26,218,41984
MV 128,v,28,v,48
TR 28,219,40960
TR 30,219,41984
MV 144,v,32,v,48
buffer_load_dwordx4 v208, s[44:47], s75 offen offset:0 lds
buffer_load_dwordx4 v209, s[44:47], s75 offen offset:1024 lds
MV 160,v,36,v,48
v_and_b32 v238, 3, v1
v_lshlrev_b32 v238, 14, v238
MV 148,v,32,v,52
ds_read_b128 v[76:79], v225 offset:38912
v_add_u32 v238, s38, v238
MV 164,v,36,v,52
buffer_load_dwordx4 v210, s[44:47], s75 offen offset:2048 lds
MV 152,v,32,v,56
v_min_u32 v238, L_p3_s1m_top - L_p3_begin - 4, v238
MV 168,v,36,v,56
v_add_co_u32 v228, vcc, v228, v238
s_nop 1
v_addc_co_u32 v229, vcc, 0, v229, vcc
MV 156,v,32,v,60
TR 32,220,40960
TR 34,220,41984
MV 172,v,36,v,60
TR 36,221,40960
TR 38,221,41984
s_waitcnt lgkmcnt(15)
MV 188,v,40,v,60
buffer_load_dwordx4 v211, s[44:47], s75 offen offset:3072 lds
MV 204,v,44,v,60
s_add_u32 s74, s74, 128
MV 184,v,40,v,56
MV 200,v,44,v,56
MV 180,v,40,v,52
s_and_b32 s74, s74, 2047
global_load_dword v238, v[228:229], off
MV 196,v,44,v,52
MV 176,v,40,v,48
TR 40,222,40960
TR 42,222,41984
MV 192,v,44,v,48
TR 44,223,40960
TR 46,223,41984
s_waitcnt lgkmcnt(4)
MV 80,v,16,v,64
MV 96,v,20,v,64
MV 84,v,16,v,68
MV 100,v,20,v,68
MV 88,v,16,v,72
MV 104,v,20,v,72
MV 92,v,16,v,76
MV 108,v,20,v,76
s_waitcnt vmcnt(13) lgkmcnt(0)
s_barrier
MV 124,v,24,v,76
v_cmp_gt_u32 vcc, 1, v254
s_nop 4
s_cbranch_vccnz L_spin_go
L_spin_go_ret:
v_mov_b32 v254, 1
s_lshl_b32 s36, s2, 2
buffer_store_dword v254, v255, s[8:11], s36 offen offset:0 sc1
s_load_dwordx4 s[32:35], s[0:1], 32
s_load_dwordx2 s[82:83], s[0:1], 88
MV 140,v,28,v,76
TR 16,216,0
TR 18,216,1024
MV 120,v,24,v,72
TR 20,217,0
TR 22,217,1024
MV 136,v,28,v,72
ds_read_b128 v[48:51], v226 offset:0
s_add_u32 m0, s68, 131072
MV 116,v,24,v,68
ds_read_b128 v[52:55], v226 offset:2048
buffer_load_dwordx4 v212, s[48:51], s66 offen offset:0 lds
MV 132,v,28,v,68
buffer_load_dwordx4 v213, s[48:51], s66 offen offset:1024 lds
MV 112,v,24,v,64
TR 24,218,0
TR 26,218,1024
MV 128,v,28,v,64
TR 28,219,0
TR 30,219,1024
MV 144,v,32,v,64
ds_read_b128 v[56:59], v226 offset:4096
buffer_load_dwordx4 v214, s[48:51], s66 offen offset:2048 lds
MV 160,v,36,v,64
buffer_load_dwordx4 v215, s[48:51], s66 offen offset:3072 lds
MV 148,v,32,v,68
MV 164,v,36,v,68
s_add_u32 s66, s66, 524288
MV 152,v,32,v,72
ds_read_b128 v[60:63], v226 offset:6144
MV 168,v,36,v,72
s_and_b32 s66, s66, 8388607
MV 156,v,32,v,76
TR 32,220,0
TR 34,220,1024
MV 172,v,36,v,76
TR 36,221,0
TR 38,221,1024
MV 188,v,40,v,76
s_add_u32 s75, s64, s74
MV 204,v,44,v,76
MV 184,v,40,v,72
s_add_u32 m0, s67, 32768
MV 200,v,44,v,72
MV 180,v,40,v,68
buffer_load_dwordx4 v208, s[44:47], s75 offen offset:0 lds
MV 196,v,44,v,68
MV 176,v,40,v,64
TR 40,222,0
TR 42,222,1024
MV 192,v,44,v,64
TR 44,223,0
TR 46,223,1024
s_waitcnt lgkmcnt(4)
MV 80,v,16,v,48
buffer_load_dwordx4 v209, s[44:47], s75 offen offset:1024 lds
s_and_b32 s36, s2, 3
MV 96,v,20,v,48
ds_read_b128 v[64:67], v227 offset:0
s_lshl_b32 s36, s36, 1
MV 84,v,16,v,52
buffer_load_dwordx4 v210, s[44:47], s75 offen offset:2048 lds
s_sub_u32 s43, 14, s36
MV 100,v,20,v,52
s_bitcmp1_b32 s2, 4
s_cselect_b32 s36, s43, s36
MV 88,v,16,v,56
s_bfe_u32 s43, s2, 0x10003
MV 104,v,20,v,56
buffer_load_dwordx4 v211, s[44:47], s75 offen offset:3072 lds
s_add_u32 s36, s36, s43
MV 92,v,16,v,60
TR 16,216,8192
TR 18,216,9216
MV 108,v,20,v,60
TR 20,217,8192
TR 22,217,9216
MV 124,v,24,v,60
ds_read_b128 v[68:71], v227 offset:2048
s_add_u32 s75, s65, s74
MV 140,v,28,v,60
s_bfe_u32 s37, s2, 0x10002
s_lshr_b32 s43, s2, 5
MV 120,v,24,v,56
s_lshl_b32 s43, s43, 1
s_add_u32 s37, s37, s43
MV 136,v,28,v,56
s_add_u32 m0, s67, 36864
v_and_b32 v230, 15, v1
MV 116,v,24,v,52
ds_read_b128 v[72:75], v227 offset:4096
s_lshl_b32 s36, s36, 4
MV 132,v,28,v,52
v_add_u32 v231, s36, v230
s_lshr_b32 s36, s2, 4
MV 112,v,24,v,48
TR 24,218,8192
TR 26,218,9216
MV 128,v,28,v,48
TR 28,219,8192
TR 30,219,9216
MV 144,v,32,v,48
buffer_load_dwordx4 v208, s[44:47], s75 offen offset:0 lds
buffer_load_dwordx4 v209, s[44:47], s75 offen offset:1024 lds
MV 160,v,36,v,48
v_lshl_add_u32 v232, v230, 4, s36
v_and_b32 v233, 7, v1
MV 148,v,32,v,52
ds_read_b128 v[76:79], v227 offset:6144
v_bfe_u32 v234, v1, 3, 1
MV 164,v,36,v,52
buffer_load_dwordx4 v210, s[44:47], s75 offen offset:2048 lds
v_lshlrev_b32 v233, 3, v233
MV 152,v,32,v,56
v_lshl_add_u32 v233, v234, 7, v233
s_bfe_u32 s36, s69, 0x10001
MV 168,v,36,v,56
s_lshl_b32 s36, s36, 6
s_lshr_b32 s37, s69, 2
MV 156,v,32,v,60
TR 32,220,8192
TR 34,220,9216
MV 172,v,36,v,60
TR 36,221,8192
TR 38,221,9216
s_waitcnt lgkmcnt(15)
MV 188,v,40,v,60
buffer_load_dwordx4 v211, s[44:47], s75 offen offset:3072 lds
s_add_u32 s36, s36, s37
MV 204,v,44,v,60
s_add_u32 s74, s74, 128
v_add_u32 v233, s36, v233
MV 184,v,40,v,56
v_lshrrev_b32 v234, 4, v1
MV 200,v,44,v,56
v_cmp_eq_u32 vcc, 1, v234
s_nop 1
v_cndmask_b32 v233, v233, v232, vcc
MV 180,v,40,v,52
s_and_b32 s74, s74, 2047
MV 196,v,44,v,52
v_cmp_eq_u32 vcc, 2, v234
s_nop 1
v_cndmask_b32 v233, v233, v231, vcc
MV 176,v,40,v,48
TR 40,222,8192
TR 42,222,9216
MV 192,v,44,v,48
TR 44,223,8192
TR 46,223,9216
v_lshlrev_b32 v233, 2, v233
s_waitcnt lgkmcnt(4)
MV 80,v,16,v,64
MV 96,v,20,v,64
MV 84,v,16,v,68
MV 100,v,20,v,68
MV 88,v,16,v,72
MV 104,v,20,v,72
MV 92,v,16,v,76
MV 108,v,20,v,76
s_waitcnt vmcnt(14) lgkmcnt(0)
s_barrier
MV 124,v,24,v,76
TR 16,216,16384
TR 18,216,17408
MV 140,v,28,v,76
ds_read_b128 v[48:51], v224 offset:0
s_add_u32 m0, s68, 98304
MV 120,v,24,v,72
TR 20,217,16384
TR 22,217,17408
MV 136,v,28,v,72
buffer_load_dwordx4 v212, s[48:51], s66 offen offset:0 lds
MV 116,v,24,v,68
ds_read_b128 v[52:55], v224 offset:2048
buffer_load_dwordx4 v213, s[48:51], s66 offen offset:1024 lds
MV 132,v,28,v,68
MV 112,v,24,v,64
TR 24,218,16384
TR 26,218,17408
MV 128,v,28,v,64
TR 28,219,16384
TR 30,219,17408
MV 144,v,32,v,64
ds_read_b128 v[56:59], v224 offset:4096
buffer_load_dwordx4 v214, s[48:51], s66 offen offset:2048 lds
MV 160,v,36,v,64
buffer_load_dwordx4 v215, s[48:51], s66 offen offset:3072 lds
MV 148,v,32,v,68
MV 164,v,36,v,68
s_add_u32 s66, s66, 524288
MV 152,v,32,v,72
ds_read_b128 v[60:63], v224 offset:6144
MV 168,v,36,v,72
s_and_b32 s66, s66, 8388607
MV 156,v,32,v,76
TR 32,220,16384
TR 34,220,17408
MV 172,v,36,v,76
TR 36,221,16384
TR 38,221,17408
MV 188,v,40,v,76
s_add_u32 s75, s64, s74
MV 204,v,44,v,76
MV 184,v,40,v,72
s_add_u32 m0, s67, 65536
MV 200,v,44,v,72
MV 180,v,40,v,68
buffer_load_dwordx4 v208, s[44:47], s75 offen offset:0 lds
MV 196,v,44,v,68
MV 176,v,40,v,64
TR 40,222,16384
TR 42,222,17408
MV 192,v,44,v,64
TR 44,223,16384
TR 46,223,17408
s_waitcnt lgkmcnt(4)
MV 80,v,16,v,48
buffer_load_dwordx4 v209, s[44:47], s75 offen offset:1024 lds
s_lshl_b32 s36, s2, 2
MV 96,v,20,v,48
ds_read_b128 v[64:67], v225 offset:0
s_add_u32 s36, s36, s3
MV 84,v,16,v,52
buffer_load_dwordx4 v210, s[44:47], s75 offen offset:2048 lds
s_lshl_b32 s42, s36, 1
MV 100,v,20,v,52
s_lshl_b32 s37, s36, 12
MV 88,v,16,v,56
s_add_u32 s16, s32, s37
s_addc_u32 s17, s33, 0
MV 104,v,20,v,56
buffer_load_dwordx4 v211, s[44:47], s75 offen offset:3072 lds
MV 92,v,16,v,60
TR 16,216,24576
TR 18,216,25600
MV 108,v,20,v,60
TR 20,217,24576
TR 22,217,25600
MV 124,v,24,v,60
ds_read_b128 v[68:71], v225 offset:2048
s_add_u32 s75, s65, s74
MV 140,v,28,v,60
s_mov_b32 s18, 4096
s_mov_b32 s19, 0x20000
MV 120,v,24,v,56
s_add_u32 s37, s37, 50331648
MV 136,v,28,v,56
s_add_u32 m0, s67, 69632
MV 116,v,24,v,52
ds_read_b128 v[72:75], v225 offset:4096
MV 132,v,28,v,52
s_add_u32 s20, s40, s37
s_addc_u32 s21, s41, 0
MV 112,v,24,v,48
TR 24,218,24576
TR 26,218,25600
MV 128,v,28,v,48
TR 28,219,24576
TR 30,219,25600
MV 144,v,32,v,48
buffer_load_dwordx4 v208, s[44:47], s75 offen offset:0 lds
buffer_load_dwordx4 v209, s[44:47], s75 offen offset:1024 lds
MV 160,v,36,v,48
s_mov_b32 s22, 4096
s_mov_b32 s23, 0x20000
MV 148,v,32,v,52
ds_read_b128 v[76:79], v225 offset:6144
s_lshl_b32 s37, s2, 14
MV 164,v,36,v,52
buffer_load_dwordx4 v210, s[44:47], s75 offen offset:2048 lds
s_add_u32 s37, s37, 54525952
MV 152,v,32,v,56
s_add_u32 s24, s40, s37
s_addc_u32 s25, s41, 0
MV 168,v,36,v,56
s_mov_b32 s26, 16384
s_mov_b32 s27, 0x20000
MV 156,v,32,v,60
TR 32,220,24576
TR 34,220,25600
MV 172,v,36,v,60
TR 36,221,24576
TR 38,221,25600
s_waitcnt lgkmcnt(15)
MV 188,v,40,v,60
buffer_load_dwordx4 v211, s[44:47], s75 offen offset:3072 lds
s_mov_b32 s28, s34
MV 204,v,44,v,60
s_add_u32 s74, s74, 128
s_mov_b32 s29, s35
MV 184,v,40,v,56
s_mov_b32 s30, 2048
s_mov_b32 s31, 0x20000
MV 200,v,44,v,56
s_mul_i32 s43, s3, 4608
MV 180,v,40,v,52
s_and_b32 s74, s74, 2047
s_add_u32 s43, s43, 132096
MV 196,v,44,v,52
MV 176,v,40,v,48
TR 40,222,24576
TR 42,222,25600
MV 192,v,44,v,48
TR 44,223,24576
TR 46,223,25600
s_waitcnt lgkmcnt(4)
MV 80,v,16,v,64
buffer_load_dwordx4 v[208:211], v15, s[16:19], 0 offen offset:0
MV 96,v,20,v,64
MV 84,v,16,v,68
MV 100,v,20,v,68
MV 88,v,16,v,72
MV 104,v,20,v,72
MV 92,v,16,v,76
MV 108,v,20,v,76
s_waitcnt vmcnt(13) lgkmcnt(0)
s_barrier
MV 124,v,24,v,76
TR 16,216,32768
TR 18,216,33792
MV 140,v,28,v,76
ds_read_b128 v[48:51], v224 offset:32768
MV 120,v,24,v,72
TR 20,217,32768
TR 22,217,33792
MV 136,v,28,v,72
buffer_load_dwordx4 v[212:215], v15, s[16:19], 0 offen offset:1024
MV 116,v,24,v,68
ds_read_b128 v[52:55], v224 offset:34816
MV 132,v,28,v,68
MV 112,v,24,v,64
TR 24,218,32768
TR 26,218,33792
MV 128,v,28,v,64
TR 28,219,32768
TR 30,219,33792
MV 144,v,32,v,64
ds_read_b128 v[56:59], v224 offset:36864
MV 160,v,36,v,64
MV 148,v,32,v,68
MV 164,v,36,v,68
MV 152,v,32,v,72
ds_read_b128 v[60:63], v224 offset:38912
buffer_load_dwordx4 v[228:231], v15, s[16:19], 0 offen offset:2048
MV 168,v,36,v,72
MV 156,v,32,v,76
TR 32,220,32768
TR 34,220,33792
MV 172,v,36,v,76
TR 36,221,32768
TR 38,221,33792
MV 188,v,40,v,76
MV 204,v,44,v,76
MV 184,v,40,v,72
MV 200,v,44,v,72
MV 180,v,40,v,68
MV 196,v,44,v,68
MV 176,v,40,v,64
TR 40,222,32768
TR 42,222,33792
MV 192,v,44,v,64
TR 44,223,32768
TR 46,223,33792
s_waitcnt lgkmcnt(4)
MV 80,v,16,v,48
buffer_load_dwordx4 v[234:237], v15, s[16:19], 0 offen offset:3072
MV 96,v,20,v,48
ds_read_b128 v[64:67], v225 offset:32768
MV 84,v,16,v,52
buffer_load_ushort v232, off, s[28:31], s42
MV 100,v,20,v,52
MV 88,v,16,v,56
s_add_u32 s4, s40, 109051904
s_addc_u32 s5, s41, 0
MV 104,v,20,v,56
MV 92,v,16,v,60
TR 16,216,40960
TR 18,216,41984
MV 108,v,20,v,60
TR 20,217,40960
TR 22,217,41984
MV 124,v,24,v,60
ds_read_b128 v[68:71], v225 offset:34816
s_mov_b32 s6, 4194304
MV 140,v,28,v,60
MV 120,v,24,v,56
s_mov_b32 s7, 0x20000
MV 136,v,28,v,56
MV 116,v,24,v,52
ds_read_b128 v[72:75], v225 offset:36864
s_lshl_b32 s36, s2, 14
MV 132,v,28,v,52
MV 112,v,24,v,48
TR 24,218,40960
TR 26,218,41984
MV 128,v,28,v,48
TR 28,219,40960
TR 30,219,41984
MV 144,v,32,v,48
v_mov_b32 v244, -1
v_mov_b32 v245, -1
MV 160,v,36,v,48
MV 148,v,32,v,52
ds_read_b128 v[76:79], v225 offset:38912
v_mov_b32 v246, -1
MV 164,v,36,v,52
MV 152,v,32,v,56
v_mov_b32 v247, -1
MV 168,v,36,v,56
MV 156,v,32,v,60
TR 32,220,40960
TR 34,220,41984
MV 172,v,36,v,60
TR 36,221,40960
TR 38,221,41984
s_waitcnt lgkmcnt(15)
MV 188,v,40,v,60
buffer_store_dwordx4 v[244:247], v12, s[4:7], s36 offen offset:0 sc1
buffer_store_dwordx4 v[244:247], v12, s[4:7], s36 offen offset:1024 sc1
MV 204,v,44,v,60
MV 184,v,40,v,56
buffer_store_dwordx4 v[244:247], v12, s[4:7], s36 offen offset:2048 sc1
MV 200,v,44,v,56
MV 180,v,40,v,52
buffer_store_dwordx4 v[244:247], v12, s[4:7], s36 offen offset:3072 sc1
MV 196,v,44,v,52
MV 176,v,40,v,48
TR 40,222,40960
TR 42,222,41984
MV 192,v,44,v,48
TR 44,223,40960
TR 46,223,41984
s_waitcnt lgkmcnt(4)
MV 80,v,16,v,64
MV 96,v,20,v,64
MV 84,v,16,v,68
MV 100,v,20,v,68
MV 88,v,16,v,72
MV 104,v,20,v,72
MV 92,v,16,v,76
MV 108,v,20,v,76
s_waitcnt vmcnt(9) lgkmcnt(0)
s_barrier
MV 124,v,24,v,76
TR 16,216,0
TR 18,216,1024
MV 140,v,28,v,76
ds_read_b128 v[48:51], v226 offset:0
MV 120,v,24,v,72
TR 20,217,0
TR 22,217,1024
MV 136,v,28,v,72
MV 116,v,24,v,68
ds_read_b128 v[52:55], v226 offset:2048
MV 132,v,28,v,68
MV 112,v,24,v,64
TR 24,218,0
TR 26,218,1024
MV 128,v,28,v,64
TR 28,219,0
TR 30,219,1024
MV 144,v,32,v,64
ds_read_b128 v[56:59], v226 offset:4096
MV 160,v,36,v,64
MV 148,v,32,v,68
MV 164,v,36,v,68
MV 152,v,32,v,72
ds_read_b128 v[60:63], v226 offset:6144
MV 168,v,36,v,72
MV 156,v,32,v,76
TR 32,220,0
TR 34,220,1024
MV 172,v,36,v,76
TR 36,221,0
TR 38,221,1024
MV 188,v,40,v,76
MV 204,v,44,v,76
MV 184,v,40,v,72
MV 200,v,44,v,72
MV 180,v,40,v,68
MV 196,v,44,v,68
MV 176,v,40,v,64
TR 40,222,0
TR 42,222,1024
MV 192,v,44,v,64
TR 44,223,0
TR 46,223,1024
s_waitcnt lgkmcnt(4)
MV 80,v,16,v,48
buffer_load_dword v238, v233, s[8:11], 0 offen offset:0 sc1
MV 96,v,20,v,48
ds_read_b128 v[64:67], v227 offset:0
MV 84,v,16,v,52
s_lshr_b32 s36, s2, 3
MV 100,v,20,v,52
MV 88,v,16,v,56
MV 104,v,20,v,56
s_lshl_b32 s36, s36, 18
MV 92,v,16,v,60
TR 16,216,8192
TR 18,216,9216
MV 108,v,20,v,60
TR 20,217,8192
TR 22,217,9216
MV 124,v,24,v,60
ds_read_b128 v[68:71], v227 offset:2048
s_and_b32 s37, s2, 7
MV 140,v,28,v,60
MV 120,v,24,v,56
s_lshl_b32 s37, s37, 8
MV 136,v,28,v,56
MV 116,v,24,v,52
ds_read_b128 v[72:75], v227 offset:4096
s_add_u32 s36, s36, s37
MV 132,v,28,v,52
MV 112,v,24,v,48
TR 24,218,8192
TR 26,218,9216
MV 128,v,28,v,48
TR 28,219,8192
TR 30,219,9216
MV 144,v,32,v,48
s_lshl_b32 s37, s3, 16
MV 160,v,36,v,48
s_add_u32 s36, s36, s37
MV 148,v,32,v,52
ds_read_b128 v[76:79], v227 offset:6144
MV 164,v,36,v,52
MV 152,v,32,v,56
s_add_u32 s32, s82, s36
s_addc_u32 s33, s83, 0
MV 168,v,36,v,56
MV 156,v,32,v,60
TR 32,220,8192
TR 34,220,9216
MV 172,v,36,v,60
TR 36,221,8192
TR 38,221,9216
s_waitcnt lgkmcnt(15)
MV 188,v,40,v,60
MV 204,v,44,v,60
s_mov_b32 s34, 65536
MV 184,v,40,v,56
MV 200,v,44,v,56
s_mov_b32 s35, 0x20000
MV 180,v,40,v,52
MV 196,v,44,v,52
MV 176,v,40,v,48
TR 40,222,8192
TR 42,222,9216
MV 192,v,44,v,48
TR 44,223,8192
TR 46,223,9216
s_waitcnt vmcnt(0)
v_cmp_gt_u32 vcc, 1, v238
s_nop 4
s_cbranch_vccnz L_spin_f1
L_spin_f1_ret:
s_waitcnt lgkmcnt(4)
MV 80,v,16,v,64
s_add_u32 m0, s68, 16384
MV 96,v,20,v,64
MV 84,v,16,v,68
s_mov_b32 s80, 0
MV 100,v,20,v,68
MV 88,v,16,v,72
MV 104,v,20,v,72
buffer_load_dwordx4 v12, s[52:55], s80 offen offset:0 sc1 lds
MV 92,v,16,v,76
MV 108,v,20,v,76
buffer_load_dwordx4 v12, s[52:55], s80 offen offset:1024 sc1 lds
MV 124,v,24,v,76
MV 140,v,28,v,76
MV 120,v,24,v,72
buffer_load_dwordx4 v12, s[52:55], s80 offen offset:2048 sc1 lds
MV 136,v,28,v,72
MV 116,v,24,v,68
buffer_load_dwordx4 v12, s[52:55], s80 offen offset:3072 sc1 lds
MV 132,v,28,v,68
MV 112,v,24,v,64
MV 128,v,28,v,64
s_add_u32 m0, s68, 32768
MV 144,v,32,v,64
MV 160,v,36,v,64
s_mov_b32 s80, 16384
MV 148,v,32,v,68
MV 164,v,36,v,68
MV 152,v,32,v,72
buffer_load_dwordx4 v12, s[52:55], s80 offen offset:0 sc1 lds
MV 168,v,36,v,72
MV 156,v,32,v,76
buffer_load_dwordx4 v12, s[52:55], s80 offen offset:1024 sc1 lds
MV 172,v,36,v,76
s_waitcnt lgkmcnt(2)
MV 188,v,40,v,76
s_waitcnt lgkmcnt(0)
MV 204,v,44,v,76
buffer_load_dwordx4 v12, s[52:55], s80 offen offset:2048 sc1 lds
MV 184,v,40,v,72
MV 200,v,44,v,72
buffer_load_dwordx4 v12, s[52:55], s80 offen offset:3072 sc1 lds
MV 180,v,40,v,68
MV 196,v,44,v,68
MV 176,v,40,v,64
MV 192,v,44,v,64
L_p3_begin:
s_waitcnt lgkmcnt(0)
s_barrier
s_mov_b32 s82, 0x3e0293ee
s_mov_b32 s83, 0x3e0293ee
v_pk_mul_f32 v[80:81], v[80:81], s[82:83]
v_pk_mul_f32 v[82:83], v[82:83], s[82:83]
v_pk_mul_f32 v[84:85], v[84:85], s[82:83]
v_pk_mul_f32 v[86:87], v[86:87], s[82:83]
v_pk_mul_f32 v[88:89], v[88:89], s[82:83]
v_pk_mul_f32 v[90:91], v[90:91], s[82:83]
v_pk_mul_f32 v[92:93], v[92:93], s[82:83]
v_pk_mul_f32 v[94:95], v[94:95], s[82:83]
v_pk_mul_f32 v[96:97], v[96:97], s[82:83]
v_pk_mul_f32 v[98:99], v[98:99], s[82:83]
v_pk_mul_f32 v[100:101], v[100:101], s[82:83]
v_pk_mul_f32 v[102:103], v[102:103], s[82:83]
s_add_u32 m0, s68, 114688
v_pk_mul_f32 v[104:105], v[104:105], s[82:83]
v_pk_mul_f32 v[106:107], v[106:107], s[82:83]
v_pk_mul_f32 v[108:109], v[108:109], s[82:83]
v_pk_mul_f32 v[110:111], v[110:111], s[82:83]
v_cvt_pk_bf16_f32 v16, v80, v81
v_cvt_pk_bf16_f32 v17, v82, v83
v_cvt_pk_bf16_f32 v18, v96, v97
v_cvt_pk_bf16_f32 v19, v98, v99
v_cvt_pk_bf16_f32 v32, v84, v85
v_cvt_pk_bf16_f32 v33, v86, v87
v_cvt_pk_bf16_f32 v34, v100, v101
v_cvt_pk_bf16_f32 v35, v102, v103
v_cvt_pk_bf16_f32 v48, v88, v89
v_cvt_pk_bf16_f32 v49, v90, v91
v_cvt_pk_bf16_f32 v50, v104, v105
s_mov_b32 s80, 16384
v_cvt_pk_bf16_f32 v51, v106, v107
v_cvt_pk_bf16_f32 v64, v92, v93
v_cvt_pk_bf16_f32 v65, v94, v95
v_cvt_pk_bf16_f32 v66, v108, v109
v_cvt_pk_bf16_f32 v67, v110, v111
v_pk_mul_f32 v[112:113], v[112:113], s[82:83]
v_pk_mul_f32 v[114:115], v[114:115], s[82:83]
v_pk_mul_f32 v[116:117], v[116:117], s[82:83]
v_pk_mul_f32 v[118:119], v[118:119], s[82:83]
v_pk_mul_f32 v[120:121], v[120:121], s[82:83]
v_pk_mul_f32 v[122:123], v[122:123], s[82:83]
v_pk_mul_f32 v[124:125], v[124:125], s[82:83]
v_pk_mul_f32 v[126:127], v[126:127], s[82:83]
v_pk_mul_f32 v[128:129], v[128:129], s[82:83]
buffer_load_dwordx4 v12, s[56:59], s80 offen offset:0 sc1 lds
v_pk_mul_f32 v[130:131], v[130:131], s[82:83]
v_pk_mul_f32 v[132:133], v[132:133], s[82:83]
v_pk_mul_f32 v[134:135], v[134:135], s[82:83]
v_pk_mul_f32 v[136:137], v[136:137], s[82:83]
v_pk_mul_f32 v[138:139], v[138:139], s[82:83]
v_pk_mul_f32 v[140:141], v[140:141], s[82:83]
v_pk_mul_f32 v[142:143], v[142:143], s[82:83]
v_cvt_pk_bf16_f32 v20, v112, v113
v_cvt_pk_bf16_f32 v21, v114, v115
v_cvt_pk_bf16_f32 v22, v128, v129
v_cvt_pk_bf16_f32 v23, v130, v131
v_cvt_pk_bf16_f32 v36, v116, v117
v_cvt_pk_bf16_f32 v37, v118, v119
v_cvt_pk_bf16_f32 v38, v132, v133
v_cvt_pk_bf16_f32 v39, v134, v135
buffer_load_dwordx4 v12, s[56:59], s80 offen offset:1024 sc1 lds
v_cvt_pk_bf16_f32 v52, v120, v121
v_cvt_pk_bf16_f32 v53, v122, v123
v_cvt_pk_bf16_f32 v54, v136, v137
v_cvt_pk_bf16_f32 v55, v138, v139
v_cvt_pk_bf16_f32 v68, v124, v125
v_cvt_pk_bf16_f32 v69, v126, v127
v_cvt_pk_bf16_f32 v70, v140, v141
v_cvt_pk_bf16_f32 v71, v142, v143
v_pk_mul_f32 v[144:145], v[144:145], s[82:83]
v_pk_mul_f32 v[146:147], v[146:147], s[82:83]
v_pk_mul_f32 v[148:149], v[148:149], s[82:83]
v_pk_mul_f32 v[150:151], v[150:151], s[82:83]
v_pk_mul_f32 v[152:153], v[152:153], s[82:83]
v_pk_mul_f32 v[154:155], v[154:155], s[82:83]
v_pk_mul_f32 v[156:157], v[156:157], s[82:83]
buffer_load_dwordx4 v12, s[56:59], s80 offen offset:2048 sc1 lds
v_pk_mul_f32 v[158:159], v[158:159], s[82:83]
v_pk_mul_f32 v[160:161], v[160:161], s[82:83]
v_pk_mul_f32 v[162:163], v[162:163], s[82:83]
v_pk_mul_f32 v[164:165], v[164:165], s[82:83]
v_pk_mul_f32 v[166:167], v[166:167], s[82:83]
v_pk_mul_f32 v[168:169], v[168:169], s[82:83]
v_pk_mul_f32 v[170:171], v[170:171], s[82:83]
v_pk_mul_f32 v[172:173], v[172:173], s[82:83]
v_pk_mul_f32 v[174:175], v[174:175], s[82:83]
v_cvt_pk_bf16_f32 v24, v144, v145
v_cvt_pk_bf16_f32 v25, v146, v147
v_cvt_pk_bf16_f32 v26, v160, v161
v_cvt_pk_bf16_f32 v27, v162, v163
v_cvt_pk_bf16_f32 v40, v148, v149
buffer_load_dwordx4 v12, s[56:59], s80 offen offset:3072 sc1 lds
v_cvt_pk_bf16_f32 v41, v150, v151
v_cvt_pk_bf16_f32 v42, v164, v165
v_cvt_pk_bf16_f32 v43, v166, v167
v_cvt_pk_bf16_f32 v56, v152, v153
v_cvt_pk_bf16_f32 v57, v154, v155
v_cvt_pk_bf16_f32 v58, v168, v169
v_cvt_pk_bf16_f32 v59, v170, v171
v_cvt_pk_bf16_f32 v72, v156, v157
v_cvt_pk_bf16_f32 v73, v158, v159
v_cvt_pk_bf16_f32 v74, v172, v173
v_cvt_pk_bf16_f32 v75, v174, v175
v_pk_mul_f32 v[176:177], v[176:177], s[82:83]
v_pk_mul_f32 v[178:179], v[178:179], s[82:83]
v_pk_mul_f32 v[180:181], v[180:181], s[82:83]
v_pk_mul_f32 v[182:183], v[182:183], s[82:83]
s_add_u32 m0, s68, 49152
v_pk_mul_f32 v[184:185], v[184:185], s[82:83]
v_pk_mul_f32 v[186:187], v[186:187], s[82:83]
v_pk_mul_f32 v[188:189], v[188:189], s[82:83]
v_pk_mul_f32 v[190:191], v[190:191], s[82:83]
v_pk_mul_f32 v[192:193], v[192:193], s[82:83]
v_pk_mul_f32 v[194:195], v[194:195], s[82:83]
v_pk_mul_f32 v[196:197], v[196:197], s[82:83]
v_pk_mul_f32 v[198:199], v[198:199], s[82:83]
v_pk_mul_f32 v[200:201], v[200:201], s[82:83]
v_pk_mul_f32 v[202:203], v[202:203], s[82:83]
v_pk_mul_f32 v[204:205], v[204:205], s[82:83]
v_pk_mul_f32 v[206:207], v[206:207], s[82:83]
v_cvt_pk_bf16_f32 v28, v176, v177
v_cvt_pk_bf16_f32 v29, v178, v179
s_mov_b32 s80, 32768
v_cvt_pk_bf16_f32 v30, v192, v193
v_cvt_pk_bf16_f32 v31, v194, v195
v_cvt_pk_bf16_f32 v44, v180, v181
v_cvt_pk_bf16_f32 v45, v182, v183
v_cvt_pk_bf16_f32 v46, v196, v197
v_cvt_pk_bf16_f32 v47, v198, v199
v_cvt_pk_bf16_f32 v60, v184, v185
v_cvt_pk_bf16_f32 v61, v186, v187
v_cvt_pk_bf16_f32 v62, v200, v201
v_cvt_pk_bf16_f32 v63, v202, v203
v_cvt_pk_bf16_f32 v76, v188, v189
v_cvt_pk_bf16_f32 v77, v190, v191
v_cvt_pk_bf16_f32 v78, v204, v205
v_cvt_pk_bf16_f32 v79, v206, v207
v_mov_b32 v2, 0
buffer_load_dwordx4 v12, s[52:55], s80 offen offset:0 sc1 lds
v_mov_b32 v3, 0
v_mov_b32 v4, 0
v_mov_b32 v5, 0
v_accvgpr_write_b32 a0, 0
v_accvgpr_write_b32 a1, 0
v_accvgpr_write_b32 a2, 0
v_accvgpr_write_b32 a3, 0
v_accvgpr_write_b32 a4, 0
v_accvgpr_write_b32 a5, 0
v_accvgpr_write_b32 a6, 0
v_accvgpr_write_b32 a7, 0
v_accvgpr_write_b32 a8, 0
v_accvgpr_write_b32 a9, 0
v_accvgpr_write_b32 a10, 0
v_accvgpr_write_b32 a11, 0
buffer_load_dwordx4 v12, s[52:55], s80 offen offset:1024 sc1 lds
v_accvgpr_write_b32 a12, 0
v_accvgpr_write_b32 a13, 0
v_accvgpr_write_b32 a14, 0
v_accvgpr_write_b32 a15, 0
v_accvgpr_write_b32 a16, 0
v_accvgpr_write_b32 a17, 0
v_accvgpr_write_b32 a18, 0
v_accvgpr_write_b32 a19, 0
v_accvgpr_write_b32 a20, 0
v_accvgpr_write_b32 a21, 0
v_accvgpr_write_b32 a22, 0
v_accvgpr_write_b32 a23, 0
v_accvgpr_write_b32 a24, 0
v_accvgpr_write_b32 a25, 0
buffer_load_dwordx4 v12, s[52:55], s80 offen offset:2048 sc1 lds
v_accvgpr_write_b32 a26, 0
v_accvgpr_write_b32 a27, 0
v_accvgpr_write_b32 a28, 0
v_accvgpr_write_b32 a29, 0
v_accvgpr_write_b32 a30, 0
v_accvgpr_write_b32 a31, 0
v_accvgpr_write_b32 a32, 0
v_accvgpr_write_b32 a33, 0
v_accvgpr_write_b32 a34, 0
v_accvgpr_write_b32 a35, 0
v_accvgpr_write_b32 a36, 0
v_accvgpr_write_b32 a37, 0
v_accvgpr_write_b32 a38, 0
v_accvgpr_write_b32 a39, 0
v_accvgpr_write_b32 a40, 0
buffer_load_dwordx4 v12, s[52:55], s80 offen offset:3072 sc1 lds
v_accvgpr_write_b32 a41, 0
v_accvgpr_write_b32 a42, 0
v_accvgpr_write_b32 a43, 0
v_accvgpr_write_b32 a44, 0
v_accvgpr_write_b32 a45, 0
v_accvgpr_write_b32 a46, 0
v_accvgpr_write_b32 a47, 0
v_accvgpr_write_b32 a48, 0
v_accvgpr_write_b32 a49, 0
v_accvgpr_write_b32 a50, 0
v_accvgpr_write_b32 a51, 0
v_accvgpr_write_b32 a52, 0
v_accvgpr_write_b32 a53, 0
v_accvgpr_write_b32 a54, 0
s_add_u32 m0, s68, 65536
v_accvgpr_write_b32 a55, 0
v_accvgpr_write_b32 a56, 0
v_accvgpr_write_b32 a57, 0
v_accvgpr_write_b32 a58, 0
v_accvgpr_write_b32 a59, 0
v_accvgpr_write_b32 a60, 0
v_accvgpr_write_b32 a61, 0
v_accvgpr_write_b32 a62, 0
v_accvgpr_write_b32 a63, 0
v_accvgpr_write_b32 a64, 0
v_accvgpr_write_b32 a65, 0
v_accvgpr_write_b32 a66, 0
v_accvgpr_write_b32 a67, 0
v_accvgpr_write_b32 a68, 0
v_accvgpr_write_b32 a69, 0
s_mov_b32 s80, 32768
v_accvgpr_write_b32 a70, 0
v_accvgpr_write_b32 a71, 0
v_accvgpr_write_b32 a72, 0
v_accvgpr_write_b32 a73, 0
v_accvgpr_write_b32 a74, 0
v_accvgpr_write_b32 a75, 0
v_accvgpr_write_b32 a76, 0
v_accvgpr_write_b32 a77, 0
v_accvgpr_write_b32 a78, 0
v_accvgpr_write_b32 a79, 0
v_accvgpr_write_b32 a80, 0
v_accvgpr_write_b32 a81, 0
v_accvgpr_write_b32 a82, 0
v_accvgpr_write_b32 a83, 0
v_accvgpr_write_b32 a84, 0
buffer_load_dwordx4 v12, s[56:59], s80 offen offset:0 sc1 lds
v_accvgpr_write_b32 a85, 0
v_accvgpr_write_b32 a86, 0
v_accvgpr_write_b32 a87, 0
v_accvgpr_write_b32 a88, 0
v_accvgpr_write_b32 a89, 0
v_accvgpr_write_b32 a90, 0
v_accvgpr_write_b32 a91, 0
v_accvgpr_write_b32 a92, 0
v_accvgpr_write_b32 a93, 0
v_accvgpr_write_b32 a94, 0
v_accvgpr_write_b32 a95, 0
v_accvgpr_write_b32 a96, 0
v_accvgpr_write_b32 a97, 0
v_accvgpr_write_b32 a98, 0
buffer_load_dwordx4 v12, s[56:59], s80 offen offset:1024 sc1 lds
v_accvgpr_write_b32 a99, 0
v_accvgpr_write_b32 a100, 0
v_accvgpr_write_b32 a101, 0
v_accvgpr_write_b32 a102, 0
v_accvgpr_write_b32 a103, 0
v_accvgpr_write_b32 a104, 0
v_accvgpr_write_b32 a105, 0
v_accvgpr_write_b32 a106, 0
v_accvgpr_write_b32 a107, 0
v_accvgpr_write_b32 a108, 0
v_accvgpr_write_b32 a109, 0
v_accvgpr_write_b32 a110, 0
v_accvgpr_write_b32 a111, 0
v_accvgpr_write_b32 a112, 0
v_accvgpr_write_b32 a113, 0
buffer_load_dwordx4 v12, s[56:59], s80 offen offset:2048 sc1 lds
v_accvgpr_write_b32 a114, 0
v_accvgpr_write_b32 a115, 0
v_accvgpr_write_b32 a116, 0
v_accvgpr_write_b32 a117, 0
v_accvgpr_write_b32 a118, 0
v_accvgpr_write_b32 a119, 0
v_accvgpr_write_b32 a120, 0
v_accvgpr_write_b32 a121, 0
v_accvgpr_write_b32 a122, 0
v_accvgpr_write_b32 a123, 0
v_accvgpr_write_b32 a124, 0
v_accvgpr_write_b32 a125, 0
v_accvgpr_write_b32 a126, 0
v_accvgpr_write_b32 a127, 0
v_xor_b32 v244, 0x8000, v10
buffer_load_dwordx4 v12, s[56:59], s80 offen offset:3072 sc1 lds
s_waitcnt vmcnt(16)
s_barrier
ds_read_b128 a[128:131], v244 offset:16384
ds_read_b128 a[132:135], v244 offset:17408
ds_read_b128 a[136:139], v244 offset:18432
ds_read_b128 a[140:143], v244 offset:19456
ds_read_b128 a[144:147], v244 offset:20480
ds_read_b128 a[148:151], v244 offset:21504
ds_read_b128 a[152:155], v244 offset:22528
ds_read_b128 a[156:159], v244 offset:23552
ds_read_b128 a[160:163], v244 offset:24576
ds_read_b128 a[164:167], v244 offset:25600
ds_read_b128 a[168:171], v244 offset:26624
ds_read_b128 a[172:175], v244 offset:27648
ds_read_b128 a[176:179], v244 offset:28672
ds_read_b128 a[180:183], v244 offset:29696
ds_read_b128 a[184:187], v244 offset:30720
ds_read_b128 a[188:191], v244 offset:31744
s_waitcnt lgkmcnt(15)
v_mfma_f32_16x16x32_bf16 v[80:83], a[128:131], v[16:19], 0
s_add_u32 m0, s68, 0
v_mfma_f32_16x16x32_bf16 v[88:91], a[128:131], v[32:35], 0
s_mov_b32 s80, 49152
v_mfma_f32_16x16x32_bf16 v[96:99], a[128:131], v[48:51], 0
v_mfma_f32_16x16x32_bf16 v[104:107], a[128:131], v[64:67], 0
buffer_load_dwordx4 v12, s[52:55], s80 offen offset:0 sc1 lds
s_waitcnt lgkmcnt(14)
MV 80,a,132,v,20
MV 88,a,132,v,36
buffer_load_dwordx4 v12, s[52:55], s80 offen offset:1024 sc1 lds
MV 96,a,132,v,52
MV 104,a,132,v,68
buffer_load_dwordx4 v12, s[52:55], s80 offen offset:2048 sc1 lds
s_waitcnt lgkmcnt(13)
MV 80,a,136,v,24
MV 88,a,136,v,40
buffer_load_dwordx4 v12, s[52:55], s80 offen offset:3072 sc1 lds
MV 96,a,136,v,56
MV 104,a,136,v,72
s_add_u32 m0, s68, 81920
s_waitcnt lgkmcnt(12)
MV 80,a,140,v,28
s_mov_b32 s80, 49152
MV 88,a,140,v,44
MV 96,a,140,v,60
buffer_load_dwordx4 v12, s[56:59], s80 offen offset:0 sc1 lds
MV 104,a,140,v,76
s_waitcnt lgkmcnt(11)
v_mfma_f32_16x16x32_bf16 v[84:87], a[144:147], v[16:19], 0
buffer_load_dwordx4 v12, s[56:59], s80 offen offset:1024 sc1 lds
v_mfma_f32_16x16x32_bf16 v[92:95], a[144:147], v[32:35], 0
v_mfma_f32_16x16x32_bf16 v[100:103], a[144:147], v[48:51], 0
buffer_load_dwordx4 v12, s[56:59], s80 offen offset:2048 sc1 lds
v_mfma_f32_16x16x32_bf16 v[108:111], a[144:147], v[64:67], 0
s_waitcnt lgkmcnt(10)
MV 84,a,148,v,20
buffer_load_dwordx4 v12, s[56:59], s80 offen offset:3072 sc1 lds
MV 92,a,148,v,36
MV 100,a,148,v,52
MV 108,a,148,v,68
s_waitcnt lgkmcnt(9)
MV 84,a,152,v,24
s_waitcnt vmcnt(16) lgkmcnt(0)
s_barrier
MV 92,a,152,v,40
ds_read_b128 a[128:131], v10 offset:0
s_add_u32 m0, s68, 16384
MV 100,a,152,v,56
ds_read_b128 a[132:135], v10 offset:1024
s_mov_b32 s80, 65536
MV 108,a,152,v,72
ds_read_b128 a[136:139], v10 offset:2048
buffer_load_dwordx4 v12, s[52:55], s80 offen offset:0 sc1 lds
MV 84,a,156,v,28
ds_read_b128 a[140:143], v10 offset:3072
buffer_load_dwordx4 v12, s[52:55], s80 offen offset:1024 sc1 lds
MV 92,a,156,v,44
ds_read_b128 a[144:147], v10 offset:4096
buffer_load_dwordx4 v12, s[52:55], s80 offen offset:2048 sc1 lds
MV 100,a,156,v,60
ds_read_b128 a[148:151], v10 offset:5120
buffer_load_dwordx4 v12, s[52:55], s80 offen offset:3072 sc1 lds
MV 108,a,156,v,76
ds_read_b128 a[152:155], v10 offset:6144
s_mov_b32 s71, 65536
v_mfma_f32_16x16x32_bf16 v[112:115], a[160:163], v[16:19], 0
ds_read_b128 a[156:159], v10 offset:7168
v_mfma_f32_16x16x32_bf16 v[120:123], a[160:163], v[32:35], 0
v_lshrrev_b32 v245, 4, v1
v_mfma_f32_16x16x32_bf16 v[128:131], a[160:163], v[48:51], 0
v_and_b32 v246, 15, v1
v_mfma_f32_16x16x32_bf16 v[136:139], a[160:163], v[64:67], 0
ds_read_b128 a[160:163], v10 offset:8192
v_lshlrev_b32 v247, 1, v245
MV 112,a,164,v,20
v_xor_b32 v246, v246, v247
MV 120,a,164,v,36
v_lshlrev_b32 v245, 11, v245
MV 128,a,164,v,52
v_lshl_add_u32 v245, v246, 4, v245
MV 136,a,164,v,68
ds_read_b128 a[164:167], v10 offset:9216
v_xor_b32 v246, 128, v245
MV 112,a,168,v,24
MV 120,a,168,v,40
s_lshl_b32 s36, s3, 13
MV 128,a,168,v,56
s_add_u32 m0, s36, 131072
MV 136,a,168,v,72
ds_read_b128 a[168:171], v10 offset:10240
s_mov_b32 s37, 0
MV 112,a,172,v,28
buffer_load_dwordx4 v245, s[32:35], s37 offen offset:0 lds
MV 120,a,172,v,44
s_mov_b32 s37, 7168
MV 128,a,172,v,60
buffer_load_dwordx4 v246, s[32:35], s37 offen offset:1024 lds
MV 136,a,172,v,76
ds_read_b128 a[172:175], v10 offset:11264
v_mfma_f32_16x16x32_bf16 v[116:119], a[176:179], v[16:19], 0
s_mov_b32 s37, 14336
v_mfma_f32_16x16x32_bf16 v[124:127], a[176:179], v[32:35], 0
buffer_load_dwordx4 v245, s[32:35], s37 offen offset:2048 lds
v_mfma_f32_16x16x32_bf16 v[132:135], a[176:179], v[48:51], 0
s_mov_b32 s37, 21504
v_mfma_f32_16x16x32_bf16 v[140:143], a[176:179], v[64:67], 0
ds_read_b128 a[176:179], v10 offset:12288
buffer_load_dwordx4 v246, s[32:35], s37 offen offset:3072 lds
MV 116,a,180,v,20
s_add_u32 m0, s36, 135168
MV 124,a,180,v,36
s_mov_b32 s37, 32768
MV 132,a,180,v,52
buffer_load_dwordx4 v245, s[32:35], s37 offen offset:0 lds
MV 140,a,180,v,68
ds_read_b128 a[180:183], v10 offset:13312
MV 116,a,184,v,24
s_mov_b32 s37, 39936
MV 124,a,184,v,40
buffer_load_dwordx4 v246, s[32:35], s37 offen offset:1024 lds
MV 132,a,184,v,56
s_mov_b32 s37, 47104
MV 140,a,184,v,72
ds_read_b128 a[184:187], v10 offset:14336
buffer_load_dwordx4 v245, s[32:35], s37 offen offset:2048 lds
MV 116,a,188,v,28
s_mov_b32 s37, 54272
MV 124,a,188,v,44
buffer_load_dwordx4 v246, s[32:35], s37 offen offset:3072 lds
MV 132,a,188,v,60
MV 140,a,188,v,76
ds_read_b128 a[188:191], v10 offset:15360
s_cmp_eq_u32 s70, 0
s_cbranch_scc1 L_p3_pmask
L_p3_pmask_ret:
v_exp_f32 v80, v80
v_exp_f32 v81, v81
v_exp_f32 v82, v82
v_add_f32 v2, v2, v80
v_add_f32 v2, v2, v81
v_exp_f32 v83, v83
v_cvt_pk_bf16_f32 v80, v80, v81
v_exp_f32 v84, v84
v_add_f32 v2, v2, v82
v_add_f32 v2, v2, v83
v_exp_f32 v85, v85
v_cvt_pk_bf16_f32 v81, v82, v83
v_exp_f32 v86, v86
v_add_f32 v2, v2, v84
v_add_f32 v2, v2, v85
v_exp_f32 v87, v87
v_cvt_pk_bf16_f32 v82, v84, v85
v_exp_f32 v88, v88
v_add_f32 v2, v2, v86
v_add_f32 v2, v2, v87
v_exp_f32 v89, v89
v_cvt_pk_bf16_f32 v83, v86, v87
v_exp_f32 v90, v90
v_add_f32 v3, v3, v88
v_add_f32 v3, v3, v89
v_exp_f32 v91, v91
v_cvt_pk_bf16_f32 v88, v88, v89
v_exp_f32 v92, v92
v_add_f32 v3, v3, v90
v_add_f32 v3, v3, v91
v_exp_f32 v93, v93
v_cvt_pk_bf16_f32 v89, v90, v91
v_exp_f32 v94, v94
v_add_f32 v3, v3, v92
v_add_f32 v3, v3, v93
v_exp_f32 v95, v95
v_cvt_pk_bf16_f32 v90, v92, v93
v_exp_f32 v96, v96
v_add_f32 v3, v3, v94
v_add_f32 v3, v3, v95
v_exp_f32 v97, v97
v_cvt_pk_bf16_f32 v91, v94, v95
v_exp_f32 v98, v98
v_add_f32 v4, v4, v96
v_add_f32 v4, v4, v97
v_exp_f32 v99, v99
v_cvt_pk_bf16_f32 v96, v96, v97
v_exp_f32 v100, v100
v_add_f32 v4, v4, v98
v_add_f32 v4, v4, v99
v_exp_f32 v101, v101
v_cvt_pk_bf16_f32 v97, v98, v99
v_exp_f32 v102, v102
v_add_f32 v4, v4, v100
v_add_f32 v4, v4, v101
v_exp_f32 v103, v103
v_cvt_pk_bf16_f32 v98, v100, v101
v_exp_f32 v104, v104
v_add_f32 v4, v4, v102
v_add_f32 v4, v4, v103
v_exp_f32 v105, v105
v_cvt_pk_bf16_f32 v99, v102, v103
v_exp_f32 v106, v106
v_add_f32 v5, v5, v104
v_add_f32 v5, v5, v105
v_exp_f32 v107, v107
v_cvt_pk_bf16_f32 v104, v104, v105
v_exp_f32 v108, v108
v_add_f32 v5, v5, v106
v_add_f32 v5, v5, v107
v_exp_f32 v109, v109
v_cvt_pk_bf16_f32 v105, v106, v107
v_exp_f32 v110, v110
v_add_f32 v5, v5, v108
v_add_f32 v5, v5, v109
v_exp_f32 v111, v111
v_cvt_pk_bf16_f32 v106, v108, v109
v_add_f32 v5, v5, v110
v_add_f32 v5, v5, v111
v_cvt_pk_bf16_f32 v107, v110, v111
s_sub_u32 s74, s70, 1
s_cbranch_scc1 L_p3_d0m_top
.p2align 5
L_p3_d0_top:
s_waitcnt lgkmcnt(0)
v_mfma_f32_16x16x32_bf16 v[144:147], a[128:131], v[16:19], 0
s_add_u32 m0, s73, 0
ds_read_b128 a[192:195], v11 offset:16384
v_mfma_f32_16x16x32_bf16 v[152:155], a[128:131], v[32:35], 0
v_exp_f32 v112, v112
v_mfma_f32_16x16x32_bf16 v[148:151], a[144:147], v[16:19], 0
ds_read_b128 a[196:199], v11 offset:17408
buffer_load_dwordx4 v12, s[56:59], s71 offen offset:0 sc1 lds
v_mfma_f32_16x16x32_bf16 v[156:159], a[144:147], v[32:35], 0
v_exp_f32 v113, v113
v_mfma_f32_16x16x32_bf16 v[176:179], a[160:163], v[16:19], 0
v_exp_f32 v114, v114
v_mfma_f32_16x16x32_bf16 v[184:187], a[160:163], v[32:35], 0
v_add_f32 v2, v2, v112
v_add_f32 v2, v2, v113
v_mfma_f32_16x16x32_bf16 v[180:183], a[176:179], v[16:19], 0
v_exp_f32 v115, v115
v_mfma_f32_16x16x32_bf16 v[188:191], a[176:179], v[32:35], 0
ds_read_b128 a[200:203], v11 offset:18432
v_cvt_pk_bf16_f32 v112, v112, v113
v_mfma_f32_16x16x32_bf16 v[196:199], a[176:179], v[48:51], 0
v_exp_f32 v116, v116
v_mfma_f32_16x16x32_bf16 v[204:207], a[176:179], v[64:67], 0
v_add_f32 v2, v2, v114
v_add_f32 v2, v2, v115
v_mfma_f32_16x16x32_bf16 v[192:195], a[160:163], v[48:51], 0
v_exp_f32 v117, v117
v_mfma_f32_16x16x32_bf16 v[200:203], a[160:163], v[64:67], 0
ds_read_b128 a[204:207], v11 offset:19456
v_cvt_pk_bf16_f32 v113, v114, v115
v_mfma_f32_16x16x32_bf16 v[164:167], a[144:147], v[48:51], 0
v_exp_f32 v118, v118
v_mfma_f32_16x16x32_bf16 v[172:175], a[144:147], v[64:67], 0
ds_read_b128 a[208:211], v11 offset:20480
v_add_f32 v2, v2, v116
v_mfma_f32_16x16x32_bf16 v[160:163], a[128:131], v[48:51], 0
buffer_load_dwordx4 v12, s[56:59], s71 offen offset:1024 sc1 lds
v_add_f32 v2, v2, v117
v_mfma_f32_16x16x32_bf16 v[168:171], a[128:131], v[64:67], 0
v_exp_f32 v119, v119
MV 180,a,180,v,20
ds_read_b128 a[212:215], v11 offset:21504
v_cvt_pk_bf16_f32 v114, v116, v117
MV 188,a,180,v,36
v_exp_f32 v120, v120
MV 176,a,164,v,20
v_add_f32 v2, v2, v118
v_add_f32 v2, v2, v119
MV 184,a,164,v,36
v_exp_f32 v121, v121
MV 148,a,148,v,20
ds_read_b128 a[216:219], v11 offset:22528
v_cvt_pk_bf16_f32 v115, v118, v119
MV 156,a,148,v,36
v_exp_f32 v122, v122
MV 144,a,132,v,20
v_add_f32 v3, v3, v120
v_add_f32 v3, v3, v121
MV 152,a,132,v,36
v_exp_f32 v123, v123
MV 160,a,132,v,52
ds_read_b128 a[220:223], v11 offset:23552
v_cvt_pk_bf16_f32 v120, v120, v121
MV 168,a,132,v,68
v_exp_f32 v124, v124
MV 164,a,148,v,52
ds_read_b128 a[224:227], v11 offset:24576
v_add_f32 v3, v3, v122
MV 172,a,148,v,68
buffer_load_dwordx4 v12, s[56:59], s71 offen offset:2048 sc1 lds
v_add_f32 v3, v3, v123
MV 192,a,164,v,52
v_exp_f32 v125, v125
MV 200,a,164,v,68
ds_read_b128 a[228:231], v11 offset:25600
v_cvt_pk_bf16_f32 v121, v122, v123
MV 196,a,180,v,52
v_exp_f32 v126, v126
MV 204,a,180,v,68
v_add_f32 v3, v3, v124
v_add_f32 v3, v3, v125
MV 144,a,136,v,24
v_exp_f32 v127, v127
MV 152,a,136,v,40
ds_read_b128 a[232:235], v11 offset:26624
v_cvt_pk_bf16_f32 v122, v124, v125
MV 148,a,152,v,24
v_exp_f32 v128, v128
MV 156,a,152,v,40
v_add_f32 v3, v3, v126
v_add_f32 v3, v3, v127
MV 176,a,168,v,24
v_exp_f32 v129, v129
MV 184,a,168,v,40
ds_read_b128 a[236:239], v11 offset:27648
v_cvt_pk_bf16_f32 v123, v126, v127
MV 180,a,184,v,24
v_exp_f32 v130, v130
MV 188,a,184,v,40
ds_read_b128 a[240:243], v11 offset:28672
v_add_f32 v4, v4, v128
MV 196,a,184,v,56
buffer_load_dwordx4 v12, s[56:59], s71 offen offset:3072 sc1 lds
v_add_f32 v4, v4, v129
MV 204,a,184,v,72
v_exp_f32 v131, v131
MV 192,a,168,v,56
ds_read_b128 a[244:247], v11 offset:29696
v_cvt_pk_bf16_f32 v128, v128, v129
MV 200,a,168,v,72
v_exp_f32 v132, v132
MV 164,a,152,v,56
v_add_f32 v4, v4, v130
v_add_f32 v4, v4, v131
MV 172,a,152,v,72
v_exp_f32 v133, v133
MV 160,a,136,v,56
ds_read_b128 a[248:251], v11 offset:30720
v_cvt_pk_bf16_f32 v129, v130, v131
MV 168,a,136,v,72
v_exp_f32 v134, v134
MV 180,a,188,v,28
v_add_f32 v4, v4, v132
v_add_f32 v4, v4, v133
MV 188,a,188,v,44
v_exp_f32 v135, v135
MV 176,a,172,v,28
ds_read_b128 a[252:255], v11 offset:31744
v_cvt_pk_bf16_f32 v130, v132, v133
MV 184,a,172,v,44
v_exp_f32 v136, v136
MV 148,a,156,v,28
v_add_f32 v4, v4, v134
v_add_f32 v4, v4, v135
MV 156,a,156,v,44
v_exp_f32 v137, v137
MV 144,a,140,v,28
s_add_u32 s71, s71, 16384
v_cvt_pk_bf16_f32 v131, v134, v135
MV 152,a,140,v,44
v_exp_f32 v138, v138
MV 160,a,140,v,60
v_add_f32 v5, v5, v136
v_add_f32 v5, v5, v137
MV 168,a,140,v,76
v_exp_f32 v139, v139
MV 164,a,156,v,60
v_cvt_pk_bf16_f32 v136, v136, v137
MV 172,a,156,v,76
v_exp_f32 v140, v140
MV 192,a,172,v,60
v_add_f32 v5, v5, v138
v_add_f32 v5, v5, v139
MV 200,a,172,v,76
v_exp_f32 v141, v141
MV 196,a,188,v,60
v_cvt_pk_bf16_f32 v137, v138, v139
MV 204,a,188,v,76
v_exp_f32 v142, v142
v_add_f32 v5, v5, v140
v_add_f32 v5, v5, v141
v_exp_f32 v143, v143
v_cvt_pk_bf16_f32 v138, v140, v141
v_add_f32 v5, v5, v142
v_add_f32 v5, v5, v143
v_cvt_pk_bf16_f32 v139, v142, v143
s_waitcnt vmcnt(16) lgkmcnt(0)
MA 0,a,192,v,80
s_barrier
MA 32,a,192,v,88
s_add_u32 m0, s72, 0
ds_read_b128 a[128:131], v10 offset:16384
MA 4,a,196,v,80
ds_read_b128 a[132:135], v10 offset:17408
buffer_load_dwordx4 v12, s[52:55], s71 offen offset:0 sc1 lds
MA 36,a,196,v,88
v_exp_f32 v144, v144
MA 8,a,200,v,80
v_exp_f32 v145, v145
MA 40,a,200,v,88
v_exp_f32 v146, v146
MA 12,a,204,v,80
v_add_f32 v2, v2, v144
v_add_f32 v2, v2, v145
MA 44,a,204,v,88
ds_read_b128 a[136:139], v10 offset:18432
ds_read_b128 a[140:143], v10 offset:19456
MA 16,a,208,v,80
v_exp_f32 v147, v147
MA 48,a,208,v,88
ds_read_b128 a[144:147], v10 offset:20480
v_cvt_pk_bf16_f32 v144, v144, v145
MA 20,a,212,v,80
v_exp_f32 v148, v148
MA 52,a,212,v,88
v_add_f32 v2, v2, v146
v_add_f32 v2, v2, v147
MA 24,a,216,v,80
v_exp_f32 v149, v149
MA 56,a,216,v,88
buffer_load_dwordx4 v12, s[52:55], s71 offen offset:1024 sc1 lds
v_cvt_pk_bf16_f32 v145, v146, v147
MA 28,a,220,v,80
v_exp_f32 v150, v150
MA 60,a,220,v,88
v_add_f32 v2, v2, v148
v_add_f32 v2, v2, v149
MA 92,a,220,v,96
v_exp_f32 v151, v151
MA 124,a,220,v,104
ds_read_b128 a[148:151], v10 offset:21504
v_cvt_pk_bf16_f32 v146, v148, v149
MA 88,a,216,v,96
v_exp_f32 v152, v152
MA 120,a,216,v,104
v_add_f32 v2, v2, v150
v_add_f32 v2, v2, v151
MA 84,a,212,v,96
ds_read_b128 a[152:155], v10 offset:22528
ds_read_b128 a[156:159], v10 offset:23552
MA 116,a,212,v,104
v_exp_f32 v153, v153
MA 80,a,208,v,96
ds_read_b128 a[160:163], v10 offset:24576
v_cvt_pk_bf16_f32 v147, v150, v151
MA 112,a,208,v,104
v_exp_f32 v154, v154
MA 76,a,204,v,96
v_add_f32 v3, v3, v152
v_add_f32 v3, v3, v153
MA 108,a,204,v,104
v_exp_f32 v155, v155
MA 72,a,200,v,96
buffer_load_dwordx4 v12, s[52:55], s71 offen offset:2048 sc1 lds
v_cvt_pk_bf16_f32 v152, v152, v153
MA 104,a,200,v,104
v_exp_f32 v156, v156
MA 68,a,196,v,96
v_add_f32 v3, v3, v154
v_add_f32 v3, v3, v155
MA 100,a,196,v,104
v_exp_f32 v157, v157
MA 64,a,192,v,96
ds_read_b128 a[164:167], v10 offset:25600
v_cvt_pk_bf16_f32 v153, v154, v155
MA 96,a,192,v,104
v_exp_f32 v158, v158
MA 0,a,224,v,112
v_add_f32 v3, v3, v156
v_add_f32 v3, v3, v157
MA 32,a,224,v,120
v_exp_f32 v159, v159
MA 4,a,228,v,112
ds_read_b128 a[168:171], v10 offset:26624
v_cvt_pk_bf16_f32 v154, v156, v157
MA 36,a,228,v,120
v_exp_f32 v160, v160
MA 8,a,232,v,112
ds_read_b128 a[172:175], v10 offset:27648
v_add_f32 v3, v3, v158
MA 40,a,232,v,120
ds_read_b128 a[176:179], v10 offset:28672
v_add_f32 v3, v3, v159
MA 12,a,236,v,112
v_exp_f32 v161, v161
MA 44,a,236,v,120
ds_read_b128 a[180:183], v10 offset:29696
v_cvt_pk_bf16_f32 v155, v158, v159
MA 16,a,240,v,112
v_exp_f32 v162, v162
MA 48,a,240,v,120
v_add_f32 v4, v4, v160
v_add_f32 v4, v4, v161
MA 20,a,244,v,112
v_exp_f32 v163, v163
MA 52,a,244,v,120
buffer_load_dwordx4 v12, s[52:55], s71 offen offset:3072 sc1 lds
v_cvt_pk_bf16_f32 v160, v160, v161
MA 24,a,248,v,112
v_exp_f32 v164, v164
MA 56,a,248,v,120
v_add_f32 v4, v4, v162
v_add_f32 v4, v4, v163
MA 28,a,252,v,112
v_exp_f32 v165, v165
MA 60,a,252,v,120
ds_read_b128 a[184:187], v10 offset:30720
v_cvt_pk_bf16_f32 v161, v162, v163
MA 92,a,252,v,128
v_exp_f32 v166, v166
MA 124,a,252,v,136
v_add_f32 v4, v4, v164
v_add_f32 v4, v4, v165
MA 88,a,248,v,128
ds_read_b128 a[188:191], v10 offset:31744
s_sub_u32 s74, s74, 1
MA 120,a,248,v,136
v_exp_f32 v167, v167
MA 84,a,244,v,128
v_cvt_pk_bf16_f32 v162, v164, v165
MA 116,a,244,v,136
v_exp_f32 v168, v168
MA 80,a,240,v,128
v_add_f32 v4, v4, v166
v_add_f32 v4, v4, v167
MA 112,a,240,v,136
v_exp_f32 v169, v169
MA 76,a,236,v,128
v_cvt_pk_bf16_f32 v163, v166, v167
MA 108,a,236,v,136
v_exp_f32 v170, v170
MA 72,a,232,v,128
v_add_f32 v5, v5, v168
v_add_f32 v5, v5, v169
MA 104,a,232,v,136
v_exp_f32 v171, v171
MA 68,a,228,v,128
v_cvt_pk_bf16_f32 v168, v168, v169
MA 100,a,228,v,136
v_exp_f32 v172, v172
MA 64,a,224,v,128
v_add_f32 v5, v5, v170
v_add_f32 v5, v5, v171
MA 96,a,224,v,136
v_exp_f32 v173, v173
v_cvt_pk_bf16_f32 v169, v170, v171
v_exp_f32 v174, v174
v_add_f32 v5, v5, v172
v_add_f32 v5, v5, v173
v_exp_f32 v175, v175
v_cvt_pk_bf16_f32 v170, v172, v173
v_add_f32 v5, v5, v174
v_add_f32 v5, v5, v175
v_cvt_pk_bf16_f32 v171, v174, v175
s_cbranch_scc1 L_p3_d1m_top
s_waitcnt lgkmcnt(0)
v_xor_b32 v11, 0x8000, v11
v_mfma_f32_16x16x32_bf16 v[80:83], a[128:131], v[16:19], 0
s_add_u32 m0, s73, 16384
ds_read_b128 a[192:195], v11 offset:0
v_mfma_f32_16x16x32_bf16 v[88:91], a[128:131], v[32:35], 0
v_exp_f32 v176, v176
v_mfma_f32_16x16x32_bf16 v[84:87], a[144:147], v[16:19], 0
ds_read_b128 a[196:199], v11 offset:1024
buffer_load_dwordx4 v12, s[56:59], s71 offen offset:0 sc1 lds
v_mfma_f32_16x16x32_bf16 v[92:95], a[144:147], v[32:35], 0
v_exp_f32 v177, v177
v_mfma_f32_16x16x32_bf16 v[112:115], a[160:163], v[16:19], 0
v_exp_f32 v178, v178
v_mfma_f32_16x16x32_bf16 v[120:123], a[160:163], v[32:35], 0
v_add_f32 v2, v2, v176
v_add_f32 v2, v2, v177
v_mfma_f32_16x16x32_bf16 v[116:119], a[176:179], v[16:19], 0
v_exp_f32 v179, v179
v_mfma_f32_16x16x32_bf16 v[124:127], a[176:179], v[32:35], 0
ds_read_b128 a[200:203], v11 offset:2048
v_cvt_pk_bf16_f32 v176, v176, v177
v_mfma_f32_16x16x32_bf16 v[132:135], a[176:179], v[48:51], 0
v_exp_f32 v180, v180
v_mfma_f32_16x16x32_bf16 v[140:143], a[176:179], v[64:67], 0
v_add_f32 v2, v2, v178
v_add_f32 v2, v2, v179
v_mfma_f32_16x16x32_bf16 v[128:131], a[160:163], v[48:51], 0
v_exp_f32 v181, v181
v_mfma_f32_16x16x32_bf16 v[136:139], a[160:163], v[64:67], 0
ds_read_b128 a[204:207], v11 offset:3072
v_cvt_pk_bf16_f32 v177, v178, v179
v_mfma_f32_16x16x32_bf16 v[100:103], a[144:147], v[48:51], 0
v_exp_f32 v182, v182
v_mfma_f32_16x16x32_bf16 v[108:111], a[144:147], v[64:67], 0
buffer_load_dwordx4 v12, s[56:59], s71 offen offset:1024 sc1 lds
v_add_f32 v2, v2, v180
v_mfma_f32_16x16x32_bf16 v[96:99], a[128:131], v[48:51], 0
ds_read_b128 a[208:211], v11 offset:4096
v_add_f32 v2, v2, v181
v_mfma_f32_16x16x32_bf16 v[104:107], a[128:131], v[64:67], 0
v_exp_f32 v183, v183
MV 116,a,180,v,20
ds_read_b128 a[212:215], v11 offset:5120
v_cvt_pk_bf16_f32 v178, v180, v181
MV 124,a,180,v,36
v_exp_f32 v184, v184
MV 112,a,164,v,20
v_add_f32 v2, v2, v182
v_add_f32 v2, v2, v183
MV 120,a,164,v,36
v_exp_f32 v185, v185
MV 84,a,148,v,20
ds_read_b128 a[216:219], v11 offset:6144
v_cvt_pk_bf16_f32 v179, v182, v183
MV 92,a,148,v,36
v_exp_f32 v186, v186
MV 80,a,132,v,20
v_add_f32 v3, v3, v184
v_add_f32 v3, v3, v185
MV 88,a,132,v,36
v_exp_f32 v187, v187
MV 96,a,132,v,52
ds_read_b128 a[220:223], v11 offset:7168
v_cvt_pk_bf16_f32 v184, v184, v185
MV 104,a,132,v,68
ds_read_b128 a[224:227], v11 offset:8192
buffer_load_dwordx4 v12, s[56:59], s71 offen offset:2048 sc1 lds
MV 100,a,148,v,52
v_exp_f32 v188, v188
MV 108,a,148,v,68
v_add_f32 v3, v3, v186
v_add_f32 v3, v3, v187
MV 128,a,164,v,52
v_exp_f32 v189, v189
MV 136,a,164,v,68
ds_read_b128 a[228:231], v11 offset:9216
v_cvt_pk_bf16_f32 v185, v186, v187
MV 132,a,180,v,52
v_exp_f32 v190, v190
MV 140,a,180,v,68
v_add_f32 v3, v3, v188
v_add_f32 v3, v3, v189
MV 80,a,136,v,24
v_exp_f32 v191, v191
MV 88,a,136,v,40
ds_read_b128 a[232:235], v11 offset:10240
v_cvt_pk_bf16_f32 v186, v188, v189
MV 84,a,152,v,24
v_exp_f32 v192, v192
MV 92,a,152,v,40
buffer_load_dwordx4 v12, s[56:59], s71 offen offset:3072 sc1 lds
v_add_f32 v3, v3, v190
MV 112,a,168,v,24
ds_read_b128 a[236:239], v11 offset:11264
v_add_f32 v3, v3, v191
MV 120,a,168,v,40
v_exp_f32 v193, v193
MV 116,a,184,v,24
ds_read_b128 a[240:243], v11 offset:12288
v_cvt_pk_bf16_f32 v187, v190, v191
MV 124,a,184,v,40
v_exp_f32 v194, v194
MV 132,a,184,v,56
v_add_f32 v4, v4, v192
v_add_f32 v4, v4, v193
MV 140,a,184,v,72
v_exp_f32 v195, v195
MV 128,a,168,v,56
ds_read_b128 a[244:247], v11 offset:13312
v_cvt_pk_bf16_f32 v192, v192, v193
MV 136,a,168,v,72
v_exp_f32 v196, v196
MV 100,a,152,v,56
v_add_f32 v4, v4, v194
v_add_f32 v4, v4, v195
MV 108,a,152,v,72
v_exp_f32 v197, v197
MV 96,a,136,v,56
ds_read_b128 a[248:251], v11 offset:14336
v_cvt_pk_bf16_f32 v193, v194, v195
MV 104,a,136,v,72
v_exp_f32 v198, v198
MV 116,a,188,v,28
s_add_u32 s71, s71, 16384
v_add_f32 v4, v4, v196
MV 124,a,188,v,44
ds_read_b128 a[252:255], v11 offset:15360
v_add_f32 v4, v4, v197
MV 112,a,172,v,28
v_exp_f32 v199, v199
MV 120,a,172,v,44
s_xor_b32 s73, s73, 0x8000
v_cvt_pk_bf16_f32 v194, v196, v197
MV 84,a,156,v,28
v_exp_f32 v200, v200
MV 92,a,156,v,44
v_add_f32 v4, v4, v198
v_add_f32 v4, v4, v199
MV 80,a,140,v,28
v_exp_f32 v201, v201
MV 88,a,140,v,44
v_cvt_pk_bf16_f32 v195, v198, v199
MV 96,a,140,v,60
v_exp_f32 v202, v202
MV 104,a,140,v,76
v_add_f32 v5, v5, v200
v_add_f32 v5, v5, v201
MV 100,a,156,v,60
v_exp_f32 v203, v203
MV 108,a,156,v,76
v_cvt_pk_bf16_f32 v200, v200, v201
MV 128,a,172,v,60
v_exp_f32 v204, v204
MV 136,a,172,v,76
v_add_f32 v5, v5, v202
v_add_f32 v5, v5, v203
MV 132,a,188,v,60
v_exp_f32 v205, v205
MV 140,a,188,v,76
v_cvt_pk_bf16_f32 v201, v202, v203
v_exp_f32 v206, v206
v_add_f32 v5, v5, v204
v_add_f32 v5, v5, v205
v_exp_f32 v207, v207
v_cvt_pk_bf16_f32 v202, v204, v205
v_add_f32 v5, v5, v206
v_add_f32 v5, v5, v207
v_cvt_pk_bf16_f32 v203, v206, v207
s_waitcnt vmcnt(16) lgkmcnt(0)
MA 0,a,192,v,144
s_barrier
v_xor_b32 v10, 0x8000, v10
MA 32,a,192,v,152
s_add_u32 m0, s72, 16384
ds_read_b128 a[128:131], v10 offset:0
MA 4,a,196,v,144
ds_read_b128 a[132:135], v10 offset:1024
buffer_load_dwordx4 v12, s[52:55], s71 offen offset:0 sc1 lds
MA 36,a,196,v,152
v_exp_f32 v80, v80
MA 8,a,200,v,144
v_exp_f32 v81, v81
MA 40,a,200,v,152
v_exp_f32 v82, v82
MA 12,a,204,v,144
v_add_f32 v2, v2, v80
v_add_f32 v2, v2, v81
MA 44,a,204,v,152
ds_read_b128 a[136:139], v10 offset:2048
ds_read_b128 a[140:143], v10 offset:3072
MA 16,a,208,v,144
v_exp_f32 v83, v83
MA 48,a,208,v,152
ds_read_b128 a[144:147], v10 offset:4096
v_cvt_pk_bf16_f32 v80, v80, v81
MA 20,a,212,v,144
v_exp_f32 v84, v84
MA 52,a,212,v,152
v_add_f32 v2, v2, v82
v_add_f32 v2, v2, v83
MA 24,a,216,v,144
v_exp_f32 v85, v85
MA 56,a,216,v,152
buffer_load_dwordx4 v12, s[52:55], s71 offen offset:1024 sc1 lds
v_cvt_pk_bf16_f32 v81, v82, v83
MA 28,a,220,v,144
v_exp_f32 v86, v86
MA 60,a,220,v,152
v_add_f32 v2, v2, v84
v_add_f32 v2, v2, v85
MA 92,a,220,v,160
v_exp_f32 v87, v87
MA 124,a,220,v,168
ds_read_b128 a[148:151], v10 offset:5120
v_cvt_pk_bf16_f32 v82, v84, v85
MA 88,a,216,v,160
v_exp_f32 v88, v88
MA 120,a,216,v,168
v_add_f32 v2, v2, v86
v_add_f32 v2, v2, v87
MA 84,a,212,v,160
ds_read_b128 a[152:155], v10 offset:6144
ds_read_b128 a[156:159], v10 offset:7168
MA 116,a,212,v,168
v_exp_f32 v89, v89
MA 80,a,208,v,160
ds_read_b128 a[160:163], v10 offset:8192
v_cvt_pk_bf16_f32 v83, v86, v87
MA 112,a,208,v,168
v_exp_f32 v90, v90
MA 76,a,204,v,160
v_add_f32 v3, v3, v88
v_add_f32 v3, v3, v89
MA 108,a,204,v,168
v_exp_f32 v91, v91
MA 72,a,200,v,160
buffer_load_dwordx4 v12, s[52:55], s71 offen offset:2048 sc1 lds
v_cvt_pk_bf16_f32 v88, v88, v89
MA 104,a,200,v,168
v_exp_f32 v92, v92
MA 68,a,196,v,160
v_add_f32 v3, v3, v90
v_add_f32 v3, v3, v91
MA 100,a,196,v,168
v_exp_f32 v93, v93
MA 64,a,192,v,160
ds_read_b128 a[164:167], v10 offset:9216
v_cvt_pk_bf16_f32 v89, v90, v91
MA 96,a,192,v,168
v_exp_f32 v94, v94
MA 0,a,224,v,176
v_add_f32 v3, v3, v92
v_add_f32 v3, v3, v93
MA 32,a,224,v,184
v_exp_f32 v95, v95
MA 4,a,228,v,176
ds_read_b128 a[168:171], v10 offset:10240
v_cvt_pk_bf16_f32 v90, v92, v93
MA 36,a,228,v,184
v_exp_f32 v96, v96
MA 8,a,232,v,176
ds_read_b128 a[172:175], v10 offset:11264
v_add_f32 v3, v3, v94
MA 40,a,232,v,184
ds_read_b128 a[176:179], v10 offset:12288
v_add_f32 v3, v3, v95
MA 12,a,236,v,176
v_exp_f32 v97, v97
MA 44,a,236,v,184
ds_read_b128 a[180:183], v10 offset:13312
v_cvt_pk_bf16_f32 v91, v94, v95
MA 16,a,240,v,176
v_exp_f32 v98, v98
MA 48,a,240,v,184
v_add_f32 v4, v4, v96
v_add_f32 v4, v4, v97
MA 20,a,244,v,176
v_exp_f32 v99, v99
MA 52,a,244,v,184
buffer_load_dwordx4 v12, s[52:55], s71 offen offset:3072 sc1 lds
v_cvt_pk_bf16_f32 v96, v96, v97
MA 24,a,248,v,176
v_exp_f32 v100, v100
MA 56,a,248,v,184
v_add_f32 v4, v4, v98
v_add_f32 v4, v4, v99
MA 28,a,252,v,176
v_exp_f32 v101, v101
MA 60,a,252,v,184
ds_read_b128 a[184:187], v10 offset:14336
v_cvt_pk_bf16_f32 v97, v98, v99
MA 92,a,252,v,192
v_exp_f32 v102, v102
MA 124,a,252,v,200
v_add_f32 v4, v4, v100
v_add_f32 v4, v4, v101
MA 88,a,248,v,192
ds_read_b128 a[188:191], v10 offset:15360
s_xor_b32 s72, s72, 0x8000
MA 120,a,248,v,200
v_exp_f32 v103, v103
MA 84,a,244,v,192
v_cvt_pk_bf16_f32 v98, v100, v101
MA 116,a,244,v,200
v_exp_f32 v104, v104
MA 80,a,240,v,192
v_add_f32 v4, v4, v102
v_add_f32 v4, v4, v103
MA 112,a,240,v,200
v_exp_f32 v105, v105
MA 76,a,236,v,192
v_cvt_pk_bf16_f32 v99, v102, v103
MA 108,a,236,v,200
v_exp_f32 v106, v106
MA 72,a,232,v,192
v_add_f32 v5, v5, v104
v_add_f32 v5, v5, v105
MA 104,a,232,v,200
v_exp_f32 v107, v107
MA 68,a,228,v,192
v_cvt_pk_bf16_f32 v104, v104, v105
MA 100,a,228,v,200
v_exp_f32 v108, v108
MA 64,a,224,v,192
v_add_f32 v5, v5, v106
v_add_f32 v5, v5, v107
MA 96,a,224,v,200
v_exp_f32 v109, v109
v_cvt_pk_bf16_f32 v105, v106, v107
v_exp_f32 v110, v110
v_add_f32 v5, v5, v108
v_add_f32 v5, v5, v109
v_exp_f32 v111, v111
v_cvt_pk_bf16_f32 v106, v108, v109
v_add_f32 v5, v5, v110
v_add_f32 v5, v5, v111
v_cvt_pk_bf16_f32 v107, v110, v111
s_branch L_p3_d0_top
L_p3_d1m_top:
s_waitcnt lgkmcnt(0)
v_xor_b32 v11, 0x8000, v11
v_mfma_f32_16x16x32_bf16 v[80:83], a[128:131], v[16:19], 0
s_add_u32 m0, s73, 16384
ds_read_b128 a[192:195], v11 offset:0
v_mfma_f32_16x16x32_bf16 v[88:91], a[128:131], v[32:35], 0
v_exp_f32 v176, v176
v_mfma_f32_16x16x32_bf16 v[96:99], a[128:131], v[48:51], 0
ds_read_b128 a[196:199], v11 offset:1024
buffer_load_dwordx4 v12, s[56:59], s71 offen offset:0 sc1 lds
v_mfma_f32_16x16x32_bf16 v[104:107], a[128:131], v[64:67], 0
v_exp_f32 v177, v177
MV 80,a,132,v,20
v_exp_f32 v178, v178
MV 88,a,132,v,36
v_add_f32 v2, v2, v176
v_add_f32 v2, v2, v177
MV 96,a,132,v,52
v_exp_f32 v179, v179
MV 104,a,132,v,68
ds_read_b128 a[200:203], v11 offset:2048
v_cvt_pk_bf16_f32 v176, v176, v177
MV 80,a,136,v,24
v_exp_f32 v180, v180
MV 88,a,136,v,40
v_add_f32 v2, v2, v178
v_add_f32 v2, v2, v179
MV 96,a,136,v,56
v_exp_f32 v181, v181
MV 104,a,136,v,72
ds_read_b128 a[204:207], v11 offset:3072
v_cvt_pk_bf16_f32 v177, v178, v179
MV 80,a,140,v,28
v_exp_f32 v182, v182
MV 88,a,140,v,44
buffer_load_dwordx4 v12, s[56:59], s71 offen offset:1024 sc1 lds
v_add_f32 v2, v2, v180
MV 96,a,140,v,60
ds_read_b128 a[208:211], v11 offset:4096
v_add_f32 v2, v2, v181
MV 104,a,140,v,76
v_exp_f32 v183, v183
v_mfma_f32_16x16x32_bf16 v[84:87], a[144:147], v[16:19], 0
ds_read_b128 a[212:215], v11 offset:5120
v_cvt_pk_bf16_f32 v178, v180, v181
v_mfma_f32_16x16x32_bf16 v[92:95], a[144:147], v[32:35], 0
v_exp_f32 v184, v184
v_mfma_f32_16x16x32_bf16 v[100:103], a[144:147], v[48:51], 0
v_add_f32 v2, v2, v182
v_add_f32 v2, v2, v183
v_mfma_f32_16x16x32_bf16 v[108:111], a[144:147], v[64:67], 0
v_exp_f32 v185, v185
MV 84,a,148,v,20
ds_read_b128 a[216:219], v11 offset:6144
v_cvt_pk_bf16_f32 v179, v182, v183
MV 92,a,148,v,36
v_exp_f32 v186, v186
MV 100,a,148,v,52
v_add_f32 v3, v3, v184
v_add_f32 v3, v3, v185
MV 108,a,148,v,68
v_exp_f32 v187, v187
MV 84,a,152,v,24
ds_read_b128 a[220:223], v11 offset:7168
v_cvt_pk_bf16_f32 v184, v184, v185
MV 92,a,152,v,40
ds_read_b128 a[224:227], v11 offset:8192
buffer_load_dwordx4 v12, s[56:59], s71 offen offset:2048 sc1 lds
MV 100,a,152,v,56
v_exp_f32 v188, v188
MV 108,a,152,v,72
v_add_f32 v3, v3, v186
v_add_f32 v3, v3, v187
MV 84,a,156,v,28
v_exp_f32 v189, v189
MV 92,a,156,v,44
ds_read_b128 a[228:231], v11 offset:9216
v_cvt_pk_bf16_f32 v185, v186, v187
MV 100,a,156,v,60
v_exp_f32 v190, v190
MV 108,a,156,v,76
v_add_f32 v3, v3, v188
v_add_f32 v3, v3, v189
v_mfma_f32_16x16x32_bf16 v[112:115], a[160:163], v[16:19], 0
v_exp_f32 v191, v191
v_mfma_f32_16x16x32_bf16 v[120:123], a[160:163], v[32:35], 0
ds_read_b128 a[232:235], v11 offset:10240
v_cvt_pk_bf16_f32 v186, v188, v189
v_mfma_f32_16x16x32_bf16 v[128:131], a[160:163], v[48:51], 0
v_exp_f32 v192, v192
v_mfma_f32_16x16x32_bf16 v[136:139], a[160:163], v[64:67], 0
buffer_load_dwordx4 v12, s[56:59], s71 offen offset:3072 sc1 lds
v_add_f32 v3, v3, v190
MV 112,a,164,v,20
ds_read_b128 a[236:239], v11 offset:11264
v_add_f32 v3, v3, v191
MV 120,a,164,v,36
v_exp_f32 v193, v193
MV 128,a,164,v,52
ds_read_b128 a[240:243], v11 offset:12288
v_cvt_pk_bf16_f32 v187, v190, v191
MV 136,a,164,v,68
v_exp_f32 v194, v194
MV 112,a,168,v,24
v_add_f32 v4, v4, v192
v_add_f32 v4, v4, v193
MV 120,a,168,v,40
v_exp_f32 v195, v195
MV 128,a,168,v,56
v_cvt_pk_bf16_f32 v192, v192, v193
v_add_u32 v246, 0, v13
MV 136,a,168,v,72
v_exp_f32 v196, v196
MV 112,a,172,v,28
ds_read_b128 a[244:247], v11 offset:13312
v_add_f32 v4, v4, v194
MV 120,a,172,v,44
v_add_f32 v4, v4, v195
v_cmp_gt_i32_e64 s[84:85], 0, v246
MV 128,a,172,v,60
ds_read_b128 a[248:251], v11 offset:14336
v_cmp_gt_i32_e64 s[86:87], 1, v246
MV 136,a,172,v,76
v_exp_f32 v197, v197
v_mfma_f32_16x16x32_bf16 v[116:119], a[176:179], v[16:19], 0
v_cvt_pk_bf16_f32 v193, v194, v195
v_cmp_gt_i32_e64 s[88:89], 2, v246
v_mfma_f32_16x16x32_bf16 v[124:127], a[176:179], v[32:35], 0
v_exp_f32 v198, v198
v_mfma_f32_16x16x32_bf16 v[132:135], a[176:179], v[48:51], 0
s_add_u32 s71, s71, 16384
v_add_f32 v4, v4, v196
v_mfma_f32_16x16x32_bf16 v[140:143], a[176:179], v[64:67], 0
v_add_f32 v4, v4, v197
v_cmp_gt_i32_e64 s[90:91], 3, v246
MV 116,a,180,v,20
v_exp_f32 v199, v199
MV 124,a,180,v,36
ds_read_b128 a[252:255], v11 offset:15360
v_cvt_pk_bf16_f32 v194, v196, v197
MV 132,a,180,v,52
v_cndmask_b32_e64 v96, v96, v14, s[84:85]
v_cndmask_b32_e64 v97, v97, v14, s[86:87]
MV 140,a,180,v,68
v_exp_f32 v200, v200
MV 116,a,184,v,24
v_add_f32 v4, v4, v198
v_add_f32 v4, v4, v199
MV 124,a,184,v,40
v_cndmask_b32_e64 v98, v98, v14, s[88:89]
v_cndmask_b32_e64 v99, v99, v14, s[90:91]
MV 132,a,184,v,56
v_exp_f32 v201, v201
MV 140,a,184,v,72
v_cvt_pk_bf16_f32 v195, v198, v199
v_add_u32 v247, -16, v13
MV 116,a,188,v,28
v_exp_f32 v202, v202
MV 124,a,188,v,44
v_add_f32 v5, v5, v200
v_add_f32 v5, v5, v201
MV 132,a,188,v,60
s_xor_b32 s73, s73, 0x8000
v_cmp_gt_i32_e64 s[92:93], 0, v247
MV 140,a,188,v,76
v_exp_f32 v203, v203
v_cvt_pk_bf16_f32 v200, v200, v201
v_cmp_gt_i32_e64 s[94:95], 1, v247
v_exp_f32 v204, v204
v_add_f32 v5, v5, v202
v_cmp_gt_i32_e64 s[96:97], 2, v247
v_add_f32 v5, v5, v203
v_exp_f32 v205, v205
v_cmp_gt_i32_e64 s[98:99], 3, v247
v_cvt_pk_bf16_f32 v201, v202, v203
v_exp_f32 v206, v206
v_cndmask_b32_e64 v100, v100, v14, s[92:93]
v_add_f32 v5, v5, v204
v_cndmask_b32_e64 v101, v101, v14, s[94:95]
v_add_f32 v5, v5, v205
v_exp_f32 v207, v207
v_cvt_pk_bf16_f32 v202, v204, v205
v_cndmask_b32_e64 v102, v102, v14, s[96:97]
v_add_f32 v5, v5, v206
v_add_f32 v5, v5, v207
v_cndmask_b32_e64 v103, v103, v14, s[98:99]
v_cvt_pk_bf16_f32 v203, v206, v207
s_waitcnt vmcnt(16) lgkmcnt(0)
MA 0,a,192,v,144
s_barrier
v_xor_b32 v10, 0x8000, v10
MA 32,a,192,v,152
s_add_u32 m0, s72, 16384
ds_read_b128 a[128:131], v10 offset:0
MA 4,a,196,v,144
ds_read_b128 a[132:135], v10 offset:1024
buffer_load_dwordx4 v12, s[52:55], s71 offen offset:0 sc1 lds
MA 36,a,196,v,152
v_exp_f32 v80, v80
MA 8,a,200,v,144
v_exp_f32 v81, v81
MA 40,a,200,v,152
v_exp_f32 v82, v82
MA 12,a,204,v,144
v_add_f32 v2, v2, v80
v_add_f32 v2, v2, v81
MA 44,a,204,v,152
ds_read_b128 a[136:139], v10 offset:2048
v_add_u32 v246, -32, v13
MA 16,a,208,v,144
v_exp_f32 v83, v83
MA 48,a,208,v,152
ds_read_b128 a[140:143], v10 offset:3072
v_cvt_pk_bf16_f32 v80, v80, v81
MA 20,a,212,v,144
v_exp_f32 v84, v84
MA 52,a,212,v,152
v_add_f32 v2, v2, v82
v_add_f32 v2, v2, v83
MA 24,a,216,v,144
ds_read_b128 a[144:147], v10 offset:4096
v_cmp_gt_i32_e64 s[84:85], 0, v246
MA 56,a,216,v,152
v_exp_f32 v85, v85
MA 28,a,220,v,144
v_cvt_pk_bf16_f32 v81, v82, v83
v_cmp_gt_i32_e64 s[86:87], 1, v246
MA 60,a,220,v,152
v_exp_f32 v86, v86
MA 92,a,220,v,160
v_add_f32 v2, v2, v84
v_add_f32 v2, v2, v85
MA 124,a,220,v,168
ds_read_b128 a[148:151], v10 offset:5120
buffer_load_dwordx4 v12, s[52:55], s71 offen offset:1024 sc1 lds
MA 88,a,216,v,160
v_exp_f32 v87, v87
MA 120,a,216,v,168
v_cvt_pk_bf16_f32 v82, v84, v85
v_cmp_gt_i32_e64 s[88:89], 2, v246
MA 84,a,212,v,160
v_exp_f32 v88, v88
MA 116,a,212,v,168
v_add_f32 v2, v2, v86
v_add_f32 v2, v2, v87
MA 80,a,208,v,160
ds_read_b128 a[152:155], v10 offset:6144
v_cmp_gt_i32_e64 s[90:91], 3, v246
MA 112,a,208,v,168
v_exp_f32 v89, v89
MA 76,a,204,v,160
ds_read_b128 a[156:159], v10 offset:7168
v_cvt_pk_bf16_f32 v83, v86, v87
MA 108,a,204,v,168
v_exp_f32 v90, v90
MA 72,a,200,v,160
v_add_f32 v3, v3, v88
v_add_f32 v3, v3, v89
MA 104,a,200,v,168
v_exp_f32 v91, v91
MA 68,a,196,v,160
v_cvt_pk_bf16_f32 v88, v88, v89
v_cndmask_b32_e64 v128, v128, v14, s[84:85]
MA 100,a,196,v,168
v_exp_f32 v92, v92
MA 64,a,192,v,160
ds_read_b128 a[160:163], v10 offset:8192
v_add_f32 v3, v3, v90
MA 96,a,192,v,168
v_add_f32 v3, v3, v91
v_cndmask_b32_e64 v129, v129, v14, s[86:87]
MA 0,a,224,v,176
v_exp_f32 v93, v93
MA 32,a,224,v,184
buffer_load_dwordx4 v12, s[52:55], s71 offen offset:2048 sc1 lds
v_cvt_pk_bf16_f32 v89, v90, v91
MA 4,a,228,v,176
ds_read_b128 a[164:167], v10 offset:9216
v_cndmask_b32_e64 v130, v130, v14, s[88:89]
MA 36,a,228,v,184
v_exp_f32 v94, v94
MA 8,a,232,v,176
v_add_f32 v3, v3, v92
v_add_f32 v3, v3, v93
MA 40,a,232,v,184
v_exp_f32 v95, v95
MA 12,a,236,v,176
ds_read_b128 a[168:171], v10 offset:10240
v_cvt_pk_bf16_f32 v90, v92, v93
MA 44,a,236,v,184
ds_read_b128 a[172:175], v10 offset:11264
v_cndmask_b32_e64 v131, v131, v14, s[90:91]
MA 16,a,240,v,176
v_exp_f32 v96, v96
MA 48,a,240,v,184
v_add_f32 v3, v3, v94
v_add_f32 v3, v3, v95
MA 20,a,244,v,176
v_exp_f32 v97, v97
MA 52,a,244,v,184
v_cvt_pk_bf16_f32 v91, v94, v95
v_add_u32 v247, -48, v13
MA 24,a,248,v,176
v_exp_f32 v98, v98
MA 56,a,248,v,184
ds_read_b128 a[176:179], v10 offset:12288
v_add_f32 v4, v4, v96
MA 28,a,252,v,176
v_add_f32 v4, v4, v97
v_cmp_gt_i32_e64 s[92:93], 0, v247
MA 60,a,252,v,184
v_exp_f32 v99, v99
MA 92,a,252,v,192
ds_read_b128 a[180:183], v10 offset:13312
v_cvt_pk_bf16_f32 v96, v96, v97
MA 124,a,252,v,200
buffer_load_dwordx4 v12, s[52:55], s71 offen offset:3072 sc1 lds
v_cmp_gt_i32_e64 s[94:95], 1, v247
MA 88,a,248,v,192
v_exp_f32 v100, v100
MA 120,a,248,v,200
v_add_f32 v4, v4, v98
v_add_f32 v4, v4, v99
MA 84,a,244,v,192
v_exp_f32 v101, v101
MA 116,a,244,v,200
ds_read_b128 a[184:187], v10 offset:14336
v_cvt_pk_bf16_f32 v97, v98, v99
MA 80,a,240,v,192
v_exp_f32 v102, v102
MA 112,a,240,v,200
v_add_f32 v4, v4, v100
v_add_f32 v4, v4, v101
MA 76,a,236,v,192
ds_read_b128 a[188:191], v10 offset:15360
v_cmp_gt_i32_e64 s[96:97], 2, v247
MA 108,a,236,v,200
v_exp_f32 v103, v103
MA 72,a,232,v,192
v_cvt_pk_bf16_f32 v98, v100, v101
v_cmp_gt_i32_e64 s[98:99], 3, v247
MA 104,a,232,v,200
v_exp_f32 v104, v104
MA 68,a,228,v,192
v_add_f32 v4, v4, v102
v_add_f32 v4, v4, v103
MA 100,a,228,v,200
v_exp_f32 v105, v105
MA 64,a,224,v,192
s_xor_b32 s72, s72, 0x8000
v_cvt_pk_bf16_f32 v99, v102, v103
MA 96,a,224,v,200
v_exp_f32 v106, v106
v_add_f32 v5, v5, v104
v_cndmask_b32_e64 v132, v132, v14, s[92:93]
v_add_f32 v5, v5, v105
v_exp_f32 v107, v107
v_cvt_pk_bf16_f32 v104, v104, v105
v_exp_f32 v108, v108
v_cndmask_b32_e64 v133, v133, v14, s[94:95]
v_add_f32 v5, v5, v106
v_add_f32 v5, v5, v107
v_exp_f32 v109, v109
v_cvt_pk_bf16_f32 v105, v106, v107
v_cndmask_b32_e64 v134, v134, v14, s[96:97]
v_exp_f32 v110, v110
v_add_f32 v5, v5, v108
v_add_f32 v5, v5, v109
v_exp_f32 v111, v111
v_cndmask_b32_e64 v135, v135, v14, s[98:99]
v_cvt_pk_bf16_f32 v106, v108, v109
v_add_f32 v5, v5, v110
v_add_f32 v5, v5, v111
v_cvt_pk_bf16_f32 v107, v110, v111
L_p3_d0m_top:
s_waitcnt lgkmcnt(0)
v_mfma_f32_16x16x32_bf16 v[144:147], a[128:131], v[16:19], 0
s_add_u32 m0, s73, 0
ds_read_b128 a[192:195], v11 offset:16384
v_mfma_f32_16x16x32_bf16 v[152:155], a[128:131], v[32:35], 0
v_exp_f32 v112, v112
v_mfma_f32_16x16x32_bf16 v[168:171], a[128:131], v[64:67], 0
v_exp_f32 v113, v113
MV 144,a,132,v,20
ds_read_b128 a[196:199], v11 offset:17408
buffer_load_dwordx4 v12, s[56:59], s71 offen offset:0 sc1 lds
MV 152,a,132,v,36
v_exp_f32 v114, v114
MV 168,a,132,v,68
v_add_f32 v2, v2, v112
v_add_f32 v2, v2, v113
MV 144,a,136,v,24
v_exp_f32 v115, v115
MV 152,a,136,v,40
ds_read_b128 a[200:203], v11 offset:18432
v_cvt_pk_bf16_f32 v112, v112, v113
MV 168,a,136,v,72
v_exp_f32 v116, v116
MV 144,a,140,v,28
ds_read_b128 a[204:207], v11 offset:19456
v_add_f32 v2, v2, v114
MV 152,a,140,v,44
ds_read_b128 a[208:211], v11 offset:20480
v_add_f32 v2, v2, v115
MV 168,a,140,v,76
v_exp_f32 v117, v117
v_mfma_f32_16x16x32_bf16 v[148:151], a[144:147], v[16:19], 0
buffer_load_dwordx4 v12, s[56:59], s71 offen offset:1024 sc1 lds
v_cvt_pk_bf16_f32 v113, v114, v115
v_mfma_f32_16x16x32_bf16 v[156:159], a[144:147], v[32:35], 0
v_exp_f32 v118, v118
v_mfma_f32_16x16x32_bf16 v[172:175], a[144:147], v[64:67], 0
v_add_f32 v2, v2, v116
v_add_f32 v2, v2, v117
MV 148,a,148,v,20
v_exp_f32 v119, v119
MV 156,a,148,v,36
ds_read_b128 a[212:215], v11 offset:21504
v_cvt_pk_bf16_f32 v114, v116, v117
MV 172,a,148,v,68
v_exp_f32 v120, v120
MV 148,a,152,v,24
v_add_f32 v2, v2, v118
v_add_f32 v2, v2, v119
MV 156,a,152,v,40
v_exp_f32 v121, v121
MV 172,a,152,v,72
ds_read_b128 a[216:219], v11 offset:22528
v_cvt_pk_bf16_f32 v115, v118, v119
MV 148,a,156,v,28
v_exp_f32 v122, v122
MV 156,a,156,v,44
ds_read_b128 a[220:223], v11 offset:23552
v_add_f32 v3, v3, v120
MV 172,a,156,v,76
ds_read_b128 a[224:227], v11 offset:24576
v_add_f32 v3, v3, v121
v_mfma_f32_16x16x32_bf16 v[176:179], a[160:163], v[16:19], 0
v_exp_f32 v123, v123
v_mfma_f32_16x16x32_bf16 v[184:187], a[160:163], v[32:35], 0
buffer_load_dwordx4 v12, s[56:59], s71 offen offset:2048 sc1 lds
v_cvt_pk_bf16_f32 v120, v120, v121
v_mfma_f32_16x16x32_bf16 v[200:203], a[160:163], v[64:67], 0
v_exp_f32 v124, v124
MV 176,a,164,v,20
v_add_f32 v3, v3, v122
v_add_f32 v3, v3, v123
MV 184,a,164,v,36
v_exp_f32 v125, v125
MV 200,a,164,v,68
ds_read_b128 a[228:231], v11 offset:25600
v_cvt_pk_bf16_f32 v121, v122, v123
MV 176,a,168,v,24
v_exp_f32 v126, v126
MV 184,a,168,v,40
v_add_f32 v3, v3, v124
v_add_f32 v3, v3, v125
MV 200,a,168,v,72
v_exp_f32 v127, v127
MV 176,a,172,v,28
ds_read_b128 a[232:235], v11 offset:26624
v_cvt_pk_bf16_f32 v122, v124, v125
MV 184,a,172,v,44
v_exp_f32 v128, v128
MV 200,a,172,v,76
ds_read_b128 a[236:239], v11 offset:27648
v_add_f32 v3, v3, v126
v_mfma_f32_16x16x32_bf16 v[180:183], a[176:179], v[16:19], 0
ds_read_b128 a[240:243], v11 offset:28672
v_add_f32 v3, v3, v127
v_mfma_f32_16x16x32_bf16 v[188:191], a[176:179], v[32:35], 0
v_exp_f32 v129, v129
v_mfma_f32_16x16x32_bf16 v[204:207], a[176:179], v[64:67], 0
ds_read_b128 a[244:247], v11 offset:29696
v_cvt_pk_bf16_f32 v123, v126, v127
MV 180,a,180,v,20
v_exp_f32 v130, v130
MV 188,a,180,v,36
v_add_f32 v4, v4, v128
v_add_f32 v4, v4, v129
MV 204,a,180,v,68
v_exp_f32 v131, v131
MV 180,a,184,v,24
buffer_load_dwordx4 v12, s[56:59], s71 offen offset:3072 sc1 lds
v_cvt_pk_bf16_f32 v128, v128, v129
MV 188,a,184,v,40
v_exp_f32 v132, v132
MV 204,a,184,v,72
v_add_f32 v4, v4, v130
v_add_f32 v4, v4, v131
MV 180,a,188,v,28
ds_read_b128 a[248:251], v11 offset:30720
v_add_u32 v246, -64, v239
MV 188,a,188,v,44
v_exp_f32 v133, v133
MV 204,a,188,v,76
ds_read_b128 a[252:255], v11 offset:31744
s_add_u32 s71, s71, 16384
v_cvt_pk_bf16_f32 v129, v130, v131
v_exp_f32 v134, v134
v_cmp_gt_i32_e64 s[84:85], 0, v246
v_add_f32 v4, v4, v132
v_cmp_gt_i32_e64 s[86:87], 1, v246
v_add_f32 v4, v4, v133
v_exp_f32 v135, v135
v_cmp_gt_i32_e64 s[88:89], 2, v246
v_cvt_pk_bf16_f32 v130, v132, v133
v_exp_f32 v136, v136
v_cmp_gt_i32_e64 s[90:91], 3, v246
v_add_f32 v4, v4, v134
v_cndmask_b32_e64 v168, v168, v14, s[84:85]
v_add_f32 v4, v4, v135
v_exp_f32 v137, v137
v_cndmask_b32_e64 v169, v169, v14, s[86:87]
v_cvt_pk_bf16_f32 v131, v134, v135
v_exp_f32 v138, v138
v_cndmask_b32_e64 v170, v170, v14, s[88:89]
v_add_f32 v5, v5, v136
v_cndmask_b32_e64 v171, v171, v14, s[90:91]
v_add_f32 v5, v5, v137
v_exp_f32 v139, v139
v_add_u32 v247, -80, v239
v_cvt_pk_bf16_f32 v136, v136, v137
v_exp_f32 v140, v140
v_cmp_gt_i32_e64 s[92:93], 0, v247
v_add_f32 v5, v5, v138
v_cmp_gt_i32_e64 s[94:95], 1, v247
v_add_f32 v5, v5, v139
v_exp_f32 v141, v141
v_cmp_gt_i32_e64 s[96:97], 2, v247
v_cvt_pk_bf16_f32 v137, v138, v139
v_exp_f32 v142, v142
v_cmp_gt_i32_e64 s[98:99], 3, v247
v_add_f32 v5, v5, v140
v_cndmask_b32_e64 v172, v172, v14, s[92:93]
v_add_f32 v5, v5, v141
v_exp_f32 v143, v143
v_cndmask_b32_e64 v173, v173, v14, s[94:95]
v_cvt_pk_bf16_f32 v138, v140, v141
v_add_f32 v5, v5, v142
v_cndmask_b32_e64 v174, v174, v14, s[96:97]
v_add_f32 v5, v5, v143
v_cvt_pk_bf16_f32 v139, v142, v143
v_cndmask_b32_e64 v175, v175, v14, s[98:99]
s_waitcnt vmcnt(16) lgkmcnt(0)
MA 0,a,192,v,80
s_barrier
MA 32,a,192,v,88
s_add_u32 m0, s72, 0
ds_read_b128 a[128:131], v10 offset:16384
MA 4,a,196,v,80
ds_read_b128 a[132:135], v10 offset:17408
buffer_load_dwordx4 v12, s[52:55], s71 offen offset:0 sc1 lds
MA 36,a,196,v,88
v_exp_f32 v144, v144
MA 8,a,200,v,80
v_exp_f32 v145, v145
MA 40,a,200,v,88
v_exp_f32 v146, v146
MA 12,a,204,v,80
ds_read_b128 a[136:139], v10 offset:18432
v_add_f32 v2, v2, v144
MA 44,a,204,v,88
v_add_f32 v2, v2, v145
v_add_u32 v246, -96, v239
MA 16,a,208,v,80
v_exp_f32 v147, v147
MA 48,a,208,v,88
ds_read_b128 a[140:143], v10 offset:19456
v_cvt_pk_bf16_f32 v144, v144, v145
MA 20,a,212,v,80
ds_read_b128 a[144:147], v10 offset:20480
v_cmp_gt_i32_e64 s[84:85], 0, v246
MA 52,a,212,v,88
v_exp_f32 v148, v148
MA 24,a,216,v,80
v_add_f32 v2, v2, v146
v_add_f32 v2, v2, v147
MA 56,a,216,v,88
buffer_load_dwordx4 v12, s[52:55], s71 offen offset:1024 sc1 lds
v_cmp_gt_i32_e64 s[86:87], 1, v246
MA 28,a,220,v,80
v_exp_f32 v149, v149
MA 60,a,220,v,88
ds_read_b128 a[148:151], v10 offset:21504
v_cvt_pk_bf16_f32 v145, v146, v147
MA 92,a,220,v,96
v_exp_f32 v150, v150
MA 124,a,220,v,104
v_add_f32 v2, v2, v148
v_cmp_gt_i32_e64 s[88:89], 2, v246
MA 88,a,216,v,96
ds_read_b128 a[152:155], v10 offset:22528
v_add_f32 v2, v2, v149
MA 120,a,216,v,104
v_exp_f32 v151, v151
MA 84,a,212,v,96
v_cvt_pk_bf16_f32 v146, v148, v149
v_cmp_gt_i32_e64 s[90:91], 3, v246
MA 116,a,212,v,104
v_exp_f32 v152, v152
MA 80,a,208,v,96
ds_read_b128 a[156:159], v10 offset:23552
v_add_f32 v2, v2, v150
MA 112,a,208,v,104
v_add_f32 v2, v2, v151
v_cndmask_b32_e64 v200, v200, v14, s[84:85]
MA 76,a,204,v,96
v_exp_f32 v153, v153
MA 108,a,204,v,104
ds_read_b128 a[160:163], v10 offset:24576
v_cvt_pk_bf16_f32 v147, v150, v151
MA 72,a,200,v,96
buffer_load_dwordx4 v12, s[52:55], s71 offen offset:2048 sc1 lds
v_cndmask_b32_e64 v201, v201, v14, s[86:87]
MA 104,a,200,v,104
v_exp_f32 v154, v154
MA 68,a,196,v,96
ds_read_b128 a[164:167], v10 offset:25600
v_add_f32 v3, v3, v152
MA 100,a,196,v,104
v_add_f32 v3, v3, v153
v_cndmask_b32_e64 v202, v202, v14, s[88:89]
MA 64,a,192,v,96
v_exp_f32 v155, v155
MA 96,a,192,v,104
ds_read_b128 a[168:171], v10 offset:26624
v_cvt_pk_bf16_f32 v152, v152, v153
MA 0,a,224,v,112
v_exp_f32 v156, v156
MA 32,a,224,v,120
v_add_f32 v3, v3, v154
v_cndmask_b32_e64 v203, v203, v14, s[90:91]
MA 4,a,228,v,112
ds_read_b128 a[172:175], v10 offset:27648
v_add_f32 v3, v3, v155
MA 36,a,228,v,120
v_exp_f32 v157, v157
MA 8,a,232,v,112
v_cvt_pk_bf16_f32 v153, v154, v155
v_add_u32 v247, -112, v239
MA 40,a,232,v,120
v_exp_f32 v158, v158
MA 12,a,236,v,112
ds_read_b128 a[176:179], v10 offset:28672
v_add_f32 v3, v3, v156
MA 44,a,236,v,120
v_add_f32 v3, v3, v157
v_cmp_gt_i32_e64 s[92:93], 0, v247
MA 16,a,240,v,112
v_exp_f32 v159, v159
MA 48,a,240,v,120
ds_read_b128 a[180:183], v10 offset:29696
buffer_load_dwordx4 v12, s[52:55], s71 offen offset:3072 sc1 lds
MA 20,a,244,v,112
v_cvt_pk_bf16_f32 v154, v156, v157
v_cmp_gt_i32_e64 s[94:95], 1, v247
MA 52,a,244,v,120
v_exp_f32 v168, v168
MA 24,a,248,v,112
ds_read_b128 a[184:187], v10 offset:30720
v_add_f32 v3, v3, v158
MA 56,a,248,v,120
v_add_f32 v3, v3, v159
v_cmp_gt_i32_e64 s[96:97], 2, v247
MA 28,a,252,v,112
v_exp_f32 v169, v169
MA 60,a,252,v,120
ds_read_b128 a[188:191], v10 offset:31744
v_cvt_pk_bf16_f32 v155, v158, v159
MA 92,a,252,v,128
v_exp_f32 v170, v170
MA 124,a,252,v,136
v_add_f32 v5, v5, v168
v_cmp_gt_i32_e64 s[98:99], 3, v247
MA 88,a,248,v,128
s_cmp_eq_u32 s70, 7
v_add_f32 v5, v5, v169
MA 120,a,248,v,136
v_exp_f32 v171, v171
MA 84,a,244,v,128
v_cvt_pk_bf16_f32 v168, v168, v169
v_cndmask_b32_e64 v204, v204, v14, s[92:93]
MA 116,a,244,v,136
v_exp_f32 v172, v172
MA 80,a,240,v,128
v_add_f32 v5, v5, v170
v_add_f32 v5, v5, v171
MA 112,a,240,v,136
v_exp_f32 v173, v173
MA 76,a,236,v,128
v_cvt_pk_bf16_f32 v169, v170, v171
v_cndmask_b32_e64 v205, v205, v14, s[94:95]
MA 108,a,236,v,136
v_exp_f32 v174, v174
MA 72,a,232,v,128
v_add_f32 v5, v5, v172
v_cndmask_b32_e64 v206, v206, v14, s[96:97]
MA 104,a,232,v,136
v_add_f32 v5, v5, v173
v_cndmask_b32_e64 v207, v207, v14, s[98:99]
MA 68,a,228,v,128
v_exp_f32 v175, v175
MA 100,a,228,v,136
v_cvt_pk_bf16_f32 v170, v172, v173
v_add_f32 v5, v5, v174
MA 64,a,224,v,128
v_add_f32 v5, v5, v175
v_cvt_pk_bf16_f32 v171, v174, v175
MA 96,a,224,v,136
s_cbranch_scc1 L_p3_mxm_top
s_waitcnt lgkmcnt(0)
v_xor_b32 v11, 0x8000, v11
v_mfma_f32_16x16x32_bf16 v[80:83], a[128:131], v[16:19], 0
s_add_u32 m0, s73, 16384
ds_read_b128 a[192:195], v11 offset:0
v_mfma_f32_16x16x32_bf16 v[88:91], a[128:131], v[32:35], 0
v_exp_f32 v176, v176
v_mfma_f32_16x16x32_bf16 v[84:87], a[144:147], v[16:19], 0
v_exp_f32 v177, v177
v_mfma_f32_16x16x32_bf16 v[92:95], a[144:147], v[32:35], 0
ds_read_b128 a[196:199], v11 offset:1024
buffer_load_dwordx4 v12, s[56:59], s71 offen offset:0 sc1 lds
v_mfma_f32_16x16x32_bf16 v[112:115], a[160:163], v[16:19], 0
v_exp_f32 v178, v178
v_mfma_f32_16x16x32_bf16 v[120:123], a[160:163], v[32:35], 0
v_add_f32 v2, v2, v176
v_add_f32 v2, v2, v177
v_mfma_f32_16x16x32_bf16 v[116:119], a[176:179], v[16:19], 0
ds_read_b128 a[200:203], v11 offset:2048
ds_read_b128 a[204:207], v11 offset:3072
v_mfma_f32_16x16x32_bf16 v[124:127], a[176:179], v[32:35], 0
v_exp_f32 v179, v179
MV 116,a,180,v,20
ds_read_b128 a[208:211], v11 offset:4096
v_cvt_pk_bf16_f32 v176, v176, v177
MV 124,a,180,v,36
v_exp_f32 v180, v180
MV 112,a,164,v,20
v_add_f32 v2, v2, v178
v_add_f32 v2, v2, v179
MV 120,a,164,v,36
v_exp_f32 v181, v181
MV 84,a,148,v,20
buffer_load_dwordx4 v12, s[56:59], s71 offen offset:1024 sc1 lds
v_cvt_pk_bf16_f32 v177, v178, v179
MV 92,a,148,v,36
v_exp_f32 v182, v182
MV 80,a,132,v,20
ds_read_b128 a[212:215], v11 offset:5120
v_add_f32 v2, v2, v180
MV 88,a,132,v,36
ds_read_b128 a[216:219], v11 offset:6144
v_add_f32 v2, v2, v181
MV 80,a,136,v,24
v_exp_f32 v183, v183
MV 88,a,136,v,40
ds_read_b128 a[220:223], v11 offset:7168
v_cvt_pk_bf16_f32 v178, v180, v181
MV 84,a,152,v,24
v_exp_f32 v184, v184
MV 92,a,152,v,40
v_add_f32 v2, v2, v182
v_add_f32 v2, v2, v183
MV 112,a,168,v,24
ds_read_b128 a[224:227], v11 offset:8192
buffer_load_dwordx4 v12, s[56:59], s71 offen offset:2048 sc1 lds
MV 120,a,168,v,40
v_exp_f32 v185, v185
MV 116,a,184,v,24
ds_read_b128 a[228:231], v11 offset:9216
v_cvt_pk_bf16_f32 v179, v182, v183
MV 124,a,184,v,40
v_exp_f32 v186, v186
MV 116,a,188,v,28
v_add_f32 v3, v3, v184
v_add_f32 v3, v3, v185
MV 124,a,188,v,44
v_exp_f32 v187, v187
MV 112,a,172,v,28
ds_read_b128 a[232:235], v11 offset:10240
v_cvt_pk_bf16_f32 v184, v184, v185
MV 120,a,172,v,44
v_exp_f32 v188, v188
MV 84,a,156,v,28
ds_read_b128 a[236:239], v11 offset:11264
v_add_f32 v3, v3, v186
MV 92,a,156,v,44
buffer_load_dwordx4 v12, s[56:59], s71 offen offset:3072 sc1 lds
v_add_f32 v3, v3, v187
MV 80,a,140,v,28
v_exp_f32 v189, v189
MV 88,a,140,v,44
ds_read_b128 a[240:243], v11 offset:12288
ds_read_b128 a[244:247], v11 offset:13312
ds_read_b128 a[248:251], v11 offset:14336
ds_read_b128 a[252:255], v11 offset:15360
s_add_u32 s71, s71, 16384
s_xor_b32 s73, s73, 0x8000
v_cvt_pk_bf16_f32 v185, v186, v187
v_exp_f32 v190, v190
v_add_f32 v3, v3, v188
v_add_f32 v3, v3, v189
v_exp_f32 v191, v191
v_cvt_pk_bf16_f32 v186, v188, v189
v_exp_f32 v200, v200
v_add_f32 v3, v3, v190
v_add_f32 v3, v3, v191
v_exp_f32 v201, v201
v_cvt_pk_bf16_f32 v187, v190, v191
v_exp_f32 v202, v202
v_add_f32 v5, v5, v200
v_add_f32 v5, v5, v201
v_exp_f32 v203, v203
v_cvt_pk_bf16_f32 v200, v200, v201
v_exp_f32 v204, v204
v_add_f32 v5, v5, v202
v_add_f32 v5, v5, v203
v_exp_f32 v205, v205
v_cvt_pk_bf16_f32 v201, v202, v203
v_exp_f32 v206, v206
v_add_f32 v5, v5, v204
v_add_f32 v5, v5, v205
v_exp_f32 v207, v207
v_cvt_pk_bf16_f32 v202, v204, v205
v_add_f32 v5, v5, v206
v_add_f32 v5, v5, v207
v_cvt_pk_bf16_f32 v203, v206, v207
s_waitcnt vmcnt(16) lgkmcnt(0)
MA 0,a,192,v,144
s_barrier
v_xor_b32 v10, 0x8000, v10
MA 32,a,192,v,152
s_add_u32 m0, s72, 16384
ds_read_b128 a[128:131], v10 offset:0
MA 4,a,196,v,144
buffer_load_dwordx4 v12, s[52:55], s71 offen offset:0 sc1 lds
v_lshrrev_b32 v249, 2, v1
MA 36,a,196,v,152
ds_read_b128 a[132:135], v10 offset:1024
v_and_b32 v248, 7, v249
MA 8,a,200,v,144
v_exp_f32 v80, v80
MA 40,a,200,v,152
v_lshlrev_b32 v249, 8, v249
v_and_b32 v250, 3, v1
MA 12,a,204,v,144
v_exp_f32 v81, v81
MA 44,a,204,v,152
ds_read_b128 a[136:139], v10 offset:2048
v_lshl_add_u32 v249, v250, 3, v249
MA 16,a,208,v,144
s_lshl_b32 s36, s3, 13
s_add_u32 s36, s36, 131072
MA 48,a,208,v,152
v_exp_f32 v82, v82
MA 20,a,212,v,144
ds_read_b128 a[140:143], v10 offset:3072
v_add_u32 v249, s36, v249
MA 52,a,212,v,152
s_waitcnt vmcnt(13)
v_xor_b32 v250, 0, v248
MA 24,a,216,v,144
v_exp_f32 v83, v83
MA 56,a,216,v,152
ds_read_b128 a[144:147], v10 offset:4096
v_lshl_add_u32 v250, v250, 5, v249
MA 28,a,220,v,144
ds_read_b128 a[148:151], v10 offset:5120
TR 96,250,0
MA 60,a,220,v,152
buffer_load_dwordx4 v12, s[52:55], s71 offen offset:1024 sc1 lds
v_cvt_pk_bf16_f32 v80, v80, v81
MA 124,a,220,v,168
TR 98,250,4096
v_xor_b32 v250, 1, v248
MA 120,a,216,v,168
v_lshl_add_u32 v250, v250, 5, v249
TR 100,250,0
MA 116,a,212,v,168
v_exp_f32 v84, v84
MA 112,a,208,v,168
ds_read_b128 a[152:155], v10 offset:6144
TR 102,250,4096
MA 108,a,204,v,168
v_xor_b32 v250, 2, v248
v_lshl_add_u32 v250, v250, 5, v249
MA 104,a,200,v,168
v_exp_f32 v85, v85
MA 100,a,196,v,168
ds_read_b128 a[156:159], v10 offset:7168
v_cvt_pk_bf16_f32 v81, v82, v83
MA 96,a,192,v,168
TR 104,250,0
TR 106,250,4096
MA 0,a,224,v,176
ds_read_b128 a[160:163], v10 offset:8192
v_xor_b32 v250, 3, v248
MA 32,a,224,v,184
v_lshl_add_u32 v250, v250, 5, v249
TR 108,250,0
MA 4,a,228,v,176
v_exp_f32 v86, v86
MA 36,a,228,v,184
ds_read_b128 a[164:167], v10 offset:9216
buffer_load_dwordx4 v12, s[52:55], s71 offen offset:2048 sc1 lds
MA 8,a,232,v,176
TR 110,250,4096
v_xor_b32 v250, 4, v248
MA 40,a,232,v,184
v_exp_f32 v87, v87
MA 12,a,236,v,176
ds_read_b128 a[168:171], v10 offset:10240
v_lshl_add_u32 v250, v250, 5, v249
MA 44,a,236,v,184
v_cvt_pk_bf16_f32 v82, v84, v85
TR 128,250,0
MA 16,a,240,v,176
TR 130,250,4096
v_xor_b32 v250, 5, v248
MA 48,a,240,v,184
v_exp_f32 v88, v88
MA 20,a,244,v,176
ds_read_b128 a[172:175], v10 offset:11264
v_lshl_add_u32 v250, v250, 5, v249
MA 52,a,244,v,184
TR 132,250,0
TR 134,250,4096
MA 24,a,248,v,176
ds_read_b128 a[176:179], v10 offset:12288
v_xor_b32 v250, 6, v248
MA 56,a,248,v,184
v_exp_f32 v89, v89
MA 28,a,252,v,176
v_cvt_pk_bf16_f32 v83, v86, v87
v_lshl_add_u32 v250, v250, 5, v249
MA 60,a,252,v,184
ds_read_b128 a[180:183], v10 offset:13312
TR 136,250,0
MA 124,a,252,v,200
buffer_load_dwordx4 v12, s[52:55], s71 offen offset:3072 sc1 lds
TR 138,250,4096
MA 120,a,248,v,200
v_xor_b32 v250, 7, v248
v_lshl_add_u32 v250, v250, 5, v249
MA 116,a,244,v,200
v_exp_f32 v90, v90
MA 112,a,240,v,200
ds_read_b128 a[184:187], v10 offset:14336
TR 140,250,0
MA 108,a,236,v,200
v_exp_f32 v91, v91
MA 104,a,232,v,200
ds_read_b128 a[188:191], v10 offset:15360
TR 142,250,4096
MA 100,a,228,v,200
s_add_u32 s32, s40, 100663296
s_addc_u32 s33, s41, 0
MA 96,a,224,v,200
s_xor_b32 s72, s72, 0x8000
v_cvt_pk_bf16_f32 v88, v88, v89
s_mov_b32 s34, 8388608
v_exp_f32 v92, v92
s_mov_b32 s35, 0x20000
s_and_b32 s36, s2, 7
s_lshl_b32 s36, s36, 20
v_exp_f32 v93, v93
s_lshr_b32 s37, s2, 3
s_lshl_b32 s37, s37, 15
s_add_u32 s36, s36, s37
v_cvt_pk_bf16_f32 v89, v90, v91
s_lshl_b32 s37, s3, 12
s_add_u32 s36, s36, s37
v_exp_f32 v94, v94
s_add_u32 s37, s36, 4096
s_waitcnt lgkmcnt(15)
buffer_store_dwordx4 v[96:99], v12, s[32:35], s36 offen offset:0 sc1
buffer_store_dwordx4 v[100:103], v12, s[32:35], s36 offen offset:1024 sc1
v_exp_f32 v95, v95
buffer_store_dwordx4 v[104:107], v12, s[32:35], s36 offen offset:2048 sc1
s_waitcnt lgkmcnt(14)
buffer_store_dwordx4 v[108:111], v12, s[32:35], s36 offen offset:3072 sc1
s_waitcnt lgkmcnt(11)
buffer_store_dwordx4 v[128:131], v12, s[32:35], s37 offen offset:0 sc1
v_cvt_pk_bf16_f32 v90, v92, v93
s_waitcnt lgkmcnt(8)
buffer_store_dwordx4 v[132:135], v12, s[32:35], s37 offen offset:1024 sc1
v_cvt_pk_bf16_f32 v91, v94, v95
s_waitcnt lgkmcnt(4)
buffer_store_dwordx4 v[136:139], v12, s[32:35], s37 offen offset:2048 sc1
s_waitcnt lgkmcnt(0)
buffer_store_dwordx4 v[140:143], v12, s[32:35], s37 offen offset:3072 sc1
L_p3_eps:
v_mov_b32 v240, v4
v_mov_b32 v241, v5
s_nop 0
v_permlane32_swap_b32 v4, v240
v_permlane32_swap_b32 v5, v241
v_add_f32 v4, v4, v240
v_add_f32 v5, v5, v241
v_mov_b32 v240, v4
v_mov_b32 v241, v5
s_nop 0
v_permlane16_swap_b32 v4, v240
v_permlane16_swap_b32 v5, v241
v_add_f32 v4, v4, v240
v_add_f32 v5, v5, v241
v_cmp_nle_f32 vcc, 0x30800000, v4
s_nop 0
s_mov_b64 s[78:79], vcc
v_cmp_nge_f32 vcc, 0x4e800000, v4
s_nop 0
s_or_b64 s[78:79], s[78:79], vcc
v_cmp_nle_f32 vcc, 0x30800000, v5
s_nop 0
s_or_b64 s[78:79], s[78:79], vcc
v_cmp_nge_f32 vcc, 0x4e800000, v5
s_nop 0
s_or_b64 s[78:79], s[78:79], vcc
v_rcp_f32 v4, v4
v_rcp_f32 v5, v5
s_add_u32 s80, s101, s76
s_nop 4
v_accvgpr_read_b32 v240, a64
v_accvgpr_read_b32 v241, a65
v_accvgpr_read_b32 v242, a66
v_accvgpr_read_b32 v243, a67
v_accvgpr_read_b32 v244, a68
v_accvgpr_read_b32 v245, a69
v_accvgpr_read_b32 v246, a70
v_accvgpr_read_b32 v247, a71
v_pk_mul_f32 v[240:241], v[240:241], v[4:5] op_sel:[0,0] op_sel_hi:[1,0]
v_pk_mul_f32 v[242:243], v[242:243], v[4:5] op_sel:[0,0] op_sel_hi:[1,0]
v_pk_mul_f32 v[244:245], v[244:245], v[4:5] op_sel:[0,0] op_sel_hi:[1,0]
v_pk_mul_f32 v[246:247], v[246:247], v[4:5] op_sel:[0,0] op_sel_hi:[1,0]
v_cvt_pk_bf16_f32 v248, v240, v241
v_cvt_pk_bf16_f32 v249, v242, v243
v_cvt_pk_bf16_f32 v250, v244, v245
v_cvt_pk_bf16_f32 v251, v246, v247
buffer_store_dwordx4 v[248:251], v15, s[60:63], s101 offen offset:0 sc1
v_accvgpr_read_b32 v240, a72
v_accvgpr_read_b32 v241, a73
v_accvgpr_read_b32 v242, a74
v_accvgpr_read_b32 v243, a75
v_accvgpr_read_b32 v244, a76
v_accvgpr_read_b32 v245, a77
v_accvgpr_read_b32 v246, a78
v_accvgpr_read_b32 v247, a79
v_pk_mul_f32 v[240:241], v[240:241], v[4:5] op_sel:[0,0] op_sel_hi:[1,0]
v_pk_mul_f32 v[242:243], v[242:243], v[4:5] op_sel:[0,0] op_sel_hi:[1,0]
v_pk_mul_f32 v[244:245], v[244:245], v[4:5] op_sel:[0,0] op_sel_hi:[1,0]
v_pk_mul_f32 v[246:247], v[246:247], v[4:5] op_sel:[0,0] op_sel_hi:[1,0]
v_cvt_pk_bf16_f32 v252, v240, v241
v_cvt_pk_bf16_f32 v253, v242, v243
v_cvt_pk_bf16_f32 v254, v244, v245
v_cvt_pk_bf16_f32 v255, v246, v247
buffer_store_dwordx4 v[252:255], v15, s[60:63], s101 offen offset:1024 sc1
v_accvgpr_read_b32 v240, a80
v_accvgpr_read_b32 v241, a81
v_accvgpr_read_b32 v242, a82
v_accvgpr_read_b32 v243, a83
v_accvgpr_read_b32 v244, a84
v_accvgpr_read_b32 v245, a85
v_accvgpr_read_b32 v246, a86
v_accvgpr_read_b32 v247, a87
v_pk_mul_f32 v[240:241], v[240:241], v[4:5] op_sel:[0,0] op_sel_hi:[1,0]
v_pk_mul_f32 v[242:243], v[242:243], v[4:5] op_sel:[0,0] op_sel_hi:[1,0]
v_pk_mul_f32 v[244:245], v[244:245], v[4:5] op_sel:[0,0] op_sel_hi:[1,0]
v_pk_mul_f32 v[246:247], v[246:247], v[4:5] op_sel:[0,0] op_sel_hi:[1,0]
v_cvt_pk_bf16_f32 v248, v240, v241
v_cvt_pk_bf16_f32 v249, v242, v243
v_cvt_pk_bf16_f32 v250, v244, v245
v_cvt_pk_bf16_f32 v251, v246, v247
buffer_store_dwordx4 v[248:251], v15, s[60:63], s101 offen offset:2048 sc1
v_accvgpr_read_b32 v240, a88
v_accvgpr_read_b32 v241, a89
v_accvgpr_read_b32 v242, a90
v_accvgpr_read_b32 v243, a91
v_accvgpr_read_b32 v244, a92
v_accvgpr_read_b32 v245, a93
v_accvgpr_read_b32 v246, a94
v_accvgpr_read_b32 v247, a95
v_pk_mul_f32 v[240:241], v[240:241], v[4:5] op_sel:[0,0] op_sel_hi:[1,0]
v_pk_mul_f32 v[242:243], v[242:243], v[4:5] op_sel:[0,0] op_sel_hi:[1,0]
v_pk_mul_f32 v[244:245], v[244:245], v[4:5] op_sel:[0,0] op_sel_hi:[1,0]
v_pk_mul_f32 v[246:247], v[246:247], v[4:5] op_sel:[0,0] op_sel_hi:[1,0]
v_cvt_pk_bf16_f32 v252, v240, v241
v_cvt_pk_bf16_f32 v253, v242, v243
v_cvt_pk_bf16_f32 v254, v244, v245
v_cvt_pk_bf16_f32 v255, v246, v247
buffer_store_dwordx4 v[252:255], v15, s[60:63], s101 offen offset:3072 sc1
v_accvgpr_read_b32 v240, a96
v_accvgpr_read_b32 v241, a97
v_accvgpr_read_b32 v242, a98
v_accvgpr_read_b32 v243, a99
v_accvgpr_read_b32 v244, a100
v_accvgpr_read_b32 v245, a101
v_accvgpr_read_b32 v246, a102
v_accvgpr_read_b32 v247, a103
v_pk_mul_f32 v[240:241], v[240:241], v[4:5] op_sel:[0,1] op_sel_hi:[1,1]
v_pk_mul_f32 v[242:243], v[242:243], v[4:5] op_sel:[0,1] op_sel_hi:[1,1]
v_pk_mul_f32 v[244:245], v[244:245], v[4:5] op_sel:[0,1] op_sel_hi:[1,1]
v_pk_mul_f32 v[246:247], v[246:247], v[4:5] op_sel:[0,1] op_sel_hi:[1,1]
v_cvt_pk_bf16_f32 v248, v240, v241
v_cvt_pk_bf16_f32 v249, v242, v243
v_cvt_pk_bf16_f32 v250, v244, v245
v_cvt_pk_bf16_f32 v251, v246, v247
buffer_store_dwordx4 v[248:251], v15, s[60:63], s80 offen offset:0 sc1
v_accvgpr_read_b32 v240, a104
v_accvgpr_read_b32 v241, a105
v_accvgpr_read_b32 v242, a106
v_accvgpr_read_b32 v243, a107
v_accvgpr_read_b32 v244, a108
v_accvgpr_read_b32 v245, a109
v_accvgpr_read_b32 v246, a110
v_accvgpr_read_b32 v247, a111
v_pk_mul_f32 v[240:241], v[240:241], v[4:5] op_sel:[0,1] op_sel_hi:[1,1]
v_pk_mul_f32 v[242:243], v[242:243], v[4:5] op_sel:[0,1] op_sel_hi:[1,1]
v_pk_mul_f32 v[244:245], v[244:245], v[4:5] op_sel:[0,1] op_sel_hi:[1,1]
v_pk_mul_f32 v[246:247], v[246:247], v[4:5] op_sel:[0,1] op_sel_hi:[1,1]
v_cvt_pk_bf16_f32 v252, v240, v241
v_cvt_pk_bf16_f32 v253, v242, v243
v_cvt_pk_bf16_f32 v254, v244, v245
v_cvt_pk_bf16_f32 v255, v246, v247
buffer_store_dwordx4 v[252:255], v15, s[60:63], s80 offen offset:1024 sc1
v_accvgpr_read_b32 v240, a112
v_accvgpr_read_b32 v241, a113
v_accvgpr_read_b32 v242, a114
v_accvgpr_read_b32 v243, a115
v_accvgpr_read_b32 v244, a116
v_accvgpr_read_b32 v245, a117
v_accvgpr_read_b32 v246, a118
v_accvgpr_read_b32 v247, a119
v_pk_mul_f32 v[240:241], v[240:241], v[4:5] op_sel:[0,1] op_sel_hi:[1,1]
v_pk_mul_f32 v[242:243], v[242:243], v[4:5] op_sel:[0,1] op_sel_hi:[1,1]
v_pk_mul_f32 v[244:245], v[244:245], v[4:5] op_sel:[0,1] op_sel_hi:[1,1]
v_pk_mul_f32 v[246:247], v[246:247], v[4:5] op_sel:[0,1] op_sel_hi:[1,1]
v_cvt_pk_bf16_f32 v248, v240, v241
v_cvt_pk_bf16_f32 v249, v242, v243
v_cvt_pk_bf16_f32 v250, v244, v245
v_cvt_pk_bf16_f32 v251, v246, v247
buffer_store_dwordx4 v[248:251], v15, s[60:63], s80 offen offset:2048 sc1
v_accvgpr_read_b32 v240, a120
v_accvgpr_read_b32 v241, a121
v_accvgpr_read_b32 v242, a122
v_accvgpr_read_b32 v243, a123
v_accvgpr_read_b32 v244, a124
v_accvgpr_read_b32 v245, a125
v_accvgpr_read_b32 v246, a126
v_accvgpr_read_b32 v247, a127
v_pk_mul_f32 v[240:241], v[240:241], v[4:5] op_sel:[0,1] op_sel_hi:[1,1]
v_pk_mul_f32 v[242:243], v[242:243], v[4:5] op_sel:[0,1] op_sel_hi:[1,1]
v_pk_mul_f32 v[244:245], v[244:245], v[4:5] op_sel:[0,1] op_sel_hi:[1,1]
v_pk_mul_f32 v[246:247], v[246:247], v[4:5] op_sel:[0,1] op_sel_hi:[1,1]
v_cvt_pk_bf16_f32 v252, v240, v241
v_cvt_pk_bf16_f32 v253, v242, v243
v_cvt_pk_bf16_f32 v254, v244, v245
v_cvt_pk_bf16_f32 v255, v246, v247
buffer_store_dwordx4 v[252:255], v15, s[60:63], s80 offen offset:3072 sc1
v_mov_b32 v160, 0x3f803f80
v_mov_b32 v161, 0x3f803f80
v_mov_b32 v162, 0x3f803f80
v_mov_b32 v163, 0x3f803f80
v_mov_b32 v164, 0
v_mov_b32 v165, 0
v_mov_b32 v166, 0
v_mov_b32 v167, 0
v_mov_b32 v168, 0
v_mov_b32 v169, 0
v_mov_b32 v170, 0
v_mov_b32 v171, 0
s_and_b32 s36, s2, 3
s_lshl_b32 s36, s36, 1
s_sub_u32 s32, 14, s36
s_bitcmp1_b32 s2, 4
s_cselect_b32 s36, s32, s36
s_bfe_u32 s32, s2, 0x10003
s_add_u32 s36, s36, s32
s_bfe_u32 s37, s2, 0x10002
s_lshr_b32 s32, s2, 5
s_lshl_b32 s32, s32, 1
s_add_u32 s37, s37, s32
s_lshl_b32 s36, s36, 2
s_add_u32 s36, s36, s3
s_lshl_b32 s37, s37, 7
s_lshl_b32 s32, s36, 16
s_add_u32 s37, s37, s32
s_lshl_b32 s36, s36, 7
v_and_b32 v240, 15, v1
v_bfe_u32 v241, v1, 4, 1
v_lshlrev_b32 v241, 5, v241
v_lshrrev_b32 v242, 5, v1
v_lshl_add_u32 v241, v242, 4, v241
v_lshl_add_u32 v241, v240, 11, v241
v_lshlrev_b32 v240, 2, v240
s_add_u32 s32, s40, 58720256
s_addc_u32 s33, s41, 0
s_mov_b32 s34, 8192
s_mov_b32 s35, 0x20000
buffer_load_dwordx4 v[192:195], v241, s[44:47], s37 offen offset:0
buffer_load_dwordx4 v[196:199], v241, s[44:47], s37 offen offset:64
buffer_load_dword v6, v240, s[32:35], s36 offen offset:0 sc1
s_add_u32 s37, s37, 32768
buffer_load_dwordx4 v[200:203], v241, s[44:47], s37 offen offset:0
buffer_load_dwordx4 v[204:207], v241, s[44:47], s37 offen offset:64
buffer_load_dword v7, v240, s[32:35], s36 offen offset:64 sc1
v_lshlrev_b32 v216, 20, v1
s_lshl_b32 s36, s3, 26
v_add_u32 v216, s36, v216
v_mov_b32 v217, 1
s_lshl_b32 s37, s2, 2
s_getpc_b64 s[38:39]
L_ct_b:
s_add_u32 s38, s38, L_p3_s1m_top - L_ct_b
s_addc_u32 s39, s39, 0
v_mov_b32 v173, s39
v_mov_b32 v172, s38
s_lshr_b32 s38, s2, 3
s_lshl_b32 s38, s38, 2
s_add_u32 s38, s38, s3
s_lshl_b32 s38, s38, 7
v_and_b32 v174, 3, v1
v_lshlrev_b32 v174, 14, v174
v_add_u32 v174, s38, v174
v_min_u32 v174, L_end - L_p3_s1m_top - 4, v174
v_add_co_u32 v172, vcc, v172, v174
s_nop 1
v_addc_co_u32 v173, vcc, 0, v173, vcc
global_load_dword v174, v[172:173], off
s_lshl_b32 s74, s70, 1
s_sub_u32 s74, 13, s74
s_cbranch_scc1 L_p3_s0m_top
.p2align 5
L_p3_s0_top:
s_waitcnt lgkmcnt(0)
v_mfma_f32_16x16x32_bf16 v[144:147], a[128:131], v[16:19], 0
s_add_u32 m0, s73, 0
ds_read_b128 a[192:195], v11 offset:16384
v_mfma_f32_16x16x32_bf16 v[152:155], a[128:131], v[32:35], 0
v_exp_f32 v112, v112
v_mfma_f32_16x16x32_bf16 v[148:151], a[144:147], v[16:19], 0
ds_read_b128 a[196:199], v11 offset:17408
buffer_load_dwordx4 v12, s[56:59], s71 offen offset:0 sc1 lds
v_mfma_f32_16x16x32_bf16 v[156:159], a[144:147], v[32:35], 0
v_exp_f32 v113, v113
v_mfma_f32_16x16x32_bf16 v[176:179], a[160:163], v[16:19], 0
ds_read_b128 a[200:203], v11 offset:18432
ds_read_b128 a[204:207], v11 offset:19456
v_mfma_f32_16x16x32_bf16 v[184:187], a[160:163], v[32:35], 0
v_exp_f32 v114, v114
v_mfma_f32_16x16x32_bf16 v[180:183], a[176:179], v[16:19], 0
v_exp_f32 v115, v115
v_mfma_f32_16x16x32_bf16 v[188:191], a[176:179], v[32:35], 0
ds_read_b128 a[208:211], v11 offset:20480
v_cvt_pk_bf16_f32 v112, v112, v113
MV 180,a,180,v,20
ds_read_b128 a[212:215], v11 offset:21504
buffer_load_dwordx4 v12, s[56:59], s71 offen offset:1024 sc1 lds
MV 188,a,180,v,36
v_exp_f32 v116, v116
MV 176,a,164,v,20
v_exp_f32 v117, v117
MV 184,a,164,v,36
ds_read_b128 a[216:219], v11 offset:22528
ds_read_b128 a[220:223], v11 offset:23552
MV 148,a,148,v,20
ds_read_b128 a[224:227], v11 offset:24576
v_cvt_pk_bf16_f32 v113, v114, v115
MV 156,a,148,v,36
v_exp_f32 v118, v118
MV 144,a,132,v,20
v_exp_f32 v119, v119
MV 152,a,132,v,36
ds_read_b128 a[228:231], v11 offset:25600
buffer_load_dwordx4 v12, s[56:59], s71 offen offset:2048 sc1 lds
MV 144,a,136,v,24
ds_read_b128 a[232:235], v11 offset:26624
v_cvt_pk_bf16_f32 v114, v116, v117
MV 152,a,136,v,40
v_exp_f32 v120, v120
MV 148,a,152,v,24
ds_read_b128 a[236:239], v11 offset:27648
ds_read_b128 a[240:243], v11 offset:28672
MV 156,a,152,v,40
v_exp_f32 v121, v121
MV 176,a,168,v,24
ds_read_b128 a[244:247], v11 offset:29696
v_cvt_pk_bf16_f32 v115, v118, v119
MV 184,a,168,v,40
ds_read_b128 a[248:251], v11 offset:30720
buffer_load_dwordx4 v12, s[56:59], s71 offen offset:3072 sc1 lds
MV 180,a,184,v,24
v_exp_f32 v122, v122
MV 188,a,184,v,40
v_exp_f32 v123, v123
MV 180,a,188,v,28
ds_read_b128 a[252:255], v11 offset:31744
v_cvt_pk_bf16_f32 v120, v120, v121
MV 188,a,188,v,44
v_exp_f32 v124, v124
MV 176,a,172,v,28
v_exp_f32 v125, v125
MV 184,a,172,v,44
s_add_u32 s71, s71, 16384
v_cvt_pk_bf16_f32 v121, v122, v123
MV 148,a,156,v,28
v_exp_f32 v126, v126
MV 156,a,156,v,44
v_exp_f32 v127, v127
MV 144,a,140,v,28
v_cvt_pk_bf16_f32 v122, v124, v125
v_cvt_pk_bf16_f32 v123, v126, v127
MV 152,a,140,v,44
s_waitcnt vmcnt(16) lgkmcnt(0)
MA 0,a,192,v,80
s_barrier
MA 32,a,192,v,88
s_add_u32 m0, s72, 0
ds_read_b128 a[128:131], v10 offset:16384
MA 4,a,196,v,80
ds_read_b128 a[132:135], v10 offset:17408
buffer_load_dwordx4 v12, s[52:55], s71 offen offset:0 sc1 lds
MA 36,a,196,v,88
v_exp_f32 v144, v144
MA 8,a,200,v,80
v_exp_f32 v145, v145
MA 40,a,200,v,88
ds_read_b128 a[136:139], v10 offset:18432
ds_read_b128 a[140:143], v10 offset:19456
MA 12,a,204,v,80
v_exp_f32 v146, v146
MA 44,a,204,v,88
ds_read_b128 a[144:147], v10 offset:20480
buffer_load_dwordx4 v12, s[52:55], s71 offen offset:1024 sc1 lds
MV 164,v,160,v,80
v_exp_f32 v147, v147
MV 168,v,160,v,88
ds_read_b128 a[148:151], v10 offset:21504
v_cvt_pk_bf16_f32 v144, v144, v145
MA 16,a,208,v,80
v_exp_f32 v148, v148
MA 48,a,208,v,88
ds_read_b128 a[152:155], v10 offset:22528
ds_read_b128 a[156:159], v10 offset:23552
MA 20,a,212,v,80
v_exp_f32 v149, v149
MA 52,a,212,v,88
ds_read_b128 a[160:163], v10 offset:24576
v_cvt_pk_bf16_f32 v145, v146, v147
MA 24,a,216,v,80
v_exp_f32 v150, v150
MA 56,a,216,v,88
ds_read_b128 a[164:167], v10 offset:25600
buffer_load_dwordx4 v12, s[52:55], s71 offen offset:2048 sc1 lds
MA 28,a,220,v,80
v_exp_f32 v151, v151
MA 60,a,220,v,88
ds_read_b128 a[168:171], v10 offset:26624
v_cvt_pk_bf16_f32 v146, v148, v149
MA 0,a,224,v,112
ds_read_b128 a[172:175], v10 offset:27648
ds_read_b128 a[176:179], v10 offset:28672
MA 32,a,224,v,120
v_exp_f32 v152, v152
MA 4,a,228,v,112
v_exp_f32 v153, v153
MA 36,a,228,v,120
ds_read_b128 a[180:183], v10 offset:29696
v_cvt_pk_bf16_f32 v147, v150, v151
MA 8,a,232,v,112
ds_read_b128 a[184:187], v10 offset:30720
buffer_load_dwordx4 v12, s[52:55], s71 offen offset:3072 sc1 lds
MA 40,a,232,v,120
v_exp_f32 v154, v154
MA 12,a,236,v,112
v_exp_f32 v155, v155
MA 44,a,236,v,120
ds_read_b128 a[188:191], v10 offset:31744
v_cvt_pk_bf16_f32 v152, v152, v153
MV 164,v,160,v,112
v_exp_f32 v156, v156
MV 168,v,160,v,120
MA 16,a,240,v,112
v_exp_f32 v157, v157
MA 48,a,240,v,120
s_sub_u32 s74, s74, 1
v_cvt_pk_bf16_f32 v153, v154, v155
MA 20,a,244,v,112
v_exp_f32 v158, v158
MA 52,a,244,v,120
MA 24,a,248,v,112
v_exp_f32 v159, v159
MA 56,a,248,v,120
MA 28,a,252,v,112
v_cvt_pk_bf16_f32 v154, v156, v157
v_cvt_pk_bf16_f32 v155, v158, v159
MA 60,a,252,v,120
s_cbranch_scc1 L_p3_s1m_top
s_waitcnt lgkmcnt(0)
v_xor_b32 v11, 0x8000, v11
v_mfma_f32_16x16x32_bf16 v[80:83], a[128:131], v[16:19], 0
s_add_u32 m0, s73, 16384
ds_read_b128 a[192:195], v11 offset:0
v_mfma_f32_16x16x32_bf16 v[88:91], a[128:131], v[32:35], 0
v_exp_f32 v176, v176
v_mfma_f32_16x16x32_bf16 v[84:87], a[144:147], v[16:19], 0
ds_read_b128 a[196:199], v11 offset:1024
buffer_load_dwordx4 v12, s[56:59], s71 offen offset:0 sc1 lds
v_mfma_f32_16x16x32_bf16 v[92:95], a[144:147], v[32:35], 0
v_exp_f32 v177, v177
v_mfma_f32_16x16x32_bf16 v[112:115], a[160:163], v[16:19], 0
ds_read_b128 a[200:203], v11 offset:2048
ds_read_b128 a[204:207], v11 offset:3072
v_mfma_f32_16x16x32_bf16 v[120:123], a[160:163], v[32:35], 0
v_exp_f32 v178, v178
v_mfma_f32_16x16x32_bf16 v[116:119], a[176:179], v[16:19], 0
v_exp_f32 v179, v179
v_mfma_f32_16x16x32_bf16 v[124:127], a[176:179], v[32:35], 0
ds_read_b128 a[208:211], v11 offset:4096
buffer_load_dwordx4 v12, s[56:59], s71 offen offset:1024 sc1 lds
MV 116,a,180,v,20
ds_read_b128 a[212:215], v11 offset:5120
v_cvt_pk_bf16_f32 v176, v176, v177
MV 124,a,180,v,36
v_exp_f32 v180, v180
MV 112,a,164,v,20
v_exp_f32 v181, v181
MV 120,a,164,v,36
ds_read_b128 a[216:219], v11 offset:6144
ds_read_b128 a[220:223], v11 offset:7168
MV 84,a,148,v,20
buffer_load_dwordx4 v12, s[56:59], s71 offen offset:2048 sc1 lds
v_cvt_pk_bf16_f32 v177, v178, v179
MV 92,a,148,v,36
v_exp_f32 v182, v182
MV 80,a,132,v,20
ds_read_b128 a[224:227], v11 offset:8192
ds_read_b128 a[228:231], v11 offset:9216
MV 88,a,132,v,36
v_exp_f32 v183, v183
MV 80,a,136,v,24
ds_read_b128 a[232:235], v11 offset:10240
v_cvt_pk_bf16_f32 v178, v180, v181
MV 88,a,136,v,40
v_exp_f32 v184, v184
MV 84,a,152,v,24
ds_read_b128 a[236:239], v11 offset:11264
buffer_load_dwordx4 v12, s[56:59], s71 offen offset:3072 sc1 lds
MV 92,a,152,v,40
v_exp_f32 v185, v185
MV 112,a,168,v,24
ds_read_b128 a[240:243], v11 offset:12288
v_cvt_pk_bf16_f32 v179, v182, v183
MV 120,a,168,v,40
ds_read_b128 a[244:247], v11 offset:13312
ds_read_b128 a[248:251], v11 offset:14336
MV 116,a,184,v,24
v_exp_f32 v186, v186
MV 124,a,184,v,40
v_exp_f32 v187, v187
MV 116,a,188,v,28
ds_read_b128 a[252:255], v11 offset:15360
s_add_u32 s71, s71, 16384
MV 124,a,188,v,44
s_xor_b32 s73, s73, 0x8000
v_cvt_pk_bf16_f32 v184, v184, v185
MV 112,a,172,v,28
v_exp_f32 v188, v188
MV 120,a,172,v,44
v_exp_f32 v189, v189
MV 84,a,156,v,28
v_cvt_pk_bf16_f32 v185, v186, v187
MV 92,a,156,v,44
v_exp_f32 v190, v190
MV 80,a,140,v,28
v_exp_f32 v191, v191
MV 88,a,140,v,44
v_cvt_pk_bf16_f32 v186, v188, v189
v_cvt_pk_bf16_f32 v187, v190, v191
s_waitcnt vmcnt(16) lgkmcnt(0)
MA 0,a,192,v,144
s_barrier
v_xor_b32 v10, 0x8000, v10
MA 32,a,192,v,152
s_add_u32 m0, s72, 16384
ds_read_b128 a[128:131], v10 offset:0
MA 4,a,196,v,144
ds_read_b128 a[132:135], v10 offset:1024
buffer_load_dwordx4 v12, s[52:55], s71 offen offset:0 sc1 lds
MA 36,a,196,v,152
v_exp_f32 v80, v80
MA 8,a,200,v,144
v_exp_f32 v81, v81
MA 40,a,200,v,152
ds_read_b128 a[136:139], v10 offset:2048
ds_read_b128 a[140:143], v10 offset:3072
MA 12,a,204,v,144
v_exp_f32 v82, v82
MA 44,a,204,v,152
ds_read_b128 a[144:147], v10 offset:4096
buffer_load_dwordx4 v12, s[52:55], s71 offen offset:1024 sc1 lds
MV 164,v,160,v,144
v_exp_f32 v83, v83
MV 168,v,160,v,152
ds_read_b128 a[148:151], v10 offset:5120
v_cvt_pk_bf16_f32 v80, v80, v81
MA 16,a,208,v,144
v_exp_f32 v84, v84
MA 48,a,208,v,152
ds_read_b128 a[152:155], v10 offset:6144
buffer_load_dwordx4 v12, s[52:55], s71 offen offset:2048 sc1 lds
MA 20,a,212,v,144
v_exp_f32 v85, v85
MA 52,a,212,v,152
ds_read_b128 a[156:159], v10 offset:7168
v_cvt_pk_bf16_f32 v81, v82, v83
MA 24,a,216,v,144
v_exp_f32 v86, v86
MA 56,a,216,v,152
ds_read_b128 a[160:163], v10 offset:8192
ds_read_b128 a[164:167], v10 offset:9216
MA 28,a,220,v,144
v_exp_f32 v87, v87
MA 60,a,220,v,152
ds_read_b128 a[168:171], v10 offset:10240
buffer_load_dwordx4 v12, s[52:55], s71 offen offset:3072 sc1 lds
MA 0,a,224,v,176
ds_read_b128 a[172:175], v10 offset:11264
v_cvt_pk_bf16_f32 v82, v84, v85
MA 32,a,224,v,184
v_exp_f32 v88, v88
MA 4,a,228,v,176
v_exp_f32 v89, v89
MA 36,a,228,v,184
ds_read_b128 a[176:179], v10 offset:12288
s_xor_b32 s72, s72, 0x8000
MA 8,a,232,v,176
ds_read_b128 a[180:183], v10 offset:13312
v_cvt_pk_bf16_f32 v83, v86, v87
MA 40,a,232,v,184
v_exp_f32 v90, v90
MA 12,a,236,v,176
ds_read_b128 a[184:187], v10 offset:14336
ds_read_b128 a[188:191], v10 offset:15360
MA 44,a,236,v,184
v_exp_f32 v91, v91
MV 164,v,160,v,176
buffer_store_dword v217, v216, s[8:11], s37 offen offset:1024 sc1
v_cvt_pk_bf16_f32 v88, v88, v89
MV 168,v,160,v,184
v_exp_f32 v92, v92
MA 16,a,240,v,176
v_exp_f32 v93, v93
MA 48,a,240,v,184
MA 20,a,244,v,176
global_load_dword v174, v[172:173], off
v_cvt_pk_bf16_f32 v89, v90, v91
MA 52,a,244,v,184
v_exp_f32 v94, v94
MA 24,a,248,v,176
v_exp_f32 v95, v95
MA 56,a,248,v,184
MA 28,a,252,v,176
v_cvt_pk_bf16_f32 v90, v92, v93
v_cvt_pk_bf16_f32 v91, v94, v95
MA 60,a,252,v,184
s_branch L_p3_s0_top
L_p3_s1m_top:
s_waitcnt lgkmcnt(0)
v_xor_b32 v11, 0x8000, v11
v_mfma_f32_16x16x32_bf16 v[80:83], a[128:131], v[16:19], 0
ds_read_b128 a[192:195], v11 offset:0
ds_read_b128 a[196:199], v11 offset:1024
v_mfma_f32_16x16x32_bf16 v[88:91], a[128:131], v[32:35], 0
v_exp_f32 v176, v176
MV 80,a,132,v,20
v_exp_f32 v177, v177
MV 88,a,132,v,36
ds_read_b128 a[200:203], v11 offset:2048
ds_read_b128 a[204:207], v11 offset:3072
MV 80,a,136,v,24
v_exp_f32 v178, v178
MV 88,a,136,v,40
v_exp_f32 v179, v179
MV 80,a,140,v,28
ds_read_b128 a[208:211], v11 offset:4096
v_cvt_pk_bf16_f32 v176, v176, v177
MV 88,a,140,v,44
ds_read_b128 a[212:215], v11 offset:5120
ds_read_b128 a[216:219], v11 offset:6144
v_mfma_f32_16x16x32_bf16 v[84:87], a[144:147], v[16:19], 0
v_exp_f32 v180, v180
v_mfma_f32_16x16x32_bf16 v[92:95], a[144:147], v[32:35], 0
v_exp_f32 v181, v181
MV 84,a,148,v,20
ds_read_b128 a[220:223], v11 offset:7168
v_cvt_pk_bf16_f32 v177, v178, v179
MV 92,a,148,v,36
v_exp_f32 v182, v182
MV 84,a,152,v,24
ds_read_b128 a[224:227], v11 offset:8192
ds_read_b128 a[228:231], v11 offset:9216
MV 92,a,152,v,40
v_exp_f32 v183, v183
MV 84,a,156,v,28
ds_read_b128 a[232:235], v11 offset:10240
v_cvt_pk_bf16_f32 v178, v180, v181
MV 92,a,156,v,44
v_exp_f32 v184, v184
v_mfma_f32_16x16x32_bf16 v[112:115], a[160:163], v[16:19], 0
ds_read_b128 a[236:239], v11 offset:11264
ds_read_b128 a[240:243], v11 offset:12288
v_mfma_f32_16x16x32_bf16 v[120:123], a[160:163], v[32:35], 0
v_exp_f32 v185, v185
MV 112,a,164,v,20
ds_read_b128 a[244:247], v11 offset:13312
v_cvt_pk_bf16_f32 v179, v182, v183
MV 120,a,164,v,36
v_exp_f32 v186, v186
MV 112,a,168,v,24
v_exp_f32 v187, v187
MV 120,a,168,v,40
ds_read_b128 a[248:251], v11 offset:14336
ds_read_b128 a[252:255], v11 offset:15360
MV 112,a,172,v,28
v_cvt_pk_bf16_f32 v184, v184, v185
v_add_u32 v246, 0, v13
MV 120,a,172,v,44
v_cmp_gt_i32_e64 s[84:85], 0, v246
v_cmp_gt_i32_e64 s[86:87], 1, v246
v_mfma_f32_16x16x32_bf16 v[116:119], a[176:179], v[16:19], 0
v_exp_f32 v188, v188
v_mfma_f32_16x16x32_bf16 v[124:127], a[176:179], v[32:35], 0
v_cmp_gt_i32_e64 s[88:89], 2, v246
v_cmp_gt_i32_e64 s[90:91], 3, v246
MV 116,a,180,v,20
v_cndmask_b32_e64 v80, v80, v14, s[84:85]
v_cndmask_b32_e64 v81, v81, v14, s[86:87]
MV 124,a,180,v,36
v_exp_f32 v189, v189
MV 116,a,184,v,24
v_cvt_pk_bf16_f32 v185, v186, v187
v_cndmask_b32_e64 v82, v82, v14, s[88:89]
MV 124,a,184,v,40
v_cndmask_b32_e64 v83, v83, v14, s[90:91]
v_add_u32 v247, -16, v13
MV 116,a,188,v,28
v_cmp_gt_i32_e64 s[92:93], 0, v247
v_cmp_gt_i32_e64 s[94:95], 1, v247
MV 124,a,188,v,44
v_exp_f32 v190, v190
v_exp_f32 v191, v191
v_cmp_gt_i32_e64 s[96:97], 2, v247
v_cmp_gt_i32_e64 s[98:99], 3, v247
v_cndmask_b32_e64 v84, v84, v14, s[92:93]
v_cvt_pk_bf16_f32 v186, v188, v189
v_cndmask_b32_e64 v85, v85, v14, s[94:95]
v_cndmask_b32_e64 v86, v86, v14, s[96:97]
v_cvt_pk_bf16_f32 v187, v190, v191
v_cndmask_b32_e64 v87, v87, v14, s[98:99]
s_waitcnt vmcnt(12) lgkmcnt(0)
MA 0,a,192,v,144
s_barrier
v_xor_b32 v10, 0x8000, v10
MA 32,a,192,v,152
ds_read_b128 a[128:131], v10 offset:0
ds_read_b128 a[132:135], v10 offset:1024
MA 4,a,196,v,144
v_exp_f32 v80, v80
MA 36,a,196,v,152
v_exp_f32 v81, v81
MA 8,a,200,v,144
ds_read_b128 a[136:139], v10 offset:2048
ds_read_b128 a[140:143], v10 offset:3072
MA 40,a,200,v,152
v_exp_f32 v82, v82
MA 12,a,204,v,144
ds_read_b128 a[144:147], v10 offset:4096
v_add_u32 v246, -32, v13
MA 44,a,204,v,152
v_exp_f32 v83, v83
MV 164,v,160,v,144
v_cvt_pk_bf16_f32 v80, v80, v81
v_cmp_gt_i32_e64 s[84:85], 0, v246
MV 168,v,160,v,152
ds_read_b128 a[148:151], v10 offset:5120
v_cmp_gt_i32_e64 s[86:87], 1, v246
MA 16,a,208,v,144
v_exp_f32 v84, v84
MA 48,a,208,v,152
ds_read_b128 a[152:155], v10 offset:6144
v_cmp_gt_i32_e64 s[88:89], 2, v246
MA 20,a,212,v,144
v_exp_f32 v85, v85
MA 52,a,212,v,152
ds_read_b128 a[156:159], v10 offset:7168
v_cmp_gt_i32_e64 s[90:91], 3, v246
MA 24,a,216,v,144
ds_read_b128 a[160:163], v10 offset:8192
v_cvt_pk_bf16_f32 v81, v82, v83
MA 56,a,216,v,152
v_exp_f32 v86, v86
MA 28,a,220,v,144
ds_read_b128 a[164:167], v10 offset:9216
v_cndmask_b32_e64 v112, v112, v14, s[84:85]
MA 60,a,220,v,152
v_exp_f32 v87, v87
MA 0,a,224,v,176
ds_read_b128 a[168:171], v10 offset:10240
v_cndmask_b32_e64 v113, v113, v14, s[86:87]
MA 32,a,224,v,184
v_cvt_pk_bf16_f32 v82, v84, v85
v_cndmask_b32_e64 v114, v114, v14, s[88:89]
MA 4,a,228,v,176
ds_read_b128 a[172:175], v10 offset:11264
v_cndmask_b32_e64 v115, v115, v14, s[90:91]
MA 36,a,228,v,184
v_exp_f32 v88, v88
MA 8,a,232,v,176
v_exp_f32 v89, v89
MA 40,a,232,v,184
ds_read_b128 a[176:179], v10 offset:12288
v_cvt_pk_bf16_f32 v83, v86, v87
MA 12,a,236,v,176
ds_read_b128 a[180:183], v10 offset:13312
v_add_u32 v247, -48, v13
MA 44,a,236,v,184
ds_read_b128 a[184:187], v10 offset:14336
v_cmp_gt_i32_e64 s[92:93], 0, v247
MV 164,v,160,v,176
v_exp_f32 v90, v90
MV 168,v,160,v,184
ds_read_b128 a[188:191], v10 offset:15360
v_cmp_gt_i32_e64 s[94:95], 1, v247
MA 16,a,240,v,176
v_exp_f32 v91, v91
MA 48,a,240,v,184
v_cvt_pk_bf16_f32 v88, v88, v89
v_cmp_gt_i32_e64 s[96:97], 2, v247
MA 20,a,244,v,176
v_exp_f32 v92, v92
MA 52,a,244,v,184
v_cmp_gt_i32_e64 s[98:99], 3, v247
v_cndmask_b32_e64 v116, v116, v14, s[92:93]
MA 24,a,248,v,176
v_exp_f32 v93, v93
MA 56,a,248,v,184
v_cvt_pk_bf16_f32 v89, v90, v91
v_cndmask_b32_e64 v117, v117, v14, s[94:95]
MA 28,a,252,v,176
v_exp_f32 v94, v94
MA 60,a,252,v,184
v_exp_f32 v95, v95
v_cndmask_b32_e64 v118, v118, v14, s[96:97]
v_cvt_pk_bf16_f32 v90, v92, v93
v_cndmask_b32_e64 v119, v119, v14, s[98:99]
v_cvt_pk_bf16_f32 v91, v94, v95
L_p3_s0m_top:
s_waitcnt lgkmcnt(0)
v_mfma_f32_16x16x32_bf16 v[152:155], a[128:131], v[32:35], 0
ds_read_b128 a[192:195], v11 offset:16384
ds_read_b128 a[196:199], v11 offset:17408
MV 152,a,132,v,36
v_exp_f32 v112, v112
MV 152,a,136,v,40
v_exp_f32 v113, v113
MV 152,a,140,v,44
ds_read_b128 a[200:203], v11 offset:18432
ds_read_b128 a[204:207], v11 offset:19456
v_mfma_f32_16x16x32_bf16 v[156:159], a[144:147], v[32:35], 0
v_exp_f32 v114, v114
MV 156,a,148,v,36
v_exp_f32 v115, v115
MV 156,a,152,v,40
ds_read_b128 a[208:211], v11 offset:20480
ds_read_b128 a[212:215], v11 offset:21504
MV 156,a,156,v,44
ds_read_b128 a[216:219], v11 offset:22528
v_cvt_pk_bf16_f32 v112, v112, v113
v_mfma_f32_16x16x32_bf16 v[184:187], a[160:163], v[32:35], 0
v_exp_f32 v116, v116
MV 184,a,164,v,36
v_exp_f32 v117, v117
MV 184,a,168,v,40
ds_read_b128 a[220:223], v11 offset:23552
v_cvt_pk_bf16_f32 v113, v114, v115
MV 184,a,172,v,44
v_exp_f32 v118, v118
v_mfma_f32_16x16x32_bf16 v[188:191], a[176:179], v[32:35], 0
ds_read_b128 a[224:227], v11 offset:24576
ds_read_b128 a[228:231], v11 offset:25600
MV 188,a,180,v,36
v_exp_f32 v119, v119
MV 188,a,184,v,40
ds_read_b128 a[232:235], v11 offset:26624
v_cvt_pk_bf16_f32 v114, v116, v117
MV 188,a,188,v,44
ds_read_b128 a[236:239], v11 offset:27648
ds_read_b128 a[240:243], v11 offset:28672
ds_read_b128 a[244:247], v11 offset:29696
ds_read_b128 a[248:251], v11 offset:30720
ds_read_b128 a[252:255], v11 offset:31744
v_exp_f32 v120, v120
v_exp_f32 v121, v121
v_cvt_pk_bf16_f32 v115, v118, v119
v_exp_f32 v122, v122
v_exp_f32 v123, v123
v_cvt_pk_bf16_f32 v120, v120, v121
v_exp_f32 v124, v124
v_exp_f32 v125, v125
v_cvt_pk_bf16_f32 v121, v122, v123
v_exp_f32 v126, v126
v_exp_f32 v127, v127
v_add_u32 v246, -64, v239
v_cmp_gt_i32_e64 s[84:85], 0, v246
v_cmp_gt_i32_e64 s[86:87], 1, v246
v_cmp_gt_i32_e64 s[88:89], 2, v246
v_cmp_gt_i32_e64 s[90:91], 3, v246
v_cndmask_b32_e64 v152, v152, v14, s[84:85]
v_cndmask_b32_e64 v153, v153, v14, s[86:87]
v_cndmask_b32_e64 v154, v154, v14, s[88:89]
v_cndmask_b32_e64 v155, v155, v14, s[90:91]
v_cvt_pk_bf16_f32 v122, v124, v125
v_cvt_pk_bf16_f32 v123, v126, v127
v_add_u32 v247, -80, v239
v_cmp_gt_i32_e64 s[92:93], 0, v247
v_cmp_gt_i32_e64 s[94:95], 1, v247
v_cmp_gt_i32_e64 s[96:97], 2, v247
v_cmp_gt_i32_e64 s[98:99], 3, v247
v_cndmask_b32_e64 v156, v156, v14, s[92:93]
v_cndmask_b32_e64 v157, v157, v14, s[94:95]
v_cndmask_b32_e64 v158, v158, v14, s[96:97]
v_cndmask_b32_e64 v159, v159, v14, s[98:99]
s_waitcnt vmcnt(4) lgkmcnt(0)
MA 0,a,192,v,80
s_barrier
MA 32,a,192,v,88
MA 4,a,196,v,80
v_lshlrev_b32 v245, 4, v1
s_mov_b32 m0, s43
MA 36,a,196,v,88
v_exp_f32 v152, v152
MA 8,a,200,v,80
MA 40,a,200,v,88
v_exp_f32 v153, v153
MA 12,a,204,v,80
v_add_u32 v246, -96, v239
v_cmp_gt_i32_e64 s[84:85], 0, v246
MA 44,a,204,v,88
MV 164,v,160,v,80
v_exp_f32 v154, v154
MV 168,v,160,v,88
s_nop 0
v_cmp_gt_i32_e64 s[86:87], 1, v246
MA 16,a,208,v,80
MA 48,a,208,v,88
v_cmp_gt_i32_e64 s[88:89], 2, v246
v_cmp_gt_i32_e64 s[90:91], 3, v246
MA 20,a,212,v,80
v_exp_f32 v155, v155
MA 52,a,212,v,88
MA 24,a,216,v,80
v_cvt_pk_bf16_f32 v152, v152, v153
v_cndmask_b32_e64 v184, v184, v14, s[84:85]
MA 56,a,216,v,88
MA 28,a,220,v,80
buffer_load_dwordx4 v245, s[20:23], 0 offen offset:0 sc1 lds
v_cndmask_b32_e64 v185, v185, v14, s[86:87]
MA 60,a,220,v,88
v_exp_f32 v156, v156
MA 0,a,224,v,112
v_cndmask_b32_e64 v186, v186, v14, s[88:89]
v_cndmask_b32_e64 v187, v187, v14, s[90:91]
MA 32,a,224,v,120
MA 4,a,228,v,112
v_exp_f32 v157, v157
MA 36,a,228,v,120
buffer_load_dwordx4 v245, s[20:23], 0 offen offset:1024 sc1 lds
v_add_u32 v247, -112, v239
MA 8,a,232,v,112
v_cvt_pk_bf16_f32 v153, v154, v155
v_cmp_gt_i32_e64 s[92:93], 0, v247
MA 40,a,232,v,120
MA 12,a,236,v,112
buffer_load_dwordx4 v245, s[20:23], 0 offen offset:2048 sc1 lds
v_cmp_gt_i32_e64 s[94:95], 1, v247
MA 44,a,236,v,120
v_exp_f32 v158, v158
MV 164,v,160,v,112
v_cmp_gt_i32_e64 s[96:97], 2, v247
v_cmp_gt_i32_e64 s[98:99], 3, v247
MV 168,v,160,v,120
MA 16,a,240,v,112
MA 48,a,240,v,120
v_exp_f32 v159, v159
MA 20,a,244,v,112
buffer_load_dwordx4 v245, s[20:23], 0 offen offset:3072 sc1 lds
v_cndmask_b32_e64 v188, v188, v14, s[92:93]
MA 52,a,244,v,120
v_cvt_pk_bf16_f32 v154, v156, v157
v_cndmask_b32_e64 v189, v189, v14, s[94:95]
MA 24,a,248,v,112
v_cvt_pk_bf16_f32 v155, v158, v159
v_cndmask_b32_e64 v190, v190, v14, s[96:97]
MA 56,a,248,v,120
MA 28,a,252,v,112
v_cndmask_b32_e64 v191, v191, v14, s[98:99]
MA 60,a,252,v,120
s_load_dwordx2 s[88:89], s[0:1], 104
s_waitcnt lgkmcnt(0)
v_xor_b32 v11, 0x8000, v11
ds_read_b128 a[192:195], v11 offset:0
ds_read_b128 a[196:199], v11 offset:1024
ds_read_b128 a[200:203], v11 offset:2048
ds_read_b128 a[204:207], v11 offset:3072
ds_read_b128 a[208:211], v11 offset:4096
ds_read_b128 a[212:215], v11 offset:5120
ds_read_b128 a[216:219], v11 offset:6144
ds_read_b128 a[220:223], v11 offset:7168
ds_read_b128 a[224:227], v11 offset:8192
ds_read_b128 a[228:231], v11 offset:9216
ds_read_b128 a[232:235], v11 offset:10240
ds_read_b128 a[236:239], v11 offset:11264
ds_read_b128 a[240:243], v11 offset:12288
ds_read_b128 a[244:247], v11 offset:13312
ds_read_b128 a[248:251], v11 offset:14336
ds_read_b128 a[252:255], v11 offset:15360
v_exp_f32 v184, v184
v_exp_f32 v185, v185
v_exp_f32 v186, v186
v_exp_f32 v187, v187
v_cvt_pk_bf16_f32 v184, v184, v185
v_exp_f32 v188, v188
v_exp_f32 v189, v189
v_cvt_pk_bf16_f32 v185, v186, v187
v_exp_f32 v190, v190
v_exp_f32 v191, v191
v_cvt_pk_bf16_f32 v186, v188, v189
v_cvt_pk_bf16_f32 v187, v190, v191
MV 168,v,160,v,152
s_nop 0
MV 168,v,160,v,184
v_mov_b32 v240, v2
v_mov_b32 v241, v3
s_nop 0
v_permlane32_swap_b32 v2, v240
v_permlane32_swap_b32 v3, v241
v_add_f32 v2, v2, v240
v_add_f32 v3, v3, v241
v_mov_b32 v240, v2
v_mov_b32 v241, v3
s_nop 0
v_permlane16_swap_b32 v2, v240
v_permlane16_swap_b32 v3, v241
v_add_f32 v2, v2, v240
v_add_f32 v3, v3, v241
v_add_f32 v2, v2, v164
v_cmp_nle_f32 vcc, 0x30800000, v2
s_nop 0
s_or_b64 s[78:79], s[78:79], vcc
v_cmp_nge_f32 vcc, 0x4e800000, v2
s_nop 0
s_or_b64 s[78:79], s[78:79], vcc
v_add_f32 v3, v3, v168
v_cmp_nle_f32 vcc, 0x30800000, v3
s_nop 0
s_or_b64 s[78:79], s[78:79], vcc
v_cmp_nge_f32 vcc, 0x4e800000, v3
s_nop 0
s_or_b64 s[78:79], s[78:79], vcc
s_cmp_lg_u64 s[78:79], 0
s_cselect_b32 s80, 1, 0
v_mov_b32 v240, s80
s_lshl_b32 s80, s3, 2
s_add_u32 s80, s80, 163824
v_mov_b32 v241, s80
ds_write_b32 v241, v240
v_mov_b32 v241, 163824
s_waitcnt vmcnt(0) lgkmcnt(0)
s_barrier
ds_read_b128 v[244:247], v241
buffer_store_dword v217, v216, s[8:11], s37 offen offset:1024 sc1
MA 32,a,192,v,152
MA 36,a,196,v,152
MA 40,a,200,v,152
MA 44,a,204,v,152
MA 48,a,208,v,152
MA 52,a,212,v,152
s_waitcnt lgkmcnt(0)
v_or3_b32 v240, v244, v245, v246
v_or_b32 v240, v240, v247
MA 56,a,216,v,152
v_cmp_ne_u32 vcc, 0, v240
MA 60,a,220,v,152
MA 32,a,224,v,184
s_cbranch_vccnz L_fallback
MA 36,a,228,v,184
s_mul_i32 s36, s3, 8320
v_and_b32 v16, 15, v1
MA 40,a,232,v,184
v_lshrrev_b32 v17, 4, v1
v_add_u32 v18, 1, v16
MA 44,a,236,v,184
v_and_b32 v19, 1, v18
v_mul_u32_u24 v19, 4160, v19
MA 48,a,240,v,184
v_add_u32 v18, 2, v16
v_lshrrev_b32 v18, 1, v18
MA 52,a,244,v,184
v_lshl_add_u32 v19, v18, 2, v19
v_lshl_add_u32 v19, v17, 4, v19
MA 56,a,248,v,184
v_add_u32 v40, s36, v19
v_add_u32 v41, 1024, v40
MA 60,a,252,v,184
v_add_u32 v42, 2048, v40
v_add_u32 v43, 3072, v40
v_add_u32 v10, s36, v15
v_lshlrev_b32 v18, 5, v16
v_lshlrev_b32 v19, 4, v17
v_sub_u32 v19, v19, v18
s_add_u32 s37, s43, 480
v_add_u32 v5, s37, v19
v_mov_b32 v20, 0
v_mov_b32 v21, 0
v_mov_b32 v22, 0
v_mov_b32 v23, 0
v_and_b32 v16, 1, v1
v_mul_u32_u24 v16, 4160, v16
v_and_b32 v17, 2, v1
v_lshl_add_u32 v16, v17, 3, v16
v_add_u32 v16, s36, v16
ds_write_b128 v16, v[20:23]
v_and_b32 v17, 31, v1
v_lshlrev_b32 v17, 4, v17
v_add_u32 v17, s43, v17
ds_write_b128 v17, v[20:23] offset:4096
v_mov_b32 v18, 0
ds_write_b128 v10, v[208:211] offset:32
s_nop 0
v_mov_b32_dpp v18, v211 wave_shr:1 row_mask:0xf bank_mask:0xf
v_alignbit_b32 v24, v208, v18, 16
v_alignbit_b32 v25, v209, v208, 16
v_alignbit_b32 v26, v210, v209, 16
v_alignbit_b32 v27, v211, v210, 16
ds_write_b128 v10, v[24:27] offset:4192
v_mov_b32_dpp v18, v211 wave_ror:1 row_mask:0xf bank_mask:0xf
ds_write_b128 v10, v[212:215] offset:1056
s_nop 0
v_mov_b32_dpp v18, v215 wave_shr:1 row_mask:0xf bank_mask:0xf
v_alignbit_b32 v28, v212, v18, 16
v_alignbit_b32 v29, v213, v212, 16
v_alignbit_b32 v30, v214, v213, 16
v_alignbit_b32 v31, v215, v214, 16
ds_write_b128 v10, v[28:31] offset:5216
v_mov_b32_dpp v18, v215 wave_ror:1 row_mask:0xf bank_mask:0xf
ds_write_b128 v10, v[228:231] offset:2080
s_nop 0
v_mov_b32_dpp v18, v231 wave_shr:1 row_mask:0xf bank_mask:0xf
v_alignbit_b32 v24, v228, v18, 16
v_alignbit_b32 v25, v229, v228, 16
v_alignbit_b32 v26, v230, v229, 16
v_alignbit_b32 v27, v231, v230, 16
ds_write_b128 v10, v[24:27] offset:6240
v_mov_b32_dpp v18, v231 wave_ror:1 row_mask:0xf bank_mask:0xf
ds_write_b128 v10, v[234:237] offset:3104
s_nop 0
v_mov_b32_dpp v18, v237 wave_shr:1 row_mask:0xf bank_mask:0xf
v_alignbit_b32 v28, v234, v18, 16
v_alignbit_b32 v29, v235, v234, 16
v_alignbit_b32 v30, v236, v235, 16
v_alignbit_b32 v31, v237, v236, 16
ds_write_b128 v10, v[28:31] offset:7264
ds_read_b128 a[160:163], v5 offset:3584
ds_read2_b32 a[128:129], v40 offset0:0 offset1:1
ds_read2_b32 a[130:131], v40 offset0:2 offset1:3
ds_read_b128 a[164:167], v5 offset:3072
ds_read2_b32 a[132:133], v40 offset0:128 offset1:129
ds_read2_b32 a[134:135], v40 offset0:130 offset1:131
ds_read_b128 a[168:171], v5 offset:2560
ds_read2_b32 a[136:137], v41 offset0:0 offset1:1
ds_read2_b32 a[138:139], v41 offset0:2 offset1:3
ds_read_b128 a[172:175], v5 offset:2048
ds_read2_b32 a[140:141], v41 offset0:128 offset1:129
ds_read2_b32 a[142:143], v41 offset0:130 offset1:131
ds_read_b128 a[176:179], v5 offset:1536
ds_read2_b32 a[144:145], v42 offset0:0 offset1:1
ds_read2_b32 a[146:147], v42 offset0:2 offset1:3
ds_read_b128 a[180:183], v5 offset:1024
ds_read2_b32 a[148:149], v42 offset0:128 offset1:129
ds_read2_b32 a[150:151], v42 offset0:130 offset1:131
ds_read_b128 a[184:187], v5 offset:512
ds_read2_b32 a[152:153], v43 offset0:0 offset1:1
ds_read2_b32 a[154:155], v43 offset0:2 offset1:3
ds_read_b128 a[188:191], v5 offset:0
ds_read2_b32 a[156:157], v43 offset0:128 offset1:129
ds_read2_b32 a[158:159], v43 offset0:130 offset1:131
v_rcp_f32 v2, v2
v_rcp_f32 v3, v3
s_add_u32 s80, s100, s76
s_nop 4
v_accvgpr_read_b32 v240, a0
v_accvgpr_read_b32 v241, a1
v_accvgpr_read_b32 v242, a2
v_accvgpr_read_b32 v243, a3
v_accvgpr_read_b32 v244, a4
v_accvgpr_read_b32 v245, a5
v_accvgpr_read_b32 v246, a6
v_accvgpr_read_b32 v247, a7
v_pk_mul_f32 v[240:241], v[240:241], v[2:3] op_sel:[0,0] op_sel_hi:[1,0]
v_pk_mul_f32 v[242:243], v[242:243], v[2:3] op_sel:[0,0] op_sel_hi:[1,0]
v_pk_mul_f32 v[244:245], v[244:245], v[2:3] op_sel:[0,0] op_sel_hi:[1,0]
v_pk_mul_f32 v[246:247], v[246:247], v[2:3] op_sel:[0,0] op_sel_hi:[1,0]
v_cvt_pk_bf16_f32 v248, v240, v241
v_cvt_pk_bf16_f32 v249, v242, v243
v_cvt_pk_bf16_f32 v250, v244, v245
v_cvt_pk_bf16_f32 v251, v246, v247
buffer_store_dwordx4 v[248:251], v15, s[60:63], s100 offen offset:0 sc1
v_accvgpr_read_b32 v240, a8
v_accvgpr_read_b32 v241, a9
v_accvgpr_read_b32 v242, a10
v_accvgpr_read_b32 v243, a11
v_accvgpr_read_b32 v244, a12
v_accvgpr_read_b32 v245, a13
v_accvgpr_read_b32 v246, a14
v_accvgpr_read_b32 v247, a15
v_pk_mul_f32 v[240:241], v[240:241], v[2:3] op_sel:[0,0] op_sel_hi:[1,0]
v_pk_mul_f32 v[242:243], v[242:243], v[2:3] op_sel:[0,0] op_sel_hi:[1,0]
v_pk_mul_f32 v[244:245], v[244:245], v[2:3] op_sel:[0,0] op_sel_hi:[1,0]
v_pk_mul_f32 v[246:247], v[246:247], v[2:3] op_sel:[0,0] op_sel_hi:[1,0]
v_cvt_pk_bf16_f32 v252, v240, v241
v_cvt_pk_bf16_f32 v253, v242, v243
v_cvt_pk_bf16_f32 v254, v244, v245
v_cvt_pk_bf16_f32 v255, v246, v247
buffer_store_dwordx4 v[252:255], v15, s[60:63], s100 offen offset:1024 sc1
v_accvgpr_read_b32 v240, a16
v_accvgpr_read_b32 v241, a17
v_accvgpr_read_b32 v242, a18
v_accvgpr_read_b32 v243, a19
v_accvgpr_read_b32 v244, a20
v_accvgpr_read_b32 v245, a21
v_accvgpr_read_b32 v246, a22
v_accvgpr_read_b32 v247, a23
v_pk_mul_f32 v[240:241], v[240:241], v[2:3] op_sel:[0,0] op_sel_hi:[1,0]
v_pk_mul_f32 v[242:243], v[242:243], v[2:3] op_sel:[0,0] op_sel_hi:[1,0]
v_pk_mul_f32 v[244:245], v[244:245], v[2:3] op_sel:[0,0] op_sel_hi:[1,0]
v_pk_mul_f32 v[246:247], v[246:247], v[2:3] op_sel:[0,0] op_sel_hi:[1,0]
v_cvt_pk_bf16_f32 v248, v240, v241
v_cvt_pk_bf16_f32 v249, v242, v243
v_cvt_pk_bf16_f32 v250, v244, v245
v_cvt_pk_bf16_f32 v251, v246, v247
buffer_store_dwordx4 v[248:251], v15, s[60:63], s100 offen offset:2048 sc1
v_accvgpr_read_b32 v240, a24
v_accvgpr_read_b32 v241, a25
v_accvgpr_read_b32 v242, a26
v_accvgpr_read_b32 v243, a27
v_accvgpr_read_b32 v244, a28
v_accvgpr_read_b32 v245, a29
v_accvgpr_read_b32 v246, a30
v_accvgpr_read_b32 v247, a31
v_pk_mul_f32 v[240:241], v[240:241], v[2:3] op_sel:[0,0] op_sel_hi:[1,0]
v_pk_mul_f32 v[242:243], v[242:243], v[2:3] op_sel:[0,0] op_sel_hi:[1,0]
v_pk_mul_f32 v[244:245], v[244:245], v[2:3] op_sel:[0,0] op_sel_hi:[1,0]
v_pk_mul_f32 v[246:247], v[246:247], v[2:3] op_sel:[0,0] op_sel_hi:[1,0]
v_cvt_pk_bf16_f32 v252, v240, v241
v_cvt_pk_bf16_f32 v253, v242, v243
v_cvt_pk_bf16_f32 v254, v244, v245
v_cvt_pk_bf16_f32 v255, v246, v247
buffer_store_dwordx4 v[252:255], v15, s[60:63], s100 offen offset:3072 sc1
v_accvgpr_read_b32 v240, a32
v_accvgpr_read_b32 v241, a33
v_accvgpr_read_b32 v242, a34
v_accvgpr_read_b32 v243, a35
v_accvgpr_read_b32 v244, a36
v_accvgpr_read_b32 v245, a37
v_accvgpr_read_b32 v246, a38
v_accvgpr_read_b32 v247, a39
v_pk_mul_f32 v[240:241], v[240:241], v[2:3] op_sel:[0,1] op_sel_hi:[1,1]
v_pk_mul_f32 v[242:243], v[242:243], v[2:3] op_sel:[0,1] op_sel_hi:[1,1]
v_pk_mul_f32 v[244:245], v[244:245], v[2:3] op_sel:[0,1] op_sel_hi:[1,1]
v_pk_mul_f32 v[246:247], v[246:247], v[2:3] op_sel:[0,1] op_sel_hi:[1,1]
v_cvt_pk_bf16_f32 v248, v240, v241
v_cvt_pk_bf16_f32 v249, v242, v243
v_cvt_pk_bf16_f32 v250, v244, v245
v_cvt_pk_bf16_f32 v251, v246, v247
buffer_store_dwordx4 v[248:251], v15, s[60:63], s80 offen offset:0 sc1
v_accvgpr_read_b32 v240, a40
v_accvgpr_read_b32 v241, a41
v_accvgpr_read_b32 v242, a42
v_accvgpr_read_b32 v243, a43
v_accvgpr_read_b32 v244, a44
v_accvgpr_read_b32 v245, a45
v_accvgpr_read_b32 v246, a46
v_accvgpr_read_b32 v247, a47
v_pk_mul_f32 v[240:241], v[240:241], v[2:3] op_sel:[0,1] op_sel_hi:[1,1]
v_pk_mul_f32 v[242:243], v[242:243], v[2:3] op_sel:[0,1] op_sel_hi:[1,1]
v_pk_mul_f32 v[244:245], v[244:245], v[2:3] op_sel:[0,1] op_sel_hi:[1,1]
v_pk_mul_f32 v[246:247], v[246:247], v[2:3] op_sel:[0,1] op_sel_hi:[1,1]
v_cvt_pk_bf16_f32 v252, v240, v241
v_cvt_pk_bf16_f32 v253, v242, v243
v_cvt_pk_bf16_f32 v254, v244, v245
v_cvt_pk_bf16_f32 v255, v246, v247
buffer_store_dwordx4 v[252:255], v15, s[60:63], s80 offen offset:1024 sc1
v_accvgpr_read_b32 v240, a48
v_accvgpr_read_b32 v241, a49
v_accvgpr_read_b32 v242, a50
v_accvgpr_read_b32 v243, a51
v_accvgpr_read_b32 v244, a52
v_accvgpr_read_b32 v245, a53
v_accvgpr_read_b32 v246, a54
v_accvgpr_read_b32 v247, a55
v_pk_mul_f32 v[240:241], v[240:241], v[2:3] op_sel:[0,1] op_sel_hi:[1,1]
v_pk_mul_f32 v[242:243], v[242:243], v[2:3] op_sel:[0,1] op_sel_hi:[1,1]
v_pk_mul_f32 v[244:245], v[244:245], v[2:3] op_sel:[0,1] op_sel_hi:[1,1]
v_pk_mul_f32 v[246:247], v[246:247], v[2:3] op_sel:[0,1] op_sel_hi:[1,1]
v_cvt_pk_bf16_f32 v248, v240, v241
v_cvt_pk_bf16_f32 v249, v242, v243
v_cvt_pk_bf16_f32 v250, v244, v245
v_cvt_pk_bf16_f32 v251, v246, v247
buffer_store_dwordx4 v[248:251], v15, s[60:63], s80 offen offset:2048 sc1
v_accvgpr_read_b32 v240, a56
v_accvgpr_read_b32 v241, a57
v_accvgpr_read_b32 v242, a58
v_accvgpr_read_b32 v243, a59
v_accvgpr_read_b32 v244, a60
v_accvgpr_read_b32 v245, a61
v_accvgpr_read_b32 v246, a62
v_accvgpr_read_b32 v247, a63
v_pk_mul_f32 v[240:241], v[240:241], v[2:3] op_sel:[0,1] op_sel_hi:[1,1]
v_pk_mul_f32 v[242:243], v[242:243], v[2:3] op_sel:[0,1] op_sel_hi:[1,1]
v_pk_mul_f32 v[244:245], v[244:245], v[2:3] op_sel:[0,1] op_sel_hi:[1,1]
v_pk_mul_f32 v[246:247], v[246:247], v[2:3] op_sel:[0,1] op_sel_hi:[1,1]
v_cvt_pk_bf16_f32 v252, v240, v241
v_cvt_pk_bf16_f32 v253, v242, v243
v_cvt_pk_bf16_f32 v254, v244, v245
v_cvt_pk_bf16_f32 v255, v246, v247
buffer_store_dwordx4 v[252:255], v15, s[60:63], s80 offen offset:3072 sc1
L_p3_done:
s_nop 1
v_lshlrev_b32 v255, 20, v1
v_mov_b32 v253, 1
s_lshl_b32 s83, s3, 8
s_add_u32 s83, s83, s2
s_lshl_b32 s83, s83, 2
s_add_u32 s83, s83, 4096
s_waitcnt lgkmcnt(15)
v_mfma_f32_16x16x32_bf16 v[76:79], a[128:131], a[160:163], 0
v_and_b32 v16, 15, v1
v_lshrrev_b32 v17, 4, v1
v_mfma_f32_16x16x32_bf16 v[80:83], a[128:131], a[164:167], 0
v_lshl_add_u32 v18, v17, 3, v16
ds_read_b128 a[224:227], v5 offset:3648
v_mfma_f32_16x16x32_bf16 v[84:87], a[128:131], a[168:171], 0
v_sub_u32 v233, 15, v18
ds_read2_b32 a[192:193], v40 offset0:16 offset1:17
s_waitcnt lgkmcnt(15)
v_mfma_f32_16x16x32_bf16 v[88:91], a[128:131], a[172:175], 0
v_lshlrev_b32 v18, 16, v232
ds_read2_b32 a[194:195], v40 offset0:18 offset1:19
s_waitcnt lgkmcnt(14)
v_mfma_f32_16x16x32_bf16 v[92:95], a[128:131], a[176:179], 0
v_cmp_eq_u32 vcc, 0, v233
v_cmp_eq_u32_e64 s[38:39], 1, v233
s_waitcnt lgkmcnt(11)
v_mfma_f32_16x16x32_bf16 v[96:99], a[128:131], a[180:183], 0
ds_read_b128 a[228:231], v5 offset:3136
ds_read2_b32 a[196:197], v40 offset0:144 offset1:145
s_waitcnt lgkmcnt(10)
v_mfma_f32_16x16x32_bf16 v[100:103], a[128:131], a[184:187], 0
s_nop 0
v_cndmask_b32 v44, 0, v232, vcc
s_waitcnt lgkmcnt(7)
v_mfma_f32_16x16x32_bf16 v[104:107], a[128:131], a[188:191], 0
ds_read2_b32 a[198:199], v40 offset0:146 offset1:147
ds_read_b128 a[232:235], v5 offset:2624
MV 80,a,132,a,160
v_cndmask_b32_e64 v44, v44, v18, s[38:39]
ds_read2_b32 a[200:201], v41 offset0:16 offset1:17
MV 84,a,132,a,164
v_cmp_eq_u32 vcc, 2, v233
v_cmp_eq_u32_e64 s[38:39], 3, v233
MV 88,a,132,a,168
ds_read2_b32 a[202:203], v41 offset0:18 offset1:19
s_and_b32 s81, s2, 3
MV 92,a,132,a,172
s_nop 0
v_cndmask_b32 v45, 0, v232, vcc
MV 96,a,132,a,176
ds_read_b128 a[236:239], v5 offset:2112
ds_read2_b32 a[204:205], v41 offset0:144 offset1:145
MV 100,a,132,a,180
v_cndmask_b32_e64 v45, v45, v18, s[38:39]
ds_read2_b32 a[206:207], v41 offset0:146 offset1:147
MV 104,a,132,a,184
v_cmp_eq_u32 vcc, 4, v233
v_cmp_eq_u32_e64 s[38:39], 5, v233
MV 84,a,136,a,160
ds_read_b128 a[240:243], v5 offset:1600
s_lshl_b32 s81, s81, 1
MV 88,a,136,a,164
s_nop 0
v_cndmask_b32 v46, 0, v232, vcc
MV 92,a,136,a,168
ds_read2_b32 a[208:209], v42 offset0:16 offset1:17
ds_read2_b32 a[210:211], v42 offset0:18 offset1:19
MV 96,a,136,a,172
v_cndmask_b32_e64 v46, v46, v18, s[38:39]
ds_read_b128 a[244:247], v5 offset:1088
MV 100,a,136,a,176
v_cmp_eq_u32 vcc, 6, v233
v_cmp_eq_u32_e64 s[38:39], 7, v233
MV 104,a,136,a,180
ds_read2_b32 a[212:213], v42 offset0:144 offset1:145
s_sub_u32 s74, 14, s81
MV 88,a,140,a,160
s_nop 0
v_cndmask_b32 v47, 0, v232, vcc
MV 92,a,140,a,164
ds_read2_b32 a[214:215], v42 offset0:146 offset1:147
ds_read_b128 a[248:251], v5 offset:576
MV 96,a,140,a,168
v_cndmask_b32_e64 v47, v47, v18, s[38:39]
ds_read2_b32 a[216:217], v43 offset0:16 offset1:17
MV 100,a,140,a,172
s_bitcmp1_b32 s2, 4
s_cselect_b32 s81, s74, s81
MV 104,a,140,a,176
ds_read2_b32 a[218:219], v43 offset0:18 offset1:19
s_bfe_u32 s74, s2, 0x10003
MV 92,a,144,a,160
ds_read_b128 a[252:255], v5 offset:64
s_add_u32 s81, s81, s74
MV 96,a,144,a,164
ds_read2_b32 a[220:221], v43 offset0:144 offset1:145
s_bfe_u32 s82, s2, 0x10002
MV 100,a,144,a,168
ds_read2_b32 a[222:223], v43 offset0:146 offset1:147
s_lshr_b32 s74, s2, 5
MV 104,a,144,a,172
s_lshl_b32 s74, s74, 1
s_add_u32 s82, s82, s74
MV 96,a,148,a,160
s_mov_b32 s72, s81
s_mov_b32 s73, s82
MV 100,a,148,a,164
s_lshl_b32 s74, s72, 2
s_add_u32 s74, s74, s3
MV 104,a,148,a,168
s_lshl_b32 s68, s74, 18
MV 100,a,152,a,160
MV 104,a,152,a,164
s_and_b32 s80, s73, 1
s_waitcnt lgkmcnt(15)
MV 104,a,156,a,160
MV 76,v,44,a,160
s_lshl_b32 s75, s80, 16
MV 80,v,44,a,164
MV 84,v,44,a,168
s_add_u32 s68, s68, s75
MV 88,v,44,a,172
MV 92,v,44,a,176
s_lshl_b32 s69, s73, 19
MV 96,v,44,a,180
MV 100,v,44,a,184
MV 104,v,44,a,188
s_waitcnt vmcnt(0)
buffer_store_dword v253, v255, s[8:11], s83 offen sc1
MV 76,a,192,a,224
ds_read_b128 a[160:163], v5 offset:3712
s_lshl_b32 s75, s73, 7
MV 80,a,196,a,224
ds_read2_b32 a[128:129], v40 offset0:32 offset1:33
s_lshl_b32 s70, s3, 12
MV 80,a,192,a,228
ds_read2_b32 a[130:131], v40 offset0:34 offset1:35
s_lshl_b32 s78, s74, 16
MV 84,a,196,a,228
ds_read_b128 a[164:167], v5 offset:3200
s_add_u32 s78, s78, s75
MV 84,a,192,a,232
s_lshl_b32 s79, s73, 18
s_lshl_b32 s75, s74, 8
MV 88,a,196,a,232
ds_read2_b32 a[132:133], v40 offset0:160 offset1:161
s_add_u32 s79, s79, s75
s_waitcnt lgkmcnt(15)
MV 88,a,192,a,236
ds_read2_b32 a[134:135], v40 offset0:162 offset1:163
v_lshlrev_b32 v236, 4, v1
MV 92,a,196,a,236
ds_read_b128 a[168:171], v5 offset:2688
v_add_u32 v237, 0x20000, v236
MV 92,a,192,a,240
ds_read2_b32 a[136:137], v41 offset0:32 offset1:33
v_add_u32 v238, s70, v236
MV 96,a,196,a,240
s_lshl_b32 s75, s80, 12
v_add_u32 v244, s75, v236
s_waitcnt lgkmcnt(15)
MV 96,a,192,a,244
ds_read2_b32 a[138:139], v41 offset0:34 offset1:35
v_xor_b32 v245, 0x1000, v244
MV 100,a,196,a,244
ds_read_b128 a[172:175], v5 offset:2176
v_add_u32 v242, 66560, v244
s_waitcnt lgkmcnt(15)
MV 100,a,192,a,248
ds_read2_b32 a[140:141], v41 offset0:160 offset1:161
v_add_u32 v243, 66560, v245
MV 104,a,196,a,248
ds_read2_b32 a[142:143], v41 offset0:162 offset1:163
v_bfe_u32 v50, v1, 4, 1
s_waitcnt lgkmcnt(14)
MV 104,a,192,a,252
v_lshrrev_b32 v52, 5, v1
v_and_b32 v48, 15, v1
MV 84,a,200,a,224
ds_read_b128 a[176:179], v5 offset:1664
v_lshlrev_b32 v53, 5, v50
MV 88,a,204,a,224
ds_read2_b32 a[144:145], v42 offset0:32 offset1:33
v_lshl_add_u32 v53, v52, 4, v53
MV 88,a,200,a,228
ds_read2_b32 a[146:147], v42 offset0:34 offset1:35
v_lshl_add_u32 v250, v48, 11, v53
MV 92,a,204,a,228
ds_read_b128 a[180:183], v5 offset:1152
v_lshlrev_b32 v53, 11, v53
MV 92,a,200,a,232
v_lshl_add_u32 v251, v48, 3, v53
MV 96,a,204,a,232
ds_read2_b32 a[148:149], v42 offset0:160 offset1:161
MV 96,a,200,a,236
ds_read2_b32 a[150:151], v42 offset0:162 offset1:163
MV 100,a,204,a,236
ds_read_b128 a[184:187], v5 offset:640
MV 100,a,200,a,240
ds_read2_b32 a[152:153], v43 offset0:32 offset1:33
MV 104,a,204,a,240
s_add_u32 s44, s40, 33554432
s_addc_u32 s45, s41, 0
MV 104,a,200,a,244
ds_read2_b32 a[154:155], v43 offset0:34 offset1:35
s_mov_b32 s46, 16777216
MV 92,a,208,a,224
ds_read_b128 a[188:191], v5 offset:128
s_mov_b32 s47, 0x20000
MV 96,a,212,a,224
ds_read2_b32 a[156:157], v43 offset0:160 offset1:161
MV 96,a,208,a,228
ds_read2_b32 a[158:159], v43 offset0:162 offset1:163
MV 100,a,212,a,228
s_add_u32 s48, s40, 100663296
s_addc_u32 s49, s41, 0
MV 100,a,208,a,232
s_mov_b32 s50, 8388608
s_mov_b32 s51, 0x20000
MV 104,a,212,a,232
s_add_u32 s52, s40, 109051904
s_addc_u32 s53, s41, 0
MV 104,a,208,a,236
s_mov_b32 s54, 4194304
s_mov_b32 s55, 0x20000
MV 100,a,216,a,224
s_add_u32 s56, s40, 54525952
s_addc_u32 s57, s41, 0
s_waitcnt lgkmcnt(15)
MV 104,a,220,a,224
s_mov_b32 s58, 4194304
s_mov_b32 s59, 0x20000
MV 104,a,216,a,228
s_mov_b32 s60, s88
s_mov_b32 s61, s89
s_mov_b32 s62, 4194304
s_mov_b32 s63, 0x20000
s_lshr_b32 s36, s82, 1
s_lshl_b32 s37, s80, 7
s_add_u32 s36, s36, s37
v_lshl_add_u32 v254, v1, 3, s36
s_xor_b32 s36, s2, 4
v_mov_b32 v253, s36
v_cmp_lt_u32 vcc, 15, v1
s_nop 1
v_cndmask_b32 v254, v254, v253, vcc
v_lshlrev_b32 v254, 2, v254
buffer_load_dword v253, v254, s[8:11], 0 offen offset:1024 sc1
MV 76,a,128,a,160
ds_read_b128 a[224:227], v5 offset:3776
s_sub_u32 s36, 15, s81
MV 80,a,132,a,160
ds_read2_b32 a[192:193], v40 offset0:48 offset1:49
s_min_u32 s36, s36, s81
MV 80,a,128,a,164
ds_read2_b32 a[194:195], v40 offset0:50 offset1:51
MV 84,a,132,a,164
ds_read_b128 a[228:231], v5 offset:3264
s_lshr_b32 s37, s36, 1
MV 84,a,128,a,168
MV 88,a,132,a,168
ds_read2_b32 a[196:197], v40 offset0:176 offset1:177
s_xor_b32 s36, s36, s37
s_waitcnt lgkmcnt(15)
MV 88,a,128,a,172
ds_read2_b32 a[198:199], v40 offset0:178 offset1:179
s_and_b32 s36, s36, 1
MV 92,a,132,a,172
ds_read_b128 a[232:235], v5 offset:2752
MV 92,a,128,a,176
ds_read2_b32 a[200:201], v41 offset0:48 offset1:49
s_lshl_b32 s37, s37, 6
MV 96,a,132,a,176
s_waitcnt lgkmcnt(15)
MV 96,a,128,a,180
ds_read2_b32 a[202:203], v41 offset0:50 offset1:51
s_add_u32 s36, s36, s37
MV 100,a,132,a,180
ds_read_b128 a[236:239], v5 offset:2240
s_lshl_b32 s37, s80, 2
s_waitcnt lgkmcnt(15)
MV 100,a,128,a,184
ds_read2_b32 a[204:205], v41 offset0:176 offset1:177
MV 104,a,132,a,184
ds_read2_b32 a[206:207], v41 offset0:178 offset1:179
s_add_u32 s36, s36, s37
s_waitcnt lgkmcnt(14)
MV 104,a,128,a,188
MV 84,a,136,a,160
ds_read_b128 a[240:243], v5 offset:1728
s_add_u32 s36, s36, 1024
MV 88,a,140,a,160
ds_read2_b32 a[208:209], v42 offset0:48 offset1:49
v_bfe_u32 v228, v1, 4, 1
MV 88,a,136,a,164
ds_read2_b32 a[210:211], v42 offset0:50 offset1:51
MV 92,a,140,a,164
ds_read_b128 a[244:247], v5 offset:1216
v_lshl_add_u32 v228, s3, 1, v228
MV 92,a,136,a,168
MV 96,a,140,a,168
ds_read2_b32 a[212:213], v42 offset0:176 offset1:177
v_sub_u32 v229, 7, v228
MV 96,a,136,a,172
ds_read2_b32 a[214:215], v42 offset0:178 offset1:179
v_min_u32 v228, v228, v229
MV 100,a,140,a,172
ds_read_b128 a[248:251], v5 offset:704
MV 100,a,136,a,176
ds_read2_b32 a[216:217], v43 offset0:48 offset1:49
v_lshl_add_u32 v229, v228, 8, s36
MV 104,a,140,a,176
MV 104,a,136,a,180
ds_read2_b32 a[218:219], v43 offset0:50 offset1:51
v_and_b32 v252, 7, v1
MV 92,a,144,a,160
ds_read_b128 a[252:255], v5 offset:192
v_lshlrev_b32 v252, 3, v252
MV 96,a,148,a,160
ds_read2_b32 a[220:221], v43 offset0:176 offset1:177
MV 96,a,144,a,164
ds_read2_b32 a[222:223], v43 offset0:178 offset1:179
v_bfe_u32 v228, v1, 3, 1
MV 100,a,148,a,164
MV 100,a,144,a,168
v_lshlrev_b32 v228, 1, v228
MV 104,a,148,a,168
v_add3_u32 v252, v252, v228, v229
MV 104,a,144,a,172
MV 100,a,152,a,160
v_lshlrev_b32 v252, 2, v252
s_waitcnt lgkmcnt(15)
MV 104,a,156,a,160
MV 104,a,152,a,164
s_waitcnt vmcnt(0)
v_cmp_gt_u32 vcc, 1, v253
s_nop 4
s_cbranch_vccnz L_spin_w
L_spin_w_ret:
MV 76,a,192,a,224
ds_read_b128 a[160:163], v5 offset:3840
s_add_u32 m0, s70, 66560
MV 80,a,196,a,224
ds_read2_b32 a[128:129], v40 offset0:64 offset1:65
v_lshlrev_b32 v255, 20, v1
MV 80,a,192,a,228
ds_read2_b32 a[130:131], v40 offset0:66 offset1:67
buffer_load_dwordx4 v238, s[48:51], s69 offen offset:0 sc1 lds
MV 84,a,196,a,228
ds_read_b128 a[164:167], v5 offset:3328
MV 84,a,192,a,232
MV 88,a,196,a,232
ds_read2_b32 a[132:133], v40 offset0:192 offset1:193
buffer_load_dwordx4 v238, s[48:51], s69 offen offset:1024 sc1 lds
s_waitcnt lgkmcnt(15)
MV 88,a,192,a,236
ds_read2_b32 a[134:135], v40 offset0:194 offset1:195
MV 92,a,196,a,236
ds_read_b128 a[168:171], v5 offset:2816
MV 92,a,192,a,240
ds_read2_b32 a[136:137], v41 offset0:64 offset1:65
buffer_load_dwordx4 v238, s[48:51], s69 offen offset:2048 sc1 lds
MV 96,a,196,a,240
s_waitcnt lgkmcnt(15)
MV 96,a,192,a,244
ds_read2_b32 a[138:139], v41 offset0:66 offset1:67
MV 100,a,196,a,244
ds_read_b128 a[172:175], v5 offset:2304
buffer_load_dwordx4 v238, s[48:51], s69 offen offset:3072 sc1 lds
s_waitcnt lgkmcnt(15)
MV 100,a,192,a,248
ds_read2_b32 a[140:141], v41 offset0:192 offset1:193
s_lshl_b32 s36, s3, 26
MV 104,a,196,a,248
ds_read2_b32 a[142:143], v41 offset0:194 offset1:195
s_waitcnt lgkmcnt(14)
MV 104,a,192,a,252
s_add_u32 s69, s69, 16384
MV 84,a,200,a,224
ds_read_b128 a[176:179], v5 offset:1792
MV 88,a,204,a,224
ds_read2_b32 a[144:145], v42 offset0:64 offset1:65
MV 88,a,200,a,228
ds_read2_b32 a[146:147], v42 offset0:66 offset1:67
s_add_u32 m0, s70, 82944
MV 92,a,204,a,228
ds_read_b128 a[180:183], v5 offset:1280
MV 92,a,200,a,232
MV 96,a,204,a,232
ds_read2_b32 a[148:149], v42 offset0:192 offset1:193
buffer_load_dwordx4 v238, s[48:51], s69 offen offset:0 sc1 lds
MV 96,a,200,a,236
ds_read2_b32 a[150:151], v42 offset0:194 offset1:195
MV 100,a,204,a,236
ds_read_b128 a[184:187], v5 offset:768
MV 100,a,200,a,240
ds_read2_b32 a[152:153], v43 offset0:64 offset1:65
buffer_load_dwordx4 v238, s[48:51], s69 offen offset:1024 sc1 lds
MV 104,a,204,a,240
v_add_u32 v255, s36, v255
MV 104,a,200,a,244
ds_read2_b32 a[154:155], v43 offset0:66 offset1:67
MV 92,a,208,a,224
ds_read_b128 a[188:191], v5 offset:256
buffer_load_dwordx4 v238, s[48:51], s69 offen offset:2048 sc1 lds
MV 96,a,212,a,224
ds_read2_b32 a[156:157], v43 offset0:192 offset1:193
MV 96,a,208,a,228
ds_read2_b32 a[158:159], v43 offset0:194 offset1:195
MV 100,a,212,a,228
buffer_load_dwordx4 v238, s[48:51], s69 offen offset:3072 sc1 lds
MV 100,a,208,a,232
MV 104,a,212,a,232
MV 104,a,208,a,236
s_add_u32 s69, s69, 16384
MV 100,a,216,a,224
s_waitcnt lgkmcnt(15)
MV 104,a,220,a,224
MV 104,a,216,a,228
MV 76,a,128,a,160
ds_read_b128 a[224:227], v5 offset:3904
s_add_u32 m0, s70, 99328
MV 80,a,132,a,160
ds_read2_b32 a[192:193], v40 offset0:80 offset1:81
v_mul_u32_u24 v18, 136, v16
MV 80,a,128,a,164
ds_read2_b32 a[194:195], v40 offset0:82 offset1:83
v_lshl_add_u32 v18, v17, 5, v18
MV 84,a,132,a,164
ds_read_b128 a[228:231], v5 offset:3392
MV 84,a,128,a,168
MV 88,a,132,a,168
ds_read2_b32 a[196:197], v40 offset0:208 offset1:209
buffer_load_dwordx4 v238, s[48:51], s69 offen offset:0 sc1 lds
s_waitcnt lgkmcnt(15)
MV 88,a,128,a,172
ds_read2_b32 a[198:199], v40 offset0:210 offset1:211
s_lshl_b32 s37, s3, 1
MV 92,a,132,a,172
ds_read_b128 a[232:235], v5 offset:2880
s_add_u32 s37, s37, 49152
MV 92,a,128,a,176
ds_read2_b32 a[200:201], v41 offset0:80 offset1:81
MV 96,a,132,a,176
s_waitcnt lgkmcnt(15)
MV 96,a,128,a,180
ds_read2_b32 a[202:203], v41 offset0:82 offset1:83
v_add_u32 v11, s37, v18
MV 100,a,132,a,180
ds_read_b128 a[236:239], v5 offset:2368
buffer_load_dwordx4 v238, s[48:51], s69 offen offset:1024 sc1 lds
s_waitcnt lgkmcnt(15)
MV 100,a,128,a,184
ds_read2_b32 a[204:205], v41 offset0:208 offset1:209
v_lshrrev_b32 v18, 3, v1
MV 104,a,132,a,184
ds_read2_b32 a[206:207], v41 offset0:210 offset1:211
s_waitcnt lgkmcnt(14)
MV 104,a,128,a,188
MV 84,a,136,a,160
ds_read_b128 a[240:243], v5 offset:1856
v_mul_u32_u24 v18, 136, v18
MV 88,a,140,a,160
ds_read2_b32 a[208:209], v42 offset0:80 offset1:81
MV 88,a,136,a,164
ds_read2_b32 a[210:211], v42 offset0:82 offset1:83
buffer_load_dwordx4 v238, s[48:51], s69 offen offset:2048 sc1 lds
MV 92,a,140,a,164
ds_read_b128 a[244:247], v5 offset:1344
v_and_b32 v19, 7, v1
MV 92,a,136,a,168
MV 96,a,140,a,168
ds_read2_b32 a[212:213], v42 offset0:208 offset1:209
v_lshl_add_u32 v18, v19, 4, v18
MV 96,a,136,a,172
ds_read2_b32 a[214:215], v42 offset0:210 offset1:211
MV 100,a,140,a,172
ds_read_b128 a[248:251], v5 offset:832
s_mul_i32 s37, s3, 4352
MV 100,a,136,a,176
ds_read2_b32 a[216:217], v43 offset0:80 offset1:81
buffer_load_dwordx4 v238, s[48:51], s69 offen offset:3072 sc1 lds
MV 104,a,140,a,176
MV 104,a,136,a,180
ds_read2_b32 a[218:219], v43 offset0:82 offset1:83
s_add_u32 s37, s37, 49152
MV 92,a,144,a,160
ds_read_b128 a[252:255], v5 offset:320
MV 96,a,148,a,160
ds_read2_b32 a[220:221], v43 offset0:208 offset1:209
v_add_u32 v12, s37, v18
MV 96,a,144,a,164
ds_read2_b32 a[222:223], v43 offset0:210 offset1:211
MV 100,a,148,a,164
s_add_u32 s69, s69, 16384
MV 100,a,144,a,168
s_lshl_b32 s37, s3, 12
MV 104,a,148,a,168
MV 104,a,144,a,172
v_add_u32 v13, s37, v15
MV 100,a,152,a,160
s_waitcnt lgkmcnt(15)
MV 104,a,156,a,160
MV 104,a,152,a,164
buffer_load_dword v253, v252, s[8:11], 0 offen sc1
MV 76,a,192,a,224
ds_read_b128 a[160:163], v5 offset:3968
MV 80,a,196,a,224
ds_read2_b32 a[128:129], v40 offset0:96 offset1:97
MV 80,a,192,a,228
ds_read2_b32 a[130:131], v40 offset0:98 offset1:99
MV 84,a,196,a,228
ds_read_b128 a[164:167], v5 offset:3456
MV 84,a,192,a,232
MV 88,a,196,a,232
ds_read2_b32 a[132:133], v40 offset0:224 offset1:225
s_waitcnt lgkmcnt(15)
MV 88,a,192,a,236
ds_read2_b32 a[134:135], v40 offset0:226 offset1:227
MV 92,a,196,a,236
ds_read_b128 a[168:171], v5 offset:2944
MV 92,a,192,a,240
ds_read2_b32 a[136:137], v41 offset0:96 offset1:97
MV 96,a,196,a,240
s_waitcnt lgkmcnt(15)
MV 96,a,192,a,244
ds_read2_b32 a[138:139], v41 offset0:98 offset1:99
MV 100,a,196,a,244
ds_read_b128 a[172:175], v5 offset:2432
s_waitcnt lgkmcnt(15)
MV 100,a,192,a,248
ds_read2_b32 a[140:141], v41 offset0:224 offset1:225
MV 104,a,196,a,248
ds_read2_b32 a[142:143], v41 offset0:226 offset1:227
s_waitcnt lgkmcnt(14)
MV 104,a,192,a,252
MV 84,a,200,a,224
ds_read_b128 a[176:179], v5 offset:1920
MV 88,a,204,a,224
ds_read2_b32 a[144:145], v42 offset0:96 offset1:97
MV 88,a,200,a,228
ds_read2_b32 a[146:147], v42 offset0:98 offset1:99
MV 92,a,204,a,228
ds_read_b128 a[180:183], v5 offset:1408
MV 92,a,200,a,232
MV 96,a,204,a,232
ds_read2_b32 a[148:149], v42 offset0:224 offset1:225
MV 96,a,200,a,236
ds_read2_b32 a[150:151], v42 offset0:226 offset1:227
MV 100,a,204,a,236
ds_read_b128 a[184:187], v5 offset:896
MV 100,a,200,a,240
ds_read2_b32 a[152:153], v43 offset0:96 offset1:97
MV 104,a,204,a,240
MV 104,a,200,a,244
ds_read2_b32 a[154:155], v43 offset0:98 offset1:99
MV 92,a,208,a,224
ds_read_b128 a[188:191], v5 offset:384
MV 96,a,212,a,224
ds_read2_b32 a[156:157], v43 offset0:224 offset1:225
MV 96,a,208,a,228
ds_read2_b32 a[158:159], v43 offset0:226 offset1:227
MV 100,a,212,a,228
MV 100,a,208,a,232
MV 104,a,212,a,232
MV 104,a,208,a,236
MV 100,a,216,a,224
s_waitcnt lgkmcnt(15)
MV 104,a,220,a,224
MV 104,a,216,a,228
s_waitcnt vmcnt(0)
v_cmp_gt_u32 vcc, 1, v253
s_nop 4
s_cbranch_vccnz L_spin_f2
L_spin_f2_ret:
buffer_load_dwordx4 a[0:3], v236, s[44:47], s68 offen offset:0 sc1
buffer_load_dwordx4 a[4:7], v237, s[44:47], s68 offen offset:0 sc1
buffer_load_dwordx4 a[8:11], v236, s[44:47], s68 offen offset:1024 sc1
buffer_load_dwordx4 a[12:15], v237, s[44:47], s68 offen offset:1024 sc1
s_add_u32 s68, s68, 2048
MV 76,a,128,a,160
ds_read_b128 a[224:227], v5 offset:4032
buffer_load_dwordx4 a[16:19], v236, s[44:47], s68 offen offset:0 sc1
MV 80,a,132,a,160
ds_read2_b32 a[192:193], v40 offset0:112 offset1:113
MV 80,a,128,a,164
ds_read2_b32 a[194:195], v40 offset0:114 offset1:115
buffer_load_dwordx4 a[20:23], v237, s[44:47], s68 offen offset:0 sc1
MV 84,a,132,a,164
ds_read_b128 a[228:231], v5 offset:3520
MV 84,a,128,a,168
buffer_load_dwordx4 a[24:27], v236, s[44:47], s68 offen offset:1024 sc1
MV 88,a,132,a,168
ds_read2_b32 a[196:197], v40 offset0:240 offset1:241
s_waitcnt lgkmcnt(15)
MV 88,a,128,a,172
ds_read2_b32 a[198:199], v40 offset0:242 offset1:243
MV 92,a,132,a,172
ds_read_b128 a[232:235], v5 offset:3008
buffer_load_dwordx4 a[28:31], v237, s[44:47], s68 offen offset:1024 sc1
MV 92,a,128,a,176
ds_read2_b32 a[200:201], v41 offset0:112 offset1:113
MV 96,a,132,a,176
s_add_u32 s68, s68, 2048
s_waitcnt lgkmcnt(15)
MV 96,a,128,a,180
ds_read2_b32 a[202:203], v41 offset0:114 offset1:115
MV 100,a,132,a,180
ds_read_b128 a[236:239], v5 offset:2496
buffer_load_dwordx4 a[32:35], v236, s[44:47], s68 offen offset:0 sc1
s_waitcnt lgkmcnt(15)
MV 100,a,128,a,184
ds_read2_b32 a[204:205], v41 offset0:240 offset1:241
MV 104,a,132,a,184
ds_read2_b32 a[206:207], v41 offset0:242 offset1:243
s_waitcnt lgkmcnt(14)
MV 104,a,128,a,188
buffer_load_dwordx4 a[36:39], v237, s[44:47], s68 offen offset:0 sc1
MV 84,a,136,a,160
ds_read_b128 a[240:243], v5 offset:1984
MV 88,a,140,a,160
ds_read2_b32 a[208:209], v42 offset0:112 offset1:113
buffer_load_dwordx4 a[40:43], v236, s[44:47], s68 offen offset:1024 sc1
MV 88,a,136,a,164
ds_read2_b32 a[210:211], v42 offset0:114 offset1:115
MV 92,a,140,a,164
ds_read_b128 a[244:247], v5 offset:1472
buffer_load_dwordx4 a[44:47], v237, s[44:47], s68 offen offset:1024 sc1
MV 92,a,136,a,168
MV 96,a,140,a,168
ds_read2_b32 a[212:213], v42 offset0:240 offset1:241
MV 96,a,136,a,172
ds_read2_b32 a[214:215], v42 offset0:242 offset1:243
s_add_u32 s68, s68, 2048
MV 100,a,140,a,172
ds_read_b128 a[248:251], v5 offset:960
MV 100,a,136,a,176
ds_read2_b32 a[216:217], v43 offset0:112 offset1:113
buffer_load_dwordx4 a[48:51], v236, s[44:47], s68 offen offset:0 sc1
MV 104,a,140,a,176
MV 104,a,136,a,180
ds_read2_b32 a[218:219], v43 offset0:114 offset1:115
buffer_load_dwordx4 a[52:55], v237, s[44:47], s68 offen offset:0 sc1
MV 92,a,144,a,160
ds_read_b128 a[252:255], v5 offset:448
MV 96,a,148,a,160
ds_read2_b32 a[220:221], v43 offset0:240 offset1:241
MV 96,a,144,a,164
ds_read2_b32 a[222:223], v43 offset0:242 offset1:243
buffer_load_dwordx4 a[56:59], v236, s[44:47], s68 offen offset:1024 sc1
MV 100,a,148,a,164
MV 100,a,144,a,168
buffer_load_dwordx4 a[60:63], v237, s[44:47], s68 offen offset:1024 sc1
MV 104,a,148,a,168
MV 104,a,144,a,172
s_add_u32 s68, s68, 2048
MV 100,a,152,a,160
s_waitcnt lgkmcnt(15)
MV 104,a,156,a,160
MV 104,a,152,a,164
s_waitcnt lgkmcnt(0)
s_barrier
ds_read_b128 a[64:67], v242 offset:0
ds_read_b128 a[68:71], v242 offset:1024
ds_read_b128 a[72:75], v242 offset:2048
ds_read_b128 a[76:79], v242 offset:3072
ds_read_b128 a[80:83], v243 offset:0
ds_read_b128 a[84:87], v243 offset:1024
ds_read_b128 a[88:91], v243 offset:2048
ds_read_b128 a[92:95], v243 offset:3072
s_waitcnt lgkmcnt(0)
s_waitcnt vmcnt(15)
v_mfma_f32_16x16x32_bf16 v[124:127], a[64:67], a[0:3], 0
ds_read_b128 a[96:99], v242 offset:8192
MV 76,a,192,a,224
s_add_u32 m0, s70, 115712
s_waitcnt vmcnt(14)
v_mfma_f32_16x16x32_bf16 v[128:131], a[64:67], a[4:7], 0
ds_read_b128 a[100:103], v242 offset:9216
MV 80,a,196,a,224
v_mfma_f32_16x16x32_bf16 v[132:135], a[68:71], a[0:3], 0
MV 80,a,192,a,228
ds_read_b128 a[104:107], v242 offset:10240
v_mfma_f32_16x16x32_bf16 v[136:139], a[68:71], a[4:7], 0
v_mfma_f32_16x16x32_bf16 v[140:143], a[72:75], a[0:3], 0
ds_read_b128 a[108:111], v242 offset:11264
MV 84,a,196,a,228
v_mfma_f32_16x16x32_bf16 v[144:147], a[72:75], a[4:7], 0
buffer_load_dwordx4 v238, s[48:51], s69 offen offset:0 sc1 lds
MV 84,a,192,a,232
ds_read_b128 a[112:115], v243 offset:8192
v_mfma_f32_16x16x32_bf16 v[148:151], a[76:79], a[0:3], 0
MV 88,a,196,a,232
v_mfma_f32_16x16x32_bf16 v[152:155], a[76:79], a[4:7], 0
ds_read_b128 a[116:119], v243 offset:9216
v_mfma_f32_16x16x32_bf16 v[156:159], a[80:83], a[0:3], 0
MV 88,a,192,a,236
ds_read_b128 a[120:123], v243 offset:10240
v_mfma_f32_16x16x32_bf16 v[160:163], a[80:83], a[4:7], 0
MV 92,a,196,a,236
buffer_load_dwordx4 v238, s[48:51], s69 offen offset:1024 sc1 lds
v_mfma_f32_16x16x32_bf16 v[164:167], a[84:87], a[0:3], 0
ds_read_b128 a[124:127], v243 offset:11264
MV 92,a,192,a,240
v_mfma_f32_16x16x32_bf16 v[168:171], a[84:87], a[4:7], 0
v_mfma_f32_16x16x32_bf16 v[172:175], a[88:91], a[0:3], 0
MV 96,a,196,a,240
v_mfma_f32_16x16x32_bf16 v[176:179], a[88:91], a[4:7], 0
MV 96,a,192,a,244
v_mfma_f32_16x16x32_bf16 v[180:183], a[92:95], a[0:3], 0
buffer_load_dwordx4 a[0:3], v236, s[44:47], s68 offen offset:0 sc1
MV 100,a,196,a,244
v_mfma_f32_16x16x32_bf16 v[184:187], a[92:95], a[4:7], 0
buffer_load_dwordx4 a[4:7], v237, s[44:47], s68 offen offset:0 sc1
s_waitcnt lgkmcnt(0)
s_barrier
s_waitcnt vmcnt(17)
MV 124,a,96,a,8
ds_read_b128 a[64:67], v242 offset:16384
MV 100,a,192,a,248
buffer_load_dwordx4 v238, s[48:51], s69 offen offset:2048 sc1 lds
s_waitcnt vmcnt(17)
MV 128,a,96,a,12
ds_read_b128 a[68:71], v242 offset:17408
MV 104,a,196,a,248
MV 132,a,100,a,8
MV 104,a,192,a,252
ds_read_b128 a[72:75], v242 offset:18432
MV 136,a,100,a,12
MV 140,a,104,a,8
ds_read_b128 a[76:79], v242 offset:19456
MV 84,a,200,a,224
MV 144,a,104,a,12
buffer_load_dwordx4 v238, s[48:51], s69 offen offset:3072 sc1 lds
MV 88,a,204,a,224
ds_read_b128 a[80:83], v243 offset:16384
MV 148,a,108,a,8
MV 88,a,200,a,228
MV 152,a,108,a,12
ds_read_b128 a[84:87], v243 offset:17408
MV 156,a,112,a,8
MV 92,a,204,a,228
ds_read_b128 a[88:91], v243 offset:18432
MV 160,a,112,a,12
MV 92,a,200,a,232
s_add_u32 s69, s69, 16384
MV 164,a,116,a,8
ds_read_b128 a[92:95], v243 offset:19456
MV 96,a,204,a,232
MV 168,a,116,a,12
MV 172,a,120,a,8
MV 96,a,200,a,236
MV 176,a,120,a,12
MV 100,a,204,a,236
MV 180,a,124,a,8
buffer_load_dwordx4 a[8:11], v236, s[44:47], s68 offen offset:1024 sc1
MV 100,a,200,a,240
MV 184,a,124,a,12
buffer_load_dwordx4 a[12:15], v237, s[44:47], s68 offen offset:1024 sc1
s_add_u32 s68, s68, 2048
s_waitcnt lgkmcnt(0)
s_waitcnt vmcnt(19)
MV 124,a,64,a,16
ds_read_b128 a[96:99], v242 offset:24576
MV 104,a,204,a,240
s_add_u32 m0, s70, 66560
s_waitcnt vmcnt(18)
MV 128,a,64,a,20
ds_read_b128 a[100:103], v242 offset:25600
MV 104,a,200,a,244
MV 132,a,68,a,16
MV 92,a,208,a,224
ds_read_b128 a[104:107], v242 offset:26624
MV 136,a,68,a,20
MV 140,a,72,a,16
ds_read_b128 a[108:111], v242 offset:27648
MV 96,a,212,a,224
MV 144,a,72,a,20
buffer_load_dwordx4 v238, s[48:51], s69 offen offset:0 sc1 lds
MV 96,a,208,a,228
ds_read_b128 a[112:115], v243 offset:24576
MV 148,a,76,a,16
MV 100,a,212,a,228
MV 152,a,76,a,20
ds_read_b128 a[116:119], v243 offset:25600
MV 156,a,80,a,16
MV 100,a,208,a,232
ds_read_b128 a[120:123], v243 offset:26624
MV 160,a,80,a,20
MV 104,a,212,a,232
buffer_load_dwordx4 v238, s[48:51], s69 offen offset:1024 sc1 lds
MV 164,a,84,a,16
ds_read_b128 a[124:127], v243 offset:27648
MV 104,a,208,a,236
MV 168,a,84,a,20
MV 172,a,88,a,16
MV 100,a,216,a,224
MV 176,a,88,a,20
MV 104,a,220,a,224
MV 180,a,92,a,16
buffer_load_dwordx4 a[16:19], v236, s[44:47], s68 offen offset:0 sc1
MV 104,a,216,a,228
MV 184,a,92,a,20
buffer_load_dwordx4 a[20:23], v237, s[44:47], s68 offen offset:0 sc1
s_waitcnt lgkmcnt(0)
s_barrier
s_waitcnt vmcnt(21)
MV 124,a,96,a,24
ds_read_b128 a[64:67], v242 offset:32768
s_waitcnt vmcnt(20)
MV 128,a,96,a,28
ds_read_b128 a[68:71], v242 offset:33792
buffer_load_dwordx4 v238, s[48:51], s69 offen offset:2048 sc1 lds
MV 132,a,100,a,24
MV 136,a,100,a,28
ds_read_b128 a[72:75], v242 offset:34816
MV 140,a,104,a,24
ds_read_b128 a[76:79], v242 offset:35840
MV 144,a,104,a,28
buffer_load_dwordx4 v238, s[48:51], s69 offen offset:3072 sc1 lds
MV 148,a,108,a,24
ds_read_b128 a[80:83], v243 offset:32768
MV 152,a,108,a,28
ds_read_b128 a[84:87], v243 offset:33792
MV 156,a,112,a,24
MV 160,a,112,a,28
ds_read_b128 a[88:91], v243 offset:34816
s_add_u32 s69, s69, 16384
MV 164,a,116,a,24
ds_read_b128 a[92:95], v243 offset:35840
MV 168,a,116,a,28
MV 172,a,120,a,24
MV 176,a,120,a,28
MV 180,a,124,a,24
buffer_load_dwordx4 a[24:27], v236, s[44:47], s68 offen offset:1024 sc1
MV 184,a,124,a,28
buffer_load_dwordx4 a[28:31], v237, s[44:47], s68 offen offset:1024 sc1
s_add_u32 s68, s68, 2048
s_waitcnt lgkmcnt(0)
s_waitcnt vmcnt(23)
MV 124,a,64,a,32
ds_read_b128 a[96:99], v242 offset:40960
v_cvt_pk_bf16_f32 v16, v76, v77
s_waitcnt vmcnt(22)
MV 128,a,64,a,36
ds_read_b128 a[100:103], v242 offset:41984
s_add_u32 m0, s70, 82944
MV 132,a,68,a,32
v_cvt_pk_bf16_f32 v17, v78, v79
MV 136,a,68,a,36
ds_read_b128 a[104:107], v242 offset:43008
ds_write_b16 v11, v16 offset:0
MV 140,a,72,a,32
ds_read_b128 a[108:111], v242 offset:44032
MV 144,a,72,a,36
buffer_load_dwordx4 v238, s[48:51], s69 offen offset:0 sc1 lds
ds_write_b16_d16_hi v11, v16 offset:8
MV 148,a,76,a,32
ds_read_b128 a[112:115], v243 offset:40960
MV 152,a,76,a,36
ds_read_b128 a[116:119], v243 offset:41984
ds_write_b16 v11, v17 offset:16
MV 156,a,80,a,32
ds_write_b16_d16_hi v11, v17 offset:24
MV 160,a,80,a,36
ds_read_b128 a[120:123], v243 offset:43008
buffer_load_dwordx4 v238, s[48:51], s69 offen offset:1024 sc1 lds
MV 164,a,84,a,32
ds_read_b128 a[124:127], v243 offset:44032
v_cvt_pk_bf16_f32 v18, v80, v81
MV 168,a,84,a,36
MV 172,a,88,a,32
v_cvt_pk_bf16_f32 v19, v82, v83
MV 176,a,88,a,36
MV 180,a,92,a,32
buffer_load_dwordx4 a[32:35], v236, s[44:47], s68 offen offset:0 sc1
ds_write_b16 v11, v18 offset:2176
MV 184,a,92,a,36
buffer_load_dwordx4 a[36:39], v237, s[44:47], s68 offen offset:0 sc1
s_waitcnt vmcnt(14) lgkmcnt(0)
s_barrier
MV 124,a,96,a,40
ds_read_b128 a[64:67], v242 offset:49152
ds_write_b16_d16_hi v11, v18 offset:2184
MV 128,a,96,a,44
ds_read_b128 a[68:71], v242 offset:50176
buffer_load_dwordx4 v238, s[48:51], s69 offen offset:2048 sc1 lds
MV 132,a,100,a,40
ds_write_b16 v11, v19 offset:2192
MV 136,a,100,a,44
ds_read_b128 a[72:75], v242 offset:51200
ds_write_b16_d16_hi v11, v19 offset:2200
MV 140,a,104,a,40
ds_read_b128 a[76:79], v242 offset:52224
v_cvt_pk_bf16_f32 v16, v84, v85
MV 144,a,104,a,44
buffer_load_dwordx4 v238, s[48:51], s69 offen offset:3072 sc1 lds
MV 148,a,108,a,40
ds_read_b128 a[80:83], v243 offset:49152
v_cvt_pk_bf16_f32 v17, v86, v87
MV 152,a,108,a,44
ds_read_b128 a[84:87], v243 offset:50176
MV 156,a,112,a,40
ds_write_b16 v11, v16 offset:4352
MV 160,a,112,a,44
ds_read_b128 a[88:91], v243 offset:51200
s_add_u32 s69, s69, 16384
MV 164,a,116,a,40
ds_read_b128 a[92:95], v243 offset:52224
ds_write_b16_d16_hi v11, v16 offset:4360
MV 168,a,116,a,44
ds_write_b16 v11, v17 offset:4368
MV 172,a,120,a,40
ds_write_b16_d16_hi v11, v17 offset:4376
MV 176,a,120,a,44
MV 180,a,124,a,40
buffer_load_dwordx4 a[40:43], v236, s[44:47], s68 offen offset:1024 sc1
v_cvt_pk_bf16_f32 v18, v88, v89
MV 184,a,124,a,44
buffer_load_dwordx4 a[44:47], v237, s[44:47], s68 offen offset:1024 sc1
s_add_u32 s68, s68, 2048
s_waitcnt lgkmcnt(0)
MV 124,a,64,a,48
ds_read_b128 a[96:99], v242 offset:57344
v_cvt_pk_bf16_f32 v19, v90, v91
MV 128,a,64,a,52
ds_read_b128 a[100:103], v242 offset:58368
s_add_u32 m0, s70, 99328
MV 132,a,68,a,48
ds_write_b16 v11, v18 offset:6528
MV 136,a,68,a,52
ds_read_b128 a[104:107], v242 offset:59392
ds_write_b16_d16_hi v11, v18 offset:6536
MV 140,a,72,a,48
ds_read_b128 a[108:111], v242 offset:60416
MV 144,a,72,a,52
buffer_load_dwordx4 v238, s[48:51], s69 offen offset:0 sc1 lds
ds_write_b16 v11, v19 offset:6544
MV 148,a,76,a,48
ds_read_b128 a[112:115], v243 offset:57344
MV 152,a,76,a,52
ds_read_b128 a[116:119], v243 offset:58368
ds_write_b16_d16_hi v11, v19 offset:6552
MV 156,a,80,a,48
v_cvt_pk_bf16_f32 v16, v92, v93
MV 160,a,80,a,52
ds_read_b128 a[120:123], v243 offset:59392
buffer_load_dwordx4 v238, s[48:51], s69 offen offset:1024 sc1 lds
MV 164,a,84,a,48
ds_read_b128 a[124:127], v243 offset:60416
v_cvt_pk_bf16_f32 v17, v94, v95
MV 168,a,84,a,52
MV 172,a,88,a,48
ds_write_b16 v11, v16 offset:8704
MV 176,a,88,a,52
MV 180,a,92,a,48
buffer_load_dwordx4 a[48:51], v236, s[44:47], s68 offen offset:0 sc1
ds_write_b16_d16_hi v11, v16 offset:8712
MV 184,a,92,a,52
buffer_load_dwordx4 a[52:55], v237, s[44:47], s68 offen offset:0 sc1
s_waitcnt vmcnt(14) lgkmcnt(0)
s_barrier
MV 124,a,96,a,56
ds_read_b128 a[64:67], v242 offset:0
ds_write_b16 v11, v17 offset:8720
MV 128,a,96,a,60
ds_read_b128 a[68:71], v242 offset:1024
buffer_load_dwordx4 v238, s[48:51], s69 offen offset:2048 sc1 lds
MV 132,a,100,a,56
ds_write_b16_d16_hi v11, v17 offset:8728
MV 136,a,100,a,60
ds_read_b128 a[72:75], v242 offset:2048
v_cvt_pk_bf16_f32 v18, v96, v97
MV 140,a,104,a,56
ds_read_b128 a[76:79], v242 offset:3072
v_cvt_pk_bf16_f32 v19, v98, v99
MV 144,a,104,a,60
buffer_load_dwordx4 v238, s[48:51], s69 offen offset:3072 sc1 lds
MV 148,a,108,a,56
ds_read_b128 a[80:83], v243 offset:0
ds_write_b16 v11, v18 offset:10880
MV 152,a,108,a,60
ds_read_b128 a[84:87], v243 offset:1024
MV 156,a,112,a,56
ds_write_b16_d16_hi v11, v18 offset:10888
MV 160,a,112,a,60
ds_read_b128 a[88:91], v243 offset:2048
s_add_u32 s69, s69, 16384
MV 164,a,116,a,56
ds_read_b128 a[92:95], v243 offset:3072
ds_write_b16 v11, v19 offset:10896
MV 168,a,116,a,60
ds_write_b16_d16_hi v11, v19 offset:10904
MV 172,a,120,a,56
v_cvt_pk_bf16_f32 v16, v100, v101
MV 176,a,120,a,60
MV 180,a,124,a,56
buffer_load_dwordx4 a[56:59], v236, s[44:47], s68 offen offset:1024 sc1
v_cvt_pk_bf16_f32 v17, v102, v103
MV 184,a,124,a,60
buffer_load_dwordx4 a[60:63], v237, s[44:47], s68 offen offset:1024 sc1
s_add_u32 s68, s68, 2048
s_waitcnt lgkmcnt(0)
MV 124,a,64,a,0
ds_read_b128 a[96:99], v242 offset:8192
ds_write_b16 v11, v16 offset:13056
MV 128,a,64,a,4
ds_read_b128 a[100:103], v242 offset:9216
s_add_u32 m0, s70, 115712
MV 132,a,68,a,0
ds_write_b16_d16_hi v11, v16 offset:13064
MV 136,a,68,a,4
ds_read_b128 a[104:107], v242 offset:10240
ds_write_b16 v11, v17 offset:13072
MV 140,a,72,a,0
ds_read_b128 a[108:111], v242 offset:11264
ds_write_b16_d16_hi v11, v17 offset:13080
MV 144,a,72,a,4
buffer_load_dwordx4 v238, s[48:51], s69 offen offset:0 sc1 lds
MV 148,a,76,a,0
ds_read_b128 a[112:115], v243 offset:8192
v_cvt_pk_bf16_f32 v18, v104, v105
MV 152,a,76,a,4
ds_read_b128 a[116:119], v243 offset:9216
MV 156,a,80,a,0
v_cvt_pk_bf16_f32 v19, v106, v107
MV 160,a,80,a,4
ds_read_b128 a[120:123], v243 offset:10240
buffer_load_dwordx4 v238, s[48:51], s69 offen offset:1024 sc1 lds
MV 164,a,84,a,0
ds_read_b128 a[124:127], v243 offset:11264
ds_write_b16 v11, v18 offset:15232
MV 168,a,84,a,4
ds_write_b16_d16_hi v11, v18 offset:15240
MV 172,a,88,a,0
ds_write_b16 v11, v19 offset:15248
MV 176,a,88,a,4
MV 180,a,92,a,0
buffer_load_dwordx4 a[0:3], v236, s[44:47], s68 offen offset:0 sc1
ds_write_b16_d16_hi v11, v19 offset:15256
MV 184,a,92,a,4
buffer_load_dwordx4 a[4:7], v237, s[44:47], s68 offen offset:0 sc1
s_waitcnt vmcnt(14) lgkmcnt(0)
s_barrier
MV 124,a,96,a,8
ds_read_b128 a[64:67], v242 offset:16384
ds_read_b64 v[108:109], v12 offset:0
MV 128,a,96,a,12
ds_read_b128 a[68:71], v242 offset:17408
buffer_load_dwordx4 v238, s[48:51], s69 offen offset:2048 sc1 lds
MV 132,a,100,a,8
ds_read_b64 v[110:111], v12 offset:8
MV 136,a,100,a,12
ds_read_b128 a[72:75], v242 offset:18432
MV 140,a,104,a,8
ds_read_b128 a[76:79], v242 offset:19456
ds_read_b64 v[112:113], v12 offset:1088
MV 144,a,104,a,12
buffer_load_dwordx4 v238, s[48:51], s69 offen offset:3072 sc1 lds
MV 148,a,108,a,8
ds_read_b128 a[80:83], v243 offset:16384
ds_read_b64 v[114:115], v12 offset:1096
MV 152,a,108,a,12
ds_read_b128 a[84:87], v243 offset:17408
MV 156,a,112,a,8
ds_read_b64 v[116:117], v12 offset:2176
MV 160,a,112,a,12
ds_read_b128 a[88:91], v243 offset:18432
s_add_u32 s69, s69, 16384
MV 164,a,116,a,8
ds_read_b128 a[92:95], v243 offset:19456
ds_read_b64 v[118:119], v12 offset:2184
MV 168,a,116,a,12
MV 172,a,120,a,8
ds_read_b64 v[120:121], v12 offset:3264
MV 176,a,120,a,12
MV 180,a,124,a,8
buffer_load_dwordx4 a[8:11], v236, s[44:47], s68 offen offset:1024 sc1
ds_read_b64 v[122:123], v12 offset:3272
MV 184,a,124,a,12
buffer_load_dwordx4 a[12:15], v237, s[44:47], s68 offen offset:1024 sc1
s_add_u32 s68, s68, 2048
s_waitcnt lgkmcnt(0)
MV 124,a,64,a,16
ds_read_b128 a[96:99], v242 offset:24576
buffer_store_dwordx4 v[108:111], v13, s[24:27], 0 offen offset:0 sc1
MV 128,a,64,a,20
ds_read_b128 a[100:103], v242 offset:25600
s_add_u32 m0, s70, 66560
MV 132,a,68,a,16
MV 136,a,68,a,20
ds_read_b128 a[104:107], v242 offset:26624
MV 140,a,72,a,16
ds_read_b128 a[108:111], v242 offset:27648
MV 144,a,72,a,20
buffer_load_dwordx4 v238, s[48:51], s69 offen offset:0 sc1 lds
MV 148,a,76,a,16
ds_read_b128 a[112:115], v243 offset:24576
MV 152,a,76,a,20
ds_read_b128 a[116:119], v243 offset:25600
MV 156,a,80,a,16
buffer_store_dwordx4 v[112:115], v13, s[24:27], 0 offen offset:1024 sc1
MV 160,a,80,a,20
ds_read_b128 a[120:123], v243 offset:26624
buffer_load_dwordx4 v238, s[48:51], s69 offen offset:1024 sc1 lds
MV 164,a,84,a,16
ds_read_b128 a[124:127], v243 offset:27648
MV 168,a,84,a,20
MV 172,a,88,a,16
MV 176,a,88,a,20
MV 180,a,92,a,16
buffer_load_dwordx4 a[16:19], v236, s[44:47], s68 offen offset:0 sc1
MV 184,a,92,a,20
buffer_load_dwordx4 a[20:23], v237, s[44:47], s68 offen offset:0 sc1
s_waitcnt vmcnt(16) lgkmcnt(0)
s_barrier
MV 124,a,96,a,24
ds_read_b128 a[64:67], v242 offset:32768
buffer_store_dwordx4 v[116:119], v13, s[24:27], 0 offen offset:2048 sc1
MV 128,a,96,a,28
ds_read_b128 a[68:71], v242 offset:33792
buffer_load_dwordx4 v238, s[48:51], s69 offen offset:2048 sc1 lds
MV 132,a,100,a,24
MV 136,a,100,a,28
ds_read_b128 a[72:75], v242 offset:34816
MV 140,a,104,a,24
ds_read_b128 a[76:79], v242 offset:35840
MV 144,a,104,a,28
buffer_load_dwordx4 v238, s[48:51], s69 offen offset:3072 sc1 lds
MV 148,a,108,a,24
ds_read_b128 a[80:83], v243 offset:32768
MV 152,a,108,a,28
ds_read_b128 a[84:87], v243 offset:33792
MV 156,a,112,a,24
buffer_store_dwordx4 v[120:123], v13, s[24:27], 0 offen offset:3072 sc1
MV 160,a,112,a,28
ds_read_b128 a[88:91], v243 offset:34816
s_add_u32 s69, s69, 16384
MV 164,a,116,a,24
ds_read_b128 a[92:95], v243 offset:35840
MV 168,a,116,a,28
MV 172,a,120,a,24
MV 176,a,120,a,28
MV 180,a,124,a,24
buffer_load_dwordx4 a[24:27], v236, s[44:47], s68 offen offset:1024 sc1
MV 184,a,124,a,28
buffer_load_dwordx4 a[28:31], v237, s[44:47], s68 offen offset:1024 sc1
s_add_u32 s68, s68, 2048
s_mov_b32 s71, 3
.p2align 5
L_p5_loop:
s_waitcnt lgkmcnt(0)
MV 124,a,64,a,32
ds_read_b128 a[96:99], v242 offset:40960
MV 128,a,64,a,36
ds_read_b128 a[100:103], v242 offset:41984
s_add_u32 m0, s70, 82944
MV 132,a,68,a,32
MV 136,a,68,a,36
ds_read_b128 a[104:107], v242 offset:43008
MV 140,a,72,a,32
ds_read_b128 a[108:111], v242 offset:44032
MV 144,a,72,a,36
buffer_load_dwordx4 v238, s[48:51], s69 offen offset:0 sc1 lds
MV 148,a,76,a,32
ds_read_b128 a[112:115], v243 offset:40960
MV 152,a,76,a,36
ds_read_b128 a[116:119], v243 offset:41984
MV 156,a,80,a,32
MV 160,a,80,a,36
ds_read_b128 a[120:123], v243 offset:43008
buffer_load_dwordx4 v238, s[48:51], s69 offen offset:1024 sc1 lds
MV 164,a,84,a,32
ds_read_b128 a[124:127], v243 offset:44032
MV 168,a,84,a,36
MV 172,a,88,a,32
MV 176,a,88,a,36
MV 180,a,92,a,32
buffer_load_dwordx4 a[32:35], v236, s[44:47], s68 offen offset:0 sc1
MV 184,a,92,a,36
buffer_load_dwordx4 a[36:39], v237, s[44:47], s68 offen offset:0 sc1
s_waitcnt vmcnt(14) lgkmcnt(0)
s_barrier
MV 124,a,96,a,40
ds_read_b128 a[64:67], v242 offset:49152
MV 128,a,96,a,44
ds_read_b128 a[68:71], v242 offset:50176
buffer_load_dwordx4 v238, s[48:51], s69 offen offset:2048 sc1 lds
MV 132,a,100,a,40
MV 136,a,100,a,44
ds_read_b128 a[72:75], v242 offset:51200
MV 140,a,104,a,40
ds_read_b128 a[76:79], v242 offset:52224
MV 144,a,104,a,44
buffer_load_dwordx4 v238, s[48:51], s69 offen offset:3072 sc1 lds
MV 148,a,108,a,40
ds_read_b128 a[80:83], v243 offset:49152
MV 152,a,108,a,44
ds_read_b128 a[84:87], v243 offset:50176
MV 156,a,112,a,40
MV 160,a,112,a,44
ds_read_b128 a[88:91], v243 offset:51200
s_add_u32 s69, s69, 16384
MV 164,a,116,a,40
ds_read_b128 a[92:95], v243 offset:52224
MV 168,a,116,a,44
MV 172,a,120,a,40
MV 176,a,120,a,44
MV 180,a,124,a,40
buffer_load_dwordx4 a[40:43], v236, s[44:47], s68 offen offset:1024 sc1
MV 184,a,124,a,44
buffer_load_dwordx4 a[44:47], v237, s[44:47], s68 offen offset:1024 sc1
s_add_u32 s68, s68, 2048
s_waitcnt lgkmcnt(0)
MV 124,a,64,a,48
ds_read_b128 a[96:99], v242 offset:57344
MV 128,a,64,a,52
ds_read_b128 a[100:103], v242 offset:58368
s_add_u32 m0, s70, 99328
MV 132,a,68,a,48
MV 136,a,68,a,52
ds_read_b128 a[104:107], v242 offset:59392
MV 140,a,72,a,48
ds_read_b128 a[108:111], v242 offset:60416
MV 144,a,72,a,52
buffer_load_dwordx4 v238, s[48:51], s69 offen offset:0 sc1 lds
MV 148,a,76,a,48
ds_read_b128 a[112:115], v243 offset:57344
MV 152,a,76,a,52
ds_read_b128 a[116:119], v243 offset:58368
MV 156,a,80,a,48
MV 160,a,80,a,52
ds_read_b128 a[120:123], v243 offset:59392
buffer_load_dwordx4 v238, s[48:51], s69 offen offset:1024 sc1 lds
MV 164,a,84,a,48
ds_read_b128 a[124:127], v243 offset:60416
MV 168,a,84,a,52
MV 172,a,88,a,48
MV 176,a,88,a,52
MV 180,a,92,a,48
buffer_load_dwordx4 a[48:51], v236, s[44:47], s68 offen offset:0 sc1
MV 184,a,92,a,52
buffer_load_dwordx4 a[52:55], v237, s[44:47], s68 offen offset:0 sc1
s_waitcnt vmcnt(14) lgkmcnt(0)
s_barrier
MV 124,a,96,a,56
ds_read_b128 a[64:67], v242 offset:0
MV 128,a,96,a,60
ds_read_b128 a[68:71], v242 offset:1024
buffer_load_dwordx4 v238, s[48:51], s69 offen offset:2048 sc1 lds
MV 132,a,100,a,56
MV 136,a,100,a,60
ds_read_b128 a[72:75], v242 offset:2048
MV 140,a,104,a,56
ds_read_b128 a[76:79], v242 offset:3072
MV 144,a,104,a,60
buffer_load_dwordx4 v238, s[48:51], s69 offen offset:3072 sc1 lds
MV 148,a,108,a,56
ds_read_b128 a[80:83], v243 offset:0
MV 152,a,108,a,60
ds_read_b128 a[84:87], v243 offset:1024
MV 156,a,112,a,56
MV 160,a,112,a,60
ds_read_b128 a[88:91], v243 offset:2048
s_add_u32 s69, s69, 16384
MV 164,a,116,a,56
ds_read_b128 a[92:95], v243 offset:3072
MV 168,a,116,a,60
MV 172,a,120,a,56
MV 176,a,120,a,60
MV 180,a,124,a,56
buffer_load_dwordx4 a[56:59], v236, s[44:47], s68 offen offset:1024 sc1
MV 184,a,124,a,60
buffer_load_dwordx4 a[60:63], v237, s[44:47], s68 offen offset:1024 sc1
s_add_u32 s68, s68, 2048
s_waitcnt lgkmcnt(0)
MV 124,a,64,a,0
ds_read_b128 a[96:99], v242 offset:8192
MV 128,a,64,a,4
ds_read_b128 a[100:103], v242 offset:9216
s_add_u32 m0, s70, 115712
MV 132,a,68,a,0
MV 136,a,68,a,4
ds_read_b128 a[104:107], v242 offset:10240
MV 140,a,72,a,0
ds_read_b128 a[108:111], v242 offset:11264
MV 144,a,72,a,4
buffer_load_dwordx4 v238, s[48:51], s69 offen offset:0 sc1 lds
MV 148,a,76,a,0
ds_read_b128 a[112:115], v243 offset:8192
MV 152,a,76,a,4
ds_read_b128 a[116:119], v243 offset:9216
MV 156,a,80,a,0
MV 160,a,80,a,4
ds_read_b128 a[120:123], v243 offset:10240
buffer_load_dwordx4 v238, s[48:51], s69 offen offset:1024 sc1 lds
MV 164,a,84,a,0
ds_read_b128 a[124:127], v243 offset:11264
MV 168,a,84,a,4
MV 172,a,88,a,0
MV 176,a,88,a,4
MV 180,a,92,a,0
buffer_load_dwordx4 a[0:3], v236, s[44:47], s68 offen offset:0 sc1
MV 184,a,92,a,4
buffer_load_dwordx4 a[4:7], v237, s[44:47], s68 offen offset:0 sc1
s_waitcnt vmcnt(14) lgkmcnt(0)
s_barrier
MV 124,a,96,a,8
ds_read_b128 a[64:67], v242 offset:16384
MV 128,a,96,a,12
ds_read_b128 a[68:71], v242 offset:17408
buffer_load_dwordx4 v238, s[48:51], s69 offen offset:2048 sc1 lds
MV 132,a,100,a,8
MV 136,a,100,a,12
ds_read_b128 a[72:75], v242 offset:18432
MV 140,a,104,a,8
ds_read_b128 a[76:79], v242 offset:19456
MV 144,a,104,a,12
buffer_load_dwordx4 v238, s[48:51], s69 offen offset:3072 sc1 lds
MV 148,a,108,a,8
ds_read_b128 a[80:83], v243 offset:16384
MV 152,a,108,a,12
ds_read_b128 a[84:87], v243 offset:17408
MV 156,a,112,a,8
MV 160,a,112,a,12
ds_read_b128 a[88:91], v243 offset:18432
s_add_u32 s69, s69, 16384
MV 164,a,116,a,8
ds_read_b128 a[92:95], v243 offset:19456
MV 168,a,116,a,12
MV 172,a,120,a,8
MV 176,a,120,a,12
MV 180,a,124,a,8
buffer_load_dwordx4 a[8:11], v236, s[44:47], s68 offen offset:1024 sc1
MV 184,a,124,a,12
buffer_load_dwordx4 a[12:15], v237, s[44:47], s68 offen offset:1024 sc1
s_add_u32 s68, s68, 2048
s_waitcnt lgkmcnt(0)
MV 124,a,64,a,16
ds_read_b128 a[96:99], v242 offset:24576
MV 128,a,64,a,20
ds_read_b128 a[100:103], v242 offset:25600
s_add_u32 m0, s70, 66560
MV 132,a,68,a,16
MV 136,a,68,a,20
ds_read_b128 a[104:107], v242 offset:26624
MV 140,a,72,a,16
ds_read_b128 a[108:111], v242 offset:27648
MV 144,a,72,a,20
buffer_load_dwordx4 v238, s[48:51], s69 offen offset:0 sc1 lds
MV 148,a,76,a,16
ds_read_b128 a[112:115], v243 offset:24576
MV 152,a,76,a,20
ds_read_b128 a[116:119], v243 offset:25600
MV 156,a,80,a,16
MV 160,a,80,a,20
ds_read_b128 a[120:123], v243 offset:26624
buffer_load_dwordx4 v238, s[48:51], s69 offen offset:1024 sc1 lds
MV 164,a,84,a,16
ds_read_b128 a[124:127], v243 offset:27648
MV 168,a,84,a,20
MV 172,a,88,a,16
MV 176,a,88,a,20
MV 180,a,92,a,16
buffer_load_dwordx4 a[16:19], v236, s[44:47], s68 offen offset:0 sc1
MV 184,a,92,a,20
buffer_load_dwordx4 a[20:23], v237, s[44:47], s68 offen offset:0 sc1
s_waitcnt vmcnt(14) lgkmcnt(0)
s_barrier
MV 124,a,96,a,24
ds_read_b128 a[64:67], v242 offset:32768
MV 128,a,96,a,28
ds_read_b128 a[68:71], v242 offset:33792
buffer_load_dwordx4 v238, s[48:51], s69 offen offset:2048 sc1 lds
MV 132,a,100,a,24
MV 136,a,100,a,28
ds_read_b128 a[72:75], v242 offset:34816
MV 140,a,104,a,24
ds_read_b128 a[76:79], v242 offset:35840
MV 144,a,104,a,28
buffer_load_dwordx4 v238, s[48:51], s69 offen offset:3072 sc1 lds
MV 148,a,108,a,24
ds_read_b128 a[80:83], v243 offset:32768
MV 152,a,108,a,28
ds_read_b128 a[84:87], v243 offset:33792
MV 156,a,112,a,24
MV 160,a,112,a,28
ds_read_b128 a[88:91], v243 offset:34816
s_add_u32 s69, s69, 16384
MV 164,a,116,a,24
ds_read_b128 a[92:95], v243 offset:35840
MV 168,a,116,a,28
MV 172,a,120,a,24
MV 176,a,120,a,28
MV 180,a,124,a,24
buffer_load_dwordx4 a[24:27], v236, s[44:47], s68 offen offset:1024 sc1
MV 184,a,124,a,28
buffer_load_dwordx4 a[28:31], v237, s[44:47], s68 offen offset:1024 sc1
s_add_u32 s68, s68, 2048
s_sub_u32 s71, s71, 1
s_cbranch_scc1 L_p5_out
s_cmp_eq_u32 s71, 2
s_cbranch_scc1 L_p5_x1
s_cmp_eq_u32 s71, 0
s_cbranch_scc1 L_p5_x2
s_branch L_p5_loop
L_p5_out:
s_waitcnt lgkmcnt(0)
MV 124,a,64,a,32
ds_read_b128 a[96:99], v242 offset:40960
MV 128,a,64,a,36
ds_read_b128 a[100:103], v242 offset:41984
s_add_u32 m0, s70, 82944
MV 132,a,68,a,32
v_cmp_gt_u32 vcc, 1, v253
s_nop 4
s_cbranch_vccnz L_spin_f3
L_spin_f3_ret:
MV 136,a,68,a,36
ds_read_b128 a[104:107], v242 offset:43008
MV 140,a,72,a,32
ds_read_b128 a[108:111], v242 offset:44032
MV 144,a,72,a,36
buffer_load_dwordx4 v238, s[48:51], s69 offen offset:0 sc1 lds
MV 148,a,76,a,32
ds_read_b128 a[112:115], v243 offset:40960
MV 152,a,76,a,36
ds_read_b128 a[116:119], v243 offset:41984
MV 156,a,80,a,32
MV 160,a,80,a,36
ds_read_b128 a[120:123], v243 offset:43008
buffer_load_dwordx4 v238, s[48:51], s69 offen offset:1024 sc1 lds
MV 164,a,84,a,32
ds_read_b128 a[124:127], v243 offset:44032
MV 168,a,84,a,36
MV 172,a,88,a,32
s_add_u32 s72, s79, 0
MV 176,a,88,a,36
MV 180,a,92,a,32
buffer_load_dwordx4 a[32:35], v236, s[44:47], s68 offen offset:0 sc1
buffer_load_dwordx2 v[208:209], v251, s[56:59], s72 offen offset:0 sc1
MV 184,a,92,a,36
buffer_load_dwordx4 a[36:39], v237, s[44:47], s68 offen offset:0 sc1
s_waitcnt vmcnt(15) lgkmcnt(0)
s_barrier
MV 124,a,96,a,40
ds_read_b128 a[64:67], v242 offset:49152
s_add_u32 s72, s79, 16384
MV 128,a,96,a,44
ds_read_b128 a[68:71], v242 offset:50176
buffer_load_dwordx4 v238, s[48:51], s69 offen offset:2048 sc1 lds
MV 132,a,100,a,40
MV 136,a,100,a,44
ds_read_b128 a[72:75], v242 offset:51200
MV 140,a,104,a,40
ds_read_b128 a[76:79], v242 offset:52224
MV 144,a,104,a,44
buffer_load_dwordx4 v238, s[48:51], s69 offen offset:3072 sc1 lds
MV 148,a,108,a,40
ds_read_b128 a[80:83], v243 offset:49152
MV 152,a,108,a,44
ds_read_b128 a[84:87], v243 offset:50176
MV 156,a,112,a,40
buffer_load_dwordx2 v[210:211], v251, s[56:59], s72 offen offset:0 sc1
MV 160,a,112,a,44
ds_read_b128 a[88:91], v243 offset:51200
s_add_u32 s69, s69, 16384
MV 164,a,116,a,40
ds_read_b128 a[92:95], v243 offset:52224
MV 168,a,116,a,44
MV 172,a,120,a,40
MV 176,a,120,a,44
MV 180,a,124,a,40
buffer_load_dwordx4 a[40:43], v236, s[44:47], s68 offen offset:1024 sc1
MV 184,a,124,a,44
buffer_load_dwordx4 a[44:47], v237, s[44:47], s68 offen offset:1024 sc1
s_add_u32 s68, s68, 2048
s_waitcnt lgkmcnt(0)
MV 124,a,64,a,48
ds_read_b128 a[96:99], v242 offset:57344
s_add_u32 s72, s79, 131072
MV 128,a,64,a,52
ds_read_b128 a[100:103], v242 offset:58368
s_add_u32 m0, s70, 99328
MV 132,a,68,a,48
MV 136,a,68,a,52
ds_read_b128 a[104:107], v242 offset:59392
MV 140,a,72,a,48
ds_read_b128 a[108:111], v242 offset:60416
buffer_load_dwordx2 v[212:213], v251, s[56:59], s72 offen offset:0 sc1
MV 144,a,72,a,52
buffer_load_dwordx4 v238, s[48:51], s69 offen offset:0 sc1 lds
MV 148,a,76,a,48
ds_read_b128 a[112:115], v243 offset:57344
MV 152,a,76,a,52
ds_read_b128 a[116:119], v243 offset:58368
MV 156,a,80,a,48
s_add_u32 s72, s79, 147456
MV 160,a,80,a,52
ds_read_b128 a[120:123], v243 offset:59392
buffer_load_dwordx4 v238, s[48:51], s69 offen offset:1024 sc1 lds
MV 164,a,84,a,48
ds_read_b128 a[124:127], v243 offset:60416
MV 168,a,84,a,52
MV 172,a,88,a,48
buffer_load_dwordx2 v[214:215], v251, s[56:59], s72 offen offset:0 sc1
MV 176,a,88,a,52
MV 180,a,92,a,48
buffer_load_dwordx4 a[48:51], v236, s[44:47], s68 offen offset:0 sc1
MV 184,a,92,a,52
buffer_load_dwordx4 a[52:55], v237, s[44:47], s68 offen offset:0 sc1
s_waitcnt vmcnt(18) lgkmcnt(0)
s_barrier
MV 124,a,96,a,56
ds_read_b128 a[64:67], v242 offset:0
s_add_u32 s72, s79, 0
MV 128,a,96,a,60
ds_read_b128 a[68:71], v242 offset:1024
buffer_load_dwordx4 v238, s[48:51], s69 offen offset:2048 sc1 lds
MV 132,a,100,a,56
MV 136,a,100,a,60
ds_read_b128 a[72:75], v242 offset:2048
MV 140,a,104,a,56
ds_read_b128 a[76:79], v242 offset:3072
MV 144,a,104,a,60
buffer_load_dwordx4 v238, s[48:51], s69 offen offset:3072 sc1 lds
MV 148,a,108,a,56
ds_read_b128 a[80:83], v243 offset:0
MV 152,a,108,a,60
ds_read_b128 a[84:87], v243 offset:1024
MV 156,a,112,a,56
buffer_load_dwordx2 v[216:217], v251, s[56:59], s72 offen offset:128 sc1
MV 160,a,112,a,60
ds_read_b128 a[88:91], v243 offset:2048
s_add_u32 s69, s69, 16384
MV 164,a,116,a,56
ds_read_b128 a[92:95], v243 offset:3072
MV 168,a,116,a,60
MV 172,a,120,a,56
MV 176,a,120,a,60
MV 180,a,124,a,56
buffer_load_dwordx4 a[56:59], v236, s[44:47], s68 offen offset:1024 sc1
MV 184,a,124,a,60
buffer_load_dwordx4 a[60:63], v237, s[44:47], s68 offen offset:1024 sc1
s_add_u32 s68, s68, 2048
s_waitcnt lgkmcnt(0)
MV 124,a,64,a,0
ds_read_b128 a[96:99], v242 offset:8192
s_add_u32 s72, s79, 16384
MV 128,a,64,a,4
ds_read_b128 a[100:103], v242 offset:9216
s_add_u32 m0, s70, 115712
MV 132,a,68,a,0
MV 136,a,68,a,4
ds_read_b128 a[104:107], v242 offset:10240
MV 140,a,72,a,0
ds_read_b128 a[108:111], v242 offset:11264
MV 144,a,72,a,4
buffer_load_dwordx4 v238, s[48:51], s69 offen offset:0 sc1 lds
MV 148,a,76,a,0
ds_read_b128 a[112:115], v243 offset:8192
MV 152,a,76,a,4
ds_read_b128 a[116:119], v243 offset:9216
MV 156,a,80,a,0
buffer_load_dwordx2 v[218:219], v251, s[56:59], s72 offen offset:128 sc1
MV 160,a,80,a,4
ds_read_b128 a[120:123], v243 offset:10240
buffer_load_dwordx4 v238, s[48:51], s69 offen offset:1024 sc1 lds
MV 164,a,84,a,0
ds_read_b128 a[124:127], v243 offset:11264
MV 168,a,84,a,4
MV 172,a,88,a,0
MV 176,a,88,a,4
MV 180,a,92,a,0
buffer_load_dwordx4 a[0:3], v236, s[44:47], s68 offen offset:0 sc1
MV 184,a,92,a,4
buffer_load_dwordx4 a[4:7], v237, s[44:47], s68 offen offset:0 sc1
s_waitcnt vmcnt(19) lgkmcnt(0)
s_barrier
MV 124,a,96,a,8
ds_read_b128 a[64:67], v242 offset:16384
s_add_u32 s72, s79, 131072
MV 128,a,96,a,12
ds_read_b128 a[68:71], v242 offset:17408
buffer_load_dwordx4 v238, s[48:51], s69 offen offset:2048 sc1 lds
MV 132,a,100,a,8
MV 136,a,100,a,12
ds_read_b128 a[72:75], v242 offset:18432
MV 140,a,104,a,8
ds_read_b128 a[76:79], v242 offset:19456
buffer_load_dwordx2 v[220:221], v251, s[56:59], s72 offen offset:128 sc1
MV 144,a,104,a,12
buffer_load_dwordx4 v238, s[48:51], s69 offen offset:3072 sc1 lds
MV 148,a,108,a,8
ds_read_b128 a[80:83], v243 offset:16384
MV 152,a,108,a,12
ds_read_b128 a[84:87], v243 offset:17408
MV 156,a,112,a,8
s_add_u32 s72, s79, 147456
MV 160,a,112,a,12
ds_read_b128 a[88:91], v243 offset:18432
s_add_u32 s69, s69, 16384
MV 164,a,116,a,8
ds_read_b128 a[92:95], v243 offset:19456
MV 168,a,116,a,12
MV 172,a,120,a,8
buffer_load_dwordx2 v[222:223], v251, s[56:59], s72 offen offset:128 sc1
MV 176,a,120,a,12
MV 180,a,124,a,8
buffer_load_dwordx4 a[8:11], v236, s[44:47], s68 offen offset:1024 sc1
MV 184,a,124,a,12
buffer_load_dwordx4 a[12:15], v237, s[44:47], s68 offen offset:1024 sc1
s_add_u32 s68, s68, 2048
s_waitcnt lgkmcnt(0)
MV 124,a,64,a,16
ds_read_b128 a[96:99], v242 offset:24576
MV 128,a,64,a,20
ds_read_b128 a[100:103], v242 offset:25600
s_add_u32 m0, s70, 66560
MV 132,a,68,a,16
MV 136,a,68,a,20
ds_read_b128 a[104:107], v242 offset:26624
MV 140,a,72,a,16
ds_read_b128 a[108:111], v242 offset:27648
MV 144,a,72,a,20
buffer_load_dwordx4 v238, s[48:51], s69 offen offset:0 sc1 lds
MV 148,a,76,a,16
ds_read_b128 a[112:115], v243 offset:24576
MV 152,a,76,a,20
ds_read_b128 a[116:119], v243 offset:25600
MV 156,a,80,a,16
MV 160,a,80,a,20
ds_read_b128 a[120:123], v243 offset:26624
buffer_load_dwordx4 v238, s[48:51], s69 offen offset:1024 sc1 lds
MV 164,a,84,a,16
ds_read_b128 a[124:127], v243 offset:27648
MV 168,a,84,a,20
MV 172,a,88,a,16
MV 176,a,88,a,20
MV 180,a,92,a,16
buffer_load_dwordx4 a[16:19], v236, s[44:47], s68 offen offset:0 sc1
MV 184,a,92,a,20
buffer_load_dwordx4 a[20:23], v237, s[44:47], s68 offen offset:0 sc1
s_waitcnt vmcnt(18) lgkmcnt(0)
s_barrier
MV 124,a,96,a,24
ds_read_b128 a[64:67], v242 offset:32768
MV 128,a,96,a,28
ds_read_b128 a[68:71], v242 offset:33792
buffer_load_dwordx4 v238, s[48:51], s69 offen offset:2048 sc1 lds
MV 132,a,100,a,24
MV 136,a,100,a,28
ds_read_b128 a[72:75], v242 offset:34816
MV 140,a,104,a,24
ds_read_b128 a[76:79], v242 offset:35840
MV 144,a,104,a,28
buffer_load_dwordx4 v238, s[48:51], s69 offen offset:3072 sc1 lds
MV 148,a,108,a,24
ds_read_b128 a[80:83], v243 offset:32768
MV 152,a,108,a,28
ds_read_b128 a[84:87], v243 offset:33792
MV 156,a,112,a,24
MV 160,a,112,a,28
ds_read_b128 a[88:91], v243 offset:34816
s_add_u32 s69, s69, 16384
MV 164,a,116,a,24
ds_read_b128 a[92:95], v243 offset:35840
MV 168,a,116,a,28
MV 172,a,120,a,24
MV 176,a,120,a,28
MV 180,a,124,a,24
buffer_load_dwordx4 a[24:27], v236, s[44:47], s68 offen offset:1024 sc1
MV 184,a,124,a,28
buffer_load_dwordx4 a[28:31], v237, s[44:47], s68 offen offset:1024 sc1
s_add_u32 s68, s68, 2048
s_waitcnt lgkmcnt(0)
MV 124,a,64,a,32
ds_read_b128 a[96:99], v242 offset:40960
v_sub_f32 v8, 1.0, v6
MV 128,a,64,a,36
ds_read_b128 a[100:103], v242 offset:41984
s_add_u32 m0, s70, 82944
MV 132,a,68,a,32
v_lshlrev_b32 v36, 16, v192
v_lshlrev_b32 v228, 16, v208
MV 136,a,68,a,36
ds_read_b128 a[104:107], v242 offset:43008
v_and_b32 v37, 0xffff0000, v192
MV 140,a,72,a,32
ds_read_b128 a[108:111], v242 offset:44032
v_and_b32 v229, 0xffff0000, v208
MV 144,a,72,a,36
buffer_load_dwordx4 v238, s[48:51], s69 offen offset:0 sc1 lds
v_mul_f32 v36, v36, v228
MV 148,a,76,a,32
ds_read_b128 a[112:115], v243 offset:40960
v_mul_f32 v37, v37, v229
MV 152,a,76,a,36
ds_read_b128 a[116:119], v243 offset:41984
v_mul_f32 v36, v36, v6
MV 156,a,80,a,32
v_mul_f32 v37, v37, v6
v_lshlrev_b32 v38, 16, v193
MV 160,a,80,a,36
ds_read_b128 a[120:123], v243 offset:43008
buffer_load_dwordx4 v238, s[48:51], s69 offen offset:1024 sc1 lds
MV 164,a,84,a,32
ds_read_b128 a[124:127], v243 offset:44032
v_lshlrev_b32 v228, 16, v209
MV 168,a,84,a,36
v_and_b32 v39, 0xffff0000, v193
v_and_b32 v229, 0xffff0000, v209
MV 172,a,88,a,32
v_mul_f32 v38, v38, v228
v_mul_f32 v39, v39, v229
MV 176,a,88,a,36
v_mul_f32 v38, v38, v6
v_mul_f32 v39, v39, v6
MV 180,a,92,a,32
buffer_load_dwordx4 a[32:35], v236, s[44:47], s68 offen offset:0 sc1
v_lshlrev_b32 v40, 16, v194
MV 184,a,92,a,36
buffer_load_dwordx4 a[36:39], v237, s[44:47], s68 offen offset:0 sc1
v_lshlrev_b32 v228, 16, v210
v_and_b32 v41, 0xffff0000, v194
v_and_b32 v229, 0xffff0000, v210
s_waitcnt vmcnt(15) lgkmcnt(0)
s_barrier
MV 124,a,96,a,40
ds_read_b128 a[64:67], v242 offset:49152
v_mul_f32 v40, v40, v228
MV 128,a,96,a,44
ds_read_b128 a[68:71], v242 offset:50176
buffer_load_dwordx4 v238, s[48:51], s69 offen offset:2048 sc1 lds
MV 132,a,100,a,40
v_mul_f32 v41, v41, v229
v_mul_f32 v40, v40, v6
MV 136,a,100,a,44
ds_read_b128 a[72:75], v242 offset:51200
v_mul_f32 v41, v41, v6
MV 140,a,104,a,40
ds_read_b128 a[76:79], v242 offset:52224
v_lshlrev_b32 v42, 16, v195
MV 144,a,104,a,44
buffer_load_dwordx4 v238, s[48:51], s69 offen offset:3072 sc1 lds
v_lshlrev_b32 v228, 16, v211
MV 148,a,108,a,40
ds_read_b128 a[80:83], v243 offset:49152
v_and_b32 v43, 0xffff0000, v195
MV 152,a,108,a,44
ds_read_b128 a[84:87], v243 offset:50176
v_and_b32 v229, 0xffff0000, v211
MV 156,a,112,a,40
v_mul_f32 v42, v42, v228
v_mul_f32 v43, v43, v229
MV 160,a,112,a,44
ds_read_b128 a[88:91], v243 offset:51200
s_add_u32 s69, s69, 16384
MV 164,a,116,a,40
ds_read_b128 a[92:95], v243 offset:52224
v_mul_f32 v42, v42, v6
MV 168,a,116,a,44
v_mul_f32 v43, v43, v6
v_lshlrev_b32 v44, 16, v196
MV 172,a,120,a,40
v_lshlrev_b32 v228, 16, v212
v_and_b32 v45, 0xffff0000, v196
MV 176,a,120,a,44
v_and_b32 v229, 0xffff0000, v212
v_mul_f32 v44, v44, v228
MV 180,a,124,a,40
buffer_load_dwordx4 a[40:43], v236, s[44:47], s68 offen offset:1024 sc1
v_mul_f32 v45, v45, v229
MV 184,a,124,a,44
buffer_load_dwordx4 a[44:47], v237, s[44:47], s68 offen offset:1024 sc1
s_add_u32 s68, s68, 2048
v_mul_f32 v44, v44, v6
v_mul_f32 v45, v45, v6
v_lshlrev_b32 v46, 16, v197
v_lshlrev_b32 v228, 16, v213
s_waitcnt lgkmcnt(0)
MV 124,a,64,a,48
ds_read_b128 a[96:99], v242 offset:57344
v_and_b32 v47, 0xffff0000, v197
MV 128,a,64,a,52
ds_read_b128 a[100:103], v242 offset:58368
s_add_u32 m0, s70, 99328
MV 132,a,68,a,48
v_and_b32 v229, 0xffff0000, v213
v_mul_f32 v46, v46, v228
MV 136,a,68,a,52
ds_read_b128 a[104:107], v242 offset:59392
v_mul_f32 v47, v47, v229
MV 140,a,72,a,48
ds_read_b128 a[108:111], v242 offset:60416
v_mul_f32 v46, v46, v6
MV 144,a,72,a,52
buffer_load_dwordx4 v238, s[48:51], s69 offen offset:0 sc1 lds
v_mul_f32 v47, v47, v6
MV 148,a,76,a,48
ds_read_b128 a[112:115], v243 offset:57344
v_lshlrev_b32 v48, 16, v198
MV 152,a,76,a,52
ds_read_b128 a[116:119], v243 offset:58368
v_lshlrev_b32 v228, 16, v214
MV 156,a,80,a,48
v_and_b32 v49, 0xffff0000, v198
v_and_b32 v229, 0xffff0000, v214
MV 160,a,80,a,52
ds_read_b128 a[120:123], v243 offset:59392
buffer_load_dwordx4 v238, s[48:51], s69 offen offset:1024 sc1 lds
MV 164,a,84,a,48
ds_read_b128 a[124:127], v243 offset:60416
v_mul_f32 v48, v48, v228
MV 168,a,84,a,52
v_mul_f32 v49, v49, v229
v_mul_f32 v48, v48, v6
MV 172,a,88,a,48
v_mul_f32 v49, v49, v6
v_lshlrev_b32 v50, 16, v199
MV 176,a,88,a,52
v_lshlrev_b32 v228, 16, v215
v_and_b32 v51, 0xffff0000, v199
MV 180,a,92,a,48
buffer_load_dwordx4 a[48:51], v236, s[44:47], s68 offen offset:0 sc1
v_and_b32 v229, 0xffff0000, v215
MV 184,a,92,a,52
buffer_load_dwordx4 a[52:55], v237, s[44:47], s68 offen offset:0 sc1
v_mul_f32 v50, v50, v228
v_mul_f32 v51, v51, v229
v_mul_f32 v50, v50, v6
v_mul_f32 v51, v51, v6
s_waitcnt vmcnt(14) lgkmcnt(0)
s_barrier
MV 124,a,96,a,56
ds_read_b128 a[64:67], v242 offset:0
v_sub_f32 v9, 1.0, v7
MV 128,a,96,a,60
ds_read_b128 a[68:71], v242 offset:1024
buffer_load_dwordx4 v238, s[48:51], s69 offen offset:2048 sc1 lds
MV 132,a,100,a,56
v_lshlrev_b32 v52, 16, v200
v_lshlrev_b32 v228, 16, v216
MV 136,a,100,a,60
ds_read_b128 a[72:75], v242 offset:2048
v_and_b32 v53, 0xffff0000, v200
MV 140,a,104,a,56
ds_read_b128 a[76:79], v242 offset:3072
v_and_b32 v229, 0xffff0000, v216
MV 144,a,104,a,60
buffer_load_dwordx4 v238, s[48:51], s69 offen offset:3072 sc1 lds
v_mul_f32 v52, v52, v228
MV 148,a,108,a,56
ds_read_b128 a[80:83], v243 offset:0
v_mul_f32 v53, v53, v229
MV 152,a,108,a,60
ds_read_b128 a[84:87], v243 offset:1024
v_mul_f32 v52, v52, v7
MV 156,a,112,a,56
v_mul_f32 v53, v53, v7
v_lshlrev_b32 v54, 16, v201
MV 160,a,112,a,60
ds_read_b128 a[88:91], v243 offset:2048
s_add_u32 s69, s69, 16384
MV 164,a,116,a,56
ds_read_b128 a[92:95], v243 offset:3072
v_lshlrev_b32 v228, 16, v217
MV 168,a,116,a,60
v_and_b32 v55, 0xffff0000, v201
v_and_b32 v229, 0xffff0000, v217
MV 172,a,120,a,56
v_mul_f32 v54, v54, v228
v_mul_f32 v55, v55, v229
MV 176,a,120,a,60
v_mul_f32 v54, v54, v7
v_mul_f32 v55, v55, v7
MV 180,a,124,a,56
buffer_load_dwordx4 a[56:59], v236, s[44:47], s68 offen offset:1024 sc1
v_lshlrev_b32 v56, 16, v202
MV 184,a,124,a,60
buffer_load_dwordx4 a[60:63], v237, s[44:47], s68 offen offset:1024 sc1
s_add_u32 s68, s68, 2048
v_lshlrev_b32 v228, 16, v218
v_and_b32 v57, 0xffff0000, v202
v_and_b32 v229, 0xffff0000, v218
s_waitcnt lgkmcnt(0)
MV 124,a,64,a,0
ds_read_b128 a[96:99], v242 offset:8192
v_mul_f32 v56, v56, v228
MV 128,a,64,a,4
ds_read_b128 a[100:103], v242 offset:9216
s_add_u32 m0, s70, 115712
MV 132,a,68,a,0
v_mul_f32 v57, v57, v229
v_mul_f32 v56, v56, v7
MV 136,a,68,a,4
ds_read_b128 a[104:107], v242 offset:10240
v_mul_f32 v57, v57, v7
MV 140,a,72,a,0
ds_read_b128 a[108:111], v242 offset:11264
v_lshlrev_b32 v58, 16, v203
MV 144,a,72,a,4
buffer_load_dwordx4 v238, s[48:51], s69 offen offset:0 sc1 lds
v_lshlrev_b32 v228, 16, v219
MV 148,a,76,a,0
ds_read_b128 a[112:115], v243 offset:8192
v_and_b32 v59, 0xffff0000, v203
MV 152,a,76,a,4
ds_read_b128 a[116:119], v243 offset:9216
v_and_b32 v229, 0xffff0000, v219
MV 156,a,80,a,0
v_mul_f32 v58, v58, v228
v_mul_f32 v59, v59, v229
MV 160,a,80,a,4
ds_read_b128 a[120:123], v243 offset:10240
buffer_load_dwordx4 v238, s[48:51], s69 offen offset:1024 sc1 lds
MV 164,a,84,a,0
ds_read_b128 a[124:127], v243 offset:11264
v_mul_f32 v58, v58, v7
MV 168,a,84,a,4
v_mul_f32 v59, v59, v7
v_lshlrev_b32 v60, 16, v204
MV 172,a,88,a,0
v_lshlrev_b32 v228, 16, v220
v_and_b32 v61, 0xffff0000, v204
MV 176,a,88,a,4
v_and_b32 v229, 0xffff0000, v220
v_mul_f32 v60, v60, v228
MV 180,a,92,a,0
v_mul_f32 v61, v61, v229
v_mul_f32 v60, v60, v7
MV 184,a,92,a,4
v_mul_f32 v61, v61, v7
v_lshlrev_b32 v62, 16, v205
v_lshlrev_b32 v228, 16, v221
s_waitcnt vmcnt(12) lgkmcnt(0)
s_barrier
MV 124,a,96,a,8
ds_read_b128 a[80:83], v243 offset:16384
v_and_b32 v63, 0xffff0000, v205
MV 128,a,96,a,12
buffer_load_dwordx4 v238, s[48:51], s69 offen offset:2048 sc1 lds
v_and_b32 v229, 0xffff0000, v221
MV 132,a,100,a,8
v_mul_f32 v62, v62, v228
v_mul_f32 v63, v63, v229
MV 136,a,100,a,12
ds_read_b128 a[84:87], v243 offset:17408
v_mul_f32 v62, v62, v7
MV 140,a,104,a,8
v_mul_f32 v63, v63, v7
v_lshlrev_b32 v64, 16, v206
MV 144,a,104,a,12
buffer_load_dwordx4 v238, s[48:51], s69 offen offset:3072 sc1 lds
v_lshlrev_b32 v228, 16, v222
MV 148,a,108,a,8
ds_read_b128 a[88:91], v243 offset:18432
v_and_b32 v65, 0xffff0000, v206
MV 152,a,108,a,12
v_and_b32 v229, 0xffff0000, v222
v_mul_f32 v64, v64, v228
MV 156,a,112,a,8
v_mul_f32 v65, v65, v229
v_mul_f32 v64, v64, v7
MV 160,a,112,a,12
ds_read_b128 a[92:95], v243 offset:19456
s_add_u32 s69, s69, 16384
MV 164,a,116,a,8
v_mul_f32 v65, v65, v7
v_lshlrev_b32 v66, 16, v207
MV 168,a,116,a,12
v_lshlrev_b32 v228, 16, v223
v_and_b32 v67, 0xffff0000, v207
MV 172,a,120,a,8
v_and_b32 v229, 0xffff0000, v223
MV 176,a,120,a,12
v_mul_f32 v66, v66, v228
v_mul_f32 v67, v67, v229
MV 180,a,124,a,8
v_mul_f32 v66, v66, v7
MV 184,a,124,a,12
v_mul_f32 v67, v67, v7
s_waitcnt lgkmcnt(0)
MV 156,a,80,a,16
ds_read_b128 a[112:115], v243 offset:24576
s_xor_b32 s72, s2, 4
MV 160,a,80,a,20
ds_read_b128 a[116:119], v243 offset:25600
s_lshl_b32 s72, s72, 14
MV 164,a,84,a,16
ds_read_b128 a[120:123], v243 offset:26624
MV 168,a,84,a,20
ds_read_b128 a[124:127], v243 offset:27648
MV 172,a,88,a,16
MV 176,a,88,a,20
MV 180,a,92,a,16
MV 184,a,92,a,20
s_waitcnt vmcnt(6)
s_barrier
s_waitcnt lgkmcnt(3)
MV 156,a,112,a,24
ds_read_b128 a[80:83], v243 offset:32768
MV 160,a,112,a,28
ds_read_b128 a[84:87], v243 offset:33792
s_waitcnt lgkmcnt(4)
MV 164,a,116,a,24
ds_read_b128 a[88:91], v243 offset:34816
MV 168,a,116,a,28
ds_read_b128 a[92:95], v243 offset:35840
s_waitcnt lgkmcnt(5)
MV 172,a,120,a,24
MV 176,a,120,a,28
s_waitcnt lgkmcnt(4)
MV 180,a,124,a,24
MV 184,a,124,a,28
s_waitcnt lgkmcnt(3)
MV 156,a,80,a,32
ds_read_b128 a[112:115], v243 offset:40960
MV 160,a,80,a,36
ds_read_b128 a[116:119], v243 offset:41984
s_waitcnt lgkmcnt(4)
MV 164,a,84,a,32
ds_read_b128 a[120:123], v243 offset:43008
MV 168,a,84,a,36
ds_read_b128 a[124:127], v243 offset:44032
s_waitcnt lgkmcnt(5)
MV 172,a,88,a,32
MV 176,a,88,a,36
s_waitcnt lgkmcnt(4)
MV 180,a,92,a,32
MV 184,a,92,a,36
s_waitcnt vmcnt(0)
s_barrier
s_waitcnt lgkmcnt(3)
MV 156,a,112,a,40
ds_read_b128 a[80:83], v243 offset:49152
MV 160,a,112,a,44
ds_read_b128 a[84:87], v243 offset:50176
s_waitcnt lgkmcnt(4)
MV 164,a,116,a,40
ds_read_b128 a[88:91], v243 offset:51200
MV 168,a,116,a,44
ds_read_b128 a[92:95], v243 offset:52224
s_waitcnt lgkmcnt(5)
MV 172,a,120,a,40
MV 176,a,120,a,44
s_waitcnt lgkmcnt(4)
MV 180,a,124,a,40
MV 184,a,124,a,44
s_waitcnt lgkmcnt(3)
MV 156,a,80,a,48
ds_read_b128 a[112:115], v243 offset:57344
MV 160,a,80,a,52
ds_read_b128 a[116:119], v243 offset:58368
s_waitcnt lgkmcnt(4)
MV 164,a,84,a,48
ds_read_b128 a[120:123], v243 offset:59392
MV 168,a,84,a,52
ds_read_b128 a[124:127], v243 offset:60416
s_waitcnt lgkmcnt(5)
MV 172,a,88,a,48
MV 176,a,88,a,52
s_waitcnt lgkmcnt(4)
MV 180,a,92,a,48
MV 184,a,92,a,52
s_waitcnt lgkmcnt(3)
MV 156,a,112,a,56
ds_read_b128 a[64:67], v242 offset:16384
MV 160,a,112,a,60
ds_read_b128 a[68:71], v242 offset:17408
s_waitcnt lgkmcnt(4)
MV 164,a,116,a,56
ds_read_b128 a[72:75], v242 offset:18432
MV 168,a,116,a,60
ds_read_b128 a[76:79], v242 offset:19456
s_waitcnt lgkmcnt(5)
MV 172,a,120,a,56
MV 176,a,120,a,60
s_waitcnt lgkmcnt(4)
MV 180,a,124,a,56
MV 184,a,124,a,60
s_waitcnt lgkmcnt(3)
MV 124,a,64,a,16
ds_read_b128 a[96:99], v242 offset:24576
MV 128,a,64,a,20
ds_read_b128 a[100:103], v242 offset:25600
s_waitcnt lgkmcnt(4)
MV 132,a,68,a,16
ds_read_b128 a[104:107], v242 offset:26624
v_permlane16_swap_b32 v156, v164
MV 136,a,68,a,20
ds_read_b128 a[108:111], v242 offset:27648
v_permlane16_swap_b32 v157, v165
s_waitcnt lgkmcnt(5)
MV 140,a,72,a,16
v_permlane16_swap_b32 v158, v166
v_permlane16_swap_b32 v159, v167
MV 144,a,72,a,20
v_cvt_pk_bf16_f32 v156, v156, v157
v_cvt_pk_bf16_f32 v157, v158, v159
s_waitcnt lgkmcnt(4)
MV 148,a,76,a,16
v_cvt_pk_bf16_f32 v158, v164, v165
v_cvt_pk_bf16_f32 v159, v166, v167
MV 152,a,76,a,20
buffer_store_dwordx4 v[156:159], v238, s[52:55], s72 offen offset:0 sc1
v_permlane16_swap_b32 v172, v180
s_waitcnt lgkmcnt(3)
MV 124,a,96,a,24
ds_read_b128 a[64:67], v242 offset:32768
v_permlane16_swap_b32 v173, v181
MV 128,a,96,a,28
ds_read_b128 a[68:71], v242 offset:33792
v_permlane16_swap_b32 v174, v182
s_waitcnt lgkmcnt(4)
MV 132,a,100,a,24
ds_read_b128 a[72:75], v242 offset:34816
v_permlane16_swap_b32 v175, v183
MV 136,a,100,a,28
ds_read_b128 a[76:79], v242 offset:35840
v_cvt_pk_bf16_f32 v172, v172, v173
s_waitcnt lgkmcnt(5)
MV 140,a,104,a,24
v_cvt_pk_bf16_f32 v173, v174, v175
v_cvt_pk_bf16_f32 v174, v180, v181
MV 144,a,104,a,28
v_cvt_pk_bf16_f32 v175, v182, v183
buffer_store_dwordx4 v[172:175], v238, s[52:55], s72 offen offset:1024 sc1
s_waitcnt lgkmcnt(4)
MV 148,a,108,a,24
v_permlane16_swap_b32 v160, v168
v_permlane16_swap_b32 v161, v169
MV 152,a,108,a,28
v_permlane16_swap_b32 v162, v170
v_permlane16_swap_b32 v163, v171
s_waitcnt lgkmcnt(3)
MV 124,a,64,a,32
ds_read_b128 a[96:99], v242 offset:40960
v_cvt_pk_bf16_f32 v160, v160, v161
MV 128,a,64,a,36
ds_read_b128 a[100:103], v242 offset:41984
v_cvt_pk_bf16_f32 v161, v162, v163
s_waitcnt lgkmcnt(4)
MV 132,a,68,a,32
ds_read_b128 a[104:107], v242 offset:43008
v_cvt_pk_bf16_f32 v162, v168, v169
MV 136,a,68,a,36
ds_read_b128 a[108:111], v242 offset:44032
v_cvt_pk_bf16_f32 v163, v170, v171
s_waitcnt lgkmcnt(5)
MV 140,a,72,a,32
buffer_store_dwordx4 v[160:163], v238, s[52:55], s72 offen offset:2048 sc1
v_permlane16_swap_b32 v176, v184
MV 144,a,72,a,36
v_permlane16_swap_b32 v177, v185
v_permlane16_swap_b32 v178, v186
s_waitcnt lgkmcnt(4)
MV 148,a,76,a,32
v_permlane16_swap_b32 v179, v187
v_cvt_pk_bf16_f32 v176, v176, v177
MV 152,a,76,a,36
v_cvt_pk_bf16_f32 v177, v178, v179
v_cvt_pk_bf16_f32 v178, v184, v185
s_waitcnt lgkmcnt(3)
MV 124,a,96,a,40
ds_read_b128 a[64:67], v242 offset:49152
v_cvt_pk_bf16_f32 v179, v186, v187
MV 128,a,96,a,44
ds_read_b128 a[68:71], v242 offset:50176
buffer_store_dwordx4 v[176:179], v238, s[52:55], s72 offen offset:3072 sc1
s_waitcnt lgkmcnt(4)
MV 132,a,100,a,40
ds_read_b128 a[72:75], v242 offset:51200
MV 136,a,100,a,44
ds_read_b128 a[76:79], v242 offset:52224
s_waitcnt lgkmcnt(5)
MV 140,a,104,a,40
MV 144,a,104,a,44
s_waitcnt lgkmcnt(4)
MV 148,a,108,a,40
MV 152,a,108,a,44
s_waitcnt lgkmcnt(3)
MV 124,a,64,a,48
ds_read_b128 a[96:99], v242 offset:57344
MV 128,a,64,a,52
ds_read_b128 a[100:103], v242 offset:58368
s_waitcnt lgkmcnt(4)
MV 132,a,68,a,48
ds_read_b128 a[104:107], v242 offset:59392
MV 136,a,68,a,52
ds_read_b128 a[108:111], v242 offset:60416
s_waitcnt lgkmcnt(5)
MV 140,a,72,a,48
MV 144,a,72,a,52
s_waitcnt lgkmcnt(4)
MV 148,a,76,a,48
MV 152,a,76,a,52
s_waitcnt lgkmcnt(3)
MV 124,a,96,a,56
MV 128,a,96,a,60
s_waitcnt lgkmcnt(2)
MV 132,a,100,a,56
MV 136,a,100,a,60
s_waitcnt lgkmcnt(1)
MV 140,a,104,a,56
MV 144,a,104,a,60
s_waitcnt lgkmcnt(0)
MV 148,a,108,a,56
MV 152,a,108,a,60
s_lshl_b32 s72, s2, 14
s_mov_b32 s73, 400000
buffer_load_dwordx4 v[76:79], v238, s[52:55], s72 offen offset:0 sc1
buffer_load_dwordx4 v[80:83], v238, s[52:55], s72 offen offset:1024 sc1
buffer_load_dwordx4 v[84:87], v238, s[52:55], s72 offen offset:2048 sc1
buffer_load_dwordx4 v[88:91], v238, s[52:55], s72 offen offset:3072 sc1
v_permlane16_swap_b32 v124, v132
v_permlane16_swap_b32 v125, v133
v_permlane16_swap_b32 v126, v134
v_permlane16_swap_b32 v127, v135
v_permlane16_swap_b32 v140, v148
v_permlane16_swap_b32 v141, v149
v_permlane16_swap_b32 v142, v150
v_permlane16_swap_b32 v143, v151
v_permlane16_swap_b32 v128, v136
v_permlane16_swap_b32 v129, v137
v_permlane16_swap_b32 v130, v138
v_permlane16_swap_b32 v131, v139
v_permlane16_swap_b32 v144, v152
v_permlane16_swap_b32 v145, v153
v_permlane16_swap_b32 v146, v154
v_permlane16_swap_b32 v147, v155
v_fma_f32 v36, v124, v8, v36
v_fma_f32 v37, v125, v8, v37
v_fma_f32 v38, v126, v8, v38
v_fma_f32 v39, v127, v8, v39
v_fma_f32 v40, v132, v8, v40
v_fma_f32 v41, v133, v8, v41
v_fma_f32 v42, v134, v8, v42
v_fma_f32 v43, v135, v8, v43
v_fma_f32 v44, v140, v8, v44
v_fma_f32 v45, v141, v8, v45
v_fma_f32 v46, v142, v8, v46
v_fma_f32 v47, v143, v8, v47
v_fma_f32 v48, v148, v8, v48
v_fma_f32 v49, v149, v8, v49
v_fma_f32 v50, v150, v8, v50
v_fma_f32 v51, v151, v8, v51
v_fma_f32 v52, v128, v9, v52
v_fma_f32 v53, v129, v9, v53
v_fma_f32 v54, v130, v9, v54
v_fma_f32 v55, v131, v9, v55
v_fma_f32 v56, v136, v9, v56
v_fma_f32 v57, v137, v9, v57
v_fma_f32 v58, v138, v9, v58
v_fma_f32 v59, v139, v9, v59
v_fma_f32 v60, v144, v9, v60
v_fma_f32 v61, v145, v9, v61
v_fma_f32 v62, v146, v9, v62
v_fma_f32 v63, v147, v9, v63
v_fma_f32 v64, v152, v9, v64
v_fma_f32 v65, v153, v9, v65
v_fma_f32 v66, v154, v9, v66
v_fma_f32 v67, v155, v9, v67
s_branch L_xb_chk
L_xb:
buffer_load_dwordx4 v[76:79], v238, s[52:55], s72 offen offset:0 sc1
buffer_load_dwordx4 v[80:83], v238, s[52:55], s72 offen offset:1024 sc1
buffer_load_dwordx4 v[84:87], v238, s[52:55], s72 offen offset:2048 sc1
buffer_load_dwordx4 v[88:91], v238, s[52:55], s72 offen offset:3072 sc1
s_sub_u32 s73, s73, 1
s_cbranch_scc1 L_xb_done
L_xb_chk:
s_waitcnt vmcnt(3)
v_max3_u32 v228, v76, v77, v78
s_waitcnt vmcnt(2)
v_max3_u32 v228, v228, v79, v80
v_max3_u32 v228, v228, v81, v82
s_waitcnt vmcnt(1)
v_max3_u32 v228, v228, v83, v84
v_max3_u32 v228, v228, v85, v86
s_waitcnt vmcnt(0)
v_max3_u32 v228, v228, v87, v88
v_max3_u32 v228, v228, v89, v90
v_max_u32 v228, v228, v91
v_cmp_eq_u32 vcc, -1, v228
s_nop 4
s_cbranch_vccnz L_xb
L_xb_done:
s_waitcnt vmcnt(0)
s_add_u32 s72, s78, 0
v_lshlrev_b32 v92, 16, v76
v_and_b32 v93, 0xffff0000, v76
v_fmac_f32 v36, v92, v8
v_fmac_f32 v37, v93, v8
v_cvt_pk_bf16_f32 v192, v36, v37
v_lshlrev_b32 v92, 16, v77
v_and_b32 v93, 0xffff0000, v77
v_fmac_f32 v38, v92, v8
v_fmac_f32 v39, v93, v8
v_cvt_pk_bf16_f32 v193, v38, v39
v_lshlrev_b32 v92, 16, v78
v_and_b32 v93, 0xffff0000, v78
v_fmac_f32 v40, v92, v8
v_fmac_f32 v41, v93, v8
v_cvt_pk_bf16_f32 v194, v40, v41
v_lshlrev_b32 v92, 16, v79
v_and_b32 v93, 0xffff0000, v79
v_fmac_f32 v42, v92, v8
v_fmac_f32 v43, v93, v8
v_cvt_pk_bf16_f32 v195, v42, v43
buffer_store_dwordx4 v[192:195], v250, s[60:63], s72 offen offset:0 sc1
v_lshlrev_b32 v92, 16, v80
v_and_b32 v93, 0xffff0000, v80
v_fmac_f32 v44, v92, v8
v_fmac_f32 v45, v93, v8
v_cvt_pk_bf16_f32 v196, v44, v45
v_lshlrev_b32 v92, 16, v81
v_and_b32 v93, 0xffff0000, v81
v_fmac_f32 v46, v92, v8
v_fmac_f32 v47, v93, v8
v_cvt_pk_bf16_f32 v197, v46, v47
v_lshlrev_b32 v92, 16, v82
v_and_b32 v93, 0xffff0000, v82
v_fmac_f32 v48, v92, v8
v_fmac_f32 v49, v93, v8
v_cvt_pk_bf16_f32 v198, v48, v49
v_lshlrev_b32 v92, 16, v83
v_and_b32 v93, 0xffff0000, v83
v_fmac_f32 v50, v92, v8
v_fmac_f32 v51, v93, v8
v_cvt_pk_bf16_f32 v199, v50, v51
buffer_store_dwordx4 v[196:199], v250, s[60:63], s72 offen offset:64 sc1
s_add_u32 s72, s78, 32768
v_lshlrev_b32 v92, 16, v84
v_and_b32 v93, 0xffff0000, v84
v_fmac_f32 v52, v92, v9
v_fmac_f32 v53, v93, v9
v_cvt_pk_bf16_f32 v200, v52, v53
v_lshlrev_b32 v92, 16, v85
v_and_b32 v93, 0xffff0000, v85
v_fmac_f32 v54, v92, v9
v_fmac_f32 v55, v93, v9
v_cvt_pk_bf16_f32 v201, v54, v55
v_lshlrev_b32 v92, 16, v86
v_and_b32 v93, 0xffff0000, v86
v_fmac_f32 v56, v92, v9
v_fmac_f32 v57, v93, v9
v_cvt_pk_bf16_f32 v202, v56, v57
v_lshlrev_b32 v92, 16, v87
v_and_b32 v93, 0xffff0000, v87
v_fmac_f32 v58, v92, v9
v_fmac_f32 v59, v93, v9
v_cvt_pk_bf16_f32 v203, v58, v59
buffer_store_dwordx4 v[200:203], v250, s[60:63], s72 offen offset:0 sc1
v_lshlrev_b32 v92, 16, v88
v_and_b32 v93, 0xffff0000, v88
v_fmac_f32 v60, v92, v9
v_fmac_f32 v61, v93, v9
v_cvt_pk_bf16_f32 v204, v60, v61
v_lshlrev_b32 v92, 16, v89
v_and_b32 v93, 0xffff0000, v89
v_fmac_f32 v62, v92, v9
v_fmac_f32 v63, v93, v9
v_cvt_pk_bf16_f32 v205, v62, v63
v_lshlrev_b32 v92, 16, v90
v_and_b32 v93, 0xffff0000, v90
v_fmac_f32 v64, v92, v9
v_fmac_f32 v65, v93, v9
v_cvt_pk_bf16_f32 v206, v64, v65
v_lshlrev_b32 v92, 16, v91
v_and_b32 v93, 0xffff0000, v91
v_fmac_f32 v66, v92, v9
v_fmac_f32 v67, v93, v9
v_cvt_pk_bf16_f32 v207, v66, v67
buffer_store_dwordx4 v[204:207], v250, s[60:63], s72 offen offset:64 sc1
L_end:
s_endpgm
L_p3_pmask:
s_nop 7
v_add_u32 v246, 0, v13
v_cmp_gt_i32_e64 s[84:85], 0, v246
v_cmp_gt_i32_e64 s[86:87], 1, v246
v_cmp_gt_i32_e64 s[88:89], 2, v246
v_cmp_gt_i32_e64 s[90:91], 3, v246
v_cndmask_b32_e64 v96, v96, v14, s[84:85]
v_cndmask_b32_e64 v97, v97, v14, s[86:87]
v_cndmask_b32_e64 v98, v98, v14, s[88:89]
v_cndmask_b32_e64 v99, v99, v14, s[90:91]
v_add_u32 v247, -16, v13
v_cmp_gt_i32_e64 s[92:93], 0, v247
v_cmp_gt_i32_e64 s[94:95], 1, v247
v_cmp_gt_i32_e64 s[96:97], 2, v247
v_cmp_gt_i32_e64 s[98:99], 3, v247
v_cndmask_b32_e64 v100, v100, v14, s[92:93]
v_cndmask_b32_e64 v101, v101, v14, s[94:95]
v_cndmask_b32_e64 v102, v102, v14, s[96:97]
v_cndmask_b32_e64 v103, v103, v14, s[98:99]
v_add_u32 v246, -32, v13
v_cmp_gt_i32_e64 s[84:85], 0, v246
v_cmp_gt_i32_e64 s[86:87], 1, v246
v_cmp_gt_i32_e64 s[88:89], 2, v246
v_cmp_gt_i32_e64 s[90:91], 3, v246
v_cndmask_b32_e64 v128, v128, v14, s[84:85]
v_cndmask_b32_e64 v129, v129, v14, s[86:87]
v_cndmask_b32_e64 v130, v130, v14, s[88:89]
v_cndmask_b32_e64 v131, v131, v14, s[90:91]
v_add_u32 v247, -48, v13
v_cmp_gt_i32_e64 s[92:93], 0, v247
v_cmp_gt_i32_e64 s[94:95], 1, v247
v_cmp_gt_i32_e64 s[96:97], 2, v247
v_cmp_gt_i32_e64 s[98:99], 3, v247
v_cndmask_b32_e64 v132, v132, v14, s[92:93]
v_cndmask_b32_e64 v133, v133, v14, s[94:95]
v_cndmask_b32_e64 v134, v134, v14, s[96:97]
v_cndmask_b32_e64 v135, v135, v14, s[98:99]
s_branch L_p3_pmask_ret
L_p3_mxm_top:
s_waitcnt lgkmcnt(0)
v_xor_b32 v11, 0x8000, v11
v_mfma_f32_16x16x32_bf16 v[80:83], a[128:131], v[16:19], 0
s_add_u32 m0, s73, 16384
ds_read_b128 a[192:195], v11 offset:0
v_mfma_f32_16x16x32_bf16 v[88:91], a[128:131], v[32:35], 0
v_exp_f32 v176, v176
MV 80,a,132,v,20
v_exp_f32 v177, v177
MV 88,a,132,v,36
ds_read_b128 a[196:199], v11 offset:1024
buffer_load_dwordx4 v12, s[56:59], s71 offen offset:0 sc1 lds
MV 80,a,136,v,24
v_exp_f32 v178, v178
MV 88,a,136,v,40
v_add_f32 v2, v2, v176
v_add_f32 v2, v2, v177
MV 80,a,140,v,28
ds_read_b128 a[200:203], v11 offset:2048
ds_read_b128 a[204:207], v11 offset:3072
MV 88,a,140,v,44
v_exp_f32 v179, v179
v_mfma_f32_16x16x32_bf16 v[84:87], a[144:147], v[16:19], 0
ds_read_b128 a[208:211], v11 offset:4096
v_cvt_pk_bf16_f32 v176, v176, v177
v_mfma_f32_16x16x32_bf16 v[92:95], a[144:147], v[32:35], 0
v_exp_f32 v180, v180
MV 84,a,148,v,20
v_add_f32 v2, v2, v178
v_add_f32 v2, v2, v179
MV 92,a,148,v,36
v_exp_f32 v181, v181
MV 84,a,152,v,24
buffer_load_dwordx4 v12, s[56:59], s71 offen offset:1024 sc1 lds
v_cvt_pk_bf16_f32 v177, v178, v179
MV 92,a,152,v,40
v_exp_f32 v182, v182
MV 84,a,156,v,28
ds_read_b128 a[212:215], v11 offset:5120
v_add_f32 v2, v2, v180
MV 92,a,156,v,44
ds_read_b128 a[216:219], v11 offset:6144
v_add_f32 v2, v2, v181
v_mfma_f32_16x16x32_bf16 v[112:115], a[160:163], v[16:19], 0
v_exp_f32 v183, v183
v_mfma_f32_16x16x32_bf16 v[120:123], a[160:163], v[32:35], 0
ds_read_b128 a[220:223], v11 offset:7168
v_cvt_pk_bf16_f32 v178, v180, v181
MV 112,a,164,v,20
v_exp_f32 v184, v184
MV 120,a,164,v,36
v_add_f32 v2, v2, v182
v_add_f32 v2, v2, v183
MV 112,a,168,v,24
ds_read_b128 a[224:227], v11 offset:8192
buffer_load_dwordx4 v12, s[56:59], s71 offen offset:2048 sc1 lds
MV 120,a,168,v,40
v_exp_f32 v185, v185
MV 112,a,172,v,28
ds_read_b128 a[228:231], v11 offset:9216
v_cvt_pk_bf16_f32 v179, v182, v183
MV 120,a,172,v,44
v_exp_f32 v186, v186
v_mfma_f32_16x16x32_bf16 v[116:119], a[176:179], v[16:19], 0
v_add_f32 v3, v3, v184
v_add_f32 v3, v3, v185
v_mfma_f32_16x16x32_bf16 v[124:127], a[176:179], v[32:35], 0
v_exp_f32 v187, v187
MV 116,a,180,v,20
ds_read_b128 a[232:235], v11 offset:10240
v_cvt_pk_bf16_f32 v184, v184, v185
MV 124,a,180,v,36
v_exp_f32 v188, v188
MV 116,a,184,v,24
ds_read_b128 a[236:239], v11 offset:11264
v_add_f32 v3, v3, v186
MV 124,a,184,v,40
buffer_load_dwordx4 v12, s[56:59], s71 offen offset:3072 sc1 lds
v_add_f32 v3, v3, v187
MV 116,a,188,v,28
v_exp_f32 v189, v189
MV 124,a,188,v,44
ds_read_b128 a[240:243], v11 offset:12288
ds_read_b128 a[244:247], v11 offset:13312
ds_read_b128 a[248:251], v11 offset:14336
ds_read_b128 a[252:255], v11 offset:15360
s_add_u32 s71, s71, 16384
s_xor_b32 s73, s73, 0x8000
v_cvt_pk_bf16_f32 v185, v186, v187
v_exp_f32 v190, v190
v_add_f32 v3, v3, v188
v_add_f32 v3, v3, v189
v_exp_f32 v191, v191
v_cvt_pk_bf16_f32 v186, v188, v189
v_exp_f32 v200, v200
v_add_f32 v3, v3, v190
v_add_f32 v3, v3, v191
v_exp_f32 v201, v201
v_cvt_pk_bf16_f32 v187, v190, v191
v_exp_f32 v202, v202
v_add_u32 v246, 0, v13
v_cmp_gt_i32_e64 s[84:85], 0, v246
v_add_f32 v5, v5, v200
v_cmp_gt_i32_e64 s[86:87], 1, v246
v_cmp_gt_i32_e64 s[88:89], 2, v246
v_add_f32 v5, v5, v201
v_exp_f32 v203, v203
v_cmp_gt_i32_e64 s[90:91], 3, v246
v_cndmask_b32_e64 v80, v80, v14, s[84:85]
v_cvt_pk_bf16_f32 v200, v200, v201
v_exp_f32 v204, v204
v_cndmask_b32_e64 v81, v81, v14, s[86:87]
v_cndmask_b32_e64 v82, v82, v14, s[88:89]
v_add_f32 v5, v5, v202
v_add_f32 v5, v5, v203
v_cndmask_b32_e64 v83, v83, v14, s[90:91]
v_exp_f32 v205, v205
v_cvt_pk_bf16_f32 v201, v202, v203
v_add_u32 v247, -16, v13
v_cmp_gt_i32_e64 s[92:93], 0, v247
v_exp_f32 v206, v206
v_add_f32 v5, v5, v204
v_cmp_gt_i32_e64 s[94:95], 1, v247
v_cmp_gt_i32_e64 s[96:97], 2, v247
v_add_f32 v5, v5, v205
v_exp_f32 v207, v207
v_cmp_gt_i32_e64 s[98:99], 3, v247
v_cndmask_b32_e64 v84, v84, v14, s[92:93]
v_cvt_pk_bf16_f32 v202, v204, v205
v_add_f32 v5, v5, v206
v_cndmask_b32_e64 v85, v85, v14, s[94:95]
v_cndmask_b32_e64 v86, v86, v14, s[96:97]
v_add_f32 v5, v5, v207
v_cvt_pk_bf16_f32 v203, v206, v207
v_cndmask_b32_e64 v87, v87, v14, s[98:99]
s_waitcnt vmcnt(16) lgkmcnt(0)
MA 0,a,192,v,144
s_barrier
v_xor_b32 v10, 0x8000, v10
MA 32,a,192,v,152
s_add_u32 m0, s72, 16384
ds_read_b128 a[128:131], v10 offset:0
MA 4,a,196,v,144
buffer_load_dwordx4 v12, s[52:55], s71 offen offset:0 sc1 lds
v_lshrrev_b32 v249, 2, v1
MA 36,a,196,v,152
ds_read_b128 a[132:135], v10 offset:1024
v_and_b32 v248, 7, v249
MA 8,a,200,v,144
v_exp_f32 v80, v80
MA 40,a,200,v,152
v_lshlrev_b32 v249, 8, v249
v_and_b32 v250, 3, v1
MA 12,a,204,v,144
v_exp_f32 v81, v81
MA 44,a,204,v,152
ds_read_b128 a[136:139], v10 offset:2048
v_lshl_add_u32 v249, v250, 3, v249
MA 16,a,208,v,144
v_add_u32 v246, -32, v13
s_lshl_b32 s36, s3, 13
MA 48,a,208,v,152
ds_read_b128 a[140:143], v10 offset:3072
s_add_u32 s36, s36, 131072
MA 20,a,212,v,144
v_exp_f32 v82, v82
MA 52,a,212,v,152
v_cmp_gt_i32_e64 s[84:85], 0, v246
v_add_u32 v249, s36, v249
MA 24,a,216,v,144
s_nop 0
v_xor_b32 v250, 0, v248
MA 56,a,216,v,152
v_exp_f32 v83, v83
MA 28,a,220,v,144
ds_read_b128 a[144:147], v10 offset:4096
v_lshl_add_u32 v250, v250, 5, v249
MA 60,a,220,v,152
v_cmp_gt_i32_e64 s[86:87], 1, v246
TR 96,250,0
MA 124,a,220,v,168
ds_read_b128 a[148:151], v10 offset:5120
buffer_load_dwordx4 v12, s[52:55], s71 offen offset:1024 sc1 lds
MA 120,a,216,v,168
v_cvt_pk_bf16_f32 v80, v80, v81
TR 98,250,4096
MA 116,a,212,v,168
v_xor_b32 v250, 1, v248
v_lshl_add_u32 v250, v250, 5, v249
MA 112,a,208,v,168
v_exp_f32 v84, v84
MA 108,a,204,v,168
v_cmp_gt_i32_e64 s[88:89], 2, v246
TR 100,250,0
MA 104,a,200,v,168
ds_read_b128 a[152:155], v10 offset:6144
TR 102,250,4096
MA 100,a,196,v,168
v_cmp_gt_i32_e64 s[90:91], 3, v246
v_xor_b32 v250, 2, v248
MA 96,a,192,v,168
v_exp_f32 v85, v85
MA 0,a,224,v,176
ds_read_b128 a[156:159], v10 offset:7168
v_lshl_add_u32 v250, v250, 5, v249
MA 32,a,224,v,184
v_cvt_pk_bf16_f32 v81, v82, v83
TR 104,250,0
MA 4,a,228,v,176
v_cndmask_b32_e64 v112, v112, v14, s[84:85]
TR 106,250,4096
MA 36,a,228,v,184
ds_read_b128 a[160:163], v10 offset:8192
v_xor_b32 v250, 3, v248
MA 8,a,232,v,176
v_lshl_add_u32 v250, v250, 5, v249
TR 108,250,0
MA 40,a,232,v,184
v_exp_f32 v86, v86
MA 12,a,236,v,176
ds_read_b128 a[164:167], v10 offset:9216
buffer_load_dwordx4 v12, s[52:55], s71 offen offset:2048 sc1 lds
MA 44,a,236,v,184
v_cndmask_b32_e64 v113, v113, v14, s[86:87]
TR 110,250,4096
MA 16,a,240,v,176
v_xor_b32 v250, 4, v248
v_lshl_add_u32 v250, v250, 5, v249
MA 48,a,240,v,184
v_exp_f32 v87, v87
MA 20,a,244,v,176
ds_read_b128 a[168:171], v10 offset:10240
v_cvt_pk_bf16_f32 v82, v84, v85
MA 52,a,244,v,184
v_cndmask_b32_e64 v114, v114, v14, s[88:89]
TR 128,250,0
MA 24,a,248,v,176
TR 130,250,4096
v_xor_b32 v250, 5, v248
MA 56,a,248,v,184
v_exp_f32 v88, v88
MA 28,a,252,v,176
v_cndmask_b32_e64 v115, v115, v14, s[90:91]
v_lshl_add_u32 v250, v250, 5, v249
MA 60,a,252,v,184
ds_read_b128 a[172:175], v10 offset:11264
TR 132,250,0
MA 124,a,252,v,200
TR 134,250,4096
v_xor_b32 v250, 6, v248
MA 120,a,248,v,200
v_exp_f32 v89, v89
MA 116,a,244,v,200
ds_read_b128 a[176:179], v10 offset:12288
v_add_u32 v247, -48, v13
MA 112,a,240,v,200
v_cvt_pk_bf16_f32 v83, v86, v87
v_lshl_add_u32 v250, v250, 5, v249
MA 108,a,236,v,200
ds_read_b128 a[180:183], v10 offset:13312
TR 136,250,0
MA 104,a,232,v,200
buffer_load_dwordx4 v12, s[52:55], s71 offen offset:3072 sc1 lds
v_cmp_gt_i32_e64 s[92:93], 0, v247
MA 100,a,228,v,200
TR 138,250,4096
v_xor_b32 v250, 7, v248
MA 96,a,224,v,200
ds_read_b128 a[184:187], v10 offset:14336
ds_read_b128 a[188:191], v10 offset:15360
s_xor_b32 s72, s72, 0x8000
v_exp_f32 v90, v90
v_lshl_add_u32 v250, v250, 5, v249
v_exp_f32 v91, v91
v_cmp_gt_i32_e64 s[94:95], 1, v247
TR 140,250,0
TR 142,250,4096
s_add_u32 s32, s40, 100663296
s_addc_u32 s33, s41, 0
v_cvt_pk_bf16_f32 v88, v88, v89
v_cmp_gt_i32_e64 s[96:97], 2, v247
s_mov_b32 s34, 8388608
v_exp_f32 v92, v92
s_mov_b32 s35, 0x20000
s_and_b32 s36, s2, 7
v_cmp_gt_i32_e64 s[98:99], 3, v247
s_lshl_b32 s36, s36, 20
v_exp_f32 v93, v93
s_lshr_b32 s37, s2, 3
v_cndmask_b32_e64 v116, v116, v14, s[92:93]
s_lshl_b32 s37, s37, 15
s_add_u32 s36, s36, s37
v_cvt_pk_bf16_f32 v89, v90, v91
s_lshl_b32 s37, s3, 12
s_add_u32 s36, s36, s37
v_exp_f32 v94, v94
v_cndmask_b32_e64 v117, v117, v14, s[94:95]
s_add_u32 s37, s36, 4096
s_waitcnt lgkmcnt(15)
buffer_store_dwordx4 v[96:99], v12, s[32:35], s36 offen offset:0 sc1
buffer_store_dwordx4 v[100:103], v12, s[32:35], s36 offen offset:1024 sc1
v_exp_f32 v95, v95
v_cndmask_b32_e64 v118, v118, v14, s[96:97]
buffer_store_dwordx4 v[104:107], v12, s[32:35], s36 offen offset:2048 sc1
s_waitcnt lgkmcnt(14)
buffer_store_dwordx4 v[108:111], v12, s[32:35], s36 offen offset:3072 sc1
s_waitcnt lgkmcnt(11)
buffer_store_dwordx4 v[128:131], v12, s[32:35], s37 offen offset:0 sc1
v_cvt_pk_bf16_f32 v90, v92, v93
v_cndmask_b32_e64 v119, v119, v14, s[98:99]
s_waitcnt lgkmcnt(8)
buffer_store_dwordx4 v[132:135], v12, s[32:35], s37 offen offset:1024 sc1
v_cvt_pk_bf16_f32 v91, v94, v95
s_waitcnt lgkmcnt(4)
buffer_store_dwordx4 v[136:139], v12, s[32:35], s37 offen offset:2048 sc1
s_waitcnt lgkmcnt(0)
buffer_store_dwordx4 v[140:143], v12, s[32:35], s37 offen offset:3072 sc1
s_branch L_p3_eps
L_fallback:
s_mov_b32 s81, 0
s_mov_b32 s74, s77
s_mov_b32 s73, s100
s_sub_u32 s72, 15, s70
v_mov_b32 v10, v15
v_add_u32 v11, 16384, v15
s_nop 15
L_fb_set:
s_lshl_b32 s72, s72, 7
s_mov_b32 s71, 0
v_accvgpr_write_b32 a0, 0
v_accvgpr_write_b32 a1, 0
v_accvgpr_write_b32 a2, 0
v_accvgpr_write_b32 a3, 0
v_accvgpr_write_b32 a4, 0
v_accvgpr_write_b32 a5, 0
v_accvgpr_write_b32 a6, 0
v_accvgpr_write_b32 a7, 0
v_accvgpr_write_b32 a8, 0
v_accvgpr_write_b32 a9, 0
v_accvgpr_write_b32 a10, 0
v_accvgpr_write_b32 a11, 0
v_accvgpr_write_b32 a12, 0
v_accvgpr_write_b32 a13, 0
v_accvgpr_write_b32 a14, 0
v_accvgpr_write_b32 a15, 0
v_accvgpr_write_b32 a16, 0
v_accvgpr_write_b32 a17, 0
v_accvgpr_write_b32 a18, 0
v_accvgpr_write_b32 a19, 0
v_accvgpr_write_b32 a20, 0
v_accvgpr_write_b32 a21, 0
v_accvgpr_write_b32 a22, 0
v_accvgpr_write_b32 a23, 0
v_accvgpr_write_b32 a24, 0
v_accvgpr_write_b32 a25, 0
v_accvgpr_write_b32 a26, 0
v_accvgpr_write_b32 a27, 0
v_accvgpr_write_b32 a28, 0
v_accvgpr_write_b32 a29, 0
v_accvgpr_write_b32 a30, 0
v_accvgpr_write_b32 a31, 0
v_accvgpr_write_b32 a32, 0
v_accvgpr_write_b32 a33, 0
v_accvgpr_write_b32 a34, 0
v_accvgpr_write_b32 a35, 0
v_accvgpr_write_b32 a36, 0
v_accvgpr_write_b32 a37, 0
v_accvgpr_write_b32 a38, 0
v_accvgpr_write_b32 a39, 0
v_accvgpr_write_b32 a40, 0
v_accvgpr_write_b32 a41, 0
v_accvgpr_write_b32 a42, 0
v_accvgpr_write_b32 a43, 0
v_accvgpr_write_b32 a44, 0
v_accvgpr_write_b32 a45, 0
v_accvgpr_write_b32 a46, 0
v_accvgpr_write_b32 a47, 0
v_accvgpr_write_b32 a48, 0
v_accvgpr_write_b32 a49, 0
v_accvgpr_write_b32 a50, 0
v_accvgpr_write_b32 a51, 0
v_accvgpr_write_b32 a52, 0
v_accvgpr_write_b32 a53, 0
v_accvgpr_write_b32 a54, 0
v_accvgpr_write_b32 a55, 0
v_accvgpr_write_b32 a56, 0
v_accvgpr_write_b32 a57, 0
v_accvgpr_write_b32 a58, 0
v_accvgpr_write_b32 a59, 0
v_accvgpr_write_b32 a60, 0
v_accvgpr_write_b32 a61, 0
v_accvgpr_write_b32 a62, 0
v_accvgpr_write_b32 a63, 0
v_mov_b32 v2, 0
v_mov_b32 v96, v14
v_mov_b32 v3, 0
v_mov_b32 v97, v14
L_fb_tile:
s_waitcnt vmcnt(0) lgkmcnt(0)
s_barrier
s_mov_b32 m0, s68
s_add_u32 s80, s71, 16384
buffer_load_dwordx4 v12, s[52:55], s71 offen offset:0 sc1 lds
buffer_load_dwordx4 v12, s[52:55], s71 offen offset:1024 sc1 lds
buffer_load_dwordx4 v12, s[52:55], s71 offen offset:2048 sc1 lds
buffer_load_dwordx4 v12, s[52:55], s71 offen offset:3072 sc1 lds
s_add_u32 m0, s68, 16384
s_nop 0
buffer_load_dwordx4 v12, s[56:59], s80 offen offset:0 sc1 lds
buffer_load_dwordx4 v12, s[56:59], s80 offen offset:1024 sc1 lds
buffer_load_dwordx4 v12, s[56:59], s80 offen offset:2048 sc1 lds
buffer_load_dwordx4 v12, s[56:59], s80 offen offset:3072 sc1 lds
s_waitcnt vmcnt(0)
s_barrier
ds_read_b128 a[128:131], v10 offset:0
ds_read_b128 a[132:135], v10 offset:1024
ds_read_b128 a[136:139], v10 offset:2048
ds_read_b128 a[140:143], v10 offset:3072
ds_read_b128 a[144:147], v10 offset:4096
ds_read_b128 a[148:151], v10 offset:5120
ds_read_b128 a[152:155], v10 offset:6144
ds_read_b128 a[156:159], v10 offset:7168
ds_read_b128 a[160:163], v10 offset:8192
ds_read_b128 a[164:167], v10 offset:9216
ds_read_b128 a[168:171], v10 offset:10240
ds_read_b128 a[172:175], v10 offset:11264
ds_read_b128 a[176:179], v10 offset:12288
ds_read_b128 a[180:183], v10 offset:13312
ds_read_b128 a[184:187], v10 offset:14336
ds_read_b128 a[188:191], v10 offset:15360
s_waitcnt lgkmcnt(0)
ds_read_b128 a[192:195], v11 offset:0
ds_read_b128 a[196:199], v11 offset:1024
ds_read_b128 a[200:203], v11 offset:2048
ds_read_b128 a[204:207], v11 offset:3072
ds_read_b128 a[208:211], v11 offset:4096
ds_read_b128 a[212:215], v11 offset:5120
ds_read_b128 a[216:219], v11 offset:6144
ds_read_b128 a[220:223], v11 offset:7168
ds_read_b128 a[224:227], v11 offset:8192
ds_read_b128 a[228:231], v11 offset:9216
ds_read_b128 a[232:235], v11 offset:10240
ds_read_b128 a[236:239], v11 offset:11264
ds_read_b128 a[240:243], v11 offset:12288
ds_read_b128 a[244:247], v11 offset:13312
ds_read_b128 a[248:251], v11 offset:14336
ds_read_b128 a[252:255], v11 offset:15360
v_mfma_f32_16x16x32_bf16 v[80:83], a[128:131], v[16:19], 0
v_mfma_f32_16x16x32_bf16 v[88:91], a[128:131], v[32:35], 0
MV 80,a,132,v,20
MV 88,a,132,v,36
MV 80,a,136,v,24
MV 88,a,136,v,40
MV 80,a,140,v,28
MV 88,a,140,v,44
v_mfma_f32_16x16x32_bf16 v[84:87], a[144:147], v[16:19], 0
v_mfma_f32_16x16x32_bf16 v[92:95], a[144:147], v[32:35], 0
MV 84,a,148,v,20
MV 92,a,148,v,36
MV 84,a,152,v,24
MV 92,a,152,v,40
MV 84,a,156,v,28
MV 92,a,156,v,44
v_mfma_f32_16x16x32_bf16 v[112:115], a[160:163], v[16:19], 0
v_mfma_f32_16x16x32_bf16 v[120:123], a[160:163], v[32:35], 0
MV 112,a,164,v,20
MV 120,a,164,v,36
MV 112,a,168,v,24
MV 120,a,168,v,40
MV 112,a,172,v,28
MV 120,a,172,v,44
v_mfma_f32_16x16x32_bf16 v[116:119], a[176:179], v[16:19], 0
v_mfma_f32_16x16x32_bf16 v[124:127], a[176:179], v[32:35], 0
MV 116,a,180,v,20
MV 124,a,180,v,36
MV 116,a,184,v,24
MV 124,a,184,v,40
MV 116,a,188,v,28
MV 124,a,188,v,44
v_add_u32 v246, s72, v13
v_add_u32 v246, 0, v246
v_cmp_gt_i32_e64 s[84:85], 0, v246
v_cmp_gt_i32_e64 s[86:87], 1, v246
v_cmp_gt_i32_e64 s[88:89], 2, v246
v_cmp_gt_i32_e64 s[90:91], 3, v246
v_cndmask_b32_e64 v80, v80, v14, s[84:85]
v_cndmask_b32_e64 v81, v81, v14, s[86:87]
v_cndmask_b32_e64 v82, v82, v14, s[88:89]
v_cndmask_b32_e64 v83, v83, v14, s[90:91]
v_add_u32 v247, s72, v239
v_add_u32 v247, 0, v247
v_cmp_gt_i32_e64 s[92:93], 0, v247
v_cmp_gt_i32_e64 s[94:95], 1, v247
v_cmp_gt_i32_e64 s[96:97], 2, v247
v_cmp_gt_i32_e64 s[98:99], 3, v247
v_cndmask_b32_e64 v88, v88, v14, s[92:93]
v_cndmask_b32_e64 v89, v89, v14, s[94:95]
v_cndmask_b32_e64 v90, v90, v14, s[96:97]
v_cndmask_b32_e64 v91, v91, v14, s[98:99]
v_add_u32 v246, s72, v13
v_add_u32 v246, -16, v246
v_cmp_gt_i32_e64 s[84:85], 0, v246
v_cmp_gt_i32_e64 s[86:87], 1, v246
v_cmp_gt_i32_e64 s[88:89], 2, v246
v_cmp_gt_i32_e64 s[90:91], 3, v246
v_cndmask_b32_e64 v84, v84, v14, s[84:85]
v_cndmask_b32_e64 v85, v85, v14, s[86:87]
v_cndmask_b32_e64 v86, v86, v14, s[88:89]
v_cndmask_b32_e64 v87, v87, v14, s[90:91]
v_add_u32 v247, s72, v239
v_add_u32 v247, -16, v247
v_cmp_gt_i32_e64 s[92:93], 0, v247
v_cmp_gt_i32_e64 s[94:95], 1, v247
v_cmp_gt_i32_e64 s[96:97], 2, v247
v_cmp_gt_i32_e64 s[98:99], 3, v247
v_cndmask_b32_e64 v92, v92, v14, s[92:93]
v_cndmask_b32_e64 v93, v93, v14, s[94:95]
v_cndmask_b32_e64 v94, v94, v14, s[96:97]
v_cndmask_b32_e64 v95, v95, v14, s[98:99]
v_add_u32 v246, s72, v13
v_add_u32 v246, -32, v246
v_cmp_gt_i32_e64 s[84:85], 0, v246
v_cmp_gt_i32_e64 s[86:87], 1, v246
v_cmp_gt_i32_e64 s[88:89], 2, v246
v_cmp_gt_i32_e64 s[90:91], 3, v246
v_cndmask_b32_e64 v112, v112, v14, s[84:85]
v_cndmask_b32_e64 v113, v113, v14, s[86:87]
v_cndmask_b32_e64 v114, v114, v14, s[88:89]
v_cndmask_b32_e64 v115, v115, v14, s[90:91]
v_add_u32 v247, s72, v239
v_add_u32 v247, -32, v247
v_cmp_gt_i32_e64 s[92:93], 0, v247
v_cmp_gt_i32_e64 s[94:95], 1, v247
v_cmp_gt_i32_e64 s[96:97], 2, v247
v_cmp_gt_i32_e64 s[98:99], 3, v247
v_cndmask_b32_e64 v120, v120, v14, s[92:93]
v_cndmask_b32_e64 v121, v121, v14, s[94:95]
v_cndmask_b32_e64 v122, v122, v14, s[96:97]
v_cndmask_b32_e64 v123, v123, v14, s[98:99]
v_add_u32 v246, s72, v13
v_add_u32 v246, -48, v246
v_cmp_gt_i32_e64 s[84:85], 0, v246
v_cmp_gt_i32_e64 s[86:87], 1, v246
v_cmp_gt_i32_e64 s[88:89], 2, v246
v_cmp_gt_i32_e64 s[90:91], 3, v246
v_cndmask_b32_e64 v116, v116, v14, s[84:85]
v_cndmask_b32_e64 v117, v117, v14, s[86:87]
v_cndmask_b32_e64 v118, v118, v14, s[88:89]
v_cndmask_b32_e64 v119, v119, v14, s[90:91]
v_add_u32 v247, s72, v239
v_add_u32 v247, -48, v247
v_cmp_gt_i32_e64 s[92:93], 0, v247
v_cmp_gt_i32_e64 s[94:95], 1, v247
v_cmp_gt_i32_e64 s[96:97], 2, v247
v_cmp_gt_i32_e64 s[98:99], 3, v247
v_cndmask_b32_e64 v124, v124, v14, s[92:93]
v_cndmask_b32_e64 v125, v125, v14, s[94:95]
v_cndmask_b32_e64 v126, v126, v14, s[96:97]
v_cndmask_b32_e64 v127, v127, v14, s[98:99]
v_mov_b32 v242, v96
v_max3_f32 v242, v242, v80, v81
v_max3_f32 v242, v242, v82, v83
v_max3_f32 v242, v242, v84, v85
v_max3_f32 v242, v242, v86, v87
v_max3_f32 v242, v242, v112, v113
v_max3_f32 v242, v242, v114, v115
v_max3_f32 v242, v242, v116, v117
v_max3_f32 v242, v242, v118, v119
v_mov_b32 v243, v242
s_nop 1
v_permlane32_swap_b32 v242, v243
v_max_f32 v242, v242, v243
v_mov_b32 v243, v242
s_nop 1
v_permlane16_swap_b32 v242, v243
v_max_f32 v242, v242, v243
v_sub_f32 v98, v96, v242
v_exp_f32 v98, v98
v_mov_b32 v96, v242
v_sub_f32 v80, v80, v242
v_sub_f32 v81, v81, v242
v_sub_f32 v82, v82, v242
v_sub_f32 v83, v83, v242
v_sub_f32 v84, v84, v242
v_sub_f32 v85, v85, v242
v_sub_f32 v86, v86, v242
v_sub_f32 v87, v87, v242
v_sub_f32 v112, v112, v242
v_sub_f32 v113, v113, v242
v_sub_f32 v114, v114, v242
v_sub_f32 v115, v115, v242
v_sub_f32 v116, v116, v242
v_sub_f32 v117, v117, v242
v_sub_f32 v118, v118, v242
v_sub_f32 v119, v119, v242
v_mul_f32 v2, v2, v98
v_accvgpr_read_b32 v243, a0
v_mul_f32 v243, v243, v98
v_accvgpr_write_b32 a0, v243
v_accvgpr_read_b32 v243, a1
v_mul_f32 v243, v243, v98
v_accvgpr_write_b32 a1, v243
v_accvgpr_read_b32 v243, a2
v_mul_f32 v243, v243, v98
v_accvgpr_write_b32 a2, v243
v_accvgpr_read_b32 v243, a3
v_mul_f32 v243, v243, v98
v_accvgpr_write_b32 a3, v243
v_accvgpr_read_b32 v243, a4
v_mul_f32 v243, v243, v98
v_accvgpr_write_b32 a4, v243
v_accvgpr_read_b32 v243, a5
v_mul_f32 v243, v243, v98
v_accvgpr_write_b32 a5, v243
v_accvgpr_read_b32 v243, a6
v_mul_f32 v243, v243, v98
v_accvgpr_write_b32 a6, v243
v_accvgpr_read_b32 v243, a7
v_mul_f32 v243, v243, v98
v_accvgpr_write_b32 a7, v243
v_accvgpr_read_b32 v243, a8
v_mul_f32 v243, v243, v98
v_accvgpr_write_b32 a8, v243
v_accvgpr_read_b32 v243, a9
v_mul_f32 v243, v243, v98
v_accvgpr_write_b32 a9, v243
v_accvgpr_read_b32 v243, a10
v_mul_f32 v243, v243, v98
v_accvgpr_write_b32 a10, v243
v_accvgpr_read_b32 v243, a11
v_mul_f32 v243, v243, v98
v_accvgpr_write_b32 a11, v243
v_accvgpr_read_b32 v243, a12
v_mul_f32 v243, v243, v98
v_accvgpr_write_b32 a12, v243
v_accvgpr_read_b32 v243, a13
v_mul_f32 v243, v243, v98
v_accvgpr_write_b32 a13, v243
v_accvgpr_read_b32 v243, a14
v_mul_f32 v243, v243, v98
v_accvgpr_write_b32 a14, v243
v_accvgpr_read_b32 v243, a15
v_mul_f32 v243, v243, v98
v_accvgpr_write_b32 a15, v243
v_accvgpr_read_b32 v243, a16
v_mul_f32 v243, v243, v98
v_accvgpr_write_b32 a16, v243
v_accvgpr_read_b32 v243, a17
v_mul_f32 v243, v243, v98
v_accvgpr_write_b32 a17, v243
v_accvgpr_read_b32 v243, a18
v_mul_f32 v243, v243, v98
v_accvgpr_write_b32 a18, v243
v_accvgpr_read_b32 v243, a19
v_mul_f32 v243, v243, v98
v_accvgpr_write_b32 a19, v243
v_accvgpr_read_b32 v243, a20
v_mul_f32 v243, v243, v98
v_accvgpr_write_b32 a20, v243
v_accvgpr_read_b32 v243, a21
v_mul_f32 v243, v243, v98
v_accvgpr_write_b32 a21, v243
v_accvgpr_read_b32 v243, a22
v_mul_f32 v243, v243, v98
v_accvgpr_write_b32 a22, v243
v_accvgpr_read_b32 v243, a23
v_mul_f32 v243, v243, v98
v_accvgpr_write_b32 a23, v243
v_accvgpr_read_b32 v243, a24
v_mul_f32 v243, v243, v98
v_accvgpr_write_b32 a24, v243
v_accvgpr_read_b32 v243, a25
v_mul_f32 v243, v243, v98
v_accvgpr_write_b32 a25, v243
v_accvgpr_read_b32 v243, a26
v_mul_f32 v243, v243, v98
v_accvgpr_write_b32 a26, v243
v_accvgpr_read_b32 v243, a27
v_mul_f32 v243, v243, v98
v_accvgpr_write_b32 a27, v243
v_accvgpr_read_b32 v243, a28
v_mul_f32 v243, v243, v98
v_accvgpr_write_b32 a28, v243
v_accvgpr_read_b32 v243, a29
v_mul_f32 v243, v243, v98
v_accvgpr_write_b32 a29, v243
v_accvgpr_read_b32 v243, a30
v_mul_f32 v243, v243, v98
v_accvgpr_write_b32 a30, v243
v_accvgpr_read_b32 v243, a31
v_mul_f32 v243, v243, v98
v_accvgpr_write_b32 a31, v243
v_mov_b32 v242, v97
v_max3_f32 v242, v242, v88, v89
v_max3_f32 v242, v242, v90, v91
v_max3_f32 v242, v242, v92, v93
v_max3_f32 v242, v242, v94, v95
v_max3_f32 v242, v242, v120, v121
v_max3_f32 v242, v242, v122, v123
v_max3_f32 v242, v242, v124, v125
v_max3_f32 v242, v242, v126, v127
v_mov_b32 v243, v242
s_nop 1
v_permlane32_swap_b32 v242, v243
v_max_f32 v242, v242, v243
v_mov_b32 v243, v242
s_nop 1
v_permlane16_swap_b32 v242, v243
v_max_f32 v242, v242, v243
v_sub_f32 v99, v97, v242
v_exp_f32 v99, v99
v_mov_b32 v97, v242
v_sub_f32 v88, v88, v242
v_sub_f32 v89, v89, v242
v_sub_f32 v90, v90, v242
v_sub_f32 v91, v91, v242
v_sub_f32 v92, v92, v242
v_sub_f32 v93, v93, v242
v_sub_f32 v94, v94, v242
v_sub_f32 v95, v95, v242
v_sub_f32 v120, v120, v242
v_sub_f32 v121, v121, v242
v_sub_f32 v122, v122, v242
v_sub_f32 v123, v123, v242
v_sub_f32 v124, v124, v242
v_sub_f32 v125, v125, v242
v_sub_f32 v126, v126, v242
v_sub_f32 v127, v127, v242
v_mul_f32 v3, v3, v99
v_accvgpr_read_b32 v243, a32
v_mul_f32 v243, v243, v99
v_accvgpr_write_b32 a32, v243
v_accvgpr_read_b32 v243, a33
v_mul_f32 v243, v243, v99
v_accvgpr_write_b32 a33, v243
v_accvgpr_read_b32 v243, a34
v_mul_f32 v243, v243, v99
v_accvgpr_write_b32 a34, v243
v_accvgpr_read_b32 v243, a35
v_mul_f32 v243, v243, v99
v_accvgpr_write_b32 a35, v243
v_accvgpr_read_b32 v243, a36
v_mul_f32 v243, v243, v99
v_accvgpr_write_b32 a36, v243
v_accvgpr_read_b32 v243, a37
v_mul_f32 v243, v243, v99
v_accvgpr_write_b32 a37, v243
v_accvgpr_read_b32 v243, a38
v_mul_f32 v243, v243, v99
v_accvgpr_write_b32 a38, v243
v_accvgpr_read_b32 v243, a39
v_mul_f32 v243, v243, v99
v_accvgpr_write_b32 a39, v243
v_accvgpr_read_b32 v243, a40
v_mul_f32 v243, v243, v99
v_accvgpr_write_b32 a40, v243
v_accvgpr_read_b32 v243, a41
v_mul_f32 v243, v243, v99
v_accvgpr_write_b32 a41, v243
v_accvgpr_read_b32 v243, a42
v_mul_f32 v243, v243, v99
v_accvgpr_write_b32 a42, v243
v_accvgpr_read_b32 v243, a43
v_mul_f32 v243, v243, v99
v_accvgpr_write_b32 a43, v243
v_accvgpr_read_b32 v243, a44
v_mul_f32 v243, v243, v99
v_accvgpr_write_b32 a44, v243
v_accvgpr_read_b32 v243, a45
v_mul_f32 v243, v243, v99
v_accvgpr_write_b32 a45, v243
v_accvgpr_read_b32 v243, a46
v_mul_f32 v243, v243, v99
v_accvgpr_write_b32 a46, v243
v_accvgpr_read_b32 v243, a47
v_mul_f32 v243, v243, v99
v_accvgpr_write_b32 a47, v243
v_accvgpr_read_b32 v243, a48
v_mul_f32 v243, v243, v99
v_accvgpr_write_b32 a48, v243
v_accvgpr_read_b32 v243, a49
v_mul_f32 v243, v243, v99
v_accvgpr_write_b32 a49, v243
v_accvgpr_read_b32 v243, a50
v_mul_f32 v243, v243, v99
v_accvgpr_write_b32 a50, v243
v_accvgpr_read_b32 v243, a51
v_mul_f32 v243, v243, v99
v_accvgpr_write_b32 a51, v243
v_accvgpr_read_b32 v243, a52
v_mul_f32 v243, v243, v99
v_accvgpr_write_b32 a52, v243
v_accvgpr_read_b32 v243, a53
v_mul_f32 v243, v243, v99
v_accvgpr_write_b32 a53, v243
v_accvgpr_read_b32 v243, a54
v_mul_f32 v243, v243, v99
v_accvgpr_write_b32 a54, v243
v_accvgpr_read_b32 v243, a55
v_mul_f32 v243, v243, v99
v_accvgpr_write_b32 a55, v243
v_accvgpr_read_b32 v243, a56
v_mul_f32 v243, v243, v99
v_accvgpr_write_b32 a56, v243
v_accvgpr_read_b32 v243, a57
v_mul_f32 v243, v243, v99
v_accvgpr_write_b32 a57, v243
v_accvgpr_read_b32 v243, a58
v_mul_f32 v243, v243, v99
v_accvgpr_write_b32 a58, v243
v_accvgpr_read_b32 v243, a59
v_mul_f32 v243, v243, v99
v_accvgpr_write_b32 a59, v243
v_accvgpr_read_b32 v243, a60
v_mul_f32 v243, v243, v99
v_accvgpr_write_b32 a60, v243
v_accvgpr_read_b32 v243, a61
v_mul_f32 v243, v243, v99
v_accvgpr_write_b32 a61, v243
v_accvgpr_read_b32 v243, a62
v_mul_f32 v243, v243, v99
v_accvgpr_write_b32 a62, v243
v_accvgpr_read_b32 v243, a63
v_mul_f32 v243, v243, v99
v_accvgpr_write_b32 a63, v243
v_exp_f32 v80, v80
v_exp_f32 v81, v81
v_exp_f32 v82, v82
v_add_f32 v2, v2, v80
v_add_f32 v2, v2, v81
v_exp_f32 v83, v83
v_cvt_pk_bf16_f32 v80, v80, v81
v_exp_f32 v84, v84
v_add_f32 v2, v2, v82
v_add_f32 v2, v2, v83
v_exp_f32 v85, v85
v_cvt_pk_bf16_f32 v81, v82, v83
v_exp_f32 v86, v86
v_add_f32 v2, v2, v84
v_add_f32 v2, v2, v85
v_exp_f32 v87, v87
v_cvt_pk_bf16_f32 v82, v84, v85
v_exp_f32 v88, v88
v_add_f32 v2, v2, v86
v_add_f32 v2, v2, v87
v_exp_f32 v89, v89
v_cvt_pk_bf16_f32 v83, v86, v87
v_exp_f32 v90, v90
v_add_f32 v3, v3, v88
v_add_f32 v3, v3, v89
v_exp_f32 v91, v91
v_cvt_pk_bf16_f32 v88, v88, v89
v_exp_f32 v92, v92
v_add_f32 v3, v3, v90
v_add_f32 v3, v3, v91
v_exp_f32 v93, v93
v_cvt_pk_bf16_f32 v89, v90, v91
v_exp_f32 v94, v94
v_add_f32 v3, v3, v92
v_add_f32 v3, v3, v93
v_exp_f32 v95, v95
v_cvt_pk_bf16_f32 v90, v92, v93
v_exp_f32 v112, v112
v_add_f32 v3, v3, v94
v_add_f32 v3, v3, v95
v_exp_f32 v113, v113
v_cvt_pk_bf16_f32 v91, v94, v95
v_exp_f32 v114, v114
v_add_f32 v2, v2, v112
v_add_f32 v2, v2, v113
v_exp_f32 v115, v115
v_cvt_pk_bf16_f32 v112, v112, v113
v_exp_f32 v116, v116
v_add_f32 v2, v2, v114
v_add_f32 v2, v2, v115
v_exp_f32 v117, v117
v_cvt_pk_bf16_f32 v113, v114, v115
v_exp_f32 v118, v118
v_add_f32 v2, v2, v116
v_add_f32 v2, v2, v117
v_exp_f32 v119, v119
v_cvt_pk_bf16_f32 v114, v116, v117
v_exp_f32 v120, v120
v_add_f32 v2, v2, v118
v_add_f32 v2, v2, v119
v_exp_f32 v121, v121
v_cvt_pk_bf16_f32 v115, v118, v119
v_exp_f32 v122, v122
v_add_f32 v3, v3, v120
v_add_f32 v3, v3, v121
v_exp_f32 v123, v123
v_cvt_pk_bf16_f32 v120, v120, v121
v_exp_f32 v124, v124
v_add_f32 v3, v3, v122
v_add_f32 v3, v3, v123
v_exp_f32 v125, v125
v_cvt_pk_bf16_f32 v121, v122, v123
v_exp_f32 v126, v126
v_add_f32 v3, v3, v124
v_add_f32 v3, v3, v125
v_exp_f32 v127, v127
v_cvt_pk_bf16_f32 v122, v124, v125
v_add_f32 v3, v3, v126
v_add_f32 v3, v3, v127
v_cvt_pk_bf16_f32 v123, v126, v127
s_waitcnt lgkmcnt(15)
MA 0,a,192,v,80
MA 32,a,192,v,88
s_waitcnt lgkmcnt(14)
MA 4,a,196,v,80
MA 36,a,196,v,88
s_waitcnt lgkmcnt(13)
MA 8,a,200,v,80
MA 40,a,200,v,88
s_waitcnt lgkmcnt(12)
MA 12,a,204,v,80
MA 44,a,204,v,88
s_waitcnt lgkmcnt(11)
MA 16,a,208,v,80
MA 48,a,208,v,88
s_waitcnt lgkmcnt(10)
MA 20,a,212,v,80
MA 52,a,212,v,88
s_waitcnt lgkmcnt(9)
MA 24,a,216,v,80
MA 56,a,216,v,88
s_waitcnt lgkmcnt(8)
MA 28,a,220,v,80
MA 60,a,220,v,88
s_waitcnt lgkmcnt(7)
MA 0,a,224,v,112
MA 32,a,224,v,120
s_waitcnt lgkmcnt(6)
MA 4,a,228,v,112
MA 36,a,228,v,120
s_waitcnt lgkmcnt(5)
MA 8,a,232,v,112
MA 40,a,232,v,120
s_waitcnt lgkmcnt(4)
MA 12,a,236,v,112
MA 44,a,236,v,120
s_waitcnt lgkmcnt(3)
MA 16,a,240,v,112
MA 48,a,240,v,120
s_waitcnt lgkmcnt(2)
MA 20,a,244,v,112
MA 52,a,244,v,120
s_waitcnt lgkmcnt(1)
MA 24,a,248,v,112
MA 56,a,248,v,120
s_waitcnt lgkmcnt(0)
MA 28,a,252,v,112
MA 60,a,252,v,120
s_add_u32 s71, s71, 16384
s_sub_u32 s72, s72, 64
s_sub_u32 s74, s74, 1
s_nop 15
s_cmp_lg_u32 s74, 0
s_cbranch_scc1 L_fb_tile
v_mov_b32 v240, v2
s_nop 1
v_permlane32_swap_b32 v2, v240
v_add_f32 v2, v2, v240
v_mov_b32 v240, v2
s_nop 1
v_permlane16_swap_b32 v2, v240
v_add_f32 v2, v2, v240
v_mov_b32 v240, v3
s_nop 1
v_permlane32_swap_b32 v3, v240
v_add_f32 v3, v3, v240
v_mov_b32 v240, v3
s_nop 1
v_permlane16_swap_b32 v3, v240
v_add_f32 v3, v3, v240
v_rcp_f32 v2, v2
v_rcp_f32 v3, v3
s_add_u32 s80, s73, s76
s_nop 4
v_accvgpr_read_b32 v240, a0
v_accvgpr_read_b32 v241, a1
v_accvgpr_read_b32 v242, a2
v_accvgpr_read_b32 v243, a3
v_accvgpr_read_b32 v244, a4
v_accvgpr_read_b32 v245, a5
v_accvgpr_read_b32 v246, a6
v_accvgpr_read_b32 v247, a7
v_pk_mul_f32 v[240:241], v[240:241], v[2:3] op_sel:[0,0] op_sel_hi:[1,0]
v_pk_mul_f32 v[242:243], v[242:243], v[2:3] op_sel:[0,0] op_sel_hi:[1,0]
v_pk_mul_f32 v[244:245], v[244:245], v[2:3] op_sel:[0,0] op_sel_hi:[1,0]
v_pk_mul_f32 v[246:247], v[246:247], v[2:3] op_sel:[0,0] op_sel_hi:[1,0]
v_cvt_pk_bf16_f32 v248, v240, v241
v_cvt_pk_bf16_f32 v249, v242, v243
v_cvt_pk_bf16_f32 v250, v244, v245
v_cvt_pk_bf16_f32 v251, v246, v247
buffer_store_dwordx4 v[248:251], v15, s[60:63], s73 offen offset:0 sc1
v_accvgpr_read_b32 v240, a8
v_accvgpr_read_b32 v241, a9
v_accvgpr_read_b32 v242, a10
v_accvgpr_read_b32 v243, a11
v_accvgpr_read_b32 v244, a12
v_accvgpr_read_b32 v245, a13
v_accvgpr_read_b32 v246, a14
v_accvgpr_read_b32 v247, a15
v_pk_mul_f32 v[240:241], v[240:241], v[2:3] op_sel:[0,0] op_sel_hi:[1,0]
v_pk_mul_f32 v[242:243], v[242:243], v[2:3] op_sel:[0,0] op_sel_hi:[1,0]
v_pk_mul_f32 v[244:245], v[244:245], v[2:3] op_sel:[0,0] op_sel_hi:[1,0]
v_pk_mul_f32 v[246:247], v[246:247], v[2:3] op_sel:[0,0] op_sel_hi:[1,0]
v_cvt_pk_bf16_f32 v252, v240, v241
v_cvt_pk_bf16_f32 v253, v242, v243
v_cvt_pk_bf16_f32 v254, v244, v245
v_cvt_pk_bf16_f32 v255, v246, v247
buffer_store_dwordx4 v[252:255], v15, s[60:63], s73 offen offset:1024 sc1
v_accvgpr_read_b32 v240, a16
v_accvgpr_read_b32 v241, a17
v_accvgpr_read_b32 v242, a18
v_accvgpr_read_b32 v243, a19
v_accvgpr_read_b32 v244, a20
v_accvgpr_read_b32 v245, a21
v_accvgpr_read_b32 v246, a22
v_accvgpr_read_b32 v247, a23
v_pk_mul_f32 v[240:241], v[240:241], v[2:3] op_sel:[0,0] op_sel_hi:[1,0]
v_pk_mul_f32 v[242:243], v[242:243], v[2:3] op_sel:[0,0] op_sel_hi:[1,0]
v_pk_mul_f32 v[244:245], v[244:245], v[2:3] op_sel:[0,0] op_sel_hi:[1,0]
v_pk_mul_f32 v[246:247], v[246:247], v[2:3] op_sel:[0,0] op_sel_hi:[1,0]
v_cvt_pk_bf16_f32 v248, v240, v241
v_cvt_pk_bf16_f32 v249, v242, v243
v_cvt_pk_bf16_f32 v250, v244, v245
v_cvt_pk_bf16_f32 v251, v246, v247
buffer_store_dwordx4 v[248:251], v15, s[60:63], s73 offen offset:2048 sc1
v_accvgpr_read_b32 v240, a24
v_accvgpr_read_b32 v241, a25
v_accvgpr_read_b32 v242, a26
v_accvgpr_read_b32 v243, a27
v_accvgpr_read_b32 v244, a28
v_accvgpr_read_b32 v245, a29
v_accvgpr_read_b32 v246, a30
v_accvgpr_read_b32 v247, a31
v_pk_mul_f32 v[240:241], v[240:241], v[2:3] op_sel:[0,0] op_sel_hi:[1,0]
v_pk_mul_f32 v[242:243], v[242:243], v[2:3] op_sel:[0,0] op_sel_hi:[1,0]
v_pk_mul_f32 v[244:245], v[244:245], v[2:3] op_sel:[0,0] op_sel_hi:[1,0]
v_pk_mul_f32 v[246:247], v[246:247], v[2:3] op_sel:[0,0] op_sel_hi:[1,0]
v_cvt_pk_bf16_f32 v252, v240, v241
v_cvt_pk_bf16_f32 v253, v242, v243
v_cvt_pk_bf16_f32 v254, v244, v245
v_cvt_pk_bf16_f32 v255, v246, v247
buffer_store_dwordx4 v[252:255], v15, s[60:63], s73 offen offset:3072 sc1
v_accvgpr_read_b32 v240, a32
v_accvgpr_read_b32 v241, a33
v_accvgpr_read_b32 v242, a34
v_accvgpr_read_b32 v243, a35
v_accvgpr_read_b32 v244, a36
v_accvgpr_read_b32 v245, a37
v_accvgpr_read_b32 v246, a38
v_accvgpr_read_b32 v247, a39
v_pk_mul_f32 v[240:241], v[240:241], v[2:3] op_sel:[0,1] op_sel_hi:[1,1]
v_pk_mul_f32 v[242:243], v[242:243], v[2:3] op_sel:[0,1] op_sel_hi:[1,1]
v_pk_mul_f32 v[244:245], v[244:245], v[2:3] op_sel:[0,1] op_sel_hi:[1,1]
v_pk_mul_f32 v[246:247], v[246:247], v[2:3] op_sel:[0,1] op_sel_hi:[1,1]
v_cvt_pk_bf16_f32 v248, v240, v241
v_cvt_pk_bf16_f32 v249, v242, v243
v_cvt_pk_bf16_f32 v250, v244, v245
v_cvt_pk_bf16_f32 v251, v246, v247
buffer_store_dwordx4 v[248:251], v15, s[60:63], s80 offen offset:0 sc1
v_accvgpr_read_b32 v240, a40
v_accvgpr_read_b32 v241, a41
v_accvgpr_read_b32 v242, a42
v_accvgpr_read_b32 v243, a43
v_accvgpr_read_b32 v244, a44
v_accvgpr_read_b32 v245, a45
v_accvgpr_read_b32 v246, a46
v_accvgpr_read_b32 v247, a47
v_pk_mul_f32 v[240:241], v[240:241], v[2:3] op_sel:[0,1] op_sel_hi:[1,1]
v_pk_mul_f32 v[242:243], v[242:243], v[2:3] op_sel:[0,1] op_sel_hi:[1,1]
v_pk_mul_f32 v[244:245], v[244:245], v[2:3] op_sel:[0,1] op_sel_hi:[1,1]
v_pk_mul_f32 v[246:247], v[246:247], v[2:3] op_sel:[0,1] op_sel_hi:[1,1]
v_cvt_pk_bf16_f32 v252, v240, v241
v_cvt_pk_bf16_f32 v253, v242, v243
v_cvt_pk_bf16_f32 v254, v244, v245
v_cvt_pk_bf16_f32 v255, v246, v247
buffer_store_dwordx4 v[252:255], v15, s[60:63], s80 offen offset:1024 sc1
v_accvgpr_read_b32 v240, a48
v_accvgpr_read_b32 v241, a49
v_accvgpr_read_b32 v242, a50
v_accvgpr_read_b32 v243, a51
v_accvgpr_read_b32 v244, a52
v_accvgpr_read_b32 v245, a53
v_accvgpr_read_b32 v246, a54
v_accvgpr_read_b32 v247, a55
v_pk_mul_f32 v[240:241], v[240:241], v[2:3] op_sel:[0,1] op_sel_hi:[1,1]
v_pk_mul_f32 v[242:243], v[242:243], v[2:3] op_sel:[0,1] op_sel_hi:[1,1]
v_pk_mul_f32 v[244:245], v[244:245], v[2:3] op_sel:[0,1] op_sel_hi:[1,1]
v_pk_mul_f32 v[246:247], v[246:247], v[2:3] op_sel:[0,1] op_sel_hi:[1,1]
v_cvt_pk_bf16_f32 v248, v240, v241
v_cvt_pk_bf16_f32 v249, v242, v243
v_cvt_pk_bf16_f32 v250, v244, v245
v_cvt_pk_bf16_f32 v251, v246, v247
buffer_store_dwordx4 v[248:251], v15, s[60:63], s80 offen offset:2048 sc1
v_accvgpr_read_b32 v240, a56
v_accvgpr_read_b32 v241, a57
v_accvgpr_read_b32 v242, a58
v_accvgpr_read_b32 v243, a59
v_accvgpr_read_b32 v244, a60
v_accvgpr_read_b32 v245, a61
v_accvgpr_read_b32 v246, a62
v_accvgpr_read_b32 v247, a63
v_pk_mul_f32 v[240:241], v[240:241], v[2:3] op_sel:[0,1] op_sel_hi:[1,1]
v_pk_mul_f32 v[242:243], v[242:243], v[2:3] op_sel:[0,1] op_sel_hi:[1,1]
v_pk_mul_f32 v[244:245], v[244:245], v[2:3] op_sel:[0,1] op_sel_hi:[1,1]
v_pk_mul_f32 v[246:247], v[246:247], v[2:3] op_sel:[0,1] op_sel_hi:[1,1]
v_cvt_pk_bf16_f32 v252, v240, v241
v_cvt_pk_bf16_f32 v253, v242, v243
v_cvt_pk_bf16_f32 v254, v244, v245
v_cvt_pk_bf16_f32 v255, v246, v247
buffer_store_dwordx4 v[252:255], v15, s[60:63], s80 offen offset:3072 sc1
s_cmp_lg_u32 s81, 0
s_cbranch_scc1 L_fb_done
s_mov_b32 s81, 1
s_sub_u32 s74, 34, s77
s_mov_b32 s73, s101
s_mov_b32 s72, s70
v_mov_b32 v16, v48
v_mov_b32 v17, v49
v_mov_b32 v18, v50
v_mov_b32 v19, v51
v_mov_b32 v20, v52
v_mov_b32 v21, v53
v_mov_b32 v22, v54
v_mov_b32 v23, v55
v_mov_b32 v24, v56
v_mov_b32 v25, v57
v_mov_b32 v26, v58
v_mov_b32 v27, v59
v_mov_b32 v28, v60
v_mov_b32 v29, v61
v_mov_b32 v30, v62
v_mov_b32 v31, v63
v_mov_b32 v32, v64
v_mov_b32 v33, v65
v_mov_b32 v34, v66
v_mov_b32 v35, v67
v_mov_b32 v36, v68
v_mov_b32 v37, v69
v_mov_b32 v38, v70
v_mov_b32 v39, v71
v_mov_b32 v40, v72
v_mov_b32 v41, v73
v_mov_b32 v42, v74
v_mov_b32 v43, v75
v_mov_b32 v44, v76
v_mov_b32 v45, v77
v_mov_b32 v46, v78
v_mov_b32 v47, v79
s_branch L_fb_set
L_fb_done:
s_waitcnt vmcnt(0) lgkmcnt(0)
s_barrier
s_load_dwordx2 s[88:89], s[0:1], 104
s_mul_i32 s36, s3, 8320
v_and_b32 v16, 15, v1
v_lshrrev_b32 v17, 4, v1
v_add_u32 v18, 1, v16
v_and_b32 v19, 1, v18
v_mul_u32_u24 v19, 4160, v19
v_add_u32 v18, 2, v16
v_lshrrev_b32 v18, 1, v18
v_lshl_add_u32 v19, v18, 2, v19
v_lshl_add_u32 v19, v17, 4, v19
v_add_u32 v40, s36, v19
v_add_u32 v41, 1024, v40
v_add_u32 v42, 2048, v40
v_add_u32 v43, 3072, v40
v_add_u32 v10, s36, v15
v_lshlrev_b32 v18, 5, v16
v_lshlrev_b32 v19, 4, v17
v_sub_u32 v19, v19, v18
s_add_u32 s37, s43, 480
v_add_u32 v5, s37, v19
v_mov_b32 v20, 0
v_mov_b32 v21, 0
v_mov_b32 v22, 0
v_mov_b32 v23, 0
v_and_b32 v16, 1, v1
v_mul_u32_u24 v16, 4160, v16
v_and_b32 v17, 2, v1
v_lshl_add_u32 v16, v17, 3, v16
v_add_u32 v16, s36, v16
ds_write_b128 v16, v[20:23]
v_and_b32 v17, 31, v1
v_lshlrev_b32 v17, 4, v17
v_add_u32 v17, s43, v17
ds_write_b128 v17, v[20:23] offset:4096
v_mov_b32 v18, 0
ds_write_b128 v10, v[208:211] offset:32
s_nop 0
v_mov_b32_dpp v18, v211 wave_shr:1 row_mask:0xf bank_mask:0xf
v_alignbit_b32 v24, v208, v18, 16
v_alignbit_b32 v25, v209, v208, 16
v_alignbit_b32 v26, v210, v209, 16
v_alignbit_b32 v27, v211, v210, 16
ds_write_b128 v10, v[24:27] offset:4192
v_mov_b32_dpp v18, v211 wave_ror:1 row_mask:0xf bank_mask:0xf
ds_write_b128 v10, v[212:215] offset:1056
s_nop 0
v_mov_b32_dpp v18, v215 wave_shr:1 row_mask:0xf bank_mask:0xf
v_alignbit_b32 v28, v212, v18, 16
v_alignbit_b32 v29, v213, v212, 16
v_alignbit_b32 v30, v214, v213, 16
v_alignbit_b32 v31, v215, v214, 16
ds_write_b128 v10, v[28:31] offset:5216
v_mov_b32_dpp v18, v215 wave_ror:1 row_mask:0xf bank_mask:0xf
ds_write_b128 v10, v[228:231] offset:2080
s_nop 0
v_mov_b32_dpp v18, v231 wave_shr:1 row_mask:0xf bank_mask:0xf
v_alignbit_b32 v24, v228, v18, 16
v_alignbit_b32 v25, v229, v228, 16
v_alignbit_b32 v26, v230, v229, 16
v_alignbit_b32 v27, v231, v230, 16
ds_write_b128 v10, v[24:27] offset:6240
v_mov_b32_dpp v18, v231 wave_ror:1 row_mask:0xf bank_mask:0xf
ds_write_b128 v10, v[234:237] offset:3104
s_nop 0
v_mov_b32_dpp v18, v237 wave_shr:1 row_mask:0xf bank_mask:0xf
v_alignbit_b32 v28, v234, v18, 16
v_alignbit_b32 v29, v235, v234, 16
v_alignbit_b32 v30, v236, v235, 16
v_alignbit_b32 v31, v237, v236, 16
ds_write_b128 v10, v[28:31] offset:7264
ds_read_b128 a[160:163], v5 offset:3584
ds_read2_b32 a[128:129], v40 offset0:0 offset1:1
ds_read2_b32 a[130:131], v40 offset0:2 offset1:3
ds_read_b128 a[164:167], v5 offset:3072
ds_read2_b32 a[132:133], v40 offset0:128 offset1:129
ds_read2_b32 a[134:135], v40 offset0:130 offset1:131
ds_read_b128 a[168:171], v5 offset:2560
ds_read2_b32 a[136:137], v41 offset0:0 offset1:1
ds_read2_b32 a[138:139], v41 offset0:2 offset1:3
ds_read_b128 a[172:175], v5 offset:2048
ds_read2_b32 a[140:141], v41 offset0:128 offset1:129
ds_read2_b32 a[142:143], v41 offset0:130 offset1:131
ds_read_b128 a[176:179], v5 offset:1536
ds_read2_b32 a[144:145], v42 offset0:0 offset1:1
ds_read2_b32 a[146:147], v42 offset0:2 offset1:3
ds_read_b128 a[180:183], v5 offset:1024
ds_read2_b32 a[148:149], v42 offset0:128 offset1:129
ds_read2_b32 a[150:151], v42 offset0:130 offset1:131
ds_read_b128 a[184:187], v5 offset:512
ds_read2_b32 a[152:153], v43 offset0:0 offset1:1
ds_read2_b32 a[154:155], v43 offset0:2 offset1:3
ds_read_b128 a[188:191], v5 offset:0
ds_read2_b32 a[156:157], v43 offset0:128 offset1:129
ds_read2_b32 a[158:159], v43 offset0:130 offset1:131
s_waitcnt lgkmcnt(0)
s_branch L_p3_done
L_spin_go:
s_mov_b32 s36, 400000
L_spin_go_l:
s_sleep 1
buffer_load_dword v254, off, s[12:15], 0 sc1
s_waitcnt vmcnt(0)
v_cmp_gt_u32 vcc, 1, v254
s_nop 4
s_cbranch_vccz L_spin_go_ret
s_sub_u32 s36, s36, 1
s_cmp_lg_u32 s36, 0
s_cbranch_scc1 L_spin_go_l
s_branch L_spin_go_ret
L_spin_f1:
s_mov_b32 s36, 400000
L_spin_f1_l:
s_sleep 1
buffer_load_dword v238, v233, s[8:11], 0 offen offset:0 sc1
s_waitcnt vmcnt(0)
v_cmp_gt_u32 vcc, 1, v238
s_nop 4
s_cbranch_vccz L_spin_f1_ret
s_sub_u32 s36, s36, 1
s_cmp_lg_u32 s36, 0
s_cbranch_scc1 L_spin_f1_l
s_branch L_spin_f1_ret
L_spin_w:
s_mov_b32 s36, 400000
L_spin_w_l:
s_sleep 1
buffer_load_dword v253, v254, s[8:11], 0 offen offset:1024 sc1
s_waitcnt vmcnt(0)
v_cmp_gt_u32 vcc, 1, v253
s_nop 4
s_cbranch_vccz L_spin_w_ret
s_sub_u32 s36, s36, 1
s_cmp_lg_u32 s36, 0
s_cbranch_scc1 L_spin_w_l
s_branch L_spin_w_ret
L_spin_f2:
s_mov_b32 s36, 400000
L_spin_f2_l:
s_sleep 1
buffer_load_dword v253, v252, s[8:11], 0 offen sc1
s_waitcnt vmcnt(0)
v_cmp_gt_u32 vcc, 1, v253
s_nop 4
s_cbranch_vccz L_spin_f2_ret
s_sub_u32 s36, s36, 1
s_cmp_lg_u32 s36, 0
s_cbranch_scc1 L_spin_f2_l
s_branch L_spin_f2_ret
L_p5_x1:
v_mov_b32 v253, 1
s_lshl_b32 s36, s2, 2
buffer_store_dword v253, v255, s[8:11], s36 offen offset:2048 sc1
v_and_b32 v254, 15, v1
s_lshl_b32 s36, s82, 4
v_add_u32 v254, s36, v254
v_lshlrev_b32 v254, 2, v254
s_branch L_p5_loop
L_p5_x2:
buffer_load_dword v253, v254, s[8:11], 0 offen offset:2048 sc1
s_branch L_p5_loop
L_spin_f3:
s_mov_b32 s36, 400000
L_spin_f3_l:
s_sleep 1
buffer_load_dword v253, v254, s[8:11], 0 offen offset:2048 sc1
s_waitcnt vmcnt(0)
v_cmp_gt_u32 vcc, 1, v253
s_nop 4
s_cbranch_vccz L_spin_f3_ret
s_sub_u32 s36, s36, 1
s_cmp_lg_u32 s36, 0
s_cbranch_scc1 L_spin_f3_l
s_branch L_spin_f3_ret
L_code_end:
s_endpgm
.section .rodata,"a"
.p2align 6
.amdhsa_kernel gated_mix__ssm_conv_h3__compressed_kv_cla__prompt_kernel
  .amdhsa_next_free_vgpr 512
  .amdhsa_next_free_sgpr 102
  .amdhsa_accum_offset 256
  .amdhsa_group_segment_fixed_size 0
  .amdhsa_kernarg_size 128
  .amdhsa_user_sgpr_count 2
  .amdhsa_user_sgpr_kernarg_segment_ptr 1
  .amdhsa_system_sgpr_workgroup_id_x 1
  .amdhsa_float_denorm_mode_32 3
.end_amdhsa_kernel
.text
```
